```python
import torch

def _softmax(x, axis=-1):
    return torch.softmax(x, dim=axis)
def _gelu(x):
    return torch.nn.functional.gelu(x, approximate="tanh")
def _silu(x):
    return torch.nn.functional.silu(x)
def _sigmoid(x):
    return torch.sigmoid(x)
def _layernorm(x, axis=-1, eps=1e-5):
    m = x.mean(dim=axis, keepdim=True)
    v = x.var(dim=axis, keepdim=True, unbiased=False)
    return (x - m) / torch.sqrt(v + eps)
def _scatter_add(tgt, idx, src, axis=0):
    return tgt.clone().index_add_(axis, idx, src)
def _segment_sum(src, seg, n):
    out = torch.zeros((n,) + src.shape[1:], dtype=src.dtype)
    return out.index_add_(0, seg, src)
def _pad(x, pw):
    flat = tuple(v for pair in reversed(pw) for v in pair)
    return torch.nn.functional.pad(x, flat)

kernel_name = 'standalone__winograd__vision'

def setup_inputs():

    _w = (lambda a: (lambda t: t.to(torch.bfloat16) if t.is_floating_point() else t)(torch.as_tensor(a)))
    H = W = 512 // 2 * 2
    C = 192
    return {
        "x": _w((lambda *s: torch.randn(*s, dtype=torch.bfloat16) * 0.05)(1, H, W, C)),
        "w": _w((lambda *s: torch.randn(*s, dtype=torch.bfloat16) * 0.05)(3, 3, C, C)),
    }

def reference(x, w):
    N, H, W, C = x.shape
    K = w.shape[-1]
    G  = torch.as_tensor([[1.0,0.0,0.0],[0.5,0.5,0.5],[0.5,-0.5,0.5],[0.0,0.0,1.0]], dtype=x.dtype)
    Bt = torch.as_tensor([[1.0,0.0,-1.0,0.0],[0.0,1.0,1.0,0.0],[0.0,-1.0,1.0,0.0],[0.0,1.0,0.0,-1.0]], dtype=x.dtype)
    At = torch.as_tensor([[1.0,1.0,1.0,0.0],[0.0,1.0,-1.0,-1.0]], dtype=x.dtype)
    U = torch.einsum("ar,rsck,bs->abck", G, w, G)
    xp = _pad(x, ((0,0),(1,1),(1,1),(0,0)))
    nH, nW = H // 2, W // 2
    patches = []
    for i in range(4):
        for j in range(4):
            patches.append(xp[:, i:i + 2 * nH:2, j:j + 2 * nW:2, :])
    d = torch.stack(patches).reshape(4, 4, N * nH * nW, C)
    V = torch.einsum("ai,ijpc,bj->abpc", Bt, d, Bt)
    M = torch.einsum("abck,abpc->abpk", U, V)
    Y = torch.einsum("ma,abpk,nb->pmnk", At, M, At)
    Y = Y.reshape(N, nH, nW, 2, 2, K)
    Y = (lambda x, *d: x.permute(*d))(Y, 0, 1, 3, 2, 4, 5).reshape(N, H, W, K)
    return Y
```

```asm
; @launch kernel=wtrans_kernel grid=(216,1,1) block=(64,1,1) lds=0
; @launch kernel=standalone__winograd__vision_kernel grid=(256,1,1) block=(256,1,1) lds=156672
.amdgcn_target "amdgcn-amd-amdhsa--gfx950"
.macro M d,a,b,c
v_mfma_f32_16x16x32_bf16 \d,\a,\b,\c
.endm
.text
.globl wtrans_kernel
.p2align 8
.type wtrans_kernel,@function
wtrans_kernel:
s_cmp_ge_u32 s2,216
s_cbranch_scc1 L_uend
s_load_dwordx2 s[4:5],s[0:1],8
s_load_dwordx2 s[6:7],s[0:1],32
s_mul_hi_u32 s20,s2,0x55555556
s_mul_i32 s21,s20,3
s_sub_u32 s21,s2,s21
s_mul_hi_u32 s22,s20,0x55555556
s_mul_i32 s23,s22,3
s_sub_u32 s23,s20,s23
s_mul_hi_u32 s24,s22,0x2aaaaaab
s_mul_i32 s25,s24,6
s_sub_u32 s25,s22,s25
v_and_b32 v1,15,v0
v_lshrrev_b32 v2,4,v0
v_lshrrev_b32 v3,2,v1
v_and_b32 v4,3,v1
v_lshl_add_u32 v3,v3,3,v4
s_lshl_b32 s26,s23,2
v_add_u32 v3,s26,v3
v_add_u32 v4,32,v1
s_cmp_eq_u32 s23,2
s_cselect_b64 vcc,-1,0
v_cndmask_b32 v3,v3,v4,vcc
s_mul_i32 s26,s24,48
v_add_u32 v3,s26,v3
v_lshlrev_b32 v3,1,v3
v_mul_u32_u24 v4,3072,v2
v_add_u32 v3,v3,v4
s_mul_i32 s26,s21,221184
s_mul_i32 s27,s25,12288
s_add_u32 s26,s26,s27
s_add_u32 s27,s26,73728
s_add_u32 s28,s27,73728
s_waitcnt lgkmcnt(0)
s_mov_b32 s8,s4
s_and_b32 s9,s5,0xffff
s_mov_b32 s10,663552
s_mov_b32 s11,0x20000
s_mov_b32 s12,s6
s_and_b32 s13,s7,0xffff
s_mov_b32 s14,1327104
s_mov_b32 s15,0x20000
buffer_load_short_d16_hi v8,v3,s[8:11],s26 offen offset:0
buffer_load_short_d16_hi v9,v3,s[8:11],s26 offen offset:384
buffer_load_short_d16_hi v10,v3,s[8:11],s26 offen offset:768
buffer_load_short_d16_hi v11,v3,s[8:11],s26 offen offset:1152
buffer_load_short_d16_hi v12,v3,s[8:11],s26 offen offset:1536
buffer_load_short_d16_hi v13,v3,s[8:11],s26 offen offset:1920
buffer_load_short_d16_hi v14,v3,s[8:11],s26 offen offset:2304
buffer_load_short_d16_hi v15,v3,s[8:11],s26 offen offset:2688
buffer_load_short_d16_hi v16,v3,s[8:11],s27 offen offset:0
buffer_load_short_d16_hi v17,v3,s[8:11],s27 offen offset:384
buffer_load_short_d16_hi v18,v3,s[8:11],s27 offen offset:768
buffer_load_short_d16_hi v19,v3,s[8:11],s27 offen offset:1152
buffer_load_short_d16_hi v20,v3,s[8:11],s27 offen offset:1536
buffer_load_short_d16_hi v21,v3,s[8:11],s27 offen offset:1920
buffer_load_short_d16_hi v22,v3,s[8:11],s27 offen offset:2304
buffer_load_short_d16_hi v23,v3,s[8:11],s27 offen offset:2688
buffer_load_short_d16_hi v24,v3,s[8:11],s28 offen offset:0
buffer_load_short_d16_hi v25,v3,s[8:11],s28 offen offset:384
buffer_load_short_d16_hi v26,v3,s[8:11],s28 offen offset:768
buffer_load_short_d16_hi v27,v3,s[8:11],s28 offen offset:1152
buffer_load_short_d16_hi v28,v3,s[8:11],s28 offen offset:1536
buffer_load_short_d16_hi v29,v3,s[8:11],s28 offen offset:1920
buffer_load_short_d16_hi v30,v3,s[8:11],s28 offen offset:2304
buffer_load_short_d16_hi v31,v3,s[8:11],s28 offen offset:2688
s_mul_i32 s30,s24,331776
s_mul_i32 s31,s25,55296
s_add_u32 s30,s30,s31
s_mul_i32 s31,s23,3072
s_add_u32 s30,s30,s31
s_lshl_b32 s31,s21,10
s_add_u32 s30,s30,s31
v_lshlrev_b32 v5,4,v0
s_mov_b32 s33,0xbe2aaaab
s_mov_b32 s34,0x3d2aaaab
s_mov_b32 s35,0x3e2aaaab
s_mov_b32 s36,0x3daaaaab
s_waitcnt vmcnt(0)
v_add_f32 v6,v8,v24
v_add_f32 v32,v6,v16
v_sub_f32 v40,v6,v16
v_mul_f32 v32,s33,v32
v_mul_f32 v40,s33,v40
v_mul_f32 v6,s34,v8
v_fmac_f32 v6,s35,v24
v_fma_f32 v48,s36,v16,v6
v_fma_f32 v56,-s36,v16,v6
v_add_f32 v6,v9,v25
v_add_f32 v33,v6,v17
v_sub_f32 v41,v6,v17
v_mul_f32 v33,s33,v33
v_mul_f32 v41,s33,v41
v_mul_f32 v6,s34,v9
v_fmac_f32 v6,s35,v25
v_fma_f32 v49,s36,v17,v6
v_fma_f32 v57,-s36,v17,v6
v_add_f32 v6,v10,v26
v_add_f32 v34,v6,v18
v_sub_f32 v42,v6,v18
v_mul_f32 v34,s33,v34
v_mul_f32 v42,s33,v42
v_mul_f32 v6,s34,v10
v_fmac_f32 v6,s35,v26
v_fma_f32 v50,s36,v18,v6
v_fma_f32 v58,-s36,v18,v6
v_add_f32 v6,v11,v27
v_add_f32 v35,v6,v19
v_sub_f32 v43,v6,v19
v_mul_f32 v35,s33,v35
v_mul_f32 v43,s33,v43
v_mul_f32 v6,s34,v11
v_fmac_f32 v6,s35,v27
v_fma_f32 v51,s36,v19,v6
v_fma_f32 v59,-s36,v19,v6
v_add_f32 v6,v12,v28
v_add_f32 v36,v6,v20
v_sub_f32 v44,v6,v20
v_mul_f32 v36,s33,v36
v_mul_f32 v44,s33,v44
v_mul_f32 v6,s34,v12
v_fmac_f32 v6,s35,v28
v_fma_f32 v52,s36,v20,v6
v_fma_f32 v60,-s36,v20,v6
v_add_f32 v6,v13,v29
v_add_f32 v37,v6,v21
v_sub_f32 v45,v6,v21
v_mul_f32 v37,s33,v37
v_mul_f32 v45,s33,v45
v_mul_f32 v6,s34,v13
v_fmac_f32 v6,s35,v29
v_fma_f32 v53,s36,v21,v6
v_fma_f32 v61,-s36,v21,v6
v_add_f32 v6,v14,v30
v_add_f32 v38,v6,v22
v_sub_f32 v46,v6,v22
v_mul_f32 v38,s33,v38
v_mul_f32 v46,s33,v46
v_mul_f32 v6,s34,v14
v_fmac_f32 v6,s35,v30
v_fma_f32 v54,s36,v22,v6
v_fma_f32 v62,-s36,v22,v6
v_add_f32 v6,v15,v31
v_add_f32 v39,v6,v23
v_sub_f32 v47,v6,v23
v_mul_f32 v39,s33,v39
v_mul_f32 v47,s33,v47
v_mul_f32 v6,s34,v15
v_fmac_f32 v6,s35,v31
v_fma_f32 v55,s36,v23,v6
v_fma_f32 v63,-s36,v23,v6
v_cvt_pk_bf16_f32 v64,v8,v9
v_cvt_pk_bf16_f32 v65,v10,v11
v_cvt_pk_bf16_f32 v66,v12,v13
v_cvt_pk_bf16_f32 v67,v14,v15
s_add_u32 s31,s30,0
buffer_store_dwordx4 v[64:67],v5,s[12:15],s31 offen
v_cvt_pk_bf16_f32 v68,v32,v33
v_cvt_pk_bf16_f32 v69,v34,v35
v_cvt_pk_bf16_f32 v70,v36,v37
v_cvt_pk_bf16_f32 v71,v38,v39
s_add_u32 s31,s30,9216
buffer_store_dwordx4 v[68:71],v5,s[12:15],s31 offen
v_cvt_pk_bf16_f32 v72,v40,v41
v_cvt_pk_bf16_f32 v73,v42,v43
v_cvt_pk_bf16_f32 v74,v44,v45
v_cvt_pk_bf16_f32 v75,v46,v47
s_add_u32 s31,s30,18432
buffer_store_dwordx4 v[72:75],v5,s[12:15],s31 offen
v_cvt_pk_bf16_f32 v76,v48,v49
v_cvt_pk_bf16_f32 v77,v50,v51
v_cvt_pk_bf16_f32 v78,v52,v53
v_cvt_pk_bf16_f32 v79,v54,v55
s_add_u32 s31,s30,27648
buffer_store_dwordx4 v[76:79],v5,s[12:15],s31 offen
v_cvt_pk_bf16_f32 v80,v56,v57
v_cvt_pk_bf16_f32 v81,v58,v59
v_cvt_pk_bf16_f32 v82,v60,v61
v_cvt_pk_bf16_f32 v83,v62,v63
s_add_u32 s31,s30,36864
buffer_store_dwordx4 v[80:83],v5,s[12:15],s31 offen
v_cvt_pk_bf16_f32 v84,v24,v25
v_cvt_pk_bf16_f32 v85,v26,v27
v_cvt_pk_bf16_f32 v86,v28,v29
v_cvt_pk_bf16_f32 v87,v30,v31
s_add_u32 s31,s30,46080
buffer_store_dwordx4 v[84:87],v5,s[12:15],s31 offen
L_uend:
s_endpgm
.globl standalone__winograd__vision_kernel
.p2align 8
.type standalone__winograd__vision_kernel,@function
standalone__winograd__vision_kernel:
s_cmp_ge_u32 s2,256
s_cbranch_scc0 L_go
s_endpgm
L_go:
s_load_dwordx2 s[4:5],s[0:1],0
s_load_dwordx2 s[6:7],s[0:1],16
s_load_dwordx2 s[52:53],s[0:1],32
v_lshrrev_b32 v60,6,v0
v_and_b32 v64,63,v0
v_readfirstlane_b32 s50,v60
v_lshrrev_b32 v60,4,v64
v_bfe_u32 v61,v64,3,1
v_lshl_add_u32 v61,v60,3,v61
v_and_b32 v62,7,v64
v_mul_u32_u24 v247,196608,v61
v_lshl_add_u32 v247,v62,3,v247
v_lshlrev_b32 v253,4,v64
s_and_b32 s54,s2,7
s_lshr_b32 s55,s2,3
s_lshl_b32 s49,s54,6
s_lshl_b32 s55,s55,4
s_lshl_b32 s56,s50,2
s_add_u32 s56,s56,s55
s_mul_i32 s31,s56,384
s_mul_i32 s57,s49,196608
s_add_u32 s30,s57,s31
s_waitcnt lgkmcnt(0)
s_mov_b32 s8,s4
s_and_b32 s9,s5,0xffff
s_mov_b32 s10,100663296
s_mov_b32 s11,0x20000
s_sub_u32 s12,s4,384
s_subb_u32 s13,s9,0
s_cmp_eq_u32 s56,0
s_cselect_b32 s14,0,100663680
s_mov_b32 s15,0x20000
s_mov_b32 s16,s4
s_mov_b32 s17,s9
s_cmp_eq_u32 s56,508
s_cselect_b32 s18,0,100663296
s_mov_b32 s19,0x20000
v_lshrrev_b32 v228,9,v253
v_mul_u32_u24 v228,33,v228
v_add_u32 v228,s49,v228
v_add_u32 v228,-1,v228
v_mul_u32_u24 v229,196608,v228
v_cmp_gt_u32 vcc,512,v228
v_bfe_u32 v228,v253,3,6
v_add_u32 v229,v229,v228
v_bfrev_b32 v228,1
v_cndmask_b32 v248,v228,v229,vcc
s_add_u32 s28,s30,0
buffer_load_dwordx2 v[0:1],v247,s[12:15],s28 offen offset:0
buffer_load_dwordx2 v[10:11],v247,s[16:19],s28 offen offset:1536
buffer_load_dwordx2 v[2:3],v247,s[8:11],s28 offen offset:0
buffer_load_dwordx2 v[4:5],v247,s[8:11],s28 offen offset:384
buffer_load_dwordx2 v[6:7],v247,s[8:11],s28 offen offset:768
buffer_load_dwordx2 v[8:9],v247,s[8:11],s28 offen offset:1152
s_add_u32 s28,s30,393216
buffer_load_dwordx2 v[12:13],v247,s[12:15],s28 offen offset:0
buffer_load_dwordx2 v[22:23],v247,s[16:19],s28 offen offset:1536
buffer_load_dwordx2 v[14:15],v247,s[8:11],s28 offen offset:0
buffer_load_dwordx2 v[16:17],v247,s[8:11],s28 offen offset:384
buffer_load_dwordx2 v[18:19],v247,s[8:11],s28 offen offset:768
buffer_load_dwordx2 v[20:21],v247,s[8:11],s28 offen offset:1152
s_add_u32 s28,s30,786432
buffer_load_dwordx2 v[24:25],v247,s[12:15],s28 offen offset:0
buffer_load_dwordx2 v[34:35],v247,s[16:19],s28 offen offset:1536
buffer_load_dwordx2 v[26:27],v247,s[8:11],s28 offen offset:0
buffer_load_dwordx2 v[28:29],v247,s[8:11],s28 offen offset:384
buffer_load_dwordx2 v[30:31],v247,s[8:11],s28 offen offset:768
buffer_load_dwordx2 v[32:33],v247,s[8:11],s28 offen offset:1152
s_add_u32 s28,s30,1179648
buffer_load_dwordx2 v[36:37],v247,s[12:15],s28 offen offset:0
buffer_load_dwordx2 v[46:47],v247,s[16:19],s28 offen offset:1536
buffer_load_dwordx2 v[38:39],v247,s[8:11],s28 offen offset:0
buffer_load_dwordx2 v[40:41],v247,s[8:11],s28 offen offset:384
buffer_load_dwordx2 v[42:43],v247,s[8:11],s28 offen offset:768
buffer_load_dwordx2 v[44:45],v247,s[8:11],s28 offen offset:1152
s_add_u32 s29,s31,0
buffer_load_short_d16_hi v48,v248,s[12:15],s29 offen offset:0
buffer_load_short_d16_hi v49,v248,s[8:11],s29 offen offset:0
buffer_load_short_d16_hi v50,v248,s[8:11],s29 offen offset:384
buffer_load_short_d16_hi v51,v248,s[8:11],s29 offen offset:768
buffer_load_short_d16_hi v52,v248,s[8:11],s29 offen offset:1152
buffer_load_short_d16_hi v53,v248,s[16:19],s29 offen offset:1536
s_mov_b32 s20,s52
s_and_b32 s21,s53,0xffff
s_mov_b32 s22,1327104
s_mov_b32 s23,0x20000
s_mul_i32 s44,s50,331776
s_add_u32 s46,s44,9216
buffer_load_dwordx4 a[224:227],v253,s[20:23],s46 offen offset:0
s_add_u32 s47,s44,12288
buffer_load_dwordx4 a[228:231],v253,s[20:23],s47 offen offset:0
s_add_u32 s48,s44,15360
buffer_load_dwordx4 a[232:235],v253,s[20:23],s48 offen offset:0
buffer_load_dwordx4 a[236:239],v253,s[20:23],s46 offen offset:1024
buffer_load_dwordx4 a[240:243],v253,s[20:23],s47 offen offset:1024
buffer_load_dwordx4 a[244:247],v253,s[20:23],s48 offen offset:1024
buffer_load_dwordx4 a[248:251],v253,s[20:23],s46 offen offset:2048
buffer_load_dwordx4 a[252:255],v253,s[20:23],s47 offen offset:2048
buffer_load_dwordx4 v[216:219],v253,s[20:23],s48 offen offset:2048
s_add_u32 s46,s44,18432
buffer_load_dwordx4 v[220:223],v253,s[20:23],s46 offen offset:0
s_add_u32 s47,s44,21504
buffer_load_dwordx4 v[224:227],v253,s[20:23],s47 offen offset:0
s_add_u32 s28,s30,64
buffer_load_dwordx2 v[192:193],v247,s[12:15],s28 offen offset:0
buffer_load_dwordx2 v[202:203],v247,s[16:19],s28 offen offset:1536
buffer_load_dwordx2 v[194:195],v247,s[8:11],s28 offen offset:0
buffer_load_dwordx2 v[196:197],v247,s[8:11],s28 offen offset:384
buffer_load_dwordx2 v[198:199],v247,s[8:11],s28 offen offset:768
buffer_load_dwordx2 v[200:201],v247,s[8:11],s28 offen offset:1152
s_add_u32 s28,s30,393280
buffer_load_dwordx2 v[204:205],v247,s[12:15],s28 offen offset:0
buffer_load_dwordx2 v[214:215],v247,s[16:19],s28 offen offset:1536
buffer_load_dwordx2 v[206:207],v247,s[8:11],s28 offen offset:0
buffer_load_dwordx2 v[208:209],v247,s[8:11],s28 offen offset:384
buffer_load_dwordx2 v[210:211],v247,s[8:11],s28 offen offset:768
buffer_load_dwordx2 v[212:213],v247,s[8:11],s28 offen offset:1152
s_add_u32 s29,s31,64
buffer_load_short_d16_hi v241,v248,s[12:15],s29 offen offset:0
buffer_load_short_d16_hi v242,v248,s[8:11],s29 offen offset:0
buffer_load_short_d16_hi v243,v248,s[8:11],s29 offen offset:384
buffer_load_short_d16_hi v244,v248,s[8:11],s29 offen offset:768
buffer_load_short_d16_hi v245,v248,s[8:11],s29 offen offset:1152
buffer_load_short_d16_hi v246,v248,s[16:19],s29 offen offset:1536
s_mov_b32 s24,s6
s_and_b32 s25,s7,0xffff
s_mov_b32 s26,100663296
s_mov_b32 s27,0x20000
s_mov_b32 s40,0xc0a00000
s_mov_b32 s41,0x41000000
s_mov_b32 s42,0xffff0000
s_mov_b32 s43,0xbfa00000
s_mov_b32 s45,0x3e800000
s_mul_i32 s58,s55,384
s_mul_i32 s59,s50,96
s_add_u32 s51,s57,s58
s_add_u32 s51,s51,s59
s_lshl_b32 s59,s50,6
v_lshlrev_b32 v249,8,v61
v_and_b32 v63,1,v60
v_xor_b32 v63,1,v63
v_lshlrev_b32 v63,2,v63
v_xor_b32 v63,v63,v62
v_lshl_add_u32 v249,v63,3,v249
v_add_u32 v249,s59,v249
v_add_u32 v249,256,v249
v_lshrrev_b32 v60,5,v64
v_mul_u32_u24 v250,8448,v60
v_lshlrev_b32 v60,5,v60
v_bfe_u32 v61,v253,3,6
v_xor_b32 v61,v61,v60
v_add3_u32 v250,v250,v61,s59
v_bfe_u32 v60,v64,2,2
v_and_b32 v61,3,v64
v_lshrrev_b32 v62,4,v64
v_lshlrev_b32 v251,11,v60
v_lshl_add_u32 v251,v61,6,v251
v_and_b32 v63,1,v60
v_lshlrev_b32 v63,1,v63
v_xor_b32 v63,v63,v62
v_lshl_add_u32 v251,v63,4,v251
v_xor_b32 v252,32,v251
v_mul_u32_u24 v255,1572864,v60
v_mul_u32_u24 v61,1536,v61
v_add_u32 v255,v255,v61
v_lshl_add_u32 v254,v62,4,v255
v_lshl_add_u32 v255,v62,3,v255
v_add_u32 v255,64,v255
s_waitcnt vmcnt(55)
v_lshlrev_b32 v230,16,v4
v_lshlrev_b32 v228,16,v0
v_lshlrev_b32 v229,16,v2
v_lshlrev_b32 v233,16,v10
s_waitcnt vmcnt(53)
v_lshlrev_b32 v232,16,v8
v_lshlrev_b32 v231,16,v6
v_fmac_f32 v228,s43,v230
v_fmac_f32 v233,4.0,v229
v_fma_f32 v234,-4.0,v230,v232
v_fmac_f32 v228,s45,v232
v_fmac_f32 v233,s40,v231
v_sub_f32 v232,v232,v230
v_fma_f32 v230,-4.0,v229,v231
v_sub_f32 v231,v231,v229
v_add_f32 v229,v234,v230
v_sub_f32 v234,v234,v230
v_fma_f32 v230,2.0,v231,v232
v_fmac_f32 v232,-2.0,v231
v_and_b32 v237,s42,v4
v_and_b32 v235,s42,v0
v_and_b32 v236,s42,v2
v_and_b32 v240,s42,v10
v_and_b32 v239,s42,v8
v_and_b32 v238,s42,v6
v_fmac_f32 v235,s43,v237
v_fmac_f32 v240,4.0,v236
v_fma_f32 v231,-4.0,v237,v239
v_fmac_f32 v235,s45,v239
v_fmac_f32 v240,s40,v238
v_sub_f32 v239,v239,v237
v_fma_f32 v237,-4.0,v236,v238
v_sub_f32 v238,v238,v236
v_add_f32 v236,v231,v237
v_sub_f32 v231,v231,v237
v_fma_f32 v237,2.0,v238,v239
v_fmac_f32 v239,-2.0,v238
v_cvt_pk_bf16_f32 v0,v228,v235
v_cvt_pk_bf16_f32 v10,v233,v240
v_cvt_pk_bf16_f32 v2,v229,v236
v_cvt_pk_bf16_f32 v4,v234,v231
v_cvt_pk_bf16_f32 v6,v230,v237
v_cvt_pk_bf16_f32 v8,v232,v239
v_lshlrev_b32 v230,16,v5
v_lshlrev_b32 v228,16,v1
v_lshlrev_b32 v229,16,v3
v_lshlrev_b32 v233,16,v11
v_lshlrev_b32 v232,16,v9
v_lshlrev_b32 v231,16,v7
v_fmac_f32 v228,s43,v230
v_fmac_f32 v233,4.0,v229
v_fma_f32 v234,-4.0,v230,v232
v_fmac_f32 v228,s45,v232
v_fmac_f32 v233,s40,v231
v_sub_f32 v232,v232,v230
v_fma_f32 v230,-4.0,v229,v231
v_sub_f32 v231,v231,v229
v_add_f32 v229,v234,v230
v_sub_f32 v234,v234,v230
v_fma_f32 v230,2.0,v231,v232
v_fmac_f32 v232,-2.0,v231
v_and_b32 v237,s42,v5
v_and_b32 v235,s42,v1
v_and_b32 v236,s42,v3
v_and_b32 v240,s42,v11
v_and_b32 v239,s42,v9
v_and_b32 v238,s42,v7
v_fmac_f32 v235,s43,v237
v_fmac_f32 v240,4.0,v236
v_fma_f32 v231,-4.0,v237,v239
v_fmac_f32 v235,s45,v239
v_fmac_f32 v240,s40,v238
v_sub_f32 v239,v239,v237
v_fma_f32 v237,-4.0,v236,v238
v_sub_f32 v238,v238,v236
v_add_f32 v236,v231,v237
v_sub_f32 v231,v231,v237
v_fma_f32 v237,2.0,v238,v239
v_fmac_f32 v239,-2.0,v238
v_cvt_pk_bf16_f32 v1,v228,v235
v_cvt_pk_bf16_f32 v11,v233,v240
v_cvt_pk_bf16_f32 v3,v229,v236
v_cvt_pk_bf16_f32 v5,v234,v231
v_cvt_pk_bf16_f32 v7,v230,v237
v_cvt_pk_bf16_f32 v9,v232,v239
ds_write2st64_b64 v249,v[0:1],v[10:11] offset0:0 offset1:17
ds_write2st64_b64 v249,v[2:3],v[4:5] offset0:34 offset1:51
ds_write2st64_b64 v249,v[6:7],v[8:9] offset0:68 offset1:85
s_waitcnt vmcnt(49)
v_lshlrev_b32 v230,16,v16
v_lshlrev_b32 v228,16,v12
v_lshlrev_b32 v229,16,v14
v_lshlrev_b32 v233,16,v22
s_waitcnt vmcnt(47)
v_lshlrev_b32 v232,16,v20
v_lshlrev_b32 v231,16,v18
v_fmac_f32 v228,s43,v230
v_fmac_f32 v233,4.0,v229
v_fma_f32 v234,-4.0,v230,v232
v_fmac_f32 v228,s45,v232
v_fmac_f32 v233,s40,v231
v_sub_f32 v232,v232,v230
v_fma_f32 v230,-4.0,v229,v231
v_sub_f32 v231,v231,v229
v_add_f32 v229,v234,v230
v_sub_f32 v234,v234,v230
v_fma_f32 v230,2.0,v231,v232
v_fmac_f32 v232,-2.0,v231
v_and_b32 v237,s42,v16
v_and_b32 v235,s42,v12
v_and_b32 v236,s42,v14
v_and_b32 v240,s42,v22
v_and_b32 v239,s42,v20
v_and_b32 v238,s42,v18
v_fmac_f32 v235,s43,v237
v_fmac_f32 v240,4.0,v236
v_fma_f32 v231,-4.0,v237,v239
v_fmac_f32 v235,s45,v239
v_fmac_f32 v240,s40,v238
v_sub_f32 v239,v239,v237
v_fma_f32 v237,-4.0,v236,v238
v_sub_f32 v238,v238,v236
v_add_f32 v236,v231,v237
v_sub_f32 v231,v231,v237
v_fma_f32 v237,2.0,v238,v239
v_fmac_f32 v239,-2.0,v238
v_cvt_pk_bf16_f32 v12,v228,v235
v_cvt_pk_bf16_f32 v22,v233,v240
v_cvt_pk_bf16_f32 v14,v229,v236
v_cvt_pk_bf16_f32 v16,v234,v231
v_cvt_pk_bf16_f32 v18,v230,v237
v_cvt_pk_bf16_f32 v20,v232,v239
v_lshlrev_b32 v230,16,v17
v_lshlrev_b32 v228,16,v13
v_lshlrev_b32 v229,16,v15
v_lshlrev_b32 v233,16,v23
v_lshlrev_b32 v232,16,v21
v_lshlrev_b32 v231,16,v19
v_fmac_f32 v228,s43,v230
v_fmac_f32 v233,4.0,v229
v_fma_f32 v234,-4.0,v230,v232
v_fmac_f32 v228,s45,v232
v_fmac_f32 v233,s40,v231
v_sub_f32 v232,v232,v230
v_fma_f32 v230,-4.0,v229,v231
v_sub_f32 v231,v231,v229
v_add_f32 v229,v234,v230
v_sub_f32 v234,v234,v230
v_fma_f32 v230,2.0,v231,v232
v_fmac_f32 v232,-2.0,v231
v_and_b32 v237,s42,v17
v_and_b32 v235,s42,v13
v_and_b32 v236,s42,v15
v_and_b32 v240,s42,v23
v_and_b32 v239,s42,v21
v_and_b32 v238,s42,v19
v_fmac_f32 v235,s43,v237
v_fmac_f32 v240,4.0,v236
v_fma_f32 v231,-4.0,v237,v239
v_fmac_f32 v235,s45,v239
v_fmac_f32 v240,s40,v238
v_sub_f32 v239,v239,v237
v_fma_f32 v237,-4.0,v236,v238
v_sub_f32 v238,v238,v236
v_add_f32 v236,v231,v237
v_sub_f32 v231,v231,v237
v_fma_f32 v237,2.0,v238,v239
v_fmac_f32 v239,-2.0,v238
v_cvt_pk_bf16_f32 v13,v228,v235
v_cvt_pk_bf16_f32 v23,v233,v240
v_cvt_pk_bf16_f32 v15,v229,v236
v_cvt_pk_bf16_f32 v17,v234,v231
v_cvt_pk_bf16_f32 v19,v230,v237
v_cvt_pk_bf16_f32 v21,v232,v239
ds_write2st64_b64 v249,v[12:13],v[22:23] offset0:1 offset1:18
ds_write2st64_b64 v249,v[14:15],v[16:17] offset0:35 offset1:52
ds_write2st64_b64 v249,v[18:19],v[20:21] offset0:69 offset1:86
s_waitcnt vmcnt(43)
v_lshlrev_b32 v230,16,v28
v_lshlrev_b32 v228,16,v24
v_lshlrev_b32 v229,16,v26
v_lshlrev_b32 v233,16,v34
s_waitcnt vmcnt(41)
v_lshlrev_b32 v232,16,v32
v_lshlrev_b32 v231,16,v30
v_fmac_f32 v228,s43,v230
v_fmac_f32 v233,4.0,v229
v_fma_f32 v234,-4.0,v230,v232
v_fmac_f32 v228,s45,v232
v_fmac_f32 v233,s40,v231
v_sub_f32 v232,v232,v230
v_fma_f32 v230,-4.0,v229,v231
v_sub_f32 v231,v231,v229
v_add_f32 v229,v234,v230
v_sub_f32 v234,v234,v230
v_fma_f32 v230,2.0,v231,v232
v_fmac_f32 v232,-2.0,v231
v_and_b32 v237,s42,v28
v_and_b32 v235,s42,v24
v_and_b32 v236,s42,v26
v_and_b32 v240,s42,v34
v_and_b32 v239,s42,v32
v_and_b32 v238,s42,v30
v_fmac_f32 v235,s43,v237
v_fmac_f32 v240,4.0,v236
v_fma_f32 v231,-4.0,v237,v239
v_fmac_f32 v235,s45,v239
v_fmac_f32 v240,s40,v238
v_sub_f32 v239,v239,v237
v_fma_f32 v237,-4.0,v236,v238
v_sub_f32 v238,v238,v236
v_add_f32 v236,v231,v237
v_sub_f32 v231,v231,v237
v_fma_f32 v237,2.0,v238,v239
v_fmac_f32 v239,-2.0,v238
v_cvt_pk_bf16_f32 v24,v228,v235
v_cvt_pk_bf16_f32 v34,v233,v240
v_cvt_pk_bf16_f32 v26,v229,v236
v_cvt_pk_bf16_f32 v28,v234,v231
v_cvt_pk_bf16_f32 v30,v230,v237
v_cvt_pk_bf16_f32 v32,v232,v239
v_lshlrev_b32 v230,16,v29
v_lshlrev_b32 v228,16,v25
v_lshlrev_b32 v229,16,v27
v_lshlrev_b32 v233,16,v35
v_lshlrev_b32 v232,16,v33
v_lshlrev_b32 v231,16,v31
v_fmac_f32 v228,s43,v230
v_fmac_f32 v233,4.0,v229
v_fma_f32 v234,-4.0,v230,v232
v_fmac_f32 v228,s45,v232
v_fmac_f32 v233,s40,v231
v_sub_f32 v232,v232,v230
v_fma_f32 v230,-4.0,v229,v231
v_sub_f32 v231,v231,v229
v_add_f32 v229,v234,v230
v_sub_f32 v234,v234,v230
v_fma_f32 v230,2.0,v231,v232
v_fmac_f32 v232,-2.0,v231
v_and_b32 v237,s42,v29
v_and_b32 v235,s42,v25
v_and_b32 v236,s42,v27
v_and_b32 v240,s42,v35
v_and_b32 v239,s42,v33
v_and_b32 v238,s42,v31
v_fmac_f32 v235,s43,v237
v_fmac_f32 v240,4.0,v236
v_fma_f32 v231,-4.0,v237,v239
v_fmac_f32 v235,s45,v239
v_fmac_f32 v240,s40,v238
v_sub_f32 v239,v239,v237
v_fma_f32 v237,-4.0,v236,v238
v_sub_f32 v238,v238,v236
v_add_f32 v236,v231,v237
v_sub_f32 v231,v231,v237
v_fma_f32 v237,2.0,v238,v239
v_fmac_f32 v239,-2.0,v238
v_cvt_pk_bf16_f32 v25,v228,v235
v_cvt_pk_bf16_f32 v35,v233,v240
v_cvt_pk_bf16_f32 v27,v229,v236
v_cvt_pk_bf16_f32 v29,v234,v231
v_cvt_pk_bf16_f32 v31,v230,v237
v_cvt_pk_bf16_f32 v33,v232,v239
ds_write2st64_b64 v249,v[24:25],v[34:35] offset0:2 offset1:19
ds_write2st64_b64 v249,v[26:27],v[28:29] offset0:36 offset1:53
ds_write2st64_b64 v249,v[30:31],v[32:33] offset0:70 offset1:87
s_waitcnt vmcnt(37)
v_lshlrev_b32 v230,16,v40
v_lshlrev_b32 v228,16,v36
v_lshlrev_b32 v229,16,v38
v_lshlrev_b32 v233,16,v46
s_waitcnt vmcnt(35)
v_lshlrev_b32 v232,16,v44
v_lshlrev_b32 v231,16,v42
v_fmac_f32 v228,s43,v230
v_fmac_f32 v233,4.0,v229
v_fma_f32 v234,-4.0,v230,v232
v_fmac_f32 v228,s45,v232
v_fmac_f32 v233,s40,v231
v_sub_f32 v232,v232,v230
v_fma_f32 v230,-4.0,v229,v231
v_sub_f32 v231,v231,v229
v_add_f32 v229,v234,v230
v_sub_f32 v234,v234,v230
v_fma_f32 v230,2.0,v231,v232
v_fmac_f32 v232,-2.0,v231
v_and_b32 v237,s42,v40
v_and_b32 v235,s42,v36
v_and_b32 v236,s42,v38
v_and_b32 v240,s42,v46
v_and_b32 v239,s42,v44
v_and_b32 v238,s42,v42
v_fmac_f32 v235,s43,v237
v_fmac_f32 v240,4.0,v236
v_fma_f32 v231,-4.0,v237,v239
v_fmac_f32 v235,s45,v239
v_fmac_f32 v240,s40,v238
v_sub_f32 v239,v239,v237
v_fma_f32 v237,-4.0,v236,v238
v_sub_f32 v238,v238,v236
v_add_f32 v236,v231,v237
v_sub_f32 v231,v231,v237
v_fma_f32 v237,2.0,v238,v239
v_fmac_f32 v239,-2.0,v238
v_cvt_pk_bf16_f32 v36,v228,v235
v_cvt_pk_bf16_f32 v46,v233,v240
v_cvt_pk_bf16_f32 v38,v229,v236
v_cvt_pk_bf16_f32 v40,v234,v231
v_cvt_pk_bf16_f32 v42,v230,v237
v_cvt_pk_bf16_f32 v44,v232,v239
v_lshlrev_b32 v230,16,v41
v_lshlrev_b32 v228,16,v37
v_lshlrev_b32 v229,16,v39
v_lshlrev_b32 v233,16,v47
v_lshlrev_b32 v232,16,v45
v_lshlrev_b32 v231,16,v43
v_fmac_f32 v228,s43,v230
v_fmac_f32 v233,4.0,v229
v_fma_f32 v234,-4.0,v230,v232
v_fmac_f32 v228,s45,v232
v_fmac_f32 v233,s40,v231
v_sub_f32 v232,v232,v230
v_fma_f32 v230,-4.0,v229,v231
v_sub_f32 v231,v231,v229
v_add_f32 v229,v234,v230
v_sub_f32 v234,v234,v230
v_fma_f32 v230,2.0,v231,v232
v_fmac_f32 v232,-2.0,v231
v_and_b32 v237,s42,v41
v_and_b32 v235,s42,v37
v_and_b32 v236,s42,v39
v_and_b32 v240,s42,v47
v_and_b32 v239,s42,v45
v_and_b32 v238,s42,v43
v_fmac_f32 v235,s43,v237
v_fmac_f32 v240,4.0,v236
v_fma_f32 v231,-4.0,v237,v239
v_fmac_f32 v235,s45,v239
v_fmac_f32 v240,s40,v238
v_sub_f32 v239,v239,v237
v_fma_f32 v237,-4.0,v236,v238
v_sub_f32 v238,v238,v236
v_add_f32 v236,v231,v237
v_sub_f32 v231,v231,v237
v_fma_f32 v237,2.0,v238,v239
v_fmac_f32 v239,-2.0,v238
v_cvt_pk_bf16_f32 v37,v228,v235
v_cvt_pk_bf16_f32 v47,v233,v240
v_cvt_pk_bf16_f32 v39,v229,v236
v_cvt_pk_bf16_f32 v41,v234,v231
v_cvt_pk_bf16_f32 v43,v230,v237
v_cvt_pk_bf16_f32 v45,v232,v239
ds_write2st64_b64 v249,v[36:37],v[46:47] offset0:3 offset1:20
ds_write2st64_b64 v249,v[38:39],v[40:41] offset0:37 offset1:54
ds_write2st64_b64 v249,v[42:43],v[44:45] offset0:71 offset1:88
s_waitcnt vmcnt(32)
v_fmac_f32 v48,s43,v50
s_waitcnt vmcnt(29)
v_fmac_f32 v53,4.0,v49
v_fma_f32 v228,-4.0,v50,v52
v_fmac_f32 v48,s45,v52
v_fmac_f32 v53,s40,v51
v_sub_f32 v52,v52,v50
v_fma_f32 v50,-4.0,v49,v51
v_sub_f32 v51,v51,v49
v_add_f32 v49,v228,v50
v_sub_f32 v228,v228,v50
v_fma_f32 v50,2.0,v51,v52
v_fmac_f32 v52,-2.0,v51
v_cvt_pk_bf16_f32 v229,v48,v53
v_cvt_pk_bf16_f32 v230,v49,v228
v_cvt_pk_bf16_f32 v231,v50,v52
ds_write_b16 v250,v229 offset:0
ds_write_b16_d16_hi v250,v229 offset:8704
ds_write_b16 v250,v230 offset:17408
ds_write_b16_d16_hi v250,v230 offset:26112
ds_write_b16 v250,v231 offset:34816
ds_write_b16_d16_hi v250,v231 offset:43520
s_waitcnt lgkmcnt(0)
s_barrier
ds_read_b128 a[192:195],v251 offset:17408
ds_read_b128 a[196:199],v252 offset:17664
ds_read_b128 a[200:203],v252 offset:17920
ds_read_b128 a[204:207],v252 offset:18176
ds_read_b128 a[208:211],v252 offset:18432
ds_read_b128 a[212:215],v252 offset:18688
ds_read_b128 a[216:219],v252 offset:18944
ds_read_b128 a[220:223],v252 offset:19200
s_waitcnt vmcnt(28) lgkmcnt(7)
M a[0:3],a[224:227],a[192:195],0
s_waitcnt vmcnt(14) lgkmcnt(6)
v_lshlrev_b32 v230,16,v196
v_lshlrev_b32 v228,16,v192
M a[4:7],a[224:227],a[196:199],0
s_waitcnt lgkmcnt(5)
s_add_u32 s48,s44,24576
v_lshlrev_b32 v229,16,v194
v_lshlrev_b32 v233,16,v202
M a[8:11],a[224:227],a[200:203],0
s_waitcnt vmcnt(12) lgkmcnt(4)
v_lshlrev_b32 v232,16,v200
v_lshlrev_b32 v231,16,v198
M a[12:15],a[224:227],a[204:207],0
s_waitcnt lgkmcnt(3)
v_fmac_f32 v228,s43,v230
v_fmac_f32 v233,4.0,v229
M a[16:19],a[224:227],a[208:211],0
s_waitcnt lgkmcnt(2)
v_fma_f32 v234,-4.0,v230,v232
v_fmac_f32 v228,s45,v232
M a[20:23],a[224:227],a[212:215],0
s_waitcnt lgkmcnt(1)
v_fmac_f32 v233,s40,v231
v_sub_f32 v232,v232,v230
M a[24:27],a[224:227],a[216:219],0
s_waitcnt lgkmcnt(0)
v_fma_f32 v230,-4.0,v229,v231
v_sub_f32 v231,v231,v229
v_add_f32 v229,v234,v230
M a[28:31],a[224:227],a[220:223],0
buffer_load_dwordx4 a[224:227],v253,s[20:23],s48 offen offset:0
M a[32:35],a[228:231],a[192:195],0
v_sub_f32 v234,v234,v230
v_fma_f32 v230,2.0,v231,v232
M a[36:39],a[228:231],a[196:199],0
v_fmac_f32 v232,-2.0,v231
v_and_b32 v237,s42,v196
M a[40:43],a[228:231],a[200:203],0
v_and_b32 v235,s42,v192
v_and_b32 v236,s42,v194
M a[44:47],a[228:231],a[204:207],0
v_and_b32 v240,s42,v202
v_and_b32 v239,s42,v200
M a[48:51],a[228:231],a[208:211],0
v_and_b32 v238,s42,v198
v_fmac_f32 v235,s43,v237
v_fmac_f32 v240,4.0,v236
M a[52:55],a[228:231],a[212:215],0
v_fma_f32 v231,-4.0,v237,v239
v_fmac_f32 v235,s45,v239
M a[56:59],a[228:231],a[216:219],0
v_fmac_f32 v240,s40,v238
v_sub_f32 v239,v239,v237
M a[60:63],a[228:231],a[220:223],0
buffer_load_dwordx4 a[228:231],v253,s[20:23],s46 offen offset:1024
M a[64:67],a[232:235],a[192:195],0
ds_read_b128 a[192:195],v252 offset:19456
v_fma_f32 v237,-4.0,v236,v238
M a[68:71],a[232:235],a[196:199],0
v_sub_f32 v238,v238,v236
v_add_f32 v236,v231,v237
M a[72:75],a[232:235],a[200:203],0
v_sub_f32 v231,v231,v237
v_fma_f32 v237,2.0,v238,v239
v_fmac_f32 v239,-2.0,v238
M a[76:79],a[232:235],a[204:207],0
v_cvt_pk_bf16_f32 v192,v228,v235
v_cvt_pk_bf16_f32 v202,v233,v240
M a[80:83],a[232:235],a[208:211],0
v_cvt_pk_bf16_f32 v194,v229,v236
v_cvt_pk_bf16_f32 v196,v234,v231
M a[84:87],a[232:235],a[212:215],0
v_cvt_pk_bf16_f32 v198,v230,v237
v_cvt_pk_bf16_f32 v200,v232,v239
M a[88:91],a[232:235],a[216:219],0
v_lshlrev_b32 v230,16,v197
v_lshlrev_b32 v228,16,v193
M a[92:95],a[232:235],a[220:223],0
buffer_load_dwordx4 a[232:235],v253,s[20:23],s47 offen offset:1024
M a[0:3],a[236:239],a[196:199],a[0:3]
v_lshlrev_b32 v229,16,v195
v_lshlrev_b32 v233,16,v203
v_lshlrev_b32 v232,16,v201
M a[4:7],a[236:239],a[200:203],a[4:7]
v_lshlrev_b32 v231,16,v199
v_fmac_f32 v228,s43,v230
M a[8:11],a[236:239],a[204:207],a[8:11]
v_fmac_f32 v233,4.0,v229
v_fma_f32 v234,-4.0,v230,v232
M a[12:15],a[236:239],a[208:211],a[12:15]
v_fmac_f32 v228,s45,v232
v_fmac_f32 v233,s40,v231
M a[16:19],a[236:239],a[212:215],a[16:19]
v_sub_f32 v232,v232,v230
v_fma_f32 v230,-4.0,v229,v231
M a[20:23],a[236:239],a[216:219],a[20:23]
v_sub_f32 v231,v231,v229
v_add_f32 v229,v234,v230
M a[24:27],a[236:239],a[220:223],a[24:27]
s_waitcnt lgkmcnt(0)
v_sub_f32 v234,v234,v230
v_fma_f32 v230,2.0,v231,v232
M a[28:31],a[236:239],a[192:195],a[28:31]
buffer_load_dwordx4 a[236:239],v253,s[20:23],s48 offen offset:1024
v_fmac_f32 v232,-2.0,v231
M a[32:35],a[240:243],a[196:199],a[32:35]
v_and_b32 v237,s42,v197
v_and_b32 v235,s42,v193
M a[36:39],a[240:243],a[200:203],a[36:39]
v_and_b32 v236,s42,v195
v_and_b32 v240,s42,v203
M a[40:43],a[240:243],a[204:207],a[40:43]
v_and_b32 v239,s42,v201
v_and_b32 v238,s42,v199
M a[44:47],a[240:243],a[208:211],a[44:47]
v_fmac_f32 v235,s43,v237
v_fmac_f32 v240,4.0,v236
M a[48:51],a[240:243],a[212:215],a[48:51]
v_fma_f32 v231,-4.0,v237,v239
v_fmac_f32 v235,s45,v239
M a[52:55],a[240:243],a[216:219],a[52:55]
v_fmac_f32 v240,s40,v238
v_sub_f32 v239,v239,v237
v_fma_f32 v237,-4.0,v236,v238
M a[56:59],a[240:243],a[220:223],a[56:59]
v_sub_f32 v238,v238,v236
v_add_f32 v236,v231,v237
M a[60:63],a[240:243],a[192:195],a[60:63]
buffer_load_dwordx4 a[240:243],v253,s[20:23],s46 offen offset:2048
M a[64:67],a[244:247],a[196:199],a[64:67]
ds_read_b128 a[196:199],v251 offset:19712
v_sub_f32 v231,v231,v237
M a[68:71],a[244:247],a[200:203],a[68:71]
v_fma_f32 v237,2.0,v238,v239
v_fmac_f32 v239,-2.0,v238
M a[72:75],a[244:247],a[204:207],a[72:75]
v_cvt_pk_bf16_f32 v193,v228,v235
v_cvt_pk_bf16_f32 v203,v233,v240
M a[76:79],a[244:247],a[208:211],a[76:79]
v_cvt_pk_bf16_f32 v195,v229,v236
v_cvt_pk_bf16_f32 v197,v234,v231
v_cvt_pk_bf16_f32 v199,v230,v237
M a[80:83],a[244:247],a[212:215],a[80:83]
v_cvt_pk_bf16_f32 v201,v232,v239
M a[84:87],a[244:247],a[216:219],a[84:87]
ds_write2st64_b64 v249,v[192:193],v[202:203] offset0:170 offset1:187
M a[88:91],a[244:247],a[220:223],a[88:91]
s_add_u32 s28,s30,786496
buffer_load_dwordx2 v[192:193],v247,s[12:15],s28 offen offset:0
M a[92:95],a[244:247],a[192:195],a[92:95]
buffer_load_dwordx2 v[202:203],v247,s[16:19],s28 offen offset:1536
M a[0:3],a[248:251],a[200:203],a[0:3]
buffer_load_dwordx4 a[244:247],v253,s[20:23],s47 offen offset:2048
M a[4:7],a[248:251],a[204:207],a[4:7]
ds_write2st64_b64 v249,v[194:195],v[196:197] offset0:102 offset1:119
M a[8:11],a[248:251],a[208:211],a[8:11]
buffer_load_dwordx2 v[194:195],v247,s[8:11],s28 offen offset:0
M a[12:15],a[248:251],a[212:215],a[12:15]
buffer_load_dwordx2 v[196:197],v247,s[8:11],s28 offen offset:384
M a[16:19],a[248:251],a[216:219],a[16:19]
ds_write2st64_b64 v249,v[198:199],v[200:201] offset0:136 offset1:153
M a[20:23],a[248:251],a[220:223],a[20:23]
buffer_load_dwordx2 v[198:199],v247,s[8:11],s28 offen offset:768
M a[24:27],a[248:251],a[192:195],a[24:27]
s_waitcnt lgkmcnt(3)
buffer_load_dwordx2 v[200:201],v247,s[8:11],s28 offen offset:1152
M a[28:31],a[248:251],a[196:199],a[28:31]
buffer_load_dwordx4 a[248:251],v253,s[20:23],s48 offen offset:2048
M a[32:35],a[252:255],a[200:203],a[32:35]
s_waitcnt vmcnt(21)
v_lshlrev_b32 v230,16,v208
v_lshlrev_b32 v228,16,v204
M a[36:39],a[252:255],a[204:207],a[36:39]
s_add_u32 s46,s44,27648
v_lshlrev_b32 v229,16,v206
v_lshlrev_b32 v233,16,v214
M a[40:43],a[252:255],a[208:211],a[40:43]
s_waitcnt vmcnt(19)
v_lshlrev_b32 v232,16,v212
v_lshlrev_b32 v231,16,v210
M a[44:47],a[252:255],a[212:215],a[44:47]
v_fmac_f32 v228,s43,v230
v_fmac_f32 v233,4.0,v229
M a[48:51],a[252:255],a[216:219],a[48:51]
v_fma_f32 v234,-4.0,v230,v232
v_fmac_f32 v228,s45,v232
M a[52:55],a[252:255],a[220:223],a[52:55]
v_fmac_f32 v233,s40,v231
v_sub_f32 v232,v232,v230
M a[56:59],a[252:255],a[192:195],a[56:59]
v_fma_f32 v230,-4.0,v229,v231
v_sub_f32 v231,v231,v229
M a[60:63],a[252:255],a[196:199],a[60:63]
buffer_load_dwordx4 a[252:255],v253,s[20:23],s46 offen offset:0
M a[64:67],v[216:219],a[200:203],a[64:67]
ds_read_b128 a[200:203],v251 offset:26112
v_add_f32 v229,v234,v230
M a[68:71],v[216:219],a[204:207],a[68:71]
s_add_u32 s47,s44,30720
ds_read_b128 a[204:207],v252 offset:26368
v_sub_f32 v234,v234,v230
M a[72:75],v[216:219],a[208:211],a[72:75]
ds_read_b128 a[208:211],v252 offset:26624
v_fma_f32 v230,2.0,v231,v232
M a[76:79],v[216:219],a[212:215],a[76:79]
ds_read_b128 a[212:215],v252 offset:26880
v_fmac_f32 v232,-2.0,v231
M a[80:83],v[216:219],a[216:219],a[80:83]
ds_read_b128 a[216:219],v252 offset:27136
v_and_b32 v237,s42,v208
M a[84:87],v[216:219],a[220:223],a[84:87]
ds_read_b128 a[220:223],v252 offset:27392
v_and_b32 v235,s42,v204
M a[88:91],v[216:219],a[192:195],a[88:91]
ds_read_b128 a[192:195],v252 offset:27648
v_and_b32 v236,s42,v206
M a[92:95],v[216:219],a[196:199],a[92:95]
s_waitcnt lgkmcnt(6)
buffer_load_dwordx4 v[216:219],v253,s[20:23],s47 offen offset:0
M a[96:99],v[220:223],a[200:203],0
s_waitcnt lgkmcnt(5)
ds_read_b128 a[196:199],v252 offset:27904
v_and_b32 v240,s42,v214
M a[100:103],v[220:223],a[204:207],0
s_waitcnt lgkmcnt(5)
s_add_u32 s48,s44,33792
v_and_b32 v239,s42,v212
v_and_b32 v238,s42,v210
M a[104:107],v[220:223],a[208:211],0
s_waitcnt lgkmcnt(4)
v_fmac_f32 v235,s43,v237
v_fmac_f32 v240,4.0,v236
M a[108:111],v[220:223],a[212:215],0
s_waitcnt lgkmcnt(3)
v_fma_f32 v231,-4.0,v237,v239
v_fmac_f32 v235,s45,v239
M a[112:115],v[220:223],a[216:219],0
s_waitcnt lgkmcnt(2)
v_fmac_f32 v240,s40,v238
v_sub_f32 v239,v239,v237
M a[116:119],v[220:223],a[220:223],0
s_waitcnt lgkmcnt(1)
v_fma_f32 v237,-4.0,v236,v238
v_sub_f32 v238,v238,v236
M a[120:123],v[220:223],a[192:195],0
s_waitcnt lgkmcnt(0)
v_add_f32 v236,v231,v237
v_sub_f32 v231,v231,v237
M a[124:127],v[220:223],a[196:199],0
buffer_load_dwordx4 v[220:223],v253,s[20:23],s48 offen offset:0
M a[128:131],v[224:227],a[200:203],0
v_fma_f32 v237,2.0,v238,v239
v_fmac_f32 v239,-2.0,v238
M a[132:135],v[224:227],a[204:207],0
v_cvt_pk_bf16_f32 v204,v228,v235
v_cvt_pk_bf16_f32 v214,v233,v240
M a[136:139],v[224:227],a[208:211],0
v_cvt_pk_bf16_f32 v206,v229,v236
v_cvt_pk_bf16_f32 v208,v234,v231
M a[140:143],v[224:227],a[212:215],0
v_cvt_pk_bf16_f32 v210,v230,v237
v_cvt_pk_bf16_f32 v212,v232,v239
M a[144:147],v[224:227],a[216:219],0
v_lshlrev_b32 v230,16,v209
v_lshlrev_b32 v228,16,v205
M a[148:151],v[224:227],a[220:223],0
v_lshlrev_b32 v229,16,v207
v_lshlrev_b32 v233,16,v215
M a[152:155],v[224:227],a[192:195],0
v_lshlrev_b32 v232,16,v213
v_lshlrev_b32 v231,16,v211
M a[156:159],v[224:227],a[196:199],0
s_waitcnt vmcnt(15)
buffer_load_dwordx4 v[224:227],v253,s[20:23],s46 offen offset:1024
M a[160:163],a[224:227],a[200:203],0
ds_read_b128 a[200:203],v252 offset:28160
v_fmac_f32 v228,s43,v230
M a[164:167],a[224:227],a[204:207],0
v_fmac_f32 v233,4.0,v229
v_fma_f32 v234,-4.0,v230,v232
M a[168:171],a[224:227],a[208:211],0
v_fmac_f32 v228,s45,v232
v_fmac_f32 v233,s40,v231
M a[172:175],a[224:227],a[212:215],0
v_sub_f32 v232,v232,v230
v_fma_f32 v230,-4.0,v229,v231
M a[176:179],a[224:227],a[216:219],0
v_sub_f32 v231,v231,v229
v_add_f32 v229,v234,v230
M a[180:183],a[224:227],a[220:223],0
v_sub_f32 v234,v234,v230
v_fma_f32 v230,2.0,v231,v232
M a[184:187],a[224:227],a[192:195],0
v_fmac_f32 v232,-2.0,v231
v_and_b32 v237,s42,v209
M a[188:191],a[224:227],a[196:199],0
s_waitcnt vmcnt(15)
buffer_load_dwordx4 a[224:227],v253,s[20:23],s47 offen offset:1024
M a[96:99],a[228:231],a[204:207],a[96:99]
v_and_b32 v235,s42,v205
v_and_b32 v236,s42,v207
M a[100:103],a[228:231],a[208:211],a[100:103]
v_and_b32 v240,s42,v215
v_and_b32 v239,s42,v213
M a[104:107],a[228:231],a[212:215],a[104:107]
v_and_b32 v238,s42,v211
v_fmac_f32 v235,s43,v237
M a[108:111],a[228:231],a[216:219],a[108:111]
v_fmac_f32 v240,4.0,v236
v_fma_f32 v231,-4.0,v237,v239
M a[112:115],a[228:231],a[220:223],a[112:115]
v_fmac_f32 v235,s45,v239
v_fmac_f32 v240,s40,v238
M a[116:119],a[228:231],a[192:195],a[116:119]
v_sub_f32 v239,v239,v237
v_fma_f32 v237,-4.0,v236,v238
M a[120:123],a[228:231],a[196:199],a[120:123]
s_waitcnt lgkmcnt(0)
v_sub_f32 v238,v238,v236
v_add_f32 v236,v231,v237
M a[124:127],a[228:231],a[200:203],a[124:127]
s_waitcnt vmcnt(15)
buffer_load_dwordx4 a[228:231],v253,s[20:23],s48 offen offset:1024
M a[128:131],a[232:235],a[204:207],a[128:131]
v_sub_f32 v231,v231,v237
v_fma_f32 v237,2.0,v238,v239
M a[132:135],a[232:235],a[208:211],a[132:135]
v_fmac_f32 v239,-2.0,v238
v_cvt_pk_bf16_f32 v205,v228,v235
v_cvt_pk_bf16_f32 v215,v233,v240
M a[136:139],a[232:235],a[212:215],a[136:139]
v_cvt_pk_bf16_f32 v207,v229,v236
v_cvt_pk_bf16_f32 v209,v234,v231
M a[140:143],a[232:235],a[216:219],a[140:143]
v_cvt_pk_bf16_f32 v211,v230,v237
v_cvt_pk_bf16_f32 v213,v232,v239
M a[144:147],a[232:235],a[220:223],a[144:147]
ds_write2st64_b64 v249,v[204:205],v[214:215] offset0:171 offset1:188
M a[148:151],a[232:235],a[192:195],a[148:151]
s_add_u32 s28,s30,1179712
buffer_load_dwordx2 v[204:205],v247,s[12:15],s28 offen offset:0
M a[152:155],a[232:235],a[196:199],a[152:155]
buffer_load_dwordx2 v[214:215],v247,s[16:19],s28 offen offset:1536
M a[156:159],a[232:235],a[200:203],a[156:159]
s_waitcnt vmcnt(17)
buffer_load_dwordx4 a[232:235],v253,s[20:23],s46 offen offset:2048
M a[160:163],a[236:239],a[204:207],a[160:163]
ds_read_b128 a[204:207],v251 offset:28416
ds_write2st64_b64 v249,v[206:207],v[208:209] offset0:103 offset1:120
M a[164:167],a[236:239],a[208:211],a[164:167]
buffer_load_dwordx2 v[206:207],v247,s[8:11],s28 offen offset:0
M a[168:171],a[236:239],a[212:215],a[168:171]
buffer_load_dwordx2 v[208:209],v247,s[8:11],s28 offen offset:384
M a[172:175],a[236:239],a[216:219],a[172:175]
ds_write2st64_b64 v249,v[210:211],v[212:213] offset0:137 offset1:154
M a[176:179],a[236:239],a[220:223],a[176:179]
buffer_load_dwordx2 v[210:211],v247,s[8:11],s28 offen offset:768
M a[180:183],a[236:239],a[192:195],a[180:183]
buffer_load_dwordx2 v[212:213],v247,s[8:11],s28 offen offset:1152
M a[184:187],a[236:239],a[196:199],a[184:187]
v_fmac_f32 v241,s43,v243
v_fmac_f32 v246,4.0,v242
M a[188:191],a[236:239],a[200:203],a[188:191]
s_waitcnt vmcnt(21)
buffer_load_dwordx4 a[236:239],v253,s[20:23],s47 offen offset:2048
M a[96:99],a[240:243],a[208:211],a[96:99]
v_fma_f32 v228,-4.0,v243,v245
v_fmac_f32 v241,s45,v245
M a[100:103],a[240:243],a[212:215],a[100:103]
v_fmac_f32 v246,s40,v244
v_sub_f32 v245,v245,v243
M a[104:107],a[240:243],a[216:219],a[104:107]
v_fma_f32 v243,-4.0,v242,v244
v_sub_f32 v244,v244,v242
M a[108:111],a[240:243],a[220:223],a[108:111]
v_add_f32 v242,v228,v243
v_sub_f32 v228,v228,v243
M a[112:115],a[240:243],a[192:195],a[112:115]
v_fma_f32 v243,2.0,v244,v245
v_fmac_f32 v245,-2.0,v244
M a[116:119],a[240:243],a[196:199],a[116:119]
v_cvt_pk_bf16_f32 v229,v241,v246
v_cvt_pk_bf16_f32 v230,v242,v228
M a[120:123],a[240:243],a[200:203],a[120:123]
s_waitcnt lgkmcnt(2)
v_cvt_pk_bf16_f32 v231,v243,v245
v_add_u32 v228,87040,v250
M a[124:127],a[240:243],a[204:207],a[124:127]
s_waitcnt vmcnt(19)
s_add_u32 s29,s31,128
buffer_load_short_d16_hi v241,v248,s[12:15],s29 offen offset:0
M a[128:131],a[244:247],a[208:211],a[128:131]
buffer_load_short_d16_hi v242,v248,s[8:11],s29 offen offset:0
M a[132:135],a[244:247],a[212:215],a[132:135]
buffer_load_short_d16_hi v243,v248,s[8:11],s29 offen offset:384
M a[136:139],a[244:247],a[216:219],a[136:139]
buffer_load_short_d16_hi v244,v248,s[8:11],s29 offen offset:768
M a[140:143],a[244:247],a[220:223],a[140:143]
buffer_load_short_d16_hi v245,v248,s[8:11],s29 offen offset:1152
M a[144:147],a[244:247],a[192:195],a[144:147]
buffer_load_short_d16_hi v246,v248,s[16:19],s29 offen offset:1536
M a[148:151],a[244:247],a[196:199],a[148:151]
buffer_load_dwordx4 a[240:243],v253,s[20:23],s48 offen offset:2048
M a[152:155],a[244:247],a[200:203],a[152:155]
s_add_u32 s46,s44,36864
ds_write_b16 v228,v229 offset:0
M a[156:159],a[244:247],a[204:207],a[156:159]
s_waitcnt vmcnt(21)
buffer_load_dwordx4 a[244:247],v253,s[20:23],s46 offen offset:0
M a[160:163],a[248:251],a[208:211],a[160:163]
ds_read_b128 a[208:211],v251 offset:34816
ds_write_b16_d16_hi v228,v229 offset:8704
M a[164:167],a[248:251],a[212:215],a[164:167]
s_add_u32 s47,s44,39936
ds_read_b128 a[212:215],v252 offset:35072
ds_write_b16 v250,v230 offset:52224
M a[168:171],a[248:251],a[216:219],a[168:171]
ds_read_b128 a[216:219],v252 offset:35328
ds_write_b16_d16_hi v250,v230 offset:60928
M a[172:175],a[248:251],a[220:223],a[172:175]
ds_read_b128 a[220:223],v252 offset:35584
v_add_u32 v228,69632,v250
M a[176:179],a[248:251],a[192:195],a[176:179]
ds_read_b128 a[192:195],v252 offset:35840
ds_write_b16 v228,v231 offset:0
M a[180:183],a[248:251],a[196:199],a[180:183]
ds_read_b128 a[196:199],v252 offset:36096
ds_write_b16_d16_hi v228,v231 offset:8704
M a[184:187],a[248:251],a[200:203],a[184:187]
ds_read_b128 a[200:203],v252 offset:36352
v_lshlrev_b32 v230,16,v196
M a[188:191],a[248:251],a[204:207],a[188:191]
s_waitcnt vmcnt(21) lgkmcnt(11)
buffer_load_dwordx4 a[248:251],v253,s[20:23],s47 offen offset:0
M v[0:3],a[252:255],a[208:211],0
s_waitcnt lgkmcnt(9)
ds_read_b128 a[204:207],v252 offset:36608
v_lshlrev_b32 v228,16,v192
M v[4:7],a[252:255],a[212:215],0
s_waitcnt lgkmcnt(8)
s_add_u32 s48,s44,43008
v_lshlrev_b32 v229,16,v194
v_lshlrev_b32 v233,16,v202
M v[8:11],a[252:255],a[216:219],0
s_waitcnt lgkmcnt(6)
v_lshlrev_b32 v232,16,v200
v_lshlrev_b32 v231,16,v198
M v[12:15],a[252:255],a[220:223],0
s_waitcnt lgkmcnt(5)
v_fmac_f32 v228,s43,v230
v_fmac_f32 v233,4.0,v229
M v[16:19],a[252:255],a[192:195],0
s_waitcnt lgkmcnt(3)
v_fma_f32 v234,-4.0,v230,v232
v_fmac_f32 v228,s45,v232
M v[20:23],a[252:255],a[196:199],0
s_waitcnt lgkmcnt(1)
v_fmac_f32 v233,s40,v231
v_sub_f32 v232,v232,v230
M v[24:27],a[252:255],a[200:203],0
s_waitcnt lgkmcnt(0)
v_fma_f32 v230,-4.0,v229,v231
v_sub_f32 v231,v231,v229
M v[28:31],a[252:255],a[204:207],0
s_waitcnt vmcnt(21)
buffer_load_dwordx4 a[252:255],v253,s[20:23],s48 offen offset:0
M v[32:35],v[216:219],a[208:211],0
v_add_f32 v229,v234,v230
v_sub_f32 v234,v234,v230
M v[36:39],v[216:219],a[212:215],0
v_fma_f32 v230,2.0,v231,v232
v_fmac_f32 v232,-2.0,v231
M v[40:43],v[216:219],a[216:219],0
v_and_b32 v237,s42,v196
v_and_b32 v235,s42,v192
M v[44:47],v[216:219],a[220:223],0
v_and_b32 v236,s42,v194
v_and_b32 v240,s42,v202
M v[48:51],v[216:219],a[192:195],0
v_and_b32 v239,s42,v200
v_and_b32 v238,s42,v198
M v[52:55],v[216:219],a[196:199],0
v_fmac_f32 v235,s43,v237
v_fmac_f32 v240,4.0,v236
M v[56:59],v[216:219],a[200:203],0
v_fma_f32 v231,-4.0,v237,v239
v_fmac_f32 v235,s45,v239
M v[60:63],v[216:219],a[204:207],0
s_waitcnt vmcnt(21)
buffer_load_dwordx4 v[216:219],v253,s[20:23],s46 offen offset:1024
M v[64:67],v[220:223],a[208:211],0
ds_read_b128 a[208:211],v252 offset:36864
v_fmac_f32 v240,s40,v238
M v[68:71],v[220:223],a[212:215],0
v_sub_f32 v239,v239,v237
v_fma_f32 v237,-4.0,v236,v238
M v[72:75],v[220:223],a[216:219],0
v_sub_f32 v238,v238,v236
v_add_f32 v236,v231,v237
M v[76:79],v[220:223],a[220:223],0
v_sub_f32 v231,v231,v237
v_fma_f32 v237,2.0,v238,v239
M v[80:83],v[220:223],a[192:195],0
v_fmac_f32 v239,-2.0,v238
v_cvt_pk_bf16_f32 v192,v228,v235
M v[84:87],v[220:223],a[196:199],0
v_cvt_pk_bf16_f32 v202,v233,v240
v_cvt_pk_bf16_f32 v194,v229,v236
M v[88:91],v[220:223],a[200:203],0
v_cvt_pk_bf16_f32 v196,v234,v231
v_cvt_pk_bf16_f32 v198,v230,v237
M v[92:95],v[220:223],a[204:207],0
s_waitcnt vmcnt(21)
buffer_load_dwordx4 v[220:223],v253,s[20:23],s47 offen offset:1024
M v[0:3],v[224:227],a[212:215],v[0:3]
v_cvt_pk_bf16_f32 v200,v232,v239
v_lshlrev_b32 v230,16,v197
M v[4:7],v[224:227],a[216:219],v[4:7]
v_lshlrev_b32 v228,16,v193
v_lshlrev_b32 v229,16,v195
M v[8:11],v[224:227],a[220:223],v[8:11]
v_lshlrev_b32 v233,16,v203
v_lshlrev_b32 v232,16,v201
M v[12:15],v[224:227],a[192:195],v[12:15]
v_lshlrev_b32 v231,16,v199
v_fmac_f32 v228,s43,v230
M v[16:19],v[224:227],a[196:199],v[16:19]
v_fmac_f32 v233,4.0,v229
v_fma_f32 v234,-4.0,v230,v232
M v[20:23],v[224:227],a[200:203],v[20:23]
v_fmac_f32 v228,s45,v232
v_fmac_f32 v233,s40,v231
M v[24:27],v[224:227],a[204:207],v[24:27]
s_waitcnt lgkmcnt(0)
v_sub_f32 v232,v232,v230
v_fma_f32 v230,-4.0,v229,v231
M v[28:31],v[224:227],a[208:211],v[28:31]
s_waitcnt vmcnt(21)
buffer_load_dwordx4 v[224:227],v253,s[20:23],s48 offen offset:1024
M v[32:35],a[224:227],a[212:215],v[32:35]
v_sub_f32 v231,v231,v229
v_add_f32 v229,v234,v230
M v[36:39],a[224:227],a[216:219],v[36:39]
v_sub_f32 v234,v234,v230
v_fma_f32 v230,2.0,v231,v232
M v[40:43],a[224:227],a[220:223],v[40:43]
v_fmac_f32 v232,-2.0,v231
v_and_b32 v237,s42,v197
M v[44:47],a[224:227],a[192:195],v[44:47]
v_and_b32 v235,s42,v193
v_and_b32 v236,s42,v195
M v[48:51],a[224:227],a[196:199],v[48:51]
v_and_b32 v240,s42,v203
v_and_b32 v239,s42,v201
M v[52:55],a[224:227],a[200:203],v[52:55]
v_and_b32 v238,s42,v199
v_fmac_f32 v235,s43,v237
M v[56:59],a[224:227],a[204:207],v[56:59]
v_fmac_f32 v240,4.0,v236
v_fma_f32 v231,-4.0,v237,v239
M v[60:63],a[224:227],a[208:211],v[60:63]
s_waitcnt vmcnt(21)
buffer_load_dwordx4 a[224:227],v253,s[20:23],s46 offen offset:2048
M v[64:67],a[228:231],a[212:215],v[64:67]
ds_read_b128 a[212:215],v251 offset:37120
v_fmac_f32 v235,s45,v239
M v[68:71],a[228:231],a[216:219],v[68:71]
v_fmac_f32 v240,s40,v238
v_sub_f32 v239,v239,v237
M v[72:75],a[228:231],a[220:223],v[72:75]
v_fma_f32 v237,-4.0,v236,v238
v_sub_f32 v238,v238,v236
M v[76:79],a[228:231],a[192:195],v[76:79]
v_add_f32 v236,v231,v237
v_sub_f32 v231,v231,v237
M v[80:83],a[228:231],a[196:199],v[80:83]
v_fma_f32 v237,2.0,v238,v239
v_fmac_f32 v239,-2.0,v238
M v[84:87],a[228:231],a[200:203],v[84:87]
v_cvt_pk_bf16_f32 v193,v228,v235
v_cvt_pk_bf16_f32 v203,v233,v240
M v[88:91],a[228:231],a[204:207],v[88:91]
v_cvt_pk_bf16_f32 v195,v229,v236
v_cvt_pk_bf16_f32 v197,v234,v231
M v[92:95],a[228:231],a[208:211],v[92:95]
s_waitcnt vmcnt(19)
buffer_load_dwordx4 a[228:231],v253,s[20:23],s47 offen offset:2048
M v[0:3],a[232:235],a[216:219],v[0:3]
v_cvt_pk_bf16_f32 v199,v230,v237
v_cvt_pk_bf16_f32 v201,v232,v239
M v[4:7],a[232:235],a[220:223],v[4:7]
ds_write2st64_b64 v249,v[192:193],v[202:203] offset0:172 offset1:189
M v[8:11],a[232:235],a[192:195],v[8:11]
s_add_u32 s28,s30,128
buffer_load_dwordx2 v[192:193],v247,s[12:15],s28 offen offset:0
M v[12:15],a[232:235],a[196:199],v[12:15]
buffer_load_dwordx2 v[202:203],v247,s[16:19],s28 offen offset:1536
M v[16:19],a[232:235],a[200:203],v[16:19]
ds_write2st64_b64 v249,v[194:195],v[196:197] offset0:104 offset1:121
M v[20:23],a[232:235],a[204:207],v[20:23]
buffer_load_dwordx2 v[194:195],v247,s[8:11],s28 offen offset:0
M v[24:27],a[232:235],a[208:211],v[24:27]
s_waitcnt lgkmcnt(2)
buffer_load_dwordx2 v[196:197],v247,s[8:11],s28 offen offset:384
M v[28:31],a[232:235],a[212:215],v[28:31]
s_waitcnt vmcnt(19)
buffer_load_dwordx4 a[232:235],v253,s[20:23],s48 offen offset:2048
M v[32:35],a[236:239],a[216:219],v[32:35]
ds_write2st64_b64 v249,v[198:199],v[200:201] offset0:138 offset1:155
M v[36:39],a[236:239],a[220:223],v[36:39]
s_add_u32 s46,s44,64512
buffer_load_dwordx2 v[198:199],v247,s[8:11],s28 offen offset:768
M v[40:43],a[236:239],a[192:195],v[40:43]
buffer_load_dwordx2 v[200:201],v247,s[8:11],s28 offen offset:1152
M v[44:47],a[236:239],a[196:199],v[44:47]
v_lshlrev_b32 v230,16,v208
v_lshlrev_b32 v228,16,v204
M v[48:51],a[236:239],a[200:203],v[48:51]
v_lshlrev_b32 v229,16,v206
v_lshlrev_b32 v233,16,v214
M v[52:55],a[236:239],a[204:207],v[52:55]
v_lshlrev_b32 v232,16,v212
v_lshlrev_b32 v231,16,v210
M v[56:59],a[236:239],a[208:211],v[56:59]
v_fmac_f32 v228,s43,v230
v_fmac_f32 v233,4.0,v229
M v[60:63],a[236:239],a[212:215],v[60:63]
s_waitcnt vmcnt(15)
buffer_load_dwordx4 a[236:239],v253,s[20:23],s46 offen offset:0
M v[64:67],a[240:243],a[216:219],v[64:67]
ds_read_b128 a[216:219],v251 offset:43520
v_fma_f32 v234,-4.0,v230,v232
M v[68:71],a[240:243],a[220:223],v[68:71]
s_add_u32 s47,s44,67584
ds_read_b128 a[220:223],v252 offset:43776
v_fmac_f32 v228,s45,v232
M v[72:75],a[240:243],a[192:195],v[72:75]
ds_read_b128 a[192:195],v252 offset:44032
v_fmac_f32 v233,s40,v231
M v[76:79],a[240:243],a[196:199],v[76:79]
ds_read_b128 a[196:199],v252 offset:44288
v_sub_f32 v232,v232,v230
M v[80:83],a[240:243],a[200:203],v[80:83]
ds_read_b128 a[200:203],v252 offset:44544
v_fma_f32 v230,-4.0,v229,v231
M v[84:87],a[240:243],a[204:207],v[84:87]
ds_read_b128 a[204:207],v252 offset:44800
v_sub_f32 v231,v231,v229
M v[88:91],a[240:243],a[208:211],v[88:91]
ds_read_b128 a[208:211],v252 offset:45056
v_add_f32 v229,v234,v230
M v[92:95],a[240:243],a[212:215],v[92:95]
s_waitcnt vmcnt(15) lgkmcnt(6)
buffer_load_dwordx4 a[240:243],v253,s[20:23],s47 offen offset:0
M v[96:99],a[244:247],a[216:219],0
s_waitcnt lgkmcnt(5)
ds_read_b128 a[212:215],v252 offset:45312
v_sub_f32 v234,v234,v230
M v[100:103],a[244:247],a[220:223],0
s_waitcnt lgkmcnt(5)
s_add_u32 s48,s44,70656
v_fma_f32 v230,2.0,v231,v232
v_fmac_f32 v232,-2.0,v231
M v[104:107],a[244:247],a[192:195],0
s_waitcnt lgkmcnt(4)
v_and_b32 v237,s42,v208
v_and_b32 v235,s42,v204
M v[108:111],a[244:247],a[196:199],0
s_waitcnt lgkmcnt(3)
v_and_b32 v236,s42,v206
v_and_b32 v240,s42,v214
M v[112:115],a[244:247],a[200:203],0
s_waitcnt lgkmcnt(2)
v_and_b32 v239,s42,v212
v_and_b32 v238,s42,v210
M v[116:119],a[244:247],a[204:207],0
s_waitcnt lgkmcnt(1)
v_fmac_f32 v235,s43,v237
v_fmac_f32 v240,4.0,v236
M v[120:123],a[244:247],a[208:211],0
s_waitcnt lgkmcnt(0)
v_fma_f32 v231,-4.0,v237,v239
v_fmac_f32 v235,s45,v239
M v[124:127],a[244:247],a[212:215],0
s_waitcnt vmcnt(15)
buffer_load_dwordx4 a[244:247],v253,s[20:23],s48 offen offset:0
M v[128:131],a[248:251],a[216:219],0
v_fmac_f32 v240,s40,v238
v_sub_f32 v239,v239,v237
M v[132:135],a[248:251],a[220:223],0
v_fma_f32 v237,-4.0,v236,v238
v_sub_f32 v238,v238,v236
M v[136:139],a[248:251],a[192:195],0
v_add_f32 v236,v231,v237
v_sub_f32 v231,v231,v237
M v[140:143],a[248:251],a[196:199],0
v_fma_f32 v237,2.0,v238,v239
v_fmac_f32 v239,-2.0,v238
M v[144:147],a[248:251],a[200:203],0
v_cvt_pk_bf16_f32 v204,v228,v235
v_cvt_pk_bf16_f32 v214,v233,v240
M v[148:151],a[248:251],a[204:207],0
v_cvt_pk_bf16_f32 v206,v229,v236
v_cvt_pk_bf16_f32 v208,v234,v231
M v[152:155],a[248:251],a[208:211],0
v_cvt_pk_bf16_f32 v210,v230,v237
v_cvt_pk_bf16_f32 v212,v232,v239
M v[156:159],a[248:251],a[212:215],0
s_waitcnt vmcnt(15)
buffer_load_dwordx4 a[248:251],v253,s[20:23],s46 offen offset:1024
M v[160:163],a[252:255],a[216:219],0
ds_read_b128 a[216:219],v252 offset:45568
v_lshlrev_b32 v230,16,v209
M v[164:167],a[252:255],a[220:223],0
v_lshlrev_b32 v228,16,v205
v_lshlrev_b32 v229,16,v207
M v[168:171],a[252:255],a[192:195],0
v_lshlrev_b32 v233,16,v215
v_lshlrev_b32 v232,16,v213
M v[172:175],a[252:255],a[196:199],0
v_lshlrev_b32 v231,16,v211
v_fmac_f32 v228,s43,v230
M v[176:179],a[252:255],a[200:203],0
v_fmac_f32 v233,4.0,v229
v_fma_f32 v234,-4.0,v230,v232
M v[180:183],a[252:255],a[204:207],0
v_fmac_f32 v228,s45,v232
v_fmac_f32 v233,s40,v231
M v[184:187],a[252:255],a[208:211],0
v_sub_f32 v232,v232,v230
v_fma_f32 v230,-4.0,v229,v231
M v[188:191],a[252:255],a[212:215],0
s_waitcnt vmcnt(15)
buffer_load_dwordx4 a[252:255],v253,s[20:23],s47 offen offset:1024
M v[96:99],v[216:219],a[220:223],v[96:99]
v_sub_f32 v231,v231,v229
v_add_f32 v229,v234,v230
M v[100:103],v[216:219],a[192:195],v[100:103]
v_sub_f32 v234,v234,v230
v_fma_f32 v230,2.0,v231,v232
M v[104:107],v[216:219],a[196:199],v[104:107]
v_fmac_f32 v232,-2.0,v231
v_and_b32 v237,s42,v209
M v[108:111],v[216:219],a[200:203],v[108:111]
v_and_b32 v235,s42,v205
v_and_b32 v236,s42,v207
M v[112:115],v[216:219],a[204:207],v[112:115]
v_and_b32 v240,s42,v215
v_and_b32 v239,s42,v213
M v[116:119],v[216:219],a[208:211],v[116:119]
v_and_b32 v238,s42,v211
v_fmac_f32 v235,s43,v237
M v[120:123],v[216:219],a[212:215],v[120:123]
s_waitcnt lgkmcnt(0)
v_fmac_f32 v240,4.0,v236
v_fma_f32 v231,-4.0,v237,v239
M v[124:127],v[216:219],a[216:219],v[124:127]
s_waitcnt vmcnt(15)
buffer_load_dwordx4 v[216:219],v253,s[20:23],s48 offen offset:1024
M v[128:131],v[220:223],a[220:223],v[128:131]
v_fmac_f32 v235,s45,v239
v_fmac_f32 v240,s40,v238
M v[132:135],v[220:223],a[192:195],v[132:135]
v_sub_f32 v239,v239,v237
v_fma_f32 v237,-4.0,v236,v238
M v[136:139],v[220:223],a[196:199],v[136:139]
v_sub_f32 v238,v238,v236
v_add_f32 v236,v231,v237
M v[140:143],v[220:223],a[200:203],v[140:143]
v_sub_f32 v231,v231,v237
v_fma_f32 v237,2.0,v238,v239
M v[144:147],v[220:223],a[204:207],v[144:147]
v_fmac_f32 v239,-2.0,v238
v_cvt_pk_bf16_f32 v205,v228,v235
M v[148:151],v[220:223],a[208:211],v[148:151]
v_cvt_pk_bf16_f32 v215,v233,v240
v_cvt_pk_bf16_f32 v207,v229,v236
M v[152:155],v[220:223],a[212:215],v[152:155]
v_cvt_pk_bf16_f32 v209,v234,v231
v_cvt_pk_bf16_f32 v211,v230,v237
M v[156:159],v[220:223],a[216:219],v[156:159]
s_waitcnt vmcnt(15)
buffer_load_dwordx4 v[220:223],v253,s[20:23],s46 offen offset:2048
M v[160:163],v[224:227],a[220:223],v[160:163]
ds_read_b128 a[220:223],v251 offset:45824
v_cvt_pk_bf16_f32 v213,v232,v239
M v[164:167],v[224:227],a[192:195],v[164:167]
ds_write2st64_b64 v249,v[204:205],v[214:215] offset0:173 offset1:190
M v[168:171],v[224:227],a[196:199],v[168:171]
s_add_u32 s28,s30,393344
buffer_load_dwordx2 v[204:205],v247,s[12:15],s28 offen offset:0
M v[172:175],v[224:227],a[200:203],v[172:175]
buffer_load_dwordx2 v[214:215],v247,s[16:19],s28 offen offset:1536
M v[176:179],v[224:227],a[204:207],v[176:179]
ds_write2st64_b64 v249,v[206:207],v[208:209] offset0:105 offset1:122
M v[180:183],v[224:227],a[208:211],v[180:183]
buffer_load_dwordx2 v[206:207],v247,s[8:11],s28 offen offset:0
M v[184:187],v[224:227],a[212:215],v[184:187]
buffer_load_dwordx2 v[208:209],v247,s[8:11],s28 offen offset:384
M v[188:191],v[224:227],a[216:219],v[188:191]
s_waitcnt vmcnt(19)
buffer_load_dwordx4 v[224:227],v253,s[20:23],s47 offen offset:2048
M v[96:99],a[224:227],a[192:195],v[96:99]
ds_write2st64_b64 v249,v[210:211],v[212:213] offset0:139 offset1:156
M v[100:103],a[224:227],a[196:199],v[100:103]
buffer_load_dwordx2 v[210:211],v247,s[8:11],s28 offen offset:768
M v[104:107],a[224:227],a[200:203],v[104:107]
buffer_load_dwordx2 v[212:213],v247,s[8:11],s28 offen offset:1152
M v[108:111],a[224:227],a[204:207],v[108:111]
s_waitcnt vmcnt(17)
v_lshlrev_b32 v230,16,v196
v_lshlrev_b32 v228,16,v192
M v[112:115],a[224:227],a[208:211],v[112:115]
v_lshlrev_b32 v229,16,v194
v_lshlrev_b32 v233,16,v202
M v[116:119],a[224:227],a[212:215],v[116:119]
s_waitcnt vmcnt(14)
v_lshlrev_b32 v232,16,v200
v_lshlrev_b32 v231,16,v198
M v[120:123],a[224:227],a[216:219],v[120:123]
s_waitcnt lgkmcnt(3)
v_fmac_f32 v228,s43,v230
v_fmac_f32 v233,4.0,v229
M v[124:127],a[224:227],a[220:223],v[124:127]
buffer_load_dwordx4 a[224:227],v253,s[20:23],s48 offen offset:2048
M v[128:131],a[228:231],a[192:195],v[128:131]
v_fma_f32 v234,-4.0,v230,v232
v_fmac_f32 v228,s45,v232
M v[132:135],a[228:231],a[196:199],v[132:135]
s_add_u32 s46,s44,73728
v_fmac_f32 v233,s40,v231
v_sub_f32 v232,v232,v230
M v[136:139],a[228:231],a[200:203],v[136:139]
v_fma_f32 v230,-4.0,v229,v231
v_sub_f32 v231,v231,v229
M v[140:143],a[228:231],a[204:207],v[140:143]
v_add_f32 v229,v234,v230
v_sub_f32 v234,v234,v230
M v[144:147],a[228:231],a[208:211],v[144:147]
v_fma_f32 v230,2.0,v231,v232
v_fmac_f32 v232,-2.0,v231
M v[148:151],a[228:231],a[212:215],v[148:151]
v_and_b32 v237,s42,v196
v_and_b32 v235,s42,v192
M v[152:155],a[228:231],a[216:219],v[152:155]
s_waitcnt lgkmcnt(0)
s_barrier
v_and_b32 v236,s42,v194
M v[156:159],a[228:231],a[220:223],v[156:159]
buffer_load_dwordx4 a[228:231],v253,s[20:23],s46 offen offset:0
M v[160:163],a[232:235],a[192:195],v[160:163]
ds_read_b128 a[192:195],v251 offset:52224
v_and_b32 v240,s42,v202
M v[164:167],a[232:235],a[196:199],v[164:167]
s_add_u32 s47,s44,76800
ds_read_b128 a[196:199],v252 offset:52480
v_and_b32 v239,s42,v200
M v[168:171],a[232:235],a[200:203],v[168:171]
ds_read_b128 a[200:203],v252 offset:52736
v_and_b32 v238,s42,v198
M v[172:175],a[232:235],a[204:207],v[172:175]
ds_read_b128 a[204:207],v252 offset:52992
v_fmac_f32 v235,s43,v237
M v[176:179],a[232:235],a[208:211],v[176:179]
ds_read_b128 a[208:211],v252 offset:53248
v_fmac_f32 v240,4.0,v236
M v[180:183],a[232:235],a[212:215],v[180:183]
ds_read_b128 a[212:215],v252 offset:53504
v_fma_f32 v231,-4.0,v237,v239
M v[184:187],a[232:235],a[216:219],v[184:187]
ds_read_b128 a[216:219],v252 offset:53760
v_fmac_f32 v235,s45,v239
M v[188:191],a[232:235],a[220:223],v[188:191]
s_waitcnt vmcnt(15) lgkmcnt(6)
buffer_load_dwordx4 a[232:235],v253,s[20:23],s47 offen offset:0
M a[0:3],a[236:239],a[192:195],a[0:3]
s_waitcnt lgkmcnt(5)
ds_read_b128 a[220:223],v252 offset:54016
v_fmac_f32 v240,s40,v238
M a[4:7],a[236:239],a[196:199],a[4:7]
s_waitcnt lgkmcnt(5)
s_add_u32 s48,s44,79872
v_sub_f32 v239,v239,v237
v_fma_f32 v237,-4.0,v236,v238
M a[8:11],a[236:239],a[200:203],a[8:11]
s_waitcnt lgkmcnt(4)
v_sub_f32 v238,v238,v236
v_add_f32 v236,v231,v237
M a[12:15],a[236:239],a[204:207],a[12:15]
s_waitcnt lgkmcnt(3)
v_sub_f32 v231,v231,v237
v_fma_f32 v237,2.0,v238,v239
M a[16:19],a[236:239],a[208:211],a[16:19]
s_waitcnt lgkmcnt(2)
v_fmac_f32 v239,-2.0,v238
v_cvt_pk_bf16_f32 v192,v228,v235
M a[20:23],a[236:239],a[212:215],a[20:23]
s_waitcnt lgkmcnt(1)
v_cvt_pk_bf16_f32 v202,v233,v240
v_cvt_pk_bf16_f32 v194,v229,v236
M a[24:27],a[236:239],a[216:219],a[24:27]
s_waitcnt lgkmcnt(0)
v_cvt_pk_bf16_f32 v196,v234,v231
v_cvt_pk_bf16_f32 v198,v230,v237
M a[28:31],a[236:239],a[220:223],a[28:31]
s_waitcnt vmcnt(15)
buffer_load_dwordx4 a[236:239],v253,s[20:23],s48 offen offset:0
M a[32:35],a[240:243],a[192:195],a[32:35]
v_cvt_pk_bf16_f32 v200,v232,v239
v_lshlrev_b32 v230,16,v197
M a[36:39],a[240:243],a[196:199],a[36:39]
v_lshlrev_b32 v228,16,v193
v_lshlrev_b32 v229,16,v195
M a[40:43],a[240:243],a[200:203],a[40:43]
v_lshlrev_b32 v233,16,v203
v_lshlrev_b32 v232,16,v201
M a[44:47],a[240:243],a[204:207],a[44:47]
v_lshlrev_b32 v231,16,v199
v_fmac_f32 v228,s43,v230
M a[48:51],a[240:243],a[208:211],a[48:51]
v_fmac_f32 v233,4.0,v229
v_fma_f32 v234,-4.0,v230,v232
M a[52:55],a[240:243],a[212:215],a[52:55]
v_fmac_f32 v228,s45,v232
v_fmac_f32 v233,s40,v231
M a[56:59],a[240:243],a[216:219],a[56:59]
v_sub_f32 v232,v232,v230
v_fma_f32 v230,-4.0,v229,v231
M a[60:63],a[240:243],a[220:223],a[60:63]
s_waitcnt vmcnt(15)
buffer_load_dwordx4 a[240:243],v253,s[20:23],s46 offen offset:1024
M a[64:67],a[244:247],a[192:195],a[64:67]
ds_read_b128 a[192:195],v252 offset:54272
v_sub_f32 v231,v231,v229
M a[68:71],a[244:247],a[196:199],a[68:71]
v_add_f32 v229,v234,v230
v_sub_f32 v234,v234,v230
M a[72:75],a[244:247],a[200:203],a[72:75]
v_fma_f32 v230,2.0,v231,v232
v_fmac_f32 v232,-2.0,v231
M a[76:79],a[244:247],a[204:207],a[76:79]
v_and_b32 v237,s42,v197
v_and_b32 v235,s42,v193
M a[80:83],a[244:247],a[208:211],a[80:83]
v_and_b32 v236,s42,v195
v_and_b32 v240,s42,v203
M a[84:87],a[244:247],a[212:215],a[84:87]
v_and_b32 v239,s42,v201
v_and_b32 v238,s42,v199
M a[88:91],a[244:247],a[216:219],a[88:91]
v_fmac_f32 v235,s43,v237
v_fmac_f32 v240,4.0,v236
M a[92:95],a[244:247],a[220:223],a[92:95]
s_waitcnt vmcnt(15)
buffer_load_dwordx4 a[244:247],v253,s[20:23],s47 offen offset:1024
M a[0:3],a[248:251],a[196:199],a[0:3]
v_fma_f32 v231,-4.0,v237,v239
v_fmac_f32 v235,s45,v239
M a[4:7],a[248:251],a[200:203],a[4:7]
v_fmac_f32 v240,s40,v238
v_sub_f32 v239,v239,v237
M a[8:11],a[248:251],a[204:207],a[8:11]
v_fma_f32 v237,-4.0,v236,v238
v_sub_f32 v238,v238,v236
M a[12:15],a[248:251],a[208:211],a[12:15]
v_add_f32 v236,v231,v237
v_sub_f32 v231,v231,v237
M a[16:19],a[248:251],a[212:215],a[16:19]
v_fma_f32 v237,2.0,v238,v239
v_fmac_f32 v239,-2.0,v238
M a[20:23],a[248:251],a[216:219],a[20:23]
v_cvt_pk_bf16_f32 v193,v228,v235
v_cvt_pk_bf16_f32 v203,v233,v240
M a[24:27],a[248:251],a[220:223],a[24:27]
s_waitcnt lgkmcnt(0)
v_cvt_pk_bf16_f32 v195,v229,v236
v_cvt_pk_bf16_f32 v197,v234,v231
M a[28:31],a[248:251],a[192:195],a[28:31]
s_waitcnt vmcnt(15)
buffer_load_dwordx4 a[248:251],v253,s[20:23],s48 offen offset:1024
M a[32:35],a[252:255],a[196:199],a[32:35]
v_cvt_pk_bf16_f32 v199,v230,v237
v_cvt_pk_bf16_f32 v201,v232,v239
M a[36:39],a[252:255],a[200:203],a[36:39]
ds_write2st64_b64 v249,v[192:193],v[202:203] offset0:204 offset1:221
M a[40:43],a[252:255],a[204:207],a[40:43]
s_add_u32 s28,s30,786560
buffer_load_dwordx2 v[192:193],v247,s[12:15],s28 offen offset:0
M a[44:47],a[252:255],a[208:211],a[44:47]
buffer_load_dwordx2 v[202:203],v247,s[16:19],s28 offen offset:1536
M a[48:51],a[252:255],a[212:215],a[48:51]
ds_write2st64_b64 v249,v[194:195],v[196:197] offset0:34 offset1:51
M a[52:55],a[252:255],a[216:219],a[52:55]
buffer_load_dwordx2 v[194:195],v247,s[8:11],s28 offen offset:0
M a[56:59],a[252:255],a[220:223],a[56:59]
buffer_load_dwordx2 v[196:197],v247,s[8:11],s28 offen offset:384
M a[60:63],a[252:255],a[192:195],a[60:63]
s_waitcnt vmcnt(19)
buffer_load_dwordx4 a[252:255],v253,s[20:23],s46 offen offset:2048
M a[64:67],v[216:219],a[196:199],a[64:67]
ds_read_b128 a[196:199],v251 offset:54528
ds_write2st64_b64 v249,v[198:199],v[200:201] offset0:68 offset1:85
M a[68:71],v[216:219],a[200:203],a[68:71]
buffer_load_dwordx2 v[198:199],v247,s[8:11],s28 offen offset:768
M a[72:75],v[216:219],a[204:207],a[72:75]
buffer_load_dwordx2 v[200:201],v247,s[8:11],s28 offen offset:1152
M a[76:79],v[216:219],a[208:211],a[76:79]
s_waitcnt vmcnt(17)
v_lshlrev_b32 v230,16,v208
v_lshlrev_b32 v228,16,v204
M a[80:83],v[216:219],a[212:215],a[80:83]
v_lshlrev_b32 v229,16,v206
v_lshlrev_b32 v233,16,v214
M a[84:87],v[216:219],a[216:219],a[84:87]
s_waitcnt vmcnt(14)
v_lshlrev_b32 v232,16,v212
v_lshlrev_b32 v231,16,v210
M a[88:91],v[216:219],a[220:223],a[88:91]
v_fmac_f32 v228,s43,v230
v_fmac_f32 v233,4.0,v229
M a[92:95],v[216:219],a[192:195],a[92:95]
buffer_load_dwordx4 v[216:219],v253,s[20:23],s47 offen offset:2048
M a[0:3],v[220:223],a[200:203],a[0:3]
v_fma_f32 v234,-4.0,v230,v232
v_fmac_f32 v228,s45,v232
M a[4:7],v[220:223],a[204:207],a[4:7]
v_fmac_f32 v233,s40,v231
v_sub_f32 v232,v232,v230
M a[8:11],v[220:223],a[208:211],a[8:11]
v_fma_f32 v230,-4.0,v229,v231
v_sub_f32 v231,v231,v229
M a[12:15],v[220:223],a[212:215],a[12:15]
v_add_f32 v229,v234,v230
v_sub_f32 v234,v234,v230
M a[16:19],v[220:223],a[216:219],a[16:19]
v_fma_f32 v230,2.0,v231,v232
v_fmac_f32 v232,-2.0,v231
M a[20:23],v[220:223],a[220:223],a[20:23]
v_and_b32 v237,s42,v208
v_and_b32 v235,s42,v204
M a[24:27],v[220:223],a[192:195],a[24:27]
s_waitcnt lgkmcnt(1)
v_and_b32 v236,s42,v206
v_and_b32 v240,s42,v214
M a[28:31],v[220:223],a[196:199],a[28:31]
buffer_load_dwordx4 v[220:223],v253,s[20:23],s48 offen offset:2048
M a[32:35],v[224:227],a[200:203],a[32:35]
v_and_b32 v239,s42,v212
v_and_b32 v238,s42,v210
M a[36:39],v[224:227],a[204:207],a[36:39]
s_add_u32 s46,s44,82944
v_fmac_f32 v235,s43,v237
v_fmac_f32 v240,4.0,v236
M a[40:43],v[224:227],a[208:211],a[40:43]
v_fma_f32 v231,-4.0,v237,v239
v_fmac_f32 v235,s45,v239
M a[44:47],v[224:227],a[212:215],a[44:47]
v_fmac_f32 v240,s40,v238
v_sub_f32 v239,v239,v237
M a[48:51],v[224:227],a[216:219],a[48:51]
v_fma_f32 v237,-4.0,v236,v238
v_sub_f32 v238,v238,v236
M a[52:55],v[224:227],a[220:223],a[52:55]
v_add_f32 v236,v231,v237
v_sub_f32 v231,v231,v237
M a[56:59],v[224:227],a[192:195],a[56:59]
v_fma_f32 v237,2.0,v238,v239
v_fmac_f32 v239,-2.0,v238
M a[60:63],v[224:227],a[196:199],a[60:63]
s_waitcnt vmcnt(15)
buffer_load_dwordx4 v[224:227],v253,s[20:23],s46 offen offset:0
M a[64:67],a[224:227],a[200:203],a[64:67]
ds_read_b128 a[200:203],v251 offset:60928
v_cvt_pk_bf16_f32 v204,v228,v235
M a[68:71],a[224:227],a[204:207],a[68:71]
s_add_u32 s47,s44,86016
ds_read_b128 a[204:207],v252 offset:61184
v_cvt_pk_bf16_f32 v214,v233,v240
M a[72:75],a[224:227],a[208:211],a[72:75]
ds_read_b128 a[208:211],v252 offset:61440
v_cvt_pk_bf16_f32 v206,v229,v236
M a[76:79],a[224:227],a[212:215],a[76:79]
ds_read_b128 a[212:215],v252 offset:61696
v_cvt_pk_bf16_f32 v208,v234,v231
M a[80:83],a[224:227],a[216:219],a[80:83]
ds_read_b128 a[216:219],v252 offset:61952
v_cvt_pk_bf16_f32 v210,v230,v237
M a[84:87],a[224:227],a[220:223],a[84:87]
ds_read_b128 a[220:223],v252 offset:62208
v_cvt_pk_bf16_f32 v212,v232,v239
M a[88:91],a[224:227],a[192:195],a[88:91]
ds_read_b128 a[192:195],v252 offset:62464
v_lshlrev_b32 v230,16,v209
M a[92:95],a[224:227],a[196:199],a[92:95]
s_waitcnt vmcnt(15) lgkmcnt(6)
buffer_load_dwordx4 a[224:227],v253,s[20:23],s47 offen offset:0
M a[96:99],a[228:231],a[200:203],a[96:99]
s_waitcnt lgkmcnt(5)
ds_read_b128 a[196:199],v252 offset:62720
v_lshlrev_b32 v228,16,v205
M a[100:103],a[228:231],a[204:207],a[100:103]
s_waitcnt lgkmcnt(5)
s_add_u32 s48,s44,89088
v_lshlrev_b32 v229,16,v207
v_lshlrev_b32 v233,16,v215
M a[104:107],a[228:231],a[208:211],a[104:107]
s_waitcnt lgkmcnt(4)
v_lshlrev_b32 v232,16,v213
v_lshlrev_b32 v231,16,v211
M a[108:111],a[228:231],a[212:215],a[108:111]
s_waitcnt lgkmcnt(3)
v_fmac_f32 v228,s43,v230
v_fmac_f32 v233,4.0,v229
M a[112:115],a[228:231],a[216:219],a[112:115]
s_waitcnt lgkmcnt(2)
v_fma_f32 v234,-4.0,v230,v232
v_fmac_f32 v228,s45,v232
M a[116:119],a[228:231],a[220:223],a[116:119]
s_waitcnt lgkmcnt(1)
v_fmac_f32 v233,s40,v231
v_sub_f32 v232,v232,v230
M a[120:123],a[228:231],a[192:195],a[120:123]
s_waitcnt lgkmcnt(0)
v_fma_f32 v230,-4.0,v229,v231
v_sub_f32 v231,v231,v229
M a[124:127],a[228:231],a[196:199],a[124:127]
s_waitcnt vmcnt(15)
buffer_load_dwordx4 a[228:231],v253,s[20:23],s48 offen offset:0
M a[128:131],a[232:235],a[200:203],a[128:131]
v_add_f32 v229,v234,v230
v_sub_f32 v234,v234,v230
M a[132:135],a[232:235],a[204:207],a[132:135]
v_fma_f32 v230,2.0,v231,v232
v_fmac_f32 v232,-2.0,v231
M a[136:139],a[232:235],a[208:211],a[136:139]
v_and_b32 v237,s42,v209
v_and_b32 v235,s42,v205
M a[140:143],a[232:235],a[212:215],a[140:143]
v_and_b32 v236,s42,v207
v_and_b32 v240,s42,v215
M a[144:147],a[232:235],a[216:219],a[144:147]
v_and_b32 v239,s42,v213
v_and_b32 v238,s42,v211
M a[148:151],a[232:235],a[220:223],a[148:151]
v_fmac_f32 v235,s43,v237
v_fmac_f32 v240,4.0,v236
M a[152:155],a[232:235],a[192:195],a[152:155]
v_fma_f32 v231,-4.0,v237,v239
v_fmac_f32 v235,s45,v239
M a[156:159],a[232:235],a[196:199],a[156:159]
s_waitcnt vmcnt(15)
buffer_load_dwordx4 a[232:235],v253,s[20:23],s46 offen offset:1024
M a[160:163],a[236:239],a[200:203],a[160:163]
ds_read_b128 a[200:203],v252 offset:62976
v_fmac_f32 v240,s40,v238
M a[164:167],a[236:239],a[204:207],a[164:167]
v_sub_f32 v239,v239,v237
v_fma_f32 v237,-4.0,v236,v238
M a[168:171],a[236:239],a[208:211],a[168:171]
v_sub_f32 v238,v238,v236
v_add_f32 v236,v231,v237
M a[172:175],a[236:239],a[212:215],a[172:175]
v_sub_f32 v231,v231,v237
v_fma_f32 v237,2.0,v238,v239
M a[176:179],a[236:239],a[216:219],a[176:179]
v_fmac_f32 v239,-2.0,v238
v_cvt_pk_bf16_f32 v205,v228,v235
M a[180:183],a[236:239],a[220:223],a[180:183]
v_cvt_pk_bf16_f32 v215,v233,v240
v_cvt_pk_bf16_f32 v207,v229,v236
M a[184:187],a[236:239],a[192:195],a[184:187]
v_cvt_pk_bf16_f32 v209,v234,v231
v_cvt_pk_bf16_f32 v211,v230,v237
M a[188:191],a[236:239],a[196:199],a[188:191]
s_waitcnt vmcnt(15)
buffer_load_dwordx4 a[236:239],v253,s[20:23],s47 offen offset:1024
M a[96:99],a[240:243],a[204:207],a[96:99]
v_cvt_pk_bf16_f32 v213,v232,v239
M a[100:103],a[240:243],a[208:211],a[100:103]
ds_write2st64_b64 v249,v[204:205],v[214:215] offset0:205 offset1:222
M a[104:107],a[240:243],a[212:215],a[104:107]
s_add_u32 s28,s30,1179776
buffer_load_dwordx2 v[204:205],v247,s[12:15],s28 offen offset:0
M a[108:111],a[240:243],a[216:219],a[108:111]
buffer_load_dwordx2 v[214:215],v247,s[16:19],s28 offen offset:1536
M a[112:115],a[240:243],a[220:223],a[112:115]
ds_write2st64_b64 v249,v[206:207],v[208:209] offset0:35 offset1:52
M a[116:119],a[240:243],a[192:195],a[116:119]
buffer_load_dwordx2 v[206:207],v247,s[8:11],s28 offen offset:0
M a[120:123],a[240:243],a[196:199],a[120:123]
s_waitcnt lgkmcnt(2)
buffer_load_dwordx2 v[208:209],v247,s[8:11],s28 offen offset:384
M a[124:127],a[240:243],a[200:203],a[124:127]
s_waitcnt vmcnt(19)
buffer_load_dwordx4 a[240:243],v253,s[20:23],s48 offen offset:1024
M a[128:131],a[244:247],a[204:207],a[128:131]
ds_write2st64_b64 v249,v[210:211],v[212:213] offset0:69 offset1:86
M a[132:135],a[244:247],a[208:211],a[132:135]
buffer_load_dwordx2 v[210:211],v247,s[8:11],s28 offen offset:768
M a[136:139],a[244:247],a[212:215],a[136:139]
buffer_load_dwordx2 v[212:213],v247,s[8:11],s28 offen offset:1152
M a[140:143],a[244:247],a[216:219],a[140:143]
v_fmac_f32 v241,s43,v243
v_fmac_f32 v246,4.0,v242
M a[144:147],a[244:247],a[220:223],a[144:147]
v_fma_f32 v228,-4.0,v243,v245
v_fmac_f32 v241,s45,v245
M a[148:151],a[244:247],a[192:195],a[148:151]
v_fmac_f32 v246,s40,v244
v_sub_f32 v245,v245,v243
M a[152:155],a[244:247],a[196:199],a[152:155]
v_fma_f32 v243,-4.0,v242,v244
v_sub_f32 v244,v244,v242
M a[156:159],a[244:247],a[200:203],a[156:159]
s_waitcnt vmcnt(21)
buffer_load_dwordx4 a[244:247],v253,s[20:23],s46 offen offset:2048
M a[160:163],a[248:251],a[204:207],a[160:163]
ds_read_b128 a[204:207],v251 offset:63232
v_add_f32 v242,v228,v243
M a[164:167],a[248:251],a[208:211],a[164:167]
v_sub_f32 v228,v228,v243
v_fma_f32 v243,2.0,v244,v245
M a[168:171],a[248:251],a[212:215],a[168:171]
v_fmac_f32 v245,-2.0,v244
v_cvt_pk_bf16_f32 v229,v241,v246
M a[172:175],a[248:251],a[216:219],a[172:175]
v_cvt_pk_bf16_f32 v230,v242,v228
v_cvt_pk_bf16_f32 v231,v243,v245
M a[176:179],a[248:251],a[220:223],a[176:179]
s_add_u32 s29,s31,192
buffer_load_short_d16_hi v241,v248,s[12:15],s29 offen offset:0
M a[180:183],a[248:251],a[192:195],a[180:183]
buffer_load_short_d16_hi v242,v248,s[8:11],s29 offen offset:0
M a[184:187],a[248:251],a[196:199],a[184:187]
buffer_load_short_d16_hi v243,v248,s[8:11],s29 offen offset:384
M a[188:191],a[248:251],a[200:203],a[188:191]
s_waitcnt vmcnt(20)
buffer_load_short_d16_hi v244,v248,s[8:11],s29 offen offset:768
M a[96:99],a[252:255],a[208:211],a[96:99]
buffer_load_short_d16_hi v245,v248,s[8:11],s29 offen offset:1152
M a[100:103],a[252:255],a[212:215],a[100:103]
buffer_load_short_d16_hi v246,v248,s[16:19],s29 offen offset:1536
M a[104:107],a[252:255],a[216:219],a[104:107]
buffer_load_dwordx4 a[248:251],v253,s[20:23],s47 offen offset:2048
M a[108:111],a[252:255],a[220:223],a[108:111]
v_add_u32 v228,104448,v250
M a[112:115],a[252:255],a[192:195],a[112:115]
ds_write_b16 v228,v229 offset:0
M a[116:119],a[252:255],a[196:199],a[116:119]
ds_write_b16_d16_hi v228,v229 offset:8704
M a[120:123],a[252:255],a[200:203],a[120:123]
s_waitcnt lgkmcnt(2)
ds_write_b16 v250,v230 offset:17408
M a[124:127],a[252:255],a[204:207],a[124:127]
s_waitcnt vmcnt(21)
buffer_load_dwordx4 a[252:255],v253,s[20:23],s48 offen offset:2048
M a[128:131],v[216:219],a[208:211],a[128:131]
ds_write_b16_d16_hi v250,v230 offset:26112
M a[132:135],v[216:219],a[212:215],a[132:135]
s_add_u32 s46,s44,92160
ds_write_b16 v250,v231 offset:34816
M a[136:139],v[216:219],a[216:219],a[136:139]
ds_write_b16_d16_hi v250,v231 offset:43520
M a[140:143],v[216:219],a[220:223],a[140:143]
v_lshlrev_b32 v230,16,v196
v_lshlrev_b32 v228,16,v192
M a[144:147],v[216:219],a[192:195],a[144:147]
v_lshlrev_b32 v229,16,v194
v_lshlrev_b32 v233,16,v202
M a[148:151],v[216:219],a[196:199],a[148:151]
v_add_u32 v251,0x4400,v251
v_add_u32 v252,0x4400,v252
M a[152:155],v[216:219],a[200:203],a[152:155]
v_lshlrev_b32 v232,16,v200
v_lshlrev_b32 v231,16,v198
M a[156:159],v[216:219],a[204:207],a[156:159]
s_waitcnt vmcnt(21)
buffer_load_dwordx4 v[216:219],v253,s[20:23],s46 offen offset:0
M a[160:163],v[220:223],a[208:211],a[160:163]
ds_read_b128 a[208:211],v251 offset:52224
v_fmac_f32 v228,s43,v230
M a[164:167],v[220:223],a[212:215],a[164:167]
s_add_u32 s47,s44,95232
ds_read_b128 a[212:215],v252 offset:52480
v_fmac_f32 v233,4.0,v229
M a[168:171],v[220:223],a[216:219],a[168:171]
ds_read_b128 a[216:219],v252 offset:52736
v_fma_f32 v234,-4.0,v230,v232
M a[172:175],v[220:223],a[220:223],a[172:175]
ds_read_b128 a[220:223],v252 offset:52992
v_fmac_f32 v228,s45,v232
M a[176:179],v[220:223],a[192:195],a[176:179]
ds_read_b128 a[192:195],v252 offset:53248
v_fmac_f32 v233,s40,v231
M a[180:183],v[220:223],a[196:199],a[180:183]
ds_read_b128 a[196:199],v252 offset:53504
v_sub_f32 v232,v232,v230
M a[184:187],v[220:223],a[200:203],a[184:187]
ds_read_b128 a[200:203],v252 offset:53760
v_fma_f32 v230,-4.0,v229,v231
M a[188:191],v[220:223],a[204:207],a[188:191]
s_waitcnt vmcnt(21) lgkmcnt(6)
buffer_load_dwordx4 v[220:223],v253,s[20:23],s47 offen offset:0
M v[0:3],v[224:227],a[208:211],v[0:3]
s_waitcnt lgkmcnt(5)
ds_read_b128 a[204:207],v252 offset:54016
v_sub_f32 v231,v231,v229
M v[4:7],v[224:227],a[212:215],v[4:7]
s_waitcnt lgkmcnt(5)
s_add_u32 s48,s44,98304
v_add_f32 v229,v234,v230
v_sub_f32 v234,v234,v230
M v[8:11],v[224:227],a[216:219],v[8:11]
s_waitcnt lgkmcnt(4)
v_fma_f32 v230,2.0,v231,v232
v_fmac_f32 v232,-2.0,v231
M v[12:15],v[224:227],a[220:223],v[12:15]
s_waitcnt lgkmcnt(3)
v_and_b32 v237,s42,v196
v_and_b32 v235,s42,v192
M v[16:19],v[224:227],a[192:195],v[16:19]
s_waitcnt lgkmcnt(2)
v_and_b32 v236,s42,v194
v_and_b32 v240,s42,v202
M v[20:23],v[224:227],a[196:199],v[20:23]
s_waitcnt lgkmcnt(1)
v_and_b32 v239,s42,v200
v_and_b32 v238,s42,v198
M v[24:27],v[224:227],a[200:203],v[24:27]
s_waitcnt lgkmcnt(0)
v_fmac_f32 v235,s43,v237
v_fmac_f32 v240,4.0,v236
M v[28:31],v[224:227],a[204:207],v[28:31]
s_waitcnt vmcnt(21)
buffer_load_dwordx4 v[224:227],v253,s[20:23],s48 offen offset:0
M v[32:35],a[224:227],a[208:211],v[32:35]
v_fma_f32 v231,-4.0,v237,v239
v_fmac_f32 v235,s45,v239
M v[36:39],a[224:227],a[212:215],v[36:39]
v_fmac_f32 v240,s40,v238
v_sub_f32 v239,v239,v237
M v[40:43],a[224:227],a[216:219],v[40:43]
v_fma_f32 v237,-4.0,v236,v238
v_sub_f32 v238,v238,v236
M v[44:47],a[224:227],a[220:223],v[44:47]
v_add_f32 v236,v231,v237
v_sub_f32 v231,v231,v237
M v[48:51],a[224:227],a[192:195],v[48:51]
v_fma_f32 v237,2.0,v238,v239
v_fmac_f32 v239,-2.0,v238
M v[52:55],a[224:227],a[196:199],v[52:55]
v_cvt_pk_bf16_f32 v192,v228,v235
v_cvt_pk_bf16_f32 v202,v233,v240
M v[56:59],a[224:227],a[200:203],v[56:59]
v_cvt_pk_bf16_f32 v194,v229,v236
v_cvt_pk_bf16_f32 v196,v234,v231
M v[60:63],a[224:227],a[204:207],v[60:63]
s_waitcnt vmcnt(21)
buffer_load_dwordx4 a[224:227],v253,s[20:23],s46 offen offset:1024
M v[64:67],a[228:231],a[208:211],v[64:67]
ds_read_b128 a[208:211],v252 offset:54272
v_cvt_pk_bf16_f32 v198,v230,v237
M v[68:71],a[228:231],a[212:215],v[68:71]
v_cvt_pk_bf16_f32 v200,v232,v239
v_lshlrev_b32 v230,16,v197
M v[72:75],a[228:231],a[216:219],v[72:75]
v_lshlrev_b32 v228,16,v193
v_lshlrev_b32 v229,16,v195
M v[76:79],a[228:231],a[220:223],v[76:79]
v_lshlrev_b32 v233,16,v203
v_lshlrev_b32 v232,16,v201
M v[80:83],a[228:231],a[192:195],v[80:83]
v_lshlrev_b32 v231,16,v199
v_fmac_f32 v228,s43,v230
M v[84:87],a[228:231],a[196:199],v[84:87]
v_fmac_f32 v233,4.0,v229
v_fma_f32 v234,-4.0,v230,v232
M v[88:91],a[228:231],a[200:203],v[88:91]
v_fmac_f32 v228,s45,v232
v_fmac_f32 v233,s40,v231
M v[92:95],a[228:231],a[204:207],v[92:95]
s_waitcnt vmcnt(21)
buffer_load_dwordx4 a[228:231],v253,s[20:23],s47 offen offset:1024
M v[0:3],a[232:235],a[212:215],v[0:3]
v_sub_f32 v232,v232,v230
v_fma_f32 v230,-4.0,v229,v231
M v[4:7],a[232:235],a[216:219],v[4:7]
v_sub_f32 v231,v231,v229
v_add_f32 v229,v234,v230
M v[8:11],a[232:235],a[220:223],v[8:11]
v_sub_f32 v234,v234,v230
v_fma_f32 v230,2.0,v231,v232
M v[12:15],a[232:235],a[192:195],v[12:15]
v_fmac_f32 v232,-2.0,v231
v_and_b32 v237,s42,v197
M v[16:19],a[232:235],a[196:199],v[16:19]
v_and_b32 v235,s42,v193
v_and_b32 v236,s42,v195
M v[20:23],a[232:235],a[200:203],v[20:23]
v_and_b32 v240,s42,v203
v_and_b32 v239,s42,v201
M v[24:27],a[232:235],a[204:207],v[24:27]
s_waitcnt lgkmcnt(0)
v_and_b32 v238,s42,v199
v_fmac_f32 v235,s43,v237
M v[28:31],a[232:235],a[208:211],v[28:31]
s_waitcnt vmcnt(21)
buffer_load_dwordx4 a[232:235],v253,s[20:23],s48 offen offset:1024
M v[32:35],a[236:239],a[212:215],v[32:35]
v_fmac_f32 v240,4.0,v236
v_fma_f32 v231,-4.0,v237,v239
M v[36:39],a[236:239],a[216:219],v[36:39]
v_fmac_f32 v235,s45,v239
v_fmac_f32 v240,s40,v238
M v[40:43],a[236:239],a[220:223],v[40:43]
v_sub_f32 v239,v239,v237
v_fma_f32 v237,-4.0,v236,v238
M v[44:47],a[236:239],a[192:195],v[44:47]
v_sub_f32 v238,v238,v236
v_add_f32 v236,v231,v237
M v[48:51],a[236:239],a[196:199],v[48:51]
v_sub_f32 v231,v231,v237
v_fma_f32 v237,2.0,v238,v239
M v[52:55],a[236:239],a[200:203],v[52:55]
v_fmac_f32 v239,-2.0,v238
v_cvt_pk_bf16_f32 v193,v228,v235
M v[56:59],a[236:239],a[204:207],v[56:59]
v_cvt_pk_bf16_f32 v203,v233,v240
v_cvt_pk_bf16_f32 v195,v229,v236
M v[60:63],a[236:239],a[208:211],v[60:63]
s_waitcnt vmcnt(17)
buffer_load_dwordx4 a[236:239],v253,s[20:23],s46 offen offset:2048
M v[64:67],a[240:243],a[212:215],v[64:67]
ds_read_b128 a[212:215],v251 offset:54528
v_cvt_pk_bf16_f32 v197,v234,v231
v_cvt_pk_bf16_f32 v199,v230,v237
M v[68:71],a[240:243],a[216:219],v[68:71]
v_cvt_pk_bf16_f32 v201,v232,v239
M v[72:75],a[240:243],a[220:223],v[72:75]
ds_write2st64_b64 v249,v[192:193],v[202:203] offset0:206 offset1:223
M v[76:79],a[240:243],a[192:195],v[76:79]
s_add_u32 s28,s30,192
buffer_load_dwordx2 v[192:193],v247,s[12:15],s28 offen offset:0
M v[80:83],a[240:243],a[196:199],v[80:83]
buffer_load_dwordx2 v[202:203],v247,s[16:19],s28 offen offset:1536
M v[84:87],a[240:243],a[200:203],v[84:87]
ds_write2st64_b64 v249,v[194:195],v[196:197] offset0:36 offset1:53
M v[88:91],a[240:243],a[204:207],v[88:91]
buffer_load_dwordx2 v[194:195],v247,s[8:11],s28 offen offset:0
M v[92:95],a[240:243],a[208:211],v[92:95]
s_waitcnt vmcnt(18)
buffer_load_dwordx2 v[196:197],v247,s[8:11],s28 offen offset:384
M v[0:3],a[244:247],a[216:219],v[0:3]
buffer_load_dwordx4 a[240:243],v253,s[20:23],s47 offen offset:2048
M v[4:7],a[244:247],a[220:223],v[4:7]
ds_write2st64_b64 v249,v[198:199],v[200:201] offset0:70 offset1:87
M v[8:11],a[244:247],a[192:195],v[8:11]
buffer_load_dwordx2 v[198:199],v247,s[8:11],s28 offen offset:768
M v[12:15],a[244:247],a[196:199],v[12:15]
buffer_load_dwordx2 v[200:201],v247,s[8:11],s28 offen offset:1152
M v[16:19],a[244:247],a[200:203],v[16:19]
v_lshlrev_b32 v230,16,v208
v_lshlrev_b32 v228,16,v204
M v[20:23],a[244:247],a[204:207],v[20:23]
v_lshlrev_b32 v229,16,v206
v_lshlrev_b32 v233,16,v214
M v[24:27],a[244:247],a[208:211],v[24:27]
s_waitcnt lgkmcnt(3)
v_lshlrev_b32 v232,16,v212
v_lshlrev_b32 v231,16,v210
M v[28:31],a[244:247],a[212:215],v[28:31]
s_waitcnt vmcnt(15)
buffer_load_dwordx4 a[244:247],v253,s[20:23],s48 offen offset:2048
M v[32:35],a[248:251],a[216:219],v[32:35]
v_fmac_f32 v228,s43,v230
v_fmac_f32 v233,4.0,v229
M v[36:39],a[248:251],a[220:223],v[36:39]
s_add_u32 s46,s44,119808
v_fma_f32 v234,-4.0,v230,v232
v_fmac_f32 v228,s45,v232
M v[40:43],a[248:251],a[192:195],v[40:43]
v_fmac_f32 v233,s40,v231
v_sub_f32 v232,v232,v230
M v[44:47],a[248:251],a[196:199],v[44:47]
v_fma_f32 v230,-4.0,v229,v231
v_sub_f32 v231,v231,v229
M v[48:51],a[248:251],a[200:203],v[48:51]
v_add_f32 v229,v234,v230
v_sub_f32 v234,v234,v230
M v[52:55],a[248:251],a[204:207],v[52:55]
v_fma_f32 v230,2.0,v231,v232
v_fmac_f32 v232,-2.0,v231
M v[56:59],a[248:251],a[208:211],v[56:59]
v_and_b32 v237,s42,v208
v_and_b32 v235,s42,v204
M v[60:63],a[248:251],a[212:215],v[60:63]
s_waitcnt vmcnt(15)
buffer_load_dwordx4 a[248:251],v253,s[20:23],s46 offen offset:0
M v[64:67],a[252:255],a[216:219],v[64:67]
ds_read_b128 a[216:219],v251 offset:60928
v_and_b32 v236,s42,v206
M v[68:71],a[252:255],a[220:223],v[68:71]
s_add_u32 s47,s44,122880
ds_read_b128 a[220:223],v252 offset:61184
v_and_b32 v240,s42,v214
M v[72:75],a[252:255],a[192:195],v[72:75]
ds_read_b128 a[192:195],v252 offset:61440
v_and_b32 v239,s42,v212
M v[76:79],a[252:255],a[196:199],v[76:79]
ds_read_b128 a[196:199],v252 offset:61696
v_and_b32 v238,s42,v210
M v[80:83],a[252:255],a[200:203],v[80:83]
ds_read_b128 a[200:203],v252 offset:61952
v_fmac_f32 v235,s43,v237
M v[84:87],a[252:255],a[204:207],v[84:87]
ds_read_b128 a[204:207],v252 offset:62208
v_fmac_f32 v240,4.0,v236
M v[88:91],a[252:255],a[208:211],v[88:91]
ds_read_b128 a[208:211],v252 offset:62464
v_fma_f32 v231,-4.0,v237,v239
M v[92:95],a[252:255],a[212:215],v[92:95]
s_waitcnt vmcnt(15) lgkmcnt(6)
buffer_load_dwordx4 a[252:255],v253,s[20:23],s47 offen offset:0
M v[96:99],v[216:219],a[216:219],v[96:99]
s_waitcnt lgkmcnt(5)
ds_read_b128 a[212:215],v252 offset:62720
v_fmac_f32 v235,s45,v239
M v[100:103],v[216:219],a[220:223],v[100:103]
s_waitcnt lgkmcnt(5)
s_add_u32 s48,s44,125952
v_fmac_f32 v240,s40,v238
v_sub_f32 v239,v239,v237
M v[104:107],v[216:219],a[192:195],v[104:107]
s_waitcnt lgkmcnt(4)
v_fma_f32 v237,-4.0,v236,v238
v_sub_f32 v238,v238,v236
M v[108:111],v[216:219],a[196:199],v[108:111]
s_waitcnt lgkmcnt(3)
v_add_f32 v236,v231,v237
v_sub_f32 v231,v231,v237
M v[112:115],v[216:219],a[200:203],v[112:115]
s_waitcnt lgkmcnt(2)
v_fma_f32 v237,2.0,v238,v239
v_fmac_f32 v239,-2.0,v238
M v[116:119],v[216:219],a[204:207],v[116:119]
s_waitcnt lgkmcnt(1)
v_cvt_pk_bf16_f32 v204,v228,v235
v_cvt_pk_bf16_f32 v214,v233,v240
M v[120:123],v[216:219],a[208:211],v[120:123]
s_waitcnt lgkmcnt(0)
v_cvt_pk_bf16_f32 v206,v229,v236
v_cvt_pk_bf16_f32 v208,v234,v231
M v[124:127],v[216:219],a[212:215],v[124:127]
s_waitcnt vmcnt(15)
buffer_load_dwordx4 v[216:219],v253,s[20:23],s48 offen offset:0
M v[128:131],v[220:223],a[216:219],v[128:131]
v_cvt_pk_bf16_f32 v210,v230,v237
v_cvt_pk_bf16_f32 v212,v232,v239
M v[132:135],v[220:223],a[220:223],v[132:135]
v_lshlrev_b32 v230,16,v209
v_lshlrev_b32 v228,16,v205
M v[136:139],v[220:223],a[192:195],v[136:139]
v_lshlrev_b32 v229,16,v207
v_lshlrev_b32 v233,16,v215
M v[140:143],v[220:223],a[196:199],v[140:143]
v_lshlrev_b32 v232,16,v213
v_lshlrev_b32 v231,16,v211
M v[144:147],v[220:223],a[200:203],v[144:147]
v_fmac_f32 v228,s43,v230
v_fmac_f32 v233,4.0,v229
M v[148:151],v[220:223],a[204:207],v[148:151]
v_fma_f32 v234,-4.0,v230,v232
v_fmac_f32 v228,s45,v232
M v[152:155],v[220:223],a[208:211],v[152:155]
v_fmac_f32 v233,s40,v231
v_sub_f32 v232,v232,v230
M v[156:159],v[220:223],a[212:215],v[156:159]
s_waitcnt vmcnt(15)
buffer_load_dwordx4 v[220:223],v253,s[20:23],s46 offen offset:1024
M v[160:163],v[224:227],a[216:219],v[160:163]
ds_read_b128 a[216:219],v252 offset:62976
v_fma_f32 v230,-4.0,v229,v231
M v[164:167],v[224:227],a[220:223],v[164:167]
v_sub_f32 v231,v231,v229
v_add_f32 v229,v234,v230
M v[168:171],v[224:227],a[192:195],v[168:171]
v_sub_f32 v234,v234,v230
v_fma_f32 v230,2.0,v231,v232
M v[172:175],v[224:227],a[196:199],v[172:175]
v_fmac_f32 v232,-2.0,v231
v_and_b32 v237,s42,v209
M v[176:179],v[224:227],a[200:203],v[176:179]
v_and_b32 v235,s42,v205
v_and_b32 v236,s42,v207
M v[180:183],v[224:227],a[204:207],v[180:183]
v_and_b32 v240,s42,v215
v_and_b32 v239,s42,v213
M v[184:187],v[224:227],a[208:211],v[184:187]
v_and_b32 v238,s42,v211
v_fmac_f32 v235,s43,v237
M v[188:191],v[224:227],a[212:215],v[188:191]
s_waitcnt vmcnt(15)
buffer_load_dwordx4 v[224:227],v253,s[20:23],s47 offen offset:1024
M v[96:99],a[224:227],a[220:223],v[96:99]
v_fmac_f32 v240,4.0,v236
v_fma_f32 v231,-4.0,v237,v239
M v[100:103],a[224:227],a[192:195],v[100:103]
v_fmac_f32 v235,s45,v239
v_fmac_f32 v240,s40,v238
M v[104:107],a[224:227],a[196:199],v[104:107]
v_sub_f32 v239,v239,v237
v_fma_f32 v237,-4.0,v236,v238
M v[108:111],a[224:227],a[200:203],v[108:111]
v_sub_f32 v238,v238,v236
v_add_f32 v236,v231,v237
M v[112:115],a[224:227],a[204:207],v[112:115]
v_sub_f32 v231,v231,v237
v_fma_f32 v237,2.0,v238,v239
M v[116:119],a[224:227],a[208:211],v[116:119]
v_fmac_f32 v239,-2.0,v238
v_cvt_pk_bf16_f32 v205,v228,v235
M v[120:123],a[224:227],a[212:215],v[120:123]
s_waitcnt lgkmcnt(0)
v_cvt_pk_bf16_f32 v215,v233,v240
v_cvt_pk_bf16_f32 v207,v229,v236
M v[124:127],a[224:227],a[216:219],v[124:127]
s_waitcnt vmcnt(15)
buffer_load_dwordx4 a[224:227],v253,s[20:23],s48 offen offset:1024
M v[128:131],a[228:231],a[220:223],v[128:131]
v_cvt_pk_bf16_f32 v209,v234,v231
v_cvt_pk_bf16_f32 v211,v230,v237
M v[132:135],a[228:231],a[192:195],v[132:135]
v_cvt_pk_bf16_f32 v213,v232,v239
M v[136:139],a[228:231],a[196:199],v[136:139]
ds_write2st64_b64 v249,v[204:205],v[214:215] offset0:207 offset1:224
M v[140:143],a[228:231],a[200:203],v[140:143]
s_add_u32 s28,s30,393408
buffer_load_dwordx2 v[204:205],v247,s[12:15],s28 offen offset:0
M v[144:147],a[228:231],a[204:207],v[144:147]
buffer_load_dwordx2 v[214:215],v247,s[16:19],s28 offen offset:1536
M v[148:151],a[228:231],a[208:211],v[148:151]
ds_write2st64_b64 v249,v[206:207],v[208:209] offset0:37 offset1:54
M v[152:155],a[228:231],a[212:215],v[152:155]
buffer_load_dwordx2 v[206:207],v247,s[8:11],s28 offen offset:0
M v[156:159],a[228:231],a[216:219],v[156:159]
s_waitcnt vmcnt(18)
buffer_load_dwordx2 v[208:209],v247,s[8:11],s28 offen offset:384
M v[160:163],a[232:235],a[220:223],v[160:163]
buffer_load_dwordx4 a[228:231],v253,s[20:23],s46 offen offset:2048
M v[164:167],a[232:235],a[192:195],v[164:167]
ds_read_b128 a[220:223],v251 offset:63232
ds_write2st64_b64 v249,v[210:211],v[212:213] offset0:71 offset1:88
M v[168:171],a[232:235],a[196:199],v[168:171]
buffer_load_dwordx2 v[210:211],v247,s[8:11],s28 offen offset:768
M v[172:175],a[232:235],a[200:203],v[172:175]
buffer_load_dwordx2 v[212:213],v247,s[8:11],s28 offen offset:1152
M v[176:179],a[232:235],a[204:207],v[176:179]
s_waitcnt vmcnt(17)
v_lshlrev_b32 v230,16,v196
v_lshlrev_b32 v228,16,v192
M v[180:183],a[232:235],a[208:211],v[180:183]
v_lshlrev_b32 v229,16,v194
v_lshlrev_b32 v233,16,v202
M v[184:187],a[232:235],a[212:215],v[184:187]
s_waitcnt vmcnt(14)
v_lshlrev_b32 v232,16,v200
v_lshlrev_b32 v231,16,v198
M v[188:191],a[232:235],a[216:219],v[188:191]
buffer_load_dwordx4 a[232:235],v253,s[20:23],s47 offen offset:2048
M v[96:99],a[236:239],a[192:195],v[96:99]
v_fmac_f32 v228,s43,v230
v_fmac_f32 v233,4.0,v229
M v[100:103],a[236:239],a[196:199],v[100:103]
v_fma_f32 v234,-4.0,v230,v232
v_fmac_f32 v228,s45,v232
M v[104:107],a[236:239],a[200:203],v[104:107]
v_fmac_f32 v233,s40,v231
v_sub_f32 v232,v232,v230
M v[108:111],a[236:239],a[204:207],v[108:111]
v_fma_f32 v230,-4.0,v229,v231
v_sub_f32 v231,v231,v229
M v[112:115],a[236:239],a[208:211],v[112:115]
v_add_f32 v229,v234,v230
v_sub_f32 v234,v234,v230
M v[116:119],a[236:239],a[212:215],v[116:119]
v_fma_f32 v230,2.0,v231,v232
v_fmac_f32 v232,-2.0,v231
M v[120:123],a[236:239],a[216:219],v[120:123]
s_waitcnt lgkmcnt(1)
v_and_b32 v237,s42,v196
v_and_b32 v235,s42,v192
M v[124:127],a[236:239],a[220:223],v[124:127]
buffer_load_dwordx4 a[236:239],v253,s[20:23],s48 offen offset:2048
M v[128:131],a[240:243],a[192:195],v[128:131]
v_and_b32 v236,s42,v194
v_and_b32 v240,s42,v202
M v[132:135],a[240:243],a[196:199],v[132:135]
s_add_u32 s46,s44,129024
v_and_b32 v239,s42,v200
v_and_b32 v238,s42,v198
M v[136:139],a[240:243],a[200:203],v[136:139]
v_fmac_f32 v235,s43,v237
v_fmac_f32 v240,4.0,v236
M v[140:143],a[240:243],a[204:207],v[140:143]
v_fma_f32 v231,-4.0,v237,v239
v_fmac_f32 v235,s45,v239
M v[144:147],a[240:243],a[208:211],v[144:147]
v_fmac_f32 v240,s40,v238
v_sub_f32 v239,v239,v237
M v[148:151],a[240:243],a[212:215],v[148:151]
v_fma_f32 v237,-4.0,v236,v238
v_sub_f32 v238,v238,v236
M v[152:155],a[240:243],a[216:219],v[152:155]
s_waitcnt lgkmcnt(0)
s_barrier
v_add_f32 v236,v231,v237
M v[156:159],a[240:243],a[220:223],v[156:159]
s_waitcnt vmcnt(15)
buffer_load_dwordx4 a[240:243],v253,s[20:23],s46 offen offset:0
M v[160:163],a[244:247],a[192:195],v[160:163]
ds_read_b128 a[192:195],v251 offset:0
v_sub_f32 v231,v231,v237
M v[164:167],a[244:247],a[196:199],v[164:167]
s_add_u32 s47,s44,132096
ds_read_b128 a[196:199],v252 offset:256
v_fma_f32 v237,2.0,v238,v239
M v[168:171],a[244:247],a[200:203],v[168:171]
ds_read_b128 a[200:203],v252 offset:512
v_fmac_f32 v239,-2.0,v238
M v[172:175],a[244:247],a[204:207],v[172:175]
ds_read_b128 a[204:207],v252 offset:768
v_cvt_pk_bf16_f32 v192,v228,v235
M v[176:179],a[244:247],a[208:211],v[176:179]
ds_read_b128 a[208:211],v252 offset:1024
v_cvt_pk_bf16_f32 v202,v233,v240
M v[180:183],a[244:247],a[212:215],v[180:183]
ds_read_b128 a[212:215],v252 offset:1280
v_cvt_pk_bf16_f32 v194,v229,v236
M v[184:187],a[244:247],a[216:219],v[184:187]
ds_read_b128 a[216:219],v252 offset:1536
v_cvt_pk_bf16_f32 v196,v234,v231
M v[188:191],a[244:247],a[220:223],v[188:191]
s_waitcnt vmcnt(15) lgkmcnt(6)
buffer_load_dwordx4 a[244:247],v253,s[20:23],s47 offen offset:0
M a[0:3],a[248:251],a[192:195],a[0:3]
s_waitcnt lgkmcnt(5)
ds_read_b128 a[220:223],v252 offset:1792
v_cvt_pk_bf16_f32 v198,v230,v237
M a[4:7],a[248:251],a[196:199],a[4:7]
s_waitcnt lgkmcnt(5)
s_add_u32 s48,s44,135168
v_cvt_pk_bf16_f32 v200,v232,v239
v_lshlrev_b32 v230,16,v197
M a[8:11],a[248:251],a[200:203],a[8:11]
s_waitcnt lgkmcnt(4)
v_lshlrev_b32 v228,16,v193
v_lshlrev_b32 v229,16,v195
M a[12:15],a[248:251],a[204:207],a[12:15]
s_waitcnt lgkmcnt(3)
v_lshlrev_b32 v233,16,v203
v_lshlrev_b32 v232,16,v201
M a[16:19],a[248:251],a[208:211],a[16:19]
s_waitcnt lgkmcnt(2)
v_lshlrev_b32 v231,16,v199
v_fmac_f32 v228,s43,v230
M a[20:23],a[248:251],a[212:215],a[20:23]
s_waitcnt lgkmcnt(1)
v_fmac_f32 v233,4.0,v229
v_fma_f32 v234,-4.0,v230,v232
M a[24:27],a[248:251],a[216:219],a[24:27]
s_waitcnt lgkmcnt(0)
v_fmac_f32 v228,s45,v232
v_fmac_f32 v233,s40,v231
M a[28:31],a[248:251],a[220:223],a[28:31]
s_waitcnt vmcnt(15)
buffer_load_dwordx4 a[248:251],v253,s[20:23],s48 offen offset:0
M a[32:35],a[252:255],a[192:195],a[32:35]
v_sub_f32 v232,v232,v230
v_fma_f32 v230,-4.0,v229,v231
M a[36:39],a[252:255],a[196:199],a[36:39]
v_sub_f32 v231,v231,v229
v_add_f32 v229,v234,v230
M a[40:43],a[252:255],a[200:203],a[40:43]
v_sub_f32 v234,v234,v230
v_fma_f32 v230,2.0,v231,v232
M a[44:47],a[252:255],a[204:207],a[44:47]
v_fmac_f32 v232,-2.0,v231
v_and_b32 v237,s42,v197
M a[48:51],a[252:255],a[208:211],a[48:51]
v_and_b32 v235,s42,v193
v_and_b32 v236,s42,v195
M a[52:55],a[252:255],a[212:215],a[52:55]
v_and_b32 v240,s42,v203
v_and_b32 v239,s42,v201
M a[56:59],a[252:255],a[216:219],a[56:59]
v_and_b32 v238,s42,v199
v_fmac_f32 v235,s43,v237
M a[60:63],a[252:255],a[220:223],a[60:63]
s_waitcnt vmcnt(15)
buffer_load_dwordx4 a[252:255],v253,s[20:23],s46 offen offset:1024
M a[64:67],v[216:219],a[192:195],a[64:67]
ds_read_b128 a[192:195],v252 offset:2048
v_fmac_f32 v240,4.0,v236
M a[68:71],v[216:219],a[196:199],a[68:71]
v_fma_f32 v231,-4.0,v237,v239
v_fmac_f32 v235,s45,v239
M a[72:75],v[216:219],a[200:203],a[72:75]
v_fmac_f32 v240,s40,v238
v_sub_f32 v239,v239,v237
M a[76:79],v[216:219],a[204:207],a[76:79]
v_fma_f32 v237,-4.0,v236,v238
v_sub_f32 v238,v238,v236
M a[80:83],v[216:219],a[208:211],a[80:83]
v_add_f32 v236,v231,v237
v_sub_f32 v231,v231,v237
M a[84:87],v[216:219],a[212:215],a[84:87]
v_fma_f32 v237,2.0,v238,v239
v_fmac_f32 v239,-2.0,v238
M a[88:91],v[216:219],a[216:219],a[88:91]
v_cvt_pk_bf16_f32 v193,v228,v235
v_cvt_pk_bf16_f32 v203,v233,v240
M a[92:95],v[216:219],a[220:223],a[92:95]
s_waitcnt vmcnt(15)
buffer_load_dwordx4 v[216:219],v253,s[20:23],s47 offen offset:1024
M a[0:3],v[220:223],a[196:199],a[0:3]
v_cvt_pk_bf16_f32 v195,v229,v236
v_cvt_pk_bf16_f32 v197,v234,v231
M a[4:7],v[220:223],a[200:203],a[4:7]
v_cvt_pk_bf16_f32 v199,v230,v237
v_cvt_pk_bf16_f32 v201,v232,v239
M a[8:11],v[220:223],a[204:207],a[8:11]
ds_write2st64_b64 v249,v[192:193],v[202:203] offset0:238 offset1:255
M a[12:15],v[220:223],a[208:211],a[12:15]
s_add_u32 s28,s30,786624
buffer_load_dwordx2 v[192:193],v247,s[12:15],s28 offen offset:0
M a[16:19],v[220:223],a[212:215],a[16:19]
buffer_load_dwordx2 v[202:203],v247,s[16:19],s28 offen offset:1536
M a[20:23],v[220:223],a[216:219],a[20:23]
ds_write2st64_b64 v249,v[194:195],v[196:197] offset0:102 offset1:119
M a[24:27],v[220:223],a[220:223],a[24:27]
s_waitcnt lgkmcnt(2)
buffer_load_dwordx2 v[194:195],v247,s[8:11],s28 offen offset:0
M a[28:31],v[220:223],a[192:195],a[28:31]
s_waitcnt vmcnt(18)
buffer_load_dwordx2 v[196:197],v247,s[8:11],s28 offen offset:384
M a[32:35],v[224:227],a[196:199],a[32:35]
buffer_load_dwordx4 v[220:223],v253,s[20:23],s48 offen offset:1024
M a[36:39],v[224:227],a[200:203],a[36:39]
ds_write2st64_b64 v249,v[198:199],v[200:201] offset0:136 offset1:153
M a[40:43],v[224:227],a[204:207],a[40:43]
buffer_load_dwordx2 v[198:199],v247,s[8:11],s28 offen offset:768
M a[44:47],v[224:227],a[208:211],a[44:47]
buffer_load_dwordx2 v[200:201],v247,s[8:11],s28 offen offset:1152
M a[48:51],v[224:227],a[212:215],a[48:51]
s_waitcnt vmcnt(17)
v_lshlrev_b32 v230,16,v208
v_lshlrev_b32 v228,16,v204
M a[52:55],v[224:227],a[216:219],a[52:55]
v_lshlrev_b32 v229,16,v206
v_lshlrev_b32 v233,16,v214
M a[56:59],v[224:227],a[220:223],a[56:59]
s_waitcnt vmcnt(14)
v_lshlrev_b32 v232,16,v212
v_lshlrev_b32 v231,16,v210
M a[60:63],v[224:227],a[192:195],a[60:63]
buffer_load_dwordx4 v[224:227],v253,s[20:23],s46 offen offset:2048
M a[64:67],a[224:227],a[196:199],a[64:67]
ds_read_b128 a[196:199],v251 offset:2304
v_fmac_f32 v228,s43,v230
M a[68:71],a[224:227],a[200:203],a[68:71]
v_fmac_f32 v233,4.0,v229
v_fma_f32 v234,-4.0,v230,v232
M a[72:75],a[224:227],a[204:207],a[72:75]
v_fmac_f32 v228,s45,v232
v_fmac_f32 v233,s40,v231
M a[76:79],a[224:227],a[208:211],a[76:79]
v_sub_f32 v232,v232,v230
v_fma_f32 v230,-4.0,v229,v231
M a[80:83],a[224:227],a[212:215],a[80:83]
v_sub_f32 v231,v231,v229
v_add_f32 v229,v234,v230
M a[84:87],a[224:227],a[216:219],a[84:87]
v_sub_f32 v234,v234,v230
v_fma_f32 v230,2.0,v231,v232
M a[88:91],a[224:227],a[220:223],a[88:91]
v_fmac_f32 v232,-2.0,v231
v_and_b32 v237,s42,v208
M a[92:95],a[224:227],a[192:195],a[92:95]
buffer_load_dwordx4 a[224:227],v253,s[20:23],s47 offen offset:2048
M a[0:3],a[228:231],a[200:203],a[0:3]
v_and_b32 v235,s42,v204
v_and_b32 v236,s42,v206
M a[4:7],a[228:231],a[204:207],a[4:7]
v_and_b32 v240,s42,v214
v_and_b32 v239,s42,v212
M a[8:11],a[228:231],a[208:211],a[8:11]
v_and_b32 v238,s42,v210
v_fmac_f32 v235,s43,v237
M a[12:15],a[228:231],a[212:215],a[12:15]
v_fmac_f32 v240,4.0,v236
v_fma_f32 v231,-4.0,v237,v239
M a[16:19],a[228:231],a[216:219],a[16:19]
v_fmac_f32 v235,s45,v239
v_fmac_f32 v240,s40,v238
M a[20:23],a[228:231],a[220:223],a[20:23]
v_sub_f32 v239,v239,v237
v_fma_f32 v237,-4.0,v236,v238
M a[24:27],a[228:231],a[192:195],a[24:27]
s_waitcnt lgkmcnt(0)
v_sub_f32 v238,v238,v236
v_add_f32 v236,v231,v237
M a[28:31],a[228:231],a[196:199],a[28:31]
s_waitcnt vmcnt(15)
buffer_load_dwordx4 a[228:231],v253,s[20:23],s48 offen offset:2048
M a[32:35],a[232:235],a[200:203],a[32:35]
v_sub_f32 v231,v231,v237
v_fma_f32 v237,2.0,v238,v239
M a[36:39],a[232:235],a[204:207],a[36:39]
s_add_u32 s46,s44,138240
v_fmac_f32 v239,-2.0,v238
v_cvt_pk_bf16_f32 v204,v228,v235
M a[40:43],a[232:235],a[208:211],a[40:43]
v_cvt_pk_bf16_f32 v214,v233,v240
v_cvt_pk_bf16_f32 v206,v229,v236
M a[44:47],a[232:235],a[212:215],a[44:47]
v_cvt_pk_bf16_f32 v208,v234,v231
v_cvt_pk_bf16_f32 v210,v230,v237
M a[48:51],a[232:235],a[216:219],a[48:51]
v_cvt_pk_bf16_f32 v212,v232,v239
v_lshlrev_b32 v230,16,v209
M a[52:55],a[232:235],a[220:223],a[52:55]
v_lshlrev_b32 v228,16,v205
v_lshlrev_b32 v229,16,v207
M a[56:59],a[232:235],a[192:195],a[56:59]
v_lshlrev_b32 v233,16,v215
v_lshlrev_b32 v232,16,v213
M a[60:63],a[232:235],a[196:199],a[60:63]
s_waitcnt vmcnt(15)
buffer_load_dwordx4 a[232:235],v253,s[20:23],s46 offen offset:0
M a[64:67],a[236:239],a[200:203],a[64:67]
ds_read_b128 a[200:203],v251 offset:8704
v_lshlrev_b32 v231,16,v211
M a[68:71],a[236:239],a[204:207],a[68:71]
s_add_u32 s47,s44,141312
ds_read_b128 a[204:207],v252 offset:8960
v_fmac_f32 v228,s43,v230
M a[72:75],a[236:239],a[208:211],a[72:75]
ds_read_b128 a[208:211],v252 offset:9216
v_fmac_f32 v233,4.0,v229
M a[76:79],a[236:239],a[212:215],a[76:79]
ds_read_b128 a[212:215],v252 offset:9472
v_fma_f32 v234,-4.0,v230,v232
M a[80:83],a[236:239],a[216:219],a[80:83]
ds_read_b128 a[216:219],v252 offset:9728
v_fmac_f32 v228,s45,v232
M a[84:87],a[236:239],a[220:223],a[84:87]
ds_read_b128 a[220:223],v252 offset:9984
v_fmac_f32 v233,s40,v231
M a[88:91],a[236:239],a[192:195],a[88:91]
ds_read_b128 a[192:195],v252 offset:10240
v_sub_f32 v232,v232,v230
M a[92:95],a[236:239],a[196:199],a[92:95]
s_waitcnt vmcnt(15) lgkmcnt(6)
buffer_load_dwordx4 a[236:239],v253,s[20:23],s47 offen offset:0
M a[96:99],a[240:243],a[200:203],a[96:99]
s_waitcnt lgkmcnt(5)
ds_read_b128 a[196:199],v252 offset:10496
v_fma_f32 v230,-4.0,v229,v231
M a[100:103],a[240:243],a[204:207],a[100:103]
s_waitcnt lgkmcnt(5)
s_add_u32 s48,s44,144384
v_sub_f32 v231,v231,v229
v_add_f32 v229,v234,v230
M a[104:107],a[240:243],a[208:211],a[104:107]
s_waitcnt lgkmcnt(4)
v_sub_f32 v234,v234,v230
v_fma_f32 v230,2.0,v231,v232
M a[108:111],a[240:243],a[212:215],a[108:111]
s_waitcnt lgkmcnt(3)
v_fmac_f32 v232,-2.0,v231
v_and_b32 v237,s42,v209
M a[112:115],a[240:243],a[216:219],a[112:115]
s_waitcnt lgkmcnt(2)
v_and_b32 v235,s42,v205
v_and_b32 v236,s42,v207
M a[116:119],a[240:243],a[220:223],a[116:119]
s_waitcnt lgkmcnt(1)
v_and_b32 v240,s42,v215
v_and_b32 v239,s42,v213
M a[120:123],a[240:243],a[192:195],a[120:123]
s_waitcnt lgkmcnt(0)
v_and_b32 v238,s42,v211
v_fmac_f32 v235,s43,v237
M a[124:127],a[240:243],a[196:199],a[124:127]
s_waitcnt vmcnt(15)
buffer_load_dwordx4 a[240:243],v253,s[20:23],s48 offen offset:0
M a[128:131],a[244:247],a[200:203],a[128:131]
v_fmac_f32 v240,4.0,v236
v_fma_f32 v231,-4.0,v237,v239
M a[132:135],a[244:247],a[204:207],a[132:135]
v_fmac_f32 v235,s45,v239
v_fmac_f32 v240,s40,v238
M a[136:139],a[244:247],a[208:211],a[136:139]
v_sub_f32 v239,v239,v237
v_fma_f32 v237,-4.0,v236,v238
M a[140:143],a[244:247],a[212:215],a[140:143]
v_sub_f32 v238,v238,v236
v_add_f32 v236,v231,v237
M a[144:147],a[244:247],a[216:219],a[144:147]
v_sub_f32 v231,v231,v237
v_fma_f32 v237,2.0,v238,v239
M a[148:151],a[244:247],a[220:223],a[148:151]
v_fmac_f32 v239,-2.0,v238
v_cvt_pk_bf16_f32 v205,v228,v235
M a[152:155],a[244:247],a[192:195],a[152:155]
v_cvt_pk_bf16_f32 v215,v233,v240
v_cvt_pk_bf16_f32 v207,v229,v236
M a[156:159],a[244:247],a[196:199],a[156:159]
s_waitcnt vmcnt(15)
buffer_load_dwordx4 a[244:247],v253,s[20:23],s46 offen offset:1024
M a[160:163],a[248:251],a[200:203],a[160:163]
ds_read_b128 a[200:203],v252 offset:10752
v_cvt_pk_bf16_f32 v209,v234,v231
M a[164:167],a[248:251],a[204:207],a[164:167]
v_cvt_pk_bf16_f32 v211,v230,v237
v_cvt_pk_bf16_f32 v213,v232,v239
M a[168:171],a[248:251],a[208:211],a[168:171]
v_add_u32 v228,121856,v249
M a[172:175],a[248:251],a[212:215],a[172:175]
ds_write2st64_b64 v228,v[204:205],v[214:215] offset0:1 offset1:18
M a[176:179],a[248:251],a[216:219],a[176:179]
s_add_u32 s28,s30,1179840
buffer_load_dwordx2 v[204:205],v247,s[12:15],s28 offen offset:0
M a[180:183],a[248:251],a[220:223],a[180:183]
buffer_load_dwordx2 v[214:215],v247,s[16:19],s28 offen offset:1536
M a[184:187],a[248:251],a[192:195],a[184:187]
ds_write2st64_b64 v249,v[206:207],v[208:209] offset0:103 offset1:120
M a[188:191],a[248:251],a[196:199],a[188:191]
s_waitcnt vmcnt(17)
buffer_load_dwordx2 v[206:207],v247,s[8:11],s28 offen offset:0
M a[96:99],a[252:255],a[204:207],a[96:99]
buffer_load_dwordx2 v[208:209],v247,s[8:11],s28 offen offset:384
M a[100:103],a[252:255],a[208:211],a[100:103]
buffer_load_dwordx4 a[248:251],v253,s[20:23],s47 offen offset:1024
M a[104:107],a[252:255],a[212:215],a[104:107]
ds_write2st64_b64 v249,v[210:211],v[212:213] offset0:137 offset1:154
M a[108:111],a[252:255],a[216:219],a[108:111]
buffer_load_dwordx2 v[210:211],v247,s[8:11],s28 offen offset:768
M a[112:115],a[252:255],a[220:223],a[112:115]
buffer_load_dwordx2 v[212:213],v247,s[8:11],s28 offen offset:1152
M a[116:119],a[252:255],a[192:195],a[116:119]
v_fmac_f32 v241,s43,v243
v_fmac_f32 v246,4.0,v242
M a[120:123],a[252:255],a[196:199],a[120:123]
s_waitcnt lgkmcnt(3)
v_fma_f32 v228,-4.0,v243,v245
v_fmac_f32 v241,s45,v245
M a[124:127],a[252:255],a[200:203],a[124:127]
s_waitcnt vmcnt(21)
buffer_load_dwordx4 a[252:255],v253,s[20:23],s48 offen offset:1024
M a[128:131],v[216:219],a[204:207],a[128:131]
v_fmac_f32 v246,s40,v244
v_sub_f32 v245,v245,v243
M a[132:135],v[216:219],a[208:211],a[132:135]
v_fma_f32 v243,-4.0,v242,v244
v_sub_f32 v244,v244,v242
M a[136:139],v[216:219],a[212:215],a[136:139]
v_add_f32 v242,v228,v243
v_sub_f32 v228,v228,v243
M a[140:143],v[216:219],a[216:219],a[140:143]
v_fma_f32 v243,2.0,v244,v245
v_fmac_f32 v245,-2.0,v244
M a[144:147],v[216:219],a[220:223],a[144:147]
v_cvt_pk_bf16_f32 v229,v241,v246
v_cvt_pk_bf16_f32 v230,v242,v228
M a[148:151],v[216:219],a[192:195],a[148:151]
v_cvt_pk_bf16_f32 v231,v243,v245
v_add_u32 v228,121856,v250
M a[152:155],v[216:219],a[196:199],a[152:155]
s_add_u32 s29,s31,256
buffer_load_short_d16_hi v241,v248,s[12:15],s29 offen offset:0
M a[156:159],v[216:219],a[200:203],a[156:159]
s_waitcnt vmcnt(18)
buffer_load_short_d16_hi v242,v248,s[8:11],s29 offen offset:0
M a[160:163],v[220:223],a[204:207],a[160:163]
buffer_load_short_d16_hi v243,v248,s[8:11],s29 offen offset:384
M a[164:167],v[220:223],a[208:211],a[164:167]
buffer_load_short_d16_hi v244,v248,s[8:11],s29 offen offset:768
M a[168:171],v[220:223],a[212:215],a[168:171]
buffer_load_short_d16_hi v245,v248,s[8:11],s29 offen offset:1152
M a[172:175],v[220:223],a[216:219],a[172:175]
buffer_load_short_d16_hi v246,v248,s[16:19],s29 offen offset:1536
M a[176:179],v[220:223],a[220:223],a[176:179]
buffer_load_dwordx4 v[216:219],v253,s[20:23],s46 offen offset:2048
M a[180:183],v[220:223],a[192:195],a[180:183]
ds_read_b128 a[204:207],v251 offset:11008
ds_write_b16 v228,v229 offset:0
M a[184:187],v[220:223],a[196:199],a[184:187]
ds_write_b16_d16_hi v228,v229 offset:8704
M a[188:191],v[220:223],a[200:203],a[188:191]
s_waitcnt vmcnt(21)
buffer_load_dwordx4 v[220:223],v253,s[20:23],s47 offen offset:2048
M a[96:99],v[224:227],a[208:211],a[96:99]
ds_write_b16 v250,v230 offset:52224
M a[100:103],v[224:227],a[212:215],a[100:103]
ds_write_b16_d16_hi v250,v230 offset:60928
M a[104:107],v[224:227],a[216:219],a[104:107]
v_add_u32 v228,69632,v250
M a[108:111],v[224:227],a[220:223],a[108:111]
ds_write_b16 v228,v231 offset:0
M a[112:115],v[224:227],a[192:195],a[112:115]
ds_write_b16_d16_hi v228,v231 offset:8704
M a[116:119],v[224:227],a[196:199],a[116:119]
v_lshlrev_b32 v230,16,v196
v_lshlrev_b32 v228,16,v192
M a[120:123],v[224:227],a[200:203],a[120:123]
s_waitcnt lgkmcnt(6)
v_lshlrev_b32 v229,16,v194
v_lshlrev_b32 v233,16,v202
M a[124:127],v[224:227],a[204:207],a[124:127]
s_waitcnt vmcnt(21)
buffer_load_dwordx4 v[224:227],v253,s[20:23],s48 offen offset:2048
M a[128:131],a[224:227],a[208:211],a[128:131]
v_lshlrev_b32 v232,16,v200
v_lshlrev_b32 v231,16,v198
M a[132:135],a[224:227],a[212:215],a[132:135]
s_add_u32 s46,s44,147456
v_fmac_f32 v228,s43,v230
v_fmac_f32 v233,4.0,v229
M a[136:139],a[224:227],a[216:219],a[136:139]
v_fma_f32 v234,-4.0,v230,v232
v_fmac_f32 v228,s45,v232
M a[140:143],a[224:227],a[220:223],a[140:143]
v_fmac_f32 v233,s40,v231
v_sub_f32 v232,v232,v230
M a[144:147],a[224:227],a[192:195],a[144:147]
v_fma_f32 v230,-4.0,v229,v231
v_sub_f32 v231,v231,v229
M a[148:151],a[224:227],a[196:199],a[148:151]
v_add_f32 v229,v234,v230
v_sub_f32 v234,v234,v230
M a[152:155],a[224:227],a[200:203],a[152:155]
v_fma_f32 v230,2.0,v231,v232
v_fmac_f32 v232,-2.0,v231
M a[156:159],a[224:227],a[204:207],a[156:159]
s_waitcnt vmcnt(21)
buffer_load_dwordx4 a[224:227],v253,s[20:23],s46 offen offset:0
M a[160:163],a[228:231],a[208:211],a[160:163]
ds_read_b128 a[208:211],v251 offset:17408
v_and_b32 v237,s42,v196
M a[164:167],a[228:231],a[212:215],a[164:167]
s_add_u32 s47,s44,150528
ds_read_b128 a[212:215],v252 offset:17664
v_and_b32 v235,s42,v192
M a[168:171],a[228:231],a[216:219],a[168:171]
ds_read_b128 a[216:219],v252 offset:17920
v_and_b32 v236,s42,v194
M a[172:175],a[228:231],a[220:223],a[172:175]
ds_read_b128 a[220:223],v252 offset:18176
v_and_b32 v240,s42,v202
M a[176:179],a[228:231],a[192:195],a[176:179]
ds_read_b128 a[192:195],v252 offset:18432
v_and_b32 v239,s42,v200
M a[180:183],a[228:231],a[196:199],a[180:183]
ds_read_b128 a[196:199],v252 offset:18688
v_and_b32 v238,s42,v198
M a[184:187],a[228:231],a[200:203],a[184:187]
ds_read_b128 a[200:203],v252 offset:18944
v_fmac_f32 v235,s43,v237
M a[188:191],a[228:231],a[204:207],a[188:191]
s_waitcnt vmcnt(21) lgkmcnt(6)
buffer_load_dwordx4 a[228:231],v253,s[20:23],s47 offen offset:0
M v[0:3],a[232:235],a[208:211],v[0:3]
s_waitcnt lgkmcnt(5)
ds_read_b128 a[204:207],v252 offset:19200
v_fmac_f32 v240,4.0,v236
M v[4:7],a[232:235],a[212:215],v[4:7]
s_waitcnt lgkmcnt(5)
s_add_u32 s48,s44,153600
v_fma_f32 v231,-4.0,v237,v239
v_fmac_f32 v235,s45,v239
M v[8:11],a[232:235],a[216:219],v[8:11]
s_waitcnt lgkmcnt(4)
v_fmac_f32 v240,s40,v238
v_sub_f32 v239,v239,v237
M v[12:15],a[232:235],a[220:223],v[12:15]
s_waitcnt lgkmcnt(3)
v_fma_f32 v237,-4.0,v236,v238
v_sub_f32 v238,v238,v236
M v[16:19],a[232:235],a[192:195],v[16:19]
s_waitcnt lgkmcnt(2)
v_add_f32 v236,v231,v237
v_sub_f32 v231,v231,v237
M v[20:23],a[232:235],a[196:199],v[20:23]
s_waitcnt lgkmcnt(1)
v_fma_f32 v237,2.0,v238,v239
v_fmac_f32 v239,-2.0,v238
M v[24:27],a[232:235],a[200:203],v[24:27]
s_waitcnt lgkmcnt(0)
v_cvt_pk_bf16_f32 v192,v228,v235
v_cvt_pk_bf16_f32 v202,v233,v240
M v[28:31],a[232:235],a[204:207],v[28:31]
s_waitcnt vmcnt(21)
buffer_load_dwordx4 a[232:235],v253,s[20:23],s48 offen offset:0
M v[32:35],a[236:239],a[208:211],v[32:35]
v_cvt_pk_bf16_f32 v194,v229,v236
v_cvt_pk_bf16_f32 v196,v234,v231
M v[36:39],a[236:239],a[212:215],v[36:39]
v_cvt_pk_bf16_f32 v198,v230,v237
v_cvt_pk_bf16_f32 v200,v232,v239
M v[40:43],a[236:239],a[216:219],v[40:43]
v_lshlrev_b32 v230,16,v197
v_lshlrev_b32 v228,16,v193
M v[44:47],a[236:239],a[220:223],v[44:47]
v_lshlrev_b32 v229,16,v195
v_lshlrev_b32 v233,16,v203
M v[48:51],a[236:239],a[192:195],v[48:51]
v_lshlrev_b32 v232,16,v201
v_lshlrev_b32 v231,16,v199
M v[52:55],a[236:239],a[196:199],v[52:55]
v_fmac_f32 v228,s43,v230
v_fmac_f32 v233,4.0,v229
M v[56:59],a[236:239],a[200:203],v[56:59]
v_fma_f32 v234,-4.0,v230,v232
v_fmac_f32 v228,s45,v232
M v[60:63],a[236:239],a[204:207],v[60:63]
s_waitcnt vmcnt(21)
buffer_load_dwordx4 a[236:239],v253,s[20:23],s46 offen offset:1024
M v[64:67],a[240:243],a[208:211],v[64:67]
ds_read_b128 a[208:211],v252 offset:19456
v_fmac_f32 v233,s40,v231
M v[68:71],a[240:243],a[212:215],v[68:71]
v_sub_f32 v232,v232,v230
v_fma_f32 v230,-4.0,v229,v231
M v[72:75],a[240:243],a[216:219],v[72:75]
v_sub_f32 v231,v231,v229
v_add_f32 v229,v234,v230
M v[76:79],a[240:243],a[220:223],v[76:79]
v_sub_f32 v234,v234,v230
v_fma_f32 v230,2.0,v231,v232
M v[80:83],a[240:243],a[192:195],v[80:83]
v_fmac_f32 v232,-2.0,v231
v_and_b32 v237,s42,v197
M v[84:87],a[240:243],a[196:199],v[84:87]
v_and_b32 v235,s42,v193
v_and_b32 v236,s42,v195
M v[88:91],a[240:243],a[200:203],v[88:91]
v_and_b32 v240,s42,v203
v_and_b32 v239,s42,v201
M v[92:95],a[240:243],a[204:207],v[92:95]
s_waitcnt vmcnt(21)
buffer_load_dwordx4 a[240:243],v253,s[20:23],s47 offen offset:1024
M v[0:3],a[244:247],a[212:215],v[0:3]
v_and_b32 v238,s42,v199
v_fmac_f32 v235,s43,v237
M v[4:7],a[244:247],a[216:219],v[4:7]
v_fmac_f32 v240,4.0,v236
v_fma_f32 v231,-4.0,v237,v239
M v[8:11],a[244:247],a[220:223],v[8:11]
v_fmac_f32 v235,s45,v239
v_fmac_f32 v240,s40,v238
M v[12:15],a[244:247],a[192:195],v[12:15]
v_sub_f32 v239,v239,v237
v_fma_f32 v237,-4.0,v236,v238
M v[16:19],a[244:247],a[196:199],v[16:19]
v_sub_f32 v238,v238,v236
v_add_f32 v236,v231,v237
M v[20:23],a[244:247],a[200:203],v[20:23]
v_sub_f32 v231,v231,v237
v_fma_f32 v237,2.0,v238,v239
M v[24:27],a[244:247],a[204:207],v[24:27]
s_waitcnt lgkmcnt(0)
v_fmac_f32 v239,-2.0,v238
v_cvt_pk_bf16_f32 v193,v228,v235
M v[28:31],a[244:247],a[208:211],v[28:31]
s_waitcnt vmcnt(17)
buffer_load_dwordx4 a[244:247],v253,s[20:23],s48 offen offset:1024
M v[32:35],a[248:251],a[212:215],v[32:35]
v_cvt_pk_bf16_f32 v203,v233,v240
v_cvt_pk_bf16_f32 v195,v229,v236
M v[36:39],a[248:251],a[216:219],v[36:39]
v_cvt_pk_bf16_f32 v197,v234,v231
v_cvt_pk_bf16_f32 v199,v230,v237
M v[40:43],a[248:251],a[220:223],v[40:43]
v_cvt_pk_bf16_f32 v201,v232,v239
v_add_u32 v228,121856,v249
M v[44:47],a[248:251],a[192:195],v[44:47]
ds_write2st64_b64 v228,v[192:193],v[202:203] offset0:2 offset1:19
M v[48:51],a[248:251],a[196:199],v[48:51]
s_add_u32 s28,s30,256
buffer_load_dwordx2 v[192:193],v247,s[12:15],s28 offen offset:0
M v[52:55],a[248:251],a[200:203],v[52:55]
buffer_load_dwordx2 v[202:203],v247,s[16:19],s28 offen offset:1536
M v[56:59],a[248:251],a[204:207],v[56:59]
ds_write2st64_b64 v249,v[194:195],v[196:197] offset0:104 offset1:121
M v[60:63],a[248:251],a[208:211],v[60:63]
s_waitcnt vmcnt(17)
buffer_load_dwordx2 v[194:195],v247,s[8:11],s28 offen offset:0
M v[64:67],a[252:255],a[212:215],v[64:67]
buffer_load_dwordx2 v[196:197],v247,s[8:11],s28 offen offset:384
M v[68:71],a[252:255],a[216:219],v[68:71]
buffer_load_dwordx4 a[248:251],v253,s[20:23],s46 offen offset:2048
M v[72:75],a[252:255],a[220:223],v[72:75]
ds_read_b128 a[212:215],v251 offset:19712
ds_write2st64_b64 v249,v[198:199],v[200:201] offset0:138 offset1:155
M v[76:79],a[252:255],a[192:195],v[76:79]
buffer_load_dwordx2 v[198:199],v247,s[8:11],s28 offen offset:768
M v[80:83],a[252:255],a[196:199],v[80:83]
buffer_load_dwordx2 v[200:201],v247,s[8:11],s28 offen offset:1152
M v[84:87],a[252:255],a[200:203],v[84:87]
v_lshlrev_b32 v230,16,v208
v_lshlrev_b32 v228,16,v204
M v[88:91],a[252:255],a[204:207],v[88:91]
v_lshlrev_b32 v229,16,v206
v_lshlrev_b32 v233,16,v214
M v[92:95],a[252:255],a[208:211],v[92:95]
s_waitcnt vmcnt(15)
buffer_load_dwordx4 a[252:255],v253,s[20:23],s47 offen offset:2048
M v[0:3],v[216:219],a[216:219],v[0:3]
v_lshlrev_b32 v232,16,v212
v_lshlrev_b32 v231,16,v210
M v[4:7],v[216:219],a[220:223],v[4:7]
v_fmac_f32 v228,s43,v230
v_fmac_f32 v233,4.0,v229
M v[8:11],v[216:219],a[192:195],v[8:11]
v_fma_f32 v234,-4.0,v230,v232
v_fmac_f32 v228,s45,v232
M v[12:15],v[216:219],a[196:199],v[12:15]
v_fmac_f32 v233,s40,v231
v_sub_f32 v232,v232,v230
M v[16:19],v[216:219],a[200:203],v[16:19]
v_fma_f32 v230,-4.0,v229,v231
v_sub_f32 v231,v231,v229
M v[20:23],v[216:219],a[204:207],v[20:23]
v_add_f32 v229,v234,v230
v_sub_f32 v234,v234,v230
M v[24:27],v[216:219],a[208:211],v[24:27]
s_waitcnt lgkmcnt(1)
v_fma_f32 v230,2.0,v231,v232
v_fmac_f32 v232,-2.0,v231
M v[28:31],v[216:219],a[212:215],v[28:31]
s_waitcnt vmcnt(15)
buffer_load_dwordx4 v[216:219],v253,s[20:23],s48 offen offset:2048
M v[32:35],v[220:223],a[216:219],v[32:35]
v_and_b32 v237,s42,v208
v_and_b32 v235,s42,v204
M v[36:39],v[220:223],a[220:223],v[36:39]
s_add_u32 s46,s44,175104
v_and_b32 v236,s42,v206
v_and_b32 v240,s42,v214
M v[40:43],v[220:223],a[192:195],v[40:43]
v_and_b32 v239,s42,v212
v_and_b32 v238,s42,v210
M v[44:47],v[220:223],a[196:199],v[44:47]
v_fmac_f32 v235,s43,v237
v_fmac_f32 v240,4.0,v236
M v[48:51],v[220:223],a[200:203],v[48:51]
v_fma_f32 v231,-4.0,v237,v239
v_fmac_f32 v235,s45,v239
M v[52:55],v[220:223],a[204:207],v[52:55]
v_fmac_f32 v240,s40,v238
v_sub_f32 v239,v239,v237
M v[56:59],v[220:223],a[208:211],v[56:59]
v_fma_f32 v237,-4.0,v236,v238
v_sub_f32 v238,v238,v236
M v[60:63],v[220:223],a[212:215],v[60:63]
s_waitcnt vmcnt(15)
buffer_load_dwordx4 v[220:223],v253,s[20:23],s46 offen offset:0
M v[64:67],v[224:227],a[216:219],v[64:67]
ds_read_b128 a[216:219],v251 offset:26112
v_add_f32 v236,v231,v237
M v[68:71],v[224:227],a[220:223],v[68:71]
s_add_u32 s47,s44,178176
ds_read_b128 a[220:223],v252 offset:26368
v_sub_f32 v231,v231,v237
M v[72:75],v[224:227],a[192:195],v[72:75]
ds_read_b128 a[192:195],v252 offset:26624
v_fma_f32 v237,2.0,v238,v239
M v[76:79],v[224:227],a[196:199],v[76:79]
ds_read_b128 a[196:199],v252 offset:26880
v_fmac_f32 v239,-2.0,v238
M v[80:83],v[224:227],a[200:203],v[80:83]
ds_read_b128 a[200:203],v252 offset:27136
v_cvt_pk_bf16_f32 v204,v228,v235
M v[84:87],v[224:227],a[204:207],v[84:87]
ds_read_b128 a[204:207],v252 offset:27392
v_cvt_pk_bf16_f32 v214,v233,v240
M v[88:91],v[224:227],a[208:211],v[88:91]
ds_read_b128 a[208:211],v252 offset:27648
v_cvt_pk_bf16_f32 v206,v229,v236
M v[92:95],v[224:227],a[212:215],v[92:95]
s_waitcnt vmcnt(15) lgkmcnt(6)
buffer_load_dwordx4 v[224:227],v253,s[20:23],s47 offen offset:0
M v[96:99],a[224:227],a[216:219],v[96:99]
s_waitcnt lgkmcnt(5)
ds_read_b128 a[212:215],v252 offset:27904
v_cvt_pk_bf16_f32 v208,v234,v231
M v[100:103],a[224:227],a[220:223],v[100:103]
s_waitcnt lgkmcnt(5)
s_add_u32 s48,s44,181248
v_cvt_pk_bf16_f32 v210,v230,v237
v_cvt_pk_bf16_f32 v212,v232,v239
M v[104:107],a[224:227],a[192:195],v[104:107]
s_waitcnt lgkmcnt(4)
v_lshlrev_b32 v230,16,v209
v_lshlrev_b32 v228,16,v205
M v[108:111],a[224:227],a[196:199],v[108:111]
s_waitcnt lgkmcnt(3)
v_lshlrev_b32 v229,16,v207
v_lshlrev_b32 v233,16,v215
M v[112:115],a[224:227],a[200:203],v[112:115]
s_waitcnt lgkmcnt(2)
v_lshlrev_b32 v232,16,v213
v_lshlrev_b32 v231,16,v211
M v[116:119],a[224:227],a[204:207],v[116:119]
s_waitcnt lgkmcnt(1)
v_fmac_f32 v228,s43,v230
v_fmac_f32 v233,4.0,v229
M v[120:123],a[224:227],a[208:211],v[120:123]
s_waitcnt lgkmcnt(0)
v_fma_f32 v234,-4.0,v230,v232
v_fmac_f32 v228,s45,v232
M v[124:127],a[224:227],a[212:215],v[124:127]
s_waitcnt vmcnt(15)
buffer_load_dwordx4 a[224:227],v253,s[20:23],s48 offen offset:0
M v[128:131],a[228:231],a[216:219],v[128:131]
v_fmac_f32 v233,s40,v231
v_sub_f32 v232,v232,v230
M v[132:135],a[228:231],a[220:223],v[132:135]
v_fma_f32 v230,-4.0,v229,v231
v_sub_f32 v231,v231,v229
M v[136:139],a[228:231],a[192:195],v[136:139]
v_add_f32 v229,v234,v230
v_sub_f32 v234,v234,v230
M v[140:143],a[228:231],a[196:199],v[140:143]
v_fma_f32 v230,2.0,v231,v232
v_fmac_f32 v232,-2.0,v231
M v[144:147],a[228:231],a[200:203],v[144:147]
v_and_b32 v237,s42,v209
v_and_b32 v235,s42,v205
M v[148:151],a[228:231],a[204:207],v[148:151]
v_and_b32 v236,s42,v207
v_and_b32 v240,s42,v215
M v[152:155],a[228:231],a[208:211],v[152:155]
v_and_b32 v239,s42,v213
v_and_b32 v238,s42,v211
M v[156:159],a[228:231],a[212:215],v[156:159]
s_waitcnt vmcnt(15)
buffer_load_dwordx4 a[228:231],v253,s[20:23],s46 offen offset:1024
M v[160:163],a[232:235],a[216:219],v[160:163]
ds_read_b128 a[216:219],v252 offset:28160
v_fmac_f32 v235,s43,v237
M v[164:167],a[232:235],a[220:223],v[164:167]
v_fmac_f32 v240,4.0,v236
v_fma_f32 v231,-4.0,v237,v239
M v[168:171],a[232:235],a[192:195],v[168:171]
v_fmac_f32 v235,s45,v239
v_fmac_f32 v240,s40,v238
M v[172:175],a[232:235],a[196:199],v[172:175]
v_sub_f32 v239,v239,v237
v_fma_f32 v237,-4.0,v236,v238
M v[176:179],a[232:235],a[200:203],v[176:179]
v_sub_f32 v238,v238,v236
v_add_f32 v236,v231,v237
M v[180:183],a[232:235],a[204:207],v[180:183]
v_sub_f32 v231,v231,v237
v_fma_f32 v237,2.0,v238,v239
M v[184:187],a[232:235],a[208:211],v[184:187]
v_fmac_f32 v239,-2.0,v238
v_cvt_pk_bf16_f32 v205,v228,v235
M v[188:191],a[232:235],a[212:215],v[188:191]
s_waitcnt vmcnt(15)
buffer_load_dwordx4 a[232:235],v253,s[20:23],s47 offen offset:1024
M v[96:99],a[236:239],a[220:223],v[96:99]
v_cvt_pk_bf16_f32 v215,v233,v240
v_cvt_pk_bf16_f32 v207,v229,v236
M v[100:103],a[236:239],a[192:195],v[100:103]
v_cvt_pk_bf16_f32 v209,v234,v231
v_cvt_pk_bf16_f32 v211,v230,v237
M v[104:107],a[236:239],a[196:199],v[104:107]
v_cvt_pk_bf16_f32 v213,v232,v239
v_add_u32 v228,121856,v249
M v[108:111],a[236:239],a[200:203],v[108:111]
ds_write2st64_b64 v228,v[204:205],v[214:215] offset0:3 offset1:20
M v[112:115],a[236:239],a[204:207],v[112:115]
s_add_u32 s28,s30,393472
buffer_load_dwordx2 v[204:205],v247,s[12:15],s28 offen offset:0
M v[116:119],a[236:239],a[208:211],v[116:119]
buffer_load_dwordx2 v[214:215],v247,s[16:19],s28 offen offset:1536
M v[120:123],a[236:239],a[212:215],v[120:123]
s_waitcnt lgkmcnt(1)
ds_write2st64_b64 v249,v[206:207],v[208:209] offset0:105 offset1:122
M v[124:127],a[236:239],a[216:219],v[124:127]
s_waitcnt vmcnt(17)
buffer_load_dwordx2 v[206:207],v247,s[8:11],s28 offen offset:0
M v[128:131],a[240:243],a[220:223],v[128:131]
buffer_load_dwordx2 v[208:209],v247,s[8:11],s28 offen offset:384
M v[132:135],a[240:243],a[192:195],v[132:135]
buffer_load_dwordx4 a[236:239],v253,s[20:23],s48 offen offset:1024
M v[136:139],a[240:243],a[196:199],v[136:139]
ds_write2st64_b64 v249,v[210:211],v[212:213] offset0:139 offset1:156
M v[140:143],a[240:243],a[200:203],v[140:143]
buffer_load_dwordx2 v[210:211],v247,s[8:11],s28 offen offset:768
M v[144:147],a[240:243],a[204:207],v[144:147]
buffer_load_dwordx2 v[212:213],v247,s[8:11],s28 offen offset:1152
M v[148:151],a[240:243],a[208:211],v[148:151]
s_waitcnt vmcnt(17)
v_lshlrev_b32 v230,16,v196
v_lshlrev_b32 v228,16,v192
M v[152:155],a[240:243],a[212:215],v[152:155]
v_lshlrev_b32 v229,16,v194
v_lshlrev_b32 v233,16,v202
M v[156:159],a[240:243],a[216:219],v[156:159]
buffer_load_dwordx4 a[240:243],v253,s[20:23],s46 offen offset:2048
M v[160:163],a[244:247],a[220:223],v[160:163]
s_waitcnt vmcnt(15)
ds_read_b128 a[220:223],v251 offset:28416
v_lshlrev_b32 v232,16,v200
M v[164:167],a[244:247],a[192:195],v[164:167]
v_lshlrev_b32 v231,16,v198
v_fmac_f32 v228,s43,v230
M v[168:171],a[244:247],a[196:199],v[168:171]
v_fmac_f32 v233,4.0,v229
v_fma_f32 v234,-4.0,v230,v232
M v[172:175],a[244:247],a[200:203],v[172:175]
v_fmac_f32 v228,s45,v232
v_fmac_f32 v233,s40,v231
M v[176:179],a[244:247],a[204:207],v[176:179]
v_sub_f32 v232,v232,v230
v_fma_f32 v230,-4.0,v229,v231
M v[180:183],a[244:247],a[208:211],v[180:183]
v_sub_f32 v231,v231,v229
v_add_f32 v229,v234,v230
M v[184:187],a[244:247],a[212:215],v[184:187]
v_sub_f32 v234,v234,v230
v_fma_f32 v230,2.0,v231,v232
M v[188:191],a[244:247],a[216:219],v[188:191]
buffer_load_dwordx4 a[244:247],v253,s[20:23],s47 offen offset:2048
M v[96:99],a[248:251],a[192:195],v[96:99]
v_fmac_f32 v232,-2.0,v231
v_and_b32 v237,s42,v196
M v[100:103],a[248:251],a[196:199],v[100:103]
v_and_b32 v235,s42,v192
v_and_b32 v236,s42,v194
M v[104:107],a[248:251],a[200:203],v[104:107]
v_and_b32 v240,s42,v202
v_and_b32 v239,s42,v200
M v[108:111],a[248:251],a[204:207],v[108:111]
v_and_b32 v238,s42,v198
v_fmac_f32 v235,s43,v237
M v[112:115],a[248:251],a[208:211],v[112:115]
v_fmac_f32 v240,4.0,v236
v_fma_f32 v231,-4.0,v237,v239
M v[116:119],a[248:251],a[212:215],v[116:119]
v_fmac_f32 v235,s45,v239
v_fmac_f32 v240,s40,v238
M v[120:123],a[248:251],a[216:219],v[120:123]
s_waitcnt lgkmcnt(0)
v_sub_f32 v239,v239,v237
v_fma_f32 v237,-4.0,v236,v238
M v[124:127],a[248:251],a[220:223],v[124:127]
s_waitcnt vmcnt(15)
buffer_load_dwordx4 a[248:251],v253,s[20:23],s48 offen offset:2048
M v[128:131],a[252:255],a[192:195],v[128:131]
v_sub_f32 v238,v238,v236
v_add_f32 v236,v231,v237
M v[132:135],a[252:255],a[196:199],v[132:135]
s_add_u32 s46,s44,184320
v_sub_f32 v231,v231,v237
v_fma_f32 v237,2.0,v238,v239
M v[136:139],a[252:255],a[200:203],v[136:139]
v_fmac_f32 v239,-2.0,v238
v_cvt_pk_bf16_f32 v192,v228,v235
M v[140:143],a[252:255],a[204:207],v[140:143]
v_cvt_pk_bf16_f32 v202,v233,v240
v_cvt_pk_bf16_f32 v194,v229,v236
M v[144:147],a[252:255],a[208:211],v[144:147]
v_cvt_pk_bf16_f32 v196,v234,v231
v_cvt_pk_bf16_f32 v198,v230,v237
M v[148:151],a[252:255],a[212:215],v[148:151]
v_cvt_pk_bf16_f32 v200,v232,v239
v_lshlrev_b32 v230,16,v197
M v[152:155],a[252:255],a[216:219],v[152:155]
s_barrier
v_lshlrev_b32 v228,16,v193
M v[156:159],a[252:255],a[220:223],v[156:159]
s_waitcnt vmcnt(15)
buffer_load_dwordx4 a[252:255],v253,s[20:23],s46 offen offset:0
M v[160:163],v[216:219],a[192:195],v[160:163]
ds_read_b128 a[192:195],v251 offset:34816
v_lshlrev_b32 v229,16,v195
M v[164:167],v[216:219],a[196:199],v[164:167]
s_add_u32 s47,s44,187392
ds_read_b128 a[196:199],v252 offset:35072
v_lshlrev_b32 v233,16,v203
M v[168:171],v[216:219],a[200:203],v[168:171]
ds_read_b128 a[200:203],v252 offset:35328
v_lshlrev_b32 v232,16,v201
M v[172:175],v[216:219],a[204:207],v[172:175]
ds_read_b128 a[204:207],v252 offset:35584
v_lshlrev_b32 v231,16,v199
M v[176:179],v[216:219],a[208:211],v[176:179]
ds_read_b128 a[208:211],v252 offset:35840
v_fmac_f32 v228,s43,v230
M v[180:183],v[216:219],a[212:215],v[180:183]
ds_read_b128 a[212:215],v252 offset:36096
v_fmac_f32 v233,4.0,v229
M v[184:187],v[216:219],a[216:219],v[184:187]
ds_read_b128 a[216:219],v252 offset:36352
v_fma_f32 v234,-4.0,v230,v232
M v[188:191],v[216:219],a[220:223],v[188:191]
s_waitcnt vmcnt(15) lgkmcnt(6)
buffer_load_dwordx4 v[216:219],v253,s[20:23],s47 offen offset:0
M a[0:3],v[220:223],a[192:195],a[0:3]
s_waitcnt lgkmcnt(5)
ds_read_b128 a[220:223],v252 offset:36608
v_fmac_f32 v228,s45,v232
M a[4:7],v[220:223],a[196:199],a[4:7]
s_waitcnt lgkmcnt(5)
s_add_u32 s48,s44,190464
v_fmac_f32 v233,s40,v231
v_sub_f32 v232,v232,v230
M a[8:11],v[220:223],a[200:203],a[8:11]
s_waitcnt lgkmcnt(4)
v_fma_f32 v230,-4.0,v229,v231
v_sub_f32 v231,v231,v229
M a[12:15],v[220:223],a[204:207],a[12:15]
s_waitcnt lgkmcnt(3)
v_add_f32 v229,v234,v230
v_sub_f32 v234,v234,v230
M a[16:19],v[220:223],a[208:211],a[16:19]
s_waitcnt lgkmcnt(2)
v_fma_f32 v230,2.0,v231,v232
v_fmac_f32 v232,-2.0,v231
M a[20:23],v[220:223],a[212:215],a[20:23]
s_waitcnt lgkmcnt(1)
v_and_b32 v237,s42,v197
v_and_b32 v235,s42,v193
M a[24:27],v[220:223],a[216:219],a[24:27]
s_waitcnt lgkmcnt(0)
v_and_b32 v236,s42,v195
v_and_b32 v240,s42,v203
M a[28:31],v[220:223],a[220:223],a[28:31]
s_waitcnt vmcnt(15)
buffer_load_dwordx4 v[220:223],v253,s[20:23],s48 offen offset:0
M a[32:35],v[224:227],a[192:195],a[32:35]
v_and_b32 v239,s42,v201
v_and_b32 v238,s42,v199
M a[36:39],v[224:227],a[196:199],a[36:39]
v_fmac_f32 v235,s43,v237
v_fmac_f32 v240,4.0,v236
M a[40:43],v[224:227],a[200:203],a[40:43]
v_fma_f32 v231,-4.0,v237,v239
v_fmac_f32 v235,s45,v239
M a[44:47],v[224:227],a[204:207],a[44:47]
v_fmac_f32 v240,s40,v238
v_sub_f32 v239,v239,v237
M a[48:51],v[224:227],a[208:211],a[48:51]
v_fma_f32 v237,-4.0,v236,v238
v_sub_f32 v238,v238,v236
M a[52:55],v[224:227],a[212:215],a[52:55]
v_add_f32 v236,v231,v237
v_sub_f32 v231,v231,v237
M a[56:59],v[224:227],a[216:219],a[56:59]
v_fma_f32 v237,2.0,v238,v239
v_fmac_f32 v239,-2.0,v238
M a[60:63],v[224:227],a[220:223],a[60:63]
s_waitcnt vmcnt(15)
buffer_load_dwordx4 v[224:227],v253,s[20:23],s46 offen offset:1024
M a[64:67],a[224:227],a[192:195],a[64:67]
ds_read_b128 a[192:195],v252 offset:36864
v_cvt_pk_bf16_f32 v193,v228,v235
M a[68:71],a[224:227],a[196:199],a[68:71]
v_cvt_pk_bf16_f32 v203,v233,v240
v_cvt_pk_bf16_f32 v195,v229,v236
M a[72:75],a[224:227],a[200:203],a[72:75]
v_cvt_pk_bf16_f32 v197,v234,v231
v_cvt_pk_bf16_f32 v199,v230,v237
M a[76:79],a[224:227],a[204:207],a[76:79]
v_cvt_pk_bf16_f32 v201,v232,v239
v_add_u32 v228,139264,v249
M a[80:83],a[224:227],a[208:211],a[80:83]
ds_write2st64_b64 v228,v[192:193],v[202:203] offset0:0 offset1:17
M a[84:87],a[224:227],a[212:215],a[84:87]
s_add_u32 s28,s30,786688
buffer_load_dwordx2 v[192:193],v247,s[12:15],s28 offen offset:0
M a[88:91],a[224:227],a[216:219],a[88:91]
buffer_load_dwordx2 v[202:203],v247,s[16:19],s28 offen offset:1536
M a[92:95],a[224:227],a[220:223],a[92:95]
s_waitcnt vmcnt(17)
buffer_load_dwordx4 a[224:227],v253,s[20:23],s47 offen offset:1024
M a[0:3],a[228:231],a[196:199],a[0:3]
ds_write2st64_b64 v249,v[194:195],v[196:197] offset0:34 offset1:51
M a[4:7],a[228:231],a[200:203],a[4:7]
buffer_load_dwordx2 v[194:195],v247,s[8:11],s28 offen offset:0
M a[8:11],a[228:231],a[204:207],a[8:11]
buffer_load_dwordx2 v[196:197],v247,s[8:11],s28 offen offset:384
M a[12:15],a[228:231],a[208:211],a[12:15]
ds_write2st64_b64 v249,v[198:199],v[200:201] offset0:68 offset1:85
M a[16:19],a[228:231],a[212:215],a[16:19]
buffer_load_dwordx2 v[198:199],v247,s[8:11],s28 offen offset:768
M a[20:23],a[228:231],a[216:219],a[20:23]
buffer_load_dwordx2 v[200:201],v247,s[8:11],s28 offen offset:1152
M a[24:27],a[228:231],a[220:223],a[24:27]
s_waitcnt vmcnt(17) lgkmcnt(3)
v_lshlrev_b32 v230,16,v208
v_lshlrev_b32 v228,16,v204
M a[28:31],a[228:231],a[192:195],a[28:31]
buffer_load_dwordx4 a[228:231],v253,s[20:23],s48 offen offset:1024
M a[32:35],a[232:235],a[196:199],a[32:35]
v_lshlrev_b32 v229,16,v206
v_lshlrev_b32 v233,16,v214
M a[36:39],a[232:235],a[200:203],a[36:39]
s_waitcnt vmcnt(15)
v_lshlrev_b32 v232,16,v212
v_lshlrev_b32 v231,16,v210
M a[40:43],a[232:235],a[204:207],a[40:43]
v_fmac_f32 v228,s43,v230
v_fmac_f32 v233,4.0,v229
M a[44:47],a[232:235],a[208:211],a[44:47]
v_fma_f32 v234,-4.0,v230,v232
v_fmac_f32 v228,s45,v232
M a[48:51],a[232:235],a[212:215],a[48:51]
v_fmac_f32 v233,s40,v231
v_sub_f32 v232,v232,v230
M a[52:55],a[232:235],a[216:219],a[52:55]
v_fma_f32 v230,-4.0,v229,v231
v_sub_f32 v231,v231,v229
M a[56:59],a[232:235],a[220:223],a[56:59]
v_add_f32 v229,v234,v230
v_sub_f32 v234,v234,v230
M a[60:63],a[232:235],a[192:195],a[60:63]
buffer_load_dwordx4 a[232:235],v253,s[20:23],s46 offen offset:2048
M a[64:67],a[236:239],a[196:199],a[64:67]
ds_read_b128 a[196:199],v251 offset:37120
v_fma_f32 v230,2.0,v231,v232
M a[68:71],a[236:239],a[200:203],a[68:71]
v_fmac_f32 v232,-2.0,v231
v_and_b32 v237,s42,v208
M a[72:75],a[236:239],a[204:207],a[72:75]
v_and_b32 v235,s42,v204
v_and_b32 v236,s42,v206
M a[76:79],a[236:239],a[208:211],a[76:79]
v_and_b32 v240,s42,v214
v_and_b32 v239,s42,v212
M a[80:83],a[236:239],a[212:215],a[80:83]
v_and_b32 v238,s42,v210
v_fmac_f32 v235,s43,v237
M a[84:87],a[236:239],a[216:219],a[84:87]
v_fmac_f32 v240,4.0,v236
v_fma_f32 v231,-4.0,v237,v239
M a[88:91],a[236:239],a[220:223],a[88:91]
v_fmac_f32 v235,s45,v239
v_fmac_f32 v240,s40,v238
M a[92:95],a[236:239],a[192:195],a[92:95]
s_waitcnt vmcnt(15)
buffer_load_dwordx4 a[236:239],v253,s[20:23],s47 offen offset:2048
M a[0:3],a[240:243],a[200:203],a[0:3]
v_sub_f32 v239,v239,v237
v_fma_f32 v237,-4.0,v236,v238
M a[4:7],a[240:243],a[204:207],a[4:7]
v_sub_f32 v238,v238,v236
v_add_f32 v236,v231,v237
M a[8:11],a[240:243],a[208:211],a[8:11]
v_sub_f32 v231,v231,v237
v_fma_f32 v237,2.0,v238,v239
M a[12:15],a[240:243],a[212:215],a[12:15]
v_fmac_f32 v239,-2.0,v238
v_cvt_pk_bf16_f32 v204,v228,v235
M a[16:19],a[240:243],a[216:219],a[16:19]
v_cvt_pk_bf16_f32 v214,v233,v240
v_cvt_pk_bf16_f32 v206,v229,v236
M a[20:23],a[240:243],a[220:223],a[20:23]
v_cvt_pk_bf16_f32 v208,v234,v231
v_cvt_pk_bf16_f32 v210,v230,v237
M a[24:27],a[240:243],a[192:195],a[24:27]
s_waitcnt lgkmcnt(0)
v_cvt_pk_bf16_f32 v212,v232,v239
v_lshlrev_b32 v230,16,v209
M a[28:31],a[240:243],a[196:199],a[28:31]
s_waitcnt vmcnt(15)
buffer_load_dwordx4 a[240:243],v253,s[20:23],s48 offen offset:2048
M a[32:35],a[244:247],a[200:203],a[32:35]
v_lshlrev_b32 v228,16,v205
v_lshlrev_b32 v229,16,v207
M a[36:39],a[244:247],a[204:207],a[36:39]
s_add_u32 s46,s44,193536
v_lshlrev_b32 v233,16,v215
v_lshlrev_b32 v232,16,v213
M a[40:43],a[244:247],a[208:211],a[40:43]
v_lshlrev_b32 v231,16,v211
v_fmac_f32 v228,s43,v230
M a[44:47],a[244:247],a[212:215],a[44:47]
v_fmac_f32 v233,4.0,v229
v_fma_f32 v234,-4.0,v230,v232
M a[48:51],a[244:247],a[216:219],a[48:51]
v_fmac_f32 v228,s45,v232
v_fmac_f32 v233,s40,v231
M a[52:55],a[244:247],a[220:223],a[52:55]
v_sub_f32 v232,v232,v230
v_fma_f32 v230,-4.0,v229,v231
M a[56:59],a[244:247],a[192:195],a[56:59]
v_sub_f32 v231,v231,v229
v_add_f32 v229,v234,v230
M a[60:63],a[244:247],a[196:199],a[60:63]
s_waitcnt vmcnt(15)
buffer_load_dwordx4 a[244:247],v253,s[20:23],s46 offen offset:0
M a[64:67],a[248:251],a[200:203],a[64:67]
ds_read_b128 a[200:203],v251 offset:43520
v_sub_f32 v234,v234,v230
M a[68:71],a[248:251],a[204:207],a[68:71]
s_add_u32 s47,s44,196608
ds_read_b128 a[204:207],v252 offset:43776
v_fma_f32 v230,2.0,v231,v232
M a[72:75],a[248:251],a[208:211],a[72:75]
ds_read_b128 a[208:211],v252 offset:44032
v_fmac_f32 v232,-2.0,v231
M a[76:79],a[248:251],a[212:215],a[76:79]
ds_read_b128 a[212:215],v252 offset:44288
v_and_b32 v237,s42,v209
M a[80:83],a[248:251],a[216:219],a[80:83]
ds_read_b128 a[216:219],v252 offset:44544
v_and_b32 v235,s42,v205
M a[84:87],a[248:251],a[220:223],a[84:87]
ds_read_b128 a[220:223],v252 offset:44800
v_and_b32 v236,s42,v207
M a[88:91],a[248:251],a[192:195],a[88:91]
ds_read_b128 a[192:195],v252 offset:45056
v_and_b32 v240,s42,v215
M a[92:95],a[248:251],a[196:199],a[92:95]
s_waitcnt vmcnt(15) lgkmcnt(6)
buffer_load_dwordx4 a[248:251],v253,s[20:23],s47 offen offset:0
M a[96:99],a[252:255],a[200:203],a[96:99]
s_waitcnt lgkmcnt(5)
ds_read_b128 a[196:199],v252 offset:45312
v_and_b32 v239,s42,v213
M a[100:103],a[252:255],a[204:207],a[100:103]
s_waitcnt lgkmcnt(5)
s_add_u32 s48,s44,199680
v_and_b32 v238,s42,v211
v_fmac_f32 v235,s43,v237
M a[104:107],a[252:255],a[208:211],a[104:107]
s_waitcnt lgkmcnt(4)
v_fmac_f32 v240,4.0,v236
v_fma_f32 v231,-4.0,v237,v239
M a[108:111],a[252:255],a[212:215],a[108:111]
s_waitcnt lgkmcnt(3)
v_fmac_f32 v235,s45,v239
v_fmac_f32 v240,s40,v238
M a[112:115],a[252:255],a[216:219],a[112:115]
s_waitcnt lgkmcnt(2)
v_sub_f32 v239,v239,v237
v_fma_f32 v237,-4.0,v236,v238
M a[116:119],a[252:255],a[220:223],a[116:119]
s_waitcnt lgkmcnt(1)
v_sub_f32 v238,v238,v236
v_add_f32 v236,v231,v237
M a[120:123],a[252:255],a[192:195],a[120:123]
s_waitcnt lgkmcnt(0)
v_sub_f32 v231,v231,v237
v_fma_f32 v237,2.0,v238,v239
M a[124:127],a[252:255],a[196:199],a[124:127]
s_waitcnt vmcnt(15)
buffer_load_dwordx4 a[252:255],v253,s[20:23],s48 offen offset:0
M a[128:131],v[216:219],a[200:203],a[128:131]
v_fmac_f32 v239,-2.0,v238
v_cvt_pk_bf16_f32 v205,v228,v235
M a[132:135],v[216:219],a[204:207],a[132:135]
v_cvt_pk_bf16_f32 v215,v233,v240
v_cvt_pk_bf16_f32 v207,v229,v236
M a[136:139],v[216:219],a[208:211],a[136:139]
v_cvt_pk_bf16_f32 v209,v234,v231
v_cvt_pk_bf16_f32 v211,v230,v237
M a[140:143],v[216:219],a[212:215],a[140:143]
v_cvt_pk_bf16_f32 v213,v232,v239
v_add_u32 v228,139264,v249
M a[144:147],v[216:219],a[216:219],a[144:147]
ds_write2st64_b64 v228,v[204:205],v[214:215] offset0:1 offset1:18
M a[148:151],v[216:219],a[220:223],a[148:151]
s_add_u32 s28,s30,1179904
buffer_load_dwordx2 v[204:205],v247,s[12:15],s28 offen offset:0
M a[152:155],v[216:219],a[192:195],a[152:155]
buffer_load_dwordx2 v[214:215],v247,s[16:19],s28 offen offset:1536
M a[156:159],v[216:219],a[196:199],a[156:159]
s_waitcnt vmcnt(17)
buffer_load_dwordx4 v[216:219],v253,s[20:23],s46 offen offset:1024
M a[160:163],v[220:223],a[200:203],a[160:163]
ds_read_b128 a[200:203],v252 offset:45568
ds_write2st64_b64 v249,v[206:207],v[208:209] offset0:35 offset1:52
M a[164:167],v[220:223],a[204:207],a[164:167]
buffer_load_dwordx2 v[206:207],v247,s[8:11],s28 offen offset:0
M a[168:171],v[220:223],a[208:211],a[168:171]
buffer_load_dwordx2 v[208:209],v247,s[8:11],s28 offen offset:384
M a[172:175],v[220:223],a[212:215],a[172:175]
ds_write2st64_b64 v249,v[210:211],v[212:213] offset0:69 offset1:86
M a[176:179],v[220:223],a[216:219],a[176:179]
buffer_load_dwordx2 v[210:211],v247,s[8:11],s28 offen offset:768
M a[180:183],v[220:223],a[220:223],a[180:183]
buffer_load_dwordx2 v[212:213],v247,s[8:11],s28 offen offset:1152
M a[184:187],v[220:223],a[192:195],a[184:187]
v_fmac_f32 v241,s43,v243
v_fmac_f32 v246,4.0,v242
M a[188:191],v[220:223],a[196:199],a[188:191]
s_waitcnt vmcnt(21)
buffer_load_dwordx4 v[220:223],v253,s[20:23],s47 offen offset:1024
M a[96:99],v[224:227],a[204:207],a[96:99]
v_fma_f32 v228,-4.0,v243,v245
v_fmac_f32 v241,s45,v245
M a[100:103],v[224:227],a[208:211],a[100:103]
v_fmac_f32 v246,s40,v244
v_sub_f32 v245,v245,v243
M a[104:107],v[224:227],a[212:215],a[104:107]
v_fma_f32 v243,-4.0,v242,v244
v_sub_f32 v244,v244,v242
M a[108:111],v[224:227],a[216:219],a[108:111]
v_add_f32 v242,v228,v243
v_sub_f32 v228,v228,v243
M a[112:115],v[224:227],a[220:223],a[112:115]
v_fma_f32 v243,2.0,v244,v245
v_fmac_f32 v245,-2.0,v244
M a[116:119],v[224:227],a[192:195],a[116:119]
v_cvt_pk_bf16_f32 v229,v241,v246
v_cvt_pk_bf16_f32 v230,v242,v228
M a[120:123],v[224:227],a[196:199],a[120:123]
s_waitcnt lgkmcnt(2)
v_cvt_pk_bf16_f32 v231,v243,v245
v_add_u32 v228,139264,v250
M a[124:127],v[224:227],a[200:203],a[124:127]
s_waitcnt vmcnt(19)
s_add_u32 s29,s31,320
buffer_load_short_d16_hi v241,v248,s[12:15],s29 offen offset:0
M a[128:131],a[224:227],a[204:207],a[128:131]
buffer_load_short_d16_hi v242,v248,s[8:11],s29 offen offset:0
M a[132:135],a[224:227],a[208:211],a[132:135]
buffer_load_short_d16_hi v243,v248,s[8:11],s29 offen offset:384
M a[136:139],a[224:227],a[212:215],a[136:139]
buffer_load_short_d16_hi v244,v248,s[8:11],s29 offen offset:768
M a[140:143],a[224:227],a[216:219],a[140:143]
buffer_load_short_d16_hi v245,v248,s[8:11],s29 offen offset:1152
M a[144:147],a[224:227],a[220:223],a[144:147]
buffer_load_short_d16_hi v246,v248,s[16:19],s29 offen offset:1536
M a[148:151],a[224:227],a[192:195],a[148:151]
buffer_load_dwordx4 v[224:227],v253,s[20:23],s48 offen offset:1024
M a[152:155],a[224:227],a[196:199],a[152:155]
ds_write_b16 v228,v229 offset:0
M a[156:159],a[224:227],a[200:203],a[156:159]
s_waitcnt vmcnt(21)
buffer_load_dwordx4 a[224:227],v253,s[20:23],s46 offen offset:2048
M a[160:163],a[228:231],a[204:207],a[160:163]
ds_read_b128 a[204:207],v251 offset:45824
ds_write_b16_d16_hi v228,v229 offset:8704
M a[164:167],a[228:231],a[208:211],a[164:167]
ds_write_b16 v250,v230 offset:17408
M a[168:171],a[228:231],a[212:215],a[168:171]
ds_write_b16_d16_hi v250,v230 offset:26112
M a[172:175],a[228:231],a[216:219],a[172:175]
ds_write_b16 v250,v231 offset:34816
M a[176:179],a[228:231],a[220:223],a[176:179]
ds_write_b16_d16_hi v250,v231 offset:43520
M a[180:183],a[228:231],a[192:195],a[180:183]
v_lshlrev_b32 v230,16,v196
v_lshlrev_b32 v228,16,v192
M a[184:187],a[228:231],a[196:199],a[184:187]
v_lshlrev_b32 v229,16,v194
v_lshlrev_b32 v233,16,v202
M a[188:191],a[228:231],a[200:203],a[188:191]
s_waitcnt vmcnt(21)
buffer_load_dwordx4 a[228:231],v253,s[20:23],s47 offen offset:2048
M a[96:99],a[232:235],a[208:211],a[96:99]
v_lshlrev_b32 v232,16,v200
v_lshlrev_b32 v231,16,v198
M a[100:103],a[232:235],a[212:215],a[100:103]
v_fmac_f32 v228,s43,v230
v_fmac_f32 v233,4.0,v229
M a[104:107],a[232:235],a[216:219],a[104:107]
v_fma_f32 v234,-4.0,v230,v232
v_fmac_f32 v228,s45,v232
M a[108:111],a[232:235],a[220:223],a[108:111]
v_fmac_f32 v233,s40,v231
v_sub_f32 v232,v232,v230
M a[112:115],a[232:235],a[192:195],a[112:115]
v_fma_f32 v230,-4.0,v229,v231
v_sub_f32 v231,v231,v229
M a[116:119],a[232:235],a[196:199],a[116:119]
v_add_f32 v229,v234,v230
v_sub_f32 v234,v234,v230
M a[120:123],a[232:235],a[200:203],a[120:123]
s_waitcnt lgkmcnt(5)
v_fma_f32 v230,2.0,v231,v232
v_fmac_f32 v232,-2.0,v231
M a[124:127],a[232:235],a[204:207],a[124:127]
s_waitcnt vmcnt(21)
buffer_load_dwordx4 a[232:235],v253,s[20:23],s48 offen offset:2048
M a[128:131],a[236:239],a[208:211],a[128:131]
v_and_b32 v237,s42,v196
v_and_b32 v235,s42,v192
M a[132:135],a[236:239],a[212:215],a[132:135]
s_add_u32 s46,s44,202752
v_and_b32 v236,s42,v194
v_and_b32 v240,s42,v202
M a[136:139],a[236:239],a[216:219],a[136:139]
v_and_b32 v239,s42,v200
v_and_b32 v238,s42,v198
M a[140:143],a[236:239],a[220:223],a[140:143]
v_fmac_f32 v235,s43,v237
v_fmac_f32 v240,4.0,v236
M a[144:147],a[236:239],a[192:195],a[144:147]
v_fma_f32 v231,-4.0,v237,v239
v_fmac_f32 v235,s45,v239
M a[148:151],a[236:239],a[196:199],a[148:151]
v_fmac_f32 v240,s40,v238
v_sub_f32 v239,v239,v237
M a[152:155],a[236:239],a[200:203],a[152:155]
v_fma_f32 v237,-4.0,v236,v238
v_sub_f32 v238,v238,v236
M a[156:159],a[236:239],a[204:207],a[156:159]
s_waitcnt vmcnt(21)
buffer_load_dwordx4 a[236:239],v253,s[20:23],s46 offen offset:0
M a[160:163],a[240:243],a[208:211],a[160:163]
s_add_u32 s32,s51,0
ds_read_b128 a[208:211],v251 offset:52224
v_add_f32 v236,v231,v237
M a[164:167],a[240:243],a[212:215],a[164:167]
s_add_u32 s47,s44,205824
ds_read_b128 a[212:215],v252 offset:52480
v_sub_f32 v231,v231,v237
M a[168:171],a[240:243],a[216:219],a[168:171]
ds_read_b128 a[216:219],v252 offset:52736
v_fma_f32 v237,2.0,v238,v239
M a[172:175],a[240:243],a[220:223],a[172:175]
s_add_u32 s33,s51,196608
ds_read_b128 a[220:223],v252 offset:52992
v_fmac_f32 v239,-2.0,v238
M a[176:179],a[240:243],a[192:195],a[176:179]
ds_read_b128 a[192:195],v252 offset:53248
v_cvt_pk_bf16_f32 v192,v228,v235
M a[180:183],a[240:243],a[196:199],a[180:183]
ds_read_b128 a[196:199],v252 offset:53504
v_cvt_pk_bf16_f32 v202,v233,v240
M a[184:187],a[240:243],a[200:203],a[184:187]
s_add_u32 s34,s51,393216
ds_read_b128 a[200:203],v252 offset:53760
v_cvt_pk_bf16_f32 v194,v229,v236
M a[188:191],a[240:243],a[204:207],a[188:191]
s_waitcnt vmcnt(21) lgkmcnt(6)
buffer_load_dwordx4 a[240:243],v253,s[20:23],s47 offen offset:0
M v[0:3],a[244:247],a[208:211],v[0:3]
s_waitcnt lgkmcnt(5)
ds_read_b128 a[204:207],v252 offset:54016
v_cvt_pk_bf16_f32 v196,v234,v231
M v[4:7],a[244:247],a[212:215],v[4:7]
s_waitcnt lgkmcnt(5)
s_add_u32 s48,s44,208896
s_add_u32 s35,s51,589824
v_cvt_pk_bf16_f32 v198,v230,v237
M v[8:11],a[244:247],a[216:219],v[8:11]
s_waitcnt lgkmcnt(4)
v_cvt_pk_bf16_f32 v200,v232,v239
v_lshlrev_b32 v230,16,v197
M v[12:15],a[244:247],a[220:223],v[12:15]
s_waitcnt lgkmcnt(3)
v_lshlrev_b32 v228,16,v193
v_lshlrev_b32 v229,16,v195
M v[16:19],a[244:247],a[192:195],v[16:19]
s_waitcnt lgkmcnt(2)
s_add_u32 s36,s51,786432
v_lshlrev_b32 v233,16,v203
v_lshlrev_b32 v232,16,v201
M v[20:23],a[244:247],a[196:199],v[20:23]
s_waitcnt lgkmcnt(1)
v_lshlrev_b32 v231,16,v199
v_fmac_f32 v228,s43,v230
M v[24:27],a[244:247],a[200:203],v[24:27]
s_waitcnt lgkmcnt(0)
v_fmac_f32 v233,4.0,v229
v_fma_f32 v234,-4.0,v230,v232
M v[28:31],a[244:247],a[204:207],v[28:31]
s_waitcnt vmcnt(21)
s_add_u32 s37,s51,983040
buffer_load_dwordx4 a[244:247],v253,s[20:23],s48 offen offset:0
M v[32:35],a[248:251],a[208:211],v[32:35]
v_fmac_f32 v228,s45,v232
v_fmac_f32 v233,s40,v231
M v[36:39],a[248:251],a[212:215],v[36:39]
v_sub_f32 v232,v232,v230
v_fma_f32 v230,-4.0,v229,v231
M v[40:43],a[248:251],a[216:219],v[40:43]
s_add_u32 s38,s51,1179648
v_sub_f32 v231,v231,v229
v_add_f32 v229,v234,v230
M v[44:47],a[248:251],a[220:223],v[44:47]
v_sub_f32 v234,v234,v230
v_fma_f32 v230,2.0,v231,v232
M v[48:51],a[248:251],a[192:195],v[48:51]
v_fmac_f32 v232,-2.0,v231
v_and_b32 v237,s42,v197
M v[52:55],a[248:251],a[196:199],v[52:55]
s_add_u32 s39,s51,1376256
v_and_b32 v235,s42,v193
v_and_b32 v236,s42,v195
M v[56:59],a[248:251],a[200:203],v[56:59]
v_and_b32 v240,s42,v203
v_and_b32 v239,s42,v201
M v[60:63],a[248:251],a[204:207],v[60:63]
s_waitcnt vmcnt(21)
buffer_load_dwordx4 a[248:251],v253,s[20:23],s46 offen offset:1024
M v[64:67],a[252:255],a[208:211],v[64:67]
ds_read_b128 a[208:211],v252 offset:54272
v_and_b32 v238,s42,v199
M v[68:71],a[252:255],a[212:215],v[68:71]
v_fmac_f32 v235,s43,v237
v_fmac_f32 v240,4.0,v236
M v[72:75],a[252:255],a[216:219],v[72:75]
v_fma_f32 v231,-4.0,v237,v239
v_fmac_f32 v235,s45,v239
M v[76:79],a[252:255],a[220:223],v[76:79]
v_fmac_f32 v240,s40,v238
v_sub_f32 v239,v239,v237
M v[80:83],a[252:255],a[192:195],v[80:83]
v_fma_f32 v237,-4.0,v236,v238
v_sub_f32 v238,v238,v236
M v[84:87],a[252:255],a[196:199],v[84:87]
v_add_f32 v236,v231,v237
v_sub_f32 v231,v231,v237
M v[88:91],a[252:255],a[200:203],v[88:91]
v_fma_f32 v237,2.0,v238,v239
v_fmac_f32 v239,-2.0,v238
M v[92:95],a[252:255],a[204:207],v[92:95]
s_waitcnt vmcnt(19)
buffer_load_dwordx4 a[252:255],v253,s[20:23],s47 offen offset:1024
M v[0:3],v[216:219],a[212:215],v[0:3]
v_cvt_pk_bf16_f32 v193,v228,v235
v_cvt_pk_bf16_f32 v203,v233,v240
M v[4:7],v[216:219],a[216:219],v[4:7]
v_cvt_pk_bf16_f32 v195,v229,v236
v_cvt_pk_bf16_f32 v197,v234,v231
M v[8:11],v[216:219],a[220:223],v[8:11]
v_cvt_pk_bf16_f32 v199,v230,v237
v_cvt_pk_bf16_f32 v201,v232,v239
M v[12:15],v[216:219],a[192:195],v[12:15]
v_add_u32 v228,139264,v249
M v[16:19],v[216:219],a[196:199],v[16:19]
ds_write2st64_b64 v228,v[192:193],v[202:203] offset0:2 offset1:19
M v[20:23],v[216:219],a[200:203],v[20:23]
s_add_u32 s28,s30,320
buffer_load_dwordx2 v[192:193],v247,s[12:15],s28 offen offset:0
M v[24:27],v[216:219],a[204:207],v[24:27]
s_waitcnt lgkmcnt(1)
buffer_load_dwordx2 v[202:203],v247,s[16:19],s28 offen offset:1536
M v[28:31],v[216:219],a[208:211],v[28:31]
s_waitcnt vmcnt(17)
buffer_load_dwordx4 v[216:219],v253,s[20:23],s48 offen offset:1024
M v[32:35],v[220:223],a[212:215],v[32:35]
ds_write2st64_b64 v249,v[194:195],v[196:197] offset0:36 offset1:53
M v[36:39],v[220:223],a[216:219],v[36:39]
buffer_load_dwordx2 v[194:195],v247,s[8:11],s28 offen offset:0
M v[40:43],v[220:223],a[220:223],v[40:43]
buffer_load_dwordx2 v[196:197],v247,s[8:11],s28 offen offset:384
M v[44:47],v[220:223],a[192:195],v[44:47]
ds_write2st64_b64 v249,v[198:199],v[200:201] offset0:70 offset1:87
M v[48:51],v[220:223],a[196:199],v[48:51]
buffer_load_dwordx2 v[198:199],v247,s[8:11],s28 offen offset:768
M v[52:55],v[220:223],a[200:203],v[52:55]
buffer_load_dwordx2 v[200:201],v247,s[8:11],s28 offen offset:1152
M v[56:59],v[220:223],a[204:207],v[56:59]
v_lshlrev_b32 v230,16,v208
v_lshlrev_b32 v228,16,v204
M v[60:63],v[220:223],a[208:211],v[60:63]
s_waitcnt vmcnt(15)
buffer_load_dwordx4 v[220:223],v253,s[20:23],s46 offen offset:2048
M v[64:67],v[224:227],a[212:215],v[64:67]
ds_read_b128 a[212:215],v251 offset:54528
v_lshlrev_b32 v229,16,v206
M v[68:71],v[224:227],a[216:219],v[68:71]
v_lshlrev_b32 v233,16,v214
v_lshlrev_b32 v232,16,v212
M v[72:75],v[224:227],a[220:223],v[72:75]
v_lshlrev_b32 v231,16,v210
v_fmac_f32 v228,s43,v230
M v[76:79],v[224:227],a[192:195],v[76:79]
v_fmac_f32 v233,4.0,v229
v_fma_f32 v234,-4.0,v230,v232
M v[80:83],v[224:227],a[196:199],v[80:83]
v_fmac_f32 v228,s45,v232
v_fmac_f32 v233,s40,v231
M v[84:87],v[224:227],a[200:203],v[84:87]
v_sub_f32 v232,v232,v230
v_fma_f32 v230,-4.0,v229,v231
M v[88:91],v[224:227],a[204:207],v[88:91]
v_sub_f32 v231,v231,v229
v_add_f32 v229,v234,v230
M v[92:95],v[224:227],a[208:211],v[92:95]
s_waitcnt vmcnt(15)
buffer_load_dwordx4 v[224:227],v253,s[20:23],s47 offen offset:2048
M v[0:3],a[224:227],a[216:219],v[0:3]
v_sub_f32 v234,v234,v230
v_fma_f32 v230,2.0,v231,v232
M v[4:7],a[224:227],a[220:223],v[4:7]
v_fmac_f32 v232,-2.0,v231
v_and_b32 v237,s42,v208
M v[8:11],a[224:227],a[192:195],v[8:11]
v_and_b32 v235,s42,v204
v_and_b32 v236,s42,v206
M v[12:15],a[224:227],a[196:199],v[12:15]
v_and_b32 v240,s42,v214
v_and_b32 v239,s42,v212
M v[16:19],a[224:227],a[200:203],v[16:19]
v_and_b32 v238,s42,v210
v_fmac_f32 v235,s43,v237
M v[20:23],a[224:227],a[204:207],v[20:23]
v_fmac_f32 v240,4.0,v236
v_fma_f32 v231,-4.0,v237,v239
M v[24:27],a[224:227],a[208:211],v[24:27]
s_waitcnt lgkmcnt(0)
v_fmac_f32 v235,s45,v239
v_fmac_f32 v240,s40,v238
M v[28:31],a[224:227],a[212:215],v[28:31]
s_waitcnt vmcnt(15)
buffer_load_dwordx4 a[224:227],v253,s[20:23],s48 offen offset:2048
M v[32:35],a[228:231],a[216:219],v[32:35]
v_sub_f32 v239,v239,v237
v_fma_f32 v237,-4.0,v236,v238
M v[36:39],a[228:231],a[220:223],v[36:39]
s_add_u32 s46,s44,230400
v_sub_f32 v238,v238,v236
v_add_f32 v236,v231,v237
M v[40:43],a[228:231],a[192:195],v[40:43]
v_sub_f32 v231,v231,v237
v_fma_f32 v237,2.0,v238,v239
M v[44:47],a[228:231],a[196:199],v[44:47]
v_fmac_f32 v239,-2.0,v238
v_cvt_pk_bf16_f32 v204,v228,v235
M v[48:51],a[228:231],a[200:203],v[48:51]
v_cvt_pk_bf16_f32 v214,v233,v240
v_cvt_pk_bf16_f32 v206,v229,v236
M v[52:55],a[228:231],a[204:207],v[52:55]
v_cvt_pk_bf16_f32 v208,v234,v231
v_cvt_pk_bf16_f32 v210,v230,v237
M v[56:59],a[228:231],a[208:211],v[56:59]
v_cvt_pk_bf16_f32 v212,v232,v239
v_lshlrev_b32 v230,16,v209
M v[60:63],a[228:231],a[212:215],v[60:63]
s_waitcnt vmcnt(15)
buffer_load_dwordx4 a[228:231],v253,s[20:23],s46 offen offset:0
M v[64:67],a[232:235],a[216:219],v[64:67]
ds_read_b128 a[216:219],v251 offset:60928
v_lshlrev_b32 v228,16,v205
M v[68:71],a[232:235],a[220:223],v[68:71]
s_add_u32 s47,s44,233472
ds_read_b128 a[220:223],v252 offset:61184
v_lshlrev_b32 v229,16,v207
M v[72:75],a[232:235],a[192:195],v[72:75]
ds_read_b128 a[192:195],v252 offset:61440
v_lshlrev_b32 v233,16,v215
M v[76:79],a[232:235],a[196:199],v[76:79]
ds_read_b128 a[196:199],v252 offset:61696
v_lshlrev_b32 v232,16,v213
M v[80:83],a[232:235],a[200:203],v[80:83]
ds_read_b128 a[200:203],v252 offset:61952
v_lshlrev_b32 v231,16,v211
M v[84:87],a[232:235],a[204:207],v[84:87]
ds_read_b128 a[204:207],v252 offset:62208
v_fmac_f32 v228,s43,v230
M v[88:91],a[232:235],a[208:211],v[88:91]
ds_read_b128 a[208:211],v252 offset:62464
v_fmac_f32 v233,4.0,v229
M v[92:95],a[232:235],a[212:215],v[92:95]
s_waitcnt vmcnt(15) lgkmcnt(6)
buffer_load_dwordx4 a[232:235],v253,s[20:23],s47 offen offset:0
M v[96:99],a[236:239],a[216:219],v[96:99]
s_waitcnt lgkmcnt(5)
ds_read_b128 a[212:215],v252 offset:62720
v_fma_f32 v234,-4.0,v230,v232
M v[100:103],a[236:239],a[220:223],v[100:103]
s_waitcnt lgkmcnt(5)
s_add_u32 s48,s44,236544
v_fmac_f32 v228,s45,v232
v_fmac_f32 v233,s40,v231
M v[104:107],a[236:239],a[192:195],v[104:107]
s_waitcnt lgkmcnt(4)
v_sub_f32 v232,v232,v230
v_fma_f32 v230,-4.0,v229,v231
M v[108:111],a[236:239],a[196:199],v[108:111]
s_waitcnt lgkmcnt(3)
v_sub_f32 v231,v231,v229
v_add_f32 v229,v234,v230
M v[112:115],a[236:239],a[200:203],v[112:115]
s_waitcnt lgkmcnt(2)
v_sub_f32 v234,v234,v230
v_fma_f32 v230,2.0,v231,v232
M v[116:119],a[236:239],a[204:207],v[116:119]
s_waitcnt lgkmcnt(1)
v_fmac_f32 v232,-2.0,v231
v_and_b32 v237,s42,v209
M v[120:123],a[236:239],a[208:211],v[120:123]
s_waitcnt lgkmcnt(0)
v_and_b32 v235,s42,v205
v_and_b32 v236,s42,v207
M v[124:127],a[236:239],a[212:215],v[124:127]
s_waitcnt vmcnt(15)
buffer_load_dwordx4 a[236:239],v253,s[20:23],s48 offen offset:0
M v[128:131],a[240:243],a[216:219],v[128:131]
v_and_b32 v240,s42,v215
v_and_b32 v239,s42,v213
M v[132:135],a[240:243],a[220:223],v[132:135]
v_and_b32 v238,s42,v211
v_fmac_f32 v235,s43,v237
M v[136:139],a[240:243],a[192:195],v[136:139]
v_fmac_f32 v240,4.0,v236
v_fma_f32 v231,-4.0,v237,v239
M v[140:143],a[240:243],a[196:199],v[140:143]
v_fmac_f32 v235,s45,v239
v_fmac_f32 v240,s40,v238
M v[144:147],a[240:243],a[200:203],v[144:147]
v_sub_f32 v239,v239,v237
v_fma_f32 v237,-4.0,v236,v238
M v[148:151],a[240:243],a[204:207],v[148:151]
v_sub_f32 v238,v238,v236
v_add_f32 v236,v231,v237
M v[152:155],a[240:243],a[208:211],v[152:155]
v_sub_f32 v231,v231,v237
v_fma_f32 v237,2.0,v238,v239
M v[156:159],a[240:243],a[212:215],v[156:159]
s_waitcnt vmcnt(15)
buffer_load_dwordx4 a[240:243],v253,s[20:23],s46 offen offset:1024
M v[160:163],a[244:247],a[216:219],v[160:163]
ds_read_b128 a[216:219],v252 offset:62976
v_fmac_f32 v239,-2.0,v238
M v[164:167],a[244:247],a[220:223],v[164:167]
v_cvt_pk_bf16_f32 v205,v228,v235
v_cvt_pk_bf16_f32 v215,v233,v240
M v[168:171],a[244:247],a[192:195],v[168:171]
v_cvt_pk_bf16_f32 v207,v229,v236
v_cvt_pk_bf16_f32 v209,v234,v231
M v[172:175],a[244:247],a[196:199],v[172:175]
v_cvt_pk_bf16_f32 v211,v230,v237
v_cvt_pk_bf16_f32 v213,v232,v239
M v[176:179],a[244:247],a[200:203],v[176:179]
v_add_u32 v228,139264,v249
M v[180:183],a[244:247],a[204:207],v[180:183]
ds_write2st64_b64 v228,v[204:205],v[214:215] offset0:3 offset1:20
M v[184:187],a[244:247],a[208:211],v[184:187]
s_add_u32 s28,s30,393536
buffer_load_dwordx2 v[204:205],v247,s[12:15],s28 offen offset:0
M v[188:191],a[244:247],a[212:215],v[188:191]
s_waitcnt vmcnt(16)
buffer_load_dwordx2 v[214:215],v247,s[16:19],s28 offen offset:1536
M v[96:99],a[248:251],a[220:223],v[96:99]
buffer_load_dwordx4 a[244:247],v253,s[20:23],s47 offen offset:1024
M v[100:103],a[248:251],a[192:195],v[100:103]
ds_write2st64_b64 v249,v[206:207],v[208:209] offset0:37 offset1:54
M v[104:107],a[248:251],a[196:199],v[104:107]
buffer_load_dwordx2 v[206:207],v247,s[8:11],s28 offen offset:0
M v[108:111],a[248:251],a[200:203],v[108:111]
buffer_load_dwordx2 v[208:209],v247,s[8:11],s28 offen offset:384
M v[112:115],a[248:251],a[204:207],v[112:115]
ds_write2st64_b64 v249,v[210:211],v[212:213] offset0:71 offset1:88
M v[116:119],a[248:251],a[208:211],v[116:119]
buffer_load_dwordx2 v[210:211],v247,s[8:11],s28 offen offset:768
M v[120:123],a[248:251],a[212:215],v[120:123]
s_waitcnt lgkmcnt(3)
buffer_load_dwordx2 v[212:213],v247,s[8:11],s28 offen offset:1152
M v[124:127],a[248:251],a[216:219],v[124:127]
s_waitcnt vmcnt(21)
buffer_load_dwordx4 a[248:251],v253,s[20:23],s48 offen offset:1024
M v[128:131],a[252:255],a[220:223],v[128:131]
s_waitcnt vmcnt(17)
v_lshlrev_b32 v230,16,v196
v_lshlrev_b32 v228,16,v192
M v[132:135],a[252:255],a[192:195],v[132:135]
v_lshlrev_b32 v229,16,v194
v_lshlrev_b32 v233,16,v202
M v[136:139],a[252:255],a[196:199],v[136:139]
s_waitcnt vmcnt(15)
v_lshlrev_b32 v232,16,v200
v_lshlrev_b32 v231,16,v198
M v[140:143],a[252:255],a[200:203],v[140:143]
v_fmac_f32 v228,s43,v230
v_fmac_f32 v233,4.0,v229
M v[144:147],a[252:255],a[204:207],v[144:147]
v_fma_f32 v234,-4.0,v230,v232
v_fmac_f32 v228,s45,v232
M v[148:151],a[252:255],a[208:211],v[148:151]
v_fmac_f32 v233,s40,v231
v_sub_f32 v232,v232,v230
M v[152:155],a[252:255],a[212:215],v[152:155]
v_fma_f32 v230,-4.0,v229,v231
v_sub_f32 v231,v231,v229
M v[156:159],a[252:255],a[216:219],v[156:159]
buffer_load_dwordx4 a[252:255],v253,s[20:23],s46 offen offset:2048
M v[160:163],v[216:219],a[220:223],v[160:163]
ds_read_b128 a[220:223],v251 offset:63232
v_add_f32 v229,v234,v230
M v[164:167],v[216:219],a[192:195],v[164:167]
v_sub_f32 v234,v234,v230
v_fma_f32 v230,2.0,v231,v232
M v[168:171],v[216:219],a[196:199],v[168:171]
v_fmac_f32 v232,-2.0,v231
v_and_b32 v237,s42,v196
M v[172:175],v[216:219],a[200:203],v[172:175]
v_and_b32 v235,s42,v192
v_and_b32 v236,s42,v194
M v[176:179],v[216:219],a[204:207],v[176:179]
v_and_b32 v240,s42,v202
v_and_b32 v239,s42,v200
M v[180:183],v[216:219],a[208:211],v[180:183]
v_and_b32 v238,s42,v198
v_fmac_f32 v235,s43,v237
M v[184:187],v[216:219],a[212:215],v[184:187]
v_fmac_f32 v240,4.0,v236
v_fma_f32 v231,-4.0,v237,v239
M v[188:191],v[216:219],a[216:219],v[188:191]
s_waitcnt vmcnt(15)
buffer_load_dwordx4 v[216:219],v253,s[20:23],s47 offen offset:2048
M v[96:99],v[220:223],a[192:195],v[96:99]
v_fmac_f32 v235,s45,v239
v_fmac_f32 v240,s40,v238
M v[100:103],v[220:223],a[196:199],v[100:103]
v_sub_f32 v239,v239,v237
v_fma_f32 v237,-4.0,v236,v238
M v[104:107],v[220:223],a[200:203],v[104:107]
v_sub_f32 v238,v238,v236
v_add_f32 v236,v231,v237
M v[108:111],v[220:223],a[204:207],v[108:111]
v_sub_f32 v231,v231,v237
v_fma_f32 v237,2.0,v238,v239
M v[112:115],v[220:223],a[208:211],v[112:115]
v_fmac_f32 v239,-2.0,v238
v_cvt_pk_bf16_f32 v192,v228,v235
M v[116:119],v[220:223],a[212:215],v[116:119]
v_cvt_pk_bf16_f32 v202,v233,v240
v_cvt_pk_bf16_f32 v194,v229,v236
M v[120:123],v[220:223],a[216:219],v[120:123]
s_waitcnt lgkmcnt(0)
v_cvt_pk_bf16_f32 v196,v234,v231
v_cvt_pk_bf16_f32 v198,v230,v237
M v[124:127],v[220:223],a[220:223],v[124:127]
s_waitcnt vmcnt(15)
buffer_load_dwordx4 v[220:223],v253,s[20:23],s48 offen offset:2048
M v[128:131],v[224:227],a[192:195],v[128:131]
v_cvt_pk_bf16_f32 v200,v232,v239
v_lshlrev_b32 v230,16,v197
M v[132:135],v[224:227],a[196:199],v[132:135]
s_add_u32 s46,s44,239616
v_lshlrev_b32 v228,16,v193
v_lshlrev_b32 v229,16,v195
M v[136:139],v[224:227],a[200:203],v[136:139]
v_lshlrev_b32 v233,16,v203
v_lshlrev_b32 v232,16,v201
M v[140:143],v[224:227],a[204:207],v[140:143]
v_lshlrev_b32 v231,16,v199
v_fmac_f32 v228,s43,v230
M v[144:147],v[224:227],a[208:211],v[144:147]
v_fmac_f32 v233,4.0,v229
v_fma_f32 v234,-4.0,v230,v232
M v[148:151],v[224:227],a[212:215],v[148:151]
v_fmac_f32 v228,s45,v232
v_fmac_f32 v233,s40,v231
M v[152:155],v[224:227],a[216:219],v[152:155]
s_barrier
v_sub_f32 v232,v232,v230
M v[156:159],v[224:227],a[220:223],v[156:159]
s_waitcnt vmcnt(15)
buffer_load_dwordx4 v[224:227],v253,s[20:23],s46 offen offset:0
M v[160:163],a[224:227],a[192:195],v[160:163]
ds_read_b128 a[192:195],v251 offset:0
v_fma_f32 v230,-4.0,v229,v231
M v[164:167],a[224:227],a[196:199],v[164:167]
s_add_u32 s47,s44,242688
ds_read_b128 a[196:199],v252 offset:256
v_sub_f32 v231,v231,v229
M v[168:171],a[224:227],a[200:203],v[168:171]
ds_read_b128 a[200:203],v252 offset:512
v_add_f32 v229,v234,v230
M v[172:175],a[224:227],a[204:207],v[172:175]
ds_read_b128 a[204:207],v252 offset:768
v_sub_f32 v234,v234,v230
M v[176:179],a[224:227],a[208:211],v[176:179]
ds_read_b128 a[208:211],v252 offset:1024
v_fma_f32 v230,2.0,v231,v232
M v[180:183],a[224:227],a[212:215],v[180:183]
ds_read_b128 a[212:215],v252 offset:1280
v_fmac_f32 v232,-2.0,v231
M v[184:187],a[224:227],a[216:219],v[184:187]
ds_read_b128 a[216:219],v252 offset:1536
v_and_b32 v237,s42,v197
M v[188:191],a[224:227],a[220:223],v[188:191]
s_waitcnt vmcnt(15) lgkmcnt(6)
buffer_load_dwordx4 a[224:227],v253,s[20:23],s47 offen offset:0
M a[0:3],a[228:231],a[192:195],a[0:3]
s_waitcnt lgkmcnt(5)
ds_read_b128 a[220:223],v252 offset:1792
v_and_b32 v235,s42,v193
M a[4:7],a[228:231],a[196:199],a[4:7]
s_waitcnt lgkmcnt(5)
s_add_u32 s48,s44,245760
v_and_b32 v236,s42,v195
v_and_b32 v240,s42,v203
M a[8:11],a[228:231],a[200:203],a[8:11]
s_waitcnt lgkmcnt(4)
v_and_b32 v239,s42,v201
v_and_b32 v238,s42,v199
M a[12:15],a[228:231],a[204:207],a[12:15]
s_waitcnt lgkmcnt(3)
v_fmac_f32 v235,s43,v237
v_fmac_f32 v240,4.0,v236
M a[16:19],a[228:231],a[208:211],a[16:19]
s_waitcnt lgkmcnt(2)
v_fma_f32 v231,-4.0,v237,v239
v_fmac_f32 v235,s45,v239
M a[20:23],a[228:231],a[212:215],a[20:23]
s_waitcnt lgkmcnt(1)
v_fmac_f32 v240,s40,v238
v_sub_f32 v239,v239,v237
M a[24:27],a[228:231],a[216:219],a[24:27]
s_waitcnt lgkmcnt(0)
v_fma_f32 v237,-4.0,v236,v238
v_sub_f32 v238,v238,v236
M a[28:31],a[228:231],a[220:223],a[28:31]
s_waitcnt vmcnt(15)
buffer_load_dwordx4 a[228:231],v253,s[20:23],s48 offen offset:0
M a[32:35],a[232:235],a[192:195],a[32:35]
v_add_f32 v236,v231,v237
v_sub_f32 v231,v231,v237
M a[36:39],a[232:235],a[196:199],a[36:39]
v_fma_f32 v237,2.0,v238,v239
v_fmac_f32 v239,-2.0,v238
M a[40:43],a[232:235],a[200:203],a[40:43]
v_cvt_pk_bf16_f32 v193,v228,v235
v_cvt_pk_bf16_f32 v203,v233,v240
M a[44:47],a[232:235],a[204:207],a[44:47]
v_cvt_pk_bf16_f32 v195,v229,v236
v_cvt_pk_bf16_f32 v197,v234,v231
M a[48:51],a[232:235],a[208:211],a[48:51]
v_cvt_pk_bf16_f32 v199,v230,v237
v_cvt_pk_bf16_f32 v201,v232,v239
M a[52:55],a[232:235],a[212:215],a[52:55]
ds_write2st64_b64 v249,v[192:193],v[202:203] offset0:136 offset1:153
M a[56:59],a[232:235],a[216:219],a[56:59]
s_add_u32 s28,s30,786752
buffer_load_dwordx2 v[192:193],v247,s[12:15],s28 offen offset:0
M a[60:63],a[232:235],a[220:223],a[60:63]
s_waitcnt vmcnt(16)
buffer_load_dwordx2 v[202:203],v247,s[16:19],s28 offen offset:1536
M a[64:67],a[236:239],a[192:195],a[64:67]
buffer_load_dwordx4 a[232:235],v253,s[20:23],s46 offen offset:1024
M a[68:71],a[236:239],a[196:199],a[68:71]
ds_read_b128 a[192:195],v252 offset:2048
ds_write2st64_b64 v249,v[194:195],v[196:197] offset0:102 offset1:119
M a[72:75],a[236:239],a[200:203],a[72:75]
buffer_load_dwordx2 v[194:195],v247,s[8:11],s28 offen offset:0
M a[76:79],a[236:239],a[204:207],a[76:79]
buffer_load_dwordx2 v[196:197],v247,s[8:11],s28 offen offset:384
M a[80:83],a[236:239],a[208:211],a[80:83]
M a[84:87],a[236:239],a[212:215],a[84:87]
M a[88:91],a[236:239],a[216:219],a[88:91]
M a[92:95],a[236:239],a[220:223],a[92:95]
s_waitcnt vmcnt(19)
buffer_load_dwordx4 a[236:239],v253,s[20:23],s47 offen offset:1024
M a[0:3],a[240:243],a[196:199],a[0:3]
M a[4:7],a[240:243],a[200:203],a[4:7]
M a[8:11],a[240:243],a[204:207],a[8:11]
M a[12:15],a[240:243],a[208:211],a[12:15]
M a[16:19],a[240:243],a[212:215],a[16:19]
M a[20:23],a[240:243],a[216:219],a[20:23]
M a[24:27],a[240:243],a[220:223],a[24:27]
s_waitcnt lgkmcnt(1)
M a[28:31],a[240:243],a[192:195],a[28:31]
s_waitcnt vmcnt(17)
buffer_load_dwordx4 a[240:243],v253,s[20:23],s48 offen offset:1024
M a[32:35],a[244:247],a[196:199],a[32:35]
M a[36:39],a[244:247],a[200:203],a[36:39]
M a[40:43],a[244:247],a[204:207],a[40:43]
M a[44:47],a[244:247],a[208:211],a[44:47]
M a[48:51],a[244:247],a[212:215],a[48:51]
M a[52:55],a[244:247],a[216:219],a[52:55]
M a[56:59],a[244:247],a[220:223],a[56:59]
M a[60:63],a[244:247],a[192:195],a[60:63]
s_waitcnt vmcnt(13)
buffer_load_dwordx4 a[244:247],v253,s[20:23],s46 offen offset:2048
M a[64:67],a[248:251],a[196:199],a[64:67]
ds_read_b128 a[196:199],v251 offset:2304
M a[68:71],a[248:251],a[200:203],a[68:71]
M a[72:75],a[248:251],a[204:207],a[72:75]
M a[76:79],a[248:251],a[208:211],a[76:79]
M a[80:83],a[248:251],a[212:215],a[80:83]
M a[84:87],a[248:251],a[216:219],a[84:87]
M a[88:91],a[248:251],a[220:223],a[88:91]
M a[92:95],a[248:251],a[192:195],a[92:95]
s_waitcnt vmcnt(13)
buffer_load_dwordx4 a[248:251],v253,s[20:23],s47 offen offset:2048
M a[0:3],a[252:255],a[200:203],a[0:3]
M a[4:7],a[252:255],a[204:207],a[4:7]
M a[8:11],a[252:255],a[208:211],a[8:11]
M a[12:15],a[252:255],a[212:215],a[12:15]
M a[16:19],a[252:255],a[216:219],a[16:19]
M a[20:23],a[252:255],a[220:223],a[20:23]
M a[24:27],a[252:255],a[192:195],a[24:27]
s_waitcnt lgkmcnt(0)
M a[28:31],a[252:255],a[196:199],a[28:31]
s_waitcnt vmcnt(13)
buffer_load_dwordx4 a[252:255],v253,s[20:23],s48 offen offset:2048
M a[32:35],v[216:219],a[200:203],a[32:35]
M a[36:39],v[216:219],a[204:207],a[36:39]
s_add_u32 s46,s44,248832
M a[40:43],v[216:219],a[208:211],a[40:43]
M a[44:47],v[216:219],a[212:215],a[44:47]
M a[48:51],v[216:219],a[216:219],a[48:51]
M a[52:55],v[216:219],a[220:223],a[52:55]
M a[56:59],v[216:219],a[192:195],a[56:59]
M a[60:63],v[216:219],a[196:199],a[60:63]
s_waitcnt vmcnt(13)
buffer_load_dwordx4 v[216:219],v253,s[20:23],s46 offen offset:0
M a[64:67],v[220:223],a[200:203],a[64:67]
ds_read_b128 a[200:203],v251 offset:8704
M a[68:71],v[220:223],a[204:207],a[68:71]
s_add_u32 s47,s44,251904
ds_read_b128 a[204:207],v252 offset:8960
M a[72:75],v[220:223],a[208:211],a[72:75]
ds_read_b128 a[208:211],v252 offset:9216
M a[76:79],v[220:223],a[212:215],a[76:79]
ds_read_b128 a[212:215],v252 offset:9472
M a[80:83],v[220:223],a[216:219],a[80:83]
ds_read_b128 a[216:219],v252 offset:9728
M a[84:87],v[220:223],a[220:223],a[84:87]
ds_read_b128 a[220:223],v252 offset:9984
M a[88:91],v[220:223],a[192:195],a[88:91]
ds_read_b128 a[192:195],v252 offset:10240
M a[92:95],v[220:223],a[196:199],a[92:95]
s_waitcnt vmcnt(13) lgkmcnt(6)
buffer_load_dwordx4 v[220:223],v253,s[20:23],s47 offen offset:0
ds_read_b128 a[196:199],v252 offset:10496
M a[96:99],v[224:227],a[200:203],a[96:99]
s_waitcnt lgkmcnt(6)
M a[100:103],v[224:227],a[204:207],a[100:103]
s_waitcnt lgkmcnt(5)
s_add_u32 s48,s44,254976
M a[104:107],v[224:227],a[208:211],a[104:107]
s_waitcnt lgkmcnt(4)
M a[108:111],v[224:227],a[212:215],a[108:111]
s_waitcnt lgkmcnt(3)
M a[112:115],v[224:227],a[216:219],a[112:115]
s_waitcnt lgkmcnt(2)
M a[116:119],v[224:227],a[220:223],a[116:119]
s_waitcnt lgkmcnt(1)
M a[120:123],v[224:227],a[192:195],a[120:123]
s_waitcnt lgkmcnt(0)
M a[124:127],v[224:227],a[196:199],a[124:127]
s_waitcnt vmcnt(13)
buffer_load_dwordx4 v[224:227],v253,s[20:23],s48 offen offset:0
M a[128:131],a[224:227],a[200:203],a[128:131]
M a[132:135],a[224:227],a[204:207],a[132:135]
M a[136:139],a[224:227],a[208:211],a[136:139]
M a[140:143],a[224:227],a[212:215],a[140:143]
M a[144:147],a[224:227],a[216:219],a[144:147]
M a[148:151],a[224:227],a[220:223],a[148:151]
M a[152:155],a[224:227],a[192:195],a[152:155]
M a[156:159],a[224:227],a[196:199],a[156:159]
s_waitcnt vmcnt(13)
buffer_load_dwordx4 a[224:227],v253,s[20:23],s46 offen offset:1024
M a[160:163],a[228:231],a[200:203],a[160:163]
ds_read_b128 a[200:203],v252 offset:10752
M a[164:167],a[228:231],a[204:207],a[164:167]
M a[168:171],a[228:231],a[208:211],a[168:171]
M a[172:175],a[228:231],a[212:215],a[172:175]
M a[176:179],a[228:231],a[216:219],a[176:179]
M a[180:183],a[228:231],a[220:223],a[180:183]
M a[184:187],a[228:231],a[192:195],a[184:187]
M a[188:191],a[228:231],a[196:199],a[188:191]
s_waitcnt vmcnt(11)
buffer_load_dwordx4 a[228:231],v253,s[20:23],s47 offen offset:1024
M a[96:99],a[232:235],a[204:207],a[96:99]
M a[100:103],a[232:235],a[208:211],a[100:103]
M a[104:107],a[232:235],a[212:215],a[104:107]
M a[108:111],a[232:235],a[216:219],a[108:111]
M a[112:115],a[232:235],a[220:223],a[112:115]
M a[116:119],a[232:235],a[192:195],a[116:119]
M a[120:123],a[232:235],a[196:199],a[120:123]
s_waitcnt lgkmcnt(0)
M a[124:127],a[232:235],a[200:203],a[124:127]
s_waitcnt vmcnt(9)
buffer_load_dwordx4 a[232:235],v253,s[20:23],s48 offen offset:1024
M a[128:131],a[236:239],a[204:207],a[128:131]
M a[132:135],a[236:239],a[208:211],a[132:135]
M a[136:139],a[236:239],a[212:215],a[136:139]
M a[140:143],a[236:239],a[216:219],a[140:143]
M a[144:147],a[236:239],a[220:223],a[144:147]
M a[148:151],a[236:239],a[192:195],a[148:151]
M a[152:155],a[236:239],a[196:199],a[152:155]
M a[156:159],a[236:239],a[200:203],a[156:159]
s_waitcnt vmcnt(9)
buffer_load_dwordx4 a[236:239],v253,s[20:23],s46 offen offset:2048
M a[160:163],a[240:243],a[204:207],a[160:163]
ds_read_b128 a[204:207],v251 offset:11008
M a[164:167],a[240:243],a[208:211],a[164:167]
M a[168:171],a[240:243],a[212:215],a[168:171]
M a[172:175],a[240:243],a[216:219],a[172:175]
M a[176:179],a[240:243],a[220:223],a[176:179]
M a[180:183],a[240:243],a[192:195],a[180:183]
M a[184:187],a[240:243],a[196:199],a[184:187]
M a[188:191],a[240:243],a[200:203],a[188:191]
s_waitcnt vmcnt(9)
buffer_load_dwordx4 a[240:243],v253,s[20:23],s47 offen offset:2048
M a[96:99],a[244:247],a[208:211],a[96:99]
M a[100:103],a[244:247],a[212:215],a[100:103]
M a[104:107],a[244:247],a[216:219],a[104:107]
M a[108:111],a[244:247],a[220:223],a[108:111]
M a[112:115],a[244:247],a[192:195],a[112:115]
M a[116:119],a[244:247],a[196:199],a[116:119]
M a[120:123],a[244:247],a[200:203],a[120:123]
s_waitcnt lgkmcnt(0)
M a[124:127],a[244:247],a[204:207],a[124:127]
s_waitcnt vmcnt(9)
buffer_load_dwordx4 a[244:247],v253,s[20:23],s48 offen offset:2048
M a[128:131],a[248:251],a[208:211],a[128:131]
M a[132:135],a[248:251],a[212:215],a[132:135]
s_barrier
ds_write2st64_b64 v249,v[198:199],v[200:201] offset0:34 offset1:51
M a[136:139],a[248:251],a[216:219],a[136:139]
s_add_u32 s46,s44,258048
buffer_load_dwordx2 v[198:199],v247,s[8:11],s28 offen offset:768
M a[140:143],a[248:251],a[220:223],a[140:143]
buffer_load_dwordx2 v[200:201],v247,s[8:11],s28 offen offset:1152
v_lshlrev_b32 v230,16,v208
M a[144:147],a[248:251],a[192:195],a[144:147]
v_lshlrev_b32 v228,16,v204
v_lshlrev_b32 v229,16,v206
M a[148:151],a[248:251],a[196:199],a[148:151]
v_lshlrev_b32 v233,16,v214
v_lshlrev_b32 v232,16,v212
v_lshlrev_b32 v231,16,v210
M a[152:155],a[248:251],a[200:203],a[152:155]
v_fmac_f32 v228,s43,v230
v_fmac_f32 v233,4.0,v229
M a[156:159],a[248:251],a[204:207],a[156:159]
s_waitcnt vmcnt(11)
buffer_load_dwordx4 a[248:251],v253,s[20:23],s46 offen offset:0
v_fma_f32 v234,-4.0,v230,v232
M a[160:163],a[252:255],a[208:211],a[160:163]
ds_read_b128 a[208:211],v251 offset:17408
v_fmac_f32 v228,s45,v232
M a[164:167],a[252:255],a[212:215],a[164:167]
s_add_u32 s47,s44,261120
ds_read_b128 a[212:215],v252 offset:17664
v_fmac_f32 v233,s40,v231
v_sub_f32 v232,v232,v230
M a[168:171],a[252:255],a[216:219],a[168:171]
ds_read_b128 a[216:219],v252 offset:17920
v_fma_f32 v230,-4.0,v229,v231
M a[172:175],a[252:255],a[220:223],a[172:175]
ds_read_b128 a[220:223],v252 offset:18176
v_sub_f32 v231,v231,v229
v_add_f32 v229,v234,v230
M a[176:179],a[252:255],a[192:195],a[176:179]
ds_read_b128 a[192:195],v252 offset:18432
v_sub_f32 v234,v234,v230
M a[180:183],a[252:255],a[196:199],a[180:183]
ds_read_b128 a[196:199],v252 offset:18688
v_fma_f32 v230,2.0,v231,v232
v_fmac_f32 v232,-2.0,v231
M a[184:187],a[252:255],a[200:203],a[184:187]
ds_read_b128 a[200:203],v252 offset:18944
v_and_b32 v237,s42,v208
M a[188:191],a[252:255],a[204:207],a[188:191]
s_waitcnt vmcnt(11) lgkmcnt(6)
buffer_load_dwordx4 a[252:255],v253,s[20:23],s47 offen offset:0
ds_read_b128 a[204:207],v252 offset:19200
M v[0:3],v[216:219],a[208:211],v[0:3]
s_waitcnt lgkmcnt(6)
v_and_b32 v235,s42,v204
v_and_b32 v236,s42,v206
v_and_b32 v240,s42,v214
M v[4:7],v[216:219],a[212:215],v[4:7]
s_waitcnt lgkmcnt(5)
s_add_u32 s48,s44,264192
v_and_b32 v239,s42,v212
v_and_b32 v238,s42,v210
M v[8:11],v[216:219],a[216:219],v[8:11]
s_waitcnt lgkmcnt(4)
v_fmac_f32 v235,s43,v237
v_fmac_f32 v240,4.0,v236
v_fma_f32 v231,-4.0,v237,v239
M v[12:15],v[216:219],a[220:223],v[12:15]
s_waitcnt lgkmcnt(3)
v_fmac_f32 v235,s45,v239
v_fmac_f32 v240,s40,v238
M v[16:19],v[216:219],a[192:195],v[16:19]
s_waitcnt lgkmcnt(2)
v_sub_f32 v239,v239,v237
v_fma_f32 v237,-4.0,v236,v238
v_sub_f32 v238,v238,v236
M v[20:23],v[216:219],a[196:199],v[20:23]
s_waitcnt lgkmcnt(1)
v_add_f32 v236,v231,v237
v_sub_f32 v231,v231,v237
M v[24:27],v[216:219],a[200:203],v[24:27]
s_waitcnt lgkmcnt(0)
v_fma_f32 v237,2.0,v238,v239
v_fmac_f32 v239,-2.0,v238
v_cvt_pk_bf16_f32 v204,v228,v235
M v[28:31],v[216:219],a[204:207],v[28:31]
s_waitcnt vmcnt(11)
buffer_load_dwordx4 v[216:219],v253,s[20:23],s48 offen offset:0
M v[32:35],v[220:223],a[208:211],v[32:35]
v_cvt_pk_bf16_f32 v214,v233,v240
v_cvt_pk_bf16_f32 v206,v229,v236
v_cvt_pk_bf16_f32 v208,v234,v231
M v[36:39],v[220:223],a[212:215],v[36:39]
v_cvt_pk_bf16_f32 v210,v230,v237
v_cvt_pk_bf16_f32 v212,v232,v239
M v[40:43],v[220:223],a[216:219],v[40:43]
v_lshlrev_b32 v230,16,v209
v_lshlrev_b32 v228,16,v205
v_lshlrev_b32 v229,16,v207
M v[44:47],v[220:223],a[220:223],v[44:47]
v_lshlrev_b32 v233,16,v215
v_lshlrev_b32 v232,16,v213
M v[48:51],v[220:223],a[192:195],v[48:51]
v_lshlrev_b32 v231,16,v211
v_fmac_f32 v228,s43,v230
v_fmac_f32 v233,4.0,v229
M v[52:55],v[220:223],a[196:199],v[52:55]
v_fma_f32 v234,-4.0,v230,v232
v_fmac_f32 v228,s45,v232
v_fmac_f32 v233,s40,v231
M v[56:59],v[220:223],a[200:203],v[56:59]
v_sub_f32 v232,v232,v230
v_fma_f32 v230,-4.0,v229,v231
M v[60:63],v[220:223],a[204:207],v[60:63]
s_waitcnt vmcnt(11)
buffer_load_dwordx4 v[220:223],v253,s[20:23],s46 offen offset:1024
v_sub_f32 v231,v231,v229
M v[64:67],v[224:227],a[208:211],v[64:67]
ds_read_b128 a[208:211],v252 offset:19456
v_add_f32 v229,v234,v230
M v[68:71],v[224:227],a[212:215],v[68:71]
v_sub_f32 v234,v234,v230
v_fma_f32 v230,2.0,v231,v232
v_fmac_f32 v232,-2.0,v231
M v[72:75],v[224:227],a[216:219],v[72:75]
v_and_b32 v237,s42,v209
v_and_b32 v235,s42,v205
M v[76:79],v[224:227],a[220:223],v[76:79]
v_and_b32 v236,s42,v207
v_and_b32 v240,s42,v215
v_and_b32 v239,s42,v213
M v[80:83],v[224:227],a[192:195],v[80:83]
v_and_b32 v238,s42,v211
v_fmac_f32 v235,s43,v237
M v[84:87],v[224:227],a[196:199],v[84:87]
v_fmac_f32 v240,4.0,v236
v_fma_f32 v231,-4.0,v237,v239
v_fmac_f32 v235,s45,v239
M v[88:91],v[224:227],a[200:203],v[88:91]
v_fmac_f32 v240,s40,v238
v_sub_f32 v239,v239,v237
M v[92:95],v[224:227],a[204:207],v[92:95]
s_waitcnt vmcnt(11)
buffer_load_dwordx4 v[224:227],v253,s[20:23],s47 offen offset:1024
v_fma_f32 v237,-4.0,v236,v238
M v[0:3],a[224:227],a[212:215],v[0:3]
v_sub_f32 v238,v238,v236
v_add_f32 v236,v231,v237
M v[4:7],a[224:227],a[216:219],v[4:7]
v_sub_f32 v231,v231,v237
v_fma_f32 v237,2.0,v238,v239
v_fmac_f32 v239,-2.0,v238
M v[8:11],a[224:227],a[220:223],v[8:11]
v_cvt_pk_bf16_f32 v205,v228,v235
v_cvt_pk_bf16_f32 v215,v233,v240
M v[12:15],a[224:227],a[192:195],v[12:15]
v_cvt_pk_bf16_f32 v207,v229,v236
v_cvt_pk_bf16_f32 v209,v234,v231
v_cvt_pk_bf16_f32 v211,v230,v237
M v[16:19],a[224:227],a[196:199],v[16:19]
v_cvt_pk_bf16_f32 v213,v232,v239
M v[20:23],a[224:227],a[200:203],v[20:23]
ds_write2st64_b64 v249,v[204:205],v[214:215] offset0:137 offset1:154
M v[24:27],a[224:227],a[204:207],v[24:27]
s_waitcnt lgkmcnt(1)
s_add_u32 s28,s30,1179968
buffer_load_dwordx2 v[204:205],v247,s[12:15],s28 offen offset:0
M v[28:31],a[224:227],a[208:211],v[28:31]
s_waitcnt vmcnt(12)
buffer_load_dwordx2 v[214:215],v247,s[16:19],s28 offen offset:1536
M v[32:35],a[228:231],a[212:215],v[32:35]
buffer_load_dwordx4 a[224:227],v253,s[20:23],s48 offen offset:1024
M v[36:39],a[228:231],a[216:219],v[36:39]
ds_write2st64_b64 v249,v[206:207],v[208:209] offset0:103 offset1:120
M v[40:43],a[228:231],a[220:223],v[40:43]
buffer_load_dwordx2 v[206:207],v247,s[8:11],s28 offen offset:0
M v[44:47],a[228:231],a[192:195],v[44:47]
buffer_load_dwordx2 v[208:209],v247,s[8:11],s28 offen offset:384
M v[48:51],a[228:231],a[196:199],v[48:51]
ds_write2st64_b64 v249,v[210:211],v[212:213] offset0:35 offset1:52
M v[52:55],a[228:231],a[200:203],v[52:55]
buffer_load_dwordx2 v[210:211],v247,s[8:11],s28 offen offset:768
M v[56:59],a[228:231],a[204:207],v[56:59]
buffer_load_dwordx2 v[212:213],v247,s[8:11],s28 offen offset:1152
M v[60:63],a[228:231],a[208:211],v[60:63]
s_waitcnt vmcnt(17)
buffer_load_dwordx4 a[228:231],v253,s[20:23],s46 offen offset:2048
M v[64:67],a[232:235],a[212:215],v[64:67]
ds_read_b128 a[212:215],v251 offset:19712
v_fmac_f32 v241,s43,v243
M v[68:71],a[232:235],a[216:219],v[68:71]
v_fmac_f32 v246,4.0,v242
v_fma_f32 v228,-4.0,v243,v245
M v[72:75],a[232:235],a[220:223],v[72:75]
v_fmac_f32 v241,s45,v245
v_fmac_f32 v246,s40,v244
M v[76:79],a[232:235],a[192:195],v[76:79]
v_sub_f32 v245,v245,v243
v_fma_f32 v243,-4.0,v242,v244
M v[80:83],a[232:235],a[196:199],v[80:83]
v_sub_f32 v244,v244,v242
v_add_f32 v242,v228,v243
M v[84:87],a[232:235],a[200:203],v[84:87]
v_sub_f32 v228,v228,v243
v_fma_f32 v243,2.0,v244,v245
v_fmac_f32 v245,-2.0,v244
M v[88:91],a[232:235],a[204:207],v[88:91]
v_cvt_pk_bf16_f32 v229,v241,v246
v_cvt_pk_bf16_f32 v230,v242,v228
M v[92:95],a[232:235],a[208:211],v[92:95]
s_waitcnt vmcnt(17)
buffer_load_dwordx4 a[232:235],v253,s[20:23],s47 offen offset:2048
v_cvt_pk_bf16_f32 v231,v243,v245
M v[0:3],a[236:239],a[216:219],v[0:3]
v_add_u32 v228,69632,v250
M v[4:7],a[236:239],a[220:223],v[4:7]
ds_write_b16 v228,v229 offset:0
M v[8:11],a[236:239],a[192:195],v[8:11]
ds_write_b16_d16_hi v228,v229 offset:8704
M v[12:15],a[236:239],a[196:199],v[12:15]
ds_write_b16 v250,v230 offset:52224
ds_write_b16_d16_hi v250,v230 offset:60928
M v[16:19],a[236:239],a[200:203],v[16:19]
ds_write_b16 v250,v231 offset:17408
M v[20:23],a[236:239],a[204:207],v[20:23]
ds_write_b16_d16_hi v250,v231 offset:26112
v_lshrrev_b32 v228,9,v253
M v[24:27],a[236:239],a[208:211],v[24:27]
s_waitcnt lgkmcnt(6)
v_mul_u32_u24 v228,33,v228
v_add_u32 v228,s49,v228
v_add_u32 v228,31,v228
M v[28:31],a[236:239],a[212:215],v[28:31]
s_waitcnt vmcnt(17)
buffer_load_dwordx4 a[236:239],v253,s[20:23],s48 offen offset:2048
M v[32:35],a[240:243],a[216:219],v[32:35]
v_mul_u32_u24 v229,196608,v228
v_cmp_gt_u32 vcc,512,v228
v_bfe_u32 v228,v253,3,6
M v[36:39],a[240:243],a[220:223],v[36:39]
s_add_u32 s46,s44,285696
v_add_u32 v229,v229,v228
v_bfrev_b32 v228,1
M v[40:43],a[240:243],a[192:195],v[40:43]
v_cndmask_b32 v248,v228,v229,vcc
v_lshlrev_b32 v230,16,v196
v_lshlrev_b32 v228,16,v192
M v[44:47],a[240:243],a[196:199],v[44:47]
s_add_u32 s29,s31,0
buffer_load_short_d16_hi v241,v248,s[12:15],s29 offen offset:0
M v[48:51],a[240:243],a[200:203],v[48:51]
buffer_load_short_d16_hi v242,v248,s[8:11],s29 offen offset:0
v_lshlrev_b32 v229,16,v194
M v[52:55],a[240:243],a[204:207],v[52:55]
buffer_load_short_d16_hi v243,v248,s[8:11],s29 offen offset:384
M v[56:59],a[240:243],a[208:211],v[56:59]
buffer_load_short_d16_hi v244,v248,s[8:11],s29 offen offset:768
v_lshlrev_b32 v233,16,v202
M v[60:63],a[240:243],a[212:215],v[60:63]
s_waitcnt vmcnt(21)
buffer_load_short_d16_hi v245,v248,s[8:11],s29 offen offset:1152
M v[64:67],a[244:247],a[216:219],v[64:67]
buffer_load_short_d16_hi v246,v248,s[16:19],s29 offen offset:1536
ds_read_b128 a[216:219],v251 offset:26112
M v[68:71],a[244:247],a[220:223],v[68:71]
buffer_load_dwordx4 a[240:243],v253,s[20:23],s46 offen offset:0
M v[72:75],a[244:247],a[192:195],v[72:75]
s_waitcnt vmcnt(22)
ds_read_b128 a[220:223],v252 offset:26368
ds_read_b128 a[192:195],v252 offset:26624
v_lshlrev_b32 v232,16,v200
M v[76:79],a[244:247],a[196:199],v[76:79]
ds_read_b128 a[196:199],v252 offset:26880
v_lshlrev_b32 v231,16,v198
M v[80:83],a[244:247],a[200:203],v[80:83]
ds_read_b128 a[200:203],v252 offset:27136
v_fmac_f32 v228,s43,v230
v_fmac_f32 v233,4.0,v229
M v[84:87],a[244:247],a[204:207],v[84:87]
ds_read_b128 a[204:207],v252 offset:27392
v_fma_f32 v234,-4.0,v230,v232
v_fmac_f32 v228,s45,v232
M v[88:91],a[244:247],a[208:211],v[88:91]
ds_read_b128 a[208:211],v252 offset:27648
v_fmac_f32 v233,s40,v231
M v[92:95],a[244:247],a[212:215],v[92:95]
s_waitcnt vmcnt(21) lgkmcnt(6)
buffer_load_dwordx4 a[244:247],v253,s[20:23],s46 offen offset:1024
ds_read_b128 a[212:215],v252 offset:27904
M v[96:99],a[248:251],a[216:219],v[96:99]
s_waitcnt lgkmcnt(6)
v_sub_f32 v232,v232,v230
v_fma_f32 v230,-4.0,v229,v231
M v[100:103],a[248:251],a[220:223],v[100:103]
s_waitcnt lgkmcnt(5)
v_sub_f32 v231,v231,v229
v_add_f32 v229,v234,v230
v_sub_f32 v234,v234,v230
M v[104:107],a[248:251],a[192:195],v[104:107]
s_waitcnt lgkmcnt(4)
v_fma_f32 v230,2.0,v231,v232
v_fmac_f32 v232,-2.0,v231
M v[108:111],a[248:251],a[196:199],v[108:111]
s_waitcnt lgkmcnt(3)
v_and_b32 v237,s42,v196
v_and_b32 v235,s42,v192
v_and_b32 v236,s42,v194
M v[112:115],a[248:251],a[200:203],v[112:115]
s_waitcnt lgkmcnt(2)
v_and_b32 v240,s42,v202
v_and_b32 v239,s42,v200
M v[116:119],a[248:251],a[204:207],v[116:119]
s_waitcnt lgkmcnt(1)
v_and_b32 v238,s42,v198
v_fmac_f32 v235,s43,v237
v_fmac_f32 v240,4.0,v236
M v[120:123],a[248:251],a[208:211],v[120:123]
s_waitcnt lgkmcnt(0)
v_fma_f32 v231,-4.0,v237,v239
v_fmac_f32 v235,s45,v239
M v[124:127],a[248:251],a[212:215],v[124:127]
s_waitcnt vmcnt(21)
buffer_load_dwordx4 a[248:251],v253,s[20:23],s46 offen offset:2048
v_fmac_f32 v240,s40,v238
M v[128:131],a[252:255],a[216:219],v[128:131]
v_sub_f32 v239,v239,v237
v_fma_f32 v237,-4.0,v236,v238
M v[132:135],a[252:255],a[220:223],v[132:135]
s_add_u32 s46,s44,294912
v_sub_f32 v238,v238,v236
v_add_f32 v236,v231,v237
v_sub_f32 v231,v231,v237
M v[136:139],a[252:255],a[192:195],v[136:139]
v_fma_f32 v237,2.0,v238,v239
v_fmac_f32 v239,-2.0,v238
v_cvt_pk_bf16_f32 v192,v228,v235
M v[140:143],a[252:255],a[196:199],v[140:143]
v_cvt_pk_bf16_f32 v202,v233,v240
v_cvt_pk_bf16_f32 v194,v229,v236
M v[144:147],a[252:255],a[200:203],v[144:147]
v_cvt_pk_bf16_f32 v196,v234,v231
v_cvt_pk_bf16_f32 v198,v230,v237
v_cvt_pk_bf16_f32 v200,v232,v239
M v[148:151],a[252:255],a[204:207],v[148:151]
v_lshlrev_b32 v230,16,v197
v_lshlrev_b32 v228,16,v193
M v[152:155],a[252:255],a[208:211],v[152:155]
v_lshlrev_b32 v229,16,v195
v_lshlrev_b32 v233,16,v203
v_lshlrev_b32 v232,16,v201
M v[156:159],a[252:255],a[212:215],v[156:159]
s_waitcnt vmcnt(21)
buffer_load_dwordx4 a[252:255],v253,s[20:23],s46 offen offset:0
M v[160:163],v[216:219],a[216:219],v[160:163]
ds_read_b128 a[216:219],v252 offset:28160
v_lshlrev_b32 v231,16,v199
v_fmac_f32 v228,s43,v230
M v[164:167],v[216:219],a[220:223],v[164:167]
v_fmac_f32 v233,4.0,v229
v_fma_f32 v234,-4.0,v230,v232
M v[168:171],v[216:219],a[192:195],v[168:171]
v_fmac_f32 v228,s45,v232
v_fmac_f32 v233,s40,v231
v_sub_f32 v232,v232,v230
M v[172:175],v[216:219],a[196:199],v[172:175]
v_fma_f32 v230,-4.0,v229,v231
v_sub_f32 v231,v231,v229
M v[176:179],v[216:219],a[200:203],v[176:179]
v_add_f32 v229,v234,v230
v_sub_f32 v234,v234,v230
v_fma_f32 v230,2.0,v231,v232
M v[180:183],v[216:219],a[204:207],v[180:183]
v_fmac_f32 v232,-2.0,v231
v_and_b32 v237,s42,v197
M v[184:187],v[216:219],a[208:211],v[184:187]
v_and_b32 v235,s42,v193
v_and_b32 v236,s42,v195
v_and_b32 v240,s42,v203
M v[188:191],v[216:219],a[212:215],v[188:191]
s_waitcnt vmcnt(21)
buffer_load_dwordx4 v[216:219],v253,s[20:23],s46 offen offset:1024
M v[96:99],v[220:223],a[220:223],v[96:99]
v_and_b32 v239,s42,v201
v_and_b32 v238,s42,v199
v_fmac_f32 v235,s43,v237
v_fmac_f32 v240,4.0,v236
M v[100:103],v[220:223],a[192:195],v[100:103]
v_fma_f32 v231,-4.0,v237,v239
v_fmac_f32 v235,s45,v239
v_fmac_f32 v240,s40,v238
v_sub_f32 v239,v239,v237
M v[104:107],v[220:223],a[196:199],v[104:107]
v_fma_f32 v237,-4.0,v236,v238
v_sub_f32 v238,v238,v236
v_add_f32 v236,v231,v237
v_sub_f32 v231,v231,v237
M v[108:111],v[220:223],a[200:203],v[108:111]
v_fma_f32 v237,2.0,v238,v239
v_fmac_f32 v239,-2.0,v238
v_cvt_pk_bf16_f32 v193,v228,v235
v_cvt_pk_bf16_f32 v203,v233,v240
M v[112:115],v[220:223],a[204:207],v[112:115]
v_cvt_pk_bf16_f32 v195,v229,v236
v_cvt_pk_bf16_f32 v197,v234,v231
v_cvt_pk_bf16_f32 v199,v230,v237
v_cvt_pk_bf16_f32 v201,v232,v239
M v[116:119],v[220:223],a[208:211],v[116:119]
ds_write2st64_b64 v249,v[192:193],v[202:203] offset0:138 offset1:155
M v[120:123],v[220:223],a[212:215],v[120:123]
s_waitcnt lgkmcnt(1)
s_add_u32 s28,s30,6291456
buffer_load_dwordx2 v[192:193],v247,s[12:15],s28 offen offset:0
ds_write2st64_b64 v249,v[194:195],v[196:197] offset0:104 offset1:121
M v[124:127],v[220:223],a[216:219],v[124:127]
s_waitcnt vmcnt(22)
buffer_load_dwordx2 v[202:203],v247,s[16:19],s28 offen offset:1536
M v[128:131],v[224:227],a[220:223],v[128:131]
buffer_load_dwordx2 v[194:195],v247,s[8:11],s28 offen offset:0
ds_write2st64_b64 v249,v[198:199],v[200:201] offset0:36 offset1:53
M v[132:135],v[224:227],a[192:195],v[132:135]
buffer_load_dwordx2 v[196:197],v247,s[8:11],s28 offen offset:384
M v[136:139],v[224:227],a[196:199],v[136:139]
s_waitcnt vmcnt(20)
buffer_load_dwordx2 v[198:199],v247,s[8:11],s28 offen offset:768
v_lshlrev_b32 v230,16,v208
v_lshlrev_b32 v228,16,v204
v_lshlrev_b32 v229,16,v206
v_lshlrev_b32 v233,16,v214
M v[140:143],v[224:227],a[200:203],v[140:143]
s_waitcnt vmcnt(19)
buffer_load_dwordx2 v[200:201],v247,s[8:11],s28 offen offset:1152
v_lshlrev_b32 v232,16,v212
v_lshlrev_b32 v231,16,v210
v_fmac_f32 v228,s43,v230
v_fmac_f32 v233,4.0,v229
M v[144:147],v[224:227],a[204:207],v[144:147]
buffer_load_dwordx4 v[220:223],v253,s[20:23],s46 offen offset:2048
v_fma_f32 v234,-4.0,v230,v232
v_fmac_f32 v228,s45,v232
v_fmac_f32 v233,s40,v231
v_sub_f32 v232,v232,v230
M v[148:151],v[224:227],a[208:211],v[148:151]
s_add_u32 s46,s44,304128
v_fma_f32 v230,-4.0,v229,v231
v_sub_f32 v231,v231,v229
v_add_f32 v229,v234,v230
v_sub_f32 v234,v234,v230
M v[152:155],v[224:227],a[212:215],v[152:155]
v_fma_f32 v230,2.0,v231,v232
v_fmac_f32 v232,-2.0,v231
v_and_b32 v237,s42,v208
v_and_b32 v235,s42,v204
M v[156:159],v[224:227],a[216:219],v[156:159]
buffer_load_dwordx4 v[224:227],v253,s[20:23],s46 offen offset:0
v_and_b32 v236,s42,v206
v_and_b32 v240,s42,v214
v_and_b32 v239,s42,v212
v_and_b32 v238,s42,v210
M v[160:163],a[224:227],a[220:223],v[160:163]
ds_read_b128 a[220:223],v251 offset:28416
v_fmac_f32 v235,s43,v237
v_fmac_f32 v240,4.0,v236
v_fma_f32 v231,-4.0,v237,v239
v_fmac_f32 v235,s45,v239
M v[164:167],a[224:227],a[192:195],v[164:167]
v_fmac_f32 v240,s40,v238
v_sub_f32 v239,v239,v237
v_fma_f32 v237,-4.0,v236,v238
v_sub_f32 v238,v238,v236
M v[168:171],a[224:227],a[196:199],v[168:171]
v_add_f32 v236,v231,v237
v_sub_f32 v231,v231,v237
v_fma_f32 v237,2.0,v238,v239
v_fmac_f32 v239,-2.0,v238
M v[172:175],a[224:227],a[200:203],v[172:175]
v_cvt_pk_bf16_f32 v204,v228,v235
v_cvt_pk_bf16_f32 v214,v233,v240
v_cvt_pk_bf16_f32 v206,v229,v236
v_cvt_pk_bf16_f32 v208,v234,v231
M v[176:179],a[224:227],a[204:207],v[176:179]
v_cvt_pk_bf16_f32 v210,v230,v237
v_cvt_pk_bf16_f32 v212,v232,v239
v_lshlrev_b32 v230,16,v209
v_lshlrev_b32 v228,16,v205
M v[180:183],a[224:227],a[208:211],v[180:183]
v_lshlrev_b32 v229,16,v207
v_lshlrev_b32 v233,16,v215
v_lshlrev_b32 v232,16,v213
v_lshlrev_b32 v231,16,v211
M v[184:187],a[224:227],a[212:215],v[184:187]
v_fmac_f32 v228,s43,v230
v_fmac_f32 v233,4.0,v229
v_fma_f32 v234,-4.0,v230,v232
v_fmac_f32 v228,s45,v232
M v[188:191],a[224:227],a[216:219],v[188:191]
s_waitcnt vmcnt(21)
buffer_load_dwordx4 a[224:227],v253,s[20:23],s46 offen offset:1024
v_fmac_f32 v233,s40,v231
v_sub_f32 v232,v232,v230
v_fma_f32 v230,-4.0,v229,v231
v_sub_f32 v231,v231,v229
M v[96:99],a[228:231],a[192:195],v[96:99]
v_add_f32 v229,v234,v230
v_sub_f32 v234,v234,v230
v_fma_f32 v230,2.0,v231,v232
v_fmac_f32 v232,-2.0,v231
M v[100:103],a[228:231],a[196:199],v[100:103]
v_and_b32 v237,s42,v209
v_and_b32 v235,s42,v205
v_and_b32 v236,s42,v207
v_and_b32 v240,s42,v215
M v[104:107],a[228:231],a[200:203],v[104:107]
v_and_b32 v239,s42,v213
v_and_b32 v238,s42,v211
v_fmac_f32 v235,s43,v237
v_fmac_f32 v240,4.0,v236
M v[108:111],a[228:231],a[204:207],v[108:111]
v_fma_f32 v231,-4.0,v237,v239
v_fmac_f32 v235,s45,v239
v_fmac_f32 v240,s40,v238
v_sub_f32 v239,v239,v237
M v[112:115],a[228:231],a[208:211],v[112:115]
v_fma_f32 v237,-4.0,v236,v238
v_sub_f32 v238,v238,v236
v_add_f32 v236,v231,v237
v_sub_f32 v231,v231,v237
M v[116:119],a[228:231],a[212:215],v[116:119]
v_fma_f32 v237,2.0,v238,v239
v_fmac_f32 v239,-2.0,v238
v_cvt_pk_bf16_f32 v205,v228,v235
v_cvt_pk_bf16_f32 v215,v233,v240
M v[120:123],a[228:231],a[216:219],v[120:123]
s_waitcnt lgkmcnt(0)
v_cvt_pk_bf16_f32 v207,v229,v236
v_cvt_pk_bf16_f32 v209,v234,v231
v_cvt_pk_bf16_f32 v211,v230,v237
v_cvt_pk_bf16_f32 v213,v232,v239
M v[124:127],a[228:231],a[220:223],v[124:127]
s_waitcnt vmcnt(21)
buffer_load_dwordx4 a[228:231],v253,s[20:23],s46 offen offset:2048
ds_write2st64_b64 v249,v[204:205],v[214:215] offset0:139 offset1:156
M v[128:131],a[232:235],a[192:195],v[128:131]
s_add_u32 s28,s30,6684672
buffer_load_dwordx2 v[204:205],v247,s[12:15],s28 offen offset:0
M v[132:135],a[232:235],a[196:199],v[132:135]
s_add_u32 s46,s44,313344
buffer_load_dwordx2 v[214:215],v247,s[16:19],s28 offen offset:1536
ds_write2st64_b64 v249,v[206:207],v[208:209] offset0:105 offset1:122
M v[136:139],a[232:235],a[200:203],v[136:139]
buffer_load_dwordx2 v[206:207],v247,s[8:11],s28 offen offset:0
M v[140:143],a[232:235],a[204:207],v[140:143]
buffer_load_dwordx2 v[208:209],v247,s[8:11],s28 offen offset:384
ds_write2st64_b64 v249,v[210:211],v[212:213] offset0:37 offset1:54
M v[144:147],a[232:235],a[208:211],v[144:147]
buffer_load_dwordx2 v[210:211],v247,s[8:11],s28 offen offset:768
M v[148:151],a[232:235],a[212:215],v[148:151]
buffer_load_dwordx2 v[212:213],v247,s[8:11],s28 offen offset:1152
M v[152:155],a[232:235],a[216:219],v[152:155]
s_waitcnt lgkmcnt(0)
s_barrier
M v[156:159],a[232:235],a[220:223],v[156:159]
s_waitcnt vmcnt(27)
buffer_load_dwordx4 a[232:235],v253,s[20:23],s46 offen offset:0
M v[160:163],a[236:239],a[192:195],v[160:163]
ds_read_b128 a[192:195],v251 offset:34816
M v[164:167],a[236:239],a[196:199],v[164:167]
s_waitcnt vmcnt(13)
ds_read_b128 a[196:199],v252 offset:35072
v_lshlrev_b32 v230,16,v196
M v[168:171],a[236:239],a[200:203],v[168:171]
ds_read_b128 a[200:203],v252 offset:35328
v_lshlrev_b32 v228,16,v192
M v[172:175],a[236:239],a[204:207],v[172:175]
ds_read_b128 a[204:207],v252 offset:35584
v_lshlrev_b32 v229,16,v194
M v[176:179],a[236:239],a[208:211],v[176:179]
ds_read_b128 a[208:211],v252 offset:35840
v_lshlrev_b32 v233,16,v202
M v[180:183],a[236:239],a[212:215],v[180:183]
s_waitcnt vmcnt(11)
ds_read_b128 a[212:215],v252 offset:36096
v_lshlrev_b32 v232,16,v200
M v[184:187],a[236:239],a[216:219],v[184:187]
ds_read_b128 a[216:219],v252 offset:36352
v_lshlrev_b32 v231,16,v198
M v[188:191],a[236:239],a[220:223],v[188:191]
s_waitcnt lgkmcnt(6)
buffer_load_dwordx4 a[236:239],v253,s[20:23],s46 offen offset:1024
M a[0:3],a[240:243],a[192:195],a[0:3]
s_waitcnt lgkmcnt(5)
ds_read_b128 a[220:223],v252 offset:36608
ds_read_b128 a[192:195],v252 offset:36864
M a[4:7],a[240:243],a[196:199],a[4:7]
s_waitcnt lgkmcnt(6)
v_fmac_f32 v228,s43,v230
v_fmac_f32 v233,4.0,v229
M a[8:11],a[240:243],a[200:203],a[8:11]
s_waitcnt lgkmcnt(5)
v_fma_f32 v234,-4.0,v230,v232
v_fmac_f32 v228,s45,v232
M a[12:15],a[240:243],a[204:207],a[12:15]
s_waitcnt lgkmcnt(4)
v_fmac_f32 v233,s40,v231
v_sub_f32 v232,v232,v230
M a[16:19],a[240:243],a[208:211],a[16:19]
s_waitcnt lgkmcnt(3)
v_fma_f32 v230,-4.0,v229,v231
v_sub_f32 v231,v231,v229
M a[20:23],a[240:243],a[212:215],a[20:23]
s_waitcnt lgkmcnt(2)
v_add_f32 v229,v234,v230
v_sub_f32 v234,v234,v230
M a[24:27],a[240:243],a[216:219],a[24:27]
s_waitcnt lgkmcnt(1)
v_fma_f32 v230,2.0,v231,v232
v_fmac_f32 v232,-2.0,v231
M a[28:31],a[240:243],a[220:223],a[28:31]
buffer_load_dwordx4 a[240:243],v253,s[20:23],s46 offen offset:2048
M a[0:3],a[244:247],a[196:199],a[0:3]
ds_read_b128 a[196:199],v251 offset:37120
v_and_b32 v237,s42,v196
M a[4:7],a[244:247],a[200:203],a[4:7]
s_add_u32 s47,s44,288768
v_and_b32 v235,s42,v192
v_and_b32 v236,s42,v194
M a[8:11],a[244:247],a[204:207],a[8:11]
v_and_b32 v240,s42,v202
v_and_b32 v239,s42,v200
M a[12:15],a[244:247],a[208:211],a[12:15]
v_and_b32 v238,s42,v198
v_fmac_f32 v235,s43,v237
M a[16:19],a[244:247],a[212:215],a[16:19]
v_fmac_f32 v240,4.0,v236
v_fma_f32 v231,-4.0,v237,v239
M a[20:23],a[244:247],a[216:219],a[20:23]
v_fmac_f32 v235,s45,v239
v_fmac_f32 v240,s40,v238
M a[24:27],a[244:247],a[220:223],a[24:27]
s_waitcnt lgkmcnt(1)
v_sub_f32 v239,v239,v237
v_fma_f32 v237,-4.0,v236,v238
M a[28:31],a[244:247],a[192:195],a[28:31]
buffer_load_dwordx4 a[244:247],v253,s[20:23],s47 offen offset:0
M a[0:3],a[248:251],a[200:203],a[0:3]
ds_read_b128 a[200:203],v251 offset:43520
v_sub_f32 v238,v238,v236
M a[4:7],a[248:251],a[204:207],a[4:7]
s_add_u32 s48,s44,291840
ds_read_b128 a[204:207],v252 offset:43776
v_add_f32 v236,v231,v237
M a[8:11],a[248:251],a[208:211],a[8:11]
ds_read_b128 a[208:211],v252 offset:44032
v_sub_f32 v231,v231,v237
M a[12:15],a[248:251],a[212:215],a[12:15]
ds_read_b128 a[212:215],v252 offset:44288
v_fma_f32 v237,2.0,v238,v239
M a[16:19],a[248:251],a[216:219],a[16:19]
ds_read_b128 a[216:219],v252 offset:44544
v_fmac_f32 v239,-2.0,v238
M a[20:23],a[248:251],a[220:223],a[20:23]
ds_read_b128 a[220:223],v252 offset:44800
v_cvt_pk_bf16_f32 v192,v228,v235
M a[24:27],a[248:251],a[192:195],a[24:27]
s_waitcnt lgkmcnt(6)
ds_read_b128 a[192:195],v252 offset:45056
v_cvt_pk_bf16_f32 v202,v233,v240
M a[28:31],a[248:251],a[196:199],a[28:31]
s_waitcnt lgkmcnt(6)
buffer_load_dwordx4 a[248:251],v253,s[20:23],s48 offen offset:0
M a[96:99],a[252:255],a[200:203],a[96:99]
s_waitcnt lgkmcnt(5)
ds_read_b128 a[196:199],v252 offset:45312
ds_read_b128 a[200:203],v252 offset:45568
M a[100:103],a[252:255],a[204:207],a[100:103]
s_waitcnt lgkmcnt(6)
v_cvt_pk_bf16_f32 v194,v229,v236
v_cvt_pk_bf16_f32 v196,v234,v231
M a[104:107],a[252:255],a[208:211],a[104:107]
s_waitcnt lgkmcnt(5)
v_cvt_pk_bf16_f32 v198,v230,v237
v_cvt_pk_bf16_f32 v200,v232,v239
M a[108:111],a[252:255],a[212:215],a[108:111]
s_waitcnt lgkmcnt(4)
v_lshlrev_b32 v230,16,v197
v_lshlrev_b32 v228,16,v193
M a[112:115],a[252:255],a[216:219],a[112:115]
s_waitcnt lgkmcnt(3)
v_lshlrev_b32 v229,16,v195
v_lshlrev_b32 v233,16,v203
M a[116:119],a[252:255],a[220:223],a[116:119]
s_waitcnt lgkmcnt(2)
v_lshlrev_b32 v232,16,v201
v_lshlrev_b32 v231,16,v199
M a[120:123],a[252:255],a[192:195],a[120:123]
s_waitcnt lgkmcnt(1)
v_fmac_f32 v228,s43,v230
v_fmac_f32 v233,4.0,v229
M a[124:127],a[252:255],a[196:199],a[124:127]
buffer_load_dwordx4 a[252:255],v253,s[20:23],s47 offen offset:1024
M a[96:99],v[216:219],a[204:207],a[96:99]
ds_read_b128 a[204:207],v251 offset:45824
v_fma_f32 v234,-4.0,v230,v232
M a[100:103],v[216:219],a[208:211],a[100:103]
v_fmac_f32 v228,s45,v232
v_fmac_f32 v233,s40,v231
M a[104:107],v[216:219],a[212:215],a[104:107]
v_sub_f32 v232,v232,v230
v_fma_f32 v230,-4.0,v229,v231
M a[108:111],v[216:219],a[216:219],a[108:111]
v_sub_f32 v231,v231,v229
v_add_f32 v229,v234,v230
M a[112:115],v[216:219],a[220:223],a[112:115]
v_sub_f32 v234,v234,v230
v_fma_f32 v230,2.0,v231,v232
M a[116:119],v[216:219],a[192:195],a[116:119]
v_fmac_f32 v232,-2.0,v231
v_and_b32 v237,s42,v197
M a[120:123],v[216:219],a[196:199],a[120:123]
s_waitcnt lgkmcnt(1)
v_and_b32 v235,s42,v193
v_and_b32 v236,s42,v195
M a[124:127],v[216:219],a[200:203],a[124:127]
s_waitcnt vmcnt(15)
buffer_load_dwordx4 v[216:219],v253,s[20:23],s48 offen offset:1024
M a[96:99],v[220:223],a[208:211],a[96:99]
ds_read_b128 a[208:211],v251 offset:0
v_and_b32 v240,s42,v203
M a[100:103],v[220:223],a[212:215],a[100:103]
ds_read_b128 a[212:215],v252 offset:256
v_and_b32 v239,s42,v201
M a[104:107],v[220:223],a[216:219],a[104:107]
ds_read_b128 a[216:219],v252 offset:512
v_and_b32 v238,s42,v199
M a[108:111],v[220:223],a[220:223],a[108:111]
ds_read_b128 a[220:223],v252 offset:768
v_fmac_f32 v235,s43,v237
M a[112:115],v[220:223],a[192:195],a[112:115]
ds_read_b128 a[192:195],v252 offset:1024
v_fmac_f32 v240,4.0,v236
M a[116:119],v[220:223],a[196:199],a[116:119]
ds_read_b128 a[196:199],v252 offset:1280
v_fma_f32 v231,-4.0,v237,v239
M a[120:123],v[220:223],a[200:203],a[120:123]
s_waitcnt lgkmcnt(6)
ds_read_b128 a[200:203],v252 offset:1536
v_fmac_f32 v235,s45,v239
M a[124:127],v[220:223],a[204:207],a[124:127]
s_waitcnt vmcnt(15) lgkmcnt(6)
buffer_load_dwordx4 v[220:223],v253,s[20:23],s47 offen offset:2048
M v[0:3],v[224:227],a[208:211],v[0:3]
s_waitcnt lgkmcnt(5)
ds_read_b128 a[204:207],v252 offset:1792
ds_read_b128 a[208:211],v252 offset:2048
M v[4:7],v[224:227],a[212:215],v[4:7]
s_waitcnt lgkmcnt(6)
v_fmac_f32 v240,s40,v238
v_sub_f32 v239,v239,v237
M v[8:11],v[224:227],a[216:219],v[8:11]
s_waitcnt lgkmcnt(5)
v_fma_f32 v237,-4.0,v236,v238
v_sub_f32 v238,v238,v236
M v[12:15],v[224:227],a[220:223],v[12:15]
s_waitcnt lgkmcnt(4)
v_add_f32 v236,v231,v237
v_sub_f32 v231,v231,v237
M v[16:19],v[224:227],a[192:195],v[16:19]
s_waitcnt lgkmcnt(3)
v_fma_f32 v237,2.0,v238,v239
v_fmac_f32 v239,-2.0,v238
M v[20:23],v[224:227],a[196:199],v[20:23]
s_waitcnt lgkmcnt(2)
v_cvt_pk_bf16_f32 v193,v228,v235
v_cvt_pk_bf16_f32 v203,v233,v240
M v[24:27],v[224:227],a[200:203],v[24:27]
s_waitcnt lgkmcnt(1)
v_cvt_pk_bf16_f32 v195,v229,v236
v_cvt_pk_bf16_f32 v197,v234,v231
M v[28:31],v[224:227],a[204:207],v[28:31]
s_waitcnt vmcnt(15)
buffer_load_dwordx4 v[224:227],v253,s[20:23],s48 offen offset:2048
M v[0:3],a[224:227],a[212:215],v[0:3]
ds_read_b128 a[212:215],v251 offset:2304
v_cvt_pk_bf16_f32 v199,v230,v237
M v[4:7],a[224:227],a[216:219],v[4:7]
s_add_u32 s47,s44,297984
v_cvt_pk_bf16_f32 v201,v232,v239
M v[8:11],a[224:227],a[220:223],v[8:11]
M v[12:15],a[224:227],a[192:195],v[12:15]
M v[16:19],a[224:227],a[196:199],v[16:19]
M v[20:23],a[224:227],a[200:203],v[20:23]
M v[24:27],a[224:227],a[204:207],v[24:27]
s_waitcnt lgkmcnt(1)
M v[28:31],a[224:227],a[208:211],v[28:31]
s_waitcnt vmcnt(15)
buffer_load_dwordx4 a[224:227],v253,s[20:23],s47 offen offset:0
M v[0:3],a[228:231],a[216:219],v[0:3]
ds_read_b128 a[216:219],v251 offset:8704
M v[4:7],a[228:231],a[220:223],v[4:7]
s_add_u32 s48,s44,301056
ds_read_b128 a[220:223],v252 offset:8960
M v[8:11],a[228:231],a[192:195],v[8:11]
ds_read_b128 a[192:195],v252 offset:9216
M v[12:15],a[228:231],a[196:199],v[12:15]
ds_read_b128 a[196:199],v252 offset:9472
M v[16:19],a[228:231],a[200:203],v[16:19]
ds_read_b128 a[200:203],v252 offset:9728
M v[20:23],a[228:231],a[204:207],v[20:23]
ds_read_b128 a[204:207],v252 offset:9984
M v[24:27],a[228:231],a[208:211],v[24:27]
s_waitcnt lgkmcnt(6)
ds_read_b128 a[208:211],v252 offset:10240
M v[28:31],a[228:231],a[212:215],v[28:31]
s_waitcnt vmcnt(9) lgkmcnt(6)
buffer_load_dwordx4 a[228:231],v253,s[20:23],s48 offen offset:0
M v[96:99],a[232:235],a[216:219],v[96:99]
s_waitcnt lgkmcnt(5)
ds_read_b128 a[212:215],v252 offset:10496
ds_read_b128 a[216:219],v252 offset:10752
M v[100:103],a[232:235],a[220:223],v[100:103]
s_waitcnt lgkmcnt(6)
M v[104:107],a[232:235],a[192:195],v[104:107]
s_waitcnt lgkmcnt(5)
M v[108:111],a[232:235],a[196:199],v[108:111]
s_waitcnt lgkmcnt(4)
M v[112:115],a[232:235],a[200:203],v[112:115]
s_waitcnt lgkmcnt(3)
M v[116:119],a[232:235],a[204:207],v[116:119]
s_waitcnt lgkmcnt(2)
M v[120:123],a[232:235],a[208:211],v[120:123]
s_waitcnt lgkmcnt(1)
M v[124:127],a[232:235],a[212:215],v[124:127]
s_waitcnt vmcnt(9)
buffer_load_dwordx4 a[232:235],v253,s[20:23],s47 offen offset:1024
M v[96:99],a[236:239],a[220:223],v[96:99]
ds_read_b128 a[220:223],v251 offset:11008
M v[100:103],a[236:239],a[192:195],v[100:103]
M v[104:107],a[236:239],a[196:199],v[104:107]
M v[108:111],a[236:239],a[200:203],v[108:111]
M v[112:115],a[236:239],a[204:207],v[112:115]
M v[116:119],a[236:239],a[208:211],v[116:119]
M v[120:123],a[236:239],a[212:215],v[120:123]
s_waitcnt lgkmcnt(1)
M v[124:127],a[236:239],a[216:219],v[124:127]
s_waitcnt vmcnt(9)
buffer_load_dwordx4 a[236:239],v253,s[20:23],s48 offen offset:1024
M v[96:99],a[240:243],a[192:195],v[96:99]
ds_read_b128 a[192:195],v251 offset:34816
M v[100:103],a[240:243],a[196:199],v[100:103]
ds_read_b128 a[196:199],v252 offset:35072
M v[104:107],a[240:243],a[200:203],v[104:107]
ds_read_b128 a[200:203],v252 offset:35328
M v[108:111],a[240:243],a[204:207],v[108:111]
ds_read_b128 a[204:207],v252 offset:35584
v_accvgpr_read_b32 v240,a0
M v[112:115],a[240:243],a[208:211],v[112:115]
ds_read_b128 a[208:211],v252 offset:35840
v_accvgpr_read_b32 v238,a96
M v[116:119],a[240:243],a[212:215],v[116:119]
ds_read_b128 a[212:215],v252 offset:36096
v_add_f32 v236,v240,v238
M v[120:123],a[240:243],a[216:219],v[120:123]
s_waitcnt lgkmcnt(6)
ds_read_b128 a[216:219],v252 offset:36352
v_sub_f32 v240,v240,v238
M v[124:127],a[240:243],a[220:223],v[124:127]
s_waitcnt vmcnt(9) lgkmcnt(6)
buffer_load_dwordx4 a[240:243],v253,s[20:23],s47 offen offset:2048
M a[32:35],a[244:247],a[192:195],a[32:35]
s_waitcnt lgkmcnt(5)
ds_read_b128 a[220:223],v252 offset:36608
v_add_f32 v238,v0,v96
M a[36:39],a[244:247],a[196:199],a[36:39]
s_waitcnt lgkmcnt(5)
v_sub_f32 v96,v0,v96
v_add_f32 v0,v236,v238
M a[40:43],a[244:247],a[200:203],a[40:43]
s_waitcnt lgkmcnt(4)
v_fmac_f32 v236,4.0,v238
v_fma_f32 v238,2.0,v96,v240
M a[44:47],a[244:247],a[204:207],a[44:47]
s_waitcnt lgkmcnt(3)
v_fma_f32 v96,s41,v96,v240
v_accvgpr_read_b32 v240,a1
M a[48:51],a[244:247],a[208:211],a[48:51]
s_waitcnt lgkmcnt(2)
v_accvgpr_read_b32 v239,a97
v_add_f32 v237,v240,v239
M a[52:55],a[244:247],a[212:215],a[52:55]
s_waitcnt lgkmcnt(1)
v_sub_f32 v240,v240,v239
v_add_f32 v239,v1,v97
M a[56:59],a[244:247],a[216:219],a[56:59]
s_waitcnt lgkmcnt(0)
v_sub_f32 v97,v1,v97
v_add_f32 v1,v237,v239
M a[60:63],a[244:247],a[220:223],a[60:63]
s_waitcnt vmcnt(9)
buffer_load_dwordx4 a[244:247],v253,s[20:23],s48 offen offset:2048
M a[64:67],a[248:251],a[192:195],a[64:67]
ds_read_b128 a[192:195],v252 offset:36864
v_fmac_f32 v237,4.0,v239
M a[68:71],a[248:251],a[196:199],a[68:71]
s_add_u32 s47,s44,307200
v_fma_f32 v239,2.0,v97,v240
v_fma_f32 v97,s41,v97,v240
M a[72:75],a[248:251],a[200:203],a[72:75]
v_cvt_pk_bf16_f32 v238,v238,v239
v_accvgpr_write_b32 a0,v238
M a[76:79],a[248:251],a[204:207],a[76:79]
v_cvt_pk_bf16_f32 v236,v236,v237
v_accvgpr_write_b32 a96,v236
M a[80:83],a[248:251],a[208:211],a[80:83]
v_accvgpr_read_b32 v240,a2
v_accvgpr_read_b32 v238,a98
M a[84:87],a[248:251],a[212:215],a[84:87]
v_add_f32 v236,v240,v238
v_sub_f32 v240,v240,v238
M a[88:91],a[248:251],a[216:219],a[88:91]
v_add_f32 v238,v2,v98
v_sub_f32 v98,v2,v98
M a[92:95],a[248:251],a[220:223],a[92:95]
s_waitcnt vmcnt(9)
buffer_load_dwordx4 a[248:251],v253,s[20:23],s47 offen offset:0
M a[32:35],a[252:255],a[196:199],a[32:35]
v_add_f32 v2,v236,v238
v_fmac_f32 v236,4.0,v238
M a[36:39],a[252:255],a[200:203],a[36:39]
s_add_u32 s48,s44,310272
v_fma_f32 v238,2.0,v98,v240
v_fma_f32 v98,s41,v98,v240
M a[40:43],a[252:255],a[204:207],a[40:43]
v_accvgpr_read_b32 v240,a3
v_accvgpr_read_b32 v239,a99
M a[44:47],a[252:255],a[208:211],a[44:47]
v_add_f32 v237,v240,v239
v_sub_f32 v240,v240,v239
M a[48:51],a[252:255],a[212:215],a[48:51]
v_add_f32 v239,v3,v99
v_sub_f32 v99,v3,v99
M a[52:55],a[252:255],a[216:219],a[52:55]
v_add_f32 v3,v237,v239
v_fmac_f32 v237,4.0,v239
M a[56:59],a[252:255],a[220:223],a[56:59]
s_waitcnt lgkmcnt(0)
v_fma_f32 v239,2.0,v99,v240
v_fma_f32 v99,s41,v99,v240
M a[60:63],a[252:255],a[192:195],a[60:63]
s_waitcnt vmcnt(9)
buffer_load_dwordx4 a[252:255],v253,s[20:23],s48 offen offset:0
M a[64:67],v[216:219],a[196:199],a[64:67]
ds_read_b128 a[196:199],v251 offset:37120
v_cvt_pk_bf16_f32 v238,v238,v239
M a[68:71],v[216:219],a[200:203],a[68:71]
v_accvgpr_write_b32 a1,v238
v_cvt_pk_bf16_f32 v236,v236,v237
M a[72:75],v[216:219],a[204:207],a[72:75]
v_accvgpr_write_b32 a97,v236
v_accvgpr_read_b32 v240,a4
M a[76:79],v[216:219],a[208:211],a[76:79]
v_accvgpr_read_b32 v238,a100
v_add_f32 v236,v240,v238
M a[80:83],v[216:219],a[212:215],a[80:83]
v_sub_f32 v240,v240,v238
v_add_f32 v238,v4,v100
M a[84:87],v[216:219],a[216:219],a[84:87]
v_sub_f32 v100,v4,v100
v_add_f32 v4,v236,v238
M a[88:91],v[216:219],a[220:223],a[88:91]
v_fmac_f32 v236,4.0,v238
v_fma_f32 v238,2.0,v100,v240
M a[92:95],v[216:219],a[192:195],a[92:95]
s_waitcnt vmcnt(9)
buffer_load_dwordx4 v[216:219],v253,s[20:23],s47 offen offset:1024
M a[32:35],v[220:223],a[200:203],a[32:35]
v_fma_f32 v100,s41,v100,v240
v_accvgpr_read_b32 v240,a5
M a[36:39],v[220:223],a[204:207],a[36:39]
v_accvgpr_read_b32 v239,a101
v_add_f32 v237,v240,v239
M a[40:43],v[220:223],a[208:211],a[40:43]
v_sub_f32 v240,v240,v239
v_add_f32 v239,v5,v101
M a[44:47],v[220:223],a[212:215],a[44:47]
v_sub_f32 v101,v5,v101
v_add_f32 v5,v237,v239
M a[48:51],v[220:223],a[216:219],a[48:51]
v_fmac_f32 v237,4.0,v239
v_fma_f32 v239,2.0,v101,v240
M a[52:55],v[220:223],a[220:223],a[52:55]
v_fma_f32 v101,s41,v101,v240
v_cvt_pk_bf16_f32 v238,v238,v239
M a[56:59],v[220:223],a[192:195],a[56:59]
s_waitcnt lgkmcnt(0)
v_accvgpr_write_b32 a4,v238
v_cvt_pk_bf16_f32 v236,v236,v237
M a[60:63],v[220:223],a[196:199],a[60:63]
s_waitcnt vmcnt(9)
buffer_load_dwordx4 v[220:223],v253,s[20:23],s48 offen offset:1024
M a[64:67],v[224:227],a[200:203],a[64:67]
ds_read_b128 a[200:203],v251 offset:43520
v_accvgpr_write_b32 a100,v236
M a[68:71],v[224:227],a[204:207],a[68:71]
ds_read_b128 a[204:207],v252 offset:43776
v_accvgpr_read_b32 v240,a6
M a[72:75],v[224:227],a[208:211],a[72:75]
ds_read_b128 a[208:211],v252 offset:44032
v_accvgpr_read_b32 v238,a102
M a[76:79],v[224:227],a[212:215],a[76:79]
ds_read_b128 a[212:215],v252 offset:44288
v_add_f32 v236,v240,v238
M a[80:83],v[224:227],a[216:219],a[80:83]
ds_read_b128 a[216:219],v252 offset:44544
v_sub_f32 v240,v240,v238
M a[84:87],v[224:227],a[220:223],a[84:87]
ds_read_b128 a[220:223],v252 offset:44800
v_add_f32 v238,v6,v102
M a[88:91],v[224:227],a[192:195],a[88:91]
ds_read_b128 a[192:195],v252 offset:45056
v_sub_f32 v102,v6,v102
M a[92:95],v[224:227],a[196:199],a[92:95]
s_waitcnt vmcnt(9) lgkmcnt(6)
buffer_load_dwordx4 v[224:227],v253,s[20:23],s47 offen offset:2048
M a[128:131],a[224:227],a[200:203],a[128:131]
s_waitcnt lgkmcnt(5)
ds_read_b128 a[196:199],v252 offset:45312
v_add_f32 v6,v236,v238
M a[132:135],a[224:227],a[204:207],a[132:135]
s_waitcnt lgkmcnt(5)
v_fmac_f32 v236,4.0,v238
v_fma_f32 v238,2.0,v102,v240
M a[136:139],a[224:227],a[208:211],a[136:139]
s_waitcnt lgkmcnt(4)
v_fma_f32 v102,s41,v102,v240
v_accvgpr_read_b32 v240,a7
M a[140:143],a[224:227],a[212:215],a[140:143]
s_waitcnt lgkmcnt(3)
v_accvgpr_read_b32 v239,a103
v_add_f32 v237,v240,v239
M a[144:147],a[224:227],a[216:219],a[144:147]
s_waitcnt lgkmcnt(2)
v_sub_f32 v240,v240,v239
v_add_f32 v239,v7,v103
M a[148:151],a[224:227],a[220:223],a[148:151]
s_waitcnt lgkmcnt(1)
v_sub_f32 v103,v7,v103
v_add_f32 v7,v237,v239
M a[152:155],a[224:227],a[192:195],a[152:155]
s_waitcnt lgkmcnt(0)
v_fmac_f32 v237,4.0,v239
v_fma_f32 v239,2.0,v103,v240
M a[156:159],a[224:227],a[196:199],a[156:159]
s_waitcnt vmcnt(9)
buffer_load_dwordx4 a[224:227],v253,s[20:23],s48 offen offset:2048
M a[160:163],a[228:231],a[200:203],a[160:163]
ds_read_b128 a[200:203],v252 offset:45568
v_fma_f32 v103,s41,v103,v240
M a[164:167],a[228:231],a[204:207],a[164:167]
s_add_u32 s47,s44,316416
v_cvt_pk_bf16_f32 v238,v238,v239
v_accvgpr_write_b32 a5,v238
M a[168:171],a[228:231],a[208:211],a[168:171]
v_cvt_pk_bf16_f32 v236,v236,v237
v_accvgpr_write_b32 a101,v236
M a[172:175],a[228:231],a[212:215],a[172:175]
v_accvgpr_read_b32 v240,a8
v_accvgpr_read_b32 v238,a104
M a[176:179],a[228:231],a[216:219],a[176:179]
v_add_f32 v236,v240,v238
v_sub_f32 v240,v240,v238
M a[180:183],a[228:231],a[220:223],a[180:183]
v_add_f32 v238,v8,v104
v_sub_f32 v104,v8,v104
M a[184:187],a[228:231],a[192:195],a[184:187]
v_add_f32 v8,v236,v238
v_fmac_f32 v236,4.0,v238
M a[188:191],a[228:231],a[196:199],a[188:191]
s_waitcnt vmcnt(9)
buffer_load_dwordx4 a[228:231],v253,s[20:23],s47 offen offset:0
M a[128:131],a[232:235],a[204:207],a[128:131]
v_fma_f32 v238,2.0,v104,v240
v_fma_f32 v104,s41,v104,v240
M a[132:135],a[232:235],a[208:211],a[132:135]
s_add_u32 s48,s44,319488
v_accvgpr_read_b32 v240,a9
v_accvgpr_read_b32 v239,a105
M a[136:139],a[232:235],a[212:215],a[136:139]
v_add_f32 v237,v240,v239
v_sub_f32 v240,v240,v239
M a[140:143],a[232:235],a[216:219],a[140:143]
v_add_f32 v239,v9,v105
v_sub_f32 v105,v9,v105
M a[144:147],a[232:235],a[220:223],a[144:147]
v_add_f32 v9,v237,v239
v_fmac_f32 v237,4.0,v239
M a[148:151],a[232:235],a[192:195],a[148:151]
v_fma_f32 v239,2.0,v105,v240
v_fma_f32 v105,s41,v105,v240
M a[152:155],a[232:235],a[196:199],a[152:155]
s_waitcnt lgkmcnt(0)
v_cvt_pk_bf16_f32 v238,v238,v239
v_accvgpr_write_b32 a8,v238
M a[156:159],a[232:235],a[200:203],a[156:159]
s_waitcnt vmcnt(9)
buffer_load_dwordx4 a[232:235],v253,s[20:23],s48 offen offset:0
M a[160:163],a[236:239],a[204:207],a[160:163]
ds_read_b128 a[204:207],v251 offset:45824
v_cvt_pk_bf16_f32 v236,v236,v237
M a[164:167],a[236:239],a[208:211],a[164:167]
v_accvgpr_write_b32 a104,v236
v_accvgpr_read_b32 v240,a10
M a[168:171],a[236:239],a[212:215],a[168:171]
v_accvgpr_read_b32 v238,a106
v_add_f32 v236,v240,v238
M a[172:175],a[236:239],a[216:219],a[172:175]
v_sub_f32 v240,v240,v238
v_add_f32 v238,v10,v106
M a[176:179],a[236:239],a[220:223],a[176:179]
v_sub_f32 v106,v10,v106
v_add_f32 v10,v236,v238
M a[180:183],a[236:239],a[192:195],a[180:183]
v_fmac_f32 v236,4.0,v238
v_fma_f32 v238,2.0,v106,v240
M a[184:187],a[236:239],a[196:199],a[184:187]
v_fma_f32 v106,s41,v106,v240
v_accvgpr_read_b32 v240,a11
M a[188:191],a[236:239],a[200:203],a[188:191]
s_waitcnt vmcnt(9)
buffer_load_dwordx4 a[236:239],v253,s[20:23],s47 offen offset:1024
M a[128:131],a[240:243],a[208:211],a[128:131]
v_accvgpr_read_b32 v239,a107
v_add_f32 v237,v240,v239
M a[132:135],a[240:243],a[212:215],a[132:135]
v_sub_f32 v240,v240,v239
v_add_f32 v239,v11,v107
M a[136:139],a[240:243],a[216:219],a[136:139]
v_sub_f32 v107,v11,v107
v_add_f32 v11,v237,v239
M a[140:143],a[240:243],a[220:223],a[140:143]
v_fmac_f32 v237,4.0,v239
v_fma_f32 v239,2.0,v107,v240
M a[144:147],a[240:243],a[192:195],a[144:147]
v_fma_f32 v107,s41,v107,v240
v_cvt_pk_bf16_f32 v238,v238,v239
M a[148:151],a[240:243],a[196:199],a[148:151]
v_accvgpr_write_b32 a9,v238
v_cvt_pk_bf16_f32 v236,v236,v237
M a[152:155],a[240:243],a[200:203],a[152:155]
s_waitcnt lgkmcnt(0)
v_accvgpr_write_b32 a105,v236
v_accvgpr_read_b32 v240,a12
M a[156:159],a[240:243],a[204:207],a[156:159]
s_waitcnt vmcnt(9)
buffer_load_dwordx4 a[240:243],v253,s[20:23],s48 offen offset:1024
M a[160:163],a[244:247],a[208:211],a[160:163]
ds_read_b128 a[208:211],v251 offset:0
v_accvgpr_read_b32 v238,a108
M a[164:167],a[244:247],a[212:215],a[164:167]
ds_read_b128 a[212:215],v252 offset:256
v_add_f32 v236,v240,v238
M a[168:171],a[244:247],a[216:219],a[168:171]
ds_read_b128 a[216:219],v252 offset:512
v_sub_f32 v240,v240,v238
M a[172:175],a[244:247],a[220:223],a[172:175]
ds_read_b128 a[220:223],v252 offset:768
v_add_f32 v238,v12,v108
M a[176:179],a[244:247],a[192:195],a[176:179]
ds_read_b128 a[192:195],v252 offset:1024
v_sub_f32 v108,v12,v108
M a[180:183],a[244:247],a[196:199],a[180:183]
ds_read_b128 a[196:199],v252 offset:1280
v_add_f32 v12,v236,v238
M a[184:187],a[244:247],a[200:203],a[184:187]
ds_read_b128 a[200:203],v252 offset:1536
v_fmac_f32 v236,4.0,v238
M a[188:191],a[244:247],a[204:207],a[188:191]
s_waitcnt vmcnt(9) lgkmcnt(6)
buffer_load_dwordx4 a[244:247],v253,s[20:23],s47 offen offset:2048
M v[32:35],a[248:251],a[208:211],v[32:35]
s_waitcnt lgkmcnt(5)
ds_read_b128 a[204:207],v252 offset:1792
v_fma_f32 v238,2.0,v108,v240
M v[36:39],a[248:251],a[212:215],v[36:39]
s_waitcnt lgkmcnt(5)
v_fma_f32 v108,s41,v108,v240
v_accvgpr_read_b32 v240,a13
M v[40:43],a[248:251],a[216:219],v[40:43]
s_waitcnt lgkmcnt(4)
v_accvgpr_read_b32 v239,a109
v_add_f32 v237,v240,v239
M v[44:47],a[248:251],a[220:223],v[44:47]
s_waitcnt lgkmcnt(3)
v_sub_f32 v240,v240,v239
v_add_f32 v239,v13,v109
M v[48:51],a[248:251],a[192:195],v[48:51]
s_waitcnt lgkmcnt(2)
v_sub_f32 v109,v13,v109
v_add_f32 v13,v237,v239
M v[52:55],a[248:251],a[196:199],v[52:55]
s_waitcnt lgkmcnt(1)
v_fmac_f32 v237,4.0,v239
v_fma_f32 v239,2.0,v109,v240
M v[56:59],a[248:251],a[200:203],v[56:59]
s_waitcnt lgkmcnt(0)
v_fma_f32 v109,s41,v109,v240
v_cvt_pk_bf16_f32 v238,v238,v239
M v[60:63],a[248:251],a[204:207],v[60:63]
s_waitcnt vmcnt(9)
buffer_load_dwordx4 a[248:251],v253,s[20:23],s48 offen offset:2048
M v[64:67],a[252:255],a[208:211],v[64:67]
ds_read_b128 a[208:211],v252 offset:2048
v_accvgpr_write_b32 a12,v238
M v[68:71],a[252:255],a[212:215],v[68:71]
s_add_u32 s46,s44,0
v_cvt_pk_bf16_f32 v236,v236,v237
v_accvgpr_write_b32 a108,v236
M v[72:75],a[252:255],a[216:219],v[72:75]
v_accvgpr_read_b32 v240,a14
v_accvgpr_read_b32 v238,a110
M v[76:79],a[252:255],a[220:223],v[76:79]
v_add_f32 v236,v240,v238
v_sub_f32 v240,v240,v238
M v[80:83],a[252:255],a[192:195],v[80:83]
v_add_f32 v238,v14,v110
v_sub_f32 v110,v14,v110
M v[84:87],a[252:255],a[196:199],v[84:87]
v_add_f32 v14,v236,v238
v_fmac_f32 v236,4.0,v238
M v[88:91],a[252:255],a[200:203],v[88:91]
v_fma_f32 v238,2.0,v110,v240
v_fma_f32 v110,s41,v110,v240
M v[92:95],a[252:255],a[204:207],v[92:95]
s_waitcnt vmcnt(9)
buffer_load_dwordx4 a[252:255],v253,s[20:23],s46 offen offset:0
M v[32:35],v[216:219],a[212:215],v[32:35]
v_accvgpr_read_b32 v240,a15
v_accvgpr_read_b32 v239,a111
M v[36:39],v[216:219],a[216:219],v[36:39]
v_add_f32 v237,v240,v239
v_sub_f32 v240,v240,v239
M v[40:43],v[216:219],a[220:223],v[40:43]
v_add_f32 v239,v15,v111
v_sub_f32 v111,v15,v111
M v[44:47],v[216:219],a[192:195],v[44:47]
v_add_f32 v15,v237,v239
v_fmac_f32 v237,4.0,v239
M v[48:51],v[216:219],a[196:199],v[48:51]
v_fma_f32 v239,2.0,v111,v240
v_fma_f32 v111,s41,v111,v240
M v[52:55],v[216:219],a[200:203],v[52:55]
v_cvt_pk_bf16_f32 v238,v238,v239
v_accvgpr_write_b32 a13,v238
M v[56:59],v[216:219],a[204:207],v[56:59]
s_waitcnt lgkmcnt(0)
v_cvt_pk_bf16_f32 v236,v236,v237
v_accvgpr_write_b32 a109,v236
M v[60:63],v[216:219],a[208:211],v[60:63]
s_waitcnt vmcnt(9)
buffer_load_dwordx4 v[216:219],v253,s[20:23],s46 offen offset:1024
M v[64:67],v[220:223],a[212:215],v[64:67]
ds_read_b128 a[212:215],v251 offset:2304
v_accvgpr_read_b32 v240,a16
M v[68:71],v[220:223],a[216:219],v[68:71]
v_accvgpr_read_b32 v238,a112
v_add_f32 v236,v240,v238
M v[72:75],v[220:223],a[220:223],v[72:75]
v_sub_f32 v240,v240,v238
v_add_f32 v238,v16,v112
M v[76:79],v[220:223],a[192:195],v[76:79]
v_sub_f32 v112,v16,v112
v_add_f32 v16,v236,v238
M v[80:83],v[220:223],a[196:199],v[80:83]
v_fmac_f32 v236,4.0,v238
v_fma_f32 v238,2.0,v112,v240
M v[84:87],v[220:223],a[200:203],v[84:87]
v_fma_f32 v112,s41,v112,v240
v_accvgpr_read_b32 v240,a17
M v[88:91],v[220:223],a[204:207],v[88:91]
v_accvgpr_read_b32 v239,a113
v_add_f32 v237,v240,v239
M v[92:95],v[220:223],a[208:211],v[92:95]
s_waitcnt vmcnt(9)
buffer_load_dwordx4 v[220:223],v253,s[20:23],s46 offen offset:2048
M v[32:35],v[224:227],a[216:219],v[32:35]
v_sub_f32 v240,v240,v239
v_add_f32 v239,v17,v113
M v[36:39],v[224:227],a[220:223],v[36:39]
s_add_u32 s46,s44,55296
v_sub_f32 v113,v17,v113
v_add_f32 v17,v237,v239
M v[40:43],v[224:227],a[192:195],v[40:43]
v_fmac_f32 v237,4.0,v239
v_fma_f32 v239,2.0,v113,v240
M v[44:47],v[224:227],a[196:199],v[44:47]
v_fma_f32 v113,s41,v113,v240
v_cvt_pk_bf16_f32 v238,v238,v239
M v[48:51],v[224:227],a[200:203],v[48:51]
v_accvgpr_write_b32 a16,v238
v_cvt_pk_bf16_f32 v236,v236,v237
M v[52:55],v[224:227],a[204:207],v[52:55]
v_accvgpr_write_b32 a112,v236
v_accvgpr_read_b32 v240,a18
M v[56:59],v[224:227],a[208:211],v[56:59]
s_waitcnt lgkmcnt(0)
v_accvgpr_read_b32 v238,a114
v_add_f32 v236,v240,v238
M v[60:63],v[224:227],a[212:215],v[60:63]
s_waitcnt vmcnt(9)
buffer_load_dwordx4 v[224:227],v253,s[20:23],s46 offen offset:0
M v[64:67],a[224:227],a[216:219],v[64:67]
ds_read_b128 a[216:219],v251 offset:8704
v_sub_f32 v240,v240,v238
M v[68:71],a[224:227],a[220:223],v[68:71]
ds_read_b128 a[220:223],v252 offset:8960
v_add_f32 v238,v18,v114
M v[72:75],a[224:227],a[192:195],v[72:75]
ds_read_b128 a[192:195],v252 offset:9216
v_sub_f32 v114,v18,v114
M v[76:79],a[224:227],a[196:199],v[76:79]
ds_read_b128 a[196:199],v252 offset:9472
v_add_f32 v18,v236,v238
M v[80:83],a[224:227],a[200:203],v[80:83]
ds_read_b128 a[200:203],v252 offset:9728
v_fmac_f32 v236,4.0,v238
M v[84:87],a[224:227],a[204:207],v[84:87]
ds_read_b128 a[204:207],v252 offset:9984
v_fma_f32 v238,2.0,v114,v240
M v[88:91],a[224:227],a[208:211],v[88:91]
ds_read_b128 a[208:211],v252 offset:10240
v_fma_f32 v114,s41,v114,v240
M v[92:95],a[224:227],a[212:215],v[92:95]
s_waitcnt vmcnt(9) lgkmcnt(6)
buffer_load_dwordx4 a[224:227],v253,s[20:23],s46 offen offset:1024
M v[128:131],a[228:231],a[216:219],v[128:131]
s_waitcnt lgkmcnt(5)
ds_read_b128 a[212:215],v252 offset:10496
v_accvgpr_read_b32 v240,a19
M v[132:135],a[228:231],a[220:223],v[132:135]
s_waitcnt lgkmcnt(5)
v_accvgpr_read_b32 v239,a115
v_add_f32 v237,v240,v239
M v[136:139],a[228:231],a[192:195],v[136:139]
s_waitcnt lgkmcnt(4)
v_sub_f32 v240,v240,v239
v_add_f32 v239,v19,v115
M v[140:143],a[228:231],a[196:199],v[140:143]
s_waitcnt lgkmcnt(3)
v_sub_f32 v115,v19,v115
v_add_f32 v19,v237,v239
M v[144:147],a[228:231],a[200:203],v[144:147]
s_waitcnt lgkmcnt(2)
v_fmac_f32 v237,4.0,v239
v_fma_f32 v239,2.0,v115,v240
M v[148:151],a[228:231],a[204:207],v[148:151]
s_waitcnt lgkmcnt(1)
v_fma_f32 v115,s41,v115,v240
v_cvt_pk_bf16_f32 v238,v238,v239
M v[152:155],a[228:231],a[208:211],v[152:155]
s_waitcnt lgkmcnt(0)
v_accvgpr_write_b32 a17,v238
v_cvt_pk_bf16_f32 v236,v236,v237
M v[156:159],a[228:231],a[212:215],v[156:159]
s_waitcnt vmcnt(9)
buffer_load_dwordx4 a[228:231],v253,s[20:23],s46 offen offset:2048
M v[160:163],a[232:235],a[216:219],v[160:163]
ds_read_b128 a[216:219],v252 offset:10752
v_accvgpr_write_b32 a113,v236
M v[164:167],a[232:235],a[220:223],v[164:167]
s_add_u32 s46,s44,110592
v_accvgpr_read_b32 v240,a20
v_accvgpr_read_b32 v238,a116
M v[168:171],a[232:235],a[192:195],v[168:171]
v_add_f32 v236,v240,v238
v_sub_f32 v240,v240,v238
M v[172:175],a[232:235],a[196:199],v[172:175]
v_add_f32 v238,v20,v116
v_sub_f32 v116,v20,v116
M v[176:179],a[232:235],a[200:203],v[176:179]
v_add_f32 v20,v236,v238
v_fmac_f32 v236,4.0,v238
M v[180:183],a[232:235],a[204:207],v[180:183]
v_fma_f32 v238,2.0,v116,v240
v_fma_f32 v116,s41,v116,v240
M v[184:187],a[232:235],a[208:211],v[184:187]
v_accvgpr_read_b32 v240,a21
v_accvgpr_read_b32 v239,a117
M v[188:191],a[232:235],a[212:215],v[188:191]
s_waitcnt vmcnt(9)
buffer_load_dwordx4 a[232:235],v253,s[20:23],s46 offen offset:0
M v[128:131],a[236:239],a[220:223],v[128:131]
v_add_f32 v237,v240,v239
v_sub_f32 v240,v240,v239
M v[132:135],a[236:239],a[192:195],v[132:135]
v_add_f32 v239,v21,v117
v_sub_f32 v117,v21,v117
M v[136:139],a[236:239],a[196:199],v[136:139]
v_add_f32 v21,v237,v239
v_fmac_f32 v237,4.0,v239
M v[140:143],a[236:239],a[200:203],v[140:143]
v_fma_f32 v239,2.0,v117,v240
v_fma_f32 v117,s41,v117,v240
M v[144:147],a[236:239],a[204:207],v[144:147]
v_cvt_pk_bf16_f32 v238,v238,v239
v_accvgpr_write_b32 a20,v238
M v[148:151],a[236:239],a[208:211],v[148:151]
v_cvt_pk_bf16_f32 v236,v236,v237
v_accvgpr_write_b32 a116,v236
M v[152:155],a[236:239],a[212:215],v[152:155]
s_waitcnt lgkmcnt(0)
v_accvgpr_read_b32 v240,a22
v_accvgpr_read_b32 v238,a118
M v[156:159],a[236:239],a[216:219],v[156:159]
s_waitcnt vmcnt(9)
buffer_load_dwordx4 a[236:239],v253,s[20:23],s46 offen offset:1024
M v[160:163],a[240:243],a[220:223],v[160:163]
ds_read_b128 a[220:223],v251 offset:11008
v_add_f32 v236,v240,v238
M v[164:167],a[240:243],a[192:195],v[164:167]
v_sub_f32 v240,v240,v238
v_add_f32 v238,v22,v118
v_sub_f32 v118,v22,v118
v_add_f32 v22,v236,v238
M v[168:171],a[240:243],a[196:199],v[168:171]
v_fmac_f32 v236,4.0,v238
v_fma_f32 v238,2.0,v118,v240
v_fma_f32 v118,s41,v118,v240
v_accvgpr_read_b32 v240,a23
M v[172:175],a[240:243],a[200:203],v[172:175]
v_accvgpr_read_b32 v239,a119
v_add_f32 v237,v240,v239
v_sub_f32 v240,v240,v239
v_add_f32 v239,v23,v119
M v[176:179],a[240:243],a[204:207],v[176:179]
v_sub_f32 v119,v23,v119
v_add_f32 v23,v237,v239
v_fmac_f32 v237,4.0,v239
v_fma_f32 v239,2.0,v119,v240
M v[180:183],a[240:243],a[208:211],v[180:183]
v_fma_f32 v119,s41,v119,v240
v_cvt_pk_bf16_f32 v238,v238,v239
v_accvgpr_write_b32 a21,v238
v_cvt_pk_bf16_f32 v236,v236,v237
M v[184:187],a[240:243],a[212:215],v[184:187]
v_accvgpr_write_b32 a117,v236
v_accvgpr_read_b32 v240,a24
v_accvgpr_read_b32 v238,a120
v_add_f32 v236,v240,v238
M v[188:191],a[240:243],a[216:219],v[188:191]
s_waitcnt vmcnt(9)
buffer_load_dwordx4 a[240:243],v253,s[20:23],s46 offen offset:2048
v_sub_f32 v240,v240,v238
v_add_f32 v238,v24,v120
v_sub_f32 v120,v24,v120
v_add_f32 v24,v236,v238
M v[128:131],a[244:247],a[192:195],v[128:131]
v_fmac_f32 v236,4.0,v238
v_fma_f32 v238,2.0,v120,v240
v_fma_f32 v120,s41,v120,v240
v_accvgpr_read_b32 v240,a25
M v[132:135],a[244:247],a[196:199],v[132:135]
s_add_u32 s46,s44,165888
v_accvgpr_read_b32 v239,a121
v_add_f32 v237,v240,v239
v_sub_f32 v240,v240,v239
v_add_f32 v239,v25,v121
M v[136:139],a[244:247],a[200:203],v[136:139]
v_sub_f32 v121,v25,v121
v_add_f32 v25,v237,v239
v_fmac_f32 v237,4.0,v239
v_fma_f32 v239,2.0,v121,v240
M v[140:143],a[244:247],a[204:207],v[140:143]
v_fma_f32 v121,s41,v121,v240
v_cvt_pk_bf16_f32 v238,v238,v239
v_accvgpr_write_b32 a24,v238
v_cvt_pk_bf16_f32 v236,v236,v237
M v[144:147],a[244:247],a[208:211],v[144:147]
v_accvgpr_write_b32 a120,v236
v_accvgpr_read_b32 v240,a26
v_accvgpr_read_b32 v238,a122
v_add_f32 v236,v240,v238
M v[148:151],a[244:247],a[212:215],v[148:151]
v_sub_f32 v240,v240,v238
v_add_f32 v238,v26,v122
v_sub_f32 v122,v26,v122
v_add_f32 v26,v236,v238
M v[152:155],a[244:247],a[216:219],v[152:155]
s_waitcnt lgkmcnt(0)
v_add_u32 v251,0xffffbc00,v251
v_add_u32 v252,0xffffbc00,v252
v_fmac_f32 v236,4.0,v238
v_fma_f32 v238,2.0,v122,v240
v_fma_f32 v122,s41,v122,v240
v_accvgpr_read_b32 v240,a27
M v[156:159],a[244:247],a[220:223],v[156:159]
s_waitcnt vmcnt(9)
buffer_load_dwordx4 a[244:247],v253,s[20:23],s46 offen offset:0
v_accvgpr_read_b32 v239,a123
v_add_f32 v237,v240,v239
v_sub_f32 v240,v240,v239
v_add_f32 v239,v27,v123
M v[160:163],a[248:251],a[192:195],v[160:163]
ds_read_b128 a[192:195],v251 offset:0
v_sub_f32 v123,v27,v123
v_add_f32 v27,v237,v239
v_fmac_f32 v237,4.0,v239
v_fma_f32 v239,2.0,v123,v240
M v[164:167],a[248:251],a[196:199],v[164:167]
ds_read_b128 a[196:199],v252 offset:256
v_fma_f32 v123,s41,v123,v240
v_cvt_pk_bf16_f32 v238,v238,v239
v_accvgpr_write_b32 a25,v238
v_cvt_pk_bf16_f32 v236,v236,v237
M v[168:171],a[248:251],a[200:203],v[168:171]
s_waitcnt lgkmcnt(0)
s_barrier
ds_read_b128 a[200:203],v252 offset:512
v_accvgpr_write_b32 a121,v236
v_accvgpr_read_b32 v240,a28
v_accvgpr_read_b32 v238,a124
v_add_f32 v236,v240,v238
M v[172:175],a[248:251],a[204:207],v[172:175]
ds_read_b128 a[204:207],v252 offset:768
v_sub_f32 v240,v240,v238
v_add_f32 v238,v28,v124
v_sub_f32 v124,v28,v124
v_add_f32 v28,v236,v238
M v[176:179],a[248:251],a[208:211],v[176:179]
ds_read_b128 a[208:211],v252 offset:1024
v_fmac_f32 v236,4.0,v238
v_fma_f32 v238,2.0,v124,v240
v_fma_f32 v124,s41,v124,v240
v_accvgpr_read_b32 v240,a29
M v[180:183],a[248:251],a[212:215],v[180:183]
ds_read_b128 a[212:215],v252 offset:1280
v_accvgpr_read_b32 v239,a125
v_add_f32 v237,v240,v239
v_sub_f32 v240,v240,v239
v_add_f32 v239,v29,v125
M v[184:187],a[248:251],a[216:219],v[184:187]
ds_read_b128 a[216:219],v252 offset:1536
v_sub_f32 v125,v29,v125
v_add_f32 v29,v237,v239
v_fmac_f32 v237,4.0,v239
v_fma_f32 v239,2.0,v125,v240
M v[188:191],a[248:251],a[220:223],v[188:191]
s_waitcnt vmcnt(9)
buffer_load_dwordx4 a[248:251],v253,s[20:23],s46 offen offset:1024
v_fma_f32 v125,s41,v125,v240
v_cvt_pk_bf16_f32 v238,v238,v239
v_accvgpr_write_b32 a28,v238
v_cvt_pk_bf16_f32 v236,v236,v237
M v[0:3],a[252:255],a[192:195],v[0:3]
ds_read_b128 a[220:223],v252 offset:1792
ds_read_b128 a[192:195],v252 offset:2048
v_accvgpr_write_b32 a124,v236
v_accvgpr_read_b32 v240,a30
v_accvgpr_read_b32 v238,a126
v_add_f32 v236,v240,v238
M v[4:7],a[252:255],a[196:199],v[4:7]
s_waitcnt lgkmcnt(6)
v_sub_f32 v240,v240,v238
v_add_f32 v238,v30,v126
v_sub_f32 v126,v30,v126
v_add_f32 v30,v236,v238
M v[8:11],a[252:255],a[200:203],v[8:11]
s_waitcnt lgkmcnt(5)
v_fmac_f32 v236,4.0,v238
v_fma_f32 v238,2.0,v126,v240
v_fma_f32 v126,s41,v126,v240
v_accvgpr_read_b32 v240,a31
M v[12:15],a[252:255],a[204:207],v[12:15]
s_waitcnt lgkmcnt(4)
v_accvgpr_read_b32 v239,a127
v_add_f32 v237,v240,v239
v_sub_f32 v240,v240,v239
v_add_f32 v239,v31,v127
M v[16:19],a[252:255],a[208:211],v[16:19]
s_waitcnt lgkmcnt(3)
v_sub_f32 v127,v31,v127
v_add_f32 v31,v237,v239
M v[20:23],a[252:255],a[212:215],v[20:23]
s_waitcnt lgkmcnt(2)
v_fmac_f32 v237,4.0,v239
v_fma_f32 v239,2.0,v127,v240
M v[24:27],a[252:255],a[216:219],v[24:27]
s_waitcnt lgkmcnt(1)
v_fma_f32 v127,s41,v127,v240
v_cvt_pk_bf16_f32 v238,v238,v239
M v[28:31],a[252:255],a[220:223],v[28:31]
s_waitcnt vmcnt(9)
buffer_load_dwordx4 a[252:255],v253,s[20:23],s46 offen offset:2048
M v[0:3],v[216:219],a[196:199],v[0:3]
ds_read_b128 a[196:199],v251 offset:2304
v_accvgpr_write_b32 a29,v238
M v[4:7],v[216:219],a[200:203],v[4:7]
s_add_u32 s46,s44,221184
v_cvt_pk_bf16_f32 v236,v236,v237
v_accvgpr_write_b32 a125,v236
M v[8:11],v[216:219],a[204:207],v[8:11]
ds_write2st64_b64 v249,v[192:193],v[202:203] offset0:102 offset1:119
M v[12:15],v[216:219],a[208:211],v[12:15]
s_add_u32 s28,s30,7077888
buffer_load_dwordx2 v[192:193],v247,s[12:15],s28 offen offset:0
M v[16:19],v[216:219],a[212:215],v[16:19]
buffer_load_dwordx2 v[202:203],v247,s[16:19],s28 offen offset:1536
M v[20:23],v[216:219],a[216:219],v[20:23]
ds_write2st64_b64 v249,v[194:195],v[196:197] offset0:34 offset1:51
M v[24:27],v[216:219],a[220:223],v[24:27]
s_waitcnt lgkmcnt(3)
buffer_load_dwordx2 v[194:195],v247,s[8:11],s28 offen offset:0
M v[28:31],v[216:219],a[192:195],v[28:31]
s_waitcnt vmcnt(12)
buffer_load_dwordx2 v[196:197],v247,s[8:11],s28 offen offset:384
M v[0:3],v[220:223],a[200:203],v[0:3]
buffer_load_dwordx4 v[216:219],v253,s[20:23],s46 offen offset:0
M v[4:7],v[220:223],a[204:207],v[4:7]
ds_write2st64_b64 v249,v[198:199],v[200:201] offset0:68 offset1:85
v_add_u32 v251,0x15400,v251
v_add_u32 v252,0x15400,v252
M v[8:11],v[220:223],a[208:211],v[8:11]
buffer_load_dwordx2 v[198:199],v247,s[8:11],s28 offen offset:768
M v[12:15],v[220:223],a[212:215],v[12:15]
buffer_load_dwordx2 v[200:201],v247,s[8:11],s28 offen offset:1152
ds_read_b128 a[200:203],v251 offset:0
M v[16:19],v[220:223],a[216:219],v[16:19]
ds_read_b128 a[204:207],v252 offset:256
ds_read_b128 a[208:211],v252 offset:512
M v[20:23],v[220:223],a[220:223],v[20:23]
ds_read_b128 a[212:215],v252 offset:768
ds_read_b128 a[216:219],v252 offset:1024
M v[24:27],v[220:223],a[192:195],v[24:27]
s_waitcnt lgkmcnt(8)
ds_read_b128 a[220:223],v252 offset:1280
ds_read_b128 a[192:195],v252 offset:1536
M v[28:31],v[220:223],a[196:199],v[28:31]
s_waitcnt vmcnt(15) lgkmcnt(6)
buffer_load_dwordx4 v[220:223],v253,s[20:23],s46 offen offset:1024
M v[0:3],v[224:227],a[200:203],v[0:3]
s_waitcnt lgkmcnt(5)
ds_read_b128 a[196:199],v252 offset:1792
ds_read_b128 a[200:203],v252 offset:2048
M v[4:7],v[224:227],a[204:207],v[4:7]
s_waitcnt lgkmcnt(6)
v_accvgpr_read_b32 v240,a32
v_accvgpr_read_b32 v238,a128
M v[8:11],v[224:227],a[208:211],v[8:11]
s_waitcnt lgkmcnt(5)
v_add_f32 v236,v240,v238
v_sub_f32 v240,v240,v238
M v[12:15],v[224:227],a[212:215],v[12:15]
s_waitcnt lgkmcnt(4)
v_add_f32 v238,v32,v128
v_sub_f32 v128,v32,v128
M v[16:19],v[224:227],a[216:219],v[16:19]
s_waitcnt lgkmcnt(3)
v_add_f32 v32,v236,v238
v_fmac_f32 v236,4.0,v238
M v[20:23],v[224:227],a[220:223],v[20:23]
s_waitcnt lgkmcnt(2)
v_fma_f32 v238,2.0,v128,v240
v_fma_f32 v128,s41,v128,v240
M v[24:27],v[224:227],a[192:195],v[24:27]
s_waitcnt lgkmcnt(1)
v_accvgpr_read_b32 v240,a33
v_accvgpr_read_b32 v239,a129
M v[28:31],v[224:227],a[196:199],v[28:31]
s_waitcnt vmcnt(15)
buffer_load_dwordx4 v[224:227],v253,s[20:23],s46 offen offset:2048
M v[0:3],a[224:227],a[204:207],v[0:3]
ds_read_b128 a[204:207],v251 offset:2304
v_add_f32 v237,v240,v239
M v[4:7],a[224:227],a[208:211],v[4:7]
s_add_u32 s46,s44,276480
v_sub_f32 v240,v240,v239
v_add_f32 v239,v33,v129
M v[8:11],a[224:227],a[212:215],v[8:11]
v_sub_f32 v129,v33,v129
v_add_f32 v33,v237,v239
M v[12:15],a[224:227],a[216:219],v[12:15]
v_fmac_f32 v237,4.0,v239
v_fma_f32 v239,2.0,v129,v240
M v[16:19],a[224:227],a[220:223],v[16:19]
v_fma_f32 v129,s41,v129,v240
v_cvt_pk_bf16_f32 v238,v238,v239
M v[20:23],a[224:227],a[192:195],v[20:23]
v_accvgpr_write_b32 a2,v238
v_cvt_pk_bf16_f32 v236,v236,v237
M v[24:27],a[224:227],a[196:199],v[24:27]
s_waitcnt lgkmcnt(1)
v_accvgpr_write_b32 a98,v236
v_accvgpr_read_b32 v240,a34
M v[28:31],a[224:227],a[200:203],v[28:31]
s_waitcnt vmcnt(15)
buffer_load_dwordx4 a[224:227],v253,s[20:23],s46 offen offset:0
M v[0:3],a[228:231],a[208:211],v[0:3]
ds_read_b128 a[208:211],v251 offset:17408
v_accvgpr_read_b32 v238,a130
M v[4:7],a[228:231],a[212:215],v[4:7]
ds_read_b128 a[212:215],v252 offset:17664
v_add_f32 v236,v240,v238
M v[8:11],a[228:231],a[216:219],v[8:11]
ds_read_b128 a[216:219],v252 offset:17920
v_sub_f32 v240,v240,v238
M v[12:15],a[228:231],a[220:223],v[12:15]
ds_read_b128 a[220:223],v252 offset:18176
v_add_f32 v238,v34,v130
M v[16:19],a[228:231],a[192:195],v[16:19]
ds_read_b128 a[192:195],v252 offset:18432
v_sub_f32 v130,v34,v130
M v[20:23],a[228:231],a[196:199],v[20:23]
ds_read_b128 a[196:199],v252 offset:18688
v_add_f32 v34,v236,v238
M v[24:27],a[228:231],a[200:203],v[24:27]
s_waitcnt lgkmcnt(6)
ds_read_b128 a[200:203],v252 offset:18944
v_fmac_f32 v236,4.0,v238
M v[28:31],a[228:231],a[204:207],v[28:31]
s_waitcnt vmcnt(15) lgkmcnt(6)
buffer_load_dwordx4 a[228:231],v253,s[20:23],s46 offen offset:1024
M v[0:3],a[232:235],a[208:211],v[0:3]
s_waitcnt lgkmcnt(5)
ds_read_b128 a[204:207],v252 offset:19200
ds_read_b128 a[208:211],v252 offset:19456
M v[4:7],a[232:235],a[212:215],v[4:7]
s_waitcnt lgkmcnt(6)
v_fma_f32 v238,2.0,v130,v240
v_fma_f32 v130,s41,v130,v240
M v[8:11],a[232:235],a[216:219],v[8:11]
s_waitcnt lgkmcnt(5)
v_accvgpr_read_b32 v240,a35
v_accvgpr_read_b32 v239,a131
M v[12:15],a[232:235],a[220:223],v[12:15]
s_waitcnt lgkmcnt(4)
v_add_f32 v237,v240,v239
v_sub_f32 v240,v240,v239
M v[16:19],a[232:235],a[192:195],v[16:19]
s_waitcnt lgkmcnt(3)
v_add_f32 v239,v35,v131
v_sub_f32 v131,v35,v131
M v[20:23],a[232:235],a[196:199],v[20:23]
s_waitcnt lgkmcnt(2)
v_add_f32 v35,v237,v239
v_fmac_f32 v237,4.0,v239
M v[24:27],a[232:235],a[200:203],v[24:27]
s_waitcnt lgkmcnt(1)
v_fma_f32 v239,2.0,v131,v240
v_fma_f32 v131,s41,v131,v240
M v[28:31],a[232:235],a[204:207],v[28:31]
s_waitcnt vmcnt(15)
buffer_load_dwordx4 a[232:235],v253,s[20:23],s46 offen offset:2048
M v[0:3],a[236:239],a[212:215],v[0:3]
ds_read_b128 a[212:215],v251 offset:19712
v_cvt_pk_bf16_f32 v238,v238,v239
M v[4:7],a[236:239],a[216:219],v[4:7]
s_add_u32 s46,s44,46080
v_accvgpr_write_b32 a3,v238
v_cvt_pk_bf16_f32 v236,v236,v237
M v[8:11],a[236:239],a[220:223],v[8:11]
v_accvgpr_write_b32 a99,v236
v_accvgpr_read_b32 v240,a36
M v[12:15],a[236:239],a[192:195],v[12:15]
v_accvgpr_read_b32 v238,a132
v_add_f32 v236,v240,v238
M v[16:19],a[236:239],a[196:199],v[16:19]
buffer_store_dwordx4 a[0:3],v254,s[24:27],s32 offen offset:384
M v[20:23],a[236:239],a[200:203],v[20:23]
v_sub_f32 v240,v240,v238
v_add_f32 v238,v36,v132
M v[24:27],a[236:239],a[204:207],v[24:27]
s_waitcnt lgkmcnt(1)
v_sub_f32 v132,v36,v132
v_add_f32 v36,v236,v238
M v[28:31],a[236:239],a[208:211],v[28:31]
s_waitcnt vmcnt(16)
buffer_load_dwordx4 a[236:239],v253,s[20:23],s46 offen offset:0
M v[0:3],a[240:243],a[216:219],v[0:3]
ds_read_b128 a[216:219],v251 offset:34816
v_fmac_f32 v236,4.0,v238
M v[4:7],a[240:243],a[220:223],v[4:7]
ds_read_b128 a[220:223],v252 offset:35072
v_fma_f32 v238,2.0,v132,v240
M v[8:11],a[240:243],a[192:195],v[8:11]
ds_read_b128 a[192:195],v252 offset:35328
v_fma_f32 v132,s41,v132,v240
M v[12:15],a[240:243],a[196:199],v[12:15]
ds_read_b128 a[196:199],v252 offset:35584
v_accvgpr_read_b32 v240,a37
M v[16:19],a[240:243],a[200:203],v[16:19]
ds_read_b128 a[200:203],v252 offset:35840
v_accvgpr_read_b32 v239,a133
M v[20:23],a[240:243],a[204:207],v[20:23]
ds_read_b128 a[204:207],v252 offset:36096
v_add_f32 v237,v240,v239
M v[24:27],a[240:243],a[208:211],v[24:27]
s_waitcnt lgkmcnt(6)
ds_read_b128 a[208:211],v252 offset:36352
v_sub_f32 v240,v240,v239
M v[28:31],a[240:243],a[212:215],v[28:31]
s_waitcnt vmcnt(16) lgkmcnt(6)
buffer_load_dwordx4 a[240:243],v253,s[20:23],s46 offen offset:1024
M v[0:3],a[244:247],a[216:219],v[0:3]
s_waitcnt lgkmcnt(5)
ds_read_b128 a[212:215],v252 offset:36608
ds_read_b128 a[216:219],v252 offset:36864
M v[4:7],a[244:247],a[220:223],v[4:7]
s_waitcnt lgkmcnt(6)
v_add_f32 v239,v37,v133
v_sub_f32 v133,v37,v133
M v[8:11],a[244:247],a[192:195],v[8:11]
s_waitcnt lgkmcnt(5)
v_add_f32 v37,v237,v239
v_fmac_f32 v237,4.0,v239
M v[12:15],a[244:247],a[196:199],v[12:15]
s_waitcnt lgkmcnt(4)
v_fma_f32 v239,2.0,v133,v240
v_fma_f32 v133,s41,v133,v240
M v[16:19],a[244:247],a[200:203],v[16:19]
s_waitcnt lgkmcnt(3)
v_cvt_pk_bf16_f32 v238,v238,v239
v_accvgpr_write_b32 a6,v238
M v[20:23],a[244:247],a[204:207],v[20:23]
s_waitcnt lgkmcnt(2)
buffer_store_dwordx4 a[96:99],v254,s[24:27],s32 offen offset:768
M v[24:27],a[244:247],a[208:211],v[24:27]
s_waitcnt lgkmcnt(1)
v_cvt_pk_bf16_f32 v236,v236,v237
v_accvgpr_write_b32 a102,v236
M v[28:31],a[244:247],a[212:215],v[28:31]
s_waitcnt vmcnt(17)
buffer_load_dwordx4 a[244:247],v253,s[20:23],s46 offen offset:2048
M v[0:3],a[248:251],a[220:223],v[0:3]
ds_read_b128 a[220:223],v251 offset:37120
v_accvgpr_read_b32 v240,a38
M v[4:7],a[248:251],a[192:195],v[4:7]
s_add_u32 s46,s44,101376
v_accvgpr_read_b32 v238,a134
v_add_f32 v236,v240,v238
M v[8:11],a[248:251],a[196:199],v[8:11]
v_sub_f32 v240,v240,v238
v_add_f32 v238,v38,v134
M v[12:15],a[248:251],a[200:203],v[12:15]
v_sub_f32 v134,v38,v134
v_add_f32 v38,v236,v238
M v[16:19],a[248:251],a[204:207],v[16:19]
v_fmac_f32 v236,4.0,v238
v_fma_f32 v238,2.0,v134,v240
M v[20:23],a[248:251],a[208:211],v[20:23]
v_fma_f32 v134,s41,v134,v240
v_accvgpr_read_b32 v240,a39
M v[24:27],a[248:251],a[212:215],v[24:27]
s_waitcnt lgkmcnt(1)
v_accvgpr_read_b32 v239,a135
v_add_f32 v237,v240,v239
M v[28:31],a[248:251],a[216:219],v[28:31]
s_waitcnt vmcnt(17)
buffer_load_dwordx4 a[248:251],v253,s[20:23],s46 offen offset:0
M v[0:3],a[252:255],a[192:195],v[0:3]
ds_read_b128 a[192:195],v251 offset:52224
v_sub_f32 v240,v240,v239
M v[4:7],a[252:255],a[196:199],v[4:7]
ds_read_b128 a[196:199],v252 offset:52480
v_add_f32 v239,v39,v135
M v[8:11],a[252:255],a[200:203],v[8:11]
ds_read_b128 a[200:203],v252 offset:52736
v_sub_f32 v135,v39,v135
M v[12:15],a[252:255],a[204:207],v[12:15]
ds_read_b128 a[204:207],v252 offset:52992
v_add_f32 v39,v237,v239
M v[16:19],a[252:255],a[208:211],v[16:19]
ds_read_b128 a[208:211],v252 offset:53248
v_fmac_f32 v237,4.0,v239
M v[20:23],a[252:255],a[212:215],v[20:23]
ds_read_b128 a[212:215],v252 offset:53504
v_fma_f32 v239,2.0,v135,v240
M v[24:27],a[252:255],a[216:219],v[24:27]
s_waitcnt lgkmcnt(6)
ds_read_b128 a[216:219],v252 offset:53760
v_fma_f32 v135,s41,v135,v240
M v[28:31],a[252:255],a[220:223],v[28:31]
s_waitcnt vmcnt(13) lgkmcnt(6)
buffer_load_dwordx4 a[252:255],v253,s[20:23],s46 offen offset:1024
M v[0:3],v[216:219],a[192:195],v[0:3]
s_waitcnt lgkmcnt(5)
ds_read_b128 a[220:223],v252 offset:54016
ds_read_b128 a[192:195],v252 offset:54272
M v[4:7],v[216:219],a[196:199],v[4:7]
s_waitcnt lgkmcnt(6)
v_cvt_pk_bf16_f32 v238,v238,v239
v_accvgpr_write_b32 a7,v238
M v[8:11],v[216:219],a[200:203],v[8:11]
s_waitcnt lgkmcnt(5)
v_cvt_pk_bf16_f32 v236,v236,v237
v_accvgpr_write_b32 a103,v236
M v[12:15],v[216:219],a[204:207],v[12:15]
s_waitcnt lgkmcnt(4)
buffer_store_dwordx4 a[4:7],v254,s[24:27],s33 offen offset:384
M v[16:19],v[216:219],a[208:211],v[16:19]
s_waitcnt lgkmcnt(3)
v_accvgpr_read_b32 v240,a40
v_accvgpr_read_b32 v238,a136
M v[20:23],v[216:219],a[212:215],v[20:23]
s_waitcnt lgkmcnt(2)
v_add_f32 v236,v240,v238
v_sub_f32 v240,v240,v238
M v[24:27],v[216:219],a[216:219],v[24:27]
s_waitcnt lgkmcnt(1)
v_add_f32 v238,v40,v136
v_sub_f32 v136,v40,v136
M v[28:31],v[216:219],a[220:223],v[28:31]
s_waitcnt vmcnt(12)
buffer_load_dwordx4 v[216:219],v253,s[20:23],s46 offen offset:2048
M v[0:3],v[220:223],a[196:199],v[0:3]
ds_read_b128 a[196:199],v251 offset:54528
v_add_f32 v40,v236,v238
M v[4:7],v[220:223],a[200:203],v[4:7]
s_add_u32 s46,s44,156672
v_fmac_f32 v236,4.0,v238
v_fma_f32 v238,2.0,v136,v240
M v[8:11],v[220:223],a[204:207],v[8:11]
v_fma_f32 v136,s41,v136,v240
v_accvgpr_read_b32 v240,a41
M v[12:15],v[220:223],a[208:211],v[12:15]
v_accvgpr_read_b32 v239,a137
v_add_f32 v237,v240,v239
M v[16:19],v[220:223],a[212:215],v[16:19]
v_sub_f32 v240,v240,v239
v_add_f32 v239,v41,v137
M v[20:23],v[220:223],a[216:219],v[20:23]
v_add_u32 v251,0xfffece00,v251
v_add_u32 v252,0xfffece00,v252
M v[24:27],v[220:223],a[220:223],v[24:27]
s_waitcnt lgkmcnt(1)
v_sub_f32 v137,v41,v137
v_add_f32 v41,v237,v239
M v[28:31],v[220:223],a[192:195],v[28:31]
s_waitcnt vmcnt(12)
buffer_load_dwordx4 v[220:223],v253,s[20:23],s46 offen offset:0
M v[0:3],v[224:227],a[200:203],v[0:3]
buffer_store_dwordx4 a[100:103],v254,s[24:27],s33 offen offset:768
M v[4:7],v[224:227],a[204:207],v[4:7]
ds_read_b128 a[200:203],v251 offset:60928
ds_read_b128 a[204:207],v252 offset:61184
M v[8:11],v[224:227],a[208:211],v[8:11]
ds_read_b128 a[208:211],v252 offset:61440
v_fmac_f32 v237,4.0,v239
M v[12:15],v[224:227],a[212:215],v[12:15]
ds_read_b128 a[212:215],v252 offset:61696
v_fma_f32 v239,2.0,v137,v240
M v[16:19],v[224:227],a[216:219],v[16:19]
ds_read_b128 a[216:219],v252 offset:61952
v_fma_f32 v137,s41,v137,v240
M v[20:23],v[224:227],a[220:223],v[20:23]
ds_read_b128 a[220:223],v252 offset:62208
v_cvt_pk_bf16_f32 v238,v238,v239
M v[24:27],v[224:227],a[192:195],v[24:27]
s_waitcnt lgkmcnt(6)
ds_read_b128 a[192:195],v252 offset:62464
v_accvgpr_write_b32 a10,v238
M v[28:31],v[224:227],a[196:199],v[28:31]
s_waitcnt vmcnt(13) lgkmcnt(6)
buffer_load_dwordx4 v[224:227],v253,s[20:23],s46 offen offset:1024
M v[0:3],a[224:227],a[200:203],v[0:3]
s_waitcnt lgkmcnt(5)
ds_read_b128 a[196:199],v252 offset:62720
ds_read_b128 a[200:203],v252 offset:62976
M v[4:7],a[224:227],a[204:207],v[4:7]
s_waitcnt lgkmcnt(6)
v_cvt_pk_bf16_f32 v236,v236,v237
v_accvgpr_write_b32 a106,v236
M v[8:11],a[224:227],a[208:211],v[8:11]
s_waitcnt lgkmcnt(5)
v_accvgpr_read_b32 v240,a42
v_accvgpr_read_b32 v238,a138
M v[12:15],a[224:227],a[212:215],v[12:15]
s_waitcnt lgkmcnt(4)
v_add_f32 v236,v240,v238
v_sub_f32 v240,v240,v238
M v[16:19],a[224:227],a[216:219],v[16:19]
s_waitcnt lgkmcnt(3)
v_add_f32 v238,v42,v138
v_sub_f32 v138,v42,v138
M v[20:23],a[224:227],a[220:223],v[20:23]
s_waitcnt lgkmcnt(2)
v_add_f32 v42,v236,v238
v_fmac_f32 v236,4.0,v238
M v[24:27],a[224:227],a[192:195],v[24:27]
s_waitcnt lgkmcnt(1)
v_fma_f32 v238,2.0,v138,v240
v_fma_f32 v138,s41,v138,v240
M v[28:31],a[224:227],a[196:199],v[28:31]
s_waitcnt vmcnt(13)
buffer_load_dwordx4 a[224:227],v253,s[20:23],s46 offen offset:2048
M v[0:3],a[228:231],a[204:207],v[0:3]
ds_read_b128 a[204:207],v251 offset:63232
v_accvgpr_read_b32 v240,a43
M v[4:7],a[228:231],a[208:211],v[4:7]
s_add_u32 s46,s44,211968
v_accvgpr_read_b32 v239,a139
v_add_f32 v237,v240,v239
M v[8:11],a[228:231],a[212:215],v[8:11]
v_sub_f32 v240,v240,v239
v_add_f32 v239,v43,v139
M v[12:15],a[228:231],a[216:219],v[12:15]
v_sub_f32 v139,v43,v139
v_add_f32 v43,v237,v239
M v[16:19],a[228:231],a[220:223],v[16:19]
v_fmac_f32 v237,4.0,v239
v_fma_f32 v239,2.0,v139,v240
M v[20:23],a[228:231],a[192:195],v[20:23]
v_fma_f32 v139,s41,v139,v240
v_cvt_pk_bf16_f32 v238,v238,v239
M v[24:27],a[228:231],a[196:199],v[24:27]
s_waitcnt lgkmcnt(1)
v_accvgpr_write_b32 a11,v238
v_cvt_pk_bf16_f32 v236,v236,v237
M v[28:31],a[228:231],a[200:203],v[28:31]
s_waitcnt vmcnt(13)
buffer_load_dwordx4 a[228:231],v253,s[20:23],s46 offen offset:0
M v[0:3],a[232:235],a[208:211],v[0:3]
ds_read_b128 a[208:211],v251 offset:0
v_accvgpr_write_b32 a107,v236
M v[4:7],a[232:235],a[212:215],v[4:7]
buffer_store_dwordx4 a[8:11],v254,s[24:27],s34 offen offset:384
M v[8:11],a[232:235],a[216:219],v[8:11]
ds_read_b128 a[212:215],v252 offset:256
ds_read_b128 a[216:219],v252 offset:512
M v[12:15],a[232:235],a[220:223],v[12:15]
ds_read_b128 a[220:223],v252 offset:768
v_cvt_pk_bf16_f32 v0,v0,v1
M v[16:19],a[232:235],a[192:195],v[16:19]
ds_read_b128 a[192:195],v252 offset:1024
v_cvt_pk_bf16_f32 v1,v2,v3
M v[20:23],a[232:235],a[196:199],v[20:23]
ds_read_b128 a[196:199],v252 offset:1280
v_cvt_pk_bf16_f32 v4,v4,v5
M v[24:27],a[232:235],a[200:203],v[24:27]
s_waitcnt lgkmcnt(6)
ds_read_b128 a[200:203],v252 offset:1536
v_cvt_pk_bf16_f32 v5,v6,v7
M v[28:31],a[232:235],a[204:207],v[28:31]
s_waitcnt vmcnt(13) lgkmcnt(6)
buffer_load_dwordx4 a[232:235],v253,s[20:23],s46 offen offset:1024
M v[96:99],a[236:239],a[208:211],v[96:99]
s_waitcnt lgkmcnt(5)
ds_read_b128 a[204:207],v252 offset:1792
ds_read_b128 a[208:211],v252 offset:2048
M v[100:103],a[236:239],a[212:215],v[100:103]
s_waitcnt lgkmcnt(6)
buffer_store_dwordx4 a[104:107],v254,s[24:27],s34 offen offset:768
M v[104:107],a[236:239],a[216:219],v[104:107]
s_waitcnt lgkmcnt(5)
v_cvt_pk_bf16_f32 v8,v8,v9
v_cvt_pk_bf16_f32 v9,v10,v11
M v[108:111],a[236:239],a[220:223],v[108:111]
s_waitcnt lgkmcnt(4)
v_cvt_pk_bf16_f32 v12,v12,v13
v_cvt_pk_bf16_f32 v13,v14,v15
M v[112:115],a[236:239],a[192:195],v[112:115]
s_waitcnt lgkmcnt(3)
v_cvt_pk_bf16_f32 v16,v16,v17
v_cvt_pk_bf16_f32 v17,v18,v19
M v[116:119],a[236:239],a[196:199],v[116:119]
s_waitcnt lgkmcnt(2)
v_cvt_pk_bf16_f32 v20,v20,v21
v_cvt_pk_bf16_f32 v21,v22,v23
M v[120:123],a[236:239],a[200:203],v[120:123]
s_waitcnt lgkmcnt(1)
v_cvt_pk_bf16_f32 v24,v24,v25
v_cvt_pk_bf16_f32 v25,v26,v27
M v[124:127],a[236:239],a[204:207],v[124:127]
s_waitcnt vmcnt(14)
buffer_load_dwordx4 a[236:239],v253,s[20:23],s46 offen offset:2048
M v[96:99],a[240:243],a[212:215],v[96:99]
ds_read_b128 a[212:215],v251 offset:2304
v_cvt_pk_bf16_f32 v28,v28,v29
M v[100:103],a[240:243],a[216:219],v[100:103]
s_add_u32 s46,s44,267264
v_cvt_pk_bf16_f32 v29,v30,v31
v_accvgpr_read_b32 v240,a44
M v[104:107],a[240:243],a[220:223],v[104:107]
v_accvgpr_read_b32 v238,a140
v_add_f32 v236,v240,v238
M v[108:111],a[240:243],a[192:195],v[108:111]
v_sub_f32 v240,v240,v238
v_add_f32 v238,v44,v140
M v[112:115],a[240:243],a[196:199],v[112:115]
v_sub_f32 v140,v44,v140
v_add_f32 v44,v236,v238
M v[116:119],a[240:243],a[200:203],v[116:119]
v_add_u32 v251,0x15400,v251
v_add_u32 v252,0x15400,v252
M v[120:123],a[240:243],a[204:207],v[120:123]
s_waitcnt lgkmcnt(1)
v_fmac_f32 v236,4.0,v238
v_fma_f32 v238,2.0,v140,v240
M v[124:127],a[240:243],a[208:211],v[124:127]
s_waitcnt vmcnt(13)
buffer_load_dwordx4 a[240:243],v253,s[20:23],s46 offen offset:0
M v[96:99],a[244:247],a[216:219],v[96:99]
ds_read_b128 a[216:219],v251 offset:0
v_fma_f32 v140,s41,v140,v240
M v[100:103],a[244:247],a[220:223],v[100:103]
ds_read_b128 a[220:223],v252 offset:256
v_accvgpr_read_b32 v240,a45
M v[104:107],a[244:247],a[192:195],v[104:107]
ds_read_b128 a[192:195],v252 offset:512
v_accvgpr_read_b32 v239,a141
M v[108:111],a[244:247],a[196:199],v[108:111]
ds_read_b128 a[196:199],v252 offset:768
v_add_f32 v237,v240,v239
M v[112:115],a[244:247],a[200:203],v[112:115]
ds_read_b128 a[200:203],v252 offset:1024
v_sub_f32 v240,v240,v239
M v[116:119],a[244:247],a[204:207],v[116:119]
ds_read_b128 a[204:207],v252 offset:1280
v_add_f32 v239,v45,v141
M v[120:123],a[244:247],a[208:211],v[120:123]
s_waitcnt lgkmcnt(6)
ds_read_b128 a[208:211],v252 offset:1536
v_sub_f32 v141,v45,v141
M v[124:127],a[244:247],a[212:215],v[124:127]
s_waitcnt vmcnt(13) lgkmcnt(6)
buffer_load_dwordx4 a[244:247],v253,s[20:23],s46 offen offset:1024
M v[96:99],a[248:251],a[216:219],v[96:99]
s_waitcnt lgkmcnt(5)
ds_read_b128 a[212:215],v252 offset:1792
ds_read_b128 a[216:219],v252 offset:2048
M v[100:103],a[248:251],a[220:223],v[100:103]
s_waitcnt lgkmcnt(6)
v_add_f32 v45,v237,v239
v_fmac_f32 v237,4.0,v239
M v[104:107],a[248:251],a[192:195],v[104:107]
s_waitcnt lgkmcnt(5)
v_fma_f32 v239,2.0,v141,v240
v_fma_f32 v141,s41,v141,v240
M v[108:111],a[248:251],a[196:199],v[108:111]
s_waitcnt lgkmcnt(4)
v_cvt_pk_bf16_f32 v238,v238,v239
v_accvgpr_write_b32 a14,v238
M v[112:115],a[248:251],a[200:203],v[112:115]
s_waitcnt lgkmcnt(3)
v_cvt_pk_bf16_f32 v236,v236,v237
v_accvgpr_write_b32 a110,v236
M v[116:119],a[248:251],a[204:207],v[116:119]
s_waitcnt lgkmcnt(2)
v_accvgpr_read_b32 v240,a46
v_accvgpr_read_b32 v238,a142
M v[120:123],a[248:251],a[208:211],v[120:123]
s_waitcnt lgkmcnt(1)
v_add_f32 v236,v240,v238
v_sub_f32 v240,v240,v238
M v[124:127],a[248:251],a[212:215],v[124:127]
s_waitcnt vmcnt(13)
buffer_load_dwordx4 a[248:251],v253,s[20:23],s46 offen offset:2048
M v[96:99],a[252:255],a[220:223],v[96:99]
ds_read_b128 a[220:223],v251 offset:2304
v_add_f32 v238,v46,v142
M v[100:103],a[252:255],a[192:195],v[100:103]
s_add_u32 s46,s44,322560
v_sub_f32 v142,v46,v142
v_add_f32 v46,v236,v238
M v[104:107],a[252:255],a[196:199],v[104:107]
v_fmac_f32 v236,4.0,v238
v_fma_f32 v238,2.0,v142,v240
M v[108:111],a[252:255],a[200:203],v[108:111]
v_fma_f32 v142,s41,v142,v240
v_accvgpr_read_b32 v240,a47
M v[112:115],a[252:255],a[204:207],v[112:115]
v_accvgpr_read_b32 v239,a143
v_add_f32 v237,v240,v239
M v[116:119],a[252:255],a[208:211],v[116:119]
v_sub_f32 v240,v240,v239
v_add_f32 v239,v47,v143
M v[120:123],a[252:255],a[212:215],v[120:123]
s_waitcnt lgkmcnt(1)
v_sub_f32 v143,v47,v143
v_add_f32 v47,v237,v239
M v[124:127],a[252:255],a[216:219],v[124:127]
s_waitcnt vmcnt(12)
buffer_load_dwordx4 a[252:255],v253,s[20:23],s46 offen offset:0
M v[96:99],v[216:219],a[192:195],v[96:99]
ds_read_b128 a[192:195],v251 offset:17408
v_fmac_f32 v237,4.0,v239
M v[100:103],v[216:219],a[196:199],v[100:103]
ds_read_b128 a[196:199],v252 offset:17664
v_fma_f32 v239,2.0,v143,v240
M v[104:107],v[216:219],a[200:203],v[104:107]
ds_read_b128 a[200:203],v252 offset:17920
v_fma_f32 v143,s41,v143,v240
M v[108:111],v[216:219],a[204:207],v[108:111]
ds_read_b128 a[204:207],v252 offset:18176
v_cvt_pk_bf16_f32 v238,v238,v239
M v[112:115],v[216:219],a[208:211],v[112:115]
ds_read_b128 a[208:211],v252 offset:18432
v_accvgpr_write_b32 a15,v238
M v[116:119],v[216:219],a[212:215],v[116:119]
ds_read_b128 a[212:215],v252 offset:18688
v_cvt_pk_bf16_f32 v236,v236,v237
M v[120:123],v[216:219],a[216:219],v[120:123]
s_waitcnt lgkmcnt(6)
ds_read_b128 a[216:219],v252 offset:18944
v_accvgpr_write_b32 a111,v236
M v[124:127],v[216:219],a[220:223],v[124:127]
s_waitcnt vmcnt(12) lgkmcnt(6)
buffer_load_dwordx4 v[216:219],v253,s[20:23],s46 offen offset:1024
M v[96:99],v[220:223],a[192:195],v[96:99]
s_waitcnt lgkmcnt(5)
buffer_store_dwordx4 a[12:15],v254,s[24:27],s35 offen offset:384
M v[100:103],v[220:223],a[196:199],v[100:103]
s_waitcnt lgkmcnt(4)
buffer_store_dwordx4 a[108:111],v254,s[24:27],s35 offen offset:768
M v[104:107],v[220:223],a[200:203],v[104:107]
s_waitcnt lgkmcnt(3)
ds_read_b128 a[220:223],v252 offset:19200
ds_read_b128 a[192:195],v252 offset:19456
M v[108:111],v[220:223],a[204:207],v[108:111]
s_waitcnt lgkmcnt(4)
v_accvgpr_read_b32 v240,a48
v_accvgpr_read_b32 v238,a144
M v[112:115],v[220:223],a[208:211],v[112:115]
s_waitcnt lgkmcnt(3)
v_add_f32 v236,v240,v238
v_sub_f32 v240,v240,v238
M v[116:119],v[220:223],a[212:215],v[116:119]
s_waitcnt lgkmcnt(2)
v_add_f32 v238,v48,v144
v_sub_f32 v144,v48,v144
M v[120:123],v[220:223],a[216:219],v[120:123]
s_waitcnt lgkmcnt(1)
v_add_f32 v48,v236,v238
v_fmac_f32 v236,4.0,v238
M v[124:127],v[220:223],a[220:223],v[124:127]
s_waitcnt vmcnt(13)
buffer_load_dwordx4 v[220:223],v253,s[20:23],s46 offen offset:2048
M v[96:99],v[224:227],a[196:199],v[96:99]
ds_read_b128 a[196:199],v251 offset:19712
v_fma_f32 v238,2.0,v144,v240
M v[100:103],v[224:227],a[200:203],v[100:103]
s_add_u32 s47,s44,3072
v_fma_f32 v144,s41,v144,v240
v_accvgpr_read_b32 v240,a49
M v[104:107],v[224:227],a[204:207],v[104:107]
v_accvgpr_read_b32 v239,a145
v_add_f32 v237,v240,v239
M v[108:111],v[224:227],a[208:211],v[108:111]
v_sub_f32 v240,v240,v239
v_add_f32 v239,v49,v145
M v[112:115],v[224:227],a[212:215],v[112:115]
v_sub_f32 v145,v49,v145
v_add_f32 v49,v237,v239
M v[116:119],v[224:227],a[216:219],v[116:119]
v_fmac_f32 v237,4.0,v239
v_fma_f32 v239,2.0,v145,v240
M v[120:123],v[224:227],a[220:223],v[120:123]
s_waitcnt lgkmcnt(1)
v_fma_f32 v145,s41,v145,v240
v_cvt_pk_bf16_f32 v238,v238,v239
M v[124:127],v[224:227],a[192:195],v[124:127]
s_waitcnt vmcnt(13)
buffer_load_dwordx4 v[224:227],v253,s[20:23],s47 offen offset:0
M v[96:99],a[224:227],a[200:203],v[96:99]
ds_read_b128 a[200:203],v251 offset:34816
v_accvgpr_write_b32 a18,v238
M v[100:103],a[224:227],a[204:207],v[100:103]
ds_read_b128 a[204:207],v252 offset:35072
v_cvt_pk_bf16_f32 v236,v236,v237
M v[104:107],a[224:227],a[208:211],v[104:107]
ds_read_b128 a[208:211],v252 offset:35328
v_accvgpr_write_b32 a114,v236
M v[108:111],a[224:227],a[212:215],v[108:111]
ds_read_b128 a[212:215],v252 offset:35584
v_accvgpr_read_b32 v240,a50
M v[112:115],a[224:227],a[216:219],v[112:115]
ds_read_b128 a[216:219],v252 offset:35840
v_accvgpr_read_b32 v238,a146
M v[116:119],a[224:227],a[220:223],v[116:119]
ds_read_b128 a[220:223],v252 offset:36096
v_add_f32 v236,v240,v238
M v[120:123],a[224:227],a[192:195],v[120:123]
s_waitcnt lgkmcnt(6)
ds_read_b128 a[192:195],v252 offset:36352
v_sub_f32 v240,v240,v238
M v[124:127],a[224:227],a[196:199],v[124:127]
s_waitcnt vmcnt(13) lgkmcnt(6)
buffer_load_dwordx4 a[224:227],v253,s[20:23],s47 offen offset:1024
M v[96:99],a[228:231],a[200:203],v[96:99]
s_waitcnt lgkmcnt(5)
ds_read_b128 a[196:199],v252 offset:36608
ds_read_b128 a[200:203],v252 offset:36864
M v[100:103],a[228:231],a[204:207],v[100:103]
s_waitcnt lgkmcnt(6)
v_add_f32 v238,v50,v146
v_sub_f32 v146,v50,v146
M v[104:107],a[228:231],a[208:211],v[104:107]
s_waitcnt lgkmcnt(5)
v_add_f32 v50,v236,v238
v_fmac_f32 v236,4.0,v238
M v[108:111],a[228:231],a[212:215],v[108:111]
s_waitcnt lgkmcnt(4)
v_fma_f32 v238,2.0,v146,v240
v_fma_f32 v146,s41,v146,v240
M v[112:115],a[228:231],a[216:219],v[112:115]
s_waitcnt lgkmcnt(3)
v_accvgpr_read_b32 v240,a51
v_accvgpr_read_b32 v239,a147
M v[116:119],a[228:231],a[220:223],v[116:119]
s_waitcnt lgkmcnt(2)
v_add_f32 v237,v240,v239
v_sub_f32 v240,v240,v239
M v[120:123],a[228:231],a[192:195],v[120:123]
s_waitcnt lgkmcnt(1)
v_add_f32 v239,v51,v147
v_sub_f32 v147,v51,v147
M v[124:127],a[228:231],a[196:199],v[124:127]
s_waitcnt vmcnt(12)
buffer_load_dwordx4 a[228:231],v253,s[20:23],s47 offen offset:2048
M v[96:99],a[232:235],a[204:207],v[96:99]
ds_read_b128 a[204:207],v251 offset:37120
v_add_f32 v51,v237,v239
M v[100:103],a[232:235],a[208:211],v[100:103]
s_add_u32 s47,s44,58368
v_fmac_f32 v237,4.0,v239
v_fma_f32 v239,2.0,v147,v240
M v[104:107],a[232:235],a[212:215],v[104:107]
v_fma_f32 v147,s41,v147,v240
v_cvt_pk_bf16_f32 v238,v238,v239
M v[108:111],a[232:235],a[216:219],v[108:111]
v_accvgpr_write_b32 a19,v238
v_cvt_pk_bf16_f32 v236,v236,v237
M v[112:115],a[232:235],a[220:223],v[112:115]
v_accvgpr_write_b32 a115,v236
v_accvgpr_read_b32 v240,a52
M v[116:119],a[232:235],a[192:195],v[116:119]
buffer_store_dwordx4 a[16:19],v254,s[24:27],s36 offen offset:384
M v[120:123],a[232:235],a[196:199],v[120:123]
s_waitcnt lgkmcnt(1)
buffer_store_dwordx4 a[112:115],v254,s[24:27],s36 offen offset:768
M v[124:127],a[232:235],a[200:203],v[124:127]
s_waitcnt vmcnt(13)
buffer_load_dwordx4 a[232:235],v253,s[20:23],s47 offen offset:0
M v[96:99],a[236:239],a[208:211],v[96:99]
ds_read_b128 a[208:211],v251 offset:52224
v_accvgpr_read_b32 v238,a148
M v[100:103],a[236:239],a[212:215],v[100:103]
ds_read_b128 a[212:215],v252 offset:52480
v_add_f32 v236,v240,v238
M v[104:107],a[236:239],a[216:219],v[104:107]
ds_read_b128 a[216:219],v252 offset:52736
v_sub_f32 v240,v240,v238
M v[108:111],a[236:239],a[220:223],v[108:111]
ds_read_b128 a[220:223],v252 offset:52992
v_add_f32 v238,v52,v148
M v[112:115],a[236:239],a[192:195],v[112:115]
ds_read_b128 a[192:195],v252 offset:53248
v_sub_f32 v148,v52,v148
M v[116:119],a[236:239],a[196:199],v[116:119]
ds_read_b128 a[196:199],v252 offset:53504
v_add_f32 v52,v236,v238
M v[120:123],a[236:239],a[200:203],v[120:123]
s_waitcnt lgkmcnt(6)
ds_read_b128 a[200:203],v252 offset:53760
v_fmac_f32 v236,4.0,v238
M v[124:127],a[236:239],a[204:207],v[124:127]
s_waitcnt vmcnt(13) lgkmcnt(6)
buffer_load_dwordx4 a[236:239],v253,s[20:23],s47 offen offset:1024
M v[96:99],a[240:243],a[208:211],v[96:99]
s_waitcnt lgkmcnt(5)
ds_read_b128 a[204:207],v252 offset:54016
ds_read_b128 a[208:211],v252 offset:54272
M v[100:103],a[240:243],a[212:215],v[100:103]
s_waitcnt lgkmcnt(6)
v_fma_f32 v238,2.0,v148,v240
v_fma_f32 v148,s41,v148,v240
M v[104:107],a[240:243],a[216:219],v[104:107]
s_waitcnt lgkmcnt(5)
v_accvgpr_read_b32 v240,a53
v_accvgpr_read_b32 v239,a149
M v[108:111],a[240:243],a[220:223],v[108:111]
s_waitcnt lgkmcnt(4)
v_add_f32 v237,v240,v239
v_sub_f32 v240,v240,v239
M v[112:115],a[240:243],a[192:195],v[112:115]
s_waitcnt lgkmcnt(3)
v_add_f32 v239,v53,v149
v_sub_f32 v149,v53,v149
M v[116:119],a[240:243],a[196:199],v[116:119]
s_waitcnt lgkmcnt(2)
v_add_f32 v53,v237,v239
v_fmac_f32 v237,4.0,v239
M v[120:123],a[240:243],a[200:203],v[120:123]
s_waitcnt lgkmcnt(1)
v_fma_f32 v239,2.0,v149,v240
v_fma_f32 v149,s41,v149,v240
M v[124:127],a[240:243],a[204:207],v[124:127]
s_waitcnt vmcnt(13)
buffer_load_dwordx4 a[240:243],v253,s[20:23],s47 offen offset:2048
M v[96:99],a[244:247],a[212:215],v[96:99]
ds_read_b128 a[212:215],v251 offset:54528
v_cvt_pk_bf16_f32 v238,v238,v239
M v[100:103],a[244:247],a[216:219],v[100:103]
s_add_u32 s47,s44,113664
v_accvgpr_write_b32 a22,v238
v_cvt_pk_bf16_f32 v236,v236,v237
M v[104:107],a[244:247],a[220:223],v[104:107]
v_accvgpr_write_b32 a118,v236
v_accvgpr_read_b32 v240,a54
M v[108:111],a[244:247],a[192:195],v[108:111]
v_accvgpr_read_b32 v238,a150
v_add_f32 v236,v240,v238
M v[112:115],a[244:247],a[196:199],v[112:115]
v_sub_f32 v240,v240,v238
v_add_f32 v238,v54,v150
M v[116:119],a[244:247],a[200:203],v[116:119]
v_add_u32 v251,0xffffbc00,v251
v_add_u32 v252,0xffffbc00,v252
M v[120:123],a[244:247],a[204:207],v[120:123]
s_waitcnt lgkmcnt(1)
v_sub_f32 v150,v54,v150
v_add_f32 v54,v236,v238
M v[124:127],a[244:247],a[208:211],v[124:127]
s_waitcnt vmcnt(13)
buffer_load_dwordx4 a[244:247],v253,s[20:23],s47 offen offset:0
M v[96:99],a[248:251],a[216:219],v[96:99]
ds_read_b128 a[216:219],v251 offset:0
v_fmac_f32 v236,4.0,v238
M v[100:103],a[248:251],a[220:223],v[100:103]
ds_read_b128 a[220:223],v252 offset:256
v_fma_f32 v238,2.0,v150,v240
M v[104:107],a[248:251],a[192:195],v[104:107]
ds_read_b128 a[192:195],v252 offset:512
v_fma_f32 v150,s41,v150,v240
M v[108:111],a[248:251],a[196:199],v[108:111]
ds_read_b128 a[196:199],v252 offset:768
v_accvgpr_read_b32 v240,a55
M v[112:115],a[248:251],a[200:203],v[112:115]
ds_read_b128 a[200:203],v252 offset:1024
v_accvgpr_read_b32 v239,a151
M v[116:119],a[248:251],a[204:207],v[116:119]
ds_read_b128 a[204:207],v252 offset:1280
v_add_f32 v237,v240,v239
M v[120:123],a[248:251],a[208:211],v[120:123]
s_waitcnt lgkmcnt(6)
ds_read_b128 a[208:211],v252 offset:1536
v_sub_f32 v240,v240,v239
M v[124:127],a[248:251],a[212:215],v[124:127]
s_waitcnt vmcnt(13) lgkmcnt(6)
buffer_load_dwordx4 a[248:251],v253,s[20:23],s47 offen offset:1024
M v[96:99],a[252:255],a[216:219],v[96:99]
s_waitcnt lgkmcnt(5)
ds_read_b128 a[212:215],v252 offset:1792
ds_read_b128 a[216:219],v252 offset:2048
M v[100:103],a[252:255],a[220:223],v[100:103]
s_waitcnt lgkmcnt(6)
v_add_f32 v239,v55,v151
v_sub_f32 v151,v55,v151
M v[104:107],a[252:255],a[192:195],v[104:107]
s_waitcnt lgkmcnt(5)
v_add_f32 v55,v237,v239
v_fmac_f32 v237,4.0,v239
M v[108:111],a[252:255],a[196:199],v[108:111]
s_waitcnt lgkmcnt(4)
v_fma_f32 v239,2.0,v151,v240
v_fma_f32 v151,s41,v151,v240
M v[112:115],a[252:255],a[200:203],v[112:115]
s_waitcnt lgkmcnt(3)
v_cvt_pk_bf16_f32 v238,v238,v239
v_accvgpr_write_b32 a23,v238
M v[116:119],a[252:255],a[204:207],v[116:119]
s_waitcnt lgkmcnt(2)
v_cvt_pk_bf16_f32 v236,v236,v237
v_accvgpr_write_b32 a119,v236
M v[120:123],a[252:255],a[208:211],v[120:123]
s_waitcnt lgkmcnt(1)
buffer_store_dwordx4 a[20:23],v254,s[24:27],s37 offen offset:384
v_accvgpr_read_b32 v240,a56
v_accvgpr_read_b32 v238,a152
v_add_f32 v236,v240,v238
M v[124:127],a[252:255],a[212:215],v[124:127]
s_waitcnt vmcnt(14)
buffer_load_dwordx4 a[252:255],v253,s[20:23],s47 offen offset:2048
v_sub_f32 v240,v240,v238
v_add_f32 v238,v56,v152
v_sub_f32 v152,v56,v152
v_add_f32 v56,v236,v238
M v[96:99],v[216:219],a[220:223],v[96:99]
buffer_store_dwordx4 a[116:119],v254,s[24:27],s37 offen offset:768
v_fmac_f32 v236,4.0,v238
v_fma_f32 v238,2.0,v152,v240
v_fma_f32 v152,s41,v152,v240
v_accvgpr_read_b32 v240,a57
M v[100:103],v[216:219],a[192:195],v[100:103]
s_add_u32 s47,s44,168960
ds_read_b128 a[220:223],v251 offset:2304
v_accvgpr_read_b32 v239,a153
v_add_f32 v237,v240,v239
v_sub_f32 v240,v240,v239
v_add_f32 v239,v57,v153
M v[104:107],v[216:219],a[196:199],v[104:107]
v_sub_f32 v153,v57,v153
v_add_f32 v57,v237,v239
v_fmac_f32 v237,4.0,v239
v_fma_f32 v239,2.0,v153,v240
M v[108:111],v[216:219],a[200:203],v[108:111]
v_fma_f32 v153,s41,v153,v240
v_cvt_pk_bf16_f32 v238,v238,v239
v_accvgpr_write_b32 a26,v238
v_cvt_pk_bf16_f32 v236,v236,v237
M v[112:115],v[216:219],a[204:207],v[112:115]
v_accvgpr_write_b32 a122,v236
v_accvgpr_read_b32 v240,a58
v_accvgpr_read_b32 v238,a154
v_add_f32 v236,v240,v238
M v[116:119],v[216:219],a[208:211],v[116:119]
v_sub_f32 v240,v240,v238
v_add_f32 v238,v58,v154
v_sub_f32 v154,v58,v154
v_add_f32 v58,v236,v238
M v[120:123],v[216:219],a[212:215],v[120:123]
s_waitcnt lgkmcnt(1)
v_add_u32 v251,0xfffece00,v251
v_add_u32 v252,0xfffece00,v252
v_fmac_f32 v236,4.0,v238
v_fma_f32 v238,2.0,v154,v240
v_fma_f32 v154,s41,v154,v240
v_accvgpr_read_b32 v240,a59
M v[124:127],v[216:219],a[216:219],v[124:127]
s_waitcnt vmcnt(13)
buffer_load_dwordx4 v[216:219],v253,s[20:23],s47 offen offset:0
v_accvgpr_read_b32 v239,a155
v_add_f32 v237,v240,v239
v_sub_f32 v240,v240,v239
v_add_f32 v239,v59,v155
M v[96:99],v[220:223],a[192:195],v[96:99]
ds_read_b128 a[192:195],v251 offset:0
v_sub_f32 v155,v59,v155
v_add_f32 v59,v237,v239
v_fmac_f32 v237,4.0,v239
v_fma_f32 v239,2.0,v155,v240
M v[100:103],v[220:223],a[196:199],v[100:103]
ds_read_b128 a[196:199],v252 offset:256
v_fma_f32 v155,s41,v155,v240
v_cvt_pk_bf16_f32 v238,v238,v239
v_accvgpr_write_b32 a27,v238
v_cvt_pk_bf16_f32 v236,v236,v237
M v[104:107],v[220:223],a[200:203],v[104:107]
ds_read_b128 a[200:203],v252 offset:512
v_accvgpr_write_b32 a123,v236
v_accvgpr_read_b32 v240,a60
v_accvgpr_read_b32 v238,a156
v_add_f32 v236,v240,v238
M v[108:111],v[220:223],a[204:207],v[108:111]
ds_read_b128 a[204:207],v252 offset:768
v_sub_f32 v240,v240,v238
v_add_f32 v238,v60,v156
v_sub_f32 v156,v60,v156
v_add_f32 v60,v236,v238
M v[112:115],v[220:223],a[208:211],v[112:115]
ds_read_b128 a[208:211],v252 offset:1024
v_fmac_f32 v236,4.0,v238
v_fma_f32 v238,2.0,v156,v240
v_fma_f32 v156,s41,v156,v240
v_accvgpr_read_b32 v240,a61
M v[116:119],v[220:223],a[212:215],v[116:119]
ds_read_b128 a[212:215],v252 offset:1280
v_accvgpr_read_b32 v239,a157
v_add_f32 v237,v240,v239
v_sub_f32 v240,v240,v239
v_add_f32 v239,v61,v157
M v[120:123],v[220:223],a[216:219],v[120:123]
s_waitcnt lgkmcnt(6)
ds_read_b128 a[216:219],v252 offset:1536
v_sub_f32 v157,v61,v157
v_add_f32 v61,v237,v239
v_fmac_f32 v237,4.0,v239
v_fma_f32 v239,2.0,v157,v240
M v[124:127],v[220:223],a[220:223],v[124:127]
s_waitcnt vmcnt(13) lgkmcnt(6)
buffer_load_dwordx4 v[220:223],v253,s[20:23],s47 offen offset:1024
v_fma_f32 v157,s41,v157,v240
v_cvt_pk_bf16_f32 v238,v238,v239
v_accvgpr_write_b32 a30,v238
v_cvt_pk_bf16_f32 v236,v236,v237
M v[32:35],v[224:227],a[192:195],v[32:35]
s_waitcnt lgkmcnt(5)
ds_read_b128 a[220:223],v252 offset:1792
ds_read_b128 a[192:195],v252 offset:2048
v_accvgpr_write_b32 a126,v236
v_accvgpr_read_b32 v240,a62
v_accvgpr_read_b32 v238,a158
v_add_f32 v236,v240,v238
M v[36:39],v[224:227],a[196:199],v[36:39]
s_waitcnt lgkmcnt(6)
v_sub_f32 v240,v240,v238
v_add_f32 v238,v62,v158
v_sub_f32 v158,v62,v158
v_add_f32 v62,v236,v238
M v[40:43],v[224:227],a[200:203],v[40:43]
s_waitcnt lgkmcnt(5)
v_fmac_f32 v236,4.0,v238
v_fma_f32 v238,2.0,v158,v240
v_fma_f32 v158,s41,v158,v240
v_accvgpr_read_b32 v240,a63
M v[44:47],v[224:227],a[204:207],v[44:47]
s_waitcnt lgkmcnt(4)
v_accvgpr_read_b32 v239,a159
v_add_f32 v237,v240,v239
v_sub_f32 v240,v240,v239
v_add_f32 v239,v63,v159
M v[48:51],v[224:227],a[208:211],v[48:51]
s_waitcnt lgkmcnt(3)
v_sub_f32 v159,v63,v159
v_cvt_pk_bf16_f32 v96,v96,v97
M v[52:55],v[224:227],a[212:215],v[52:55]
s_waitcnt lgkmcnt(2)
v_cvt_pk_bf16_f32 v97,v98,v99
v_add_f32 v63,v237,v239
M v[56:59],v[224:227],a[216:219],v[56:59]
s_waitcnt lgkmcnt(1)
v_cvt_pk_bf16_f32 v100,v100,v101
v_cvt_pk_bf16_f32 v101,v102,v103
M v[60:63],v[224:227],a[220:223],v[60:63]
s_waitcnt vmcnt(13)
buffer_load_dwordx4 v[224:227],v253,s[20:23],s47 offen offset:2048
M v[32:35],a[224:227],a[196:199],v[32:35]
ds_read_b128 a[196:199],v251 offset:2304
v_cvt_pk_bf16_f32 v104,v104,v105
M v[36:39],a[224:227],a[200:203],v[36:39]
s_add_u32 s47,s44,224256
v_cvt_pk_bf16_f32 v105,v106,v107
v_cvt_pk_bf16_f32 v108,v108,v109
M v[40:43],a[224:227],a[204:207],v[40:43]
buffer_store_dwordx4 a[24:27],v254,s[24:27],s38 offen offset:384
M v[44:47],a[224:227],a[208:211],v[44:47]
v_cvt_pk_bf16_f32 v109,v110,v111
v_cvt_pk_bf16_f32 v112,v112,v113
M v[48:51],a[224:227],a[212:215],v[48:51]
v_cvt_pk_bf16_f32 v113,v114,v115
v_cvt_pk_bf16_f32 v116,v116,v117
M v[52:55],a[224:227],a[216:219],v[52:55]
v_cvt_pk_bf16_f32 v117,v118,v119
v_cvt_pk_bf16_f32 v120,v120,v121
M v[56:59],a[224:227],a[220:223],v[56:59]
s_waitcnt lgkmcnt(1)
v_cvt_pk_bf16_f32 v121,v122,v123
v_cvt_pk_bf16_f32 v124,v124,v125
M v[60:63],a[224:227],a[192:195],v[60:63]
s_waitcnt vmcnt(14)
buffer_load_dwordx4 a[224:227],v253,s[20:23],s47 offen offset:0
M v[32:35],a[228:231],a[200:203],v[32:35]
v_cvt_pk_bf16_f32 v125,v126,v127
v_add_u32 v251,0x15400,v251
M v[36:39],a[228:231],a[204:207],v[36:39]
v_add_u32 v252,0x15400,v252
v_fmac_f32 v237,4.0,v239
M v[40:43],a[228:231],a[208:211],v[40:43]
ds_read_b128 a[200:203],v251 offset:0
ds_read_b128 a[204:207],v252 offset:256
M v[44:47],a[228:231],a[212:215],v[44:47]
ds_read_b128 a[208:211],v252 offset:512
ds_read_b128 a[212:215],v252 offset:768
M v[48:51],a[228:231],a[216:219],v[48:51]
ds_read_b128 a[216:219],v252 offset:1024
v_fma_f32 v239,2.0,v159,v240
M v[52:55],a[228:231],a[220:223],v[52:55]
ds_read_b128 a[220:223],v252 offset:1280
v_fma_f32 v159,s41,v159,v240
M v[56:59],a[228:231],a[192:195],v[56:59]
s_waitcnt lgkmcnt(6)
ds_read_b128 a[192:195],v252 offset:1536
v_cvt_pk_bf16_f32 v238,v238,v239
M v[60:63],a[228:231],a[196:199],v[60:63]
s_waitcnt vmcnt(12) lgkmcnt(6)
buffer_load_dwordx4 a[228:231],v253,s[20:23],s47 offen offset:1024
M v[32:35],a[232:235],a[200:203],v[32:35]
s_waitcnt lgkmcnt(5)
ds_read_b128 a[196:199],v252 offset:1792
ds_read_b128 a[200:203],v252 offset:2048
M v[36:39],a[232:235],a[204:207],v[36:39]
s_waitcnt lgkmcnt(6)
v_accvgpr_write_b32 a31,v238
v_cvt_pk_bf16_f32 v236,v236,v237
M v[40:43],a[232:235],a[208:211],v[40:43]
s_waitcnt lgkmcnt(5)
v_accvgpr_write_b32 a127,v236
v_accvgpr_read_b32 v240,a64
M v[44:47],a[232:235],a[212:215],v[44:47]
s_waitcnt lgkmcnt(4)
v_accvgpr_read_b32 v238,a160
v_add_f32 v236,v240,v238
M v[48:51],a[232:235],a[216:219],v[48:51]
s_waitcnt lgkmcnt(3)
v_sub_f32 v240,v240,v238
v_add_f32 v238,v64,v160
M v[52:55],a[232:235],a[220:223],v[52:55]
s_waitcnt lgkmcnt(2)
v_sub_f32 v160,v64,v160
v_add_f32 v64,v236,v238
M v[56:59],a[232:235],a[192:195],v[56:59]
s_waitcnt lgkmcnt(1)
v_fmac_f32 v236,4.0,v238
v_fma_f32 v238,2.0,v160,v240
M v[60:63],a[232:235],a[196:199],v[60:63]
s_waitcnt vmcnt(12)
buffer_load_dwordx4 a[232:235],v253,s[20:23],s47 offen offset:2048
M v[32:35],a[236:239],a[204:207],v[32:35]
ds_read_b128 a[204:207],v251 offset:2304
v_fma_f32 v160,s41,v160,v240
M v[36:39],a[236:239],a[208:211],v[36:39]
s_add_u32 s47,s44,279552
v_accvgpr_read_b32 v240,a65
v_accvgpr_read_b32 v239,a161
M v[40:43],a[236:239],a[212:215],v[40:43]
v_add_f32 v237,v240,v239
v_sub_f32 v240,v240,v239
M v[44:47],a[236:239],a[216:219],v[44:47]
buffer_store_dwordx4 a[120:123],v254,s[24:27],s38 offen offset:768
M v[48:51],a[236:239],a[220:223],v[48:51]
v_add_f32 v239,v65,v161
v_sub_f32 v161,v65,v161
M v[52:55],a[236:239],a[192:195],v[52:55]
v_add_f32 v65,v237,v239
v_fmac_f32 v237,4.0,v239
M v[56:59],a[236:239],a[196:199],v[56:59]
s_waitcnt lgkmcnt(1)
v_fma_f32 v239,2.0,v161,v240
v_fma_f32 v161,s41,v161,v240
M v[60:63],a[236:239],a[200:203],v[60:63]
s_waitcnt vmcnt(13)
buffer_load_dwordx4 a[236:239],v253,s[20:23],s47 offen offset:0
M v[32:35],a[240:243],a[208:211],v[32:35]
ds_read_b128 a[208:211],v251 offset:17408
v_cvt_pk_bf16_f32 v228,v238,v239
M v[36:39],a[240:243],a[212:215],v[36:39]
ds_read_b128 a[212:215],v252 offset:17664
v_cvt_pk_bf16_f32 v230,v236,v237
M v[40:43],a[240:243],a[216:219],v[40:43]
ds_read_b128 a[216:219],v252 offset:17920
v_accvgpr_read_b32 v240,a66
M v[44:47],a[240:243],a[220:223],v[44:47]
ds_read_b128 a[220:223],v252 offset:18176
v_accvgpr_read_b32 v238,a162
M v[48:51],a[240:243],a[192:195],v[48:51]
ds_read_b128 a[192:195],v252 offset:18432
v_add_f32 v236,v240,v238
M v[52:55],a[240:243],a[196:199],v[52:55]
ds_read_b128 a[196:199],v252 offset:18688
v_sub_f32 v240,v240,v238
M v[56:59],a[240:243],a[200:203],v[56:59]
s_waitcnt lgkmcnt(6)
ds_read_b128 a[200:203],v252 offset:18944
v_add_f32 v238,v66,v162
M v[60:63],a[240:243],a[204:207],v[60:63]
s_waitcnt vmcnt(13) lgkmcnt(6)
buffer_load_dwordx4 a[240:243],v253,s[20:23],s47 offen offset:1024
M v[32:35],a[244:247],a[208:211],v[32:35]
s_waitcnt lgkmcnt(5)
ds_read_b128 a[204:207],v252 offset:19200
ds_read_b128 a[208:211],v252 offset:19456
M v[36:39],a[244:247],a[212:215],v[36:39]
s_waitcnt lgkmcnt(6)
v_sub_f32 v162,v66,v162
v_add_f32 v66,v236,v238
M v[40:43],a[244:247],a[216:219],v[40:43]
s_waitcnt lgkmcnt(5)
v_fmac_f32 v236,4.0,v238
v_fma_f32 v238,2.0,v162,v240
M v[44:47],a[244:247],a[220:223],v[44:47]
s_waitcnt lgkmcnt(4)
v_fma_f32 v162,s41,v162,v240
v_accvgpr_read_b32 v240,a67
M v[48:51],a[244:247],a[192:195],v[48:51]
s_waitcnt lgkmcnt(3)
v_accvgpr_read_b32 v239,a163
v_add_f32 v237,v240,v239
M v[52:55],a[244:247],a[196:199],v[52:55]
s_waitcnt lgkmcnt(2)
v_sub_f32 v240,v240,v239
v_add_f32 v239,v67,v163
M v[56:59],a[244:247],a[200:203],v[56:59]
s_waitcnt lgkmcnt(1)
v_sub_f32 v163,v67,v163
v_add_f32 v67,v237,v239
M v[60:63],a[244:247],a[204:207],v[60:63]
s_waitcnt vmcnt(13)
buffer_load_dwordx4 a[244:247],v253,s[20:23],s47 offen offset:2048
M v[32:35],a[248:251],a[212:215],v[32:35]
ds_read_b128 a[212:215],v251 offset:19712
v_fmac_f32 v237,4.0,v239
M v[36:39],a[248:251],a[216:219],v[36:39]
s_add_u32 s47,s44,49152
v_fma_f32 v239,2.0,v163,v240
v_fma_f32 v163,s41,v163,v240
M v[40:43],a[248:251],a[220:223],v[40:43]
v_cvt_pk_bf16_f32 v229,v238,v239
v_cvt_pk_bf16_f32 v231,v236,v237
M v[44:47],a[248:251],a[192:195],v[44:47]
buffer_store_dwordx2 v[228:229],v255,s[24:27],s32 offen offset:384
M v[48:51],a[248:251],a[196:199],v[48:51]
buffer_store_dwordx2 v[230:231],v255,s[24:27],s32 offen offset:768
M v[52:55],a[248:251],a[200:203],v[52:55]
buffer_store_dwordx4 a[28:31],v254,s[24:27],s39 offen offset:384
M v[56:59],a[248:251],a[204:207],v[56:59]
s_waitcnt lgkmcnt(1)
v_accvgpr_read_b32 v240,a68
v_accvgpr_read_b32 v238,a164
M v[60:63],a[248:251],a[208:211],v[60:63]
s_waitcnt vmcnt(15)
buffer_load_dwordx4 a[248:251],v253,s[20:23],s47 offen offset:0
M v[32:35],a[252:255],a[216:219],v[32:35]
ds_read_b128 a[216:219],v251 offset:34816
v_add_f32 v236,v240,v238
M v[36:39],a[252:255],a[220:223],v[36:39]
ds_read_b128 a[220:223],v252 offset:35072
v_sub_f32 v240,v240,v238
M v[40:43],a[252:255],a[192:195],v[40:43]
ds_read_b128 a[192:195],v252 offset:35328
v_add_f32 v238,v68,v164
M v[44:47],a[252:255],a[196:199],v[44:47]
ds_read_b128 a[196:199],v252 offset:35584
v_sub_f32 v164,v68,v164
M v[48:51],a[252:255],a[200:203],v[48:51]
ds_read_b128 a[200:203],v252 offset:35840
v_add_f32 v68,v236,v238
M v[52:55],a[252:255],a[204:207],v[52:55]
ds_read_b128 a[204:207],v252 offset:36096
v_fmac_f32 v236,4.0,v238
M v[56:59],a[252:255],a[208:211],v[56:59]
s_waitcnt lgkmcnt(6)
ds_read_b128 a[208:211],v252 offset:36352
v_fma_f32 v238,2.0,v164,v240
M v[60:63],a[252:255],a[212:215],v[60:63]
s_waitcnt vmcnt(14) lgkmcnt(6)
buffer_load_dwordx4 a[252:255],v253,s[20:23],s47 offen offset:1024
M v[32:35],v[216:219],a[216:219],v[32:35]
s_waitcnt lgkmcnt(5)
ds_read_b128 a[212:215],v252 offset:36608
ds_read_b128 a[216:219],v252 offset:36864
M v[36:39],v[216:219],a[220:223],v[36:39]
s_waitcnt lgkmcnt(6)
v_fma_f32 v164,s41,v164,v240
v_accvgpr_read_b32 v240,a69
M v[40:43],v[216:219],a[192:195],v[40:43]
s_waitcnt lgkmcnt(5)
v_accvgpr_read_b32 v239,a165
v_add_f32 v237,v240,v239
M v[44:47],v[216:219],a[196:199],v[44:47]
s_waitcnt lgkmcnt(4)
v_sub_f32 v240,v240,v239
v_add_f32 v239,v69,v165
M v[48:51],v[216:219],a[200:203],v[48:51]
s_waitcnt lgkmcnt(3)
v_sub_f32 v165,v69,v165
v_add_f32 v69,v237,v239
M v[52:55],v[216:219],a[204:207],v[52:55]
s_waitcnt lgkmcnt(2)
v_fmac_f32 v237,4.0,v239
v_fma_f32 v239,2.0,v165,v240
M v[56:59],v[216:219],a[208:211],v[56:59]
s_waitcnt lgkmcnt(1)
v_fma_f32 v165,s41,v165,v240
v_cvt_pk_bf16_f32 v232,v238,v239
M v[60:63],v[216:219],a[212:215],v[60:63]
s_waitcnt vmcnt(14)
buffer_load_dwordx4 v[216:219],v253,s[20:23],s47 offen offset:2048
M v[32:35],v[220:223],a[220:223],v[32:35]
ds_read_b128 a[220:223],v251 offset:37120
v_cvt_pk_bf16_f32 v234,v236,v237
M v[36:39],v[220:223],a[192:195],v[36:39]
s_add_u32 s47,s44,104448
v_accvgpr_read_b32 v240,a70
v_accvgpr_read_b32 v238,a166
M v[40:43],v[220:223],a[196:199],v[40:43]
v_add_f32 v236,v240,v238
v_sub_f32 v240,v240,v238
M v[44:47],v[220:223],a[200:203],v[44:47]
v_add_f32 v238,v70,v166
v_sub_f32 v166,v70,v166
M v[48:51],v[220:223],a[204:207],v[48:51]
v_add_f32 v70,v236,v238
v_fmac_f32 v236,4.0,v238
M v[52:55],v[220:223],a[208:211],v[52:55]
v_fma_f32 v238,2.0,v166,v240
v_fma_f32 v166,s41,v166,v240
M v[56:59],v[220:223],a[212:215],v[56:59]
s_waitcnt lgkmcnt(1)
buffer_store_dwordx4 a[124:127],v254,s[24:27],s39 offen offset:768
M v[60:63],v[220:223],a[216:219],v[60:63]
s_waitcnt vmcnt(15)
buffer_load_dwordx4 v[220:223],v253,s[20:23],s47 offen offset:0
M v[32:35],v[224:227],a[192:195],v[32:35]
ds_read_b128 a[192:195],v251 offset:52224
v_accvgpr_read_b32 v240,a71
M v[36:39],v[224:227],a[196:199],v[36:39]
ds_read_b128 a[196:199],v252 offset:52480
v_accvgpr_read_b32 v239,a167
M v[40:43],v[224:227],a[200:203],v[40:43]
ds_read_b128 a[200:203],v252 offset:52736
v_add_f32 v237,v240,v239
M v[44:47],v[224:227],a[204:207],v[44:47]
ds_read_b128 a[204:207],v252 offset:52992
v_sub_f32 v240,v240,v239
M v[48:51],v[224:227],a[208:211],v[48:51]
ds_read_b128 a[208:211],v252 offset:53248
v_add_f32 v239,v71,v167
M v[52:55],v[224:227],a[212:215],v[52:55]
ds_read_b128 a[212:215],v252 offset:53504
v_sub_f32 v167,v71,v167
M v[56:59],v[224:227],a[216:219],v[56:59]
s_waitcnt lgkmcnt(6)
ds_read_b128 a[216:219],v252 offset:53760
v_add_f32 v71,v237,v239
M v[60:63],v[224:227],a[220:223],v[60:63]
s_waitcnt vmcnt(14) lgkmcnt(6)
buffer_load_dwordx4 v[224:227],v253,s[20:23],s47 offen offset:1024
M v[32:35],a[224:227],a[192:195],v[32:35]
s_waitcnt lgkmcnt(5)
ds_read_b128 a[220:223],v252 offset:54016
ds_read_b128 a[192:195],v252 offset:54272
M v[36:39],a[224:227],a[196:199],v[36:39]
s_waitcnt lgkmcnt(6)
v_fmac_f32 v237,4.0,v239
v_fma_f32 v239,2.0,v167,v240
M v[40:43],a[224:227],a[200:203],v[40:43]
s_waitcnt lgkmcnt(5)
v_fma_f32 v167,s41,v167,v240
v_cvt_pk_bf16_f32 v233,v238,v239
M v[44:47],a[224:227],a[204:207],v[44:47]
s_waitcnt lgkmcnt(4)
v_cvt_pk_bf16_f32 v235,v236,v237
M v[48:51],a[224:227],a[208:211],v[48:51]
s_waitcnt lgkmcnt(3)
buffer_store_dwordx2 v[232:233],v255,s[24:27],s33 offen offset:384
M v[52:55],a[224:227],a[212:215],v[52:55]
s_waitcnt lgkmcnt(2)
buffer_store_dwordx2 v[234:235],v255,s[24:27],s33 offen offset:768
M v[56:59],a[224:227],a[216:219],v[56:59]
s_waitcnt lgkmcnt(1)
v_accvgpr_read_b32 v240,a72
v_accvgpr_read_b32 v238,a168
M v[60:63],a[224:227],a[220:223],v[60:63]
s_waitcnt vmcnt(16)
buffer_load_dwordx4 a[224:227],v253,s[20:23],s47 offen offset:2048
M v[32:35],a[228:231],a[196:199],v[32:35]
ds_read_b128 a[196:199],v251 offset:54528
v_add_f32 v236,v240,v238
M v[36:39],a[228:231],a[200:203],v[36:39]
s_add_u32 s47,s44,159744
v_sub_f32 v240,v240,v238
v_add_f32 v238,v72,v168
M v[40:43],a[228:231],a[204:207],v[40:43]
v_sub_f32 v168,v72,v168
v_add_f32 v72,v236,v238
M v[44:47],a[228:231],a[208:211],v[44:47]
v_fmac_f32 v236,4.0,v238
v_fma_f32 v238,2.0,v168,v240
M v[48:51],a[228:231],a[212:215],v[48:51]
v_fma_f32 v168,s41,v168,v240
v_accvgpr_read_b32 v240,a73
M v[52:55],a[228:231],a[216:219],v[52:55]
v_add_u32 v251,0xfffece00,v251
v_add_u32 v252,0xfffece00,v252
M v[56:59],a[228:231],a[220:223],v[56:59]
s_waitcnt lgkmcnt(1)
v_accvgpr_read_b32 v239,a169
v_add_f32 v237,v240,v239
M v[60:63],a[228:231],a[192:195],v[60:63]
s_waitcnt vmcnt(16)
buffer_load_dwordx4 a[228:231],v253,s[20:23],s47 offen offset:0
M v[32:35],a[232:235],a[200:203],v[32:35]
ds_read_b128 a[200:203],v251 offset:60928
v_sub_f32 v240,v240,v239
M v[36:39],a[232:235],a[204:207],v[36:39]
ds_read_b128 a[204:207],v252 offset:61184
v_add_f32 v239,v73,v169
M v[40:43],a[232:235],a[208:211],v[40:43]
ds_read_b128 a[208:211],v252 offset:61440
v_sub_f32 v169,v73,v169
M v[44:47],a[232:235],a[212:215],v[44:47]
ds_read_b128 a[212:215],v252 offset:61696
v_add_f32 v73,v237,v239
M v[48:51],a[232:235],a[216:219],v[48:51]
ds_read_b128 a[216:219],v252 offset:61952
v_fmac_f32 v237,4.0,v239
M v[52:55],a[232:235],a[220:223],v[52:55]
ds_read_b128 a[220:223],v252 offset:62208
v_fma_f32 v239,2.0,v169,v240
M v[56:59],a[232:235],a[192:195],v[56:59]
s_waitcnt lgkmcnt(6)
ds_read_b128 a[192:195],v252 offset:62464
v_fma_f32 v169,s41,v169,v240
M v[60:63],a[232:235],a[196:199],v[60:63]
s_waitcnt vmcnt(15) lgkmcnt(6)
buffer_load_dwordx4 a[232:235],v253,s[20:23],s47 offen offset:1024
M v[32:35],a[236:239],a[200:203],v[32:35]
s_waitcnt lgkmcnt(5)
ds_read_b128 a[196:199],v252 offset:62720
ds_read_b128 a[200:203],v252 offset:62976
M v[36:39],a[236:239],a[204:207],v[36:39]
s_waitcnt lgkmcnt(6)
v_cvt_pk_bf16_f32 v228,v238,v239
v_cvt_pk_bf16_f32 v230,v236,v237
M v[40:43],a[236:239],a[208:211],v[40:43]
s_waitcnt lgkmcnt(5)
v_accvgpr_read_b32 v240,a74
v_accvgpr_read_b32 v238,a170
M v[44:47],a[236:239],a[212:215],v[44:47]
s_waitcnt lgkmcnt(4)
v_add_f32 v236,v240,v238
v_sub_f32 v240,v240,v238
M v[48:51],a[236:239],a[216:219],v[48:51]
s_waitcnt lgkmcnt(3)
v_add_f32 v238,v74,v170
v_sub_f32 v170,v74,v170
M v[52:55],a[236:239],a[220:223],v[52:55]
s_waitcnt lgkmcnt(2)
v_add_f32 v74,v236,v238
v_fmac_f32 v236,4.0,v238
M v[56:59],a[236:239],a[192:195],v[56:59]
s_waitcnt lgkmcnt(1)
v_fma_f32 v238,2.0,v170,v240
v_fma_f32 v170,s41,v170,v240
M v[60:63],a[236:239],a[196:199],v[60:63]
s_waitcnt vmcnt(15)
buffer_load_dwordx4 a[236:239],v253,s[20:23],s47 offen offset:2048
M v[32:35],a[240:243],a[204:207],v[32:35]
ds_read_b128 a[204:207],v251 offset:63232
v_accvgpr_read_b32 v240,a75
M v[36:39],a[240:243],a[208:211],v[36:39]
s_add_u32 s47,s44,215040
v_accvgpr_read_b32 v239,a171
v_add_f32 v237,v240,v239
M v[40:43],a[240:243],a[212:215],v[40:43]
v_sub_f32 v240,v240,v239
v_add_f32 v239,v75,v171
M v[44:47],a[240:243],a[216:219],v[44:47]
v_sub_f32 v171,v75,v171
v_add_f32 v75,v237,v239
M v[48:51],a[240:243],a[220:223],v[48:51]
v_fmac_f32 v237,4.0,v239
v_fma_f32 v239,2.0,v171,v240
M v[52:55],a[240:243],a[192:195],v[52:55]
v_fma_f32 v171,s41,v171,v240
v_cvt_pk_bf16_f32 v229,v238,v239
M v[56:59],a[240:243],a[196:199],v[56:59]
s_waitcnt lgkmcnt(1)
v_cvt_pk_bf16_f32 v231,v236,v237
M v[60:63],a[240:243],a[200:203],v[60:63]
s_waitcnt vmcnt(15)
buffer_load_dwordx4 a[240:243],v253,s[20:23],s47 offen offset:0
M v[32:35],a[244:247],a[208:211],v[32:35]
ds_read_b128 a[208:211],v251 offset:0
buffer_store_dwordx2 v[228:229],v255,s[24:27],s34 offen offset:384
M v[36:39],a[244:247],a[212:215],v[36:39]
ds_read_b128 a[212:215],v252 offset:256
buffer_store_dwordx2 v[230:231],v255,s[24:27],s34 offen offset:768
M v[40:43],a[244:247],a[216:219],v[40:43]
ds_read_b128 a[216:219],v252 offset:512
v_accvgpr_read_b32 v240,a76
M v[44:47],a[244:247],a[220:223],v[44:47]
ds_read_b128 a[220:223],v252 offset:768
v_cvt_pk_bf16_f32 v2,v32,v33
M v[48:51],a[244:247],a[192:195],v[48:51]
ds_read_b128 a[192:195],v252 offset:1024
v_cvt_pk_bf16_f32 v3,v34,v35
M v[52:55],a[244:247],a[196:199],v[52:55]
buffer_store_dwordx4 v[0:3],v254,s[24:27],s32 offen offset:0
M v[56:59],a[244:247],a[200:203],v[56:59]
s_waitcnt lgkmcnt(5)
ds_read_b128 a[196:199],v252 offset:1280
ds_read_b128 a[200:203],v252 offset:1536
M v[60:63],a[244:247],a[204:207],v[60:63]
s_waitcnt vmcnt(15) lgkmcnt(6)
buffer_load_dwordx4 a[244:247],v253,s[20:23],s47 offen offset:1024
M v[128:131],a[248:251],a[208:211],v[128:131]
s_waitcnt lgkmcnt(5)
ds_read_b128 a[204:207],v252 offset:1792
ds_read_b128 a[208:211],v252 offset:2048
M v[132:135],a[248:251],a[212:215],v[132:135]
s_waitcnt lgkmcnt(6)
v_cvt_pk_bf16_f32 v6,v36,v37
v_cvt_pk_bf16_f32 v7,v38,v39
M v[136:139],a[248:251],a[216:219],v[136:139]
s_waitcnt lgkmcnt(5)
buffer_store_dwordx4 v[4:7],v254,s[24:27],s33 offen offset:0
M v[140:143],a[248:251],a[220:223],v[140:143]
s_waitcnt lgkmcnt(4)
v_cvt_pk_bf16_f32 v10,v40,v41
v_cvt_pk_bf16_f32 v11,v42,v43
M v[144:147],a[248:251],a[192:195],v[144:147]
s_waitcnt lgkmcnt(3)
v_cvt_pk_bf16_f32 v14,v44,v45
v_cvt_pk_bf16_f32 v15,v46,v47
M v[148:151],a[248:251],a[196:199],v[148:151]
s_waitcnt lgkmcnt(2)
v_cvt_pk_bf16_f32 v18,v48,v49
v_cvt_pk_bf16_f32 v19,v50,v51
M v[152:155],a[248:251],a[200:203],v[152:155]
s_waitcnt lgkmcnt(1)
v_cvt_pk_bf16_f32 v22,v52,v53
v_cvt_pk_bf16_f32 v23,v54,v55
M v[156:159],a[248:251],a[204:207],v[156:159]
s_waitcnt vmcnt(16)
buffer_load_dwordx4 a[248:251],v253,s[20:23],s47 offen offset:2048
M v[128:131],a[252:255],a[212:215],v[128:131]
ds_read_b128 a[212:215],v251 offset:2304
v_cvt_pk_bf16_f32 v26,v56,v57
M v[132:135],a[252:255],a[216:219],v[132:135]
s_add_u32 s47,s44,270336
v_cvt_pk_bf16_f32 v27,v58,v59
v_cvt_pk_bf16_f32 v30,v60,v61
M v[136:139],a[252:255],a[220:223],v[136:139]
v_cvt_pk_bf16_f32 v31,v62,v63
v_accvgpr_read_b32 v238,a172
M v[140:143],a[252:255],a[192:195],v[140:143]
v_add_f32 v236,v240,v238
v_sub_f32 v240,v240,v238
M v[144:147],a[252:255],a[196:199],v[144:147]
v_add_f32 v238,v76,v172
v_sub_f32 v172,v76,v172
M v[148:151],a[252:255],a[200:203],v[148:151]
v_add_u32 v251,0x15400,v251
v_add_u32 v252,0x15400,v252
M v[152:155],a[252:255],a[204:207],v[152:155]
s_waitcnt lgkmcnt(1)
v_add_f32 v76,v236,v238
v_fmac_f32 v236,4.0,v238
M v[156:159],a[252:255],a[208:211],v[156:159]
s_waitcnt vmcnt(16)
buffer_load_dwordx4 a[252:255],v253,s[20:23],s47 offen offset:0
M v[128:131],v[216:219],a[216:219],v[128:131]
ds_read_b128 a[216:219],v251 offset:0
v_fma_f32 v238,2.0,v172,v240
M v[132:135],v[216:219],a[220:223],v[132:135]
ds_read_b128 a[220:223],v252 offset:256
v_fma_f32 v172,s41,v172,v240
M v[136:139],v[216:219],a[192:195],v[136:139]
ds_read_b128 a[192:195],v252 offset:512
v_accvgpr_read_b32 v240,a77
M v[140:143],v[216:219],a[196:199],v[140:143]
buffer_store_dwordx4 v[8:11],v254,s[24:27],s34 offen offset:0
M v[144:147],v[216:219],a[200:203],v[144:147]
ds_read_b128 a[196:199],v252 offset:768
ds_read_b128 a[200:203],v252 offset:1024
M v[148:151],v[216:219],a[204:207],v[148:151]
ds_read_b128 a[204:207],v252 offset:1280
v_accvgpr_read_b32 v239,a173
M v[152:155],v[216:219],a[208:211],v[152:155]
s_waitcnt lgkmcnt(6)
ds_read_b128 a[208:211],v252 offset:1536
v_add_f32 v237,v240,v239
M v[156:159],v[216:219],a[212:215],v[156:159]
s_waitcnt vmcnt(16) lgkmcnt(6)
buffer_load_dwordx4 v[216:219],v253,s[20:23],s47 offen offset:1024
M v[128:131],v[220:223],a[216:219],v[128:131]
s_waitcnt lgkmcnt(5)
ds_read_b128 a[212:215],v252 offset:1792
ds_read_b128 a[216:219],v252 offset:2048
M v[132:135],v[220:223],a[220:223],v[132:135]
s_waitcnt lgkmcnt(6)
v_sub_f32 v240,v240,v239
v_add_f32 v239,v77,v173
M v[136:139],v[220:223],a[192:195],v[136:139]
s_waitcnt lgkmcnt(5)
v_sub_f32 v173,v77,v173
v_add_f32 v77,v237,v239
M v[140:143],v[220:223],a[196:199],v[140:143]
s_waitcnt lgkmcnt(4)
v_fmac_f32 v237,4.0,v239
v_fma_f32 v239,2.0,v173,v240
M v[144:147],v[220:223],a[200:203],v[144:147]
s_waitcnt lgkmcnt(3)
v_fma_f32 v173,s41,v173,v240
v_cvt_pk_bf16_f32 v232,v238,v239
M v[148:151],v[220:223],a[204:207],v[148:151]
s_waitcnt lgkmcnt(2)
v_cvt_pk_bf16_f32 v234,v236,v237
v_accvgpr_read_b32 v240,a78
M v[152:155],v[220:223],a[208:211],v[152:155]
s_waitcnt lgkmcnt(1)
v_accvgpr_read_b32 v238,a174
v_add_f32 v236,v240,v238
M v[156:159],v[220:223],a[212:215],v[156:159]
s_waitcnt vmcnt(16)
buffer_load_dwordx4 v[220:223],v253,s[20:23],s47 offen offset:2048
M v[128:131],v[224:227],a[220:223],v[128:131]
ds_read_b128 a[220:223],v251 offset:2304
v_sub_f32 v240,v240,v238
M v[132:135],v[224:227],a[192:195],v[132:135]
s_add_u32 s47,s44,325632
v_add_f32 v238,v78,v174
v_sub_f32 v174,v78,v174
M v[136:139],v[224:227],a[196:199],v[136:139]
v_add_f32 v78,v236,v238
v_fmac_f32 v236,4.0,v238
M v[140:143],v[224:227],a[200:203],v[140:143]
v_fma_f32 v238,2.0,v174,v240
v_fma_f32 v174,s41,v174,v240
M v[144:147],v[224:227],a[204:207],v[144:147]
v_accvgpr_read_b32 v240,a79
v_accvgpr_read_b32 v239,a175
M v[148:151],v[224:227],a[208:211],v[148:151]
v_add_f32 v237,v240,v239
v_sub_f32 v240,v240,v239
M v[152:155],v[224:227],a[212:215],v[152:155]
s_waitcnt lgkmcnt(1)
v_add_f32 v239,v79,v175
v_sub_f32 v175,v79,v175
M v[156:159],v[224:227],a[216:219],v[156:159]
s_waitcnt vmcnt(14)
buffer_load_dwordx4 v[224:227],v253,s[20:23],s47 offen offset:0
M v[128:131],a[224:227],a[192:195],v[128:131]
ds_read_b128 a[192:195],v251 offset:17408
v_add_f32 v79,v237,v239
M v[132:135],a[224:227],a[196:199],v[132:135]
ds_read_b128 a[196:199],v252 offset:17664
v_fmac_f32 v237,4.0,v239
M v[136:139],a[224:227],a[200:203],v[136:139]
ds_read_b128 a[200:203],v252 offset:17920
v_fma_f32 v239,2.0,v175,v240
M v[140:143],a[224:227],a[204:207],v[140:143]
ds_read_b128 a[204:207],v252 offset:18176
v_fma_f32 v175,s41,v175,v240
M v[144:147],a[224:227],a[208:211],v[144:147]
buffer_store_dwordx4 v[12:15],v254,s[24:27],s35 offen offset:0
M v[148:151],a[224:227],a[212:215],v[148:151]
ds_read_b128 a[208:211],v252 offset:18432
ds_read_b128 a[212:215],v252 offset:18688
M v[152:155],a[224:227],a[216:219],v[152:155]
s_waitcnt lgkmcnt(6)
ds_read_b128 a[216:219],v252 offset:18944
v_cvt_pk_bf16_f32 v233,v238,v239
M v[156:159],a[224:227],a[220:223],v[156:159]
s_waitcnt vmcnt(15) lgkmcnt(6)
buffer_load_dwordx4 a[224:227],v253,s[20:23],s47 offen offset:1024
M v[128:131],a[228:231],a[192:195],v[128:131]
s_waitcnt lgkmcnt(5)
ds_read_b128 a[220:223],v252 offset:19200
ds_read_b128 a[192:195],v252 offset:19456
M v[132:135],a[228:231],a[196:199],v[132:135]
s_waitcnt lgkmcnt(6)
v_cvt_pk_bf16_f32 v235,v236,v237
M v[136:139],a[228:231],a[200:203],v[136:139]
s_waitcnt lgkmcnt(5)
buffer_store_dwordx2 v[232:233],v255,s[24:27],s35 offen offset:384
M v[140:143],a[228:231],a[204:207],v[140:143]
s_waitcnt lgkmcnt(4)
buffer_store_dwordx2 v[234:235],v255,s[24:27],s35 offen offset:768
M v[144:147],a[228:231],a[208:211],v[144:147]
s_waitcnt lgkmcnt(3)
v_accvgpr_read_b32 v240,a80
v_accvgpr_read_b32 v238,a176
M v[148:151],a[228:231],a[212:215],v[148:151]
s_waitcnt lgkmcnt(2)
v_add_f32 v236,v240,v238
v_sub_f32 v240,v240,v238
M v[152:155],a[228:231],a[216:219],v[152:155]
s_waitcnt lgkmcnt(1)
v_add_f32 v238,v80,v176
v_sub_f32 v176,v80,v176
M v[156:159],a[228:231],a[220:223],v[156:159]
s_waitcnt vmcnt(17)
buffer_load_dwordx4 a[228:231],v253,s[20:23],s47 offen offset:2048
M v[128:131],a[232:235],a[196:199],v[128:131]
ds_read_b128 a[196:199],v251 offset:19712
v_add_f32 v80,v236,v238
M v[132:135],a[232:235],a[200:203],v[132:135]
s_add_u32 s48,s44,6144
v_fmac_f32 v236,4.0,v238
v_fma_f32 v238,2.0,v176,v240
M v[136:139],a[232:235],a[204:207],v[136:139]
v_fma_f32 v176,s41,v176,v240
v_accvgpr_read_b32 v240,a81
M v[140:143],a[232:235],a[208:211],v[140:143]
v_accvgpr_read_b32 v239,a177
v_add_f32 v237,v240,v239
M v[144:147],a[232:235],a[212:215],v[144:147]
v_sub_f32 v240,v240,v239
v_add_f32 v239,v81,v177
M v[148:151],a[232:235],a[216:219],v[148:151]
v_sub_f32 v177,v81,v177
v_add_f32 v81,v237,v239
M v[152:155],a[232:235],a[220:223],v[152:155]
s_waitcnt lgkmcnt(1)
v_fmac_f32 v237,4.0,v239
v_fma_f32 v239,2.0,v177,v240
M v[156:159],a[232:235],a[192:195],v[156:159]
s_waitcnt vmcnt(17)
buffer_load_dwordx4 a[232:235],v253,s[20:23],s48 offen offset:0
M v[128:131],a[236:239],a[200:203],v[128:131]
ds_read_b128 a[200:203],v251 offset:34816
v_fma_f32 v177,s41,v177,v240
M v[132:135],a[236:239],a[204:207],v[132:135]
ds_read_b128 a[204:207],v252 offset:35072
v_cvt_pk_bf16_f32 v228,v238,v239
M v[136:139],a[236:239],a[208:211],v[136:139]
ds_read_b128 a[208:211],v252 offset:35328
v_cvt_pk_bf16_f32 v230,v236,v237
M v[140:143],a[236:239],a[212:215],v[140:143]
ds_read_b128 a[212:215],v252 offset:35584
v_accvgpr_read_b32 v240,a82
M v[144:147],a[236:239],a[216:219],v[144:147]
ds_read_b128 a[216:219],v252 offset:35840
v_accvgpr_read_b32 v238,a178
M v[148:151],a[236:239],a[220:223],v[148:151]
ds_read_b128 a[220:223],v252 offset:36096
v_add_f32 v236,v240,v238
M v[152:155],a[236:239],a[192:195],v[152:155]
s_waitcnt lgkmcnt(6)
buffer_store_dwordx4 v[16:19],v254,s[24:27],s36 offen offset:0
M v[156:159],a[236:239],a[196:199],v[156:159]
s_waitcnt vmcnt(18) lgkmcnt(5)
buffer_load_dwordx4 a[236:239],v253,s[20:23],s48 offen offset:1024
M v[128:131],a[240:243],a[200:203],v[128:131]
s_waitcnt lgkmcnt(4)
ds_read_b128 a[192:195],v252 offset:36352
ds_read_b128 a[196:199],v252 offset:36608
M v[132:135],a[240:243],a[204:207],v[132:135]
s_waitcnt lgkmcnt(5)
ds_read_b128 a[200:203],v252 offset:36864
v_sub_f32 v240,v240,v238
M v[136:139],a[240:243],a[208:211],v[136:139]
s_waitcnt lgkmcnt(5)
v_add_f32 v238,v82,v178
v_sub_f32 v178,v82,v178
M v[140:143],a[240:243],a[212:215],v[140:143]
s_waitcnt lgkmcnt(4)
v_add_f32 v82,v236,v238
v_fmac_f32 v236,4.0,v238
M v[144:147],a[240:243],a[216:219],v[144:147]
s_waitcnt lgkmcnt(3)
v_fma_f32 v238,2.0,v178,v240
v_fma_f32 v178,s41,v178,v240
M v[148:151],a[240:243],a[220:223],v[148:151]
s_waitcnt lgkmcnt(2)
v_accvgpr_read_b32 v240,a83
v_accvgpr_read_b32 v239,a179
M v[152:155],a[240:243],a[192:195],v[152:155]
s_waitcnt lgkmcnt(1)
v_add_f32 v237,v240,v239
v_sub_f32 v240,v240,v239
M v[156:159],a[240:243],a[196:199],v[156:159]
s_waitcnt vmcnt(15)
buffer_load_dwordx4 a[240:243],v253,s[20:23],s48 offen offset:2048
M v[128:131],a[244:247],a[204:207],v[128:131]
ds_read_b128 a[204:207],v251 offset:37120
v_add_f32 v239,v83,v179
M v[132:135],a[244:247],a[208:211],v[132:135]
s_add_u32 s48,s44,61440
v_sub_f32 v179,v83,v179
v_add_f32 v83,v237,v239
M v[136:139],a[244:247],a[212:215],v[136:139]
v_fmac_f32 v237,4.0,v239
v_fma_f32 v239,2.0,v179,v240
M v[140:143],a[244:247],a[216:219],v[140:143]
v_fma_f32 v179,s41,v179,v240
v_cvt_pk_bf16_f32 v229,v238,v239
M v[144:147],a[244:247],a[220:223],v[144:147]
v_cvt_pk_bf16_f32 v231,v236,v237
M v[148:151],a[244:247],a[192:195],v[148:151]
buffer_store_dwordx2 v[228:229],v255,s[24:27],s36 offen offset:384
M v[152:155],a[244:247],a[196:199],v[152:155]
s_waitcnt lgkmcnt(1)
buffer_store_dwordx2 v[230:231],v255,s[24:27],s36 offen offset:768
M v[156:159],a[244:247],a[200:203],v[156:159]
s_waitcnt vmcnt(16)
buffer_load_dwordx4 a[244:247],v253,s[20:23],s48 offen offset:0
M v[128:131],a[248:251],a[208:211],v[128:131]
buffer_store_dwordx4 v[20:23],v254,s[24:27],s37 offen offset:0
M v[132:135],a[248:251],a[212:215],v[132:135]
ds_read_b128 a[208:211],v251 offset:52224
ds_read_b128 a[212:215],v252 offset:52480
M v[136:139],a[248:251],a[216:219],v[136:139]
ds_read_b128 a[216:219],v252 offset:52736
v_accvgpr_read_b32 v240,a84
M v[140:143],a[248:251],a[220:223],v[140:143]
ds_read_b128 a[220:223],v252 offset:52992
v_accvgpr_read_b32 v238,a180
M v[144:147],a[248:251],a[192:195],v[144:147]
ds_read_b128 a[192:195],v252 offset:53248
v_add_f32 v236,v240,v238
M v[148:151],a[248:251],a[196:199],v[148:151]
ds_read_b128 a[196:199],v252 offset:53504
v_sub_f32 v240,v240,v238
M v[152:155],a[248:251],a[200:203],v[152:155]
s_waitcnt lgkmcnt(6)
ds_read_b128 a[200:203],v252 offset:53760
v_add_f32 v238,v84,v180
M v[156:159],a[248:251],a[204:207],v[156:159]
s_waitcnt vmcnt(17) lgkmcnt(6)
buffer_load_dwordx4 a[248:251],v253,s[20:23],s48 offen offset:1024
M v[128:131],a[252:255],a[208:211],v[128:131]
s_waitcnt lgkmcnt(5)
ds_read_b128 a[204:207],v252 offset:54016
ds_read_b128 a[208:211],v252 offset:54272
M v[132:135],a[252:255],a[212:215],v[132:135]
s_waitcnt lgkmcnt(6)
v_sub_f32 v180,v84,v180
v_add_f32 v84,v236,v238
M v[136:139],a[252:255],a[216:219],v[136:139]
s_waitcnt lgkmcnt(5)
v_fmac_f32 v236,4.0,v238
v_fma_f32 v238,2.0,v180,v240
M v[140:143],a[252:255],a[220:223],v[140:143]
s_waitcnt lgkmcnt(4)
v_fma_f32 v180,s41,v180,v240
v_accvgpr_read_b32 v240,a85
M v[144:147],a[252:255],a[192:195],v[144:147]
s_waitcnt lgkmcnt(3)
v_accvgpr_read_b32 v239,a181
v_add_f32 v237,v240,v239
M v[148:151],a[252:255],a[196:199],v[148:151]
s_waitcnt lgkmcnt(2)
v_sub_f32 v240,v240,v239
v_add_f32 v239,v85,v181
M v[152:155],a[252:255],a[200:203],v[152:155]
s_waitcnt lgkmcnt(1)
v_sub_f32 v181,v85,v181
v_add_f32 v85,v237,v239
M v[156:159],a[252:255],a[204:207],v[156:159]
s_waitcnt vmcnt(16)
buffer_load_dwordx4 a[252:255],v253,s[20:23],s48 offen offset:2048
M v[128:131],v[216:219],a[212:215],v[128:131]
buffer_store_dwordx4 v[24:27],v254,s[24:27],s38 offen offset:0
M v[132:135],v[216:219],a[216:219],v[132:135]
s_add_u32 s48,s44,116736
ds_read_b128 a[212:215],v251 offset:54528
v_fmac_f32 v237,4.0,v239
M v[136:139],v[216:219],a[220:223],v[136:139]
v_fma_f32 v239,2.0,v181,v240
v_fma_f32 v181,s41,v181,v240
M v[140:143],v[216:219],a[192:195],v[140:143]
v_cvt_pk_bf16_f32 v232,v238,v239
v_cvt_pk_bf16_f32 v234,v236,v237
M v[144:147],v[216:219],a[196:199],v[144:147]
v_accvgpr_read_b32 v240,a86
v_accvgpr_read_b32 v238,a182
M v[148:151],v[216:219],a[200:203],v[148:151]
v_add_u32 v251,0xffffbc00,v251
v_add_u32 v252,0xffffbc00,v252
M v[152:155],v[216:219],a[204:207],v[152:155]
s_waitcnt lgkmcnt(1)
v_add_f32 v236,v240,v238
v_sub_f32 v240,v240,v238
M v[156:159],v[216:219],a[208:211],v[156:159]
s_waitcnt vmcnt(17)
buffer_load_dwordx4 v[216:219],v253,s[20:23],s48 offen offset:0
M v[128:131],v[220:223],a[216:219],v[128:131]
ds_read_b128 a[216:219],v251 offset:0
v_add_f32 v238,v86,v182
M v[132:135],v[220:223],a[220:223],v[132:135]
ds_read_b128 a[220:223],v252 offset:256
v_sub_f32 v182,v86,v182
M v[136:139],v[220:223],a[192:195],v[136:139]
ds_read_b128 a[192:195],v252 offset:512
v_add_f32 v86,v236,v238
M v[140:143],v[220:223],a[196:199],v[140:143]
ds_read_b128 a[196:199],v252 offset:768
v_fmac_f32 v236,4.0,v238
M v[144:147],v[220:223],a[200:203],v[144:147]
ds_read_b128 a[200:203],v252 offset:1024
v_fma_f32 v238,2.0,v182,v240
M v[148:151],v[220:223],a[204:207],v[148:151]
ds_read_b128 a[204:207],v252 offset:1280
v_fma_f32 v182,s41,v182,v240
M v[152:155],v[220:223],a[208:211],v[152:155]
s_waitcnt lgkmcnt(6)
ds_read_b128 a[208:211],v252 offset:1536
v_accvgpr_read_b32 v240,a87
M v[156:159],v[220:223],a[212:215],v[156:159]
s_waitcnt vmcnt(17) lgkmcnt(6)
buffer_load_dwordx4 v[220:223],v253,s[20:23],s48 offen offset:1024
v_accvgpr_read_b32 v239,a183
v_add_f32 v237,v240,v239
M v[128:131],v[224:227],a[216:219],v[128:131]
s_waitcnt lgkmcnt(5)
ds_read_b128 a[212:215],v252 offset:1792
ds_read_b128 a[216:219],v252 offset:2048
v_sub_f32 v240,v240,v239
v_add_f32 v239,v87,v183
v_sub_f32 v183,v87,v183
v_add_f32 v87,v237,v239
M v[132:135],v[224:227],a[220:223],v[132:135]
s_waitcnt lgkmcnt(6)
buffer_store_dwordx4 v[28:31],v254,s[24:27],s39 offen offset:0
v_fmac_f32 v237,4.0,v239
v_fma_f32 v239,2.0,v183,v240
v_fma_f32 v183,s41,v183,v240
v_cvt_pk_bf16_f32 v233,v238,v239
M v[136:139],v[224:227],a[192:195],v[136:139]
s_waitcnt lgkmcnt(5)
v_cvt_pk_bf16_f32 v235,v236,v237
M v[140:143],v[224:227],a[196:199],v[140:143]
s_waitcnt lgkmcnt(4)
buffer_store_dwordx2 v[232:233],v255,s[24:27],s37 offen offset:384
buffer_store_dwordx2 v[234:235],v255,s[24:27],s37 offen offset:768
M v[144:147],v[224:227],a[200:203],v[144:147]
s_waitcnt lgkmcnt(3)
v_accvgpr_read_b32 v240,a88
v_accvgpr_read_b32 v238,a184
M v[148:151],v[224:227],a[204:207],v[148:151]
s_waitcnt lgkmcnt(2)
v_add_f32 v236,v240,v238
v_sub_f32 v240,v240,v238
M v[152:155],v[224:227],a[208:211],v[152:155]
s_waitcnt lgkmcnt(1)
v_add_f32 v238,v88,v184
v_sub_f32 v184,v88,v184
v_add_f32 v88,v236,v238
v_fmac_f32 v236,4.0,v238
M v[156:159],v[224:227],a[212:215],v[156:159]
s_waitcnt vmcnt(19)
buffer_load_dwordx4 v[224:227],v253,s[20:23],s48 offen offset:2048
v_fma_f32 v238,2.0,v184,v240
v_fma_f32 v184,s41,v184,v240
v_accvgpr_read_b32 v240,a89
v_accvgpr_read_b32 v239,a185
M v[128:131],a[224:227],a[220:223],v[128:131]
ds_read_b128 a[220:223],v251 offset:2304
v_add_f32 v237,v240,v239
v_sub_f32 v240,v240,v239
v_add_f32 v239,v89,v185
v_sub_f32 v185,v89,v185
M v[132:135],a[224:227],a[192:195],v[132:135]
s_add_u32 s48,s44,172032
v_add_f32 v89,v237,v239
v_fmac_f32 v237,4.0,v239
v_fma_f32 v239,2.0,v185,v240
v_fma_f32 v185,s41,v185,v240
M v[136:139],a[224:227],a[196:199],v[136:139]
v_cvt_pk_bf16_f32 v228,v238,v239
v_cvt_pk_bf16_f32 v230,v236,v237
v_accvgpr_read_b32 v240,a90
v_accvgpr_read_b32 v238,a186
M v[140:143],a[224:227],a[200:203],v[140:143]
v_add_f32 v236,v240,v238
v_sub_f32 v240,v240,v238
v_add_f32 v238,v90,v186
v_sub_f32 v186,v90,v186
M v[144:147],a[224:227],a[204:207],v[144:147]
v_add_f32 v90,v236,v238
v_fmac_f32 v236,4.0,v238
v_fma_f32 v238,2.0,v186,v240
v_fma_f32 v186,s41,v186,v240
M v[148:151],a[224:227],a[208:211],v[148:151]
v_accvgpr_read_b32 v240,a91
v_accvgpr_read_b32 v239,a187
v_add_f32 v237,v240,v239
v_sub_f32 v240,v240,v239
M v[152:155],a[224:227],a[212:215],v[152:155]
s_waitcnt lgkmcnt(1)
v_add_u32 v251,0xfffece00,v251
v_add_u32 v252,0xfffece00,v252
v_add_f32 v239,v91,v187
v_sub_f32 v187,v91,v187
v_add_f32 v91,v237,v239
v_fmac_f32 v237,4.0,v239
M v[156:159],a[224:227],a[216:219],v[156:159]
s_waitcnt vmcnt(17)
buffer_load_dwordx4 a[224:227],v253,s[20:23],s48 offen offset:0
v_fma_f32 v239,2.0,v187,v240
v_fma_f32 v187,s41,v187,v240
v_cvt_pk_bf16_f32 v229,v238,v239
v_cvt_pk_bf16_f32 v231,v236,v237
M v[128:131],a[228:231],a[192:195],v[128:131]
buffer_store_dwordx2 v[228:229],v255,s[24:27],s38 offen offset:384
M v[132:135],a[228:231],a[196:199],v[132:135]
ds_read_b128 a[192:195],v251 offset:0
buffer_store_dwordx2 v[230:231],v255,s[24:27],s38 offen offset:768
M v[136:139],a[228:231],a[200:203],v[136:139]
ds_read_b128 a[196:199],v252 offset:256
ds_read_b128 a[200:203],v252 offset:512
v_accvgpr_read_b32 v240,a92
M v[140:143],a[228:231],a[204:207],v[140:143]
ds_read_b128 a[204:207],v252 offset:768
v_accvgpr_read_b32 v238,a188
v_add_f32 v236,v240,v238
v_sub_f32 v240,v240,v238
v_add_f32 v238,v92,v188
M v[144:147],a[228:231],a[208:211],v[144:147]
ds_read_b128 a[208:211],v252 offset:1024
v_sub_f32 v188,v92,v188
v_add_f32 v92,v236,v238
v_fmac_f32 v236,4.0,v238
v_fma_f32 v238,2.0,v188,v240
M v[148:151],a[228:231],a[212:215],v[148:151]
ds_read_b128 a[212:215],v252 offset:1280
v_fma_f32 v188,s41,v188,v240
v_accvgpr_read_b32 v240,a93
v_accvgpr_read_b32 v239,a189
v_add_f32 v237,v240,v239
M v[152:155],a[228:231],a[216:219],v[152:155]
s_waitcnt lgkmcnt(6)
ds_read_b128 a[216:219],v252 offset:1536
v_sub_f32 v240,v240,v239
v_add_f32 v239,v93,v189
v_sub_f32 v189,v93,v189
v_add_f32 v93,v237,v239
M v[156:159],a[228:231],a[220:223],v[156:159]
s_waitcnt vmcnt(19) lgkmcnt(6)
buffer_load_dwordx4 a[228:231],v253,s[20:23],s48 offen offset:1024
v_fmac_f32 v237,4.0,v239
v_fma_f32 v239,2.0,v189,v240
v_fma_f32 v189,s41,v189,v240
v_cvt_pk_bf16_f32 v232,v238,v239
M v[64:67],a[232:235],a[192:195],v[64:67]
s_waitcnt lgkmcnt(5)
ds_read_b128 a[220:223],v252 offset:1792
ds_read_b128 a[192:195],v252 offset:2048
v_cvt_pk_bf16_f32 v234,v236,v237
v_accvgpr_read_b32 v240,a94
v_accvgpr_read_b32 v238,a190
v_add_f32 v236,v240,v238
M v[68:71],a[232:235],a[196:199],v[68:71]
s_waitcnt lgkmcnt(6)
v_sub_f32 v240,v240,v238
v_add_f32 v238,v94,v190
v_sub_f32 v190,v94,v190
v_add_f32 v94,v236,v238
M v[72:75],a[232:235],a[200:203],v[72:75]
s_waitcnt lgkmcnt(5)
v_fmac_f32 v236,4.0,v238
v_fma_f32 v238,2.0,v190,v240
v_fma_f32 v190,s41,v190,v240
v_accvgpr_read_b32 v240,a95
M v[76:79],a[232:235],a[204:207],v[76:79]
s_waitcnt lgkmcnt(4)
v_accvgpr_read_b32 v239,a191
v_add_f32 v237,v240,v239
v_sub_f32 v240,v240,v239
v_add_f32 v239,v95,v191
M v[80:83],a[232:235],a[208:211],v[80:83]
s_waitcnt lgkmcnt(3)
v_sub_f32 v191,v95,v191
v_cvt_pk_bf16_f32 v98,v128,v129
M v[84:87],a[232:235],a[212:215],v[84:87]
s_waitcnt lgkmcnt(2)
v_cvt_pk_bf16_f32 v99,v130,v131
v_add_f32 v95,v237,v239
M v[88:91],a[232:235],a[216:219],v[88:91]
s_waitcnt lgkmcnt(1)
buffer_store_dwordx4 v[96:99],v254,s[24:27],s32 offen offset:1152
M v[92:95],a[232:235],a[220:223],v[92:95]
s_waitcnt vmcnt(19)
buffer_load_dwordx4 a[232:235],v253,s[20:23],s48 offen offset:2048
M v[64:67],a[236:239],a[196:199],v[64:67]
ds_read_b128 a[196:199],v251 offset:2304
v_cvt_pk_bf16_f32 v102,v132,v133
M v[68:71],a[236:239],a[200:203],v[68:71]
s_add_u32 s48,s44,227328
v_cvt_pk_bf16_f32 v103,v134,v135
v_cvt_pk_bf16_f32 v106,v136,v137
M v[72:75],a[236:239],a[204:207],v[72:75]
v_cvt_pk_bf16_f32 v107,v138,v139
v_cvt_pk_bf16_f32 v110,v140,v141
M v[76:79],a[236:239],a[208:211],v[76:79]
buffer_store_dwordx4 v[100:103],v254,s[24:27],s33 offen offset:1152
M v[80:83],a[236:239],a[212:215],v[80:83]
v_cvt_pk_bf16_f32 v111,v142,v143
v_cvt_pk_bf16_f32 v114,v144,v145
M v[84:87],a[236:239],a[216:219],v[84:87]
v_cvt_pk_bf16_f32 v115,v146,v147
v_cvt_pk_bf16_f32 v118,v148,v149
M v[88:91],a[236:239],a[220:223],v[88:91]
s_waitcnt lgkmcnt(1)
v_cvt_pk_bf16_f32 v119,v150,v151
v_cvt_pk_bf16_f32 v122,v152,v153
M v[92:95],a[236:239],a[192:195],v[92:95]
s_waitcnt vmcnt(20)
buffer_load_dwordx4 a[236:239],v253,s[20:23],s48 offen offset:0
M v[64:67],a[240:243],a[200:203],v[64:67]
v_cvt_pk_bf16_f32 v123,v154,v155
v_cvt_pk_bf16_f32 v126,v156,v157
M v[68:71],a[240:243],a[204:207],v[68:71]
v_cvt_pk_bf16_f32 v127,v158,v159
v_add_u32 v251,0x15400,v251
v_add_u32 v252,0x15400,v252
M v[72:75],a[240:243],a[208:211],v[72:75]
ds_read_b128 a[200:203],v251 offset:0
ds_read_b128 a[204:207],v252 offset:256
M v[76:79],a[240:243],a[212:215],v[76:79]
ds_read_b128 a[208:211],v252 offset:512
ds_read_b128 a[212:215],v252 offset:768
M v[80:83],a[240:243],a[216:219],v[80:83]
ds_read_b128 a[216:219],v252 offset:1024
v_fmac_f32 v237,4.0,v239
M v[84:87],a[240:243],a[220:223],v[84:87]
ds_read_b128 a[220:223],v252 offset:1280
v_fma_f32 v239,2.0,v191,v240
M v[88:91],a[240:243],a[192:195],v[88:91]
s_waitcnt lgkmcnt(6)
ds_read_b128 a[192:195],v252 offset:1536
v_fma_f32 v191,s41,v191,v240
M v[92:95],a[240:243],a[196:199],v[92:95]
s_waitcnt vmcnt(18) lgkmcnt(6)
buffer_load_dwordx4 a[240:243],v253,s[20:23],s48 offen offset:1024
M v[64:67],a[244:247],a[200:203],v[64:67]
s_waitcnt lgkmcnt(5)
ds_read_b128 a[196:199],v252 offset:1792
ds_read_b128 a[200:203],v252 offset:2048
M v[68:71],a[244:247],a[204:207],v[68:71]
s_waitcnt lgkmcnt(6)
v_cvt_pk_bf16_f32 v233,v238,v239
v_cvt_pk_bf16_f32 v235,v236,v237
M v[72:75],a[244:247],a[208:211],v[72:75]
s_waitcnt lgkmcnt(5)
buffer_store_dwordx2 v[232:233],v255,s[24:27],s39 offen offset:384
M v[76:79],a[244:247],a[212:215],v[76:79]
s_waitcnt lgkmcnt(4)
buffer_store_dwordx2 v[234:235],v255,s[24:27],s39 offen offset:768
M v[80:83],a[244:247],a[216:219],v[80:83]
s_waitcnt lgkmcnt(3)
buffer_store_dwordx4 v[104:107],v254,s[24:27],s34 offen offset:1152
M v[84:87],a[244:247],a[220:223],v[84:87]
s_waitcnt lgkmcnt(2)
v_lshlrev_b32 v230,16,v208
v_lshlrev_b32 v228,16,v204
M v[88:91],a[244:247],a[192:195],v[88:91]
s_waitcnt lgkmcnt(1)
v_lshlrev_b32 v229,16,v206
v_lshlrev_b32 v233,16,v214
M v[92:95],a[244:247],a[196:199],v[92:95]
s_waitcnt vmcnt(20)
buffer_load_dwordx4 a[244:247],v253,s[20:23],s48 offen offset:2048
M v[64:67],a[248:251],a[204:207],v[64:67]
ds_read_b128 a[204:207],v251 offset:2304
v_lshlrev_b32 v232,16,v212
M v[68:71],a[248:251],a[208:211],v[68:71]
s_add_u32 s48,s44,282624
v_lshlrev_b32 v231,16,v210
v_fmac_f32 v228,s43,v230
M v[72:75],a[248:251],a[212:215],v[72:75]
v_fmac_f32 v233,4.0,v229
v_fma_f32 v234,-4.0,v230,v232
M v[76:79],a[248:251],a[216:219],v[76:79]
v_fmac_f32 v228,s45,v232
v_fmac_f32 v233,s40,v231
M v[80:83],a[248:251],a[220:223],v[80:83]
v_sub_f32 v232,v232,v230
v_fma_f32 v230,-4.0,v229,v231
M v[84:87],a[248:251],a[192:195],v[84:87]
v_sub_f32 v231,v231,v229
v_add_f32 v229,v234,v230
M v[88:91],a[248:251],a[196:199],v[88:91]
s_waitcnt lgkmcnt(1)
v_sub_f32 v234,v234,v230
v_fma_f32 v230,2.0,v231,v232
M v[92:95],a[248:251],a[200:203],v[92:95]
s_waitcnt vmcnt(20)
buffer_load_dwordx4 a[248:251],v253,s[20:23],s48 offen offset:0
M v[64:67],a[252:255],a[208:211],v[64:67]
ds_read_b128 a[208:211],v251 offset:17408
v_fmac_f32 v232,-2.0,v231
M v[68:71],a[252:255],a[212:215],v[68:71]
ds_read_b128 a[212:215],v252 offset:17664
v_and_b32 v237,s42,v208
M v[72:75],a[252:255],a[216:219],v[72:75]
ds_read_b128 a[216:219],v252 offset:17920
v_and_b32 v235,s42,v204
M v[76:79],a[252:255],a[220:223],v[76:79]
ds_read_b128 a[220:223],v252 offset:18176
v_and_b32 v236,s42,v206
M v[80:83],a[252:255],a[192:195],v[80:83]
ds_read_b128 a[192:195],v252 offset:18432
v_and_b32 v240,s42,v214
M v[84:87],a[252:255],a[196:199],v[84:87]
buffer_store_dwordx4 v[108:111],v254,s[24:27],s35 offen offset:1152
M v[88:91],a[252:255],a[200:203],v[88:91]
s_waitcnt lgkmcnt(5)
ds_read_b128 a[196:199],v252 offset:18688
ds_read_b128 a[200:203],v252 offset:18944
M v[92:95],a[252:255],a[204:207],v[92:95]
s_waitcnt vmcnt(20) lgkmcnt(6)
buffer_load_dwordx4 a[252:255],v253,s[20:23],s48 offen offset:1024
M v[64:67],v[216:219],a[208:211],v[64:67]
s_waitcnt lgkmcnt(5)
ds_read_b128 a[204:207],v252 offset:19200
ds_read_b128 a[208:211],v252 offset:19456
M v[68:71],v[216:219],a[212:215],v[68:71]
s_waitcnt lgkmcnt(6)
v_and_b32 v239,s42,v212
v_and_b32 v238,s42,v210
M v[72:75],v[216:219],a[216:219],v[72:75]
s_waitcnt lgkmcnt(5)
v_fmac_f32 v235,s43,v237
v_fmac_f32 v240,4.0,v236
M v[76:79],v[216:219],a[220:223],v[76:79]
s_waitcnt lgkmcnt(4)
v_fma_f32 v231,-4.0,v237,v239
v_fmac_f32 v235,s45,v239
M v[80:83],v[216:219],a[192:195],v[80:83]
s_waitcnt lgkmcnt(3)
v_fmac_f32 v240,s40,v238
v_sub_f32 v239,v239,v237
M v[84:87],v[216:219],a[196:199],v[84:87]
s_waitcnt lgkmcnt(2)
v_fma_f32 v237,-4.0,v236,v238
v_sub_f32 v238,v238,v236
M v[88:91],v[216:219],a[200:203],v[88:91]
s_waitcnt lgkmcnt(1)
v_add_f32 v236,v231,v237
v_sub_f32 v231,v231,v237
M v[92:95],v[216:219],a[204:207],v[92:95]
s_waitcnt vmcnt(20)
buffer_load_dwordx4 v[216:219],v253,s[20:23],s48 offen offset:2048
M v[64:67],v[220:223],a[212:215],v[64:67]
ds_read_b128 a[212:215],v251 offset:19712
v_fma_f32 v237,2.0,v238,v239
M v[68:71],v[220:223],a[216:219],v[68:71]
s_add_u32 s48,s44,52224
v_fmac_f32 v239,-2.0,v238
v_cvt_pk_bf16_f32 v204,v228,v235
M v[72:75],v[220:223],a[220:223],v[72:75]
v_cvt_pk_bf16_f32 v214,v233,v240
v_cvt_pk_bf16_f32 v206,v229,v236
M v[76:79],v[220:223],a[192:195],v[76:79]
v_cvt_pk_bf16_f32 v208,v234,v231
v_cvt_pk_bf16_f32 v210,v230,v237
M v[80:83],v[220:223],a[196:199],v[80:83]
v_cvt_pk_bf16_f32 v212,v232,v239
v_lshlrev_b32 v230,16,v209
M v[84:87],v[220:223],a[200:203],v[84:87]
v_lshlrev_b32 v228,16,v205
v_lshlrev_b32 v229,16,v207
M v[88:91],v[220:223],a[204:207],v[88:91]
s_waitcnt lgkmcnt(1)
buffer_store_dwordx4 v[112:115],v254,s[24:27],s36 offen offset:1152
M v[92:95],v[220:223],a[208:211],v[92:95]
s_waitcnt vmcnt(18)
buffer_load_dwordx4 v[220:223],v253,s[20:23],s48 offen offset:0
M v[64:67],v[224:227],a[216:219],v[64:67]
ds_read_b128 a[216:219],v251 offset:34816
v_lshlrev_b32 v233,16,v215
M v[68:71],v[224:227],a[220:223],v[68:71]
ds_read_b128 a[220:223],v252 offset:35072
v_lshlrev_b32 v232,16,v213
M v[72:75],v[224:227],a[192:195],v[72:75]
ds_read_b128 a[192:195],v252 offset:35328
v_lshlrev_b32 v231,16,v211
M v[76:79],v[224:227],a[196:199],v[76:79]
ds_read_b128 a[196:199],v252 offset:35584
v_fmac_f32 v228,s43,v230
M v[80:83],v[224:227],a[200:203],v[80:83]
ds_read_b128 a[200:203],v252 offset:35840
v_fmac_f32 v233,4.0,v229
M v[84:87],v[224:227],a[204:207],v[84:87]
ds_read_b128 a[204:207],v252 offset:36096
v_fma_f32 v234,-4.0,v230,v232
M v[88:91],v[224:227],a[208:211],v[88:91]
s_waitcnt lgkmcnt(6)
ds_read_b128 a[208:211],v252 offset:36352
v_fmac_f32 v228,s45,v232
M v[92:95],v[224:227],a[212:215],v[92:95]
s_waitcnt vmcnt(18) lgkmcnt(6)
buffer_load_dwordx4 v[224:227],v253,s[20:23],s48 offen offset:1024
M v[64:67],a[224:227],a[216:219],v[64:67]
s_waitcnt lgkmcnt(5)
ds_read_b128 a[212:215],v252 offset:36608
ds_read_b128 a[216:219],v252 offset:36864
M v[68:71],a[224:227],a[220:223],v[68:71]
s_waitcnt lgkmcnt(6)
v_fmac_f32 v233,s40,v231
v_sub_f32 v232,v232,v230
M v[72:75],a[224:227],a[192:195],v[72:75]
s_waitcnt lgkmcnt(5)
v_fma_f32 v230,-4.0,v229,v231
v_sub_f32 v231,v231,v229
M v[76:79],a[224:227],a[196:199],v[76:79]
s_waitcnt lgkmcnt(4)
v_add_f32 v229,v234,v230
v_sub_f32 v234,v234,v230
M v[80:83],a[224:227],a[200:203],v[80:83]
s_waitcnt lgkmcnt(3)
v_fma_f32 v230,2.0,v231,v232
v_fmac_f32 v232,-2.0,v231
M v[84:87],a[224:227],a[204:207],v[84:87]
s_waitcnt lgkmcnt(2)
v_and_b32 v237,s42,v209
v_and_b32 v235,s42,v205
M v[88:91],a[224:227],a[208:211],v[88:91]
s_waitcnt lgkmcnt(1)
v_and_b32 v236,s42,v207
v_and_b32 v240,s42,v215
M v[92:95],a[224:227],a[212:215],v[92:95]
s_waitcnt vmcnt(16)
buffer_load_dwordx4 a[224:227],v253,s[20:23],s48 offen offset:2048
M v[64:67],a[228:231],a[220:223],v[64:67]
buffer_store_dwordx4 v[116:119],v254,s[24:27],s37 offen offset:1152
M v[68:71],a[228:231],a[192:195],v[68:71]
s_add_u32 s48,s44,107520
ds_read_b128 a[220:223],v251 offset:37120
v_and_b32 v239,s42,v213
M v[72:75],a[228:231],a[196:199],v[72:75]
v_and_b32 v238,s42,v211
v_fmac_f32 v235,s43,v237
M v[76:79],a[228:231],a[200:203],v[76:79]
v_fmac_f32 v240,4.0,v236
v_fma_f32 v231,-4.0,v237,v239
M v[80:83],a[228:231],a[204:207],v[80:83]
v_fmac_f32 v235,s45,v239
v_fmac_f32 v240,s40,v238
M v[84:87],a[228:231],a[208:211],v[84:87]
v_sub_f32 v239,v239,v237
v_fma_f32 v237,-4.0,v236,v238
M v[88:91],a[228:231],a[212:215],v[88:91]
s_waitcnt lgkmcnt(1)
v_sub_f32 v238,v238,v236
v_add_f32 v236,v231,v237
M v[92:95],a[228:231],a[216:219],v[92:95]
s_waitcnt vmcnt(16)
buffer_load_dwordx4 a[228:231],v253,s[20:23],s48 offen offset:0
M v[64:67],a[232:235],a[192:195],v[64:67]
ds_read_b128 a[192:195],v251 offset:52224
v_sub_f32 v231,v231,v237
M v[68:71],a[232:235],a[196:199],v[68:71]
ds_read_b128 a[196:199],v252 offset:52480
v_fma_f32 v237,2.0,v238,v239
M v[72:75],a[232:235],a[200:203],v[72:75]
ds_read_b128 a[200:203],v252 offset:52736
v_fmac_f32 v239,-2.0,v238
M v[76:79],a[232:235],a[204:207],v[76:79]
ds_read_b128 a[204:207],v252 offset:52992
v_cvt_pk_bf16_f32 v205,v228,v235
M v[80:83],a[232:235],a[208:211],v[80:83]
ds_read_b128 a[208:211],v252 offset:53248
v_cvt_pk_bf16_f32 v215,v233,v240
M v[84:87],a[232:235],a[212:215],v[84:87]
ds_read_b128 a[212:215],v252 offset:53504
v_cvt_pk_bf16_f32 v207,v229,v236
M v[88:91],a[232:235],a[216:219],v[88:91]
s_waitcnt lgkmcnt(6)
ds_read_b128 a[216:219],v252 offset:53760
v_cvt_pk_bf16_f32 v209,v234,v231
M v[92:95],a[232:235],a[220:223],v[92:95]
s_waitcnt vmcnt(15) lgkmcnt(6)
buffer_load_dwordx4 a[232:235],v253,s[20:23],s48 offen offset:1024
M v[64:67],a[236:239],a[192:195],v[64:67]
s_waitcnt lgkmcnt(5)
ds_read_b128 a[220:223],v252 offset:54016
ds_read_b128 a[192:195],v252 offset:54272
M v[68:71],a[236:239],a[196:199],v[68:71]
s_waitcnt lgkmcnt(6)
buffer_store_dwordx4 v[120:123],v254,s[24:27],s38 offen offset:1152
M v[72:75],a[236:239],a[200:203],v[72:75]
s_waitcnt lgkmcnt(5)
v_cvt_pk_bf16_f32 v211,v230,v237
v_cvt_pk_bf16_f32 v213,v232,v239
M v[76:79],a[236:239],a[204:207],v[76:79]
s_waitcnt lgkmcnt(4)
ds_write2st64_b64 v249,v[204:205],v[214:215] offset0:103 offset1:120
M v[80:83],a[236:239],a[208:211],v[80:83]
s_waitcnt lgkmcnt(4)
s_add_u32 s28,s30,7471104
buffer_load_dwordx2 v[204:205],v247,s[12:15],s28 offen offset:0
M v[84:87],a[236:239],a[212:215],v[84:87]
s_waitcnt lgkmcnt(3)
buffer_load_dwordx2 v[214:215],v247,s[16:19],s28 offen offset:1536
M v[88:91],a[236:239],a[216:219],v[88:91]
s_waitcnt lgkmcnt(2)
ds_write2st64_b64 v249,v[206:207],v[208:209] offset0:35 offset1:52
M v[92:95],a[236:239],a[220:223],v[92:95]
s_waitcnt vmcnt(18)
buffer_load_dwordx2 v[206:207],v247,s[8:11],s28 offen offset:0
M v[64:67],a[240:243],a[196:199],v[64:67]
buffer_load_dwordx2 v[208:209],v247,s[8:11],s28 offen offset:384
M v[68:71],a[240:243],a[200:203],v[68:71]
buffer_load_dwordx4 a[236:239],v253,s[20:23],s48 offen offset:2048
M v[72:75],a[240:243],a[204:207],v[72:75]
s_add_u32 s48,s44,162816
ds_read_b128 a[196:199],v251 offset:54528
ds_write2st64_b64 v249,v[210:211],v[212:213] offset0:69 offset1:86
M v[76:79],a[240:243],a[208:211],v[76:79]
buffer_load_dwordx2 v[210:211],v247,s[8:11],s28 offen offset:768
M v[80:83],a[240:243],a[212:215],v[80:83]
buffer_load_dwordx2 v[212:213],v247,s[8:11],s28 offen offset:1152
M v[84:87],a[240:243],a[216:219],v[84:87]
v_add_u32 v251,0xfffece00,v251
v_add_u32 v252,0xfffece00,v252
M v[88:91],a[240:243],a[220:223],v[88:91]
s_waitcnt lgkmcnt(4)
v_fmac_f32 v241,s43,v243
v_fmac_f32 v246,4.0,v242
M v[92:95],a[240:243],a[192:195],v[92:95]
s_waitcnt vmcnt(19)
buffer_load_dwordx4 a[240:243],v253,s[20:23],s48 offen offset:0
M v[64:67],a[244:247],a[200:203],v[64:67]
ds_read_b128 a[200:203],v251 offset:60928
v_fma_f32 v228,-4.0,v243,v245
M v[68:71],a[244:247],a[204:207],v[68:71]
buffer_store_dwordx4 v[124:127],v254,s[24:27],s39 offen offset:1152
M v[72:75],a[244:247],a[208:211],v[72:75]
ds_read_b128 a[204:207],v252 offset:61184
ds_read_b128 a[208:211],v252 offset:61440
M v[76:79],a[244:247],a[212:215],v[76:79]
ds_read_b128 a[212:215],v252 offset:61696
v_fmac_f32 v241,s45,v245
M v[80:83],a[244:247],a[216:219],v[80:83]
ds_read_b128 a[216:219],v252 offset:61952
v_fmac_f32 v246,s40,v244
M v[84:87],a[244:247],a[220:223],v[84:87]
ds_read_b128 a[220:223],v252 offset:62208
v_sub_f32 v245,v245,v243
M v[88:91],a[244:247],a[192:195],v[88:91]
s_waitcnt lgkmcnt(7)
ds_read_b128 a[192:195],v252 offset:62464
v_fma_f32 v243,-4.0,v242,v244
M v[92:95],a[244:247],a[196:199],v[92:95]
s_waitcnt vmcnt(20) lgkmcnt(6)
buffer_load_dwordx4 a[244:247],v253,s[20:23],s48 offen offset:1024
M v[64:67],a[248:251],a[200:203],v[64:67]
s_waitcnt lgkmcnt(5)
ds_read_b128 a[196:199],v252 offset:62720
ds_read_b128 a[200:203],v252 offset:62976
M v[68:71],a[248:251],a[204:207],v[68:71]
s_waitcnt lgkmcnt(6)
v_sub_f32 v244,v244,v242
v_add_f32 v242,v228,v243
M v[72:75],a[248:251],a[208:211],v[72:75]
s_waitcnt lgkmcnt(5)
v_sub_f32 v228,v228,v243
v_fma_f32 v243,2.0,v244,v245
M v[76:79],a[248:251],a[212:215],v[76:79]
s_waitcnt lgkmcnt(4)
v_fmac_f32 v245,-2.0,v244
v_cvt_pk_bf16_f32 v229,v241,v246
M v[80:83],a[248:251],a[216:219],v[80:83]
s_waitcnt lgkmcnt(3)
v_cvt_pk_bf16_f32 v230,v242,v228
v_cvt_pk_bf16_f32 v231,v243,v245
M v[84:87],a[248:251],a[220:223],v[84:87]
s_waitcnt lgkmcnt(2)
s_add_u32 s29,s31,64
buffer_load_short_d16_hi v241,v248,s[12:15],s29 offen offset:0
M v[88:91],a[248:251],a[192:195],v[88:91]
s_waitcnt lgkmcnt(1)
buffer_load_short_d16_hi v242,v248,s[8:11],s29 offen offset:0
M v[92:95],a[248:251],a[196:199],v[92:95]
s_waitcnt vmcnt(21)
buffer_load_short_d16_hi v243,v248,s[8:11],s29 offen offset:384
M v[64:67],a[252:255],a[204:207],v[64:67]
buffer_load_short_d16_hi v244,v248,s[8:11],s29 offen offset:768
M v[68:71],a[252:255],a[208:211],v[68:71]
buffer_load_short_d16_hi v245,v248,s[8:11],s29 offen offset:1152
M v[72:75],a[252:255],a[212:215],v[72:75]
buffer_load_short_d16_hi v246,v248,s[16:19],s29 offen offset:1536
M v[76:79],a[252:255],a[216:219],v[76:79]
buffer_load_dwordx4 a[248:251],v253,s[20:23],s48 offen offset:2048
M v[80:83],a[252:255],a[220:223],v[80:83]
s_add_u32 s48,s44,218112
ds_read_b128 a[204:207],v251 offset:63232
ds_write_b16 v250,v229 offset:52224
M v[84:87],a[252:255],a[192:195],v[84:87]
ds_write_b16_d16_hi v250,v229 offset:60928
M v[88:91],a[252:255],a[196:199],v[88:91]
s_waitcnt lgkmcnt(3)
ds_write_b16 v250,v230 offset:17408
M v[92:95],a[252:255],a[200:203],v[92:95]
s_waitcnt vmcnt(25)
buffer_load_dwordx4 a[252:255],v253,s[20:23],s48 offen offset:0
M v[64:67],v[216:219],a[208:211],v[64:67]
ds_read_b128 a[208:211],v251 offset:0
ds_write_b16_d16_hi v250,v230 offset:26112
M v[68:71],v[216:219],a[212:215],v[68:71]
ds_read_b128 a[212:215],v252 offset:256
ds_write_b16 v250,v231 offset:34816
M v[72:75],v[216:219],a[216:219],v[72:75]
ds_read_b128 a[216:219],v252 offset:512
ds_write_b16_d16_hi v250,v231 offset:43520
M v[76:79],v[216:219],a[220:223],v[76:79]
ds_read_b128 a[220:223],v252 offset:768
v_cvt_pk_bf16_f32 v64,v64,v65
M v[80:83],v[216:219],a[192:195],v[80:83]
ds_read_b128 a[192:195],v252 offset:1024
v_cvt_pk_bf16_f32 v65,v66,v67
M v[84:87],v[216:219],a[196:199],v[84:87]
buffer_store_dwordx2 v[64:65],v255,s[24:27],s32 offen offset:0
M v[88:91],v[216:219],a[200:203],v[88:91]
s_waitcnt lgkmcnt(11)
ds_read_b128 a[196:199],v252 offset:1280
ds_read_b128 a[200:203],v252 offset:1536
M v[92:95],v[216:219],a[204:207],v[92:95]
s_waitcnt vmcnt(25) lgkmcnt(9)
buffer_load_dwordx4 v[216:219],v253,s[20:23],s48 offen offset:1024
M v[160:163],v[220:223],a[208:211],v[160:163]
s_waitcnt lgkmcnt(7)
ds_read_b128 a[204:207],v252 offset:1792
ds_read_b128 a[208:211],v252 offset:2048
M v[164:167],v[220:223],a[212:215],v[164:167]
s_waitcnt lgkmcnt(7)
v_cvt_pk_bf16_f32 v68,v68,v69
v_cvt_pk_bf16_f32 v69,v70,v71
M v[168:171],v[220:223],a[216:219],v[168:171]
s_waitcnt lgkmcnt(5)
buffer_store_dwordx2 v[68:69],v255,s[24:27],s33 offen offset:0
M v[172:175],v[220:223],a[220:223],v[172:175]
s_waitcnt lgkmcnt(4)
v_cvt_pk_bf16_f32 v72,v72,v73
v_cvt_pk_bf16_f32 v73,v74,v75
M v[176:179],v[220:223],a[192:195],v[176:179]
s_waitcnt lgkmcnt(3)
buffer_store_dwordx2 v[72:73],v255,s[24:27],s34 offen offset:0
M v[180:183],v[220:223],a[196:199],v[180:183]
s_waitcnt lgkmcnt(2)
v_cvt_pk_bf16_f32 v76,v76,v77
v_cvt_pk_bf16_f32 v77,v78,v79
M v[184:187],v[220:223],a[200:203],v[184:187]
s_waitcnt lgkmcnt(1)
v_cvt_pk_bf16_f32 v80,v80,v81
v_cvt_pk_bf16_f32 v81,v82,v83
M v[188:191],v[220:223],a[204:207],v[188:191]
s_waitcnt vmcnt(27)
buffer_load_dwordx4 v[220:223],v253,s[20:23],s48 offen offset:2048
M v[160:163],v[224:227],a[212:215],v[160:163]
ds_read_b128 a[212:215],v251 offset:2304
v_cvt_pk_bf16_f32 v84,v84,v85
M v[164:167],v[224:227],a[216:219],v[164:167]
s_add_u32 s48,s44,273408
v_cvt_pk_bf16_f32 v85,v86,v87
v_cvt_pk_bf16_f32 v88,v88,v89
M v[168:171],v[224:227],a[220:223],v[168:171]
v_cvt_pk_bf16_f32 v89,v90,v91
v_cvt_pk_bf16_f32 v92,v92,v93
M v[172:175],v[224:227],a[192:195],v[172:175]
buffer_store_dwordx2 v[76:77],v255,s[24:27],s35 offen offset:0
M v[176:179],v[224:227],a[196:199],v[176:179]
v_cvt_pk_bf16_f32 v93,v94,v95
v_lshlrev_b32 v230,16,v196
M v[180:183],v[224:227],a[200:203],v[180:183]
v_add_u32 v251,0x15400,v251
v_add_u32 v252,0x15400,v252
M v[184:187],v[224:227],a[204:207],v[184:187]
s_waitcnt lgkmcnt(1)
v_lshlrev_b32 v228,16,v192
v_lshlrev_b32 v229,16,v194
M v[188:191],v[224:227],a[208:211],v[188:191]
s_waitcnt vmcnt(28)
buffer_load_dwordx4 v[224:227],v253,s[20:23],s48 offen offset:0
M v[160:163],a[224:227],a[216:219],v[160:163]
ds_read_b128 a[216:219],v251 offset:0
v_lshlrev_b32 v233,16,v202
M v[164:167],a[224:227],a[220:223],v[164:167]
ds_read_b128 a[220:223],v252 offset:256
v_lshlrev_b32 v232,16,v200
M v[168:171],a[224:227],a[192:195],v[168:171]
ds_read_b128 a[192:195],v252 offset:512
v_lshlrev_b32 v231,16,v198
M v[172:175],a[224:227],a[196:199],v[172:175]
ds_read_b128 a[196:199],v252 offset:768
v_fmac_f32 v228,s43,v230
M v[176:179],a[224:227],a[200:203],v[176:179]
buffer_store_dwordx2 v[80:81],v255,s[24:27],s36 offen offset:0
M v[180:183],a[224:227],a[204:207],v[180:183]
ds_read_b128 a[200:203],v252 offset:1024
ds_read_b128 a[204:207],v252 offset:1280
M v[184:187],a[224:227],a[208:211],v[184:187]
s_waitcnt lgkmcnt(6)
ds_read_b128 a[208:211],v252 offset:1536
v_fmac_f32 v233,4.0,v229
M v[188:191],a[224:227],a[212:215],v[188:191]
s_waitcnt vmcnt(28) lgkmcnt(6)
buffer_load_dwordx4 a[224:227],v253,s[20:23],s48 offen offset:1024
M v[160:163],a[228:231],a[216:219],v[160:163]
s_waitcnt lgkmcnt(5)
ds_read_b128 a[212:215],v252 offset:1792
ds_read_b128 a[216:219],v252 offset:2048
M v[164:167],a[228:231],a[220:223],v[164:167]
s_waitcnt lgkmcnt(6)
v_fma_f32 v234,-4.0,v230,v232
v_fmac_f32 v228,s45,v232
M v[168:171],a[228:231],a[192:195],v[168:171]
s_waitcnt lgkmcnt(5)
v_fmac_f32 v233,s40,v231
v_sub_f32 v232,v232,v230
M v[172:175],a[228:231],a[196:199],v[172:175]
s_waitcnt lgkmcnt(4)
v_fma_f32 v230,-4.0,v229,v231
v_sub_f32 v231,v231,v229
M v[176:179],a[228:231],a[200:203],v[176:179]
s_waitcnt lgkmcnt(3)
buffer_store_dwordx2 v[84:85],v255,s[24:27],s37 offen offset:0
M v[180:183],a[228:231],a[204:207],v[180:183]
s_waitcnt lgkmcnt(2)
v_add_f32 v229,v234,v230
v_sub_f32 v234,v234,v230
M v[184:187],a[228:231],a[208:211],v[184:187]
s_waitcnt lgkmcnt(1)
v_fma_f32 v230,2.0,v231,v232
v_fmac_f32 v232,-2.0,v231
M v[188:191],a[228:231],a[212:215],v[188:191]
s_waitcnt vmcnt(29)
buffer_load_dwordx4 a[228:231],v253,s[20:23],s48 offen offset:2048
M v[160:163],a[232:235],a[220:223],v[160:163]
ds_read_b128 a[220:223],v251 offset:2304
v_and_b32 v237,s42,v196
M v[164:167],a[232:235],a[192:195],v[164:167]
s_add_u32 s48,s44,328704
v_and_b32 v235,s42,v192
v_and_b32 v236,s42,v194
M v[168:171],a[232:235],a[196:199],v[168:171]
v_and_b32 v240,s42,v202
v_and_b32 v239,s42,v200
M v[172:175],a[232:235],a[200:203],v[172:175]
v_and_b32 v238,s42,v198
v_fmac_f32 v235,s43,v237
M v[176:179],a[232:235],a[204:207],v[176:179]
v_fmac_f32 v240,4.0,v236
v_fma_f32 v231,-4.0,v237,v239
M v[180:183],a[232:235],a[208:211],v[180:183]
buffer_store_dwordx2 v[88:89],v255,s[24:27],s38 offen offset:0
M v[184:187],a[232:235],a[212:215],v[184:187]
s_waitcnt lgkmcnt(1)
v_fmac_f32 v235,s45,v239
v_fmac_f32 v240,s40,v238
M v[188:191],a[232:235],a[216:219],v[188:191]
s_waitcnt vmcnt(25)
buffer_load_dwordx4 a[232:235],v253,s[20:23],s48 offen offset:0
M v[160:163],a[236:239],a[192:195],v[160:163]
ds_read_b128 a[192:195],v251 offset:17408
v_sub_f32 v239,v239,v237
M v[164:167],a[236:239],a[196:199],v[164:167]
ds_read_b128 a[196:199],v252 offset:17664
v_fma_f32 v237,-4.0,v236,v238
M v[168:171],a[236:239],a[200:203],v[168:171]
ds_read_b128 a[200:203],v252 offset:17920
v_sub_f32 v238,v238,v236
M v[172:175],a[236:239],a[204:207],v[172:175]
ds_read_b128 a[204:207],v252 offset:18176
v_add_f32 v236,v231,v237
M v[176:179],a[236:239],a[208:211],v[176:179]
ds_read_b128 a[208:211],v252 offset:18432
v_sub_f32 v231,v231,v237
M v[180:183],a[236:239],a[212:215],v[180:183]
buffer_store_dwordx2 v[92:93],v255,s[24:27],s39 offen offset:0
M v[184:187],a[236:239],a[216:219],v[184:187]
s_waitcnt lgkmcnt(5)
ds_read_b128 a[212:215],v252 offset:18688
ds_read_b128 a[216:219],v252 offset:18944
M v[188:191],a[236:239],a[220:223],v[188:191]
s_waitcnt vmcnt(24) lgkmcnt(6)
buffer_load_dwordx4 a[236:239],v253,s[20:23],s48 offen offset:1024
M v[160:163],a[240:243],a[192:195],v[160:163]
s_waitcnt lgkmcnt(5)
ds_read_b128 a[220:223],v252 offset:19200
ds_read_b128 a[192:195],v252 offset:19456
M v[164:167],a[240:243],a[196:199],v[164:167]
s_waitcnt lgkmcnt(6)
v_fma_f32 v237,2.0,v238,v239
v_fmac_f32 v239,-2.0,v238
M v[168:171],a[240:243],a[200:203],v[168:171]
s_waitcnt lgkmcnt(5)
v_cvt_pk_bf16_f32 v192,v228,v235
v_cvt_pk_bf16_f32 v202,v233,v240
M v[172:175],a[240:243],a[204:207],v[172:175]
s_waitcnt lgkmcnt(4)
v_cvt_pk_bf16_f32 v194,v229,v236
v_cvt_pk_bf16_f32 v196,v234,v231
M v[176:179],a[240:243],a[208:211],v[176:179]
s_waitcnt lgkmcnt(3)
v_cvt_pk_bf16_f32 v198,v230,v237
v_cvt_pk_bf16_f32 v200,v232,v239
M v[180:183],a[240:243],a[212:215],v[180:183]
s_waitcnt lgkmcnt(2)
v_lshlrev_b32 v230,16,v197
v_lshlrev_b32 v228,16,v193
M v[184:187],a[240:243],a[216:219],v[184:187]
s_waitcnt lgkmcnt(1)
v_lshlrev_b32 v229,16,v195
v_lshlrev_b32 v233,16,v203
M v[188:191],a[240:243],a[220:223],v[188:191]
s_waitcnt vmcnt(23)
buffer_load_dwordx4 a[240:243],v253,s[20:23],s48 offen offset:2048
M v[160:163],a[244:247],a[196:199],v[160:163]
ds_read_b128 a[196:199],v251 offset:19712
v_lshlrev_b32 v232,16,v201
M v[164:167],a[244:247],a[200:203],v[164:167]
s_add_u32 s46,s44,9216
v_lshlrev_b32 v231,16,v199
v_fmac_f32 v228,s43,v230
M v[168:171],a[244:247],a[204:207],v[168:171]
v_fmac_f32 v233,4.0,v229
v_fma_f32 v234,-4.0,v230,v232
M v[172:175],a[244:247],a[208:211],v[172:175]
v_fmac_f32 v228,s45,v232
v_fmac_f32 v233,s40,v231
M v[176:179],a[244:247],a[212:215],v[176:179]
v_sub_f32 v232,v232,v230
v_fma_f32 v230,-4.0,v229,v231
M v[180:183],a[244:247],a[216:219],v[180:183]
v_sub_f32 v231,v231,v229
v_add_f32 v229,v234,v230
M v[184:187],a[244:247],a[220:223],v[184:187]
s_waitcnt lgkmcnt(1)
v_sub_f32 v234,v234,v230
v_fma_f32 v230,2.0,v231,v232
M v[188:191],a[244:247],a[192:195],v[188:191]
s_waitcnt vmcnt(17)
buffer_load_dwordx4 a[244:247],v253,s[20:23],s46 offen offset:0
M v[160:163],a[248:251],a[200:203],v[160:163]
ds_read_b128 a[200:203],v251 offset:34816
v_fmac_f32 v232,-2.0,v231
M v[164:167],a[248:251],a[204:207],v[164:167]
s_add_u32 s47,s44,12288
ds_read_b128 a[204:207],v252 offset:35072
v_and_b32 v237,s42,v197
M v[168:171],a[248:251],a[208:211],v[168:171]
ds_read_b128 a[208:211],v252 offset:35328
v_and_b32 v235,s42,v193
M v[172:175],a[248:251],a[212:215],v[172:175]
ds_read_b128 a[212:215],v252 offset:35584
v_and_b32 v236,s42,v195
M v[176:179],a[248:251],a[216:219],v[176:179]
ds_read_b128 a[216:219],v252 offset:35840
v_and_b32 v240,s42,v203
M v[180:183],a[248:251],a[220:223],v[180:183]
ds_read_b128 a[220:223],v252 offset:36096
v_and_b32 v239,s42,v201
M v[184:187],a[248:251],a[192:195],v[184:187]
s_waitcnt lgkmcnt(6)
ds_read_b128 a[192:195],v252 offset:36352
v_and_b32 v238,s42,v199
M v[188:191],a[248:251],a[196:199],v[188:191]
s_waitcnt vmcnt(17) lgkmcnt(6)
buffer_load_dwordx4 a[248:251],v253,s[20:23],s47 offen offset:0
M v[160:163],a[252:255],a[200:203],v[160:163]
s_waitcnt lgkmcnt(5)
ds_read_b128 a[196:199],v252 offset:36608
ds_read_b128 a[200:203],v252 offset:36864
M v[164:167],a[252:255],a[204:207],v[164:167]
s_waitcnt lgkmcnt(6)
s_add_u32 s48,s44,15360
v_fmac_f32 v235,s43,v237
v_fmac_f32 v240,4.0,v236
M v[168:171],a[252:255],a[208:211],v[168:171]
s_waitcnt lgkmcnt(5)
v_fma_f32 v231,-4.0,v237,v239
v_fmac_f32 v235,s45,v239
M v[172:175],a[252:255],a[212:215],v[172:175]
s_waitcnt lgkmcnt(4)
v_fmac_f32 v240,s40,v238
v_sub_f32 v239,v239,v237
M v[176:179],a[252:255],a[216:219],v[176:179]
s_waitcnt lgkmcnt(3)
v_fma_f32 v237,-4.0,v236,v238
v_sub_f32 v238,v238,v236
M v[180:183],a[252:255],a[220:223],v[180:183]
s_waitcnt lgkmcnt(2)
v_add_f32 v236,v231,v237
v_sub_f32 v231,v231,v237
M v[184:187],a[252:255],a[192:195],v[184:187]
s_waitcnt lgkmcnt(1)
v_fma_f32 v237,2.0,v238,v239
v_fmac_f32 v239,-2.0,v238
M v[188:191],a[252:255],a[196:199],v[188:191]
s_waitcnt vmcnt(16)
buffer_load_dwordx4 a[252:255],v253,s[20:23],s48 offen offset:0
M v[160:163],v[216:219],a[204:207],v[160:163]
ds_read_b128 a[204:207],v251 offset:37120
v_cvt_pk_bf16_f32 v193,v228,v235
M v[164:167],v[216:219],a[208:211],v[164:167]
v_cvt_pk_bf16_f32 v203,v233,v240
v_cvt_pk_bf16_f32 v195,v229,v236
M v[168:171],v[216:219],a[212:215],v[168:171]
v_cvt_pk_bf16_f32 v197,v234,v231
v_cvt_pk_bf16_f32 v199,v230,v237
M v[172:175],v[216:219],a[216:219],v[172:175]
v_cvt_pk_bf16_f32 v201,v232,v239
M v[176:179],v[216:219],a[220:223],v[176:179]
ds_write2st64_b64 v249,v[192:193],v[202:203] offset0:104 offset1:121
M v[180:183],v[216:219],a[192:195],v[180:183]
s_add_u32 s28,s30,6291520
buffer_load_dwordx2 v[192:193],v247,s[12:15],s28 offen offset:0
M v[184:187],v[216:219],a[196:199],v[184:187]
s_waitcnt lgkmcnt(2)
buffer_load_dwordx2 v[202:203],v247,s[16:19],s28 offen offset:1536
M v[188:191],v[216:219],a[200:203],v[188:191]
s_waitcnt vmcnt(16)
buffer_load_dwordx4 v[216:219],v253,s[20:23],s46 offen offset:1024
M v[160:163],v[220:223],a[208:211],v[160:163]
ds_read_b128 a[208:211],v251 offset:52224
ds_write2st64_b64 v249,v[194:195],v[196:197] offset0:36 offset1:53
M v[164:167],v[220:223],a[212:215],v[164:167]
buffer_load_dwordx2 v[194:195],v247,s[8:11],s28 offen offset:0
M v[168:171],v[220:223],a[216:219],v[168:171]
buffer_load_dwordx2 v[196:197],v247,s[8:11],s28 offen offset:384
M v[172:175],v[220:223],a[220:223],v[172:175]
ds_read_b128 a[212:215],v252 offset:52480
ds_read_b128 a[216:219],v252 offset:52736
M v[176:179],v[220:223],a[192:195],v[176:179]
ds_read_b128 a[220:223],v252 offset:52992
ds_read_b128 a[192:195],v252 offset:53248
M v[180:183],v[220:223],a[196:199],v[180:183]
ds_read_b128 a[196:199],v252 offset:53504
ds_write2st64_b64 v249,v[198:199],v[200:201] offset0:70 offset1:87
M v[184:187],v[220:223],a[200:203],v[184:187]
s_waitcnt lgkmcnt(9)
buffer_load_dwordx2 v[198:199],v247,s[8:11],s28 offen offset:768
M v[188:191],v[220:223],a[204:207],v[188:191]
s_waitcnt vmcnt(18) lgkmcnt(7)
buffer_load_dwordx2 v[200:201],v247,s[8:11],s28 offen offset:1152
M v[160:163],v[224:227],a[208:211],v[160:163]
s_waitcnt lgkmcnt(5)
buffer_load_dwordx4 v[220:223],v253,s[20:23],s47 offen offset:1024
M v[164:167],v[224:227],a[212:215],v[164:167]
s_waitcnt lgkmcnt(4)
ds_read_b128 a[200:203],v252 offset:53760
ds_read_b128 a[204:207],v252 offset:54016
M v[168:171],v[224:227],a[216:219],v[168:171]
s_waitcnt lgkmcnt(5)
ds_read_b128 a[208:211],v252 offset:54272
v_lshlrev_b32 v230,16,v208
M v[172:175],v[224:227],a[220:223],v[172:175]
s_waitcnt lgkmcnt(5)
v_lshlrev_b32 v228,16,v204
v_lshlrev_b32 v229,16,v206
M v[176:179],v[224:227],a[192:195],v[176:179]
s_waitcnt lgkmcnt(4)
v_lshlrev_b32 v233,16,v214
v_lshlrev_b32 v232,16,v212
M v[180:183],v[224:227],a[196:199],v[180:183]
s_waitcnt lgkmcnt(2)
v_lshlrev_b32 v231,16,v210
v_fmac_f32 v228,s43,v230
M v[184:187],v[224:227],a[200:203],v[184:187]
s_waitcnt lgkmcnt(1)
v_fmac_f32 v233,4.0,v229
v_fma_f32 v234,-4.0,v230,v232
M v[188:191],v[224:227],a[204:207],v[188:191]
s_waitcnt vmcnt(18)
buffer_load_dwordx4 v[224:227],v253,s[20:23],s48 offen offset:1024
M v[160:163],a[224:227],a[212:215],v[160:163]
ds_read_b128 a[212:215],v251 offset:54528
v_fmac_f32 v228,s45,v232
M v[164:167],a[224:227],a[216:219],v[164:167]
v_fmac_f32 v233,s40,v231
v_sub_f32 v232,v232,v230
M v[168:171],a[224:227],a[220:223],v[168:171]
v_fma_f32 v230,-4.0,v229,v231
v_sub_f32 v231,v231,v229
M v[172:175],a[224:227],a[192:195],v[172:175]
v_add_f32 v229,v234,v230
v_sub_f32 v234,v234,v230
M v[176:179],a[224:227],a[196:199],v[176:179]
v_fma_f32 v230,2.0,v231,v232
v_fmac_f32 v232,-2.0,v231
M v[180:183],a[224:227],a[200:203],v[180:183]
v_add_u32 v251,0xfffece00,v251
v_add_u32 v252,0xfffece00,v252
M v[184:187],a[224:227],a[204:207],v[184:187]
s_waitcnt lgkmcnt(1)
v_and_b32 v237,s42,v208
v_and_b32 v235,s42,v204
M v[188:191],a[224:227],a[208:211],v[188:191]
s_waitcnt vmcnt(17)
buffer_load_dwordx4 a[224:227],v253,s[20:23],s46 offen offset:2048
v_and_b32 v236,s42,v206
v_and_b32 v240,s42,v214
v_and_b32 v239,s42,v212
v_and_b32 v238,s42,v210
M v[160:163],a[228:231],a[216:219],v[160:163]
ds_read_b128 a[216:219],v251 offset:60928
v_fmac_f32 v235,s43,v237
v_fmac_f32 v240,4.0,v236
v_fma_f32 v231,-4.0,v237,v239
v_fmac_f32 v235,s45,v239
M v[164:167],a[228:231],a[220:223],v[164:167]
ds_read_b128 a[220:223],v252 offset:61184
v_fmac_f32 v240,s40,v238
v_sub_f32 v239,v239,v237
v_fma_f32 v237,-4.0,v236,v238
v_sub_f32 v238,v238,v236
M v[168:171],a[228:231],a[192:195],v[168:171]
ds_read_b128 a[192:195],v252 offset:61440
v_add_f32 v236,v231,v237
v_sub_f32 v231,v231,v237
v_fma_f32 v237,2.0,v238,v239
v_fmac_f32 v239,-2.0,v238
M v[172:175],a[228:231],a[196:199],v[172:175]
ds_read_b128 a[196:199],v252 offset:61696
v_cvt_pk_bf16_f32 v204,v228,v235
v_cvt_pk_bf16_f32 v214,v233,v240
v_cvt_pk_bf16_f32 v206,v229,v236
v_cvt_pk_bf16_f32 v208,v234,v231
M v[176:179],a[228:231],a[200:203],v[176:179]
ds_read_b128 a[200:203],v252 offset:61952
v_cvt_pk_bf16_f32 v210,v230,v237
v_cvt_pk_bf16_f32 v212,v232,v239
v_lshlrev_b32 v230,16,v209
v_lshlrev_b32 v228,16,v205
M v[180:183],a[228:231],a[204:207],v[180:183]
ds_read_b128 a[204:207],v252 offset:62208
v_lshlrev_b32 v229,16,v207
v_lshlrev_b32 v233,16,v215
v_lshlrev_b32 v232,16,v213
v_lshlrev_b32 v231,16,v211
M v[184:187],a[228:231],a[208:211],v[184:187]
s_waitcnt lgkmcnt(6)
ds_read_b128 a[208:211],v252 offset:62464
v_fmac_f32 v228,s43,v230
v_fmac_f32 v233,4.0,v229
v_fma_f32 v234,-4.0,v230,v232
v_fmac_f32 v228,s45,v232
M v[188:191],a[228:231],a[212:215],v[188:191]
s_waitcnt vmcnt(16) lgkmcnt(6)
buffer_load_dwordx4 a[228:231],v253,s[20:23],s47 offen offset:2048
v_fmac_f32 v233,s40,v231
v_sub_f32 v232,v232,v230
v_fma_f32 v230,-4.0,v229,v231
v_sub_f32 v231,v231,v229
M v[160:163],a[232:235],a[216:219],v[160:163]
s_waitcnt lgkmcnt(5)
ds_read_b128 a[212:215],v252 offset:62720
ds_read_b128 a[216:219],v252 offset:62976
v_add_f32 v229,v234,v230
v_sub_f32 v234,v234,v230
v_fma_f32 v230,2.0,v231,v232
v_fmac_f32 v232,-2.0,v231
M v[164:167],a[232:235],a[220:223],v[164:167]
s_waitcnt lgkmcnt(6)
v_and_b32 v237,s42,v209
v_and_b32 v235,s42,v205
v_and_b32 v236,s42,v207
v_and_b32 v240,s42,v215
M v[168:171],a[232:235],a[192:195],v[168:171]
s_waitcnt lgkmcnt(5)
v_and_b32 v239,s42,v213
v_and_b32 v238,s42,v211
v_fmac_f32 v235,s43,v237
v_fmac_f32 v240,4.0,v236
M v[172:175],a[232:235],a[196:199],v[172:175]
s_waitcnt lgkmcnt(4)
v_fma_f32 v231,-4.0,v237,v239
v_fmac_f32 v235,s45,v239
v_fmac_f32 v240,s40,v238
v_sub_f32 v239,v239,v237
M v[176:179],a[232:235],a[200:203],v[176:179]
s_waitcnt lgkmcnt(3)
v_fma_f32 v237,-4.0,v236,v238
v_sub_f32 v238,v238,v236
v_add_f32 v236,v231,v237
v_sub_f32 v231,v231,v237
M v[180:183],a[232:235],a[204:207],v[180:183]
s_waitcnt lgkmcnt(2)
v_fma_f32 v237,2.0,v238,v239
v_fmac_f32 v239,-2.0,v238
v_cvt_pk_bf16_f32 v205,v228,v235
v_cvt_pk_bf16_f32 v215,v233,v240
M v[184:187],a[232:235],a[208:211],v[184:187]
s_waitcnt lgkmcnt(1)
v_cvt_pk_bf16_f32 v207,v229,v236
v_cvt_pk_bf16_f32 v209,v234,v231
v_cvt_pk_bf16_f32 v211,v230,v237
v_cvt_pk_bf16_f32 v213,v232,v239
M v[188:191],a[232:235],a[212:215],v[188:191]
s_waitcnt vmcnt(15)
buffer_load_dwordx4 a[232:235],v253,s[20:23],s48 offen offset:2048
ds_write2st64_b64 v249,v[204:205],v[214:215] offset0:105 offset1:122
M v[160:163],a[236:239],a[220:223],v[160:163]
s_add_u32 s28,s30,6684736
buffer_load_dwordx2 v[204:205],v247,s[12:15],s28 offen offset:0
M v[164:167],a[236:239],a[192:195],v[164:167]
s_add_u32 s46,s44,18432
buffer_load_dwordx2 v[214:215],v247,s[16:19],s28 offen offset:1536
ds_write2st64_b64 v249,v[206:207],v[208:209] offset0:37 offset1:54
M v[168:171],a[236:239],a[196:199],v[168:171]
buffer_load_dwordx2 v[206:207],v247,s[8:11],s28 offen offset:0
M v[172:175],a[236:239],a[200:203],v[172:175]
buffer_load_dwordx2 v[208:209],v247,s[8:11],s28 offen offset:384
ds_write2st64_b64 v249,v[210:211],v[212:213] offset0:71 offset1:88
M v[176:179],a[236:239],a[204:207],v[176:179]
buffer_load_dwordx2 v[210:211],v247,s[8:11],s28 offen offset:768
M v[180:183],a[236:239],a[208:211],v[180:183]
buffer_load_dwordx2 v[212:213],v247,s[8:11],s28 offen offset:1152
ds_read_b128 a[220:223],v251 offset:63232
M v[184:187],a[236:239],a[212:215],v[184:187]
s_waitcnt lgkmcnt(0)
s_barrier
s_waitcnt vmcnt(13)
v_lshlrev_b32 v230,16,v196
M v[188:191],a[236:239],a[216:219],v[188:191]
buffer_load_dwordx4 a[236:239],v253,s[20:23],s46 offen offset:0
M v[160:163],a[240:243],a[192:195],v[160:163]
ds_read_b128 a[192:195],v251 offset:0
v_lshlrev_b32 v228,16,v192
M v[164:167],a[240:243],a[196:199],v[164:167]
s_add_u32 s47,s44,21504
ds_read_b128 a[196:199],v252 offset:256
v_lshlrev_b32 v229,16,v194
M v[168:171],a[240:243],a[200:203],v[168:171]
ds_read_b128 a[200:203],v252 offset:512
v_lshlrev_b32 v233,16,v202
M v[172:175],a[240:243],a[204:207],v[172:175]
ds_read_b128 a[204:207],v252 offset:768
v_cvt_pk_bf16_f32 v160,v160,v161
M v[176:179],a[240:243],a[208:211],v[176:179]
ds_read_b128 a[208:211],v252 offset:1024
v_cvt_pk_bf16_f32 v161,v162,v163
M v[180:183],a[240:243],a[212:215],v[180:183]
buffer_store_dwordx2 v[160:161],v255,s[24:27],s32 offen offset:1152
M v[184:187],a[240:243],a[216:219],v[184:187]
ds_read_b128 a[212:215],v252 offset:1280
ds_read_b128 a[216:219],v252 offset:1536
M v[188:191],a[240:243],a[220:223],v[188:191]
s_waitcnt lgkmcnt(6)
buffer_load_dwordx4 a[240:243],v253,s[20:23],s47 offen offset:0
M a[0:3],a[244:247],a[192:195],0
s_waitcnt lgkmcnt(5)
ds_read_b128 a[220:223],v252 offset:1792
v_cvt_pk_bf16_f32 v164,v164,v165
M a[4:7],a[244:247],a[196:199],0
s_waitcnt lgkmcnt(5)
s_add_u32 s48,s44,24576
v_cvt_pk_bf16_f32 v165,v166,v167
v_cvt_pk_bf16_f32 v168,v168,v169
M a[8:11],a[244:247],a[200:203],0
s_waitcnt lgkmcnt(4)
buffer_store_dwordx2 v[164:165],v255,s[24:27],s33 offen offset:1152
M a[12:15],a[244:247],a[204:207],0
s_waitcnt lgkmcnt(3)
v_cvt_pk_bf16_f32 v169,v170,v171
v_cvt_pk_bf16_f32 v172,v172,v173
M a[16:19],a[244:247],a[208:211],0
s_waitcnt lgkmcnt(2)
buffer_store_dwordx2 v[168:169],v255,s[24:27],s34 offen offset:1152
M a[20:23],a[244:247],a[212:215],0
s_waitcnt lgkmcnt(1)
v_cvt_pk_bf16_f32 v173,v174,v175
v_cvt_pk_bf16_f32 v176,v176,v177
M a[24:27],a[244:247],a[216:219],0
s_waitcnt lgkmcnt(0)
buffer_store_dwordx2 v[172:173],v255,s[24:27],s35 offen offset:1152
M a[28:31],a[244:247],a[220:223],0
buffer_load_dwordx4 a[244:247],v253,s[20:23],s48 offen offset:0
M a[32:35],a[248:251],a[192:195],0
v_cvt_pk_bf16_f32 v177,v178,v179
v_cvt_pk_bf16_f32 v180,v180,v181
M a[36:39],a[248:251],a[196:199],0
buffer_store_dwordx2 v[176:177],v255,s[24:27],s36 offen offset:1152
M a[40:43],a[248:251],a[200:203],0
v_cvt_pk_bf16_f32 v181,v182,v183
v_cvt_pk_bf16_f32 v184,v184,v185
M a[44:47],a[248:251],a[204:207],0
buffer_store_dwordx2 v[180:181],v255,s[24:27],s37 offen offset:1152
M a[48:51],a[248:251],a[208:211],0
v_cvt_pk_bf16_f32 v185,v186,v187
v_cvt_pk_bf16_f32 v188,v188,v189
M a[52:55],a[248:251],a[212:215],0
buffer_store_dwordx2 v[184:185],v255,s[24:27],s38 offen offset:1152
M a[56:59],a[248:251],a[216:219],0
s_waitcnt vmcnt(21)
v_cvt_pk_bf16_f32 v189,v190,v191
v_lshlrev_b32 v232,16,v200
M a[60:63],a[248:251],a[220:223],0
buffer_load_dwordx4 a[248:251],v253,s[20:23],s46 offen offset:1024
M a[64:67],a[252:255],a[192:195],0
buffer_store_dwordx2 v[188:189],v255,s[24:27],s39 offen offset:1152
M a[68:71],a[252:255],a[196:199],0
ds_read_b128 a[192:195],v252 offset:2048
v_lshlrev_b32 v231,16,v198
M a[72:75],a[252:255],a[200:203],0
v_fmac_f32 v228,s43,v230
v_fmac_f32 v233,4.0,v229
M a[76:79],a[252:255],a[204:207],0
v_fma_f32 v234,-4.0,v230,v232
v_fmac_f32 v228,s45,v232
M a[80:83],a[252:255],a[208:211],0
v_fmac_f32 v233,s40,v231
v_sub_f32 v232,v232,v230
M a[84:87],a[252:255],a[212:215],0
v_fma_f32 v230,-4.0,v229,v231
v_sub_f32 v231,v231,v229
M a[88:91],a[252:255],a[216:219],0
v_add_f32 v229,v234,v230
v_sub_f32 v234,v234,v230
M a[92:95],a[252:255],a[220:223],0
buffer_load_dwordx4 a[252:255],v253,s[20:23],s47 offen offset:1024
M a[0:3],v[216:219],a[196:199],a[0:3]
v_fma_f32 v230,2.0,v231,v232
v_fmac_f32 v232,-2.0,v231
M a[4:7],v[216:219],a[200:203],a[4:7]
v_and_b32 v237,s42,v196
v_and_b32 v235,s42,v192
M a[8:11],v[216:219],a[204:207],a[8:11]
v_and_b32 v236,s42,v194
v_and_b32 v240,s42,v202
M a[12:15],v[216:219],a[208:211],a[12:15]
v_and_b32 v239,s42,v200
v_and_b32 v238,s42,v198
M a[16:19],v[216:219],a[212:215],a[16:19]
v_fmac_f32 v235,s43,v237
v_fmac_f32 v240,4.0,v236
M a[20:23],v[216:219],a[216:219],a[20:23]
v_fma_f32 v231,-4.0,v237,v239
v_fmac_f32 v235,s45,v239
M a[24:27],v[216:219],a[220:223],a[24:27]
s_waitcnt lgkmcnt(0)
v_fmac_f32 v240,s40,v238
v_sub_f32 v239,v239,v237
M a[28:31],v[216:219],a[192:195],a[28:31]
s_waitcnt vmcnt(23)
buffer_load_dwordx4 v[216:219],v253,s[20:23],s48 offen offset:1024
M a[32:35],v[220:223],a[196:199],a[32:35]
v_fma_f32 v237,-4.0,v236,v238
v_sub_f32 v238,v238,v236
M a[36:39],v[220:223],a[200:203],a[36:39]
v_add_f32 v236,v231,v237
v_sub_f32 v231,v231,v237
M a[40:43],v[220:223],a[204:207],a[40:43]
v_fma_f32 v237,2.0,v238,v239
v_fmac_f32 v239,-2.0,v238
M a[44:47],v[220:223],a[208:211],a[44:47]
v_cvt_pk_bf16_f32 v192,v228,v235
v_cvt_pk_bf16_f32 v202,v233,v240
M a[48:51],v[220:223],a[212:215],a[48:51]
v_cvt_pk_bf16_f32 v194,v229,v236
v_cvt_pk_bf16_f32 v196,v234,v231
M a[52:55],v[220:223],a[216:219],a[52:55]
v_cvt_pk_bf16_f32 v198,v230,v237
v_cvt_pk_bf16_f32 v200,v232,v239
M a[56:59],v[220:223],a[220:223],a[56:59]
v_lshlrev_b32 v230,16,v197
v_lshlrev_b32 v228,16,v193
M a[60:63],v[220:223],a[192:195],a[60:63]
s_waitcnt vmcnt(23)
buffer_load_dwordx4 v[220:223],v253,s[20:23],s46 offen offset:2048
M a[64:67],v[224:227],a[196:199],a[64:67]
ds_read_b128 a[196:199],v251 offset:2304
v_lshlrev_b32 v229,16,v195
M a[68:71],v[224:227],a[200:203],a[68:71]
v_lshlrev_b32 v233,16,v203
v_lshlrev_b32 v232,16,v201
M a[72:75],v[224:227],a[204:207],a[72:75]
v_lshlrev_b32 v231,16,v199
v_fmac_f32 v228,s43,v230
M a[76:79],v[224:227],a[208:211],a[76:79]
v_fmac_f32 v233,4.0,v229
v_fma_f32 v234,-4.0,v230,v232
M a[80:83],v[224:227],a[212:215],a[80:83]
v_fmac_f32 v228,s45,v232
v_fmac_f32 v233,s40,v231
M a[84:87],v[224:227],a[216:219],a[84:87]
v_sub_f32 v232,v232,v230
v_fma_f32 v230,-4.0,v229,v231
M a[88:91],v[224:227],a[220:223],a[88:91]
v_sub_f32 v231,v231,v229
v_add_f32 v229,v234,v230
M a[92:95],v[224:227],a[192:195],a[92:95]
s_waitcnt vmcnt(23)
buffer_load_dwordx4 v[224:227],v253,s[20:23],s47 offen offset:2048
M a[0:3],a[224:227],a[200:203],a[0:3]
v_sub_f32 v234,v234,v230
v_fma_f32 v230,2.0,v231,v232
M a[4:7],a[224:227],a[204:207],a[4:7]
v_fmac_f32 v232,-2.0,v231
v_and_b32 v237,s42,v197
M a[8:11],a[224:227],a[208:211],a[8:11]
v_and_b32 v235,s42,v193
v_and_b32 v236,s42,v195
M a[12:15],a[224:227],a[212:215],a[12:15]
v_and_b32 v240,s42,v203
v_and_b32 v239,s42,v201
M a[16:19],a[224:227],a[216:219],a[16:19]
v_and_b32 v238,s42,v199
v_fmac_f32 v235,s43,v237
M a[20:23],a[224:227],a[220:223],a[20:23]
v_fmac_f32 v240,4.0,v236
v_fma_f32 v231,-4.0,v237,v239
M a[24:27],a[224:227],a[192:195],a[24:27]
s_waitcnt lgkmcnt(0)
v_fmac_f32 v235,s45,v239
v_fmac_f32 v240,s40,v238
M a[28:31],a[224:227],a[196:199],a[28:31]
s_waitcnt vmcnt(23)
buffer_load_dwordx4 a[224:227],v253,s[20:23],s48 offen offset:2048
M a[32:35],a[228:231],a[200:203],a[32:35]
v_sub_f32 v239,v239,v237
v_fma_f32 v237,-4.0,v236,v238
M a[36:39],a[228:231],a[204:207],a[36:39]
s_add_u32 s46,s44,27648
v_sub_f32 v238,v238,v236
v_add_f32 v236,v231,v237
M a[40:43],a[228:231],a[208:211],a[40:43]
v_sub_f32 v231,v231,v237
v_fma_f32 v237,2.0,v238,v239
M a[44:47],a[228:231],a[212:215],a[44:47]
v_fmac_f32 v239,-2.0,v238
v_cvt_pk_bf16_f32 v193,v228,v235
M a[48:51],a[228:231],a[216:219],a[48:51]
v_cvt_pk_bf16_f32 v203,v233,v240
v_cvt_pk_bf16_f32 v195,v229,v236
M a[52:55],a[228:231],a[220:223],a[52:55]
v_cvt_pk_bf16_f32 v197,v234,v231
v_cvt_pk_bf16_f32 v199,v230,v237
M a[56:59],a[228:231],a[192:195],a[56:59]
v_cvt_pk_bf16_f32 v201,v232,v239
M a[60:63],a[228:231],a[196:199],a[60:63]
s_waitcnt vmcnt(23)
buffer_load_dwordx4 a[228:231],v253,s[20:23],s46 offen offset:0
M a[64:67],a[232:235],a[200:203],a[64:67]
ds_read_b128 a[200:203],v251 offset:8704
ds_write2st64_b64 v249,v[192:193],v[202:203] offset0:170 offset1:187
M a[68:71],a[232:235],a[204:207],a[68:71]
s_add_u32 s28,s30,7077952
buffer_load_dwordx2 v[192:193],v247,s[12:15],s28 offen offset:0
M a[72:75],a[232:235],a[208:211],a[72:75]
s_add_u32 s47,s44,30720
buffer_load_dwordx2 v[202:203],v247,s[16:19],s28 offen offset:1536
M a[76:79],a[232:235],a[212:215],a[76:79]
ds_read_b128 a[204:207],v252 offset:8960
ds_read_b128 a[208:211],v252 offset:9216
M a[80:83],a[232:235],a[216:219],a[80:83]
ds_read_b128 a[212:215],v252 offset:9472
ds_read_b128 a[216:219],v252 offset:9728
M a[84:87],a[232:235],a[220:223],a[84:87]
ds_read_b128 a[220:223],v252 offset:9984
ds_write2st64_b64 v249,v[194:195],v[196:197] offset0:0 offset1:17
M a[88:91],a[232:235],a[192:195],a[88:91]
buffer_load_dwordx2 v[194:195],v247,s[8:11],s28 offen offset:0
M a[92:95],a[232:235],a[196:199],a[92:95]
s_waitcnt vmcnt(20) lgkmcnt(7)
buffer_load_dwordx2 v[196:197],v247,s[8:11],s28 offen offset:384
M a[96:99],a[236:239],a[200:203],0
s_waitcnt lgkmcnt(5)
buffer_load_dwordx4 a[232:235],v253,s[20:23],s47 offen offset:0
M a[100:103],a[236:239],a[204:207],0
s_waitcnt lgkmcnt(4)
s_add_u32 s48,s44,33792
ds_read_b128 a[192:195],v252 offset:10240
ds_read_b128 a[196:199],v252 offset:10496
M a[104:107],a[236:239],a[208:211],0
s_waitcnt lgkmcnt(5)
ds_write2st64_b64 v249,v[198:199],v[200:201] offset0:136 offset1:153
M a[108:111],a[236:239],a[212:215],0
s_waitcnt lgkmcnt(5)
buffer_load_dwordx2 v[198:199],v247,s[8:11],s28 offen offset:768
M a[112:115],a[236:239],a[216:219],0
s_waitcnt lgkmcnt(4)
buffer_load_dwordx2 v[200:201],v247,s[8:11],s28 offen offset:1152
M a[116:119],a[236:239],a[220:223],0
s_waitcnt lgkmcnt(2)
v_lshlrev_b32 v230,16,v208
v_lshlrev_b32 v228,16,v204
M a[120:123],a[236:239],a[192:195],0
s_waitcnt lgkmcnt(1)
v_lshlrev_b32 v229,16,v206
v_lshlrev_b32 v233,16,v214
M a[124:127],a[236:239],a[196:199],0
s_waitcnt vmcnt(22)
buffer_load_dwordx4 a[236:239],v253,s[20:23],s48 offen offset:0
M a[128:131],a[240:243],a[200:203],0
v_lshlrev_b32 v232,16,v212
v_lshlrev_b32 v231,16,v210
M a[132:135],a[240:243],a[204:207],0
v_fmac_f32 v228,s43,v230
v_fmac_f32 v233,4.0,v229
M a[136:139],a[240:243],a[208:211],0
v_fma_f32 v234,-4.0,v230,v232
v_fmac_f32 v228,s45,v232
M a[140:143],a[240:243],a[212:215],0
v_fmac_f32 v233,s40,v231
v_sub_f32 v232,v232,v230
M a[144:147],a[240:243],a[216:219],0
v_fma_f32 v230,-4.0,v229,v231
v_sub_f32 v231,v231,v229
M a[148:151],a[240:243],a[220:223],0
v_add_f32 v229,v234,v230
v_sub_f32 v234,v234,v230
M a[152:155],a[240:243],a[192:195],0
v_fma_f32 v230,2.0,v231,v232
v_fmac_f32 v232,-2.0,v231
M a[156:159],a[240:243],a[196:199],0
s_waitcnt vmcnt(19)
buffer_load_dwordx4 a[240:243],v253,s[20:23],s46 offen offset:1024
M a[160:163],a[244:247],a[200:203],0
ds_read_b128 a[200:203],v252 offset:10752
v_and_b32 v237,s42,v208
M a[164:167],a[244:247],a[204:207],0
v_and_b32 v235,s42,v204
v_and_b32 v236,s42,v206
M a[168:171],a[244:247],a[208:211],0
v_and_b32 v240,s42,v214
v_and_b32 v239,s42,v212
M a[172:175],a[244:247],a[212:215],0
v_and_b32 v238,s42,v210
v_fmac_f32 v235,s43,v237
M a[176:179],a[244:247],a[216:219],0
v_fmac_f32 v240,4.0,v236
v_fma_f32 v231,-4.0,v237,v239
M a[180:183],a[244:247],a[220:223],0
v_fmac_f32 v235,s45,v239
v_fmac_f32 v240,s40,v238
M a[184:187],a[244:247],a[192:195],0
v_sub_f32 v239,v239,v237
v_fma_f32 v237,-4.0,v236,v238
M a[188:191],a[244:247],a[196:199],0
s_waitcnt vmcnt(16)
buffer_load_dwordx4 a[244:247],v253,s[20:23],s47 offen offset:1024
M a[96:99],a[248:251],a[204:207],a[96:99]
v_sub_f32 v238,v238,v236
v_add_f32 v236,v231,v237
M a[100:103],a[248:251],a[208:211],a[100:103]
v_sub_f32 v231,v231,v237
v_fma_f32 v237,2.0,v238,v239
M a[104:107],a[248:251],a[212:215],a[104:107]
v_fmac_f32 v239,-2.0,v238
v_cvt_pk_bf16_f32 v204,v228,v235
M a[108:111],a[248:251],a[216:219],a[108:111]
v_cvt_pk_bf16_f32 v214,v233,v240
v_cvt_pk_bf16_f32 v206,v229,v236
M a[112:115],a[248:251],a[220:223],a[112:115]
v_cvt_pk_bf16_f32 v208,v234,v231
v_cvt_pk_bf16_f32 v210,v230,v237
M a[116:119],a[248:251],a[192:195],a[116:119]
v_cvt_pk_bf16_f32 v212,v232,v239
v_lshlrev_b32 v230,16,v209
M a[120:123],a[248:251],a[196:199],a[120:123]
s_waitcnt lgkmcnt(0)
v_lshlrev_b32 v228,16,v205
v_lshlrev_b32 v229,16,v207
M a[124:127],a[248:251],a[200:203],a[124:127]
s_waitcnt vmcnt(15)
buffer_load_dwordx4 a[248:251],v253,s[20:23],s48 offen offset:1024
M a[128:131],a[252:255],a[204:207],a[128:131]
v_lshlrev_b32 v233,16,v215
v_lshlrev_b32 v232,16,v213
M a[132:135],a[252:255],a[208:211],a[132:135]
v_lshlrev_b32 v231,16,v211
v_fmac_f32 v228,s43,v230
M a[136:139],a[252:255],a[212:215],a[136:139]
v_fmac_f32 v233,4.0,v229
v_fma_f32 v234,-4.0,v230,v232
M a[140:143],a[252:255],a[216:219],a[140:143]
v_fmac_f32 v228,s45,v232
v_fmac_f32 v233,s40,v231
M a[144:147],a[252:255],a[220:223],a[144:147]
v_sub_f32 v232,v232,v230
v_fma_f32 v230,-4.0,v229,v231
M a[148:151],a[252:255],a[192:195],a[148:151]
v_sub_f32 v231,v231,v229
v_add_f32 v229,v234,v230
M a[152:155],a[252:255],a[196:199],a[152:155]
v_sub_f32 v234,v234,v230
v_fma_f32 v230,2.0,v231,v232
M a[156:159],a[252:255],a[200:203],a[156:159]
s_waitcnt vmcnt(15)
buffer_load_dwordx4 a[252:255],v253,s[20:23],s46 offen offset:2048
M a[160:163],v[216:219],a[204:207],a[160:163]
ds_read_b128 a[204:207],v251 offset:11008
v_fmac_f32 v232,-2.0,v231
M a[164:167],v[216:219],a[208:211],a[164:167]
v_and_b32 v237,s42,v209
v_and_b32 v235,s42,v205
M a[168:171],v[216:219],a[212:215],a[168:171]
v_and_b32 v236,s42,v207
v_and_b32 v240,s42,v215
M a[172:175],v[216:219],a[216:219],a[172:175]
v_and_b32 v239,s42,v213
v_and_b32 v238,s42,v211
M a[176:179],v[216:219],a[220:223],a[176:179]
v_fmac_f32 v235,s43,v237
v_fmac_f32 v240,4.0,v236
M a[180:183],v[216:219],a[192:195],a[180:183]
v_fma_f32 v231,-4.0,v237,v239
v_fmac_f32 v235,s45,v239
M a[184:187],v[216:219],a[196:199],a[184:187]
v_fmac_f32 v240,s40,v238
v_sub_f32 v239,v239,v237
M a[188:191],v[216:219],a[200:203],a[188:191]
s_waitcnt vmcnt(15)
buffer_load_dwordx4 v[216:219],v253,s[20:23],s47 offen offset:2048
M a[96:99],v[220:223],a[208:211],a[96:99]
v_fma_f32 v237,-4.0,v236,v238
v_sub_f32 v238,v238,v236
M a[100:103],v[220:223],a[212:215],a[100:103]
v_add_f32 v236,v231,v237
v_sub_f32 v231,v231,v237
M a[104:107],v[220:223],a[216:219],a[104:107]
v_fma_f32 v237,2.0,v238,v239
v_fmac_f32 v239,-2.0,v238
M a[108:111],v[220:223],a[220:223],a[108:111]
v_cvt_pk_bf16_f32 v205,v228,v235
v_cvt_pk_bf16_f32 v215,v233,v240
M a[112:115],v[220:223],a[192:195],a[112:115]
v_cvt_pk_bf16_f32 v207,v229,v236
v_cvt_pk_bf16_f32 v209,v234,v231
M a[116:119],v[220:223],a[196:199],a[116:119]
v_cvt_pk_bf16_f32 v211,v230,v237
v_cvt_pk_bf16_f32 v213,v232,v239
M a[120:123],v[220:223],a[200:203],a[120:123]
s_waitcnt lgkmcnt(0)
ds_write2st64_b64 v249,v[204:205],v[214:215] offset0:171 offset1:188
M a[124:127],v[220:223],a[204:207],a[124:127]
s_waitcnt vmcnt(15)
s_add_u32 s28,s30,7471168
buffer_load_dwordx2 v[204:205],v247,s[12:15],s28 offen offset:0
M a[128:131],v[224:227],a[208:211],a[128:131]
buffer_load_dwordx2 v[214:215],v247,s[16:19],s28 offen offset:1536
M a[132:135],v[224:227],a[212:215],a[132:135]
buffer_load_dwordx4 v[220:223],v253,s[20:23],s48 offen offset:2048
M a[136:139],v[224:227],a[216:219],a[136:139]
s_add_u32 s46,s44,36864
ds_write2st64_b64 v249,v[206:207],v[208:209] offset0:1 offset1:18
M a[140:143],v[224:227],a[220:223],a[140:143]
buffer_load_dwordx2 v[206:207],v247,s[8:11],s28 offen offset:0
M a[144:147],v[224:227],a[192:195],a[144:147]
buffer_load_dwordx2 v[208:209],v247,s[8:11],s28 offen offset:384
M a[148:151],v[224:227],a[196:199],a[148:151]
ds_write2st64_b64 v249,v[210:211],v[212:213] offset0:137 offset1:154
M a[152:155],v[224:227],a[200:203],a[152:155]
buffer_load_dwordx2 v[210:211],v247,s[8:11],s28 offen offset:768
M a[156:159],v[224:227],a[204:207],a[156:159]
s_waitcnt vmcnt(20)
buffer_load_dwordx2 v[212:213],v247,s[8:11],s28 offen offset:1152
M a[160:163],a[224:227],a[208:211],a[160:163]
buffer_load_dwordx4 v[224:227],v253,s[20:23],s46 offen offset:0
M a[164:167],a[224:227],a[212:215],a[164:167]
s_add_u32 s47,s44,39936
ds_read_b128 a[208:211],v251 offset:17408
ds_read_b128 a[212:215],v252 offset:17664
M a[168:171],a[224:227],a[216:219],a[168:171]
ds_read_b128 a[216:219],v252 offset:17920
v_fmac_f32 v241,s43,v243
M a[172:175],a[224:227],a[220:223],a[172:175]
ds_read_b128 a[220:223],v252 offset:18176
v_fmac_f32 v246,4.0,v242
M a[176:179],a[224:227],a[192:195],a[176:179]
ds_read_b128 a[192:195],v252 offset:18432
v_fma_f32 v228,-4.0,v243,v245
M a[180:183],a[224:227],a[196:199],a[180:183]
ds_read_b128 a[196:199],v252 offset:18688
v_fmac_f32 v241,s45,v245
M a[184:187],a[224:227],a[200:203],a[184:187]
ds_read_b128 a[200:203],v252 offset:18944
v_fmac_f32 v246,s40,v244
M a[188:191],a[224:227],a[204:207],a[188:191]
s_waitcnt vmcnt(21) lgkmcnt(6)
buffer_load_dwordx4 a[224:227],v253,s[20:23],s47 offen offset:0
M v[0:3],a[228:231],a[208:211],0
s_waitcnt lgkmcnt(5)
ds_read_b128 a[204:207],v252 offset:19200
v_sub_f32 v245,v245,v243
M v[4:7],a[228:231],a[212:215],0
s_waitcnt lgkmcnt(5)
s_add_u32 s48,s44,43008
v_fma_f32 v243,-4.0,v242,v244
v_sub_f32 v244,v244,v242
M v[8:11],a[228:231],a[216:219],0
s_waitcnt lgkmcnt(4)
v_add_f32 v242,v228,v243
v_sub_f32 v228,v228,v243
M v[12:15],a[228:231],a[220:223],0
s_waitcnt lgkmcnt(3)
v_fma_f32 v243,2.0,v244,v245
v_fmac_f32 v245,-2.0,v244
M v[16:19],a[228:231],a[192:195],0
s_waitcnt lgkmcnt(2)
v_cvt_pk_bf16_f32 v229,v241,v246
v_cvt_pk_bf16_f32 v230,v242,v228
M v[20:23],a[228:231],a[196:199],0
s_waitcnt lgkmcnt(1)
v_cvt_pk_bf16_f32 v231,v243,v245
v_add_u32 v228,87040,v250
M v[24:27],a[228:231],a[200:203],0
s_waitcnt lgkmcnt(0)
s_add_u32 s29,s31,128
buffer_load_short_d16_hi v241,v248,s[12:15],s29 offen offset:0
M v[28:31],a[228:231],a[204:207],0
s_waitcnt vmcnt(18)
buffer_load_short_d16_hi v242,v248,s[8:11],s29 offen offset:0
M v[32:35],a[232:235],a[208:211],0
buffer_load_short_d16_hi v243,v248,s[8:11],s29 offen offset:384
M v[36:39],a[232:235],a[212:215],0
buffer_load_short_d16_hi v244,v248,s[8:11],s29 offen offset:768
M v[40:43],a[232:235],a[216:219],0
buffer_load_short_d16_hi v245,v248,s[8:11],s29 offen offset:1152
M v[44:47],a[232:235],a[220:223],0
buffer_load_short_d16_hi v246,v248,s[16:19],s29 offen offset:1536
M v[48:51],a[232:235],a[192:195],0
buffer_load_dwordx4 a[228:231],v253,s[20:23],s48 offen offset:0
M v[52:55],a[232:235],a[196:199],0
ds_write_b16 v228,v229 offset:0
M v[56:59],a[232:235],a[200:203],0
ds_write_b16_d16_hi v228,v229 offset:8704
M v[60:63],a[232:235],a[204:207],0
s_waitcnt vmcnt(21)
buffer_load_dwordx4 a[232:235],v253,s[20:23],s46 offen offset:1024
M v[64:67],a[236:239],a[208:211],0
ds_read_b128 a[208:211],v252 offset:19456
ds_write_b16 v250,v230 offset:0
M v[68:71],a[236:239],a[212:215],0
ds_write_b16_d16_hi v250,v230 offset:8704
M v[72:75],a[236:239],a[216:219],0
v_add_u32 v228,69632,v250
M v[76:79],a[236:239],a[220:223],0
ds_write_b16 v228,v231 offset:0
M v[80:83],a[236:239],a[192:195],0
ds_write_b16_d16_hi v228,v231 offset:8704
M v[84:87],a[236:239],a[196:199],0
v_lshlrev_b32 v230,16,v196
v_lshlrev_b32 v228,16,v192
M v[88:91],a[236:239],a[200:203],0
v_lshlrev_b32 v229,16,v194
v_lshlrev_b32 v233,16,v202
M v[92:95],a[236:239],a[204:207],0
s_waitcnt vmcnt(21)
buffer_load_dwordx4 a[236:239],v253,s[20:23],s47 offen offset:1024
M v[0:3],a[240:243],a[212:215],v[0:3]
v_lshlrev_b32 v232,16,v200
v_lshlrev_b32 v231,16,v198
M v[4:7],a[240:243],a[216:219],v[4:7]
v_fmac_f32 v228,s43,v230
v_fmac_f32 v233,4.0,v229
M v[8:11],a[240:243],a[220:223],v[8:11]
v_fma_f32 v234,-4.0,v230,v232
v_fmac_f32 v228,s45,v232
M v[12:15],a[240:243],a[192:195],v[12:15]
v_fmac_f32 v233,s40,v231
v_sub_f32 v232,v232,v230
M v[16:19],a[240:243],a[196:199],v[16:19]
v_fma_f32 v230,-4.0,v229,v231
v_sub_f32 v231,v231,v229
M v[20:23],a[240:243],a[200:203],v[20:23]
v_add_f32 v229,v234,v230
v_sub_f32 v234,v234,v230
M v[24:27],a[240:243],a[204:207],v[24:27]
s_waitcnt lgkmcnt(4)
v_fma_f32 v230,2.0,v231,v232
v_fmac_f32 v232,-2.0,v231
M v[28:31],a[240:243],a[208:211],v[28:31]
s_waitcnt vmcnt(21)
buffer_load_dwordx4 a[240:243],v253,s[20:23],s48 offen offset:1024
M v[32:35],a[244:247],a[212:215],v[32:35]
v_and_b32 v237,s42,v196
v_and_b32 v235,s42,v192
M v[36:39],a[244:247],a[216:219],v[36:39]
v_and_b32 v236,s42,v194
v_and_b32 v240,s42,v202
M v[40:43],a[244:247],a[220:223],v[40:43]
v_and_b32 v239,s42,v200
v_and_b32 v238,s42,v198
M v[44:47],a[244:247],a[192:195],v[44:47]
v_fmac_f32 v235,s43,v237
v_fmac_f32 v240,4.0,v236
M v[48:51],a[244:247],a[196:199],v[48:51]
v_fma_f32 v231,-4.0,v237,v239
v_fmac_f32 v235,s45,v239
M v[52:55],a[244:247],a[200:203],v[52:55]
v_fmac_f32 v240,s40,v238
v_sub_f32 v239,v239,v237
M v[56:59],a[244:247],a[204:207],v[56:59]
v_fma_f32 v237,-4.0,v236,v238
v_sub_f32 v238,v238,v236
M v[60:63],a[244:247],a[208:211],v[60:63]
s_waitcnt vmcnt(21)
buffer_load_dwordx4 a[244:247],v253,s[20:23],s46 offen offset:2048
M v[64:67],a[248:251],a[212:215],v[64:67]
ds_read_b128 a[212:215],v251 offset:19712
v_add_f32 v236,v231,v237
M v[68:71],a[248:251],a[216:219],v[68:71]
v_sub_f32 v231,v231,v237
v_fma_f32 v237,2.0,v238,v239
M v[72:75],a[248:251],a[220:223],v[72:75]
v_fmac_f32 v239,-2.0,v238
v_cvt_pk_bf16_f32 v192,v228,v235
M v[76:79],a[248:251],a[192:195],v[76:79]
v_cvt_pk_bf16_f32 v202,v233,v240
v_cvt_pk_bf16_f32 v194,v229,v236
M v[80:83],a[248:251],a[196:199],v[80:83]
v_cvt_pk_bf16_f32 v196,v234,v231
v_cvt_pk_bf16_f32 v198,v230,v237
M v[84:87],a[248:251],a[200:203],v[84:87]
v_cvt_pk_bf16_f32 v200,v232,v239
v_lshlrev_b32 v230,16,v197
M v[88:91],a[248:251],a[204:207],v[88:91]
v_lshlrev_b32 v228,16,v193
v_lshlrev_b32 v229,16,v195
M v[92:95],a[248:251],a[208:211],v[92:95]
s_waitcnt vmcnt(21)
buffer_load_dwordx4 a[248:251],v253,s[20:23],s47 offen offset:2048
M v[0:3],a[252:255],a[216:219],v[0:3]
v_lshlrev_b32 v233,16,v203
v_lshlrev_b32 v232,16,v201
M v[4:7],a[252:255],a[220:223],v[4:7]
v_lshlrev_b32 v231,16,v199
v_fmac_f32 v228,s43,v230
M v[8:11],a[252:255],a[192:195],v[8:11]
v_fmac_f32 v233,4.0,v229
v_fma_f32 v234,-4.0,v230,v232
M v[12:15],a[252:255],a[196:199],v[12:15]
v_fmac_f32 v228,s45,v232
v_fmac_f32 v233,s40,v231
M v[16:19],a[252:255],a[200:203],v[16:19]
v_sub_f32 v232,v232,v230
v_fma_f32 v230,-4.0,v229,v231
M v[20:23],a[252:255],a[204:207],v[20:23]
v_sub_f32 v231,v231,v229
v_add_f32 v229,v234,v230
M v[24:27],a[252:255],a[208:211],v[24:27]
s_waitcnt lgkmcnt(0)
v_sub_f32 v234,v234,v230
v_fma_f32 v230,2.0,v231,v232
M v[28:31],a[252:255],a[212:215],v[28:31]
s_waitcnt vmcnt(21)
buffer_load_dwordx4 a[252:255],v253,s[20:23],s48 offen offset:2048
M v[32:35],v[216:219],a[216:219],v[32:35]
v_fmac_f32 v232,-2.0,v231
v_and_b32 v237,s42,v197
M v[36:39],v[216:219],a[220:223],v[36:39]
s_add_u32 s46,s44,64512
v_and_b32 v235,s42,v193
v_and_b32 v236,s42,v195
M v[40:43],v[216:219],a[192:195],v[40:43]
v_and_b32 v240,s42,v203
v_and_b32 v239,s42,v201
M v[44:47],v[216:219],a[196:199],v[44:47]
v_and_b32 v238,s42,v199
v_fmac_f32 v235,s43,v237
M v[48:51],v[216:219],a[200:203],v[48:51]
v_fmac_f32 v240,4.0,v236
v_fma_f32 v231,-4.0,v237,v239
M v[52:55],v[216:219],a[204:207],v[52:55]
v_fmac_f32 v235,s45,v239
v_fmac_f32 v240,s40,v238
M v[56:59],v[216:219],a[208:211],v[56:59]
v_sub_f32 v239,v239,v237
v_fma_f32 v237,-4.0,v236,v238
M v[60:63],v[216:219],a[212:215],v[60:63]
s_waitcnt vmcnt(19)
buffer_load_dwordx4 v[216:219],v253,s[20:23],s46 offen offset:0
M v[64:67],v[220:223],a[216:219],v[64:67]
ds_read_b128 a[216:219],v251 offset:26112
v_sub_f32 v238,v238,v236
M v[68:71],v[220:223],a[220:223],v[68:71]
s_add_u32 s47,s44,67584
ds_read_b128 a[220:223],v252 offset:26368
v_add_f32 v236,v231,v237
M v[72:75],v[220:223],a[192:195],v[72:75]
ds_read_b128 a[192:195],v252 offset:26624
v_sub_f32 v231,v231,v237
M v[76:79],v[220:223],a[196:199],v[76:79]
ds_read_b128 a[196:199],v252 offset:26880
v_fma_f32 v237,2.0,v238,v239
M v[80:83],v[220:223],a[200:203],v[80:83]
ds_read_b128 a[200:203],v252 offset:27136
v_fmac_f32 v239,-2.0,v238
M v[84:87],v[220:223],a[204:207],v[84:87]
ds_read_b128 a[204:207],v252 offset:27392
v_cvt_pk_bf16_f32 v193,v228,v235
M v[88:91],v[220:223],a[208:211],v[88:91]
ds_read_b128 a[208:211],v252 offset:27648
v_cvt_pk_bf16_f32 v203,v233,v240
M v[92:95],v[220:223],a[212:215],v[92:95]
s_waitcnt vmcnt(15) lgkmcnt(6)
buffer_load_dwordx4 v[220:223],v253,s[20:23],s47 offen offset:0
M v[96:99],v[224:227],a[216:219],0
s_waitcnt lgkmcnt(5)
ds_read_b128 a[212:215],v252 offset:27904
v_cvt_pk_bf16_f32 v195,v229,v236
M v[100:103],v[224:227],a[220:223],0
s_waitcnt lgkmcnt(5)
s_add_u32 s48,s44,70656
v_cvt_pk_bf16_f32 v197,v234,v231
v_cvt_pk_bf16_f32 v199,v230,v237
M v[104:107],v[224:227],a[192:195],0
s_waitcnt lgkmcnt(4)
v_cvt_pk_bf16_f32 v201,v232,v239
M v[108:111],v[224:227],a[196:199],0
s_waitcnt lgkmcnt(3)
ds_write2st64_b64 v249,v[192:193],v[202:203] offset0:172 offset1:189
M v[112:115],v[224:227],a[200:203],0
s_waitcnt lgkmcnt(3)
s_add_u32 s28,s30,6291584
buffer_load_dwordx2 v[192:193],v247,s[12:15],s28 offen offset:0
M v[116:119],v[224:227],a[204:207],0
s_waitcnt lgkmcnt(2)
buffer_load_dwordx2 v[202:203],v247,s[16:19],s28 offen offset:1536
M v[120:123],v[224:227],a[208:211],0
s_waitcnt lgkmcnt(1)
ds_write2st64_b64 v249,v[194:195],v[196:197] offset0:2 offset1:19
M v[124:127],v[224:227],a[212:215],0
s_waitcnt vmcnt(17)
buffer_load_dwordx2 v[194:195],v247,s[8:11],s28 offen offset:0
M v[128:131],a[224:227],a[216:219],0
buffer_load_dwordx2 v[196:197],v247,s[8:11],s28 offen offset:384
M v[132:135],a[224:227],a[220:223],0
buffer_load_dwordx4 v[224:227],v253,s[20:23],s48 offen offset:0
M v[136:139],a[224:227],a[192:195],0
ds_write2st64_b64 v249,v[198:199],v[200:201] offset0:138 offset1:155
M v[140:143],a[224:227],a[196:199],0
buffer_load_dwordx2 v[198:199],v247,s[8:11],s28 offen offset:768
M v[144:147],a[224:227],a[200:203],0
buffer_load_dwordx2 v[200:201],v247,s[8:11],s28 offen offset:1152
M v[148:151],a[224:227],a[204:207],0
v_lshlrev_b32 v230,16,v208
v_lshlrev_b32 v228,16,v204
M v[152:155],a[224:227],a[208:211],0
v_lshlrev_b32 v229,16,v206
v_lshlrev_b32 v233,16,v214
M v[156:159],a[224:227],a[212:215],0
s_waitcnt vmcnt(15)
buffer_load_dwordx4 a[224:227],v253,s[20:23],s46 offen offset:1024
M v[160:163],a[228:231],a[216:219],0
ds_read_b128 a[216:219],v252 offset:28160
v_lshlrev_b32 v232,16,v212
M v[164:167],a[228:231],a[220:223],0
v_lshlrev_b32 v231,16,v210
v_fmac_f32 v228,s43,v230
M v[168:171],a[228:231],a[192:195],0
v_fmac_f32 v233,4.0,v229
v_fma_f32 v234,-4.0,v230,v232
M v[172:175],a[228:231],a[196:199],0
v_fmac_f32 v228,s45,v232
v_fmac_f32 v233,s40,v231
M v[176:179],a[228:231],a[200:203],0
v_sub_f32 v232,v232,v230
v_fma_f32 v230,-4.0,v229,v231
M v[180:183],a[228:231],a[204:207],0
v_sub_f32 v231,v231,v229
v_add_f32 v229,v234,v230
M v[184:187],a[228:231],a[208:211],0
v_sub_f32 v234,v234,v230
v_fma_f32 v230,2.0,v231,v232
M v[188:191],a[228:231],a[212:215],0
s_waitcnt vmcnt(15)
buffer_load_dwordx4 a[228:231],v253,s[20:23],s47 offen offset:1024
M v[96:99],a[232:235],a[220:223],v[96:99]
v_fmac_f32 v232,-2.0,v231
v_and_b32 v237,s42,v208
M v[100:103],a[232:235],a[192:195],v[100:103]
v_and_b32 v235,s42,v204
v_and_b32 v236,s42,v206
M v[104:107],a[232:235],a[196:199],v[104:107]
v_and_b32 v240,s42,v214
v_and_b32 v239,s42,v212
M v[108:111],a[232:235],a[200:203],v[108:111]
v_and_b32 v238,s42,v210
v_fmac_f32 v235,s43,v237
M v[112:115],a[232:235],a[204:207],v[112:115]
v_fmac_f32 v240,4.0,v236
v_fma_f32 v231,-4.0,v237,v239
M v[116:119],a[232:235],a[208:211],v[116:119]
v_fmac_f32 v235,s45,v239
v_fmac_f32 v240,s40,v238
M v[120:123],a[232:235],a[212:215],v[120:123]
s_waitcnt lgkmcnt(0)
v_sub_f32 v239,v239,v237
v_fma_f32 v237,-4.0,v236,v238
M v[124:127],a[232:235],a[216:219],v[124:127]
s_waitcnt vmcnt(15)
buffer_load_dwordx4 a[232:235],v253,s[20:23],s48 offen offset:1024
M v[128:131],a[236:239],a[220:223],v[128:131]
v_sub_f32 v238,v238,v236
v_add_f32 v236,v231,v237
M v[132:135],a[236:239],a[192:195],v[132:135]
v_sub_f32 v231,v231,v237
v_fma_f32 v237,2.0,v238,v239
M v[136:139],a[236:239],a[196:199],v[136:139]
v_fmac_f32 v239,-2.0,v238
v_cvt_pk_bf16_f32 v204,v228,v235
M v[140:143],a[236:239],a[200:203],v[140:143]
v_cvt_pk_bf16_f32 v214,v233,v240
v_cvt_pk_bf16_f32 v206,v229,v236
M v[144:147],a[236:239],a[204:207],v[144:147]
v_cvt_pk_bf16_f32 v208,v234,v231
v_cvt_pk_bf16_f32 v210,v230,v237
M v[148:151],a[236:239],a[208:211],v[148:151]
v_cvt_pk_bf16_f32 v212,v232,v239
v_lshlrev_b32 v230,16,v209
M v[152:155],a[236:239],a[212:215],v[152:155]
v_lshlrev_b32 v228,16,v205
v_lshlrev_b32 v229,16,v207
M v[156:159],a[236:239],a[216:219],v[156:159]
s_waitcnt vmcnt(15)
buffer_load_dwordx4 a[236:239],v253,s[20:23],s46 offen offset:2048
M v[160:163],a[240:243],a[220:223],v[160:163]
ds_read_b128 a[220:223],v251 offset:28416
v_lshlrev_b32 v233,16,v215
M v[164:167],a[240:243],a[192:195],v[164:167]
v_lshlrev_b32 v232,16,v213
v_lshlrev_b32 v231,16,v211
M v[168:171],a[240:243],a[196:199],v[168:171]
v_fmac_f32 v228,s43,v230
v_fmac_f32 v233,4.0,v229
M v[172:175],a[240:243],a[200:203],v[172:175]
v_fma_f32 v234,-4.0,v230,v232
v_fmac_f32 v228,s45,v232
M v[176:179],a[240:243],a[204:207],v[176:179]
v_fmac_f32 v233,s40,v231
v_sub_f32 v232,v232,v230
M v[180:183],a[240:243],a[208:211],v[180:183]
v_fma_f32 v230,-4.0,v229,v231
v_sub_f32 v231,v231,v229
M v[184:187],a[240:243],a[212:215],v[184:187]
v_add_f32 v229,v234,v230
v_sub_f32 v234,v234,v230
M v[188:191],a[240:243],a[216:219],v[188:191]
s_waitcnt vmcnt(15)
buffer_load_dwordx4 a[240:243],v253,s[20:23],s47 offen offset:2048
M v[96:99],a[244:247],a[192:195],v[96:99]
v_fma_f32 v230,2.0,v231,v232
v_fmac_f32 v232,-2.0,v231
M v[100:103],a[244:247],a[196:199],v[100:103]
v_and_b32 v237,s42,v209
v_and_b32 v235,s42,v205
v_and_b32 v236,s42,v207
v_and_b32 v240,s42,v215
M v[104:107],a[244:247],a[200:203],v[104:107]
v_and_b32 v239,s42,v213
v_and_b32 v238,s42,v211
v_fmac_f32 v235,s43,v237
v_fmac_f32 v240,4.0,v236
M v[108:111],a[244:247],a[204:207],v[108:111]
v_fma_f32 v231,-4.0,v237,v239
v_fmac_f32 v235,s45,v239
v_fmac_f32 v240,s40,v238
v_sub_f32 v239,v239,v237
M v[112:115],a[244:247],a[208:211],v[112:115]
v_fma_f32 v237,-4.0,v236,v238
v_sub_f32 v238,v238,v236
v_add_f32 v236,v231,v237
v_sub_f32 v231,v231,v237
M v[116:119],a[244:247],a[212:215],v[116:119]
v_fma_f32 v237,2.0,v238,v239
v_fmac_f32 v239,-2.0,v238
v_cvt_pk_bf16_f32 v205,v228,v235
v_cvt_pk_bf16_f32 v215,v233,v240
M v[120:123],a[244:247],a[216:219],v[120:123]
s_waitcnt lgkmcnt(0)
v_cvt_pk_bf16_f32 v207,v229,v236
v_cvt_pk_bf16_f32 v209,v234,v231
v_cvt_pk_bf16_f32 v211,v230,v237
v_cvt_pk_bf16_f32 v213,v232,v239
M v[124:127],a[244:247],a[220:223],v[124:127]
s_waitcnt vmcnt(15)
buffer_load_dwordx4 a[244:247],v253,s[20:23],s48 offen offset:2048
ds_write2st64_b64 v249,v[204:205],v[214:215] offset0:173 offset1:190
M v[128:131],a[248:251],a[192:195],v[128:131]
s_add_u32 s28,s30,6684800
buffer_load_dwordx2 v[204:205],v247,s[12:15],s28 offen offset:0
M v[132:135],a[248:251],a[196:199],v[132:135]
s_add_u32 s46,s44,73728
buffer_load_dwordx2 v[214:215],v247,s[16:19],s28 offen offset:1536
ds_write2st64_b64 v249,v[206:207],v[208:209] offset0:3 offset1:20
M v[136:139],a[248:251],a[200:203],v[136:139]
buffer_load_dwordx2 v[206:207],v247,s[8:11],s28 offen offset:0
M v[140:143],a[248:251],a[204:207],v[140:143]
buffer_load_dwordx2 v[208:209],v247,s[8:11],s28 offen offset:384
ds_write2st64_b64 v249,v[210:211],v[212:213] offset0:139 offset1:156
M v[144:147],a[248:251],a[208:211],v[144:147]
buffer_load_dwordx2 v[210:211],v247,s[8:11],s28 offen offset:768
M v[148:151],a[248:251],a[212:215],v[148:151]
buffer_load_dwordx2 v[212:213],v247,s[8:11],s28 offen offset:1152
M v[152:155],a[248:251],a[216:219],v[152:155]
s_waitcnt lgkmcnt(0)
s_barrier
v_add_u32 v251,0xffffbc00,v251
M v[156:159],a[248:251],a[220:223],v[156:159]
s_waitcnt vmcnt(21)
buffer_load_dwordx4 a[248:251],v253,s[20:23],s46 offen offset:0
M v[160:163],a[252:255],a[192:195],v[160:163]
s_waitcnt vmcnt(16)
v_add_u32 v252,0xffffbc00,v252
v_lshlrev_b32 v230,16,v196
M v[164:167],a[252:255],a[196:199],v[164:167]
s_add_u32 s47,s44,76800
ds_read_b128 a[192:195],v251 offset:0
ds_read_b128 a[196:199],v252 offset:256
M v[168:171],a[252:255],a[200:203],v[168:171]
ds_read_b128 a[200:203],v252 offset:512
v_lshlrev_b32 v228,16,v192
M v[172:175],a[252:255],a[204:207],v[172:175]
ds_read_b128 a[204:207],v252 offset:768
v_lshlrev_b32 v229,16,v194
M v[176:179],a[252:255],a[208:211],v[176:179]
ds_read_b128 a[208:211],v252 offset:1024
v_lshlrev_b32 v233,16,v202
M v[180:183],a[252:255],a[212:215],v[180:183]
s_waitcnt vmcnt(13)
ds_read_b128 a[212:215],v252 offset:1280
v_lshlrev_b32 v232,16,v200
M v[184:187],a[252:255],a[216:219],v[184:187]
ds_read_b128 a[216:219],v252 offset:1536
v_lshlrev_b32 v231,16,v198
M v[188:191],a[252:255],a[220:223],v[188:191]
s_waitcnt lgkmcnt(6)
buffer_load_dwordx4 a[252:255],v253,s[20:23],s47 offen offset:0
M a[0:3],v[216:219],a[192:195],a[0:3]
s_waitcnt lgkmcnt(5)
ds_read_b128 a[220:223],v252 offset:1792
v_fmac_f32 v228,s43,v230
M a[4:7],v[216:219],a[196:199],a[4:7]
s_waitcnt lgkmcnt(5)
s_add_u32 s48,s44,79872
v_fmac_f32 v233,4.0,v229
v_fma_f32 v234,-4.0,v230,v232
M a[8:11],v[216:219],a[200:203],a[8:11]
s_waitcnt lgkmcnt(4)
v_fmac_f32 v228,s45,v232
v_fmac_f32 v233,s40,v231
M a[12:15],v[216:219],a[204:207],a[12:15]
s_waitcnt lgkmcnt(3)
v_sub_f32 v232,v232,v230
v_fma_f32 v230,-4.0,v229,v231
M a[16:19],v[216:219],a[208:211],a[16:19]
s_waitcnt lgkmcnt(2)
v_sub_f32 v231,v231,v229
v_add_f32 v229,v234,v230
M a[20:23],v[216:219],a[212:215],a[20:23]
s_waitcnt lgkmcnt(1)
v_sub_f32 v234,v234,v230
v_fma_f32 v230,2.0,v231,v232
M a[24:27],v[216:219],a[216:219],a[24:27]
s_waitcnt lgkmcnt(0)
v_fmac_f32 v232,-2.0,v231
v_and_b32 v237,s42,v196
M a[28:31],v[216:219],a[220:223],a[28:31]
buffer_load_dwordx4 v[216:219],v253,s[20:23],s48 offen offset:0
M a[32:35],v[220:223],a[192:195],a[32:35]
v_and_b32 v235,s42,v192
v_and_b32 v236,s42,v194
M a[36:39],v[220:223],a[196:199],a[36:39]
v_and_b32 v240,s42,v202
v_and_b32 v239,s42,v200
M a[40:43],v[220:223],a[200:203],a[40:43]
v_and_b32 v238,s42,v198
v_fmac_f32 v235,s43,v237
M a[44:47],v[220:223],a[204:207],a[44:47]
v_fmac_f32 v240,4.0,v236
v_fma_f32 v231,-4.0,v237,v239
M a[48:51],v[220:223],a[208:211],a[48:51]
v_fmac_f32 v235,s45,v239
v_fmac_f32 v240,s40,v238
M a[52:55],v[220:223],a[212:215],a[52:55]
v_sub_f32 v239,v239,v237
v_fma_f32 v237,-4.0,v236,v238
M a[56:59],v[220:223],a[216:219],a[56:59]
v_sub_f32 v238,v238,v236
v_add_f32 v236,v231,v237
M a[60:63],v[220:223],a[220:223],a[60:63]
buffer_load_dwordx4 v[220:223],v253,s[20:23],s46 offen offset:1024
M a[64:67],v[224:227],a[192:195],a[64:67]
ds_read_b128 a[192:195],v252 offset:2048
v_sub_f32 v231,v231,v237
M a[68:71],v[224:227],a[196:199],a[68:71]
v_fma_f32 v237,2.0,v238,v239
v_fmac_f32 v239,-2.0,v238
M a[72:75],v[224:227],a[200:203],a[72:75]
v_cvt_pk_bf16_f32 v192,v228,v235
v_cvt_pk_bf16_f32 v202,v233,v240
M a[76:79],v[224:227],a[204:207],a[76:79]
v_cvt_pk_bf16_f32 v194,v229,v236
v_cvt_pk_bf16_f32 v196,v234,v231
M a[80:83],v[224:227],a[208:211],a[80:83]
v_cvt_pk_bf16_f32 v198,v230,v237
v_cvt_pk_bf16_f32 v200,v232,v239
M a[84:87],v[224:227],a[212:215],a[84:87]
v_lshlrev_b32 v230,16,v197
v_lshlrev_b32 v228,16,v193
M a[88:91],v[224:227],a[216:219],a[88:91]
v_lshlrev_b32 v229,16,v195
v_lshlrev_b32 v233,16,v203
M a[92:95],v[224:227],a[220:223],a[92:95]
s_waitcnt vmcnt(15)
buffer_load_dwordx4 v[224:227],v253,s[20:23],s47 offen offset:1024
M a[0:3],a[224:227],a[196:199],a[0:3]
v_lshlrev_b32 v232,16,v201
v_lshlrev_b32 v231,16,v199
M a[4:7],a[224:227],a[200:203],a[4:7]
v_fmac_f32 v228,s43,v230
v_fmac_f32 v233,4.0,v229
M a[8:11],a[224:227],a[204:207],a[8:11]
v_fma_f32 v234,-4.0,v230,v232
v_fmac_f32 v228,s45,v232
M a[12:15],a[224:227],a[208:211],a[12:15]
v_fmac_f32 v233,s40,v231
v_sub_f32 v232,v232,v230
M a[16:19],a[224:227],a[212:215],a[16:19]
v_fma_f32 v230,-4.0,v229,v231
v_sub_f32 v231,v231,v229
M a[20:23],a[224:227],a[216:219],a[20:23]
v_add_f32 v229,v234,v230
v_sub_f32 v234,v234,v230
M a[24:27],a[224:227],a[220:223],a[24:27]
s_waitcnt lgkmcnt(0)
v_fma_f32 v230,2.0,v231,v232
v_fmac_f32 v232,-2.0,v231
M a[28:31],a[224:227],a[192:195],a[28:31]
s_waitcnt vmcnt(15)
buffer_load_dwordx4 a[224:227],v253,s[20:23],s48 offen offset:1024
M a[32:35],a[228:231],a[196:199],a[32:35]
v_and_b32 v237,s42,v197
v_and_b32 v235,s42,v193
M a[36:39],a[228:231],a[200:203],a[36:39]
v_and_b32 v236,s42,v195
v_and_b32 v240,s42,v203
M a[40:43],a[228:231],a[204:207],a[40:43]
v_and_b32 v239,s42,v201
v_and_b32 v238,s42,v199
M a[44:47],a[228:231],a[208:211],a[44:47]
v_fmac_f32 v235,s43,v237
v_fmac_f32 v240,4.0,v236
M a[48:51],a[228:231],a[212:215],a[48:51]
v_fma_f32 v231,-4.0,v237,v239
v_fmac_f32 v235,s45,v239
M a[52:55],a[228:231],a[216:219],a[52:55]
v_fmac_f32 v240,s40,v238
v_sub_f32 v239,v239,v237
M a[56:59],a[228:231],a[220:223],a[56:59]
v_fma_f32 v237,-4.0,v236,v238
v_sub_f32 v238,v238,v236
M a[60:63],a[228:231],a[192:195],a[60:63]
s_waitcnt vmcnt(15)
buffer_load_dwordx4 a[228:231],v253,s[20:23],s46 offen offset:2048
M a[64:67],a[232:235],a[196:199],a[64:67]
ds_read_b128 a[196:199],v251 offset:2304
v_add_f32 v236,v231,v237
M a[68:71],a[232:235],a[200:203],a[68:71]
v_sub_f32 v231,v231,v237
v_fma_f32 v237,2.0,v238,v239
M a[72:75],a[232:235],a[204:207],a[72:75]
v_fmac_f32 v239,-2.0,v238
v_cvt_pk_bf16_f32 v193,v228,v235
M a[76:79],a[232:235],a[208:211],a[76:79]
v_cvt_pk_bf16_f32 v203,v233,v240
v_cvt_pk_bf16_f32 v195,v229,v236
M a[80:83],a[232:235],a[212:215],a[80:83]
v_cvt_pk_bf16_f32 v197,v234,v231
v_cvt_pk_bf16_f32 v199,v230,v237
M a[84:87],a[232:235],a[216:219],a[84:87]
v_cvt_pk_bf16_f32 v201,v232,v239
M a[88:91],a[232:235],a[220:223],a[88:91]
ds_write2st64_b64 v249,v[192:193],v[202:203] offset0:204 offset1:221
M a[92:95],a[232:235],a[192:195],a[92:95]
s_waitcnt vmcnt(15)
s_add_u32 s28,s30,7078016
buffer_load_dwordx2 v[192:193],v247,s[12:15],s28 offen offset:0
M a[0:3],a[236:239],a[200:203],a[0:3]
buffer_load_dwordx2 v[202:203],v247,s[16:19],s28 offen offset:1536
M a[4:7],a[236:239],a[204:207],a[4:7]
buffer_load_dwordx4 a[232:235],v253,s[20:23],s47 offen offset:2048
M a[8:11],a[236:239],a[208:211],a[8:11]
ds_write2st64_b64 v249,v[194:195],v[196:197] offset0:34 offset1:51
M a[12:15],a[236:239],a[212:215],a[12:15]
buffer_load_dwordx2 v[194:195],v247,s[8:11],s28 offen offset:0
M a[16:19],a[236:239],a[216:219],a[16:19]
buffer_load_dwordx2 v[196:197],v247,s[8:11],s28 offen offset:384
M a[20:23],a[236:239],a[220:223],a[20:23]
ds_write2st64_b64 v249,v[198:199],v[200:201] offset0:68 offset1:85
M a[24:27],a[236:239],a[192:195],a[24:27]
s_waitcnt lgkmcnt(3)
buffer_load_dwordx2 v[198:199],v247,s[8:11],s28 offen offset:768
M a[28:31],a[236:239],a[196:199],a[28:31]
s_waitcnt vmcnt(20)
buffer_load_dwordx2 v[200:201],v247,s[8:11],s28 offen offset:1152
M a[32:35],a[240:243],a[200:203],a[32:35]
buffer_load_dwordx4 a[236:239],v253,s[20:23],s48 offen offset:2048
M a[36:39],a[240:243],a[204:207],a[36:39]
s_waitcnt vmcnt(17)
s_add_u32 s46,s44,82944
v_lshlrev_b32 v230,16,v208
v_lshlrev_b32 v228,16,v204
M a[40:43],a[240:243],a[208:211],a[40:43]
v_lshlrev_b32 v229,16,v206
v_lshlrev_b32 v233,16,v214
M a[44:47],a[240:243],a[212:215],a[44:47]
s_waitcnt vmcnt(15)
v_lshlrev_b32 v232,16,v212
v_lshlrev_b32 v231,16,v210
M a[48:51],a[240:243],a[216:219],a[48:51]
v_fmac_f32 v228,s43,v230
v_fmac_f32 v233,4.0,v229
M a[52:55],a[240:243],a[220:223],a[52:55]
v_fma_f32 v234,-4.0,v230,v232
v_fmac_f32 v228,s45,v232
M a[56:59],a[240:243],a[192:195],a[56:59]
v_fmac_f32 v233,s40,v231
v_sub_f32 v232,v232,v230
M a[60:63],a[240:243],a[196:199],a[60:63]
buffer_load_dwordx4 a[240:243],v253,s[20:23],s46 offen offset:0
M a[64:67],a[244:247],a[200:203],a[64:67]
ds_read_b128 a[200:203],v251 offset:8704
v_fma_f32 v230,-4.0,v229,v231
M a[68:71],a[244:247],a[204:207],a[68:71]
s_add_u32 s47,s44,86016
ds_read_b128 a[204:207],v252 offset:8960
v_sub_f32 v231,v231,v229
M a[72:75],a[244:247],a[208:211],a[72:75]
ds_read_b128 a[208:211],v252 offset:9216
v_add_f32 v229,v234,v230
M a[76:79],a[244:247],a[212:215],a[76:79]
ds_read_b128 a[212:215],v252 offset:9472
v_sub_f32 v234,v234,v230
M a[80:83],a[244:247],a[216:219],a[80:83]
ds_read_b128 a[216:219],v252 offset:9728
v_fma_f32 v230,2.0,v231,v232
M a[84:87],a[244:247],a[220:223],a[84:87]
ds_read_b128 a[220:223],v252 offset:9984
v_fmac_f32 v232,-2.0,v231
M a[88:91],a[244:247],a[192:195],a[88:91]
ds_read_b128 a[192:195],v252 offset:10240
v_and_b32 v237,s42,v208
M a[92:95],a[244:247],a[196:199],a[92:95]
s_waitcnt vmcnt(15) lgkmcnt(6)
buffer_load_dwordx4 a[244:247],v253,s[20:23],s47 offen offset:0
M a[96:99],a[248:251],a[200:203],a[96:99]
s_waitcnt lgkmcnt(5)
ds_read_b128 a[196:199],v252 offset:10496
v_and_b32 v235,s42,v204
M a[100:103],a[248:251],a[204:207],a[100:103]
s_waitcnt lgkmcnt(5)
s_add_u32 s48,s44,89088
v_and_b32 v236,s42,v206
v_and_b32 v240,s42,v214
M a[104:107],a[248:251],a[208:211],a[104:107]
s_waitcnt lgkmcnt(4)
v_and_b32 v239,s42,v212
v_and_b32 v238,s42,v210
M a[108:111],a[248:251],a[212:215],a[108:111]
s_waitcnt lgkmcnt(3)
v_fmac_f32 v235,s43,v237
v_fmac_f32 v240,4.0,v236
M a[112:115],a[248:251],a[216:219],a[112:115]
s_waitcnt lgkmcnt(2)
v_fma_f32 v231,-4.0,v237,v239
v_fmac_f32 v235,s45,v239
M a[116:119],a[248:251],a[220:223],a[116:119]
s_waitcnt lgkmcnt(1)
v_fmac_f32 v240,s40,v238
v_sub_f32 v239,v239,v237
M a[120:123],a[248:251],a[192:195],a[120:123]
s_waitcnt lgkmcnt(0)
v_fma_f32 v237,-4.0,v236,v238
v_sub_f32 v238,v238,v236
M a[124:127],a[248:251],a[196:199],a[124:127]
s_waitcnt vmcnt(15)
buffer_load_dwordx4 a[248:251],v253,s[20:23],s48 offen offset:0
M a[128:131],a[252:255],a[200:203],a[128:131]
v_add_f32 v236,v231,v237
v_sub_f32 v231,v231,v237
M a[132:135],a[252:255],a[204:207],a[132:135]
v_fma_f32 v237,2.0,v238,v239
v_fmac_f32 v239,-2.0,v238
M a[136:139],a[252:255],a[208:211],a[136:139]
v_cvt_pk_bf16_f32 v204,v228,v235
v_cvt_pk_bf16_f32 v214,v233,v240
M a[140:143],a[252:255],a[212:215],a[140:143]
v_cvt_pk_bf16_f32 v206,v229,v236
v_cvt_pk_bf16_f32 v208,v234,v231
M a[144:147],a[252:255],a[216:219],a[144:147]
v_cvt_pk_bf16_f32 v210,v230,v237
v_cvt_pk_bf16_f32 v212,v232,v239
M a[148:151],a[252:255],a[220:223],a[148:151]
v_lshlrev_b32 v230,16,v209
v_lshlrev_b32 v228,16,v205
M a[152:155],a[252:255],a[192:195],a[152:155]
v_lshlrev_b32 v229,16,v207
v_lshlrev_b32 v233,16,v215
M a[156:159],a[252:255],a[196:199],a[156:159]
s_waitcnt vmcnt(15)
buffer_load_dwordx4 a[252:255],v253,s[20:23],s46 offen offset:1024
M a[160:163],v[216:219],a[200:203],a[160:163]
ds_read_b128 a[200:203],v252 offset:10752
v_lshlrev_b32 v232,16,v213
M a[164:167],v[216:219],a[204:207],a[164:167]
v_lshlrev_b32 v231,16,v211
v_fmac_f32 v228,s43,v230
M a[168:171],v[216:219],a[208:211],a[168:171]
v_fmac_f32 v233,4.0,v229
v_fma_f32 v234,-4.0,v230,v232
M a[172:175],v[216:219],a[212:215],a[172:175]
v_fmac_f32 v228,s45,v232
v_fmac_f32 v233,s40,v231
M a[176:179],v[216:219],a[216:219],a[176:179]
v_sub_f32 v232,v232,v230
v_fma_f32 v230,-4.0,v229,v231
M a[180:183],v[216:219],a[220:223],a[180:183]
v_sub_f32 v231,v231,v229
v_add_f32 v229,v234,v230
M a[184:187],v[216:219],a[192:195],a[184:187]
v_sub_f32 v234,v234,v230
v_fma_f32 v230,2.0,v231,v232
M a[188:191],v[216:219],a[196:199],a[188:191]
s_waitcnt vmcnt(15)
buffer_load_dwordx4 v[216:219],v253,s[20:23],s47 offen offset:1024
M a[96:99],v[220:223],a[204:207],a[96:99]
v_fmac_f32 v232,-2.0,v231
v_and_b32 v237,s42,v209
M a[100:103],v[220:223],a[208:211],a[100:103]
v_and_b32 v235,s42,v205
v_and_b32 v236,s42,v207
M a[104:107],v[220:223],a[212:215],a[104:107]
v_and_b32 v240,s42,v215
v_and_b32 v239,s42,v213
M a[108:111],v[220:223],a[216:219],a[108:111]
v_and_b32 v238,s42,v211
v_fmac_f32 v235,s43,v237
M a[112:115],v[220:223],a[220:223],a[112:115]
v_fmac_f32 v240,4.0,v236
v_fma_f32 v231,-4.0,v237,v239
M a[116:119],v[220:223],a[192:195],a[116:119]
v_fmac_f32 v235,s45,v239
v_fmac_f32 v240,s40,v238
M a[120:123],v[220:223],a[196:199],a[120:123]
s_waitcnt lgkmcnt(0)
v_sub_f32 v239,v239,v237
v_fma_f32 v237,-4.0,v236,v238
M a[124:127],v[220:223],a[200:203],a[124:127]
s_waitcnt vmcnt(15)
buffer_load_dwordx4 v[220:223],v253,s[20:23],s48 offen offset:1024
M a[128:131],v[224:227],a[204:207],a[128:131]
v_sub_f32 v238,v238,v236
v_add_f32 v236,v231,v237
M a[132:135],v[224:227],a[208:211],a[132:135]
v_sub_f32 v231,v231,v237
v_fma_f32 v237,2.0,v238,v239
M a[136:139],v[224:227],a[212:215],a[136:139]
v_fmac_f32 v239,-2.0,v238
v_cvt_pk_bf16_f32 v205,v228,v235
M a[140:143],v[224:227],a[216:219],a[140:143]
v_cvt_pk_bf16_f32 v215,v233,v240
v_cvt_pk_bf16_f32 v207,v229,v236
M a[144:147],v[224:227],a[220:223],a[144:147]
v_cvt_pk_bf16_f32 v209,v234,v231
v_cvt_pk_bf16_f32 v211,v230,v237
M a[148:151],v[224:227],a[192:195],a[148:151]
v_cvt_pk_bf16_f32 v213,v232,v239
M a[152:155],v[224:227],a[196:199],a[152:155]
ds_write2st64_b64 v249,v[204:205],v[214:215] offset0:205 offset1:222
M a[156:159],v[224:227],a[200:203],a[156:159]
s_waitcnt vmcnt(15)
s_add_u32 s28,s30,7471232
buffer_load_dwordx2 v[204:205],v247,s[12:15],s28 offen offset:0
M a[160:163],a[224:227],a[204:207],a[160:163]
buffer_load_dwordx2 v[214:215],v247,s[16:19],s28 offen offset:1536
M a[164:167],a[224:227],a[208:211],a[164:167]
buffer_load_dwordx4 v[224:227],v253,s[20:23],s46 offen offset:2048
M a[168:171],a[224:227],a[212:215],a[168:171]
ds_read_b128 a[204:207],v251 offset:11008
ds_write2st64_b64 v249,v[206:207],v[208:209] offset0:35 offset1:52
M a[172:175],a[224:227],a[216:219],a[172:175]
buffer_load_dwordx2 v[206:207],v247,s[8:11],s28 offen offset:0
M a[176:179],a[224:227],a[220:223],a[176:179]
buffer_load_dwordx2 v[208:209],v247,s[8:11],s28 offen offset:384
M a[180:183],a[224:227],a[192:195],a[180:183]
ds_write2st64_b64 v249,v[210:211],v[212:213] offset0:69 offset1:86
M a[184:187],a[224:227],a[196:199],a[184:187]
buffer_load_dwordx2 v[210:211],v247,s[8:11],s28 offen offset:768
M a[188:191],a[224:227],a[200:203],a[188:191]
s_waitcnt vmcnt(20)
buffer_load_dwordx2 v[212:213],v247,s[8:11],s28 offen offset:1152
M a[96:99],a[228:231],a[208:211],a[96:99]
buffer_load_dwordx4 a[224:227],v253,s[20:23],s47 offen offset:2048
M a[100:103],a[228:231],a[212:215],a[100:103]
v_fmac_f32 v241,s43,v243
v_fmac_f32 v246,4.0,v242
M a[104:107],a[228:231],a[216:219],a[104:107]
v_fma_f32 v228,-4.0,v243,v245
v_fmac_f32 v241,s45,v245
M a[108:111],a[228:231],a[220:223],a[108:111]
v_fmac_f32 v246,s40,v244
v_sub_f32 v245,v245,v243
M a[112:115],a[228:231],a[192:195],a[112:115]
v_fma_f32 v243,-4.0,v242,v244
v_sub_f32 v244,v244,v242
M a[116:119],a[228:231],a[196:199],a[116:119]
v_add_f32 v242,v228,v243
v_sub_f32 v228,v228,v243
M a[120:123],a[228:231],a[200:203],a[120:123]
s_waitcnt lgkmcnt(2)
v_fma_f32 v243,2.0,v244,v245
v_fmac_f32 v245,-2.0,v244
M a[124:127],a[228:231],a[204:207],a[124:127]
s_waitcnt vmcnt(19)
buffer_load_dwordx4 a[228:231],v253,s[20:23],s48 offen offset:2048
M a[128:131],a[232:235],a[208:211],a[128:131]
v_cvt_pk_bf16_f32 v229,v241,v246
v_cvt_pk_bf16_f32 v230,v242,v228
M a[132:135],a[232:235],a[212:215],a[132:135]
s_add_u32 s46,s44,92160
v_cvt_pk_bf16_f32 v231,v243,v245
v_add_u32 v228,104448,v250
M a[136:139],a[232:235],a[216:219],a[136:139]
s_add_u32 s29,s31,192
buffer_load_short_d16_hi v241,v248,s[12:15],s29 offen offset:0
M a[140:143],a[232:235],a[220:223],a[140:143]
buffer_load_short_d16_hi v242,v248,s[8:11],s29 offen offset:0
M a[144:147],a[232:235],a[192:195],a[144:147]
buffer_load_short_d16_hi v243,v248,s[8:11],s29 offen offset:384
M a[148:151],a[232:235],a[196:199],a[148:151]
buffer_load_short_d16_hi v244,v248,s[8:11],s29 offen offset:768
M a[152:155],a[232:235],a[200:203],a[152:155]
buffer_load_short_d16_hi v245,v248,s[8:11],s29 offen offset:1152
M a[156:159],a[232:235],a[204:207],a[156:159]
s_waitcnt vmcnt(20)
buffer_load_short_d16_hi v246,v248,s[16:19],s29 offen offset:1536
M a[160:163],a[236:239],a[208:211],a[160:163]
buffer_load_dwordx4 a[232:235],v253,s[20:23],s46 offen offset:0
M a[164:167],a[236:239],a[212:215],a[164:167]
s_add_u32 s47,s44,95232
ds_write_b16 v228,v229 offset:0
v_add_u32 v251,0x4400,v251
v_add_u32 v252,0x4400,v252
M a[168:171],a[236:239],a[216:219],a[168:171]
ds_read_b128 a[208:211],v251 offset:52224
ds_read_b128 a[212:215],v252 offset:52480
M a[172:175],a[236:239],a[220:223],a[172:175]
ds_read_b128 a[216:219],v252 offset:52736
ds_read_b128 a[220:223],v252 offset:52992
M a[176:179],a[236:239],a[192:195],a[176:179]
ds_read_b128 a[192:195],v252 offset:53248
ds_write_b16_d16_hi v228,v229 offset:8704
M a[180:183],a[236:239],a[196:199],a[180:183]
ds_read_b128 a[196:199],v252 offset:53504
ds_write_b16 v250,v230 offset:17408
M a[184:187],a[236:239],a[200:203],a[184:187]
ds_read_b128 a[200:203],v252 offset:53760
ds_write_b16_d16_hi v250,v230 offset:26112
M a[188:191],a[236:239],a[204:207],a[188:191]
s_waitcnt vmcnt(21) lgkmcnt(9)
buffer_load_dwordx4 a[236:239],v253,s[20:23],s47 offen offset:0
M v[0:3],a[240:243],a[208:211],v[0:3]
s_waitcnt lgkmcnt(8)
ds_read_b128 a[204:207],v252 offset:54016
ds_write_b16 v250,v231 offset:34816
M v[4:7],a[240:243],a[212:215],v[4:7]
s_waitcnt lgkmcnt(9)
s_add_u32 s48,s44,98304
ds_write_b16_d16_hi v250,v231 offset:43520
M v[8:11],a[240:243],a[216:219],v[8:11]
s_waitcnt lgkmcnt(9)
v_lshlrev_b32 v230,16,v196
v_lshlrev_b32 v228,16,v192
M v[12:15],a[240:243],a[220:223],v[12:15]
s_waitcnt lgkmcnt(8)
v_lshlrev_b32 v229,16,v194
v_lshlrev_b32 v233,16,v202
M v[16:19],a[240:243],a[192:195],v[16:19]
s_waitcnt lgkmcnt(6)
v_lshlrev_b32 v232,16,v200
v_lshlrev_b32 v231,16,v198
M v[20:23],a[240:243],a[196:199],v[20:23]
s_waitcnt lgkmcnt(4)
v_fmac_f32 v228,s43,v230
v_fmac_f32 v233,4.0,v229
M v[24:27],a[240:243],a[200:203],v[24:27]
s_waitcnt lgkmcnt(2)
v_fma_f32 v234,-4.0,v230,v232
v_fmac_f32 v228,s45,v232
M v[28:31],a[240:243],a[204:207],v[28:31]
s_waitcnt vmcnt(21)
buffer_load_dwordx4 a[240:243],v253,s[20:23],s48 offen offset:0
M v[32:35],a[244:247],a[208:211],v[32:35]
v_fmac_f32 v233,s40,v231
v_sub_f32 v232,v232,v230
M v[36:39],a[244:247],a[212:215],v[36:39]
v_fma_f32 v230,-4.0,v229,v231
v_sub_f32 v231,v231,v229
M v[40:43],a[244:247],a[216:219],v[40:43]
v_add_f32 v229,v234,v230
v_sub_f32 v234,v234,v230
M v[44:47],a[244:247],a[220:223],v[44:47]
v_fma_f32 v230,2.0,v231,v232
v_fmac_f32 v232,-2.0,v231
M v[48:51],a[244:247],a[192:195],v[48:51]
v_and_b32 v237,s42,v196
v_and_b32 v235,s42,v192
M v[52:55],a[244:247],a[196:199],v[52:55]
v_and_b32 v236,s42,v194
v_and_b32 v240,s42,v202
M v[56:59],a[244:247],a[200:203],v[56:59]
v_and_b32 v239,s42,v200
v_and_b32 v238,s42,v198
M v[60:63],a[244:247],a[204:207],v[60:63]
s_waitcnt vmcnt(21)
buffer_load_dwordx4 a[244:247],v253,s[20:23],s46 offen offset:1024
M v[64:67],a[248:251],a[208:211],v[64:67]
ds_read_b128 a[208:211],v252 offset:54272
v_fmac_f32 v235,s43,v237
M v[68:71],a[248:251],a[212:215],v[68:71]
v_fmac_f32 v240,4.0,v236
v_fma_f32 v231,-4.0,v237,v239
M v[72:75],a[248:251],a[216:219],v[72:75]
v_fmac_f32 v235,s45,v239
v_fmac_f32 v240,s40,v238
M v[76:79],a[248:251],a[220:223],v[76:79]
v_sub_f32 v239,v239,v237
v_fma_f32 v237,-4.0,v236,v238
M v[80:83],a[248:251],a[192:195],v[80:83]
v_sub_f32 v238,v238,v236
v_add_f32 v236,v231,v237
M v[84:87],a[248:251],a[196:199],v[84:87]
v_sub_f32 v231,v231,v237
v_fma_f32 v237,2.0,v238,v239
M v[88:91],a[248:251],a[200:203],v[88:91]
v_fmac_f32 v239,-2.0,v238
v_cvt_pk_bf16_f32 v192,v228,v235
M v[92:95],a[248:251],a[204:207],v[92:95]
s_waitcnt vmcnt(21)
buffer_load_dwordx4 a[248:251],v253,s[20:23],s47 offen offset:1024
M v[0:3],a[252:255],a[212:215],v[0:3]
v_cvt_pk_bf16_f32 v202,v233,v240
v_cvt_pk_bf16_f32 v194,v229,v236
M v[4:7],a[252:255],a[216:219],v[4:7]
v_cvt_pk_bf16_f32 v196,v234,v231
v_cvt_pk_bf16_f32 v198,v230,v237
M v[8:11],a[252:255],a[220:223],v[8:11]
v_cvt_pk_bf16_f32 v200,v232,v239
v_lshlrev_b32 v230,16,v197
M v[12:15],a[252:255],a[192:195],v[12:15]
v_lshlrev_b32 v228,16,v193
v_lshlrev_b32 v229,16,v195
M v[16:19],a[252:255],a[196:199],v[16:19]
v_lshlrev_b32 v233,16,v203
v_lshlrev_b32 v232,16,v201
M v[20:23],a[252:255],a[200:203],v[20:23]
v_lshlrev_b32 v231,16,v199
v_fmac_f32 v228,s43,v230
M v[24:27],a[252:255],a[204:207],v[24:27]
s_waitcnt lgkmcnt(0)
v_fmac_f32 v233,4.0,v229
v_fma_f32 v234,-4.0,v230,v232
M v[28:31],a[252:255],a[208:211],v[28:31]
s_waitcnt vmcnt(21)
buffer_load_dwordx4 a[252:255],v253,s[20:23],s48 offen offset:1024
M v[32:35],v[216:219],a[212:215],v[32:35]
v_fmac_f32 v228,s45,v232
v_fmac_f32 v233,s40,v231
M v[36:39],v[216:219],a[216:219],v[36:39]
v_sub_f32 v232,v232,v230
v_fma_f32 v230,-4.0,v229,v231
M v[40:43],v[216:219],a[220:223],v[40:43]
v_sub_f32 v231,v231,v229
v_add_f32 v229,v234,v230
M v[44:47],v[216:219],a[192:195],v[44:47]
v_sub_f32 v234,v234,v230
v_fma_f32 v230,2.0,v231,v232
M v[48:51],v[216:219],a[196:199],v[48:51]
v_fmac_f32 v232,-2.0,v231
v_and_b32 v237,s42,v197
M v[52:55],v[216:219],a[200:203],v[52:55]
v_and_b32 v235,s42,v193
v_and_b32 v236,s42,v195
M v[56:59],v[216:219],a[204:207],v[56:59]
v_and_b32 v240,s42,v203
v_and_b32 v239,s42,v201
M v[60:63],v[216:219],a[208:211],v[60:63]
s_waitcnt vmcnt(21)
buffer_load_dwordx4 v[216:219],v253,s[20:23],s46 offen offset:2048
M v[64:67],v[220:223],a[212:215],v[64:67]
ds_read_b128 a[212:215],v251 offset:54528
v_and_b32 v238,s42,v199
M v[68:71],v[220:223],a[216:219],v[68:71]
v_fmac_f32 v235,s43,v237
v_fmac_f32 v240,4.0,v236
M v[72:75],v[220:223],a[220:223],v[72:75]
v_fma_f32 v231,-4.0,v237,v239
v_fmac_f32 v235,s45,v239
M v[76:79],v[220:223],a[192:195],v[76:79]
v_fmac_f32 v240,s40,v238
v_sub_f32 v239,v239,v237
M v[80:83],v[220:223],a[196:199],v[80:83]
v_fma_f32 v237,-4.0,v236,v238
v_sub_f32 v238,v238,v236
M v[84:87],v[220:223],a[200:203],v[84:87]
v_add_f32 v236,v231,v237
v_sub_f32 v231,v231,v237
M v[88:91],v[220:223],a[204:207],v[88:91]
v_fma_f32 v237,2.0,v238,v239
v_fmac_f32 v239,-2.0,v238
M v[92:95],v[220:223],a[208:211],v[92:95]
s_waitcnt vmcnt(19)
buffer_load_dwordx4 v[220:223],v253,s[20:23],s47 offen offset:2048
M v[0:3],v[224:227],a[216:219],v[0:3]
v_cvt_pk_bf16_f32 v193,v228,v235
v_cvt_pk_bf16_f32 v203,v233,v240
M v[4:7],v[224:227],a[220:223],v[4:7]
v_cvt_pk_bf16_f32 v195,v229,v236
v_cvt_pk_bf16_f32 v197,v234,v231
M v[8:11],v[224:227],a[192:195],v[8:11]
v_cvt_pk_bf16_f32 v199,v230,v237
v_cvt_pk_bf16_f32 v201,v232,v239
M v[12:15],v[224:227],a[196:199],v[12:15]
ds_write2st64_b64 v249,v[192:193],v[202:203] offset0:206 offset1:223
M v[16:19],v[224:227],a[200:203],v[16:19]
s_add_u32 s28,s30,6291648
buffer_load_dwordx2 v[192:193],v247,s[12:15],s28 offen offset:0
M v[20:23],v[224:227],a[204:207],v[20:23]
buffer_load_dwordx2 v[202:203],v247,s[16:19],s28 offen offset:1536
M v[24:27],v[224:227],a[208:211],v[24:27]
s_waitcnt lgkmcnt(1)
ds_write2st64_b64 v249,v[194:195],v[196:197] offset0:36 offset1:53
M v[28:31],v[224:227],a[212:215],v[28:31]
s_waitcnt vmcnt(17)
buffer_load_dwordx2 v[194:195],v247,s[8:11],s28 offen offset:0
M v[32:35],a[224:227],a[216:219],v[32:35]
buffer_load_dwordx2 v[196:197],v247,s[8:11],s28 offen offset:384
M v[36:39],a[224:227],a[220:223],v[36:39]
buffer_load_dwordx4 v[224:227],v253,s[20:23],s48 offen offset:2048
M v[40:43],a[224:227],a[192:195],v[40:43]
s_add_u32 s46,s44,119808
ds_write2st64_b64 v249,v[198:199],v[200:201] offset0:70 offset1:87
M v[44:47],a[224:227],a[196:199],v[44:47]
buffer_load_dwordx2 v[198:199],v247,s[8:11],s28 offen offset:768
M v[48:51],a[224:227],a[200:203],v[48:51]
buffer_load_dwordx2 v[200:201],v247,s[8:11],s28 offen offset:1152
M v[52:55],a[224:227],a[204:207],v[52:55]
v_lshlrev_b32 v230,16,v208
v_lshlrev_b32 v228,16,v204
M v[56:59],a[224:227],a[208:211],v[56:59]
v_lshlrev_b32 v229,16,v206
v_lshlrev_b32 v233,16,v214
M v[60:63],a[224:227],a[212:215],v[60:63]
s_waitcnt vmcnt(21)
buffer_load_dwordx4 a[224:227],v253,s[20:23],s46 offen offset:0
M v[64:67],a[228:231],a[216:219],v[64:67]
ds_read_b128 a[216:219],v251 offset:60928
v_lshlrev_b32 v232,16,v212
M v[68:71],a[228:231],a[220:223],v[68:71]
s_add_u32 s47,s44,122880
ds_read_b128 a[220:223],v252 offset:61184
v_lshlrev_b32 v231,16,v210
M v[72:75],a[228:231],a[192:195],v[72:75]
ds_read_b128 a[192:195],v252 offset:61440
v_fmac_f32 v228,s43,v230
M v[76:79],a[228:231],a[196:199],v[76:79]
ds_read_b128 a[196:199],v252 offset:61696
v_fmac_f32 v233,4.0,v229
M v[80:83],a[228:231],a[200:203],v[80:83]
ds_read_b128 a[200:203],v252 offset:61952
v_fma_f32 v234,-4.0,v230,v232
M v[84:87],a[228:231],a[204:207],v[84:87]
ds_read_b128 a[204:207],v252 offset:62208
v_fmac_f32 v228,s45,v232
M v[88:91],a[228:231],a[208:211],v[88:91]
ds_read_b128 a[208:211],v252 offset:62464
v_fmac_f32 v233,s40,v231
M v[92:95],a[228:231],a[212:215],v[92:95]
s_waitcnt vmcnt(15) lgkmcnt(6)
buffer_load_dwordx4 a[228:231],v253,s[20:23],s47 offen offset:0
M v[96:99],a[232:235],a[216:219],v[96:99]
s_waitcnt lgkmcnt(5)
ds_read_b128 a[212:215],v252 offset:62720
v_sub_f32 v232,v232,v230
M v[100:103],a[232:235],a[220:223],v[100:103]
s_waitcnt lgkmcnt(5)
s_add_u32 s48,s44,125952
v_fma_f32 v230,-4.0,v229,v231
v_sub_f32 v231,v231,v229
M v[104:107],a[232:235],a[192:195],v[104:107]
s_waitcnt lgkmcnt(4)
v_add_f32 v229,v234,v230
v_sub_f32 v234,v234,v230
M v[108:111],a[232:235],a[196:199],v[108:111]
s_waitcnt lgkmcnt(3)
v_fma_f32 v230,2.0,v231,v232
v_fmac_f32 v232,-2.0,v231
M v[112:115],a[232:235],a[200:203],v[112:115]
s_waitcnt lgkmcnt(2)
v_and_b32 v237,s42,v208
v_and_b32 v235,s42,v204
M v[116:119],a[232:235],a[204:207],v[116:119]
s_waitcnt lgkmcnt(1)
v_and_b32 v236,s42,v206
v_and_b32 v240,s42,v214
M v[120:123],a[232:235],a[208:211],v[120:123]
s_waitcnt lgkmcnt(0)
v_and_b32 v239,s42,v212
v_and_b32 v238,s42,v210
M v[124:127],a[232:235],a[212:215],v[124:127]
s_waitcnt vmcnt(15)
buffer_load_dwordx4 a[232:235],v253,s[20:23],s48 offen offset:0
M v[128:131],a[236:239],a[216:219],v[128:131]
v_fmac_f32 v235,s43,v237
v_fmac_f32 v240,4.0,v236
M v[132:135],a[236:239],a[220:223],v[132:135]
v_fma_f32 v231,-4.0,v237,v239
v_fmac_f32 v235,s45,v239
M v[136:139],a[236:239],a[192:195],v[136:139]
v_fmac_f32 v240,s40,v238
v_sub_f32 v239,v239,v237
M v[140:143],a[236:239],a[196:199],v[140:143]
v_fma_f32 v237,-4.0,v236,v238
v_sub_f32 v238,v238,v236
M v[144:147],a[236:239],a[200:203],v[144:147]
v_add_f32 v236,v231,v237
v_sub_f32 v231,v231,v237
M v[148:151],a[236:239],a[204:207],v[148:151]
v_fma_f32 v237,2.0,v238,v239
v_fmac_f32 v239,-2.0,v238
M v[152:155],a[236:239],a[208:211],v[152:155]
v_cvt_pk_bf16_f32 v204,v228,v235
v_cvt_pk_bf16_f32 v214,v233,v240
M v[156:159],a[236:239],a[212:215],v[156:159]
s_waitcnt vmcnt(15)
buffer_load_dwordx4 a[236:239],v253,s[20:23],s46 offen offset:1024
M v[160:163],a[240:243],a[216:219],v[160:163]
ds_read_b128 a[216:219],v252 offset:62976
v_cvt_pk_bf16_f32 v206,v229,v236
M v[164:167],a[240:243],a[220:223],v[164:167]
v_cvt_pk_bf16_f32 v208,v234,v231
v_cvt_pk_bf16_f32 v210,v230,v237
M v[168:171],a[240:243],a[192:195],v[168:171]
v_cvt_pk_bf16_f32 v212,v232,v239
v_lshlrev_b32 v230,16,v209
M v[172:175],a[240:243],a[196:199],v[172:175]
v_lshlrev_b32 v228,16,v205
v_lshlrev_b32 v229,16,v207
M v[176:179],a[240:243],a[200:203],v[176:179]
v_lshlrev_b32 v233,16,v215
v_lshlrev_b32 v232,16,v213
M v[180:183],a[240:243],a[204:207],v[180:183]
v_lshlrev_b32 v231,16,v211
v_fmac_f32 v228,s43,v230
M v[184:187],a[240:243],a[208:211],v[184:187]
v_fmac_f32 v233,4.0,v229
v_fma_f32 v234,-4.0,v230,v232
M v[188:191],a[240:243],a[212:215],v[188:191]
s_waitcnt vmcnt(15)
buffer_load_dwordx4 a[240:243],v253,s[20:23],s47 offen offset:1024
M v[96:99],a[244:247],a[220:223],v[96:99]
v_fmac_f32 v228,s45,v232
v_fmac_f32 v233,s40,v231
M v[100:103],a[244:247],a[192:195],v[100:103]
v_sub_f32 v232,v232,v230
v_fma_f32 v230,-4.0,v229,v231
M v[104:107],a[244:247],a[196:199],v[104:107]
v_sub_f32 v231,v231,v229
v_add_f32 v229,v234,v230
M v[108:111],a[244:247],a[200:203],v[108:111]
v_sub_f32 v234,v234,v230
v_fma_f32 v230,2.0,v231,v232
M v[112:115],a[244:247],a[204:207],v[112:115]
v_fmac_f32 v232,-2.0,v231
v_and_b32 v237,s42,v209
M v[116:119],a[244:247],a[208:211],v[116:119]
v_and_b32 v235,s42,v205
v_and_b32 v236,s42,v207
M v[120:123],a[244:247],a[212:215],v[120:123]
s_waitcnt lgkmcnt(0)
v_and_b32 v240,s42,v215
v_and_b32 v239,s42,v213
M v[124:127],a[244:247],a[216:219],v[124:127]
s_waitcnt vmcnt(15)
buffer_load_dwordx4 a[244:247],v253,s[20:23],s48 offen offset:1024
M v[128:131],a[248:251],a[220:223],v[128:131]
v_and_b32 v238,s42,v211
v_fmac_f32 v235,s43,v237
M v[132:135],a[248:251],a[192:195],v[132:135]
v_fmac_f32 v240,4.0,v236
v_fma_f32 v231,-4.0,v237,v239
M v[136:139],a[248:251],a[196:199],v[136:139]
v_fmac_f32 v235,s45,v239
v_fmac_f32 v240,s40,v238
M v[140:143],a[248:251],a[200:203],v[140:143]
v_sub_f32 v239,v239,v237
v_fma_f32 v237,-4.0,v236,v238
M v[144:147],a[248:251],a[204:207],v[144:147]
v_sub_f32 v238,v238,v236
v_add_f32 v236,v231,v237
M v[148:151],a[248:251],a[208:211],v[148:151]
v_sub_f32 v231,v231,v237
v_fma_f32 v237,2.0,v238,v239
M v[152:155],a[248:251],a[212:215],v[152:155]
v_fmac_f32 v239,-2.0,v238
v_cvt_pk_bf16_f32 v205,v228,v235
M v[156:159],a[248:251],a[216:219],v[156:159]
s_waitcnt vmcnt(15)
buffer_load_dwordx4 a[248:251],v253,s[20:23],s46 offen offset:2048
M v[160:163],a[252:255],a[220:223],v[160:163]
ds_read_b128 a[220:223],v251 offset:63232
v_cvt_pk_bf16_f32 v215,v233,v240
M v[164:167],a[252:255],a[192:195],v[164:167]
v_cvt_pk_bf16_f32 v207,v229,v236
v_cvt_pk_bf16_f32 v209,v234,v231
M v[168:171],a[252:255],a[196:199],v[168:171]
v_cvt_pk_bf16_f32 v211,v230,v237
v_cvt_pk_bf16_f32 v213,v232,v239
M v[172:175],a[252:255],a[200:203],v[172:175]
ds_write2st64_b64 v249,v[204:205],v[214:215] offset0:207 offset1:224
M v[176:179],a[252:255],a[204:207],v[176:179]
s_add_u32 s28,s30,6684864
buffer_load_dwordx2 v[204:205],v247,s[12:15],s28 offen offset:0
M v[180:183],a[252:255],a[208:211],v[180:183]
buffer_load_dwordx2 v[214:215],v247,s[16:19],s28 offen offset:1536
M v[184:187],a[252:255],a[212:215],v[184:187]
ds_write2st64_b64 v249,v[206:207],v[208:209] offset0:37 offset1:54
M v[188:191],a[252:255],a[216:219],v[188:191]
s_waitcnt vmcnt(17)
buffer_load_dwordx2 v[206:207],v247,s[8:11],s28 offen offset:0
M v[96:99],v[216:219],a[192:195],v[96:99]
buffer_load_dwordx2 v[208:209],v247,s[8:11],s28 offen offset:384
M v[100:103],v[216:219],a[196:199],v[100:103]
buffer_load_dwordx4 a[252:255],v253,s[20:23],s47 offen offset:2048
M v[104:107],v[216:219],a[200:203],v[104:107]
ds_write2st64_b64 v249,v[210:211],v[212:213] offset0:71 offset1:88
M v[108:111],v[216:219],a[204:207],v[108:111]
buffer_load_dwordx2 v[210:211],v247,s[8:11],s28 offen offset:768
M v[112:115],v[216:219],a[208:211],v[112:115]
buffer_load_dwordx2 v[212:213],v247,s[8:11],s28 offen offset:1152
M v[116:119],v[216:219],a[212:215],v[116:119]
s_waitcnt vmcnt(17)
v_lshlrev_b32 v230,16,v196
v_lshlrev_b32 v228,16,v192
M v[120:123],v[216:219],a[216:219],v[120:123]
s_waitcnt lgkmcnt(3)
v_lshlrev_b32 v229,16,v194
v_lshlrev_b32 v233,16,v202
M v[124:127],v[216:219],a[220:223],v[124:127]
buffer_load_dwordx4 v[216:219],v253,s[20:23],s48 offen offset:2048
M v[128:131],v[220:223],a[192:195],v[128:131]
s_waitcnt vmcnt(15)
v_lshlrev_b32 v232,16,v200
v_lshlrev_b32 v231,16,v198
M v[132:135],v[220:223],a[196:199],v[132:135]
s_add_u32 s46,s44,129024
v_fmac_f32 v228,s43,v230
v_fmac_f32 v233,4.0,v229
M v[136:139],v[220:223],a[200:203],v[136:139]
v_fma_f32 v234,-4.0,v230,v232
v_fmac_f32 v228,s45,v232
M v[140:143],v[220:223],a[204:207],v[140:143]
v_fmac_f32 v233,s40,v231
v_sub_f32 v232,v232,v230
M v[144:147],v[220:223],a[208:211],v[144:147]
v_fma_f32 v230,-4.0,v229,v231
v_sub_f32 v231,v231,v229
M v[148:151],v[220:223],a[212:215],v[148:151]
v_add_f32 v229,v234,v230
v_sub_f32 v234,v234,v230
M v[152:155],v[220:223],a[216:219],v[152:155]
s_waitcnt lgkmcnt(0)
s_barrier
v_fma_f32 v230,2.0,v231,v232
M v[156:159],v[220:223],a[220:223],v[156:159]
buffer_load_dwordx4 v[220:223],v253,s[20:23],s46 offen offset:0
M v[160:163],v[224:227],a[192:195],v[160:163]
ds_read_b128 a[192:195],v251 offset:0
v_fmac_f32 v232,-2.0,v231
M v[164:167],v[224:227],a[196:199],v[164:167]
s_add_u32 s47,s44,132096
ds_read_b128 a[196:199],v252 offset:256
v_and_b32 v237,s42,v196
M v[168:171],v[224:227],a[200:203],v[168:171]
ds_read_b128 a[200:203],v252 offset:512
v_and_b32 v235,s42,v192
M v[172:175],v[224:227],a[204:207],v[172:175]
ds_read_b128 a[204:207],v252 offset:768
v_and_b32 v236,s42,v194
M v[176:179],v[224:227],a[208:211],v[176:179]
ds_read_b128 a[208:211],v252 offset:1024
v_and_b32 v240,s42,v202
M v[180:183],v[224:227],a[212:215],v[180:183]
ds_read_b128 a[212:215],v252 offset:1280
v_and_b32 v239,s42,v200
M v[184:187],v[224:227],a[216:219],v[184:187]
ds_read_b128 a[216:219],v252 offset:1536
v_and_b32 v238,s42,v198
M v[188:191],v[224:227],a[220:223],v[188:191]
s_waitcnt vmcnt(15) lgkmcnt(6)
buffer_load_dwordx4 v[224:227],v253,s[20:23],s47 offen offset:0
M a[0:3],a[224:227],a[192:195],a[0:3]
s_waitcnt lgkmcnt(5)
ds_read_b128 a[220:223],v252 offset:1792
v_fmac_f32 v235,s43,v237
M a[4:7],a[224:227],a[196:199],a[4:7]
s_waitcnt lgkmcnt(5)
s_add_u32 s48,s44,135168
v_fmac_f32 v240,4.0,v236
v_fma_f32 v231,-4.0,v237,v239
M a[8:11],a[224:227],a[200:203],a[8:11]
s_waitcnt lgkmcnt(4)
v_fmac_f32 v235,s45,v239
v_fmac_f32 v240,s40,v238
M a[12:15],a[224:227],a[204:207],a[12:15]
s_waitcnt lgkmcnt(3)
v_sub_f32 v239,v239,v237
v_fma_f32 v237,-4.0,v236,v238
M a[16:19],a[224:227],a[208:211],a[16:19]
s_waitcnt lgkmcnt(2)
v_sub_f32 v238,v238,v236
v_add_f32 v236,v231,v237
M a[20:23],a[224:227],a[212:215],a[20:23]
s_waitcnt lgkmcnt(1)
v_sub_f32 v231,v231,v237
v_fma_f32 v237,2.0,v238,v239
M a[24:27],a[224:227],a[216:219],a[24:27]
s_waitcnt lgkmcnt(0)
v_fmac_f32 v239,-2.0,v238
v_cvt_pk_bf16_f32 v192,v228,v235
M a[28:31],a[224:227],a[220:223],a[28:31]
s_waitcnt vmcnt(15)
buffer_load_dwordx4 a[224:227],v253,s[20:23],s48 offen offset:0
M a[32:35],a[228:231],a[192:195],a[32:35]
v_cvt_pk_bf16_f32 v202,v233,v240
v_cvt_pk_bf16_f32 v194,v229,v236
M a[36:39],a[228:231],a[196:199],a[36:39]
v_cvt_pk_bf16_f32 v196,v234,v231
v_cvt_pk_bf16_f32 v198,v230,v237
M a[40:43],a[228:231],a[200:203],a[40:43]
v_cvt_pk_bf16_f32 v200,v232,v239
v_lshlrev_b32 v230,16,v197
M a[44:47],a[228:231],a[204:207],a[44:47]
v_lshlrev_b32 v228,16,v193
v_lshlrev_b32 v229,16,v195
M a[48:51],a[228:231],a[208:211],a[48:51]
v_lshlrev_b32 v233,16,v203
v_lshlrev_b32 v232,16,v201
M a[52:55],a[228:231],a[212:215],a[52:55]
v_lshlrev_b32 v231,16,v199
v_fmac_f32 v228,s43,v230
M a[56:59],a[228:231],a[216:219],a[56:59]
v_fmac_f32 v233,4.0,v229
v_fma_f32 v234,-4.0,v230,v232
M a[60:63],a[228:231],a[220:223],a[60:63]
s_waitcnt vmcnt(15)
buffer_load_dwordx4 a[228:231],v253,s[20:23],s46 offen offset:1024
M a[64:67],a[232:235],a[192:195],a[64:67]
ds_read_b128 a[192:195],v252 offset:2048
v_fmac_f32 v228,s45,v232
M a[68:71],a[232:235],a[196:199],a[68:71]
v_fmac_f32 v233,s40,v231
v_sub_f32 v232,v232,v230
M a[72:75],a[232:235],a[200:203],a[72:75]
v_fma_f32 v230,-4.0,v229,v231
v_sub_f32 v231,v231,v229
M a[76:79],a[232:235],a[204:207],a[76:79]
v_add_f32 v229,v234,v230
v_sub_f32 v234,v234,v230
M a[80:83],a[232:235],a[208:211],a[80:83]
v_fma_f32 v230,2.0,v231,v232
v_fmac_f32 v232,-2.0,v231
M a[84:87],a[232:235],a[212:215],a[84:87]
v_and_b32 v237,s42,v197
v_and_b32 v235,s42,v193
M a[88:91],a[232:235],a[216:219],a[88:91]
v_and_b32 v236,s42,v195
v_and_b32 v240,s42,v203
M a[92:95],a[232:235],a[220:223],a[92:95]
s_waitcnt vmcnt(15)
buffer_load_dwordx4 a[232:235],v253,s[20:23],s47 offen offset:1024
M a[0:3],a[236:239],a[196:199],a[0:3]
v_and_b32 v239,s42,v201
v_and_b32 v238,s42,v199
M a[4:7],a[236:239],a[200:203],a[4:7]
v_fmac_f32 v235,s43,v237
v_fmac_f32 v240,4.0,v236
M a[8:11],a[236:239],a[204:207],a[8:11]
v_fma_f32 v231,-4.0,v237,v239
v_fmac_f32 v235,s45,v239
M a[12:15],a[236:239],a[208:211],a[12:15]
v_fmac_f32 v240,s40,v238
v_sub_f32 v239,v239,v237
M a[16:19],a[236:239],a[212:215],a[16:19]
v_fma_f32 v237,-4.0,v236,v238
v_sub_f32 v238,v238,v236
M a[20:23],a[236:239],a[216:219],a[20:23]
v_add_f32 v236,v231,v237
v_sub_f32 v231,v231,v237
M a[24:27],a[236:239],a[220:223],a[24:27]
s_waitcnt lgkmcnt(0)
v_fma_f32 v237,2.0,v238,v239
v_fmac_f32 v239,-2.0,v238
M a[28:31],a[236:239],a[192:195],a[28:31]
s_waitcnt vmcnt(15)
buffer_load_dwordx4 a[236:239],v253,s[20:23],s48 offen offset:1024
M a[32:35],a[240:243],a[196:199],a[32:35]
v_cvt_pk_bf16_f32 v193,v228,v235
v_cvt_pk_bf16_f32 v203,v233,v240
M a[36:39],a[240:243],a[200:203],a[36:39]
v_cvt_pk_bf16_f32 v195,v229,v236
v_cvt_pk_bf16_f32 v197,v234,v231
M a[40:43],a[240:243],a[204:207],a[40:43]
v_cvt_pk_bf16_f32 v199,v230,v237
v_cvt_pk_bf16_f32 v201,v232,v239
M a[44:47],a[240:243],a[208:211],a[44:47]
ds_write2st64_b64 v249,v[192:193],v[202:203] offset0:238 offset1:255
M a[48:51],a[240:243],a[212:215],a[48:51]
s_add_u32 s28,s30,7078080
buffer_load_dwordx2 v[192:193],v247,s[12:15],s28 offen offset:0
M a[52:55],a[240:243],a[216:219],a[52:55]
buffer_load_dwordx2 v[202:203],v247,s[16:19],s28 offen offset:1536
M a[56:59],a[240:243],a[220:223],a[56:59]
ds_write2st64_b64 v249,v[194:195],v[196:197] offset0:0 offset1:17
M a[60:63],a[240:243],a[192:195],a[60:63]
s_waitcnt vmcnt(17)
buffer_load_dwordx2 v[194:195],v247,s[8:11],s28 offen offset:0
M a[64:67],a[244:247],a[196:199],a[64:67]
buffer_load_dwordx2 v[196:197],v247,s[8:11],s28 offen offset:384
M a[68:71],a[244:247],a[200:203],a[68:71]
buffer_load_dwordx4 a[240:243],v253,s[20:23],s46 offen offset:2048
M a[72:75],a[244:247],a[204:207],a[72:75]
ds_read_b128 a[196:199],v251 offset:2304
ds_write2st64_b64 v249,v[198:199],v[200:201] offset0:136 offset1:153
M a[76:79],a[244:247],a[208:211],a[76:79]
buffer_load_dwordx2 v[198:199],v247,s[8:11],s28 offen offset:768
M a[80:83],a[244:247],a[212:215],a[80:83]
buffer_load_dwordx2 v[200:201],v247,s[8:11],s28 offen offset:1152
M a[84:87],a[244:247],a[216:219],a[84:87]
s_waitcnt vmcnt(17)
v_lshlrev_b32 v230,16,v208
v_lshlrev_b32 v228,16,v204
M a[88:91],a[244:247],a[220:223],a[88:91]
v_lshlrev_b32 v229,16,v206
v_lshlrev_b32 v233,16,v214
M a[92:95],a[244:247],a[192:195],a[92:95]
buffer_load_dwordx4 a[244:247],v253,s[20:23],s47 offen offset:2048
M a[0:3],a[248:251],a[200:203],a[0:3]
s_waitcnt vmcnt(15)
v_lshlrev_b32 v232,16,v212
v_lshlrev_b32 v231,16,v210
M a[4:7],a[248:251],a[204:207],a[4:7]
v_fmac_f32 v228,s43,v230
v_fmac_f32 v233,4.0,v229
M a[8:11],a[248:251],a[208:211],a[8:11]
v_fma_f32 v234,-4.0,v230,v232
v_fmac_f32 v228,s45,v232
M a[12:15],a[248:251],a[212:215],a[12:15]
v_fmac_f32 v233,s40,v231
v_sub_f32 v232,v232,v230
M a[16:19],a[248:251],a[216:219],a[16:19]
v_fma_f32 v230,-4.0,v229,v231
v_sub_f32 v231,v231,v229
M a[20:23],a[248:251],a[220:223],a[20:23]
v_add_f32 v229,v234,v230
v_sub_f32 v234,v234,v230
M a[24:27],a[248:251],a[192:195],a[24:27]
s_waitcnt lgkmcnt(1)
v_fma_f32 v230,2.0,v231,v232
v_fmac_f32 v232,-2.0,v231
M a[28:31],a[248:251],a[196:199],a[28:31]
buffer_load_dwordx4 a[248:251],v253,s[20:23],s48 offen offset:2048
M a[32:35],a[252:255],a[200:203],a[32:35]
v_and_b32 v237,s42,v208
v_and_b32 v235,s42,v204
M a[36:39],a[252:255],a[204:207],a[36:39]
s_add_u32 s46,s44,138240
v_and_b32 v236,s42,v206
v_and_b32 v240,s42,v214
M a[40:43],a[252:255],a[208:211],a[40:43]
v_and_b32 v239,s42,v212
v_and_b32 v238,s42,v210
M a[44:47],a[252:255],a[212:215],a[44:47]
v_fmac_f32 v235,s43,v237
v_fmac_f32 v240,4.0,v236
M a[48:51],a[252:255],a[216:219],a[48:51]
v_fma_f32 v231,-4.0,v237,v239
v_fmac_f32 v235,s45,v239
M a[52:55],a[252:255],a[220:223],a[52:55]
v_fmac_f32 v240,s40,v238
v_sub_f32 v239,v239,v237
M a[56:59],a[252:255],a[192:195],a[56:59]
v_fma_f32 v237,-4.0,v236,v238
v_sub_f32 v238,v238,v236
M a[60:63],a[252:255],a[196:199],a[60:63]
s_waitcnt vmcnt(15)
buffer_load_dwordx4 a[252:255],v253,s[20:23],s46 offen offset:0
M a[64:67],v[216:219],a[200:203],a[64:67]
ds_read_b128 a[200:203],v251 offset:8704
v_add_f32 v236,v231,v237
M a[68:71],v[216:219],a[204:207],a[68:71]
s_add_u32 s47,s44,141312
ds_read_b128 a[204:207],v252 offset:8960
v_sub_f32 v231,v231,v237
M a[72:75],v[216:219],a[208:211],a[72:75]
ds_read_b128 a[208:211],v252 offset:9216
v_fma_f32 v237,2.0,v238,v239
M a[76:79],v[216:219],a[212:215],a[76:79]
ds_read_b128 a[212:215],v252 offset:9472
v_fmac_f32 v239,-2.0,v238
M a[80:83],v[216:219],a[216:219],a[80:83]
ds_read_b128 a[216:219],v252 offset:9728
v_cvt_pk_bf16_f32 v204,v228,v235
M a[84:87],v[216:219],a[220:223],a[84:87]
ds_read_b128 a[220:223],v252 offset:9984
v_cvt_pk_bf16_f32 v214,v233,v240
M a[88:91],v[216:219],a[192:195],a[88:91]
ds_read_b128 a[192:195],v252 offset:10240
v_cvt_pk_bf16_f32 v206,v229,v236
M a[92:95],v[216:219],a[196:199],a[92:95]
s_waitcnt vmcnt(15) lgkmcnt(6)
buffer_load_dwordx4 v[216:219],v253,s[20:23],s47 offen offset:0
M a[96:99],v[220:223],a[200:203],a[96:99]
s_waitcnt lgkmcnt(5)
ds_read_b128 a[196:199],v252 offset:10496
v_cvt_pk_bf16_f32 v208,v234,v231
M a[100:103],v[220:223],a[204:207],a[100:103]
s_waitcnt lgkmcnt(5)
s_add_u32 s48,s44,144384
v_cvt_pk_bf16_f32 v210,v230,v237
v_cvt_pk_bf16_f32 v212,v232,v239
M a[104:107],v[220:223],a[208:211],a[104:107]
s_waitcnt lgkmcnt(4)
v_lshlrev_b32 v230,16,v209
v_lshlrev_b32 v228,16,v205
M a[108:111],v[220:223],a[212:215],a[108:111]
s_waitcnt lgkmcnt(3)
v_lshlrev_b32 v229,16,v207
v_lshlrev_b32 v233,16,v215
M a[112:115],v[220:223],a[216:219],a[112:115]
s_waitcnt lgkmcnt(2)
v_lshlrev_b32 v232,16,v213
v_lshlrev_b32 v231,16,v211
M a[116:119],v[220:223],a[220:223],a[116:119]
s_waitcnt lgkmcnt(1)
v_fmac_f32 v228,s43,v230
v_fmac_f32 v233,4.0,v229
M a[120:123],v[220:223],a[192:195],a[120:123]
s_waitcnt lgkmcnt(0)
v_fma_f32 v234,-4.0,v230,v232
v_fmac_f32 v228,s45,v232
M a[124:127],v[220:223],a[196:199],a[124:127]
s_waitcnt vmcnt(15)
buffer_load_dwordx4 v[220:223],v253,s[20:23],s48 offen offset:0
M a[128:131],v[224:227],a[200:203],a[128:131]
v_fmac_f32 v233,s40,v231
v_sub_f32 v232,v232,v230
M a[132:135],v[224:227],a[204:207],a[132:135]
v_fma_f32 v230,-4.0,v229,v231
v_sub_f32 v231,v231,v229
M a[136:139],v[224:227],a[208:211],a[136:139]
v_add_f32 v229,v234,v230
v_sub_f32 v234,v234,v230
M a[140:143],v[224:227],a[212:215],a[140:143]
v_fma_f32 v230,2.0,v231,v232
v_fmac_f32 v232,-2.0,v231
M a[144:147],v[224:227],a[216:219],a[144:147]
v_and_b32 v237,s42,v209
v_and_b32 v235,s42,v205
M a[148:151],v[224:227],a[220:223],a[148:151]
v_and_b32 v236,s42,v207
v_and_b32 v240,s42,v215
M a[152:155],v[224:227],a[192:195],a[152:155]
v_and_b32 v239,s42,v213
v_and_b32 v238,s42,v211
M a[156:159],v[224:227],a[196:199],a[156:159]
s_waitcnt vmcnt(15)
buffer_load_dwordx4 v[224:227],v253,s[20:23],s46 offen offset:1024
M a[160:163],a[224:227],a[200:203],a[160:163]
ds_read_b128 a[200:203],v252 offset:10752
v_fmac_f32 v235,s43,v237
M a[164:167],a[224:227],a[204:207],a[164:167]
v_fmac_f32 v240,4.0,v236
v_fma_f32 v231,-4.0,v237,v239
M a[168:171],a[224:227],a[208:211],a[168:171]
v_fmac_f32 v235,s45,v239
v_fmac_f32 v240,s40,v238
M a[172:175],a[224:227],a[212:215],a[172:175]
v_sub_f32 v239,v239,v237
v_fma_f32 v237,-4.0,v236,v238
M a[176:179],a[224:227],a[216:219],a[176:179]
v_sub_f32 v238,v238,v236
v_add_f32 v236,v231,v237
M a[180:183],a[224:227],a[220:223],a[180:183]
v_sub_f32 v231,v231,v237
v_fma_f32 v237,2.0,v238,v239
M a[184:187],a[224:227],a[192:195],a[184:187]
v_fmac_f32 v239,-2.0,v238
v_cvt_pk_bf16_f32 v205,v228,v235
M a[188:191],a[224:227],a[196:199],a[188:191]
s_waitcnt vmcnt(15)
buffer_load_dwordx4 a[224:227],v253,s[20:23],s47 offen offset:1024
M a[96:99],a[228:231],a[204:207],a[96:99]
v_cvt_pk_bf16_f32 v215,v233,v240
v_cvt_pk_bf16_f32 v207,v229,v236
M a[100:103],a[228:231],a[208:211],a[100:103]
v_cvt_pk_bf16_f32 v209,v234,v231
v_cvt_pk_bf16_f32 v211,v230,v237
M a[104:107],a[228:231],a[212:215],a[104:107]
v_cvt_pk_bf16_f32 v213,v232,v239
v_add_u32 v228,121856,v249
M a[108:111],a[228:231],a[216:219],a[108:111]
ds_write2st64_b64 v228,v[204:205],v[214:215] offset0:1 offset1:18
M a[112:115],a[228:231],a[220:223],a[112:115]
s_add_u32 s28,s30,7471296
buffer_load_dwordx2 v[204:205],v247,s[12:15],s28 offen offset:0
M a[116:119],a[228:231],a[192:195],a[116:119]
buffer_load_dwordx2 v[214:215],v247,s[16:19],s28 offen offset:1536
M a[120:123],a[228:231],a[196:199],a[120:123]
s_waitcnt lgkmcnt(1)
ds_write2st64_b64 v249,v[206:207],v[208:209] offset0:1 offset1:18
M a[124:127],a[228:231],a[200:203],a[124:127]
s_waitcnt vmcnt(17)
buffer_load_dwordx2 v[206:207],v247,s[8:11],s28 offen offset:0
M a[128:131],a[232:235],a[204:207],a[128:131]
buffer_load_dwordx2 v[208:209],v247,s[8:11],s28 offen offset:384
M a[132:135],a[232:235],a[208:211],a[132:135]
buffer_load_dwordx4 a[228:231],v253,s[20:23],s48 offen offset:1024
M a[136:139],a[232:235],a[212:215],a[136:139]
ds_write2st64_b64 v249,v[210:211],v[212:213] offset0:137 offset1:154
M a[140:143],a[232:235],a[216:219],a[140:143]
buffer_load_dwordx2 v[210:211],v247,s[8:11],s28 offen offset:768
M a[144:147],a[232:235],a[220:223],a[144:147]
buffer_load_dwordx2 v[212:213],v247,s[8:11],s28 offen offset:1152
M a[148:151],a[232:235],a[192:195],a[148:151]
v_fmac_f32 v241,s43,v243
v_fmac_f32 v246,4.0,v242
M a[152:155],a[232:235],a[196:199],a[152:155]
v_fma_f32 v228,-4.0,v243,v245
v_fmac_f32 v241,s45,v245
M a[156:159],a[232:235],a[200:203],a[156:159]
s_waitcnt vmcnt(21)
buffer_load_dwordx4 a[232:235],v253,s[20:23],s46 offen offset:2048
M a[160:163],a[236:239],a[204:207],a[160:163]
ds_read_b128 a[204:207],v251 offset:11008
v_fmac_f32 v246,s40,v244
M a[164:167],a[236:239],a[208:211],a[164:167]
v_sub_f32 v245,v245,v243
v_fma_f32 v243,-4.0,v242,v244
M a[168:171],a[236:239],a[212:215],a[168:171]
v_sub_f32 v244,v244,v242
v_add_f32 v242,v228,v243
M a[172:175],a[236:239],a[216:219],a[172:175]
v_sub_f32 v228,v228,v243
v_fma_f32 v243,2.0,v244,v245
M a[176:179],a[236:239],a[220:223],a[176:179]
v_fmac_f32 v245,-2.0,v244
v_cvt_pk_bf16_f32 v229,v241,v246
M a[180:183],a[236:239],a[192:195],a[180:183]
v_cvt_pk_bf16_f32 v230,v242,v228
v_cvt_pk_bf16_f32 v231,v243,v245
M a[184:187],a[236:239],a[196:199],a[184:187]
s_add_u32 s29,s31,256
buffer_load_short_d16_hi v241,v248,s[12:15],s29 offen offset:0
M a[188:191],a[236:239],a[200:203],a[188:191]
s_waitcnt vmcnt(18)
buffer_load_short_d16_hi v242,v248,s[8:11],s29 offen offset:0
M a[96:99],a[240:243],a[208:211],a[96:99]
buffer_load_short_d16_hi v243,v248,s[8:11],s29 offen offset:384
M a[100:103],a[240:243],a[212:215],a[100:103]
buffer_load_short_d16_hi v244,v248,s[8:11],s29 offen offset:768
M a[104:107],a[240:243],a[216:219],a[104:107]
buffer_load_short_d16_hi v245,v248,s[8:11],s29 offen offset:1152
M a[108:111],a[240:243],a[220:223],a[108:111]
buffer_load_short_d16_hi v246,v248,s[16:19],s29 offen offset:1536
M a[112:115],a[240:243],a[192:195],a[112:115]
buffer_load_dwordx4 a[236:239],v253,s[20:23],s47 offen offset:2048
M a[116:119],a[240:243],a[196:199],a[116:119]
v_add_u32 v228,121856,v250
M a[120:123],a[240:243],a[200:203],a[120:123]
s_waitcnt lgkmcnt(0)
ds_write_b16 v228,v229 offset:0
M a[124:127],a[240:243],a[204:207],a[124:127]
s_waitcnt vmcnt(21)
buffer_load_dwordx4 a[240:243],v253,s[20:23],s48 offen offset:2048
M a[128:131],a[244:247],a[208:211],a[128:131]
ds_write_b16_d16_hi v228,v229 offset:8704
M a[132:135],a[244:247],a[212:215],a[132:135]
s_add_u32 s46,s44,147456
ds_write_b16 v250,v230 offset:0
M a[136:139],a[244:247],a[216:219],a[136:139]
ds_write_b16_d16_hi v250,v230 offset:8704
M a[140:143],a[244:247],a[220:223],a[140:143]
v_add_u32 v228,69632,v250
M a[144:147],a[244:247],a[192:195],a[144:147]
ds_write_b16 v228,v231 offset:0
M a[148:151],a[244:247],a[196:199],a[148:151]
ds_write_b16_d16_hi v228,v231 offset:8704
M a[152:155],a[244:247],a[200:203],a[152:155]
v_lshlrev_b32 v230,16,v196
v_lshlrev_b32 v228,16,v192
M a[156:159],a[244:247],a[204:207],a[156:159]
s_waitcnt vmcnt(21)
buffer_load_dwordx4 a[244:247],v253,s[20:23],s46 offen offset:0
M a[160:163],a[248:251],a[208:211],a[160:163]
ds_read_b128 a[208:211],v251 offset:17408
v_lshlrev_b32 v229,16,v194
M a[164:167],a[248:251],a[212:215],a[164:167]
s_add_u32 s47,s44,150528
ds_read_b128 a[212:215],v252 offset:17664
v_lshlrev_b32 v233,16,v202
M a[168:171],a[248:251],a[216:219],a[168:171]
ds_read_b128 a[216:219],v252 offset:17920
v_lshlrev_b32 v232,16,v200
M a[172:175],a[248:251],a[220:223],a[172:175]
ds_read_b128 a[220:223],v252 offset:18176
v_lshlrev_b32 v231,16,v198
M a[176:179],a[248:251],a[192:195],a[176:179]
ds_read_b128 a[192:195],v252 offset:18432
v_fmac_f32 v228,s43,v230
M a[180:183],a[248:251],a[196:199],a[180:183]
ds_read_b128 a[196:199],v252 offset:18688
v_fmac_f32 v233,4.0,v229
M a[184:187],a[248:251],a[200:203],a[184:187]
ds_read_b128 a[200:203],v252 offset:18944
v_fma_f32 v234,-4.0,v230,v232
M a[188:191],a[248:251],a[204:207],a[188:191]
s_waitcnt vmcnt(21) lgkmcnt(6)
buffer_load_dwordx4 a[248:251],v253,s[20:23],s47 offen offset:0
M v[0:3],a[252:255],a[208:211],v[0:3]
s_waitcnt lgkmcnt(5)
ds_read_b128 a[204:207],v252 offset:19200
v_fmac_f32 v228,s45,v232
M v[4:7],a[252:255],a[212:215],v[4:7]
s_waitcnt lgkmcnt(5)
s_add_u32 s48,s44,153600
v_fmac_f32 v233,s40,v231
v_sub_f32 v232,v232,v230
M v[8:11],a[252:255],a[216:219],v[8:11]
s_waitcnt lgkmcnt(4)
v_fma_f32 v230,-4.0,v229,v231
v_sub_f32 v231,v231,v229
M v[12:15],a[252:255],a[220:223],v[12:15]
s_waitcnt lgkmcnt(3)
v_add_f32 v229,v234,v230
v_sub_f32 v234,v234,v230
M v[16:19],a[252:255],a[192:195],v[16:19]
s_waitcnt lgkmcnt(2)
v_fma_f32 v230,2.0,v231,v232
v_fmac_f32 v232,-2.0,v231
M v[20:23],a[252:255],a[196:199],v[20:23]
s_waitcnt lgkmcnt(1)
v_and_b32 v237,s42,v196
v_and_b32 v235,s42,v192
M v[24:27],a[252:255],a[200:203],v[24:27]
s_waitcnt lgkmcnt(0)
v_and_b32 v236,s42,v194
v_and_b32 v240,s42,v202
M v[28:31],a[252:255],a[204:207],v[28:31]
s_waitcnt vmcnt(21)
buffer_load_dwordx4 a[252:255],v253,s[20:23],s48 offen offset:0
M v[32:35],v[216:219],a[208:211],v[32:35]
v_and_b32 v239,s42,v200
v_and_b32 v238,s42,v198
M v[36:39],v[216:219],a[212:215],v[36:39]
v_fmac_f32 v235,s43,v237
v_fmac_f32 v240,4.0,v236
M v[40:43],v[216:219],a[216:219],v[40:43]
v_fma_f32 v231,-4.0,v237,v239
v_fmac_f32 v235,s45,v239
M v[44:47],v[216:219],a[220:223],v[44:47]
v_fmac_f32 v240,s40,v238
v_sub_f32 v239,v239,v237
M v[48:51],v[216:219],a[192:195],v[48:51]
v_fma_f32 v237,-4.0,v236,v238
v_sub_f32 v238,v238,v236
M v[52:55],v[216:219],a[196:199],v[52:55]
v_add_f32 v236,v231,v237
v_sub_f32 v231,v231,v237
M v[56:59],v[216:219],a[200:203],v[56:59]
v_fma_f32 v237,2.0,v238,v239
v_fmac_f32 v239,-2.0,v238
M v[60:63],v[216:219],a[204:207],v[60:63]
s_waitcnt vmcnt(21)
buffer_load_dwordx4 v[216:219],v253,s[20:23],s46 offen offset:1024
M v[64:67],v[220:223],a[208:211],v[64:67]
ds_read_b128 a[208:211],v252 offset:19456
v_cvt_pk_bf16_f32 v192,v228,v235
M v[68:71],v[220:223],a[212:215],v[68:71]
v_cvt_pk_bf16_f32 v202,v233,v240
v_cvt_pk_bf16_f32 v194,v229,v236
M v[72:75],v[220:223],a[216:219],v[72:75]
v_cvt_pk_bf16_f32 v196,v234,v231
v_cvt_pk_bf16_f32 v198,v230,v237
M v[76:79],v[220:223],a[220:223],v[76:79]
v_cvt_pk_bf16_f32 v200,v232,v239
v_lshlrev_b32 v230,16,v197
M v[80:83],v[220:223],a[192:195],v[80:83]
v_lshlrev_b32 v228,16,v193
v_lshlrev_b32 v229,16,v195
M v[84:87],v[220:223],a[196:199],v[84:87]
v_lshlrev_b32 v233,16,v203
v_lshlrev_b32 v232,16,v201
M v[88:91],v[220:223],a[200:203],v[88:91]
v_lshlrev_b32 v231,16,v199
v_fmac_f32 v228,s43,v230
M v[92:95],v[220:223],a[204:207],v[92:95]
s_waitcnt vmcnt(21)
buffer_load_dwordx4 v[220:223],v253,s[20:23],s47 offen offset:1024
M v[0:3],v[224:227],a[212:215],v[0:3]
v_fmac_f32 v233,4.0,v229
v_fma_f32 v234,-4.0,v230,v232
M v[4:7],v[224:227],a[216:219],v[4:7]
v_fmac_f32 v228,s45,v232
v_fmac_f32 v233,s40,v231
M v[8:11],v[224:227],a[220:223],v[8:11]
v_sub_f32 v232,v232,v230
v_fma_f32 v230,-4.0,v229,v231
M v[12:15],v[224:227],a[192:195],v[12:15]
v_sub_f32 v231,v231,v229
v_add_f32 v229,v234,v230
M v[16:19],v[224:227],a[196:199],v[16:19]
v_sub_f32 v234,v234,v230
v_fma_f32 v230,2.0,v231,v232
M v[20:23],v[224:227],a[200:203],v[20:23]
v_fmac_f32 v232,-2.0,v231
v_and_b32 v237,s42,v197
M v[24:27],v[224:227],a[204:207],v[24:27]
s_waitcnt lgkmcnt(0)
v_and_b32 v235,s42,v193
v_and_b32 v236,s42,v195
M v[28:31],v[224:227],a[208:211],v[28:31]
s_waitcnt vmcnt(21)
buffer_load_dwordx4 v[224:227],v253,s[20:23],s48 offen offset:1024
M v[32:35],a[224:227],a[212:215],v[32:35]
v_and_b32 v240,s42,v203
v_and_b32 v239,s42,v201
M v[36:39],a[224:227],a[216:219],v[36:39]
v_and_b32 v238,s42,v199
v_fmac_f32 v235,s43,v237
M v[40:43],a[224:227],a[220:223],v[40:43]
v_fmac_f32 v240,4.0,v236
v_fma_f32 v231,-4.0,v237,v239
M v[44:47],a[224:227],a[192:195],v[44:47]
v_fmac_f32 v235,s45,v239
v_fmac_f32 v240,s40,v238
M v[48:51],a[224:227],a[196:199],v[48:51]
v_sub_f32 v239,v239,v237
v_fma_f32 v237,-4.0,v236,v238
M v[52:55],a[224:227],a[200:203],v[52:55]
v_sub_f32 v238,v238,v236
v_add_f32 v236,v231,v237
M v[56:59],a[224:227],a[204:207],v[56:59]
v_sub_f32 v231,v231,v237
v_fma_f32 v237,2.0,v238,v239
M v[60:63],a[224:227],a[208:211],v[60:63]
s_waitcnt vmcnt(17)
buffer_load_dwordx4 a[224:227],v253,s[20:23],s46 offen offset:2048
M v[64:67],a[228:231],a[212:215],v[64:67]
ds_read_b128 a[212:215],v251 offset:19712
v_fmac_f32 v239,-2.0,v238
M v[68:71],a[228:231],a[216:219],v[68:71]
v_cvt_pk_bf16_f32 v193,v228,v235
v_cvt_pk_bf16_f32 v203,v233,v240
M v[72:75],a[228:231],a[220:223],v[72:75]
v_cvt_pk_bf16_f32 v195,v229,v236
v_cvt_pk_bf16_f32 v197,v234,v231
M v[76:79],a[228:231],a[192:195],v[76:79]
v_cvt_pk_bf16_f32 v199,v230,v237
v_cvt_pk_bf16_f32 v201,v232,v239
M v[80:83],a[228:231],a[196:199],v[80:83]
v_add_u32 v228,121856,v249
M v[84:87],a[228:231],a[200:203],v[84:87]
ds_write2st64_b64 v228,v[192:193],v[202:203] offset0:2 offset1:19
M v[88:91],a[228:231],a[204:207],v[88:91]
s_add_u32 s28,s30,6291712
buffer_load_dwordx2 v[192:193],v247,s[12:15],s28 offen offset:0
M v[92:95],a[228:231],a[208:211],v[92:95]
s_waitcnt vmcnt(16)
buffer_load_dwordx2 v[202:203],v247,s[16:19],s28 offen offset:1536
M v[0:3],a[232:235],a[216:219],v[0:3]
buffer_load_dwordx4 a[228:231],v253,s[20:23],s47 offen offset:2048
M v[4:7],a[232:235],a[220:223],v[4:7]
ds_write2st64_b64 v249,v[194:195],v[196:197] offset0:2 offset1:19
M v[8:11],a[232:235],a[192:195],v[8:11]
buffer_load_dwordx2 v[194:195],v247,s[8:11],s28 offen offset:0
M v[12:15],a[232:235],a[196:199],v[12:15]
buffer_load_dwordx2 v[196:197],v247,s[8:11],s28 offen offset:384
M v[16:19],a[232:235],a[200:203],v[16:19]
ds_write2st64_b64 v249,v[198:199],v[200:201] offset0:138 offset1:155
M v[20:23],a[232:235],a[204:207],v[20:23]
buffer_load_dwordx2 v[198:199],v247,s[8:11],s28 offen offset:768
M v[24:27],a[232:235],a[208:211],v[24:27]
s_waitcnt lgkmcnt(3)
buffer_load_dwordx2 v[200:201],v247,s[8:11],s28 offen offset:1152
M v[28:31],a[232:235],a[212:215],v[28:31]
s_waitcnt vmcnt(15)
buffer_load_dwordx4 a[232:235],v253,s[20:23],s48 offen offset:2048
M v[32:35],a[236:239],a[216:219],v[32:35]
v_lshlrev_b32 v230,16,v208
v_lshlrev_b32 v228,16,v204
M v[36:39],a[236:239],a[220:223],v[36:39]
s_add_u32 s46,s44,175104
v_lshlrev_b32 v229,16,v206
v_lshlrev_b32 v233,16,v214
M v[40:43],a[236:239],a[192:195],v[40:43]
v_lshlrev_b32 v232,16,v212
v_lshlrev_b32 v231,16,v210
M v[44:47],a[236:239],a[196:199],v[44:47]
v_fmac_f32 v228,s43,v230
v_fmac_f32 v233,4.0,v229
M v[48:51],a[236:239],a[200:203],v[48:51]
v_fma_f32 v234,-4.0,v230,v232
v_fmac_f32 v228,s45,v232
M v[52:55],a[236:239],a[204:207],v[52:55]
v_fmac_f32 v233,s40,v231
v_sub_f32 v232,v232,v230
M v[56:59],a[236:239],a[208:211],v[56:59]
v_fma_f32 v230,-4.0,v229,v231
v_sub_f32 v231,v231,v229
M v[60:63],a[236:239],a[212:215],v[60:63]
s_waitcnt vmcnt(15)
buffer_load_dwordx4 a[236:239],v253,s[20:23],s46 offen offset:0
M v[64:67],a[240:243],a[216:219],v[64:67]
ds_read_b128 a[216:219],v251 offset:26112
v_add_f32 v229,v234,v230
M v[68:71],a[240:243],a[220:223],v[68:71]
s_add_u32 s47,s44,178176
ds_read_b128 a[220:223],v252 offset:26368
v_sub_f32 v234,v234,v230
M v[72:75],a[240:243],a[192:195],v[72:75]
ds_read_b128 a[192:195],v252 offset:26624
v_fma_f32 v230,2.0,v231,v232
M v[76:79],a[240:243],a[196:199],v[76:79]
ds_read_b128 a[196:199],v252 offset:26880
v_fmac_f32 v232,-2.0,v231
M v[80:83],a[240:243],a[200:203],v[80:83]
ds_read_b128 a[200:203],v252 offset:27136
v_and_b32 v237,s42,v208
M v[84:87],a[240:243],a[204:207],v[84:87]
ds_read_b128 a[204:207],v252 offset:27392
v_and_b32 v235,s42,v204
M v[88:91],a[240:243],a[208:211],v[88:91]
ds_read_b128 a[208:211],v252 offset:27648
v_and_b32 v236,s42,v206
M v[92:95],a[240:243],a[212:215],v[92:95]
s_waitcnt vmcnt(15) lgkmcnt(6)
buffer_load_dwordx4 a[240:243],v253,s[20:23],s47 offen offset:0
M v[96:99],a[244:247],a[216:219],v[96:99]
s_waitcnt lgkmcnt(5)
ds_read_b128 a[212:215],v252 offset:27904
v_and_b32 v240,s42,v214
M v[100:103],a[244:247],a[220:223],v[100:103]
s_waitcnt lgkmcnt(5)
s_add_u32 s48,s44,181248
v_and_b32 v239,s42,v212
v_and_b32 v238,s42,v210
M v[104:107],a[244:247],a[192:195],v[104:107]
s_waitcnt lgkmcnt(4)
v_fmac_f32 v235,s43,v237
v_fmac_f32 v240,4.0,v236
M v[108:111],a[244:247],a[196:199],v[108:111]
s_waitcnt lgkmcnt(3)
v_fma_f32 v231,-4.0,v237,v239
v_fmac_f32 v235,s45,v239
M v[112:115],a[244:247],a[200:203],v[112:115]
s_waitcnt lgkmcnt(2)
v_fmac_f32 v240,s40,v238
v_sub_f32 v239,v239,v237
M v[116:119],a[244:247],a[204:207],v[116:119]
s_waitcnt lgkmcnt(1)
v_fma_f32 v237,-4.0,v236,v238
v_sub_f32 v238,v238,v236
M v[120:123],a[244:247],a[208:211],v[120:123]
s_waitcnt lgkmcnt(0)
v_add_f32 v236,v231,v237
v_sub_f32 v231,v231,v237
M v[124:127],a[244:247],a[212:215],v[124:127]
s_waitcnt vmcnt(15)
buffer_load_dwordx4 a[244:247],v253,s[20:23],s48 offen offset:0
M v[128:131],a[248:251],a[216:219],v[128:131]
v_fma_f32 v237,2.0,v238,v239
v_fmac_f32 v239,-2.0,v238
M v[132:135],a[248:251],a[220:223],v[132:135]
v_cvt_pk_bf16_f32 v204,v228,v235
v_cvt_pk_bf16_f32 v214,v233,v240
M v[136:139],a[248:251],a[192:195],v[136:139]
v_cvt_pk_bf16_f32 v206,v229,v236
v_cvt_pk_bf16_f32 v208,v234,v231
M v[140:143],a[248:251],a[196:199],v[140:143]
v_cvt_pk_bf16_f32 v210,v230,v237
v_cvt_pk_bf16_f32 v212,v232,v239
M v[144:147],a[248:251],a[200:203],v[144:147]
v_lshlrev_b32 v230,16,v209
v_lshlrev_b32 v228,16,v205
M v[148:151],a[248:251],a[204:207],v[148:151]
v_lshlrev_b32 v229,16,v207
v_lshlrev_b32 v233,16,v215
M v[152:155],a[248:251],a[208:211],v[152:155]
v_lshlrev_b32 v232,16,v213
v_lshlrev_b32 v231,16,v211
M v[156:159],a[248:251],a[212:215],v[156:159]
s_waitcnt vmcnt(15)
buffer_load_dwordx4 a[248:251],v253,s[20:23],s46 offen offset:1024
M v[160:163],a[252:255],a[216:219],v[160:163]
ds_read_b128 a[216:219],v252 offset:28160
v_fmac_f32 v228,s43,v230
M v[164:167],a[252:255],a[220:223],v[164:167]
v_fmac_f32 v233,4.0,v229
v_fma_f32 v234,-4.0,v230,v232
M v[168:171],a[252:255],a[192:195],v[168:171]
v_fmac_f32 v228,s45,v232
v_fmac_f32 v233,s40,v231
M v[172:175],a[252:255],a[196:199],v[172:175]
v_sub_f32 v232,v232,v230
v_fma_f32 v230,-4.0,v229,v231
M v[176:179],a[252:255],a[200:203],v[176:179]
v_sub_f32 v231,v231,v229
v_add_f32 v229,v234,v230
M v[180:183],a[252:255],a[204:207],v[180:183]
v_sub_f32 v234,v234,v230
v_fma_f32 v230,2.0,v231,v232
M v[184:187],a[252:255],a[208:211],v[184:187]
v_fmac_f32 v232,-2.0,v231
v_and_b32 v237,s42,v209
M v[188:191],a[252:255],a[212:215],v[188:191]
s_waitcnt vmcnt(15)
buffer_load_dwordx4 a[252:255],v253,s[20:23],s47 offen offset:1024
M v[96:99],v[216:219],a[220:223],v[96:99]
v_and_b32 v235,s42,v205
v_and_b32 v236,s42,v207
M v[100:103],v[216:219],a[192:195],v[100:103]
v_and_b32 v240,s42,v215
v_and_b32 v239,s42,v213
M v[104:107],v[216:219],a[196:199],v[104:107]
v_and_b32 v238,s42,v211
v_fmac_f32 v235,s43,v237
M v[108:111],v[216:219],a[200:203],v[108:111]
v_fmac_f32 v240,4.0,v236
v_fma_f32 v231,-4.0,v237,v239
M v[112:115],v[216:219],a[204:207],v[112:115]
v_fmac_f32 v235,s45,v239
v_fmac_f32 v240,s40,v238
M v[116:119],v[216:219],a[208:211],v[116:119]
v_sub_f32 v239,v239,v237
v_fma_f32 v237,-4.0,v236,v238
M v[120:123],v[216:219],a[212:215],v[120:123]
s_waitcnt lgkmcnt(0)
v_sub_f32 v238,v238,v236
v_add_f32 v236,v231,v237
M v[124:127],v[216:219],a[216:219],v[124:127]
s_waitcnt vmcnt(15)
buffer_load_dwordx4 v[216:219],v253,s[20:23],s48 offen offset:1024
M v[128:131],v[220:223],a[220:223],v[128:131]
v_sub_f32 v231,v231,v237
v_fma_f32 v237,2.0,v238,v239
M v[132:135],v[220:223],a[192:195],v[132:135]
v_fmac_f32 v239,-2.0,v238
v_cvt_pk_bf16_f32 v205,v228,v235
M v[136:139],v[220:223],a[196:199],v[136:139]
v_cvt_pk_bf16_f32 v215,v233,v240
v_cvt_pk_bf16_f32 v207,v229,v236
M v[140:143],v[220:223],a[200:203],v[140:143]
v_cvt_pk_bf16_f32 v209,v234,v231
v_cvt_pk_bf16_f32 v211,v230,v237
M v[144:147],v[220:223],a[204:207],v[144:147]
v_cvt_pk_bf16_f32 v213,v232,v239
v_add_u32 v228,121856,v249
M v[148:151],v[220:223],a[208:211],v[148:151]
ds_write2st64_b64 v228,v[204:205],v[214:215] offset0:3 offset1:20
M v[152:155],v[220:223],a[212:215],v[152:155]
s_add_u32 s28,s30,6684928
buffer_load_dwordx2 v[204:205],v247,s[12:15],s28 offen offset:0
M v[156:159],v[220:223],a[216:219],v[156:159]
s_waitcnt vmcnt(16)
buffer_load_dwordx2 v[214:215],v247,s[16:19],s28 offen offset:1536
M v[160:163],v[224:227],a[220:223],v[160:163]
buffer_load_dwordx4 v[220:223],v253,s[20:23],s46 offen offset:2048
M v[164:167],v[224:227],a[192:195],v[164:167]
ds_read_b128 a[220:223],v251 offset:28416
ds_write2st64_b64 v249,v[206:207],v[208:209] offset0:3 offset1:20
M v[168:171],v[224:227],a[196:199],v[168:171]
buffer_load_dwordx2 v[206:207],v247,s[8:11],s28 offen offset:0
M v[172:175],v[224:227],a[200:203],v[172:175]
buffer_load_dwordx2 v[208:209],v247,s[8:11],s28 offen offset:384
M v[176:179],v[224:227],a[204:207],v[176:179]
ds_write2st64_b64 v249,v[210:211],v[212:213] offset0:139 offset1:156
M v[180:183],v[224:227],a[208:211],v[180:183]
buffer_load_dwordx2 v[210:211],v247,s[8:11],s28 offen offset:768
M v[184:187],v[224:227],a[212:215],v[184:187]
buffer_load_dwordx2 v[212:213],v247,s[8:11],s28 offen offset:1152
M v[188:191],v[224:227],a[216:219],v[188:191]
s_waitcnt vmcnt(21)
buffer_load_dwordx4 v[224:227],v253,s[20:23],s47 offen offset:2048
M v[96:99],a[224:227],a[192:195],v[96:99]
s_waitcnt vmcnt(17)
v_lshlrev_b32 v230,16,v196
v_lshlrev_b32 v228,16,v192
M v[100:103],a[224:227],a[196:199],v[100:103]
v_lshlrev_b32 v229,16,v194
v_lshlrev_b32 v233,16,v202
M v[104:107],a[224:227],a[200:203],v[104:107]
s_waitcnt vmcnt(15)
v_lshlrev_b32 v232,16,v200
v_lshlrev_b32 v231,16,v198
M v[108:111],a[224:227],a[204:207],v[108:111]
v_fmac_f32 v228,s43,v230
v_fmac_f32 v233,4.0,v229
M v[112:115],a[224:227],a[208:211],v[112:115]
v_fma_f32 v234,-4.0,v230,v232
v_fmac_f32 v228,s45,v232
M v[116:119],a[224:227],a[212:215],v[116:119]
v_fmac_f32 v233,s40,v231
v_sub_f32 v232,v232,v230
M v[120:123],a[224:227],a[216:219],v[120:123]
s_waitcnt lgkmcnt(2)
v_fma_f32 v230,-4.0,v229,v231
v_sub_f32 v231,v231,v229
M v[124:127],a[224:227],a[220:223],v[124:127]
buffer_load_dwordx4 a[224:227],v253,s[20:23],s48 offen offset:2048
M v[128:131],a[228:231],a[192:195],v[128:131]
v_add_f32 v229,v234,v230
v_sub_f32 v234,v234,v230
M v[132:135],a[228:231],a[196:199],v[132:135]
s_add_u32 s46,s44,184320
v_fma_f32 v230,2.0,v231,v232
v_fmac_f32 v232,-2.0,v231
M v[136:139],a[228:231],a[200:203],v[136:139]
v_and_b32 v237,s42,v196
v_and_b32 v235,s42,v192
M v[140:143],a[228:231],a[204:207],v[140:143]
v_and_b32 v236,s42,v194
v_and_b32 v240,s42,v202
M v[144:147],a[228:231],a[208:211],v[144:147]
v_and_b32 v239,s42,v200
v_and_b32 v238,s42,v198
M v[148:151],a[228:231],a[212:215],v[148:151]
v_add_u32 v251,0xffffbc00,v251
v_add_u32 v252,0xffffbc00,v252
M v[152:155],a[228:231],a[216:219],v[152:155]
s_waitcnt lgkmcnt(0)
s_barrier
v_fmac_f32 v235,s43,v237
M v[156:159],a[228:231],a[220:223],v[156:159]
s_waitcnt vmcnt(15)
buffer_load_dwordx4 a[228:231],v253,s[20:23],s46 offen offset:0
M v[160:163],a[232:235],a[192:195],v[160:163]
ds_read_b128 a[192:195],v251 offset:0
v_fmac_f32 v240,4.0,v236
M v[164:167],a[232:235],a[196:199],v[164:167]
s_add_u32 s47,s44,187392
ds_read_b128 a[196:199],v252 offset:256
v_fma_f32 v231,-4.0,v237,v239
M v[168:171],a[232:235],a[200:203],v[168:171]
ds_read_b128 a[200:203],v252 offset:512
v_fmac_f32 v235,s45,v239
M v[172:175],a[232:235],a[204:207],v[172:175]
ds_read_b128 a[204:207],v252 offset:768
v_fmac_f32 v240,s40,v238
M v[176:179],a[232:235],a[208:211],v[176:179]
ds_read_b128 a[208:211],v252 offset:1024
v_sub_f32 v239,v239,v237
M v[180:183],a[232:235],a[212:215],v[180:183]
ds_read_b128 a[212:215],v252 offset:1280
v_fma_f32 v237,-4.0,v236,v238
M v[184:187],a[232:235],a[216:219],v[184:187]
ds_read_b128 a[216:219],v252 offset:1536
v_sub_f32 v238,v238,v236
M v[188:191],a[232:235],a[220:223],v[188:191]
s_waitcnt vmcnt(15) lgkmcnt(6)
buffer_load_dwordx4 a[232:235],v253,s[20:23],s47 offen offset:0
M a[0:3],a[236:239],a[192:195],a[0:3]
s_waitcnt lgkmcnt(5)
ds_read_b128 a[220:223],v252 offset:1792
v_add_f32 v236,v231,v237
M a[4:7],a[236:239],a[196:199],a[4:7]
s_waitcnt lgkmcnt(5)
s_add_u32 s48,s44,190464
v_sub_f32 v231,v231,v237
v_fma_f32 v237,2.0,v238,v239
M a[8:11],a[236:239],a[200:203],a[8:11]
s_waitcnt lgkmcnt(4)
v_fmac_f32 v239,-2.0,v238
v_cvt_pk_bf16_f32 v192,v228,v235
M a[12:15],a[236:239],a[204:207],a[12:15]
s_waitcnt lgkmcnt(3)
v_cvt_pk_bf16_f32 v202,v233,v240
v_cvt_pk_bf16_f32 v194,v229,v236
M a[16:19],a[236:239],a[208:211],a[16:19]
s_waitcnt lgkmcnt(2)
v_cvt_pk_bf16_f32 v196,v234,v231
v_cvt_pk_bf16_f32 v198,v230,v237
M a[20:23],a[236:239],a[212:215],a[20:23]
s_waitcnt lgkmcnt(1)
v_cvt_pk_bf16_f32 v200,v232,v239
v_lshlrev_b32 v230,16,v197
M a[24:27],a[236:239],a[216:219],a[24:27]
s_waitcnt lgkmcnt(0)
v_lshlrev_b32 v228,16,v193
v_lshlrev_b32 v229,16,v195
M a[28:31],a[236:239],a[220:223],a[28:31]
s_waitcnt vmcnt(15)
buffer_load_dwordx4 a[236:239],v253,s[20:23],s48 offen offset:0
M a[32:35],a[240:243],a[192:195],a[32:35]
v_lshlrev_b32 v233,16,v203
v_lshlrev_b32 v232,16,v201
M a[36:39],a[240:243],a[196:199],a[36:39]
v_lshlrev_b32 v231,16,v199
v_fmac_f32 v228,s43,v230
M a[40:43],a[240:243],a[200:203],a[40:43]
v_fmac_f32 v233,4.0,v229
v_fma_f32 v234,-4.0,v230,v232
M a[44:47],a[240:243],a[204:207],a[44:47]
v_fmac_f32 v228,s45,v232
v_fmac_f32 v233,s40,v231
M a[48:51],a[240:243],a[208:211],a[48:51]
v_sub_f32 v232,v232,v230
v_fma_f32 v230,-4.0,v229,v231
M a[52:55],a[240:243],a[212:215],a[52:55]
v_sub_f32 v231,v231,v229
v_add_f32 v229,v234,v230
M a[56:59],a[240:243],a[216:219],a[56:59]
v_sub_f32 v234,v234,v230
v_fma_f32 v230,2.0,v231,v232
M a[60:63],a[240:243],a[220:223],a[60:63]
s_waitcnt vmcnt(15)
buffer_load_dwordx4 a[240:243],v253,s[20:23],s46 offen offset:1024
M a[64:67],a[244:247],a[192:195],a[64:67]
ds_read_b128 a[192:195],v252 offset:2048
v_fmac_f32 v232,-2.0,v231
M a[68:71],a[244:247],a[196:199],a[68:71]
v_and_b32 v237,s42,v197
v_and_b32 v235,s42,v193
M a[72:75],a[244:247],a[200:203],a[72:75]
v_and_b32 v236,s42,v195
v_and_b32 v240,s42,v203
M a[76:79],a[244:247],a[204:207],a[76:79]
v_and_b32 v239,s42,v201
v_and_b32 v238,s42,v199
M a[80:83],a[244:247],a[208:211],a[80:83]
v_fmac_f32 v235,s43,v237
v_fmac_f32 v240,4.0,v236
M a[84:87],a[244:247],a[212:215],a[84:87]
v_fma_f32 v231,-4.0,v237,v239
v_fmac_f32 v235,s45,v239
M a[88:91],a[244:247],a[216:219],a[88:91]
v_fmac_f32 v240,s40,v238
v_sub_f32 v239,v239,v237
M a[92:95],a[244:247],a[220:223],a[92:95]
s_waitcnt vmcnt(15)
buffer_load_dwordx4 a[244:247],v253,s[20:23],s47 offen offset:1024
M a[0:3],a[248:251],a[196:199],a[0:3]
v_fma_f32 v237,-4.0,v236,v238
v_sub_f32 v238,v238,v236
M a[4:7],a[248:251],a[200:203],a[4:7]
v_add_f32 v236,v231,v237
v_sub_f32 v231,v231,v237
M a[8:11],a[248:251],a[204:207],a[8:11]
v_fma_f32 v237,2.0,v238,v239
v_fmac_f32 v239,-2.0,v238
M a[12:15],a[248:251],a[208:211],a[12:15]
v_cvt_pk_bf16_f32 v193,v228,v235
v_cvt_pk_bf16_f32 v203,v233,v240
M a[16:19],a[248:251],a[212:215],a[16:19]
v_cvt_pk_bf16_f32 v195,v229,v236
v_cvt_pk_bf16_f32 v197,v234,v231
M a[20:23],a[248:251],a[216:219],a[20:23]
v_cvt_pk_bf16_f32 v199,v230,v237
v_cvt_pk_bf16_f32 v201,v232,v239
M a[24:27],a[248:251],a[220:223],a[24:27]
s_waitcnt lgkmcnt(0)
v_add_u32 v228,139264,v249
M a[28:31],a[248:251],a[192:195],a[28:31]
s_waitcnt vmcnt(15)
buffer_load_dwordx4 a[248:251],v253,s[20:23],s48 offen offset:1024
M a[32:35],a[252:255],a[196:199],a[32:35]
ds_write2st64_b64 v228,v[192:193],v[202:203] offset0:0 offset1:17
M a[36:39],a[252:255],a[200:203],a[36:39]
s_add_u32 s28,s30,7078144
buffer_load_dwordx2 v[192:193],v247,s[12:15],s28 offen offset:0
M a[40:43],a[252:255],a[204:207],a[40:43]
buffer_load_dwordx2 v[202:203],v247,s[16:19],s28 offen offset:1536
M a[44:47],a[252:255],a[208:211],a[44:47]
ds_write2st64_b64 v249,v[194:195],v[196:197] offset0:34 offset1:51
M a[48:51],a[252:255],a[212:215],a[48:51]
buffer_load_dwordx2 v[194:195],v247,s[8:11],s28 offen offset:0
M a[52:55],a[252:255],a[216:219],a[52:55]
buffer_load_dwordx2 v[196:197],v247,s[8:11],s28 offen offset:384
M a[56:59],a[252:255],a[220:223],a[56:59]
ds_write2st64_b64 v249,v[198:199],v[200:201] offset0:68 offset1:85
M a[60:63],a[252:255],a[192:195],a[60:63]
s_waitcnt vmcnt(19)
buffer_load_dwordx2 v[198:199],v247,s[8:11],s28 offen offset:768
M a[64:67],v[216:219],a[196:199],a[64:67]
buffer_load_dwordx2 v[200:201],v247,s[8:11],s28 offen offset:1152
M a[68:71],v[216:219],a[200:203],a[68:71]
buffer_load_dwordx4 a[252:255],v253,s[20:23],s46 offen offset:2048
M a[72:75],v[216:219],a[204:207],a[72:75]
s_waitcnt vmcnt(17)
ds_read_b128 a[196:199],v251 offset:2304
v_lshlrev_b32 v230,16,v208
M a[76:79],v[216:219],a[208:211],a[76:79]
v_lshlrev_b32 v228,16,v204
v_lshlrev_b32 v229,16,v206
M a[80:83],v[216:219],a[212:215],a[80:83]
s_waitcnt vmcnt(15)
v_lshlrev_b32 v233,16,v214
v_lshlrev_b32 v232,16,v212
M a[84:87],v[216:219],a[216:219],a[84:87]
v_lshlrev_b32 v231,16,v210
v_fmac_f32 v228,s43,v230
M a[88:91],v[216:219],a[220:223],a[88:91]
v_fmac_f32 v233,4.0,v229
v_fma_f32 v234,-4.0,v230,v232
M a[92:95],v[216:219],a[192:195],a[92:95]
buffer_load_dwordx4 v[216:219],v253,s[20:23],s47 offen offset:2048
M a[0:3],v[220:223],a[200:203],a[0:3]
v_fmac_f32 v228,s45,v232
v_fmac_f32 v233,s40,v231
M a[4:7],v[220:223],a[204:207],a[4:7]
v_sub_f32 v232,v232,v230
v_fma_f32 v230,-4.0,v229,v231
M a[8:11],v[220:223],a[208:211],a[8:11]
v_sub_f32 v231,v231,v229
v_add_f32 v229,v234,v230
M a[12:15],v[220:223],a[212:215],a[12:15]
v_sub_f32 v234,v234,v230
v_fma_f32 v230,2.0,v231,v232
M a[16:19],v[220:223],a[216:219],a[16:19]
v_fmac_f32 v232,-2.0,v231
v_and_b32 v237,s42,v208
M a[20:23],v[220:223],a[220:223],a[20:23]
v_and_b32 v235,s42,v204
v_and_b32 v236,s42,v206
M a[24:27],v[220:223],a[192:195],a[24:27]
s_waitcnt lgkmcnt(0)
v_and_b32 v240,s42,v214
v_and_b32 v239,s42,v212
M a[28:31],v[220:223],a[196:199],a[28:31]
s_waitcnt vmcnt(15)
buffer_load_dwordx4 v[220:223],v253,s[20:23],s48 offen offset:2048
M a[32:35],v[224:227],a[200:203],a[32:35]
v_and_b32 v238,s42,v210
v_fmac_f32 v235,s43,v237
M a[36:39],v[224:227],a[204:207],a[36:39]
s_add_u32 s46,s44,193536
v_fmac_f32 v240,4.0,v236
v_fma_f32 v231,-4.0,v237,v239
M a[40:43],v[224:227],a[208:211],a[40:43]
v_fmac_f32 v235,s45,v239
v_fmac_f32 v240,s40,v238
M a[44:47],v[224:227],a[212:215],a[44:47]
v_sub_f32 v239,v239,v237
v_fma_f32 v237,-4.0,v236,v238
M a[48:51],v[224:227],a[216:219],a[48:51]
v_sub_f32 v238,v238,v236
v_add_f32 v236,v231,v237
M a[52:55],v[224:227],a[220:223],a[52:55]
v_sub_f32 v231,v231,v237
v_fma_f32 v237,2.0,v238,v239
M a[56:59],v[224:227],a[192:195],a[56:59]
v_fmac_f32 v239,-2.0,v238
v_cvt_pk_bf16_f32 v204,v228,v235
M a[60:63],v[224:227],a[196:199],a[60:63]
s_waitcnt vmcnt(15)
buffer_load_dwordx4 v[224:227],v253,s[20:23],s46 offen offset:0
M a[64:67],a[224:227],a[200:203],a[64:67]
ds_read_b128 a[200:203],v251 offset:8704
v_cvt_pk_bf16_f32 v214,v233,v240
M a[68:71],a[224:227],a[204:207],a[68:71]
s_add_u32 s47,s44,196608
ds_read_b128 a[204:207],v252 offset:8960
v_cvt_pk_bf16_f32 v206,v229,v236
M a[72:75],a[224:227],a[208:211],a[72:75]
ds_read_b128 a[208:211],v252 offset:9216
v_cvt_pk_bf16_f32 v208,v234,v231
M a[76:79],a[224:227],a[212:215],a[76:79]
ds_read_b128 a[212:215],v252 offset:9472
v_cvt_pk_bf16_f32 v210,v230,v237
M a[80:83],a[224:227],a[216:219],a[80:83]
ds_read_b128 a[216:219],v252 offset:9728
v_cvt_pk_bf16_f32 v212,v232,v239
M a[84:87],a[224:227],a[220:223],a[84:87]
ds_read_b128 a[220:223],v252 offset:9984
v_lshlrev_b32 v230,16,v209
M a[88:91],a[224:227],a[192:195],a[88:91]
ds_read_b128 a[192:195],v252 offset:10240
v_lshlrev_b32 v228,16,v205
M a[92:95],a[224:227],a[196:199],a[92:95]
s_waitcnt vmcnt(15) lgkmcnt(6)
buffer_load_dwordx4 a[224:227],v253,s[20:23],s47 offen offset:0
M a[96:99],a[228:231],a[200:203],a[96:99]
s_waitcnt lgkmcnt(5)
ds_read_b128 a[196:199],v252 offset:10496
v_lshlrev_b32 v229,16,v207
M a[100:103],a[228:231],a[204:207],a[100:103]
s_waitcnt lgkmcnt(5)
s_add_u32 s48,s44,199680
v_lshlrev_b32 v233,16,v215
v_lshlrev_b32 v232,16,v213
M a[104:107],a[228:231],a[208:211],a[104:107]
s_waitcnt lgkmcnt(4)
v_lshlrev_b32 v231,16,v211
v_fmac_f32 v228,s43,v230
M a[108:111],a[228:231],a[212:215],a[108:111]
s_waitcnt lgkmcnt(3)
v_fmac_f32 v233,4.0,v229
v_fma_f32 v234,-4.0,v230,v232
M a[112:115],a[228:231],a[216:219],a[112:115]
s_waitcnt lgkmcnt(2)
v_fmac_f32 v228,s45,v232
v_fmac_f32 v233,s40,v231
M a[116:119],a[228:231],a[220:223],a[116:119]
s_waitcnt lgkmcnt(1)
v_sub_f32 v232,v232,v230
v_fma_f32 v230,-4.0,v229,v231
M a[120:123],a[228:231],a[192:195],a[120:123]
s_waitcnt lgkmcnt(0)
v_sub_f32 v231,v231,v229
v_add_f32 v229,v234,v230
M a[124:127],a[228:231],a[196:199],a[124:127]
s_waitcnt vmcnt(15)
buffer_load_dwordx4 a[228:231],v253,s[20:23],s48 offen offset:0
M a[128:131],a[232:235],a[200:203],a[128:131]
v_sub_f32 v234,v234,v230
v_fma_f32 v230,2.0,v231,v232
M a[132:135],a[232:235],a[204:207],a[132:135]
v_fmac_f32 v232,-2.0,v231
v_and_b32 v237,s42,v209
M a[136:139],a[232:235],a[208:211],a[136:139]
v_and_b32 v235,s42,v205
v_and_b32 v236,s42,v207
M a[140:143],a[232:235],a[212:215],a[140:143]
v_and_b32 v240,s42,v215
v_and_b32 v239,s42,v213
M a[144:147],a[232:235],a[216:219],a[144:147]
v_and_b32 v238,s42,v211
v_fmac_f32 v235,s43,v237
M a[148:151],a[232:235],a[220:223],a[148:151]
v_fmac_f32 v240,4.0,v236
v_fma_f32 v231,-4.0,v237,v239
M a[152:155],a[232:235],a[192:195],a[152:155]
v_fmac_f32 v235,s45,v239
v_fmac_f32 v240,s40,v238
M a[156:159],a[232:235],a[196:199],a[156:159]
s_waitcnt vmcnt(15)
buffer_load_dwordx4 a[232:235],v253,s[20:23],s46 offen offset:1024
M a[160:163],a[236:239],a[200:203],a[160:163]
ds_read_b128 a[200:203],v252 offset:10752
v_sub_f32 v239,v239,v237
M a[164:167],a[236:239],a[204:207],a[164:167]
v_fma_f32 v237,-4.0,v236,v238
v_sub_f32 v238,v238,v236
M a[168:171],a[236:239],a[208:211],a[168:171]
v_add_f32 v236,v231,v237
v_sub_f32 v231,v231,v237
M a[172:175],a[236:239],a[212:215],a[172:175]
v_fma_f32 v237,2.0,v238,v239
v_fmac_f32 v239,-2.0,v238
M a[176:179],a[236:239],a[216:219],a[176:179]
v_cvt_pk_bf16_f32 v205,v228,v235
v_cvt_pk_bf16_f32 v215,v233,v240
M a[180:183],a[236:239],a[220:223],a[180:183]
v_cvt_pk_bf16_f32 v207,v229,v236
v_cvt_pk_bf16_f32 v209,v234,v231
M a[184:187],a[236:239],a[192:195],a[184:187]
v_cvt_pk_bf16_f32 v211,v230,v237
v_cvt_pk_bf16_f32 v213,v232,v239
M a[188:191],a[236:239],a[196:199],a[188:191]
s_waitcnt vmcnt(15)
buffer_load_dwordx4 a[236:239],v253,s[20:23],s47 offen offset:1024
M a[96:99],a[240:243],a[204:207],a[96:99]
v_add_u32 v228,139264,v249
M a[100:103],a[240:243],a[208:211],a[100:103]
ds_write2st64_b64 v228,v[204:205],v[214:215] offset0:1 offset1:18
M a[104:107],a[240:243],a[212:215],a[104:107]
s_add_u32 s28,s30,7471360
buffer_load_dwordx2 v[204:205],v247,s[12:15],s28 offen offset:0
M a[108:111],a[240:243],a[216:219],a[108:111]
buffer_load_dwordx2 v[214:215],v247,s[16:19],s28 offen offset:1536
M a[112:115],a[240:243],a[220:223],a[112:115]
ds_write2st64_b64 v249,v[206:207],v[208:209] offset0:35 offset1:52
M a[116:119],a[240:243],a[192:195],a[116:119]
buffer_load_dwordx2 v[206:207],v247,s[8:11],s28 offen offset:0
M a[120:123],a[240:243],a[196:199],a[120:123]
s_waitcnt lgkmcnt(2)
buffer_load_dwordx2 v[208:209],v247,s[8:11],s28 offen offset:384
M a[124:127],a[240:243],a[200:203],a[124:127]
s_waitcnt vmcnt(19)
buffer_load_dwordx4 a[240:243],v253,s[20:23],s48 offen offset:1024
M a[128:131],a[244:247],a[204:207],a[128:131]
ds_write2st64_b64 v249,v[210:211],v[212:213] offset0:69 offset1:86
M a[132:135],a[244:247],a[208:211],a[132:135]
buffer_load_dwordx2 v[210:211],v247,s[8:11],s28 offen offset:768
M a[136:139],a[244:247],a[212:215],a[136:139]
buffer_load_dwordx2 v[212:213],v247,s[8:11],s28 offen offset:1152
M a[140:143],a[244:247],a[216:219],a[140:143]
v_fmac_f32 v241,s43,v243
v_fmac_f32 v246,4.0,v242
M a[144:147],a[244:247],a[220:223],a[144:147]
v_fma_f32 v228,-4.0,v243,v245
v_fmac_f32 v241,s45,v245
M a[148:151],a[244:247],a[192:195],a[148:151]
v_fmac_f32 v246,s40,v244
v_sub_f32 v245,v245,v243
M a[152:155],a[244:247],a[196:199],a[152:155]
v_fma_f32 v243,-4.0,v242,v244
v_sub_f32 v244,v244,v242
M a[156:159],a[244:247],a[200:203],a[156:159]
s_waitcnt vmcnt(21)
buffer_load_dwordx4 a[244:247],v253,s[20:23],s46 offen offset:2048
M a[160:163],a[248:251],a[204:207],a[160:163]
ds_read_b128 a[204:207],v251 offset:11008
v_add_f32 v242,v228,v243
M a[164:167],a[248:251],a[208:211],a[164:167]
v_sub_f32 v228,v228,v243
v_fma_f32 v243,2.0,v244,v245
M a[168:171],a[248:251],a[212:215],a[168:171]
v_fmac_f32 v245,-2.0,v244
v_cvt_pk_bf16_f32 v229,v241,v246
M a[172:175],a[248:251],a[216:219],a[172:175]
v_cvt_pk_bf16_f32 v230,v242,v228
v_cvt_pk_bf16_f32 v231,v243,v245
M a[176:179],a[248:251],a[220:223],a[176:179]
s_add_u32 s29,s31,320
buffer_load_short_d16_hi v241,v248,s[12:15],s29 offen offset:0
M a[180:183],a[248:251],a[192:195],a[180:183]
buffer_load_short_d16_hi v242,v248,s[8:11],s29 offen offset:0
M a[184:187],a[248:251],a[196:199],a[184:187]
buffer_load_short_d16_hi v243,v248,s[8:11],s29 offen offset:384
M a[188:191],a[248:251],a[200:203],a[188:191]
s_waitcnt vmcnt(18)
buffer_load_short_d16_hi v244,v248,s[8:11],s29 offen offset:768
M a[96:99],a[252:255],a[208:211],a[96:99]
buffer_load_short_d16_hi v245,v248,s[8:11],s29 offen offset:1152
M a[100:103],a[252:255],a[212:215],a[100:103]
buffer_load_short_d16_hi v246,v248,s[16:19],s29 offen offset:1536
M a[104:107],a[252:255],a[216:219],a[104:107]
buffer_load_dwordx4 a[248:251],v253,s[20:23],s47 offen offset:2048
M a[108:111],a[252:255],a[220:223],a[108:111]
v_add_u32 v228,139264,v250
M a[112:115],a[252:255],a[192:195],a[112:115]
ds_write_b16 v228,v229 offset:0
M a[116:119],a[252:255],a[196:199],a[116:119]
ds_write_b16_d16_hi v228,v229 offset:8704
M a[120:123],a[252:255],a[200:203],a[120:123]
s_waitcnt lgkmcnt(2)
ds_write_b16 v250,v230 offset:17408
M a[124:127],a[252:255],a[204:207],a[124:127]
s_waitcnt vmcnt(21)
buffer_load_dwordx4 a[252:255],v253,s[20:23],s48 offen offset:2048
M a[128:131],v[216:219],a[208:211],a[128:131]
ds_write_b16_d16_hi v250,v230 offset:26112
M a[132:135],v[216:219],a[212:215],a[132:135]
s_add_u32 s46,s44,202752
ds_write_b16 v250,v231 offset:34816
M a[136:139],v[216:219],a[216:219],a[136:139]
ds_write_b16_d16_hi v250,v231 offset:43520
M a[140:143],v[216:219],a[220:223],a[140:143]
v_lshlrev_b32 v230,16,v196
v_lshlrev_b32 v228,16,v192
M a[144:147],v[216:219],a[192:195],a[144:147]
v_lshlrev_b32 v229,16,v194
v_lshlrev_b32 v233,16,v202
M a[148:151],v[216:219],a[196:199],a[148:151]
v_add_u32 v251,0x4400,v251
v_add_u32 v252,0x4400,v252
M a[152:155],v[216:219],a[200:203],a[152:155]
v_lshlrev_b32 v232,16,v200
v_lshlrev_b32 v231,16,v198
M a[156:159],v[216:219],a[204:207],a[156:159]
s_waitcnt vmcnt(21)
buffer_load_dwordx4 v[216:219],v253,s[20:23],s46 offen offset:0
M a[160:163],v[220:223],a[208:211],a[160:163]
s_add_u32 s32,s51,6291456
ds_read_b128 a[208:211],v251 offset:52224
v_fmac_f32 v228,s43,v230
M a[164:167],v[220:223],a[212:215],a[164:167]
s_add_u32 s47,s44,205824
ds_read_b128 a[212:215],v252 offset:52480
v_fmac_f32 v233,4.0,v229
M a[168:171],v[220:223],a[216:219],a[168:171]
ds_read_b128 a[216:219],v252 offset:52736
v_fma_f32 v234,-4.0,v230,v232
M a[172:175],v[220:223],a[220:223],a[172:175]
s_add_u32 s33,s51,6488064
ds_read_b128 a[220:223],v252 offset:52992
v_fmac_f32 v228,s45,v232
M a[176:179],v[220:223],a[192:195],a[176:179]
ds_read_b128 a[192:195],v252 offset:53248
v_fmac_f32 v233,s40,v231
M a[180:183],v[220:223],a[196:199],a[180:183]
ds_read_b128 a[196:199],v252 offset:53504
v_sub_f32 v232,v232,v230
M a[184:187],v[220:223],a[200:203],a[184:187]
s_add_u32 s34,s51,6684672
ds_read_b128 a[200:203],v252 offset:53760
v_fma_f32 v230,-4.0,v229,v231
M a[188:191],v[220:223],a[204:207],a[188:191]
s_waitcnt vmcnt(21) lgkmcnt(6)
buffer_load_dwordx4 v[220:223],v253,s[20:23],s47 offen offset:0
M v[0:3],v[224:227],a[208:211],v[0:3]
s_waitcnt lgkmcnt(5)
ds_read_b128 a[204:207],v252 offset:54016
v_sub_f32 v231,v231,v229
M v[4:7],v[224:227],a[212:215],v[4:7]
s_waitcnt lgkmcnt(5)
s_add_u32 s48,s44,208896
s_add_u32 s35,s51,6881280
v_add_f32 v229,v234,v230
M v[8:11],v[224:227],a[216:219],v[8:11]
s_waitcnt lgkmcnt(4)
v_sub_f32 v234,v234,v230
v_fma_f32 v230,2.0,v231,v232
M v[12:15],v[224:227],a[220:223],v[12:15]
s_waitcnt lgkmcnt(3)
v_fmac_f32 v232,-2.0,v231
v_and_b32 v237,s42,v196
M v[16:19],v[224:227],a[192:195],v[16:19]
s_waitcnt lgkmcnt(2)
s_add_u32 s36,s51,7077888
v_and_b32 v235,s42,v192
v_and_b32 v236,s42,v194
M v[20:23],v[224:227],a[196:199],v[20:23]
s_waitcnt lgkmcnt(1)
v_and_b32 v240,s42,v202
v_and_b32 v239,s42,v200
M v[24:27],v[224:227],a[200:203],v[24:27]
s_waitcnt lgkmcnt(0)
v_and_b32 v238,s42,v198
v_fmac_f32 v235,s43,v237
M v[28:31],v[224:227],a[204:207],v[28:31]
s_waitcnt vmcnt(21)
s_add_u32 s37,s51,7274496
buffer_load_dwordx4 v[224:227],v253,s[20:23],s48 offen offset:0
M v[32:35],a[224:227],a[208:211],v[32:35]
v_fmac_f32 v240,4.0,v236
v_fma_f32 v231,-4.0,v237,v239
M v[36:39],a[224:227],a[212:215],v[36:39]
v_fmac_f32 v235,s45,v239
v_fmac_f32 v240,s40,v238
M v[40:43],a[224:227],a[216:219],v[40:43]
s_add_u32 s38,s51,7471104
v_sub_f32 v239,v239,v237
v_fma_f32 v237,-4.0,v236,v238
M v[44:47],a[224:227],a[220:223],v[44:47]
v_sub_f32 v238,v238,v236
v_add_f32 v236,v231,v237
M v[48:51],a[224:227],a[192:195],v[48:51]
v_sub_f32 v231,v231,v237
v_fma_f32 v237,2.0,v238,v239
M v[52:55],a[224:227],a[196:199],v[52:55]
s_add_u32 s39,s51,7667712
v_fmac_f32 v239,-2.0,v238
v_cvt_pk_bf16_f32 v192,v228,v235
M v[56:59],a[224:227],a[200:203],v[56:59]
v_cvt_pk_bf16_f32 v202,v233,v240
v_cvt_pk_bf16_f32 v194,v229,v236
M v[60:63],a[224:227],a[204:207],v[60:63]
s_waitcnt vmcnt(21)
buffer_load_dwordx4 a[224:227],v253,s[20:23],s46 offen offset:1024
M v[64:67],a[228:231],a[208:211],v[64:67]
ds_read_b128 a[208:211],v252 offset:54272
v_cvt_pk_bf16_f32 v196,v234,v231
M v[68:71],a[228:231],a[212:215],v[68:71]
v_cvt_pk_bf16_f32 v198,v230,v237
v_cvt_pk_bf16_f32 v200,v232,v239
M v[72:75],a[228:231],a[216:219],v[72:75]
v_lshlrev_b32 v230,16,v197
v_lshlrev_b32 v228,16,v193
M v[76:79],a[228:231],a[220:223],v[76:79]
v_lshlrev_b32 v229,16,v195
v_lshlrev_b32 v233,16,v203
M v[80:83],a[228:231],a[192:195],v[80:83]
v_lshlrev_b32 v232,16,v201
v_lshlrev_b32 v231,16,v199
M v[84:87],a[228:231],a[196:199],v[84:87]
v_fmac_f32 v228,s43,v230
v_fmac_f32 v233,4.0,v229
M v[88:91],a[228:231],a[200:203],v[88:91]
v_fma_f32 v234,-4.0,v230,v232
v_fmac_f32 v228,s45,v232
M v[92:95],a[228:231],a[204:207],v[92:95]
s_waitcnt vmcnt(21)
buffer_load_dwordx4 a[228:231],v253,s[20:23],s47 offen offset:1024
M v[0:3],a[232:235],a[212:215],v[0:3]
v_fmac_f32 v233,s40,v231
v_sub_f32 v232,v232,v230
M v[4:7],a[232:235],a[216:219],v[4:7]
v_fma_f32 v230,-4.0,v229,v231
v_sub_f32 v231,v231,v229
M v[8:11],a[232:235],a[220:223],v[8:11]
v_add_f32 v229,v234,v230
v_sub_f32 v234,v234,v230
M v[12:15],a[232:235],a[192:195],v[12:15]
v_fma_f32 v230,2.0,v231,v232
v_fmac_f32 v232,-2.0,v231
M v[16:19],a[232:235],a[196:199],v[16:19]
v_and_b32 v237,s42,v197
v_and_b32 v235,s42,v193
M v[20:23],a[232:235],a[200:203],v[20:23]
v_and_b32 v236,s42,v195
v_and_b32 v240,s42,v203
M v[24:27],a[232:235],a[204:207],v[24:27]
s_waitcnt lgkmcnt(0)
v_and_b32 v239,s42,v201
v_and_b32 v238,s42,v199
M v[28:31],a[232:235],a[208:211],v[28:31]
s_waitcnt vmcnt(21)
buffer_load_dwordx4 a[232:235],v253,s[20:23],s48 offen offset:1024
M v[32:35],a[236:239],a[212:215],v[32:35]
v_fmac_f32 v235,s43,v237
v_fmac_f32 v240,4.0,v236
M v[36:39],a[236:239],a[216:219],v[36:39]
v_fma_f32 v231,-4.0,v237,v239
v_fmac_f32 v235,s45,v239
M v[40:43],a[236:239],a[220:223],v[40:43]
v_fmac_f32 v240,s40,v238
v_sub_f32 v239,v239,v237
M v[44:47],a[236:239],a[192:195],v[44:47]
v_fma_f32 v237,-4.0,v236,v238
v_sub_f32 v238,v238,v236
M v[48:51],a[236:239],a[196:199],v[48:51]
v_add_f32 v236,v231,v237
v_sub_f32 v231,v231,v237
M v[52:55],a[236:239],a[200:203],v[52:55]
v_fma_f32 v237,2.0,v238,v239
v_fmac_f32 v239,-2.0,v238
M v[56:59],a[236:239],a[204:207],v[56:59]
v_cvt_pk_bf16_f32 v193,v228,v235
v_cvt_pk_bf16_f32 v203,v233,v240
M v[60:63],a[236:239],a[208:211],v[60:63]
s_waitcnt vmcnt(17)
buffer_load_dwordx4 a[236:239],v253,s[20:23],s46 offen offset:2048
M v[64:67],a[240:243],a[212:215],v[64:67]
ds_read_b128 a[212:215],v251 offset:54528
v_cvt_pk_bf16_f32 v195,v229,v236
M v[68:71],a[240:243],a[216:219],v[68:71]
v_cvt_pk_bf16_f32 v197,v234,v231
v_cvt_pk_bf16_f32 v199,v230,v237
M v[72:75],a[240:243],a[220:223],v[72:75]
v_cvt_pk_bf16_f32 v201,v232,v239
v_add_u32 v228,139264,v249
M v[76:79],a[240:243],a[192:195],v[76:79]
ds_write2st64_b64 v228,v[192:193],v[202:203] offset0:2 offset1:19
M v[80:83],a[240:243],a[196:199],v[80:83]
s_add_u32 s28,s30,6291776
buffer_load_dwordx2 v[192:193],v247,s[12:15],s28 offen offset:0
M v[84:87],a[240:243],a[200:203],v[84:87]
buffer_load_dwordx2 v[202:203],v247,s[16:19],s28 offen offset:1536
M v[88:91],a[240:243],a[204:207],v[88:91]
ds_write2st64_b64 v249,v[194:195],v[196:197] offset0:36 offset1:53
M v[92:95],a[240:243],a[208:211],v[92:95]
s_waitcnt vmcnt(17)
buffer_load_dwordx2 v[194:195],v247,s[8:11],s28 offen offset:0
M v[0:3],a[244:247],a[216:219],v[0:3]
buffer_load_dwordx2 v[196:197],v247,s[8:11],s28 offen offset:384
M v[4:7],a[244:247],a[220:223],v[4:7]
buffer_load_dwordx4 a[240:243],v253,s[20:23],s47 offen offset:2048
M v[8:11],a[244:247],a[192:195],v[8:11]
ds_write2st64_b64 v249,v[198:199],v[200:201] offset0:70 offset1:87
M v[12:15],a[244:247],a[196:199],v[12:15]
buffer_load_dwordx2 v[198:199],v247,s[8:11],s28 offen offset:768
M v[16:19],a[244:247],a[200:203],v[16:19]
buffer_load_dwordx2 v[200:201],v247,s[8:11],s28 offen offset:1152
M v[20:23],a[244:247],a[204:207],v[20:23]
v_lshlrev_b32 v230,16,v208
v_lshlrev_b32 v228,16,v204
M v[24:27],a[244:247],a[208:211],v[24:27]
s_waitcnt lgkmcnt(3)
v_lshlrev_b32 v229,16,v206
v_lshlrev_b32 v233,16,v214
M v[28:31],a[244:247],a[212:215],v[28:31]
s_waitcnt vmcnt(15)
buffer_load_dwordx4 a[244:247],v253,s[20:23],s48 offen offset:2048
M v[32:35],a[248:251],a[216:219],v[32:35]
v_lshlrev_b32 v232,16,v212
v_lshlrev_b32 v231,16,v210
M v[36:39],a[248:251],a[220:223],v[36:39]
s_add_u32 s46,s44,230400
v_fmac_f32 v228,s43,v230
v_fmac_f32 v233,4.0,v229
M v[40:43],a[248:251],a[192:195],v[40:43]
v_fma_f32 v234,-4.0,v230,v232
v_fmac_f32 v228,s45,v232
M v[44:47],a[248:251],a[196:199],v[44:47]
v_fmac_f32 v233,s40,v231
v_sub_f32 v232,v232,v230
M v[48:51],a[248:251],a[200:203],v[48:51]
v_fma_f32 v230,-4.0,v229,v231
v_sub_f32 v231,v231,v229
M v[52:55],a[248:251],a[204:207],v[52:55]
v_add_f32 v229,v234,v230
v_sub_f32 v234,v234,v230
M v[56:59],a[248:251],a[208:211],v[56:59]
v_fma_f32 v230,2.0,v231,v232
v_fmac_f32 v232,-2.0,v231
M v[60:63],a[248:251],a[212:215],v[60:63]
s_waitcnt vmcnt(15)
buffer_load_dwordx4 a[248:251],v253,s[20:23],s46 offen offset:0
M v[64:67],a[252:255],a[216:219],v[64:67]
ds_read_b128 a[216:219],v251 offset:60928
v_and_b32 v237,s42,v208
M v[68:71],a[252:255],a[220:223],v[68:71]
s_add_u32 s47,s44,233472
ds_read_b128 a[220:223],v252 offset:61184
v_and_b32 v235,s42,v204
M v[72:75],a[252:255],a[192:195],v[72:75]
ds_read_b128 a[192:195],v252 offset:61440
v_and_b32 v236,s42,v206
M v[76:79],a[252:255],a[196:199],v[76:79]
ds_read_b128 a[196:199],v252 offset:61696
v_and_b32 v240,s42,v214
M v[80:83],a[252:255],a[200:203],v[80:83]
ds_read_b128 a[200:203],v252 offset:61952
v_and_b32 v239,s42,v212
M v[84:87],a[252:255],a[204:207],v[84:87]
ds_read_b128 a[204:207],v252 offset:62208
v_and_b32 v238,s42,v210
M v[88:91],a[252:255],a[208:211],v[88:91]
ds_read_b128 a[208:211],v252 offset:62464
v_fmac_f32 v235,s43,v237
M v[92:95],a[252:255],a[212:215],v[92:95]
s_waitcnt vmcnt(15) lgkmcnt(6)
buffer_load_dwordx4 a[252:255],v253,s[20:23],s47 offen offset:0
M v[96:99],v[216:219],a[216:219],v[96:99]
s_waitcnt lgkmcnt(5)
ds_read_b128 a[212:215],v252 offset:62720
v_fmac_f32 v240,4.0,v236
M v[100:103],v[216:219],a[220:223],v[100:103]
s_waitcnt lgkmcnt(5)
s_add_u32 s48,s44,236544
v_fma_f32 v231,-4.0,v237,v239
v_fmac_f32 v235,s45,v239
M v[104:107],v[216:219],a[192:195],v[104:107]
s_waitcnt lgkmcnt(4)
v_fmac_f32 v240,s40,v238
v_sub_f32 v239,v239,v237
M v[108:111],v[216:219],a[196:199],v[108:111]
s_waitcnt lgkmcnt(3)
v_fma_f32 v237,-4.0,v236,v238
v_sub_f32 v238,v238,v236
M v[112:115],v[216:219],a[200:203],v[112:115]
s_waitcnt lgkmcnt(2)
v_add_f32 v236,v231,v237
v_sub_f32 v231,v231,v237
M v[116:119],v[216:219],a[204:207],v[116:119]
s_waitcnt lgkmcnt(1)
v_fma_f32 v237,2.0,v238,v239
v_fmac_f32 v239,-2.0,v238
M v[120:123],v[216:219],a[208:211],v[120:123]
s_waitcnt lgkmcnt(0)
v_cvt_pk_bf16_f32 v204,v228,v235
v_cvt_pk_bf16_f32 v214,v233,v240
M v[124:127],v[216:219],a[212:215],v[124:127]
s_waitcnt vmcnt(15)
buffer_load_dwordx4 v[216:219],v253,s[20:23],s48 offen offset:0
M v[128:131],v[220:223],a[216:219],v[128:131]
v_cvt_pk_bf16_f32 v206,v229,v236
v_cvt_pk_bf16_f32 v208,v234,v231
M v[132:135],v[220:223],a[220:223],v[132:135]
v_cvt_pk_bf16_f32 v210,v230,v237
v_cvt_pk_bf16_f32 v212,v232,v239
M v[136:139],v[220:223],a[192:195],v[136:139]
v_lshlrev_b32 v230,16,v209
v_lshlrev_b32 v228,16,v205
M v[140:143],v[220:223],a[196:199],v[140:143]
v_lshlrev_b32 v229,16,v207
v_lshlrev_b32 v233,16,v215
M v[144:147],v[220:223],a[200:203],v[144:147]
v_lshlrev_b32 v232,16,v213
v_lshlrev_b32 v231,16,v211
M v[148:151],v[220:223],a[204:207],v[148:151]
v_fmac_f32 v228,s43,v230
v_fmac_f32 v233,4.0,v229
M v[152:155],v[220:223],a[208:211],v[152:155]
v_fma_f32 v234,-4.0,v230,v232
v_fmac_f32 v228,s45,v232
M v[156:159],v[220:223],a[212:215],v[156:159]
s_waitcnt vmcnt(15)
buffer_load_dwordx4 v[220:223],v253,s[20:23],s46 offen offset:1024
M v[160:163],v[224:227],a[216:219],v[160:163]
ds_read_b128 a[216:219],v252 offset:62976
v_fmac_f32 v233,s40,v231
M v[164:167],v[224:227],a[220:223],v[164:167]
v_sub_f32 v232,v232,v230
v_fma_f32 v230,-4.0,v229,v231
M v[168:171],v[224:227],a[192:195],v[168:171]
v_sub_f32 v231,v231,v229
v_add_f32 v229,v234,v230
M v[172:175],v[224:227],a[196:199],v[172:175]
v_sub_f32 v234,v234,v230
v_fma_f32 v230,2.0,v231,v232
M v[176:179],v[224:227],a[200:203],v[176:179]
v_fmac_f32 v232,-2.0,v231
v_and_b32 v237,s42,v209
M v[180:183],v[224:227],a[204:207],v[180:183]
v_and_b32 v235,s42,v205
v_and_b32 v236,s42,v207
M v[184:187],v[224:227],a[208:211],v[184:187]
v_and_b32 v240,s42,v215
v_and_b32 v239,s42,v213
M v[188:191],v[224:227],a[212:215],v[188:191]
s_waitcnt vmcnt(15)
buffer_load_dwordx4 v[224:227],v253,s[20:23],s47 offen offset:1024
M v[96:99],a[224:227],a[220:223],v[96:99]
v_and_b32 v238,s42,v211
v_fmac_f32 v235,s43,v237
M v[100:103],a[224:227],a[192:195],v[100:103]
v_fmac_f32 v240,4.0,v236
v_fma_f32 v231,-4.0,v237,v239
M v[104:107],a[224:227],a[196:199],v[104:107]
v_fmac_f32 v235,s45,v239
v_fmac_f32 v240,s40,v238
M v[108:111],a[224:227],a[200:203],v[108:111]
v_sub_f32 v239,v239,v237
v_fma_f32 v237,-4.0,v236,v238
M v[112:115],a[224:227],a[204:207],v[112:115]
v_sub_f32 v238,v238,v236
v_add_f32 v236,v231,v237
M v[116:119],a[224:227],a[208:211],v[116:119]
v_sub_f32 v231,v231,v237
v_fma_f32 v237,2.0,v238,v239
M v[120:123],a[224:227],a[212:215],v[120:123]
s_waitcnt lgkmcnt(0)
v_fmac_f32 v239,-2.0,v238
v_cvt_pk_bf16_f32 v205,v228,v235
M v[124:127],a[224:227],a[216:219],v[124:127]
s_waitcnt vmcnt(15)
buffer_load_dwordx4 a[224:227],v253,s[20:23],s48 offen offset:1024
M v[128:131],a[228:231],a[220:223],v[128:131]
v_cvt_pk_bf16_f32 v215,v233,v240
v_cvt_pk_bf16_f32 v207,v229,v236
M v[132:135],a[228:231],a[192:195],v[132:135]
v_cvt_pk_bf16_f32 v209,v234,v231
v_cvt_pk_bf16_f32 v211,v230,v237
M v[136:139],a[228:231],a[196:199],v[136:139]
v_cvt_pk_bf16_f32 v213,v232,v239
v_add_u32 v228,139264,v249
M v[140:143],a[228:231],a[200:203],v[140:143]
ds_write2st64_b64 v228,v[204:205],v[214:215] offset0:3 offset1:20
M v[144:147],a[228:231],a[204:207],v[144:147]
s_add_u32 s28,s30,6684992
buffer_load_dwordx2 v[204:205],v247,s[12:15],s28 offen offset:0
M v[148:151],a[228:231],a[208:211],v[148:151]
buffer_load_dwordx2 v[214:215],v247,s[16:19],s28 offen offset:1536
M v[152:155],a[228:231],a[212:215],v[152:155]
ds_write2st64_b64 v249,v[206:207],v[208:209] offset0:37 offset1:54
M v[156:159],a[228:231],a[216:219],v[156:159]
s_waitcnt vmcnt(17)
buffer_load_dwordx2 v[206:207],v247,s[8:11],s28 offen offset:0
M v[160:163],a[232:235],a[220:223],v[160:163]
buffer_load_dwordx2 v[208:209],v247,s[8:11],s28 offen offset:384
M v[164:167],a[232:235],a[192:195],v[164:167]
buffer_load_dwordx4 a[228:231],v253,s[20:23],s46 offen offset:2048
M v[168:171],a[232:235],a[196:199],v[168:171]
ds_read_b128 a[220:223],v251 offset:63232
ds_write2st64_b64 v249,v[210:211],v[212:213] offset0:71 offset1:88
M v[172:175],a[232:235],a[200:203],v[172:175]
buffer_load_dwordx2 v[210:211],v247,s[8:11],s28 offen offset:768
M v[176:179],a[232:235],a[204:207],v[176:179]
buffer_load_dwordx2 v[212:213],v247,s[8:11],s28 offen offset:1152
M v[180:183],a[232:235],a[208:211],v[180:183]
s_waitcnt vmcnt(17)
v_lshlrev_b32 v230,16,v196
v_lshlrev_b32 v228,16,v192
M v[184:187],a[232:235],a[212:215],v[184:187]
v_lshlrev_b32 v229,16,v194
v_lshlrev_b32 v233,16,v202
M v[188:191],a[232:235],a[216:219],v[188:191]
buffer_load_dwordx4 a[232:235],v253,s[20:23],s47 offen offset:2048
M v[96:99],a[236:239],a[192:195],v[96:99]
s_waitcnt vmcnt(15)
v_lshlrev_b32 v232,16,v200
v_lshlrev_b32 v231,16,v198
M v[100:103],a[236:239],a[196:199],v[100:103]
v_fmac_f32 v228,s43,v230
v_fmac_f32 v233,4.0,v229
M v[104:107],a[236:239],a[200:203],v[104:107]
v_fma_f32 v234,-4.0,v230,v232
v_fmac_f32 v228,s45,v232
M v[108:111],a[236:239],a[204:207],v[108:111]
v_fmac_f32 v233,s40,v231
v_sub_f32 v232,v232,v230
M v[112:115],a[236:239],a[208:211],v[112:115]
v_fma_f32 v230,-4.0,v229,v231
v_sub_f32 v231,v231,v229
M v[116:119],a[236:239],a[212:215],v[116:119]
v_add_f32 v229,v234,v230
v_sub_f32 v234,v234,v230
M v[120:123],a[236:239],a[216:219],v[120:123]
s_waitcnt lgkmcnt(1)
v_fma_f32 v230,2.0,v231,v232
v_fmac_f32 v232,-2.0,v231
M v[124:127],a[236:239],a[220:223],v[124:127]
buffer_load_dwordx4 a[236:239],v253,s[20:23],s48 offen offset:2048
M v[128:131],a[240:243],a[192:195],v[128:131]
v_and_b32 v237,s42,v196
v_and_b32 v235,s42,v192
M v[132:135],a[240:243],a[196:199],v[132:135]
s_add_u32 s46,s44,239616
v_and_b32 v236,s42,v194
v_and_b32 v240,s42,v202
M v[136:139],a[240:243],a[200:203],v[136:139]
v_and_b32 v239,s42,v200
v_and_b32 v238,s42,v198
M v[140:143],a[240:243],a[204:207],v[140:143]
v_fmac_f32 v235,s43,v237
v_fmac_f32 v240,4.0,v236
M v[144:147],a[240:243],a[208:211],v[144:147]
v_fma_f32 v231,-4.0,v237,v239
v_fmac_f32 v235,s45,v239
M v[148:151],a[240:243],a[212:215],v[148:151]
v_fmac_f32 v240,s40,v238
v_sub_f32 v239,v239,v237
M v[152:155],a[240:243],a[216:219],v[152:155]
s_waitcnt lgkmcnt(0)
s_barrier
v_fma_f32 v237,-4.0,v236,v238
M v[156:159],a[240:243],a[220:223],v[156:159]
s_waitcnt vmcnt(15)
buffer_load_dwordx4 a[240:243],v253,s[20:23],s46 offen offset:0
M v[160:163],a[244:247],a[192:195],v[160:163]
ds_read_b128 a[192:195],v251 offset:0
v_sub_f32 v238,v238,v236
M v[164:167],a[244:247],a[196:199],v[164:167]
s_add_u32 s47,s44,242688
ds_read_b128 a[196:199],v252 offset:256
v_add_f32 v236,v231,v237
M v[168:171],a[244:247],a[200:203],v[168:171]
ds_read_b128 a[200:203],v252 offset:512
v_sub_f32 v231,v231,v237
M v[172:175],a[244:247],a[204:207],v[172:175]
ds_read_b128 a[204:207],v252 offset:768
v_fma_f32 v237,2.0,v238,v239
M v[176:179],a[244:247],a[208:211],v[176:179]
ds_read_b128 a[208:211],v252 offset:1024
v_fmac_f32 v239,-2.0,v238
M v[180:183],a[244:247],a[212:215],v[180:183]
ds_read_b128 a[212:215],v252 offset:1280
v_cvt_pk_bf16_f32 v192,v228,v235
M v[184:187],a[244:247],a[216:219],v[184:187]
ds_read_b128 a[216:219],v252 offset:1536
v_cvt_pk_bf16_f32 v202,v233,v240
M v[188:191],a[244:247],a[220:223],v[188:191]
s_waitcnt vmcnt(15) lgkmcnt(6)
buffer_load_dwordx4 a[244:247],v253,s[20:23],s47 offen offset:0
M a[0:3],a[248:251],a[192:195],a[0:3]
s_waitcnt lgkmcnt(5)
ds_read_b128 a[220:223],v252 offset:1792
v_cvt_pk_bf16_f32 v194,v229,v236
M a[4:7],a[248:251],a[196:199],a[4:7]
s_waitcnt lgkmcnt(5)
s_add_u32 s48,s44,245760
v_cvt_pk_bf16_f32 v196,v234,v231
v_cvt_pk_bf16_f32 v198,v230,v237
M a[8:11],a[248:251],a[200:203],a[8:11]
s_waitcnt lgkmcnt(4)
v_cvt_pk_bf16_f32 v200,v232,v239
v_lshlrev_b32 v230,16,v197
M a[12:15],a[248:251],a[204:207],a[12:15]
s_waitcnt lgkmcnt(3)
v_lshlrev_b32 v228,16,v193
v_lshlrev_b32 v229,16,v195
M a[16:19],a[248:251],a[208:211],a[16:19]
s_waitcnt lgkmcnt(2)
v_lshlrev_b32 v233,16,v203
v_lshlrev_b32 v232,16,v201
M a[20:23],a[248:251],a[212:215],a[20:23]
s_waitcnt lgkmcnt(1)
v_lshlrev_b32 v231,16,v199
v_fmac_f32 v228,s43,v230
M a[24:27],a[248:251],a[216:219],a[24:27]
s_waitcnt lgkmcnt(0)
v_fmac_f32 v233,4.0,v229
v_fma_f32 v234,-4.0,v230,v232
M a[28:31],a[248:251],a[220:223],a[28:31]
s_waitcnt vmcnt(15)
buffer_load_dwordx4 a[248:251],v253,s[20:23],s48 offen offset:0
M a[32:35],a[252:255],a[192:195],a[32:35]
v_fmac_f32 v228,s45,v232
v_fmac_f32 v233,s40,v231
M a[36:39],a[252:255],a[196:199],a[36:39]
v_sub_f32 v232,v232,v230
v_fma_f32 v230,-4.0,v229,v231
M a[40:43],a[252:255],a[200:203],a[40:43]
v_sub_f32 v231,v231,v229
v_add_f32 v229,v234,v230
M a[44:47],a[252:255],a[204:207],a[44:47]
v_sub_f32 v234,v234,v230
v_fma_f32 v230,2.0,v231,v232
M a[48:51],a[252:255],a[208:211],a[48:51]
v_fmac_f32 v232,-2.0,v231
v_and_b32 v237,s42,v197
M a[52:55],a[252:255],a[212:215],a[52:55]
v_and_b32 v235,s42,v193
v_and_b32 v236,s42,v195
M a[56:59],a[252:255],a[216:219],a[56:59]
v_and_b32 v240,s42,v203
v_and_b32 v239,s42,v201
M a[60:63],a[252:255],a[220:223],a[60:63]
s_waitcnt vmcnt(15)
buffer_load_dwordx4 a[252:255],v253,s[20:23],s46 offen offset:1024
M a[64:67],v[216:219],a[192:195],a[64:67]
ds_read_b128 a[192:195],v252 offset:2048
v_and_b32 v238,s42,v199
M a[68:71],v[216:219],a[196:199],a[68:71]
v_fmac_f32 v235,s43,v237
v_fmac_f32 v240,4.0,v236
M a[72:75],v[216:219],a[200:203],a[72:75]
v_fma_f32 v231,-4.0,v237,v239
v_fmac_f32 v235,s45,v239
M a[76:79],v[216:219],a[204:207],a[76:79]
v_fmac_f32 v240,s40,v238
v_sub_f32 v239,v239,v237
M a[80:83],v[216:219],a[208:211],a[80:83]
v_fma_f32 v237,-4.0,v236,v238
v_sub_f32 v238,v238,v236
M a[84:87],v[216:219],a[212:215],a[84:87]
v_add_f32 v236,v231,v237
v_sub_f32 v231,v231,v237
M a[88:91],v[216:219],a[216:219],a[88:91]
v_fma_f32 v237,2.0,v238,v239
v_fmac_f32 v239,-2.0,v238
M a[92:95],v[216:219],a[220:223],a[92:95]
s_waitcnt vmcnt(15)
buffer_load_dwordx4 v[216:219],v253,s[20:23],s47 offen offset:1024
M a[0:3],v[220:223],a[196:199],a[0:3]
v_cvt_pk_bf16_f32 v193,v228,v235
v_cvt_pk_bf16_f32 v203,v233,v240
M a[4:7],v[220:223],a[200:203],a[4:7]
v_cvt_pk_bf16_f32 v195,v229,v236
v_cvt_pk_bf16_f32 v197,v234,v231
M a[8:11],v[220:223],a[204:207],a[8:11]
v_cvt_pk_bf16_f32 v199,v230,v237
v_cvt_pk_bf16_f32 v201,v232,v239
M a[12:15],v[220:223],a[208:211],a[12:15]
ds_write2st64_b64 v249,v[192:193],v[202:203] offset0:136 offset1:153
M a[16:19],v[220:223],a[212:215],a[16:19]
s_add_u32 s28,s30,7078208
buffer_load_dwordx2 v[192:193],v247,s[12:15],s28 offen offset:0
M a[20:23],v[220:223],a[216:219],a[20:23]
buffer_load_dwordx2 v[202:203],v247,s[16:19],s28 offen offset:1536
M a[24:27],v[220:223],a[220:223],a[24:27]
s_waitcnt lgkmcnt(1)
ds_write2st64_b64 v249,v[194:195],v[196:197] offset0:0 offset1:17
M a[28:31],v[220:223],a[192:195],a[28:31]
s_waitcnt vmcnt(17)
buffer_load_dwordx2 v[194:195],v247,s[8:11],s28 offen offset:0
M a[32:35],v[224:227],a[196:199],a[32:35]
buffer_load_dwordx2 v[196:197],v247,s[8:11],s28 offen offset:384
M a[36:39],v[224:227],a[200:203],a[36:39]
buffer_load_dwordx4 v[220:223],v253,s[20:23],s48 offen offset:1024
M a[40:43],v[224:227],a[204:207],a[40:43]
M a[44:47],v[224:227],a[208:211],a[44:47]
M a[48:51],v[224:227],a[212:215],a[48:51]
M a[52:55],v[224:227],a[216:219],a[52:55]
M a[56:59],v[224:227],a[220:223],a[56:59]
M a[60:63],v[224:227],a[192:195],a[60:63]
s_waitcnt vmcnt(19)
buffer_load_dwordx4 v[224:227],v253,s[20:23],s46 offen offset:2048
M a[64:67],a[224:227],a[196:199],a[64:67]
ds_read_b128 a[196:199],v251 offset:2304
M a[68:71],a[224:227],a[200:203],a[68:71]
M a[72:75],a[224:227],a[204:207],a[72:75]
M a[76:79],a[224:227],a[208:211],a[76:79]
M a[80:83],a[224:227],a[212:215],a[80:83]
M a[84:87],a[224:227],a[216:219],a[84:87]
M a[88:91],a[224:227],a[220:223],a[88:91]
M a[92:95],a[224:227],a[192:195],a[92:95]
s_waitcnt vmcnt(15)
buffer_load_dwordx4 a[224:227],v253,s[20:23],s47 offen offset:2048
M a[0:3],a[228:231],a[200:203],a[0:3]
M a[4:7],a[228:231],a[204:207],a[4:7]
M a[8:11],a[228:231],a[208:211],a[8:11]
M a[12:15],a[228:231],a[212:215],a[12:15]
M a[16:19],a[228:231],a[216:219],a[16:19]
M a[20:23],a[228:231],a[220:223],a[20:23]
M a[24:27],a[228:231],a[192:195],a[24:27]
s_waitcnt lgkmcnt(0)
M a[28:31],a[228:231],a[196:199],a[28:31]
s_waitcnt vmcnt(13)
buffer_load_dwordx4 a[228:231],v253,s[20:23],s48 offen offset:2048
M a[32:35],a[232:235],a[200:203],a[32:35]
M a[36:39],a[232:235],a[204:207],a[36:39]
s_add_u32 s46,s44,248832
M a[40:43],a[232:235],a[208:211],a[40:43]
M a[44:47],a[232:235],a[212:215],a[44:47]
M a[48:51],a[232:235],a[216:219],a[48:51]
M a[52:55],a[232:235],a[220:223],a[52:55]
M a[56:59],a[232:235],a[192:195],a[56:59]
M a[60:63],a[232:235],a[196:199],a[60:63]
s_waitcnt vmcnt(13)
buffer_load_dwordx4 a[232:235],v253,s[20:23],s46 offen offset:0
M a[64:67],a[236:239],a[200:203],a[64:67]
ds_read_b128 a[200:203],v251 offset:8704
M a[68:71],a[236:239],a[204:207],a[68:71]
s_add_u32 s47,s44,251904
ds_read_b128 a[204:207],v252 offset:8960
M a[72:75],a[236:239],a[208:211],a[72:75]
ds_read_b128 a[208:211],v252 offset:9216
M a[76:79],a[236:239],a[212:215],a[76:79]
ds_read_b128 a[212:215],v252 offset:9472
M a[80:83],a[236:239],a[216:219],a[80:83]
ds_read_b128 a[216:219],v252 offset:9728
M a[84:87],a[236:239],a[220:223],a[84:87]
ds_read_b128 a[220:223],v252 offset:9984
M a[88:91],a[236:239],a[192:195],a[88:91]
ds_read_b128 a[192:195],v252 offset:10240
M a[92:95],a[236:239],a[196:199],a[92:95]
s_waitcnt vmcnt(13) lgkmcnt(6)
buffer_load_dwordx4 a[236:239],v253,s[20:23],s47 offen offset:0
M a[96:99],a[240:243],a[200:203],a[96:99]
s_waitcnt lgkmcnt(5)
ds_read_b128 a[196:199],v252 offset:10496
M a[100:103],a[240:243],a[204:207],a[100:103]
s_waitcnt lgkmcnt(5)
s_add_u32 s48,s44,254976
M a[104:107],a[240:243],a[208:211],a[104:107]
s_waitcnt lgkmcnt(4)
M a[108:111],a[240:243],a[212:215],a[108:111]
s_waitcnt lgkmcnt(3)
M a[112:115],a[240:243],a[216:219],a[112:115]
s_waitcnt lgkmcnt(2)
M a[116:119],a[240:243],a[220:223],a[116:119]
s_waitcnt lgkmcnt(1)
M a[120:123],a[240:243],a[192:195],a[120:123]
s_waitcnt lgkmcnt(0)
M a[124:127],a[240:243],a[196:199],a[124:127]
s_waitcnt vmcnt(13)
buffer_load_dwordx4 a[240:243],v253,s[20:23],s48 offen offset:0
M a[128:131],a[244:247],a[200:203],a[128:131]
M a[132:135],a[244:247],a[204:207],a[132:135]
M a[136:139],a[244:247],a[208:211],a[136:139]
M a[140:143],a[244:247],a[212:215],a[140:143]
M a[144:147],a[244:247],a[216:219],a[144:147]
M a[148:151],a[244:247],a[220:223],a[148:151]
M a[152:155],a[244:247],a[192:195],a[152:155]
M a[156:159],a[244:247],a[196:199],a[156:159]
s_waitcnt vmcnt(13)
buffer_load_dwordx4 a[244:247],v253,s[20:23],s46 offen offset:1024
M a[160:163],a[248:251],a[200:203],a[160:163]
ds_read_b128 a[200:203],v252 offset:10752
M a[164:167],a[248:251],a[204:207],a[164:167]
M a[168:171],a[248:251],a[208:211],a[168:171]
M a[172:175],a[248:251],a[212:215],a[172:175]
M a[176:179],a[248:251],a[216:219],a[176:179]
M a[180:183],a[248:251],a[220:223],a[180:183]
M a[184:187],a[248:251],a[192:195],a[184:187]
M a[188:191],a[248:251],a[196:199],a[188:191]
s_waitcnt vmcnt(13)
buffer_load_dwordx4 a[248:251],v253,s[20:23],s47 offen offset:1024
M a[96:99],a[252:255],a[204:207],a[96:99]
M a[100:103],a[252:255],a[208:211],a[100:103]
M a[104:107],a[252:255],a[212:215],a[104:107]
M a[108:111],a[252:255],a[216:219],a[108:111]
M a[112:115],a[252:255],a[220:223],a[112:115]
M a[116:119],a[252:255],a[192:195],a[116:119]
M a[120:123],a[252:255],a[196:199],a[120:123]
s_waitcnt lgkmcnt(0)
M a[124:127],a[252:255],a[200:203],a[124:127]
s_waitcnt vmcnt(13)
buffer_load_dwordx4 a[252:255],v253,s[20:23],s48 offen offset:1024
M a[128:131],v[216:219],a[204:207],a[128:131]
M a[132:135],v[216:219],a[208:211],a[132:135]
M a[136:139],v[216:219],a[212:215],a[136:139]
M a[140:143],v[216:219],a[216:219],a[140:143]
M a[144:147],v[216:219],a[220:223],a[144:147]
M a[148:151],v[216:219],a[192:195],a[148:151]
M a[152:155],v[216:219],a[196:199],a[152:155]
M a[156:159],v[216:219],a[200:203],a[156:159]
s_waitcnt vmcnt(9)
buffer_load_dwordx4 v[216:219],v253,s[20:23],s46 offen offset:2048
M a[160:163],v[220:223],a[204:207],a[160:163]
ds_read_b128 a[204:207],v251 offset:11008
M a[164:167],v[220:223],a[208:211],a[164:167]
M a[168:171],v[220:223],a[212:215],a[168:171]
M a[172:175],v[220:223],a[216:219],a[172:175]
M a[176:179],v[220:223],a[220:223],a[176:179]
M a[180:183],v[220:223],a[192:195],a[180:183]
M a[184:187],v[220:223],a[196:199],a[184:187]
M a[188:191],v[220:223],a[200:203],a[188:191]
s_waitcnt vmcnt(9)
buffer_load_dwordx4 v[220:223],v253,s[20:23],s47 offen offset:2048
M a[96:99],v[224:227],a[208:211],a[96:99]
M a[100:103],v[224:227],a[212:215],a[100:103]
M a[104:107],v[224:227],a[216:219],a[104:107]
M a[108:111],v[224:227],a[220:223],a[108:111]
M a[112:115],v[224:227],a[192:195],a[112:115]
M a[116:119],v[224:227],a[196:199],a[116:119]
M a[120:123],v[224:227],a[200:203],a[120:123]
s_waitcnt lgkmcnt(0)
M a[124:127],v[224:227],a[204:207],a[124:127]
s_waitcnt vmcnt(9)
buffer_load_dwordx4 v[224:227],v253,s[20:23],s48 offen offset:2048
M a[128:131],a[224:227],a[208:211],a[128:131]
M a[132:135],a[224:227],a[212:215],a[132:135]
s_barrier
ds_write2st64_b64 v249,v[198:199],v[200:201] offset0:34 offset1:51
M a[136:139],a[224:227],a[216:219],a[136:139]
s_add_u32 s46,s44,258048
buffer_load_dwordx2 v[198:199],v247,s[8:11],s28 offen offset:768
M a[140:143],a[224:227],a[220:223],a[140:143]
buffer_load_dwordx2 v[200:201],v247,s[8:11],s28 offen offset:1152
M a[144:147],a[224:227],a[192:195],a[144:147]
v_lshlrev_b32 v230,16,v208
v_lshlrev_b32 v228,16,v204
M a[148:151],a[224:227],a[196:199],a[148:151]
v_lshlrev_b32 v229,16,v206
v_lshlrev_b32 v233,16,v214
M a[152:155],a[224:227],a[200:203],a[152:155]
v_lshlrev_b32 v232,16,v212
v_lshlrev_b32 v231,16,v210
M a[156:159],a[224:227],a[204:207],a[156:159]
s_waitcnt vmcnt(11)
buffer_load_dwordx4 a[224:227],v253,s[20:23],s46 offen offset:0
M a[160:163],a[228:231],a[208:211],a[160:163]
ds_read_b128 a[208:211],v251 offset:17408
v_fmac_f32 v228,s43,v230
M a[164:167],a[228:231],a[212:215],a[164:167]
s_add_u32 s47,s44,261120
ds_read_b128 a[212:215],v252 offset:17664
v_fmac_f32 v233,4.0,v229
M a[168:171],a[228:231],a[216:219],a[168:171]
ds_read_b128 a[216:219],v252 offset:17920
v_fma_f32 v234,-4.0,v230,v232
M a[172:175],a[228:231],a[220:223],a[172:175]
ds_read_b128 a[220:223],v252 offset:18176
v_fmac_f32 v228,s45,v232
M a[176:179],a[228:231],a[192:195],a[176:179]
ds_read_b128 a[192:195],v252 offset:18432
v_fmac_f32 v233,s40,v231
M a[180:183],a[228:231],a[196:199],a[180:183]
ds_read_b128 a[196:199],v252 offset:18688
v_sub_f32 v232,v232,v230
M a[184:187],a[228:231],a[200:203],a[184:187]
ds_read_b128 a[200:203],v252 offset:18944
v_fma_f32 v230,-4.0,v229,v231
M a[188:191],a[228:231],a[204:207],a[188:191]
s_waitcnt vmcnt(11) lgkmcnt(6)
buffer_load_dwordx4 a[228:231],v253,s[20:23],s47 offen offset:0
M v[0:3],a[232:235],a[208:211],v[0:3]
s_waitcnt lgkmcnt(5)
ds_read_b128 a[204:207],v252 offset:19200
v_sub_f32 v231,v231,v229
M v[4:7],a[232:235],a[212:215],v[4:7]
s_waitcnt lgkmcnt(5)
s_add_u32 s48,s44,264192
v_add_f32 v229,v234,v230
v_sub_f32 v234,v234,v230
M v[8:11],a[232:235],a[216:219],v[8:11]
s_waitcnt lgkmcnt(4)
v_fma_f32 v230,2.0,v231,v232
v_fmac_f32 v232,-2.0,v231
M v[12:15],a[232:235],a[220:223],v[12:15]
s_waitcnt lgkmcnt(3)
v_and_b32 v237,s42,v208
v_and_b32 v235,s42,v204
M v[16:19],a[232:235],a[192:195],v[16:19]
s_waitcnt lgkmcnt(2)
v_and_b32 v236,s42,v206
v_and_b32 v240,s42,v214
M v[20:23],a[232:235],a[196:199],v[20:23]
s_waitcnt lgkmcnt(1)
v_and_b32 v239,s42,v212
v_and_b32 v238,s42,v210
M v[24:27],a[232:235],a[200:203],v[24:27]
s_waitcnt lgkmcnt(0)
v_fmac_f32 v235,s43,v237
v_fmac_f32 v240,4.0,v236
M v[28:31],a[232:235],a[204:207],v[28:31]
s_waitcnt vmcnt(11)
buffer_load_dwordx4 a[232:235],v253,s[20:23],s48 offen offset:0
M v[32:35],a[236:239],a[208:211],v[32:35]
v_fma_f32 v231,-4.0,v237,v239
v_fmac_f32 v235,s45,v239
M v[36:39],a[236:239],a[212:215],v[36:39]
v_fmac_f32 v240,s40,v238
v_sub_f32 v239,v239,v237
M v[40:43],a[236:239],a[216:219],v[40:43]
v_fma_f32 v237,-4.0,v236,v238
v_sub_f32 v238,v238,v236
M v[44:47],a[236:239],a[220:223],v[44:47]
v_add_f32 v236,v231,v237
v_sub_f32 v231,v231,v237
M v[48:51],a[236:239],a[192:195],v[48:51]
v_fma_f32 v237,2.0,v238,v239
v_fmac_f32 v239,-2.0,v238
M v[52:55],a[236:239],a[196:199],v[52:55]
v_cvt_pk_bf16_f32 v204,v228,v235
v_cvt_pk_bf16_f32 v214,v233,v240
M v[56:59],a[236:239],a[200:203],v[56:59]
v_cvt_pk_bf16_f32 v206,v229,v236
v_cvt_pk_bf16_f32 v208,v234,v231
M v[60:63],a[236:239],a[204:207],v[60:63]
s_waitcnt vmcnt(11)
buffer_load_dwordx4 a[236:239],v253,s[20:23],s46 offen offset:1024
M v[64:67],a[240:243],a[208:211],v[64:67]
ds_read_b128 a[208:211],v252 offset:19456
v_cvt_pk_bf16_f32 v210,v230,v237
M v[68:71],a[240:243],a[212:215],v[68:71]
v_cvt_pk_bf16_f32 v212,v232,v239
v_lshlrev_b32 v230,16,v209
M v[72:75],a[240:243],a[216:219],v[72:75]
v_lshlrev_b32 v228,16,v205
v_lshlrev_b32 v229,16,v207
M v[76:79],a[240:243],a[220:223],v[76:79]
v_lshlrev_b32 v233,16,v215
v_lshlrev_b32 v232,16,v213
M v[80:83],a[240:243],a[192:195],v[80:83]
v_lshlrev_b32 v231,16,v211
v_fmac_f32 v228,s43,v230
M v[84:87],a[240:243],a[196:199],v[84:87]
v_fmac_f32 v233,4.0,v229
v_fma_f32 v234,-4.0,v230,v232
M v[88:91],a[240:243],a[200:203],v[88:91]
v_fmac_f32 v228,s45,v232
v_fmac_f32 v233,s40,v231
M v[92:95],a[240:243],a[204:207],v[92:95]
s_waitcnt vmcnt(11)
buffer_load_dwordx4 a[240:243],v253,s[20:23],s47 offen offset:1024
M v[0:3],a[244:247],a[212:215],v[0:3]
v_sub_f32 v232,v232,v230
v_fma_f32 v230,-4.0,v229,v231
M v[4:7],a[244:247],a[216:219],v[4:7]
v_sub_f32 v231,v231,v229
v_add_f32 v229,v234,v230
M v[8:11],a[244:247],a[220:223],v[8:11]
v_sub_f32 v234,v234,v230
v_fma_f32 v230,2.0,v231,v232
M v[12:15],a[244:247],a[192:195],v[12:15]
v_fmac_f32 v232,-2.0,v231
v_and_b32 v237,s42,v209
M v[16:19],a[244:247],a[196:199],v[16:19]
v_and_b32 v235,s42,v205
v_and_b32 v236,s42,v207
M v[20:23],a[244:247],a[200:203],v[20:23]
v_and_b32 v240,s42,v215
v_and_b32 v239,s42,v213
M v[24:27],a[244:247],a[204:207],v[24:27]
s_waitcnt lgkmcnt(0)
v_and_b32 v238,s42,v211
v_fmac_f32 v235,s43,v237
M v[28:31],a[244:247],a[208:211],v[28:31]
s_waitcnt vmcnt(11)
buffer_load_dwordx4 a[244:247],v253,s[20:23],s48 offen offset:1024
M v[32:35],a[248:251],a[212:215],v[32:35]
v_fmac_f32 v240,4.0,v236
v_fma_f32 v231,-4.0,v237,v239
M v[36:39],a[248:251],a[216:219],v[36:39]
v_fmac_f32 v235,s45,v239
v_fmac_f32 v240,s40,v238
M v[40:43],a[248:251],a[220:223],v[40:43]
v_sub_f32 v239,v239,v237
v_fma_f32 v237,-4.0,v236,v238
M v[44:47],a[248:251],a[192:195],v[44:47]
v_sub_f32 v238,v238,v236
v_add_f32 v236,v231,v237
M v[48:51],a[248:251],a[196:199],v[48:51]
v_sub_f32 v231,v231,v237
v_fma_f32 v237,2.0,v238,v239
M v[52:55],a[248:251],a[200:203],v[52:55]
v_fmac_f32 v239,-2.0,v238
v_cvt_pk_bf16_f32 v205,v228,v235
M v[56:59],a[248:251],a[204:207],v[56:59]
v_cvt_pk_bf16_f32 v215,v233,v240
v_cvt_pk_bf16_f32 v207,v229,v236
M v[60:63],a[248:251],a[208:211],v[60:63]
s_waitcnt vmcnt(11)
buffer_load_dwordx4 a[248:251],v253,s[20:23],s46 offen offset:2048
M v[64:67],a[252:255],a[212:215],v[64:67]
ds_read_b128 a[212:215],v251 offset:19712
v_cvt_pk_bf16_f32 v209,v234,v231
M v[68:71],a[252:255],a[216:219],v[68:71]
v_cvt_pk_bf16_f32 v211,v230,v237
v_cvt_pk_bf16_f32 v213,v232,v239
M v[72:75],a[252:255],a[220:223],v[72:75]
ds_write2st64_b64 v249,v[204:205],v[214:215] offset0:137 offset1:154
M v[76:79],a[252:255],a[192:195],v[76:79]
s_add_u32 s28,s30,7471424
buffer_load_dwordx2 v[204:205],v247,s[12:15],s28 offen offset:0
M v[80:83],a[252:255],a[196:199],v[80:83]
buffer_load_dwordx2 v[214:215],v247,s[16:19],s28 offen offset:1536
M v[84:87],a[252:255],a[200:203],v[84:87]
ds_write2st64_b64 v249,v[206:207],v[208:209] offset0:1 offset1:18
M v[88:91],a[252:255],a[204:207],v[88:91]
buffer_load_dwordx2 v[206:207],v247,s[8:11],s28 offen offset:0
M v[92:95],a[252:255],a[208:211],v[92:95]
s_waitcnt vmcnt(14)
buffer_load_dwordx2 v[208:209],v247,s[8:11],s28 offen offset:384
M v[0:3],v[216:219],a[216:219],v[0:3]
buffer_load_dwordx4 a[252:255],v253,s[20:23],s47 offen offset:2048
M v[4:7],v[216:219],a[220:223],v[4:7]
ds_write2st64_b64 v249,v[210:211],v[212:213] offset0:35 offset1:52
M v[8:11],v[216:219],a[192:195],v[8:11]
buffer_load_dwordx2 v[210:211],v247,s[8:11],s28 offen offset:768
M v[12:15],v[216:219],a[196:199],v[12:15]
buffer_load_dwordx2 v[212:213],v247,s[8:11],s28 offen offset:1152
M v[16:19],v[216:219],a[200:203],v[16:19]
v_fmac_f32 v241,s43,v243
v_fmac_f32 v246,4.0,v242
M v[20:23],v[216:219],a[204:207],v[20:23]
v_fma_f32 v228,-4.0,v243,v245
v_fmac_f32 v241,s45,v245
M v[24:27],v[216:219],a[208:211],v[24:27]
s_waitcnt lgkmcnt(3)
v_fmac_f32 v246,s40,v244
v_sub_f32 v245,v245,v243
M v[28:31],v[216:219],a[212:215],v[28:31]
s_waitcnt vmcnt(17)
buffer_load_dwordx4 v[216:219],v253,s[20:23],s48 offen offset:2048
M v[32:35],v[220:223],a[216:219],v[32:35]
v_fma_f32 v243,-4.0,v242,v244
v_sub_f32 v244,v244,v242
M v[36:39],v[220:223],a[220:223],v[36:39]
s_add_u32 s46,s44,285696
v_add_f32 v242,v228,v243
v_sub_f32 v228,v228,v243
M v[40:43],v[220:223],a[192:195],v[40:43]
v_fma_f32 v243,2.0,v244,v245
v_fmac_f32 v245,-2.0,v244
M v[44:47],v[220:223],a[196:199],v[44:47]
v_cvt_pk_bf16_f32 v229,v241,v246
v_cvt_pk_bf16_f32 v230,v242,v228
M v[48:51],v[220:223],a[200:203],v[48:51]
v_cvt_pk_bf16_f32 v231,v243,v245
v_add_u32 v228,69632,v250
M v[52:55],v[220:223],a[204:207],v[52:55]
ds_write_b16 v228,v229 offset:0
M v[56:59],v[220:223],a[208:211],v[56:59]
ds_write_b16_d16_hi v228,v229 offset:8704
M v[60:63],v[220:223],a[212:215],v[60:63]
s_waitcnt vmcnt(17)
buffer_load_dwordx4 v[220:223],v253,s[20:23],s46 offen offset:0
M v[64:67],v[224:227],a[216:219],v[64:67]
ds_read_b128 a[216:219],v251 offset:26112
ds_write_b16 v250,v230 offset:0
M v[68:71],v[224:227],a[220:223],v[68:71]
ds_read_b128 a[220:223],v252 offset:26368
ds_write_b16_d16_hi v250,v230 offset:8704
M v[72:75],v[224:227],a[192:195],v[72:75]
ds_read_b128 a[192:195],v252 offset:26624
ds_write_b16 v250,v231 offset:17408
M v[76:79],v[224:227],a[196:199],v[76:79]
ds_read_b128 a[196:199],v252 offset:26880
ds_write_b16_d16_hi v250,v231 offset:26112
M v[80:83],v[224:227],a[200:203],v[80:83]
ds_read_b128 a[200:203],v252 offset:27136
v_lshlrev_b32 v230,16,v196
M v[84:87],v[224:227],a[204:207],v[84:87]
ds_read_b128 a[204:207],v252 offset:27392
v_lshlrev_b32 v228,16,v192
M v[88:91],v[224:227],a[208:211],v[88:91]
ds_read_b128 a[208:211],v252 offset:27648
v_lshlrev_b32 v229,16,v194
M v[92:95],v[224:227],a[212:215],v[92:95]
s_waitcnt vmcnt(15) lgkmcnt(10)
buffer_load_dwordx4 v[224:227],v253,s[20:23],s46 offen offset:1024
M v[96:99],a[224:227],a[216:219],v[96:99]
s_waitcnt lgkmcnt(8)
ds_read_b128 a[212:215],v252 offset:27904
v_lshlrev_b32 v233,16,v202
M v[100:103],a[224:227],a[220:223],v[100:103]
s_waitcnt lgkmcnt(7)
v_lshlrev_b32 v232,16,v200
v_lshlrev_b32 v231,16,v198
M v[104:107],a[224:227],a[192:195],v[104:107]
s_waitcnt lgkmcnt(5)
v_fmac_f32 v228,s43,v230
v_fmac_f32 v233,4.0,v229
M v[108:111],a[224:227],a[196:199],v[108:111]
s_waitcnt lgkmcnt(3)
v_fma_f32 v234,-4.0,v230,v232
v_fmac_f32 v228,s45,v232
M v[112:115],a[224:227],a[200:203],v[112:115]
s_waitcnt lgkmcnt(2)
v_fmac_f32 v233,s40,v231
v_sub_f32 v232,v232,v230
M v[116:119],a[224:227],a[204:207],v[116:119]
s_waitcnt lgkmcnt(1)
v_fma_f32 v230,-4.0,v229,v231
v_sub_f32 v231,v231,v229
M v[120:123],a[224:227],a[208:211],v[120:123]
s_waitcnt lgkmcnt(0)
v_add_f32 v229,v234,v230
v_sub_f32 v234,v234,v230
M v[124:127],a[224:227],a[212:215],v[124:127]
s_waitcnt vmcnt(15)
buffer_load_dwordx4 a[224:227],v253,s[20:23],s46 offen offset:2048
M v[128:131],a[228:231],a[216:219],v[128:131]
v_fma_f32 v230,2.0,v231,v232
v_fmac_f32 v232,-2.0,v231
M v[132:135],a[228:231],a[220:223],v[132:135]
s_add_u32 s46,s44,294912
v_and_b32 v237,s42,v196
v_and_b32 v235,s42,v192
M v[136:139],a[228:231],a[192:195],v[136:139]
v_and_b32 v236,s42,v194
v_and_b32 v240,s42,v202
M v[140:143],a[228:231],a[196:199],v[140:143]
v_and_b32 v239,s42,v200
v_and_b32 v238,s42,v198
M v[144:147],a[228:231],a[200:203],v[144:147]
v_fmac_f32 v235,s43,v237
v_fmac_f32 v240,4.0,v236
M v[148:151],a[228:231],a[204:207],v[148:151]
v_fma_f32 v231,-4.0,v237,v239
v_fmac_f32 v235,s45,v239
M v[152:155],a[228:231],a[208:211],v[152:155]
v_fmac_f32 v240,s40,v238
v_sub_f32 v239,v239,v237
M v[156:159],a[228:231],a[212:215],v[156:159]
s_waitcnt vmcnt(15)
buffer_load_dwordx4 a[228:231],v253,s[20:23],s46 offen offset:0
v_fma_f32 v237,-4.0,v236,v238
v_sub_f32 v238,v238,v236
M v[160:163],a[232:235],a[216:219],v[160:163]
ds_read_b128 a[216:219],v252 offset:28160
v_add_f32 v236,v231,v237
v_sub_f32 v231,v231,v237
v_fma_f32 v237,2.0,v238,v239
v_fmac_f32 v239,-2.0,v238
M v[164:167],a[232:235],a[220:223],v[164:167]
v_cvt_pk_bf16_f32 v192,v228,v235
v_cvt_pk_bf16_f32 v202,v233,v240
v_cvt_pk_bf16_f32 v194,v229,v236
v_cvt_pk_bf16_f32 v196,v234,v231
M v[168:171],a[232:235],a[192:195],v[168:171]
v_cvt_pk_bf16_f32 v198,v230,v237
v_cvt_pk_bf16_f32 v200,v232,v239
v_lshlrev_b32 v230,16,v197
v_lshlrev_b32 v228,16,v193
M v[172:175],a[232:235],a[196:199],v[172:175]
v_lshlrev_b32 v229,16,v195
v_lshlrev_b32 v233,16,v203
v_lshlrev_b32 v232,16,v201
v_lshlrev_b32 v231,16,v199
M v[176:179],a[232:235],a[200:203],v[176:179]
v_fmac_f32 v228,s43,v230
v_fmac_f32 v233,4.0,v229
v_fma_f32 v234,-4.0,v230,v232
v_fmac_f32 v228,s45,v232
M v[180:183],a[232:235],a[204:207],v[180:183]
v_fmac_f32 v233,s40,v231
v_sub_f32 v232,v232,v230
v_fma_f32 v230,-4.0,v229,v231
v_sub_f32 v231,v231,v229
M v[184:187],a[232:235],a[208:211],v[184:187]
v_add_f32 v229,v234,v230
v_sub_f32 v234,v234,v230
v_fma_f32 v230,2.0,v231,v232
v_fmac_f32 v232,-2.0,v231
M v[188:191],a[232:235],a[212:215],v[188:191]
s_waitcnt vmcnt(15)
buffer_load_dwordx4 a[232:235],v253,s[20:23],s46 offen offset:1024
v_and_b32 v237,s42,v197
v_and_b32 v235,s42,v193
v_and_b32 v236,s42,v195
v_and_b32 v240,s42,v203
M v[96:99],a[236:239],a[220:223],v[96:99]
v_and_b32 v239,s42,v201
v_and_b32 v238,s42,v199
v_fmac_f32 v235,s43,v237
v_fmac_f32 v240,4.0,v236
M v[100:103],a[236:239],a[192:195],v[100:103]
v_fma_f32 v231,-4.0,v237,v239
v_fmac_f32 v235,s45,v239
v_fmac_f32 v240,s40,v238
v_sub_f32 v239,v239,v237
M v[104:107],a[236:239],a[196:199],v[104:107]
v_fma_f32 v237,-4.0,v236,v238
v_sub_f32 v238,v238,v236
v_add_f32 v236,v231,v237
v_sub_f32 v231,v231,v237
M v[108:111],a[236:239],a[200:203],v[108:111]
v_fma_f32 v237,2.0,v238,v239
v_fmac_f32 v239,-2.0,v238
v_cvt_pk_bf16_f32 v193,v228,v235
v_cvt_pk_bf16_f32 v203,v233,v240
M v[112:115],a[236:239],a[204:207],v[112:115]
v_cvt_pk_bf16_f32 v195,v229,v236
v_cvt_pk_bf16_f32 v197,v234,v231
v_cvt_pk_bf16_f32 v199,v230,v237
v_cvt_pk_bf16_f32 v201,v232,v239
M v[116:119],a[236:239],a[208:211],v[116:119]
ds_write2st64_b64 v249,v[192:193],v[202:203] offset0:138 offset1:155
M v[120:123],a[236:239],a[212:215],v[120:123]
s_waitcnt lgkmcnt(1)
ds_write2st64_b64 v249,v[194:195],v[196:197] offset0:2 offset1:19
M v[124:127],a[236:239],a[216:219],v[124:127]
s_waitcnt vmcnt(15)
buffer_load_dwordx4 a[236:239],v253,s[20:23],s46 offen offset:2048
M v[128:131],a[240:243],a[220:223],v[128:131]
ds_write2st64_b64 v249,v[198:199],v[200:201] offset0:36 offset1:53
M v[132:135],a[240:243],a[192:195],v[132:135]
s_waitcnt vmcnt(10)
s_add_u32 s46,s44,304128
v_lshlrev_b32 v230,16,v208
v_lshlrev_b32 v228,16,v204
M v[136:139],a[240:243],a[196:199],v[136:139]
v_lshlrev_b32 v229,16,v206
v_lshlrev_b32 v233,16,v214
M v[140:143],a[240:243],a[200:203],v[140:143]
s_waitcnt vmcnt(7)
v_lshlrev_b32 v232,16,v212
v_lshlrev_b32 v231,16,v210
v_fmac_f32 v228,s43,v230
v_fmac_f32 v233,4.0,v229
M v[144:147],a[240:243],a[204:207],v[144:147]
v_fma_f32 v234,-4.0,v230,v232
v_fmac_f32 v228,s45,v232
v_fmac_f32 v233,s40,v231
v_sub_f32 v232,v232,v230
M v[148:151],a[240:243],a[208:211],v[148:151]
v_fma_f32 v230,-4.0,v229,v231
v_sub_f32 v231,v231,v229
v_add_f32 v229,v234,v230
v_sub_f32 v234,v234,v230
M v[152:155],a[240:243],a[212:215],v[152:155]
v_fma_f32 v230,2.0,v231,v232
v_fmac_f32 v232,-2.0,v231
v_and_b32 v237,s42,v208
v_and_b32 v235,s42,v204
M v[156:159],a[240:243],a[216:219],v[156:159]
buffer_load_dwordx4 a[240:243],v253,s[20:23],s46 offen offset:0
v_and_b32 v236,s42,v206
v_and_b32 v240,s42,v214
v_and_b32 v239,s42,v212
v_and_b32 v238,s42,v210
M v[160:163],a[244:247],a[220:223],v[160:163]
ds_read_b128 a[220:223],v251 offset:28416
v_fmac_f32 v235,s43,v237
v_fmac_f32 v240,4.0,v236
v_fma_f32 v231,-4.0,v237,v239
v_fmac_f32 v235,s45,v239
M v[164:167],a[244:247],a[192:195],v[164:167]
v_fmac_f32 v240,s40,v238
v_sub_f32 v239,v239,v237
v_fma_f32 v237,-4.0,v236,v238
v_sub_f32 v238,v238,v236
M v[168:171],a[244:247],a[196:199],v[168:171]
v_add_f32 v236,v231,v237
v_sub_f32 v231,v231,v237
v_fma_f32 v237,2.0,v238,v239
v_fmac_f32 v239,-2.0,v238
M v[172:175],a[244:247],a[200:203],v[172:175]
v_cvt_pk_bf16_f32 v204,v228,v235
v_cvt_pk_bf16_f32 v214,v233,v240
v_cvt_pk_bf16_f32 v206,v229,v236
v_cvt_pk_bf16_f32 v208,v234,v231
M v[176:179],a[244:247],a[204:207],v[176:179]
v_cvt_pk_bf16_f32 v210,v230,v237
v_cvt_pk_bf16_f32 v212,v232,v239
v_lshlrev_b32 v230,16,v209
v_lshlrev_b32 v228,16,v205
M v[180:183],a[244:247],a[208:211],v[180:183]
v_lshlrev_b32 v229,16,v207
v_lshlrev_b32 v233,16,v215
v_lshlrev_b32 v232,16,v213
v_lshlrev_b32 v231,16,v211
M v[184:187],a[244:247],a[212:215],v[184:187]
v_fmac_f32 v228,s43,v230
v_fmac_f32 v233,4.0,v229
v_fma_f32 v234,-4.0,v230,v232
v_fmac_f32 v228,s45,v232
M v[188:191],a[244:247],a[216:219],v[188:191]
buffer_load_dwordx4 a[244:247],v253,s[20:23],s46 offen offset:1024
v_fmac_f32 v233,s40,v231
v_sub_f32 v232,v232,v230
v_fma_f32 v230,-4.0,v229,v231
v_sub_f32 v231,v231,v229
M v[96:99],a[248:251],a[192:195],v[96:99]
v_add_f32 v229,v234,v230
v_sub_f32 v234,v234,v230
v_fma_f32 v230,2.0,v231,v232
v_fmac_f32 v232,-2.0,v231
M v[100:103],a[248:251],a[196:199],v[100:103]
v_and_b32 v237,s42,v209
v_and_b32 v235,s42,v205
v_and_b32 v236,s42,v207
v_and_b32 v240,s42,v215
M v[104:107],a[248:251],a[200:203],v[104:107]
v_and_b32 v239,s42,v213
v_and_b32 v238,s42,v211
v_fmac_f32 v235,s43,v237
v_fmac_f32 v240,4.0,v236
M v[108:111],a[248:251],a[204:207],v[108:111]
v_fma_f32 v231,-4.0,v237,v239
v_fmac_f32 v235,s45,v239
v_fmac_f32 v240,s40,v238
v_sub_f32 v239,v239,v237
M v[112:115],a[248:251],a[208:211],v[112:115]
v_fma_f32 v237,-4.0,v236,v238
v_sub_f32 v238,v238,v236
v_add_f32 v236,v231,v237
v_sub_f32 v231,v231,v237
M v[116:119],a[248:251],a[212:215],v[116:119]
v_fma_f32 v237,2.0,v238,v239
v_fmac_f32 v239,-2.0,v238
v_cvt_pk_bf16_f32 v205,v228,v235
v_cvt_pk_bf16_f32 v215,v233,v240
M v[120:123],a[248:251],a[216:219],v[120:123]
s_waitcnt lgkmcnt(0)
v_cvt_pk_bf16_f32 v207,v229,v236
v_cvt_pk_bf16_f32 v209,v234,v231
v_cvt_pk_bf16_f32 v211,v230,v237
v_cvt_pk_bf16_f32 v213,v232,v239
M v[124:127],a[248:251],a[220:223],v[124:127]
buffer_load_dwordx4 a[248:251],v253,s[20:23],s46 offen offset:2048
ds_write2st64_b64 v249,v[204:205],v[214:215] offset0:139 offset1:156
M v[128:131],a[252:255],a[192:195],v[128:131]
ds_write2st64_b64 v249,v[206:207],v[208:209] offset0:3 offset1:20
M v[132:135],a[252:255],a[196:199],v[132:135]
s_add_u32 s46,s44,313344
ds_write2st64_b64 v249,v[210:211],v[212:213] offset0:37 offset1:54
M v[136:139],a[252:255],a[200:203],v[136:139]
M v[140:143],a[252:255],a[204:207],v[140:143]
M v[144:147],a[252:255],a[208:211],v[144:147]
M v[148:151],a[252:255],a[212:215],v[148:151]
v_add_u32 v251,0xffffbc00,v251
v_add_u32 v252,0xffffbc00,v252
M v[152:155],a[252:255],a[216:219],v[152:155]
s_waitcnt lgkmcnt(0)
s_barrier
M v[156:159],a[252:255],a[220:223],v[156:159]
s_waitcnt vmcnt(9)
buffer_load_dwordx4 a[252:255],v253,s[20:23],s46 offen offset:0
M v[160:163],v[216:219],a[192:195],v[160:163]
ds_read_b128 a[192:195],v251 offset:0
M v[164:167],v[216:219],a[196:199],v[164:167]
ds_read_b128 a[196:199],v252 offset:256
M v[168:171],v[216:219],a[200:203],v[168:171]
ds_read_b128 a[200:203],v252 offset:512
M v[172:175],v[216:219],a[204:207],v[172:175]
ds_read_b128 a[204:207],v252 offset:768
M v[176:179],v[216:219],a[208:211],v[176:179]
ds_read_b128 a[208:211],v252 offset:1024
M v[180:183],v[216:219],a[212:215],v[180:183]
ds_read_b128 a[212:215],v252 offset:1280
M v[184:187],v[216:219],a[216:219],v[184:187]
ds_read_b128 a[216:219],v252 offset:1536
M v[188:191],v[216:219],a[220:223],v[188:191]
s_waitcnt vmcnt(9) lgkmcnt(6)
buffer_load_dwordx4 v[216:219],v253,s[20:23],s46 offen offset:1024
M a[0:3],v[220:223],a[192:195],a[0:3]
s_waitcnt lgkmcnt(5)
ds_read_b128 a[220:223],v252 offset:1792
ds_read_b128 a[192:195],v252 offset:2048
M a[4:7],v[220:223],a[196:199],a[4:7]
s_waitcnt lgkmcnt(6)
M a[8:11],v[220:223],a[200:203],a[8:11]
s_waitcnt lgkmcnt(5)
M a[12:15],v[220:223],a[204:207],a[12:15]
s_waitcnt lgkmcnt(4)
M a[16:19],v[220:223],a[208:211],a[16:19]
s_waitcnt lgkmcnt(3)
M a[20:23],v[220:223],a[212:215],a[20:23]
s_waitcnt lgkmcnt(2)
M a[24:27],v[220:223],a[216:219],a[24:27]
s_waitcnt lgkmcnt(1)
M a[28:31],v[220:223],a[220:223],a[28:31]
s_waitcnt vmcnt(9)
buffer_load_dwordx4 v[220:223],v253,s[20:23],s46 offen offset:2048
M a[0:3],v[224:227],a[196:199],a[0:3]
ds_read_b128 a[196:199],v251 offset:2304
M a[4:7],v[224:227],a[200:203],a[4:7]
s_add_u32 s47,s44,288768
M a[8:11],v[224:227],a[204:207],a[8:11]
M a[12:15],v[224:227],a[208:211],a[12:15]
M a[16:19],v[224:227],a[212:215],a[16:19]
M a[20:23],v[224:227],a[216:219],a[20:23]
M a[24:27],v[224:227],a[220:223],a[24:27]
s_waitcnt lgkmcnt(1)
M a[28:31],v[224:227],a[192:195],a[28:31]
s_waitcnt vmcnt(9)
buffer_load_dwordx4 v[224:227],v253,s[20:23],s47 offen offset:0
M a[0:3],a[224:227],a[200:203],a[0:3]
ds_read_b128 a[200:203],v251 offset:8704
M a[4:7],a[224:227],a[204:207],a[4:7]
s_add_u32 s48,s44,291840
ds_read_b128 a[204:207],v252 offset:8960
M a[8:11],a[224:227],a[208:211],a[8:11]
ds_read_b128 a[208:211],v252 offset:9216
M a[12:15],a[224:227],a[212:215],a[12:15]
ds_read_b128 a[212:215],v252 offset:9472
M a[16:19],a[224:227],a[216:219],a[16:19]
ds_read_b128 a[216:219],v252 offset:9728
M a[20:23],a[224:227],a[220:223],a[20:23]
ds_read_b128 a[220:223],v252 offset:9984
M a[24:27],a[224:227],a[192:195],a[24:27]
s_waitcnt lgkmcnt(6)
ds_read_b128 a[192:195],v252 offset:10240
M a[28:31],a[224:227],a[196:199],a[28:31]
s_waitcnt vmcnt(9) lgkmcnt(6)
buffer_load_dwordx4 a[224:227],v253,s[20:23],s48 offen offset:0
M a[96:99],a[228:231],a[200:203],a[96:99]
s_waitcnt lgkmcnt(5)
ds_read_b128 a[196:199],v252 offset:10496
ds_read_b128 a[200:203],v252 offset:10752
M a[100:103],a[228:231],a[204:207],a[100:103]
s_waitcnt lgkmcnt(6)
M a[104:107],a[228:231],a[208:211],a[104:107]
s_waitcnt lgkmcnt(5)
M a[108:111],a[228:231],a[212:215],a[108:111]
s_waitcnt lgkmcnt(4)
M a[112:115],a[228:231],a[216:219],a[112:115]
s_waitcnt lgkmcnt(3)
M a[116:119],a[228:231],a[220:223],a[116:119]
s_waitcnt lgkmcnt(2)
M a[120:123],a[228:231],a[192:195],a[120:123]
s_waitcnt lgkmcnt(1)
M a[124:127],a[228:231],a[196:199],a[124:127]
s_waitcnt vmcnt(9)
buffer_load_dwordx4 a[228:231],v253,s[20:23],s47 offen offset:1024
M a[96:99],a[232:235],a[204:207],a[96:99]
ds_read_b128 a[204:207],v251 offset:11008
M a[100:103],a[232:235],a[208:211],a[100:103]
M a[104:107],a[232:235],a[212:215],a[104:107]
M a[108:111],a[232:235],a[216:219],a[108:111]
M a[112:115],a[232:235],a[220:223],a[112:115]
M a[116:119],a[232:235],a[192:195],a[116:119]
M a[120:123],a[232:235],a[196:199],a[120:123]
s_waitcnt lgkmcnt(1)
M a[124:127],a[232:235],a[200:203],a[124:127]
s_waitcnt vmcnt(9)
buffer_load_dwordx4 a[232:235],v253,s[20:23],s48 offen offset:1024
M a[96:99],a[236:239],a[208:211],a[96:99]
ds_read_b128 a[208:211],v251 offset:17408
M a[100:103],a[236:239],a[212:215],a[100:103]
ds_read_b128 a[212:215],v252 offset:17664
M a[104:107],a[236:239],a[216:219],a[104:107]
ds_read_b128 a[216:219],v252 offset:17920
M a[108:111],a[236:239],a[220:223],a[108:111]
ds_read_b128 a[220:223],v252 offset:18176
M a[112:115],a[236:239],a[192:195],a[112:115]
ds_read_b128 a[192:195],v252 offset:18432
M a[116:119],a[236:239],a[196:199],a[116:119]
ds_read_b128 a[196:199],v252 offset:18688
M a[120:123],a[236:239],a[200:203],a[120:123]
s_waitcnt lgkmcnt(6)
ds_read_b128 a[200:203],v252 offset:18944
M a[124:127],a[236:239],a[204:207],a[124:127]
s_waitcnt vmcnt(9) lgkmcnt(6)
buffer_load_dwordx4 a[236:239],v253,s[20:23],s47 offen offset:2048
M v[0:3],a[240:243],a[208:211],v[0:3]
s_waitcnt lgkmcnt(5)
ds_read_b128 a[204:207],v252 offset:19200
ds_read_b128 a[208:211],v252 offset:19456
M v[4:7],a[240:243],a[212:215],v[4:7]
s_waitcnt lgkmcnt(6)
M v[8:11],a[240:243],a[216:219],v[8:11]
s_waitcnt lgkmcnt(5)
M v[12:15],a[240:243],a[220:223],v[12:15]
s_waitcnt lgkmcnt(4)
M v[16:19],a[240:243],a[192:195],v[16:19]
s_waitcnt lgkmcnt(3)
M v[20:23],a[240:243],a[196:199],v[20:23]
s_waitcnt lgkmcnt(2)
M v[24:27],a[240:243],a[200:203],v[24:27]
s_waitcnt lgkmcnt(1)
M v[28:31],a[240:243],a[204:207],v[28:31]
s_waitcnt vmcnt(9)
buffer_load_dwordx4 a[240:243],v253,s[20:23],s48 offen offset:2048
M v[0:3],a[244:247],a[212:215],v[0:3]
ds_read_b128 a[212:215],v251 offset:19712
M v[4:7],a[244:247],a[216:219],v[4:7]
s_add_u32 s47,s44,297984
M v[8:11],a[244:247],a[220:223],v[8:11]
M v[12:15],a[244:247],a[192:195],v[12:15]
M v[16:19],a[244:247],a[196:199],v[16:19]
M v[20:23],a[244:247],a[200:203],v[20:23]
M v[24:27],a[244:247],a[204:207],v[24:27]
s_waitcnt lgkmcnt(1)
M v[28:31],a[244:247],a[208:211],v[28:31]
s_waitcnt vmcnt(9)
buffer_load_dwordx4 a[244:247],v253,s[20:23],s47 offen offset:0
M v[0:3],a[248:251],a[216:219],v[0:3]
ds_read_b128 a[216:219],v251 offset:26112
M v[4:7],a[248:251],a[220:223],v[4:7]
s_add_u32 s48,s44,301056
ds_read_b128 a[220:223],v252 offset:26368
M v[8:11],a[248:251],a[192:195],v[8:11]
ds_read_b128 a[192:195],v252 offset:26624
M v[12:15],a[248:251],a[196:199],v[12:15]
ds_read_b128 a[196:199],v252 offset:26880
M v[16:19],a[248:251],a[200:203],v[16:19]
ds_read_b128 a[200:203],v252 offset:27136
M v[20:23],a[248:251],a[204:207],v[20:23]
ds_read_b128 a[204:207],v252 offset:27392
M v[24:27],a[248:251],a[208:211],v[24:27]
s_waitcnt lgkmcnt(6)
ds_read_b128 a[208:211],v252 offset:27648
M v[28:31],a[248:251],a[212:215],v[28:31]
s_waitcnt vmcnt(9) lgkmcnt(6)
buffer_load_dwordx4 a[248:251],v253,s[20:23],s48 offen offset:0
M v[96:99],a[252:255],a[216:219],v[96:99]
s_waitcnt lgkmcnt(5)
ds_read_b128 a[212:215],v252 offset:27904
ds_read_b128 a[216:219],v252 offset:28160
M v[100:103],a[252:255],a[220:223],v[100:103]
s_waitcnt lgkmcnt(6)
M v[104:107],a[252:255],a[192:195],v[104:107]
s_waitcnt lgkmcnt(5)
M v[108:111],a[252:255],a[196:199],v[108:111]
s_waitcnt lgkmcnt(4)
M v[112:115],a[252:255],a[200:203],v[112:115]
s_waitcnt lgkmcnt(3)
M v[116:119],a[252:255],a[204:207],v[116:119]
s_waitcnt lgkmcnt(2)
M v[120:123],a[252:255],a[208:211],v[120:123]
s_waitcnt lgkmcnt(1)
M v[124:127],a[252:255],a[212:215],v[124:127]
s_waitcnt vmcnt(9)
buffer_load_dwordx4 a[252:255],v253,s[20:23],s47 offen offset:1024
M v[96:99],v[216:219],a[220:223],v[96:99]
ds_read_b128 a[220:223],v251 offset:28416
M v[100:103],v[216:219],a[192:195],v[100:103]
M v[104:107],v[216:219],a[196:199],v[104:107]
M v[108:111],v[216:219],a[200:203],v[108:111]
M v[112:115],v[216:219],a[204:207],v[112:115]
M v[116:119],v[216:219],a[208:211],v[116:119]
M v[120:123],v[216:219],a[212:215],v[120:123]
s_waitcnt lgkmcnt(1)
M v[124:127],v[216:219],a[216:219],v[124:127]
s_waitcnt vmcnt(9)
buffer_load_dwordx4 v[216:219],v253,s[20:23],s48 offen offset:1024
M v[96:99],v[220:223],a[192:195],v[96:99]
ds_read_b128 a[192:195],v251 offset:0
M v[100:103],v[220:223],a[196:199],v[100:103]
ds_read_b128 a[196:199],v252 offset:256
M v[104:107],v[220:223],a[200:203],v[104:107]
ds_read_b128 a[200:203],v252 offset:512
M v[108:111],v[220:223],a[204:207],v[108:111]
ds_read_b128 a[204:207],v252 offset:768
v_accvgpr_read_b32 v240,a0
M v[112:115],v[220:223],a[208:211],v[112:115]
ds_read_b128 a[208:211],v252 offset:1024
v_accvgpr_read_b32 v238,a96
M v[116:119],v[220:223],a[212:215],v[116:119]
ds_read_b128 a[212:215],v252 offset:1280
v_add_f32 v236,v240,v238
M v[120:123],v[220:223],a[216:219],v[120:123]
s_waitcnt lgkmcnt(6)
ds_read_b128 a[216:219],v252 offset:1536
v_sub_f32 v240,v240,v238
M v[124:127],v[220:223],a[220:223],v[124:127]
s_waitcnt vmcnt(9) lgkmcnt(6)
buffer_load_dwordx4 v[220:223],v253,s[20:23],s47 offen offset:2048
M a[32:35],v[224:227],a[192:195],a[32:35]
s_waitcnt lgkmcnt(5)
ds_read_b128 a[220:223],v252 offset:1792
v_add_f32 v238,v0,v96
M a[36:39],v[224:227],a[196:199],a[36:39]
s_waitcnt lgkmcnt(5)
v_sub_f32 v96,v0,v96
v_add_f32 v0,v236,v238
M a[40:43],v[224:227],a[200:203],a[40:43]
s_waitcnt lgkmcnt(4)
v_fmac_f32 v236,4.0,v238
v_fma_f32 v238,2.0,v96,v240
M a[44:47],v[224:227],a[204:207],a[44:47]
s_waitcnt lgkmcnt(3)
v_fma_f32 v96,s41,v96,v240
v_accvgpr_read_b32 v240,a1
M a[48:51],v[224:227],a[208:211],a[48:51]
s_waitcnt lgkmcnt(2)
v_accvgpr_read_b32 v239,a97
v_add_f32 v237,v240,v239
M a[52:55],v[224:227],a[212:215],a[52:55]
s_waitcnt lgkmcnt(1)
v_sub_f32 v240,v240,v239
v_add_f32 v239,v1,v97
M a[56:59],v[224:227],a[216:219],a[56:59]
s_waitcnt lgkmcnt(0)
v_sub_f32 v97,v1,v97
v_add_f32 v1,v237,v239
M a[60:63],v[224:227],a[220:223],a[60:63]
s_waitcnt vmcnt(9)
buffer_load_dwordx4 v[224:227],v253,s[20:23],s48 offen offset:2048
M a[64:67],a[224:227],a[192:195],a[64:67]
ds_read_b128 a[192:195],v252 offset:2048
v_fmac_f32 v237,4.0,v239
M a[68:71],a[224:227],a[196:199],a[68:71]
s_add_u32 s47,s44,307200
v_fma_f32 v239,2.0,v97,v240
v_fma_f32 v97,s41,v97,v240
M a[72:75],a[224:227],a[200:203],a[72:75]
v_cvt_pk_bf16_f32 v238,v238,v239
v_accvgpr_write_b32 a0,v238
M a[76:79],a[224:227],a[204:207],a[76:79]
v_cvt_pk_bf16_f32 v236,v236,v237
v_accvgpr_write_b32 a96,v236
M a[80:83],a[224:227],a[208:211],a[80:83]
v_accvgpr_read_b32 v240,a2
v_accvgpr_read_b32 v238,a98
M a[84:87],a[224:227],a[212:215],a[84:87]
v_add_f32 v236,v240,v238
v_sub_f32 v240,v240,v238
M a[88:91],a[224:227],a[216:219],a[88:91]
v_add_f32 v238,v2,v98
v_sub_f32 v98,v2,v98
M a[92:95],a[224:227],a[220:223],a[92:95]
s_waitcnt vmcnt(9)
buffer_load_dwordx4 a[224:227],v253,s[20:23],s47 offen offset:0
M a[32:35],a[228:231],a[196:199],a[32:35]
v_add_f32 v2,v236,v238
v_fmac_f32 v236,4.0,v238
M a[36:39],a[228:231],a[200:203],a[36:39]
s_add_u32 s48,s44,310272
v_fma_f32 v238,2.0,v98,v240
v_fma_f32 v98,s41,v98,v240
M a[40:43],a[228:231],a[204:207],a[40:43]
v_accvgpr_read_b32 v240,a3
v_accvgpr_read_b32 v239,a99
M a[44:47],a[228:231],a[208:211],a[44:47]
v_add_f32 v237,v240,v239
v_sub_f32 v240,v240,v239
M a[48:51],a[228:231],a[212:215],a[48:51]
v_add_f32 v239,v3,v99
v_sub_f32 v99,v3,v99
M a[52:55],a[228:231],a[216:219],a[52:55]
v_add_f32 v3,v237,v239
v_fmac_f32 v237,4.0,v239
M a[56:59],a[228:231],a[220:223],a[56:59]
s_waitcnt lgkmcnt(0)
v_fma_f32 v239,2.0,v99,v240
v_fma_f32 v99,s41,v99,v240
M a[60:63],a[228:231],a[192:195],a[60:63]
s_waitcnt vmcnt(9)
buffer_load_dwordx4 a[228:231],v253,s[20:23],s48 offen offset:0
M a[64:67],a[232:235],a[196:199],a[64:67]
ds_read_b128 a[196:199],v251 offset:2304
v_cvt_pk_bf16_f32 v238,v238,v239
M a[68:71],a[232:235],a[200:203],a[68:71]
v_accvgpr_write_b32 a1,v238
v_cvt_pk_bf16_f32 v236,v236,v237
M a[72:75],a[232:235],a[204:207],a[72:75]
v_accvgpr_write_b32 a97,v236
v_accvgpr_read_b32 v240,a4
M a[76:79],a[232:235],a[208:211],a[76:79]
v_accvgpr_read_b32 v238,a100
v_add_f32 v236,v240,v238
M a[80:83],a[232:235],a[212:215],a[80:83]
v_sub_f32 v240,v240,v238
v_add_f32 v238,v4,v100
M a[84:87],a[232:235],a[216:219],a[84:87]
v_sub_f32 v100,v4,v100
v_add_f32 v4,v236,v238
M a[88:91],a[232:235],a[220:223],a[88:91]
v_fmac_f32 v236,4.0,v238
v_fma_f32 v238,2.0,v100,v240
M a[92:95],a[232:235],a[192:195],a[92:95]
s_waitcnt vmcnt(9)
buffer_load_dwordx4 a[232:235],v253,s[20:23],s47 offen offset:1024
M a[32:35],a[236:239],a[200:203],a[32:35]
v_fma_f32 v100,s41,v100,v240
v_accvgpr_read_b32 v240,a5
M a[36:39],a[236:239],a[204:207],a[36:39]
v_accvgpr_read_b32 v239,a101
v_add_f32 v237,v240,v239
M a[40:43],a[236:239],a[208:211],a[40:43]
v_sub_f32 v240,v240,v239
v_add_f32 v239,v5,v101
M a[44:47],a[236:239],a[212:215],a[44:47]
v_sub_f32 v101,v5,v101
v_add_f32 v5,v237,v239
M a[48:51],a[236:239],a[216:219],a[48:51]
v_fmac_f32 v237,4.0,v239
v_fma_f32 v239,2.0,v101,v240
M a[52:55],a[236:239],a[220:223],a[52:55]
v_fma_f32 v101,s41,v101,v240
v_cvt_pk_bf16_f32 v238,v238,v239
M a[56:59],a[236:239],a[192:195],a[56:59]
s_waitcnt lgkmcnt(0)
v_accvgpr_write_b32 a4,v238
v_cvt_pk_bf16_f32 v236,v236,v237
M a[60:63],a[236:239],a[196:199],a[60:63]
s_waitcnt vmcnt(9)
buffer_load_dwordx4 a[236:239],v253,s[20:23],s48 offen offset:1024
M a[64:67],a[240:243],a[200:203],a[64:67]
ds_read_b128 a[200:203],v251 offset:8704
v_accvgpr_write_b32 a100,v236
M a[68:71],a[240:243],a[204:207],a[68:71]
ds_read_b128 a[204:207],v252 offset:8960
v_accvgpr_read_b32 v240,a6
M a[72:75],a[240:243],a[208:211],a[72:75]
ds_read_b128 a[208:211],v252 offset:9216
v_accvgpr_read_b32 v238,a102
M a[76:79],a[240:243],a[212:215],a[76:79]
ds_read_b128 a[212:215],v252 offset:9472
v_add_f32 v236,v240,v238
M a[80:83],a[240:243],a[216:219],a[80:83]
ds_read_b128 a[216:219],v252 offset:9728
v_sub_f32 v240,v240,v238
M a[84:87],a[240:243],a[220:223],a[84:87]
ds_read_b128 a[220:223],v252 offset:9984
v_add_f32 v238,v6,v102
M a[88:91],a[240:243],a[192:195],a[88:91]
ds_read_b128 a[192:195],v252 offset:10240
v_sub_f32 v102,v6,v102
M a[92:95],a[240:243],a[196:199],a[92:95]
s_waitcnt vmcnt(9) lgkmcnt(6)
buffer_load_dwordx4 a[240:243],v253,s[20:23],s47 offen offset:2048
M a[128:131],a[244:247],a[200:203],a[128:131]
s_waitcnt lgkmcnt(5)
ds_read_b128 a[196:199],v252 offset:10496
v_add_f32 v6,v236,v238
M a[132:135],a[244:247],a[204:207],a[132:135]
s_waitcnt lgkmcnt(5)
v_fmac_f32 v236,4.0,v238
v_fma_f32 v238,2.0,v102,v240
M a[136:139],a[244:247],a[208:211],a[136:139]
s_waitcnt lgkmcnt(4)
v_fma_f32 v102,s41,v102,v240
v_accvgpr_read_b32 v240,a7
M a[140:143],a[244:247],a[212:215],a[140:143]
s_waitcnt lgkmcnt(3)
v_accvgpr_read_b32 v239,a103
v_add_f32 v237,v240,v239
M a[144:147],a[244:247],a[216:219],a[144:147]
s_waitcnt lgkmcnt(2)
v_sub_f32 v240,v240,v239
v_add_f32 v239,v7,v103
M a[148:151],a[244:247],a[220:223],a[148:151]
s_waitcnt lgkmcnt(1)
v_sub_f32 v103,v7,v103
v_add_f32 v7,v237,v239
M a[152:155],a[244:247],a[192:195],a[152:155]
s_waitcnt lgkmcnt(0)
v_fmac_f32 v237,4.0,v239
v_fma_f32 v239,2.0,v103,v240
M a[156:159],a[244:247],a[196:199],a[156:159]
s_waitcnt vmcnt(9)
buffer_load_dwordx4 a[244:247],v253,s[20:23],s48 offen offset:2048
M a[160:163],a[248:251],a[200:203],a[160:163]
ds_read_b128 a[200:203],v252 offset:10752
v_fma_f32 v103,s41,v103,v240
M a[164:167],a[248:251],a[204:207],a[164:167]
s_add_u32 s47,s44,316416
v_cvt_pk_bf16_f32 v238,v238,v239
v_accvgpr_write_b32 a5,v238
M a[168:171],a[248:251],a[208:211],a[168:171]
v_cvt_pk_bf16_f32 v236,v236,v237
v_accvgpr_write_b32 a101,v236
M a[172:175],a[248:251],a[212:215],a[172:175]
v_accvgpr_read_b32 v240,a8
v_accvgpr_read_b32 v238,a104
M a[176:179],a[248:251],a[216:219],a[176:179]
v_add_f32 v236,v240,v238
v_sub_f32 v240,v240,v238
M a[180:183],a[248:251],a[220:223],a[180:183]
v_add_f32 v238,v8,v104
v_sub_f32 v104,v8,v104
M a[184:187],a[248:251],a[192:195],a[184:187]
v_add_f32 v8,v236,v238
v_fmac_f32 v236,4.0,v238
M a[188:191],a[248:251],a[196:199],a[188:191]
s_waitcnt vmcnt(9)
buffer_load_dwordx4 a[248:251],v253,s[20:23],s47 offen offset:0
M a[128:131],a[252:255],a[204:207],a[128:131]
v_fma_f32 v238,2.0,v104,v240
v_fma_f32 v104,s41,v104,v240
M a[132:135],a[252:255],a[208:211],a[132:135]
s_add_u32 s48,s44,319488
v_accvgpr_read_b32 v240,a9
v_accvgpr_read_b32 v239,a105
M a[136:139],a[252:255],a[212:215],a[136:139]
v_add_f32 v237,v240,v239
v_sub_f32 v240,v240,v239
M a[140:143],a[252:255],a[216:219],a[140:143]
v_add_f32 v239,v9,v105
v_sub_f32 v105,v9,v105
M a[144:147],a[252:255],a[220:223],a[144:147]
v_add_f32 v9,v237,v239
v_fmac_f32 v237,4.0,v239
M a[148:151],a[252:255],a[192:195],a[148:151]
v_fma_f32 v239,2.0,v105,v240
v_fma_f32 v105,s41,v105,v240
M a[152:155],a[252:255],a[196:199],a[152:155]
s_waitcnt lgkmcnt(0)
v_cvt_pk_bf16_f32 v238,v238,v239
v_accvgpr_write_b32 a8,v238
M a[156:159],a[252:255],a[200:203],a[156:159]
s_waitcnt vmcnt(9)
buffer_load_dwordx4 a[252:255],v253,s[20:23],s48 offen offset:0
M a[160:163],v[216:219],a[204:207],a[160:163]
ds_read_b128 a[204:207],v251 offset:11008
v_cvt_pk_bf16_f32 v236,v236,v237
M a[164:167],v[216:219],a[208:211],a[164:167]
v_accvgpr_write_b32 a104,v236
v_accvgpr_read_b32 v240,a10
M a[168:171],v[216:219],a[212:215],a[168:171]
v_accvgpr_read_b32 v238,a106
v_add_f32 v236,v240,v238
M a[172:175],v[216:219],a[216:219],a[172:175]
v_sub_f32 v240,v240,v238
v_add_f32 v238,v10,v106
M a[176:179],v[216:219],a[220:223],a[176:179]
v_sub_f32 v106,v10,v106
v_add_f32 v10,v236,v238
M a[180:183],v[216:219],a[192:195],a[180:183]
v_fmac_f32 v236,4.0,v238
v_fma_f32 v238,2.0,v106,v240
M a[184:187],v[216:219],a[196:199],a[184:187]
v_fma_f32 v106,s41,v106,v240
v_accvgpr_read_b32 v240,a11
M a[188:191],v[216:219],a[200:203],a[188:191]
s_waitcnt vmcnt(9)
buffer_load_dwordx4 v[216:219],v253,s[20:23],s47 offen offset:1024
M a[128:131],v[220:223],a[208:211],a[128:131]
v_accvgpr_read_b32 v239,a107
v_add_f32 v237,v240,v239
M a[132:135],v[220:223],a[212:215],a[132:135]
v_sub_f32 v240,v240,v239
v_add_f32 v239,v11,v107
M a[136:139],v[220:223],a[216:219],a[136:139]
v_sub_f32 v107,v11,v107
v_add_f32 v11,v237,v239
M a[140:143],v[220:223],a[220:223],a[140:143]
v_fmac_f32 v237,4.0,v239
v_fma_f32 v239,2.0,v107,v240
M a[144:147],v[220:223],a[192:195],a[144:147]
v_fma_f32 v107,s41,v107,v240
v_cvt_pk_bf16_f32 v238,v238,v239
M a[148:151],v[220:223],a[196:199],a[148:151]
v_accvgpr_write_b32 a9,v238
v_cvt_pk_bf16_f32 v236,v236,v237
M a[152:155],v[220:223],a[200:203],a[152:155]
s_waitcnt lgkmcnt(0)
v_accvgpr_write_b32 a105,v236
v_accvgpr_read_b32 v240,a12
M a[156:159],v[220:223],a[204:207],a[156:159]
s_waitcnt vmcnt(9)
buffer_load_dwordx4 v[220:223],v253,s[20:23],s48 offen offset:1024
M a[160:163],v[224:227],a[208:211],a[160:163]
ds_read_b128 a[208:211],v251 offset:17408
v_accvgpr_read_b32 v238,a108
M a[164:167],v[224:227],a[212:215],a[164:167]
ds_read_b128 a[212:215],v252 offset:17664
v_add_f32 v236,v240,v238
M a[168:171],v[224:227],a[216:219],a[168:171]
ds_read_b128 a[216:219],v252 offset:17920
v_sub_f32 v240,v240,v238
M a[172:175],v[224:227],a[220:223],a[172:175]
ds_read_b128 a[220:223],v252 offset:18176
v_add_f32 v238,v12,v108
M a[176:179],v[224:227],a[192:195],a[176:179]
ds_read_b128 a[192:195],v252 offset:18432
v_sub_f32 v108,v12,v108
M a[180:183],v[224:227],a[196:199],a[180:183]
ds_read_b128 a[196:199],v252 offset:18688
v_add_f32 v12,v236,v238
M a[184:187],v[224:227],a[200:203],a[184:187]
ds_read_b128 a[200:203],v252 offset:18944
v_fmac_f32 v236,4.0,v238
M a[188:191],v[224:227],a[204:207],a[188:191]
s_waitcnt vmcnt(9) lgkmcnt(6)
buffer_load_dwordx4 v[224:227],v253,s[20:23],s47 offen offset:2048
M v[32:35],a[224:227],a[208:211],v[32:35]
s_waitcnt lgkmcnt(5)
ds_read_b128 a[204:207],v252 offset:19200
v_fma_f32 v238,2.0,v108,v240
M v[36:39],a[224:227],a[212:215],v[36:39]
s_waitcnt lgkmcnt(5)
v_fma_f32 v108,s41,v108,v240
v_accvgpr_read_b32 v240,a13
M v[40:43],a[224:227],a[216:219],v[40:43]
s_waitcnt lgkmcnt(4)
v_accvgpr_read_b32 v239,a109
v_add_f32 v237,v240,v239
M v[44:47],a[224:227],a[220:223],v[44:47]
s_waitcnt lgkmcnt(3)
v_sub_f32 v240,v240,v239
v_add_f32 v239,v13,v109
M v[48:51],a[224:227],a[192:195],v[48:51]
s_waitcnt lgkmcnt(2)
v_sub_f32 v109,v13,v109
v_add_f32 v13,v237,v239
M v[52:55],a[224:227],a[196:199],v[52:55]
s_waitcnt lgkmcnt(1)
v_fmac_f32 v237,4.0,v239
v_fma_f32 v239,2.0,v109,v240
M v[56:59],a[224:227],a[200:203],v[56:59]
s_waitcnt lgkmcnt(0)
v_fma_f32 v109,s41,v109,v240
v_cvt_pk_bf16_f32 v238,v238,v239
M v[60:63],a[224:227],a[204:207],v[60:63]
s_waitcnt vmcnt(9)
buffer_load_dwordx4 a[224:227],v253,s[20:23],s48 offen offset:2048
M v[64:67],a[228:231],a[208:211],v[64:67]
ds_read_b128 a[208:211],v252 offset:19456
v_accvgpr_write_b32 a12,v238
M v[68:71],a[228:231],a[212:215],v[68:71]
s_add_u32 s46,s44,0
v_cvt_pk_bf16_f32 v236,v236,v237
v_accvgpr_write_b32 a108,v236
M v[72:75],a[228:231],a[216:219],v[72:75]
v_accvgpr_read_b32 v240,a14
v_accvgpr_read_b32 v238,a110
M v[76:79],a[228:231],a[220:223],v[76:79]
v_add_f32 v236,v240,v238
v_sub_f32 v240,v240,v238
M v[80:83],a[228:231],a[192:195],v[80:83]
v_add_f32 v238,v14,v110
v_sub_f32 v110,v14,v110
M v[84:87],a[228:231],a[196:199],v[84:87]
v_add_f32 v14,v236,v238
v_fmac_f32 v236,4.0,v238
M v[88:91],a[228:231],a[200:203],v[88:91]
v_fma_f32 v238,2.0,v110,v240
v_fma_f32 v110,s41,v110,v240
M v[92:95],a[228:231],a[204:207],v[92:95]
s_waitcnt vmcnt(9)
buffer_load_dwordx4 a[228:231],v253,s[20:23],s46 offen offset:0
M v[32:35],a[232:235],a[212:215],v[32:35]
v_accvgpr_read_b32 v240,a15
v_accvgpr_read_b32 v239,a111
M v[36:39],a[232:235],a[216:219],v[36:39]
v_add_f32 v237,v240,v239
v_sub_f32 v240,v240,v239
M v[40:43],a[232:235],a[220:223],v[40:43]
v_add_f32 v239,v15,v111
v_sub_f32 v111,v15,v111
M v[44:47],a[232:235],a[192:195],v[44:47]
v_add_f32 v15,v237,v239
v_fmac_f32 v237,4.0,v239
M v[48:51],a[232:235],a[196:199],v[48:51]
v_fma_f32 v239,2.0,v111,v240
v_fma_f32 v111,s41,v111,v240
M v[52:55],a[232:235],a[200:203],v[52:55]
v_cvt_pk_bf16_f32 v238,v238,v239
v_accvgpr_write_b32 a13,v238
M v[56:59],a[232:235],a[204:207],v[56:59]
s_waitcnt lgkmcnt(0)
v_cvt_pk_bf16_f32 v236,v236,v237
v_accvgpr_write_b32 a109,v236
M v[60:63],a[232:235],a[208:211],v[60:63]
s_waitcnt vmcnt(9)
buffer_load_dwordx4 a[232:235],v253,s[20:23],s46 offen offset:1024
M v[64:67],a[236:239],a[212:215],v[64:67]
ds_read_b128 a[212:215],v251 offset:19712
v_accvgpr_read_b32 v240,a16
M v[68:71],a[236:239],a[216:219],v[68:71]
v_accvgpr_read_b32 v238,a112
v_add_f32 v236,v240,v238
M v[72:75],a[236:239],a[220:223],v[72:75]
v_sub_f32 v240,v240,v238
v_add_f32 v238,v16,v112
M v[76:79],a[236:239],a[192:195],v[76:79]
v_sub_f32 v112,v16,v112
v_add_f32 v16,v236,v238
M v[80:83],a[236:239],a[196:199],v[80:83]
v_fmac_f32 v236,4.0,v238
v_fma_f32 v238,2.0,v112,v240
M v[84:87],a[236:239],a[200:203],v[84:87]
v_fma_f32 v112,s41,v112,v240
v_accvgpr_read_b32 v240,a17
M v[88:91],a[236:239],a[204:207],v[88:91]
v_accvgpr_read_b32 v239,a113
v_add_f32 v237,v240,v239
M v[92:95],a[236:239],a[208:211],v[92:95]
s_waitcnt vmcnt(9)
buffer_load_dwordx4 a[236:239],v253,s[20:23],s46 offen offset:2048
M v[32:35],a[240:243],a[216:219],v[32:35]
v_sub_f32 v240,v240,v239
v_add_f32 v239,v17,v113
M v[36:39],a[240:243],a[220:223],v[36:39]
s_add_u32 s46,s44,55296
v_sub_f32 v113,v17,v113
v_add_f32 v17,v237,v239
M v[40:43],a[240:243],a[192:195],v[40:43]
v_fmac_f32 v237,4.0,v239
v_fma_f32 v239,2.0,v113,v240
M v[44:47],a[240:243],a[196:199],v[44:47]
v_fma_f32 v113,s41,v113,v240
v_cvt_pk_bf16_f32 v238,v238,v239
M v[48:51],a[240:243],a[200:203],v[48:51]
v_accvgpr_write_b32 a16,v238
v_cvt_pk_bf16_f32 v236,v236,v237
M v[52:55],a[240:243],a[204:207],v[52:55]
v_accvgpr_write_b32 a112,v236
v_accvgpr_read_b32 v240,a18
M v[56:59],a[240:243],a[208:211],v[56:59]
s_waitcnt lgkmcnt(0)
v_accvgpr_read_b32 v238,a114
v_add_f32 v236,v240,v238
M v[60:63],a[240:243],a[212:215],v[60:63]
s_waitcnt vmcnt(9)
buffer_load_dwordx4 a[240:243],v253,s[20:23],s46 offen offset:0
M v[64:67],a[244:247],a[216:219],v[64:67]
ds_read_b128 a[216:219],v251 offset:26112
v_sub_f32 v240,v240,v238
M v[68:71],a[244:247],a[220:223],v[68:71]
ds_read_b128 a[220:223],v252 offset:26368
v_add_f32 v238,v18,v114
M v[72:75],a[244:247],a[192:195],v[72:75]
ds_read_b128 a[192:195],v252 offset:26624
v_sub_f32 v114,v18,v114
M v[76:79],a[244:247],a[196:199],v[76:79]
ds_read_b128 a[196:199],v252 offset:26880
v_add_f32 v18,v236,v238
M v[80:83],a[244:247],a[200:203],v[80:83]
ds_read_b128 a[200:203],v252 offset:27136
v_fmac_f32 v236,4.0,v238
M v[84:87],a[244:247],a[204:207],v[84:87]
ds_read_b128 a[204:207],v252 offset:27392
v_fma_f32 v238,2.0,v114,v240
M v[88:91],a[244:247],a[208:211],v[88:91]
ds_read_b128 a[208:211],v252 offset:27648
v_fma_f32 v114,s41,v114,v240
M v[92:95],a[244:247],a[212:215],v[92:95]
s_waitcnt vmcnt(9) lgkmcnt(6)
buffer_load_dwordx4 a[244:247],v253,s[20:23],s46 offen offset:1024
M v[128:131],a[248:251],a[216:219],v[128:131]
s_waitcnt lgkmcnt(5)
ds_read_b128 a[212:215],v252 offset:27904
v_accvgpr_read_b32 v240,a19
M v[132:135],a[248:251],a[220:223],v[132:135]
s_waitcnt lgkmcnt(5)
v_accvgpr_read_b32 v239,a115
v_add_f32 v237,v240,v239
M v[136:139],a[248:251],a[192:195],v[136:139]
s_waitcnt lgkmcnt(4)
v_sub_f32 v240,v240,v239
v_add_f32 v239,v19,v115
M v[140:143],a[248:251],a[196:199],v[140:143]
s_waitcnt lgkmcnt(3)
v_sub_f32 v115,v19,v115
v_add_f32 v19,v237,v239
M v[144:147],a[248:251],a[200:203],v[144:147]
s_waitcnt lgkmcnt(2)
v_fmac_f32 v237,4.0,v239
v_fma_f32 v239,2.0,v115,v240
M v[148:151],a[248:251],a[204:207],v[148:151]
s_waitcnt lgkmcnt(1)
v_fma_f32 v115,s41,v115,v240
v_cvt_pk_bf16_f32 v238,v238,v239
M v[152:155],a[248:251],a[208:211],v[152:155]
s_waitcnt lgkmcnt(0)
v_accvgpr_write_b32 a17,v238
v_cvt_pk_bf16_f32 v236,v236,v237
M v[156:159],a[248:251],a[212:215],v[156:159]
s_waitcnt vmcnt(9)
buffer_load_dwordx4 a[248:251],v253,s[20:23],s46 offen offset:2048
M v[160:163],a[252:255],a[216:219],v[160:163]
ds_read_b128 a[216:219],v252 offset:28160
v_accvgpr_write_b32 a113,v236
M v[164:167],a[252:255],a[220:223],v[164:167]
s_add_u32 s46,s44,110592
v_accvgpr_read_b32 v240,a20
v_accvgpr_read_b32 v238,a116
M v[168:171],a[252:255],a[192:195],v[168:171]
v_add_f32 v236,v240,v238
v_sub_f32 v240,v240,v238
M v[172:175],a[252:255],a[196:199],v[172:175]
v_add_f32 v238,v20,v116
v_sub_f32 v116,v20,v116
M v[176:179],a[252:255],a[200:203],v[176:179]
v_add_f32 v20,v236,v238
v_fmac_f32 v236,4.0,v238
M v[180:183],a[252:255],a[204:207],v[180:183]
v_fma_f32 v238,2.0,v116,v240
v_fma_f32 v116,s41,v116,v240
M v[184:187],a[252:255],a[208:211],v[184:187]
v_accvgpr_read_b32 v240,a21
v_accvgpr_read_b32 v239,a117
M v[188:191],a[252:255],a[212:215],v[188:191]
s_waitcnt vmcnt(9)
buffer_load_dwordx4 a[252:255],v253,s[20:23],s46 offen offset:0
M v[128:131],v[216:219],a[220:223],v[128:131]
v_add_f32 v237,v240,v239
v_sub_f32 v240,v240,v239
M v[132:135],v[216:219],a[192:195],v[132:135]
v_add_f32 v239,v21,v117
v_sub_f32 v117,v21,v117
M v[136:139],v[216:219],a[196:199],v[136:139]
v_add_f32 v21,v237,v239
v_fmac_f32 v237,4.0,v239
M v[140:143],v[216:219],a[200:203],v[140:143]
v_fma_f32 v239,2.0,v117,v240
v_fma_f32 v117,s41,v117,v240
M v[144:147],v[216:219],a[204:207],v[144:147]
v_cvt_pk_bf16_f32 v238,v238,v239
v_accvgpr_write_b32 a20,v238
M v[148:151],v[216:219],a[208:211],v[148:151]
v_cvt_pk_bf16_f32 v236,v236,v237
v_accvgpr_write_b32 a116,v236
M v[152:155],v[216:219],a[212:215],v[152:155]
s_waitcnt lgkmcnt(0)
v_accvgpr_read_b32 v240,a22
v_accvgpr_read_b32 v238,a118
M v[156:159],v[216:219],a[216:219],v[156:159]
s_waitcnt vmcnt(9)
buffer_load_dwordx4 v[216:219],v253,s[20:23],s46 offen offset:1024
M v[160:163],v[220:223],a[220:223],v[160:163]
ds_read_b128 a[220:223],v251 offset:28416
v_add_f32 v236,v240,v238
M v[164:167],v[220:223],a[192:195],v[164:167]
v_sub_f32 v240,v240,v238
v_add_f32 v238,v22,v118
v_sub_f32 v118,v22,v118
v_add_f32 v22,v236,v238
M v[168:171],v[220:223],a[196:199],v[168:171]
v_fmac_f32 v236,4.0,v238
v_fma_f32 v238,2.0,v118,v240
v_fma_f32 v118,s41,v118,v240
v_accvgpr_read_b32 v240,a23
M v[172:175],v[220:223],a[200:203],v[172:175]
v_accvgpr_read_b32 v239,a119
v_add_f32 v237,v240,v239
v_sub_f32 v240,v240,v239
v_add_f32 v239,v23,v119
M v[176:179],v[220:223],a[204:207],v[176:179]
v_sub_f32 v119,v23,v119
v_add_f32 v23,v237,v239
v_fmac_f32 v237,4.0,v239
v_fma_f32 v239,2.0,v119,v240
M v[180:183],v[220:223],a[208:211],v[180:183]
v_fma_f32 v119,s41,v119,v240
v_cvt_pk_bf16_f32 v238,v238,v239
v_accvgpr_write_b32 a21,v238
v_cvt_pk_bf16_f32 v236,v236,v237
M v[184:187],v[220:223],a[212:215],v[184:187]
v_accvgpr_write_b32 a117,v236
v_accvgpr_read_b32 v240,a24
v_accvgpr_read_b32 v238,a120
v_add_f32 v236,v240,v238
M v[188:191],v[220:223],a[216:219],v[188:191]
s_waitcnt vmcnt(9)
buffer_load_dwordx4 v[220:223],v253,s[20:23],s46 offen offset:2048
v_sub_f32 v240,v240,v238
v_add_f32 v238,v24,v120
v_sub_f32 v120,v24,v120
v_add_f32 v24,v236,v238
M v[128:131],v[224:227],a[192:195],v[128:131]
v_fmac_f32 v236,4.0,v238
v_fma_f32 v238,2.0,v120,v240
v_fma_f32 v120,s41,v120,v240
v_accvgpr_read_b32 v240,a25
M v[132:135],v[224:227],a[196:199],v[132:135]
s_add_u32 s46,s44,165888
v_accvgpr_read_b32 v239,a121
v_add_f32 v237,v240,v239
v_sub_f32 v240,v240,v239
v_add_f32 v239,v25,v121
M v[136:139],v[224:227],a[200:203],v[136:139]
v_sub_f32 v121,v25,v121
v_add_f32 v25,v237,v239
v_fmac_f32 v237,4.0,v239
v_fma_f32 v239,2.0,v121,v240
M v[140:143],v[224:227],a[204:207],v[140:143]
v_fma_f32 v121,s41,v121,v240
v_cvt_pk_bf16_f32 v238,v238,v239
v_accvgpr_write_b32 a24,v238
v_cvt_pk_bf16_f32 v236,v236,v237
M v[144:147],v[224:227],a[208:211],v[144:147]
v_accvgpr_write_b32 a120,v236
v_accvgpr_read_b32 v240,a26
v_accvgpr_read_b32 v238,a122
v_add_f32 v236,v240,v238
M v[148:151],v[224:227],a[212:215],v[148:151]
v_sub_f32 v240,v240,v238
v_add_f32 v238,v26,v122
v_sub_f32 v122,v26,v122
v_add_f32 v26,v236,v238
M v[152:155],v[224:227],a[216:219],v[152:155]
s_waitcnt lgkmcnt(0)
v_fmac_f32 v236,4.0,v238
v_fma_f32 v238,2.0,v122,v240
v_fma_f32 v122,s41,v122,v240
v_accvgpr_read_b32 v240,a27
M v[156:159],v[224:227],a[220:223],v[156:159]
s_waitcnt vmcnt(9)
buffer_load_dwordx4 v[224:227],v253,s[20:23],s46 offen offset:0
v_accvgpr_read_b32 v239,a123
v_add_f32 v237,v240,v239
v_sub_f32 v240,v240,v239
v_add_f32 v239,v27,v123
M v[160:163],a[224:227],a[192:195],v[160:163]
ds_read_b128 a[192:195],v251 offset:52224
v_sub_f32 v123,v27,v123
v_add_f32 v27,v237,v239
v_fmac_f32 v237,4.0,v239
v_fma_f32 v239,2.0,v123,v240
M v[164:167],a[224:227],a[196:199],v[164:167]
ds_read_b128 a[196:199],v252 offset:52480
v_fma_f32 v123,s41,v123,v240
v_cvt_pk_bf16_f32 v238,v238,v239
v_accvgpr_write_b32 a25,v238
v_cvt_pk_bf16_f32 v236,v236,v237
M v[168:171],a[224:227],a[200:203],v[168:171]
ds_read_b128 a[200:203],v252 offset:52736
v_accvgpr_write_b32 a121,v236
v_accvgpr_read_b32 v240,a28
v_accvgpr_read_b32 v238,a124
v_add_f32 v236,v240,v238
M v[172:175],a[224:227],a[204:207],v[172:175]
ds_read_b128 a[204:207],v252 offset:52992
v_sub_f32 v240,v240,v238
v_add_f32 v238,v28,v124
v_sub_f32 v124,v28,v124
v_add_f32 v28,v236,v238
M v[176:179],a[224:227],a[208:211],v[176:179]
ds_read_b128 a[208:211],v252 offset:53248
v_fmac_f32 v236,4.0,v238
v_fma_f32 v238,2.0,v124,v240
v_fma_f32 v124,s41,v124,v240
v_accvgpr_read_b32 v240,a29
M v[180:183],a[224:227],a[212:215],v[180:183]
ds_read_b128 a[212:215],v252 offset:53504
v_accvgpr_read_b32 v239,a125
v_add_f32 v237,v240,v239
v_sub_f32 v240,v240,v239
v_add_f32 v239,v29,v125
M v[184:187],a[224:227],a[216:219],v[184:187]
ds_read_b128 a[216:219],v252 offset:53760
v_sub_f32 v125,v29,v125
v_add_f32 v29,v237,v239
v_fmac_f32 v237,4.0,v239
v_fma_f32 v239,2.0,v125,v240
M v[188:191],a[224:227],a[220:223],v[188:191]
s_waitcnt vmcnt(9) lgkmcnt(6)
buffer_load_dwordx4 a[224:227],v253,s[20:23],s46 offen offset:1024
v_fma_f32 v125,s41,v125,v240
v_cvt_pk_bf16_f32 v238,v238,v239
v_accvgpr_write_b32 a28,v238
v_cvt_pk_bf16_f32 v236,v236,v237
M v[0:3],a[228:231],a[192:195],v[0:3]
s_waitcnt lgkmcnt(5)
ds_read_b128 a[220:223],v252 offset:54016
ds_read_b128 a[192:195],v252 offset:54272
v_accvgpr_write_b32 a124,v236
v_accvgpr_read_b32 v240,a30
v_accvgpr_read_b32 v238,a126
v_add_f32 v236,v240,v238
M v[4:7],a[228:231],a[196:199],v[4:7]
s_waitcnt lgkmcnt(6)
v_sub_f32 v240,v240,v238
v_add_f32 v238,v30,v126
v_sub_f32 v126,v30,v126
v_add_f32 v30,v236,v238
M v[8:11],a[228:231],a[200:203],v[8:11]
s_waitcnt lgkmcnt(5)
v_fmac_f32 v236,4.0,v238
v_fma_f32 v238,2.0,v126,v240
v_fma_f32 v126,s41,v126,v240
v_accvgpr_read_b32 v240,a31
M v[12:15],a[228:231],a[204:207],v[12:15]
s_waitcnt lgkmcnt(4)
v_accvgpr_read_b32 v239,a127
v_add_f32 v237,v240,v239
v_sub_f32 v240,v240,v239
v_add_f32 v239,v31,v127
M v[16:19],a[228:231],a[208:211],v[16:19]
s_waitcnt lgkmcnt(3)
v_sub_f32 v127,v31,v127
v_add_f32 v31,v237,v239
M v[20:23],a[228:231],a[212:215],v[20:23]
s_waitcnt lgkmcnt(2)
v_fmac_f32 v237,4.0,v239
v_fma_f32 v239,2.0,v127,v240
M v[24:27],a[228:231],a[216:219],v[24:27]
s_waitcnt lgkmcnt(1)
v_fma_f32 v127,s41,v127,v240
v_cvt_pk_bf16_f32 v238,v238,v239
M v[28:31],a[228:231],a[220:223],v[28:31]
s_waitcnt vmcnt(9)
buffer_load_dwordx4 a[228:231],v253,s[20:23],s46 offen offset:2048
M v[0:3],a[232:235],a[196:199],v[0:3]
ds_read_b128 a[196:199],v251 offset:54528
v_accvgpr_write_b32 a29,v238
M v[4:7],a[232:235],a[200:203],v[4:7]
s_add_u32 s46,s44,221184
v_cvt_pk_bf16_f32 v236,v236,v237
v_accvgpr_write_b32 a125,v236
M v[8:11],a[232:235],a[204:207],v[8:11]
v_accvgpr_read_b32 v240,a32
v_accvgpr_read_b32 v238,a128
M v[12:15],a[232:235],a[208:211],v[12:15]
v_add_f32 v236,v240,v238
v_sub_f32 v240,v240,v238
M v[16:19],a[232:235],a[212:215],v[16:19]
v_add_f32 v238,v32,v128
v_sub_f32 v128,v32,v128
M v[20:23],a[232:235],a[216:219],v[20:23]
v_add_u32 v251,0x15400,v251
v_add_u32 v252,0x15400,v252
M v[24:27],a[232:235],a[220:223],v[24:27]
s_waitcnt lgkmcnt(1)
v_add_f32 v32,v236,v238
v_fmac_f32 v236,4.0,v238
M v[28:31],a[232:235],a[192:195],v[28:31]
s_waitcnt vmcnt(9)
buffer_load_dwordx4 a[232:235],v253,s[20:23],s46 offen offset:0
M v[0:3],a[236:239],a[200:203],v[0:3]
ds_read_b128 a[200:203],v251 offset:0
v_fma_f32 v238,2.0,v128,v240
M v[4:7],a[236:239],a[204:207],v[4:7]
ds_read_b128 a[204:207],v252 offset:256
v_fma_f32 v128,s41,v128,v240
M v[8:11],a[236:239],a[208:211],v[8:11]
ds_read_b128 a[208:211],v252 offset:512
v_accvgpr_read_b32 v240,a33
M v[12:15],a[236:239],a[212:215],v[12:15]
ds_read_b128 a[212:215],v252 offset:768
v_accvgpr_read_b32 v239,a129
M v[16:19],a[236:239],a[216:219],v[16:19]
ds_read_b128 a[216:219],v252 offset:1024
v_add_f32 v237,v240,v239
M v[20:23],a[236:239],a[220:223],v[20:23]
ds_read_b128 a[220:223],v252 offset:1280
v_sub_f32 v240,v240,v239
M v[24:27],a[236:239],a[192:195],v[24:27]
s_waitcnt lgkmcnt(6)
ds_read_b128 a[192:195],v252 offset:1536
v_add_f32 v239,v33,v129
M v[28:31],a[236:239],a[196:199],v[28:31]
s_waitcnt vmcnt(9) lgkmcnt(6)
buffer_load_dwordx4 a[236:239],v253,s[20:23],s46 offen offset:1024
M v[0:3],a[240:243],a[200:203],v[0:3]
s_waitcnt lgkmcnt(5)
ds_read_b128 a[196:199],v252 offset:1792
ds_read_b128 a[200:203],v252 offset:2048
M v[4:7],a[240:243],a[204:207],v[4:7]
s_waitcnt lgkmcnt(6)
v_sub_f32 v129,v33,v129
v_add_f32 v33,v237,v239
M v[8:11],a[240:243],a[208:211],v[8:11]
s_waitcnt lgkmcnt(5)
v_fmac_f32 v237,4.0,v239
v_fma_f32 v239,2.0,v129,v240
M v[12:15],a[240:243],a[212:215],v[12:15]
s_waitcnt lgkmcnt(4)
v_fma_f32 v129,s41,v129,v240
v_cvt_pk_bf16_f32 v238,v238,v239
M v[16:19],a[240:243],a[216:219],v[16:19]
s_waitcnt lgkmcnt(3)
v_accvgpr_write_b32 a2,v238
v_cvt_pk_bf16_f32 v236,v236,v237
M v[20:23],a[240:243],a[220:223],v[20:23]
s_waitcnt lgkmcnt(2)
v_accvgpr_write_b32 a98,v236
v_accvgpr_read_b32 v240,a34
M v[24:27],a[240:243],a[192:195],v[24:27]
s_waitcnt lgkmcnt(1)
v_accvgpr_read_b32 v238,a130
v_add_f32 v236,v240,v238
M v[28:31],a[240:243],a[196:199],v[28:31]
s_waitcnt vmcnt(9)
buffer_load_dwordx4 a[240:243],v253,s[20:23],s46 offen offset:2048
M v[0:3],a[244:247],a[204:207],v[0:3]
ds_read_b128 a[204:207],v251 offset:2304
v_sub_f32 v240,v240,v238
M v[4:7],a[244:247],a[208:211],v[4:7]
s_add_u32 s46,s44,276480
v_add_f32 v238,v34,v130
v_sub_f32 v130,v34,v130
M v[8:11],a[244:247],a[212:215],v[8:11]
v_add_f32 v34,v236,v238
v_fmac_f32 v236,4.0,v238
M v[12:15],a[244:247],a[216:219],v[12:15]
v_fma_f32 v238,2.0,v130,v240
v_fma_f32 v130,s41,v130,v240
M v[16:19],a[244:247],a[220:223],v[16:19]
v_accvgpr_read_b32 v240,a35
v_accvgpr_read_b32 v239,a131
M v[20:23],a[244:247],a[192:195],v[20:23]
v_add_f32 v237,v240,v239
v_sub_f32 v240,v240,v239
M v[24:27],a[244:247],a[196:199],v[24:27]
s_waitcnt lgkmcnt(1)
v_add_f32 v239,v35,v131
v_sub_f32 v131,v35,v131
M v[28:31],a[244:247],a[200:203],v[28:31]
s_waitcnt vmcnt(9)
buffer_load_dwordx4 a[244:247],v253,s[20:23],s46 offen offset:0
M v[0:3],a[248:251],a[208:211],v[0:3]
ds_read_b128 a[208:211],v251 offset:17408
v_add_f32 v35,v237,v239
M v[4:7],a[248:251],a[212:215],v[4:7]
ds_read_b128 a[212:215],v252 offset:17664
v_fmac_f32 v237,4.0,v239
M v[8:11],a[248:251],a[216:219],v[8:11]
ds_read_b128 a[216:219],v252 offset:17920
v_fma_f32 v239,2.0,v131,v240
M v[12:15],a[248:251],a[220:223],v[12:15]
ds_read_b128 a[220:223],v252 offset:18176
v_fma_f32 v131,s41,v131,v240
M v[16:19],a[248:251],a[192:195],v[16:19]
ds_read_b128 a[192:195],v252 offset:18432
v_cvt_pk_bf16_f32 v238,v238,v239
M v[20:23],a[248:251],a[196:199],v[20:23]
ds_read_b128 a[196:199],v252 offset:18688
v_accvgpr_write_b32 a3,v238
M v[24:27],a[248:251],a[200:203],v[24:27]
s_waitcnt lgkmcnt(6)
ds_read_b128 a[200:203],v252 offset:18944
v_cvt_pk_bf16_f32 v236,v236,v237
M v[28:31],a[248:251],a[204:207],v[28:31]
s_waitcnt vmcnt(9) lgkmcnt(6)
buffer_load_dwordx4 a[248:251],v253,s[20:23],s46 offen offset:1024
M v[0:3],a[252:255],a[208:211],v[0:3]
s_waitcnt lgkmcnt(5)
ds_read_b128 a[204:207],v252 offset:19200
ds_read_b128 a[208:211],v252 offset:19456
M v[4:7],a[252:255],a[212:215],v[4:7]
s_waitcnt lgkmcnt(6)
v_accvgpr_write_b32 a99,v236
v_accvgpr_read_b32 v240,a36
M v[8:11],a[252:255],a[216:219],v[8:11]
s_waitcnt lgkmcnt(5)
v_accvgpr_read_b32 v238,a132
v_add_f32 v236,v240,v238
M v[12:15],a[252:255],a[220:223],v[12:15]
s_waitcnt lgkmcnt(4)
v_sub_f32 v240,v240,v238
v_add_f32 v238,v36,v132
M v[16:19],a[252:255],a[192:195],v[16:19]
s_waitcnt lgkmcnt(3)
v_sub_f32 v132,v36,v132
v_add_f32 v36,v236,v238
M v[20:23],a[252:255],a[196:199],v[20:23]
s_waitcnt lgkmcnt(2)
v_fmac_f32 v236,4.0,v238
v_fma_f32 v238,2.0,v132,v240
M v[24:27],a[252:255],a[200:203],v[24:27]
s_waitcnt lgkmcnt(1)
v_fma_f32 v132,s41,v132,v240
v_accvgpr_read_b32 v240,a37
M v[28:31],a[252:255],a[204:207],v[28:31]
s_waitcnt vmcnt(9)
buffer_load_dwordx4 a[252:255],v253,s[20:23],s46 offen offset:2048
M v[0:3],v[216:219],a[212:215],v[0:3]
ds_read_b128 a[212:215],v251 offset:19712
v_accvgpr_read_b32 v239,a133
M v[4:7],v[216:219],a[216:219],v[4:7]
s_add_u32 s46,s44,46080
v_add_f32 v237,v240,v239
v_sub_f32 v240,v240,v239
M v[8:11],v[216:219],a[220:223],v[8:11]
v_add_f32 v239,v37,v133
v_sub_f32 v133,v37,v133
M v[12:15],v[216:219],a[192:195],v[12:15]
v_add_f32 v37,v237,v239
v_fmac_f32 v237,4.0,v239
M v[16:19],v[216:219],a[196:199],v[16:19]
buffer_store_dwordx4 a[0:3],v254,s[24:27],s32 offen offset:384
M v[20:23],v[216:219],a[200:203],v[20:23]
v_fma_f32 v239,2.0,v133,v240
v_fma_f32 v133,s41,v133,v240
M v[24:27],v[216:219],a[204:207],v[24:27]
s_waitcnt lgkmcnt(1)
v_cvt_pk_bf16_f32 v238,v238,v239
v_accvgpr_write_b32 a6,v238
M v[28:31],v[216:219],a[208:211],v[28:31]
s_waitcnt vmcnt(10)
buffer_load_dwordx4 v[216:219],v253,s[20:23],s46 offen offset:0
M v[0:3],v[220:223],a[216:219],v[0:3]
ds_read_b128 a[216:219],v251 offset:34816
v_cvt_pk_bf16_f32 v236,v236,v237
M v[4:7],v[220:223],a[220:223],v[4:7]
ds_read_b128 a[220:223],v252 offset:35072
v_accvgpr_write_b32 a102,v236
M v[8:11],v[220:223],a[192:195],v[8:11]
ds_read_b128 a[192:195],v252 offset:35328
v_accvgpr_read_b32 v240,a38
M v[12:15],v[220:223],a[196:199],v[12:15]
ds_read_b128 a[196:199],v252 offset:35584
v_accvgpr_read_b32 v238,a134
M v[16:19],v[220:223],a[200:203],v[16:19]
ds_read_b128 a[200:203],v252 offset:35840
v_add_f32 v236,v240,v238
M v[20:23],v[220:223],a[204:207],v[20:23]
ds_read_b128 a[204:207],v252 offset:36096
v_sub_f32 v240,v240,v238
M v[24:27],v[220:223],a[208:211],v[24:27]
s_waitcnt lgkmcnt(6)
ds_read_b128 a[208:211],v252 offset:36352
v_add_f32 v238,v38,v134
M v[28:31],v[220:223],a[212:215],v[28:31]
s_waitcnt vmcnt(10) lgkmcnt(6)
buffer_load_dwordx4 v[220:223],v253,s[20:23],s46 offen offset:1024
M v[0:3],v[224:227],a[216:219],v[0:3]
s_waitcnt lgkmcnt(5)
ds_read_b128 a[212:215],v252 offset:36608
ds_read_b128 a[216:219],v252 offset:36864
M v[4:7],v[224:227],a[220:223],v[4:7]
s_waitcnt lgkmcnt(6)
v_sub_f32 v134,v38,v134
v_add_f32 v38,v236,v238
M v[8:11],v[224:227],a[192:195],v[8:11]
s_waitcnt lgkmcnt(5)
v_fmac_f32 v236,4.0,v238
v_fma_f32 v238,2.0,v134,v240
M v[12:15],v[224:227],a[196:199],v[12:15]
s_waitcnt lgkmcnt(4)
v_fma_f32 v134,s41,v134,v240
v_accvgpr_read_b32 v240,a39
M v[16:19],v[224:227],a[200:203],v[16:19]
s_waitcnt lgkmcnt(3)
v_accvgpr_read_b32 v239,a135
v_add_f32 v237,v240,v239
M v[20:23],v[224:227],a[204:207],v[20:23]
s_waitcnt lgkmcnt(2)
buffer_store_dwordx4 a[96:99],v254,s[24:27],s32 offen offset:768
M v[24:27],v[224:227],a[208:211],v[24:27]
s_waitcnt lgkmcnt(1)
v_sub_f32 v240,v240,v239
v_add_f32 v239,v39,v135
M v[28:31],v[224:227],a[212:215],v[28:31]
s_waitcnt vmcnt(11)
buffer_load_dwordx4 v[224:227],v253,s[20:23],s46 offen offset:2048
M v[0:3],a[224:227],a[220:223],v[0:3]
ds_read_b128 a[220:223],v251 offset:37120
v_sub_f32 v135,v39,v135
M v[4:7],a[224:227],a[192:195],v[4:7]
s_add_u32 s46,s44,101376
v_add_f32 v39,v237,v239
v_fmac_f32 v237,4.0,v239
M v[8:11],a[224:227],a[196:199],v[8:11]
v_fma_f32 v239,2.0,v135,v240
v_fma_f32 v135,s41,v135,v240
M v[12:15],a[224:227],a[200:203],v[12:15]
v_cvt_pk_bf16_f32 v238,v238,v239
v_accvgpr_write_b32 a7,v238
M v[16:19],a[224:227],a[204:207],v[16:19]
v_cvt_pk_bf16_f32 v236,v236,v237
v_accvgpr_write_b32 a103,v236
M v[20:23],a[224:227],a[208:211],v[20:23]
v_accvgpr_read_b32 v240,a40
v_accvgpr_read_b32 v238,a136
M v[24:27],a[224:227],a[212:215],v[24:27]
s_waitcnt lgkmcnt(1)
v_add_f32 v236,v240,v238
v_sub_f32 v240,v240,v238
M v[28:31],a[224:227],a[216:219],v[28:31]
s_waitcnt vmcnt(11)
buffer_load_dwordx4 a[224:227],v253,s[20:23],s46 offen offset:0
M v[0:3],a[228:231],a[192:195],v[0:3]
ds_read_b128 a[192:195],v251 offset:52224
v_add_f32 v238,v40,v136
M v[4:7],a[228:231],a[196:199],v[4:7]
ds_read_b128 a[196:199],v252 offset:52480
v_sub_f32 v136,v40,v136
M v[8:11],a[228:231],a[200:203],v[8:11]
ds_read_b128 a[200:203],v252 offset:52736
v_add_f32 v40,v236,v238
M v[12:15],a[228:231],a[204:207],v[12:15]
ds_read_b128 a[204:207],v252 offset:52992
v_fmac_f32 v236,4.0,v238
M v[16:19],a[228:231],a[208:211],v[16:19]
ds_read_b128 a[208:211],v252 offset:53248
v_fma_f32 v238,2.0,v136,v240
M v[20:23],a[228:231],a[212:215],v[20:23]
ds_read_b128 a[212:215],v252 offset:53504
v_fma_f32 v136,s41,v136,v240
M v[24:27],a[228:231],a[216:219],v[24:27]
s_waitcnt lgkmcnt(6)
buffer_store_dwordx4 a[4:7],v254,s[24:27],s33 offen offset:384
M v[28:31],a[228:231],a[220:223],v[28:31]
s_waitcnt vmcnt(12) lgkmcnt(5)
buffer_load_dwordx4 a[228:231],v253,s[20:23],s46 offen offset:1024
M v[0:3],a[232:235],a[192:195],v[0:3]
s_waitcnt lgkmcnt(4)
ds_read_b128 a[216:219],v252 offset:53760
ds_read_b128 a[220:223],v252 offset:54016
M v[4:7],a[232:235],a[196:199],v[4:7]
s_waitcnt lgkmcnt(5)
ds_read_b128 a[192:195],v252 offset:54272
v_accvgpr_read_b32 v240,a41
M v[8:11],a[232:235],a[200:203],v[8:11]
s_waitcnt lgkmcnt(5)
v_accvgpr_read_b32 v239,a137
v_add_f32 v237,v240,v239
M v[12:15],a[232:235],a[204:207],v[12:15]
s_waitcnt lgkmcnt(4)
v_sub_f32 v240,v240,v239
v_add_f32 v239,v41,v137
M v[16:19],a[232:235],a[208:211],v[16:19]
s_waitcnt lgkmcnt(3)
v_sub_f32 v137,v41,v137
v_add_f32 v41,v237,v239
M v[20:23],a[232:235],a[212:215],v[20:23]
s_waitcnt lgkmcnt(2)
v_fmac_f32 v237,4.0,v239
v_fma_f32 v239,2.0,v137,v240
M v[24:27],a[232:235],a[216:219],v[24:27]
s_waitcnt lgkmcnt(1)
v_fma_f32 v137,s41,v137,v240
v_cvt_pk_bf16_f32 v238,v238,v239
M v[28:31],a[232:235],a[220:223],v[28:31]
s_waitcnt vmcnt(12)
buffer_load_dwordx4 a[232:235],v253,s[20:23],s46 offen offset:2048
M v[0:3],a[236:239],a[196:199],v[0:3]
ds_read_b128 a[196:199],v251 offset:54528
v_accvgpr_write_b32 a10,v238
M v[4:7],a[236:239],a[200:203],v[4:7]
s_add_u32 s46,s44,156672
v_cvt_pk_bf16_f32 v236,v236,v237
v_accvgpr_write_b32 a106,v236
M v[8:11],a[236:239],a[204:207],v[8:11]
v_accvgpr_read_b32 v240,a42
v_accvgpr_read_b32 v238,a138
M v[12:15],a[236:239],a[208:211],v[12:15]
v_add_f32 v236,v240,v238
v_sub_f32 v240,v240,v238
M v[16:19],a[236:239],a[212:215],v[16:19]
v_add_f32 v238,v42,v138
v_sub_f32 v138,v42,v138
M v[20:23],a[236:239],a[216:219],v[20:23]
v_add_u32 v251,0xffff9a00,v251
v_add_u32 v252,0xffff9a00,v252
M v[24:27],a[236:239],a[220:223],v[24:27]
s_waitcnt lgkmcnt(1)
v_add_f32 v42,v236,v238
v_fmac_f32 v236,4.0,v238
M v[28:31],a[236:239],a[192:195],v[28:31]
s_waitcnt vmcnt(12)
buffer_load_dwordx4 a[236:239],v253,s[20:23],s46 offen offset:0
M v[0:3],a[240:243],a[200:203],v[0:3]
buffer_store_dwordx4 a[100:103],v254,s[24:27],s33 offen offset:768
M v[4:7],a[240:243],a[204:207],v[4:7]
ds_read_b128 a[200:203],v251 offset:8704
ds_read_b128 a[204:207],v252 offset:8960
M v[8:11],a[240:243],a[208:211],v[8:11]
ds_read_b128 a[208:211],v252 offset:9216
v_fma_f32 v238,2.0,v138,v240
M v[12:15],a[240:243],a[212:215],v[12:15]
ds_read_b128 a[212:215],v252 offset:9472
v_fma_f32 v138,s41,v138,v240
M v[16:19],a[240:243],a[216:219],v[16:19]
ds_read_b128 a[216:219],v252 offset:9728
v_accvgpr_read_b32 v240,a43
M v[20:23],a[240:243],a[220:223],v[20:23]
ds_read_b128 a[220:223],v252 offset:9984
v_accvgpr_read_b32 v239,a139
M v[24:27],a[240:243],a[192:195],v[24:27]
s_waitcnt lgkmcnt(6)
ds_read_b128 a[192:195],v252 offset:10240
v_add_f32 v237,v240,v239
M v[28:31],a[240:243],a[196:199],v[28:31]
s_waitcnt vmcnt(13) lgkmcnt(6)
buffer_load_dwordx4 a[240:243],v253,s[20:23],s46 offen offset:1024
M v[0:3],a[244:247],a[200:203],v[0:3]
s_waitcnt lgkmcnt(5)
ds_read_b128 a[196:199],v252 offset:10496
ds_read_b128 a[200:203],v252 offset:10752
M v[4:7],a[244:247],a[204:207],v[4:7]
s_waitcnt lgkmcnt(6)
v_sub_f32 v240,v240,v239
v_add_f32 v239,v43,v139
M v[8:11],a[244:247],a[208:211],v[8:11]
s_waitcnt lgkmcnt(5)
v_sub_f32 v139,v43,v139
v_add_f32 v43,v237,v239
M v[12:15],a[244:247],a[212:215],v[12:15]
s_waitcnt lgkmcnt(4)
v_fmac_f32 v237,4.0,v239
v_fma_f32 v239,2.0,v139,v240
M v[16:19],a[244:247],a[216:219],v[16:19]
s_waitcnt lgkmcnt(3)
v_fma_f32 v139,s41,v139,v240
v_cvt_pk_bf16_f32 v238,v238,v239
M v[20:23],a[244:247],a[220:223],v[20:23]
s_waitcnt lgkmcnt(2)
v_accvgpr_write_b32 a11,v238
v_cvt_pk_bf16_f32 v236,v236,v237
M v[24:27],a[244:247],a[192:195],v[24:27]
s_waitcnt lgkmcnt(1)
v_accvgpr_write_b32 a107,v236
v_accvgpr_read_b32 v240,a44
M v[28:31],a[244:247],a[196:199],v[28:31]
s_waitcnt vmcnt(13)
buffer_load_dwordx4 a[244:247],v253,s[20:23],s46 offen offset:2048
M v[0:3],a[248:251],a[204:207],v[0:3]
buffer_store_dwordx4 a[8:11],v254,s[24:27],s34 offen offset:384
M v[4:7],a[248:251],a[208:211],v[4:7]
s_add_u32 s46,s44,211968
ds_read_b128 a[204:207],v251 offset:11008
v_accvgpr_read_b32 v238,a140
M v[8:11],a[248:251],a[212:215],v[8:11]
v_add_f32 v236,v240,v238
v_sub_f32 v240,v240,v238
M v[12:15],a[248:251],a[216:219],v[12:15]
v_add_f32 v238,v44,v140
v_sub_f32 v140,v44,v140
M v[16:19],a[248:251],a[220:223],v[16:19]
v_add_f32 v44,v236,v238
v_fmac_f32 v236,4.0,v238
M v[20:23],a[248:251],a[192:195],v[20:23]
v_fma_f32 v238,2.0,v140,v240
v_fma_f32 v140,s41,v140,v240
M v[24:27],a[248:251],a[196:199],v[24:27]
s_waitcnt lgkmcnt(1)
v_accvgpr_read_b32 v240,a45
v_accvgpr_read_b32 v239,a141
M v[28:31],a[248:251],a[200:203],v[28:31]
s_waitcnt vmcnt(14)
buffer_load_dwordx4 a[248:251],v253,s[20:23],s46 offen offset:0
M v[0:3],a[252:255],a[208:211],v[0:3]
ds_read_b128 a[208:211],v251 offset:0
v_add_f32 v237,v240,v239
M v[4:7],a[252:255],a[212:215],v[4:7]
ds_read_b128 a[212:215],v252 offset:256
v_sub_f32 v240,v240,v239
M v[8:11],a[252:255],a[216:219],v[8:11]
ds_read_b128 a[216:219],v252 offset:512
v_add_f32 v239,v45,v141
M v[12:15],a[252:255],a[220:223],v[12:15]
ds_read_b128 a[220:223],v252 offset:768
v_cvt_pk_bf16_f32 v0,v0,v1
M v[16:19],a[252:255],a[192:195],v[16:19]
ds_read_b128 a[192:195],v252 offset:1024
v_cvt_pk_bf16_f32 v1,v2,v3
M v[20:23],a[252:255],a[196:199],v[20:23]
ds_read_b128 a[196:199],v252 offset:1280
v_cvt_pk_bf16_f32 v4,v4,v5
M v[24:27],a[252:255],a[200:203],v[24:27]
s_waitcnt lgkmcnt(6)
ds_read_b128 a[200:203],v252 offset:1536
v_cvt_pk_bf16_f32 v5,v6,v7
M v[28:31],a[252:255],a[204:207],v[28:31]
s_waitcnt vmcnt(13) lgkmcnt(6)
buffer_load_dwordx4 a[252:255],v253,s[20:23],s46 offen offset:1024
M v[96:99],v[216:219],a[208:211],v[96:99]
s_waitcnt lgkmcnt(5)
ds_read_b128 a[204:207],v252 offset:1792
ds_read_b128 a[208:211],v252 offset:2048
M v[100:103],v[216:219],a[212:215],v[100:103]
s_waitcnt lgkmcnt(6)
buffer_store_dwordx4 a[104:107],v254,s[24:27],s34 offen offset:768
M v[104:107],v[216:219],a[216:219],v[104:107]
s_waitcnt lgkmcnt(5)
v_cvt_pk_bf16_f32 v8,v8,v9
v_cvt_pk_bf16_f32 v9,v10,v11
M v[108:111],v[216:219],a[220:223],v[108:111]
s_waitcnt lgkmcnt(4)
v_cvt_pk_bf16_f32 v12,v12,v13
v_cvt_pk_bf16_f32 v13,v14,v15
M v[112:115],v[216:219],a[192:195],v[112:115]
s_waitcnt lgkmcnt(3)
v_cvt_pk_bf16_f32 v16,v16,v17
v_cvt_pk_bf16_f32 v17,v18,v19
M v[116:119],v[216:219],a[196:199],v[116:119]
s_waitcnt lgkmcnt(2)
v_cvt_pk_bf16_f32 v20,v20,v21
v_cvt_pk_bf16_f32 v21,v22,v23
M v[120:123],v[216:219],a[200:203],v[120:123]
s_waitcnt lgkmcnt(1)
v_cvt_pk_bf16_f32 v24,v24,v25
v_cvt_pk_bf16_f32 v25,v26,v27
M v[124:127],v[216:219],a[204:207],v[124:127]
s_waitcnt vmcnt(14)
buffer_load_dwordx4 v[216:219],v253,s[20:23],s46 offen offset:2048
M v[96:99],v[220:223],a[212:215],v[96:99]
ds_read_b128 a[212:215],v251 offset:2304
v_cvt_pk_bf16_f32 v28,v28,v29
M v[100:103],v[220:223],a[216:219],v[100:103]
s_add_u32 s46,s44,267264
v_cvt_pk_bf16_f32 v29,v30,v31
v_sub_f32 v141,v45,v141
M v[104:107],v[220:223],a[220:223],v[104:107]
v_add_f32 v45,v237,v239
v_fmac_f32 v237,4.0,v239
M v[108:111],v[220:223],a[192:195],v[108:111]
v_fma_f32 v239,2.0,v141,v240
v_fma_f32 v141,s41,v141,v240
M v[112:115],v[220:223],a[196:199],v[112:115]
v_cvt_pk_bf16_f32 v238,v238,v239
v_accvgpr_write_b32 a14,v238
M v[116:119],v[220:223],a[200:203],v[116:119]
v_cvt_pk_bf16_f32 v236,v236,v237
v_accvgpr_write_b32 a110,v236
M v[120:123],v[220:223],a[204:207],v[120:123]
s_waitcnt lgkmcnt(1)
v_accvgpr_read_b32 v240,a46
v_accvgpr_read_b32 v238,a142
M v[124:127],v[220:223],a[208:211],v[124:127]
s_waitcnt vmcnt(13)
buffer_load_dwordx4 v[220:223],v253,s[20:23],s46 offen offset:0
M v[96:99],v[224:227],a[216:219],v[96:99]
ds_read_b128 a[216:219],v251 offset:34816
v_add_f32 v236,v240,v238
M v[100:103],v[224:227],a[220:223],v[100:103]
ds_read_b128 a[220:223],v252 offset:35072
v_sub_f32 v240,v240,v238
M v[104:107],v[224:227],a[192:195],v[104:107]
ds_read_b128 a[192:195],v252 offset:35328
v_add_f32 v238,v46,v142
M v[108:111],v[224:227],a[196:199],v[108:111]
ds_read_b128 a[196:199],v252 offset:35584
v_sub_f32 v142,v46,v142
M v[112:115],v[224:227],a[200:203],v[112:115]
ds_read_b128 a[200:203],v252 offset:35840
v_add_f32 v46,v236,v238
M v[116:119],v[224:227],a[204:207],v[116:119]
ds_read_b128 a[204:207],v252 offset:36096
v_fmac_f32 v236,4.0,v238
M v[120:123],v[224:227],a[208:211],v[120:123]
s_waitcnt lgkmcnt(6)
ds_read_b128 a[208:211],v252 offset:36352
v_fma_f32 v238,2.0,v142,v240
M v[124:127],v[224:227],a[212:215],v[124:127]
s_waitcnt vmcnt(13) lgkmcnt(6)
buffer_load_dwordx4 v[224:227],v253,s[20:23],s46 offen offset:1024
M v[96:99],a[224:227],a[216:219],v[96:99]
s_waitcnt lgkmcnt(5)
ds_read_b128 a[212:215],v252 offset:36608
ds_read_b128 a[216:219],v252 offset:36864
M v[100:103],a[224:227],a[220:223],v[100:103]
s_waitcnt lgkmcnt(6)
v_fma_f32 v142,s41,v142,v240
v_accvgpr_read_b32 v240,a47
M v[104:107],a[224:227],a[192:195],v[104:107]
s_waitcnt lgkmcnt(5)
v_accvgpr_read_b32 v239,a143
v_add_f32 v237,v240,v239
M v[108:111],a[224:227],a[196:199],v[108:111]
s_waitcnt lgkmcnt(4)
v_sub_f32 v240,v240,v239
v_add_f32 v239,v47,v143
M v[112:115],a[224:227],a[200:203],v[112:115]
s_waitcnt lgkmcnt(3)
v_sub_f32 v143,v47,v143
v_add_f32 v47,v237,v239
M v[116:119],a[224:227],a[204:207],v[116:119]
s_waitcnt lgkmcnt(2)
v_fmac_f32 v237,4.0,v239
v_fma_f32 v239,2.0,v143,v240
M v[120:123],a[224:227],a[208:211],v[120:123]
s_waitcnt lgkmcnt(1)
v_fma_f32 v143,s41,v143,v240
v_cvt_pk_bf16_f32 v238,v238,v239
M v[124:127],a[224:227],a[212:215],v[124:127]
s_waitcnt vmcnt(12)
buffer_load_dwordx4 a[224:227],v253,s[20:23],s46 offen offset:2048
M v[96:99],a[228:231],a[220:223],v[96:99]
ds_read_b128 a[220:223],v251 offset:37120
v_accvgpr_write_b32 a15,v238
M v[100:103],a[228:231],a[192:195],v[100:103]
s_add_u32 s46,s44,322560
v_cvt_pk_bf16_f32 v236,v236,v237
v_accvgpr_write_b32 a111,v236
M v[104:107],a[228:231],a[196:199],v[104:107]
buffer_store_dwordx4 a[12:15],v254,s[24:27],s35 offen offset:384
M v[108:111],a[228:231],a[200:203],v[108:111]
buffer_store_dwordx4 a[108:111],v254,s[24:27],s35 offen offset:768
M v[112:115],a[228:231],a[204:207],v[112:115]
v_accvgpr_read_b32 v240,a48
v_accvgpr_read_b32 v238,a144
M v[116:119],a[228:231],a[208:211],v[116:119]
v_add_f32 v236,v240,v238
v_sub_f32 v240,v240,v238
M v[120:123],a[228:231],a[212:215],v[120:123]
s_waitcnt lgkmcnt(1)
v_add_f32 v238,v48,v144
v_sub_f32 v144,v48,v144
M v[124:127],a[228:231],a[216:219],v[124:127]
s_waitcnt vmcnt(14)
buffer_load_dwordx4 a[228:231],v253,s[20:23],s46 offen offset:0
M v[96:99],a[232:235],a[192:195],v[96:99]
ds_read_b128 a[192:195],v251 offset:52224
v_add_f32 v48,v236,v238
M v[100:103],a[232:235],a[196:199],v[100:103]
ds_read_b128 a[196:199],v252 offset:52480
v_fmac_f32 v236,4.0,v238
M v[104:107],a[232:235],a[200:203],v[104:107]
ds_read_b128 a[200:203],v252 offset:52736
v_fma_f32 v238,2.0,v144,v240
M v[108:111],a[232:235],a[204:207],v[108:111]
ds_read_b128 a[204:207],v252 offset:52992
v_fma_f32 v144,s41,v144,v240
M v[112:115],a[232:235],a[208:211],v[112:115]
ds_read_b128 a[208:211],v252 offset:53248
v_accvgpr_read_b32 v240,a49
M v[116:119],a[232:235],a[212:215],v[116:119]
ds_read_b128 a[212:215],v252 offset:53504
v_accvgpr_read_b32 v239,a145
M v[120:123],a[232:235],a[216:219],v[120:123]
s_waitcnt lgkmcnt(6)
ds_read_b128 a[216:219],v252 offset:53760
v_add_f32 v237,v240,v239
M v[124:127],a[232:235],a[220:223],v[124:127]
s_waitcnt vmcnt(14) lgkmcnt(6)
buffer_load_dwordx4 a[232:235],v253,s[20:23],s46 offen offset:1024
M v[96:99],a[236:239],a[192:195],v[96:99]
s_waitcnt lgkmcnt(5)
ds_read_b128 a[220:223],v252 offset:54016
ds_read_b128 a[192:195],v252 offset:54272
M v[100:103],a[236:239],a[196:199],v[100:103]
s_waitcnt lgkmcnt(6)
v_sub_f32 v240,v240,v239
v_add_f32 v239,v49,v145
M v[104:107],a[236:239],a[200:203],v[104:107]
s_waitcnt lgkmcnt(5)
v_sub_f32 v145,v49,v145
v_add_f32 v49,v237,v239
M v[108:111],a[236:239],a[204:207],v[108:111]
s_waitcnt lgkmcnt(4)
v_fmac_f32 v237,4.0,v239
v_fma_f32 v239,2.0,v145,v240
M v[112:115],a[236:239],a[208:211],v[112:115]
s_waitcnt lgkmcnt(3)
v_fma_f32 v145,s41,v145,v240
v_cvt_pk_bf16_f32 v238,v238,v239
M v[116:119],a[236:239],a[212:215],v[116:119]
s_waitcnt lgkmcnt(2)
v_accvgpr_write_b32 a18,v238
v_cvt_pk_bf16_f32 v236,v236,v237
M v[120:123],a[236:239],a[216:219],v[120:123]
s_waitcnt lgkmcnt(1)
v_accvgpr_write_b32 a114,v236
v_accvgpr_read_b32 v240,a50
M v[124:127],a[236:239],a[220:223],v[124:127]
s_waitcnt vmcnt(13)
buffer_load_dwordx4 a[236:239],v253,s[20:23],s46 offen offset:2048
M v[96:99],a[240:243],a[196:199],v[96:99]
ds_read_b128 a[196:199],v251 offset:54528
v_accvgpr_read_b32 v238,a146
M v[100:103],a[240:243],a[200:203],v[100:103]
s_add_u32 s47,s44,3072
v_add_f32 v236,v240,v238
v_sub_f32 v240,v240,v238
M v[104:107],a[240:243],a[204:207],v[104:107]
v_add_f32 v238,v50,v146
v_sub_f32 v146,v50,v146
M v[108:111],a[240:243],a[208:211],v[108:111]
v_add_f32 v50,v236,v238
v_fmac_f32 v236,4.0,v238
M v[112:115],a[240:243],a[212:215],v[112:115]
v_fma_f32 v238,2.0,v146,v240
v_fma_f32 v146,s41,v146,v240
M v[116:119],a[240:243],a[216:219],v[116:119]
v_add_u32 v251,0x11000,v251
v_add_u32 v252,0x11000,v252
M v[120:123],a[240:243],a[220:223],v[120:123]
s_waitcnt lgkmcnt(1)
v_accvgpr_read_b32 v240,a51
v_accvgpr_read_b32 v239,a147
M v[124:127],a[240:243],a[192:195],v[124:127]
s_waitcnt vmcnt(13)
buffer_load_dwordx4 a[240:243],v253,s[20:23],s47 offen offset:0
M v[96:99],a[244:247],a[200:203],v[96:99]
ds_read_b128 a[200:203],v251 offset:0
v_add_f32 v237,v240,v239
M v[100:103],a[244:247],a[204:207],v[100:103]
ds_read_b128 a[204:207],v252 offset:256
v_sub_f32 v240,v240,v239
M v[104:107],a[244:247],a[208:211],v[104:107]
ds_read_b128 a[208:211],v252 offset:512
v_add_f32 v239,v51,v147
M v[108:111],a[244:247],a[212:215],v[108:111]
ds_read_b128 a[212:215],v252 offset:768
v_sub_f32 v147,v51,v147
M v[112:115],a[244:247],a[216:219],v[112:115]
ds_read_b128 a[216:219],v252 offset:1024
v_add_f32 v51,v237,v239
M v[116:119],a[244:247],a[220:223],v[116:119]
ds_read_b128 a[220:223],v252 offset:1280
v_fmac_f32 v237,4.0,v239
M v[120:123],a[244:247],a[192:195],v[120:123]
s_waitcnt lgkmcnt(6)
ds_read_b128 a[192:195],v252 offset:1536
v_fma_f32 v239,2.0,v147,v240
M v[124:127],a[244:247],a[196:199],v[124:127]
s_waitcnt vmcnt(12) lgkmcnt(6)
buffer_load_dwordx4 a[244:247],v253,s[20:23],s47 offen offset:1024
M v[96:99],a[248:251],a[200:203],v[96:99]
s_waitcnt lgkmcnt(5)
ds_read_b128 a[196:199],v252 offset:1792
ds_read_b128 a[200:203],v252 offset:2048
M v[100:103],a[248:251],a[204:207],v[100:103]
s_waitcnt lgkmcnt(6)
v_fma_f32 v147,s41,v147,v240
v_cvt_pk_bf16_f32 v238,v238,v239
M v[104:107],a[248:251],a[208:211],v[104:107]
s_waitcnt lgkmcnt(5)
v_accvgpr_write_b32 a19,v238
v_cvt_pk_bf16_f32 v236,v236,v237
M v[108:111],a[248:251],a[212:215],v[108:111]
s_waitcnt lgkmcnt(4)
v_accvgpr_write_b32 a115,v236
v_accvgpr_read_b32 v240,a52
M v[112:115],a[248:251],a[216:219],v[112:115]
s_waitcnt lgkmcnt(3)
buffer_store_dwordx4 a[16:19],v254,s[24:27],s36 offen offset:384
M v[116:119],a[248:251],a[220:223],v[116:119]
s_waitcnt lgkmcnt(2)
buffer_store_dwordx4 a[112:115],v254,s[24:27],s36 offen offset:768
M v[120:123],a[248:251],a[192:195],v[120:123]
s_waitcnt lgkmcnt(1)
v_accvgpr_read_b32 v238,a148
v_add_f32 v236,v240,v238
M v[124:127],a[248:251],a[196:199],v[124:127]
s_waitcnt vmcnt(14)
buffer_load_dwordx4 a[248:251],v253,s[20:23],s47 offen offset:2048
M v[96:99],a[252:255],a[204:207],v[96:99]
ds_read_b128 a[204:207],v251 offset:2304
v_sub_f32 v240,v240,v238
M v[100:103],a[252:255],a[208:211],v[100:103]
s_add_u32 s47,s44,58368
v_add_f32 v238,v52,v148
v_sub_f32 v148,v52,v148
M v[104:107],a[252:255],a[212:215],v[104:107]
v_add_f32 v52,v236,v238
v_fmac_f32 v236,4.0,v238
M v[108:111],a[252:255],a[216:219],v[108:111]
v_fma_f32 v238,2.0,v148,v240
v_fma_f32 v148,s41,v148,v240
M v[112:115],a[252:255],a[220:223],v[112:115]
v_accvgpr_read_b32 v240,a53
v_accvgpr_read_b32 v239,a149
M v[116:119],a[252:255],a[192:195],v[116:119]
v_add_f32 v237,v240,v239
v_sub_f32 v240,v240,v239
M v[120:123],a[252:255],a[196:199],v[120:123]
s_waitcnt lgkmcnt(1)
v_add_f32 v239,v53,v149
v_sub_f32 v149,v53,v149
M v[124:127],a[252:255],a[200:203],v[124:127]
s_waitcnt vmcnt(13)
buffer_load_dwordx4 a[252:255],v253,s[20:23],s47 offen offset:0
M v[96:99],v[216:219],a[208:211],v[96:99]
ds_read_b128 a[208:211],v251 offset:17408
v_add_f32 v53,v237,v239
M v[100:103],v[216:219],a[212:215],v[100:103]
ds_read_b128 a[212:215],v252 offset:17664
v_fmac_f32 v237,4.0,v239
M v[104:107],v[216:219],a[216:219],v[104:107]
ds_read_b128 a[216:219],v252 offset:17920
v_fma_f32 v239,2.0,v149,v240
M v[108:111],v[216:219],a[220:223],v[108:111]
ds_read_b128 a[220:223],v252 offset:18176
v_fma_f32 v149,s41,v149,v240
M v[112:115],v[216:219],a[192:195],v[112:115]
ds_read_b128 a[192:195],v252 offset:18432
v_cvt_pk_bf16_f32 v238,v238,v239
M v[116:119],v[216:219],a[196:199],v[116:119]
ds_read_b128 a[196:199],v252 offset:18688
v_accvgpr_write_b32 a22,v238
M v[120:123],v[216:219],a[200:203],v[120:123]
s_waitcnt lgkmcnt(6)
ds_read_b128 a[200:203],v252 offset:18944
v_cvt_pk_bf16_f32 v236,v236,v237
M v[124:127],v[216:219],a[204:207],v[124:127]
s_waitcnt vmcnt(13) lgkmcnt(6)
buffer_load_dwordx4 v[216:219],v253,s[20:23],s47 offen offset:1024
M v[96:99],v[220:223],a[208:211],v[96:99]
s_waitcnt lgkmcnt(5)
ds_read_b128 a[204:207],v252 offset:19200
ds_read_b128 a[208:211],v252 offset:19456
M v[100:103],v[220:223],a[212:215],v[100:103]
s_waitcnt lgkmcnt(6)
v_accvgpr_write_b32 a118,v236
v_accvgpr_read_b32 v240,a54
M v[104:107],v[220:223],a[216:219],v[104:107]
s_waitcnt lgkmcnt(5)
v_accvgpr_read_b32 v238,a150
v_add_f32 v236,v240,v238
M v[108:111],v[220:223],a[220:223],v[108:111]
s_waitcnt lgkmcnt(4)
v_sub_f32 v240,v240,v238
v_add_f32 v238,v54,v150
M v[112:115],v[220:223],a[192:195],v[112:115]
s_waitcnt lgkmcnt(3)
v_sub_f32 v150,v54,v150
v_add_f32 v54,v236,v238
M v[116:119],v[220:223],a[196:199],v[116:119]
s_waitcnt lgkmcnt(2)
v_fmac_f32 v236,4.0,v238
v_fma_f32 v238,2.0,v150,v240
M v[120:123],v[220:223],a[200:203],v[120:123]
s_waitcnt lgkmcnt(1)
v_fma_f32 v150,s41,v150,v240
v_accvgpr_read_b32 v240,a55
M v[124:127],v[220:223],a[204:207],v[124:127]
s_waitcnt vmcnt(13)
buffer_load_dwordx4 v[220:223],v253,s[20:23],s47 offen offset:2048
M v[96:99],v[224:227],a[212:215],v[96:99]
ds_read_b128 a[212:215],v251 offset:19712
v_accvgpr_read_b32 v239,a151
M v[100:103],v[224:227],a[216:219],v[100:103]
s_add_u32 s47,s44,113664
v_add_f32 v237,v240,v239
v_sub_f32 v240,v240,v239
M v[104:107],v[224:227],a[220:223],v[104:107]
v_add_f32 v239,v55,v151
v_sub_f32 v151,v55,v151
M v[108:111],v[224:227],a[192:195],v[108:111]
v_add_f32 v55,v237,v239
v_fmac_f32 v237,4.0,v239
M v[112:115],v[224:227],a[196:199],v[112:115]
v_fma_f32 v239,2.0,v151,v240
v_fma_f32 v151,s41,v151,v240
M v[116:119],v[224:227],a[200:203],v[116:119]
v_add_u32 v251,0xfffece00,v251
v_add_u32 v252,0xfffece00,v252
M v[120:123],v[224:227],a[204:207],v[120:123]
s_waitcnt lgkmcnt(1)
v_cvt_pk_bf16_f32 v238,v238,v239
v_accvgpr_write_b32 a23,v238
M v[124:127],v[224:227],a[208:211],v[124:127]
s_waitcnt vmcnt(13)
buffer_load_dwordx4 v[224:227],v253,s[20:23],s47 offen offset:0
M v[96:99],a[224:227],a[216:219],v[96:99]
ds_read_b128 a[216:219],v251 offset:26112
v_cvt_pk_bf16_f32 v236,v236,v237
M v[100:103],a[224:227],a[220:223],v[100:103]
ds_read_b128 a[220:223],v252 offset:26368
v_accvgpr_write_b32 a119,v236
M v[104:107],a[224:227],a[192:195],v[104:107]
buffer_store_dwordx4 a[20:23],v254,s[24:27],s37 offen offset:384
M v[108:111],a[224:227],a[196:199],v[108:111]
ds_read_b128 a[192:195],v252 offset:26624
ds_read_b128 a[196:199],v252 offset:26880
M v[112:115],a[224:227],a[200:203],v[112:115]
ds_read_b128 a[200:203],v252 offset:27136
v_accvgpr_read_b32 v240,a56
M v[116:119],a[224:227],a[204:207],v[116:119]
ds_read_b128 a[204:207],v252 offset:27392
v_accvgpr_read_b32 v238,a152
M v[120:123],a[224:227],a[208:211],v[120:123]
s_waitcnt lgkmcnt(6)
ds_read_b128 a[208:211],v252 offset:27648
v_add_f32 v236,v240,v238
M v[124:127],a[224:227],a[212:215],v[124:127]
s_waitcnt vmcnt(12) lgkmcnt(6)
buffer_load_dwordx4 a[224:227],v253,s[20:23],s47 offen offset:1024
M v[96:99],a[228:231],a[216:219],v[96:99]
s_waitcnt lgkmcnt(5)
ds_read_b128 a[212:215],v252 offset:27904
ds_read_b128 a[216:219],v252 offset:28160
M v[100:103],a[228:231],a[220:223],v[100:103]
s_waitcnt lgkmcnt(6)
v_sub_f32 v240,v240,v238
v_add_f32 v238,v56,v152
M v[104:107],a[228:231],a[192:195],v[104:107]
s_waitcnt lgkmcnt(5)
v_sub_f32 v152,v56,v152
v_add_f32 v56,v236,v238
M v[108:111],a[228:231],a[196:199],v[108:111]
s_waitcnt lgkmcnt(4)
v_fmac_f32 v236,4.0,v238
v_fma_f32 v238,2.0,v152,v240
M v[112:115],a[228:231],a[200:203],v[112:115]
s_waitcnt lgkmcnt(3)
v_fma_f32 v152,s41,v152,v240
v_accvgpr_read_b32 v240,a57
M v[116:119],a[228:231],a[204:207],v[116:119]
s_waitcnt lgkmcnt(2)
v_accvgpr_read_b32 v239,a153
v_add_f32 v237,v240,v239
M v[120:123],a[228:231],a[208:211],v[120:123]
s_waitcnt lgkmcnt(1)
v_sub_f32 v240,v240,v239
v_add_f32 v239,v57,v153
M v[124:127],a[228:231],a[212:215],v[124:127]
s_waitcnt vmcnt(12)
buffer_load_dwordx4 a[228:231],v253,s[20:23],s47 offen offset:2048
M v[96:99],a[232:235],a[220:223],v[96:99]
buffer_store_dwordx4 a[116:119],v254,s[24:27],s37 offen offset:768
M v[100:103],a[232:235],a[192:195],v[100:103]
s_add_u32 s47,s44,168960
ds_read_b128 a[220:223],v251 offset:28416
v_sub_f32 v153,v57,v153
M v[104:107],a[232:235],a[196:199],v[104:107]
v_add_f32 v57,v237,v239
v_fmac_f32 v237,4.0,v239
v_fma_f32 v239,2.0,v153,v240
M v[108:111],a[232:235],a[200:203],v[108:111]
v_fma_f32 v153,s41,v153,v240
v_cvt_pk_bf16_f32 v238,v238,v239
v_accvgpr_write_b32 a26,v238
v_cvt_pk_bf16_f32 v236,v236,v237
M v[112:115],a[232:235],a[204:207],v[112:115]
v_accvgpr_write_b32 a122,v236
v_accvgpr_read_b32 v240,a58
v_accvgpr_read_b32 v238,a154
v_add_f32 v236,v240,v238
M v[116:119],a[232:235],a[208:211],v[116:119]
v_sub_f32 v240,v240,v238
v_add_f32 v238,v58,v154
v_sub_f32 v154,v58,v154
v_add_f32 v58,v236,v238
M v[120:123],a[232:235],a[212:215],v[120:123]
s_waitcnt lgkmcnt(1)
v_fmac_f32 v236,4.0,v238
v_fma_f32 v238,2.0,v154,v240
v_fma_f32 v154,s41,v154,v240
v_accvgpr_read_b32 v240,a59
M v[124:127],a[232:235],a[216:219],v[124:127]
s_waitcnt vmcnt(13)
buffer_load_dwordx4 a[232:235],v253,s[20:23],s47 offen offset:0
v_accvgpr_read_b32 v239,a155
v_add_f32 v237,v240,v239
v_sub_f32 v240,v240,v239
v_add_f32 v239,v59,v155
M v[96:99],a[236:239],a[192:195],v[96:99]
ds_read_b128 a[192:195],v251 offset:0
v_sub_f32 v155,v59,v155
v_add_f32 v59,v237,v239
v_fmac_f32 v237,4.0,v239
v_fma_f32 v239,2.0,v155,v240
M v[100:103],a[236:239],a[196:199],v[100:103]
ds_read_b128 a[196:199],v252 offset:256
v_fma_f32 v155,s41,v155,v240
v_cvt_pk_bf16_f32 v238,v238,v239
v_accvgpr_write_b32 a27,v238
v_cvt_pk_bf16_f32 v236,v236,v237
M v[104:107],a[236:239],a[200:203],v[104:107]
ds_read_b128 a[200:203],v252 offset:512
v_accvgpr_write_b32 a123,v236
v_accvgpr_read_b32 v240,a60
v_accvgpr_read_b32 v238,a156
v_add_f32 v236,v240,v238
M v[108:111],a[236:239],a[204:207],v[108:111]
ds_read_b128 a[204:207],v252 offset:768
v_sub_f32 v240,v240,v238
v_add_f32 v238,v60,v156
v_sub_f32 v156,v60,v156
v_add_f32 v60,v236,v238
M v[112:115],a[236:239],a[208:211],v[112:115]
ds_read_b128 a[208:211],v252 offset:1024
v_fmac_f32 v236,4.0,v238
v_fma_f32 v238,2.0,v156,v240
v_fma_f32 v156,s41,v156,v240
v_accvgpr_read_b32 v240,a61
M v[116:119],a[236:239],a[212:215],v[116:119]
ds_read_b128 a[212:215],v252 offset:1280
v_accvgpr_read_b32 v239,a157
v_add_f32 v237,v240,v239
v_sub_f32 v240,v240,v239
v_add_f32 v239,v61,v157
M v[120:123],a[236:239],a[216:219],v[120:123]
s_waitcnt lgkmcnt(6)
ds_read_b128 a[216:219],v252 offset:1536
v_sub_f32 v157,v61,v157
v_add_f32 v61,v237,v239
v_fmac_f32 v237,4.0,v239
v_fma_f32 v239,2.0,v157,v240
M v[124:127],a[236:239],a[220:223],v[124:127]
s_waitcnt vmcnt(13) lgkmcnt(6)
buffer_load_dwordx4 a[236:239],v253,s[20:23],s47 offen offset:1024
v_fma_f32 v157,s41,v157,v240
v_cvt_pk_bf16_f32 v238,v238,v239
v_accvgpr_write_b32 a30,v238
v_cvt_pk_bf16_f32 v236,v236,v237
M v[32:35],a[240:243],a[192:195],v[32:35]
s_waitcnt lgkmcnt(5)
ds_read_b128 a[220:223],v252 offset:1792
ds_read_b128 a[192:195],v252 offset:2048
v_accvgpr_write_b32 a126,v236
v_accvgpr_read_b32 v240,a62
v_accvgpr_read_b32 v238,a158
v_add_f32 v236,v240,v238
M v[36:39],a[240:243],a[196:199],v[36:39]
s_waitcnt lgkmcnt(6)
v_sub_f32 v240,v240,v238
v_add_f32 v238,v62,v158
v_sub_f32 v158,v62,v158
v_add_f32 v62,v236,v238
M v[40:43],a[240:243],a[200:203],v[40:43]
s_waitcnt lgkmcnt(5)
v_fmac_f32 v236,4.0,v238
v_fma_f32 v238,2.0,v158,v240
v_fma_f32 v158,s41,v158,v240
v_accvgpr_read_b32 v240,a63
M v[44:47],a[240:243],a[204:207],v[44:47]
s_waitcnt lgkmcnt(4)
v_accvgpr_read_b32 v239,a159
v_add_f32 v237,v240,v239
v_sub_f32 v240,v240,v239
v_add_f32 v239,v63,v159
M v[48:51],a[240:243],a[208:211],v[48:51]
s_waitcnt lgkmcnt(3)
v_sub_f32 v159,v63,v159
v_cvt_pk_bf16_f32 v96,v96,v97
M v[52:55],a[240:243],a[212:215],v[52:55]
s_waitcnt lgkmcnt(2)
v_cvt_pk_bf16_f32 v97,v98,v99
v_add_f32 v63,v237,v239
M v[56:59],a[240:243],a[216:219],v[56:59]
s_waitcnt lgkmcnt(1)
v_cvt_pk_bf16_f32 v100,v100,v101
v_cvt_pk_bf16_f32 v101,v102,v103
M v[60:63],a[240:243],a[220:223],v[60:63]
s_waitcnt vmcnt(13)
buffer_load_dwordx4 a[240:243],v253,s[20:23],s47 offen offset:2048
M v[32:35],a[244:247],a[196:199],v[32:35]
ds_read_b128 a[196:199],v251 offset:2304
v_cvt_pk_bf16_f32 v104,v104,v105
M v[36:39],a[244:247],a[200:203],v[36:39]
s_add_u32 s47,s44,224256
v_cvt_pk_bf16_f32 v105,v106,v107
v_cvt_pk_bf16_f32 v108,v108,v109
M v[40:43],a[244:247],a[204:207],v[40:43]
buffer_store_dwordx4 a[24:27],v254,s[24:27],s38 offen offset:384
M v[44:47],a[244:247],a[208:211],v[44:47]
v_cvt_pk_bf16_f32 v109,v110,v111
v_cvt_pk_bf16_f32 v112,v112,v113
M v[48:51],a[244:247],a[212:215],v[48:51]
v_cvt_pk_bf16_f32 v113,v114,v115
v_cvt_pk_bf16_f32 v116,v116,v117
M v[52:55],a[244:247],a[216:219],v[52:55]
v_cvt_pk_bf16_f32 v117,v118,v119
v_cvt_pk_bf16_f32 v120,v120,v121
M v[56:59],a[244:247],a[220:223],v[56:59]
s_waitcnt lgkmcnt(1)
v_cvt_pk_bf16_f32 v121,v122,v123
v_cvt_pk_bf16_f32 v124,v124,v125
M v[60:63],a[244:247],a[192:195],v[60:63]
s_waitcnt vmcnt(12)
buffer_load_dwordx4 a[244:247],v253,s[20:23],s47 offen offset:0
M v[32:35],a[248:251],a[200:203],v[32:35]
ds_read_b128 a[200:203],v251 offset:34816
v_cvt_pk_bf16_f32 v125,v126,v127
M v[36:39],a[248:251],a[204:207],v[36:39]
ds_read_b128 a[204:207],v252 offset:35072
v_fmac_f32 v237,4.0,v239
M v[40:43],a[248:251],a[208:211],v[40:43]
ds_read_b128 a[208:211],v252 offset:35328
v_fma_f32 v239,2.0,v159,v240
M v[44:47],a[248:251],a[212:215],v[44:47]
ds_read_b128 a[212:215],v252 offset:35584
v_fma_f32 v159,s41,v159,v240
M v[48:51],a[248:251],a[216:219],v[48:51]
ds_read_b128 a[216:219],v252 offset:35840
v_cvt_pk_bf16_f32 v238,v238,v239
M v[52:55],a[248:251],a[220:223],v[52:55]
ds_read_b128 a[220:223],v252 offset:36096
v_accvgpr_write_b32 a31,v238
M v[56:59],a[248:251],a[192:195],v[56:59]
s_waitcnt lgkmcnt(6)
ds_read_b128 a[192:195],v252 offset:36352
v_cvt_pk_bf16_f32 v236,v236,v237
M v[60:63],a[248:251],a[196:199],v[60:63]
s_waitcnt vmcnt(12) lgkmcnt(6)
buffer_load_dwordx4 a[248:251],v253,s[20:23],s47 offen offset:1024
M v[32:35],a[252:255],a[200:203],v[32:35]
s_waitcnt lgkmcnt(5)
ds_read_b128 a[196:199],v252 offset:36608
ds_read_b128 a[200:203],v252 offset:36864
M v[36:39],a[252:255],a[204:207],v[36:39]
s_waitcnt lgkmcnt(6)
v_accvgpr_write_b32 a127,v236
v_accvgpr_read_b32 v240,a64
M v[40:43],a[252:255],a[208:211],v[40:43]
s_waitcnt lgkmcnt(5)
v_accvgpr_read_b32 v238,a160
v_add_f32 v236,v240,v238
M v[44:47],a[252:255],a[212:215],v[44:47]
s_waitcnt lgkmcnt(4)
v_sub_f32 v240,v240,v238
v_add_f32 v238,v64,v160
M v[48:51],a[252:255],a[216:219],v[48:51]
s_waitcnt lgkmcnt(3)
v_sub_f32 v160,v64,v160
v_add_f32 v64,v236,v238
M v[52:55],a[252:255],a[220:223],v[52:55]
s_waitcnt lgkmcnt(2)
v_fmac_f32 v236,4.0,v238
v_fma_f32 v238,2.0,v160,v240
M v[56:59],a[252:255],a[192:195],v[56:59]
s_waitcnt lgkmcnt(1)
v_fma_f32 v160,s41,v160,v240
v_accvgpr_read_b32 v240,a65
M v[60:63],a[252:255],a[196:199],v[60:63]
s_waitcnt vmcnt(12)
buffer_load_dwordx4 a[252:255],v253,s[20:23],s47 offen offset:2048
M v[32:35],v[216:219],a[204:207],v[32:35]
ds_read_b128 a[204:207],v251 offset:37120
v_accvgpr_read_b32 v239,a161
M v[36:39],v[216:219],a[208:211],v[36:39]
s_add_u32 s47,s44,279552
v_add_f32 v237,v240,v239
v_sub_f32 v240,v240,v239
M v[40:43],v[216:219],a[212:215],v[40:43]
v_add_f32 v239,v65,v161
v_sub_f32 v161,v65,v161
M v[44:47],v[216:219],a[216:219],v[44:47]
buffer_store_dwordx4 a[120:123],v254,s[24:27],s38 offen offset:768
M v[48:51],v[216:219],a[220:223],v[48:51]
v_add_f32 v65,v237,v239
v_fmac_f32 v237,4.0,v239
M v[52:55],v[216:219],a[192:195],v[52:55]
v_fma_f32 v239,2.0,v161,v240
v_fma_f32 v161,s41,v161,v240
M v[56:59],v[216:219],a[196:199],v[56:59]
s_waitcnt lgkmcnt(1)
v_cvt_pk_bf16_f32 v228,v238,v239
v_cvt_pk_bf16_f32 v230,v236,v237
M v[60:63],v[216:219],a[200:203],v[60:63]
s_waitcnt vmcnt(13)
buffer_load_dwordx4 v[216:219],v253,s[20:23],s47 offen offset:0
M v[32:35],v[220:223],a[208:211],v[32:35]
ds_read_b128 a[208:211],v251 offset:52224
v_accvgpr_read_b32 v240,a66
M v[36:39],v[220:223],a[212:215],v[36:39]
ds_read_b128 a[212:215],v252 offset:52480
v_accvgpr_read_b32 v238,a162
M v[40:43],v[220:223],a[216:219],v[40:43]
ds_read_b128 a[216:219],v252 offset:52736
v_add_f32 v236,v240,v238
M v[44:47],v[220:223],a[220:223],v[44:47]
ds_read_b128 a[220:223],v252 offset:52992
v_sub_f32 v240,v240,v238
M v[48:51],v[220:223],a[192:195],v[48:51]
ds_read_b128 a[192:195],v252 offset:53248
v_add_f32 v238,v66,v162
M v[52:55],v[220:223],a[196:199],v[52:55]
ds_read_b128 a[196:199],v252 offset:53504
v_sub_f32 v162,v66,v162
M v[56:59],v[220:223],a[200:203],v[56:59]
s_waitcnt lgkmcnt(6)
ds_read_b128 a[200:203],v252 offset:53760
v_add_f32 v66,v236,v238
M v[60:63],v[220:223],a[204:207],v[60:63]
s_waitcnt vmcnt(13) lgkmcnt(6)
buffer_load_dwordx4 v[220:223],v253,s[20:23],s47 offen offset:1024
M v[32:35],v[224:227],a[208:211],v[32:35]
s_waitcnt lgkmcnt(5)
ds_read_b128 a[204:207],v252 offset:54016
ds_read_b128 a[208:211],v252 offset:54272
M v[36:39],v[224:227],a[212:215],v[36:39]
s_waitcnt lgkmcnt(6)
v_fmac_f32 v236,4.0,v238
v_fma_f32 v238,2.0,v162,v240
M v[40:43],v[224:227],a[216:219],v[40:43]
s_waitcnt lgkmcnt(5)
v_fma_f32 v162,s41,v162,v240
v_accvgpr_read_b32 v240,a67
M v[44:47],v[224:227],a[220:223],v[44:47]
s_waitcnt lgkmcnt(4)
v_accvgpr_read_b32 v239,a163
v_add_f32 v237,v240,v239
M v[48:51],v[224:227],a[192:195],v[48:51]
s_waitcnt lgkmcnt(3)
v_sub_f32 v240,v240,v239
v_add_f32 v239,v67,v163
M v[52:55],v[224:227],a[196:199],v[52:55]
s_waitcnt lgkmcnt(2)
v_sub_f32 v163,v67,v163
v_add_f32 v67,v237,v239
M v[56:59],v[224:227],a[200:203],v[56:59]
s_waitcnt lgkmcnt(1)
v_fmac_f32 v237,4.0,v239
v_fma_f32 v239,2.0,v163,v240
M v[60:63],v[224:227],a[204:207],v[60:63]
s_waitcnt vmcnt(12)
buffer_load_dwordx4 v[224:227],v253,s[20:23],s47 offen offset:2048
M v[32:35],a[224:227],a[212:215],v[32:35]
ds_read_b128 a[212:215],v251 offset:54528
v_fma_f32 v163,s41,v163,v240
M v[36:39],a[224:227],a[216:219],v[36:39]
s_add_u32 s47,s44,49152
v_cvt_pk_bf16_f32 v229,v238,v239
v_cvt_pk_bf16_f32 v231,v236,v237
M v[40:43],a[224:227],a[220:223],v[40:43]
buffer_store_dwordx2 v[228:229],v255,s[24:27],s32 offen offset:384
M v[44:47],a[224:227],a[192:195],v[44:47]
buffer_store_dwordx2 v[230:231],v255,s[24:27],s32 offen offset:768
M v[48:51],a[224:227],a[196:199],v[48:51]
v_accvgpr_read_b32 v240,a68
v_accvgpr_read_b32 v238,a164
M v[52:55],a[224:227],a[200:203],v[52:55]
buffer_store_dwordx4 a[28:31],v254,s[24:27],s39 offen offset:384
M v[56:59],a[224:227],a[204:207],v[56:59]
s_waitcnt lgkmcnt(1)
v_add_u32 v251,0x11000,v251
v_add_u32 v252,0x11000,v252
M v[60:63],a[224:227],a[208:211],v[60:63]
s_waitcnt vmcnt(15)
buffer_load_dwordx4 a[224:227],v253,s[20:23],s47 offen offset:0
M v[32:35],a[228:231],a[216:219],v[32:35]
ds_read_b128 a[216:219],v251 offset:0
v_add_f32 v236,v240,v238
M v[36:39],a[228:231],a[220:223],v[36:39]
ds_read_b128 a[220:223],v252 offset:256
v_sub_f32 v240,v240,v238
M v[40:43],a[228:231],a[192:195],v[40:43]
ds_read_b128 a[192:195],v252 offset:512
v_add_f32 v238,v68,v164
M v[44:47],a[228:231],a[196:199],v[44:47]
ds_read_b128 a[196:199],v252 offset:768
v_sub_f32 v164,v68,v164
M v[48:51],a[228:231],a[200:203],v[48:51]
ds_read_b128 a[200:203],v252 offset:1024
v_add_f32 v68,v236,v238
M v[52:55],a[228:231],a[204:207],v[52:55]
ds_read_b128 a[204:207],v252 offset:1280
v_fmac_f32 v236,4.0,v238
M v[56:59],a[228:231],a[208:211],v[56:59]
s_waitcnt lgkmcnt(6)
ds_read_b128 a[208:211],v252 offset:1536
v_fma_f32 v238,2.0,v164,v240
M v[60:63],a[228:231],a[212:215],v[60:63]
s_waitcnt vmcnt(14) lgkmcnt(6)
buffer_load_dwordx4 a[228:231],v253,s[20:23],s47 offen offset:1024
M v[32:35],a[232:235],a[216:219],v[32:35]
s_waitcnt lgkmcnt(5)
ds_read_b128 a[212:215],v252 offset:1792
ds_read_b128 a[216:219],v252 offset:2048
M v[36:39],a[232:235],a[220:223],v[36:39]
s_waitcnt lgkmcnt(6)
v_fma_f32 v164,s41,v164,v240
v_accvgpr_read_b32 v240,a69
M v[40:43],a[232:235],a[192:195],v[40:43]
s_waitcnt lgkmcnt(5)
v_accvgpr_read_b32 v239,a165
v_add_f32 v237,v240,v239
M v[44:47],a[232:235],a[196:199],v[44:47]
s_waitcnt lgkmcnt(4)
v_sub_f32 v240,v240,v239
v_add_f32 v239,v69,v165
M v[48:51],a[232:235],a[200:203],v[48:51]
s_waitcnt lgkmcnt(3)
v_sub_f32 v165,v69,v165
v_add_f32 v69,v237,v239
M v[52:55],a[232:235],a[204:207],v[52:55]
s_waitcnt lgkmcnt(2)
v_fmac_f32 v237,4.0,v239
v_fma_f32 v239,2.0,v165,v240
M v[56:59],a[232:235],a[208:211],v[56:59]
s_waitcnt lgkmcnt(1)
v_fma_f32 v165,s41,v165,v240
v_cvt_pk_bf16_f32 v232,v238,v239
M v[60:63],a[232:235],a[212:215],v[60:63]
s_waitcnt vmcnt(14)
buffer_load_dwordx4 a[232:235],v253,s[20:23],s47 offen offset:2048
M v[32:35],a[236:239],a[220:223],v[32:35]
ds_read_b128 a[220:223],v251 offset:2304
v_cvt_pk_bf16_f32 v234,v236,v237
M v[36:39],a[236:239],a[192:195],v[36:39]
s_add_u32 s47,s44,104448
v_accvgpr_read_b32 v240,a70
v_accvgpr_read_b32 v238,a166
M v[40:43],a[236:239],a[196:199],v[40:43]
v_add_f32 v236,v240,v238
v_sub_f32 v240,v240,v238
M v[44:47],a[236:239],a[200:203],v[44:47]
v_add_f32 v238,v70,v166
v_sub_f32 v166,v70,v166
M v[48:51],a[236:239],a[204:207],v[48:51]
v_add_f32 v70,v236,v238
v_fmac_f32 v236,4.0,v238
M v[52:55],a[236:239],a[208:211],v[52:55]
v_fma_f32 v238,2.0,v166,v240
v_fma_f32 v166,s41,v166,v240
M v[56:59],a[236:239],a[212:215],v[56:59]
s_waitcnt lgkmcnt(1)
buffer_store_dwordx4 a[124:127],v254,s[24:27],s39 offen offset:768
M v[60:63],a[236:239],a[216:219],v[60:63]
s_waitcnt vmcnt(15)
buffer_load_dwordx4 a[236:239],v253,s[20:23],s47 offen offset:0
M v[32:35],a[240:243],a[192:195],v[32:35]
ds_read_b128 a[192:195],v251 offset:17408
v_accvgpr_read_b32 v240,a71
M v[36:39],a[240:243],a[196:199],v[36:39]
ds_read_b128 a[196:199],v252 offset:17664
v_accvgpr_read_b32 v239,a167
M v[40:43],a[240:243],a[200:203],v[40:43]
ds_read_b128 a[200:203],v252 offset:17920
v_add_f32 v237,v240,v239
M v[44:47],a[240:243],a[204:207],v[44:47]
ds_read_b128 a[204:207],v252 offset:18176
v_sub_f32 v240,v240,v239
M v[48:51],a[240:243],a[208:211],v[48:51]
ds_read_b128 a[208:211],v252 offset:18432
v_add_f32 v239,v71,v167
M v[52:55],a[240:243],a[212:215],v[52:55]
ds_read_b128 a[212:215],v252 offset:18688
v_sub_f32 v167,v71,v167
M v[56:59],a[240:243],a[216:219],v[56:59]
s_waitcnt lgkmcnt(6)
ds_read_b128 a[216:219],v252 offset:18944
v_add_f32 v71,v237,v239
M v[60:63],a[240:243],a[220:223],v[60:63]
s_waitcnt vmcnt(14) lgkmcnt(6)
buffer_load_dwordx4 a[240:243],v253,s[20:23],s47 offen offset:1024
M v[32:35],a[244:247],a[192:195],v[32:35]
s_waitcnt lgkmcnt(5)
ds_read_b128 a[220:223],v252 offset:19200
ds_read_b128 a[192:195],v252 offset:19456
M v[36:39],a[244:247],a[196:199],v[36:39]
s_waitcnt lgkmcnt(6)
v_fmac_f32 v237,4.0,v239
v_fma_f32 v239,2.0,v167,v240
M v[40:43],a[244:247],a[200:203],v[40:43]
s_waitcnt lgkmcnt(5)
v_fma_f32 v167,s41,v167,v240
v_cvt_pk_bf16_f32 v233,v238,v239
M v[44:47],a[244:247],a[204:207],v[44:47]
s_waitcnt lgkmcnt(4)
v_cvt_pk_bf16_f32 v235,v236,v237
M v[48:51],a[244:247],a[208:211],v[48:51]
s_waitcnt lgkmcnt(3)
buffer_store_dwordx2 v[232:233],v255,s[24:27],s33 offen offset:384
M v[52:55],a[244:247],a[212:215],v[52:55]
s_waitcnt lgkmcnt(2)
buffer_store_dwordx2 v[234:235],v255,s[24:27],s33 offen offset:768
M v[56:59],a[244:247],a[216:219],v[56:59]
s_waitcnt lgkmcnt(1)
v_accvgpr_read_b32 v240,a72
v_accvgpr_read_b32 v238,a168
M v[60:63],a[244:247],a[220:223],v[60:63]
s_waitcnt vmcnt(16)
buffer_load_dwordx4 a[244:247],v253,s[20:23],s47 offen offset:2048
M v[32:35],a[248:251],a[196:199],v[32:35]
ds_read_b128 a[196:199],v251 offset:19712
v_add_f32 v236,v240,v238
M v[36:39],a[248:251],a[200:203],v[36:39]
s_add_u32 s47,s44,159744
v_sub_f32 v240,v240,v238
v_add_f32 v238,v72,v168
M v[40:43],a[248:251],a[204:207],v[40:43]
v_sub_f32 v168,v72,v168
v_add_f32 v72,v236,v238
M v[44:47],a[248:251],a[208:211],v[44:47]
v_fmac_f32 v236,4.0,v238
v_fma_f32 v238,2.0,v168,v240
M v[48:51],a[248:251],a[212:215],v[48:51]
v_fma_f32 v168,s41,v168,v240
v_accvgpr_read_b32 v240,a73
M v[52:55],a[248:251],a[216:219],v[52:55]
v_add_u32 v251,0xffff1200,v251
v_add_u32 v252,0xffff1200,v252
M v[56:59],a[248:251],a[220:223],v[56:59]
s_waitcnt lgkmcnt(1)
v_accvgpr_read_b32 v239,a169
v_add_f32 v237,v240,v239
M v[60:63],a[248:251],a[192:195],v[60:63]
s_waitcnt vmcnt(16)
buffer_load_dwordx4 a[248:251],v253,s[20:23],s47 offen offset:0
M v[32:35],a[252:255],a[200:203],v[32:35]
ds_read_b128 a[200:203],v251 offset:8704
v_sub_f32 v240,v240,v239
M v[36:39],a[252:255],a[204:207],v[36:39]
ds_read_b128 a[204:207],v252 offset:8960
v_add_f32 v239,v73,v169
M v[40:43],a[252:255],a[208:211],v[40:43]
ds_read_b128 a[208:211],v252 offset:9216
v_sub_f32 v169,v73,v169
M v[44:47],a[252:255],a[212:215],v[44:47]
ds_read_b128 a[212:215],v252 offset:9472
v_add_f32 v73,v237,v239
M v[48:51],a[252:255],a[216:219],v[48:51]
ds_read_b128 a[216:219],v252 offset:9728
v_fmac_f32 v237,4.0,v239
M v[52:55],a[252:255],a[220:223],v[52:55]
ds_read_b128 a[220:223],v252 offset:9984
v_fma_f32 v239,2.0,v169,v240
M v[56:59],a[252:255],a[192:195],v[56:59]
s_waitcnt lgkmcnt(6)
ds_read_b128 a[192:195],v252 offset:10240
v_fma_f32 v169,s41,v169,v240
M v[60:63],a[252:255],a[196:199],v[60:63]
s_waitcnt vmcnt(15) lgkmcnt(6)
buffer_load_dwordx4 a[252:255],v253,s[20:23],s47 offen offset:1024
M v[32:35],v[216:219],a[200:203],v[32:35]
s_waitcnt lgkmcnt(5)
ds_read_b128 a[196:199],v252 offset:10496
ds_read_b128 a[200:203],v252 offset:10752
M v[36:39],v[216:219],a[204:207],v[36:39]
s_waitcnt lgkmcnt(6)
v_cvt_pk_bf16_f32 v228,v238,v239
v_cvt_pk_bf16_f32 v230,v236,v237
M v[40:43],v[216:219],a[208:211],v[40:43]
s_waitcnt lgkmcnt(5)
v_accvgpr_read_b32 v240,a74
v_accvgpr_read_b32 v238,a170
M v[44:47],v[216:219],a[212:215],v[44:47]
s_waitcnt lgkmcnt(4)
v_add_f32 v236,v240,v238
v_sub_f32 v240,v240,v238
M v[48:51],v[216:219],a[216:219],v[48:51]
s_waitcnt lgkmcnt(3)
v_add_f32 v238,v74,v170
v_sub_f32 v170,v74,v170
M v[52:55],v[216:219],a[220:223],v[52:55]
s_waitcnt lgkmcnt(2)
v_add_f32 v74,v236,v238
v_fmac_f32 v236,4.0,v238
M v[56:59],v[216:219],a[192:195],v[56:59]
s_waitcnt lgkmcnt(1)
v_fma_f32 v238,2.0,v170,v240
v_fma_f32 v170,s41,v170,v240
M v[60:63],v[216:219],a[196:199],v[60:63]
s_waitcnt vmcnt(15)
buffer_load_dwordx4 v[216:219],v253,s[20:23],s47 offen offset:2048
M v[32:35],v[220:223],a[204:207],v[32:35]
ds_read_b128 a[204:207],v251 offset:11008
v_accvgpr_read_b32 v240,a75
M v[36:39],v[220:223],a[208:211],v[36:39]
s_add_u32 s47,s44,215040
v_accvgpr_read_b32 v239,a171
v_add_f32 v237,v240,v239
M v[40:43],v[220:223],a[212:215],v[40:43]
v_sub_f32 v240,v240,v239
v_add_f32 v239,v75,v171
M v[44:47],v[220:223],a[216:219],v[44:47]
v_sub_f32 v171,v75,v171
v_add_f32 v75,v237,v239
M v[48:51],v[220:223],a[220:223],v[48:51]
v_fmac_f32 v237,4.0,v239
v_fma_f32 v239,2.0,v171,v240
M v[52:55],v[220:223],a[192:195],v[52:55]
v_fma_f32 v171,s41,v171,v240
v_cvt_pk_bf16_f32 v229,v238,v239
M v[56:59],v[220:223],a[196:199],v[56:59]
s_waitcnt lgkmcnt(1)
v_cvt_pk_bf16_f32 v231,v236,v237
M v[60:63],v[220:223],a[200:203],v[60:63]
s_waitcnt vmcnt(15)
buffer_load_dwordx4 v[220:223],v253,s[20:23],s47 offen offset:0
M v[32:35],v[224:227],a[208:211],v[32:35]
ds_read_b128 a[208:211],v251 offset:0
buffer_store_dwordx2 v[228:229],v255,s[24:27],s34 offen offset:384
M v[36:39],v[224:227],a[212:215],v[36:39]
ds_read_b128 a[212:215],v252 offset:256
buffer_store_dwordx2 v[230:231],v255,s[24:27],s34 offen offset:768
M v[40:43],v[224:227],a[216:219],v[40:43]
ds_read_b128 a[216:219],v252 offset:512
v_accvgpr_read_b32 v240,a76
M v[44:47],v[224:227],a[220:223],v[44:47]
ds_read_b128 a[220:223],v252 offset:768
v_cvt_pk_bf16_f32 v2,v32,v33
M v[48:51],v[224:227],a[192:195],v[48:51]
ds_read_b128 a[192:195],v252 offset:1024
v_cvt_pk_bf16_f32 v3,v34,v35
M v[52:55],v[224:227],a[196:199],v[52:55]
buffer_store_dwordx4 v[0:3],v254,s[24:27],s32 offen offset:0
M v[56:59],v[224:227],a[200:203],v[56:59]
s_waitcnt lgkmcnt(5)
ds_read_b128 a[196:199],v252 offset:1280
ds_read_b128 a[200:203],v252 offset:1536
M v[60:63],v[224:227],a[204:207],v[60:63]
s_waitcnt vmcnt(15) lgkmcnt(6)
buffer_load_dwordx4 v[224:227],v253,s[20:23],s47 offen offset:1024
M v[128:131],a[224:227],a[208:211],v[128:131]
s_waitcnt lgkmcnt(5)
ds_read_b128 a[204:207],v252 offset:1792
ds_read_b128 a[208:211],v252 offset:2048
M v[132:135],a[224:227],a[212:215],v[132:135]
s_waitcnt lgkmcnt(6)
v_cvt_pk_bf16_f32 v6,v36,v37
v_cvt_pk_bf16_f32 v7,v38,v39
M v[136:139],a[224:227],a[216:219],v[136:139]
s_waitcnt lgkmcnt(5)
buffer_store_dwordx4 v[4:7],v254,s[24:27],s33 offen offset:0
M v[140:143],a[224:227],a[220:223],v[140:143]
s_waitcnt lgkmcnt(4)
v_cvt_pk_bf16_f32 v10,v40,v41
v_cvt_pk_bf16_f32 v11,v42,v43
M v[144:147],a[224:227],a[192:195],v[144:147]
s_waitcnt lgkmcnt(3)
v_cvt_pk_bf16_f32 v14,v44,v45
v_cvt_pk_bf16_f32 v15,v46,v47
M v[148:151],a[224:227],a[196:199],v[148:151]
s_waitcnt lgkmcnt(2)
v_cvt_pk_bf16_f32 v18,v48,v49
v_cvt_pk_bf16_f32 v19,v50,v51
M v[152:155],a[224:227],a[200:203],v[152:155]
s_waitcnt lgkmcnt(1)
v_cvt_pk_bf16_f32 v22,v52,v53
v_cvt_pk_bf16_f32 v23,v54,v55
M v[156:159],a[224:227],a[204:207],v[156:159]
s_waitcnt vmcnt(16)
buffer_load_dwordx4 a[224:227],v253,s[20:23],s47 offen offset:2048
M v[128:131],a[228:231],a[212:215],v[128:131]
ds_read_b128 a[212:215],v251 offset:2304
v_cvt_pk_bf16_f32 v26,v56,v57
M v[132:135],a[228:231],a[216:219],v[132:135]
s_add_u32 s47,s44,270336
v_cvt_pk_bf16_f32 v27,v58,v59
v_cvt_pk_bf16_f32 v30,v60,v61
M v[136:139],a[228:231],a[220:223],v[136:139]
v_cvt_pk_bf16_f32 v31,v62,v63
v_accvgpr_read_b32 v238,a172
M v[140:143],a[228:231],a[192:195],v[140:143]
v_add_f32 v236,v240,v238
v_sub_f32 v240,v240,v238
M v[144:147],a[228:231],a[196:199],v[144:147]
v_add_f32 v238,v76,v172
v_sub_f32 v172,v76,v172
M v[148:151],a[228:231],a[200:203],v[148:151]
v_add_f32 v76,v236,v238
v_fmac_f32 v236,4.0,v238
M v[152:155],a[228:231],a[204:207],v[152:155]
s_waitcnt lgkmcnt(1)
v_fma_f32 v238,2.0,v172,v240
v_fma_f32 v172,s41,v172,v240
M v[156:159],a[228:231],a[208:211],v[156:159]
s_waitcnt vmcnt(16)
buffer_load_dwordx4 a[228:231],v253,s[20:23],s47 offen offset:0
M v[128:131],a[232:235],a[216:219],v[128:131]
ds_read_b128 a[216:219],v251 offset:34816
v_accvgpr_read_b32 v240,a77
M v[132:135],a[232:235],a[220:223],v[132:135]
ds_read_b128 a[220:223],v252 offset:35072
v_accvgpr_read_b32 v239,a173
M v[136:139],a[232:235],a[192:195],v[136:139]
ds_read_b128 a[192:195],v252 offset:35328
v_add_f32 v237,v240,v239
M v[140:143],a[232:235],a[196:199],v[140:143]
buffer_store_dwordx4 v[8:11],v254,s[24:27],s34 offen offset:0
M v[144:147],a[232:235],a[200:203],v[144:147]
ds_read_b128 a[196:199],v252 offset:35584
ds_read_b128 a[200:203],v252 offset:35840
M v[148:151],a[232:235],a[204:207],v[148:151]
ds_read_b128 a[204:207],v252 offset:36096
v_sub_f32 v240,v240,v239
M v[152:155],a[232:235],a[208:211],v[152:155]
s_waitcnt lgkmcnt(6)
ds_read_b128 a[208:211],v252 offset:36352
v_add_f32 v239,v77,v173
M v[156:159],a[232:235],a[212:215],v[156:159]
s_waitcnt vmcnt(16) lgkmcnt(6)
buffer_load_dwordx4 a[232:235],v253,s[20:23],s47 offen offset:1024
M v[128:131],a[236:239],a[216:219],v[128:131]
s_waitcnt lgkmcnt(5)
ds_read_b128 a[212:215],v252 offset:36608
ds_read_b128 a[216:219],v252 offset:36864
M v[132:135],a[236:239],a[220:223],v[132:135]
s_waitcnt lgkmcnt(6)
v_sub_f32 v173,v77,v173
v_add_f32 v77,v237,v239
M v[136:139],a[236:239],a[192:195],v[136:139]
s_waitcnt lgkmcnt(5)
v_fmac_f32 v237,4.0,v239
v_fma_f32 v239,2.0,v173,v240
M v[140:143],a[236:239],a[196:199],v[140:143]
s_waitcnt lgkmcnt(4)
v_fma_f32 v173,s41,v173,v240
v_cvt_pk_bf16_f32 v232,v238,v239
M v[144:147],a[236:239],a[200:203],v[144:147]
s_waitcnt lgkmcnt(3)
v_cvt_pk_bf16_f32 v234,v236,v237
v_accvgpr_read_b32 v240,a78
M v[148:151],a[236:239],a[204:207],v[148:151]
s_waitcnt lgkmcnt(2)
v_accvgpr_read_b32 v238,a174
v_add_f32 v236,v240,v238
M v[152:155],a[236:239],a[208:211],v[152:155]
s_waitcnt lgkmcnt(1)
v_sub_f32 v240,v240,v238
v_add_f32 v238,v78,v174
M v[156:159],a[236:239],a[212:215],v[156:159]
s_waitcnt vmcnt(16)
buffer_load_dwordx4 a[236:239],v253,s[20:23],s47 offen offset:2048
M v[128:131],a[240:243],a[220:223],v[128:131]
ds_read_b128 a[220:223],v251 offset:37120
v_sub_f32 v174,v78,v174
M v[132:135],a[240:243],a[192:195],v[132:135]
s_add_u32 s47,s44,325632
v_add_f32 v78,v236,v238
v_fmac_f32 v236,4.0,v238
M v[136:139],a[240:243],a[196:199],v[136:139]
v_fma_f32 v238,2.0,v174,v240
v_fma_f32 v174,s41,v174,v240
M v[140:143],a[240:243],a[200:203],v[140:143]
v_accvgpr_read_b32 v240,a79
v_accvgpr_read_b32 v239,a175
M v[144:147],a[240:243],a[204:207],v[144:147]
v_add_f32 v237,v240,v239
v_sub_f32 v240,v240,v239
M v[148:151],a[240:243],a[208:211],v[148:151]
v_add_f32 v239,v79,v175
v_sub_f32 v175,v79,v175
M v[152:155],a[240:243],a[212:215],v[152:155]
s_waitcnt lgkmcnt(1)
v_add_f32 v79,v237,v239
v_fmac_f32 v237,4.0,v239
M v[156:159],a[240:243],a[216:219],v[156:159]
s_waitcnt vmcnt(14)
buffer_load_dwordx4 a[240:243],v253,s[20:23],s47 offen offset:0
M v[128:131],a[244:247],a[192:195],v[128:131]
ds_read_b128 a[192:195],v251 offset:52224
v_fma_f32 v239,2.0,v175,v240
M v[132:135],a[244:247],a[196:199],v[132:135]
ds_read_b128 a[196:199],v252 offset:52480
v_fma_f32 v175,s41,v175,v240
M v[136:139],a[244:247],a[200:203],v[136:139]
ds_read_b128 a[200:203],v252 offset:52736
v_cvt_pk_bf16_f32 v233,v238,v239
M v[140:143],a[244:247],a[204:207],v[140:143]
ds_read_b128 a[204:207],v252 offset:52992
v_cvt_pk_bf16_f32 v235,v236,v237
M v[144:147],a[244:247],a[208:211],v[144:147]
buffer_store_dwordx4 v[12:15],v254,s[24:27],s35 offen offset:0
M v[148:151],a[244:247],a[212:215],v[148:151]
ds_read_b128 a[208:211],v252 offset:53248
ds_read_b128 a[212:215],v252 offset:53504
M v[152:155],a[244:247],a[216:219],v[152:155]
s_waitcnt lgkmcnt(6)
ds_read_b128 a[216:219],v252 offset:53760
buffer_store_dwordx2 v[232:233],v255,s[24:27],s35 offen offset:384
M v[156:159],a[244:247],a[220:223],v[156:159]
s_waitcnt vmcnt(16) lgkmcnt(6)
buffer_load_dwordx4 a[244:247],v253,s[20:23],s47 offen offset:1024
M v[128:131],a[248:251],a[192:195],v[128:131]
s_waitcnt lgkmcnt(5)
ds_read_b128 a[220:223],v252 offset:54016
ds_read_b128 a[192:195],v252 offset:54272
M v[132:135],a[248:251],a[196:199],v[132:135]
s_waitcnt lgkmcnt(6)
buffer_store_dwordx2 v[234:235],v255,s[24:27],s35 offen offset:768
M v[136:139],a[248:251],a[200:203],v[136:139]
s_waitcnt lgkmcnt(5)
v_accvgpr_read_b32 v240,a80
v_accvgpr_read_b32 v238,a176
M v[140:143],a[248:251],a[204:207],v[140:143]
s_waitcnt lgkmcnt(4)
v_add_f32 v236,v240,v238
v_sub_f32 v240,v240,v238
M v[144:147],a[248:251],a[208:211],v[144:147]
s_waitcnt lgkmcnt(3)
v_add_f32 v238,v80,v176
v_sub_f32 v176,v80,v176
M v[148:151],a[248:251],a[212:215],v[148:151]
s_waitcnt lgkmcnt(2)
v_add_f32 v80,v236,v238
v_fmac_f32 v236,4.0,v238
M v[152:155],a[248:251],a[216:219],v[152:155]
s_waitcnt lgkmcnt(1)
v_fma_f32 v238,2.0,v176,v240
v_fma_f32 v176,s41,v176,v240
M v[156:159],a[248:251],a[220:223],v[156:159]
s_waitcnt vmcnt(17)
buffer_load_dwordx4 a[248:251],v253,s[20:23],s47 offen offset:2048
M v[128:131],a[252:255],a[196:199],v[128:131]
ds_read_b128 a[196:199],v251 offset:54528
v_accvgpr_read_b32 v240,a81
M v[132:135],a[252:255],a[200:203],v[132:135]
s_add_u32 s48,s44,6144
v_accvgpr_read_b32 v239,a177
v_add_f32 v237,v240,v239
M v[136:139],a[252:255],a[204:207],v[136:139]
v_sub_f32 v240,v240,v239
v_add_f32 v239,v81,v177
M v[140:143],a[252:255],a[208:211],v[140:143]
v_sub_f32 v177,v81,v177
v_add_f32 v81,v237,v239
M v[144:147],a[252:255],a[212:215],v[144:147]
v_fmac_f32 v237,4.0,v239
v_fma_f32 v239,2.0,v177,v240
M v[148:151],a[252:255],a[216:219],v[148:151]
v_add_u32 v251,0x11000,v251
v_add_u32 v252,0x11000,v252
M v[152:155],a[252:255],a[220:223],v[152:155]
s_waitcnt lgkmcnt(1)
v_fma_f32 v177,s41,v177,v240
v_cvt_pk_bf16_f32 v228,v238,v239
M v[156:159],a[252:255],a[192:195],v[156:159]
s_waitcnt vmcnt(17)
buffer_load_dwordx4 a[252:255],v253,s[20:23],s48 offen offset:0
M v[128:131],v[216:219],a[200:203],v[128:131]
ds_read_b128 a[200:203],v251 offset:0
v_cvt_pk_bf16_f32 v230,v236,v237
M v[132:135],v[216:219],a[204:207],v[132:135]
ds_read_b128 a[204:207],v252 offset:256
v_accvgpr_read_b32 v240,a82
M v[136:139],v[216:219],a[208:211],v[136:139]
ds_read_b128 a[208:211],v252 offset:512
v_accvgpr_read_b32 v238,a178
M v[140:143],v[216:219],a[212:215],v[140:143]
ds_read_b128 a[212:215],v252 offset:768
v_add_f32 v236,v240,v238
M v[144:147],v[216:219],a[216:219],v[144:147]
ds_read_b128 a[216:219],v252 offset:1024
v_sub_f32 v240,v240,v238
M v[148:151],v[216:219],a[220:223],v[148:151]
ds_read_b128 a[220:223],v252 offset:1280
v_add_f32 v238,v82,v178
M v[152:155],v[216:219],a[192:195],v[152:155]
s_waitcnt lgkmcnt(6)
buffer_store_dwordx4 v[16:19],v254,s[24:27],s36 offen offset:0
M v[156:159],v[216:219],a[196:199],v[156:159]
s_waitcnt vmcnt(18) lgkmcnt(5)
buffer_load_dwordx4 v[216:219],v253,s[20:23],s48 offen offset:1024
M v[128:131],v[220:223],a[200:203],v[128:131]
s_waitcnt lgkmcnt(4)
ds_read_b128 a[192:195],v252 offset:1536
ds_read_b128 a[196:199],v252 offset:1792
M v[132:135],v[220:223],a[204:207],v[132:135]
s_waitcnt lgkmcnt(5)
ds_read_b128 a[200:203],v252 offset:2048
v_sub_f32 v178,v82,v178
M v[136:139],v[220:223],a[208:211],v[136:139]
s_waitcnt lgkmcnt(5)
v_add_f32 v82,v236,v238
v_fmac_f32 v236,4.0,v238
M v[140:143],v[220:223],a[212:215],v[140:143]
s_waitcnt lgkmcnt(4)
v_fma_f32 v238,2.0,v178,v240
v_fma_f32 v178,s41,v178,v240
M v[144:147],v[220:223],a[216:219],v[144:147]
s_waitcnt lgkmcnt(3)
v_accvgpr_read_b32 v240,a83
v_accvgpr_read_b32 v239,a179
M v[148:151],v[220:223],a[220:223],v[148:151]
s_waitcnt lgkmcnt(2)
v_add_f32 v237,v240,v239
v_sub_f32 v240,v240,v239
M v[152:155],v[220:223],a[192:195],v[152:155]
s_waitcnt lgkmcnt(1)
v_add_f32 v239,v83,v179
v_sub_f32 v179,v83,v179
M v[156:159],v[220:223],a[196:199],v[156:159]
s_waitcnt vmcnt(15)
buffer_load_dwordx4 v[220:223],v253,s[20:23],s48 offen offset:2048
M v[128:131],v[224:227],a[204:207],v[128:131]
ds_read_b128 a[204:207],v251 offset:2304
v_add_f32 v83,v237,v239
M v[132:135],v[224:227],a[208:211],v[132:135]
s_add_u32 s48,s44,61440
v_fmac_f32 v237,4.0,v239
v_fma_f32 v239,2.0,v179,v240
M v[136:139],v[224:227],a[212:215],v[136:139]
v_fma_f32 v179,s41,v179,v240
v_cvt_pk_bf16_f32 v229,v238,v239
M v[140:143],v[224:227],a[216:219],v[140:143]
v_cvt_pk_bf16_f32 v231,v236,v237
M v[144:147],v[224:227],a[220:223],v[144:147]
buffer_store_dwordx2 v[228:229],v255,s[24:27],s36 offen offset:384
M v[148:151],v[224:227],a[192:195],v[148:151]
buffer_store_dwordx2 v[230:231],v255,s[24:27],s36 offen offset:768
M v[152:155],v[224:227],a[196:199],v[152:155]
s_waitcnt lgkmcnt(1)
v_accvgpr_read_b32 v240,a84
v_accvgpr_read_b32 v238,a180
M v[156:159],v[224:227],a[200:203],v[156:159]
s_waitcnt vmcnt(16)
buffer_load_dwordx4 v[224:227],v253,s[20:23],s48 offen offset:0
M v[128:131],a[224:227],a[208:211],v[128:131]
buffer_store_dwordx4 v[20:23],v254,s[24:27],s37 offen offset:0
M v[132:135],a[224:227],a[212:215],v[132:135]
ds_read_b128 a[208:211],v251 offset:17408
ds_read_b128 a[212:215],v252 offset:17664
M v[136:139],a[224:227],a[216:219],v[136:139]
ds_read_b128 a[216:219],v252 offset:17920
v_add_f32 v236,v240,v238
M v[140:143],a[224:227],a[220:223],v[140:143]
ds_read_b128 a[220:223],v252 offset:18176
v_sub_f32 v240,v240,v238
M v[144:147],a[224:227],a[192:195],v[144:147]
ds_read_b128 a[192:195],v252 offset:18432
v_add_f32 v238,v84,v180
M v[148:151],a[224:227],a[196:199],v[148:151]
ds_read_b128 a[196:199],v252 offset:18688
v_sub_f32 v180,v84,v180
M v[152:155],a[224:227],a[200:203],v[152:155]
s_waitcnt lgkmcnt(6)
ds_read_b128 a[200:203],v252 offset:18944
v_add_f32 v84,v236,v238
M v[156:159],a[224:227],a[204:207],v[156:159]
s_waitcnt vmcnt(17) lgkmcnt(6)
buffer_load_dwordx4 a[224:227],v253,s[20:23],s48 offen offset:1024
M v[128:131],a[228:231],a[208:211],v[128:131]
s_waitcnt lgkmcnt(5)
ds_read_b128 a[204:207],v252 offset:19200
ds_read_b128 a[208:211],v252 offset:19456
M v[132:135],a[228:231],a[212:215],v[132:135]
s_waitcnt lgkmcnt(6)
v_fmac_f32 v236,4.0,v238
v_fma_f32 v238,2.0,v180,v240
M v[136:139],a[228:231],a[216:219],v[136:139]
s_waitcnt lgkmcnt(5)
v_fma_f32 v180,s41,v180,v240
v_accvgpr_read_b32 v240,a85
M v[140:143],a[228:231],a[220:223],v[140:143]
s_waitcnt lgkmcnt(4)
v_accvgpr_read_b32 v239,a181
v_add_f32 v237,v240,v239
M v[144:147],a[228:231],a[192:195],v[144:147]
s_waitcnt lgkmcnt(3)
v_sub_f32 v240,v240,v239
v_add_f32 v239,v85,v181
M v[148:151],a[228:231],a[196:199],v[148:151]
s_waitcnt lgkmcnt(2)
v_sub_f32 v181,v85,v181
v_add_f32 v85,v237,v239
M v[152:155],a[228:231],a[200:203],v[152:155]
s_waitcnt lgkmcnt(1)
v_fmac_f32 v237,4.0,v239
v_fma_f32 v239,2.0,v181,v240
M v[156:159],a[228:231],a[204:207],v[156:159]
s_waitcnt vmcnt(16)
buffer_load_dwordx4 a[228:231],v253,s[20:23],s48 offen offset:2048
M v[128:131],a[232:235],a[212:215],v[128:131]
buffer_store_dwordx4 v[24:27],v254,s[24:27],s38 offen offset:0
M v[132:135],a[232:235],a[216:219],v[132:135]
s_add_u32 s48,s44,116736
ds_read_b128 a[212:215],v251 offset:19712
v_fma_f32 v181,s41,v181,v240
M v[136:139],a[232:235],a[220:223],v[136:139]
v_cvt_pk_bf16_f32 v232,v238,v239
v_cvt_pk_bf16_f32 v234,v236,v237
M v[140:143],a[232:235],a[192:195],v[140:143]
v_accvgpr_read_b32 v240,a86
v_accvgpr_read_b32 v238,a182
M v[144:147],a[232:235],a[196:199],v[144:147]
v_add_f32 v236,v240,v238
v_sub_f32 v240,v240,v238
M v[148:151],a[232:235],a[200:203],v[148:151]
v_add_u32 v251,0xfffece00,v251
v_add_u32 v252,0xfffece00,v252
M v[152:155],a[232:235],a[204:207],v[152:155]
s_waitcnt lgkmcnt(1)
v_add_f32 v238,v86,v182
v_sub_f32 v182,v86,v182
M v[156:159],a[232:235],a[208:211],v[156:159]
s_waitcnt vmcnt(17)
buffer_load_dwordx4 a[232:235],v253,s[20:23],s48 offen offset:0
M v[128:131],a[236:239],a[216:219],v[128:131]
ds_read_b128 a[216:219],v251 offset:26112
v_add_f32 v86,v236,v238
M v[132:135],a[236:239],a[220:223],v[132:135]
ds_read_b128 a[220:223],v252 offset:26368
v_fmac_f32 v236,4.0,v238
M v[136:139],a[236:239],a[192:195],v[136:139]
ds_read_b128 a[192:195],v252 offset:26624
v_fma_f32 v238,2.0,v182,v240
M v[140:143],a[236:239],a[196:199],v[140:143]
ds_read_b128 a[196:199],v252 offset:26880
v_fma_f32 v182,s41,v182,v240
M v[144:147],a[236:239],a[200:203],v[144:147]
ds_read_b128 a[200:203],v252 offset:27136
v_accvgpr_read_b32 v240,a87
M v[148:151],a[236:239],a[204:207],v[148:151]
ds_read_b128 a[204:207],v252 offset:27392
v_accvgpr_read_b32 v239,a183
M v[152:155],a[236:239],a[208:211],v[152:155]
s_waitcnt lgkmcnt(6)
ds_read_b128 a[208:211],v252 offset:27648
v_add_f32 v237,v240,v239
M v[156:159],a[236:239],a[212:215],v[156:159]
s_waitcnt vmcnt(17) lgkmcnt(6)
buffer_load_dwordx4 a[236:239],v253,s[20:23],s48 offen offset:1024
M v[128:131],a[240:243],a[216:219],v[128:131]
s_waitcnt lgkmcnt(5)
ds_read_b128 a[212:215],v252 offset:27904
ds_read_b128 a[216:219],v252 offset:28160
v_sub_f32 v240,v240,v239
v_add_f32 v239,v87,v183
v_sub_f32 v183,v87,v183
v_add_f32 v87,v237,v239
M v[132:135],a[240:243],a[220:223],v[132:135]
s_waitcnt lgkmcnt(6)
buffer_store_dwordx4 v[28:31],v254,s[24:27],s39 offen offset:0
v_fmac_f32 v237,4.0,v239
v_fma_f32 v239,2.0,v183,v240
v_fma_f32 v183,s41,v183,v240
v_cvt_pk_bf16_f32 v233,v238,v239
M v[136:139],a[240:243],a[192:195],v[136:139]
s_waitcnt lgkmcnt(5)
v_cvt_pk_bf16_f32 v235,v236,v237
M v[140:143],a[240:243],a[196:199],v[140:143]
s_waitcnt lgkmcnt(4)
buffer_store_dwordx2 v[232:233],v255,s[24:27],s37 offen offset:384
buffer_store_dwordx2 v[234:235],v255,s[24:27],s37 offen offset:768
M v[144:147],a[240:243],a[200:203],v[144:147]
s_waitcnt lgkmcnt(3)
v_accvgpr_read_b32 v240,a88
v_accvgpr_read_b32 v238,a184
M v[148:151],a[240:243],a[204:207],v[148:151]
s_waitcnt lgkmcnt(2)
v_add_f32 v236,v240,v238
v_sub_f32 v240,v240,v238
M v[152:155],a[240:243],a[208:211],v[152:155]
s_waitcnt lgkmcnt(1)
v_add_f32 v238,v88,v184
v_sub_f32 v184,v88,v184
v_add_f32 v88,v236,v238
v_fmac_f32 v236,4.0,v238
M v[156:159],a[240:243],a[212:215],v[156:159]
s_waitcnt vmcnt(18)
buffer_load_dwordx4 a[240:243],v253,s[20:23],s48 offen offset:2048
v_fma_f32 v238,2.0,v184,v240
v_fma_f32 v184,s41,v184,v240
v_accvgpr_read_b32 v240,a89
v_accvgpr_read_b32 v239,a185
M v[128:131],a[244:247],a[220:223],v[128:131]
ds_read_b128 a[220:223],v251 offset:28416
v_add_f32 v237,v240,v239
v_sub_f32 v240,v240,v239
v_add_f32 v239,v89,v185
v_sub_f32 v185,v89,v185
M v[132:135],a[244:247],a[192:195],v[132:135]
s_add_u32 s48,s44,172032
v_add_f32 v89,v237,v239
v_fmac_f32 v237,4.0,v239
v_fma_f32 v239,2.0,v185,v240
v_fma_f32 v185,s41,v185,v240
M v[136:139],a[244:247],a[196:199],v[136:139]
v_cvt_pk_bf16_f32 v228,v238,v239
v_cvt_pk_bf16_f32 v230,v236,v237
v_accvgpr_read_b32 v240,a90
v_accvgpr_read_b32 v238,a186
M v[140:143],a[244:247],a[200:203],v[140:143]
v_add_f32 v236,v240,v238
v_sub_f32 v240,v240,v238
v_add_f32 v238,v90,v186
v_sub_f32 v186,v90,v186
M v[144:147],a[244:247],a[204:207],v[144:147]
v_add_f32 v90,v236,v238
v_fmac_f32 v236,4.0,v238
v_fma_f32 v238,2.0,v186,v240
v_fma_f32 v186,s41,v186,v240
M v[148:151],a[244:247],a[208:211],v[148:151]
v_accvgpr_read_b32 v240,a91
v_accvgpr_read_b32 v239,a187
v_add_f32 v237,v240,v239
v_sub_f32 v240,v240,v239
M v[152:155],a[244:247],a[212:215],v[152:155]
s_waitcnt lgkmcnt(1)
v_add_f32 v239,v91,v187
v_sub_f32 v187,v91,v187
v_add_f32 v91,v237,v239
v_fmac_f32 v237,4.0,v239
M v[156:159],a[244:247],a[216:219],v[156:159]
s_waitcnt vmcnt(17)
buffer_load_dwordx4 a[244:247],v253,s[20:23],s48 offen offset:0
v_fma_f32 v239,2.0,v187,v240
v_fma_f32 v187,s41,v187,v240
v_cvt_pk_bf16_f32 v229,v238,v239
v_cvt_pk_bf16_f32 v231,v236,v237
M v[128:131],a[248:251],a[192:195],v[128:131]
buffer_store_dwordx2 v[228:229],v255,s[24:27],s38 offen offset:384
M v[132:135],a[248:251],a[196:199],v[132:135]
ds_read_b128 a[192:195],v251 offset:0
buffer_store_dwordx2 v[230:231],v255,s[24:27],s38 offen offset:768
M v[136:139],a[248:251],a[200:203],v[136:139]
ds_read_b128 a[196:199],v252 offset:256
ds_read_b128 a[200:203],v252 offset:512
v_accvgpr_read_b32 v240,a92
M v[140:143],a[248:251],a[204:207],v[140:143]
ds_read_b128 a[204:207],v252 offset:768
v_accvgpr_read_b32 v238,a188
v_add_f32 v236,v240,v238
v_sub_f32 v240,v240,v238
v_add_f32 v238,v92,v188
M v[144:147],a[248:251],a[208:211],v[144:147]
ds_read_b128 a[208:211],v252 offset:1024
v_sub_f32 v188,v92,v188
v_add_f32 v92,v236,v238
v_fmac_f32 v236,4.0,v238
v_fma_f32 v238,2.0,v188,v240
M v[148:151],a[248:251],a[212:215],v[148:151]
ds_read_b128 a[212:215],v252 offset:1280
v_fma_f32 v188,s41,v188,v240
v_accvgpr_read_b32 v240,a93
v_accvgpr_read_b32 v239,a189
v_add_f32 v237,v240,v239
M v[152:155],a[248:251],a[216:219],v[152:155]
s_waitcnt lgkmcnt(6)
ds_read_b128 a[216:219],v252 offset:1536
v_sub_f32 v240,v240,v239
v_add_f32 v239,v93,v189
v_sub_f32 v189,v93,v189
v_add_f32 v93,v237,v239
M v[156:159],a[248:251],a[220:223],v[156:159]
s_waitcnt vmcnt(19) lgkmcnt(6)
buffer_load_dwordx4 a[248:251],v253,s[20:23],s48 offen offset:1024
v_fmac_f32 v237,4.0,v239
v_fma_f32 v239,2.0,v189,v240
v_fma_f32 v189,s41,v189,v240
v_cvt_pk_bf16_f32 v232,v238,v239
M v[64:67],a[252:255],a[192:195],v[64:67]
s_waitcnt lgkmcnt(5)
ds_read_b128 a[220:223],v252 offset:1792
ds_read_b128 a[192:195],v252 offset:2048
v_cvt_pk_bf16_f32 v234,v236,v237
v_accvgpr_read_b32 v240,a94
v_accvgpr_read_b32 v238,a190
v_add_f32 v236,v240,v238
M v[68:71],a[252:255],a[196:199],v[68:71]
s_waitcnt lgkmcnt(6)
v_sub_f32 v240,v240,v238
v_add_f32 v238,v94,v190
v_sub_f32 v190,v94,v190
v_add_f32 v94,v236,v238
M v[72:75],a[252:255],a[200:203],v[72:75]
s_waitcnt lgkmcnt(5)
v_fmac_f32 v236,4.0,v238
v_fma_f32 v238,2.0,v190,v240
v_fma_f32 v190,s41,v190,v240
v_accvgpr_read_b32 v240,a95
M v[76:79],a[252:255],a[204:207],v[76:79]
s_waitcnt lgkmcnt(4)
v_accvgpr_read_b32 v239,a191
v_add_f32 v237,v240,v239
v_sub_f32 v240,v240,v239
v_add_f32 v239,v95,v191
M v[80:83],a[252:255],a[208:211],v[80:83]
s_waitcnt lgkmcnt(3)
v_sub_f32 v191,v95,v191
v_cvt_pk_bf16_f32 v98,v128,v129
M v[84:87],a[252:255],a[212:215],v[84:87]
s_waitcnt lgkmcnt(2)
v_cvt_pk_bf16_f32 v99,v130,v131
v_add_f32 v95,v237,v239
M v[88:91],a[252:255],a[216:219],v[88:91]
s_waitcnt lgkmcnt(1)
buffer_store_dwordx4 v[96:99],v254,s[24:27],s32 offen offset:1152
M v[92:95],a[252:255],a[220:223],v[92:95]
s_waitcnt vmcnt(19)
buffer_load_dwordx4 a[252:255],v253,s[20:23],s48 offen offset:2048
M v[64:67],v[216:219],a[196:199],v[64:67]
ds_read_b128 a[196:199],v251 offset:2304
v_cvt_pk_bf16_f32 v102,v132,v133
M v[68:71],v[216:219],a[200:203],v[68:71]
s_add_u32 s48,s44,227328
v_cvt_pk_bf16_f32 v103,v134,v135
v_cvt_pk_bf16_f32 v106,v136,v137
M v[72:75],v[216:219],a[204:207],v[72:75]
v_cvt_pk_bf16_f32 v107,v138,v139
v_cvt_pk_bf16_f32 v110,v140,v141
M v[76:79],v[216:219],a[208:211],v[76:79]
buffer_store_dwordx4 v[100:103],v254,s[24:27],s33 offen offset:1152
M v[80:83],v[216:219],a[212:215],v[80:83]
v_cvt_pk_bf16_f32 v111,v142,v143
v_cvt_pk_bf16_f32 v114,v144,v145
M v[84:87],v[216:219],a[216:219],v[84:87]
v_cvt_pk_bf16_f32 v115,v146,v147
v_cvt_pk_bf16_f32 v118,v148,v149
M v[88:91],v[216:219],a[220:223],v[88:91]
s_waitcnt lgkmcnt(1)
v_cvt_pk_bf16_f32 v119,v150,v151
v_cvt_pk_bf16_f32 v122,v152,v153
M v[92:95],v[216:219],a[192:195],v[92:95]
s_waitcnt vmcnt(20)
buffer_load_dwordx4 v[216:219],v253,s[20:23],s48 offen offset:0
M v[64:67],v[220:223],a[200:203],v[64:67]
ds_read_b128 a[200:203],v251 offset:34816
v_cvt_pk_bf16_f32 v123,v154,v155
M v[68:71],v[220:223],a[204:207],v[68:71]
ds_read_b128 a[204:207],v252 offset:35072
v_cvt_pk_bf16_f32 v126,v156,v157
M v[72:75],v[220:223],a[208:211],v[72:75]
ds_read_b128 a[208:211],v252 offset:35328
v_cvt_pk_bf16_f32 v127,v158,v159
M v[76:79],v[220:223],a[212:215],v[76:79]
ds_read_b128 a[212:215],v252 offset:35584
v_fmac_f32 v237,4.0,v239
M v[80:83],v[220:223],a[216:219],v[80:83]
ds_read_b128 a[216:219],v252 offset:35840
v_fma_f32 v239,2.0,v191,v240
M v[84:87],v[220:223],a[220:223],v[84:87]
ds_read_b128 a[220:223],v252 offset:36096
v_fma_f32 v191,s41,v191,v240
M v[88:91],v[220:223],a[192:195],v[88:91]
s_waitcnt lgkmcnt(6)
ds_read_b128 a[192:195],v252 offset:36352
v_cvt_pk_bf16_f32 v233,v238,v239
M v[92:95],v[220:223],a[196:199],v[92:95]
s_waitcnt vmcnt(18) lgkmcnt(6)
buffer_load_dwordx4 v[220:223],v253,s[20:23],s48 offen offset:1024
M v[64:67],v[224:227],a[200:203],v[64:67]
s_waitcnt lgkmcnt(5)
ds_read_b128 a[196:199],v252 offset:36608
ds_read_b128 a[200:203],v252 offset:36864
M v[68:71],v[224:227],a[204:207],v[68:71]
s_waitcnt lgkmcnt(6)
v_cvt_pk_bf16_f32 v235,v236,v237
M v[72:75],v[224:227],a[208:211],v[72:75]
s_waitcnt lgkmcnt(5)
buffer_store_dwordx2 v[232:233],v255,s[24:27],s39 offen offset:384
M v[76:79],v[224:227],a[212:215],v[76:79]
s_waitcnt lgkmcnt(4)
buffer_store_dwordx2 v[234:235],v255,s[24:27],s39 offen offset:768
M v[80:83],v[224:227],a[216:219],v[80:83]
s_waitcnt lgkmcnt(3)
buffer_store_dwordx4 v[104:107],v254,s[24:27],s34 offen offset:1152
M v[84:87],v[224:227],a[220:223],v[84:87]
s_waitcnt lgkmcnt(2)
M v[88:91],v[224:227],a[192:195],v[88:91]
s_waitcnt lgkmcnt(1)
M v[92:95],v[224:227],a[196:199],v[92:95]
s_waitcnt vmcnt(20)
buffer_load_dwordx4 v[224:227],v253,s[20:23],s48 offen offset:2048
M v[64:67],a[224:227],a[204:207],v[64:67]
ds_read_b128 a[204:207],v251 offset:37120
M v[68:71],a[224:227],a[208:211],v[68:71]
s_add_u32 s48,s44,282624
M v[72:75],a[224:227],a[212:215],v[72:75]
M v[76:79],a[224:227],a[216:219],v[76:79]
M v[80:83],a[224:227],a[220:223],v[80:83]
M v[84:87],a[224:227],a[192:195],v[84:87]
M v[88:91],a[224:227],a[196:199],v[88:91]
s_waitcnt lgkmcnt(1)
M v[92:95],a[224:227],a[200:203],v[92:95]
s_waitcnt vmcnt(20)
buffer_load_dwordx4 a[224:227],v253,s[20:23],s48 offen offset:0
M v[64:67],a[228:231],a[208:211],v[64:67]
ds_read_b128 a[208:211],v251 offset:52224
M v[68:71],a[228:231],a[212:215],v[68:71]
ds_read_b128 a[212:215],v252 offset:52480
M v[72:75],a[228:231],a[216:219],v[72:75]
ds_read_b128 a[216:219],v252 offset:52736
M v[76:79],a[228:231],a[220:223],v[76:79]
ds_read_b128 a[220:223],v252 offset:52992
M v[80:83],a[228:231],a[192:195],v[80:83]
ds_read_b128 a[192:195],v252 offset:53248
M v[84:87],a[228:231],a[196:199],v[84:87]
buffer_store_dwordx4 v[108:111],v254,s[24:27],s35 offen offset:1152
M v[88:91],a[228:231],a[200:203],v[88:91]
s_waitcnt lgkmcnt(5)
ds_read_b128 a[196:199],v252 offset:53504
ds_read_b128 a[200:203],v252 offset:53760
M v[92:95],a[228:231],a[204:207],v[92:95]
s_waitcnt vmcnt(20) lgkmcnt(6)
buffer_load_dwordx4 a[228:231],v253,s[20:23],s48 offen offset:1024
M v[64:67],a[232:235],a[208:211],v[64:67]
s_waitcnt lgkmcnt(5)
ds_read_b128 a[204:207],v252 offset:54016
ds_read_b128 a[208:211],v252 offset:54272
M v[68:71],a[232:235],a[212:215],v[68:71]
s_waitcnt lgkmcnt(6)
M v[72:75],a[232:235],a[216:219],v[72:75]
s_waitcnt lgkmcnt(5)
M v[76:79],a[232:235],a[220:223],v[76:79]
s_waitcnt lgkmcnt(4)
M v[80:83],a[232:235],a[192:195],v[80:83]
s_waitcnt lgkmcnt(3)
M v[84:87],a[232:235],a[196:199],v[84:87]
s_waitcnt lgkmcnt(2)
M v[88:91],a[232:235],a[200:203],v[88:91]
s_waitcnt lgkmcnt(1)
M v[92:95],a[232:235],a[204:207],v[92:95]
s_waitcnt vmcnt(20)
buffer_load_dwordx4 a[232:235],v253,s[20:23],s48 offen offset:2048
M v[64:67],a[236:239],a[212:215],v[64:67]
ds_read_b128 a[212:215],v251 offset:54528
M v[68:71],a[236:239],a[216:219],v[68:71]
s_add_u32 s48,s44,52224
M v[72:75],a[236:239],a[220:223],v[72:75]
M v[76:79],a[236:239],a[192:195],v[76:79]
M v[80:83],a[236:239],a[196:199],v[80:83]
M v[84:87],a[236:239],a[200:203],v[84:87]
v_add_u32 v251,0x11000,v251
v_add_u32 v252,0x11000,v252
M v[88:91],a[236:239],a[204:207],v[88:91]
s_waitcnt lgkmcnt(1)
buffer_store_dwordx4 v[112:115],v254,s[24:27],s36 offen offset:1152
M v[92:95],a[236:239],a[208:211],v[92:95]
s_waitcnt vmcnt(18)
buffer_load_dwordx4 a[236:239],v253,s[20:23],s48 offen offset:0
M v[64:67],a[240:243],a[216:219],v[64:67]
ds_read_b128 a[216:219],v251 offset:0
M v[68:71],a[240:243],a[220:223],v[68:71]
ds_read_b128 a[220:223],v252 offset:256
M v[72:75],a[240:243],a[192:195],v[72:75]
ds_read_b128 a[192:195],v252 offset:512
M v[76:79],a[240:243],a[196:199],v[76:79]
ds_read_b128 a[196:199],v252 offset:768
M v[80:83],a[240:243],a[200:203],v[80:83]
ds_read_b128 a[200:203],v252 offset:1024
M v[84:87],a[240:243],a[204:207],v[84:87]
ds_read_b128 a[204:207],v252 offset:1280
M v[88:91],a[240:243],a[208:211],v[88:91]
s_waitcnt lgkmcnt(6)
ds_read_b128 a[208:211],v252 offset:1536
M v[92:95],a[240:243],a[212:215],v[92:95]
s_waitcnt vmcnt(18) lgkmcnt(6)
buffer_load_dwordx4 a[240:243],v253,s[20:23],s48 offen offset:1024
M v[64:67],a[244:247],a[216:219],v[64:67]
s_waitcnt lgkmcnt(5)
ds_read_b128 a[212:215],v252 offset:1792
ds_read_b128 a[216:219],v252 offset:2048
M v[68:71],a[244:247],a[220:223],v[68:71]
s_waitcnt lgkmcnt(6)
M v[72:75],a[244:247],a[192:195],v[72:75]
s_waitcnt lgkmcnt(5)
M v[76:79],a[244:247],a[196:199],v[76:79]
s_waitcnt lgkmcnt(4)
M v[80:83],a[244:247],a[200:203],v[80:83]
s_waitcnt lgkmcnt(3)
M v[84:87],a[244:247],a[204:207],v[84:87]
s_waitcnt lgkmcnt(2)
M v[88:91],a[244:247],a[208:211],v[88:91]
s_waitcnt lgkmcnt(1)
M v[92:95],a[244:247],a[212:215],v[92:95]
s_waitcnt vmcnt(16)
buffer_load_dwordx4 a[244:247],v253,s[20:23],s48 offen offset:2048
M v[64:67],a[248:251],a[220:223],v[64:67]
buffer_store_dwordx4 v[116:119],v254,s[24:27],s37 offen offset:1152
M v[68:71],a[248:251],a[192:195],v[68:71]
s_add_u32 s48,s44,107520
ds_read_b128 a[220:223],v251 offset:2304
M v[72:75],a[248:251],a[196:199],v[72:75]
M v[76:79],a[248:251],a[200:203],v[76:79]
M v[80:83],a[248:251],a[204:207],v[80:83]
M v[84:87],a[248:251],a[208:211],v[84:87]
M v[88:91],a[248:251],a[212:215],v[88:91]
s_waitcnt lgkmcnt(1)
M v[92:95],a[248:251],a[216:219],v[92:95]
s_waitcnt vmcnt(16)
buffer_load_dwordx4 a[248:251],v253,s[20:23],s48 offen offset:0
M v[64:67],a[252:255],a[192:195],v[64:67]
ds_read_b128 a[192:195],v251 offset:17408
M v[68:71],a[252:255],a[196:199],v[68:71]
ds_read_b128 a[196:199],v252 offset:17664
M v[72:75],a[252:255],a[200:203],v[72:75]
ds_read_b128 a[200:203],v252 offset:17920
M v[76:79],a[252:255],a[204:207],v[76:79]
ds_read_b128 a[204:207],v252 offset:18176
M v[80:83],a[252:255],a[208:211],v[80:83]
ds_read_b128 a[208:211],v252 offset:18432
M v[84:87],a[252:255],a[212:215],v[84:87]
ds_read_b128 a[212:215],v252 offset:18688
M v[88:91],a[252:255],a[216:219],v[88:91]
s_waitcnt lgkmcnt(6)
ds_read_b128 a[216:219],v252 offset:18944
M v[92:95],a[252:255],a[220:223],v[92:95]
s_waitcnt vmcnt(15) lgkmcnt(6)
buffer_load_dwordx4 a[252:255],v253,s[20:23],s48 offen offset:1024
M v[64:67],v[216:219],a[192:195],v[64:67]
s_waitcnt lgkmcnt(5)
ds_read_b128 a[220:223],v252 offset:19200
buffer_store_dwordx4 v[120:123],v254,s[24:27],s38 offen offset:1152
M v[68:71],v[216:219],a[196:199],v[68:71]
s_waitcnt lgkmcnt(5)
ds_read_b128 a[192:195],v252 offset:19456
M v[72:75],v[216:219],a[200:203],v[72:75]
s_waitcnt lgkmcnt(5)
M v[76:79],v[216:219],a[204:207],v[76:79]
s_waitcnt lgkmcnt(4)
M v[80:83],v[216:219],a[208:211],v[80:83]
s_waitcnt lgkmcnt(3)
M v[84:87],v[216:219],a[212:215],v[84:87]
s_waitcnt lgkmcnt(2)
M v[88:91],v[216:219],a[216:219],v[88:91]
s_waitcnt lgkmcnt(1)
M v[92:95],v[216:219],a[220:223],v[92:95]
s_waitcnt vmcnt(16)
buffer_load_dwordx4 v[216:219],v253,s[20:23],s48 offen offset:2048
M v[64:67],v[220:223],a[196:199],v[64:67]
ds_read_b128 a[196:199],v251 offset:19712
M v[68:71],v[220:223],a[200:203],v[68:71]
s_add_u32 s48,s44,162816
M v[72:75],v[220:223],a[204:207],v[72:75]
M v[76:79],v[220:223],a[208:211],v[76:79]
M v[80:83],v[220:223],a[212:215],v[80:83]
M v[84:87],v[220:223],a[216:219],v[84:87]
v_add_u32 v251,0xffff1200,v251
v_add_u32 v252,0xffff1200,v252
M v[88:91],v[220:223],a[220:223],v[88:91]
s_waitcnt lgkmcnt(1)
M v[92:95],v[220:223],a[192:195],v[92:95]
s_waitcnt vmcnt(13)
buffer_load_dwordx4 v[220:223],v253,s[20:23],s48 offen offset:0
M v[64:67],v[224:227],a[200:203],v[64:67]
ds_read_b128 a[200:203],v251 offset:8704
M v[68:71],v[224:227],a[204:207],v[68:71]
buffer_store_dwordx4 v[124:127],v254,s[24:27],s39 offen offset:1152
M v[72:75],v[224:227],a[208:211],v[72:75]
ds_read_b128 a[204:207],v252 offset:8960
ds_read_b128 a[208:211],v252 offset:9216
M v[76:79],v[224:227],a[212:215],v[76:79]
ds_read_b128 a[212:215],v252 offset:9472
M v[80:83],v[224:227],a[216:219],v[80:83]
ds_read_b128 a[216:219],v252 offset:9728
M v[84:87],v[224:227],a[220:223],v[84:87]
ds_read_b128 a[220:223],v252 offset:9984
M v[88:91],v[224:227],a[192:195],v[88:91]
s_waitcnt lgkmcnt(6)
ds_read_b128 a[192:195],v252 offset:10240
M v[92:95],v[224:227],a[196:199],v[92:95]
s_waitcnt vmcnt(14) lgkmcnt(6)
buffer_load_dwordx4 v[224:227],v253,s[20:23],s48 offen offset:1024
M v[64:67],a[224:227],a[200:203],v[64:67]
s_waitcnt lgkmcnt(5)
ds_read_b128 a[196:199],v252 offset:10496
ds_read_b128 a[200:203],v252 offset:10752
M v[68:71],a[224:227],a[204:207],v[68:71]
s_waitcnt lgkmcnt(6)
M v[72:75],a[224:227],a[208:211],v[72:75]
s_waitcnt lgkmcnt(5)
M v[76:79],a[224:227],a[212:215],v[76:79]
s_waitcnt lgkmcnt(4)
M v[80:83],a[224:227],a[216:219],v[80:83]
s_waitcnt lgkmcnt(3)
M v[84:87],a[224:227],a[220:223],v[84:87]
s_waitcnt lgkmcnt(2)
M v[88:91],a[224:227],a[192:195],v[88:91]
s_waitcnt lgkmcnt(1)
M v[92:95],a[224:227],a[196:199],v[92:95]
s_waitcnt vmcnt(13)
buffer_load_dwordx4 a[224:227],v253,s[20:23],s48 offen offset:2048
M v[64:67],a[228:231],a[204:207],v[64:67]
ds_read_b128 a[204:207],v251 offset:11008
M v[68:71],a[228:231],a[208:211],v[68:71]
s_add_u32 s48,s44,218112
M v[72:75],a[228:231],a[212:215],v[72:75]
M v[76:79],a[228:231],a[216:219],v[76:79]
M v[80:83],a[228:231],a[220:223],v[80:83]
M v[84:87],a[228:231],a[192:195],v[84:87]
M v[88:91],a[228:231],a[196:199],v[88:91]
s_waitcnt lgkmcnt(1)
M v[92:95],a[228:231],a[200:203],v[92:95]
s_waitcnt vmcnt(13)
buffer_load_dwordx4 a[228:231],v253,s[20:23],s48 offen offset:0
M v[64:67],a[232:235],a[208:211],v[64:67]
ds_read_b128 a[208:211],v251 offset:0
M v[68:71],a[232:235],a[212:215],v[68:71]
ds_read_b128 a[212:215],v252 offset:256
M v[72:75],a[232:235],a[216:219],v[72:75]
ds_read_b128 a[216:219],v252 offset:512
M v[76:79],a[232:235],a[220:223],v[76:79]
ds_read_b128 a[220:223],v252 offset:768
s_nop 0
v_cvt_pk_bf16_f32 v64,v64,v65
M v[80:83],a[232:235],a[192:195],v[80:83]
ds_read_b128 a[192:195],v252 offset:1024
v_cvt_pk_bf16_f32 v65,v66,v67
M v[84:87],a[232:235],a[196:199],v[84:87]
buffer_store_dwordx2 v[64:65],v255,s[24:27],s32 offen offset:0
M v[88:91],a[232:235],a[200:203],v[88:91]
s_waitcnt lgkmcnt(5)
ds_read_b128 a[196:199],v252 offset:1280
ds_read_b128 a[200:203],v252 offset:1536
M v[92:95],a[232:235],a[204:207],v[92:95]
s_waitcnt vmcnt(13) lgkmcnt(6)
buffer_load_dwordx4 a[232:235],v253,s[20:23],s48 offen offset:1024
M v[160:163],a[236:239],a[208:211],v[160:163]
s_waitcnt lgkmcnt(5)
ds_read_b128 a[204:207],v252 offset:1792
ds_read_b128 a[208:211],v252 offset:2048
M v[164:167],a[236:239],a[212:215],v[164:167]
s_waitcnt lgkmcnt(6)
v_cvt_pk_bf16_f32 v68,v68,v69
v_cvt_pk_bf16_f32 v69,v70,v71
M v[168:171],a[236:239],a[216:219],v[168:171]
s_waitcnt lgkmcnt(5)
buffer_store_dwordx2 v[68:69],v255,s[24:27],s33 offen offset:0
M v[172:175],a[236:239],a[220:223],v[172:175]
s_waitcnt lgkmcnt(4)
v_cvt_pk_bf16_f32 v72,v72,v73
v_cvt_pk_bf16_f32 v73,v74,v75
M v[176:179],a[236:239],a[192:195],v[176:179]
s_waitcnt lgkmcnt(3)
buffer_store_dwordx2 v[72:73],v255,s[24:27],s34 offen offset:0
M v[180:183],a[236:239],a[196:199],v[180:183]
s_waitcnt lgkmcnt(2)
v_cvt_pk_bf16_f32 v76,v76,v77
v_cvt_pk_bf16_f32 v77,v78,v79
M v[184:187],a[236:239],a[200:203],v[184:187]
s_waitcnt lgkmcnt(1)
buffer_store_dwordx2 v[76:77],v255,s[24:27],s35 offen offset:0
M v[188:191],a[236:239],a[204:207],v[188:191]
s_waitcnt vmcnt(16)
buffer_load_dwordx4 a[236:239],v253,s[20:23],s48 offen offset:2048
M v[160:163],a[240:243],a[212:215],v[160:163]
ds_read_b128 a[212:215],v251 offset:2304
v_cvt_pk_bf16_f32 v80,v80,v81
M v[164:167],a[240:243],a[216:219],v[164:167]
s_add_u32 s48,s44,273408
v_cvt_pk_bf16_f32 v81,v82,v83
v_cvt_pk_bf16_f32 v84,v84,v85
M v[168:171],a[240:243],a[220:223],v[168:171]
buffer_store_dwordx2 v[80:81],v255,s[24:27],s36 offen offset:0
M v[172:175],a[240:243],a[192:195],v[172:175]
v_cvt_pk_bf16_f32 v85,v86,v87
v_cvt_pk_bf16_f32 v88,v88,v89
M v[176:179],a[240:243],a[196:199],v[176:179]
buffer_store_dwordx2 v[84:85],v255,s[24:27],s37 offen offset:0
M v[180:183],a[240:243],a[200:203],v[180:183]
v_cvt_pk_bf16_f32 v89,v90,v91
v_cvt_pk_bf16_f32 v92,v92,v93
M v[184:187],a[240:243],a[204:207],v[184:187]
s_waitcnt lgkmcnt(1)
buffer_store_dwordx2 v[88:89],v255,s[24:27],s38 offen offset:0
M v[188:191],a[240:243],a[208:211],v[188:191]
s_waitcnt vmcnt(19)
buffer_load_dwordx4 a[240:243],v253,s[20:23],s48 offen offset:0
M v[160:163],a[244:247],a[216:219],v[160:163]
ds_read_b128 a[216:219],v251 offset:34816
v_cvt_pk_bf16_f32 v93,v94,v95
M v[164:167],a[244:247],a[220:223],v[164:167]
ds_read_b128 a[220:223],v252 offset:35072
buffer_store_dwordx2 v[92:93],v255,s[24:27],s39 offen offset:0
M v[168:171],a[244:247],a[192:195],v[168:171]
ds_read_b128 a[192:195],v252 offset:35328
M v[172:175],a[244:247],a[196:199],v[172:175]
ds_read_b128 a[196:199],v252 offset:35584
M v[176:179],a[244:247],a[200:203],v[176:179]
ds_read_b128 a[200:203],v252 offset:35840
M v[180:183],a[244:247],a[204:207],v[180:183]
ds_read_b128 a[204:207],v252 offset:36096
M v[184:187],a[244:247],a[208:211],v[184:187]
s_waitcnt lgkmcnt(6)
ds_read_b128 a[208:211],v252 offset:36352
M v[188:191],a[244:247],a[212:215],v[188:191]
s_waitcnt vmcnt(19) lgkmcnt(6)
buffer_load_dwordx4 a[244:247],v253,s[20:23],s48 offen offset:1024
M v[160:163],a[248:251],a[216:219],v[160:163]
s_waitcnt lgkmcnt(5)
ds_read_b128 a[212:215],v252 offset:36608
ds_read_b128 a[216:219],v252 offset:36864
M v[164:167],a[248:251],a[220:223],v[164:167]
s_waitcnt lgkmcnt(6)
M v[168:171],a[248:251],a[192:195],v[168:171]
s_waitcnt lgkmcnt(5)
M v[172:175],a[248:251],a[196:199],v[172:175]
s_waitcnt lgkmcnt(4)
M v[176:179],a[248:251],a[200:203],v[176:179]
s_waitcnt lgkmcnt(3)
M v[180:183],a[248:251],a[204:207],v[180:183]
s_waitcnt lgkmcnt(2)
M v[184:187],a[248:251],a[208:211],v[184:187]
s_waitcnt lgkmcnt(1)
M v[188:191],a[248:251],a[212:215],v[188:191]
s_waitcnt vmcnt(19)
buffer_load_dwordx4 a[248:251],v253,s[20:23],s48 offen offset:2048
M v[160:163],a[252:255],a[220:223],v[160:163]
ds_read_b128 a[220:223],v251 offset:37120
M v[164:167],a[252:255],a[192:195],v[164:167]
s_add_u32 s48,s44,328704
M v[168:171],a[252:255],a[196:199],v[168:171]
M v[172:175],a[252:255],a[200:203],v[172:175]
M v[176:179],a[252:255],a[204:207],v[176:179]
M v[180:183],a[252:255],a[208:211],v[180:183]
M v[184:187],a[252:255],a[212:215],v[184:187]
s_waitcnt lgkmcnt(1)
M v[188:191],a[252:255],a[216:219],v[188:191]
s_waitcnt vmcnt(18)
buffer_load_dwordx4 a[252:255],v253,s[20:23],s48 offen offset:0
M v[160:163],v[216:219],a[192:195],v[160:163]
ds_read_b128 a[192:195],v251 offset:52224
M v[164:167],v[216:219],a[196:199],v[164:167]
ds_read_b128 a[196:199],v252 offset:52480
M v[168:171],v[216:219],a[200:203],v[168:171]
ds_read_b128 a[200:203],v252 offset:52736
M v[172:175],v[216:219],a[204:207],v[172:175]
ds_read_b128 a[204:207],v252 offset:52992
M v[176:179],v[216:219],a[208:211],v[176:179]
ds_read_b128 a[208:211],v252 offset:53248
M v[180:183],v[216:219],a[212:215],v[180:183]
ds_read_b128 a[212:215],v252 offset:53504
M v[184:187],v[216:219],a[216:219],v[184:187]
s_waitcnt lgkmcnt(6)
ds_read_b128 a[216:219],v252 offset:53760
M v[188:191],v[216:219],a[220:223],v[188:191]
s_waitcnt vmcnt(18) lgkmcnt(6)
buffer_load_dwordx4 v[216:219],v253,s[20:23],s48 offen offset:1024
M v[160:163],v[220:223],a[192:195],v[160:163]
s_waitcnt lgkmcnt(5)
ds_read_b128 a[220:223],v252 offset:54016
ds_read_b128 a[192:195],v252 offset:54272
M v[164:167],v[220:223],a[196:199],v[164:167]
s_waitcnt lgkmcnt(6)
M v[168:171],v[220:223],a[200:203],v[168:171]
s_waitcnt lgkmcnt(5)
M v[172:175],v[220:223],a[204:207],v[172:175]
s_waitcnt lgkmcnt(4)
M v[176:179],v[220:223],a[208:211],v[176:179]
s_waitcnt lgkmcnt(3)
M v[180:183],v[220:223],a[212:215],v[180:183]
s_waitcnt lgkmcnt(2)
M v[184:187],v[220:223],a[216:219],v[184:187]
s_waitcnt lgkmcnt(1)
M v[188:191],v[220:223],a[220:223],v[188:191]
s_waitcnt vmcnt(17)
buffer_load_dwordx4 v[220:223],v253,s[20:23],s48 offen offset:2048
M v[160:163],v[224:227],a[196:199],v[160:163]
ds_read_b128 a[196:199],v251 offset:54528
M v[164:167],v[224:227],a[200:203],v[164:167]
M v[168:171],v[224:227],a[204:207],v[168:171]
M v[172:175],v[224:227],a[208:211],v[172:175]
M v[176:179],v[224:227],a[212:215],v[176:179]
M v[180:183],v[224:227],a[216:219],v[180:183]
v_add_u32 v251,0x11000,v251
v_add_u32 v252,0x11000,v252
M v[184:187],v[224:227],a[220:223],v[184:187]
s_waitcnt lgkmcnt(1)
M v[188:191],v[224:227],a[192:195],v[188:191]
s_waitcnt vmcnt(17)
M v[160:163],a[224:227],a[200:203],v[160:163]
ds_read_b128 a[200:203],v251 offset:0
M v[164:167],a[224:227],a[204:207],v[164:167]
ds_read_b128 a[204:207],v252 offset:256
M v[168:171],a[224:227],a[208:211],v[168:171]
ds_read_b128 a[208:211],v252 offset:512
M v[172:175],a[224:227],a[212:215],v[172:175]
ds_read_b128 a[212:215],v252 offset:768
M v[176:179],a[224:227],a[216:219],v[176:179]
ds_read_b128 a[216:219],v252 offset:1024
M v[180:183],a[224:227],a[220:223],v[180:183]
ds_read_b128 a[220:223],v252 offset:1280
M v[184:187],a[224:227],a[192:195],v[184:187]
s_waitcnt lgkmcnt(6)
ds_read_b128 a[192:195],v252 offset:1536
M v[188:191],a[224:227],a[196:199],v[188:191]
s_waitcnt vmcnt(16) lgkmcnt(6)
ds_read_b128 a[196:199],v252 offset:1792
M v[160:163],a[228:231],a[200:203],v[160:163]
s_waitcnt lgkmcnt(6)
ds_read_b128 a[200:203],v252 offset:2048
M v[164:167],a[228:231],a[204:207],v[164:167]
s_waitcnt lgkmcnt(6)
M v[168:171],a[228:231],a[208:211],v[168:171]
s_waitcnt lgkmcnt(5)
M v[172:175],a[228:231],a[212:215],v[172:175]
s_waitcnt lgkmcnt(4)
M v[176:179],a[228:231],a[216:219],v[176:179]
s_waitcnt lgkmcnt(3)
M v[180:183],a[228:231],a[220:223],v[180:183]
s_waitcnt lgkmcnt(2)
M v[184:187],a[228:231],a[192:195],v[184:187]
s_waitcnt lgkmcnt(1)
M v[188:191],a[228:231],a[196:199],v[188:191]
s_waitcnt vmcnt(14)
M v[160:163],a[232:235],a[204:207],v[160:163]
ds_read_b128 a[204:207],v251 offset:2304
M v[164:167],a[232:235],a[208:211],v[164:167]
M v[168:171],a[232:235],a[212:215],v[168:171]
M v[172:175],a[232:235],a[216:219],v[172:175]
M v[176:179],a[232:235],a[220:223],v[176:179]
M v[180:183],a[232:235],a[192:195],v[180:183]
M v[184:187],a[232:235],a[196:199],v[184:187]
s_waitcnt lgkmcnt(1)
M v[188:191],a[232:235],a[200:203],v[188:191]
s_waitcnt vmcnt(10)
M v[160:163],a[236:239],a[208:211],v[160:163]
ds_read_b128 a[208:211],v251 offset:17408
M v[164:167],a[236:239],a[212:215],v[164:167]
ds_read_b128 a[212:215],v252 offset:17664
M v[168:171],a[236:239],a[216:219],v[168:171]
ds_read_b128 a[216:219],v252 offset:17920
M v[172:175],a[236:239],a[220:223],v[172:175]
ds_read_b128 a[220:223],v252 offset:18176
M v[176:179],a[236:239],a[192:195],v[176:179]
ds_read_b128 a[192:195],v252 offset:18432
M v[180:183],a[236:239],a[196:199],v[180:183]
ds_read_b128 a[196:199],v252 offset:18688
M v[184:187],a[236:239],a[200:203],v[184:187]
s_waitcnt lgkmcnt(6)
ds_read_b128 a[200:203],v252 offset:18944
M v[188:191],a[236:239],a[204:207],v[188:191]
s_waitcnt vmcnt(6) lgkmcnt(6)
ds_read_b128 a[204:207],v252 offset:19200
M v[160:163],a[240:243],a[208:211],v[160:163]
s_waitcnt lgkmcnt(6)
ds_read_b128 a[208:211],v252 offset:19456
M v[164:167],a[240:243],a[212:215],v[164:167]
s_waitcnt lgkmcnt(6)
M v[168:171],a[240:243],a[216:219],v[168:171]
s_waitcnt lgkmcnt(5)
M v[172:175],a[240:243],a[220:223],v[172:175]
s_waitcnt lgkmcnt(4)
M v[176:179],a[240:243],a[192:195],v[176:179]
s_waitcnt lgkmcnt(3)
M v[180:183],a[240:243],a[196:199],v[180:183]
s_waitcnt lgkmcnt(2)
M v[184:187],a[240:243],a[200:203],v[184:187]
s_waitcnt lgkmcnt(1)
M v[188:191],a[240:243],a[204:207],v[188:191]
s_waitcnt vmcnt(4)
M v[160:163],a[244:247],a[212:215],v[160:163]
ds_read_b128 a[212:215],v251 offset:19712
M v[164:167],a[244:247],a[216:219],v[164:167]
M v[168:171],a[244:247],a[220:223],v[168:171]
M v[172:175],a[244:247],a[192:195],v[172:175]
M v[176:179],a[244:247],a[196:199],v[176:179]
M v[180:183],a[244:247],a[200:203],v[180:183]
v_add_u32 v251,0xffff3400,v251
v_add_u32 v252,0xffff3400,v252
M v[184:187],a[244:247],a[204:207],v[184:187]
s_waitcnt lgkmcnt(1)
M v[188:191],a[244:247],a[208:211],v[188:191]
s_waitcnt vmcnt(3)
M v[160:163],a[248:251],a[216:219],v[160:163]
ds_read_b128 a[216:219],v251 offset:0
M v[164:167],a[248:251],a[220:223],v[164:167]
ds_read_b128 a[220:223],v252 offset:256
M v[168:171],a[248:251],a[192:195],v[168:171]
ds_read_b128 a[192:195],v252 offset:512
M v[172:175],a[248:251],a[196:199],v[172:175]
ds_read_b128 a[196:199],v252 offset:768
M v[176:179],a[248:251],a[200:203],v[176:179]
ds_read_b128 a[200:203],v252 offset:1024
M v[180:183],a[248:251],a[204:207],v[180:183]
ds_read_b128 a[204:207],v252 offset:1280
M v[184:187],a[248:251],a[208:211],v[184:187]
s_waitcnt lgkmcnt(6)
ds_read_b128 a[208:211],v252 offset:1536
M v[188:191],a[248:251],a[212:215],v[188:191]
s_waitcnt vmcnt(2) lgkmcnt(6)
ds_read_b128 a[212:215],v252 offset:1792
M v[160:163],a[252:255],a[216:219],v[160:163]
s_waitcnt lgkmcnt(6)
ds_read_b128 a[216:219],v252 offset:2048
M v[164:167],a[252:255],a[220:223],v[164:167]
s_waitcnt lgkmcnt(6)
M v[168:171],a[252:255],a[192:195],v[168:171]
s_waitcnt lgkmcnt(5)
M v[172:175],a[252:255],a[196:199],v[172:175]
s_waitcnt lgkmcnt(4)
M v[176:179],a[252:255],a[200:203],v[176:179]
s_waitcnt lgkmcnt(3)
M v[180:183],a[252:255],a[204:207],v[180:183]
s_waitcnt lgkmcnt(2)
M v[184:187],a[252:255],a[208:211],v[184:187]
s_waitcnt lgkmcnt(1)
M v[188:191],a[252:255],a[212:215],v[188:191]
s_waitcnt vmcnt(1)
M v[160:163],v[216:219],a[220:223],v[160:163]
ds_read_b128 a[220:223],v251 offset:2304
M v[164:167],v[216:219],a[192:195],v[164:167]
M v[168:171],v[216:219],a[196:199],v[168:171]
M v[172:175],v[216:219],a[200:203],v[172:175]
M v[176:179],v[216:219],a[204:207],v[176:179]
M v[180:183],v[216:219],a[208:211],v[180:183]
M v[184:187],v[216:219],a[212:215],v[184:187]
s_waitcnt lgkmcnt(1)
M v[188:191],v[216:219],a[216:219],v[188:191]
s_waitcnt vmcnt(0)
M v[160:163],v[220:223],a[192:195],v[160:163]
M v[164:167],v[220:223],a[196:199],v[164:167]
M v[168:171],v[220:223],a[200:203],v[168:171]
M v[172:175],v[220:223],a[204:207],v[172:175]
s_nop 4
v_cvt_pk_bf16_f32 v160,v160,v161
v_cvt_pk_bf16_f32 v161,v162,v163
M v[176:179],v[220:223],a[208:211],v[176:179]
buffer_store_dwordx2 v[160:161],v255,s[24:27],s32 offen offset:1152
M v[180:183],v[220:223],a[212:215],v[180:183]
v_cvt_pk_bf16_f32 v164,v164,v165
v_cvt_pk_bf16_f32 v165,v166,v167
M v[184:187],v[220:223],a[216:219],v[184:187]
s_waitcnt lgkmcnt(0)
buffer_store_dwordx2 v[164:165],v255,s[24:27],s33 offen offset:1152
M v[188:191],v[220:223],a[220:223],v[188:191]
v_cvt_pk_bf16_f32 v168,v168,v169
v_cvt_pk_bf16_f32 v169,v170,v171
buffer_store_dwordx2 v[168:169],v255,s[24:27],s34 offen offset:1152
v_cvt_pk_bf16_f32 v172,v172,v173
v_cvt_pk_bf16_f32 v173,v174,v175
buffer_store_dwordx2 v[172:173],v255,s[24:27],s35 offen offset:1152
v_cvt_pk_bf16_f32 v176,v176,v177
v_cvt_pk_bf16_f32 v177,v178,v179
buffer_store_dwordx2 v[176:177],v255,s[24:27],s36 offen offset:1152
v_cvt_pk_bf16_f32 v180,v180,v181
v_cvt_pk_bf16_f32 v181,v182,v183
buffer_store_dwordx2 v[180:181],v255,s[24:27],s37 offen offset:1152
v_cvt_pk_bf16_f32 v184,v184,v185
v_cvt_pk_bf16_f32 v185,v186,v187
buffer_store_dwordx2 v[184:185],v255,s[24:27],s38 offen offset:1152
v_cvt_pk_bf16_f32 v188,v188,v189
v_cvt_pk_bf16_f32 v189,v190,v191
buffer_store_dwordx2 v[188:189],v255,s[24:27],s39 offen offset:1152
s_endpgm
.section .rodata,"a"
.p2align 6
.amdhsa_kernel wtrans_kernel
  .amdhsa_next_free_vgpr 96
  .amdhsa_next_free_sgpr 48
  .amdhsa_accum_offset 96
  .amdhsa_group_segment_fixed_size 0
  .amdhsa_kernarg_size 40
  .amdhsa_user_sgpr_count 2
  .amdhsa_user_sgpr_kernarg_segment_ptr 1
  .amdhsa_system_sgpr_workgroup_id_x 1
  .amdhsa_float_denorm_mode_32 3
.end_amdhsa_kernel
.p2align 6
.amdhsa_kernel standalone__winograd__vision_kernel
  .amdhsa_next_free_vgpr 512
  .amdhsa_next_free_sgpr 64
  .amdhsa_accum_offset 256
  .amdhsa_group_segment_fixed_size 0
  .amdhsa_kernarg_size 40
  .amdhsa_user_sgpr_count 2
  .amdhsa_user_sgpr_kernarg_segment_ptr 1
  .amdhsa_system_sgpr_workgroup_id_x 1
  .amdhsa_float_denorm_mode_32 3
.end_amdhsa_kernel
```

```asm
; @launch kernel=wtrans_kernel grid=(216,1,1) block=(64,1,1) lds=0
; @launch kernel=standalone__winograd__vision_kernel grid=(256,1,1) block=(256,1,1) lds=156672
.amdgcn_target "amdgcn-amd-amdhsa--gfx950"
.macro M d,a,b,c
v_mfma_f32_16x16x32_bf16 \d,\a,\b,\c
.endm
.text
.globl wtrans_kernel
.p2align 8
.type wtrans_kernel,@function
wtrans_kernel:
s_cmp_ge_u32 s2,216
s_cbranch_scc1 L_uend
s_load_dwordx2 s[4:5],s[0:1],8
s_load_dwordx2 s[6:7],s[0:1],32
s_mul_hi_u32 s20,s2,0x55555556
s_mul_i32 s21,s20,3
s_sub_u32 s21,s2,s21
s_mul_hi_u32 s22,s20,0x55555556
s_mul_i32 s23,s22,3
s_sub_u32 s23,s20,s23
s_mul_hi_u32 s24,s22,0x2aaaaaab
s_mul_i32 s25,s24,6
s_sub_u32 s25,s22,s25
v_and_b32 v1,15,v0
v_lshrrev_b32 v2,4,v0
s_lshl_b32 s26,s23,6
s_lshl_b32 s27,s24,4
s_add_u32 s26,s26,s27
v_add_u32 v3,s26,v1
v_lshlrev_b32 v3,1,v3
v_mul_u32_u24 v4,3072,v2
v_add_u32 v3,v3,v4
s_mul_i32 s26,s21,221184
s_mul_i32 s27,s25,12288
s_add_u32 s26,s26,s27
s_add_u32 s27,s26,73728
s_add_u32 s28,s27,73728
s_waitcnt lgkmcnt(0)
s_mov_b32 s8,s4
s_and_b32 s9,s5,0xffff
s_mov_b32 s10,663552
s_mov_b32 s11,0x20000
s_mov_b32 s12,s6
s_and_b32 s13,s7,0xffff
s_mov_b32 s14,1327104
s_mov_b32 s15,0x20000
buffer_load_short_d16_hi v8,v3,s[8:11],s26 offen offset:0
buffer_load_short_d16_hi v9,v3,s[8:11],s26 offen offset:384
buffer_load_short_d16_hi v10,v3,s[8:11],s26 offen offset:768
buffer_load_short_d16_hi v11,v3,s[8:11],s26 offen offset:1152
buffer_load_short_d16_hi v12,v3,s[8:11],s26 offen offset:1536
buffer_load_short_d16_hi v13,v3,s[8:11],s26 offen offset:1920
buffer_load_short_d16_hi v14,v3,s[8:11],s26 offen offset:2304
buffer_load_short_d16_hi v15,v3,s[8:11],s26 offen offset:2688
buffer_load_short_d16_hi v16,v3,s[8:11],s27 offen offset:0
buffer_load_short_d16_hi v17,v3,s[8:11],s27 offen offset:384
buffer_load_short_d16_hi v18,v3,s[8:11],s27 offen offset:768
buffer_load_short_d16_hi v19,v3,s[8:11],s27 offen offset:1152
buffer_load_short_d16_hi v20,v3,s[8:11],s27 offen offset:1536
buffer_load_short_d16_hi v21,v3,s[8:11],s27 offen offset:1920
buffer_load_short_d16_hi v22,v3,s[8:11],s27 offen offset:2304
buffer_load_short_d16_hi v23,v3,s[8:11],s27 offen offset:2688
buffer_load_short_d16_hi v24,v3,s[8:11],s28 offen offset:0
buffer_load_short_d16_hi v25,v3,s[8:11],s28 offen offset:384
buffer_load_short_d16_hi v26,v3,s[8:11],s28 offen offset:768
buffer_load_short_d16_hi v27,v3,s[8:11],s28 offen offset:1152
buffer_load_short_d16_hi v28,v3,s[8:11],s28 offen offset:1536
buffer_load_short_d16_hi v29,v3,s[8:11],s28 offen offset:1920
buffer_load_short_d16_hi v30,v3,s[8:11],s28 offen offset:2304
buffer_load_short_d16_hi v31,v3,s[8:11],s28 offen offset:2688
s_mul_i32 s30,s24,331776
s_mul_i32 s31,s25,55296
s_add_u32 s30,s30,s31
s_mul_i32 s31,s23,3072
s_add_u32 s30,s30,s31
s_lshl_b32 s31,s21,10
s_add_u32 s30,s30,s31
v_lshlrev_b32 v5,4,v0
s_mov_b32 s33,0xbe2aaaab
s_mov_b32 s34,0x3d2aaaab
s_mov_b32 s35,0x3e2aaaab
s_mov_b32 s36,0x3daaaaab
s_waitcnt vmcnt(0)
v_add_f32 v6,v8,v24
v_add_f32 v32,v6,v16
v_sub_f32 v40,v6,v16
v_mul_f32 v32,s33,v32
v_mul_f32 v40,s33,v40
v_mul_f32 v6,s34,v8
v_fmac_f32 v6,s35,v24
v_fma_f32 v48,s36,v16,v6
v_fma_f32 v56,-s36,v16,v6
v_add_f32 v6,v9,v25
v_add_f32 v33,v6,v17
v_sub_f32 v41,v6,v17
v_mul_f32 v33,s33,v33
v_mul_f32 v41,s33,v41
v_mul_f32 v6,s34,v9
v_fmac_f32 v6,s35,v25
v_fma_f32 v49,s36,v17,v6
v_fma_f32 v57,-s36,v17,v6
v_add_f32 v6,v10,v26
v_add_f32 v34,v6,v18
v_sub_f32 v42,v6,v18
v_mul_f32 v34,s33,v34
v_mul_f32 v42,s33,v42
v_mul_f32 v6,s34,v10
v_fmac_f32 v6,s35,v26
v_fma_f32 v50,s36,v18,v6
v_fma_f32 v58,-s36,v18,v6
v_add_f32 v6,v11,v27
v_add_f32 v35,v6,v19
v_sub_f32 v43,v6,v19
v_mul_f32 v35,s33,v35
v_mul_f32 v43,s33,v43
v_mul_f32 v6,s34,v11
v_fmac_f32 v6,s35,v27
v_fma_f32 v51,s36,v19,v6
v_fma_f32 v59,-s36,v19,v6
v_add_f32 v6,v12,v28
v_add_f32 v36,v6,v20
v_sub_f32 v44,v6,v20
v_mul_f32 v36,s33,v36
v_mul_f32 v44,s33,v44
v_mul_f32 v6,s34,v12
v_fmac_f32 v6,s35,v28
v_fma_f32 v52,s36,v20,v6
v_fma_f32 v60,-s36,v20,v6
v_add_f32 v6,v13,v29
v_add_f32 v37,v6,v21
v_sub_f32 v45,v6,v21
v_mul_f32 v37,s33,v37
v_mul_f32 v45,s33,v45
v_mul_f32 v6,s34,v13
v_fmac_f32 v6,s35,v29
v_fma_f32 v53,s36,v21,v6
v_fma_f32 v61,-s36,v21,v6
v_add_f32 v6,v14,v30
v_add_f32 v38,v6,v22
v_sub_f32 v46,v6,v22
v_mul_f32 v38,s33,v38
v_mul_f32 v46,s33,v46
v_mul_f32 v6,s34,v14
v_fmac_f32 v6,s35,v30
v_fma_f32 v54,s36,v22,v6
v_fma_f32 v62,-s36,v22,v6
v_add_f32 v6,v15,v31
v_add_f32 v39,v6,v23
v_sub_f32 v47,v6,v23
v_mul_f32 v39,s33,v39
v_mul_f32 v47,s33,v47
v_mul_f32 v6,s34,v15
v_fmac_f32 v6,s35,v31
v_fma_f32 v55,s36,v23,v6
v_fma_f32 v63,-s36,v23,v6
v_cvt_pk_bf16_f32 v64,v8,v9
v_cvt_pk_bf16_f32 v65,v10,v11
v_cvt_pk_bf16_f32 v66,v12,v13
v_cvt_pk_bf16_f32 v67,v14,v15
s_add_u32 s31,s30,0
buffer_store_dwordx4 v[64:67],v5,s[12:15],s31 offen
v_cvt_pk_bf16_f32 v68,v32,v33
v_cvt_pk_bf16_f32 v69,v34,v35
v_cvt_pk_bf16_f32 v70,v36,v37
v_cvt_pk_bf16_f32 v71,v38,v39
s_add_u32 s31,s30,9216
buffer_store_dwordx4 v[68:71],v5,s[12:15],s31 offen
v_cvt_pk_bf16_f32 v72,v40,v41
v_cvt_pk_bf16_f32 v73,v42,v43
v_cvt_pk_bf16_f32 v74,v44,v45
v_cvt_pk_bf16_f32 v75,v46,v47
s_add_u32 s31,s30,18432
buffer_store_dwordx4 v[72:75],v5,s[12:15],s31 offen
v_cvt_pk_bf16_f32 v76,v48,v49
v_cvt_pk_bf16_f32 v77,v50,v51
v_cvt_pk_bf16_f32 v78,v52,v53
v_cvt_pk_bf16_f32 v79,v54,v55
s_add_u32 s31,s30,27648
buffer_store_dwordx4 v[76:79],v5,s[12:15],s31 offen
v_cvt_pk_bf16_f32 v80,v56,v57
v_cvt_pk_bf16_f32 v81,v58,v59
v_cvt_pk_bf16_f32 v82,v60,v61
v_cvt_pk_bf16_f32 v83,v62,v63
s_add_u32 s31,s30,36864
buffer_store_dwordx4 v[80:83],v5,s[12:15],s31 offen
v_cvt_pk_bf16_f32 v84,v24,v25
v_cvt_pk_bf16_f32 v85,v26,v27
v_cvt_pk_bf16_f32 v86,v28,v29
v_cvt_pk_bf16_f32 v87,v30,v31
s_add_u32 s31,s30,46080
buffer_store_dwordx4 v[84:87],v5,s[12:15],s31 offen
L_uend:
s_endpgm
.globl standalone__winograd__vision_kernel
.p2align 8
.type standalone__winograd__vision_kernel,@function
standalone__winograd__vision_kernel:
s_cmp_ge_u32 s2,256
s_cbranch_scc0 L_go
s_endpgm
L_go:
s_load_dwordx2 s[4:5],s[0:1],0
s_load_dwordx2 s[6:7],s[0:1],16
s_load_dwordx2 s[52:53],s[0:1],32
v_lshrrev_b32 v60,6,v0
v_and_b32 v64,63,v0
v_readfirstlane_b32 s50,v60
v_lshrrev_b32 v60,4,v64
v_bfe_u32 v61,v64,3,1
v_lshl_add_u32 v61,v60,3,v61
v_and_b32 v62,7,v64
v_mul_u32_u24 v245,196608,v61
v_lshl_add_u32 v245,v62,3,v245
v_lshlrev_b32 v251,4,v0
v_bfe_u32 v63,v64,2,1
v_mul_u32_u24 v63,768,v63
v_mul_u32_u24 v254,196608,v61
v_add_u32 v254,v254,v63
s_and_b32 s54,s2,7
s_lshr_b32 s55,s2,3
s_lshl_b32 s49,s54,6
s_lshl_b32 s55,s55,4
s_lshl_b32 s56,s50,2
s_add_u32 s56,s56,s55
s_mul_i32 s31,s56,384
s_mul_i32 s57,s49,196608
s_add_u32 s30,s57,s31
s_mul_i32 s44,s50,330752
s_bfe_u32 s58,s2,65539
s_add_u32 s59,s58,0
s_mul_i32 s60,s59,55296
s_lshl_b32 s59,s59,6
s_add_u32 s64,s30,s59
s_add_u32 s70,s31,s59
s_add_u32 s76,s44,s60
s_add_u32 s59,s58,1
s_mul_i32 s60,s59,55296
s_lshl_b32 s59,s59,6
s_add_u32 s65,s30,s59
s_add_u32 s71,s31,s59
s_add_u32 s77,s44,s60
s_add_u32 s59,s58,2
s_mul_i32 s60,s59,55296
s_lshl_b32 s59,s59,6
s_add_u32 s66,s30,s59
s_add_u32 s72,s31,s59
s_add_u32 s78,s44,s60
s_add_u32 s59,s58,3
s_mul_i32 s60,s59,55296
s_lshl_b32 s59,s59,6
s_add_u32 s67,s30,s59
s_add_u32 s73,s31,s59
s_add_u32 s79,s44,s60
s_add_u32 s59,s58,4
s_mul_i32 s60,s59,55296
s_lshl_b32 s59,s59,6
s_add_u32 s68,s30,s59
s_add_u32 s74,s31,s59
s_add_u32 s80,s44,s60
s_add_u32 s59,s58,5
s_cmp_eq_u32 s59,6
s_cselect_b32 s59,0,s59
s_mul_i32 s60,s59,55296
s_lshl_b32 s59,s59,6
s_add_u32 s69,s30,s59
s_add_u32 s75,s31,s59
s_add_u32 s81,s44,s60
s_waitcnt lgkmcnt(0)
s_mov_b32 s8,s4
s_and_b32 s9,s5,0xffff
s_mov_b32 s10,100663296
s_mov_b32 s11,0x20000
s_sub_u32 s12,s4,384
s_subb_u32 s13,s9,0
s_cmp_eq_u32 s56,0
s_cselect_b32 s14,0,100663680
s_mov_b32 s15,0x20000
s_mov_b32 s16,s4
s_mov_b32 s17,s9
s_cmp_eq_u32 s56,508
s_cselect_b32 s18,0,100663296
s_mov_b32 s19,0x20000
v_bfe_u32 v232,v251,9,1
v_mul_u32_u24 v232,33,v232
v_add_u32 v232,s49,v232
v_add_u32 v232,-1,v232
v_mul_u32_u24 v233,196608,v232
v_cmp_gt_u32 vcc,512,v232
v_bfe_u32 v232,v251,3,6
v_add_u32 v233,v233,v232
v_bfrev_b32 v232,1
v_cndmask_b32 v246,v232,v233,vcc
s_add_u32 s28,s64,0
buffer_load_dwordx2 v[0:1],v245,s[12:15],s28 offen offset:0
buffer_load_dwordx2 v[10:11],v245,s[16:19],s28 offen offset:1536
buffer_load_dwordx2 v[2:3],v245,s[8:11],s28 offen offset:0
buffer_load_dwordx2 v[4:5],v245,s[8:11],s28 offen offset:384
buffer_load_dwordx2 v[6:7],v245,s[8:11],s28 offen offset:768
buffer_load_dwordx2 v[8:9],v245,s[8:11],s28 offen offset:1152
s_add_u32 s28,s64,393216
buffer_load_dwordx2 v[12:13],v245,s[12:15],s28 offen offset:0
buffer_load_dwordx2 v[22:23],v245,s[16:19],s28 offen offset:1536
buffer_load_dwordx2 v[14:15],v245,s[8:11],s28 offen offset:0
buffer_load_dwordx2 v[16:17],v245,s[8:11],s28 offen offset:384
buffer_load_dwordx2 v[18:19],v245,s[8:11],s28 offen offset:768
buffer_load_dwordx2 v[20:21],v245,s[8:11],s28 offen offset:1152
s_add_u32 s28,s64,786432
buffer_load_dwordx2 v[24:25],v245,s[12:15],s28 offen offset:0
buffer_load_dwordx2 v[34:35],v245,s[16:19],s28 offen offset:1536
buffer_load_dwordx2 v[26:27],v245,s[8:11],s28 offen offset:0
buffer_load_dwordx2 v[28:29],v245,s[8:11],s28 offen offset:384
buffer_load_dwordx2 v[30:31],v245,s[8:11],s28 offen offset:768
buffer_load_dwordx2 v[32:33],v245,s[8:11],s28 offen offset:1152
s_add_u32 s28,s64,1179648
buffer_load_dwordx2 v[36:37],v245,s[12:15],s28 offen offset:0
buffer_load_dwordx2 v[46:47],v245,s[16:19],s28 offen offset:1536
buffer_load_dwordx2 v[38:39],v245,s[8:11],s28 offen offset:0
buffer_load_dwordx2 v[40:41],v245,s[8:11],s28 offen offset:384
buffer_load_dwordx2 v[42:43],v245,s[8:11],s28 offen offset:768
buffer_load_dwordx2 v[44:45],v245,s[8:11],s28 offen offset:1152
buffer_load_short_d16_hi v48,v246,s[12:15],s70 offen offset:0
buffer_load_short_d16_hi v49,v246,s[8:11],s70 offen offset:0
buffer_load_short_d16_hi v50,v246,s[8:11],s70 offen offset:384
buffer_load_short_d16_hi v51,v246,s[8:11],s70 offen offset:768
buffer_load_short_d16_hi v52,v246,s[8:11],s70 offen offset:1152
buffer_load_short_d16_hi v53,v246,s[16:19],s70 offen offset:1536
s_getpc_b64 s[60:61]
s_lshr_b32 s62,s2,3
s_lshl_b32 s62,s62,2
s_add_u32 s62,s62,s50
s_lshl_b32 s62,s62,10
v_and_b32 v66,7,v64
v_lshl_add_u32 v66,v66,7,s62
v_min_u32 v66,L_code_end-L_go-2048,v66
global_load_dword v67,v66,s[60:61]
s_mov_b32 s20,s52
s_and_b32 s21,s53,0xffff
s_mov_b32 s22,1327104
s_mov_b32 s23,0x20000
s_add_u32 s46,s76,9216
buffer_load_dwordx4 a[224:227],v251,s[20:23],s46 offen offset:0
s_add_u32 s47,s76,12288
buffer_load_dwordx4 a[228:231],v251,s[20:23],s47 offen offset:0
s_add_u32 s48,s76,15360
buffer_load_dwordx4 a[232:235],v251,s[20:23],s48 offen offset:0
buffer_load_dwordx4 a[236:239],v251,s[20:23],s46 offen offset:1024
buffer_load_dwordx4 a[240:243],v251,s[20:23],s47 offen offset:1024
buffer_load_dwordx4 a[244:247],v251,s[20:23],s48 offen offset:1024
buffer_load_dwordx4 a[248:251],v251,s[20:23],s46 offen offset:2048
buffer_load_dwordx4 a[252:255],v251,s[20:23],s47 offen offset:2048
buffer_load_dwordx4 v[216:219],v251,s[20:23],s48 offen offset:2048
s_add_u32 s46,s76,18432
buffer_load_dwordx4 v[220:223],v251,s[20:23],s46 offen offset:0
s_add_u32 s47,s76,21504
buffer_load_dwordx4 v[224:227],v251,s[20:23],s47 offen offset:0
s_add_u32 s48,s76,24576
buffer_load_dwordx4 v[228:231],v251,s[20:23],s48 offen offset:0
s_mov_b32 s24,s6
s_and_b32 s25,s7,0xffff
s_mov_b32 s26,100663296
s_mov_b32 s27,0x20000
s_mov_b32 s40,0xc0a00000
s_mov_b32 s41,0x41000000
s_mov_b32 s42,0xffff0000
s_mov_b32 s43,0xbfa00000
s_mov_b32 s45,0x3e800000
s_mul_i32 s58,s55,384
s_add_u32 s58,s57,s58
s_lshr_b32 s59,s50,1
s_mul_i32 s32,s59,384
s_mul_i32 s33,s59,196608
s_add_u32 s32,s32,s58
s_add_u32 s33,s33,s58
s_lshl_b32 s59,s50,6
v_lshlrev_b32 v247,8,v61
v_and_b32 v63,1,v60
v_xor_b32 v63,1,v63
v_lshlrev_b32 v63,2,v63
v_xor_b32 v63,v63,v62
v_lshl_add_u32 v247,v63,3,v247
v_add_u32 v247,s59,v247
v_add_u32 v247,256,v247
v_lshrrev_b32 v60,5,v64
v_mul_u32_u24 v248,8448,v60
v_lshlrev_b32 v60,5,v60
v_bfe_u32 v61,v251,3,6
v_xor_b32 v61,v61,v60
v_add3_u32 v248,v248,v61,s59
v_bfe_u32 v60,v64,2,2
v_and_b32 v61,3,v64
v_lshrrev_b32 v62,4,v64
v_lshlrev_b32 v249,11,v60
v_lshl_add_u32 v249,v61,6,v249
v_and_b32 v63,1,v60
v_lshlrev_b32 v63,1,v63
v_xor_b32 v63,v63,v62
v_lshl_add_u32 v249,v63,4,v249
v_xor_b32 v250,32,v249
v_lshrrev_b32 v60,1,v62
v_lshl_add_u32 v60,s50,1,v60
v_and_b32 v61,7,v64
v_xor_b32 v60,v60,v61
v_and_b32 v63,15,v64
v_lshlrev_b32 v253,7,v63
v_lshl_add_u32 v253,v60,4,v253
v_and_b32 v63,1,v62
v_lshl_add_u32 v253,v63,3,v253
v_bfe_u32 v60,v251,7,4
v_lshrrev_b32 v62,2,v60
v_mul_u32_u24 v252,1572864,v62
v_and_b32 v62,3,v60
v_mul_u32_u24 v62,1536,v62
v_and_b32 v60,7,v60
v_xor_b32 v60,v60,v61
v_lshl_add_u32 v60,v60,4,v62
v_add_u32 v252,v252,v60
s_waitcnt vmcnt(39)
v_lshlrev_b32 v234,16,v4
v_lshlrev_b32 v232,16,v0
v_lshlrev_b32 v233,16,v2
v_lshlrev_b32 v237,16,v10
s_waitcnt vmcnt(37)
v_lshlrev_b32 v236,16,v8
v_lshlrev_b32 v235,16,v6
v_fmac_f32 v232,s43,v234
v_fmac_f32 v237,4.0,v233
v_fma_f32 v238,-4.0,v234,v236
v_fmac_f32 v232,s45,v236
v_fmac_f32 v237,s40,v235
v_sub_f32 v236,v236,v234
v_fma_f32 v234,-4.0,v233,v235
v_sub_f32 v235,v235,v233
v_add_f32 v233,v238,v234
v_sub_f32 v238,v238,v234
v_fma_f32 v234,2.0,v235,v236
v_fmac_f32 v236,-2.0,v235
v_and_b32 v4,s42,v4
v_and_b32 v0,s42,v0
v_and_b32 v2,s42,v2
v_and_b32 v10,s42,v10
v_and_b32 v8,s42,v8
v_and_b32 v6,s42,v6
v_fmac_f32 v0,s43,v4
v_fmac_f32 v10,4.0,v2
v_fma_f32 v235,-4.0,v4,v8
v_fmac_f32 v0,s45,v8
v_fmac_f32 v10,s40,v6
v_sub_f32 v8,v8,v4
v_fma_f32 v4,-4.0,v2,v6
v_sub_f32 v6,v6,v2
v_add_f32 v2,v235,v4
v_sub_f32 v235,v235,v4
v_fma_f32 v4,2.0,v6,v8
v_fmac_f32 v8,-2.0,v6
v_cvt_pk_bf16_f32 v0,v232,v0
v_cvt_pk_bf16_f32 v10,v237,v10
v_cvt_pk_bf16_f32 v2,v233,v2
v_cvt_pk_bf16_f32 v6,v234,v4
v_cvt_pk_bf16_f32 v4,v238,v235
v_cvt_pk_bf16_f32 v8,v236,v8
v_lshlrev_b32 v234,16,v5
v_lshlrev_b32 v232,16,v1
v_lshlrev_b32 v233,16,v3
v_lshlrev_b32 v237,16,v11
v_lshlrev_b32 v236,16,v9
v_lshlrev_b32 v235,16,v7
v_fmac_f32 v232,s43,v234
v_fmac_f32 v237,4.0,v233
v_fma_f32 v238,-4.0,v234,v236
v_fmac_f32 v232,s45,v236
v_fmac_f32 v237,s40,v235
v_sub_f32 v236,v236,v234
v_fma_f32 v234,-4.0,v233,v235
v_sub_f32 v235,v235,v233
v_add_f32 v233,v238,v234
v_sub_f32 v238,v238,v234
v_fma_f32 v234,2.0,v235,v236
v_fmac_f32 v236,-2.0,v235
v_and_b32 v5,s42,v5
v_and_b32 v1,s42,v1
v_and_b32 v3,s42,v3
v_and_b32 v11,s42,v11
v_and_b32 v9,s42,v9
v_and_b32 v7,s42,v7
v_fmac_f32 v1,s43,v5
v_fmac_f32 v11,4.0,v3
v_fma_f32 v235,-4.0,v5,v9
v_fmac_f32 v1,s45,v9
v_fmac_f32 v11,s40,v7
v_sub_f32 v9,v9,v5
v_fma_f32 v5,-4.0,v3,v7
v_sub_f32 v7,v7,v3
v_add_f32 v3,v235,v5
v_sub_f32 v235,v235,v5
v_fma_f32 v5,2.0,v7,v9
v_fmac_f32 v9,-2.0,v7
v_cvt_pk_bf16_f32 v1,v232,v1
v_cvt_pk_bf16_f32 v11,v237,v11
v_cvt_pk_bf16_f32 v3,v233,v3
v_cvt_pk_bf16_f32 v7,v234,v5
v_cvt_pk_bf16_f32 v5,v238,v235
v_cvt_pk_bf16_f32 v9,v236,v9
ds_write2st64_b64 v247,v[0:1],v[10:11] offset0:0 offset1:17
ds_write2st64_b64 v247,v[2:3],v[4:5] offset0:34 offset1:51
ds_write2st64_b64 v247,v[6:7],v[8:9] offset0:68 offset1:85
s_waitcnt vmcnt(33)
v_lshlrev_b32 v234,16,v16
v_lshlrev_b32 v232,16,v12
v_lshlrev_b32 v233,16,v14
v_lshlrev_b32 v237,16,v22
s_waitcnt vmcnt(31)
v_lshlrev_b32 v236,16,v20
v_lshlrev_b32 v235,16,v18
v_fmac_f32 v232,s43,v234
v_fmac_f32 v237,4.0,v233
v_fma_f32 v238,-4.0,v234,v236
v_fmac_f32 v232,s45,v236
v_fmac_f32 v237,s40,v235
v_sub_f32 v236,v236,v234
v_fma_f32 v234,-4.0,v233,v235
v_sub_f32 v235,v235,v233
v_add_f32 v233,v238,v234
v_sub_f32 v238,v238,v234
v_fma_f32 v234,2.0,v235,v236
v_fmac_f32 v236,-2.0,v235
v_and_b32 v16,s42,v16
v_and_b32 v12,s42,v12
v_and_b32 v14,s42,v14
v_and_b32 v22,s42,v22
v_and_b32 v20,s42,v20
v_and_b32 v18,s42,v18
v_fmac_f32 v12,s43,v16
v_fmac_f32 v22,4.0,v14
v_fma_f32 v235,-4.0,v16,v20
v_fmac_f32 v12,s45,v20
v_fmac_f32 v22,s40,v18
v_sub_f32 v20,v20,v16
v_fma_f32 v16,-4.0,v14,v18
v_sub_f32 v18,v18,v14
v_add_f32 v14,v235,v16
v_sub_f32 v235,v235,v16
v_fma_f32 v16,2.0,v18,v20
v_fmac_f32 v20,-2.0,v18
v_cvt_pk_bf16_f32 v12,v232,v12
v_cvt_pk_bf16_f32 v22,v237,v22
v_cvt_pk_bf16_f32 v14,v233,v14
v_cvt_pk_bf16_f32 v18,v234,v16
v_cvt_pk_bf16_f32 v16,v238,v235
v_cvt_pk_bf16_f32 v20,v236,v20
v_lshlrev_b32 v234,16,v17
v_lshlrev_b32 v232,16,v13
v_lshlrev_b32 v233,16,v15
v_lshlrev_b32 v237,16,v23
v_lshlrev_b32 v236,16,v21
v_lshlrev_b32 v235,16,v19
v_fmac_f32 v232,s43,v234
v_fmac_f32 v237,4.0,v233
v_fma_f32 v238,-4.0,v234,v236
v_fmac_f32 v232,s45,v236
v_fmac_f32 v237,s40,v235
v_sub_f32 v236,v236,v234
v_fma_f32 v234,-4.0,v233,v235
v_sub_f32 v235,v235,v233
v_add_f32 v233,v238,v234
v_sub_f32 v238,v238,v234
v_fma_f32 v234,2.0,v235,v236
v_fmac_f32 v236,-2.0,v235
v_and_b32 v17,s42,v17
v_and_b32 v13,s42,v13
v_and_b32 v15,s42,v15
v_and_b32 v23,s42,v23
v_and_b32 v21,s42,v21
v_and_b32 v19,s42,v19
v_fmac_f32 v13,s43,v17
v_fmac_f32 v23,4.0,v15
v_fma_f32 v235,-4.0,v17,v21
v_fmac_f32 v13,s45,v21
v_fmac_f32 v23,s40,v19
v_sub_f32 v21,v21,v17
v_fma_f32 v17,-4.0,v15,v19
v_sub_f32 v19,v19,v15
v_add_f32 v15,v235,v17
v_sub_f32 v235,v235,v17
v_fma_f32 v17,2.0,v19,v21
v_fmac_f32 v21,-2.0,v19
v_cvt_pk_bf16_f32 v13,v232,v13
v_cvt_pk_bf16_f32 v23,v237,v23
v_cvt_pk_bf16_f32 v15,v233,v15
v_cvt_pk_bf16_f32 v19,v234,v17
v_cvt_pk_bf16_f32 v17,v238,v235
v_cvt_pk_bf16_f32 v21,v236,v21
ds_write2st64_b64 v247,v[12:13],v[22:23] offset0:1 offset1:18
ds_write2st64_b64 v247,v[14:15],v[16:17] offset0:35 offset1:52
ds_write2st64_b64 v247,v[18:19],v[20:21] offset0:69 offset1:86
s_add_u32 s28,s65,0
buffer_load_dwordx2 v[192:193],v245,s[12:15],s28 offen offset:0
buffer_load_dwordx2 v[202:203],v245,s[16:19],s28 offen offset:1536
buffer_load_dwordx2 v[194:195],v245,s[8:11],s28 offen offset:0
buffer_load_dwordx2 v[196:197],v245,s[8:11],s28 offen offset:384
buffer_load_dwordx2 v[198:199],v245,s[8:11],s28 offen offset:768
buffer_load_dwordx2 v[200:201],v245,s[8:11],s28 offen offset:1152
s_add_u32 s28,s65,393216
buffer_load_dwordx2 v[204:205],v245,s[12:15],s28 offen offset:0
buffer_load_dwordx2 v[214:215],v245,s[16:19],s28 offen offset:1536
buffer_load_dwordx2 v[206:207],v245,s[8:11],s28 offen offset:0
buffer_load_dwordx2 v[208:209],v245,s[8:11],s28 offen offset:384
buffer_load_dwordx2 v[210:211],v245,s[8:11],s28 offen offset:768
buffer_load_dwordx2 v[212:213],v245,s[8:11],s28 offen offset:1152
buffer_load_short_d16_hi v239,v246,s[12:15],s71 offen offset:0
buffer_load_short_d16_hi v240,v246,s[8:11],s71 offen offset:0
buffer_load_short_d16_hi v241,v246,s[8:11],s71 offen offset:384
buffer_load_short_d16_hi v242,v246,s[8:11],s71 offen offset:768
buffer_load_short_d16_hi v243,v246,s[8:11],s71 offen offset:1152
buffer_load_short_d16_hi v244,v246,s[16:19],s71 offen offset:1536
s_waitcnt vmcnt(45)
v_lshlrev_b32 v234,16,v28
v_lshlrev_b32 v232,16,v24
v_lshlrev_b32 v233,16,v26
v_lshlrev_b32 v237,16,v34
s_waitcnt vmcnt(43)
v_lshlrev_b32 v236,16,v32
v_lshlrev_b32 v235,16,v30
v_fmac_f32 v232,s43,v234
v_fmac_f32 v237,4.0,v233
v_fma_f32 v238,-4.0,v234,v236
v_fmac_f32 v232,s45,v236
v_fmac_f32 v237,s40,v235
v_sub_f32 v236,v236,v234
v_fma_f32 v234,-4.0,v233,v235
v_sub_f32 v235,v235,v233
v_add_f32 v233,v238,v234
v_sub_f32 v238,v238,v234
v_fma_f32 v234,2.0,v235,v236
v_fmac_f32 v236,-2.0,v235
v_and_b32 v28,s42,v28
v_and_b32 v24,s42,v24
v_and_b32 v26,s42,v26
v_and_b32 v34,s42,v34
v_and_b32 v32,s42,v32
v_and_b32 v30,s42,v30
v_fmac_f32 v24,s43,v28
v_fmac_f32 v34,4.0,v26
v_fma_f32 v235,-4.0,v28,v32
v_fmac_f32 v24,s45,v32
v_fmac_f32 v34,s40,v30
v_sub_f32 v32,v32,v28
v_fma_f32 v28,-4.0,v26,v30
v_sub_f32 v30,v30,v26
v_add_f32 v26,v235,v28
v_sub_f32 v235,v235,v28
v_fma_f32 v28,2.0,v30,v32
v_fmac_f32 v32,-2.0,v30
v_cvt_pk_bf16_f32 v24,v232,v24
v_cvt_pk_bf16_f32 v34,v237,v34
v_cvt_pk_bf16_f32 v26,v233,v26
v_cvt_pk_bf16_f32 v30,v234,v28
v_cvt_pk_bf16_f32 v28,v238,v235
v_cvt_pk_bf16_f32 v32,v236,v32
v_lshlrev_b32 v234,16,v29
v_lshlrev_b32 v232,16,v25
v_lshlrev_b32 v233,16,v27
v_lshlrev_b32 v237,16,v35
v_lshlrev_b32 v236,16,v33
v_lshlrev_b32 v235,16,v31
v_fmac_f32 v232,s43,v234
v_fmac_f32 v237,4.0,v233
v_fma_f32 v238,-4.0,v234,v236
v_fmac_f32 v232,s45,v236
v_fmac_f32 v237,s40,v235
v_sub_f32 v236,v236,v234
v_fma_f32 v234,-4.0,v233,v235
v_sub_f32 v235,v235,v233
v_add_f32 v233,v238,v234
v_sub_f32 v238,v238,v234
v_fma_f32 v234,2.0,v235,v236
v_fmac_f32 v236,-2.0,v235
v_and_b32 v29,s42,v29
v_and_b32 v25,s42,v25
v_and_b32 v27,s42,v27
v_and_b32 v35,s42,v35
v_and_b32 v33,s42,v33
v_and_b32 v31,s42,v31
v_fmac_f32 v25,s43,v29
v_fmac_f32 v35,4.0,v27
v_fma_f32 v235,-4.0,v29,v33
v_fmac_f32 v25,s45,v33
v_fmac_f32 v35,s40,v31
v_sub_f32 v33,v33,v29
v_fma_f32 v29,-4.0,v27,v31
v_sub_f32 v31,v31,v27
v_add_f32 v27,v235,v29
v_sub_f32 v235,v235,v29
v_fma_f32 v29,2.0,v31,v33
v_fmac_f32 v33,-2.0,v31
v_cvt_pk_bf16_f32 v25,v232,v25
v_cvt_pk_bf16_f32 v35,v237,v35
v_cvt_pk_bf16_f32 v27,v233,v27
v_cvt_pk_bf16_f32 v31,v234,v29
v_cvt_pk_bf16_f32 v29,v238,v235
v_cvt_pk_bf16_f32 v33,v236,v33
ds_write2st64_b64 v247,v[24:25],v[34:35] offset0:2 offset1:19
ds_write2st64_b64 v247,v[26:27],v[28:29] offset0:36 offset1:53
ds_write2st64_b64 v247,v[30:31],v[32:33] offset0:70 offset1:87
s_waitcnt vmcnt(39)
v_lshlrev_b32 v234,16,v40
v_lshlrev_b32 v232,16,v36
v_lshlrev_b32 v233,16,v38
v_lshlrev_b32 v237,16,v46
s_waitcnt vmcnt(37)
v_lshlrev_b32 v236,16,v44
v_lshlrev_b32 v235,16,v42
v_fmac_f32 v232,s43,v234
v_fmac_f32 v237,4.0,v233
v_fma_f32 v238,-4.0,v234,v236
v_fmac_f32 v232,s45,v236
v_fmac_f32 v237,s40,v235
v_sub_f32 v236,v236,v234
v_fma_f32 v234,-4.0,v233,v235
v_sub_f32 v235,v235,v233
v_add_f32 v233,v238,v234
v_sub_f32 v238,v238,v234
v_fma_f32 v234,2.0,v235,v236
v_fmac_f32 v236,-2.0,v235
v_and_b32 v40,s42,v40
v_and_b32 v36,s42,v36
v_and_b32 v38,s42,v38
v_and_b32 v46,s42,v46
v_and_b32 v44,s42,v44
v_and_b32 v42,s42,v42
v_fmac_f32 v36,s43,v40
v_fmac_f32 v46,4.0,v38
v_fma_f32 v235,-4.0,v40,v44
v_fmac_f32 v36,s45,v44
v_fmac_f32 v46,s40,v42
v_sub_f32 v44,v44,v40
v_fma_f32 v40,-4.0,v38,v42
v_sub_f32 v42,v42,v38
v_add_f32 v38,v235,v40
v_sub_f32 v235,v235,v40
v_fma_f32 v40,2.0,v42,v44
v_fmac_f32 v44,-2.0,v42
v_cvt_pk_bf16_f32 v36,v232,v36
v_cvt_pk_bf16_f32 v46,v237,v46
v_cvt_pk_bf16_f32 v38,v233,v38
v_cvt_pk_bf16_f32 v42,v234,v40
v_cvt_pk_bf16_f32 v40,v238,v235
v_cvt_pk_bf16_f32 v44,v236,v44
v_lshlrev_b32 v234,16,v41
v_lshlrev_b32 v232,16,v37
v_lshlrev_b32 v233,16,v39
v_lshlrev_b32 v237,16,v47
v_lshlrev_b32 v236,16,v45
v_lshlrev_b32 v235,16,v43
v_fmac_f32 v232,s43,v234
v_fmac_f32 v237,4.0,v233
v_fma_f32 v238,-4.0,v234,v236
v_fmac_f32 v232,s45,v236
v_fmac_f32 v237,s40,v235
v_sub_f32 v236,v236,v234
v_fma_f32 v234,-4.0,v233,v235
v_sub_f32 v235,v235,v233
v_add_f32 v233,v238,v234
v_sub_f32 v238,v238,v234
v_fma_f32 v234,2.0,v235,v236
v_fmac_f32 v236,-2.0,v235
v_and_b32 v41,s42,v41
v_and_b32 v37,s42,v37
v_and_b32 v39,s42,v39
v_and_b32 v47,s42,v47
v_and_b32 v45,s42,v45
v_and_b32 v43,s42,v43
v_fmac_f32 v37,s43,v41
v_fmac_f32 v47,4.0,v39
v_fma_f32 v235,-4.0,v41,v45
v_fmac_f32 v37,s45,v45
v_fmac_f32 v47,s40,v43
v_sub_f32 v45,v45,v41
v_fma_f32 v41,-4.0,v39,v43
v_sub_f32 v43,v43,v39
v_add_f32 v39,v235,v41
v_sub_f32 v235,v235,v41
v_fma_f32 v41,2.0,v43,v45
v_fmac_f32 v45,-2.0,v43
v_cvt_pk_bf16_f32 v37,v232,v37
v_cvt_pk_bf16_f32 v47,v237,v47
v_cvt_pk_bf16_f32 v39,v233,v39
v_cvt_pk_bf16_f32 v43,v234,v41
v_cvt_pk_bf16_f32 v41,v238,v235
v_cvt_pk_bf16_f32 v45,v236,v45
ds_write2st64_b64 v247,v[36:37],v[46:47] offset0:3 offset1:20
ds_write2st64_b64 v247,v[38:39],v[40:41] offset0:37 offset1:54
ds_write2st64_b64 v247,v[42:43],v[44:45] offset0:71 offset1:88
s_waitcnt vmcnt(34)
v_fmac_f32 v48,s43,v50
s_waitcnt vmcnt(31)
v_fmac_f32 v53,4.0,v49
v_fma_f32 v232,-4.0,v50,v52
v_fmac_f32 v48,s45,v52
v_fmac_f32 v53,s40,v51
v_sub_f32 v52,v52,v50
v_fma_f32 v50,-4.0,v49,v51
v_sub_f32 v51,v51,v49
v_add_f32 v49,v232,v50
v_sub_f32 v232,v232,v50
v_fma_f32 v50,2.0,v51,v52
v_fmac_f32 v52,-2.0,v51
v_cvt_pk_bf16_f32 v233,v48,v53
v_cvt_pk_bf16_f32 v234,v49,v232
v_cvt_pk_bf16_f32 v235,v50,v52
ds_write_b16 v248,v233 offset:0
ds_write_b16_d16_hi v248,v233 offset:8704
ds_write_b16 v248,v234 offset:17408
ds_write_b16_d16_hi v248,v234 offset:26112
ds_write_b16 v248,v235 offset:34816
ds_write_b16_d16_hi v248,v235 offset:43520
s_waitcnt lgkmcnt(0)
s_barrier
ds_read_b128 a[192:195],v249 offset:17408
ds_read_b128 a[196:199],v250 offset:17664
ds_read_b128 a[200:203],v250 offset:17920
ds_read_b128 a[204:207],v250 offset:18176
ds_read_b128 a[208:211],v250 offset:18432
ds_read_b128 a[212:215],v250 offset:18688
ds_read_b128 a[216:219],v250 offset:18944
ds_read_b128 a[220:223],v250 offset:19200
s_waitcnt vmcnt(29) lgkmcnt(7)
M a[0:3],a[224:227],a[192:195],0
s_waitcnt vmcnt(14) lgkmcnt(6)
v_lshlrev_b32 v234,16,v196
v_lshlrev_b32 v232,16,v192
M a[4:7],a[224:227],a[196:199],0
s_waitcnt lgkmcnt(5)
v_lshlrev_b32 v233,16,v194
v_lshlrev_b32 v237,16,v202
M a[8:11],a[224:227],a[200:203],0
s_waitcnt vmcnt(12) lgkmcnt(4)
v_lshlrev_b32 v236,16,v200
v_lshlrev_b32 v235,16,v198
M a[12:15],a[224:227],a[204:207],0
s_waitcnt lgkmcnt(3)
v_fmac_f32 v232,s43,v234
v_fmac_f32 v237,4.0,v233
M a[16:19],a[224:227],a[208:211],0
s_waitcnt lgkmcnt(2)
v_fma_f32 v238,-4.0,v234,v236
v_fmac_f32 v232,s45,v236
M a[20:23],a[224:227],a[212:215],0
s_waitcnt lgkmcnt(1)
v_fmac_f32 v237,s40,v235
v_sub_f32 v236,v236,v234
M a[24:27],a[224:227],a[216:219],0
s_waitcnt lgkmcnt(0)
v_fma_f32 v234,-4.0,v233,v235
v_sub_f32 v235,v235,v233
v_add_f32 v233,v238,v234
M a[28:31],a[224:227],a[220:223],0
buffer_load_dwordx4 a[224:227],v251,s[20:23],s46 offen offset:1024
M a[32:35],a[228:231],a[192:195],0
v_sub_f32 v238,v238,v234
v_fma_f32 v234,2.0,v235,v236
M a[36:39],a[228:231],a[196:199],0
v_fmac_f32 v236,-2.0,v235
v_and_b32 v196,s42,v196
M a[40:43],a[228:231],a[200:203],0
v_and_b32 v192,s42,v192
v_and_b32 v194,s42,v194
M a[44:47],a[228:231],a[204:207],0
v_and_b32 v202,s42,v202
v_and_b32 v200,s42,v200
M a[48:51],a[228:231],a[208:211],0
v_and_b32 v198,s42,v198
v_fmac_f32 v192,s43,v196
M a[52:55],a[228:231],a[212:215],0
v_fmac_f32 v202,4.0,v194
v_fma_f32 v235,-4.0,v196,v200
v_fmac_f32 v192,s45,v200
M a[56:59],a[228:231],a[216:219],0
v_fmac_f32 v202,s40,v198
v_sub_f32 v200,v200,v196
M a[60:63],a[228:231],a[220:223],0
buffer_load_dwordx4 a[228:231],v251,s[20:23],s47 offen offset:1024
M a[64:67],a[232:235],a[192:195],0
ds_read_b128 a[192:195],v250 offset:19456
v_fma_f32 v196,-4.0,v194,v198
M a[68:71],a[232:235],a[196:199],0
v_sub_f32 v198,v198,v194
v_add_f32 v194,v235,v196
M a[72:75],a[232:235],a[200:203],0
v_sub_f32 v235,v235,v196
v_fma_f32 v196,2.0,v198,v200
M a[76:79],a[232:235],a[204:207],0
v_fmac_f32 v200,-2.0,v198
v_cvt_pk_bf16_f32 v192,v232,v192
v_cvt_pk_bf16_f32 v202,v237,v202
M a[80:83],a[232:235],a[208:211],0
v_cvt_pk_bf16_f32 v194,v233,v194
v_cvt_pk_bf16_f32 v198,v234,v196
M a[84:87],a[232:235],a[212:215],0
v_cvt_pk_bf16_f32 v196,v238,v235
v_cvt_pk_bf16_f32 v200,v236,v200
M a[88:91],a[232:235],a[216:219],0
v_lshlrev_b32 v234,16,v197
v_lshlrev_b32 v232,16,v193
M a[92:95],a[232:235],a[220:223],0
buffer_load_dwordx4 a[232:235],v251,s[20:23],s48 offen offset:1024
M a[0:3],a[236:239],a[196:199],a[0:3]
v_lshlrev_b32 v233,16,v195
v_lshlrev_b32 v237,16,v203
M a[4:7],a[236:239],a[200:203],a[4:7]
v_lshlrev_b32 v236,16,v201
v_lshlrev_b32 v235,16,v199
M a[8:11],a[236:239],a[204:207],a[8:11]
v_fmac_f32 v232,s43,v234
v_fmac_f32 v237,4.0,v233
v_fma_f32 v238,-4.0,v234,v236
M a[12:15],a[236:239],a[208:211],a[12:15]
v_fmac_f32 v232,s45,v236
v_fmac_f32 v237,s40,v235
M a[16:19],a[236:239],a[212:215],a[16:19]
v_sub_f32 v236,v236,v234
v_fma_f32 v234,-4.0,v233,v235
M a[20:23],a[236:239],a[216:219],a[20:23]
v_sub_f32 v235,v235,v233
v_add_f32 v233,v238,v234
M a[24:27],a[236:239],a[220:223],a[24:27]
s_waitcnt lgkmcnt(0)
v_sub_f32 v238,v238,v234
v_fma_f32 v234,2.0,v235,v236
M a[28:31],a[236:239],a[192:195],a[28:31]
buffer_load_dwordx4 a[236:239],v251,s[20:23],s46 offen offset:2048
M a[32:35],a[240:243],a[196:199],a[32:35]
v_fmac_f32 v236,-2.0,v235
v_and_b32 v197,s42,v197
v_and_b32 v193,s42,v193
M a[36:39],a[240:243],a[200:203],a[36:39]
v_and_b32 v195,s42,v195
v_and_b32 v203,s42,v203
M a[40:43],a[240:243],a[204:207],a[40:43]
v_and_b32 v201,s42,v201
v_and_b32 v199,s42,v199
M a[44:47],a[240:243],a[208:211],a[44:47]
v_fmac_f32 v193,s43,v197
v_fmac_f32 v203,4.0,v195
M a[48:51],a[240:243],a[212:215],a[48:51]
v_fma_f32 v235,-4.0,v197,v201
v_fmac_f32 v193,s45,v201
M a[52:55],a[240:243],a[216:219],a[52:55]
v_fmac_f32 v203,s40,v199
v_sub_f32 v201,v201,v197
M a[56:59],a[240:243],a[220:223],a[56:59]
v_fma_f32 v197,-4.0,v195,v199
v_sub_f32 v199,v199,v195
M a[60:63],a[240:243],a[192:195],a[60:63]
buffer_load_dwordx4 a[240:243],v251,s[20:23],s47 offen offset:2048
v_add_f32 v195,v235,v197
M a[64:67],a[244:247],a[196:199],a[64:67]
ds_read_b128 a[196:199],v249 offset:19712
v_sub_f32 v235,v235,v197
M a[68:71],a[244:247],a[200:203],a[68:71]
v_fma_f32 v197,2.0,v199,v201
v_fmac_f32 v201,-2.0,v199
M a[72:75],a[244:247],a[204:207],a[72:75]
v_cvt_pk_bf16_f32 v193,v232,v193
v_cvt_pk_bf16_f32 v203,v237,v203
M a[76:79],a[244:247],a[208:211],a[76:79]
v_cvt_pk_bf16_f32 v195,v233,v195
v_cvt_pk_bf16_f32 v199,v234,v197
M a[80:83],a[244:247],a[212:215],a[80:83]
v_cvt_pk_bf16_f32 v197,v238,v235
v_cvt_pk_bf16_f32 v201,v236,v201
M a[84:87],a[244:247],a[216:219],a[84:87]
ds_write2st64_b64 v247,v[192:193],v[202:203] offset0:170 offset1:187
M a[88:91],a[244:247],a[220:223],a[88:91]
s_add_u32 s28,s65,786432
buffer_load_dwordx2 v[192:193],v245,s[12:15],s28 offen offset:0
M a[92:95],a[244:247],a[192:195],a[92:95]
buffer_load_dwordx2 v[202:203],v245,s[16:19],s28 offen offset:1536
M a[0:3],a[248:251],a[200:203],a[0:3]
buffer_load_dwordx4 a[244:247],v251,s[20:23],s48 offen offset:2048
M a[4:7],a[248:251],a[204:207],a[4:7]
s_add_u32 s46,s76,27648
ds_write2st64_b64 v247,v[194:195],v[196:197] offset0:102 offset1:119
M a[8:11],a[248:251],a[208:211],a[8:11]
buffer_load_dwordx2 v[194:195],v245,s[8:11],s28 offen offset:0
M a[12:15],a[248:251],a[212:215],a[12:15]
buffer_load_dwordx2 v[196:197],v245,s[8:11],s28 offen offset:384
M a[16:19],a[248:251],a[216:219],a[16:19]
ds_write2st64_b64 v247,v[198:199],v[200:201] offset0:136 offset1:153
M a[20:23],a[248:251],a[220:223],a[20:23]
buffer_load_dwordx2 v[198:199],v245,s[8:11],s28 offen offset:768
M a[24:27],a[248:251],a[192:195],a[24:27]
s_waitcnt lgkmcnt(3)
buffer_load_dwordx2 v[200:201],v245,s[8:11],s28 offen offset:1152
M a[28:31],a[248:251],a[196:199],a[28:31]
buffer_load_dwordx4 a[248:251],v251,s[20:23],s46 offen offset:0
M a[32:35],a[252:255],a[200:203],a[32:35]
s_waitcnt vmcnt(21)
v_lshlrev_b32 v234,16,v208
v_lshlrev_b32 v232,16,v204
M a[36:39],a[252:255],a[204:207],a[36:39]
s_add_u32 s47,s76,30720
v_lshlrev_b32 v233,16,v206
v_lshlrev_b32 v237,16,v214
M a[40:43],a[252:255],a[208:211],a[40:43]
s_waitcnt vmcnt(19)
v_lshlrev_b32 v236,16,v212
v_lshlrev_b32 v235,16,v210
M a[44:47],a[252:255],a[212:215],a[44:47]
v_fmac_f32 v232,s43,v234
v_fmac_f32 v237,4.0,v233
M a[48:51],a[252:255],a[216:219],a[48:51]
v_fma_f32 v238,-4.0,v234,v236
v_fmac_f32 v232,s45,v236
M a[52:55],a[252:255],a[220:223],a[52:55]
v_fmac_f32 v237,s40,v235
v_sub_f32 v236,v236,v234
M a[56:59],a[252:255],a[192:195],a[56:59]
v_fma_f32 v234,-4.0,v233,v235
v_sub_f32 v235,v235,v233
M a[60:63],a[252:255],a[196:199],a[60:63]
buffer_load_dwordx4 a[252:255],v251,s[20:23],s47 offen offset:0
M a[64:67],v[216:219],a[200:203],a[64:67]
ds_read_b128 a[200:203],v249 offset:26112
v_add_f32 v233,v238,v234
M a[68:71],v[216:219],a[204:207],a[68:71]
s_add_u32 s48,s76,33792
ds_read_b128 a[204:207],v250 offset:26368
v_sub_f32 v238,v238,v234
M a[72:75],v[216:219],a[208:211],a[72:75]
ds_read_b128 a[208:211],v250 offset:26624
v_fma_f32 v234,2.0,v235,v236
M a[76:79],v[216:219],a[212:215],a[76:79]
ds_read_b128 a[212:215],v250 offset:26880
v_fmac_f32 v236,-2.0,v235
M a[80:83],v[216:219],a[216:219],a[80:83]
ds_read_b128 a[216:219],v250 offset:27136
v_and_b32 v208,s42,v208
M a[84:87],v[216:219],a[220:223],a[84:87]
ds_read_b128 a[220:223],v250 offset:27392
v_and_b32 v204,s42,v204
M a[88:91],v[216:219],a[192:195],a[88:91]
ds_read_b128 a[192:195],v250 offset:27648
v_and_b32 v206,s42,v206
M a[92:95],v[216:219],a[196:199],a[92:95]
s_waitcnt lgkmcnt(6)
buffer_load_dwordx4 v[216:219],v251,s[20:23],s48 offen offset:0
M a[96:99],v[220:223],a[200:203],0
s_waitcnt lgkmcnt(5)
ds_read_b128 a[196:199],v250 offset:27904
v_and_b32 v214,s42,v214
M a[100:103],v[220:223],a[204:207],0
s_waitcnt lgkmcnt(5)
v_and_b32 v212,s42,v212
v_and_b32 v210,s42,v210
M a[104:107],v[220:223],a[208:211],0
s_waitcnt lgkmcnt(4)
v_fmac_f32 v204,s43,v208
v_fmac_f32 v214,4.0,v206
M a[108:111],v[220:223],a[212:215],0
s_waitcnt lgkmcnt(3)
v_fma_f32 v235,-4.0,v208,v212
v_fmac_f32 v204,s45,v212
M a[112:115],v[220:223],a[216:219],0
s_waitcnt lgkmcnt(2)
v_fmac_f32 v214,s40,v210
v_sub_f32 v212,v212,v208
M a[116:119],v[220:223],a[220:223],0
s_waitcnt lgkmcnt(1)
v_fma_f32 v208,-4.0,v206,v210
v_sub_f32 v210,v210,v206
M a[120:123],v[220:223],a[192:195],0
s_waitcnt lgkmcnt(0)
v_add_f32 v206,v235,v208
v_sub_f32 v235,v235,v208
M a[124:127],v[220:223],a[196:199],0
buffer_load_dwordx4 v[220:223],v251,s[20:23],s46 offen offset:1024
M a[128:131],v[224:227],a[200:203],0
v_fma_f32 v208,2.0,v210,v212
v_fmac_f32 v212,-2.0,v210
M a[132:135],v[224:227],a[204:207],0
v_cvt_pk_bf16_f32 v204,v232,v204
v_cvt_pk_bf16_f32 v214,v237,v214
M a[136:139],v[224:227],a[208:211],0
v_cvt_pk_bf16_f32 v206,v233,v206
v_cvt_pk_bf16_f32 v210,v234,v208
M a[140:143],v[224:227],a[212:215],0
v_cvt_pk_bf16_f32 v208,v238,v235
v_cvt_pk_bf16_f32 v212,v236,v212
M a[144:147],v[224:227],a[216:219],0
v_lshlrev_b32 v234,16,v209
v_lshlrev_b32 v232,16,v205
M a[148:151],v[224:227],a[220:223],0
v_lshlrev_b32 v233,16,v207
v_lshlrev_b32 v237,16,v215
M a[152:155],v[224:227],a[192:195],0
v_lshlrev_b32 v236,16,v213
v_lshlrev_b32 v235,16,v211
M a[156:159],v[224:227],a[196:199],0
buffer_load_dwordx4 v[224:227],v251,s[20:23],s47 offen offset:1024
M a[160:163],v[228:231],a[200:203],0
ds_read_b128 a[200:203],v250 offset:28160
v_fmac_f32 v232,s43,v234
M a[164:167],v[228:231],a[204:207],0
v_fmac_f32 v237,4.0,v233
v_fma_f32 v238,-4.0,v234,v236
M a[168:171],v[228:231],a[208:211],0
v_fmac_f32 v232,s45,v236
v_fmac_f32 v237,s40,v235
M a[172:175],v[228:231],a[212:215],0
v_sub_f32 v236,v236,v234
v_fma_f32 v234,-4.0,v233,v235
M a[176:179],v[228:231],a[216:219],0
v_sub_f32 v235,v235,v233
v_add_f32 v233,v238,v234
M a[180:183],v[228:231],a[220:223],0
v_sub_f32 v238,v238,v234
v_fma_f32 v234,2.0,v235,v236
M a[184:187],v[228:231],a[192:195],0
v_fmac_f32 v236,-2.0,v235
v_and_b32 v209,s42,v209
M a[188:191],v[228:231],a[196:199],0
s_waitcnt vmcnt(16)
buffer_load_dwordx4 v[228:231],v251,s[20:23],s48 offen offset:1024
M a[96:99],a[224:227],a[204:207],a[96:99]
v_and_b32 v205,s42,v205
v_and_b32 v207,s42,v207
M a[100:103],a[224:227],a[208:211],a[100:103]
v_and_b32 v215,s42,v215
v_and_b32 v213,s42,v213
M a[104:107],a[224:227],a[212:215],a[104:107]
v_and_b32 v211,s42,v211
v_fmac_f32 v205,s43,v209
M a[108:111],a[224:227],a[216:219],a[108:111]
v_fmac_f32 v215,4.0,v207
v_fma_f32 v235,-4.0,v209,v213
M a[112:115],a[224:227],a[220:223],a[112:115]
v_fmac_f32 v205,s45,v213
v_fmac_f32 v215,s40,v211
M a[116:119],a[224:227],a[192:195],a[116:119]
v_sub_f32 v213,v213,v209
v_fma_f32 v209,-4.0,v207,v211
M a[120:123],a[224:227],a[196:199],a[120:123]
s_waitcnt lgkmcnt(0)
v_sub_f32 v211,v211,v207
v_add_f32 v207,v235,v209
M a[124:127],a[224:227],a[200:203],a[124:127]
s_waitcnt vmcnt(16)
buffer_load_dwordx4 a[224:227],v251,s[20:23],s46 offen offset:2048
M a[128:131],a[228:231],a[204:207],a[128:131]
v_sub_f32 v235,v235,v209
v_fma_f32 v209,2.0,v211,v213
v_fmac_f32 v213,-2.0,v211
M a[132:135],a[228:231],a[208:211],a[132:135]
v_cvt_pk_bf16_f32 v205,v232,v205
v_cvt_pk_bf16_f32 v215,v237,v215
M a[136:139],a[228:231],a[212:215],a[136:139]
v_cvt_pk_bf16_f32 v207,v233,v207
v_cvt_pk_bf16_f32 v211,v234,v209
M a[140:143],a[228:231],a[216:219],a[140:143]
v_cvt_pk_bf16_f32 v209,v238,v235
v_cvt_pk_bf16_f32 v213,v236,v213
M a[144:147],a[228:231],a[220:223],a[144:147]
ds_write2st64_b64 v247,v[204:205],v[214:215] offset0:171 offset1:188
M a[148:151],a[228:231],a[192:195],a[148:151]
s_add_u32 s28,s65,1179648
buffer_load_dwordx2 v[204:205],v245,s[12:15],s28 offen offset:0
M a[152:155],a[228:231],a[196:199],a[152:155]
buffer_load_dwordx2 v[214:215],v245,s[16:19],s28 offen offset:1536
M a[156:159],a[228:231],a[200:203],a[156:159]
s_waitcnt vmcnt(18)
buffer_load_dwordx4 a[228:231],v251,s[20:23],s47 offen offset:2048
M a[160:163],a[232:235],a[204:207],a[160:163]
ds_read_b128 a[204:207],v249 offset:28416
ds_write2st64_b64 v247,v[206:207],v[208:209] offset0:103 offset1:120
M a[164:167],a[232:235],a[208:211],a[164:167]
buffer_load_dwordx2 v[206:207],v245,s[8:11],s28 offen offset:0
M a[168:171],a[232:235],a[212:215],a[168:171]
buffer_load_dwordx2 v[208:209],v245,s[8:11],s28 offen offset:384
M a[172:175],a[232:235],a[216:219],a[172:175]
ds_write2st64_b64 v247,v[210:211],v[212:213] offset0:137 offset1:154
M a[176:179],a[232:235],a[220:223],a[176:179]
buffer_load_dwordx2 v[210:211],v245,s[8:11],s28 offen offset:768
M a[180:183],a[232:235],a[192:195],a[180:183]
buffer_load_dwordx2 v[212:213],v245,s[8:11],s28 offen offset:1152
M a[184:187],a[232:235],a[196:199],a[184:187]
v_fmac_f32 v239,s43,v241
v_fmac_f32 v244,4.0,v240
M a[188:191],a[232:235],a[200:203],a[188:191]
s_waitcnt vmcnt(22)
buffer_load_dwordx4 a[232:235],v251,s[20:23],s48 offen offset:2048
M a[96:99],a[236:239],a[208:211],a[96:99]
v_fma_f32 v232,-4.0,v241,v243
v_fmac_f32 v239,s45,v243
M a[100:103],a[236:239],a[212:215],a[100:103]
s_add_u32 s46,s76,36864
v_fmac_f32 v244,s40,v242
v_sub_f32 v243,v243,v241
M a[104:107],a[236:239],a[216:219],a[104:107]
v_fma_f32 v241,-4.0,v240,v242
v_sub_f32 v242,v242,v240
M a[108:111],a[236:239],a[220:223],a[108:111]
v_add_f32 v240,v232,v241
v_sub_f32 v232,v232,v241
M a[112:115],a[236:239],a[192:195],a[112:115]
v_fma_f32 v241,2.0,v242,v243
v_fmac_f32 v243,-2.0,v242
M a[116:119],a[236:239],a[196:199],a[116:119]
v_cvt_pk_bf16_f32 v233,v239,v244
v_cvt_pk_bf16_f32 v234,v240,v232
M a[120:123],a[236:239],a[200:203],a[120:123]
s_waitcnt lgkmcnt(2)
v_cvt_pk_bf16_f32 v235,v241,v243
v_add_u32 v232,87040,v248
M a[124:127],a[236:239],a[204:207],a[124:127]
s_waitcnt vmcnt(22)
buffer_load_short_d16_hi v239,v246,s[12:15],s72 offen offset:0
M a[128:131],a[240:243],a[208:211],a[128:131]
buffer_load_short_d16_hi v240,v246,s[8:11],s72 offen offset:0
M a[132:135],a[240:243],a[212:215],a[132:135]
buffer_load_short_d16_hi v241,v246,s[8:11],s72 offen offset:384
M a[136:139],a[240:243],a[216:219],a[136:139]
buffer_load_short_d16_hi v242,v246,s[8:11],s72 offen offset:768
M a[140:143],a[240:243],a[220:223],a[140:143]
buffer_load_short_d16_hi v243,v246,s[8:11],s72 offen offset:1152
M a[144:147],a[240:243],a[192:195],a[144:147]
buffer_load_short_d16_hi v244,v246,s[16:19],s72 offen offset:1536
M a[148:151],a[240:243],a[196:199],a[148:151]
buffer_load_dwordx4 a[236:239],v251,s[20:23],s46 offen offset:0
M a[152:155],a[240:243],a[200:203],a[152:155]
s_add_u32 s47,s76,39936
ds_write_b16 v232,v233 offset:0
M a[156:159],a[240:243],a[204:207],a[156:159]
s_waitcnt vmcnt(26)
buffer_load_dwordx4 a[240:243],v251,s[20:23],s47 offen offset:0
M a[160:163],a[244:247],a[208:211],a[160:163]
ds_read_b128 a[208:211],v249 offset:34816
ds_write_b16_d16_hi v232,v233 offset:8704
M a[164:167],a[244:247],a[212:215],a[164:167]
s_add_u32 s48,s76,43008
ds_read_b128 a[212:215],v250 offset:35072
ds_write_b16 v248,v234 offset:52224
M a[168:171],a[244:247],a[216:219],a[168:171]
ds_read_b128 a[216:219],v250 offset:35328
ds_write_b16_d16_hi v248,v234 offset:60928
M a[172:175],a[244:247],a[220:223],a[172:175]
ds_read_b128 a[220:223],v250 offset:35584
v_add_u32 v232,69632,v248
M a[176:179],a[244:247],a[192:195],a[176:179]
ds_read_b128 a[192:195],v250 offset:35840
ds_write_b16 v232,v235 offset:0
M a[180:183],a[244:247],a[196:199],a[180:183]
ds_read_b128 a[196:199],v250 offset:36096
ds_write_b16_d16_hi v232,v235 offset:8704
M a[184:187],a[244:247],a[200:203],a[184:187]
s_waitcnt vmcnt(25)
ds_read_b128 a[200:203],v250 offset:36352
v_lshlrev_b32 v234,16,v196
M a[188:191],a[244:247],a[204:207],a[188:191]
s_waitcnt vmcnt(22) lgkmcnt(11)
buffer_load_dwordx4 a[244:247],v251,s[20:23],s48 offen offset:0
M v[0:3],a[248:251],a[208:211],0
s_waitcnt lgkmcnt(9)
ds_read_b128 a[204:207],v250 offset:36608
v_lshlrev_b32 v232,16,v192
M v[4:7],a[248:251],a[212:215],0
s_waitcnt lgkmcnt(8)
v_lshlrev_b32 v233,16,v194
v_lshlrev_b32 v237,16,v202
M v[8:11],a[248:251],a[216:219],0
s_waitcnt lgkmcnt(6)
v_lshlrev_b32 v236,16,v200
v_lshlrev_b32 v235,16,v198
M v[12:15],a[248:251],a[220:223],0
s_waitcnt lgkmcnt(5)
v_fmac_f32 v232,s43,v234
v_fmac_f32 v237,4.0,v233
M v[16:19],a[248:251],a[192:195],0
s_waitcnt lgkmcnt(3)
v_fma_f32 v238,-4.0,v234,v236
v_fmac_f32 v232,s45,v236
M v[20:23],a[248:251],a[196:199],0
s_waitcnt lgkmcnt(1)
v_fmac_f32 v237,s40,v235
v_sub_f32 v236,v236,v234
M v[24:27],a[248:251],a[200:203],0
s_waitcnt lgkmcnt(0)
v_fma_f32 v234,-4.0,v233,v235
v_sub_f32 v235,v235,v233
M v[28:31],a[248:251],a[204:207],0
s_waitcnt vmcnt(22)
buffer_load_dwordx4 a[248:251],v251,s[20:23],s46 offen offset:1024
M v[32:35],a[252:255],a[208:211],0
v_add_f32 v233,v238,v234
v_sub_f32 v238,v238,v234
M v[36:39],a[252:255],a[212:215],0
v_fma_f32 v234,2.0,v235,v236
v_fmac_f32 v236,-2.0,v235
M v[40:43],a[252:255],a[216:219],0
v_and_b32 v196,s42,v196
v_and_b32 v192,s42,v192
M v[44:47],a[252:255],a[220:223],0
v_and_b32 v194,s42,v194
v_and_b32 v202,s42,v202
M v[48:51],a[252:255],a[192:195],0
v_and_b32 v200,s42,v200
v_and_b32 v198,s42,v198
M v[52:55],a[252:255],a[196:199],0
v_fmac_f32 v192,s43,v196
v_fmac_f32 v202,4.0,v194
M v[56:59],a[252:255],a[200:203],0
v_fma_f32 v235,-4.0,v196,v200
v_fmac_f32 v192,s45,v200
M v[60:63],a[252:255],a[204:207],0
s_waitcnt vmcnt(22)
buffer_load_dwordx4 a[252:255],v251,s[20:23],s47 offen offset:1024
M v[64:67],v[216:219],a[208:211],0
ds_read_b128 a[208:211],v250 offset:36864
v_fmac_f32 v202,s40,v198
M v[68:71],v[216:219],a[212:215],0
v_sub_f32 v200,v200,v196
v_fma_f32 v196,-4.0,v194,v198
M v[72:75],v[216:219],a[216:219],0
v_sub_f32 v198,v198,v194
v_add_f32 v194,v235,v196
M v[76:79],v[216:219],a[220:223],0
v_sub_f32 v235,v235,v196
v_fma_f32 v196,2.0,v198,v200
M v[80:83],v[216:219],a[192:195],0
v_fmac_f32 v200,-2.0,v198
v_cvt_pk_bf16_f32 v192,v232,v192
M v[84:87],v[216:219],a[196:199],0
v_cvt_pk_bf16_f32 v202,v237,v202
v_cvt_pk_bf16_f32 v194,v233,v194
M v[88:91],v[216:219],a[200:203],0
v_cvt_pk_bf16_f32 v198,v234,v196
v_cvt_pk_bf16_f32 v196,v238,v235
M v[92:95],v[216:219],a[204:207],0
s_waitcnt vmcnt(22)
buffer_load_dwordx4 v[216:219],v251,s[20:23],s48 offen offset:1024
M v[0:3],v[220:223],a[212:215],v[0:3]
v_cvt_pk_bf16_f32 v200,v236,v200
v_lshlrev_b32 v234,16,v197
M v[4:7],v[220:223],a[216:219],v[4:7]
v_lshlrev_b32 v232,16,v193
v_lshlrev_b32 v233,16,v195
M v[8:11],v[220:223],a[220:223],v[8:11]
v_lshlrev_b32 v237,16,v203
v_lshlrev_b32 v236,16,v201
M v[12:15],v[220:223],a[192:195],v[12:15]
v_lshlrev_b32 v235,16,v199
v_fmac_f32 v232,s43,v234
M v[16:19],v[220:223],a[196:199],v[16:19]
v_fmac_f32 v237,4.0,v233
v_fma_f32 v238,-4.0,v234,v236
M v[20:23],v[220:223],a[200:203],v[20:23]
v_fmac_f32 v232,s45,v236
v_fmac_f32 v237,s40,v235
M v[24:27],v[220:223],a[204:207],v[24:27]
s_waitcnt lgkmcnt(0)
v_sub_f32 v236,v236,v234
v_fma_f32 v234,-4.0,v233,v235
M v[28:31],v[220:223],a[208:211],v[28:31]
s_waitcnt vmcnt(22)
buffer_load_dwordx4 v[220:223],v251,s[20:23],s46 offen offset:2048
M v[32:35],v[224:227],a[212:215],v[32:35]
v_sub_f32 v235,v235,v233
v_add_f32 v233,v238,v234
M v[36:39],v[224:227],a[216:219],v[36:39]
v_sub_f32 v238,v238,v234
v_fma_f32 v234,2.0,v235,v236
M v[40:43],v[224:227],a[220:223],v[40:43]
v_fmac_f32 v236,-2.0,v235
v_and_b32 v197,s42,v197
M v[44:47],v[224:227],a[192:195],v[44:47]
v_and_b32 v193,s42,v193
v_and_b32 v195,s42,v195
M v[48:51],v[224:227],a[196:199],v[48:51]
v_and_b32 v203,s42,v203
v_and_b32 v201,s42,v201
M v[52:55],v[224:227],a[200:203],v[52:55]
v_and_b32 v199,s42,v199
v_fmac_f32 v193,s43,v197
M v[56:59],v[224:227],a[204:207],v[56:59]
v_fmac_f32 v203,4.0,v195
v_fma_f32 v235,-4.0,v197,v201
M v[60:63],v[224:227],a[208:211],v[60:63]
s_waitcnt vmcnt(22)
buffer_load_dwordx4 v[224:227],v251,s[20:23],s47 offen offset:2048
M v[64:67],v[228:231],a[212:215],v[64:67]
ds_read_b128 a[212:215],v249 offset:37120
v_fmac_f32 v193,s45,v201
M v[68:71],v[228:231],a[216:219],v[68:71]
v_fmac_f32 v203,s40,v199
v_sub_f32 v201,v201,v197
M v[72:75],v[228:231],a[220:223],v[72:75]
v_fma_f32 v197,-4.0,v195,v199
v_sub_f32 v199,v199,v195
M v[76:79],v[228:231],a[192:195],v[76:79]
v_add_f32 v195,v235,v197
v_sub_f32 v235,v235,v197
M v[80:83],v[228:231],a[196:199],v[80:83]
v_fma_f32 v197,2.0,v199,v201
v_fmac_f32 v201,-2.0,v199
M v[84:87],v[228:231],a[200:203],v[84:87]
v_cvt_pk_bf16_f32 v193,v232,v193
v_cvt_pk_bf16_f32 v203,v237,v203
M v[88:91],v[228:231],a[204:207],v[88:91]
v_cvt_pk_bf16_f32 v195,v233,v195
v_cvt_pk_bf16_f32 v199,v234,v197
M v[92:95],v[228:231],a[208:211],v[92:95]
s_waitcnt vmcnt(22)
buffer_load_dwordx4 v[228:231],v251,s[20:23],s48 offen offset:2048
M v[0:3],a[224:227],a[216:219],v[0:3]
v_cvt_pk_bf16_f32 v197,v238,v235
v_cvt_pk_bf16_f32 v201,v236,v201
M v[4:7],a[224:227],a[220:223],v[4:7]
s_add_u32 s46,s77,9216
ds_write2st64_b64 v247,v[192:193],v[202:203] offset0:172 offset1:189
M v[8:11],a[224:227],a[192:195],v[8:11]
s_add_u32 s28,s66,0
buffer_load_dwordx2 v[192:193],v245,s[12:15],s28 offen offset:0
M v[12:15],a[224:227],a[196:199],v[12:15]
buffer_load_dwordx2 v[202:203],v245,s[16:19],s28 offen offset:1536
M v[16:19],a[224:227],a[200:203],v[16:19]
ds_write2st64_b64 v247,v[194:195],v[196:197] offset0:104 offset1:121
M v[20:23],a[224:227],a[204:207],v[20:23]
buffer_load_dwordx2 v[194:195],v245,s[8:11],s28 offen offset:0
M v[24:27],a[224:227],a[208:211],v[24:27]
s_waitcnt lgkmcnt(2)
buffer_load_dwordx2 v[196:197],v245,s[8:11],s28 offen offset:384
M v[28:31],a[224:227],a[212:215],v[28:31]
s_waitcnt vmcnt(24)
buffer_load_dwordx4 a[224:227],v251,s[20:23],s46 offen offset:0
M v[32:35],a[228:231],a[216:219],v[32:35]
ds_write2st64_b64 v247,v[198:199],v[200:201] offset0:138 offset1:155
M v[36:39],a[228:231],a[220:223],v[36:39]
s_add_u32 s47,s77,12288
buffer_load_dwordx2 v[198:199],v245,s[8:11],s28 offen offset:768
M v[40:43],a[228:231],a[192:195],v[40:43]
buffer_load_dwordx2 v[200:201],v245,s[8:11],s28 offen offset:1152
M v[44:47],a[228:231],a[196:199],v[44:47]
s_waitcnt vmcnt(25)
v_lshlrev_b32 v234,16,v208
v_lshlrev_b32 v232,16,v204
M v[48:51],a[228:231],a[200:203],v[48:51]
v_lshlrev_b32 v233,16,v206
v_lshlrev_b32 v237,16,v214
M v[52:55],a[228:231],a[204:207],v[52:55]
s_waitcnt vmcnt(23)
v_lshlrev_b32 v236,16,v212
v_lshlrev_b32 v235,16,v210
M v[56:59],a[228:231],a[208:211],v[56:59]
v_fmac_f32 v232,s43,v234
v_fmac_f32 v237,4.0,v233
M v[60:63],a[228:231],a[212:215],v[60:63]
s_waitcnt vmcnt(22)
buffer_load_dwordx4 a[228:231],v251,s[20:23],s47 offen offset:0
M v[64:67],a[232:235],a[216:219],v[64:67]
ds_read_b128 a[216:219],v249 offset:43520
v_fma_f32 v238,-4.0,v234,v236
M v[68:71],a[232:235],a[220:223],v[68:71]
s_add_u32 s48,s77,15360
ds_read_b128 a[220:223],v250 offset:43776
v_fmac_f32 v232,s45,v236
M v[72:75],a[232:235],a[192:195],v[72:75]
ds_read_b128 a[192:195],v250 offset:44032
v_fmac_f32 v237,s40,v235
M v[76:79],a[232:235],a[196:199],v[76:79]
ds_read_b128 a[196:199],v250 offset:44288
v_sub_f32 v236,v236,v234
M v[80:83],a[232:235],a[200:203],v[80:83]
ds_read_b128 a[200:203],v250 offset:44544
v_fma_f32 v234,-4.0,v233,v235
M v[84:87],a[232:235],a[204:207],v[84:87]
ds_read_b128 a[204:207],v250 offset:44800
v_sub_f32 v235,v235,v233
M v[88:91],a[232:235],a[208:211],v[88:91]
ds_read_b128 a[208:211],v250 offset:45056
v_add_f32 v233,v238,v234
M v[92:95],a[232:235],a[212:215],v[92:95]
s_waitcnt vmcnt(16) lgkmcnt(6)
buffer_load_dwordx4 a[232:235],v251,s[20:23],s48 offen offset:0
M v[96:99],a[236:239],a[216:219],0
s_waitcnt lgkmcnt(5)
ds_read_b128 a[212:215],v250 offset:45312
v_sub_f32 v238,v238,v234
M v[100:103],a[236:239],a[220:223],0
s_waitcnt lgkmcnt(5)
v_fma_f32 v234,2.0,v235,v236
v_fmac_f32 v236,-2.0,v235
M v[104:107],a[236:239],a[192:195],0
s_waitcnt lgkmcnt(4)
v_and_b32 v208,s42,v208
v_and_b32 v204,s42,v204
M v[108:111],a[236:239],a[196:199],0
s_waitcnt lgkmcnt(3)
v_and_b32 v206,s42,v206
v_and_b32 v214,s42,v214
M v[112:115],a[236:239],a[200:203],0
s_waitcnt lgkmcnt(2)
v_and_b32 v212,s42,v212
v_and_b32 v210,s42,v210
M v[116:119],a[236:239],a[204:207],0
s_waitcnt lgkmcnt(1)
v_fmac_f32 v204,s43,v208
v_fmac_f32 v214,4.0,v206
M v[120:123],a[236:239],a[208:211],0
s_waitcnt lgkmcnt(0)
v_fma_f32 v235,-4.0,v208,v212
v_fmac_f32 v204,s45,v212
M v[124:127],a[236:239],a[212:215],0
s_waitcnt vmcnt(16)
buffer_load_dwordx4 a[236:239],v251,s[20:23],s46 offen offset:1024
M v[128:131],a[240:243],a[216:219],0
v_fmac_f32 v214,s40,v210
v_sub_f32 v212,v212,v208
M v[132:135],a[240:243],a[220:223],0
v_fma_f32 v208,-4.0,v206,v210
v_sub_f32 v210,v210,v206
M v[136:139],a[240:243],a[192:195],0
v_add_f32 v206,v235,v208
v_sub_f32 v235,v235,v208
M v[140:143],a[240:243],a[196:199],0
v_fma_f32 v208,2.0,v210,v212
v_fmac_f32 v212,-2.0,v210
M v[144:147],a[240:243],a[200:203],0
v_cvt_pk_bf16_f32 v204,v232,v204
v_cvt_pk_bf16_f32 v214,v237,v214
M v[148:151],a[240:243],a[204:207],0
v_cvt_pk_bf16_f32 v206,v233,v206
v_cvt_pk_bf16_f32 v210,v234,v208
M v[152:155],a[240:243],a[208:211],0
v_cvt_pk_bf16_f32 v208,v238,v235
v_cvt_pk_bf16_f32 v212,v236,v212
M v[156:159],a[240:243],a[212:215],0
s_waitcnt vmcnt(16)
buffer_load_dwordx4 a[240:243],v251,s[20:23],s47 offen offset:1024
M v[160:163],a[244:247],a[216:219],0
ds_read_b128 a[216:219],v250 offset:45568
v_lshlrev_b32 v234,16,v209
M v[164:167],a[244:247],a[220:223],0
v_lshlrev_b32 v232,16,v205
v_lshlrev_b32 v233,16,v207
M v[168:171],a[244:247],a[192:195],0
v_lshlrev_b32 v237,16,v215
v_lshlrev_b32 v236,16,v213
M v[172:175],a[244:247],a[196:199],0
v_lshlrev_b32 v235,16,v211
v_fmac_f32 v232,s43,v234
M v[176:179],a[244:247],a[200:203],0
v_fmac_f32 v237,4.0,v233
v_fma_f32 v238,-4.0,v234,v236
M v[180:183],a[244:247],a[204:207],0
v_fmac_f32 v232,s45,v236
v_fmac_f32 v237,s40,v235
M v[184:187],a[244:247],a[208:211],0
v_sub_f32 v236,v236,v234
v_fma_f32 v234,-4.0,v233,v235
M v[188:191],a[244:247],a[212:215],0
s_waitcnt vmcnt(16)
buffer_load_dwordx4 a[244:247],v251,s[20:23],s48 offen offset:1024
M v[96:99],a[248:251],a[220:223],v[96:99]
v_sub_f32 v235,v235,v233
v_add_f32 v233,v238,v234
M v[100:103],a[248:251],a[192:195],v[100:103]
v_sub_f32 v238,v238,v234
v_fma_f32 v234,2.0,v235,v236
M v[104:107],a[248:251],a[196:199],v[104:107]
v_fmac_f32 v236,-2.0,v235
v_and_b32 v209,s42,v209
M v[108:111],a[248:251],a[200:203],v[108:111]
v_and_b32 v205,s42,v205
v_and_b32 v207,s42,v207
M v[112:115],a[248:251],a[204:207],v[112:115]
v_and_b32 v215,s42,v215
v_and_b32 v213,s42,v213
M v[116:119],a[248:251],a[208:211],v[116:119]
v_and_b32 v211,s42,v211
v_fmac_f32 v205,s43,v209
M v[120:123],a[248:251],a[212:215],v[120:123]
s_waitcnt lgkmcnt(0)
v_fmac_f32 v215,4.0,v207
v_fma_f32 v235,-4.0,v209,v213
M v[124:127],a[248:251],a[216:219],v[124:127]
s_waitcnt vmcnt(16)
buffer_load_dwordx4 a[248:251],v251,s[20:23],s46 offen offset:2048
M v[128:131],a[252:255],a[220:223],v[128:131]
v_fmac_f32 v205,s45,v213
v_fmac_f32 v215,s40,v211
M v[132:135],a[252:255],a[192:195],v[132:135]
v_sub_f32 v213,v213,v209
v_fma_f32 v209,-4.0,v207,v211
M v[136:139],a[252:255],a[196:199],v[136:139]
v_sub_f32 v211,v211,v207
v_add_f32 v207,v235,v209
M v[140:143],a[252:255],a[200:203],v[140:143]
v_sub_f32 v235,v235,v209
v_fma_f32 v209,2.0,v211,v213
M v[144:147],a[252:255],a[204:207],v[144:147]
v_fmac_f32 v213,-2.0,v211
v_cvt_pk_bf16_f32 v205,v232,v205
M v[148:151],a[252:255],a[208:211],v[148:151]
v_cvt_pk_bf16_f32 v215,v237,v215
v_cvt_pk_bf16_f32 v207,v233,v207
M v[152:155],a[252:255],a[212:215],v[152:155]
v_cvt_pk_bf16_f32 v211,v234,v209
v_cvt_pk_bf16_f32 v209,v238,v235
M v[156:159],a[252:255],a[216:219],v[156:159]
s_waitcnt vmcnt(16)
buffer_load_dwordx4 a[252:255],v251,s[20:23],s47 offen offset:2048
M v[160:163],v[216:219],a[220:223],v[160:163]
ds_read_b128 a[220:223],v249 offset:45824
v_cvt_pk_bf16_f32 v213,v236,v213
M v[164:167],v[216:219],a[192:195],v[164:167]
ds_write2st64_b64 v247,v[204:205],v[214:215] offset0:173 offset1:190
M v[168:171],v[216:219],a[196:199],v[168:171]
s_add_u32 s28,s66,393216
buffer_load_dwordx2 v[204:205],v245,s[12:15],s28 offen offset:0
M v[172:175],v[216:219],a[200:203],v[172:175]
buffer_load_dwordx2 v[214:215],v245,s[16:19],s28 offen offset:1536
M v[176:179],v[216:219],a[204:207],v[176:179]
ds_write2st64_b64 v247,v[206:207],v[208:209] offset0:105 offset1:122
M v[180:183],v[216:219],a[208:211],v[180:183]
buffer_load_dwordx2 v[206:207],v245,s[8:11],s28 offen offset:0
M v[184:187],v[216:219],a[212:215],v[184:187]
buffer_load_dwordx2 v[208:209],v245,s[8:11],s28 offen offset:384
M v[188:191],v[216:219],a[216:219],v[188:191]
s_waitcnt vmcnt(20)
buffer_load_dwordx4 v[216:219],v251,s[20:23],s48 offen offset:2048
M v[96:99],v[220:223],a[192:195],v[96:99]
ds_write2st64_b64 v247,v[210:211],v[212:213] offset0:139 offset1:156
M v[100:103],v[220:223],a[196:199],v[100:103]
s_add_u32 s46,s77,18432
buffer_load_dwordx2 v[210:211],v245,s[8:11],s28 offen offset:768
M v[104:107],v[220:223],a[200:203],v[104:107]
buffer_load_dwordx2 v[212:213],v245,s[8:11],s28 offen offset:1152
M v[108:111],v[220:223],a[204:207],v[108:111]
s_waitcnt vmcnt(17)
v_lshlrev_b32 v234,16,v196
v_lshlrev_b32 v232,16,v192
M v[112:115],v[220:223],a[208:211],v[112:115]
v_lshlrev_b32 v233,16,v194
v_lshlrev_b32 v237,16,v202
M v[116:119],v[220:223],a[212:215],v[116:119]
s_waitcnt vmcnt(14)
v_lshlrev_b32 v236,16,v200
v_lshlrev_b32 v235,16,v198
M v[120:123],v[220:223],a[216:219],v[120:123]
s_waitcnt lgkmcnt(3)
v_fmac_f32 v232,s43,v234
v_fmac_f32 v237,4.0,v233
M v[124:127],v[220:223],a[220:223],v[124:127]
buffer_load_dwordx4 v[220:223],v251,s[20:23],s46 offen offset:0
M v[128:131],v[224:227],a[192:195],v[128:131]
v_fma_f32 v238,-4.0,v234,v236
v_fmac_f32 v232,s45,v236
M v[132:135],v[224:227],a[196:199],v[132:135]
s_add_u32 s47,s77,21504
v_fmac_f32 v237,s40,v235
v_sub_f32 v236,v236,v234
M v[136:139],v[224:227],a[200:203],v[136:139]
v_fma_f32 v234,-4.0,v233,v235
v_sub_f32 v235,v235,v233
M v[140:143],v[224:227],a[204:207],v[140:143]
v_add_f32 v233,v238,v234
v_sub_f32 v238,v238,v234
M v[144:147],v[224:227],a[208:211],v[144:147]
v_fma_f32 v234,2.0,v235,v236
v_fmac_f32 v236,-2.0,v235
M v[148:151],v[224:227],a[212:215],v[148:151]
v_and_b32 v196,s42,v196
v_and_b32 v192,s42,v192
M v[152:155],v[224:227],a[216:219],v[152:155]
s_waitcnt lgkmcnt(0)
s_barrier
v_and_b32 v194,s42,v194
M v[156:159],v[224:227],a[220:223],v[156:159]
buffer_load_dwordx4 v[224:227],v251,s[20:23],s47 offen offset:0
M v[160:163],v[228:231],a[192:195],v[160:163]
ds_read_b128 a[192:195],v249 offset:52224
v_and_b32 v202,s42,v202
M v[164:167],v[228:231],a[196:199],v[164:167]
s_add_u32 s48,s77,24576
ds_read_b128 a[196:199],v250 offset:52480
v_and_b32 v200,s42,v200
M v[168:171],v[228:231],a[200:203],v[168:171]
ds_read_b128 a[200:203],v250 offset:52736
v_and_b32 v198,s42,v198
M v[172:175],v[228:231],a[204:207],v[172:175]
ds_read_b128 a[204:207],v250 offset:52992
v_fmac_f32 v192,s43,v196
M v[176:179],v[228:231],a[208:211],v[176:179]
ds_read_b128 a[208:211],v250 offset:53248
v_fmac_f32 v202,4.0,v194
M v[180:183],v[228:231],a[212:215],v[180:183]
ds_read_b128 a[212:215],v250 offset:53504
v_fma_f32 v235,-4.0,v196,v200
M v[184:187],v[228:231],a[216:219],v[184:187]
ds_read_b128 a[216:219],v250 offset:53760
v_fmac_f32 v192,s45,v200
M v[188:191],v[228:231],a[220:223],v[188:191]
s_waitcnt lgkmcnt(6)
buffer_load_dwordx4 v[228:231],v251,s[20:23],s48 offen offset:0
M a[0:3],a[224:227],a[192:195],a[0:3]
s_waitcnt lgkmcnt(5)
ds_read_b128 a[220:223],v250 offset:54016
v_fmac_f32 v202,s40,v198
M a[4:7],a[224:227],a[196:199],a[4:7]
s_waitcnt lgkmcnt(5)
v_sub_f32 v200,v200,v196
v_fma_f32 v196,-4.0,v194,v198
M a[8:11],a[224:227],a[200:203],a[8:11]
s_waitcnt lgkmcnt(4)
v_sub_f32 v198,v198,v194
v_add_f32 v194,v235,v196
M a[12:15],a[224:227],a[204:207],a[12:15]
s_waitcnt lgkmcnt(3)
v_sub_f32 v235,v235,v196
v_fma_f32 v196,2.0,v198,v200
M a[16:19],a[224:227],a[208:211],a[16:19]
s_waitcnt lgkmcnt(2)
v_fmac_f32 v200,-2.0,v198
v_cvt_pk_bf16_f32 v192,v232,v192
M a[20:23],a[224:227],a[212:215],a[20:23]
s_waitcnt lgkmcnt(1)
v_cvt_pk_bf16_f32 v202,v237,v202
v_cvt_pk_bf16_f32 v194,v233,v194
M a[24:27],a[224:227],a[216:219],a[24:27]
s_waitcnt lgkmcnt(0)
v_cvt_pk_bf16_f32 v198,v234,v196
v_cvt_pk_bf16_f32 v196,v238,v235
M a[28:31],a[224:227],a[220:223],a[28:31]
s_waitcnt vmcnt(16)
buffer_load_dwordx4 a[224:227],v251,s[20:23],s46 offen offset:1024
M a[32:35],a[228:231],a[192:195],a[32:35]
v_cvt_pk_bf16_f32 v200,v236,v200
v_lshlrev_b32 v234,16,v197
M a[36:39],a[228:231],a[196:199],a[36:39]
v_lshlrev_b32 v232,16,v193
v_lshlrev_b32 v233,16,v195
M a[40:43],a[228:231],a[200:203],a[40:43]
v_lshlrev_b32 v237,16,v203
v_lshlrev_b32 v236,16,v201
M a[44:47],a[228:231],a[204:207],a[44:47]
v_lshlrev_b32 v235,16,v199
v_fmac_f32 v232,s43,v234
M a[48:51],a[228:231],a[208:211],a[48:51]
v_fmac_f32 v237,4.0,v233
v_fma_f32 v238,-4.0,v234,v236
M a[52:55],a[228:231],a[212:215],a[52:55]
v_fmac_f32 v232,s45,v236
v_fmac_f32 v237,s40,v235
M a[56:59],a[228:231],a[216:219],a[56:59]
v_sub_f32 v236,v236,v234
v_fma_f32 v234,-4.0,v233,v235
M a[60:63],a[228:231],a[220:223],a[60:63]
s_waitcnt vmcnt(16)
buffer_load_dwordx4 a[228:231],v251,s[20:23],s47 offen offset:1024
M a[64:67],a[232:235],a[192:195],a[64:67]
ds_read_b128 a[192:195],v250 offset:54272
v_sub_f32 v235,v235,v233
M a[68:71],a[232:235],a[196:199],a[68:71]
v_add_f32 v233,v238,v234
v_sub_f32 v238,v238,v234
M a[72:75],a[232:235],a[200:203],a[72:75]
v_fma_f32 v234,2.0,v235,v236
v_fmac_f32 v236,-2.0,v235
M a[76:79],a[232:235],a[204:207],a[76:79]
v_and_b32 v197,s42,v197
v_and_b32 v193,s42,v193
M a[80:83],a[232:235],a[208:211],a[80:83]
v_and_b32 v195,s42,v195
v_and_b32 v203,s42,v203
M a[84:87],a[232:235],a[212:215],a[84:87]
v_and_b32 v201,s42,v201
v_and_b32 v199,s42,v199
M a[88:91],a[232:235],a[216:219],a[88:91]
v_fmac_f32 v193,s43,v197
v_fmac_f32 v203,4.0,v195
M a[92:95],a[232:235],a[220:223],a[92:95]
s_waitcnt vmcnt(16)
buffer_load_dwordx4 a[232:235],v251,s[20:23],s48 offen offset:1024
M a[0:3],a[236:239],a[196:199],a[0:3]
v_fma_f32 v235,-4.0,v197,v201
v_fmac_f32 v193,s45,v201
M a[4:7],a[236:239],a[200:203],a[4:7]
v_fmac_f32 v203,s40,v199
v_sub_f32 v201,v201,v197
M a[8:11],a[236:239],a[204:207],a[8:11]
v_fma_f32 v197,-4.0,v195,v199
v_sub_f32 v199,v199,v195
M a[12:15],a[236:239],a[208:211],a[12:15]
v_add_f32 v195,v235,v197
v_sub_f32 v235,v235,v197
M a[16:19],a[236:239],a[212:215],a[16:19]
v_fma_f32 v197,2.0,v199,v201
v_fmac_f32 v201,-2.0,v199
M a[20:23],a[236:239],a[216:219],a[20:23]
v_cvt_pk_bf16_f32 v193,v232,v193
v_cvt_pk_bf16_f32 v203,v237,v203
M a[24:27],a[236:239],a[220:223],a[24:27]
s_waitcnt lgkmcnt(0)
v_cvt_pk_bf16_f32 v195,v233,v195
v_cvt_pk_bf16_f32 v199,v234,v197
M a[28:31],a[236:239],a[192:195],a[28:31]
s_waitcnt vmcnt(16)
buffer_load_dwordx4 a[236:239],v251,s[20:23],s46 offen offset:2048
M a[32:35],a[240:243],a[196:199],a[32:35]
v_cvt_pk_bf16_f32 v197,v238,v235
v_cvt_pk_bf16_f32 v201,v236,v201
M a[36:39],a[240:243],a[200:203],a[36:39]
ds_write2st64_b64 v247,v[192:193],v[202:203] offset0:204 offset1:221
M a[40:43],a[240:243],a[204:207],a[40:43]
s_add_u32 s28,s66,786432
buffer_load_dwordx2 v[192:193],v245,s[12:15],s28 offen offset:0
M a[44:47],a[240:243],a[208:211],a[44:47]
buffer_load_dwordx2 v[202:203],v245,s[16:19],s28 offen offset:1536
M a[48:51],a[240:243],a[212:215],a[48:51]
ds_write2st64_b64 v247,v[194:195],v[196:197] offset0:34 offset1:51
M a[52:55],a[240:243],a[216:219],a[52:55]
buffer_load_dwordx2 v[194:195],v245,s[8:11],s28 offen offset:0
M a[56:59],a[240:243],a[220:223],a[56:59]
buffer_load_dwordx2 v[196:197],v245,s[8:11],s28 offen offset:384
M a[60:63],a[240:243],a[192:195],a[60:63]
s_waitcnt vmcnt(20)
buffer_load_dwordx4 a[240:243],v251,s[20:23],s47 offen offset:2048
M a[64:67],a[244:247],a[196:199],a[64:67]
ds_read_b128 a[196:199],v249 offset:54528
ds_write2st64_b64 v247,v[198:199],v[200:201] offset0:68 offset1:85
M a[68:71],a[244:247],a[200:203],a[68:71]
buffer_load_dwordx2 v[198:199],v245,s[8:11],s28 offen offset:768
M a[72:75],a[244:247],a[204:207],a[72:75]
buffer_load_dwordx2 v[200:201],v245,s[8:11],s28 offen offset:1152
M a[76:79],a[244:247],a[208:211],a[76:79]
s_waitcnt vmcnt(17)
v_lshlrev_b32 v234,16,v208
v_lshlrev_b32 v232,16,v204
M a[80:83],a[244:247],a[212:215],a[80:83]
v_lshlrev_b32 v233,16,v206
v_lshlrev_b32 v237,16,v214
M a[84:87],a[244:247],a[216:219],a[84:87]
s_waitcnt vmcnt(14)
v_lshlrev_b32 v236,16,v212
v_lshlrev_b32 v235,16,v210
M a[88:91],a[244:247],a[220:223],a[88:91]
v_fmac_f32 v232,s43,v234
v_fmac_f32 v237,4.0,v233
M a[92:95],a[244:247],a[192:195],a[92:95]
buffer_load_dwordx4 a[244:247],v251,s[20:23],s48 offen offset:2048
M a[0:3],a[248:251],a[200:203],a[0:3]
v_fma_f32 v238,-4.0,v234,v236
v_fmac_f32 v232,s45,v236
M a[4:7],a[248:251],a[204:207],a[4:7]
s_add_u32 s46,s77,27648
v_fmac_f32 v237,s40,v235
v_sub_f32 v236,v236,v234
M a[8:11],a[248:251],a[208:211],a[8:11]
v_fma_f32 v234,-4.0,v233,v235
v_sub_f32 v235,v235,v233
M a[12:15],a[248:251],a[212:215],a[12:15]
v_add_f32 v233,v238,v234
v_sub_f32 v238,v238,v234
M a[16:19],a[248:251],a[216:219],a[16:19]
v_fma_f32 v234,2.0,v235,v236
v_fmac_f32 v236,-2.0,v235
M a[20:23],a[248:251],a[220:223],a[20:23]
v_and_b32 v208,s42,v208
v_and_b32 v204,s42,v204
M a[24:27],a[248:251],a[192:195],a[24:27]
s_waitcnt lgkmcnt(1)
v_and_b32 v206,s42,v206
v_and_b32 v214,s42,v214
M a[28:31],a[248:251],a[196:199],a[28:31]
buffer_load_dwordx4 a[248:251],v251,s[20:23],s46 offen offset:0
M a[32:35],a[252:255],a[200:203],a[32:35]
v_and_b32 v212,s42,v212
v_and_b32 v210,s42,v210
M a[36:39],a[252:255],a[204:207],a[36:39]
s_add_u32 s47,s77,30720
v_fmac_f32 v204,s43,v208
v_fmac_f32 v214,4.0,v206
M a[40:43],a[252:255],a[208:211],a[40:43]
v_fma_f32 v235,-4.0,v208,v212
v_fmac_f32 v204,s45,v212
M a[44:47],a[252:255],a[212:215],a[44:47]
v_fmac_f32 v214,s40,v210
v_sub_f32 v212,v212,v208
M a[48:51],a[252:255],a[216:219],a[48:51]
v_fma_f32 v208,-4.0,v206,v210
v_sub_f32 v210,v210,v206
M a[52:55],a[252:255],a[220:223],a[52:55]
v_add_f32 v206,v235,v208
v_sub_f32 v235,v235,v208
M a[56:59],a[252:255],a[192:195],a[56:59]
v_fma_f32 v208,2.0,v210,v212
v_fmac_f32 v212,-2.0,v210
M a[60:63],a[252:255],a[196:199],a[60:63]
buffer_load_dwordx4 a[252:255],v251,s[20:23],s47 offen offset:0
M a[64:67],v[216:219],a[200:203],a[64:67]
ds_read_b128 a[200:203],v249 offset:60928
v_cvt_pk_bf16_f32 v204,v232,v204
M a[68:71],v[216:219],a[204:207],a[68:71]
s_add_u32 s48,s77,33792
ds_read_b128 a[204:207],v250 offset:61184
v_cvt_pk_bf16_f32 v214,v237,v214
M a[72:75],v[216:219],a[208:211],a[72:75]
ds_read_b128 a[208:211],v250 offset:61440
v_cvt_pk_bf16_f32 v206,v233,v206
M a[76:79],v[216:219],a[212:215],a[76:79]
ds_read_b128 a[212:215],v250 offset:61696
v_cvt_pk_bf16_f32 v210,v234,v208
M a[80:83],v[216:219],a[216:219],a[80:83]
ds_read_b128 a[216:219],v250 offset:61952
v_cvt_pk_bf16_f32 v208,v238,v235
M a[84:87],v[216:219],a[220:223],a[84:87]
ds_read_b128 a[220:223],v250 offset:62208
v_cvt_pk_bf16_f32 v212,v236,v212
M a[88:91],v[216:219],a[192:195],a[88:91]
ds_read_b128 a[192:195],v250 offset:62464
v_lshlrev_b32 v234,16,v209
M a[92:95],v[216:219],a[196:199],a[92:95]
s_waitcnt vmcnt(16) lgkmcnt(6)
buffer_load_dwordx4 v[216:219],v251,s[20:23],s48 offen offset:0
M a[96:99],v[220:223],a[200:203],a[96:99]
s_waitcnt lgkmcnt(5)
ds_read_b128 a[196:199],v250 offset:62720
v_lshlrev_b32 v232,16,v205
M a[100:103],v[220:223],a[204:207],a[100:103]
s_waitcnt lgkmcnt(5)
v_lshlrev_b32 v233,16,v207
v_lshlrev_b32 v237,16,v215
M a[104:107],v[220:223],a[208:211],a[104:107]
s_waitcnt lgkmcnt(4)
v_lshlrev_b32 v236,16,v213
v_lshlrev_b32 v235,16,v211
M a[108:111],v[220:223],a[212:215],a[108:111]
s_waitcnt lgkmcnt(3)
v_fmac_f32 v232,s43,v234
v_fmac_f32 v237,4.0,v233
M a[112:115],v[220:223],a[216:219],a[112:115]
s_waitcnt lgkmcnt(2)
v_fma_f32 v238,-4.0,v234,v236
v_fmac_f32 v232,s45,v236
M a[116:119],v[220:223],a[220:223],a[116:119]
s_waitcnt lgkmcnt(1)
v_fmac_f32 v237,s40,v235
v_sub_f32 v236,v236,v234
M a[120:123],v[220:223],a[192:195],a[120:123]
s_waitcnt lgkmcnt(0)
v_fma_f32 v234,-4.0,v233,v235
v_sub_f32 v235,v235,v233
M a[124:127],v[220:223],a[196:199],a[124:127]
s_waitcnt vmcnt(16)
buffer_load_dwordx4 v[220:223],v251,s[20:23],s46 offen offset:1024
M a[128:131],v[224:227],a[200:203],a[128:131]
v_add_f32 v233,v238,v234
v_sub_f32 v238,v238,v234
M a[132:135],v[224:227],a[204:207],a[132:135]
v_fma_f32 v234,2.0,v235,v236
v_fmac_f32 v236,-2.0,v235
M a[136:139],v[224:227],a[208:211],a[136:139]
v_and_b32 v209,s42,v209
v_and_b32 v205,s42,v205
M a[140:143],v[224:227],a[212:215],a[140:143]
v_and_b32 v207,s42,v207
v_and_b32 v215,s42,v215
M a[144:147],v[224:227],a[216:219],a[144:147]
v_and_b32 v213,s42,v213
v_and_b32 v211,s42,v211
M a[148:151],v[224:227],a[220:223],a[148:151]
v_fmac_f32 v205,s43,v209
v_fmac_f32 v215,4.0,v207
M a[152:155],v[224:227],a[192:195],a[152:155]
v_fma_f32 v235,-4.0,v209,v213
v_fmac_f32 v205,s45,v213
M a[156:159],v[224:227],a[196:199],a[156:159]
s_waitcnt vmcnt(16)
buffer_load_dwordx4 v[224:227],v251,s[20:23],s47 offen offset:1024
M a[160:163],v[228:231],a[200:203],a[160:163]
ds_read_b128 a[200:203],v250 offset:62976
v_fmac_f32 v215,s40,v211
M a[164:167],v[228:231],a[204:207],a[164:167]
v_sub_f32 v213,v213,v209
v_fma_f32 v209,-4.0,v207,v211
M a[168:171],v[228:231],a[208:211],a[168:171]
v_sub_f32 v211,v211,v207
v_add_f32 v207,v235,v209
M a[172:175],v[228:231],a[212:215],a[172:175]
v_sub_f32 v235,v235,v209
v_fma_f32 v209,2.0,v211,v213
M a[176:179],v[228:231],a[216:219],a[176:179]
v_fmac_f32 v213,-2.0,v211
v_cvt_pk_bf16_f32 v205,v232,v205
M a[180:183],v[228:231],a[220:223],a[180:183]
v_cvt_pk_bf16_f32 v215,v237,v215
v_cvt_pk_bf16_f32 v207,v233,v207
M a[184:187],v[228:231],a[192:195],a[184:187]
v_cvt_pk_bf16_f32 v211,v234,v209
v_cvt_pk_bf16_f32 v209,v238,v235
M a[188:191],v[228:231],a[196:199],a[188:191]
s_waitcnt vmcnt(16)
buffer_load_dwordx4 v[228:231],v251,s[20:23],s48 offen offset:1024
M a[96:99],a[224:227],a[204:207],a[96:99]
v_cvt_pk_bf16_f32 v213,v236,v213
M a[100:103],a[224:227],a[208:211],a[100:103]
ds_write2st64_b64 v247,v[204:205],v[214:215] offset0:205 offset1:222
M a[104:107],a[224:227],a[212:215],a[104:107]
s_add_u32 s28,s66,1179648
buffer_load_dwordx2 v[204:205],v245,s[12:15],s28 offen offset:0
M a[108:111],a[224:227],a[216:219],a[108:111]
buffer_load_dwordx2 v[214:215],v245,s[16:19],s28 offen offset:1536
M a[112:115],a[224:227],a[220:223],a[112:115]
ds_write2st64_b64 v247,v[206:207],v[208:209] offset0:35 offset1:52
M a[116:119],a[224:227],a[192:195],a[116:119]
buffer_load_dwordx2 v[206:207],v245,s[8:11],s28 offen offset:0
M a[120:123],a[224:227],a[196:199],a[120:123]
s_waitcnt lgkmcnt(2)
buffer_load_dwordx2 v[208:209],v245,s[8:11],s28 offen offset:384
M a[124:127],a[224:227],a[200:203],a[124:127]
s_waitcnt vmcnt(20)
buffer_load_dwordx4 a[224:227],v251,s[20:23],s46 offen offset:2048
M a[128:131],a[228:231],a[204:207],a[128:131]
ds_write2st64_b64 v247,v[210:211],v[212:213] offset0:69 offset1:86
M a[132:135],a[228:231],a[208:211],a[132:135]
buffer_load_dwordx2 v[210:211],v245,s[8:11],s28 offen offset:768
M a[136:139],a[228:231],a[212:215],a[136:139]
buffer_load_dwordx2 v[212:213],v245,s[8:11],s28 offen offset:1152
M a[140:143],a[228:231],a[216:219],a[140:143]
v_fmac_f32 v239,s43,v241
v_fmac_f32 v244,4.0,v240
M a[144:147],a[228:231],a[220:223],a[144:147]
v_fma_f32 v232,-4.0,v241,v243
v_fmac_f32 v239,s45,v243
M a[148:151],a[228:231],a[192:195],a[148:151]
v_fmac_f32 v244,s40,v242
v_sub_f32 v243,v243,v241
M a[152:155],a[228:231],a[196:199],a[152:155]
v_fma_f32 v241,-4.0,v240,v242
v_sub_f32 v242,v242,v240
M a[156:159],a[228:231],a[200:203],a[156:159]
s_waitcnt vmcnt(22)
buffer_load_dwordx4 a[228:231],v251,s[20:23],s47 offen offset:2048
M a[160:163],a[232:235],a[204:207],a[160:163]
ds_read_b128 a[204:207],v249 offset:63232
v_add_f32 v240,v232,v241
M a[164:167],a[232:235],a[208:211],a[164:167]
v_sub_f32 v232,v232,v241
v_fma_f32 v241,2.0,v242,v243
M a[168:171],a[232:235],a[212:215],a[168:171]
v_fmac_f32 v243,-2.0,v242
v_cvt_pk_bf16_f32 v233,v239,v244
M a[172:175],a[232:235],a[216:219],a[172:175]
v_cvt_pk_bf16_f32 v234,v240,v232
v_cvt_pk_bf16_f32 v235,v241,v243
M a[176:179],a[232:235],a[220:223],a[176:179]
buffer_load_short_d16_hi v239,v246,s[12:15],s73 offen offset:0
M a[180:183],a[232:235],a[192:195],a[180:183]
buffer_load_short_d16_hi v240,v246,s[8:11],s73 offen offset:0
M a[184:187],a[232:235],a[196:199],a[184:187]
buffer_load_short_d16_hi v241,v246,s[8:11],s73 offen offset:384
M a[188:191],a[232:235],a[200:203],a[188:191]
s_waitcnt vmcnt(25)
buffer_load_short_d16_hi v242,v246,s[8:11],s73 offen offset:768
M a[96:99],a[236:239],a[208:211],a[96:99]
buffer_load_short_d16_hi v243,v246,s[8:11],s73 offen offset:1152
M a[100:103],a[236:239],a[212:215],a[100:103]
buffer_load_short_d16_hi v244,v246,s[16:19],s73 offen offset:1536
M a[104:107],a[236:239],a[216:219],a[104:107]
buffer_load_dwordx4 a[232:235],v251,s[20:23],s48 offen offset:2048
M a[108:111],a[236:239],a[220:223],a[108:111]
s_add_u32 s46,s77,36864
v_add_u32 v232,104448,v248
M a[112:115],a[236:239],a[192:195],a[112:115]
ds_write_b16 v232,v233 offset:0
M a[116:119],a[236:239],a[196:199],a[116:119]
ds_write_b16_d16_hi v232,v233 offset:8704
M a[120:123],a[236:239],a[200:203],a[120:123]
s_waitcnt lgkmcnt(2)
ds_write_b16 v248,v234 offset:17408
M a[124:127],a[236:239],a[204:207],a[124:127]
s_waitcnt vmcnt(24)
buffer_load_dwordx4 a[236:239],v251,s[20:23],s46 offen offset:0
M a[128:131],a[240:243],a[208:211],a[128:131]
ds_write_b16_d16_hi v248,v234 offset:26112
M a[132:135],a[240:243],a[212:215],a[132:135]
s_add_u32 s47,s77,39936
ds_write_b16 v248,v235 offset:34816
M a[136:139],a[240:243],a[216:219],a[136:139]
ds_write_b16_d16_hi v248,v235 offset:43520
M a[140:143],a[240:243],a[220:223],a[140:143]
v_lshlrev_b32 v234,16,v196
v_lshlrev_b32 v232,16,v192
M a[144:147],a[240:243],a[192:195],a[144:147]
v_lshlrev_b32 v233,16,v194
v_lshlrev_b32 v237,16,v202
M a[148:151],a[240:243],a[196:199],a[148:151]
v_add_u32 v249,0x4400,v249
v_add_u32 v250,0x4400,v250
M a[152:155],a[240:243],a[200:203],a[152:155]
s_waitcnt vmcnt(23)
v_lshlrev_b32 v236,16,v200
v_lshlrev_b32 v235,16,v198
M a[156:159],a[240:243],a[204:207],a[156:159]
s_waitcnt vmcnt(22)
buffer_load_dwordx4 a[240:243],v251,s[20:23],s47 offen offset:0
M a[160:163],a[244:247],a[208:211],a[160:163]
ds_read_b128 a[208:211],v249 offset:52224
v_fmac_f32 v232,s43,v234
M a[164:167],a[244:247],a[212:215],a[164:167]
s_add_u32 s48,s77,43008
ds_read_b128 a[212:215],v250 offset:52480
v_fmac_f32 v237,4.0,v233
M a[168:171],a[244:247],a[216:219],a[168:171]
ds_read_b128 a[216:219],v250 offset:52736
v_fma_f32 v238,-4.0,v234,v236
M a[172:175],a[244:247],a[220:223],a[172:175]
ds_read_b128 a[220:223],v250 offset:52992
v_fmac_f32 v232,s45,v236
M a[176:179],a[244:247],a[192:195],a[176:179]
ds_read_b128 a[192:195],v250 offset:53248
v_fmac_f32 v237,s40,v235
M a[180:183],a[244:247],a[196:199],a[180:183]
ds_read_b128 a[196:199],v250 offset:53504
v_sub_f32 v236,v236,v234
M a[184:187],a[244:247],a[200:203],a[184:187]
ds_read_b128 a[200:203],v250 offset:53760
v_fma_f32 v234,-4.0,v233,v235
M a[188:191],a[244:247],a[204:207],a[188:191]
s_waitcnt vmcnt(22) lgkmcnt(6)
buffer_load_dwordx4 a[244:247],v251,s[20:23],s48 offen offset:0
M v[0:3],a[248:251],a[208:211],v[0:3]
s_waitcnt lgkmcnt(5)
ds_read_b128 a[204:207],v250 offset:54016
v_sub_f32 v235,v235,v233
M v[4:7],a[248:251],a[212:215],v[4:7]
s_waitcnt lgkmcnt(5)
v_add_f32 v233,v238,v234
v_sub_f32 v238,v238,v234
M v[8:11],a[248:251],a[216:219],v[8:11]
s_waitcnt lgkmcnt(4)
v_fma_f32 v234,2.0,v235,v236
v_fmac_f32 v236,-2.0,v235
M v[12:15],a[248:251],a[220:223],v[12:15]
s_waitcnt lgkmcnt(3)
v_and_b32 v196,s42,v196
v_and_b32 v192,s42,v192
M v[16:19],a[248:251],a[192:195],v[16:19]
s_waitcnt lgkmcnt(2)
v_and_b32 v194,s42,v194
v_and_b32 v202,s42,v202
M v[20:23],a[248:251],a[196:199],v[20:23]
s_waitcnt lgkmcnt(1)
v_and_b32 v200,s42,v200
v_and_b32 v198,s42,v198
M v[24:27],a[248:251],a[200:203],v[24:27]
s_waitcnt lgkmcnt(0)
v_fmac_f32 v192,s43,v196
v_fmac_f32 v202,4.0,v194
M v[28:31],a[248:251],a[204:207],v[28:31]
s_waitcnt vmcnt(22)
buffer_load_dwordx4 a[248:251],v251,s[20:23],s46 offen offset:1024
M v[32:35],a[252:255],a[208:211],v[32:35]
v_fma_f32 v235,-4.0,v196,v200
v_fmac_f32 v192,s45,v200
M v[36:39],a[252:255],a[212:215],v[36:39]
v_fmac_f32 v202,s40,v198
v_sub_f32 v200,v200,v196
M v[40:43],a[252:255],a[216:219],v[40:43]
v_fma_f32 v196,-4.0,v194,v198
v_sub_f32 v198,v198,v194
M v[44:47],a[252:255],a[220:223],v[44:47]
v_add_f32 v194,v235,v196
v_sub_f32 v235,v235,v196
M v[48:51],a[252:255],a[192:195],v[48:51]
v_fma_f32 v196,2.0,v198,v200
v_fmac_f32 v200,-2.0,v198
M v[52:55],a[252:255],a[196:199],v[52:55]
v_cvt_pk_bf16_f32 v192,v232,v192
v_cvt_pk_bf16_f32 v202,v237,v202
M v[56:59],a[252:255],a[200:203],v[56:59]
v_cvt_pk_bf16_f32 v194,v233,v194
v_cvt_pk_bf16_f32 v198,v234,v196
M v[60:63],a[252:255],a[204:207],v[60:63]
s_waitcnt vmcnt(22)
buffer_load_dwordx4 a[252:255],v251,s[20:23],s47 offen offset:1024
M v[64:67],v[216:219],a[208:211],v[64:67]
ds_read_b128 a[208:211],v250 offset:54272
v_cvt_pk_bf16_f32 v196,v238,v235
M v[68:71],v[216:219],a[212:215],v[68:71]
v_cvt_pk_bf16_f32 v200,v236,v200
v_lshlrev_b32 v234,16,v197
M v[72:75],v[216:219],a[216:219],v[72:75]
v_lshlrev_b32 v232,16,v193
v_lshlrev_b32 v233,16,v195
M v[76:79],v[216:219],a[220:223],v[76:79]
v_lshlrev_b32 v237,16,v203
v_lshlrev_b32 v236,16,v201
M v[80:83],v[216:219],a[192:195],v[80:83]
v_lshlrev_b32 v235,16,v199
v_fmac_f32 v232,s43,v234
M v[84:87],v[216:219],a[196:199],v[84:87]
v_fmac_f32 v237,4.0,v233
v_fma_f32 v238,-4.0,v234,v236
M v[88:91],v[216:219],a[200:203],v[88:91]
v_fmac_f32 v232,s45,v236
v_fmac_f32 v237,s40,v235
M v[92:95],v[216:219],a[204:207],v[92:95]
s_waitcnt vmcnt(22)
buffer_load_dwordx4 v[216:219],v251,s[20:23],s48 offen offset:1024
M v[0:3],v[220:223],a[212:215],v[0:3]
v_sub_f32 v236,v236,v234
v_fma_f32 v234,-4.0,v233,v235
M v[4:7],v[220:223],a[216:219],v[4:7]
v_sub_f32 v235,v235,v233
v_add_f32 v233,v238,v234
M v[8:11],v[220:223],a[220:223],v[8:11]
v_sub_f32 v238,v238,v234
v_fma_f32 v234,2.0,v235,v236
M v[12:15],v[220:223],a[192:195],v[12:15]
v_fmac_f32 v236,-2.0,v235
v_and_b32 v197,s42,v197
M v[16:19],v[220:223],a[196:199],v[16:19]
v_and_b32 v193,s42,v193
v_and_b32 v195,s42,v195
M v[20:23],v[220:223],a[200:203],v[20:23]
v_and_b32 v203,s42,v203
v_and_b32 v201,s42,v201
M v[24:27],v[220:223],a[204:207],v[24:27]
s_waitcnt lgkmcnt(0)
v_and_b32 v199,s42,v199
v_fmac_f32 v193,s43,v197
M v[28:31],v[220:223],a[208:211],v[28:31]
s_waitcnt vmcnt(22)
buffer_load_dwordx4 v[220:223],v251,s[20:23],s46 offen offset:2048
M v[32:35],v[224:227],a[212:215],v[32:35]
v_fmac_f32 v203,4.0,v195
v_fma_f32 v235,-4.0,v197,v201
M v[36:39],v[224:227],a[216:219],v[36:39]
v_fmac_f32 v193,s45,v201
v_fmac_f32 v203,s40,v199
M v[40:43],v[224:227],a[220:223],v[40:43]
v_sub_f32 v201,v201,v197
v_fma_f32 v197,-4.0,v195,v199
M v[44:47],v[224:227],a[192:195],v[44:47]
v_sub_f32 v199,v199,v195
v_add_f32 v195,v235,v197
M v[48:51],v[224:227],a[196:199],v[48:51]
v_sub_f32 v235,v235,v197
v_fma_f32 v197,2.0,v199,v201
M v[52:55],v[224:227],a[200:203],v[52:55]
v_fmac_f32 v201,-2.0,v199
v_cvt_pk_bf16_f32 v193,v232,v193
M v[56:59],v[224:227],a[204:207],v[56:59]
v_cvt_pk_bf16_f32 v203,v237,v203
v_cvt_pk_bf16_f32 v195,v233,v195
M v[60:63],v[224:227],a[208:211],v[60:63]
s_waitcnt vmcnt(22)
buffer_load_dwordx4 v[224:227],v251,s[20:23],s47 offen offset:2048
M v[64:67],v[228:231],a[212:215],v[64:67]
ds_read_b128 a[212:215],v249 offset:54528
v_cvt_pk_bf16_f32 v199,v234,v197
M v[68:71],v[228:231],a[216:219],v[68:71]
v_cvt_pk_bf16_f32 v197,v238,v235
v_cvt_pk_bf16_f32 v201,v236,v201
M v[72:75],v[228:231],a[220:223],v[72:75]
ds_write2st64_b64 v247,v[192:193],v[202:203] offset0:206 offset1:223
M v[76:79],v[228:231],a[192:195],v[76:79]
s_add_u32 s28,s67,0
buffer_load_dwordx2 v[192:193],v245,s[12:15],s28 offen offset:0
M v[80:83],v[228:231],a[196:199],v[80:83]
buffer_load_dwordx2 v[202:203],v245,s[16:19],s28 offen offset:1536
M v[84:87],v[228:231],a[200:203],v[84:87]
ds_write2st64_b64 v247,v[194:195],v[196:197] offset0:36 offset1:53
M v[88:91],v[228:231],a[204:207],v[88:91]
buffer_load_dwordx2 v[194:195],v245,s[8:11],s28 offen offset:0
M v[92:95],v[228:231],a[208:211],v[92:95]
s_waitcnt vmcnt(21)
buffer_load_dwordx2 v[196:197],v245,s[8:11],s28 offen offset:384
M v[0:3],a[224:227],a[216:219],v[0:3]
buffer_load_dwordx4 v[228:231],v251,s[20:23],s48 offen offset:2048
M v[4:7],a[224:227],a[220:223],v[4:7]
s_add_u32 s46,s78,9216
ds_write2st64_b64 v247,v[198:199],v[200:201] offset0:70 offset1:87
M v[8:11],a[224:227],a[192:195],v[8:11]
buffer_load_dwordx2 v[198:199],v245,s[8:11],s28 offen offset:768
M v[12:15],a[224:227],a[196:199],v[12:15]
buffer_load_dwordx2 v[200:201],v245,s[8:11],s28 offen offset:1152
M v[16:19],a[224:227],a[200:203],v[16:19]
v_lshlrev_b32 v234,16,v208
v_lshlrev_b32 v232,16,v204
M v[20:23],a[224:227],a[204:207],v[20:23]
v_lshlrev_b32 v233,16,v206
v_lshlrev_b32 v237,16,v214
M v[24:27],a[224:227],a[208:211],v[24:27]
s_waitcnt vmcnt(23) lgkmcnt(3)
v_lshlrev_b32 v236,16,v212
v_lshlrev_b32 v235,16,v210
M v[28:31],a[224:227],a[212:215],v[28:31]
s_waitcnt vmcnt(22)
buffer_load_dwordx4 a[224:227],v251,s[20:23],s46 offen offset:0
M v[32:35],a[228:231],a[216:219],v[32:35]
v_fmac_f32 v232,s43,v234
v_fmac_f32 v237,4.0,v233
M v[36:39],a[228:231],a[220:223],v[36:39]
s_add_u32 s47,s78,12288
v_fma_f32 v238,-4.0,v234,v236
v_fmac_f32 v232,s45,v236
M v[40:43],a[228:231],a[192:195],v[40:43]
v_fmac_f32 v237,s40,v235
v_sub_f32 v236,v236,v234
M v[44:47],a[228:231],a[196:199],v[44:47]
v_fma_f32 v234,-4.0,v233,v235
v_sub_f32 v235,v235,v233
M v[48:51],a[228:231],a[200:203],v[48:51]
v_add_f32 v233,v238,v234
v_sub_f32 v238,v238,v234
M v[52:55],a[228:231],a[204:207],v[52:55]
v_fma_f32 v234,2.0,v235,v236
v_fmac_f32 v236,-2.0,v235
M v[56:59],a[228:231],a[208:211],v[56:59]
v_and_b32 v208,s42,v208
v_and_b32 v204,s42,v204
M v[60:63],a[228:231],a[212:215],v[60:63]
s_waitcnt vmcnt(16)
buffer_load_dwordx4 a[228:231],v251,s[20:23],s47 offen offset:0
M v[64:67],a[232:235],a[216:219],v[64:67]
ds_read_b128 a[216:219],v249 offset:60928
v_and_b32 v206,s42,v206
M v[68:71],a[232:235],a[220:223],v[68:71]
s_add_u32 s48,s78,15360
ds_read_b128 a[220:223],v250 offset:61184
v_and_b32 v214,s42,v214
M v[72:75],a[232:235],a[192:195],v[72:75]
ds_read_b128 a[192:195],v250 offset:61440
v_and_b32 v212,s42,v212
M v[76:79],a[232:235],a[196:199],v[76:79]
ds_read_b128 a[196:199],v250 offset:61696
v_and_b32 v210,s42,v210
M v[80:83],a[232:235],a[200:203],v[80:83]
ds_read_b128 a[200:203],v250 offset:61952
v_fmac_f32 v204,s43,v208
M v[84:87],a[232:235],a[204:207],v[84:87]
ds_read_b128 a[204:207],v250 offset:62208
v_fmac_f32 v214,4.0,v206
M v[88:91],a[232:235],a[208:211],v[88:91]
ds_read_b128 a[208:211],v250 offset:62464
v_fma_f32 v235,-4.0,v208,v212
M v[92:95],a[232:235],a[212:215],v[92:95]
s_waitcnt vmcnt(16) lgkmcnt(6)
buffer_load_dwordx4 a[232:235],v251,s[20:23],s48 offen offset:0
M v[96:99],a[236:239],a[216:219],v[96:99]
s_waitcnt lgkmcnt(5)
ds_read_b128 a[212:215],v250 offset:62720
v_fmac_f32 v204,s45,v212
M v[100:103],a[236:239],a[220:223],v[100:103]
s_waitcnt lgkmcnt(5)
v_fmac_f32 v214,s40,v210
v_sub_f32 v212,v212,v208
M v[104:107],a[236:239],a[192:195],v[104:107]
s_waitcnt lgkmcnt(4)
v_fma_f32 v208,-4.0,v206,v210
v_sub_f32 v210,v210,v206
M v[108:111],a[236:239],a[196:199],v[108:111]
s_waitcnt lgkmcnt(3)
v_add_f32 v206,v235,v208
v_sub_f32 v235,v235,v208
M v[112:115],a[236:239],a[200:203],v[112:115]
s_waitcnt lgkmcnt(2)
v_fma_f32 v208,2.0,v210,v212
v_fmac_f32 v212,-2.0,v210
M v[116:119],a[236:239],a[204:207],v[116:119]
s_waitcnt lgkmcnt(1)
v_cvt_pk_bf16_f32 v204,v232,v204
v_cvt_pk_bf16_f32 v214,v237,v214
M v[120:123],a[236:239],a[208:211],v[120:123]
s_waitcnt lgkmcnt(0)
v_cvt_pk_bf16_f32 v206,v233,v206
v_cvt_pk_bf16_f32 v210,v234,v208
M v[124:127],a[236:239],a[212:215],v[124:127]
s_waitcnt vmcnt(16)
buffer_load_dwordx4 a[236:239],v251,s[20:23],s46 offen offset:1024
M v[128:131],a[240:243],a[216:219],v[128:131]
v_cvt_pk_bf16_f32 v208,v238,v235
v_cvt_pk_bf16_f32 v212,v236,v212
M v[132:135],a[240:243],a[220:223],v[132:135]
v_lshlrev_b32 v234,16,v209
v_lshlrev_b32 v232,16,v205
M v[136:139],a[240:243],a[192:195],v[136:139]
v_lshlrev_b32 v233,16,v207
v_lshlrev_b32 v237,16,v215
M v[140:143],a[240:243],a[196:199],v[140:143]
v_lshlrev_b32 v236,16,v213
v_lshlrev_b32 v235,16,v211
M v[144:147],a[240:243],a[200:203],v[144:147]
v_fmac_f32 v232,s43,v234
v_fmac_f32 v237,4.0,v233
M v[148:151],a[240:243],a[204:207],v[148:151]
v_fma_f32 v238,-4.0,v234,v236
v_fmac_f32 v232,s45,v236
M v[152:155],a[240:243],a[208:211],v[152:155]
v_fmac_f32 v237,s40,v235
v_sub_f32 v236,v236,v234
M v[156:159],a[240:243],a[212:215],v[156:159]
s_waitcnt vmcnt(16)
buffer_load_dwordx4 a[240:243],v251,s[20:23],s47 offen offset:1024
M v[160:163],a[244:247],a[216:219],v[160:163]
ds_read_b128 a[216:219],v250 offset:62976
v_fma_f32 v234,-4.0,v233,v235
M v[164:167],a[244:247],a[220:223],v[164:167]
v_sub_f32 v235,v235,v233
v_add_f32 v233,v238,v234
M v[168:171],a[244:247],a[192:195],v[168:171]
v_sub_f32 v238,v238,v234
v_fma_f32 v234,2.0,v235,v236
M v[172:175],a[244:247],a[196:199],v[172:175]
v_fmac_f32 v236,-2.0,v235
v_and_b32 v209,s42,v209
M v[176:179],a[244:247],a[200:203],v[176:179]
v_and_b32 v205,s42,v205
v_and_b32 v207,s42,v207
M v[180:183],a[244:247],a[204:207],v[180:183]
v_and_b32 v215,s42,v215
v_and_b32 v213,s42,v213
M v[184:187],a[244:247],a[208:211],v[184:187]
v_and_b32 v211,s42,v211
v_fmac_f32 v205,s43,v209
M v[188:191],a[244:247],a[212:215],v[188:191]
s_waitcnt vmcnt(16)
buffer_load_dwordx4 a[244:247],v251,s[20:23],s48 offen offset:1024
M v[96:99],a[248:251],a[220:223],v[96:99]
v_fmac_f32 v215,4.0,v207
v_fma_f32 v235,-4.0,v209,v213
M v[100:103],a[248:251],a[192:195],v[100:103]
v_fmac_f32 v205,s45,v213
v_fmac_f32 v215,s40,v211
M v[104:107],a[248:251],a[196:199],v[104:107]
v_sub_f32 v213,v213,v209
v_fma_f32 v209,-4.0,v207,v211
M v[108:111],a[248:251],a[200:203],v[108:111]
v_sub_f32 v211,v211,v207
v_add_f32 v207,v235,v209
M v[112:115],a[248:251],a[204:207],v[112:115]
v_sub_f32 v235,v235,v209
v_fma_f32 v209,2.0,v211,v213
M v[116:119],a[248:251],a[208:211],v[116:119]
v_fmac_f32 v213,-2.0,v211
v_cvt_pk_bf16_f32 v205,v232,v205
M v[120:123],a[248:251],a[212:215],v[120:123]
s_waitcnt lgkmcnt(0)
v_cvt_pk_bf16_f32 v215,v237,v215
v_cvt_pk_bf16_f32 v207,v233,v207
M v[124:127],a[248:251],a[216:219],v[124:127]
s_waitcnt vmcnt(16)
buffer_load_dwordx4 a[248:251],v251,s[20:23],s46 offen offset:2048
M v[128:131],a[252:255],a[220:223],v[128:131]
v_cvt_pk_bf16_f32 v211,v234,v209
v_cvt_pk_bf16_f32 v209,v238,v235
M v[132:135],a[252:255],a[192:195],v[132:135]
v_cvt_pk_bf16_f32 v213,v236,v213
M v[136:139],a[252:255],a[196:199],v[136:139]
ds_write2st64_b64 v247,v[204:205],v[214:215] offset0:207 offset1:224
M v[140:143],a[252:255],a[200:203],v[140:143]
s_add_u32 s28,s67,393216
buffer_load_dwordx2 v[204:205],v245,s[12:15],s28 offen offset:0
M v[144:147],a[252:255],a[204:207],v[144:147]
buffer_load_dwordx2 v[214:215],v245,s[16:19],s28 offen offset:1536
M v[148:151],a[252:255],a[208:211],v[148:151]
ds_write2st64_b64 v247,v[206:207],v[208:209] offset0:37 offset1:54
M v[152:155],a[252:255],a[212:215],v[152:155]
buffer_load_dwordx2 v[206:207],v245,s[8:11],s28 offen offset:0
M v[156:159],a[252:255],a[216:219],v[156:159]
s_waitcnt vmcnt(19)
buffer_load_dwordx2 v[208:209],v245,s[8:11],s28 offen offset:384
M v[160:163],v[216:219],a[220:223],v[160:163]
buffer_load_dwordx4 a[252:255],v251,s[20:23],s47 offen offset:2048
M v[164:167],v[216:219],a[192:195],v[164:167]
ds_read_b128 a[220:223],v249 offset:63232
ds_write2st64_b64 v247,v[210:211],v[212:213] offset0:71 offset1:88
M v[168:171],v[216:219],a[196:199],v[168:171]
buffer_load_dwordx2 v[210:211],v245,s[8:11],s28 offen offset:768
M v[172:175],v[216:219],a[200:203],v[172:175]
buffer_load_dwordx2 v[212:213],v245,s[8:11],s28 offen offset:1152
M v[176:179],v[216:219],a[204:207],v[176:179]
s_waitcnt vmcnt(17)
v_lshlrev_b32 v234,16,v196
v_lshlrev_b32 v232,16,v192
M v[180:183],v[216:219],a[208:211],v[180:183]
v_lshlrev_b32 v233,16,v194
v_lshlrev_b32 v237,16,v202
M v[184:187],v[216:219],a[212:215],v[184:187]
s_waitcnt vmcnt(14)
v_lshlrev_b32 v236,16,v200
v_lshlrev_b32 v235,16,v198
M v[188:191],v[216:219],a[216:219],v[188:191]
buffer_load_dwordx4 v[216:219],v251,s[20:23],s48 offen offset:2048
M v[96:99],v[220:223],a[192:195],v[96:99]
v_fmac_f32 v232,s43,v234
v_fmac_f32 v237,4.0,v233
M v[100:103],v[220:223],a[196:199],v[100:103]
s_add_u32 s46,s78,18432
v_fma_f32 v238,-4.0,v234,v236
v_fmac_f32 v232,s45,v236
M v[104:107],v[220:223],a[200:203],v[104:107]
v_fmac_f32 v237,s40,v235
v_sub_f32 v236,v236,v234
M v[108:111],v[220:223],a[204:207],v[108:111]
v_fma_f32 v234,-4.0,v233,v235
v_sub_f32 v235,v235,v233
M v[112:115],v[220:223],a[208:211],v[112:115]
v_add_f32 v233,v238,v234
v_sub_f32 v238,v238,v234
M v[116:119],v[220:223],a[212:215],v[116:119]
v_fma_f32 v234,2.0,v235,v236
v_fmac_f32 v236,-2.0,v235
M v[120:123],v[220:223],a[216:219],v[120:123]
s_waitcnt lgkmcnt(1)
v_and_b32 v196,s42,v196
v_and_b32 v192,s42,v192
M v[124:127],v[220:223],a[220:223],v[124:127]
buffer_load_dwordx4 v[220:223],v251,s[20:23],s46 offen offset:0
M v[128:131],v[224:227],a[192:195],v[128:131]
v_and_b32 v194,s42,v194
v_and_b32 v202,s42,v202
M v[132:135],v[224:227],a[196:199],v[132:135]
s_add_u32 s47,s78,21504
v_and_b32 v200,s42,v200
v_and_b32 v198,s42,v198
M v[136:139],v[224:227],a[200:203],v[136:139]
v_fmac_f32 v192,s43,v196
v_fmac_f32 v202,4.0,v194
M v[140:143],v[224:227],a[204:207],v[140:143]
v_fma_f32 v235,-4.0,v196,v200
v_fmac_f32 v192,s45,v200
M v[144:147],v[224:227],a[208:211],v[144:147]
v_fmac_f32 v202,s40,v198
v_sub_f32 v200,v200,v196
M v[148:151],v[224:227],a[212:215],v[148:151]
v_fma_f32 v196,-4.0,v194,v198
v_sub_f32 v198,v198,v194
M v[152:155],v[224:227],a[216:219],v[152:155]
s_waitcnt lgkmcnt(0)
s_barrier
v_add_f32 v194,v235,v196
M v[156:159],v[224:227],a[220:223],v[156:159]
buffer_load_dwordx4 v[224:227],v251,s[20:23],s47 offen offset:0
M v[160:163],v[228:231],a[192:195],v[160:163]
ds_read_b128 a[192:195],v249 offset:0
v_sub_f32 v235,v235,v196
M v[164:167],v[228:231],a[196:199],v[164:167]
s_add_u32 s48,s78,24576
ds_read_b128 a[196:199],v250 offset:256
v_fma_f32 v196,2.0,v198,v200
M v[168:171],v[228:231],a[200:203],v[168:171]
ds_read_b128 a[200:203],v250 offset:512
v_fmac_f32 v200,-2.0,v198
M v[172:175],v[228:231],a[204:207],v[172:175]
ds_read_b128 a[204:207],v250 offset:768
v_cvt_pk_bf16_f32 v192,v232,v192
M v[176:179],v[228:231],a[208:211],v[176:179]
ds_read_b128 a[208:211],v250 offset:1024
v_cvt_pk_bf16_f32 v202,v237,v202
M v[180:183],v[228:231],a[212:215],v[180:183]
ds_read_b128 a[212:215],v250 offset:1280
v_cvt_pk_bf16_f32 v194,v233,v194
M v[184:187],v[228:231],a[216:219],v[184:187]
ds_read_b128 a[216:219],v250 offset:1536
v_cvt_pk_bf16_f32 v198,v234,v196
M v[188:191],v[228:231],a[220:223],v[188:191]
s_waitcnt vmcnt(16) lgkmcnt(6)
buffer_load_dwordx4 v[228:231],v251,s[20:23],s48 offen offset:0
M a[0:3],a[224:227],a[192:195],a[0:3]
s_waitcnt lgkmcnt(5)
ds_read_b128 a[220:223],v250 offset:1792
v_cvt_pk_bf16_f32 v196,v238,v235
M a[4:7],a[224:227],a[196:199],a[4:7]
s_waitcnt lgkmcnt(5)
v_cvt_pk_bf16_f32 v200,v236,v200
v_lshlrev_b32 v234,16,v197
M a[8:11],a[224:227],a[200:203],a[8:11]
s_waitcnt lgkmcnt(4)
v_lshlrev_b32 v232,16,v193
v_lshlrev_b32 v233,16,v195
M a[12:15],a[224:227],a[204:207],a[12:15]
s_waitcnt lgkmcnt(3)
v_lshlrev_b32 v237,16,v203
v_lshlrev_b32 v236,16,v201
M a[16:19],a[224:227],a[208:211],a[16:19]
s_waitcnt lgkmcnt(2)
v_lshlrev_b32 v235,16,v199
v_fmac_f32 v232,s43,v234
M a[20:23],a[224:227],a[212:215],a[20:23]
s_waitcnt lgkmcnt(1)
v_fmac_f32 v237,4.0,v233
v_fma_f32 v238,-4.0,v234,v236
M a[24:27],a[224:227],a[216:219],a[24:27]
s_waitcnt lgkmcnt(0)
v_fmac_f32 v232,s45,v236
v_fmac_f32 v237,s40,v235
M a[28:31],a[224:227],a[220:223],a[28:31]
s_waitcnt vmcnt(16)
buffer_load_dwordx4 a[224:227],v251,s[20:23],s46 offen offset:1024
M a[32:35],a[228:231],a[192:195],a[32:35]
v_sub_f32 v236,v236,v234
v_fma_f32 v234,-4.0,v233,v235
M a[36:39],a[228:231],a[196:199],a[36:39]
v_sub_f32 v235,v235,v233
v_add_f32 v233,v238,v234
M a[40:43],a[228:231],a[200:203],a[40:43]
v_sub_f32 v238,v238,v234
v_fma_f32 v234,2.0,v235,v236
M a[44:47],a[228:231],a[204:207],a[44:47]
v_fmac_f32 v236,-2.0,v235
v_and_b32 v197,s42,v197
M a[48:51],a[228:231],a[208:211],a[48:51]
v_and_b32 v193,s42,v193
v_and_b32 v195,s42,v195
M a[52:55],a[228:231],a[212:215],a[52:55]
v_and_b32 v203,s42,v203
v_and_b32 v201,s42,v201
M a[56:59],a[228:231],a[216:219],a[56:59]
v_and_b32 v199,s42,v199
v_fmac_f32 v193,s43,v197
M a[60:63],a[228:231],a[220:223],a[60:63]
s_waitcnt vmcnt(16)
buffer_load_dwordx4 a[228:231],v251,s[20:23],s47 offen offset:1024
M a[64:67],a[232:235],a[192:195],a[64:67]
ds_read_b128 a[192:195],v250 offset:2048
v_fmac_f32 v203,4.0,v195
M a[68:71],a[232:235],a[196:199],a[68:71]
v_fma_f32 v235,-4.0,v197,v201
v_fmac_f32 v193,s45,v201
M a[72:75],a[232:235],a[200:203],a[72:75]
v_fmac_f32 v203,s40,v199
v_sub_f32 v201,v201,v197
M a[76:79],a[232:235],a[204:207],a[76:79]
v_fma_f32 v197,-4.0,v195,v199
v_sub_f32 v199,v199,v195
M a[80:83],a[232:235],a[208:211],a[80:83]
v_add_f32 v195,v235,v197
v_sub_f32 v235,v235,v197
M a[84:87],a[232:235],a[212:215],a[84:87]
v_fma_f32 v197,2.0,v199,v201
v_fmac_f32 v201,-2.0,v199
M a[88:91],a[232:235],a[216:219],a[88:91]
v_cvt_pk_bf16_f32 v193,v232,v193
v_cvt_pk_bf16_f32 v203,v237,v203
M a[92:95],a[232:235],a[220:223],a[92:95]
s_waitcnt vmcnt(16)
buffer_load_dwordx4 a[232:235],v251,s[20:23],s48 offen offset:1024
M a[0:3],a[236:239],a[196:199],a[0:3]
v_cvt_pk_bf16_f32 v195,v233,v195
v_cvt_pk_bf16_f32 v199,v234,v197
M a[4:7],a[236:239],a[200:203],a[4:7]
v_cvt_pk_bf16_f32 v197,v238,v235
v_cvt_pk_bf16_f32 v201,v236,v201
M a[8:11],a[236:239],a[204:207],a[8:11]
ds_write2st64_b64 v247,v[192:193],v[202:203] offset0:238 offset1:255
M a[12:15],a[236:239],a[208:211],a[12:15]
s_add_u32 s28,s67,786432
buffer_load_dwordx2 v[192:193],v245,s[12:15],s28 offen offset:0
M a[16:19],a[236:239],a[212:215],a[16:19]
buffer_load_dwordx2 v[202:203],v245,s[16:19],s28 offen offset:1536
M a[20:23],a[236:239],a[216:219],a[20:23]
ds_write2st64_b64 v247,v[194:195],v[196:197] offset0:102 offset1:119
M a[24:27],a[236:239],a[220:223],a[24:27]
s_waitcnt lgkmcnt(2)
buffer_load_dwordx2 v[194:195],v245,s[8:11],s28 offen offset:0
M a[28:31],a[236:239],a[192:195],a[28:31]
s_waitcnt vmcnt(19)
buffer_load_dwordx2 v[196:197],v245,s[8:11],s28 offen offset:384
M a[32:35],a[240:243],a[196:199],a[32:35]
buffer_load_dwordx4 a[236:239],v251,s[20:23],s46 offen offset:2048
M a[36:39],a[240:243],a[200:203],a[36:39]
ds_write2st64_b64 v247,v[198:199],v[200:201] offset0:136 offset1:153
M a[40:43],a[240:243],a[204:207],a[40:43]
buffer_load_dwordx2 v[198:199],v245,s[8:11],s28 offen offset:768
M a[44:47],a[240:243],a[208:211],a[44:47]
buffer_load_dwordx2 v[200:201],v245,s[8:11],s28 offen offset:1152
M a[48:51],a[240:243],a[212:215],a[48:51]
s_waitcnt vmcnt(17)
v_lshlrev_b32 v234,16,v208
v_lshlrev_b32 v232,16,v204
M a[52:55],a[240:243],a[216:219],a[52:55]
v_lshlrev_b32 v233,16,v206
v_lshlrev_b32 v237,16,v214
M a[56:59],a[240:243],a[220:223],a[56:59]
s_waitcnt vmcnt(14)
v_lshlrev_b32 v236,16,v212
v_lshlrev_b32 v235,16,v210
M a[60:63],a[240:243],a[192:195],a[60:63]
buffer_load_dwordx4 a[240:243],v251,s[20:23],s47 offen offset:2048
M a[64:67],a[244:247],a[196:199],a[64:67]
ds_read_b128 a[196:199],v249 offset:2304
v_fmac_f32 v232,s43,v234
M a[68:71],a[244:247],a[200:203],a[68:71]
v_fmac_f32 v237,4.0,v233
v_fma_f32 v238,-4.0,v234,v236
M a[72:75],a[244:247],a[204:207],a[72:75]
v_fmac_f32 v232,s45,v236
v_fmac_f32 v237,s40,v235
M a[76:79],a[244:247],a[208:211],a[76:79]
v_sub_f32 v236,v236,v234
v_fma_f32 v234,-4.0,v233,v235
M a[80:83],a[244:247],a[212:215],a[80:83]
v_sub_f32 v235,v235,v233
v_add_f32 v233,v238,v234
M a[84:87],a[244:247],a[216:219],a[84:87]
v_sub_f32 v238,v238,v234
v_fma_f32 v234,2.0,v235,v236
M a[88:91],a[244:247],a[220:223],a[88:91]
v_fmac_f32 v236,-2.0,v235
v_and_b32 v208,s42,v208
M a[92:95],a[244:247],a[192:195],a[92:95]
buffer_load_dwordx4 a[244:247],v251,s[20:23],s48 offen offset:2048
M a[0:3],a[248:251],a[200:203],a[0:3]
v_and_b32 v204,s42,v204
v_and_b32 v206,s42,v206
M a[4:7],a[248:251],a[204:207],a[4:7]
s_add_u32 s46,s78,27648
v_and_b32 v214,s42,v214
v_and_b32 v212,s42,v212
M a[8:11],a[248:251],a[208:211],a[8:11]
v_and_b32 v210,s42,v210
v_fmac_f32 v204,s43,v208
M a[12:15],a[248:251],a[212:215],a[12:15]
v_fmac_f32 v214,4.0,v206
v_fma_f32 v235,-4.0,v208,v212
M a[16:19],a[248:251],a[216:219],a[16:19]
v_fmac_f32 v204,s45,v212
v_fmac_f32 v214,s40,v210
M a[20:23],a[248:251],a[220:223],a[20:23]
v_sub_f32 v212,v212,v208
v_fma_f32 v208,-4.0,v206,v210
M a[24:27],a[248:251],a[192:195],a[24:27]
s_waitcnt lgkmcnt(0)
v_sub_f32 v210,v210,v206
v_add_f32 v206,v235,v208
M a[28:31],a[248:251],a[196:199],a[28:31]
buffer_load_dwordx4 a[248:251],v251,s[20:23],s46 offen offset:0
M a[32:35],a[252:255],a[200:203],a[32:35]
v_sub_f32 v235,v235,v208
v_fma_f32 v208,2.0,v210,v212
M a[36:39],a[252:255],a[204:207],a[36:39]
s_add_u32 s47,s78,30720
v_fmac_f32 v212,-2.0,v210
v_cvt_pk_bf16_f32 v204,v232,v204
M a[40:43],a[252:255],a[208:211],a[40:43]
v_cvt_pk_bf16_f32 v214,v237,v214
v_cvt_pk_bf16_f32 v206,v233,v206
M a[44:47],a[252:255],a[212:215],a[44:47]
v_cvt_pk_bf16_f32 v210,v234,v208
v_cvt_pk_bf16_f32 v208,v238,v235
M a[48:51],a[252:255],a[216:219],a[48:51]
v_cvt_pk_bf16_f32 v212,v236,v212
v_lshlrev_b32 v234,16,v209
M a[52:55],a[252:255],a[220:223],a[52:55]
v_lshlrev_b32 v232,16,v205
v_lshlrev_b32 v233,16,v207
M a[56:59],a[252:255],a[192:195],a[56:59]
v_lshlrev_b32 v237,16,v215
v_lshlrev_b32 v236,16,v213
M a[60:63],a[252:255],a[196:199],a[60:63]
s_waitcnt vmcnt(16)
buffer_load_dwordx4 a[252:255],v251,s[20:23],s47 offen offset:0
M a[64:67],v[216:219],a[200:203],a[64:67]
ds_read_b128 a[200:203],v249 offset:8704
v_lshlrev_b32 v235,16,v211
M a[68:71],v[216:219],a[204:207],a[68:71]
s_add_u32 s48,s78,33792
ds_read_b128 a[204:207],v250 offset:8960
v_fmac_f32 v232,s43,v234
M a[72:75],v[216:219],a[208:211],a[72:75]
ds_read_b128 a[208:211],v250 offset:9216
v_fmac_f32 v237,4.0,v233
M a[76:79],v[216:219],a[212:215],a[76:79]
ds_read_b128 a[212:215],v250 offset:9472
v_fma_f32 v238,-4.0,v234,v236
M a[80:83],v[216:219],a[216:219],a[80:83]
ds_read_b128 a[216:219],v250 offset:9728
v_fmac_f32 v232,s45,v236
M a[84:87],v[216:219],a[220:223],a[84:87]
ds_read_b128 a[220:223],v250 offset:9984
v_fmac_f32 v237,s40,v235
M a[88:91],v[216:219],a[192:195],a[88:91]
ds_read_b128 a[192:195],v250 offset:10240
v_sub_f32 v236,v236,v234
M a[92:95],v[216:219],a[196:199],a[92:95]
s_waitcnt vmcnt(16) lgkmcnt(6)
buffer_load_dwordx4 v[216:219],v251,s[20:23],s48 offen offset:0
M a[96:99],v[220:223],a[200:203],a[96:99]
s_waitcnt lgkmcnt(5)
ds_read_b128 a[196:199],v250 offset:10496
v_fma_f32 v234,-4.0,v233,v235
M a[100:103],v[220:223],a[204:207],a[100:103]
s_waitcnt lgkmcnt(5)
v_sub_f32 v235,v235,v233
v_add_f32 v233,v238,v234
M a[104:107],v[220:223],a[208:211],a[104:107]
s_waitcnt lgkmcnt(4)
v_sub_f32 v238,v238,v234
v_fma_f32 v234,2.0,v235,v236
M a[108:111],v[220:223],a[212:215],a[108:111]
s_waitcnt lgkmcnt(3)
v_fmac_f32 v236,-2.0,v235
v_and_b32 v209,s42,v209
M a[112:115],v[220:223],a[216:219],a[112:115]
s_waitcnt lgkmcnt(2)
v_and_b32 v205,s42,v205
v_and_b32 v207,s42,v207
M a[116:119],v[220:223],a[220:223],a[116:119]
s_waitcnt lgkmcnt(1)
v_and_b32 v215,s42,v215
v_and_b32 v213,s42,v213
M a[120:123],v[220:223],a[192:195],a[120:123]
s_waitcnt lgkmcnt(0)
v_and_b32 v211,s42,v211
v_fmac_f32 v205,s43,v209
M a[124:127],v[220:223],a[196:199],a[124:127]
s_waitcnt vmcnt(16)
buffer_load_dwordx4 v[220:223],v251,s[20:23],s46 offen offset:1024
M a[128:131],v[224:227],a[200:203],a[128:131]
v_fmac_f32 v215,4.0,v207
v_fma_f32 v235,-4.0,v209,v213
M a[132:135],v[224:227],a[204:207],a[132:135]
v_fmac_f32 v205,s45,v213
v_fmac_f32 v215,s40,v211
M a[136:139],v[224:227],a[208:211],a[136:139]
v_sub_f32 v213,v213,v209
v_fma_f32 v209,-4.0,v207,v211
M a[140:143],v[224:227],a[212:215],a[140:143]
v_sub_f32 v211,v211,v207
v_add_f32 v207,v235,v209
M a[144:147],v[224:227],a[216:219],a[144:147]
v_sub_f32 v235,v235,v209
v_fma_f32 v209,2.0,v211,v213
M a[148:151],v[224:227],a[220:223],a[148:151]
v_fmac_f32 v213,-2.0,v211
v_cvt_pk_bf16_f32 v205,v232,v205
M a[152:155],v[224:227],a[192:195],a[152:155]
v_cvt_pk_bf16_f32 v215,v237,v215
v_cvt_pk_bf16_f32 v207,v233,v207
M a[156:159],v[224:227],a[196:199],a[156:159]
s_waitcnt vmcnt(16)
buffer_load_dwordx4 v[224:227],v251,s[20:23],s47 offen offset:1024
M a[160:163],v[228:231],a[200:203],a[160:163]
ds_read_b128 a[200:203],v250 offset:10752
v_cvt_pk_bf16_f32 v211,v234,v209
M a[164:167],v[228:231],a[204:207],a[164:167]
v_cvt_pk_bf16_f32 v209,v238,v235
v_cvt_pk_bf16_f32 v213,v236,v213
M a[168:171],v[228:231],a[208:211],a[168:171]
v_add_u32 v232,121856,v247
M a[172:175],v[228:231],a[212:215],a[172:175]
ds_write2st64_b64 v232,v[204:205],v[214:215] offset0:1 offset1:18
M a[176:179],v[228:231],a[216:219],a[176:179]
s_add_u32 s28,s67,1179648
buffer_load_dwordx2 v[204:205],v245,s[12:15],s28 offen offset:0
M a[180:183],v[228:231],a[220:223],a[180:183]
buffer_load_dwordx2 v[214:215],v245,s[16:19],s28 offen offset:1536
M a[184:187],v[228:231],a[192:195],a[184:187]
ds_write2st64_b64 v247,v[206:207],v[208:209] offset0:103 offset1:120
M a[188:191],v[228:231],a[196:199],a[188:191]
s_waitcnt vmcnt(18)
buffer_load_dwordx2 v[206:207],v245,s[8:11],s28 offen offset:0
M a[96:99],a[224:227],a[204:207],a[96:99]
buffer_load_dwordx2 v[208:209],v245,s[8:11],s28 offen offset:384
M a[100:103],a[224:227],a[208:211],a[100:103]
buffer_load_dwordx4 v[228:231],v251,s[20:23],s48 offen offset:1024
M a[104:107],a[224:227],a[212:215],a[104:107]
ds_write2st64_b64 v247,v[210:211],v[212:213] offset0:137 offset1:154
M a[108:111],a[224:227],a[216:219],a[108:111]
buffer_load_dwordx2 v[210:211],v245,s[8:11],s28 offen offset:768
M a[112:115],a[224:227],a[220:223],a[112:115]
buffer_load_dwordx2 v[212:213],v245,s[8:11],s28 offen offset:1152
M a[116:119],a[224:227],a[192:195],a[116:119]
v_fmac_f32 v239,s43,v241
v_fmac_f32 v244,4.0,v240
M a[120:123],a[224:227],a[196:199],a[120:123]
s_waitcnt lgkmcnt(3)
v_fma_f32 v232,-4.0,v241,v243
v_fmac_f32 v239,s45,v243
M a[124:127],a[224:227],a[200:203],a[124:127]
s_waitcnt vmcnt(22)
buffer_load_dwordx4 a[224:227],v251,s[20:23],s46 offen offset:2048
M a[128:131],a[228:231],a[204:207],a[128:131]
v_fmac_f32 v244,s40,v242
v_sub_f32 v243,v243,v241
M a[132:135],a[228:231],a[208:211],a[132:135]
v_fma_f32 v241,-4.0,v240,v242
v_sub_f32 v242,v242,v240
M a[136:139],a[228:231],a[212:215],a[136:139]
v_add_f32 v240,v232,v241
v_sub_f32 v232,v232,v241
M a[140:143],a[228:231],a[216:219],a[140:143]
v_fma_f32 v241,2.0,v242,v243
v_fmac_f32 v243,-2.0,v242
M a[144:147],a[228:231],a[220:223],a[144:147]
v_cvt_pk_bf16_f32 v233,v239,v244
v_cvt_pk_bf16_f32 v234,v240,v232
M a[148:151],a[228:231],a[192:195],a[148:151]
v_cvt_pk_bf16_f32 v235,v241,v243
v_add_u32 v232,121856,v248
M a[152:155],a[228:231],a[196:199],a[152:155]
buffer_load_short_d16_hi v239,v246,s[12:15],s74 offen offset:0
M a[156:159],a[228:231],a[200:203],a[156:159]
s_waitcnt vmcnt(23)
buffer_load_short_d16_hi v240,v246,s[8:11],s74 offen offset:0
M a[160:163],a[232:235],a[204:207],a[160:163]
buffer_load_short_d16_hi v241,v246,s[8:11],s74 offen offset:384
M a[164:167],a[232:235],a[208:211],a[164:167]
buffer_load_short_d16_hi v242,v246,s[8:11],s74 offen offset:768
M a[168:171],a[232:235],a[212:215],a[168:171]
buffer_load_short_d16_hi v243,v246,s[8:11],s74 offen offset:1152
M a[172:175],a[232:235],a[216:219],a[172:175]
buffer_load_short_d16_hi v244,v246,s[16:19],s74 offen offset:1536
M a[176:179],a[232:235],a[220:223],a[176:179]
buffer_load_dwordx4 a[228:231],v251,s[20:23],s47 offen offset:2048
M a[180:183],a[232:235],a[192:195],a[180:183]
ds_read_b128 a[204:207],v249 offset:11008
ds_write_b16 v232,v233 offset:0
M a[184:187],a[232:235],a[196:199],a[184:187]
ds_write_b16_d16_hi v232,v233 offset:8704
M a[188:191],a[232:235],a[200:203],a[188:191]
s_waitcnt vmcnt(24)
buffer_load_dwordx4 a[232:235],v251,s[20:23],s48 offen offset:2048
M a[96:99],a[236:239],a[208:211],a[96:99]
ds_write_b16 v248,v234 offset:52224
M a[100:103],a[236:239],a[212:215],a[100:103]
s_add_u32 s46,s78,36864
ds_write_b16_d16_hi v248,v234 offset:60928
M a[104:107],a[236:239],a[216:219],a[104:107]
v_add_u32 v232,69632,v248
M a[108:111],a[236:239],a[220:223],a[108:111]
ds_write_b16 v232,v235 offset:0
M a[112:115],a[236:239],a[192:195],a[112:115]
ds_write_b16_d16_hi v232,v235 offset:8704
M a[116:119],a[236:239],a[196:199],a[116:119]
v_lshlrev_b32 v234,16,v196
v_lshlrev_b32 v232,16,v192
M a[120:123],a[236:239],a[200:203],a[120:123]
s_waitcnt lgkmcnt(6)
v_lshlrev_b32 v233,16,v194
v_lshlrev_b32 v237,16,v202
M a[124:127],a[236:239],a[204:207],a[124:127]
s_waitcnt vmcnt(22)
buffer_load_dwordx4 a[236:239],v251,s[20:23],s46 offen offset:0
M a[128:131],a[240:243],a[208:211],a[128:131]
v_lshlrev_b32 v236,16,v200
v_lshlrev_b32 v235,16,v198
M a[132:135],a[240:243],a[212:215],a[132:135]
s_add_u32 s47,s78,39936
v_fmac_f32 v232,s43,v234
v_fmac_f32 v237,4.0,v233
M a[136:139],a[240:243],a[216:219],a[136:139]
v_fma_f32 v238,-4.0,v234,v236
v_fmac_f32 v232,s45,v236
M a[140:143],a[240:243],a[220:223],a[140:143]
v_fmac_f32 v237,s40,v235
v_sub_f32 v236,v236,v234
M a[144:147],a[240:243],a[192:195],a[144:147]
v_fma_f32 v234,-4.0,v233,v235
v_sub_f32 v235,v235,v233
M a[148:151],a[240:243],a[196:199],a[148:151]
v_add_f32 v233,v238,v234
v_sub_f32 v238,v238,v234
M a[152:155],a[240:243],a[200:203],a[152:155]
v_fma_f32 v234,2.0,v235,v236
v_fmac_f32 v236,-2.0,v235
M a[156:159],a[240:243],a[204:207],a[156:159]
s_waitcnt vmcnt(22)
buffer_load_dwordx4 a[240:243],v251,s[20:23],s47 offen offset:0
M a[160:163],a[244:247],a[208:211],a[160:163]
ds_read_b128 a[208:211],v249 offset:17408
v_and_b32 v196,s42,v196
M a[164:167],a[244:247],a[212:215],a[164:167]
s_add_u32 s48,s78,43008
ds_read_b128 a[212:215],v250 offset:17664
v_and_b32 v192,s42,v192
M a[168:171],a[244:247],a[216:219],a[168:171]
ds_read_b128 a[216:219],v250 offset:17920
v_and_b32 v194,s42,v194
M a[172:175],a[244:247],a[220:223],a[172:175]
ds_read_b128 a[220:223],v250 offset:18176
v_and_b32 v202,s42,v202
M a[176:179],a[244:247],a[192:195],a[176:179]
ds_read_b128 a[192:195],v250 offset:18432
v_and_b32 v200,s42,v200
M a[180:183],a[244:247],a[196:199],a[180:183]
ds_read_b128 a[196:199],v250 offset:18688
v_and_b32 v198,s42,v198
M a[184:187],a[244:247],a[200:203],a[184:187]
ds_read_b128 a[200:203],v250 offset:18944
v_fmac_f32 v192,s43,v196
M a[188:191],a[244:247],a[204:207],a[188:191]
s_waitcnt vmcnt(22) lgkmcnt(6)
buffer_load_dwordx4 a[244:247],v251,s[20:23],s48 offen offset:0
M v[0:3],a[248:251],a[208:211],v[0:3]
s_waitcnt lgkmcnt(5)
ds_read_b128 a[204:207],v250 offset:19200
v_fmac_f32 v202,4.0,v194
M v[4:7],a[248:251],a[212:215],v[4:7]
s_waitcnt lgkmcnt(5)
v_fma_f32 v235,-4.0,v196,v200
v_fmac_f32 v192,s45,v200
M v[8:11],a[248:251],a[216:219],v[8:11]
s_waitcnt lgkmcnt(4)
v_fmac_f32 v202,s40,v198
v_sub_f32 v200,v200,v196
M v[12:15],a[248:251],a[220:223],v[12:15]
s_waitcnt lgkmcnt(3)
v_fma_f32 v196,-4.0,v194,v198
v_sub_f32 v198,v198,v194
M v[16:19],a[248:251],a[192:195],v[16:19]
s_waitcnt lgkmcnt(2)
v_add_f32 v194,v235,v196
v_sub_f32 v235,v235,v196
M v[20:23],a[248:251],a[196:199],v[20:23]
s_waitcnt lgkmcnt(1)
v_fma_f32 v196,2.0,v198,v200
v_fmac_f32 v200,-2.0,v198
M v[24:27],a[248:251],a[200:203],v[24:27]
s_waitcnt lgkmcnt(0)
v_cvt_pk_bf16_f32 v192,v232,v192
v_cvt_pk_bf16_f32 v202,v237,v202
M v[28:31],a[248:251],a[204:207],v[28:31]
s_waitcnt vmcnt(22)
buffer_load_dwordx4 a[248:251],v251,s[20:23],s46 offen offset:1024
M v[32:35],a[252:255],a[208:211],v[32:35]
v_cvt_pk_bf16_f32 v194,v233,v194
v_cvt_pk_bf16_f32 v198,v234,v196
M v[36:39],a[252:255],a[212:215],v[36:39]
v_cvt_pk_bf16_f32 v196,v238,v235
v_cvt_pk_bf16_f32 v200,v236,v200
M v[40:43],a[252:255],a[216:219],v[40:43]
v_lshlrev_b32 v234,16,v197
v_lshlrev_b32 v232,16,v193
M v[44:47],a[252:255],a[220:223],v[44:47]
v_lshlrev_b32 v233,16,v195
v_lshlrev_b32 v237,16,v203
M v[48:51],a[252:255],a[192:195],v[48:51]
v_lshlrev_b32 v236,16,v201
v_lshlrev_b32 v235,16,v199
M v[52:55],a[252:255],a[196:199],v[52:55]
v_fmac_f32 v232,s43,v234
v_fmac_f32 v237,4.0,v233
M v[56:59],a[252:255],a[200:203],v[56:59]
v_fma_f32 v238,-4.0,v234,v236
v_fmac_f32 v232,s45,v236
M v[60:63],a[252:255],a[204:207],v[60:63]
s_waitcnt vmcnt(22)
buffer_load_dwordx4 a[252:255],v251,s[20:23],s47 offen offset:1024
M v[64:67],v[216:219],a[208:211],v[64:67]
ds_read_b128 a[208:211],v250 offset:19456
v_fmac_f32 v237,s40,v235
M v[68:71],v[216:219],a[212:215],v[68:71]
v_sub_f32 v236,v236,v234
v_fma_f32 v234,-4.0,v233,v235
M v[72:75],v[216:219],a[216:219],v[72:75]
v_sub_f32 v235,v235,v233
v_add_f32 v233,v238,v234
M v[76:79],v[216:219],a[220:223],v[76:79]
v_sub_f32 v238,v238,v234
v_fma_f32 v234,2.0,v235,v236
M v[80:83],v[216:219],a[192:195],v[80:83]
v_fmac_f32 v236,-2.0,v235
v_and_b32 v197,s42,v197
M v[84:87],v[216:219],a[196:199],v[84:87]
v_and_b32 v193,s42,v193
v_and_b32 v195,s42,v195
M v[88:91],v[216:219],a[200:203],v[88:91]
v_and_b32 v203,s42,v203
v_and_b32 v201,s42,v201
M v[92:95],v[216:219],a[204:207],v[92:95]
s_waitcnt vmcnt(22)
buffer_load_dwordx4 v[216:219],v251,s[20:23],s48 offen offset:1024
M v[0:3],v[220:223],a[212:215],v[0:3]
v_and_b32 v199,s42,v199
v_fmac_f32 v193,s43,v197
M v[4:7],v[220:223],a[216:219],v[4:7]
v_fmac_f32 v203,4.0,v195
v_fma_f32 v235,-4.0,v197,v201
M v[8:11],v[220:223],a[220:223],v[8:11]
v_fmac_f32 v193,s45,v201
v_fmac_f32 v203,s40,v199
M v[12:15],v[220:223],a[192:195],v[12:15]
v_sub_f32 v201,v201,v197
v_fma_f32 v197,-4.0,v195,v199
M v[16:19],v[220:223],a[196:199],v[16:19]
v_sub_f32 v199,v199,v195
v_add_f32 v195,v235,v197
M v[20:23],v[220:223],a[200:203],v[20:23]
v_sub_f32 v235,v235,v197
v_fma_f32 v197,2.0,v199,v201
M v[24:27],v[220:223],a[204:207],v[24:27]
s_waitcnt lgkmcnt(0)
v_fmac_f32 v201,-2.0,v199
v_cvt_pk_bf16_f32 v193,v232,v193
M v[28:31],v[220:223],a[208:211],v[28:31]
s_waitcnt vmcnt(22)
buffer_load_dwordx4 v[220:223],v251,s[20:23],s46 offen offset:2048
M v[32:35],v[224:227],a[212:215],v[32:35]
v_cvt_pk_bf16_f32 v203,v237,v203
v_cvt_pk_bf16_f32 v195,v233,v195
M v[36:39],v[224:227],a[216:219],v[36:39]
v_cvt_pk_bf16_f32 v199,v234,v197
v_cvt_pk_bf16_f32 v197,v238,v235
M v[40:43],v[224:227],a[220:223],v[40:43]
v_cvt_pk_bf16_f32 v201,v236,v201
v_add_u32 v232,121856,v247
M v[44:47],v[224:227],a[192:195],v[44:47]
ds_write2st64_b64 v232,v[192:193],v[202:203] offset0:2 offset1:19
M v[48:51],v[224:227],a[196:199],v[48:51]
s_add_u32 s28,s68,0
buffer_load_dwordx2 v[192:193],v245,s[12:15],s28 offen offset:0
M v[52:55],v[224:227],a[200:203],v[52:55]
buffer_load_dwordx2 v[202:203],v245,s[16:19],s28 offen offset:1536
M v[56:59],v[224:227],a[204:207],v[56:59]
ds_write2st64_b64 v247,v[194:195],v[196:197] offset0:104 offset1:121
M v[60:63],v[224:227],a[208:211],v[60:63]
s_waitcnt vmcnt(20)
buffer_load_dwordx2 v[194:195],v245,s[8:11],s28 offen offset:0
M v[64:67],v[228:231],a[212:215],v[64:67]
buffer_load_dwordx2 v[196:197],v245,s[8:11],s28 offen offset:384
M v[68:71],v[228:231],a[216:219],v[68:71]
buffer_load_dwordx4 v[224:227],v251,s[20:23],s47 offen offset:2048
M v[72:75],v[228:231],a[220:223],v[72:75]
ds_read_b128 a[212:215],v249 offset:19712
ds_write2st64_b64 v247,v[198:199],v[200:201] offset0:138 offset1:155
M v[76:79],v[228:231],a[192:195],v[76:79]
buffer_load_dwordx2 v[198:199],v245,s[8:11],s28 offen offset:768
M v[80:83],v[228:231],a[196:199],v[80:83]
buffer_load_dwordx2 v[200:201],v245,s[8:11],s28 offen offset:1152
M v[84:87],v[228:231],a[200:203],v[84:87]
v_lshlrev_b32 v234,16,v208
v_lshlrev_b32 v232,16,v204
M v[88:91],v[228:231],a[204:207],v[88:91]
v_lshlrev_b32 v233,16,v206
v_lshlrev_b32 v237,16,v214
M v[92:95],v[228:231],a[208:211],v[92:95]
s_waitcnt vmcnt(22)
buffer_load_dwordx4 v[228:231],v251,s[20:23],s48 offen offset:2048
M v[0:3],a[224:227],a[216:219],v[0:3]
v_lshlrev_b32 v236,16,v212
v_lshlrev_b32 v235,16,v210
M v[4:7],a[224:227],a[220:223],v[4:7]
s_add_u32 s46,s79,9216
v_fmac_f32 v232,s43,v234
v_fmac_f32 v237,4.0,v233
M v[8:11],a[224:227],a[192:195],v[8:11]
v_fma_f32 v238,-4.0,v234,v236
v_fmac_f32 v232,s45,v236
M v[12:15],a[224:227],a[196:199],v[12:15]
v_fmac_f32 v237,s40,v235
v_sub_f32 v236,v236,v234
M v[16:19],a[224:227],a[200:203],v[16:19]
v_fma_f32 v234,-4.0,v233,v235
v_sub_f32 v235,v235,v233
M v[20:23],a[224:227],a[204:207],v[20:23]
v_add_f32 v233,v238,v234
v_sub_f32 v238,v238,v234
M v[24:27],a[224:227],a[208:211],v[24:27]
s_waitcnt lgkmcnt(1)
v_fma_f32 v234,2.0,v235,v236
v_fmac_f32 v236,-2.0,v235
M v[28:31],a[224:227],a[212:215],v[28:31]
s_waitcnt vmcnt(16)
buffer_load_dwordx4 a[224:227],v251,s[20:23],s46 offen offset:0
M v[32:35],a[228:231],a[216:219],v[32:35]
v_and_b32 v208,s42,v208
v_and_b32 v204,s42,v204
M v[36:39],a[228:231],a[220:223],v[36:39]
s_add_u32 s47,s79,12288
v_and_b32 v206,s42,v206
v_and_b32 v214,s42,v214
M v[40:43],a[228:231],a[192:195],v[40:43]
v_and_b32 v212,s42,v212
v_and_b32 v210,s42,v210
M v[44:47],a[228:231],a[196:199],v[44:47]
v_fmac_f32 v204,s43,v208
v_fmac_f32 v214,4.0,v206
M v[48:51],a[228:231],a[200:203],v[48:51]
v_fma_f32 v235,-4.0,v208,v212
v_fmac_f32 v204,s45,v212
M v[52:55],a[228:231],a[204:207],v[52:55]
v_fmac_f32 v214,s40,v210
v_sub_f32 v212,v212,v208
M v[56:59],a[228:231],a[208:211],v[56:59]
v_fma_f32 v208,-4.0,v206,v210
v_sub_f32 v210,v210,v206
M v[60:63],a[228:231],a[212:215],v[60:63]
s_waitcnt vmcnt(16)
buffer_load_dwordx4 a[228:231],v251,s[20:23],s47 offen offset:0
M v[64:67],a[232:235],a[216:219],v[64:67]
ds_read_b128 a[216:219],v249 offset:26112
v_add_f32 v206,v235,v208
M v[68:71],a[232:235],a[220:223],v[68:71]
s_add_u32 s48,s79,15360
ds_read_b128 a[220:223],v250 offset:26368
v_sub_f32 v235,v235,v208
M v[72:75],a[232:235],a[192:195],v[72:75]
ds_read_b128 a[192:195],v250 offset:26624
v_fma_f32 v208,2.0,v210,v212
M v[76:79],a[232:235],a[196:199],v[76:79]
ds_read_b128 a[196:199],v250 offset:26880
v_fmac_f32 v212,-2.0,v210
M v[80:83],a[232:235],a[200:203],v[80:83]
ds_read_b128 a[200:203],v250 offset:27136
v_cvt_pk_bf16_f32 v204,v232,v204
M v[84:87],a[232:235],a[204:207],v[84:87]
ds_read_b128 a[204:207],v250 offset:27392
v_cvt_pk_bf16_f32 v214,v237,v214
M v[88:91],a[232:235],a[208:211],v[88:91]
ds_read_b128 a[208:211],v250 offset:27648
v_cvt_pk_bf16_f32 v206,v233,v206
M v[92:95],a[232:235],a[212:215],v[92:95]
s_waitcnt vmcnt(16) lgkmcnt(6)
buffer_load_dwordx4 a[232:235],v251,s[20:23],s48 offen offset:0
M v[96:99],a[236:239],a[216:219],v[96:99]
s_waitcnt lgkmcnt(5)
ds_read_b128 a[212:215],v250 offset:27904
v_cvt_pk_bf16_f32 v210,v234,v208
M v[100:103],a[236:239],a[220:223],v[100:103]
s_waitcnt lgkmcnt(5)
v_cvt_pk_bf16_f32 v208,v238,v235
v_cvt_pk_bf16_f32 v212,v236,v212
M v[104:107],a[236:239],a[192:195],v[104:107]
s_waitcnt lgkmcnt(4)
v_lshlrev_b32 v234,16,v209
v_lshlrev_b32 v232,16,v205
M v[108:111],a[236:239],a[196:199],v[108:111]
s_waitcnt lgkmcnt(3)
v_lshlrev_b32 v233,16,v207
v_lshlrev_b32 v237,16,v215
M v[112:115],a[236:239],a[200:203],v[112:115]
s_waitcnt lgkmcnt(2)
v_lshlrev_b32 v236,16,v213
v_lshlrev_b32 v235,16,v211
M v[116:119],a[236:239],a[204:207],v[116:119]
s_waitcnt lgkmcnt(1)
v_fmac_f32 v232,s43,v234
v_fmac_f32 v237,4.0,v233
M v[120:123],a[236:239],a[208:211],v[120:123]
s_waitcnt lgkmcnt(0)
v_fma_f32 v238,-4.0,v234,v236
v_fmac_f32 v232,s45,v236
M v[124:127],a[236:239],a[212:215],v[124:127]
s_waitcnt vmcnt(16)
buffer_load_dwordx4 a[236:239],v251,s[20:23],s46 offen offset:1024
M v[128:131],a[240:243],a[216:219],v[128:131]
v_fmac_f32 v237,s40,v235
v_sub_f32 v236,v236,v234
M v[132:135],a[240:243],a[220:223],v[132:135]
v_fma_f32 v234,-4.0,v233,v235
v_sub_f32 v235,v235,v233
M v[136:139],a[240:243],a[192:195],v[136:139]
v_add_f32 v233,v238,v234
v_sub_f32 v238,v238,v234
M v[140:143],a[240:243],a[196:199],v[140:143]
v_fma_f32 v234,2.0,v235,v236
v_fmac_f32 v236,-2.0,v235
M v[144:147],a[240:243],a[200:203],v[144:147]
v_and_b32 v209,s42,v209
v_and_b32 v205,s42,v205
M v[148:151],a[240:243],a[204:207],v[148:151]
v_and_b32 v207,s42,v207
v_and_b32 v215,s42,v215
M v[152:155],a[240:243],a[208:211],v[152:155]
v_and_b32 v213,s42,v213
v_and_b32 v211,s42,v211
M v[156:159],a[240:243],a[212:215],v[156:159]
s_waitcnt vmcnt(16)
buffer_load_dwordx4 a[240:243],v251,s[20:23],s47 offen offset:1024
M v[160:163],a[244:247],a[216:219],v[160:163]
ds_read_b128 a[216:219],v250 offset:28160
v_fmac_f32 v205,s43,v209
M v[164:167],a[244:247],a[220:223],v[164:167]
v_fmac_f32 v215,4.0,v207
v_fma_f32 v235,-4.0,v209,v213
M v[168:171],a[244:247],a[192:195],v[168:171]
v_fmac_f32 v205,s45,v213
v_fmac_f32 v215,s40,v211
M v[172:175],a[244:247],a[196:199],v[172:175]
v_sub_f32 v213,v213,v209
v_fma_f32 v209,-4.0,v207,v211
M v[176:179],a[244:247],a[200:203],v[176:179]
v_sub_f32 v211,v211,v207
v_add_f32 v207,v235,v209
M v[180:183],a[244:247],a[204:207],v[180:183]
v_sub_f32 v235,v235,v209
v_fma_f32 v209,2.0,v211,v213
M v[184:187],a[244:247],a[208:211],v[184:187]
v_fmac_f32 v213,-2.0,v211
v_cvt_pk_bf16_f32 v205,v232,v205
M v[188:191],a[244:247],a[212:215],v[188:191]
s_waitcnt vmcnt(16)
buffer_load_dwordx4 a[244:247],v251,s[20:23],s48 offen offset:1024
M v[96:99],a[248:251],a[220:223],v[96:99]
v_cvt_pk_bf16_f32 v215,v237,v215
v_cvt_pk_bf16_f32 v207,v233,v207
M v[100:103],a[248:251],a[192:195],v[100:103]
v_cvt_pk_bf16_f32 v211,v234,v209
v_cvt_pk_bf16_f32 v209,v238,v235
M v[104:107],a[248:251],a[196:199],v[104:107]
v_cvt_pk_bf16_f32 v213,v236,v213
v_add_u32 v232,121856,v247
M v[108:111],a[248:251],a[200:203],v[108:111]
ds_write2st64_b64 v232,v[204:205],v[214:215] offset0:3 offset1:20
M v[112:115],a[248:251],a[204:207],v[112:115]
s_add_u32 s28,s68,393216
buffer_load_dwordx2 v[204:205],v245,s[12:15],s28 offen offset:0
M v[116:119],a[248:251],a[208:211],v[116:119]
buffer_load_dwordx2 v[214:215],v245,s[16:19],s28 offen offset:1536
M v[120:123],a[248:251],a[212:215],v[120:123]
s_waitcnt lgkmcnt(1)
ds_write2st64_b64 v247,v[206:207],v[208:209] offset0:105 offset1:122
M v[124:127],a[248:251],a[216:219],v[124:127]
s_waitcnt vmcnt(18)
buffer_load_dwordx2 v[206:207],v245,s[8:11],s28 offen offset:0
M v[128:131],a[252:255],a[220:223],v[128:131]
buffer_load_dwordx2 v[208:209],v245,s[8:11],s28 offen offset:384
M v[132:135],a[252:255],a[192:195],v[132:135]
buffer_load_dwordx4 a[248:251],v251,s[20:23],s46 offen offset:2048
M v[136:139],a[252:255],a[196:199],v[136:139]
ds_write2st64_b64 v247,v[210:211],v[212:213] offset0:139 offset1:156
M v[140:143],a[252:255],a[200:203],v[140:143]
buffer_load_dwordx2 v[210:211],v245,s[8:11],s28 offen offset:768
M v[144:147],a[252:255],a[204:207],v[144:147]
buffer_load_dwordx2 v[212:213],v245,s[8:11],s28 offen offset:1152
M v[148:151],a[252:255],a[208:211],v[148:151]
s_waitcnt vmcnt(17)
v_lshlrev_b32 v234,16,v196
v_lshlrev_b32 v232,16,v192
M v[152:155],a[252:255],a[212:215],v[152:155]
v_lshlrev_b32 v233,16,v194
v_lshlrev_b32 v237,16,v202
M v[156:159],a[252:255],a[216:219],v[156:159]
buffer_load_dwordx4 a[252:255],v251,s[20:23],s47 offen offset:2048
M v[160:163],v[216:219],a[220:223],v[160:163]
s_waitcnt vmcnt(15)
ds_read_b128 a[220:223],v249 offset:28416
v_lshlrev_b32 v236,16,v200
M v[164:167],v[216:219],a[192:195],v[164:167]
v_lshlrev_b32 v235,16,v198
v_fmac_f32 v232,s43,v234
M v[168:171],v[216:219],a[196:199],v[168:171]
v_fmac_f32 v237,4.0,v233
v_fma_f32 v238,-4.0,v234,v236
M v[172:175],v[216:219],a[200:203],v[172:175]
v_fmac_f32 v232,s45,v236
v_fmac_f32 v237,s40,v235
M v[176:179],v[216:219],a[204:207],v[176:179]
v_sub_f32 v236,v236,v234
v_fma_f32 v234,-4.0,v233,v235
M v[180:183],v[216:219],a[208:211],v[180:183]
v_sub_f32 v235,v235,v233
v_add_f32 v233,v238,v234
M v[184:187],v[216:219],a[212:215],v[184:187]
v_sub_f32 v238,v238,v234
v_fma_f32 v234,2.0,v235,v236
M v[188:191],v[216:219],a[216:219],v[188:191]
buffer_load_dwordx4 v[216:219],v251,s[20:23],s48 offen offset:2048
M v[96:99],v[220:223],a[192:195],v[96:99]
v_fmac_f32 v236,-2.0,v235
v_and_b32 v196,s42,v196
M v[100:103],v[220:223],a[196:199],v[100:103]
s_add_u32 s46,s79,18432
v_and_b32 v192,s42,v192
v_and_b32 v194,s42,v194
M v[104:107],v[220:223],a[200:203],v[104:107]
v_and_b32 v202,s42,v202
v_and_b32 v200,s42,v200
M v[108:111],v[220:223],a[204:207],v[108:111]
v_and_b32 v198,s42,v198
v_fmac_f32 v192,s43,v196
M v[112:115],v[220:223],a[208:211],v[112:115]
v_fmac_f32 v202,4.0,v194
v_fma_f32 v235,-4.0,v196,v200
M v[116:119],v[220:223],a[212:215],v[116:119]
v_fmac_f32 v192,s45,v200
v_fmac_f32 v202,s40,v198
M v[120:123],v[220:223],a[216:219],v[120:123]
s_waitcnt lgkmcnt(0)
v_sub_f32 v200,v200,v196
v_fma_f32 v196,-4.0,v194,v198
M v[124:127],v[220:223],a[220:223],v[124:127]
buffer_load_dwordx4 v[220:223],v251,s[20:23],s46 offen offset:0
M v[128:131],v[224:227],a[192:195],v[128:131]
v_sub_f32 v198,v198,v194
v_add_f32 v194,v235,v196
M v[132:135],v[224:227],a[196:199],v[132:135]
s_add_u32 s47,s79,21504
v_sub_f32 v235,v235,v196
v_fma_f32 v196,2.0,v198,v200
M v[136:139],v[224:227],a[200:203],v[136:139]
v_fmac_f32 v200,-2.0,v198
v_cvt_pk_bf16_f32 v192,v232,v192
M v[140:143],v[224:227],a[204:207],v[140:143]
v_cvt_pk_bf16_f32 v202,v237,v202
v_cvt_pk_bf16_f32 v194,v233,v194
M v[144:147],v[224:227],a[208:211],v[144:147]
v_cvt_pk_bf16_f32 v198,v234,v196
v_cvt_pk_bf16_f32 v196,v238,v235
M v[148:151],v[224:227],a[212:215],v[148:151]
v_cvt_pk_bf16_f32 v200,v236,v200
v_lshlrev_b32 v234,16,v197
M v[152:155],v[224:227],a[216:219],v[152:155]
s_barrier
v_lshlrev_b32 v232,16,v193
M v[156:159],v[224:227],a[220:223],v[156:159]
s_waitcnt vmcnt(16)
buffer_load_dwordx4 v[224:227],v251,s[20:23],s47 offen offset:0
M v[160:163],v[228:231],a[192:195],v[160:163]
ds_read_b128 a[192:195],v249 offset:34816
v_lshlrev_b32 v233,16,v195
M v[164:167],v[228:231],a[196:199],v[164:167]
s_add_u32 s48,s79,24576
ds_read_b128 a[196:199],v250 offset:35072
v_lshlrev_b32 v237,16,v203
M v[168:171],v[228:231],a[200:203],v[168:171]
ds_read_b128 a[200:203],v250 offset:35328
v_lshlrev_b32 v236,16,v201
M v[172:175],v[228:231],a[204:207],v[172:175]
ds_read_b128 a[204:207],v250 offset:35584
v_lshlrev_b32 v235,16,v199
M v[176:179],v[228:231],a[208:211],v[176:179]
ds_read_b128 a[208:211],v250 offset:35840
v_fmac_f32 v232,s43,v234
M v[180:183],v[228:231],a[212:215],v[180:183]
ds_read_b128 a[212:215],v250 offset:36096
v_fmac_f32 v237,4.0,v233
M v[184:187],v[228:231],a[216:219],v[184:187]
ds_read_b128 a[216:219],v250 offset:36352
v_fma_f32 v238,-4.0,v234,v236
M v[188:191],v[228:231],a[220:223],v[188:191]
s_waitcnt vmcnt(16) lgkmcnt(6)
buffer_load_dwordx4 v[228:231],v251,s[20:23],s48 offen offset:0
M a[0:3],a[224:227],a[192:195],a[0:3]
s_waitcnt lgkmcnt(5)
ds_read_b128 a[220:223],v250 offset:36608
v_fmac_f32 v232,s45,v236
M a[4:7],a[224:227],a[196:199],a[4:7]
s_waitcnt lgkmcnt(5)
v_fmac_f32 v237,s40,v235
v_sub_f32 v236,v236,v234
M a[8:11],a[224:227],a[200:203],a[8:11]
s_waitcnt lgkmcnt(4)
v_fma_f32 v234,-4.0,v233,v235
v_sub_f32 v235,v235,v233
M a[12:15],a[224:227],a[204:207],a[12:15]
s_waitcnt lgkmcnt(3)
v_add_f32 v233,v238,v234
v_sub_f32 v238,v238,v234
M a[16:19],a[224:227],a[208:211],a[16:19]
s_waitcnt lgkmcnt(2)
v_fma_f32 v234,2.0,v235,v236
v_fmac_f32 v236,-2.0,v235
M a[20:23],a[224:227],a[212:215],a[20:23]
s_waitcnt lgkmcnt(1)
v_and_b32 v197,s42,v197
v_and_b32 v193,s42,v193
M a[24:27],a[224:227],a[216:219],a[24:27]
s_waitcnt lgkmcnt(0)
v_and_b32 v195,s42,v195
v_and_b32 v203,s42,v203
M a[28:31],a[224:227],a[220:223],a[28:31]
s_waitcnt vmcnt(16)
buffer_load_dwordx4 a[224:227],v251,s[20:23],s46 offen offset:1024
M a[32:35],a[228:231],a[192:195],a[32:35]
v_and_b32 v201,s42,v201
v_and_b32 v199,s42,v199
M a[36:39],a[228:231],a[196:199],a[36:39]
v_fmac_f32 v193,s43,v197
v_fmac_f32 v203,4.0,v195
M a[40:43],a[228:231],a[200:203],a[40:43]
v_fma_f32 v235,-4.0,v197,v201
v_fmac_f32 v193,s45,v201
M a[44:47],a[228:231],a[204:207],a[44:47]
v_fmac_f32 v203,s40,v199
v_sub_f32 v201,v201,v197
M a[48:51],a[228:231],a[208:211],a[48:51]
v_fma_f32 v197,-4.0,v195,v199
v_sub_f32 v199,v199,v195
M a[52:55],a[228:231],a[212:215],a[52:55]
v_add_f32 v195,v235,v197
v_sub_f32 v235,v235,v197
M a[56:59],a[228:231],a[216:219],a[56:59]
v_fma_f32 v197,2.0,v199,v201
v_fmac_f32 v201,-2.0,v199
M a[60:63],a[228:231],a[220:223],a[60:63]
s_waitcnt vmcnt(16)
buffer_load_dwordx4 a[228:231],v251,s[20:23],s47 offen offset:1024
M a[64:67],a[232:235],a[192:195],a[64:67]
ds_read_b128 a[192:195],v250 offset:36864
v_cvt_pk_bf16_f32 v193,v232,v193
M a[68:71],a[232:235],a[196:199],a[68:71]
v_cvt_pk_bf16_f32 v203,v237,v203
v_cvt_pk_bf16_f32 v195,v233,v195
M a[72:75],a[232:235],a[200:203],a[72:75]
v_cvt_pk_bf16_f32 v199,v234,v197
v_cvt_pk_bf16_f32 v197,v238,v235
M a[76:79],a[232:235],a[204:207],a[76:79]
v_cvt_pk_bf16_f32 v201,v236,v201
v_add_u32 v232,139264,v247
M a[80:83],a[232:235],a[208:211],a[80:83]
ds_write2st64_b64 v232,v[192:193],v[202:203] offset0:0 offset1:17
M a[84:87],a[232:235],a[212:215],a[84:87]
s_add_u32 s28,s68,786432
buffer_load_dwordx2 v[192:193],v245,s[12:15],s28 offen offset:0
M a[88:91],a[232:235],a[216:219],a[88:91]
buffer_load_dwordx2 v[202:203],v245,s[16:19],s28 offen offset:1536
M a[92:95],a[232:235],a[220:223],a[92:95]
s_waitcnt vmcnt(18)
buffer_load_dwordx4 a[232:235],v251,s[20:23],s48 offen offset:1024
M a[0:3],a[236:239],a[196:199],a[0:3]
ds_write2st64_b64 v247,v[194:195],v[196:197] offset0:34 offset1:51
M a[4:7],a[236:239],a[200:203],a[4:7]
buffer_load_dwordx2 v[194:195],v245,s[8:11],s28 offen offset:0
M a[8:11],a[236:239],a[204:207],a[8:11]
buffer_load_dwordx2 v[196:197],v245,s[8:11],s28 offen offset:384
M a[12:15],a[236:239],a[208:211],a[12:15]
ds_write2st64_b64 v247,v[198:199],v[200:201] offset0:68 offset1:85
M a[16:19],a[236:239],a[212:215],a[16:19]
buffer_load_dwordx2 v[198:199],v245,s[8:11],s28 offen offset:768
M a[20:23],a[236:239],a[216:219],a[20:23]
buffer_load_dwordx2 v[200:201],v245,s[8:11],s28 offen offset:1152
M a[24:27],a[236:239],a[220:223],a[24:27]
s_waitcnt vmcnt(17) lgkmcnt(3)
v_lshlrev_b32 v234,16,v208
v_lshlrev_b32 v232,16,v204
M a[28:31],a[236:239],a[192:195],a[28:31]
buffer_load_dwordx4 a[236:239],v251,s[20:23],s46 offen offset:2048
M a[32:35],a[240:243],a[196:199],a[32:35]
v_lshlrev_b32 v233,16,v206
v_lshlrev_b32 v237,16,v214
M a[36:39],a[240:243],a[200:203],a[36:39]
s_waitcnt vmcnt(15)
v_lshlrev_b32 v236,16,v212
v_lshlrev_b32 v235,16,v210
M a[40:43],a[240:243],a[204:207],a[40:43]
v_fmac_f32 v232,s43,v234
v_fmac_f32 v237,4.0,v233
M a[44:47],a[240:243],a[208:211],a[44:47]
v_fma_f32 v238,-4.0,v234,v236
v_fmac_f32 v232,s45,v236
M a[48:51],a[240:243],a[212:215],a[48:51]
v_fmac_f32 v237,s40,v235
v_sub_f32 v236,v236,v234
M a[52:55],a[240:243],a[216:219],a[52:55]
v_fma_f32 v234,-4.0,v233,v235
v_sub_f32 v235,v235,v233
M a[56:59],a[240:243],a[220:223],a[56:59]
v_add_f32 v233,v238,v234
v_sub_f32 v238,v238,v234
M a[60:63],a[240:243],a[192:195],a[60:63]
buffer_load_dwordx4 a[240:243],v251,s[20:23],s47 offen offset:2048
M a[64:67],a[244:247],a[196:199],a[64:67]
ds_read_b128 a[196:199],v249 offset:37120
v_fma_f32 v234,2.0,v235,v236
M a[68:71],a[244:247],a[200:203],a[68:71]
v_fmac_f32 v236,-2.0,v235
v_and_b32 v208,s42,v208
M a[72:75],a[244:247],a[204:207],a[72:75]
v_and_b32 v204,s42,v204
v_and_b32 v206,s42,v206
M a[76:79],a[244:247],a[208:211],a[76:79]
v_and_b32 v214,s42,v214
v_and_b32 v212,s42,v212
M a[80:83],a[244:247],a[212:215],a[80:83]
v_and_b32 v210,s42,v210
v_fmac_f32 v204,s43,v208
M a[84:87],a[244:247],a[216:219],a[84:87]
v_fmac_f32 v214,4.0,v206
v_fma_f32 v235,-4.0,v208,v212
M a[88:91],a[244:247],a[220:223],a[88:91]
v_fmac_f32 v204,s45,v212
v_fmac_f32 v214,s40,v210
M a[92:95],a[244:247],a[192:195],a[92:95]
buffer_load_dwordx4 a[244:247],v251,s[20:23],s48 offen offset:2048
M a[0:3],a[248:251],a[200:203],a[0:3]
v_sub_f32 v212,v212,v208
v_fma_f32 v208,-4.0,v206,v210
M a[4:7],a[248:251],a[204:207],a[4:7]
s_add_u32 s46,s79,27648
v_sub_f32 v210,v210,v206
v_add_f32 v206,v235,v208
M a[8:11],a[248:251],a[208:211],a[8:11]
v_sub_f32 v235,v235,v208
v_fma_f32 v208,2.0,v210,v212
M a[12:15],a[248:251],a[212:215],a[12:15]
v_fmac_f32 v212,-2.0,v210
v_cvt_pk_bf16_f32 v204,v232,v204
M a[16:19],a[248:251],a[216:219],a[16:19]
v_cvt_pk_bf16_f32 v214,v237,v214
v_cvt_pk_bf16_f32 v206,v233,v206
M a[20:23],a[248:251],a[220:223],a[20:23]
v_cvt_pk_bf16_f32 v210,v234,v208
v_cvt_pk_bf16_f32 v208,v238,v235
M a[24:27],a[248:251],a[192:195],a[24:27]
s_waitcnt lgkmcnt(0)
v_cvt_pk_bf16_f32 v212,v236,v212
v_lshlrev_b32 v234,16,v209
M a[28:31],a[248:251],a[196:199],a[28:31]
s_waitcnt vmcnt(16)
buffer_load_dwordx4 a[248:251],v251,s[20:23],s46 offen offset:0
M a[32:35],a[252:255],a[200:203],a[32:35]
v_lshlrev_b32 v232,16,v205
v_lshlrev_b32 v233,16,v207
M a[36:39],a[252:255],a[204:207],a[36:39]
s_add_u32 s47,s79,30720
v_lshlrev_b32 v237,16,v215
v_lshlrev_b32 v236,16,v213
M a[40:43],a[252:255],a[208:211],a[40:43]
v_lshlrev_b32 v235,16,v211
v_fmac_f32 v232,s43,v234
M a[44:47],a[252:255],a[212:215],a[44:47]
v_fmac_f32 v237,4.0,v233
v_fma_f32 v238,-4.0,v234,v236
M a[48:51],a[252:255],a[216:219],a[48:51]
v_fmac_f32 v232,s45,v236
v_fmac_f32 v237,s40,v235
M a[52:55],a[252:255],a[220:223],a[52:55]
v_sub_f32 v236,v236,v234
v_fma_f32 v234,-4.0,v233,v235
M a[56:59],a[252:255],a[192:195],a[56:59]
v_sub_f32 v235,v235,v233
v_add_f32 v233,v238,v234
M a[60:63],a[252:255],a[196:199],a[60:63]
s_waitcnt vmcnt(16)
buffer_load_dwordx4 a[252:255],v251,s[20:23],s47 offen offset:0
M a[64:67],v[216:219],a[200:203],a[64:67]
ds_read_b128 a[200:203],v249 offset:43520
v_sub_f32 v238,v238,v234
M a[68:71],v[216:219],a[204:207],a[68:71]
s_add_u32 s48,s79,33792
ds_read_b128 a[204:207],v250 offset:43776
v_fma_f32 v234,2.0,v235,v236
M a[72:75],v[216:219],a[208:211],a[72:75]
ds_read_b128 a[208:211],v250 offset:44032
v_fmac_f32 v236,-2.0,v235
M a[76:79],v[216:219],a[212:215],a[76:79]
ds_read_b128 a[212:215],v250 offset:44288
v_and_b32 v209,s42,v209
M a[80:83],v[216:219],a[216:219],a[80:83]
ds_read_b128 a[216:219],v250 offset:44544
v_and_b32 v205,s42,v205
M a[84:87],v[216:219],a[220:223],a[84:87]
ds_read_b128 a[220:223],v250 offset:44800
v_and_b32 v207,s42,v207
M a[88:91],v[216:219],a[192:195],a[88:91]
ds_read_b128 a[192:195],v250 offset:45056
v_and_b32 v215,s42,v215
M a[92:95],v[216:219],a[196:199],a[92:95]
s_waitcnt vmcnt(16) lgkmcnt(6)
buffer_load_dwordx4 v[216:219],v251,s[20:23],s48 offen offset:0
M a[96:99],v[220:223],a[200:203],a[96:99]
s_waitcnt lgkmcnt(5)
ds_read_b128 a[196:199],v250 offset:45312
v_and_b32 v213,s42,v213
M a[100:103],v[220:223],a[204:207],a[100:103]
s_waitcnt lgkmcnt(5)
v_and_b32 v211,s42,v211
v_fmac_f32 v205,s43,v209
M a[104:107],v[220:223],a[208:211],a[104:107]
s_waitcnt lgkmcnt(4)
v_fmac_f32 v215,4.0,v207
v_fma_f32 v235,-4.0,v209,v213
M a[108:111],v[220:223],a[212:215],a[108:111]
s_waitcnt lgkmcnt(3)
v_fmac_f32 v205,s45,v213
v_fmac_f32 v215,s40,v211
M a[112:115],v[220:223],a[216:219],a[112:115]
s_waitcnt lgkmcnt(2)
v_sub_f32 v213,v213,v209
v_fma_f32 v209,-4.0,v207,v211
M a[116:119],v[220:223],a[220:223],a[116:119]
s_waitcnt lgkmcnt(1)
v_sub_f32 v211,v211,v207
v_add_f32 v207,v235,v209
M a[120:123],v[220:223],a[192:195],a[120:123]
s_waitcnt lgkmcnt(0)
v_sub_f32 v235,v235,v209
v_fma_f32 v209,2.0,v211,v213
M a[124:127],v[220:223],a[196:199],a[124:127]
s_waitcnt vmcnt(16)
buffer_load_dwordx4 v[220:223],v251,s[20:23],s46 offen offset:1024
M a[128:131],v[224:227],a[200:203],a[128:131]
v_fmac_f32 v213,-2.0,v211
v_cvt_pk_bf16_f32 v205,v232,v205
M a[132:135],v[224:227],a[204:207],a[132:135]
v_cvt_pk_bf16_f32 v215,v237,v215
v_cvt_pk_bf16_f32 v207,v233,v207
M a[136:139],v[224:227],a[208:211],a[136:139]
v_cvt_pk_bf16_f32 v211,v234,v209
v_cvt_pk_bf16_f32 v209,v238,v235
M a[140:143],v[224:227],a[212:215],a[140:143]
v_cvt_pk_bf16_f32 v213,v236,v213
v_add_u32 v232,139264,v247
M a[144:147],v[224:227],a[216:219],a[144:147]
ds_write2st64_b64 v232,v[204:205],v[214:215] offset0:1 offset1:18
M a[148:151],v[224:227],a[220:223],a[148:151]
s_add_u32 s28,s68,1179648
buffer_load_dwordx2 v[204:205],v245,s[12:15],s28 offen offset:0
M a[152:155],v[224:227],a[192:195],a[152:155]
buffer_load_dwordx2 v[214:215],v245,s[16:19],s28 offen offset:1536
M a[156:159],v[224:227],a[196:199],a[156:159]
s_waitcnt vmcnt(18)
buffer_load_dwordx4 v[224:227],v251,s[20:23],s47 offen offset:1024
M a[160:163],v[228:231],a[200:203],a[160:163]
ds_read_b128 a[200:203],v250 offset:45568
ds_write2st64_b64 v247,v[206:207],v[208:209] offset0:35 offset1:52
M a[164:167],v[228:231],a[204:207],a[164:167]
buffer_load_dwordx2 v[206:207],v245,s[8:11],s28 offen offset:0
M a[168:171],v[228:231],a[208:211],a[168:171]
buffer_load_dwordx2 v[208:209],v245,s[8:11],s28 offen offset:384
M a[172:175],v[228:231],a[212:215],a[172:175]
ds_write2st64_b64 v247,v[210:211],v[212:213] offset0:69 offset1:86
M a[176:179],v[228:231],a[216:219],a[176:179]
buffer_load_dwordx2 v[210:211],v245,s[8:11],s28 offen offset:768
M a[180:183],v[228:231],a[220:223],a[180:183]
buffer_load_dwordx2 v[212:213],v245,s[8:11],s28 offen offset:1152
M a[184:187],v[228:231],a[192:195],a[184:187]
v_fmac_f32 v239,s43,v241
v_fmac_f32 v244,4.0,v240
M a[188:191],v[228:231],a[196:199],a[188:191]
s_waitcnt vmcnt(22)
buffer_load_dwordx4 v[228:231],v251,s[20:23],s48 offen offset:1024
M a[96:99],a[224:227],a[204:207],a[96:99]
v_fma_f32 v232,-4.0,v241,v243
v_fmac_f32 v239,s45,v243
M a[100:103],a[224:227],a[208:211],a[100:103]
v_fmac_f32 v244,s40,v242
v_sub_f32 v243,v243,v241
M a[104:107],a[224:227],a[212:215],a[104:107]
v_fma_f32 v241,-4.0,v240,v242
v_sub_f32 v242,v242,v240
M a[108:111],a[224:227],a[216:219],a[108:111]
v_add_f32 v240,v232,v241
v_sub_f32 v232,v232,v241
M a[112:115],a[224:227],a[220:223],a[112:115]
v_fma_f32 v241,2.0,v242,v243
v_fmac_f32 v243,-2.0,v242
M a[116:119],a[224:227],a[192:195],a[116:119]
v_cvt_pk_bf16_f32 v233,v239,v244
v_cvt_pk_bf16_f32 v234,v240,v232
M a[120:123],a[224:227],a[196:199],a[120:123]
s_waitcnt lgkmcnt(2)
v_cvt_pk_bf16_f32 v235,v241,v243
v_add_u32 v232,139264,v248
M a[124:127],a[224:227],a[200:203],a[124:127]
s_waitcnt vmcnt(22)
buffer_load_short_d16_hi v239,v246,s[12:15],s75 offen offset:0
M a[128:131],a[228:231],a[204:207],a[128:131]
buffer_load_short_d16_hi v240,v246,s[8:11],s75 offen offset:0
M a[132:135],a[228:231],a[208:211],a[132:135]
buffer_load_short_d16_hi v241,v246,s[8:11],s75 offen offset:384
M a[136:139],a[228:231],a[212:215],a[136:139]
buffer_load_short_d16_hi v242,v246,s[8:11],s75 offen offset:768
M a[140:143],a[228:231],a[216:219],a[140:143]
buffer_load_short_d16_hi v243,v246,s[8:11],s75 offen offset:1152
M a[144:147],a[228:231],a[220:223],a[144:147]
buffer_load_short_d16_hi v244,v246,s[16:19],s75 offen offset:1536
M a[148:151],a[228:231],a[192:195],a[148:151]
buffer_load_dwordx4 a[224:227],v251,s[20:23],s46 offen offset:2048
M a[152:155],a[228:231],a[196:199],a[152:155]
ds_write_b16 v232,v233 offset:0
M a[156:159],a[228:231],a[200:203],a[156:159]
s_waitcnt vmcnt(26)
buffer_load_dwordx4 a[228:231],v251,s[20:23],s47 offen offset:2048
M a[160:163],a[232:235],a[204:207],a[160:163]
ds_read_b128 a[204:207],v249 offset:45824
ds_write_b16_d16_hi v232,v233 offset:8704
M a[164:167],a[232:235],a[208:211],a[164:167]
ds_write_b16 v248,v234 offset:17408
M a[168:171],a[232:235],a[212:215],a[168:171]
ds_write_b16_d16_hi v248,v234 offset:26112
M a[172:175],a[232:235],a[216:219],a[172:175]
ds_write_b16 v248,v235 offset:34816
M a[176:179],a[232:235],a[220:223],a[176:179]
ds_write_b16_d16_hi v248,v235 offset:43520
M a[180:183],a[232:235],a[192:195],a[180:183]
s_waitcnt vmcnt(25)
v_lshlrev_b32 v234,16,v196
v_lshlrev_b32 v232,16,v192
M a[184:187],a[232:235],a[196:199],a[184:187]
v_lshlrev_b32 v233,16,v194
v_lshlrev_b32 v237,16,v202
M a[188:191],a[232:235],a[200:203],a[188:191]
s_waitcnt vmcnt(22)
buffer_load_dwordx4 a[232:235],v251,s[20:23],s48 offen offset:2048
M a[96:99],a[236:239],a[208:211],a[96:99]
v_lshlrev_b32 v236,16,v200
v_lshlrev_b32 v235,16,v198
M a[100:103],a[236:239],a[212:215],a[100:103]
s_add_u32 s46,s79,36864
v_fmac_f32 v232,s43,v234
v_fmac_f32 v237,4.0,v233
M a[104:107],a[236:239],a[216:219],a[104:107]
v_fma_f32 v238,-4.0,v234,v236
v_fmac_f32 v232,s45,v236
M a[108:111],a[236:239],a[220:223],a[108:111]
v_fmac_f32 v237,s40,v235
v_sub_f32 v236,v236,v234
M a[112:115],a[236:239],a[192:195],a[112:115]
v_fma_f32 v234,-4.0,v233,v235
v_sub_f32 v235,v235,v233
M a[116:119],a[236:239],a[196:199],a[116:119]
v_add_f32 v233,v238,v234
v_sub_f32 v238,v238,v234
M a[120:123],a[236:239],a[200:203],a[120:123]
s_waitcnt lgkmcnt(5)
v_fma_f32 v234,2.0,v235,v236
v_fmac_f32 v236,-2.0,v235
M a[124:127],a[236:239],a[204:207],a[124:127]
s_waitcnt vmcnt(22)
buffer_load_dwordx4 a[236:239],v251,s[20:23],s46 offen offset:0
M a[128:131],a[240:243],a[208:211],a[128:131]
v_and_b32 v196,s42,v196
v_and_b32 v192,s42,v192
M a[132:135],a[240:243],a[212:215],a[132:135]
s_add_u32 s47,s79,39936
v_and_b32 v194,s42,v194
v_and_b32 v202,s42,v202
M a[136:139],a[240:243],a[216:219],a[136:139]
v_and_b32 v200,s42,v200
v_and_b32 v198,s42,v198
M a[140:143],a[240:243],a[220:223],a[140:143]
v_fmac_f32 v192,s43,v196
v_fmac_f32 v202,4.0,v194
M a[144:147],a[240:243],a[192:195],a[144:147]
v_fma_f32 v235,-4.0,v196,v200
v_fmac_f32 v192,s45,v200
M a[148:151],a[240:243],a[196:199],a[148:151]
v_fmac_f32 v202,s40,v198
v_sub_f32 v200,v200,v196
M a[152:155],a[240:243],a[200:203],a[152:155]
v_fma_f32 v196,-4.0,v194,v198
v_sub_f32 v198,v198,v194
M a[156:159],a[240:243],a[204:207],a[156:159]
s_waitcnt vmcnt(22)
buffer_load_dwordx4 a[240:243],v251,s[20:23],s47 offen offset:0
M a[160:163],a[244:247],a[208:211],a[160:163]
ds_read_b128 a[208:211],v249 offset:52224
v_add_f32 v194,v235,v196
M a[164:167],a[244:247],a[212:215],a[164:167]
s_add_u32 s48,s79,43008
ds_read_b128 a[212:215],v250 offset:52480
v_sub_f32 v235,v235,v196
M a[168:171],a[244:247],a[216:219],a[168:171]
ds_read_b128 a[216:219],v250 offset:52736
v_fma_f32 v196,2.0,v198,v200
M a[172:175],a[244:247],a[220:223],a[172:175]
ds_read_b128 a[220:223],v250 offset:52992
v_fmac_f32 v200,-2.0,v198
M a[176:179],a[244:247],a[192:195],a[176:179]
ds_read_b128 a[192:195],v250 offset:53248
v_cvt_pk_bf16_f32 v192,v232,v192
M a[180:183],a[244:247],a[196:199],a[180:183]
ds_read_b128 a[196:199],v250 offset:53504
v_cvt_pk_bf16_f32 v202,v237,v202
M a[184:187],a[244:247],a[200:203],a[184:187]
ds_read_b128 a[200:203],v250 offset:53760
v_cvt_pk_bf16_f32 v194,v233,v194
M a[188:191],a[244:247],a[204:207],a[188:191]
s_waitcnt vmcnt(22) lgkmcnt(6)
buffer_load_dwordx4 a[244:247],v251,s[20:23],s48 offen offset:0
M v[0:3],a[248:251],a[208:211],v[0:3]
s_waitcnt lgkmcnt(5)
ds_read_b128 a[204:207],v250 offset:54016
v_cvt_pk_bf16_f32 v198,v234,v196
M v[4:7],a[248:251],a[212:215],v[4:7]
s_waitcnt lgkmcnt(5)
v_cvt_pk_bf16_f32 v196,v238,v235
v_cvt_pk_bf16_f32 v200,v236,v200
M v[8:11],a[248:251],a[216:219],v[8:11]
s_waitcnt lgkmcnt(4)
v_lshlrev_b32 v234,16,v197
v_lshlrev_b32 v232,16,v193
M v[12:15],a[248:251],a[220:223],v[12:15]
s_waitcnt lgkmcnt(3)
v_lshlrev_b32 v233,16,v195
v_lshlrev_b32 v237,16,v203
M v[16:19],a[248:251],a[192:195],v[16:19]
s_waitcnt lgkmcnt(2)
v_lshlrev_b32 v236,16,v201
v_lshlrev_b32 v235,16,v199
M v[20:23],a[248:251],a[196:199],v[20:23]
s_waitcnt lgkmcnt(1)
v_fmac_f32 v232,s43,v234
v_fmac_f32 v237,4.0,v233
M v[24:27],a[248:251],a[200:203],v[24:27]
s_waitcnt lgkmcnt(0)
v_fma_f32 v238,-4.0,v234,v236
v_fmac_f32 v232,s45,v236
M v[28:31],a[248:251],a[204:207],v[28:31]
s_waitcnt vmcnt(22)
buffer_load_dwordx4 a[248:251],v251,s[20:23],s46 offen offset:1024
M v[32:35],a[252:255],a[208:211],v[32:35]
v_fmac_f32 v237,s40,v235
v_sub_f32 v236,v236,v234
M v[36:39],a[252:255],a[212:215],v[36:39]
v_fma_f32 v234,-4.0,v233,v235
v_sub_f32 v235,v235,v233
M v[40:43],a[252:255],a[216:219],v[40:43]
v_add_f32 v233,v238,v234
v_sub_f32 v238,v238,v234
M v[44:47],a[252:255],a[220:223],v[44:47]
v_fma_f32 v234,2.0,v235,v236
v_fmac_f32 v236,-2.0,v235
M v[48:51],a[252:255],a[192:195],v[48:51]
v_and_b32 v197,s42,v197
v_and_b32 v193,s42,v193
M v[52:55],a[252:255],a[196:199],v[52:55]
v_and_b32 v195,s42,v195
v_and_b32 v203,s42,v203
M v[56:59],a[252:255],a[200:203],v[56:59]
v_and_b32 v201,s42,v201
v_and_b32 v199,s42,v199
M v[60:63],a[252:255],a[204:207],v[60:63]
s_waitcnt vmcnt(22)
buffer_load_dwordx4 a[252:255],v251,s[20:23],s47 offen offset:1024
M v[64:67],v[216:219],a[208:211],v[64:67]
ds_read_b128 a[208:211],v250 offset:54272
v_fmac_f32 v193,s43,v197
M v[68:71],v[216:219],a[212:215],v[68:71]
v_fmac_f32 v203,4.0,v195
v_fma_f32 v235,-4.0,v197,v201
M v[72:75],v[216:219],a[216:219],v[72:75]
v_fmac_f32 v193,s45,v201
v_fmac_f32 v203,s40,v199
M v[76:79],v[216:219],a[220:223],v[76:79]
v_sub_f32 v201,v201,v197
v_fma_f32 v197,-4.0,v195,v199
M v[80:83],v[216:219],a[192:195],v[80:83]
v_sub_f32 v199,v199,v195
v_add_f32 v195,v235,v197
M v[84:87],v[216:219],a[196:199],v[84:87]
v_sub_f32 v235,v235,v197
v_fma_f32 v197,2.0,v199,v201
M v[88:91],v[216:219],a[200:203],v[88:91]
v_fmac_f32 v201,-2.0,v199
v_cvt_pk_bf16_f32 v193,v232,v193
M v[92:95],v[216:219],a[204:207],v[92:95]
s_waitcnt vmcnt(22)
buffer_load_dwordx4 v[216:219],v251,s[20:23],s48 offen offset:1024
M v[0:3],v[220:223],a[212:215],v[0:3]
v_cvt_pk_bf16_f32 v203,v237,v203
v_cvt_pk_bf16_f32 v195,v233,v195
M v[4:7],v[220:223],a[216:219],v[4:7]
v_cvt_pk_bf16_f32 v199,v234,v197
v_cvt_pk_bf16_f32 v197,v238,v235
M v[8:11],v[220:223],a[220:223],v[8:11]
v_cvt_pk_bf16_f32 v201,v236,v201
v_add_u32 v232,139264,v247
M v[12:15],v[220:223],a[192:195],v[12:15]
ds_write2st64_b64 v232,v[192:193],v[202:203] offset0:2 offset1:19
M v[16:19],v[220:223],a[196:199],v[16:19]
s_add_u32 s28,s69,0
buffer_load_dwordx2 v[192:193],v245,s[12:15],s28 offen offset:0
M v[20:23],v[220:223],a[200:203],v[20:23]
buffer_load_dwordx2 v[202:203],v245,s[16:19],s28 offen offset:1536
M v[24:27],v[220:223],a[204:207],v[24:27]
s_waitcnt lgkmcnt(1)
ds_write2st64_b64 v247,v[194:195],v[196:197] offset0:36 offset1:53
M v[28:31],v[220:223],a[208:211],v[28:31]
s_waitcnt vmcnt(22)
buffer_load_dwordx2 v[194:195],v245,s[8:11],s28 offen offset:0
M v[32:35],v[224:227],a[212:215],v[32:35]
buffer_load_dwordx2 v[196:197],v245,s[8:11],s28 offen offset:384
M v[36:39],v[224:227],a[216:219],v[36:39]
buffer_load_dwordx4 v[220:223],v251,s[20:23],s46 offen offset:2048
M v[40:43],v[224:227],a[220:223],v[40:43]
ds_write2st64_b64 v247,v[198:199],v[200:201] offset0:70 offset1:87
M v[44:47],v[224:227],a[192:195],v[44:47]
buffer_load_dwordx2 v[198:199],v245,s[8:11],s28 offen offset:768
M v[48:51],v[224:227],a[196:199],v[48:51]
buffer_load_dwordx2 v[200:201],v245,s[8:11],s28 offen offset:1152
M v[52:55],v[224:227],a[200:203],v[52:55]
s_waitcnt vmcnt(25)
v_lshlrev_b32 v234,16,v208
v_lshlrev_b32 v232,16,v204
M v[56:59],v[224:227],a[204:207],v[56:59]
v_lshlrev_b32 v233,16,v206
v_lshlrev_b32 v237,16,v214
M v[60:63],v[224:227],a[208:211],v[60:63]
s_waitcnt vmcnt(22)
buffer_load_dwordx4 v[224:227],v251,s[20:23],s47 offen offset:2048
M v[64:67],v[228:231],a[212:215],v[64:67]
ds_read_b128 a[212:215],v249 offset:54528
v_lshlrev_b32 v236,16,v212
M v[68:71],v[228:231],a[216:219],v[68:71]
v_lshlrev_b32 v235,16,v210
v_fmac_f32 v232,s43,v234
M v[72:75],v[228:231],a[220:223],v[72:75]
v_fmac_f32 v237,4.0,v233
v_fma_f32 v238,-4.0,v234,v236
M v[76:79],v[228:231],a[192:195],v[76:79]
v_fmac_f32 v232,s45,v236
v_fmac_f32 v237,s40,v235
M v[80:83],v[228:231],a[196:199],v[80:83]
v_sub_f32 v236,v236,v234
v_fma_f32 v234,-4.0,v233,v235
M v[84:87],v[228:231],a[200:203],v[84:87]
v_sub_f32 v235,v235,v233
v_add_f32 v233,v238,v234
M v[88:91],v[228:231],a[204:207],v[88:91]
v_sub_f32 v238,v238,v234
v_fma_f32 v234,2.0,v235,v236
M v[92:95],v[228:231],a[208:211],v[92:95]
s_waitcnt vmcnt(16)
buffer_load_dwordx4 v[228:231],v251,s[20:23],s48 offen offset:2048
M v[0:3],a[224:227],a[216:219],v[0:3]
v_fmac_f32 v236,-2.0,v235
v_and_b32 v208,s42,v208
M v[4:7],a[224:227],a[220:223],v[4:7]
s_add_u32 s46,s80,9216
v_and_b32 v204,s42,v204
v_and_b32 v206,s42,v206
M v[8:11],a[224:227],a[192:195],v[8:11]
v_and_b32 v214,s42,v214
v_and_b32 v212,s42,v212
M v[12:15],a[224:227],a[196:199],v[12:15]
v_and_b32 v210,s42,v210
v_fmac_f32 v204,s43,v208
M v[16:19],a[224:227],a[200:203],v[16:19]
v_fmac_f32 v214,4.0,v206
v_fma_f32 v235,-4.0,v208,v212
M v[20:23],a[224:227],a[204:207],v[20:23]
v_fmac_f32 v204,s45,v212
v_fmac_f32 v214,s40,v210
M v[24:27],a[224:227],a[208:211],v[24:27]
s_waitcnt lgkmcnt(0)
v_sub_f32 v212,v212,v208
v_fma_f32 v208,-4.0,v206,v210
M v[28:31],a[224:227],a[212:215],v[28:31]
s_waitcnt vmcnt(16)
buffer_load_dwordx4 a[224:227],v251,s[20:23],s46 offen offset:0
M v[32:35],a[228:231],a[216:219],v[32:35]
v_sub_f32 v210,v210,v206
v_add_f32 v206,v235,v208
M v[36:39],a[228:231],a[220:223],v[36:39]
s_add_u32 s47,s80,12288
v_sub_f32 v235,v235,v208
v_fma_f32 v208,2.0,v210,v212
M v[40:43],a[228:231],a[192:195],v[40:43]
v_fmac_f32 v212,-2.0,v210
v_cvt_pk_bf16_f32 v204,v232,v204
M v[44:47],a[228:231],a[196:199],v[44:47]
v_cvt_pk_bf16_f32 v214,v237,v214
v_cvt_pk_bf16_f32 v206,v233,v206
M v[48:51],a[228:231],a[200:203],v[48:51]
v_cvt_pk_bf16_f32 v210,v234,v208
v_cvt_pk_bf16_f32 v208,v238,v235
M v[52:55],a[228:231],a[204:207],v[52:55]
v_cvt_pk_bf16_f32 v212,v236,v212
v_lshlrev_b32 v234,16,v209
M v[56:59],a[228:231],a[208:211],v[56:59]
v_lshlrev_b32 v232,16,v205
v_lshlrev_b32 v233,16,v207
M v[60:63],a[228:231],a[212:215],v[60:63]
s_waitcnt vmcnt(16)
buffer_load_dwordx4 a[228:231],v251,s[20:23],s47 offen offset:0
M v[64:67],a[232:235],a[216:219],v[64:67]
ds_read_b128 a[216:219],v249 offset:60928
v_lshlrev_b32 v237,16,v215
M v[68:71],a[232:235],a[220:223],v[68:71]
s_add_u32 s48,s80,15360
ds_read_b128 a[220:223],v250 offset:61184
v_lshlrev_b32 v236,16,v213
M v[72:75],a[232:235],a[192:195],v[72:75]
ds_read_b128 a[192:195],v250 offset:61440
v_lshlrev_b32 v235,16,v211
M v[76:79],a[232:235],a[196:199],v[76:79]
ds_read_b128 a[196:199],v250 offset:61696
v_fmac_f32 v232,s43,v234
M v[80:83],a[232:235],a[200:203],v[80:83]
ds_read_b128 a[200:203],v250 offset:61952
v_fmac_f32 v237,4.0,v233
M v[84:87],a[232:235],a[204:207],v[84:87]
ds_read_b128 a[204:207],v250 offset:62208
v_fma_f32 v238,-4.0,v234,v236
M v[88:91],a[232:235],a[208:211],v[88:91]
ds_read_b128 a[208:211],v250 offset:62464
v_fmac_f32 v232,s45,v236
M v[92:95],a[232:235],a[212:215],v[92:95]
s_waitcnt vmcnt(16) lgkmcnt(6)
buffer_load_dwordx4 a[232:235],v251,s[20:23],s48 offen offset:0
M v[96:99],a[236:239],a[216:219],v[96:99]
s_waitcnt lgkmcnt(5)
ds_read_b128 a[212:215],v250 offset:62720
v_fmac_f32 v237,s40,v235
M v[100:103],a[236:239],a[220:223],v[100:103]
s_waitcnt lgkmcnt(5)
v_sub_f32 v236,v236,v234
v_fma_f32 v234,-4.0,v233,v235
M v[104:107],a[236:239],a[192:195],v[104:107]
s_waitcnt lgkmcnt(4)
v_sub_f32 v235,v235,v233
v_add_f32 v233,v238,v234
M v[108:111],a[236:239],a[196:199],v[108:111]
s_waitcnt lgkmcnt(3)
v_sub_f32 v238,v238,v234
v_fma_f32 v234,2.0,v235,v236
M v[112:115],a[236:239],a[200:203],v[112:115]
s_waitcnt lgkmcnt(2)
v_fmac_f32 v236,-2.0,v235
v_and_b32 v209,s42,v209
M v[116:119],a[236:239],a[204:207],v[116:119]
s_waitcnt lgkmcnt(1)
v_and_b32 v205,s42,v205
v_and_b32 v207,s42,v207
M v[120:123],a[236:239],a[208:211],v[120:123]
s_waitcnt lgkmcnt(0)
v_and_b32 v215,s42,v215
v_and_b32 v213,s42,v213
M v[124:127],a[236:239],a[212:215],v[124:127]
s_waitcnt vmcnt(16)
buffer_load_dwordx4 a[236:239],v251,s[20:23],s46 offen offset:1024
M v[128:131],a[240:243],a[216:219],v[128:131]
v_and_b32 v211,s42,v211
v_fmac_f32 v205,s43,v209
M v[132:135],a[240:243],a[220:223],v[132:135]
v_fmac_f32 v215,4.0,v207
v_fma_f32 v235,-4.0,v209,v213
M v[136:139],a[240:243],a[192:195],v[136:139]
v_fmac_f32 v205,s45,v213
v_fmac_f32 v215,s40,v211
M v[140:143],a[240:243],a[196:199],v[140:143]
v_sub_f32 v213,v213,v209
v_fma_f32 v209,-4.0,v207,v211
M v[144:147],a[240:243],a[200:203],v[144:147]
v_sub_f32 v211,v211,v207
v_add_f32 v207,v235,v209
M v[148:151],a[240:243],a[204:207],v[148:151]
v_sub_f32 v235,v235,v209
v_fma_f32 v209,2.0,v211,v213
M v[152:155],a[240:243],a[208:211],v[152:155]
v_fmac_f32 v213,-2.0,v211
v_cvt_pk_bf16_f32 v205,v232,v205
M v[156:159],a[240:243],a[212:215],v[156:159]
s_waitcnt vmcnt(16)
buffer_load_dwordx4 a[240:243],v251,s[20:23],s47 offen offset:1024
M v[160:163],a[244:247],a[216:219],v[160:163]
ds_read_b128 a[216:219],v250 offset:62976
v_cvt_pk_bf16_f32 v215,v237,v215
M v[164:167],a[244:247],a[220:223],v[164:167]
v_cvt_pk_bf16_f32 v207,v233,v207
v_cvt_pk_bf16_f32 v211,v234,v209
M v[168:171],a[244:247],a[192:195],v[168:171]
v_cvt_pk_bf16_f32 v209,v238,v235
v_cvt_pk_bf16_f32 v213,v236,v213
M v[172:175],a[244:247],a[196:199],v[172:175]
v_add_u32 v232,139264,v247
M v[176:179],a[244:247],a[200:203],v[176:179]
ds_write2st64_b64 v232,v[204:205],v[214:215] offset0:3 offset1:20
M v[180:183],a[244:247],a[204:207],v[180:183]
s_add_u32 s28,s69,393216
buffer_load_dwordx2 v[204:205],v245,s[12:15],s28 offen offset:0
M v[184:187],a[244:247],a[208:211],v[184:187]
buffer_load_dwordx2 v[214:215],v245,s[16:19],s28 offen offset:1536
M v[188:191],a[244:247],a[212:215],v[188:191]
s_waitcnt vmcnt(18)
buffer_load_dwordx4 a[244:247],v251,s[20:23],s48 offen offset:1024
M v[96:99],a[248:251],a[220:223],v[96:99]
ds_write2st64_b64 v247,v[206:207],v[208:209] offset0:37 offset1:54
M v[100:103],a[248:251],a[192:195],v[100:103]
buffer_load_dwordx2 v[206:207],v245,s[8:11],s28 offen offset:0
M v[104:107],a[248:251],a[196:199],v[104:107]
buffer_load_dwordx2 v[208:209],v245,s[8:11],s28 offen offset:384
M v[108:111],a[248:251],a[200:203],v[108:111]
ds_write2st64_b64 v247,v[210:211],v[212:213] offset0:71 offset1:88
M v[112:115],a[248:251],a[204:207],v[112:115]
buffer_load_dwordx2 v[210:211],v245,s[8:11],s28 offen offset:768
M v[116:119],a[248:251],a[208:211],v[116:119]
buffer_load_dwordx2 v[212:213],v245,s[8:11],s28 offen offset:1152
M v[120:123],a[248:251],a[212:215],v[120:123]
s_waitcnt vmcnt(17) lgkmcnt(3)
v_lshlrev_b32 v234,16,v196
v_lshlrev_b32 v232,16,v192
M v[124:127],a[248:251],a[216:219],v[124:127]
buffer_load_dwordx4 a[248:251],v251,s[20:23],s46 offen offset:2048
M v[128:131],a[252:255],a[220:223],v[128:131]
v_lshlrev_b32 v233,16,v194
v_lshlrev_b32 v237,16,v202
M v[132:135],a[252:255],a[192:195],v[132:135]
s_waitcnt vmcnt(15)
v_lshlrev_b32 v236,16,v200
v_lshlrev_b32 v235,16,v198
M v[136:139],a[252:255],a[196:199],v[136:139]
v_fmac_f32 v232,s43,v234
v_fmac_f32 v237,4.0,v233
M v[140:143],a[252:255],a[200:203],v[140:143]
v_fma_f32 v238,-4.0,v234,v236
v_fmac_f32 v232,s45,v236
M v[144:147],a[252:255],a[204:207],v[144:147]
v_fmac_f32 v237,s40,v235
v_sub_f32 v236,v236,v234
M v[148:151],a[252:255],a[208:211],v[148:151]
v_fma_f32 v234,-4.0,v233,v235
v_sub_f32 v235,v235,v233
M v[152:155],a[252:255],a[212:215],v[152:155]
v_add_f32 v233,v238,v234
v_sub_f32 v238,v238,v234
M v[156:159],a[252:255],a[216:219],v[156:159]
buffer_load_dwordx4 a[252:255],v251,s[20:23],s47 offen offset:2048
M v[160:163],v[216:219],a[220:223],v[160:163]
ds_read_b128 a[220:223],v249 offset:63232
v_fma_f32 v234,2.0,v235,v236
M v[164:167],v[216:219],a[192:195],v[164:167]
v_fmac_f32 v236,-2.0,v235
v_and_b32 v196,s42,v196
M v[168:171],v[216:219],a[196:199],v[168:171]
v_and_b32 v192,s42,v192
v_and_b32 v194,s42,v194
M v[172:175],v[216:219],a[200:203],v[172:175]
v_and_b32 v202,s42,v202
v_and_b32 v200,s42,v200
M v[176:179],v[216:219],a[204:207],v[176:179]
v_and_b32 v198,s42,v198
v_fmac_f32 v192,s43,v196
M v[180:183],v[216:219],a[208:211],v[180:183]
v_fmac_f32 v202,4.0,v194
v_fma_f32 v235,-4.0,v196,v200
M v[184:187],v[216:219],a[212:215],v[184:187]
v_fmac_f32 v192,s45,v200
v_fmac_f32 v202,s40,v198
M v[188:191],v[216:219],a[216:219],v[188:191]
buffer_load_dwordx4 v[216:219],v251,s[20:23],s48 offen offset:2048
M v[96:99],v[220:223],a[192:195],v[96:99]
v_sub_f32 v200,v200,v196
v_fma_f32 v196,-4.0,v194,v198
M v[100:103],v[220:223],a[196:199],v[100:103]
s_add_u32 s46,s80,18432
v_sub_f32 v198,v198,v194
v_add_f32 v194,v235,v196
M v[104:107],v[220:223],a[200:203],v[104:107]
v_sub_f32 v235,v235,v196
v_fma_f32 v196,2.0,v198,v200
M v[108:111],v[220:223],a[204:207],v[108:111]
v_fmac_f32 v200,-2.0,v198
v_cvt_pk_bf16_f32 v192,v232,v192
M v[112:115],v[220:223],a[208:211],v[112:115]
v_cvt_pk_bf16_f32 v202,v237,v202
v_cvt_pk_bf16_f32 v194,v233,v194
M v[116:119],v[220:223],a[212:215],v[116:119]
v_cvt_pk_bf16_f32 v198,v234,v196
v_cvt_pk_bf16_f32 v196,v238,v235
M v[120:123],v[220:223],a[216:219],v[120:123]
s_waitcnt lgkmcnt(0)
v_cvt_pk_bf16_f32 v200,v236,v200
v_lshlrev_b32 v234,16,v197
M v[124:127],v[220:223],a[220:223],v[124:127]
s_waitcnt vmcnt(16)
buffer_load_dwordx4 v[220:223],v251,s[20:23],s46 offen offset:0
M v[128:131],v[224:227],a[192:195],v[128:131]
v_lshlrev_b32 v232,16,v193
v_lshlrev_b32 v233,16,v195
M v[132:135],v[224:227],a[196:199],v[132:135]
s_add_u32 s47,s80,21504
v_lshlrev_b32 v237,16,v203
v_lshlrev_b32 v236,16,v201
M v[136:139],v[224:227],a[200:203],v[136:139]
v_lshlrev_b32 v235,16,v199
v_fmac_f32 v232,s43,v234
M v[140:143],v[224:227],a[204:207],v[140:143]
v_fmac_f32 v237,4.0,v233
v_fma_f32 v238,-4.0,v234,v236
M v[144:147],v[224:227],a[208:211],v[144:147]
v_fmac_f32 v232,s45,v236
v_fmac_f32 v237,s40,v235
M v[148:151],v[224:227],a[212:215],v[148:151]
v_sub_f32 v236,v236,v234
v_fma_f32 v234,-4.0,v233,v235
M v[152:155],v[224:227],a[216:219],v[152:155]
s_barrier
v_sub_f32 v235,v235,v233
M v[156:159],v[224:227],a[220:223],v[156:159]
s_waitcnt vmcnt(16)
buffer_load_dwordx4 v[224:227],v251,s[20:23],s47 offen offset:0
M v[160:163],v[228:231],a[192:195],v[160:163]
ds_read_b128 a[192:195],v249 offset:0
v_add_f32 v233,v238,v234
M v[164:167],v[228:231],a[196:199],v[164:167]
s_add_u32 s48,s80,24576
ds_read_b128 a[196:199],v250 offset:256
v_sub_f32 v238,v238,v234
M v[168:171],v[228:231],a[200:203],v[168:171]
ds_read_b128 a[200:203],v250 offset:512
v_fma_f32 v234,2.0,v235,v236
M v[172:175],v[228:231],a[204:207],v[172:175]
ds_read_b128 a[204:207],v250 offset:768
v_fmac_f32 v236,-2.0,v235
M v[176:179],v[228:231],a[208:211],v[176:179]
ds_read_b128 a[208:211],v250 offset:1024
v_and_b32 v197,s42,v197
M v[180:183],v[228:231],a[212:215],v[180:183]
ds_read_b128 a[212:215],v250 offset:1280
v_and_b32 v193,s42,v193
M v[184:187],v[228:231],a[216:219],v[184:187]
ds_read_b128 a[216:219],v250 offset:1536
v_and_b32 v195,s42,v195
M v[188:191],v[228:231],a[220:223],v[188:191]
s_waitcnt vmcnt(16) lgkmcnt(6)
buffer_load_dwordx4 v[228:231],v251,s[20:23],s48 offen offset:0
M a[0:3],a[224:227],a[192:195],a[0:3]
s_waitcnt lgkmcnt(5)
ds_read_b128 a[220:223],v250 offset:1792
v_and_b32 v203,s42,v203
M a[4:7],a[224:227],a[196:199],a[4:7]
s_waitcnt lgkmcnt(5)
v_and_b32 v201,s42,v201
v_and_b32 v199,s42,v199
M a[8:11],a[224:227],a[200:203],a[8:11]
s_waitcnt lgkmcnt(4)
v_fmac_f32 v193,s43,v197
v_fmac_f32 v203,4.0,v195
M a[12:15],a[224:227],a[204:207],a[12:15]
s_waitcnt lgkmcnt(3)
v_fma_f32 v235,-4.0,v197,v201
v_fmac_f32 v193,s45,v201
M a[16:19],a[224:227],a[208:211],a[16:19]
s_waitcnt lgkmcnt(2)
v_fmac_f32 v203,s40,v199
v_sub_f32 v201,v201,v197
M a[20:23],a[224:227],a[212:215],a[20:23]
s_waitcnt lgkmcnt(1)
v_fma_f32 v197,-4.0,v195,v199
v_sub_f32 v199,v199,v195
M a[24:27],a[224:227],a[216:219],a[24:27]
s_waitcnt lgkmcnt(0)
v_add_f32 v195,v235,v197
v_sub_f32 v235,v235,v197
M a[28:31],a[224:227],a[220:223],a[28:31]
s_waitcnt vmcnt(16)
buffer_load_dwordx4 a[224:227],v251,s[20:23],s46 offen offset:1024
M a[32:35],a[228:231],a[192:195],a[32:35]
v_fma_f32 v197,2.0,v199,v201
v_fmac_f32 v201,-2.0,v199
M a[36:39],a[228:231],a[196:199],a[36:39]
v_cvt_pk_bf16_f32 v193,v232,v193
v_cvt_pk_bf16_f32 v203,v237,v203
M a[40:43],a[228:231],a[200:203],a[40:43]
v_cvt_pk_bf16_f32 v195,v233,v195
v_cvt_pk_bf16_f32 v199,v234,v197
M a[44:47],a[228:231],a[204:207],a[44:47]
v_cvt_pk_bf16_f32 v197,v238,v235
v_cvt_pk_bf16_f32 v201,v236,v201
M a[48:51],a[228:231],a[208:211],a[48:51]
ds_write2st64_b64 v247,v[192:193],v[202:203] offset0:136 offset1:153
M a[52:55],a[228:231],a[212:215],a[52:55]
s_add_u32 s28,s69,786432
buffer_load_dwordx2 v[192:193],v245,s[12:15],s28 offen offset:0
M a[56:59],a[228:231],a[216:219],a[56:59]
buffer_load_dwordx2 v[202:203],v245,s[16:19],s28 offen offset:1536
M a[60:63],a[228:231],a[220:223],a[60:63]
s_waitcnt vmcnt(18)
buffer_load_dwordx4 a[228:231],v251,s[20:23],s47 offen offset:1024
M a[64:67],a[232:235],a[192:195],a[64:67]
ds_read_b128 a[192:195],v250 offset:2048
ds_write2st64_b64 v247,v[194:195],v[196:197] offset0:102 offset1:119
M a[68:71],a[232:235],a[196:199],a[68:71]
buffer_load_dwordx2 v[194:195],v245,s[8:11],s28 offen offset:0
M a[72:75],a[232:235],a[200:203],a[72:75]
buffer_load_dwordx2 v[196:197],v245,s[8:11],s28 offen offset:384
M a[76:79],a[232:235],a[204:207],a[76:79]
M a[80:83],a[232:235],a[208:211],a[80:83]
M a[84:87],a[232:235],a[212:215],a[84:87]
M a[88:91],a[232:235],a[216:219],a[88:91]
M a[92:95],a[232:235],a[220:223],a[92:95]
s_waitcnt vmcnt(20)
buffer_load_dwordx4 a[232:235],v251,s[20:23],s48 offen offset:1024
M a[0:3],a[236:239],a[196:199],a[0:3]
M a[4:7],a[236:239],a[200:203],a[4:7]
M a[8:11],a[236:239],a[204:207],a[8:11]
M a[12:15],a[236:239],a[208:211],a[12:15]
M a[16:19],a[236:239],a[212:215],a[16:19]
M a[20:23],a[236:239],a[216:219],a[20:23]
M a[24:27],a[236:239],a[220:223],a[24:27]
s_waitcnt lgkmcnt(1)
M a[28:31],a[236:239],a[192:195],a[28:31]
s_waitcnt vmcnt(20)
buffer_load_dwordx4 a[236:239],v251,s[20:23],s46 offen offset:2048
M a[32:35],a[240:243],a[196:199],a[32:35]
M a[36:39],a[240:243],a[200:203],a[36:39]
M a[40:43],a[240:243],a[204:207],a[40:43]
M a[44:47],a[240:243],a[208:211],a[44:47]
M a[48:51],a[240:243],a[212:215],a[48:51]
M a[52:55],a[240:243],a[216:219],a[52:55]
M a[56:59],a[240:243],a[220:223],a[56:59]
M a[60:63],a[240:243],a[192:195],a[60:63]
s_waitcnt vmcnt(18)
buffer_load_dwordx4 a[240:243],v251,s[20:23],s47 offen offset:2048
M a[64:67],a[244:247],a[196:199],a[64:67]
ds_read_b128 a[196:199],v249 offset:2304
M a[68:71],a[244:247],a[200:203],a[68:71]
M a[72:75],a[244:247],a[204:207],a[72:75]
M a[76:79],a[244:247],a[208:211],a[76:79]
M a[80:83],a[244:247],a[212:215],a[80:83]
M a[84:87],a[244:247],a[216:219],a[84:87]
M a[88:91],a[244:247],a[220:223],a[88:91]
M a[92:95],a[244:247],a[192:195],a[92:95]
s_waitcnt vmcnt(14)
buffer_load_dwordx4 a[244:247],v251,s[20:23],s48 offen offset:2048
M a[0:3],a[248:251],a[200:203],a[0:3]
M a[4:7],a[248:251],a[204:207],a[4:7]
s_add_u32 s46,s80,27648
M a[8:11],a[248:251],a[208:211],a[8:11]
M a[12:15],a[248:251],a[212:215],a[12:15]
M a[16:19],a[248:251],a[216:219],a[16:19]
M a[20:23],a[248:251],a[220:223],a[20:23]
M a[24:27],a[248:251],a[192:195],a[24:27]
s_waitcnt lgkmcnt(0)
M a[28:31],a[248:251],a[196:199],a[28:31]
s_waitcnt vmcnt(14)
buffer_load_dwordx4 a[248:251],v251,s[20:23],s46 offen offset:0
M a[32:35],a[252:255],a[200:203],a[32:35]
M a[36:39],a[252:255],a[204:207],a[36:39]
s_add_u32 s47,s80,30720
M a[40:43],a[252:255],a[208:211],a[40:43]
M a[44:47],a[252:255],a[212:215],a[44:47]
M a[48:51],a[252:255],a[216:219],a[48:51]
M a[52:55],a[252:255],a[220:223],a[52:55]
M a[56:59],a[252:255],a[192:195],a[56:59]
M a[60:63],a[252:255],a[196:199],a[60:63]
s_waitcnt vmcnt(14)
buffer_load_dwordx4 a[252:255],v251,s[20:23],s47 offen offset:0
M a[64:67],v[216:219],a[200:203],a[64:67]
ds_read_b128 a[200:203],v249 offset:8704
M a[68:71],v[216:219],a[204:207],a[68:71]
s_add_u32 s48,s80,33792
ds_read_b128 a[204:207],v250 offset:8960
M a[72:75],v[216:219],a[208:211],a[72:75]
ds_read_b128 a[208:211],v250 offset:9216
M a[76:79],v[216:219],a[212:215],a[76:79]
ds_read_b128 a[212:215],v250 offset:9472
M a[80:83],v[216:219],a[216:219],a[80:83]
ds_read_b128 a[216:219],v250 offset:9728
M a[84:87],v[216:219],a[220:223],a[84:87]
ds_read_b128 a[220:223],v250 offset:9984
M a[88:91],v[216:219],a[192:195],a[88:91]
ds_read_b128 a[192:195],v250 offset:10240
M a[92:95],v[216:219],a[196:199],a[92:95]
s_waitcnt vmcnt(14) lgkmcnt(6)
buffer_load_dwordx4 v[216:219],v251,s[20:23],s48 offen offset:0
M a[96:99],v[220:223],a[200:203],a[96:99]
s_waitcnt lgkmcnt(5)
ds_read_b128 a[196:199],v250 offset:10496
M a[100:103],v[220:223],a[204:207],a[100:103]
s_waitcnt lgkmcnt(5)
M a[104:107],v[220:223],a[208:211],a[104:107]
s_waitcnt lgkmcnt(4)
M a[108:111],v[220:223],a[212:215],a[108:111]
s_waitcnt lgkmcnt(3)
M a[112:115],v[220:223],a[216:219],a[112:115]
s_waitcnt lgkmcnt(2)
M a[116:119],v[220:223],a[220:223],a[116:119]
s_waitcnt lgkmcnt(1)
M a[120:123],v[220:223],a[192:195],a[120:123]
s_waitcnt lgkmcnt(0)
M a[124:127],v[220:223],a[196:199],a[124:127]
s_waitcnt vmcnt(14)
buffer_load_dwordx4 v[220:223],v251,s[20:23],s46 offen offset:1024
M a[128:131],v[224:227],a[200:203],a[128:131]
M a[132:135],v[224:227],a[204:207],a[132:135]
M a[136:139],v[224:227],a[208:211],a[136:139]
M a[140:143],v[224:227],a[212:215],a[140:143]
M a[144:147],v[224:227],a[216:219],a[144:147]
M a[148:151],v[224:227],a[220:223],a[148:151]
M a[152:155],v[224:227],a[192:195],a[152:155]
M a[156:159],v[224:227],a[196:199],a[156:159]
s_waitcnt vmcnt(14)
buffer_load_dwordx4 v[224:227],v251,s[20:23],s47 offen offset:1024
M a[160:163],v[228:231],a[200:203],a[160:163]
ds_read_b128 a[200:203],v250 offset:10752
M a[164:167],v[228:231],a[204:207],a[164:167]
M a[168:171],v[228:231],a[208:211],a[168:171]
M a[172:175],v[228:231],a[212:215],a[172:175]
M a[176:179],v[228:231],a[216:219],a[176:179]
M a[180:183],v[228:231],a[220:223],a[180:183]
M a[184:187],v[228:231],a[192:195],a[184:187]
M a[188:191],v[228:231],a[196:199],a[188:191]
s_waitcnt vmcnt(14)
buffer_load_dwordx4 v[228:231],v251,s[20:23],s48 offen offset:1024
M a[96:99],a[224:227],a[204:207],a[96:99]
M a[100:103],a[224:227],a[208:211],a[100:103]
M a[104:107],a[224:227],a[212:215],a[104:107]
M a[108:111],a[224:227],a[216:219],a[108:111]
M a[112:115],a[224:227],a[220:223],a[112:115]
M a[116:119],a[224:227],a[192:195],a[116:119]
M a[120:123],a[224:227],a[196:199],a[120:123]
s_waitcnt lgkmcnt(0)
M a[124:127],a[224:227],a[200:203],a[124:127]
s_waitcnt vmcnt(12)
buffer_load_dwordx4 a[224:227],v251,s[20:23],s46 offen offset:2048
M a[128:131],a[228:231],a[204:207],a[128:131]
M a[132:135],a[228:231],a[208:211],a[132:135]
M a[136:139],a[228:231],a[212:215],a[136:139]
M a[140:143],a[228:231],a[216:219],a[140:143]
M a[144:147],a[228:231],a[220:223],a[144:147]
M a[148:151],a[228:231],a[192:195],a[148:151]
M a[152:155],a[228:231],a[196:199],a[152:155]
M a[156:159],a[228:231],a[200:203],a[156:159]
s_waitcnt vmcnt(10)
buffer_load_dwordx4 a[228:231],v251,s[20:23],s47 offen offset:2048
M a[160:163],a[232:235],a[204:207],a[160:163]
ds_read_b128 a[204:207],v249 offset:11008
M a[164:167],a[232:235],a[208:211],a[164:167]
M a[168:171],a[232:235],a[212:215],a[168:171]
M a[172:175],a[232:235],a[216:219],a[172:175]
M a[176:179],a[232:235],a[220:223],a[176:179]
M a[180:183],a[232:235],a[192:195],a[180:183]
M a[184:187],a[232:235],a[196:199],a[184:187]
M a[188:191],a[232:235],a[200:203],a[188:191]
s_waitcnt vmcnt(10)
buffer_load_dwordx4 a[232:235],v251,s[20:23],s48 offen offset:2048
M a[96:99],a[236:239],a[208:211],a[96:99]
M a[100:103],a[236:239],a[212:215],a[100:103]
s_add_u32 s46,s80,36864
M a[104:107],a[236:239],a[216:219],a[104:107]
M a[108:111],a[236:239],a[220:223],a[108:111]
M a[112:115],a[236:239],a[192:195],a[112:115]
M a[116:119],a[236:239],a[196:199],a[116:119]
M a[120:123],a[236:239],a[200:203],a[120:123]
s_waitcnt lgkmcnt(0)
M a[124:127],a[236:239],a[204:207],a[124:127]
s_waitcnt vmcnt(10)
buffer_load_dwordx4 a[236:239],v251,s[20:23],s46 offen offset:0
M a[128:131],a[240:243],a[208:211],a[128:131]
M a[132:135],a[240:243],a[212:215],a[132:135]
s_barrier
ds_write2st64_b64 v247,v[198:199],v[200:201] offset0:34 offset1:51
M a[136:139],a[240:243],a[216:219],a[136:139]
s_add_u32 s47,s80,39936
buffer_load_dwordx2 v[198:199],v245,s[8:11],s28 offen offset:768
M a[140:143],a[240:243],a[220:223],a[140:143]
buffer_load_dwordx2 v[200:201],v245,s[8:11],s28 offen offset:1152
M a[144:147],a[240:243],a[192:195],a[144:147]
v_lshlrev_b32 v234,16,v208
v_lshlrev_b32 v232,16,v204
M a[148:151],a[240:243],a[196:199],a[148:151]
v_lshlrev_b32 v233,16,v206
v_lshlrev_b32 v237,16,v214
M a[152:155],a[240:243],a[200:203],a[152:155]
v_lshlrev_b32 v236,16,v212
v_lshlrev_b32 v235,16,v210
M a[156:159],a[240:243],a[204:207],a[156:159]
s_waitcnt vmcnt(12)
buffer_load_dwordx4 a[240:243],v251,s[20:23],s47 offen offset:0
M a[160:163],a[244:247],a[208:211],a[160:163]
ds_read_b128 a[208:211],v249 offset:17408
v_fmac_f32 v232,s43,v234
M a[164:167],a[244:247],a[212:215],a[164:167]
s_add_u32 s48,s80,43008
ds_read_b128 a[212:215],v250 offset:17664
v_fmac_f32 v237,4.0,v233
M a[168:171],a[244:247],a[216:219],a[168:171]
ds_read_b128 a[216:219],v250 offset:17920
v_fma_f32 v238,-4.0,v234,v236
M a[172:175],a[244:247],a[220:223],a[172:175]
ds_read_b128 a[220:223],v250 offset:18176
v_fmac_f32 v232,s45,v236
M a[176:179],a[244:247],a[192:195],a[176:179]
ds_read_b128 a[192:195],v250 offset:18432
v_fmac_f32 v237,s40,v235
M a[180:183],a[244:247],a[196:199],a[180:183]
ds_read_b128 a[196:199],v250 offset:18688
v_sub_f32 v236,v236,v234
M a[184:187],a[244:247],a[200:203],a[184:187]
ds_read_b128 a[200:203],v250 offset:18944
v_fma_f32 v234,-4.0,v233,v235
M a[188:191],a[244:247],a[204:207],a[188:191]
s_waitcnt vmcnt(12) lgkmcnt(6)
buffer_load_dwordx4 a[244:247],v251,s[20:23],s48 offen offset:0
M v[0:3],a[248:251],a[208:211],v[0:3]
s_waitcnt lgkmcnt(5)
ds_read_b128 a[204:207],v250 offset:19200
v_sub_f32 v235,v235,v233
M v[4:7],a[248:251],a[212:215],v[4:7]
s_waitcnt lgkmcnt(5)
v_add_f32 v233,v238,v234
v_sub_f32 v238,v238,v234
M v[8:11],a[248:251],a[216:219],v[8:11]
s_waitcnt lgkmcnt(4)
v_fma_f32 v234,2.0,v235,v236
v_fmac_f32 v236,-2.0,v235
M v[12:15],a[248:251],a[220:223],v[12:15]
s_waitcnt lgkmcnt(3)
v_and_b32 v208,s42,v208
v_and_b32 v204,s42,v204
M v[16:19],a[248:251],a[192:195],v[16:19]
s_waitcnt lgkmcnt(2)
v_and_b32 v206,s42,v206
v_and_b32 v214,s42,v214
M v[20:23],a[248:251],a[196:199],v[20:23]
s_waitcnt lgkmcnt(1)
v_and_b32 v212,s42,v212
v_and_b32 v210,s42,v210
M v[24:27],a[248:251],a[200:203],v[24:27]
s_waitcnt lgkmcnt(0)
v_fmac_f32 v204,s43,v208
v_fmac_f32 v214,4.0,v206
M v[28:31],a[248:251],a[204:207],v[28:31]
s_waitcnt vmcnt(12)
buffer_load_dwordx4 a[248:251],v251,s[20:23],s46 offen offset:1024
M v[32:35],a[252:255],a[208:211],v[32:35]
v_fma_f32 v235,-4.0,v208,v212
v_fmac_f32 v204,s45,v212
M v[36:39],a[252:255],a[212:215],v[36:39]
v_fmac_f32 v214,s40,v210
v_sub_f32 v212,v212,v208
M v[40:43],a[252:255],a[216:219],v[40:43]
v_fma_f32 v208,-4.0,v206,v210
v_sub_f32 v210,v210,v206
M v[44:47],a[252:255],a[220:223],v[44:47]
v_add_f32 v206,v235,v208
v_sub_f32 v235,v235,v208
M v[48:51],a[252:255],a[192:195],v[48:51]
v_fma_f32 v208,2.0,v210,v212
v_fmac_f32 v212,-2.0,v210
M v[52:55],a[252:255],a[196:199],v[52:55]
v_cvt_pk_bf16_f32 v204,v232,v204
v_cvt_pk_bf16_f32 v214,v237,v214
M v[56:59],a[252:255],a[200:203],v[56:59]
v_cvt_pk_bf16_f32 v206,v233,v206
v_cvt_pk_bf16_f32 v210,v234,v208
M v[60:63],a[252:255],a[204:207],v[60:63]
s_waitcnt vmcnt(12)
buffer_load_dwordx4 a[252:255],v251,s[20:23],s47 offen offset:1024
M v[64:67],v[216:219],a[208:211],v[64:67]
ds_read_b128 a[208:211],v250 offset:19456
v_cvt_pk_bf16_f32 v208,v238,v235
M v[68:71],v[216:219],a[212:215],v[68:71]
v_cvt_pk_bf16_f32 v212,v236,v212
v_lshlrev_b32 v234,16,v209
M v[72:75],v[216:219],a[216:219],v[72:75]
v_lshlrev_b32 v232,16,v205
v_lshlrev_b32 v233,16,v207
M v[76:79],v[216:219],a[220:223],v[76:79]
v_lshlrev_b32 v237,16,v215
v_lshlrev_b32 v236,16,v213
M v[80:83],v[216:219],a[192:195],v[80:83]
v_lshlrev_b32 v235,16,v211
v_fmac_f32 v232,s43,v234
M v[84:87],v[216:219],a[196:199],v[84:87]
v_fmac_f32 v237,4.0,v233
v_fma_f32 v238,-4.0,v234,v236
M v[88:91],v[216:219],a[200:203],v[88:91]
v_fmac_f32 v232,s45,v236
v_fmac_f32 v237,s40,v235
M v[92:95],v[216:219],a[204:207],v[92:95]
s_waitcnt vmcnt(12)
buffer_load_dwordx4 v[216:219],v251,s[20:23],s48 offen offset:1024
M v[0:3],v[220:223],a[212:215],v[0:3]
v_sub_f32 v236,v236,v234
v_fma_f32 v234,-4.0,v233,v235
M v[4:7],v[220:223],a[216:219],v[4:7]
v_sub_f32 v235,v235,v233
v_add_f32 v233,v238,v234
M v[8:11],v[220:223],a[220:223],v[8:11]
v_sub_f32 v238,v238,v234
v_fma_f32 v234,2.0,v235,v236
M v[12:15],v[220:223],a[192:195],v[12:15]
v_fmac_f32 v236,-2.0,v235
v_and_b32 v209,s42,v209
M v[16:19],v[220:223],a[196:199],v[16:19]
v_and_b32 v205,s42,v205
v_and_b32 v207,s42,v207
M v[20:23],v[220:223],a[200:203],v[20:23]
v_and_b32 v215,s42,v215
v_and_b32 v213,s42,v213
M v[24:27],v[220:223],a[204:207],v[24:27]
s_waitcnt lgkmcnt(0)
v_and_b32 v211,s42,v211
v_fmac_f32 v205,s43,v209
M v[28:31],v[220:223],a[208:211],v[28:31]
s_waitcnt vmcnt(12)
buffer_load_dwordx4 v[220:223],v251,s[20:23],s46 offen offset:2048
M v[32:35],v[224:227],a[212:215],v[32:35]
v_fmac_f32 v215,4.0,v207
v_fma_f32 v235,-4.0,v209,v213
M v[36:39],v[224:227],a[216:219],v[36:39]
v_fmac_f32 v205,s45,v213
v_fmac_f32 v215,s40,v211
M v[40:43],v[224:227],a[220:223],v[40:43]
v_sub_f32 v213,v213,v209
v_fma_f32 v209,-4.0,v207,v211
M v[44:47],v[224:227],a[192:195],v[44:47]
v_sub_f32 v211,v211,v207
v_add_f32 v207,v235,v209
M v[48:51],v[224:227],a[196:199],v[48:51]
v_sub_f32 v235,v235,v209
v_fma_f32 v209,2.0,v211,v213
M v[52:55],v[224:227],a[200:203],v[52:55]
v_fmac_f32 v213,-2.0,v211
v_cvt_pk_bf16_f32 v205,v232,v205
M v[56:59],v[224:227],a[204:207],v[56:59]
v_cvt_pk_bf16_f32 v215,v237,v215
v_cvt_pk_bf16_f32 v207,v233,v207
M v[60:63],v[224:227],a[208:211],v[60:63]
s_waitcnt vmcnt(12)
buffer_load_dwordx4 v[224:227],v251,s[20:23],s47 offen offset:2048
M v[64:67],v[228:231],a[212:215],v[64:67]
ds_read_b128 a[212:215],v249 offset:19712
v_cvt_pk_bf16_f32 v211,v234,v209
M v[68:71],v[228:231],a[216:219],v[68:71]
v_cvt_pk_bf16_f32 v209,v238,v235
v_cvt_pk_bf16_f32 v213,v236,v213
M v[72:75],v[228:231],a[220:223],v[72:75]
ds_write2st64_b64 v247,v[204:205],v[214:215] offset0:137 offset1:154
M v[76:79],v[228:231],a[192:195],v[76:79]
s_add_u32 s28,s69,1179648
buffer_load_dwordx2 v[204:205],v245,s[12:15],s28 offen offset:0
M v[80:83],v[228:231],a[196:199],v[80:83]
buffer_load_dwordx2 v[214:215],v245,s[16:19],s28 offen offset:1536
M v[84:87],v[228:231],a[200:203],v[84:87]
ds_write2st64_b64 v247,v[206:207],v[208:209] offset0:103 offset1:120
M v[88:91],v[228:231],a[204:207],v[88:91]
buffer_load_dwordx2 v[206:207],v245,s[8:11],s28 offen offset:0
M v[92:95],v[228:231],a[208:211],v[92:95]
s_waitcnt vmcnt(15)
buffer_load_dwordx2 v[208:209],v245,s[8:11],s28 offen offset:384
M v[0:3],a[224:227],a[216:219],v[0:3]
buffer_load_dwordx4 v[228:231],v251,s[20:23],s48 offen offset:2048
M v[4:7],a[224:227],a[220:223],v[4:7]
s_add_u32 s46,s81,9216
ds_write2st64_b64 v247,v[210:211],v[212:213] offset0:35 offset1:52
M v[8:11],a[224:227],a[192:195],v[8:11]
buffer_load_dwordx2 v[210:211],v245,s[8:11],s28 offen offset:768
M v[12:15],a[224:227],a[196:199],v[12:15]
buffer_load_dwordx2 v[212:213],v245,s[8:11],s28 offen offset:1152
M v[16:19],a[224:227],a[200:203],v[16:19]
v_fmac_f32 v239,s43,v241
v_fmac_f32 v244,4.0,v240
M v[20:23],a[224:227],a[204:207],v[20:23]
v_fma_f32 v232,-4.0,v241,v243
v_fmac_f32 v239,s45,v243
M v[24:27],a[224:227],a[208:211],v[24:27]
s_waitcnt lgkmcnt(3)
v_fmac_f32 v244,s40,v242
v_sub_f32 v243,v243,v241
M v[28:31],a[224:227],a[212:215],v[28:31]
s_waitcnt vmcnt(18)
buffer_load_dwordx4 a[224:227],v251,s[20:23],s46 offen offset:0
M v[32:35],a[228:231],a[216:219],v[32:35]
v_fma_f32 v241,-4.0,v240,v242
v_sub_f32 v242,v242,v240
M v[36:39],a[228:231],a[220:223],v[36:39]
v_add_f32 v240,v232,v241
v_sub_f32 v232,v232,v241
M v[40:43],a[228:231],a[192:195],v[40:43]
v_fma_f32 v241,2.0,v242,v243
v_fmac_f32 v243,-2.0,v242
M v[44:47],a[228:231],a[196:199],v[44:47]
v_cvt_pk_bf16_f32 v233,v239,v244
v_cvt_pk_bf16_f32 v234,v240,v232
M v[48:51],a[228:231],a[200:203],v[48:51]
v_cvt_pk_bf16_f32 v235,v241,v243
v_add_u32 v232,69632,v248
M v[52:55],a[228:231],a[204:207],v[52:55]
ds_write_b16 v232,v233 offset:0
M v[56:59],a[228:231],a[208:211],v[56:59]
ds_write_b16_d16_hi v232,v233 offset:8704
M v[60:63],a[228:231],a[212:215],v[60:63]
s_waitcnt vmcnt(18)
buffer_load_dwordx4 a[228:231],v251,s[20:23],s46 offen offset:1024
M v[64:67],a[232:235],a[216:219],v[64:67]
ds_read_b128 a[216:219],v249 offset:26112
ds_write_b16 v248,v234 offset:52224
M v[68:71],a[232:235],a[220:223],v[68:71]
ds_read_b128 a[220:223],v250 offset:26368
ds_write_b16_d16_hi v248,v234 offset:60928
M v[72:75],a[232:235],a[192:195],v[72:75]
ds_read_b128 a[192:195],v250 offset:26624
ds_write_b16 v248,v235 offset:17408
M v[76:79],a[232:235],a[196:199],v[76:79]
ds_read_b128 a[196:199],v250 offset:26880
ds_write_b16_d16_hi v248,v235 offset:26112
M v[80:83],a[232:235],a[200:203],v[80:83]
ds_read_b128 a[200:203],v250 offset:27136
v_bfe_u32 v232,v251,9,1
M v[84:87],a[232:235],a[204:207],v[84:87]
ds_read_b128 a[204:207],v250 offset:27392
v_mul_u32_u24 v232,33,v232
M v[88:91],a[232:235],a[208:211],v[88:91]
ds_read_b128 a[208:211],v250 offset:27648
v_add_u32 v232,s49,v232
M v[92:95],a[232:235],a[212:215],v[92:95]
s_waitcnt vmcnt(18) lgkmcnt(10)
buffer_load_dwordx4 a[232:235],v251,s[20:23],s46 offen offset:2048
M v[96:99],a[236:239],a[216:219],v[96:99]
s_waitcnt lgkmcnt(8)
ds_read_b128 a[212:215],v250 offset:27904
v_add_u32 v232,31,v232
M v[100:103],a[236:239],a[220:223],v[100:103]
s_waitcnt lgkmcnt(7)
s_add_u32 s46,s81,18432
v_mul_u32_u24 v233,196608,v232
v_cmp_gt_u32 vcc,512,v232
M v[104:107],a[236:239],a[192:195],v[104:107]
s_waitcnt lgkmcnt(5)
v_bfe_u32 v232,v251,3,6
v_add_u32 v233,v233,v232
M v[108:111],a[236:239],a[196:199],v[108:111]
s_waitcnt lgkmcnt(3)
v_bfrev_b32 v232,1
v_cndmask_b32 v246,v232,v233,vcc
M v[112:115],a[236:239],a[200:203],v[112:115]
s_waitcnt lgkmcnt(2)
buffer_load_short_d16_hi v239,v246,s[12:15],s70 offen offset:0
M v[116:119],a[236:239],a[204:207],v[116:119]
s_waitcnt lgkmcnt(1)
buffer_load_short_d16_hi v240,v246,s[8:11],s70 offen offset:0
M v[120:123],a[236:239],a[208:211],v[120:123]
s_waitcnt lgkmcnt(0)
buffer_load_short_d16_hi v241,v246,s[8:11],s70 offen offset:384
M v[124:127],a[236:239],a[212:215],v[124:127]
s_waitcnt vmcnt(19)
buffer_load_short_d16_hi v242,v246,s[8:11],s70 offen offset:768
M v[128:131],a[240:243],a[216:219],v[128:131]
buffer_load_short_d16_hi v243,v246,s[8:11],s70 offen offset:1152
M v[132:135],a[240:243],a[220:223],v[132:135]
buffer_load_short_d16_hi v244,v246,s[16:19],s70 offen offset:1536
v_lshlrev_b32 v234,16,v196
v_lshlrev_b32 v232,16,v192
v_lshlrev_b32 v233,16,v194
v_lshlrev_b32 v237,16,v202
M v[136:139],a[240:243],a[192:195],v[136:139]
buffer_load_dwordx4 a[236:239],v251,s[20:23],s46 offen offset:0
v_lshlrev_b32 v236,16,v200
v_lshlrev_b32 v235,16,v198
v_fmac_f32 v232,s43,v234
v_fmac_f32 v237,4.0,v233
M v[140:143],a[240:243],a[196:199],v[140:143]
v_fma_f32 v238,-4.0,v234,v236
v_fmac_f32 v232,s45,v236
v_fmac_f32 v237,s40,v235
v_sub_f32 v236,v236,v234
M v[144:147],a[240:243],a[200:203],v[144:147]
v_fma_f32 v234,-4.0,v233,v235
v_sub_f32 v235,v235,v233
v_add_f32 v233,v238,v234
v_sub_f32 v238,v238,v234
M v[148:151],a[240:243],a[204:207],v[148:151]
v_fma_f32 v234,2.0,v235,v236
v_fmac_f32 v236,-2.0,v235
v_and_b32 v196,s42,v196
v_and_b32 v192,s42,v192
M v[152:155],a[240:243],a[208:211],v[152:155]
v_and_b32 v194,s42,v194
v_and_b32 v202,s42,v202
v_and_b32 v200,s42,v200
v_and_b32 v198,s42,v198
M v[156:159],a[240:243],a[212:215],v[156:159]
s_waitcnt vmcnt(22)
buffer_load_dwordx4 a[240:243],v251,s[20:23],s46 offen offset:1024
v_fmac_f32 v192,s43,v196
v_fmac_f32 v202,4.0,v194
v_fma_f32 v235,-4.0,v196,v200
v_fmac_f32 v192,s45,v200
M v[160:163],a[244:247],a[216:219],v[160:163]
ds_read_b128 a[216:219],v250 offset:28160
v_fmac_f32 v202,s40,v198
v_sub_f32 v200,v200,v196
v_fma_f32 v196,-4.0,v194,v198
v_sub_f32 v198,v198,v194
M v[164:167],a[244:247],a[220:223],v[164:167]
v_add_f32 v194,v235,v196
v_sub_f32 v235,v235,v196
v_fma_f32 v196,2.0,v198,v200
v_fmac_f32 v200,-2.0,v198
M v[168:171],a[244:247],a[192:195],v[168:171]
v_cvt_pk_bf16_f32 v192,v232,v192
v_cvt_pk_bf16_f32 v202,v237,v202
v_cvt_pk_bf16_f32 v194,v233,v194
v_cvt_pk_bf16_f32 v198,v234,v196
M v[172:175],a[244:247],a[196:199],v[172:175]
v_cvt_pk_bf16_f32 v196,v238,v235
v_cvt_pk_bf16_f32 v200,v236,v200
v_lshlrev_b32 v234,16,v197
v_lshlrev_b32 v232,16,v193
M v[176:179],a[244:247],a[200:203],v[176:179]
v_lshlrev_b32 v233,16,v195
v_lshlrev_b32 v237,16,v203
v_lshlrev_b32 v236,16,v201
v_lshlrev_b32 v235,16,v199
M v[180:183],a[244:247],a[204:207],v[180:183]
v_fmac_f32 v232,s43,v234
v_fmac_f32 v237,4.0,v233
v_fma_f32 v238,-4.0,v234,v236
v_fmac_f32 v232,s45,v236
M v[184:187],a[244:247],a[208:211],v[184:187]
v_fmac_f32 v237,s40,v235
v_sub_f32 v236,v236,v234
v_fma_f32 v234,-4.0,v233,v235
v_sub_f32 v235,v235,v233
M v[188:191],a[244:247],a[212:215],v[188:191]
s_waitcnt vmcnt(22)
buffer_load_dwordx4 a[244:247],v251,s[20:23],s46 offen offset:2048
v_add_f32 v233,v238,v234
v_sub_f32 v238,v238,v234
v_fma_f32 v234,2.0,v235,v236
v_fmac_f32 v236,-2.0,v235
M v[96:99],a[248:251],a[220:223],v[96:99]
v_and_b32 v197,s42,v197
v_and_b32 v193,s42,v193
v_and_b32 v195,s42,v195
v_and_b32 v203,s42,v203
M v[100:103],a[248:251],a[192:195],v[100:103]
s_add_u32 s46,s81,27648
v_and_b32 v201,s42,v201
v_and_b32 v199,s42,v199
v_fmac_f32 v193,s43,v197
v_fmac_f32 v203,4.0,v195
M v[104:107],a[248:251],a[196:199],v[104:107]
v_fma_f32 v235,-4.0,v197,v201
v_fmac_f32 v193,s45,v201
v_fmac_f32 v203,s40,v199
v_sub_f32 v201,v201,v197
M v[108:111],a[248:251],a[200:203],v[108:111]
v_fma_f32 v197,-4.0,v195,v199
v_sub_f32 v199,v199,v195
v_add_f32 v195,v235,v197
v_sub_f32 v235,v235,v197
M v[112:115],a[248:251],a[204:207],v[112:115]
v_fma_f32 v197,2.0,v199,v201
v_fmac_f32 v201,-2.0,v199
v_cvt_pk_bf16_f32 v193,v232,v193
v_cvt_pk_bf16_f32 v203,v237,v203
M v[116:119],a[248:251],a[208:211],v[116:119]
v_cvt_pk_bf16_f32 v195,v233,v195
v_cvt_pk_bf16_f32 v199,v234,v197
v_cvt_pk_bf16_f32 v197,v238,v235
v_cvt_pk_bf16_f32 v201,v236,v201
M v[120:123],a[248:251],a[212:215],v[120:123]
s_waitcnt lgkmcnt(0)
ds_write2st64_b64 v247,v[192:193],v[202:203] offset0:138 offset1:155
M v[124:127],a[248:251],a[216:219],v[124:127]
s_waitcnt vmcnt(22)
s_add_u32 s28,s64,6291456
buffer_load_dwordx2 v[192:193],v245,s[12:15],s28 offen offset:0
ds_write2st64_b64 v247,v[194:195],v[196:197] offset0:104 offset1:121
M v[128:131],a[252:255],a[220:223],v[128:131]
buffer_load_dwordx2 v[202:203],v245,s[16:19],s28 offen offset:1536
M v[132:135],a[252:255],a[192:195],v[132:135]
buffer_load_dwordx2 v[194:195],v245,s[8:11],s28 offen offset:0
ds_write2st64_b64 v247,v[198:199],v[200:201] offset0:36 offset1:53
M v[136:139],a[252:255],a[196:199],v[136:139]
s_waitcnt vmcnt(18)
buffer_load_dwordx2 v[196:197],v245,s[8:11],s28 offen offset:384
v_lshlrev_b32 v234,16,v208
M v[140:143],a[252:255],a[200:203],v[140:143]
s_waitcnt vmcnt(16)
buffer_load_dwordx2 v[198:199],v245,s[8:11],s28 offen offset:768
v_lshlrev_b32 v232,16,v204
v_lshlrev_b32 v233,16,v206
v_lshlrev_b32 v237,16,v214
v_lshlrev_b32 v236,16,v212
M v[144:147],a[252:255],a[204:207],v[144:147]
buffer_load_dwordx2 v[200:201],v245,s[8:11],s28 offen offset:1152
v_lshlrev_b32 v235,16,v210
v_fmac_f32 v232,s43,v234
v_fmac_f32 v237,4.0,v233
v_fma_f32 v238,-4.0,v234,v236
M v[148:151],a[252:255],a[208:211],v[148:151]
buffer_load_dwordx4 a[248:251],v251,s[20:23],s46 offen offset:0
v_fmac_f32 v232,s45,v236
v_fmac_f32 v237,s40,v235
v_sub_f32 v236,v236,v234
v_fma_f32 v234,-4.0,v233,v235
M v[152:155],a[252:255],a[212:215],v[152:155]
v_sub_f32 v235,v235,v233
v_add_f32 v233,v238,v234
v_sub_f32 v238,v238,v234
v_fma_f32 v234,2.0,v235,v236
M v[156:159],a[252:255],a[216:219],v[156:159]
buffer_load_dwordx4 a[252:255],v251,s[20:23],s46 offen offset:1024
v_fmac_f32 v236,-2.0,v235
v_and_b32 v208,s42,v208
v_and_b32 v204,s42,v204
v_and_b32 v206,s42,v206
M v[160:163],v[216:219],a[220:223],v[160:163]
ds_read_b128 a[220:223],v249 offset:28416
v_and_b32 v214,s42,v214
v_and_b32 v212,s42,v212
v_and_b32 v210,s42,v210
v_fmac_f32 v204,s43,v208
M v[164:167],v[216:219],a[192:195],v[164:167]
v_fmac_f32 v214,4.0,v206
v_fma_f32 v235,-4.0,v208,v212
v_fmac_f32 v204,s45,v212
v_fmac_f32 v214,s40,v210
M v[168:171],v[216:219],a[196:199],v[168:171]
v_sub_f32 v212,v212,v208
v_fma_f32 v208,-4.0,v206,v210
v_sub_f32 v210,v210,v206
v_add_f32 v206,v235,v208
M v[172:175],v[216:219],a[200:203],v[172:175]
v_sub_f32 v235,v235,v208
v_fma_f32 v208,2.0,v210,v212
v_fmac_f32 v212,-2.0,v210
v_cvt_pk_bf16_f32 v204,v232,v204
M v[176:179],v[216:219],a[204:207],v[176:179]
v_cvt_pk_bf16_f32 v214,v237,v214
v_cvt_pk_bf16_f32 v206,v233,v206
v_cvt_pk_bf16_f32 v210,v234,v208
v_cvt_pk_bf16_f32 v208,v238,v235
M v[180:183],v[216:219],a[208:211],v[180:183]
v_cvt_pk_bf16_f32 v212,v236,v212
v_lshlrev_b32 v234,16,v209
v_lshlrev_b32 v232,16,v205
v_lshlrev_b32 v233,16,v207
M v[184:187],v[216:219],a[212:215],v[184:187]
v_lshlrev_b32 v237,16,v215
v_lshlrev_b32 v236,16,v213
v_lshlrev_b32 v235,16,v211
v_fmac_f32 v232,s43,v234
M v[188:191],v[216:219],a[216:219],v[188:191]
buffer_load_dwordx4 v[216:219],v251,s[20:23],s46 offen offset:2048
v_fmac_f32 v237,4.0,v233
v_fma_f32 v238,-4.0,v234,v236
v_fmac_f32 v232,s45,v236
v_fmac_f32 v237,s40,v235
M v[96:99],v[220:223],a[192:195],v[96:99]
v_sub_f32 v236,v236,v234
v_fma_f32 v234,-4.0,v233,v235
v_sub_f32 v235,v235,v233
v_add_f32 v233,v238,v234
M v[100:103],v[220:223],a[196:199],v[100:103]
s_add_u32 s46,s81,36864
v_sub_f32 v238,v238,v234
v_fma_f32 v234,2.0,v235,v236
v_fmac_f32 v236,-2.0,v235
v_and_b32 v209,s42,v209
M v[104:107],v[220:223],a[200:203],v[104:107]
v_and_b32 v205,s42,v205
v_and_b32 v207,s42,v207
v_and_b32 v215,s42,v215
v_and_b32 v213,s42,v213
M v[108:111],v[220:223],a[204:207],v[108:111]
v_and_b32 v211,s42,v211
v_fmac_f32 v205,s43,v209
v_fmac_f32 v215,4.0,v207
v_fma_f32 v235,-4.0,v209,v213
M v[112:115],v[220:223],a[208:211],v[112:115]
v_fmac_f32 v205,s45,v213
v_fmac_f32 v215,s40,v211
v_sub_f32 v213,v213,v209
v_fma_f32 v209,-4.0,v207,v211
M v[116:119],v[220:223],a[212:215],v[116:119]
v_sub_f32 v211,v211,v207
v_add_f32 v207,v235,v209
v_sub_f32 v235,v235,v209
v_fma_f32 v209,2.0,v211,v213
M v[120:123],v[220:223],a[216:219],v[120:123]
s_waitcnt lgkmcnt(0)
v_fmac_f32 v213,-2.0,v211
v_cvt_pk_bf16_f32 v205,v232,v205
v_cvt_pk_bf16_f32 v215,v237,v215
v_cvt_pk_bf16_f32 v207,v233,v207
M v[124:127],v[220:223],a[220:223],v[124:127]
buffer_load_dwordx4 v[220:223],v251,s[20:23],s46 offen offset:0
v_cvt_pk_bf16_f32 v211,v234,v209
v_cvt_pk_bf16_f32 v209,v238,v235
v_cvt_pk_bf16_f32 v213,v236,v213
M v[128:131],v[224:227],a[192:195],v[128:131]
ds_write2st64_b64 v247,v[204:205],v[214:215] offset0:139 offset1:156
M v[132:135],v[224:227],a[196:199],v[132:135]
s_add_u32 s28,s64,6684672
buffer_load_dwordx2 v[204:205],v245,s[12:15],s28 offen offset:0
ds_write2st64_b64 v247,v[206:207],v[208:209] offset0:105 offset1:122
M v[136:139],v[224:227],a[200:203],v[136:139]
buffer_load_dwordx2 v[214:215],v245,s[16:19],s28 offen offset:1536
M v[140:143],v[224:227],a[204:207],v[140:143]
buffer_load_dwordx2 v[206:207],v245,s[8:11],s28 offen offset:0
ds_write2st64_b64 v247,v[210:211],v[212:213] offset0:37 offset1:54
M v[144:147],v[224:227],a[208:211],v[144:147]
buffer_load_dwordx2 v[208:209],v245,s[8:11],s28 offen offset:384
M v[148:151],v[224:227],a[212:215],v[148:151]
buffer_load_dwordx2 v[210:211],v245,s[8:11],s28 offen offset:768
M v[152:155],v[224:227],a[216:219],v[152:155]
s_waitcnt lgkmcnt(0)
s_barrier
buffer_load_dwordx2 v[212:213],v245,s[8:11],s28 offen offset:1152
M v[156:159],v[224:227],a[220:223],v[156:159]
buffer_load_dwordx4 v[224:227],v251,s[20:23],s46 offen offset:1024
M v[160:163],v[228:231],a[192:195],v[160:163]
ds_read_b128 a[192:195],v249 offset:34816
M v[164:167],v[228:231],a[196:199],v[164:167]
ds_read_b128 a[196:199],v250 offset:35072
M v[168:171],v[228:231],a[200:203],v[168:171]
s_waitcnt vmcnt(13)
ds_read_b128 a[200:203],v250 offset:35328
v_lshlrev_b32 v234,16,v196
M v[172:175],v[228:231],a[204:207],v[172:175]
ds_read_b128 a[204:207],v250 offset:35584
v_lshlrev_b32 v232,16,v192
M v[176:179],v[228:231],a[208:211],v[176:179]
ds_read_b128 a[208:211],v250 offset:35840
v_lshlrev_b32 v233,16,v194
M v[180:183],v[228:231],a[212:215],v[180:183]
ds_read_b128 a[212:215],v250 offset:36096
v_lshlrev_b32 v237,16,v202
M v[184:187],v[228:231],a[216:219],v[184:187]
s_waitcnt vmcnt(11)
ds_read_b128 a[216:219],v250 offset:36352
v_lshlrev_b32 v236,16,v200
M v[188:191],v[228:231],a[220:223],v[188:191]
s_waitcnt lgkmcnt(6)
buffer_load_dwordx4 v[228:231],v251,s[20:23],s46 offen offset:2048
M a[0:3],a[224:227],a[192:195],a[0:3]
s_waitcnt lgkmcnt(5)
ds_read_b128 a[220:223],v250 offset:36608
ds_read_b128 a[192:195],v250 offset:36864
M a[4:7],a[224:227],a[196:199],a[4:7]
s_waitcnt lgkmcnt(6)
s_add_u32 s47,s81,12288
v_lshlrev_b32 v235,16,v198
v_fmac_f32 v232,s43,v234
M a[8:11],a[224:227],a[200:203],a[8:11]
s_waitcnt lgkmcnt(5)
v_fmac_f32 v237,4.0,v233
v_fma_f32 v238,-4.0,v234,v236
M a[12:15],a[224:227],a[204:207],a[12:15]
s_waitcnt lgkmcnt(4)
v_fmac_f32 v232,s45,v236
v_fmac_f32 v237,s40,v235
M a[16:19],a[224:227],a[208:211],a[16:19]
s_waitcnt lgkmcnt(3)
v_sub_f32 v236,v236,v234
v_fma_f32 v234,-4.0,v233,v235
M a[20:23],a[224:227],a[212:215],a[20:23]
s_waitcnt lgkmcnt(2)
v_sub_f32 v235,v235,v233
v_add_f32 v233,v238,v234
M a[24:27],a[224:227],a[216:219],a[24:27]
s_waitcnt lgkmcnt(1)
v_sub_f32 v238,v238,v234
v_fma_f32 v234,2.0,v235,v236
M a[28:31],a[224:227],a[220:223],a[28:31]
buffer_load_dwordx4 a[224:227],v251,s[20:23],s47 offen offset:0
M a[0:3],a[228:231],a[196:199],a[0:3]
ds_read_b128 a[196:199],v249 offset:37120
v_fmac_f32 v236,-2.0,v235
M a[4:7],a[228:231],a[200:203],a[4:7]
s_add_u32 s48,s81,15360
v_and_b32 v196,s42,v196
v_and_b32 v192,s42,v192
M a[8:11],a[228:231],a[204:207],a[8:11]
v_and_b32 v194,s42,v194
v_and_b32 v202,s42,v202
M a[12:15],a[228:231],a[208:211],a[12:15]
v_and_b32 v200,s42,v200
v_and_b32 v198,s42,v198
M a[16:19],a[228:231],a[212:215],a[16:19]
v_fmac_f32 v192,s43,v196
v_fmac_f32 v202,4.0,v194
M a[20:23],a[228:231],a[216:219],a[20:23]
v_fma_f32 v235,-4.0,v196,v200
v_fmac_f32 v192,s45,v200
M a[24:27],a[228:231],a[220:223],a[24:27]
s_waitcnt lgkmcnt(1)
v_fmac_f32 v202,s40,v198
v_sub_f32 v200,v200,v196
M a[28:31],a[228:231],a[192:195],a[28:31]
buffer_load_dwordx4 a[228:231],v251,s[20:23],s48 offen offset:0
M a[0:3],a[232:235],a[200:203],a[0:3]
ds_read_b128 a[200:203],v249 offset:43520
v_fma_f32 v196,-4.0,v194,v198
M a[4:7],a[232:235],a[204:207],a[4:7]
ds_read_b128 a[204:207],v250 offset:43776
v_sub_f32 v198,v198,v194
M a[8:11],a[232:235],a[208:211],a[8:11]
ds_read_b128 a[208:211],v250 offset:44032
v_add_f32 v194,v235,v196
M a[12:15],a[232:235],a[212:215],a[12:15]
ds_read_b128 a[212:215],v250 offset:44288
v_sub_f32 v235,v235,v196
M a[16:19],a[232:235],a[216:219],a[16:19]
ds_read_b128 a[216:219],v250 offset:44544
v_fma_f32 v196,2.0,v198,v200
M a[20:23],a[232:235],a[220:223],a[20:23]
ds_read_b128 a[220:223],v250 offset:44800
v_fmac_f32 v200,-2.0,v198
M a[24:27],a[232:235],a[192:195],a[24:27]
s_waitcnt lgkmcnt(6)
ds_read_b128 a[192:195],v250 offset:45056
v_cvt_pk_bf16_f32 v192,v232,v192
M a[28:31],a[232:235],a[196:199],a[28:31]
s_waitcnt lgkmcnt(6)
buffer_load_dwordx4 a[232:235],v251,s[20:23],s47 offen offset:1024
M a[96:99],a[236:239],a[200:203],a[96:99]
s_waitcnt lgkmcnt(5)
ds_read_b128 a[196:199],v250 offset:45312
ds_read_b128 a[200:203],v250 offset:45568
M a[100:103],a[236:239],a[204:207],a[100:103]
s_waitcnt lgkmcnt(6)
v_cvt_pk_bf16_f32 v202,v237,v202
v_cvt_pk_bf16_f32 v194,v233,v194
M a[104:107],a[236:239],a[208:211],a[104:107]
s_waitcnt lgkmcnt(5)
v_cvt_pk_bf16_f32 v198,v234,v196
v_cvt_pk_bf16_f32 v196,v238,v235
M a[108:111],a[236:239],a[212:215],a[108:111]
s_waitcnt lgkmcnt(4)
v_cvt_pk_bf16_f32 v200,v236,v200
v_lshlrev_b32 v234,16,v197
M a[112:115],a[236:239],a[216:219],a[112:115]
s_waitcnt lgkmcnt(3)
v_lshlrev_b32 v232,16,v193
v_lshlrev_b32 v233,16,v195
M a[116:119],a[236:239],a[220:223],a[116:119]
s_waitcnt lgkmcnt(2)
v_lshlrev_b32 v237,16,v203
v_lshlrev_b32 v236,16,v201
M a[120:123],a[236:239],a[192:195],a[120:123]
s_waitcnt lgkmcnt(1)
v_lshlrev_b32 v235,16,v199
v_fmac_f32 v232,s43,v234
M a[124:127],a[236:239],a[196:199],a[124:127]
buffer_load_dwordx4 a[236:239],v251,s[20:23],s48 offen offset:1024
M a[96:99],a[240:243],a[204:207],a[96:99]
ds_read_b128 a[204:207],v249 offset:45824
v_fmac_f32 v237,4.0,v233
M a[100:103],a[240:243],a[208:211],a[100:103]
v_fma_f32 v238,-4.0,v234,v236
v_fmac_f32 v232,s45,v236
M a[104:107],a[240:243],a[212:215],a[104:107]
v_fmac_f32 v237,s40,v235
v_sub_f32 v236,v236,v234
M a[108:111],a[240:243],a[216:219],a[108:111]
v_fma_f32 v234,-4.0,v233,v235
v_sub_f32 v235,v235,v233
M a[112:115],a[240:243],a[220:223],a[112:115]
v_add_f32 v233,v238,v234
v_sub_f32 v238,v238,v234
M a[116:119],a[240:243],a[192:195],a[116:119]
v_fma_f32 v234,2.0,v235,v236
v_fmac_f32 v236,-2.0,v235
M a[120:123],a[240:243],a[196:199],a[120:123]
s_waitcnt lgkmcnt(1)
v_and_b32 v197,s42,v197
v_and_b32 v193,s42,v193
M a[124:127],a[240:243],a[200:203],a[124:127]
buffer_load_dwordx4 a[240:243],v251,s[20:23],s47 offen offset:2048
M a[96:99],a[244:247],a[208:211],a[96:99]
ds_read_b128 a[208:211],v249 offset:0
v_and_b32 v195,s42,v195
M a[100:103],a[244:247],a[212:215],a[100:103]
ds_read_b128 a[212:215],v250 offset:256
v_and_b32 v203,s42,v203
M a[104:107],a[244:247],a[216:219],a[104:107]
ds_read_b128 a[216:219],v250 offset:512
v_and_b32 v201,s42,v201
M a[108:111],a[244:247],a[220:223],a[108:111]
ds_read_b128 a[220:223],v250 offset:768
v_and_b32 v199,s42,v199
M a[112:115],a[244:247],a[192:195],a[112:115]
ds_read_b128 a[192:195],v250 offset:1024
v_fmac_f32 v193,s43,v197
M a[116:119],a[244:247],a[196:199],a[116:119]
ds_read_b128 a[196:199],v250 offset:1280
v_fmac_f32 v203,4.0,v195
M a[120:123],a[244:247],a[200:203],a[120:123]
s_waitcnt lgkmcnt(6)
ds_read_b128 a[200:203],v250 offset:1536
v_fma_f32 v235,-4.0,v197,v201
M a[124:127],a[244:247],a[204:207],a[124:127]
s_waitcnt vmcnt(16) lgkmcnt(6)
buffer_load_dwordx4 a[244:247],v251,s[20:23],s48 offen offset:2048
M v[0:3],a[248:251],a[208:211],v[0:3]
s_waitcnt lgkmcnt(5)
ds_read_b128 a[204:207],v250 offset:1792
ds_read_b128 a[208:211],v250 offset:2048
M v[4:7],a[248:251],a[212:215],v[4:7]
s_waitcnt lgkmcnt(6)
s_add_u32 s47,s81,21504
v_fmac_f32 v193,s45,v201
v_fmac_f32 v203,s40,v199
M v[8:11],a[248:251],a[216:219],v[8:11]
s_waitcnt lgkmcnt(5)
v_sub_f32 v201,v201,v197
v_fma_f32 v197,-4.0,v195,v199
M v[12:15],a[248:251],a[220:223],v[12:15]
s_waitcnt lgkmcnt(4)
v_sub_f32 v199,v199,v195
v_add_f32 v195,v235,v197
M v[16:19],a[248:251],a[192:195],v[16:19]
s_waitcnt lgkmcnt(3)
v_sub_f32 v235,v235,v197
v_fma_f32 v197,2.0,v199,v201
M v[20:23],a[248:251],a[196:199],v[20:23]
s_waitcnt lgkmcnt(2)
v_fmac_f32 v201,-2.0,v199
v_cvt_pk_bf16_f32 v193,v232,v193
M v[24:27],a[248:251],a[200:203],v[24:27]
s_waitcnt lgkmcnt(1)
v_cvt_pk_bf16_f32 v203,v237,v203
v_cvt_pk_bf16_f32 v195,v233,v195
M v[28:31],a[248:251],a[204:207],v[28:31]
s_waitcnt vmcnt(16)
buffer_load_dwordx4 a[248:251],v251,s[20:23],s47 offen offset:0
M v[0:3],a[252:255],a[212:215],v[0:3]
ds_read_b128 a[212:215],v249 offset:2304
v_cvt_pk_bf16_f32 v199,v234,v197
M v[4:7],a[252:255],a[216:219],v[4:7]
s_add_u32 s48,s81,24576
v_cvt_pk_bf16_f32 v197,v238,v235
v_cvt_pk_bf16_f32 v201,v236,v201
M v[8:11],a[252:255],a[220:223],v[8:11]
M v[12:15],a[252:255],a[192:195],v[12:15]
M v[16:19],a[252:255],a[196:199],v[16:19]
M v[20:23],a[252:255],a[200:203],v[20:23]
M v[24:27],a[252:255],a[204:207],v[24:27]
s_waitcnt lgkmcnt(1)
M v[28:31],a[252:255],a[208:211],v[28:31]
s_waitcnt vmcnt(16)
buffer_load_dwordx4 a[252:255],v251,s[20:23],s48 offen offset:0
M v[0:3],v[216:219],a[216:219],v[0:3]
ds_read_b128 a[216:219],v249 offset:8704
M v[4:7],v[216:219],a[220:223],v[4:7]
ds_read_b128 a[220:223],v250 offset:8960
M v[8:11],v[216:219],a[192:195],v[8:11]
ds_read_b128 a[192:195],v250 offset:9216
M v[12:15],v[216:219],a[196:199],v[12:15]
ds_read_b128 a[196:199],v250 offset:9472
M v[16:19],v[216:219],a[200:203],v[16:19]
ds_read_b128 a[200:203],v250 offset:9728
M v[20:23],v[216:219],a[204:207],v[20:23]
ds_read_b128 a[204:207],v250 offset:9984
M v[24:27],v[216:219],a[208:211],v[24:27]
s_waitcnt lgkmcnt(6)
ds_read_b128 a[208:211],v250 offset:10240
M v[28:31],v[216:219],a[212:215],v[28:31]
s_waitcnt vmcnt(16) lgkmcnt(6)
buffer_load_dwordx4 v[216:219],v251,s[20:23],s47 offen offset:1024
M v[96:99],v[220:223],a[216:219],v[96:99]
s_waitcnt lgkmcnt(5)
ds_read_b128 a[212:215],v250 offset:10496
ds_read_b128 a[216:219],v250 offset:10752
M v[100:103],v[220:223],a[220:223],v[100:103]
s_waitcnt lgkmcnt(6)
M v[104:107],v[220:223],a[192:195],v[104:107]
s_waitcnt lgkmcnt(5)
M v[108:111],v[220:223],a[196:199],v[108:111]
s_waitcnt lgkmcnt(4)
M v[112:115],v[220:223],a[200:203],v[112:115]
s_waitcnt lgkmcnt(3)
M v[116:119],v[220:223],a[204:207],v[116:119]
s_waitcnt lgkmcnt(2)
M v[120:123],v[220:223],a[208:211],v[120:123]
s_waitcnt lgkmcnt(1)
M v[124:127],v[220:223],a[212:215],v[124:127]
s_waitcnt vmcnt(10)
buffer_load_dwordx4 v[220:223],v251,s[20:23],s48 offen offset:1024
M v[96:99],v[224:227],a[220:223],v[96:99]
ds_read_b128 a[220:223],v249 offset:11008
M v[100:103],v[224:227],a[192:195],v[100:103]
M v[104:107],v[224:227],a[196:199],v[104:107]
M v[108:111],v[224:227],a[200:203],v[108:111]
M v[112:115],v[224:227],a[204:207],v[112:115]
M v[116:119],v[224:227],a[208:211],v[116:119]
M v[120:123],v[224:227],a[212:215],v[120:123]
s_waitcnt lgkmcnt(1)
M v[124:127],v[224:227],a[216:219],v[124:127]
s_waitcnt vmcnt(10)
buffer_load_dwordx4 v[224:227],v251,s[20:23],s47 offen offset:2048
M v[96:99],v[228:231],a[192:195],v[96:99]
ds_read_b128 a[192:195],v249 offset:34816
M v[100:103],v[228:231],a[196:199],v[100:103]
ds_read_b128 a[196:199],v250 offset:35072
M v[104:107],v[228:231],a[200:203],v[104:107]
ds_read_b128 a[200:203],v250 offset:35328
M v[108:111],v[228:231],a[204:207],v[108:111]
ds_read_b128 a[204:207],v250 offset:35584
v_accvgpr_read_b32 v238,a0
M v[112:115],v[228:231],a[208:211],v[112:115]
ds_read_b128 a[208:211],v250 offset:35840
v_accvgpr_read_b32 v232,a96
M v[116:119],v[228:231],a[212:215],v[116:119]
ds_read_b128 a[212:215],v250 offset:36096
v_add_f32 v234,v238,v232
M v[120:123],v[228:231],a[216:219],v[120:123]
s_waitcnt lgkmcnt(6)
ds_read_b128 a[216:219],v250 offset:36352
v_sub_f32 v238,v238,v232
M v[124:127],v[228:231],a[220:223],v[124:127]
s_waitcnt vmcnt(10) lgkmcnt(6)
buffer_load_dwordx4 v[228:231],v251,s[20:23],s48 offen offset:2048
M a[32:35],a[224:227],a[192:195],a[32:35]
s_waitcnt lgkmcnt(5)
ds_read_b128 a[220:223],v250 offset:36608
v_add_f32 v232,v0,v96
M a[36:39],a[224:227],a[196:199],a[36:39]
s_waitcnt lgkmcnt(5)
s_add_u32 s47,s81,30720
v_sub_f32 v96,v0,v96
v_add_f32 v0,v234,v232
M a[40:43],a[224:227],a[200:203],a[40:43]
s_waitcnt lgkmcnt(4)
v_fmac_f32 v234,4.0,v232
v_fma_f32 v232,2.0,v96,v238
M a[44:47],a[224:227],a[204:207],a[44:47]
s_waitcnt lgkmcnt(3)
v_fma_f32 v96,s41,v96,v238
v_accvgpr_read_b32 v238,a1
M a[48:51],a[224:227],a[208:211],a[48:51]
s_waitcnt lgkmcnt(2)
v_accvgpr_read_b32 v237,a97
v_add_f32 v236,v238,v237
M a[52:55],a[224:227],a[212:215],a[52:55]
s_waitcnt lgkmcnt(1)
v_sub_f32 v238,v238,v237
v_add_f32 v237,v1,v97
M a[56:59],a[224:227],a[216:219],a[56:59]
s_waitcnt lgkmcnt(0)
v_sub_f32 v97,v1,v97
v_add_f32 v1,v236,v237
M a[60:63],a[224:227],a[220:223],a[60:63]
s_waitcnt vmcnt(10)
buffer_load_dwordx4 a[224:227],v251,s[20:23],s47 offen offset:0
M a[64:67],a[228:231],a[192:195],a[64:67]
ds_read_b128 a[192:195],v250 offset:36864
v_fmac_f32 v236,4.0,v237
M a[68:71],a[228:231],a[196:199],a[68:71]
s_add_u32 s48,s81,33792
v_fma_f32 v237,2.0,v97,v238
v_fma_f32 v97,s41,v97,v238
M a[72:75],a[228:231],a[200:203],a[72:75]
v_cvt_pk_bf16_f32 v232,v232,v237
v_cvt_pk_bf16_f32 v234,v234,v236
M a[76:79],a[228:231],a[204:207],a[76:79]
v_accvgpr_read_b32 v238,a2
v_accvgpr_read_b32 v233,a98
M a[80:83],a[228:231],a[208:211],a[80:83]
v_add_f32 v235,v238,v233
v_sub_f32 v238,v238,v233
M a[84:87],a[228:231],a[212:215],a[84:87]
v_add_f32 v233,v2,v98
v_sub_f32 v98,v2,v98
M a[88:91],a[228:231],a[216:219],a[88:91]
v_add_f32 v2,v235,v233
v_fmac_f32 v235,4.0,v233
M a[92:95],a[228:231],a[220:223],a[92:95]
s_waitcnt vmcnt(10)
buffer_load_dwordx4 a[228:231],v251,s[20:23],s48 offen offset:0
M a[32:35],a[232:235],a[196:199],a[32:35]
v_fma_f32 v233,2.0,v98,v238
v_fma_f32 v98,s41,v98,v238
M a[36:39],a[232:235],a[200:203],a[36:39]
v_accvgpr_read_b32 v238,a3
v_accvgpr_read_b32 v237,a99
M a[40:43],a[232:235],a[204:207],a[40:43]
v_add_f32 v236,v238,v237
v_sub_f32 v238,v238,v237
M a[44:47],a[232:235],a[208:211],a[44:47]
v_add_f32 v237,v3,v99
v_sub_f32 v99,v3,v99
M a[48:51],a[232:235],a[212:215],a[48:51]
v_add_f32 v3,v236,v237
v_fmac_f32 v236,4.0,v237
M a[52:55],a[232:235],a[216:219],a[52:55]
v_fma_f32 v237,2.0,v99,v238
v_fma_f32 v99,s41,v99,v238
M a[56:59],a[232:235],a[220:223],a[56:59]
s_waitcnt lgkmcnt(0)
v_cvt_pk_bf16_f32 v233,v233,v237
v_cvt_pk_bf16_f32 v235,v235,v236
M a[60:63],a[232:235],a[192:195],a[60:63]
s_waitcnt vmcnt(10)
buffer_load_dwordx4 a[232:235],v251,s[20:23],s47 offen offset:1024
M a[64:67],a[236:239],a[196:199],a[64:67]
ds_read_b128 a[196:199],v249 offset:37120
ds_write2st64_b64 v253,v[232:233],v[234:235] offset0:68 offset1:72
M a[68:71],a[236:239],a[200:203],a[68:71]
v_accvgpr_read_b32 v238,a4
v_accvgpr_read_b32 v232,a100
M a[72:75],a[236:239],a[204:207],a[72:75]
v_add_f32 v234,v238,v232
v_sub_f32 v238,v238,v232
M a[76:79],a[236:239],a[208:211],a[76:79]
v_add_f32 v232,v4,v100
v_sub_f32 v100,v4,v100
M a[80:83],a[236:239],a[212:215],a[80:83]
v_add_f32 v4,v234,v232
v_fmac_f32 v234,4.0,v232
M a[84:87],a[236:239],a[216:219],a[84:87]
v_fma_f32 v232,2.0,v100,v238
v_fma_f32 v100,s41,v100,v238
M a[88:91],a[236:239],a[220:223],a[88:91]
v_accvgpr_read_b32 v238,a5
v_accvgpr_read_b32 v237,a101
M a[92:95],a[236:239],a[192:195],a[92:95]
s_waitcnt vmcnt(10)
buffer_load_dwordx4 a[236:239],v251,s[20:23],s48 offen offset:1024
M a[32:35],a[240:243],a[200:203],a[32:35]
v_add_f32 v236,v238,v237
v_sub_f32 v238,v238,v237
M a[36:39],a[240:243],a[204:207],a[36:39]
v_add_f32 v237,v5,v101
v_sub_f32 v101,v5,v101
M a[40:43],a[240:243],a[208:211],a[40:43]
v_add_f32 v5,v236,v237
v_fmac_f32 v236,4.0,v237
M a[44:47],a[240:243],a[212:215],a[44:47]
v_fma_f32 v237,2.0,v101,v238
v_fma_f32 v101,s41,v101,v238
M a[48:51],a[240:243],a[216:219],a[48:51]
v_cvt_pk_bf16_f32 v232,v232,v237
v_cvt_pk_bf16_f32 v234,v234,v236
M a[52:55],a[240:243],a[220:223],a[52:55]
v_accvgpr_read_b32 v238,a6
v_accvgpr_read_b32 v233,a102
M a[56:59],a[240:243],a[192:195],a[56:59]
s_waitcnt lgkmcnt(1)
v_add_f32 v235,v238,v233
v_sub_f32 v238,v238,v233
M a[60:63],a[240:243],a[196:199],a[60:63]
s_waitcnt vmcnt(10)
buffer_load_dwordx4 a[240:243],v251,s[20:23],s47 offen offset:2048
M a[64:67],a[244:247],a[200:203],a[64:67]
ds_read_b128 a[200:203],v249 offset:43520
v_add_f32 v233,v6,v102
M a[68:71],a[244:247],a[204:207],a[68:71]
ds_read_b128 a[204:207],v250 offset:43776
v_sub_f32 v102,v6,v102
M a[72:75],a[244:247],a[208:211],a[72:75]
ds_read_b128 a[208:211],v250 offset:44032
v_add_f32 v6,v235,v233
M a[76:79],a[244:247],a[212:215],a[76:79]
ds_read_b128 a[212:215],v250 offset:44288
v_fmac_f32 v235,4.0,v233
M a[80:83],a[244:247],a[216:219],a[80:83]
ds_read_b128 a[216:219],v250 offset:44544
v_fma_f32 v233,2.0,v102,v238
M a[84:87],a[244:247],a[220:223],a[84:87]
ds_read_b128 a[220:223],v250 offset:44800
v_fma_f32 v102,s41,v102,v238
M a[88:91],a[244:247],a[192:195],a[88:91]
ds_read_b128 a[192:195],v250 offset:45056
v_accvgpr_read_b32 v238,a7
M a[92:95],a[244:247],a[196:199],a[92:95]
s_waitcnt vmcnt(10) lgkmcnt(6)
buffer_load_dwordx4 a[244:247],v251,s[20:23],s48 offen offset:2048
M a[128:131],a[248:251],a[200:203],a[128:131]
s_waitcnt lgkmcnt(5)
ds_read_b128 a[196:199],v250 offset:45312
v_accvgpr_read_b32 v237,a103
M a[132:135],a[248:251],a[204:207],a[132:135]
s_waitcnt lgkmcnt(5)
s_add_u32 s47,s81,39936
v_add_f32 v236,v238,v237
v_sub_f32 v238,v238,v237
M a[136:139],a[248:251],a[208:211],a[136:139]
s_waitcnt lgkmcnt(4)
v_add_f32 v237,v7,v103
v_sub_f32 v103,v7,v103
M a[140:143],a[248:251],a[212:215],a[140:143]
s_waitcnt lgkmcnt(3)
v_add_f32 v7,v236,v237
v_fmac_f32 v236,4.0,v237
M a[144:147],a[248:251],a[216:219],a[144:147]
s_waitcnt lgkmcnt(2)
v_fma_f32 v237,2.0,v103,v238
v_fma_f32 v103,s41,v103,v238
M a[148:151],a[248:251],a[220:223],a[148:151]
s_waitcnt lgkmcnt(1)
v_cvt_pk_bf16_f32 v233,v233,v237
v_cvt_pk_bf16_f32 v235,v235,v236
M a[152:155],a[248:251],a[192:195],a[152:155]
s_waitcnt lgkmcnt(0)
ds_write2st64_b64 v253,v[232:233],v[234:235] offset0:76 offset1:80
M a[156:159],a[248:251],a[196:199],a[156:159]
s_waitcnt vmcnt(10)
buffer_load_dwordx4 a[248:251],v251,s[20:23],s47 offen offset:0
M a[160:163],a[252:255],a[200:203],a[160:163]
ds_read_b128 a[200:203],v250 offset:45568
v_accvgpr_read_b32 v238,a8
M a[164:167],a[252:255],a[204:207],a[164:167]
s_add_u32 s48,s81,43008
v_accvgpr_read_b32 v232,a104
v_add_f32 v234,v238,v232
M a[168:171],a[252:255],a[208:211],a[168:171]
v_sub_f32 v238,v238,v232
v_add_f32 v232,v8,v104
M a[172:175],a[252:255],a[212:215],a[172:175]
v_sub_f32 v104,v8,v104
M a[176:179],a[252:255],a[216:219],a[176:179]
s_waitcnt lgkmcnt(1)
s_barrier
ds_read_b128 a[0:3],v251 offset:34816
M a[180:183],a[252:255],a[220:223],a[180:183]
ds_read_b128 a[4:7],v251 offset:38912
v_add_f32 v8,v234,v232
M a[184:187],a[252:255],a[192:195],a[184:187]
v_fmac_f32 v234,4.0,v232
v_fma_f32 v232,2.0,v104,v238
M a[188:191],a[252:255],a[196:199],a[188:191]
s_waitcnt vmcnt(10)
buffer_load_dwordx4 a[252:255],v251,s[20:23],s48 offen offset:0
M a[128:131],v[216:219],a[204:207],a[128:131]
v_fma_f32 v104,s41,v104,v238
v_accvgpr_read_b32 v238,a9
M a[132:135],v[216:219],a[208:211],a[132:135]
s_waitcnt lgkmcnt(1)
s_add_u32 s34,s32,0
buffer_store_dwordx4 a[0:3],v252,s[24:27],s34 offen offset:384 nt
M a[136:139],v[216:219],a[212:215],a[136:139]
v_accvgpr_read_b32 v237,a105
v_add_f32 v236,v238,v237
M a[140:143],v[216:219],a[216:219],a[140:143]
v_sub_f32 v238,v238,v237
v_add_f32 v237,v9,v105
M a[144:147],v[216:219],a[220:223],a[144:147]
v_sub_f32 v105,v9,v105
v_add_f32 v9,v236,v237
M a[148:151],v[216:219],a[192:195],a[148:151]
v_fmac_f32 v236,4.0,v237
v_fma_f32 v237,2.0,v105,v238
M a[152:155],v[216:219],a[196:199],a[152:155]
v_fma_f32 v105,s41,v105,v238
v_cvt_pk_bf16_f32 v232,v232,v237
M a[156:159],v[216:219],a[200:203],a[156:159]
s_waitcnt vmcnt(11)
buffer_load_dwordx4 v[216:219],v251,s[20:23],s47 offen offset:1024
M a[160:163],v[220:223],a[204:207],a[160:163]
ds_read_b128 a[204:207],v249 offset:45824
v_cvt_pk_bf16_f32 v234,v234,v236
M a[164:167],v[220:223],a[208:211],a[164:167]
v_accvgpr_read_b32 v238,a10
v_accvgpr_read_b32 v233,a106
M a[168:171],v[220:223],a[212:215],a[168:171]
v_add_f32 v235,v238,v233
v_sub_f32 v238,v238,v233
M a[172:175],v[220:223],a[216:219],a[172:175]
v_add_f32 v233,v10,v106
v_sub_f32 v106,v10,v106
M a[176:179],v[220:223],a[220:223],a[176:179]
v_add_f32 v10,v235,v233
v_fmac_f32 v235,4.0,v233
M a[180:183],v[220:223],a[192:195],a[180:183]
v_fma_f32 v233,2.0,v106,v238
v_fma_f32 v106,s41,v106,v238
M a[184:187],v[220:223],a[196:199],a[184:187]
v_accvgpr_read_b32 v238,a11
v_accvgpr_read_b32 v237,a107
M a[188:191],v[220:223],a[200:203],a[188:191]
s_waitcnt vmcnt(11)
s_add_u32 s34,s32,196608
buffer_load_dwordx4 v[220:223],v251,s[20:23],s48 offen offset:1024
M a[128:131],v[224:227],a[208:211],a[128:131]
s_waitcnt lgkmcnt(1)
buffer_store_dwordx4 a[4:7],v252,s[24:27],s34 offen offset:384 nt
M a[132:135],v[224:227],a[212:215],a[132:135]
v_add_f32 v236,v238,v237
v_sub_f32 v238,v238,v237
M a[136:139],v[224:227],a[216:219],a[136:139]
v_add_f32 v237,v11,v107
v_sub_f32 v107,v11,v107
M a[140:143],v[224:227],a[220:223],a[140:143]
v_add_f32 v11,v236,v237
v_fmac_f32 v236,4.0,v237
M a[144:147],v[224:227],a[192:195],a[144:147]
v_fma_f32 v237,2.0,v107,v238
v_fma_f32 v107,s41,v107,v238
M a[148:151],v[224:227],a[196:199],a[148:151]
v_cvt_pk_bf16_f32 v233,v233,v237
v_cvt_pk_bf16_f32 v235,v235,v236
M a[152:155],v[224:227],a[200:203],a[152:155]
s_waitcnt lgkmcnt(0)
ds_write2st64_b64 v253,v[232:233],v[234:235] offset0:85 offset1:89
M a[156:159],v[224:227],a[204:207],a[156:159]
s_waitcnt vmcnt(12)
buffer_load_dwordx4 v[224:227],v251,s[20:23],s47 offen offset:2048
M a[160:163],v[228:231],a[208:211],a[160:163]
ds_read_b128 a[208:211],v249 offset:0
v_accvgpr_read_b32 v238,a12
M a[164:167],v[228:231],a[212:215],a[164:167]
ds_read_b128 a[212:215],v250 offset:256
v_accvgpr_read_b32 v232,a108
M a[168:171],v[228:231],a[216:219],a[168:171]
ds_read_b128 a[216:219],v250 offset:512
v_add_f32 v234,v238,v232
M a[172:175],v[228:231],a[220:223],a[172:175]
ds_read_b128 a[220:223],v250 offset:768
v_sub_f32 v238,v238,v232
M a[176:179],v[228:231],a[192:195],a[176:179]
ds_read_b128 a[192:195],v250 offset:1024
v_add_f32 v232,v12,v108
M a[180:183],v[228:231],a[196:199],a[180:183]
ds_read_b128 a[196:199],v250 offset:1280
v_sub_f32 v108,v12,v108
M a[184:187],v[228:231],a[200:203],a[184:187]
ds_read_b128 a[200:203],v250 offset:1536
v_add_f32 v12,v234,v232
M a[188:191],v[228:231],a[204:207],a[188:191]
s_waitcnt vmcnt(12) lgkmcnt(6)
buffer_load_dwordx4 v[228:231],v251,s[20:23],s48 offen offset:2048
M v[32:35],a[224:227],a[208:211],v[32:35]
s_waitcnt lgkmcnt(5)
ds_read_b128 a[204:207],v250 offset:1792
v_fmac_f32 v234,4.0,v232
M v[36:39],a[224:227],a[212:215],v[36:39]
s_waitcnt lgkmcnt(5)
s_add_u32 s46,s76,0
v_fma_f32 v232,2.0,v108,v238
v_fma_f32 v108,s41,v108,v238
M v[40:43],a[224:227],a[216:219],v[40:43]
s_waitcnt lgkmcnt(4)
v_accvgpr_read_b32 v238,a13
v_accvgpr_read_b32 v237,a109
M v[44:47],a[224:227],a[220:223],v[44:47]
s_waitcnt lgkmcnt(3)
v_add_f32 v236,v238,v237
v_sub_f32 v238,v238,v237
M v[48:51],a[224:227],a[192:195],v[48:51]
s_waitcnt lgkmcnt(2)
v_add_f32 v237,v13,v109
v_sub_f32 v109,v13,v109
M v[52:55],a[224:227],a[196:199],v[52:55]
s_waitcnt lgkmcnt(1)
v_add_f32 v13,v236,v237
v_fmac_f32 v236,4.0,v237
M v[56:59],a[224:227],a[200:203],v[56:59]
s_waitcnt lgkmcnt(0)
v_fma_f32 v237,2.0,v109,v238
v_fma_f32 v109,s41,v109,v238
M v[60:63],a[224:227],a[204:207],v[60:63]
s_waitcnt vmcnt(12)
buffer_load_dwordx4 a[224:227],v251,s[20:23],s46 offen offset:0
M v[64:67],a[228:231],a[208:211],v[64:67]
ds_read_b128 a[208:211],v250 offset:2048
v_cvt_pk_bf16_f32 v232,v232,v237
M v[68:71],a[228:231],a[212:215],v[68:71]
v_cvt_pk_bf16_f32 v234,v234,v236
v_accvgpr_read_b32 v238,a14
M v[72:75],a[228:231],a[216:219],v[72:75]
v_accvgpr_read_b32 v233,a110
v_add_f32 v235,v238,v233
M v[76:79],a[228:231],a[220:223],v[76:79]
v_sub_f32 v238,v238,v233
v_add_f32 v233,v14,v110
M v[80:83],a[228:231],a[192:195],v[80:83]
v_sub_f32 v110,v14,v110
v_add_f32 v14,v235,v233
M v[84:87],a[228:231],a[196:199],v[84:87]
v_fmac_f32 v235,4.0,v233
v_fma_f32 v233,2.0,v110,v238
M v[88:91],a[228:231],a[200:203],v[88:91]
v_fma_f32 v110,s41,v110,v238
v_accvgpr_read_b32 v238,a15
M v[92:95],a[228:231],a[204:207],v[92:95]
s_waitcnt vmcnt(12)
buffer_load_dwordx4 a[228:231],v251,s[20:23],s46 offen offset:1024
M v[32:35],a[232:235],a[212:215],v[32:35]
v_accvgpr_read_b32 v237,a111
v_add_f32 v236,v238,v237
M v[36:39],a[232:235],a[216:219],v[36:39]
v_sub_f32 v238,v238,v237
v_add_f32 v237,v15,v111
M v[40:43],a[232:235],a[220:223],v[40:43]
v_sub_f32 v111,v15,v111
v_add_f32 v15,v236,v237
M v[44:47],a[232:235],a[192:195],v[44:47]
v_fmac_f32 v236,4.0,v237
v_fma_f32 v237,2.0,v111,v238
M v[48:51],a[232:235],a[196:199],v[48:51]
v_fma_f32 v111,s41,v111,v238
v_cvt_pk_bf16_f32 v233,v233,v237
M v[52:55],a[232:235],a[200:203],v[52:55]
v_cvt_pk_bf16_f32 v235,v235,v236
M v[56:59],a[232:235],a[204:207],v[56:59]
s_waitcnt lgkmcnt(0)
ds_write2st64_b64 v253,v[232:233],v[234:235] offset0:93 offset1:97
M v[60:63],a[232:235],a[208:211],v[60:63]
s_waitcnt vmcnt(12)
buffer_load_dwordx4 a[232:235],v251,s[20:23],s46 offen offset:2048
M v[64:67],a[236:239],a[212:215],v[64:67]
ds_read_b128 a[212:215],v249 offset:2304
v_accvgpr_read_b32 v238,a16
M v[68:71],a[236:239],a[216:219],v[68:71]
s_add_u32 s46,s77,0
v_accvgpr_read_b32 v232,a112
v_add_f32 v234,v238,v232
M v[72:75],a[236:239],a[220:223],v[72:75]
v_sub_f32 v238,v238,v232
v_add_f32 v232,v16,v112
M v[76:79],a[236:239],a[192:195],v[76:79]
v_sub_f32 v112,v16,v112
M v[80:83],a[236:239],a[196:199],v[80:83]
s_waitcnt lgkmcnt(1)
s_barrier
ds_read_b128 a[8:11],v251 offset:43520
M v[84:87],a[236:239],a[200:203],v[84:87]
ds_read_b128 a[12:15],v251 offset:47616
v_add_f32 v16,v234,v232
M v[88:91],a[236:239],a[204:207],v[88:91]
v_fmac_f32 v234,4.0,v232
v_fma_f32 v232,2.0,v112,v238
M v[92:95],a[236:239],a[208:211],v[92:95]
s_waitcnt vmcnt(12)
buffer_load_dwordx4 a[236:239],v251,s[20:23],s46 offen offset:0
M v[32:35],a[240:243],a[216:219],v[32:35]
v_fma_f32 v112,s41,v112,v238
v_accvgpr_read_b32 v238,a17
M v[36:39],a[240:243],a[220:223],v[36:39]
s_waitcnt lgkmcnt(1)
s_add_u32 s34,s32,393216
buffer_store_dwordx4 a[8:11],v252,s[24:27],s34 offen offset:384 nt
M v[40:43],a[240:243],a[192:195],v[40:43]
s_waitcnt lgkmcnt(0)
s_add_u32 s34,s32,589824
buffer_store_dwordx4 a[12:15],v252,s[24:27],s34 offen offset:384 nt
M v[44:47],a[240:243],a[196:199],v[44:47]
v_accvgpr_read_b32 v237,a113
v_add_f32 v236,v238,v237
M v[48:51],a[240:243],a[200:203],v[48:51]
v_sub_f32 v238,v238,v237
v_add_f32 v237,v17,v113
M v[52:55],a[240:243],a[204:207],v[52:55]
v_sub_f32 v113,v17,v113
v_add_f32 v17,v236,v237
M v[56:59],a[240:243],a[208:211],v[56:59]
v_fmac_f32 v236,4.0,v237
v_fma_f32 v237,2.0,v113,v238
M v[60:63],a[240:243],a[212:215],v[60:63]
s_waitcnt vmcnt(14)
buffer_load_dwordx4 a[240:243],v251,s[20:23],s46 offen offset:1024
M v[64:67],a[244:247],a[216:219],v[64:67]
ds_read_b128 a[216:219],v249 offset:8704
v_fma_f32 v113,s41,v113,v238
M v[68:71],a[244:247],a[220:223],v[68:71]
ds_read_b128 a[220:223],v250 offset:8960
v_cvt_pk_bf16_f32 v232,v232,v237
M v[72:75],a[244:247],a[192:195],v[72:75]
ds_read_b128 a[192:195],v250 offset:9216
v_cvt_pk_bf16_f32 v234,v234,v236
M v[76:79],a[244:247],a[196:199],v[76:79]
ds_read_b128 a[196:199],v250 offset:9472
v_accvgpr_read_b32 v238,a18
M v[80:83],a[244:247],a[200:203],v[80:83]
ds_read_b128 a[200:203],v250 offset:9728
v_accvgpr_read_b32 v233,a114
M v[84:87],a[244:247],a[204:207],v[84:87]
ds_read_b128 a[204:207],v250 offset:9984
v_add_f32 v235,v238,v233
M v[88:91],a[244:247],a[208:211],v[88:91]
ds_read_b128 a[208:211],v250 offset:10240
v_sub_f32 v238,v238,v233
M v[92:95],a[244:247],a[212:215],v[92:95]
s_waitcnt vmcnt(14) lgkmcnt(6)
buffer_load_dwordx4 a[244:247],v251,s[20:23],s46 offen offset:2048
M v[128:131],a[248:251],a[216:219],v[128:131]
s_waitcnt lgkmcnt(5)
ds_read_b128 a[212:215],v250 offset:10496
v_add_f32 v233,v18,v114
M v[132:135],a[248:251],a[220:223],v[132:135]
s_waitcnt lgkmcnt(5)
s_add_u32 s46,s78,0
v_sub_f32 v114,v18,v114
v_add_f32 v18,v235,v233
M v[136:139],a[248:251],a[192:195],v[136:139]
s_waitcnt lgkmcnt(4)
v_fmac_f32 v235,4.0,v233
v_fma_f32 v233,2.0,v114,v238
M v[140:143],a[248:251],a[196:199],v[140:143]
s_waitcnt lgkmcnt(3)
v_fma_f32 v114,s41,v114,v238
v_accvgpr_read_b32 v238,a19
M v[144:147],a[248:251],a[200:203],v[144:147]
s_waitcnt lgkmcnt(2)
v_accvgpr_read_b32 v237,a115
v_add_f32 v236,v238,v237
M v[148:151],a[248:251],a[204:207],v[148:151]
s_waitcnt lgkmcnt(1)
v_sub_f32 v238,v238,v237
v_add_f32 v237,v19,v115
M v[152:155],a[248:251],a[208:211],v[152:155]
s_waitcnt lgkmcnt(0)
v_sub_f32 v115,v19,v115
v_add_f32 v19,v236,v237
M v[156:159],a[248:251],a[212:215],v[156:159]
s_waitcnt vmcnt(14)
buffer_load_dwordx4 a[248:251],v251,s[20:23],s46 offen offset:0
M v[160:163],a[252:255],a[216:219],v[160:163]
ds_read_b128 a[216:219],v250 offset:10752
v_fmac_f32 v236,4.0,v237
M v[164:167],a[252:255],a[220:223],v[164:167]
v_fma_f32 v237,2.0,v115,v238
v_fma_f32 v115,s41,v115,v238
M v[168:171],a[252:255],a[192:195],v[168:171]
v_cvt_pk_bf16_f32 v233,v233,v237
v_cvt_pk_bf16_f32 v235,v235,v236
M v[172:175],a[252:255],a[196:199],v[172:175]
ds_write2st64_b64 v253,v[232:233],v[234:235] offset0:68 offset1:72
M v[176:179],a[252:255],a[200:203],v[176:179]
v_accvgpr_read_b32 v238,a20
v_accvgpr_read_b32 v232,a116
M v[180:183],a[252:255],a[204:207],v[180:183]
v_add_f32 v234,v238,v232
v_sub_f32 v238,v238,v232
M v[184:187],a[252:255],a[208:211],v[184:187]
v_add_f32 v232,v20,v116
v_sub_f32 v116,v20,v116
M v[188:191],a[252:255],a[212:215],v[188:191]
s_waitcnt vmcnt(13)
buffer_load_dwordx4 a[252:255],v251,s[20:23],s46 offen offset:1024
M v[128:131],v[216:219],a[220:223],v[128:131]
v_add_f32 v20,v234,v232
v_fmac_f32 v234,4.0,v232
M v[132:135],v[216:219],a[192:195],v[132:135]
v_fma_f32 v232,2.0,v116,v238
v_fma_f32 v116,s41,v116,v238
M v[136:139],v[216:219],a[196:199],v[136:139]
v_accvgpr_read_b32 v238,a21
v_accvgpr_read_b32 v237,a117
M v[140:143],v[216:219],a[200:203],v[140:143]
v_add_f32 v236,v238,v237
v_sub_f32 v238,v238,v237
M v[144:147],v[216:219],a[204:207],v[144:147]
v_add_f32 v237,v21,v117
v_sub_f32 v117,v21,v117
M v[148:151],v[216:219],a[208:211],v[148:151]
v_add_f32 v21,v236,v237
v_fmac_f32 v236,4.0,v237
M v[152:155],v[216:219],a[212:215],v[152:155]
s_waitcnt lgkmcnt(1)
v_fma_f32 v237,2.0,v117,v238
v_fma_f32 v117,s41,v117,v238
v_cvt_pk_bf16_f32 v232,v232,v237
M v[156:159],v[216:219],a[216:219],v[156:159]
s_waitcnt vmcnt(13)
buffer_load_dwordx4 v[216:219],v251,s[20:23],s46 offen offset:2048
v_cvt_pk_bf16_f32 v234,v234,v236
v_accvgpr_read_b32 v238,a22
v_accvgpr_read_b32 v233,a118
v_add_f32 v235,v238,v233
M v[160:163],v[220:223],a[220:223],v[160:163]
ds_read_b128 a[220:223],v249 offset:11008
v_sub_f32 v238,v238,v233
v_add_f32 v233,v22,v118
v_sub_f32 v118,v22,v118
v_add_f32 v22,v235,v233
M v[164:167],v[220:223],a[192:195],v[164:167]
s_add_u32 s46,s79,0
v_fmac_f32 v235,4.0,v233
v_fma_f32 v233,2.0,v118,v238
v_fma_f32 v118,s41,v118,v238
v_accvgpr_read_b32 v238,a23
M v[168:171],v[220:223],a[196:199],v[168:171]
v_accvgpr_read_b32 v237,a119
v_add_f32 v236,v238,v237
v_sub_f32 v238,v238,v237
v_add_f32 v237,v23,v119
M v[172:175],v[220:223],a[200:203],v[172:175]
v_sub_f32 v119,v23,v119
v_add_f32 v23,v236,v237
v_fmac_f32 v236,4.0,v237
v_fma_f32 v237,2.0,v119,v238
M v[176:179],v[220:223],a[204:207],v[176:179]
v_fma_f32 v119,s41,v119,v238
v_cvt_pk_bf16_f32 v233,v233,v237
v_cvt_pk_bf16_f32 v235,v235,v236
M v[180:183],v[220:223],a[208:211],v[180:183]
ds_write2st64_b64 v253,v[232:233],v[234:235] offset0:76 offset1:80
M v[184:187],v[220:223],a[212:215],v[184:187]
v_accvgpr_read_b32 v238,a24
v_accvgpr_read_b32 v232,a120
M v[188:191],v[220:223],a[216:219],v[188:191]
s_waitcnt vmcnt(12)
buffer_load_dwordx4 v[220:223],v251,s[20:23],s46 offen offset:0
v_add_f32 v234,v238,v232
v_sub_f32 v238,v238,v232
v_add_f32 v232,v24,v120
v_sub_f32 v120,v24,v120
M v[128:131],v[224:227],a[192:195],v[128:131]
s_waitcnt lgkmcnt(0)
s_barrier
ds_read_b128 a[16:19],v251 offset:34816
v_add_f32 v24,v234,v232
v_fmac_f32 v234,4.0,v232
v_fma_f32 v232,2.0,v120,v238
M v[132:135],v[224:227],a[196:199],v[132:135]
ds_read_b128 a[20:23],v251 offset:38912
v_fma_f32 v120,s41,v120,v238
v_accvgpr_read_b32 v238,a25
v_accvgpr_read_b32 v237,a121
v_add_f32 v236,v238,v237
M v[136:139],v[224:227],a[200:203],v[136:139]
v_sub_f32 v238,v238,v237
v_add_f32 v237,v25,v121
v_sub_f32 v121,v25,v121
v_add_f32 v25,v236,v237
M v[140:143],v[224:227],a[204:207],v[140:143]
v_fmac_f32 v236,4.0,v237
v_fma_f32 v237,2.0,v121,v238
v_fma_f32 v121,s41,v121,v238
v_cvt_pk_bf16_f32 v232,v232,v237
M v[144:147],v[224:227],a[208:211],v[144:147]
v_cvt_pk_bf16_f32 v234,v234,v236
v_accvgpr_read_b32 v238,a26
v_accvgpr_read_b32 v233,a122
v_add_f32 v235,v238,v233
M v[148:151],v[224:227],a[212:215],v[148:151]
s_waitcnt lgkmcnt(1)
s_add_u32 s34,s32,786432
buffer_store_dwordx4 a[16:19],v252,s[24:27],s34 offen offset:384 nt
v_sub_f32 v238,v238,v233
v_add_f32 v233,v26,v122
v_sub_f32 v122,v26,v122
v_add_f32 v26,v235,v233
M v[152:155],v[224:227],a[216:219],v[152:155]
s_waitcnt lgkmcnt(0)
s_add_u32 s34,s32,983040
buffer_store_dwordx4 a[20:23],v252,s[24:27],s34 offen offset:384 nt
v_fmac_f32 v235,4.0,v233
v_fma_f32 v233,2.0,v122,v238
v_fma_f32 v122,s41,v122,v238
v_accvgpr_read_b32 v238,a27
M v[156:159],v[224:227],a[220:223],v[156:159]
s_waitcnt vmcnt(14)
buffer_load_dwordx4 v[224:227],v251,s[20:23],s46 offen offset:1024
v_accvgpr_read_b32 v237,a123
v_add_f32 v236,v238,v237
v_sub_f32 v238,v238,v237
v_add_f32 v237,v27,v123
M v[160:163],v[228:231],a[192:195],v[160:163]
v_add_u32 v249,0xffffbc00,v249
v_add_u32 v250,0xffffbc00,v250
v_sub_f32 v123,v27,v123
v_add_f32 v27,v236,v237
v_fmac_f32 v236,4.0,v237
v_fma_f32 v237,2.0,v123,v238
M v[164:167],v[228:231],a[196:199],v[164:167]
ds_read_b128 a[192:195],v249 offset:0
ds_read_b128 a[196:199],v250 offset:256
v_fma_f32 v123,s41,v123,v238
v_cvt_pk_bf16_f32 v233,v233,v237
v_cvt_pk_bf16_f32 v235,v235,v236
M v[168:171],v[228:231],a[200:203],v[168:171]
s_waitcnt lgkmcnt(0)
s_barrier
ds_write2st64_b64 v253,v[232:233],v[234:235] offset0:85 offset1:89
M v[172:175],v[228:231],a[204:207],v[172:175]
ds_read_b128 a[200:203],v250 offset:512
ds_read_b128 a[204:207],v250 offset:768
v_accvgpr_read_b32 v238,a28
v_accvgpr_read_b32 v232,a124
M v[176:179],v[228:231],a[208:211],v[176:179]
ds_read_b128 a[208:211],v250 offset:1024
v_add_f32 v234,v238,v232
v_sub_f32 v238,v238,v232
v_add_f32 v232,v28,v124
v_sub_f32 v124,v28,v124
M v[180:183],v[228:231],a[212:215],v[180:183]
ds_read_b128 a[212:215],v250 offset:1280
v_add_f32 v28,v234,v232
v_fmac_f32 v234,4.0,v232
v_fma_f32 v232,2.0,v124,v238
v_fma_f32 v124,s41,v124,v238
M v[184:187],v[228:231],a[216:219],v[184:187]
ds_read_b128 a[216:219],v250 offset:1536
v_accvgpr_read_b32 v238,a29
v_accvgpr_read_b32 v237,a125
v_add_f32 v236,v238,v237
v_sub_f32 v238,v238,v237
M v[188:191],v[228:231],a[220:223],v[188:191]
s_waitcnt vmcnt(14)
buffer_load_dwordx4 v[228:231],v251,s[20:23],s46 offen offset:2048
v_add_f32 v237,v29,v125
v_sub_f32 v125,v29,v125
v_add_f32 v29,v236,v237
v_fmac_f32 v236,4.0,v237
M v[0:3],a[224:227],a[192:195],v[0:3]
ds_read_b128 a[220:223],v250 offset:1792
ds_read_b128 a[192:195],v250 offset:2048
v_fma_f32 v237,2.0,v125,v238
v_fma_f32 v125,s41,v125,v238
v_cvt_pk_bf16_f32 v232,v232,v237
v_cvt_pk_bf16_f32 v234,v234,v236
M v[4:7],a[224:227],a[196:199],v[4:7]
s_waitcnt lgkmcnt(6)
s_add_u32 s46,s80,0
v_accvgpr_read_b32 v238,a30
v_accvgpr_read_b32 v233,a126
v_add_f32 v235,v238,v233
v_sub_f32 v238,v238,v233
M v[8:11],a[224:227],a[200:203],v[8:11]
s_waitcnt lgkmcnt(5)
v_add_f32 v233,v30,v126
v_sub_f32 v126,v30,v126
v_add_f32 v30,v235,v233
v_fmac_f32 v235,4.0,v233
M v[12:15],a[224:227],a[204:207],v[12:15]
s_waitcnt lgkmcnt(4)
v_fma_f32 v233,2.0,v126,v238
v_fma_f32 v126,s41,v126,v238
v_accvgpr_read_b32 v238,a31
v_accvgpr_read_b32 v237,a127
M v[16:19],a[224:227],a[208:211],v[16:19]
s_waitcnt lgkmcnt(3)
v_add_f32 v236,v238,v237
v_sub_f32 v238,v238,v237
v_add_f32 v237,v31,v127
v_sub_f32 v127,v31,v127
M v[20:23],a[224:227],a[212:215],v[20:23]
s_waitcnt lgkmcnt(2)
v_add_f32 v31,v236,v237
v_fmac_f32 v236,4.0,v237
M v[24:27],a[224:227],a[216:219],v[24:27]
s_waitcnt lgkmcnt(1)
v_fma_f32 v237,2.0,v127,v238
v_fma_f32 v127,s41,v127,v238
M v[28:31],a[224:227],a[220:223],v[28:31]
s_waitcnt vmcnt(14)
buffer_load_dwordx4 a[224:227],v251,s[20:23],s46 offen offset:0
M v[0:3],a[228:231],a[196:199],v[0:3]
ds_read_b128 a[196:199],v249 offset:2304
v_cvt_pk_bf16_f32 v233,v233,v237
M v[4:7],a[228:231],a[200:203],v[4:7]
v_cvt_pk_bf16_f32 v235,v235,v236
M v[8:11],a[228:231],a[204:207],v[8:11]
ds_write2st64_b64 v253,v[232:233],v[234:235] offset0:93 offset1:97
M v[12:15],a[228:231],a[208:211],v[12:15]
v_accvgpr_read_b32 v238,a32
v_accvgpr_read_b32 v232,a128
M v[16:19],a[228:231],a[212:215],v[16:19]
v_add_f32 v234,v238,v232
v_sub_f32 v238,v238,v232
M v[20:23],a[228:231],a[216:219],v[20:23]
v_add_u32 v249,0x15400,v249
v_add_u32 v250,0x15400,v250
M v[24:27],a[228:231],a[220:223],v[24:27]
s_waitcnt lgkmcnt(2)
v_add_f32 v232,v32,v128
v_sub_f32 v128,v32,v128
M v[28:31],a[228:231],a[192:195],v[28:31]
s_waitcnt vmcnt(14) lgkmcnt(0)
s_barrier
ds_read_b128 a[24:27],v251 offset:43520
M v[0:3],a[232:235],a[200:203],v[0:3]
ds_read_b128 a[28:31],v251 offset:47616
ds_read_b128 a[200:203],v249 offset:0
M v[4:7],a[232:235],a[204:207],v[4:7]
buffer_load_dwordx4 a[228:231],v251,s[20:23],s46 offen offset:1024
M v[8:11],a[232:235],a[208:211],v[8:11]
ds_read_b128 a[204:207],v250 offset:256
ds_read_b128 a[208:211],v250 offset:512
M v[12:15],a[232:235],a[212:215],v[12:15]
ds_read_b128 a[212:215],v250 offset:768
v_add_f32 v32,v234,v232
M v[16:19],a[232:235],a[216:219],v[16:19]
s_waitcnt lgkmcnt(5)
s_add_u32 s34,s32,1179648
buffer_store_dwordx4 a[24:27],v252,s[24:27],s34 offen offset:384 nt
M v[20:23],a[232:235],a[220:223],v[20:23]
ds_read_b128 a[216:219],v250 offset:1024
ds_read_b128 a[220:223],v250 offset:1280
M v[24:27],a[232:235],a[192:195],v[24:27]
ds_read_b128 a[192:195],v250 offset:1536
v_fmac_f32 v234,4.0,v232
M v[28:31],a[232:235],a[196:199],v[28:31]
s_waitcnt vmcnt(15) lgkmcnt(6)
buffer_load_dwordx4 a[232:235],v251,s[20:23],s46 offen offset:2048
M v[0:3],a[236:239],a[200:203],v[0:3]
s_waitcnt lgkmcnt(5)
ds_read_b128 a[196:199],v250 offset:1792
ds_read_b128 a[200:203],v250 offset:2048
M v[4:7],a[236:239],a[204:207],v[4:7]
s_waitcnt lgkmcnt(6)
s_add_u32 s46,s81,0
v_fma_f32 v232,2.0,v128,v238
v_fma_f32 v128,s41,v128,v238
M v[8:11],a[236:239],a[208:211],v[8:11]
s_waitcnt lgkmcnt(5)
v_accvgpr_read_b32 v238,a33
v_accvgpr_read_b32 v237,a129
M v[12:15],a[236:239],a[212:215],v[12:15]
s_waitcnt lgkmcnt(4)
v_add_f32 v236,v238,v237
v_sub_f32 v238,v238,v237
M v[16:19],a[236:239],a[216:219],v[16:19]
s_waitcnt lgkmcnt(3)
v_add_f32 v237,v33,v129
v_sub_f32 v129,v33,v129
M v[20:23],a[236:239],a[220:223],v[20:23]
s_waitcnt lgkmcnt(2)
v_add_f32 v33,v236,v237
v_fmac_f32 v236,4.0,v237
M v[24:27],a[236:239],a[192:195],v[24:27]
s_waitcnt lgkmcnt(1)
v_fma_f32 v237,2.0,v129,v238
v_fma_f32 v129,s41,v129,v238
M v[28:31],a[236:239],a[196:199],v[28:31]
s_waitcnt vmcnt(13)
buffer_load_dwordx4 a[236:239],v251,s[20:23],s46 offen offset:0
M v[0:3],a[240:243],a[204:207],v[0:3]
ds_read_b128 a[204:207],v249 offset:2304
v_cvt_pk_bf16_f32 v232,v232,v237
M v[4:7],a[240:243],a[208:211],v[4:7]
v_cvt_pk_bf16_f32 v234,v234,v236
v_accvgpr_read_b32 v238,a34
M v[8:11],a[240:243],a[212:215],v[8:11]
v_accvgpr_read_b32 v233,a130
v_add_f32 v235,v238,v233
M v[12:15],a[240:243],a[216:219],v[12:15]
v_sub_f32 v238,v238,v233
v_add_f32 v233,v34,v130
M v[16:19],a[240:243],a[220:223],v[16:19]
v_sub_f32 v130,v34,v130
v_add_f32 v34,v235,v233
M v[20:23],a[240:243],a[192:195],v[20:23]
s_add_u32 s34,s32,1376256
buffer_store_dwordx4 a[28:31],v252,s[24:27],s34 offen offset:384 nt
M v[24:27],a[240:243],a[196:199],v[24:27]
s_waitcnt lgkmcnt(1)
v_fmac_f32 v235,4.0,v233
v_fma_f32 v233,2.0,v130,v238
M v[28:31],a[240:243],a[200:203],v[28:31]
s_waitcnt vmcnt(14)
buffer_load_dwordx4 a[240:243],v251,s[20:23],s46 offen offset:1024
M v[0:3],a[244:247],a[208:211],v[0:3]
ds_read_b128 a[208:211],v249 offset:17408
v_fma_f32 v130,s41,v130,v238
M v[4:7],a[244:247],a[212:215],v[4:7]
ds_read_b128 a[212:215],v250 offset:17664
v_accvgpr_read_b32 v238,a35
M v[8:11],a[244:247],a[216:219],v[8:11]
ds_read_b128 a[216:219],v250 offset:17920
v_accvgpr_read_b32 v237,a131
M v[12:15],a[244:247],a[220:223],v[12:15]
ds_read_b128 a[220:223],v250 offset:18176
v_add_f32 v236,v238,v237
M v[16:19],a[244:247],a[192:195],v[16:19]
ds_read_b128 a[192:195],v250 offset:18432
v_sub_f32 v238,v238,v237
M v[20:23],a[244:247],a[196:199],v[20:23]
ds_read_b128 a[196:199],v250 offset:18688
v_add_f32 v237,v35,v131
M v[24:27],a[244:247],a[200:203],v[24:27]
s_waitcnt lgkmcnt(6)
ds_read_b128 a[200:203],v250 offset:18944
v_sub_f32 v131,v35,v131
M v[28:31],a[244:247],a[204:207],v[28:31]
s_waitcnt vmcnt(14) lgkmcnt(6)
buffer_load_dwordx4 a[244:247],v251,s[20:23],s46 offen offset:2048
M v[0:3],a[248:251],a[208:211],v[0:3]
s_waitcnt lgkmcnt(5)
ds_read_b128 a[204:207],v250 offset:19200
ds_read_b128 a[208:211],v250 offset:19456
M v[4:7],a[248:251],a[212:215],v[4:7]
s_waitcnt lgkmcnt(6)
s_add_u32 s46,s76,46080
v_add_f32 v35,v236,v237
v_fmac_f32 v236,4.0,v237
M v[8:11],a[248:251],a[216:219],v[8:11]
s_waitcnt lgkmcnt(5)
v_fma_f32 v237,2.0,v131,v238
v_fma_f32 v131,s41,v131,v238
M v[12:15],a[248:251],a[220:223],v[12:15]
s_waitcnt lgkmcnt(4)
v_cvt_pk_bf16_f32 v233,v233,v237
v_cvt_pk_bf16_f32 v235,v235,v236
M v[16:19],a[248:251],a[192:195],v[16:19]
s_waitcnt lgkmcnt(3)
ds_write2st64_b64 v253,v[232:233],v[234:235] offset0:34 offset1:38
M v[20:23],a[248:251],a[196:199],v[20:23]
s_waitcnt lgkmcnt(3)
v_accvgpr_read_b32 v238,a36
v_accvgpr_read_b32 v232,a132
M v[24:27],a[248:251],a[200:203],v[24:27]
s_waitcnt lgkmcnt(2)
v_add_f32 v234,v238,v232
v_sub_f32 v238,v238,v232
M v[28:31],a[248:251],a[204:207],v[28:31]
s_waitcnt vmcnt(14)
buffer_load_dwordx4 a[248:251],v251,s[20:23],s46 offen offset:0
M v[0:3],a[252:255],a[212:215],v[0:3]
ds_read_b128 a[212:215],v249 offset:19712
v_add_f32 v232,v36,v132
M v[4:7],a[252:255],a[216:219],v[4:7]
v_sub_f32 v132,v36,v132
v_add_f32 v36,v234,v232
M v[8:11],a[252:255],a[220:223],v[8:11]
v_fmac_f32 v234,4.0,v232
v_fma_f32 v232,2.0,v132,v238
M v[12:15],a[252:255],a[192:195],v[12:15]
v_fma_f32 v132,s41,v132,v238
v_accvgpr_read_b32 v238,a37
M v[16:19],a[252:255],a[196:199],v[16:19]
v_accvgpr_read_b32 v237,a133
v_add_f32 v236,v238,v237
M v[20:23],a[252:255],a[200:203],v[20:23]
v_sub_f32 v238,v238,v237
v_add_f32 v237,v37,v133
M v[24:27],a[252:255],a[204:207],v[24:27]
s_waitcnt lgkmcnt(2)
v_sub_f32 v133,v37,v133
v_add_f32 v37,v236,v237
M v[28:31],a[252:255],a[208:211],v[28:31]
s_waitcnt vmcnt(14)
buffer_load_dwordx4 a[252:255],v251,s[20:23],s46 offen offset:1024
M v[0:3],v[216:219],a[216:219],v[0:3]
ds_read_b128 a[216:219],v249 offset:34816
v_fmac_f32 v236,4.0,v237
M v[4:7],v[216:219],a[220:223],v[4:7]
ds_read_b128 a[220:223],v250 offset:35072
v_fma_f32 v237,2.0,v133,v238
M v[8:11],v[216:219],a[192:195],v[8:11]
ds_read_b128 a[192:195],v250 offset:35328
v_fma_f32 v133,s41,v133,v238
M v[12:15],v[216:219],a[196:199],v[12:15]
ds_read_b128 a[196:199],v250 offset:35584
v_cvt_pk_bf16_f32 v232,v232,v237
M v[16:19],v[216:219],a[200:203],v[16:19]
ds_read_b128 a[200:203],v250 offset:35840
v_cvt_pk_bf16_f32 v234,v234,v236
M v[20:23],v[216:219],a[204:207],v[20:23]
ds_read_b128 a[204:207],v250 offset:36096
v_accvgpr_read_b32 v238,a38
M v[24:27],v[216:219],a[208:211],v[24:27]
s_waitcnt lgkmcnt(6)
ds_read_b128 a[208:211],v250 offset:36352
v_accvgpr_read_b32 v233,a134
M v[28:31],v[216:219],a[212:215],v[28:31]
s_waitcnt vmcnt(14) lgkmcnt(6)
buffer_load_dwordx4 v[216:219],v251,s[20:23],s46 offen offset:2048
M v[0:3],v[220:223],a[216:219],v[0:3]
s_waitcnt lgkmcnt(5)
ds_read_b128 a[212:215],v250 offset:36608
ds_read_b128 a[216:219],v250 offset:36864
M v[4:7],v[220:223],a[220:223],v[4:7]
s_waitcnt lgkmcnt(6)
s_add_u32 s46,s77,46080
v_add_f32 v235,v238,v233
v_sub_f32 v238,v238,v233
M v[8:11],v[220:223],a[192:195],v[8:11]
s_waitcnt lgkmcnt(5)
v_add_f32 v233,v38,v134
v_sub_f32 v134,v38,v134
M v[12:15],v[220:223],a[196:199],v[12:15]
s_waitcnt lgkmcnt(4)
v_add_f32 v38,v235,v233
v_fmac_f32 v235,4.0,v233
M v[16:19],v[220:223],a[200:203],v[16:19]
s_waitcnt lgkmcnt(3)
v_fma_f32 v233,2.0,v134,v238
v_fma_f32 v134,s41,v134,v238
M v[20:23],v[220:223],a[204:207],v[20:23]
s_waitcnt lgkmcnt(2)
v_accvgpr_read_b32 v238,a39
v_accvgpr_read_b32 v237,a135
M v[24:27],v[220:223],a[208:211],v[24:27]
s_waitcnt lgkmcnt(1)
v_add_f32 v236,v238,v237
v_sub_f32 v238,v238,v237
M v[28:31],v[220:223],a[212:215],v[28:31]
s_waitcnt vmcnt(12)
buffer_load_dwordx4 v[220:223],v251,s[20:23],s46 offen offset:0
M v[0:3],v[224:227],a[220:223],v[0:3]
ds_read_b128 a[220:223],v249 offset:37120
v_add_f32 v237,v39,v135
M v[4:7],v[224:227],a[192:195],v[4:7]
v_sub_f32 v135,v39,v135
v_add_f32 v39,v236,v237
M v[8:11],v[224:227],a[196:199],v[8:11]
v_fmac_f32 v236,4.0,v237
v_fma_f32 v237,2.0,v135,v238
M v[12:15],v[224:227],a[200:203],v[12:15]
v_fma_f32 v135,s41,v135,v238
v_cvt_pk_bf16_f32 v233,v233,v237
M v[16:19],v[224:227],a[204:207],v[16:19]
v_cvt_pk_bf16_f32 v235,v235,v236
M v[20:23],v[224:227],a[208:211],v[20:23]
ds_write2st64_b64 v253,v[232:233],v[234:235] offset0:42 offset1:46
M v[24:27],v[224:227],a[212:215],v[24:27]
s_waitcnt lgkmcnt(2)
v_accvgpr_read_b32 v238,a40
v_accvgpr_read_b32 v232,a136
M v[28:31],v[224:227],a[216:219],v[28:31]
s_waitcnt vmcnt(12)
buffer_load_dwordx4 v[224:227],v251,s[20:23],s46 offen offset:1024
M v[0:3],v[228:231],a[192:195],v[0:3]
ds_read_b128 a[192:195],v249 offset:52224
v_add_f32 v234,v238,v232
M v[4:7],v[228:231],a[196:199],v[4:7]
ds_read_b128 a[196:199],v250 offset:52480
v_sub_f32 v238,v238,v232
M v[8:11],v[228:231],a[200:203],v[8:11]
ds_read_b128 a[200:203],v250 offset:52736
v_add_f32 v232,v40,v136
M v[12:15],v[228:231],a[204:207],v[12:15]
ds_read_b128 a[204:207],v250 offset:52992
v_sub_f32 v136,v40,v136
M v[16:19],v[228:231],a[208:211],v[16:19]
ds_read_b128 a[208:211],v250 offset:53248
v_add_f32 v40,v234,v232
M v[20:23],v[228:231],a[212:215],v[20:23]
ds_read_b128 a[212:215],v250 offset:53504
v_fmac_f32 v234,4.0,v232
M v[24:27],v[228:231],a[216:219],v[24:27]
s_waitcnt lgkmcnt(7)
ds_read_b128 a[216:219],v250 offset:53760
v_fma_f32 v232,2.0,v136,v238
M v[28:31],v[228:231],a[220:223],v[28:31]
s_waitcnt vmcnt(12) lgkmcnt(6)
buffer_load_dwordx4 v[228:231],v251,s[20:23],s46 offen offset:2048
M v[0:3],a[224:227],a[192:195],v[0:3]
s_waitcnt lgkmcnt(5)
ds_read_b128 a[220:223],v250 offset:54016
ds_read_b128 a[192:195],v250 offset:54272
M v[4:7],a[224:227],a[196:199],v[4:7]
s_waitcnt lgkmcnt(6)
s_add_u32 s46,s78,46080
v_fma_f32 v136,s41,v136,v238
v_accvgpr_read_b32 v238,a41
M v[8:11],a[224:227],a[200:203],v[8:11]
s_waitcnt lgkmcnt(5)
v_accvgpr_read_b32 v237,a137
v_add_f32 v236,v238,v237
M v[12:15],a[224:227],a[204:207],v[12:15]
s_waitcnt lgkmcnt(4)
v_sub_f32 v238,v238,v237
v_add_f32 v237,v41,v137
M v[16:19],a[224:227],a[208:211],v[16:19]
s_waitcnt lgkmcnt(3)
v_sub_f32 v137,v41,v137
v_add_f32 v41,v236,v237
M v[20:23],a[224:227],a[212:215],v[20:23]
s_waitcnt lgkmcnt(2)
v_fmac_f32 v236,4.0,v237
v_fma_f32 v237,2.0,v137,v238
M v[24:27],a[224:227],a[216:219],v[24:27]
s_waitcnt lgkmcnt(1)
v_fma_f32 v137,s41,v137,v238
v_cvt_pk_bf16_f32 v232,v232,v237
M v[28:31],a[224:227],a[220:223],v[28:31]
s_waitcnt vmcnt(12)
buffer_load_dwordx4 a[224:227],v251,s[20:23],s46 offen offset:0
M v[0:3],a[228:231],a[196:199],v[0:3]
ds_read_b128 a[196:199],v249 offset:54528
v_cvt_pk_bf16_f32 v234,v234,v236
M v[4:7],a[228:231],a[200:203],v[4:7]
v_accvgpr_read_b32 v238,a42
v_accvgpr_read_b32 v233,a138
M v[8:11],a[228:231],a[204:207],v[8:11]
v_add_f32 v235,v238,v233
v_sub_f32 v238,v238,v233
M v[12:15],a[228:231],a[208:211],v[12:15]
v_add_f32 v233,v42,v138
v_sub_f32 v138,v42,v138
M v[16:19],a[228:231],a[212:215],v[16:19]
v_add_f32 v42,v235,v233
v_fmac_f32 v235,4.0,v233
M v[20:23],a[228:231],a[216:219],v[20:23]
v_add_u32 v249,0xfffece00,v249
v_add_u32 v250,0xfffece00,v250
M v[24:27],a[228:231],a[220:223],v[24:27]
s_waitcnt lgkmcnt(1)
v_fma_f32 v233,2.0,v138,v238
v_fma_f32 v138,s41,v138,v238
M v[28:31],a[228:231],a[192:195],v[28:31]
s_waitcnt vmcnt(11)
buffer_load_dwordx4 a[228:231],v251,s[20:23],s46 offen offset:1024
M v[0:3],a[232:235],a[200:203],v[0:3]
ds_read_b128 a[200:203],v249 offset:60928
v_accvgpr_read_b32 v238,a43
M v[4:7],a[232:235],a[204:207],v[4:7]
ds_read_b128 a[204:207],v250 offset:61184
v_accvgpr_read_b32 v237,a139
M v[8:11],a[232:235],a[208:211],v[8:11]
ds_read_b128 a[208:211],v250 offset:61440
v_add_f32 v236,v238,v237
M v[12:15],a[232:235],a[212:215],v[12:15]
ds_read_b128 a[212:215],v250 offset:61696
v_sub_f32 v238,v238,v237
M v[16:19],a[232:235],a[216:219],v[16:19]
ds_read_b128 a[216:219],v250 offset:61952
v_add_f32 v237,v43,v139
M v[20:23],a[232:235],a[220:223],v[20:23]
ds_read_b128 a[220:223],v250 offset:62208
v_sub_f32 v139,v43,v139
M v[24:27],a[232:235],a[192:195],v[24:27]
s_waitcnt lgkmcnt(6)
ds_read_b128 a[192:195],v250 offset:62464
v_add_f32 v43,v236,v237
M v[28:31],a[232:235],a[196:199],v[28:31]
s_waitcnt vmcnt(11) lgkmcnt(6)
buffer_load_dwordx4 a[232:235],v251,s[20:23],s46 offen offset:2048
M v[0:3],a[236:239],a[200:203],v[0:3]
s_waitcnt lgkmcnt(5)
ds_read_b128 a[196:199],v250 offset:62720
ds_read_b128 a[200:203],v250 offset:62976
M v[4:7],a[236:239],a[204:207],v[4:7]
s_waitcnt lgkmcnt(6)
s_add_u32 s46,s79,46080
v_fmac_f32 v236,4.0,v237
v_fma_f32 v237,2.0,v139,v238
M v[8:11],a[236:239],a[208:211],v[8:11]
s_waitcnt lgkmcnt(5)
v_fma_f32 v139,s41,v139,v238
v_cvt_pk_bf16_f32 v233,v233,v237
M v[12:15],a[236:239],a[212:215],v[12:15]
s_waitcnt lgkmcnt(4)
v_cvt_pk_bf16_f32 v235,v235,v236
M v[16:19],a[236:239],a[216:219],v[16:19]
s_waitcnt lgkmcnt(3)
ds_write2st64_b64 v253,v[232:233],v[234:235] offset0:51 offset1:55
M v[20:23],a[236:239],a[220:223],v[20:23]
s_waitcnt lgkmcnt(3)
v_accvgpr_read_b32 v238,a44
v_accvgpr_read_b32 v232,a140
M v[24:27],a[236:239],a[192:195],v[24:27]
s_waitcnt lgkmcnt(2)
v_add_f32 v234,v238,v232
v_sub_f32 v238,v238,v232
M v[28:31],a[236:239],a[196:199],v[28:31]
s_waitcnt vmcnt(10)
buffer_load_dwordx4 a[236:239],v251,s[20:23],s46 offen offset:0
M v[0:3],a[240:243],a[204:207],v[0:3]
ds_read_b128 a[204:207],v249 offset:63232
v_add_f32 v232,v44,v140
M v[4:7],a[240:243],a[208:211],v[4:7]
v_sub_f32 v140,v44,v140
v_add_f32 v44,v234,v232
M v[8:11],a[240:243],a[212:215],v[8:11]
v_fmac_f32 v234,4.0,v232
v_fma_f32 v232,2.0,v140,v238
M v[12:15],a[240:243],a[216:219],v[12:15]
v_fma_f32 v140,s41,v140,v238
v_accvgpr_read_b32 v238,a45
M v[16:19],a[240:243],a[220:223],v[16:19]
v_accvgpr_read_b32 v237,a141
v_add_f32 v236,v238,v237
M v[20:23],a[240:243],a[192:195],v[20:23]
v_sub_f32 v238,v238,v237
v_add_f32 v237,v45,v141
M v[24:27],a[240:243],a[196:199],v[24:27]
s_waitcnt lgkmcnt(2)
v_sub_f32 v141,v45,v141
v_add_f32 v45,v236,v237
M v[28:31],a[240:243],a[200:203],v[28:31]
s_waitcnt vmcnt(10)
buffer_load_dwordx4 a[240:243],v251,s[20:23],s46 offen offset:1024
M v[0:3],a[244:247],a[208:211],v[0:3]
ds_read_b128 a[208:211],v249 offset:0
v_fmac_f32 v236,4.0,v237
M v[4:7],a[244:247],a[212:215],v[4:7]
ds_read_b128 a[212:215],v250 offset:256
v_fma_f32 v237,2.0,v141,v238
M v[8:11],a[244:247],a[216:219],v[8:11]
ds_read_b128 a[216:219],v250 offset:512
v_fma_f32 v141,s41,v141,v238
M v[12:15],a[244:247],a[220:223],v[12:15]
ds_read_b128 a[220:223],v250 offset:768
v_cvt_pk_bf16_f32 v232,v232,v237
M v[16:19],a[244:247],a[192:195],v[16:19]
ds_read_b128 a[192:195],v250 offset:1024
v_cvt_pk_bf16_f32 v234,v234,v236
M v[20:23],a[244:247],a[196:199],v[20:23]
ds_read_b128 a[196:199],v250 offset:1280
v_accvgpr_read_b32 v238,a46
M v[24:27],a[244:247],a[200:203],v[24:27]
s_waitcnt lgkmcnt(6)
ds_read_b128 a[200:203],v250 offset:1536
v_accvgpr_read_b32 v233,a142
M v[28:31],a[244:247],a[204:207],v[28:31]
s_waitcnt vmcnt(10) lgkmcnt(6)
buffer_load_dwordx4 a[244:247],v251,s[20:23],s46 offen offset:2048
M v[96:99],a[248:251],a[208:211],v[96:99]
s_waitcnt lgkmcnt(5)
ds_read_b128 a[204:207],v250 offset:1792
ds_read_b128 a[208:211],v250 offset:2048
M v[100:103],a[248:251],a[212:215],v[100:103]
s_waitcnt lgkmcnt(6)
s_add_u32 s46,s80,46080
v_add_f32 v235,v238,v233
v_sub_f32 v238,v238,v233
M v[104:107],a[248:251],a[216:219],v[104:107]
s_waitcnt lgkmcnt(5)
v_add_f32 v233,v46,v142
v_sub_f32 v142,v46,v142
M v[108:111],a[248:251],a[220:223],v[108:111]
s_waitcnt lgkmcnt(4)
v_add_f32 v46,v235,v233
v_fmac_f32 v235,4.0,v233
M v[112:115],a[248:251],a[192:195],v[112:115]
s_waitcnt lgkmcnt(3)
v_fma_f32 v233,2.0,v142,v238
v_fma_f32 v142,s41,v142,v238
M v[116:119],a[248:251],a[196:199],v[116:119]
s_waitcnt lgkmcnt(2)
v_accvgpr_read_b32 v238,a47
v_accvgpr_read_b32 v237,a143
M v[120:123],a[248:251],a[200:203],v[120:123]
s_waitcnt lgkmcnt(1)
v_add_f32 v236,v238,v237
v_sub_f32 v238,v238,v237
M v[124:127],a[248:251],a[204:207],v[124:127]
s_waitcnt vmcnt(10)
buffer_load_dwordx4 a[248:251],v251,s[20:23],s46 offen offset:0
M v[96:99],a[252:255],a[212:215],v[96:99]
ds_read_b128 a[212:215],v249 offset:2304
v_add_f32 v237,v47,v143
M v[100:103],a[252:255],a[216:219],v[100:103]
v_sub_f32 v143,v47,v143
v_add_f32 v47,v236,v237
M v[104:107],a[252:255],a[220:223],v[104:107]
v_fmac_f32 v236,4.0,v237
v_fma_f32 v237,2.0,v143,v238
M v[108:111],a[252:255],a[192:195],v[108:111]
v_fma_f32 v143,s41,v143,v238
v_cvt_pk_bf16_f32 v233,v233,v237
M v[112:115],a[252:255],a[196:199],v[112:115]
v_cvt_pk_bf16_f32 v235,v235,v236
M v[116:119],a[252:255],a[200:203],v[116:119]
ds_write2st64_b64 v253,v[232:233],v[234:235] offset0:59 offset1:63
M v[120:123],a[252:255],a[204:207],v[120:123]
s_waitcnt lgkmcnt(2)
v_add_u32 v249,0x15400,v249
v_add_u32 v250,0x15400,v250
M v[124:127],a[252:255],a[208:211],v[124:127]
s_waitcnt vmcnt(10)
buffer_load_dwordx4 a[252:255],v251,s[20:23],s46 offen offset:1024
M v[96:99],v[216:219],a[216:219],v[96:99]
ds_read_b128 a[216:219],v249 offset:0
v_cvt_pk_bf16_f32 v0,v0,v1
M v[100:103],v[216:219],a[220:223],v[100:103]
ds_read_b128 a[220:223],v250 offset:256
v_cvt_pk_bf16_f32 v1,v2,v3
M v[104:107],v[216:219],a[192:195],v[104:107]
ds_read_b128 a[192:195],v250 offset:512
v_cvt_pk_bf16_f32 v4,v4,v5
M v[108:111],v[216:219],a[196:199],v[108:111]
ds_read_b128 a[196:199],v250 offset:768
v_cvt_pk_bf16_f32 v5,v6,v7
M v[112:115],v[216:219],a[200:203],v[112:115]
s_waitcnt lgkmcnt(4)
s_barrier
ds_read_b128 a[32:35],v251 offset:17408
M v[116:119],v[216:219],a[204:207],v[116:119]
ds_read_b128 a[36:39],v251 offset:21504
ds_read_b128 a[40:43],v251 offset:26112
M v[120:123],v[216:219],a[208:211],v[120:123]
ds_read_b128 a[44:47],v251 offset:30208
ds_read_b128 a[200:203],v250 offset:1024
M v[124:127],v[216:219],a[212:215],v[124:127]
s_waitcnt vmcnt(10) lgkmcnt(8)
buffer_load_dwordx4 v[216:219],v251,s[20:23],s46 offen offset:2048
M v[96:99],v[220:223],a[216:219],v[96:99]
s_waitcnt lgkmcnt(7)
ds_read_b128 a[204:207],v250 offset:1280
ds_read_b128 a[208:211],v250 offset:1536
M v[100:103],v[220:223],a[220:223],v[100:103]
s_waitcnt lgkmcnt(6)
s_add_u32 s34,s32,0
buffer_store_dwordx4 a[32:35],v252,s[24:27],s34 offen offset:512 nt
M v[104:107],v[220:223],a[192:195],v[104:107]
s_waitcnt lgkmcnt(5)
s_add_u32 s34,s32,196608
buffer_store_dwordx4 a[36:39],v252,s[24:27],s34 offen offset:512 nt
ds_read_b128 a[212:215],v250 offset:1792
M v[108:111],v[220:223],a[196:199],v[108:111]
s_waitcnt lgkmcnt(3)
s_add_u32 s34,s32,393216
buffer_store_dwordx4 a[40:43],v252,s[24:27],s34 offen offset:512 nt
M v[112:115],v[220:223],a[200:203],v[112:115]
s_waitcnt lgkmcnt(2)
s_add_u32 s34,s32,589824
buffer_store_dwordx4 a[44:47],v252,s[24:27],s34 offen offset:512 nt
M v[116:119],v[220:223],a[204:207],v[116:119]
s_waitcnt lgkmcnt(1)
s_add_u32 s46,s81,46080
ds_read_b128 a[216:219],v250 offset:2048
ds_write2st64_b64 v253,v[0:1],v[4:5] offset0:119 offset1:123
M v[120:123],v[220:223],a[208:211],v[120:123]
s_waitcnt lgkmcnt(2)
v_cvt_pk_bf16_f32 v8,v8,v9
v_cvt_pk_bf16_f32 v9,v10,v11
M v[124:127],v[220:223],a[212:215],v[124:127]
s_waitcnt vmcnt(14)
buffer_load_dwordx4 v[220:223],v251,s[20:23],s46 offen offset:0
M v[96:99],v[224:227],a[220:223],v[96:99]
ds_read_b128 a[220:223],v249 offset:2304
v_cvt_pk_bf16_f32 v12,v12,v13
M v[100:103],v[224:227],a[192:195],v[100:103]
v_cvt_pk_bf16_f32 v13,v14,v15
M v[104:107],v[224:227],a[196:199],v[104:107]
ds_write2st64_b64 v253,v[8:9],v[12:13] offset0:127 offset1:131
M v[108:111],v[224:227],a[200:203],v[108:111]
v_cvt_pk_bf16_f32 v16,v16,v17
v_cvt_pk_bf16_f32 v17,v18,v19
M v[112:115],v[224:227],a[204:207],v[112:115]
v_cvt_pk_bf16_f32 v20,v20,v21
v_cvt_pk_bf16_f32 v21,v22,v23
M v[116:119],v[224:227],a[208:211],v[116:119]
ds_write2st64_b64 v253,v[16:17],v[20:21] offset0:68 offset1:72
M v[120:123],v[224:227],a[212:215],v[120:123]
s_waitcnt lgkmcnt(4)
v_cvt_pk_bf16_f32 v24,v24,v25
v_cvt_pk_bf16_f32 v25,v26,v27
M v[124:127],v[224:227],a[216:219],v[124:127]
s_waitcnt vmcnt(14)
buffer_load_dwordx4 v[224:227],v251,s[20:23],s46 offen offset:1024
M v[96:99],v[228:231],a[192:195],v[96:99]
ds_read_b128 a[192:195],v249 offset:17408
v_cvt_pk_bf16_f32 v28,v28,v29
M v[100:103],v[228:231],a[196:199],v[100:103]
ds_read_b128 a[196:199],v250 offset:17664
v_cvt_pk_bf16_f32 v29,v30,v31
M v[104:107],v[228:231],a[200:203],v[104:107]
ds_read_b128 a[200:203],v250 offset:17920
ds_write2st64_b64 v253,v[24:25],v[28:29] offset0:76 offset1:80
M v[108:111],v[228:231],a[204:207],v[108:111]
ds_read_b128 a[204:207],v250 offset:18176
v_accvgpr_read_b32 v238,a48
M v[112:115],v[228:231],a[208:211],v[112:115]
ds_read_b128 a[208:211],v250 offset:18432
v_accvgpr_read_b32 v232,a144
M v[116:119],v[228:231],a[212:215],v[116:119]
ds_read_b128 a[212:215],v250 offset:18688
v_add_f32 v234,v238,v232
M v[120:123],v[228:231],a[216:219],v[120:123]
s_waitcnt lgkmcnt(9)
ds_read_b128 a[216:219],v250 offset:18944
v_sub_f32 v238,v238,v232
M v[124:127],v[228:231],a[220:223],v[124:127]
s_waitcnt vmcnt(14) lgkmcnt(7)
buffer_load_dwordx4 v[228:231],v251,s[20:23],s46 offen offset:2048
M v[96:99],a[224:227],a[192:195],v[96:99]
s_waitcnt lgkmcnt(6)
ds_read_b128 a[220:223],v250 offset:19200
ds_read_b128 a[192:195],v250 offset:19456
M v[100:103],a[224:227],a[196:199],v[100:103]
s_waitcnt lgkmcnt(7)
s_add_u32 s47,s76,3072
v_add_f32 v232,v48,v144
v_sub_f32 v144,v48,v144
M v[104:107],a[224:227],a[200:203],v[104:107]
s_waitcnt lgkmcnt(5)
v_add_f32 v48,v234,v232
v_fmac_f32 v234,4.0,v232
M v[108:111],a[224:227],a[204:207],v[108:111]
s_waitcnt lgkmcnt(4)
v_fma_f32 v232,2.0,v144,v238
v_fma_f32 v144,s41,v144,v238
M v[112:115],a[224:227],a[208:211],v[112:115]
s_waitcnt lgkmcnt(3)
v_accvgpr_read_b32 v238,a49
v_accvgpr_read_b32 v237,a145
M v[116:119],a[224:227],a[212:215],v[116:119]
s_waitcnt lgkmcnt(2)
v_add_f32 v236,v238,v237
v_sub_f32 v238,v238,v237
M v[120:123],a[224:227],a[216:219],v[120:123]
s_waitcnt lgkmcnt(1)
v_add_f32 v237,v49,v145
v_sub_f32 v145,v49,v145
M v[124:127],a[224:227],a[220:223],v[124:127]
s_waitcnt vmcnt(14)
buffer_load_dwordx4 a[224:227],v251,s[20:23],s47 offen offset:0
M v[96:99],a[228:231],a[196:199],v[96:99]
ds_read_b128 a[196:199],v249 offset:19712
v_add_f32 v49,v236,v237
M v[100:103],a[228:231],a[200:203],v[100:103]
v_fmac_f32 v236,4.0,v237
v_fma_f32 v237,2.0,v145,v238
M v[104:107],a[228:231],a[204:207],v[104:107]
v_fma_f32 v145,s41,v145,v238
v_cvt_pk_bf16_f32 v232,v232,v237
M v[108:111],a[228:231],a[208:211],v[108:111]
v_cvt_pk_bf16_f32 v234,v234,v236
v_accvgpr_read_b32 v238,a50
M v[112:115],a[228:231],a[212:215],v[112:115]
v_accvgpr_read_b32 v233,a146
v_add_f32 v235,v238,v233
M v[116:119],a[228:231],a[216:219],v[116:119]
v_sub_f32 v238,v238,v233
v_add_f32 v233,v50,v146
M v[120:123],a[228:231],a[220:223],v[120:123]
s_waitcnt lgkmcnt(1)
v_sub_f32 v146,v50,v146
v_add_f32 v50,v235,v233
M v[124:127],a[228:231],a[192:195],v[124:127]
s_waitcnt vmcnt(14)
buffer_load_dwordx4 a[228:231],v251,s[20:23],s47 offen offset:1024
M v[96:99],a[232:235],a[200:203],v[96:99]
ds_read_b128 a[200:203],v249 offset:34816
v_fmac_f32 v235,4.0,v233
M v[100:103],a[232:235],a[204:207],v[100:103]
ds_read_b128 a[204:207],v250 offset:35072
v_fma_f32 v233,2.0,v146,v238
M v[104:107],a[232:235],a[208:211],v[104:107]
ds_read_b128 a[208:211],v250 offset:35328
v_fma_f32 v146,s41,v146,v238
M v[108:111],a[232:235],a[212:215],v[108:111]
ds_read_b128 a[212:215],v250 offset:35584
v_accvgpr_read_b32 v238,a51
M v[112:115],a[232:235],a[216:219],v[112:115]
ds_read_b128 a[216:219],v250 offset:35840
v_accvgpr_read_b32 v237,a147
M v[116:119],a[232:235],a[220:223],v[116:119]
ds_read_b128 a[220:223],v250 offset:36096
v_add_f32 v236,v238,v237
M v[120:123],a[232:235],a[192:195],v[120:123]
s_waitcnt lgkmcnt(6)
ds_read_b128 a[192:195],v250 offset:36352
v_sub_f32 v238,v238,v237
M v[124:127],a[232:235],a[196:199],v[124:127]
s_waitcnt vmcnt(14) lgkmcnt(6)
buffer_load_dwordx4 a[232:235],v251,s[20:23],s47 offen offset:2048
M v[96:99],a[236:239],a[200:203],v[96:99]
s_waitcnt lgkmcnt(5)
ds_read_b128 a[196:199],v250 offset:36608
ds_read_b128 a[200:203],v250 offset:36864
M v[100:103],a[236:239],a[204:207],v[100:103]
s_waitcnt lgkmcnt(6)
s_add_u32 s47,s77,3072
v_add_f32 v237,v51,v147
v_sub_f32 v147,v51,v147
M v[104:107],a[236:239],a[208:211],v[104:107]
s_waitcnt lgkmcnt(5)
v_add_f32 v51,v236,v237
v_fmac_f32 v236,4.0,v237
M v[108:111],a[236:239],a[212:215],v[108:111]
s_waitcnt lgkmcnt(4)
v_fma_f32 v237,2.0,v147,v238
v_fma_f32 v147,s41,v147,v238
M v[112:115],a[236:239],a[216:219],v[112:115]
s_waitcnt lgkmcnt(3)
v_cvt_pk_bf16_f32 v233,v233,v237
v_cvt_pk_bf16_f32 v235,v235,v236
M v[116:119],a[236:239],a[220:223],v[116:119]
s_waitcnt lgkmcnt(2)
ds_write2st64_b64 v253,v[232:233],v[234:235] offset0:85 offset1:89
M v[120:123],a[236:239],a[192:195],v[120:123]
s_waitcnt lgkmcnt(2)
v_accvgpr_read_b32 v238,a52
v_accvgpr_read_b32 v232,a148
M v[124:127],a[236:239],a[196:199],v[124:127]
s_waitcnt vmcnt(14)
buffer_load_dwordx4 a[236:239],v251,s[20:23],s47 offen offset:0
M v[96:99],a[240:243],a[204:207],v[96:99]
ds_read_b128 a[204:207],v249 offset:37120
v_add_f32 v234,v238,v232
M v[100:103],a[240:243],a[208:211],v[100:103]
v_sub_f32 v238,v238,v232
v_add_f32 v232,v52,v148
M v[104:107],a[240:243],a[212:215],v[104:107]
v_sub_f32 v148,v52,v148
v_add_f32 v52,v234,v232
M v[108:111],a[240:243],a[216:219],v[108:111]
v_fmac_f32 v234,4.0,v232
v_fma_f32 v232,2.0,v148,v238
M v[112:115],a[240:243],a[220:223],v[112:115]
v_fma_f32 v148,s41,v148,v238
v_accvgpr_read_b32 v238,a53
M v[116:119],a[240:243],a[192:195],v[116:119]
v_accvgpr_read_b32 v237,a149
v_add_f32 v236,v238,v237
M v[120:123],a[240:243],a[196:199],v[120:123]
s_waitcnt lgkmcnt(2)
v_sub_f32 v238,v238,v237
v_add_f32 v237,v53,v149
M v[124:127],a[240:243],a[200:203],v[124:127]
s_waitcnt vmcnt(14)
buffer_load_dwordx4 a[240:243],v251,s[20:23],s47 offen offset:1024
M v[96:99],a[244:247],a[208:211],v[96:99]
ds_read_b128 a[208:211],v249 offset:52224
v_sub_f32 v149,v53,v149
M v[100:103],a[244:247],a[212:215],v[100:103]
ds_read_b128 a[212:215],v250 offset:52480
v_add_f32 v53,v236,v237
M v[104:107],a[244:247],a[216:219],v[104:107]
ds_read_b128 a[216:219],v250 offset:52736
v_fmac_f32 v236,4.0,v237
M v[108:111],a[244:247],a[220:223],v[108:111]
ds_read_b128 a[220:223],v250 offset:52992
v_fma_f32 v237,2.0,v149,v238
M v[112:115],a[244:247],a[192:195],v[112:115]
ds_read_b128 a[192:195],v250 offset:53248
v_fma_f32 v149,s41,v149,v238
M v[116:119],a[244:247],a[196:199],v[116:119]
ds_read_b128 a[196:199],v250 offset:53504
v_cvt_pk_bf16_f32 v232,v232,v237
M v[120:123],a[244:247],a[200:203],v[120:123]
s_waitcnt lgkmcnt(6)
ds_read_b128 a[200:203],v250 offset:53760
v_cvt_pk_bf16_f32 v234,v234,v236
M v[124:127],a[244:247],a[204:207],v[124:127]
s_waitcnt vmcnt(14) lgkmcnt(6)
buffer_load_dwordx4 a[244:247],v251,s[20:23],s47 offen offset:2048
M v[96:99],a[248:251],a[208:211],v[96:99]
s_waitcnt lgkmcnt(5)
ds_read_b128 a[204:207],v250 offset:54016
ds_read_b128 a[208:211],v250 offset:54272
M v[100:103],a[248:251],a[212:215],v[100:103]
s_waitcnt lgkmcnt(6)
s_add_u32 s47,s78,3072
v_accvgpr_read_b32 v238,a54
v_accvgpr_read_b32 v233,a150
M v[104:107],a[248:251],a[216:219],v[104:107]
s_waitcnt lgkmcnt(5)
v_add_f32 v235,v238,v233
v_sub_f32 v238,v238,v233
M v[108:111],a[248:251],a[220:223],v[108:111]
s_waitcnt lgkmcnt(4)
v_add_f32 v233,v54,v150
v_sub_f32 v150,v54,v150
M v[112:115],a[248:251],a[192:195],v[112:115]
s_waitcnt lgkmcnt(3)
v_add_f32 v54,v235,v233
v_fmac_f32 v235,4.0,v233
M v[116:119],a[248:251],a[196:199],v[116:119]
s_waitcnt lgkmcnt(2)
v_fma_f32 v233,2.0,v150,v238
v_fma_f32 v150,s41,v150,v238
M v[120:123],a[248:251],a[200:203],v[120:123]
s_waitcnt lgkmcnt(1)
v_accvgpr_read_b32 v238,a55
v_accvgpr_read_b32 v237,a151
M v[124:127],a[248:251],a[204:207],v[124:127]
s_waitcnt vmcnt(14)
buffer_load_dwordx4 a[248:251],v251,s[20:23],s47 offen offset:0
M v[96:99],a[252:255],a[212:215],v[96:99]
ds_read_b128 a[212:215],v249 offset:54528
v_add_f32 v236,v238,v237
M v[100:103],a[252:255],a[216:219],v[100:103]
v_sub_f32 v238,v238,v237
v_add_f32 v237,v55,v151
M v[104:107],a[252:255],a[220:223],v[104:107]
v_sub_f32 v151,v55,v151
v_add_f32 v55,v236,v237
M v[108:111],a[252:255],a[192:195],v[108:111]
v_fmac_f32 v236,4.0,v237
v_fma_f32 v237,2.0,v151,v238
M v[112:115],a[252:255],a[196:199],v[112:115]
v_fma_f32 v151,s41,v151,v238
v_cvt_pk_bf16_f32 v233,v233,v237
M v[116:119],a[252:255],a[200:203],v[116:119]
v_add_u32 v249,0xffffbc00,v249
v_add_u32 v250,0xffffbc00,v250
M v[120:123],a[252:255],a[204:207],v[120:123]
s_waitcnt lgkmcnt(1)
v_cvt_pk_bf16_f32 v235,v235,v236
M v[124:127],a[252:255],a[208:211],v[124:127]
s_waitcnt vmcnt(14)
buffer_load_dwordx4 a[252:255],v251,s[20:23],s47 offen offset:1024
M v[96:99],v[216:219],a[216:219],v[96:99]
ds_read_b128 a[216:219],v249 offset:0
ds_write2st64_b64 v253,v[232:233],v[234:235] offset0:93 offset1:97
M v[100:103],v[216:219],a[220:223],v[100:103]
ds_read_b128 a[220:223],v250 offset:256
v_accvgpr_read_b32 v238,a56
M v[104:107],v[216:219],a[192:195],v[104:107]
ds_read_b128 a[192:195],v250 offset:512
v_accvgpr_read_b32 v232,a152
M v[108:111],v[216:219],a[196:199],v[108:111]
ds_read_b128 a[196:199],v250 offset:768
v_add_f32 v234,v238,v232
M v[112:115],v[216:219],a[200:203],v[112:115]
ds_read_b128 a[200:203],v250 offset:1024
v_sub_f32 v238,v238,v232
M v[116:119],v[216:219],a[204:207],v[116:119]
ds_read_b128 a[204:207],v250 offset:1280
v_add_f32 v232,v56,v152
M v[120:123],v[216:219],a[208:211],v[120:123]
s_waitcnt lgkmcnt(7)
ds_read_b128 a[208:211],v250 offset:1536
v_sub_f32 v152,v56,v152
M v[124:127],v[216:219],a[212:215],v[124:127]
s_waitcnt vmcnt(10) lgkmcnt(6)
s_barrier
ds_read_b128 a[96:99],v251 offset:60928
M v[96:99],v[220:223],a[216:219],v[96:99]
s_waitcnt lgkmcnt(6)
ds_read_b128 a[100:103],v251 offset:65024
ds_read_b128 a[104:107],v251 offset:34816
M v[100:103],v[220:223],a[220:223],v[100:103]
s_waitcnt lgkmcnt(7)
ds_read_b128 a[108:111],v251 offset:38912
ds_read_b128 a[48:51],v251 offset:43520
M v[104:107],v[220:223],a[192:195],v[104:107]
s_waitcnt lgkmcnt(8)
ds_read_b128 a[52:55],v251 offset:47616
ds_read_b128 a[212:215],v250 offset:1792
M v[108:111],v[220:223],a[196:199],v[108:111]
s_waitcnt lgkmcnt(9)
buffer_load_dwordx4 v[216:219],v251,s[20:23],s47 offen offset:2048
M v[112:115],v[220:223],a[200:203],v[112:115]
s_waitcnt lgkmcnt(6)
s_add_u32 s34,s33,0
buffer_store_dwordx4 a[96:99],v252,s[24:27],s34 offen offset:0 nt
M v[116:119],v[220:223],a[204:207],v[116:119]
s_waitcnt lgkmcnt(5)
s_add_u32 s34,s33,393216
buffer_store_dwordx4 a[100:103],v252,s[24:27],s34 offen offset:0 nt
M v[120:123],v[220:223],a[208:211],v[120:123]
s_waitcnt lgkmcnt(0)
s_add_u32 s34,s33,786432
buffer_store_dwordx4 a[104:107],v252,s[24:27],s34 offen offset:0 nt
M v[124:127],v[220:223],a[212:215],v[124:127]
s_waitcnt vmcnt(13)
s_add_u32 s34,s33,1179648
buffer_store_dwordx4 a[108:111],v252,s[24:27],s34 offen offset:0 nt
M v[96:99],v[224:227],a[220:223],v[96:99]
s_nop 0
s_add_u32 s34,s32,786432
buffer_store_dwordx4 a[48:51],v252,s[24:27],s34 offen offset:512 nt
v_add_f32 v56,v234,v232
v_fmac_f32 v234,4.0,v232
v_fma_f32 v232,2.0,v152,v238
M v[100:103],v[224:227],a[192:195],v[100:103]
s_add_u32 s47,s79,3072
buffer_load_dwordx4 v[220:223],v251,s[20:23],s47 offen offset:0
v_fma_f32 v152,s41,v152,v238
v_accvgpr_read_b32 v238,a57
v_accvgpr_read_b32 v237,a153
v_add_f32 v236,v238,v237
M v[104:107],v[224:227],a[196:199],v[104:107]
ds_read_b128 a[216:219],v250 offset:2048
ds_read_b128 a[220:223],v249 offset:2304
v_sub_f32 v238,v238,v237
v_add_f32 v237,v57,v153
v_sub_f32 v153,v57,v153
v_add_f32 v57,v236,v237
M v[108:111],v[224:227],a[200:203],v[108:111]
v_fmac_f32 v236,4.0,v237
v_fma_f32 v237,2.0,v153,v238
v_fma_f32 v153,s41,v153,v238
v_cvt_pk_bf16_f32 v232,v232,v237
M v[112:115],v[224:227],a[204:207],v[112:115]
v_cvt_pk_bf16_f32 v234,v234,v236
v_accvgpr_read_b32 v238,a58
v_accvgpr_read_b32 v233,a154
v_add_f32 v235,v238,v233
M v[116:119],v[224:227],a[208:211],v[116:119]
v_sub_f32 v238,v238,v233
v_add_f32 v233,v58,v154
v_sub_f32 v154,v58,v154
v_add_f32 v58,v235,v233
M v[120:123],v[224:227],a[212:215],v[120:123]
s_waitcnt lgkmcnt(1)
v_add_u32 v249,0xfffece00,v249
v_add_u32 v250,0xfffece00,v250
v_fmac_f32 v235,4.0,v233
v_fma_f32 v233,2.0,v154,v238
v_fma_f32 v154,s41,v154,v238
v_accvgpr_read_b32 v238,a59
M v[124:127],v[224:227],a[216:219],v[124:127]
s_waitcnt vmcnt(15)
buffer_load_dwordx4 v[224:227],v251,s[20:23],s47 offen offset:1024
v_accvgpr_read_b32 v237,a155
v_add_f32 v236,v238,v237
v_sub_f32 v238,v238,v237
v_add_f32 v237,v59,v155
M v[96:99],v[228:231],a[192:195],v[96:99]
ds_read_b128 a[192:195],v249 offset:0
v_sub_f32 v155,v59,v155
v_add_f32 v59,v236,v237
v_fmac_f32 v236,4.0,v237
v_fma_f32 v237,2.0,v155,v238
M v[100:103],v[228:231],a[196:199],v[100:103]
ds_read_b128 a[196:199],v250 offset:256
v_fma_f32 v155,s41,v155,v238
v_cvt_pk_bf16_f32 v233,v233,v237
v_cvt_pk_bf16_f32 v235,v235,v236
M v[104:107],v[228:231],a[200:203],v[104:107]
ds_write2st64_b64 v253,v[232:233],v[234:235] offset0:34 offset1:38
M v[108:111],v[228:231],a[204:207],v[108:111]
ds_read_b128 a[200:203],v250 offset:512
ds_read_b128 a[204:207],v250 offset:768
v_accvgpr_read_b32 v238,a60
v_accvgpr_read_b32 v232,a156
M v[112:115],v[228:231],a[208:211],v[112:115]
ds_read_b128 a[208:211],v250 offset:1024
v_add_f32 v234,v238,v232
v_sub_f32 v238,v238,v232
v_add_f32 v232,v60,v156
v_sub_f32 v156,v60,v156
M v[116:119],v[228:231],a[212:215],v[116:119]
ds_read_b128 a[212:215],v250 offset:1280
v_add_f32 v60,v234,v232
v_fmac_f32 v234,4.0,v232
v_fma_f32 v232,2.0,v156,v238
v_fma_f32 v156,s41,v156,v238
M v[120:123],v[228:231],a[216:219],v[120:123]
s_waitcnt lgkmcnt(7)
ds_read_b128 a[216:219],v250 offset:1536
v_accvgpr_read_b32 v238,a61
v_accvgpr_read_b32 v237,a157
v_add_f32 v236,v238,v237
v_sub_f32 v238,v238,v237
M v[124:127],v[228:231],a[220:223],v[124:127]
s_waitcnt vmcnt(15) lgkmcnt(7)
s_add_u32 s34,s32,983040
buffer_load_dwordx4 v[228:231],v251,s[20:23],s47 offen offset:2048
v_add_f32 v237,v61,v157
v_sub_f32 v157,v61,v157
v_add_f32 v61,v236,v237
v_fmac_f32 v236,4.0,v237
M v[32:35],a[224:227],a[192:195],v[32:35]
s_waitcnt lgkmcnt(6)
buffer_store_dwordx4 a[52:55],v252,s[24:27],s34 offen offset:512 nt
v_fma_f32 v237,2.0,v157,v238
v_fma_f32 v157,s41,v157,v238
v_cvt_pk_bf16_f32 v232,v232,v237
v_cvt_pk_bf16_f32 v234,v234,v236
M v[36:39],a[224:227],a[196:199],v[36:39]
s_waitcnt lgkmcnt(4)
s_add_u32 s47,s80,3072
ds_read_b128 a[220:223],v250 offset:1792
ds_read_b128 a[192:195],v250 offset:2048
v_accvgpr_read_b32 v238,a62
v_accvgpr_read_b32 v233,a158
v_add_f32 v235,v238,v233
v_sub_f32 v238,v238,v233
M v[40:43],a[224:227],a[200:203],v[40:43]
s_waitcnt lgkmcnt(5)
v_add_f32 v233,v62,v158
v_sub_f32 v158,v62,v158
v_add_f32 v62,v235,v233
v_fmac_f32 v235,4.0,v233
M v[44:47],a[224:227],a[204:207],v[44:47]
s_waitcnt lgkmcnt(4)
v_fma_f32 v233,2.0,v158,v238
v_fma_f32 v158,s41,v158,v238
v_accvgpr_read_b32 v238,a63
v_accvgpr_read_b32 v237,a159
M v[48:51],a[224:227],a[208:211],v[48:51]
s_waitcnt lgkmcnt(3)
v_add_f32 v236,v238,v237
v_sub_f32 v238,v238,v237
v_add_f32 v237,v63,v159
v_sub_f32 v159,v63,v159
M v[52:55],a[224:227],a[212:215],v[52:55]
s_waitcnt lgkmcnt(2)
v_add_f32 v63,v236,v237
v_fmac_f32 v236,4.0,v237
M v[56:59],a[224:227],a[216:219],v[56:59]
s_waitcnt lgkmcnt(1)
v_fma_f32 v237,2.0,v159,v238
v_fma_f32 v159,s41,v159,v238
M v[60:63],a[224:227],a[220:223],v[60:63]
s_waitcnt vmcnt(16)
buffer_load_dwordx4 a[224:227],v251,s[20:23],s47 offen offset:0
M v[32:35],a[228:231],a[196:199],v[32:35]
ds_read_b128 a[196:199],v249 offset:2304
v_cvt_pk_bf16_f32 v233,v233,v237
M v[36:39],a[228:231],a[200:203],v[36:39]
v_cvt_pk_bf16_f32 v235,v235,v236
M v[40:43],a[228:231],a[204:207],v[40:43]
ds_write2st64_b64 v253,v[232:233],v[234:235] offset0:42 offset1:46
M v[44:47],a[228:231],a[208:211],v[44:47]
v_cvt_pk_bf16_f32 v96,v96,v97
v_cvt_pk_bf16_f32 v97,v98,v99
M v[48:51],a[228:231],a[212:215],v[48:51]
v_cvt_pk_bf16_f32 v100,v100,v101
v_cvt_pk_bf16_f32 v101,v102,v103
M v[52:55],a[228:231],a[216:219],v[52:55]
ds_write2st64_b64 v253,v[96:97],v[100:101] offset0:51 offset1:55
M v[56:59],a[228:231],a[220:223],v[56:59]
s_waitcnt lgkmcnt(3)
v_add_u32 v249,0x15400,v249
v_add_u32 v250,0x15400,v250
M v[60:63],a[228:231],a[192:195],v[60:63]
s_waitcnt vmcnt(16)
buffer_load_dwordx4 a[228:231],v251,s[20:23],s47 offen offset:1024
M v[32:35],a[232:235],a[200:203],v[32:35]
ds_read_b128 a[200:203],v249 offset:0
v_cvt_pk_bf16_f32 v104,v104,v105
M v[36:39],a[232:235],a[204:207],v[36:39]
ds_read_b128 a[204:207],v250 offset:256
v_cvt_pk_bf16_f32 v105,v106,v107
M v[40:43],a[232:235],a[208:211],v[40:43]
ds_read_b128 a[208:211],v250 offset:512
v_cvt_pk_bf16_f32 v108,v108,v109
M v[44:47],a[232:235],a[212:215],v[44:47]
ds_read_b128 a[212:215],v250 offset:768
v_cvt_pk_bf16_f32 v109,v110,v111
M v[48:51],a[232:235],a[216:219],v[48:51]
ds_read_b128 a[216:219],v250 offset:1024
ds_write2st64_b64 v253,v[104:105],v[108:109] offset0:59 offset1:63
M v[52:55],a[232:235],a[220:223],v[52:55]
ds_read_b128 a[220:223],v250 offset:1280
v_cvt_pk_bf16_f32 v112,v112,v113
M v[56:59],a[232:235],a[192:195],v[56:59]
s_waitcnt lgkmcnt(9)
ds_read_b128 a[192:195],v250 offset:1536
v_cvt_pk_bf16_f32 v113,v114,v115
M v[60:63],a[232:235],a[196:199],v[60:63]
s_waitcnt vmcnt(16) lgkmcnt(7)
buffer_load_dwordx4 a[232:235],v251,s[20:23],s47 offen offset:2048
M v[32:35],a[236:239],a[200:203],v[32:35]
s_waitcnt lgkmcnt(6)
ds_read_b128 a[196:199],v250 offset:1792
ds_read_b128 a[200:203],v250 offset:2048
M v[36:39],a[236:239],a[204:207],v[36:39]
s_waitcnt lgkmcnt(7)
s_add_u32 s47,s81,3072
v_cvt_pk_bf16_f32 v116,v116,v117
v_cvt_pk_bf16_f32 v117,v118,v119
M v[40:43],a[236:239],a[208:211],v[40:43]
s_waitcnt lgkmcnt(6)
ds_write2st64_b64 v253,v[112:113],v[116:117] offset0:102 offset1:106
M v[44:47],a[236:239],a[212:215],v[44:47]
s_waitcnt lgkmcnt(6)
v_cvt_pk_bf16_f32 v120,v120,v121
v_cvt_pk_bf16_f32 v121,v122,v123
M v[48:51],a[236:239],a[216:219],v[48:51]
s_waitcnt lgkmcnt(4)
v_cvt_pk_bf16_f32 v124,v124,v125
v_cvt_pk_bf16_f32 v125,v126,v127
M v[52:55],a[236:239],a[220:223],v[52:55]
s_waitcnt lgkmcnt(3)
ds_write2st64_b64 v253,v[120:121],v[124:125] offset0:110 offset1:114
M v[56:59],a[236:239],a[192:195],v[56:59]
s_waitcnt lgkmcnt(3)
v_accvgpr_read_b32 v238,a64
v_accvgpr_read_b32 v232,a160
M v[60:63],a[236:239],a[196:199],v[60:63]
s_waitcnt vmcnt(16)
buffer_load_dwordx4 a[236:239],v251,s[20:23],s47 offen offset:0
M v[32:35],a[240:243],a[204:207],v[32:35]
ds_read_b128 a[204:207],v249 offset:2304
v_add_f32 v234,v238,v232
M v[36:39],a[240:243],a[208:211],v[36:39]
v_sub_f32 v238,v238,v232
v_add_f32 v232,v64,v160
M v[40:43],a[240:243],a[212:215],v[40:43]
v_sub_f32 v160,v64,v160
M v[44:47],a[240:243],a[216:219],v[44:47]
s_waitcnt lgkmcnt(1)
s_barrier
ds_read_b128 a[56:59],v251 offset:17408
M v[48:51],a[240:243],a[220:223],v[48:51]
ds_read_b128 a[60:63],v251 offset:21504
ds_read_b128 a[112:115],v251 offset:26112
M v[52:55],a[240:243],a[192:195],v[52:55]
ds_read_b128 a[116:119],v251 offset:30208
ds_read_b128 a[120:123],v251 offset:52224
M v[56:59],a[240:243],a[196:199],v[56:59]
ds_read_b128 a[124:127],v251 offset:56320
v_add_f32 v64,v234,v232
M v[60:63],a[240:243],a[200:203],v[60:63]
s_waitcnt vmcnt(16)
buffer_load_dwordx4 a[240:243],v251,s[20:23],s47 offen offset:1024
M v[32:35],a[244:247],a[208:211],v[32:35]
s_waitcnt lgkmcnt(5)
s_add_u32 s34,s32,1179648
buffer_store_dwordx4 a[56:59],v252,s[24:27],s34 offen offset:512 nt
M v[36:39],a[244:247],a[212:215],v[36:39]
ds_read_b128 a[208:211],v249 offset:17408
ds_read_b128 a[212:215],v250 offset:17664
M v[40:43],a[244:247],a[216:219],v[40:43]
ds_read_b128 a[216:219],v250 offset:17920
v_fmac_f32 v234,4.0,v232
M v[44:47],a[244:247],a[220:223],v[44:47]
ds_read_b128 a[220:223],v250 offset:18176
v_fma_f32 v232,2.0,v160,v238
M v[48:51],a[244:247],a[192:195],v[48:51]
ds_read_b128 a[192:195],v250 offset:18432
v_fma_f32 v160,s41,v160,v238
M v[52:55],a[244:247],a[196:199],v[52:55]
ds_read_b128 a[196:199],v250 offset:18688
v_accvgpr_read_b32 v238,a65
M v[56:59],a[244:247],a[200:203],v[56:59]
ds_read_b128 a[200:203],v250 offset:18944
v_accvgpr_read_b32 v237,a161
M v[60:63],a[244:247],a[204:207],v[60:63]
s_waitcnt vmcnt(17) lgkmcnt(6)
buffer_load_dwordx4 a[244:247],v251,s[20:23],s47 offen offset:2048
M v[32:35],a[248:251],a[208:211],v[32:35]
s_waitcnt lgkmcnt(5)
ds_read_b128 a[204:207],v250 offset:19200
ds_read_b128 a[208:211],v250 offset:19456
M v[36:39],a[248:251],a[212:215],v[36:39]
s_waitcnt lgkmcnt(6)
s_add_u32 s47,s76,49152
s_add_u32 s34,s32,1376256
v_add_f32 v236,v238,v237
M v[40:43],a[248:251],a[216:219],v[40:43]
s_waitcnt lgkmcnt(5)
buffer_store_dwordx4 a[60:63],v252,s[24:27],s34 offen offset:512 nt
M v[44:47],a[248:251],a[220:223],v[44:47]
s_waitcnt lgkmcnt(4)
v_sub_f32 v238,v238,v237
v_add_f32 v237,v65,v161
M v[48:51],a[248:251],a[192:195],v[48:51]
s_waitcnt lgkmcnt(3)
v_sub_f32 v161,v65,v161
v_add_f32 v65,v236,v237
M v[52:55],a[248:251],a[196:199],v[52:55]
s_waitcnt lgkmcnt(2)
v_fmac_f32 v236,4.0,v237
v_fma_f32 v237,2.0,v161,v238
M v[56:59],a[248:251],a[200:203],v[56:59]
s_waitcnt lgkmcnt(1)
v_fma_f32 v161,s41,v161,v238
v_cvt_pk_bf16_f32 v232,v232,v237
M v[60:63],a[248:251],a[204:207],v[60:63]
s_waitcnt vmcnt(18)
buffer_load_dwordx4 a[248:251],v251,s[20:23],s47 offen offset:0
M v[32:35],a[252:255],a[212:215],v[32:35]
ds_read_b128 a[212:215],v249 offset:19712
v_cvt_pk_bf16_f32 v234,v234,v236
M v[36:39],a[252:255],a[216:219],v[36:39]
v_accvgpr_read_b32 v238,a66
v_accvgpr_read_b32 v233,a162
M v[40:43],a[252:255],a[220:223],v[40:43]
v_add_f32 v235,v238,v233
v_sub_f32 v238,v238,v233
M v[44:47],a[252:255],a[192:195],v[44:47]
v_add_f32 v233,v66,v162
v_sub_f32 v162,v66,v162
M v[48:51],a[252:255],a[196:199],v[48:51]
v_add_f32 v66,v235,v233
v_fmac_f32 v235,4.0,v233
M v[52:55],a[252:255],a[200:203],v[52:55]
v_fma_f32 v233,2.0,v162,v238
v_fma_f32 v162,s41,v162,v238
M v[56:59],a[252:255],a[204:207],v[56:59]
s_waitcnt lgkmcnt(1)
v_accvgpr_read_b32 v238,a67
v_accvgpr_read_b32 v237,a163
M v[60:63],a[252:255],a[208:211],v[60:63]
s_waitcnt vmcnt(18)
buffer_load_dwordx4 a[252:255],v251,s[20:23],s47 offen offset:1024
M v[32:35],v[216:219],a[216:219],v[32:35]
ds_read_b128 a[216:219],v249 offset:34816
v_add_f32 v236,v238,v237
M v[36:39],v[216:219],a[220:223],v[36:39]
ds_read_b128 a[220:223],v250 offset:35072
v_sub_f32 v238,v238,v237
M v[40:43],v[216:219],a[192:195],v[40:43]
ds_read_b128 a[192:195],v250 offset:35328
v_add_f32 v237,v67,v163
M v[44:47],v[216:219],a[196:199],v[44:47]
ds_read_b128 a[196:199],v250 offset:35584
v_sub_f32 v163,v67,v163
M v[48:51],v[216:219],a[200:203],v[48:51]
ds_read_b128 a[200:203],v250 offset:35840
v_add_f32 v67,v236,v237
M v[52:55],v[216:219],a[204:207],v[52:55]
ds_read_b128 a[204:207],v250 offset:36096
v_fmac_f32 v236,4.0,v237
M v[56:59],v[216:219],a[208:211],v[56:59]
s_waitcnt lgkmcnt(6)
ds_read_b128 a[208:211],v250 offset:36352
v_fma_f32 v237,2.0,v163,v238
M v[60:63],v[216:219],a[212:215],v[60:63]
s_waitcnt vmcnt(13) lgkmcnt(6)
buffer_load_dwordx4 v[216:219],v251,s[20:23],s47 offen offset:2048
M v[32:35],v[220:223],a[216:219],v[32:35]
s_waitcnt lgkmcnt(5)
ds_read_b128 a[212:215],v250 offset:36608
ds_read_b128 a[216:219],v250 offset:36864
M v[36:39],v[220:223],a[220:223],v[36:39]
s_waitcnt lgkmcnt(6)
s_add_u32 s47,s77,49152
v_fma_f32 v163,s41,v163,v238
v_cvt_pk_bf16_f32 v233,v233,v237
M v[40:43],v[220:223],a[192:195],v[40:43]
s_waitcnt lgkmcnt(5)
s_add_u32 s34,s33,0
buffer_store_dwordx4 a[112:115],v252,s[24:27],s34 offen offset:1152 nt
M v[44:47],v[220:223],a[196:199],v[44:47]
s_waitcnt lgkmcnt(4)
v_cvt_pk_bf16_f32 v235,v235,v236
v_add_u32 v0,69632,v251
M v[48:51],v[220:223],a[200:203],v[48:51]
s_waitcnt lgkmcnt(3)
ds_write2st64_b64 v253,v[232:233],v[234:235] offset0:119 offset1:123
M v[52:55],v[220:223],a[204:207],v[52:55]
s_waitcnt lgkmcnt(3)
v_accvgpr_read_b32 v238,a68
v_accvgpr_read_b32 v232,a164
M v[56:59],v[220:223],a[208:211],v[56:59]
s_waitcnt lgkmcnt(2)
v_add_f32 v234,v238,v232
v_sub_f32 v238,v238,v232
M v[60:63],v[220:223],a[212:215],v[60:63]
s_waitcnt vmcnt(14)
buffer_load_dwordx4 v[220:223],v251,s[20:23],s47 offen offset:0
M v[32:35],v[224:227],a[220:223],v[32:35]
ds_read_b128 a[220:223],v249 offset:37120
v_add_f32 v232,v68,v164
M v[36:39],v[224:227],a[192:195],v[36:39]
v_sub_f32 v164,v68,v164
v_add_f32 v68,v234,v232
M v[40:43],v[224:227],a[196:199],v[40:43]
v_fmac_f32 v234,4.0,v232
v_fma_f32 v232,2.0,v164,v238
M v[44:47],v[224:227],a[200:203],v[44:47]
v_fma_f32 v164,s41,v164,v238
v_accvgpr_read_b32 v238,a69
M v[48:51],v[224:227],a[204:207],v[48:51]
v_accvgpr_read_b32 v237,a165
v_add_f32 v236,v238,v237
M v[52:55],v[224:227],a[208:211],v[52:55]
v_sub_f32 v238,v238,v237
v_add_f32 v237,v69,v165
M v[56:59],v[224:227],a[212:215],v[56:59]
s_waitcnt lgkmcnt(2)
v_sub_f32 v165,v69,v165
v_add_f32 v69,v236,v237
M v[60:63],v[224:227],a[216:219],v[60:63]
s_waitcnt vmcnt(14)
buffer_load_dwordx4 v[224:227],v251,s[20:23],s47 offen offset:1024
M v[32:35],v[228:231],a[192:195],v[32:35]
ds_read_b128 a[192:195],v249 offset:52224
v_fmac_f32 v236,4.0,v237
M v[36:39],v[228:231],a[196:199],v[36:39]
ds_read_b128 a[196:199],v250 offset:52480
v_fma_f32 v237,2.0,v165,v238
M v[40:43],v[228:231],a[200:203],v[40:43]
ds_read_b128 a[200:203],v250 offset:52736
v_fma_f32 v165,s41,v165,v238
M v[44:47],v[228:231],a[204:207],v[44:47]
ds_read_b128 a[204:207],v250 offset:52992
v_cvt_pk_bf16_f32 v232,v232,v237
M v[48:51],v[228:231],a[208:211],v[48:51]
ds_read_b128 a[208:211],v250 offset:53248
v_cvt_pk_bf16_f32 v234,v234,v236
M v[52:55],v[228:231],a[212:215],v[52:55]
ds_read_b128 a[212:215],v250 offset:53504
v_accvgpr_read_b32 v238,a70
M v[56:59],v[228:231],a[216:219],v[56:59]
s_waitcnt lgkmcnt(6)
ds_read_b128 a[216:219],v250 offset:53760
v_accvgpr_read_b32 v233,a166
M v[60:63],v[228:231],a[220:223],v[60:63]
s_waitcnt vmcnt(13) lgkmcnt(6)
buffer_load_dwordx4 v[228:231],v251,s[20:23],s47 offen offset:2048
M v[32:35],a[224:227],a[192:195],v[32:35]
s_waitcnt lgkmcnt(5)
ds_read_b128 a[220:223],v250 offset:54016
ds_read_b128 a[192:195],v250 offset:54272
M v[36:39],a[224:227],a[196:199],v[36:39]
s_waitcnt lgkmcnt(6)
s_add_u32 s47,s78,49152
v_add_f32 v235,v238,v233
v_sub_f32 v238,v238,v233
M v[40:43],a[224:227],a[200:203],v[40:43]
s_waitcnt lgkmcnt(5)
v_add_f32 v233,v70,v166
v_sub_f32 v166,v70,v166
M v[44:47],a[224:227],a[204:207],v[44:47]
s_waitcnt lgkmcnt(4)
s_add_u32 s34,s33,393216
buffer_store_dwordx4 a[116:119],v252,s[24:27],s34 offen offset:1152 nt
M v[48:51],a[224:227],a[208:211],v[48:51]
s_waitcnt lgkmcnt(3)
v_add_f32 v70,v235,v233
v_fmac_f32 v235,4.0,v233
M v[52:55],a[224:227],a[212:215],v[52:55]
s_waitcnt lgkmcnt(2)
v_fma_f32 v233,2.0,v166,v238
v_fma_f32 v166,s41,v166,v238
M v[56:59],a[224:227],a[216:219],v[56:59]
s_waitcnt lgkmcnt(1)
v_accvgpr_read_b32 v238,a71
v_accvgpr_read_b32 v237,a167
M v[60:63],a[224:227],a[220:223],v[60:63]
s_waitcnt vmcnt(14)
buffer_load_dwordx4 a[224:227],v251,s[20:23],s47 offen offset:0
M v[32:35],a[228:231],a[196:199],v[32:35]
ds_read_b128 a[196:199],v249 offset:54528
v_add_f32 v236,v238,v237
M v[36:39],a[228:231],a[200:203],v[36:39]
v_sub_f32 v238,v238,v237
v_add_f32 v237,v71,v167
M v[40:43],a[228:231],a[204:207],v[40:43]
v_sub_f32 v167,v71,v167
v_add_f32 v71,v236,v237
M v[44:47],a[228:231],a[208:211],v[44:47]
v_fmac_f32 v236,4.0,v237
v_fma_f32 v237,2.0,v167,v238
M v[48:51],a[228:231],a[212:215],v[48:51]
v_fma_f32 v167,s41,v167,v238
v_cvt_pk_bf16_f32 v233,v233,v237
M v[52:55],a[228:231],a[216:219],v[52:55]
v_add_u32 v249,0xfffece00,v249
v_add_u32 v250,0xfffece00,v250
M v[56:59],a[228:231],a[220:223],v[56:59]
s_waitcnt lgkmcnt(1)
v_cvt_pk_bf16_f32 v235,v235,v236
M v[60:63],a[228:231],a[192:195],v[60:63]
s_waitcnt vmcnt(14)
buffer_load_dwordx4 a[228:231],v251,s[20:23],s47 offen offset:1024
M v[32:35],a[232:235],a[200:203],v[32:35]
ds_read_b128 a[200:203],v249 offset:60928
ds_write2st64_b64 v253,v[232:233],v[234:235] offset0:127 offset1:131
M v[36:39],a[232:235],a[204:207],v[36:39]
ds_read_b128 a[204:207],v250 offset:61184
v_accvgpr_read_b32 v238,a72
M v[40:43],a[232:235],a[208:211],v[40:43]
ds_read_b128 a[208:211],v250 offset:61440
v_accvgpr_read_b32 v232,a168
M v[44:47],a[232:235],a[212:215],v[44:47]
ds_read_b128 a[212:215],v250 offset:61696
v_add_f32 v234,v238,v232
M v[48:51],a[232:235],a[216:219],v[48:51]
ds_read_b128 a[216:219],v250 offset:61952
v_sub_f32 v238,v238,v232
M v[52:55],a[232:235],a[220:223],v[52:55]
ds_read_b128 a[220:223],v250 offset:62208
v_add_f32 v232,v72,v168
M v[56:59],a[232:235],a[192:195],v[56:59]
s_waitcnt lgkmcnt(7)
ds_read_b128 a[192:195],v250 offset:62464
v_sub_f32 v168,v72,v168
M v[60:63],a[232:235],a[196:199],v[60:63]
s_waitcnt vmcnt(14) lgkmcnt(7)
buffer_load_dwordx4 a[232:235],v251,s[20:23],s47 offen offset:2048
M v[32:35],a[236:239],a[200:203],v[32:35]
s_waitcnt lgkmcnt(5)
ds_read_b128 a[196:199],v250 offset:62720
ds_read_b128 a[200:203],v250 offset:62976
M v[36:39],a[236:239],a[204:207],v[36:39]
s_waitcnt lgkmcnt(6)
s_add_u32 s47,s79,49152
v_add_f32 v72,v234,v232
v_fmac_f32 v234,4.0,v232
M v[40:43],a[236:239],a[208:211],v[40:43]
s_waitcnt lgkmcnt(5)
v_fma_f32 v232,2.0,v168,v238
v_fma_f32 v168,s41,v168,v238
M v[44:47],a[236:239],a[212:215],v[44:47]
s_waitcnt lgkmcnt(4)
v_accvgpr_read_b32 v238,a73
v_accvgpr_read_b32 v237,a169
M v[48:51],a[236:239],a[216:219],v[48:51]
s_waitcnt lgkmcnt(3)
s_add_u32 s34,s33,786432
buffer_store_dwordx4 a[120:123],v252,s[24:27],s34 offen offset:1152 nt
M v[52:55],a[236:239],a[220:223],v[52:55]
s_waitcnt lgkmcnt(2)
v_add_f32 v236,v238,v237
v_sub_f32 v238,v238,v237
M v[56:59],a[236:239],a[192:195],v[56:59]
s_waitcnt lgkmcnt(1)
v_add_f32 v237,v73,v169
v_sub_f32 v169,v73,v169
M v[60:63],a[236:239],a[196:199],v[60:63]
s_waitcnt vmcnt(15)
buffer_load_dwordx4 a[236:239],v251,s[20:23],s47 offen offset:0
M v[32:35],a[240:243],a[204:207],v[32:35]
ds_read_b128 a[204:207],v249 offset:63232
v_add_f32 v73,v236,v237
M v[36:39],a[240:243],a[208:211],v[36:39]
v_fmac_f32 v236,4.0,v237
v_fma_f32 v237,2.0,v169,v238
M v[40:43],a[240:243],a[212:215],v[40:43]
v_fma_f32 v169,s41,v169,v238
v_cvt_pk_bf16_f32 v232,v232,v237
M v[44:47],a[240:243],a[216:219],v[44:47]
v_cvt_pk_bf16_f32 v234,v234,v236
v_accvgpr_read_b32 v238,a74
M v[48:51],a[240:243],a[220:223],v[48:51]
v_accvgpr_read_b32 v233,a170
v_add_f32 v235,v238,v233
M v[52:55],a[240:243],a[192:195],v[52:55]
v_sub_f32 v238,v238,v233
v_add_f32 v233,v74,v170
M v[56:59],a[240:243],a[196:199],v[56:59]
s_waitcnt lgkmcnt(1)
v_sub_f32 v170,v74,v170
v_add_f32 v74,v235,v233
M v[60:63],a[240:243],a[200:203],v[60:63]
s_waitcnt vmcnt(14)
buffer_load_dwordx4 a[240:243],v251,s[20:23],s47 offen offset:1024
M v[32:35],a[244:247],a[208:211],v[32:35]
ds_read_b128 a[208:211],v249 offset:0
v_fmac_f32 v235,4.0,v233
M v[36:39],a[244:247],a[212:215],v[36:39]
ds_read_b128 a[212:215],v250 offset:256
v_fma_f32 v233,2.0,v170,v238
M v[40:43],a[244:247],a[216:219],v[40:43]
ds_read_b128 a[216:219],v250 offset:512
v_fma_f32 v170,s41,v170,v238
M v[44:47],a[244:247],a[220:223],v[44:47]
ds_read_b128 a[220:223],v250 offset:768
v_accvgpr_read_b32 v238,a75
M v[48:51],a[244:247],a[192:195],v[48:51]
ds_read_b128 a[192:195],v250 offset:1024
v_accvgpr_read_b32 v237,a171
M v[52:55],a[244:247],a[196:199],v[52:55]
ds_read_b128 a[196:199],v250 offset:1280
v_add_f32 v236,v238,v237
M v[56:59],a[244:247],a[200:203],v[56:59]
s_waitcnt lgkmcnt(6)
ds_read_b128 a[200:203],v250 offset:1536
v_sub_f32 v238,v238,v237
M v[60:63],a[244:247],a[204:207],v[60:63]
s_waitcnt vmcnt(13) lgkmcnt(6)
buffer_load_dwordx4 a[244:247],v251,s[20:23],s47 offen offset:2048
M v[128:131],a[248:251],a[208:211],v[128:131]
s_waitcnt lgkmcnt(5)
ds_read_b128 a[204:207],v250 offset:1792
ds_read_b128 a[208:211],v250 offset:2048
M v[132:135],a[248:251],a[212:215],v[132:135]
s_waitcnt lgkmcnt(6)
s_add_u32 s47,s80,49152
v_add_f32 v237,v75,v171
v_sub_f32 v171,v75,v171
M v[136:139],a[248:251],a[216:219],v[136:139]
s_waitcnt lgkmcnt(5)
v_add_f32 v75,v236,v237
v_fmac_f32 v236,4.0,v237
M v[140:143],a[248:251],a[220:223],v[140:143]
s_waitcnt lgkmcnt(4)
v_fma_f32 v237,2.0,v171,v238
v_fma_f32 v171,s41,v171,v238
M v[144:147],a[248:251],a[192:195],v[144:147]
s_waitcnt lgkmcnt(3)
v_cvt_pk_bf16_f32 v233,v233,v237
v_cvt_pk_bf16_f32 v235,v235,v236
M v[148:151],a[248:251],a[196:199],v[148:151]
s_waitcnt lgkmcnt(2)
s_add_u32 s34,s33,1179648
buffer_store_dwordx4 a[124:127],v252,s[24:27],s34 offen offset:1152 nt
M v[152:155],a[248:251],a[200:203],v[152:155]
s_waitcnt lgkmcnt(1)
ds_write2st64_b64 v253,v[232:233],v[234:235] offset0:68 offset1:72
M v[156:159],a[248:251],a[204:207],v[156:159]
s_waitcnt vmcnt(14)
buffer_load_dwordx4 a[248:251],v251,s[20:23],s47 offen offset:0
M v[128:131],a[252:255],a[212:215],v[128:131]
ds_read_b128 a[212:215],v249 offset:2304
v_accvgpr_read_b32 v238,a76
M v[132:135],a[252:255],a[216:219],v[132:135]
v_accvgpr_read_b32 v232,a172
v_add_f32 v234,v238,v232
M v[136:139],a[252:255],a[220:223],v[136:139]
v_sub_f32 v238,v238,v232
v_add_f32 v232,v76,v172
M v[140:143],a[252:255],a[192:195],v[140:143]
v_sub_f32 v172,v76,v172
v_add_f32 v76,v234,v232
M v[144:147],a[252:255],a[196:199],v[144:147]
v_fmac_f32 v234,4.0,v232
v_fma_f32 v232,2.0,v172,v238
M v[148:151],a[252:255],a[200:203],v[148:151]
v_add_u32 v249,0x15400,v249
v_add_u32 v250,0x15400,v250
M v[152:155],a[252:255],a[204:207],v[152:155]
s_waitcnt lgkmcnt(2)
v_fma_f32 v172,s41,v172,v238
v_accvgpr_read_b32 v238,a77
M v[156:159],a[252:255],a[208:211],v[156:159]
s_waitcnt vmcnt(14)
buffer_load_dwordx4 a[252:255],v251,s[20:23],s47 offen offset:1024
M v[128:131],v[216:219],a[216:219],v[128:131]
ds_read_b128 a[216:219],v249 offset:0
v_accvgpr_read_b32 v237,a173
M v[132:135],v[216:219],a[220:223],v[132:135]
ds_read_b128 a[220:223],v250 offset:256
v_add_f32 v236,v238,v237
M v[136:139],v[216:219],a[192:195],v[136:139]
ds_read_b128 a[192:195],v250 offset:512
v_sub_f32 v238,v238,v237
M v[140:143],v[216:219],a[196:199],v[140:143]
ds_read_b128 a[196:199],v250 offset:768
v_add_f32 v237,v77,v173
M v[144:147],v[216:219],a[200:203],v[144:147]
ds_read_b128 a[200:203],v250 offset:1024
v_sub_f32 v173,v77,v173
M v[148:151],v[216:219],a[204:207],v[148:151]
ds_read_b128 a[204:207],v250 offset:1280
v_add_f32 v77,v236,v237
M v[152:155],v[216:219],a[208:211],v[152:155]
s_waitcnt lgkmcnt(6)
ds_read_b128 a[208:211],v250 offset:1536
v_fmac_f32 v236,4.0,v237
M v[156:159],v[216:219],a[212:215],v[156:159]
s_waitcnt vmcnt(13) lgkmcnt(6)
buffer_load_dwordx4 v[216:219],v251,s[20:23],s47 offen offset:2048
M v[128:131],v[220:223],a[216:219],v[128:131]
s_waitcnt lgkmcnt(5)
ds_read_b128 a[212:215],v250 offset:1792
ds_read_b128 a[216:219],v250 offset:2048
M v[132:135],v[220:223],a[220:223],v[132:135]
s_waitcnt lgkmcnt(6)
s_add_u32 s47,s81,49152
v_fma_f32 v237,2.0,v173,v238
v_fma_f32 v173,s41,v173,v238
M v[136:139],v[220:223],a[192:195],v[136:139]
s_waitcnt lgkmcnt(5)
v_cvt_pk_bf16_f32 v232,v232,v237
v_cvt_pk_bf16_f32 v234,v234,v236
M v[140:143],v[220:223],a[196:199],v[140:143]
s_waitcnt lgkmcnt(4)
v_accvgpr_read_b32 v238,a78
v_accvgpr_read_b32 v233,a174
M v[144:147],v[220:223],a[200:203],v[144:147]
s_waitcnt lgkmcnt(3)
v_add_f32 v235,v238,v233
v_sub_f32 v238,v238,v233
M v[148:151],v[220:223],a[204:207],v[148:151]
s_waitcnt lgkmcnt(2)
v_add_f32 v233,v78,v174
v_sub_f32 v174,v78,v174
M v[152:155],v[220:223],a[208:211],v[152:155]
s_waitcnt lgkmcnt(1)
v_add_f32 v78,v235,v233
v_fmac_f32 v235,4.0,v233
M v[156:159],v[220:223],a[212:215],v[156:159]
s_waitcnt vmcnt(13)
buffer_load_dwordx4 v[220:223],v251,s[20:23],s47 offen offset:0
M v[128:131],v[224:227],a[220:223],v[128:131]
ds_read_b128 a[220:223],v249 offset:2304
v_fma_f32 v233,2.0,v174,v238
M v[132:135],v[224:227],a[192:195],v[132:135]
v_fma_f32 v174,s41,v174,v238
v_accvgpr_read_b32 v238,a79
M v[136:139],v[224:227],a[196:199],v[136:139]
v_accvgpr_read_b32 v237,a175
v_add_f32 v236,v238,v237
M v[140:143],v[224:227],a[200:203],v[140:143]
v_sub_f32 v238,v238,v237
v_add_f32 v237,v79,v175
M v[144:147],v[224:227],a[204:207],v[144:147]
v_sub_f32 v175,v79,v175
v_add_f32 v79,v236,v237
M v[148:151],v[224:227],a[208:211],v[148:151]
v_fmac_f32 v236,4.0,v237
v_fma_f32 v237,2.0,v175,v238
M v[152:155],v[224:227],a[212:215],v[152:155]
s_waitcnt lgkmcnt(1)
v_fma_f32 v175,s41,v175,v238
v_cvt_pk_bf16_f32 v233,v233,v237
M v[156:159],v[224:227],a[216:219],v[156:159]
s_waitcnt vmcnt(13)
buffer_load_dwordx4 v[224:227],v251,s[20:23],s47 offen offset:1024
M v[128:131],v[228:231],a[192:195],v[128:131]
ds_read_b128 a[192:195],v249 offset:17408
v_cvt_pk_bf16_f32 v235,v235,v236
M v[132:135],v[228:231],a[196:199],v[132:135]
ds_read_b128 a[196:199],v250 offset:17664
ds_write2st64_b64 v253,v[232:233],v[234:235] offset0:76 offset1:80
M v[136:139],v[228:231],a[200:203],v[136:139]
ds_read_b128 a[200:203],v250 offset:17920
v_cvt_pk_bf16_f32 v32,v32,v33
M v[140:143],v[228:231],a[204:207],v[140:143]
ds_read_b128 a[204:207],v250 offset:18176
v_cvt_pk_bf16_f32 v33,v34,v35
M v[144:147],v[228:231],a[208:211],v[144:147]
ds_read_b128 a[208:211],v250 offset:18432
v_cvt_pk_bf16_f32 v36,v36,v37
M v[148:151],v[228:231],a[212:215],v[148:151]
ds_read_b128 a[212:215],v250 offset:18688
v_cvt_pk_bf16_f32 v37,v38,v39
M v[152:155],v[228:231],a[216:219],v[152:155]
s_waitcnt lgkmcnt(4)
s_barrier
ds_read_b128 a[64:67],v251 offset:60928
M v[156:159],v[228:231],a[220:223],v[156:159]
s_waitcnt vmcnt(12)
ds_read_b128 a[68:71],v251 offset:65024
ds_read_b128 a[72:75],v251 offset:34816
M v[128:131],a[224:227],a[192:195],v[128:131]
ds_read_b128 a[76:79],v251 offset:38912
buffer_load_dwordx4 v[228:231],v251,s[20:23],s47 offen offset:2048
M v[132:135],a[224:227],a[196:199],v[132:135]
s_waitcnt lgkmcnt(7)
s_add_u32 s48,s76,6144
ds_read_b128 a[216:219],v250 offset:18944
ds_read_b128 a[220:223],v250 offset:19200
M v[136:139],a[224:227],a[200:203],v[136:139]
s_waitcnt lgkmcnt(8)
ds_read_b128 a[192:195],v250 offset:19456
ds_write2st64_b64 v253,v[32:33],v[36:37] offset0:34 offset1:38
M v[140:143],a[224:227],a[204:207],v[140:143]
s_waitcnt lgkmcnt(7)
s_add_u32 s34,s32,0
buffer_store_dwordx4 a[64:67],v252,s[24:27],s34 offen offset:640 nt
M v[144:147],a[224:227],a[208:211],v[144:147]
v_cvt_pk_bf16_f32 v40,v40,v41
v_cvt_pk_bf16_f32 v41,v42,v43
M v[148:151],a[224:227],a[212:215],v[148:151]
s_waitcnt lgkmcnt(3)
v_cvt_pk_bf16_f32 v44,v44,v45
v_cvt_pk_bf16_f32 v45,v46,v47
M v[152:155],a[224:227],a[216:219],v[152:155]
s_waitcnt lgkmcnt(2)
ds_write2st64_b64 v253,v[40:41],v[44:45] offset0:42 offset1:46
M v[156:159],a[224:227],a[220:223],v[156:159]
s_waitcnt vmcnt(13)
s_add_u32 s34,s32,196608
buffer_load_dwordx4 a[224:227],v251,s[20:23],s48 offen offset:0
M v[128:131],a[228:231],a[196:199],v[128:131]
buffer_store_dwordx4 a[68:71],v252,s[24:27],s34 offen offset:640 nt
M v[132:135],a[228:231],a[200:203],v[132:135]
ds_read_b128 a[196:199],v249 offset:19712
v_cvt_pk_bf16_f32 v48,v48,v49
M v[136:139],a[228:231],a[204:207],v[136:139]
v_cvt_pk_bf16_f32 v49,v50,v51
v_cvt_pk_bf16_f32 v52,v52,v53
M v[140:143],a[228:231],a[208:211],v[140:143]
v_cvt_pk_bf16_f32 v53,v54,v55
M v[144:147],a[228:231],a[212:215],v[144:147]
ds_write2st64_b64 v253,v[48:49],v[52:53] offset0:51 offset1:55
M v[148:151],a[228:231],a[216:219],v[148:151]
v_cvt_pk_bf16_f32 v56,v56,v57
v_cvt_pk_bf16_f32 v57,v58,v59
M v[152:155],a[228:231],a[220:223],v[152:155]
s_waitcnt lgkmcnt(4)
v_cvt_pk_bf16_f32 v60,v60,v61
v_cvt_pk_bf16_f32 v61,v62,v63
M v[156:159],a[228:231],a[192:195],v[156:159]
s_waitcnt vmcnt(14)
buffer_load_dwordx4 a[228:231],v251,s[20:23],s48 offen offset:1024
M v[128:131],a[232:235],a[200:203],v[128:131]
ds_read_b128 a[200:203],v249 offset:34816
ds_write2st64_b64 v253,v[56:57],v[60:61] offset0:59 offset1:63
M v[132:135],a[232:235],a[204:207],v[132:135]
ds_read_b128 a[204:207],v250 offset:35072
v_accvgpr_read_b32 v238,a80
M v[136:139],a[232:235],a[208:211],v[136:139]
ds_read_b128 a[208:211],v250 offset:35328
v_accvgpr_read_b32 v232,a176
M v[140:143],a[232:235],a[212:215],v[140:143]
ds_read_b128 a[212:215],v250 offset:35584
v_add_f32 v234,v238,v232
M v[144:147],a[232:235],a[216:219],v[144:147]
ds_read_b128 a[216:219],v250 offset:35840
v_sub_f32 v238,v238,v232
M v[148:151],a[232:235],a[220:223],v[148:151]
ds_read_b128 a[220:223],v250 offset:36096
v_add_f32 v232,v80,v176
M v[152:155],a[232:235],a[192:195],v[152:155]
s_waitcnt lgkmcnt(8)
ds_read_b128 a[192:195],v250 offset:36352
v_sub_f32 v176,v80,v176
M v[156:159],a[232:235],a[196:199],v[156:159]
s_waitcnt vmcnt(13) lgkmcnt(7)
buffer_load_dwordx4 a[232:235],v251,s[20:23],s48 offen offset:2048
M v[128:131],a[236:239],a[200:203],v[128:131]
s_waitcnt lgkmcnt(5)
ds_read_b128 a[196:199],v250 offset:36608
ds_read_b128 a[200:203],v250 offset:36864
M v[132:135],a[236:239],a[204:207],v[132:135]
s_waitcnt lgkmcnt(6)
s_add_u32 s48,s77,6144
v_add_f32 v80,v234,v232
v_fmac_f32 v234,4.0,v232
M v[136:139],a[236:239],a[208:211],v[136:139]
s_waitcnt lgkmcnt(5)
v_fma_f32 v232,2.0,v176,v238
v_fma_f32 v176,s41,v176,v238
M v[140:143],a[236:239],a[212:215],v[140:143]
s_waitcnt lgkmcnt(4)
v_accvgpr_read_b32 v238,a81
v_accvgpr_read_b32 v237,a177
M v[144:147],a[236:239],a[216:219],v[144:147]
s_waitcnt lgkmcnt(3)
v_add_f32 v236,v238,v237
v_sub_f32 v238,v238,v237
M v[148:151],a[236:239],a[220:223],v[148:151]
s_waitcnt lgkmcnt(2)
v_add_f32 v237,v81,v177
v_sub_f32 v177,v81,v177
M v[152:155],a[236:239],a[192:195],v[152:155]
s_waitcnt lgkmcnt(1)
v_add_f32 v81,v236,v237
v_fmac_f32 v236,4.0,v237
M v[156:159],a[236:239],a[196:199],v[156:159]
s_waitcnt vmcnt(13)
buffer_load_dwordx4 a[236:239],v251,s[20:23],s48 offen offset:0
M v[128:131],a[240:243],a[204:207],v[128:131]
s_add_u32 s34,s32,393216
buffer_store_dwordx4 a[72:75],v252,s[24:27],s34 offen offset:640 nt
M v[132:135],a[240:243],a[208:211],v[132:135]
ds_read_b128 a[204:207],v249 offset:37120
v_fma_f32 v237,2.0,v177,v238
M v[136:139],a[240:243],a[212:215],v[136:139]
v_fma_f32 v177,s41,v177,v238
v_cvt_pk_bf16_f32 v232,v232,v237
M v[140:143],a[240:243],a[216:219],v[140:143]
v_cvt_pk_bf16_f32 v234,v234,v236
v_accvgpr_read_b32 v238,a82
M v[144:147],a[240:243],a[220:223],v[144:147]
v_accvgpr_read_b32 v233,a178
v_add_f32 v235,v238,v233
M v[148:151],a[240:243],a[192:195],v[148:151]
v_sub_f32 v238,v238,v233
v_add_f32 v233,v82,v178
M v[152:155],a[240:243],a[196:199],v[152:155]
s_waitcnt lgkmcnt(1)
v_sub_f32 v178,v82,v178
v_add_f32 v82,v235,v233
M v[156:159],a[240:243],a[200:203],v[156:159]
s_waitcnt vmcnt(14)
buffer_load_dwordx4 a[240:243],v251,s[20:23],s48 offen offset:1024
M v[128:131],a[244:247],a[208:211],v[128:131]
ds_read_b128 a[208:211],v249 offset:52224
v_fmac_f32 v235,4.0,v233
M v[132:135],a[244:247],a[212:215],v[132:135]
ds_read_b128 a[212:215],v250 offset:52480
v_fma_f32 v233,2.0,v178,v238
M v[136:139],a[244:247],a[216:219],v[136:139]
ds_read_b128 a[216:219],v250 offset:52736
v_fma_f32 v178,s41,v178,v238
M v[140:143],a[244:247],a[220:223],v[140:143]
ds_read_b128 a[220:223],v250 offset:52992
v_accvgpr_read_b32 v238,a83
M v[144:147],a[244:247],a[192:195],v[144:147]
ds_read_b128 a[192:195],v250 offset:53248
v_accvgpr_read_b32 v237,a179
M v[148:151],a[244:247],a[196:199],v[148:151]
ds_read_b128 a[196:199],v250 offset:53504
v_add_f32 v236,v238,v237
M v[152:155],a[244:247],a[200:203],v[152:155]
s_waitcnt lgkmcnt(6)
ds_read_b128 a[200:203],v250 offset:53760
v_sub_f32 v238,v238,v237
M v[156:159],a[244:247],a[204:207],v[156:159]
s_waitcnt vmcnt(13) lgkmcnt(6)
buffer_load_dwordx4 a[244:247],v251,s[20:23],s48 offen offset:2048
M v[128:131],a[248:251],a[208:211],v[128:131]
s_waitcnt lgkmcnt(5)
ds_read_b128 a[204:207],v250 offset:54016
ds_read_b128 a[208:211],v250 offset:54272
M v[132:135],a[248:251],a[212:215],v[132:135]
s_waitcnt lgkmcnt(6)
s_add_u32 s48,s78,6144
v_add_f32 v237,v83,v179
v_sub_f32 v179,v83,v179
M v[136:139],a[248:251],a[216:219],v[136:139]
s_waitcnt lgkmcnt(5)
v_add_f32 v83,v236,v237
v_fmac_f32 v236,4.0,v237
M v[140:143],a[248:251],a[220:223],v[140:143]
s_waitcnt lgkmcnt(4)
v_fma_f32 v237,2.0,v179,v238
v_fma_f32 v179,s41,v179,v238
M v[144:147],a[248:251],a[192:195],v[144:147]
s_waitcnt lgkmcnt(3)
v_cvt_pk_bf16_f32 v233,v233,v237
v_cvt_pk_bf16_f32 v235,v235,v236
M v[148:151],a[248:251],a[196:199],v[148:151]
s_waitcnt lgkmcnt(2)
ds_write2st64_b64 v253,v[232:233],v[234:235] offset0:102 offset1:106
M v[152:155],a[248:251],a[200:203],v[152:155]
s_waitcnt lgkmcnt(2)
v_accvgpr_read_b32 v238,a84
v_accvgpr_read_b32 v232,a180
M v[156:159],a[248:251],a[204:207],v[156:159]
s_waitcnt vmcnt(13)
buffer_load_dwordx4 a[248:251],v251,s[20:23],s48 offen offset:0
M v[128:131],a[252:255],a[212:215],v[128:131]
ds_read_b128 a[212:215],v249 offset:54528
v_add_f32 v234,v238,v232
M v[132:135],a[252:255],a[216:219],v[132:135]
s_add_u32 s34,s32,589824
buffer_store_dwordx4 a[76:79],v252,s[24:27],s34 offen offset:640 nt
M v[136:139],a[252:255],a[220:223],v[136:139]
v_sub_f32 v238,v238,v232
v_add_f32 v232,v84,v180
M v[140:143],a[252:255],a[192:195],v[140:143]
v_sub_f32 v180,v84,v180
v_add_f32 v84,v234,v232
M v[144:147],a[252:255],a[196:199],v[144:147]
v_fmac_f32 v234,4.0,v232
v_fma_f32 v232,2.0,v180,v238
M v[148:151],a[252:255],a[200:203],v[148:151]
v_add_u32 v249,0xffffbc00,v249
v_add_u32 v250,0xffffbc00,v250
M v[152:155],a[252:255],a[204:207],v[152:155]
s_waitcnt lgkmcnt(2)
v_fma_f32 v180,s41,v180,v238
v_accvgpr_read_b32 v238,a85
M v[156:159],a[252:255],a[208:211],v[156:159]
s_waitcnt vmcnt(14)
buffer_load_dwordx4 a[252:255],v251,s[20:23],s48 offen offset:1024
M v[128:131],v[216:219],a[216:219],v[128:131]
ds_read_b128 a[216:219],v249 offset:0
v_accvgpr_read_b32 v237,a181
M v[132:135],v[216:219],a[220:223],v[132:135]
ds_read_b128 a[220:223],v250 offset:256
v_add_f32 v236,v238,v237
M v[136:139],v[216:219],a[192:195],v[136:139]
ds_read_b128 a[192:195],v250 offset:512
v_sub_f32 v238,v238,v237
M v[140:143],v[216:219],a[196:199],v[140:143]
ds_read_b128 a[196:199],v250 offset:768
v_add_f32 v237,v85,v181
M v[144:147],v[216:219],a[200:203],v[144:147]
ds_read_b128 a[200:203],v250 offset:1024
v_sub_f32 v181,v85,v181
M v[148:151],v[216:219],a[204:207],v[148:151]
ds_read_b128 a[204:207],v250 offset:1280
v_add_f32 v85,v236,v237
M v[152:155],v[216:219],a[208:211],v[152:155]
s_waitcnt lgkmcnt(6)
ds_read_b128 a[208:211],v250 offset:1536
v_fmac_f32 v236,4.0,v237
v_fma_f32 v237,2.0,v181,v238
v_fma_f32 v181,s41,v181,v238
v_cvt_pk_bf16_f32 v232,v232,v237
M v[156:159],v[216:219],a[212:215],v[156:159]
s_waitcnt vmcnt(14) lgkmcnt(6)
buffer_load_dwordx4 v[216:219],v251,s[20:23],s48 offen offset:2048
v_cvt_pk_bf16_f32 v234,v234,v236
v_accvgpr_read_b32 v238,a86
v_accvgpr_read_b32 v233,a182
v_add_f32 v235,v238,v233
M v[128:131],v[220:223],a[216:219],v[128:131]
s_waitcnt lgkmcnt(5)
ds_read_b128 a[212:215],v250 offset:1792
ds_read_b128 a[216:219],v250 offset:2048
v_sub_f32 v238,v238,v233
v_add_f32 v233,v86,v182
v_sub_f32 v182,v86,v182
v_add_f32 v86,v235,v233
M v[132:135],v[220:223],a[220:223],v[132:135]
s_waitcnt lgkmcnt(6)
s_add_u32 s48,s79,6144
v_fmac_f32 v235,4.0,v233
v_fma_f32 v233,2.0,v182,v238
v_fma_f32 v182,s41,v182,v238
v_accvgpr_read_b32 v238,a87
M v[136:139],v[220:223],a[192:195],v[136:139]
s_waitcnt lgkmcnt(5)
v_accvgpr_read_b32 v237,a183
v_add_f32 v236,v238,v237
v_sub_f32 v238,v238,v237
v_add_f32 v237,v87,v183
M v[140:143],v[220:223],a[196:199],v[140:143]
s_waitcnt lgkmcnt(4)
v_sub_f32 v183,v87,v183
v_add_f32 v87,v236,v237
v_fmac_f32 v236,4.0,v237
v_fma_f32 v237,2.0,v183,v238
M v[144:147],v[220:223],a[200:203],v[144:147]
s_waitcnt lgkmcnt(3)
v_fma_f32 v183,s41,v183,v238
v_cvt_pk_bf16_f32 v233,v233,v237
v_cvt_pk_bf16_f32 v235,v235,v236
M v[148:151],v[220:223],a[204:207],v[148:151]
s_waitcnt lgkmcnt(2)
ds_write2st64_b64 v253,v[232:233],v[234:235] offset0:110 offset1:114
M v[152:155],v[220:223],a[208:211],v[152:155]
s_waitcnt lgkmcnt(2)
v_accvgpr_read_b32 v238,a88
v_accvgpr_read_b32 v232,a184
M v[156:159],v[220:223],a[212:215],v[156:159]
s_waitcnt vmcnt(14)
buffer_load_dwordx4 v[220:223],v251,s[20:23],s48 offen offset:0
v_add_f32 v234,v238,v232
v_sub_f32 v238,v238,v232
v_add_f32 v232,v88,v184
v_sub_f32 v184,v88,v184
M v[128:131],v[224:227],a[220:223],v[128:131]
s_waitcnt lgkmcnt(0)
s_barrier
ds_read_b128 v[32:35],v251 offset:17408
v_add_f32 v88,v234,v232
v_fmac_f32 v234,4.0,v232
v_fma_f32 v232,2.0,v184,v238
M v[132:135],v[224:227],a[192:195],v[132:135]
ds_read_b128 v[40:43],v251 offset:21504
ds_read_b128 v[48:51],v251 offset:26112
v_fma_f32 v184,s41,v184,v238
v_accvgpr_read_b32 v238,a89
v_accvgpr_read_b32 v237,a185
v_add_f32 v236,v238,v237
M v[136:139],v[224:227],a[196:199],v[136:139]
ds_read_b128 v[56:59],v251 offset:30208
ds_read_b128 a[80:83],v251 offset:52224
v_sub_f32 v238,v238,v237
v_add_f32 v237,v89,v185
v_sub_f32 v185,v89,v185
v_add_f32 v89,v236,v237
M v[140:143],v[224:227],a[200:203],v[140:143]
ds_read_b128 a[84:87],v251 offset:56320
ds_read_b128 a[220:223],v249 offset:2304
v_fmac_f32 v236,4.0,v237
v_fma_f32 v237,2.0,v185,v238
v_fma_f32 v185,s41,v185,v238
v_cvt_pk_bf16_f32 v232,v232,v237
M v[144:147],v[224:227],a[204:207],v[144:147]
v_cvt_pk_bf16_f32 v234,v234,v236
v_accvgpr_read_b32 v238,a90
v_accvgpr_read_b32 v233,a186
v_add_f32 v235,v238,v233
M v[148:151],v[224:227],a[208:211],v[148:151]
s_waitcnt lgkmcnt(6)
s_add_u32 s34,s33,0
buffer_store_dwordx4 v[32:35],v252,s[24:27],s34 offen offset:128 nt
v_sub_f32 v238,v238,v233
v_add_f32 v233,v90,v186
v_sub_f32 v186,v90,v186
v_add_f32 v90,v235,v233
M v[152:155],v[224:227],a[212:215],v[152:155]
v_add_u32 v249,0xfffece00,v249
v_add_u32 v250,0xfffece00,v250
v_fmac_f32 v235,4.0,v233
v_fma_f32 v233,2.0,v186,v238
v_fma_f32 v186,s41,v186,v238
v_accvgpr_read_b32 v238,a91
M v[156:159],v[224:227],a[216:219],v[156:159]
s_waitcnt vmcnt(15)
buffer_load_dwordx4 v[224:227],v251,s[20:23],s48 offen offset:1024
v_accvgpr_read_b32 v237,a187
v_add_f32 v236,v238,v237
v_sub_f32 v238,v238,v237
v_add_f32 v237,v91,v187
M v[128:131],v[228:231],a[192:195],v[128:131]
ds_read_b128 a[192:195],v249 offset:0
v_sub_f32 v187,v91,v187
v_add_f32 v91,v236,v237
v_fmac_f32 v236,4.0,v237
v_fma_f32 v237,2.0,v187,v238
M v[132:135],v[228:231],a[196:199],v[132:135]
ds_read_b128 a[196:199],v250 offset:256
v_fma_f32 v187,s41,v187,v238
v_cvt_pk_bf16_f32 v233,v233,v237
v_cvt_pk_bf16_f32 v235,v235,v236
M v[136:139],v[228:231],a[200:203],v[136:139]
ds_write2st64_b64 v253,v[232:233],v[234:235] offset0:119 offset1:123
M v[140:143],v[228:231],a[204:207],v[140:143]
ds_read_b128 a[200:203],v250 offset:512
ds_read_b128 a[204:207],v250 offset:768
v_accvgpr_read_b32 v238,a92
v_accvgpr_read_b32 v232,a188
M v[144:147],v[228:231],a[208:211],v[144:147]
ds_read_b128 a[208:211],v250 offset:1024
v_add_f32 v234,v238,v232
v_sub_f32 v238,v238,v232
v_add_f32 v232,v92,v188
v_sub_f32 v188,v92,v188
M v[148:151],v[228:231],a[212:215],v[148:151]
ds_read_b128 a[212:215],v250 offset:1280
v_add_f32 v92,v234,v232
v_fmac_f32 v234,4.0,v232
v_fma_f32 v232,2.0,v188,v238
v_fma_f32 v188,s41,v188,v238
M v[152:155],v[228:231],a[216:219],v[152:155]
s_waitcnt lgkmcnt(7)
ds_read_b128 a[216:219],v250 offset:1536
v_accvgpr_read_b32 v238,a93
v_accvgpr_read_b32 v237,a189
v_add_f32 v236,v238,v237
v_sub_f32 v238,v238,v237
M v[156:159],v[228:231],a[220:223],v[156:159]
s_waitcnt vmcnt(14) lgkmcnt(7)
buffer_load_dwordx4 v[228:231],v251,s[20:23],s48 offen offset:2048
v_add_f32 v237,v93,v189
v_sub_f32 v189,v93,v189
v_add_f32 v93,v236,v237
v_fmac_f32 v236,4.0,v237
M v[64:67],a[224:227],a[192:195],v[64:67]
s_waitcnt lgkmcnt(6)
ds_read_b128 a[220:223],v250 offset:1792
ds_read_b128 a[192:195],v250 offset:2048
v_fma_f32 v237,2.0,v189,v238
v_fma_f32 v189,s41,v189,v238
v_cvt_pk_bf16_f32 v232,v232,v237
v_cvt_pk_bf16_f32 v234,v234,v236
M v[68:71],a[224:227],a[196:199],v[68:71]
s_waitcnt lgkmcnt(6)
s_add_u32 s48,s80,6144
v_accvgpr_read_b32 v238,a94
v_accvgpr_read_b32 v233,a190
v_add_f32 v235,v238,v233
v_sub_f32 v238,v238,v233
M v[72:75],a[224:227],a[200:203],v[72:75]
s_waitcnt lgkmcnt(5)
v_add_f32 v233,v94,v190
v_sub_f32 v190,v94,v190
v_add_f32 v94,v235,v233
v_fmac_f32 v235,4.0,v233
M v[76:79],a[224:227],a[204:207],v[76:79]
s_waitcnt lgkmcnt(4)
v_fma_f32 v233,2.0,v190,v238
v_fma_f32 v190,s41,v190,v238
v_accvgpr_read_b32 v238,a95
v_accvgpr_read_b32 v237,a191
M v[80:83],a[224:227],a[208:211],v[80:83]
s_waitcnt lgkmcnt(3)
v_add_f32 v236,v238,v237
v_sub_f32 v238,v238,v237
v_add_f32 v237,v95,v191
v_sub_f32 v191,v95,v191
M v[84:87],a[224:227],a[212:215],v[84:87]
s_waitcnt lgkmcnt(2)
v_add_f32 v95,v236,v237
v_fmac_f32 v236,4.0,v237
M v[88:91],a[224:227],a[216:219],v[88:91]
s_waitcnt lgkmcnt(1)
v_fma_f32 v237,2.0,v191,v238
v_fma_f32 v191,s41,v191,v238
M v[92:95],a[224:227],a[220:223],v[92:95]
s_waitcnt vmcnt(13)
buffer_load_dwordx4 a[224:227],v251,s[20:23],s48 offen offset:0
M v[64:67],a[228:231],a[196:199],v[64:67]
ds_read_b128 a[196:199],v249 offset:2304
v_cvt_pk_bf16_f32 v233,v233,v237
M v[68:71],a[228:231],a[200:203],v[68:71]
v_cvt_pk_bf16_f32 v235,v235,v236
M v[72:75],a[228:231],a[204:207],v[72:75]
ds_write2st64_b64 v253,v[232:233],v[234:235] offset0:127 offset1:131
M v[76:79],a[228:231],a[208:211],v[76:79]
s_add_u32 s34,s33,393216
buffer_store_dwordx4 v[40:43],v252,s[24:27],s34 offen offset:128 nt
M v[80:83],a[228:231],a[212:215],v[80:83]
v_cvt_pk_bf16_f32 v128,v128,v129
v_cvt_pk_bf16_f32 v129,v130,v131
M v[84:87],a[228:231],a[216:219],v[84:87]
v_add_u32 v249,0x15400,v249
v_add_u32 v250,0x15400,v250
M v[88:91],a[228:231],a[220:223],v[88:91]
s_waitcnt lgkmcnt(2)
v_cvt_pk_bf16_f32 v132,v132,v133
v_cvt_pk_bf16_f32 v133,v134,v135
M v[92:95],a[228:231],a[192:195],v[92:95]
s_waitcnt vmcnt(14)
buffer_load_dwordx4 a[228:231],v251,s[20:23],s48 offen offset:1024
M v[64:67],a[232:235],a[200:203],v[64:67]
ds_read_b128 a[200:203],v249 offset:0
ds_write2st64_b64 v253,v[128:129],v[132:133] offset0:68 offset1:72
M v[68:71],a[232:235],a[204:207],v[68:71]
ds_read_b128 a[204:207],v250 offset:256
v_cvt_pk_bf16_f32 v136,v136,v137
M v[72:75],a[232:235],a[208:211],v[72:75]
ds_read_b128 a[208:211],v250 offset:512
v_cvt_pk_bf16_f32 v137,v138,v139
M v[76:79],a[232:235],a[212:215],v[76:79]
ds_read_b128 a[212:215],v250 offset:768
v_cvt_pk_bf16_f32 v140,v140,v141
M v[80:83],a[232:235],a[216:219],v[80:83]
ds_read_b128 a[216:219],v250 offset:1024
v_cvt_pk_bf16_f32 v141,v142,v143
M v[84:87],a[232:235],a[220:223],v[84:87]
ds_read_b128 a[220:223],v250 offset:1280
ds_write2st64_b64 v253,v[136:137],v[140:141] offset0:76 offset1:80
M v[88:91],a[232:235],a[192:195],v[88:91]
s_waitcnt lgkmcnt(9)
ds_read_b128 a[192:195],v250 offset:1536
v_cvt_pk_bf16_f32 v144,v144,v145
M v[92:95],a[232:235],a[196:199],v[92:95]
s_waitcnt vmcnt(14) lgkmcnt(8)
buffer_load_dwordx4 a[232:235],v251,s[20:23],s48 offen offset:2048
M v[64:67],a[236:239],a[200:203],v[64:67]
s_waitcnt lgkmcnt(6)
ds_read_b128 a[196:199],v250 offset:1792
ds_read_b128 a[200:203],v250 offset:2048
M v[68:71],a[236:239],a[204:207],v[68:71]
s_waitcnt lgkmcnt(7)
s_add_u32 s48,s81,6144
v_cvt_pk_bf16_f32 v145,v146,v147
v_cvt_pk_bf16_f32 v148,v148,v149
M v[72:75],a[236:239],a[208:211],v[72:75]
s_waitcnt lgkmcnt(6)
v_cvt_pk_bf16_f32 v149,v150,v151
M v[76:79],a[236:239],a[212:215],v[76:79]
s_waitcnt lgkmcnt(5)
ds_write2st64_b64 v253,v[144:145],v[148:149] offset0:85 offset1:89
M v[80:83],a[236:239],a[216:219],v[80:83]
s_waitcnt lgkmcnt(5)
v_cvt_pk_bf16_f32 v152,v152,v153
v_cvt_pk_bf16_f32 v153,v154,v155
M v[84:87],a[236:239],a[220:223],v[84:87]
s_waitcnt lgkmcnt(3)
v_cvt_pk_bf16_f32 v156,v156,v157
v_cvt_pk_bf16_f32 v157,v158,v159
M v[88:91],a[236:239],a[192:195],v[88:91]
s_waitcnt lgkmcnt(2)
ds_write2st64_b64 v253,v[152:153],v[156:157] offset0:93 offset1:97
M v[92:95],a[236:239],a[196:199],v[92:95]
s_waitcnt vmcnt(13)
buffer_load_dwordx4 a[236:239],v251,s[20:23],s48 offen offset:0
M v[64:67],a[240:243],a[204:207],v[64:67]
ds_read_b128 a[204:207],v249 offset:2304
v_lshlrev_b32 v234,16,v208
M v[68:71],a[240:243],a[208:211],v[68:71]
v_lshlrev_b32 v232,16,v204
v_lshlrev_b32 v233,16,v206
M v[72:75],a[240:243],a[212:215],v[72:75]
v_lshlrev_b32 v237,16,v214
v_lshlrev_b32 v236,16,v212
M v[76:79],a[240:243],a[216:219],v[76:79]
v_lshlrev_b32 v235,16,v210
M v[80:83],a[240:243],a[220:223],v[80:83]
s_add_u32 s34,s33,786432
buffer_store_dwordx4 v[48:51],v252,s[24:27],s34 offen offset:128 nt
M v[84:87],a[240:243],a[192:195],v[84:87]
s_waitcnt lgkmcnt(1)
s_barrier
ds_read_b128 a[88:91],v251 offset:60928
M v[88:91],a[240:243],a[196:199],v[88:91]
ds_read_b128 a[92:95],v251 offset:65024
ds_read_b128 v[128:131],v251 offset:34816
M v[92:95],a[240:243],a[200:203],v[92:95]
s_waitcnt vmcnt(14)
ds_read_b128 v[136:139],v251 offset:38912
ds_read_b128 v[144:147],v251 offset:43520
M v[64:67],a[244:247],a[208:211],v[64:67]
ds_read_b128 v[152:155],v251 offset:47616
ds_read_b128 a[208:211],v249 offset:17408
M v[68:71],a[244:247],a[212:215],v[68:71]
buffer_load_dwordx4 a[240:243],v251,s[20:23],s48 offen offset:1024
M v[72:75],a[244:247],a[216:219],v[72:75]
ds_read_b128 a[212:215],v250 offset:17664
ds_read_b128 a[216:219],v250 offset:17920
M v[76:79],a[244:247],a[220:223],v[76:79]
ds_read_b128 a[220:223],v250 offset:18176
v_fmac_f32 v232,s43,v234
M v[80:83],a[244:247],a[192:195],v[80:83]
ds_read_b128 a[192:195],v250 offset:18432
v_fmac_f32 v237,4.0,v233
M v[84:87],a[244:247],a[196:199],v[84:87]
ds_read_b128 a[196:199],v250 offset:18688
v_fma_f32 v238,-4.0,v234,v236
M v[88:91],a[244:247],a[200:203],v[88:91]
s_waitcnt lgkmcnt(12)
ds_read_b128 a[200:203],v250 offset:18944
v_fmac_f32 v232,s45,v236
M v[92:95],a[244:247],a[204:207],v[92:95]
s_waitcnt vmcnt(14) lgkmcnt(6)
buffer_load_dwordx4 a[244:247],v251,s[20:23],s48 offen offset:2048
M v[64:67],a[248:251],a[208:211],v[64:67]
s_waitcnt lgkmcnt(5)
ds_read_b128 a[204:207],v250 offset:19200
ds_read_b128 a[208:211],v250 offset:19456
M v[68:71],a[248:251],a[212:215],v[68:71]
s_waitcnt lgkmcnt(6)
s_add_u32 s48,s76,52224
v_fmac_f32 v237,s40,v235
v_sub_f32 v236,v236,v234
M v[72:75],a[248:251],a[216:219],v[72:75]
s_waitcnt lgkmcnt(5)
v_fma_f32 v234,-4.0,v233,v235
v_sub_f32 v235,v235,v233
M v[76:79],a[248:251],a[220:223],v[76:79]
s_waitcnt lgkmcnt(4)
v_add_f32 v233,v238,v234
v_sub_f32 v238,v238,v234
M v[80:83],a[248:251],a[192:195],v[80:83]
s_waitcnt lgkmcnt(3)
v_fma_f32 v234,2.0,v235,v236
v_fmac_f32 v236,-2.0,v235
M v[84:87],a[248:251],a[196:199],v[84:87]
s_waitcnt lgkmcnt(2)
v_and_b32 v208,s42,v208
v_and_b32 v204,s42,v204
M v[88:91],a[248:251],a[200:203],v[88:91]
s_waitcnt lgkmcnt(1)
v_and_b32 v206,s42,v206
v_and_b32 v214,s42,v214
M v[92:95],a[248:251],a[204:207],v[92:95]
s_waitcnt vmcnt(13)
buffer_load_dwordx4 a[248:251],v251,s[20:23],s48 offen offset:0
M v[64:67],a[252:255],a[212:215],v[64:67]
ds_read_b128 a[212:215],v249 offset:19712
v_and_b32 v212,s42,v212
M v[68:71],a[252:255],a[216:219],v[68:71]
v_and_b32 v210,s42,v210
v_fmac_f32 v204,s43,v208
M v[72:75],a[252:255],a[220:223],v[72:75]
v_fmac_f32 v214,4.0,v206
v_fma_f32 v235,-4.0,v208,v212
M v[76:79],a[252:255],a[192:195],v[76:79]
v_fmac_f32 v204,s45,v212
v_fmac_f32 v214,s40,v210
M v[80:83],a[252:255],a[196:199],v[80:83]
v_sub_f32 v212,v212,v208
v_fma_f32 v208,-4.0,v206,v210
M v[84:87],a[252:255],a[200:203],v[84:87]
s_add_u32 s34,s33,1179648
buffer_store_dwordx4 v[56:59],v252,s[24:27],s34 offen offset:128 nt
M v[88:91],a[252:255],a[204:207],v[88:91]
s_waitcnt lgkmcnt(1)
v_sub_f32 v210,v210,v206
v_add_f32 v206,v235,v208
M v[92:95],a[252:255],a[208:211],v[92:95]
s_waitcnt vmcnt(14)
buffer_load_dwordx4 a[252:255],v251,s[20:23],s48 offen offset:1024
M v[64:67],v[216:219],a[216:219],v[64:67]
ds_read_b128 a[216:219],v249 offset:34816
v_sub_f32 v235,v235,v208
M v[68:71],v[216:219],a[220:223],v[68:71]
ds_read_b128 a[220:223],v250 offset:35072
v_fma_f32 v208,2.0,v210,v212
M v[72:75],v[216:219],a[192:195],v[72:75]
ds_read_b128 a[192:195],v250 offset:35328
v_fmac_f32 v212,-2.0,v210
M v[76:79],v[216:219],a[196:199],v[76:79]
ds_read_b128 a[196:199],v250 offset:35584
v_cvt_pk_bf16_f32 v204,v232,v204
M v[80:83],v[216:219],a[200:203],v[80:83]
ds_read_b128 a[200:203],v250 offset:35840
v_cvt_pk_bf16_f32 v214,v237,v214
M v[84:87],v[216:219],a[204:207],v[84:87]
ds_read_b128 a[204:207],v250 offset:36096
v_cvt_pk_bf16_f32 v206,v233,v206
M v[88:91],v[216:219],a[208:211],v[88:91]
s_waitcnt lgkmcnt(6)
ds_read_b128 a[208:211],v250 offset:36352
v_cvt_pk_bf16_f32 v210,v234,v208
M v[92:95],v[216:219],a[212:215],v[92:95]
s_waitcnt vmcnt(14) lgkmcnt(6)
buffer_load_dwordx4 v[216:219],v251,s[20:23],s48 offen offset:2048
M v[64:67],v[220:223],a[216:219],v[64:67]
s_waitcnt lgkmcnt(5)
ds_read_b128 a[212:215],v250 offset:36608
ds_read_b128 a[216:219],v250 offset:36864
M v[68:71],v[220:223],a[220:223],v[68:71]
s_waitcnt lgkmcnt(6)
s_add_u32 s48,s77,52224
v_cvt_pk_bf16_f32 v208,v238,v235
v_cvt_pk_bf16_f32 v212,v236,v212
M v[72:75],v[220:223],a[192:195],v[72:75]
s_waitcnt lgkmcnt(5)
v_lshlrev_b32 v234,16,v209
v_lshlrev_b32 v232,16,v205
M v[76:79],v[220:223],a[196:199],v[76:79]
s_waitcnt lgkmcnt(4)
v_lshlrev_b32 v233,16,v207
v_lshlrev_b32 v237,16,v215
M v[80:83],v[220:223],a[200:203],v[80:83]
s_waitcnt lgkmcnt(3)
v_lshlrev_b32 v236,16,v213
v_lshlrev_b32 v235,16,v211
M v[84:87],v[220:223],a[204:207],v[84:87]
s_waitcnt lgkmcnt(2)
v_fmac_f32 v232,s43,v234
v_fmac_f32 v237,4.0,v233
M v[88:91],v[220:223],a[208:211],v[88:91]
s_waitcnt lgkmcnt(1)
v_fma_f32 v238,-4.0,v234,v236
v_fmac_f32 v232,s45,v236
M v[92:95],v[220:223],a[212:215],v[92:95]
s_waitcnt vmcnt(13)
buffer_load_dwordx4 v[220:223],v251,s[20:23],s48 offen offset:0
M v[64:67],v[224:227],a[220:223],v[64:67]
ds_read_b128 a[220:223],v249 offset:37120
v_fmac_f32 v237,s40,v235
M v[68:71],v[224:227],a[192:195],v[68:71]
v_sub_f32 v236,v236,v234
v_fma_f32 v234,-4.0,v233,v235
M v[72:75],v[224:227],a[196:199],v[72:75]
v_sub_f32 v235,v235,v233
v_add_f32 v233,v238,v234
M v[76:79],v[224:227],a[200:203],v[76:79]
v_sub_f32 v238,v238,v234
v_fma_f32 v234,2.0,v235,v236
M v[80:83],v[224:227],a[204:207],v[80:83]
v_fmac_f32 v236,-2.0,v235
v_and_b32 v209,s42,v209
M v[84:87],v[224:227],a[208:211],v[84:87]
v_and_b32 v205,s42,v205
v_and_b32 v207,s42,v207
M v[88:91],v[224:227],a[212:215],v[88:91]
s_waitcnt lgkmcnt(1)
s_add_u32 s34,s32,786432
buffer_store_dwordx4 a[80:83],v252,s[24:27],s34 offen offset:640 nt
M v[92:95],v[224:227],a[216:219],v[92:95]
s_waitcnt vmcnt(14)
buffer_load_dwordx4 v[224:227],v251,s[20:23],s48 offen offset:1024
M v[64:67],v[228:231],a[192:195],v[64:67]
ds_read_b128 a[192:195],v249 offset:52224
v_and_b32 v215,s42,v215
M v[68:71],v[228:231],a[196:199],v[68:71]
ds_read_b128 a[196:199],v250 offset:52480
v_and_b32 v213,s42,v213
M v[72:75],v[228:231],a[200:203],v[72:75]
ds_read_b128 a[200:203],v250 offset:52736
v_and_b32 v211,s42,v211
M v[76:79],v[228:231],a[204:207],v[76:79]
ds_read_b128 a[204:207],v250 offset:52992
v_fmac_f32 v205,s43,v209
M v[80:83],v[228:231],a[208:211],v[80:83]
ds_read_b128 a[208:211],v250 offset:53248
v_fmac_f32 v215,4.0,v207
M v[84:87],v[228:231],a[212:215],v[84:87]
ds_read_b128 a[212:215],v250 offset:53504
v_fma_f32 v235,-4.0,v209,v213
M v[88:91],v[228:231],a[216:219],v[88:91]
s_waitcnt lgkmcnt(6)
ds_read_b128 a[216:219],v250 offset:53760
v_fmac_f32 v205,s45,v213
M v[92:95],v[228:231],a[220:223],v[92:95]
s_waitcnt vmcnt(14) lgkmcnt(6)
buffer_load_dwordx4 v[228:231],v251,s[20:23],s48 offen offset:2048
M v[64:67],a[224:227],a[192:195],v[64:67]
s_waitcnt lgkmcnt(5)
ds_read_b128 a[220:223],v250 offset:54016
ds_read_b128 a[192:195],v250 offset:54272
M v[68:71],a[224:227],a[196:199],v[68:71]
s_waitcnt lgkmcnt(6)
s_add_u32 s48,s78,52224
v_fmac_f32 v215,s40,v211
v_sub_f32 v213,v213,v209
M v[72:75],a[224:227],a[200:203],v[72:75]
s_waitcnt lgkmcnt(5)
v_fma_f32 v209,-4.0,v207,v211
v_sub_f32 v211,v211,v207
M v[76:79],a[224:227],a[204:207],v[76:79]
s_waitcnt lgkmcnt(4)
v_add_f32 v207,v235,v209
v_sub_f32 v235,v235,v209
M v[80:83],a[224:227],a[208:211],v[80:83]
s_waitcnt lgkmcnt(3)
v_fma_f32 v209,2.0,v211,v213
v_fmac_f32 v213,-2.0,v211
M v[84:87],a[224:227],a[212:215],v[84:87]
s_waitcnt lgkmcnt(2)
v_cvt_pk_bf16_f32 v205,v232,v205
v_cvt_pk_bf16_f32 v215,v237,v215
M v[88:91],a[224:227],a[216:219],v[88:91]
s_waitcnt lgkmcnt(1)
v_cvt_pk_bf16_f32 v207,v233,v207
v_cvt_pk_bf16_f32 v211,v234,v209
M v[92:95],a[224:227],a[220:223],v[92:95]
s_waitcnt vmcnt(13)
buffer_load_dwordx4 a[224:227],v251,s[20:23],s48 offen offset:0
M v[64:67],a[228:231],a[196:199],v[64:67]
ds_read_b128 a[196:199],v249 offset:54528
v_cvt_pk_bf16_f32 v209,v238,v235
M v[68:71],a[228:231],a[200:203],v[68:71]
v_cvt_pk_bf16_f32 v213,v236,v213
M v[72:75],a[228:231],a[204:207],v[72:75]
s_barrier
ds_write2st64_b64 v247,v[192:193],v[202:203] offset0:102 offset1:119
M v[76:79],a[228:231],a[208:211],v[76:79]
s_add_u32 s28,s64,7077888
buffer_load_dwordx2 v[192:193],v245,s[12:15],s28 offen offset:0
M v[80:83],a[228:231],a[212:215],v[80:83]
buffer_load_dwordx2 v[202:203],v245,s[16:19],s28 offen offset:1536
M v[84:87],a[228:231],a[216:219],v[84:87]
ds_write2st64_b64 v247,v[194:195],v[196:197] offset0:34 offset1:51
M v[88:91],a[228:231],a[220:223],v[88:91]
s_waitcnt lgkmcnt(3)
buffer_load_dwordx2 v[194:195],v245,s[8:11],s28 offen offset:0
M v[92:95],a[228:231],a[192:195],v[92:95]
s_waitcnt vmcnt(16)
s_add_u32 s34,s32,983040
buffer_load_dwordx2 v[196:197],v245,s[8:11],s28 offen offset:384
M v[64:67],a[232:235],a[200:203],v[64:67]
buffer_load_dwordx4 a[228:231],v251,s[20:23],s48 offen offset:1024
M v[68:71],a[232:235],a[204:207],v[68:71]
buffer_store_dwordx4 a[84:87],v252,s[24:27],s34 offen offset:640 nt
v_add_u32 v249,0xfffece00,v249
v_add_u32 v250,0xfffece00,v250
M v[72:75],a[232:235],a[208:211],v[72:75]
ds_read_b128 a[200:203],v249 offset:60928
ds_read_b128 a[204:207],v250 offset:61184
M v[76:79],a[232:235],a[212:215],v[76:79]
ds_read_b128 a[208:211],v250 offset:61440
ds_read_b128 a[212:215],v250 offset:61696
M v[80:83],a[232:235],a[216:219],v[80:83]
ds_read_b128 a[216:219],v250 offset:61952
ds_write2st64_b64 v247,v[198:199],v[200:201] offset0:68 offset1:85
M v[84:87],a[232:235],a[220:223],v[84:87]
buffer_load_dwordx2 v[198:199],v245,s[8:11],s28 offen offset:768
M v[88:91],a[232:235],a[192:195],v[88:91]
s_waitcnt lgkmcnt(8)
buffer_load_dwordx2 v[200:201],v245,s[8:11],s28 offen offset:1152
M v[92:95],a[232:235],a[196:199],v[92:95]
s_waitcnt vmcnt(20) lgkmcnt(5)
buffer_load_dwordx4 a[232:235],v251,s[20:23],s48 offen offset:2048
M v[64:67],a[236:239],a[200:203],v[64:67]
s_waitcnt lgkmcnt(4)
ds_read_b128 a[220:223],v250 offset:62208
ds_read_b128 a[192:195],v250 offset:62464
M v[68:71],a[236:239],a[204:207],v[68:71]
s_waitcnt lgkmcnt(5)
s_add_u32 s48,s79,52224
ds_read_b128 a[196:199],v250 offset:62720
ds_read_b128 a[200:203],v250 offset:62976
M v[72:75],a[236:239],a[208:211],v[72:75]
s_waitcnt lgkmcnt(6)
ds_write2st64_b64 v247,v[204:205],v[214:215] offset0:103 offset1:120
M v[76:79],a[236:239],a[212:215],v[76:79]
s_waitcnt lgkmcnt(6)
s_add_u32 s28,s64,7471104
buffer_load_dwordx2 v[204:205],v245,s[12:15],s28 offen offset:0
M v[80:83],a[236:239],a[216:219],v[80:83]
s_waitcnt lgkmcnt(4)
buffer_load_dwordx2 v[214:215],v245,s[16:19],s28 offen offset:1536
M v[84:87],a[236:239],a[220:223],v[84:87]
s_waitcnt lgkmcnt(3)
ds_write2st64_b64 v247,v[206:207],v[208:209] offset0:35 offset1:52
M v[88:91],a[236:239],a[192:195],v[88:91]
s_waitcnt lgkmcnt(3)
buffer_load_dwordx2 v[206:207],v245,s[8:11],s28 offen offset:0
M v[92:95],a[236:239],a[196:199],v[92:95]
s_waitcnt vmcnt(22)
buffer_load_dwordx2 v[208:209],v245,s[8:11],s28 offen offset:384
M v[64:67],a[240:243],a[204:207],v[64:67]
buffer_load_dwordx4 a[236:239],v251,s[20:23],s48 offen offset:0
M v[68:71],a[240:243],a[208:211],v[68:71]
ds_read_b128 a[204:207],v249 offset:63232
ds_write2st64_b64 v247,v[210:211],v[212:213] offset0:69 offset1:86
M v[72:75],a[240:243],a[212:215],v[72:75]
buffer_load_dwordx2 v[210:211],v245,s[8:11],s28 offen offset:768
M v[76:79],a[240:243],a[216:219],v[76:79]
buffer_load_dwordx2 v[212:213],v245,s[8:11],s28 offen offset:1152
M v[80:83],a[240:243],a[220:223],v[80:83]
v_fmac_f32 v239,s43,v241
v_fmac_f32 v244,4.0,v240
M v[84:87],a[240:243],a[192:195],v[84:87]
v_fma_f32 v232,-4.0,v241,v243
v_fmac_f32 v239,s45,v243
M v[88:91],a[240:243],a[196:199],v[88:91]
s_waitcnt lgkmcnt(4)
v_fmac_f32 v244,s40,v242
v_sub_f32 v243,v243,v241
M v[92:95],a[240:243],a[200:203],v[92:95]
s_waitcnt vmcnt(25)
buffer_load_dwordx4 a[240:243],v251,s[20:23],s48 offen offset:1024
M v[64:67],a[244:247],a[208:211],v[64:67]
s_add_u32 s34,s32,1179648
buffer_store_dwordx4 a[88:91],v252,s[24:27],s34 offen offset:640 nt
M v[68:71],a[244:247],a[212:215],v[68:71]
ds_read_b128 a[208:211],v249 offset:0
ds_read_b128 a[212:215],v250 offset:256
M v[72:75],a[244:247],a[216:219],v[72:75]
ds_read_b128 a[216:219],v250 offset:512
v_fma_f32 v241,-4.0,v240,v242
M v[76:79],a[244:247],a[220:223],v[76:79]
ds_read_b128 a[220:223],v250 offset:768
v_sub_f32 v242,v242,v240
M v[80:83],a[244:247],a[192:195],v[80:83]
ds_read_b128 a[192:195],v250 offset:1024
v_add_f32 v240,v232,v241
M v[84:87],a[244:247],a[196:199],v[84:87]
ds_read_b128 a[196:199],v250 offset:1280
v_sub_f32 v232,v232,v241
M v[88:91],a[244:247],a[200:203],v[88:91]
s_waitcnt lgkmcnt(7)
ds_read_b128 a[200:203],v250 offset:1536
v_fma_f32 v241,2.0,v242,v243
M v[92:95],a[244:247],a[204:207],v[92:95]
s_waitcnt vmcnt(26) lgkmcnt(6)
buffer_load_dwordx4 a[244:247],v251,s[20:23],s48 offen offset:2048
M v[160:163],a[248:251],a[208:211],v[160:163]
s_waitcnt lgkmcnt(5)
ds_read_b128 a[204:207],v250 offset:1792
ds_read_b128 a[208:211],v250 offset:2048
M v[164:167],a[248:251],a[212:215],v[164:167]
s_waitcnt lgkmcnt(6)
s_add_u32 s48,s80,52224
v_fmac_f32 v243,-2.0,v242
v_cvt_pk_bf16_f32 v233,v239,v244
M v[168:171],a[248:251],a[216:219],v[168:171]
s_waitcnt lgkmcnt(5)
v_cvt_pk_bf16_f32 v234,v240,v232
v_cvt_pk_bf16_f32 v235,v241,v243
M v[172:175],a[248:251],a[220:223],v[172:175]
s_waitcnt lgkmcnt(4)
buffer_load_short_d16_hi v239,v246,s[12:15],s71 offen offset:0
M v[176:179],a[248:251],a[192:195],v[176:179]
s_waitcnt lgkmcnt(3)
buffer_load_short_d16_hi v240,v246,s[8:11],s71 offen offset:0
M v[180:183],a[248:251],a[196:199],v[180:183]
s_waitcnt lgkmcnt(2)
buffer_load_short_d16_hi v241,v246,s[8:11],s71 offen offset:384
M v[184:187],a[248:251],a[200:203],v[184:187]
s_waitcnt lgkmcnt(1)
buffer_load_short_d16_hi v242,v246,s[8:11],s71 offen offset:768
M v[188:191],a[248:251],a[204:207],v[188:191]
s_waitcnt vmcnt(29)
buffer_load_short_d16_hi v243,v246,s[8:11],s71 offen offset:1152
M v[160:163],a[252:255],a[212:215],v[160:163]
buffer_load_short_d16_hi v244,v246,s[16:19],s71 offen offset:1536
M v[164:167],a[252:255],a[216:219],v[164:167]
buffer_load_dwordx4 a[248:251],v251,s[20:23],s48 offen offset:0
M v[168:171],a[252:255],a[220:223],v[168:171]
ds_read_b128 a[212:215],v249 offset:2304
ds_write_b16 v248,v233 offset:52224
M v[172:175],a[252:255],a[192:195],v[172:175]
ds_write_b16_d16_hi v248,v233 offset:60928
M v[176:179],a[252:255],a[196:199],v[176:179]
ds_write_b16 v248,v234 offset:17408
M v[180:183],a[252:255],a[200:203],v[180:183]
ds_write_b16_d16_hi v248,v234 offset:26112
M v[184:187],a[252:255],a[204:207],v[184:187]
s_waitcnt lgkmcnt(5)
ds_write_b16 v248,v235 offset:34816
M v[188:191],a[252:255],a[208:211],v[188:191]
s_waitcnt vmcnt(31)
buffer_load_dwordx4 a[252:255],v251,s[20:23],s48 offen offset:1024
M v[160:163],v[216:219],a[216:219],v[160:163]
ds_write_b16_d16_hi v248,v235 offset:43520
M v[164:167],v[216:219],a[220:223],v[164:167]
s_add_u32 s34,s32,1376256
buffer_store_dwordx4 a[92:95],v252,s[24:27],s34 offen offset:640 nt
v_add_u32 v249,0x15400,v249
v_add_u32 v250,0x15400,v250
M v[168:171],v[216:219],a[192:195],v[168:171]
ds_read_b128 a[216:219],v249 offset:0
ds_read_b128 a[220:223],v250 offset:256
M v[172:175],v[216:219],a[196:199],v[172:175]
ds_read_b128 a[192:195],v250 offset:512
ds_read_b128 a[196:199],v250 offset:768
M v[176:179],v[216:219],a[200:203],v[176:179]
s_waitcnt vmcnt(24)
ds_read_b128 a[200:203],v250 offset:1024
v_lshlrev_b32 v234,16,v196
M v[180:183],v[216:219],a[204:207],v[180:183]
ds_read_b128 a[204:207],v250 offset:1280
v_lshlrev_b32 v232,16,v192
M v[184:187],v[216:219],a[208:211],v[184:187]
s_waitcnt lgkmcnt(12)
ds_read_b128 a[208:211],v250 offset:1536
v_lshlrev_b32 v233,16,v194
M v[188:191],v[216:219],a[212:215],v[188:191]
s_waitcnt lgkmcnt(6)
buffer_load_dwordx4 v[216:219],v251,s[20:23],s48 offen offset:2048
M v[160:163],v[220:223],a[216:219],v[160:163]
s_waitcnt lgkmcnt(5)
ds_read_b128 a[212:215],v250 offset:1792
ds_read_b128 a[216:219],v250 offset:2048
M v[164:167],v[220:223],a[220:223],v[164:167]
s_waitcnt vmcnt(21) lgkmcnt(6)
s_add_u32 s48,s81,52224
v_lshlrev_b32 v237,16,v202
v_lshlrev_b32 v236,16,v200
M v[168:171],v[220:223],a[192:195],v[168:171]
s_waitcnt lgkmcnt(5)
v_lshlrev_b32 v235,16,v198
v_fmac_f32 v232,s43,v234
M v[172:175],v[220:223],a[196:199],v[172:175]
s_waitcnt lgkmcnt(4)
v_fmac_f32 v237,4.0,v233
v_fma_f32 v238,-4.0,v234,v236
M v[176:179],v[220:223],a[200:203],v[176:179]
s_waitcnt lgkmcnt(3)
v_fmac_f32 v232,s45,v236
v_fmac_f32 v237,s40,v235
M v[180:183],v[220:223],a[204:207],v[180:183]
s_waitcnt lgkmcnt(2)
v_sub_f32 v236,v236,v234
v_fma_f32 v234,-4.0,v233,v235
M v[184:187],v[220:223],a[208:211],v[184:187]
s_waitcnt lgkmcnt(1)
v_sub_f32 v235,v235,v233
v_add_f32 v233,v238,v234
M v[188:191],v[220:223],a[212:215],v[188:191]
buffer_load_dwordx4 v[220:223],v251,s[20:23],s48 offen offset:0
M v[160:163],v[224:227],a[220:223],v[160:163]
ds_read_b128 a[220:223],v249 offset:2304
v_sub_f32 v238,v238,v234
M v[164:167],v[224:227],a[192:195],v[164:167]
v_fma_f32 v234,2.0,v235,v236
v_fmac_f32 v236,-2.0,v235
M v[168:171],v[224:227],a[196:199],v[168:171]
v_and_b32 v196,s42,v196
v_and_b32 v192,s42,v192
M v[172:175],v[224:227],a[200:203],v[172:175]
v_and_b32 v194,s42,v194
v_and_b32 v202,s42,v202
M v[176:179],v[224:227],a[204:207],v[176:179]
v_and_b32 v200,s42,v200
v_and_b32 v198,s42,v198
M v[180:183],v[224:227],a[208:211],v[180:183]
v_fmac_f32 v192,s43,v196
v_fmac_f32 v202,4.0,v194
M v[184:187],v[224:227],a[212:215],v[184:187]
s_waitcnt lgkmcnt(1)
v_fma_f32 v235,-4.0,v196,v200
v_fmac_f32 v192,s45,v200
M v[188:191],v[224:227],a[216:219],v[188:191]
buffer_load_dwordx4 v[224:227],v251,s[20:23],s48 offen offset:1024
M v[160:163],v[228:231],a[192:195],v[160:163]
ds_read_b128 a[192:195],v249 offset:17408
v_fmac_f32 v202,s40,v198
M v[164:167],v[228:231],a[196:199],v[164:167]
ds_read_b128 a[196:199],v250 offset:17664
v_sub_f32 v200,v200,v196
M v[168:171],v[228:231],a[200:203],v[168:171]
s_add_u32 s34,s33,0
buffer_store_dwordx4 v[128:131],v252,s[24:27],s34 offen offset:1280 nt
M v[172:175],v[228:231],a[204:207],v[172:175]
ds_read_b128 a[200:203],v250 offset:17920
ds_read_b128 a[204:207],v250 offset:18176
M v[176:179],v[228:231],a[208:211],v[176:179]
ds_read_b128 a[208:211],v250 offset:18432
v_fma_f32 v196,-4.0,v194,v198
M v[180:183],v[228:231],a[212:215],v[180:183]
ds_read_b128 a[212:215],v250 offset:18688
v_sub_f32 v198,v198,v194
M v[184:187],v[228:231],a[216:219],v[184:187]
s_waitcnt lgkmcnt(6)
ds_read_b128 a[216:219],v250 offset:18944
v_add_f32 v194,v235,v196
M v[188:191],v[228:231],a[220:223],v[188:191]
s_waitcnt lgkmcnt(6)
buffer_load_dwordx4 v[228:231],v251,s[20:23],s48 offen offset:2048
M v[160:163],a[224:227],a[192:195],v[160:163]
s_waitcnt lgkmcnt(5)
ds_read_b128 a[220:223],v250 offset:19200
ds_read_b128 a[192:195],v250 offset:19456
M v[164:167],a[224:227],a[196:199],v[164:167]
s_waitcnt lgkmcnt(6)
s_add_u32 s46,s76,9216
v_sub_f32 v235,v235,v196
v_fma_f32 v196,2.0,v198,v200
M v[168:171],a[224:227],a[200:203],v[168:171]
s_waitcnt lgkmcnt(5)
v_fmac_f32 v200,-2.0,v198
v_cvt_pk_bf16_f32 v192,v232,v192
M v[172:175],a[224:227],a[204:207],v[172:175]
s_waitcnt lgkmcnt(4)
v_cvt_pk_bf16_f32 v202,v237,v202
v_cvt_pk_bf16_f32 v194,v233,v194
M v[176:179],a[224:227],a[208:211],v[176:179]
s_waitcnt lgkmcnt(3)
v_cvt_pk_bf16_f32 v198,v234,v196
v_cvt_pk_bf16_f32 v196,v238,v235
M v[180:183],a[224:227],a[212:215],v[180:183]
s_waitcnt lgkmcnt(2)
v_cvt_pk_bf16_f32 v200,v236,v200
v_lshlrev_b32 v234,16,v197
M v[184:187],a[224:227],a[216:219],v[184:187]
s_waitcnt lgkmcnt(1)
v_lshlrev_b32 v232,16,v193
v_lshlrev_b32 v233,16,v195
M v[188:191],a[224:227],a[220:223],v[188:191]
buffer_load_dwordx4 a[224:227],v251,s[20:23],s46 offen offset:0
M v[160:163],a[228:231],a[196:199],v[160:163]
ds_read_b128 a[196:199],v249 offset:19712
v_lshlrev_b32 v237,16,v203
M v[164:167],a[228:231],a[200:203],v[164:167]
s_add_u32 s47,s76,12288
v_lshlrev_b32 v236,16,v201
v_lshlrev_b32 v235,16,v199
M v[168:171],a[228:231],a[204:207],v[168:171]
v_fmac_f32 v232,s43,v234
v_fmac_f32 v237,4.0,v233
M v[172:175],a[228:231],a[208:211],v[172:175]
v_fma_f32 v238,-4.0,v234,v236
v_fmac_f32 v232,s45,v236
M v[176:179],a[228:231],a[212:215],v[176:179]
v_fmac_f32 v237,s40,v235
v_sub_f32 v236,v236,v234
M v[180:183],a[228:231],a[216:219],v[180:183]
v_fma_f32 v234,-4.0,v233,v235
v_sub_f32 v235,v235,v233
M v[184:187],a[228:231],a[220:223],v[184:187]
s_waitcnt lgkmcnt(1)
v_add_f32 v233,v238,v234
v_sub_f32 v238,v238,v234
M v[188:191],a[228:231],a[192:195],v[188:191]
s_waitcnt vmcnt(25)
buffer_load_dwordx4 a[228:231],v251,s[20:23],s47 offen offset:0
M v[160:163],a[232:235],a[200:203],v[160:163]
ds_read_b128 a[200:203],v249 offset:34816
v_fma_f32 v234,2.0,v235,v236
M v[164:167],a[232:235],a[204:207],v[164:167]
s_add_u32 s48,s76,15360
ds_read_b128 a[204:207],v250 offset:35072
v_fmac_f32 v236,-2.0,v235
M v[168:171],a[232:235],a[208:211],v[168:171]
ds_read_b128 a[208:211],v250 offset:35328
v_and_b32 v197,s42,v197
M v[172:175],a[232:235],a[212:215],v[172:175]
s_add_u32 s34,s33,393216
buffer_store_dwordx4 v[136:139],v252,s[24:27],s34 offen offset:1280 nt
M v[176:179],a[232:235],a[216:219],v[176:179]
ds_read_b128 a[212:215],v250 offset:35584
ds_read_b128 a[216:219],v250 offset:35840
M v[180:183],a[232:235],a[220:223],v[180:183]
ds_read_b128 a[220:223],v250 offset:36096
v_and_b32 v193,s42,v193
M v[184:187],a[232:235],a[192:195],v[184:187]
s_waitcnt lgkmcnt(6)
ds_read_b128 a[192:195],v250 offset:36352
v_and_b32 v195,s42,v195
M v[188:191],a[232:235],a[196:199],v[188:191]
s_waitcnt vmcnt(22) lgkmcnt(6)
buffer_load_dwordx4 a[232:235],v251,s[20:23],s48 offen offset:0
M v[160:163],a[236:239],a[200:203],v[160:163]
s_waitcnt lgkmcnt(5)
ds_read_b128 a[196:199],v250 offset:36608
ds_read_b128 a[200:203],v250 offset:36864
M v[164:167],a[236:239],a[204:207],v[164:167]
s_waitcnt lgkmcnt(6)
v_and_b32 v203,s42,v203
v_and_b32 v201,s42,v201
M v[168:171],a[236:239],a[208:211],v[168:171]
s_waitcnt lgkmcnt(5)
v_and_b32 v199,s42,v199
v_fmac_f32 v193,s43,v197
M v[172:175],a[236:239],a[212:215],v[172:175]
s_waitcnt lgkmcnt(4)
v_fmac_f32 v203,4.0,v195
v_fma_f32 v235,-4.0,v197,v201
M v[176:179],a[236:239],a[216:219],v[176:179]
s_waitcnt lgkmcnt(3)
v_fmac_f32 v193,s45,v201
v_fmac_f32 v203,s40,v199
M v[180:183],a[236:239],a[220:223],v[180:183]
s_waitcnt lgkmcnt(2)
v_sub_f32 v201,v201,v197
v_fma_f32 v197,-4.0,v195,v199
M v[184:187],a[236:239],a[192:195],v[184:187]
s_waitcnt lgkmcnt(1)
v_sub_f32 v199,v199,v195
v_add_f32 v195,v235,v197
M v[188:191],a[236:239],a[196:199],v[188:191]
s_waitcnt vmcnt(20)
buffer_load_dwordx4 a[236:239],v251,s[20:23],s46 offen offset:1024
M v[160:163],a[240:243],a[204:207],v[160:163]
ds_read_b128 a[204:207],v249 offset:37120
v_sub_f32 v235,v235,v197
M v[164:167],a[240:243],a[208:211],v[164:167]
v_fma_f32 v197,2.0,v199,v201
v_fmac_f32 v201,-2.0,v199
M v[168:171],a[240:243],a[212:215],v[168:171]
v_cvt_pk_bf16_f32 v193,v232,v193
v_cvt_pk_bf16_f32 v203,v237,v203
M v[172:175],a[240:243],a[216:219],v[172:175]
v_cvt_pk_bf16_f32 v195,v233,v195
v_cvt_pk_bf16_f32 v199,v234,v197
M v[176:179],a[240:243],a[220:223],v[176:179]
v_cvt_pk_bf16_f32 v197,v238,v235
v_cvt_pk_bf16_f32 v201,v236,v201
M v[180:183],a[240:243],a[192:195],v[180:183]
ds_write2st64_b64 v247,v[192:193],v[202:203] offset0:104 offset1:121
M v[184:187],a[240:243],a[196:199],v[184:187]
s_waitcnt lgkmcnt(2)
s_add_u32 s28,s65,6291456
buffer_load_dwordx2 v[192:193],v245,s[12:15],s28 offen offset:0
M v[188:191],a[240:243],a[200:203],v[188:191]
s_waitcnt vmcnt(20)
buffer_load_dwordx2 v[202:203],v245,s[16:19],s28 offen offset:1536
M v[160:163],a[244:247],a[208:211],v[160:163]
buffer_load_dwordx4 a[240:243],v251,s[20:23],s47 offen offset:1024
M v[164:167],a[244:247],a[212:215],v[164:167]
ds_read_b128 a[208:211],v249 offset:52224
ds_read_b128 a[212:215],v250 offset:52480
M v[168:171],a[244:247],a[216:219],v[168:171]
ds_read_b128 a[216:219],v250 offset:52736
ds_write2st64_b64 v247,v[194:195],v[196:197] offset0:36 offset1:53
M v[172:175],a[244:247],a[220:223],v[172:175]
buffer_load_dwordx2 v[194:195],v245,s[8:11],s28 offen offset:0
M v[176:179],a[244:247],a[192:195],v[176:179]
s_add_u32 s34,s33,786432
buffer_load_dwordx2 v[196:197],v245,s[8:11],s28 offen offset:384
M v[180:183],a[244:247],a[196:199],v[180:183]
ds_read_b128 a[220:223],v250 offset:52992
buffer_store_dwordx4 v[144:147],v252,s[24:27],s34 offen offset:1280 nt
M v[184:187],a[244:247],a[200:203],v[184:187]
s_waitcnt lgkmcnt(6)
ds_read_b128 a[192:195],v250 offset:53248
ds_read_b128 a[196:199],v250 offset:53504
ds_write2st64_b64 v247,v[198:199],v[200:201] offset0:70 offset1:87
M v[188:191],a[244:247],a[204:207],v[188:191]
s_waitcnt vmcnt(18) lgkmcnt(7)
s_barrier
ds_read_b128 a[200:203],v250 offset:53760
M v[160:163],a[248:251],a[208:211],v[160:163]
s_waitcnt lgkmcnt(7)
buffer_load_dwordx2 v[198:199],v245,s[8:11],s28 offen offset:768
v_cvt_pk_bf16_f32 v64,v64,v65
v_cvt_pk_bf16_f32 v65,v66,v67
v_cvt_pk_bf16_f32 v68,v68,v69
v_cvt_pk_bf16_f32 v69,v70,v71
M v[164:167],a[248:251],a[212:215],v[164:167]
s_waitcnt lgkmcnt(6)
buffer_load_dwordx2 v[200:201],v245,s[8:11],s28 offen offset:1152
ds_write2st64_b64 v253,v[64:65],v[68:69] offset0:136 offset1:140
M v[168:171],a[248:251],a[216:219],v[168:171]
s_waitcnt lgkmcnt(5)
buffer_load_dwordx4 a[244:247],v251,s[20:23],s48 offen offset:1024
ds_read_b128 a[204:207],v250 offset:54016
v_cvt_pk_bf16_f32 v72,v72,v73
v_cvt_pk_bf16_f32 v73,v74,v75
M v[172:175],a[248:251],a[220:223],v[172:175]
s_waitcnt lgkmcnt(5)
ds_read_b128 a[208:211],v250 offset:54272
v_cvt_pk_bf16_f32 v76,v76,v77
v_cvt_pk_bf16_f32 v77,v78,v79
M v[176:179],a[248:251],a[192:195],v[176:179]
s_waitcnt lgkmcnt(5)
ds_write2st64_b64 v253,v[72:73],v[76:77] offset0:144 offset1:148
M v[180:183],a[248:251],a[196:199],v[180:183]
s_waitcnt lgkmcnt(4)
v_cvt_pk_bf16_f32 v80,v80,v81
v_cvt_pk_bf16_f32 v81,v82,v83
v_cvt_pk_bf16_f32 v84,v84,v85
M v[184:187],a[248:251],a[200:203],v[184:187]
s_waitcnt lgkmcnt(2)
v_cvt_pk_bf16_f32 v85,v86,v87
M v[188:191],a[248:251],a[204:207],v[188:191]
s_waitcnt vmcnt(20)
buffer_load_dwordx4 a[248:251],v251,s[20:23],s46 offen offset:2048
ds_write2st64_b64 v253,v[80:81],v[84:85] offset0:170 offset1:174
v_cvt_pk_bf16_f32 v88,v88,v89
M v[160:163],a[252:255],a[212:215],v[160:163]
ds_read_b128 a[212:215],v249 offset:54528
v_cvt_pk_bf16_f32 v89,v90,v91
v_cvt_pk_bf16_f32 v92,v92,v93
v_cvt_pk_bf16_f32 v93,v94,v95
M v[164:167],a[252:255],a[216:219],v[164:167]
ds_write2st64_b64 v253,v[88:89],v[92:93] offset0:178 offset1:182
M v[168:171],a[252:255],a[220:223],v[168:171]
v_lshlrev_b32 v234,16,v208
v_lshlrev_b32 v232,16,v204
v_lshlrev_b32 v233,16,v206
M v[172:175],a[252:255],a[192:195],v[172:175]
v_lshlrev_b32 v237,16,v214
v_lshlrev_b32 v236,16,v212
v_lshlrev_b32 v235,16,v210
M v[176:179],a[252:255],a[196:199],v[176:179]
s_waitcnt lgkmcnt(0)
s_barrier
ds_read_b128 v[64:67],v0 offset:0
v_fmac_f32 v232,s43,v234
v_fmac_f32 v237,4.0,v233
v_fma_f32 v238,-4.0,v234,v236
M v[180:183],a[252:255],a[200:203],v[180:183]
ds_read_b128 v[72:75],v0 offset:4096
ds_read_b128 v[80:83],v0 offset:17408
v_fmac_f32 v232,s45,v236
v_fmac_f32 v237,s40,v235
v_sub_f32 v236,v236,v234
v_fma_f32 v234,-4.0,v233,v235
M v[184:187],a[252:255],a[204:207],v[184:187]
ds_read_b128 v[88:91],v0 offset:21504
v_add_u32 v249,0xfffece00,v249
v_sub_f32 v235,v235,v233
v_add_f32 v233,v238,v234
v_sub_f32 v238,v238,v234
v_fma_f32 v234,2.0,v235,v236
M v[188:191],a[252:255],a[208:211],v[188:191]
s_waitcnt vmcnt(19)
buffer_load_dwordx4 a[252:255],v251,s[20:23],s47 offen offset:2048
v_fmac_f32 v236,-2.0,v235
v_and_b32 v208,s42,v208
v_and_b32 v204,s42,v204
v_and_b32 v206,s42,v206
M v[160:163],v[216:219],a[216:219],v[160:163]
v_add_u32 v250,0xfffece00,v250
v_and_b32 v214,s42,v214
v_and_b32 v212,s42,v212
v_and_b32 v210,s42,v210
v_fmac_f32 v204,s43,v208
M v[164:167],v[216:219],a[220:223],v[164:167]
ds_read_b128 a[216:219],v249 offset:60928
ds_read_b128 a[220:223],v250 offset:61184
v_fmac_f32 v214,4.0,v206
v_fma_f32 v235,-4.0,v208,v212
v_fmac_f32 v204,s45,v212
v_fmac_f32 v214,s40,v210
M v[168:171],v[216:219],a[192:195],v[168:171]
ds_read_b128 a[192:195],v250 offset:61440
v_sub_f32 v212,v212,v208
v_fma_f32 v208,-4.0,v206,v210
v_sub_f32 v210,v210,v206
v_add_f32 v206,v235,v208
M v[172:175],v[216:219],a[196:199],v[172:175]
ds_read_b128 a[196:199],v250 offset:61696
v_sub_f32 v235,v235,v208
v_fma_f32 v208,2.0,v210,v212
v_fmac_f32 v212,-2.0,v210
v_cvt_pk_bf16_f32 v204,v232,v204
M v[176:179],v[216:219],a[200:203],v[176:179]
ds_read_b128 a[200:203],v250 offset:61952
v_cvt_pk_bf16_f32 v214,v237,v214
v_cvt_pk_bf16_f32 v206,v233,v206
v_cvt_pk_bf16_f32 v210,v234,v208
v_cvt_pk_bf16_f32 v208,v238,v235
M v[180:183],v[216:219],a[204:207],v[180:183]
s_add_u32 s34,s33,1179648
buffer_store_dwordx4 v[152:155],v252,s[24:27],s34 offen offset:1280 nt
v_cvt_pk_bf16_f32 v212,v236,v212
v_lshlrev_b32 v234,16,v209
v_lshlrev_b32 v232,16,v205
v_lshlrev_b32 v233,16,v207
M v[184:187],v[216:219],a[208:211],v[184:187]
ds_read_b128 a[204:207],v250 offset:62208
ds_read_b128 a[208:211],v250 offset:62464
v_lshlrev_b32 v237,16,v215
v_lshlrev_b32 v236,16,v213
v_lshlrev_b32 v235,16,v211
v_fmac_f32 v232,s43,v234
M v[188:191],v[216:219],a[212:215],v[188:191]
s_waitcnt vmcnt(20) lgkmcnt(6)
buffer_load_dwordx4 v[216:219],v251,s[20:23],s48 offen offset:2048
v_fmac_f32 v237,4.0,v233
v_fma_f32 v238,-4.0,v234,v236
v_fmac_f32 v232,s45,v236
v_fmac_f32 v237,s40,v235
M v[160:163],v[220:223],a[216:219],v[160:163]
s_waitcnt lgkmcnt(5)
ds_read_b128 a[212:215],v250 offset:62720
ds_read_b128 a[216:219],v250 offset:62976
v_sub_f32 v236,v236,v234
v_fma_f32 v234,-4.0,v233,v235
v_sub_f32 v235,v235,v233
v_add_f32 v233,v238,v234
M v[164:167],v[220:223],a[220:223],v[164:167]
s_waitcnt lgkmcnt(6)
s_add_u32 s46,s76,18432
v_sub_f32 v238,v238,v234
v_fma_f32 v234,2.0,v235,v236
v_fmac_f32 v236,-2.0,v235
v_and_b32 v209,s42,v209
M v[168:171],v[220:223],a[192:195],v[168:171]
s_waitcnt lgkmcnt(5)
v_and_b32 v205,s42,v205
v_and_b32 v207,s42,v207
v_and_b32 v215,s42,v215
v_and_b32 v213,s42,v213
M v[172:175],v[220:223],a[196:199],v[172:175]
s_waitcnt lgkmcnt(4)
v_and_b32 v211,s42,v211
v_fmac_f32 v205,s43,v209
v_fmac_f32 v215,4.0,v207
v_fma_f32 v235,-4.0,v209,v213
M v[176:179],v[220:223],a[200:203],v[176:179]
s_waitcnt lgkmcnt(3)
v_fmac_f32 v205,s45,v213
v_fmac_f32 v215,s40,v211
v_sub_f32 v213,v213,v209
v_fma_f32 v209,-4.0,v207,v211
M v[180:183],v[220:223],a[204:207],v[180:183]
s_waitcnt lgkmcnt(2)
v_sub_f32 v211,v211,v207
v_add_f32 v207,v235,v209
v_sub_f32 v235,v235,v209
v_fma_f32 v209,2.0,v211,v213
M v[184:187],v[220:223],a[208:211],v[184:187]
s_waitcnt lgkmcnt(1)
v_fmac_f32 v213,-2.0,v211
v_cvt_pk_bf16_f32 v205,v232,v205
v_cvt_pk_bf16_f32 v215,v237,v215
v_cvt_pk_bf16_f32 v207,v233,v207
M v[188:191],v[220:223],a[212:215],v[188:191]
s_waitcnt vmcnt(20)
buffer_load_dwordx4 v[220:223],v251,s[20:23],s46 offen offset:0
v_cvt_pk_bf16_f32 v211,v234,v209
v_cvt_pk_bf16_f32 v209,v238,v235
v_cvt_pk_bf16_f32 v213,v236,v213
M v[160:163],v[224:227],a[220:223],v[160:163]
ds_write2st64_b64 v247,v[204:205],v[214:215] offset0:105 offset1:122
M v[164:167],v[224:227],a[192:195],v[164:167]
s_add_u32 s28,s65,6684672
buffer_load_dwordx2 v[204:205],v245,s[12:15],s28 offen offset:0
ds_write2st64_b64 v247,v[206:207],v[208:209] offset0:37 offset1:54
M v[168:171],v[224:227],a[196:199],v[168:171]
s_add_u32 s47,s76,21504
buffer_load_dwordx2 v[214:215],v245,s[16:19],s28 offen offset:1536
M v[172:175],v[224:227],a[200:203],v[172:175]
buffer_load_dwordx2 v[206:207],v245,s[8:11],s28 offen offset:0
ds_write2st64_b64 v247,v[210:211],v[212:213] offset0:71 offset1:88
M v[176:179],v[224:227],a[204:207],v[176:179]
buffer_load_dwordx2 v[208:209],v245,s[8:11],s28 offen offset:384
M v[180:183],v[224:227],a[208:211],v[180:183]
buffer_load_dwordx2 v[210:211],v245,s[8:11],s28 offen offset:768
ds_read_b128 a[220:223],v249 offset:63232
M v[184:187],v[224:227],a[212:215],v[184:187]
s_waitcnt lgkmcnt(0)
s_barrier
buffer_load_dwordx2 v[212:213],v245,s[8:11],s28 offen offset:1152
M v[188:191],v[224:227],a[216:219],v[188:191]
s_waitcnt vmcnt(25)
buffer_load_dwordx4 v[224:227],v251,s[20:23],s47 offen offset:0
M v[160:163],v[228:231],a[192:195],v[160:163]
ds_read_b128 a[192:195],v249 offset:0
M v[164:167],v[228:231],a[196:199],v[164:167]
s_add_u32 s48,s76,24576
ds_read_b128 a[196:199],v250 offset:256
M v[168:171],v[228:231],a[200:203],v[168:171]
ds_read_b128 a[200:203],v250 offset:512
M v[172:175],v[228:231],a[204:207],v[172:175]
ds_read_b128 a[204:207],v250 offset:768
v_cvt_pk_bf16_f32 v160,v160,v161
M v[176:179],v[228:231],a[208:211],v[176:179]
ds_read_b128 a[208:211],v250 offset:1024
v_cvt_pk_bf16_f32 v161,v162,v163
M v[180:183],v[228:231],a[212:215],v[180:183]
ds_read_b128 a[212:215],v250 offset:1280
v_cvt_pk_bf16_f32 v164,v164,v165
M v[184:187],v[228:231],a[216:219],v[184:187]
s_add_u32 s34,s33,0
buffer_store_dwordx4 v[64:67],v252,s[24:27],s34 offen offset:256 nt
M v[188:191],v[228:231],a[220:223],v[188:191]
s_waitcnt vmcnt(26) lgkmcnt(5)
buffer_load_dwordx4 v[228:231],v251,s[20:23],s48 offen offset:0
M a[0:3],a[224:227],a[192:195],0
s_waitcnt lgkmcnt(4)
ds_read_b128 a[216:219],v250 offset:1536
ds_read_b128 a[220:223],v250 offset:1792
M a[4:7],a[224:227],a[196:199],0
s_waitcnt lgkmcnt(5)
v_cvt_pk_bf16_f32 v165,v166,v167
M a[8:11],a[224:227],a[200:203],0
s_waitcnt lgkmcnt(4)
ds_write2st64_b64 v253,v[160:161],v[164:165] offset0:204 offset1:208
M a[12:15],a[224:227],a[204:207],0
s_waitcnt lgkmcnt(4)
v_cvt_pk_bf16_f32 v168,v168,v169
v_cvt_pk_bf16_f32 v169,v170,v171
M a[16:19],a[224:227],a[208:211],0
s_waitcnt lgkmcnt(3)
v_cvt_pk_bf16_f32 v172,v172,v173
v_cvt_pk_bf16_f32 v173,v174,v175
M a[20:23],a[224:227],a[212:215],0
s_waitcnt lgkmcnt(2)
ds_write2st64_b64 v253,v[168:169],v[172:173] offset0:212 offset1:216
M a[24:27],a[224:227],a[216:219],0
s_waitcnt lgkmcnt(2)
v_cvt_pk_bf16_f32 v176,v176,v177
v_cvt_pk_bf16_f32 v177,v178,v179
M a[28:31],a[224:227],a[220:223],0
s_waitcnt vmcnt(26)
buffer_load_dwordx4 a[224:227],v251,s[20:23],s46 offen offset:1024
M a[32:35],a[228:231],a[192:195],0
v_cvt_pk_bf16_f32 v180,v180,v181
v_cvt_pk_bf16_f32 v181,v182,v183
M a[36:39],a[228:231],a[196:199],0
ds_write2st64_b64 v253,v[176:177],v[180:181] offset0:238 offset1:242
M a[40:43],a[228:231],a[200:203],0
v_cvt_pk_bf16_f32 v184,v184,v185
v_cvt_pk_bf16_f32 v185,v186,v187
M a[44:47],a[228:231],a[204:207],0
v_cvt_pk_bf16_f32 v188,v188,v189
v_cvt_pk_bf16_f32 v189,v190,v191
M a[48:51],a[228:231],a[208:211],0
ds_write2st64_b64 v253,v[184:185],v[188:189] offset0:246 offset1:250
M a[52:55],a[228:231],a[212:215],0
s_waitcnt vmcnt(19)
v_lshlrev_b32 v234,16,v196
v_lshlrev_b32 v232,16,v192
M a[56:59],a[228:231],a[216:219],0
v_lshlrev_b32 v233,16,v194
v_lshlrev_b32 v237,16,v202
M a[60:63],a[228:231],a[220:223],0
buffer_load_dwordx4 a[228:231],v251,s[20:23],s47 offen offset:1024
M a[64:67],a[232:235],a[192:195],0
s_waitcnt vmcnt(17)
ds_read_b128 a[192:195],v250 offset:2048
v_lshlrev_b32 v236,16,v200
M a[68:71],a[232:235],a[196:199],0
v_lshlrev_b32 v235,16,v198
M a[72:75],a[232:235],a[200:203],0
s_waitcnt lgkmcnt(1)
s_barrier
ds_read_b128 v[160:163],v0 offset:34816
M a[76:79],a[232:235],a[204:207],0
ds_read_b128 v[168:171],v0 offset:38912
ds_read_b128 v[176:179],v0 offset:52224
M a[80:83],a[232:235],a[208:211],0
ds_read_b128 v[184:187],v0 offset:56320
v_fmac_f32 v232,s43,v234
M a[84:87],a[232:235],a[212:215],0
v_fmac_f32 v237,4.0,v233
v_fma_f32 v238,-4.0,v234,v236
M a[88:91],a[232:235],a[216:219],0
v_fmac_f32 v232,s45,v236
v_fmac_f32 v237,s40,v235
M a[92:95],a[232:235],a[220:223],0
s_add_u32 s34,s33,393216
buffer_load_dwordx4 a[232:235],v251,s[20:23],s48 offen offset:1024
M a[0:3],a[236:239],a[196:199],a[0:3]
buffer_store_dwordx4 v[72:75],v252,s[24:27],s34 offen offset:256 nt
M a[4:7],a[236:239],a[200:203],a[4:7]
v_sub_f32 v236,v236,v234
v_fma_f32 v234,-4.0,v233,v235
M a[8:11],a[236:239],a[204:207],a[8:11]
v_sub_f32 v235,v235,v233
v_add_f32 v233,v238,v234
M a[12:15],a[236:239],a[208:211],a[12:15]
v_sub_f32 v238,v238,v234
v_fma_f32 v234,2.0,v235,v236
M a[16:19],a[236:239],a[212:215],a[16:19]
v_fmac_f32 v236,-2.0,v235
v_and_b32 v196,s42,v196
M a[20:23],a[236:239],a[216:219],a[20:23]
v_and_b32 v192,s42,v192
v_and_b32 v194,s42,v194
M a[24:27],a[236:239],a[220:223],a[24:27]
s_waitcnt lgkmcnt(4)
v_and_b32 v202,s42,v202
v_and_b32 v200,s42,v200
M a[28:31],a[236:239],a[192:195],a[28:31]
buffer_load_dwordx4 a[236:239],v251,s[20:23],s46 offen offset:2048
M a[32:35],a[240:243],a[196:199],a[32:35]
v_and_b32 v198,s42,v198
v_fmac_f32 v192,s43,v196
M a[36:39],a[240:243],a[200:203],a[36:39]
v_fmac_f32 v202,4.0,v194
v_fma_f32 v235,-4.0,v196,v200
M a[40:43],a[240:243],a[204:207],a[40:43]
v_fmac_f32 v192,s45,v200
v_fmac_f32 v202,s40,v198
M a[44:47],a[240:243],a[208:211],a[44:47]
v_sub_f32 v200,v200,v196
v_fma_f32 v196,-4.0,v194,v198
M a[48:51],a[240:243],a[212:215],a[48:51]
v_sub_f32 v198,v198,v194
v_add_f32 v194,v235,v196
M a[52:55],a[240:243],a[216:219],a[52:55]
v_sub_f32 v235,v235,v196
v_fma_f32 v196,2.0,v198,v200
M a[56:59],a[240:243],a[220:223],a[56:59]
v_fmac_f32 v200,-2.0,v198
v_cvt_pk_bf16_f32 v192,v232,v192
M a[60:63],a[240:243],a[192:195],a[60:63]
s_waitcnt vmcnt(19)
buffer_load_dwordx4 a[240:243],v251,s[20:23],s47 offen offset:2048
M a[64:67],a[244:247],a[196:199],a[64:67]
ds_read_b128 a[196:199],v249 offset:2304
v_cvt_pk_bf16_f32 v202,v237,v202
M a[68:71],a[244:247],a[200:203],a[68:71]
v_cvt_pk_bf16_f32 v194,v233,v194
v_cvt_pk_bf16_f32 v198,v234,v196
M a[72:75],a[244:247],a[204:207],a[72:75]
v_cvt_pk_bf16_f32 v196,v238,v235
v_cvt_pk_bf16_f32 v200,v236,v200
M a[76:79],a[244:247],a[208:211],a[76:79]
v_lshlrev_b32 v234,16,v197
v_lshlrev_b32 v232,16,v193
M a[80:83],a[244:247],a[212:215],a[80:83]
v_lshlrev_b32 v233,16,v195
v_lshlrev_b32 v237,16,v203
M a[84:87],a[244:247],a[216:219],a[84:87]
v_lshlrev_b32 v236,16,v201
v_lshlrev_b32 v235,16,v199
M a[88:91],a[244:247],a[220:223],a[88:91]
v_fmac_f32 v232,s43,v234
v_fmac_f32 v237,4.0,v233
M a[92:95],a[244:247],a[192:195],a[92:95]
s_waitcnt vmcnt(19)
buffer_load_dwordx4 a[244:247],v251,s[20:23],s48 offen offset:2048
M a[0:3],a[248:251],a[200:203],a[0:3]
s_add_u32 s34,s33,786432
buffer_store_dwordx4 v[80:83],v252,s[24:27],s34 offen offset:256 nt
M a[4:7],a[248:251],a[204:207],a[4:7]
s_add_u32 s46,s76,27648
v_fma_f32 v238,-4.0,v234,v236
v_fmac_f32 v232,s45,v236
M a[8:11],a[248:251],a[208:211],a[8:11]
v_fmac_f32 v237,s40,v235
v_sub_f32 v236,v236,v234
M a[12:15],a[248:251],a[212:215],a[12:15]
v_fma_f32 v234,-4.0,v233,v235
v_sub_f32 v235,v235,v233
M a[16:19],a[248:251],a[216:219],a[16:19]
v_add_f32 v233,v238,v234
v_sub_f32 v238,v238,v234
M a[20:23],a[248:251],a[220:223],a[20:23]
v_fma_f32 v234,2.0,v235,v236
v_fmac_f32 v236,-2.0,v235
M a[24:27],a[248:251],a[192:195],a[24:27]
s_waitcnt lgkmcnt(0)
v_and_b32 v197,s42,v197
v_and_b32 v193,s42,v193
M a[28:31],a[248:251],a[196:199],a[28:31]
s_waitcnt vmcnt(20)
buffer_load_dwordx4 a[248:251],v251,s[20:23],s46 offen offset:0
M a[32:35],a[252:255],a[200:203],a[32:35]
v_and_b32 v195,s42,v195
v_and_b32 v203,s42,v203
M a[36:39],a[252:255],a[204:207],a[36:39]
s_add_u32 s47,s76,30720
v_and_b32 v201,s42,v201
v_and_b32 v199,s42,v199
M a[40:43],a[252:255],a[208:211],a[40:43]
v_fmac_f32 v193,s43,v197
v_fmac_f32 v203,4.0,v195
M a[44:47],a[252:255],a[212:215],a[44:47]
v_fma_f32 v235,-4.0,v197,v201
v_fmac_f32 v193,s45,v201
M a[48:51],a[252:255],a[216:219],a[48:51]
v_fmac_f32 v203,s40,v199
v_sub_f32 v201,v201,v197
M a[52:55],a[252:255],a[220:223],a[52:55]
v_fma_f32 v197,-4.0,v195,v199
v_sub_f32 v199,v199,v195
M a[56:59],a[252:255],a[192:195],a[56:59]
v_add_f32 v195,v235,v197
v_sub_f32 v235,v235,v197
M a[60:63],a[252:255],a[196:199],a[60:63]
s_waitcnt vmcnt(19)
buffer_load_dwordx4 a[252:255],v251,s[20:23],s47 offen offset:0
M a[64:67],v[216:219],a[200:203],a[64:67]
ds_read_b128 a[200:203],v249 offset:8704
v_fma_f32 v197,2.0,v199,v201
M a[68:71],v[216:219],a[204:207],a[68:71]
s_add_u32 s48,s76,33792
ds_read_b128 a[204:207],v250 offset:8960
v_fmac_f32 v201,-2.0,v199
M a[72:75],v[216:219],a[208:211],a[72:75]
ds_read_b128 a[208:211],v250 offset:9216
v_cvt_pk_bf16_f32 v193,v232,v193
M a[76:79],v[216:219],a[212:215],a[76:79]
ds_read_b128 a[212:215],v250 offset:9472
v_cvt_pk_bf16_f32 v203,v237,v203
M a[80:83],v[216:219],a[216:219],a[80:83]
ds_read_b128 a[216:219],v250 offset:9728
v_cvt_pk_bf16_f32 v195,v233,v195
M a[84:87],v[216:219],a[220:223],a[84:87]
ds_read_b128 a[220:223],v250 offset:9984
v_cvt_pk_bf16_f32 v199,v234,v197
M a[88:91],v[216:219],a[192:195],a[88:91]
ds_read_b128 a[192:195],v250 offset:10240
v_cvt_pk_bf16_f32 v197,v238,v235
M a[92:95],v[216:219],a[196:199],a[92:95]
s_waitcnt vmcnt(19) lgkmcnt(6)
buffer_load_dwordx4 v[216:219],v251,s[20:23],s48 offen offset:0
M a[96:99],v[220:223],a[200:203],0
s_waitcnt lgkmcnt(5)
ds_read_b128 a[196:199],v250 offset:10496
v_cvt_pk_bf16_f32 v201,v236,v201
M a[100:103],v[220:223],a[204:207],0
s_waitcnt lgkmcnt(5)
s_add_u32 s34,s33,1179648
buffer_store_dwordx4 v[88:91],v252,s[24:27],s34 offen offset:256 nt
M a[104:107],v[220:223],a[208:211],0
s_waitcnt lgkmcnt(4)
ds_write2st64_b64 v247,v[192:193],v[202:203] offset0:170 offset1:187
M a[108:111],v[220:223],a[212:215],0
s_waitcnt lgkmcnt(4)
s_add_u32 s28,s65,7077888
buffer_load_dwordx2 v[192:193],v245,s[12:15],s28 offen offset:0
M a[112:115],v[220:223],a[216:219],0
s_waitcnt lgkmcnt(3)
buffer_load_dwordx2 v[202:203],v245,s[16:19],s28 offen offset:1536
M a[116:119],v[220:223],a[220:223],0
s_waitcnt lgkmcnt(2)
ds_write2st64_b64 v247,v[194:195],v[196:197] offset0:0 offset1:17
M a[120:123],v[220:223],a[192:195],0
s_waitcnt lgkmcnt(2)
buffer_load_dwordx2 v[194:195],v245,s[8:11],s28 offen offset:0
M a[124:127],v[220:223],a[196:199],0
s_waitcnt vmcnt(17)
buffer_load_dwordx2 v[196:197],v245,s[8:11],s28 offen offset:384
M a[128:131],v[224:227],a[200:203],0
buffer_load_dwordx4 v[220:223],v251,s[20:23],s46 offen offset:1024
M a[132:135],v[224:227],a[204:207],0
ds_write2st64_b64 v247,v[198:199],v[200:201] offset0:136 offset1:153
M a[136:139],v[224:227],a[208:211],0
buffer_load_dwordx2 v[198:199],v245,s[8:11],s28 offen offset:768
M a[140:143],v[224:227],a[212:215],0
buffer_load_dwordx2 v[200:201],v245,s[8:11],s28 offen offset:1152
M a[144:147],v[224:227],a[216:219],0
v_lshlrev_b32 v234,16,v208
v_lshlrev_b32 v232,16,v204
M a[148:151],v[224:227],a[220:223],0
v_lshlrev_b32 v233,16,v206
v_lshlrev_b32 v237,16,v214
M a[152:155],v[224:227],a[192:195],0
v_lshlrev_b32 v236,16,v212
v_lshlrev_b32 v235,16,v210
M a[156:159],v[224:227],a[196:199],0
s_waitcnt vmcnt(19)
buffer_load_dwordx4 v[224:227],v251,s[20:23],s47 offen offset:1024
M a[160:163],v[228:231],a[200:203],0
ds_read_b128 a[200:203],v250 offset:10752
v_fmac_f32 v232,s43,v234
M a[164:167],v[228:231],a[204:207],0
v_fmac_f32 v237,4.0,v233
v_fma_f32 v238,-4.0,v234,v236
M a[168:171],v[228:231],a[208:211],0
v_fmac_f32 v232,s45,v236
v_fmac_f32 v237,s40,v235
M a[172:175],v[228:231],a[212:215],0
v_sub_f32 v236,v236,v234
v_fma_f32 v234,-4.0,v233,v235
M a[176:179],v[228:231],a[216:219],0
v_sub_f32 v235,v235,v233
v_add_f32 v233,v238,v234
M a[180:183],v[228:231],a[220:223],0
v_sub_f32 v238,v238,v234
v_fma_f32 v234,2.0,v235,v236
M a[184:187],v[228:231],a[192:195],0
v_fmac_f32 v236,-2.0,v235
v_and_b32 v208,s42,v208
M a[188:191],v[228:231],a[196:199],0
s_waitcnt vmcnt(19)
buffer_load_dwordx4 v[228:231],v251,s[20:23],s48 offen offset:1024
M a[96:99],a[224:227],a[204:207],a[96:99]
v_and_b32 v204,s42,v204
v_and_b32 v206,s42,v206
M a[100:103],a[224:227],a[208:211],a[100:103]
v_and_b32 v214,s42,v214
v_and_b32 v212,s42,v212
M a[104:107],a[224:227],a[212:215],a[104:107]
s_add_u32 s34,s33,0
buffer_store_dwordx4 v[160:163],v252,s[24:27],s34 offen offset:1408 nt
M a[108:111],a[224:227],a[216:219],a[108:111]
v_and_b32 v210,s42,v210
v_fmac_f32 v204,s43,v208
M a[112:115],a[224:227],a[220:223],a[112:115]
v_fmac_f32 v214,4.0,v206
v_fma_f32 v235,-4.0,v208,v212
M a[116:119],a[224:227],a[192:195],a[116:119]
v_fmac_f32 v204,s45,v212
v_fmac_f32 v214,s40,v210
M a[120:123],a[224:227],a[196:199],a[120:123]
s_waitcnt lgkmcnt(0)
v_sub_f32 v212,v212,v208
v_fma_f32 v208,-4.0,v206,v210
M a[124:127],a[224:227],a[200:203],a[124:127]
s_waitcnt vmcnt(20)
buffer_load_dwordx4 a[224:227],v251,s[20:23],s46 offen offset:2048
M a[128:131],a[228:231],a[204:207],a[128:131]
v_sub_f32 v210,v210,v206
v_add_f32 v206,v235,v208
M a[132:135],a[228:231],a[208:211],a[132:135]
v_sub_f32 v235,v235,v208
v_fma_f32 v208,2.0,v210,v212
M a[136:139],a[228:231],a[212:215],a[136:139]
v_fmac_f32 v212,-2.0,v210
v_cvt_pk_bf16_f32 v204,v232,v204
M a[140:143],a[228:231],a[216:219],a[140:143]
v_cvt_pk_bf16_f32 v214,v237,v214
v_cvt_pk_bf16_f32 v206,v233,v206
M a[144:147],a[228:231],a[220:223],a[144:147]
v_cvt_pk_bf16_f32 v210,v234,v208
v_cvt_pk_bf16_f32 v208,v238,v235
M a[148:151],a[228:231],a[192:195],a[148:151]
v_cvt_pk_bf16_f32 v212,v236,v212
v_lshlrev_b32 v234,16,v209
M a[152:155],a[228:231],a[196:199],a[152:155]
v_lshlrev_b32 v232,16,v205
v_lshlrev_b32 v233,16,v207
M a[156:159],a[228:231],a[200:203],a[156:159]
s_waitcnt vmcnt(20)
buffer_load_dwordx4 a[228:231],v251,s[20:23],s47 offen offset:2048
M a[160:163],a[232:235],a[204:207],a[160:163]
ds_read_b128 a[204:207],v249 offset:11008
v_lshlrev_b32 v237,16,v215
M a[164:167],a[232:235],a[208:211],a[164:167]
v_lshlrev_b32 v236,16,v213
v_lshlrev_b32 v235,16,v211
M a[168:171],a[232:235],a[212:215],a[168:171]
v_fmac_f32 v232,s43,v234
v_fmac_f32 v237,4.0,v233
M a[172:175],a[232:235],a[216:219],a[172:175]
v_fma_f32 v238,-4.0,v234,v236
v_fmac_f32 v232,s45,v236
M a[176:179],a[232:235],a[220:223],a[176:179]
v_fmac_f32 v237,s40,v235
v_sub_f32 v236,v236,v234
M a[180:183],a[232:235],a[192:195],a[180:183]
v_fma_f32 v234,-4.0,v233,v235
v_sub_f32 v235,v235,v233
M a[184:187],a[232:235],a[196:199],a[184:187]
v_add_f32 v233,v238,v234
v_sub_f32 v238,v238,v234
M a[188:191],a[232:235],a[200:203],a[188:191]
s_waitcnt vmcnt(19)
buffer_load_dwordx4 a[232:235],v251,s[20:23],s48 offen offset:2048
M a[96:99],a[236:239],a[208:211],a[96:99]
v_fma_f32 v234,2.0,v235,v236
v_fmac_f32 v236,-2.0,v235
M a[100:103],a[236:239],a[212:215],a[100:103]
s_add_u32 s46,s76,36864
v_and_b32 v209,s42,v209
v_and_b32 v205,s42,v205
M a[104:107],a[236:239],a[216:219],a[104:107]
v_and_b32 v207,s42,v207
v_and_b32 v215,s42,v215
M a[108:111],a[236:239],a[220:223],a[108:111]
s_add_u32 s34,s33,393216
buffer_store_dwordx4 v[168:171],v252,s[24:27],s34 offen offset:1408 nt
M a[112:115],a[236:239],a[192:195],a[112:115]
v_and_b32 v213,s42,v213
v_and_b32 v211,s42,v211
M a[116:119],a[236:239],a[196:199],a[116:119]
v_fmac_f32 v205,s43,v209
v_fmac_f32 v215,4.0,v207
M a[120:123],a[236:239],a[200:203],a[120:123]
s_waitcnt lgkmcnt(0)
v_fma_f32 v235,-4.0,v209,v213
v_fmac_f32 v205,s45,v213
M a[124:127],a[236:239],a[204:207],a[124:127]
s_waitcnt vmcnt(20)
buffer_load_dwordx4 a[236:239],v251,s[20:23],s46 offen offset:0
M a[128:131],a[240:243],a[208:211],a[128:131]
v_fmac_f32 v215,s40,v211
v_sub_f32 v213,v213,v209
M a[132:135],a[240:243],a[212:215],a[132:135]
s_add_u32 s47,s76,39936
v_fma_f32 v209,-4.0,v207,v211
v_sub_f32 v211,v211,v207
M a[136:139],a[240:243],a[216:219],a[136:139]
v_add_f32 v207,v235,v209
v_sub_f32 v235,v235,v209
M a[140:143],a[240:243],a[220:223],a[140:143]
v_fma_f32 v209,2.0,v211,v213
v_fmac_f32 v213,-2.0,v211
M a[144:147],a[240:243],a[192:195],a[144:147]
v_cvt_pk_bf16_f32 v205,v232,v205
v_cvt_pk_bf16_f32 v215,v237,v215
M a[148:151],a[240:243],a[196:199],a[148:151]
v_cvt_pk_bf16_f32 v207,v233,v207
v_cvt_pk_bf16_f32 v211,v234,v209
M a[152:155],a[240:243],a[200:203],a[152:155]
v_cvt_pk_bf16_f32 v209,v238,v235
v_cvt_pk_bf16_f32 v213,v236,v213
M a[156:159],a[240:243],a[204:207],a[156:159]
s_waitcnt vmcnt(20)
buffer_load_dwordx4 a[240:243],v251,s[20:23],s47 offen offset:0
M a[160:163],a[244:247],a[208:211],a[160:163]
ds_read_b128 a[208:211],v249 offset:17408
ds_write2st64_b64 v247,v[204:205],v[214:215] offset0:171 offset1:188
M a[164:167],a[244:247],a[212:215],a[164:167]
s_add_u32 s28,s65,7471104
buffer_load_dwordx2 v[204:205],v245,s[12:15],s28 offen offset:0
M a[168:171],a[244:247],a[216:219],a[168:171]
s_add_u32 s48,s76,43008
buffer_load_dwordx2 v[214:215],v245,s[16:19],s28 offen offset:1536
M a[172:175],a[244:247],a[220:223],a[172:175]
ds_read_b128 a[212:215],v250 offset:17664
ds_read_b128 a[216:219],v250 offset:17920
M a[176:179],a[244:247],a[192:195],a[176:179]
ds_read_b128 a[220:223],v250 offset:18176
ds_read_b128 a[192:195],v250 offset:18432
M a[180:183],a[244:247],a[196:199],a[180:183]
ds_read_b128 a[196:199],v250 offset:18688
ds_write2st64_b64 v247,v[206:207],v[208:209] offset0:1 offset1:18
M a[184:187],a[244:247],a[200:203],a[184:187]
buffer_load_dwordx2 v[206:207],v245,s[8:11],s28 offen offset:0
M a[188:191],a[244:247],a[204:207],a[188:191]
s_waitcnt vmcnt(22) lgkmcnt(7)
buffer_load_dwordx2 v[208:209],v245,s[8:11],s28 offen offset:384
M v[0:3],a[248:251],a[208:211],0
s_waitcnt lgkmcnt(5)
buffer_load_dwordx4 a[244:247],v251,s[20:23],s48 offen offset:0
M v[4:7],a[248:251],a[212:215],0
s_waitcnt lgkmcnt(4)
ds_read_b128 a[200:203],v250 offset:18944
ds_read_b128 a[204:207],v250 offset:19200
M v[8:11],a[248:251],a[216:219],0
s_waitcnt lgkmcnt(5)
ds_write2st64_b64 v247,v[210:211],v[212:213] offset0:137 offset1:154
M v[12:15],a[248:251],a[220:223],0
s_waitcnt lgkmcnt(5)
buffer_load_dwordx2 v[210:211],v245,s[8:11],s28 offen offset:768
M v[16:19],a[248:251],a[192:195],0
s_waitcnt lgkmcnt(4)
s_add_u32 s34,s33,786432
buffer_load_dwordx2 v[212:213],v245,s[8:11],s28 offen offset:1152
M v[20:23],a[248:251],a[196:199],0
s_waitcnt lgkmcnt(2)
buffer_store_dwordx4 v[176:179],v252,s[24:27],s34 offen offset:1408 nt
M v[24:27],a[248:251],a[200:203],0
s_waitcnt lgkmcnt(1)
v_fmac_f32 v239,s43,v241
v_fmac_f32 v244,4.0,v240
M v[28:31],a[248:251],a[204:207],0
s_waitcnt vmcnt(26)
buffer_load_dwordx4 a[248:251],v251,s[20:23],s46 offen offset:1024
M v[32:35],a[252:255],a[208:211],0
v_fma_f32 v232,-4.0,v241,v243
v_fmac_f32 v239,s45,v243
M v[36:39],a[252:255],a[212:215],0
v_fmac_f32 v244,s40,v242
v_sub_f32 v243,v243,v241
M v[40:43],a[252:255],a[216:219],0
v_fma_f32 v241,-4.0,v240,v242
v_sub_f32 v242,v242,v240
M v[44:47],a[252:255],a[220:223],0
v_add_f32 v240,v232,v241
v_sub_f32 v232,v232,v241
M v[48:51],a[252:255],a[192:195],0
v_fma_f32 v241,2.0,v242,v243
v_fmac_f32 v243,-2.0,v242
M v[52:55],a[252:255],a[196:199],0
v_cvt_pk_bf16_f32 v233,v239,v244
v_cvt_pk_bf16_f32 v234,v240,v232
M v[56:59],a[252:255],a[200:203],0
v_cvt_pk_bf16_f32 v235,v241,v243
v_add_u32 v232,87040,v248
M v[60:63],a[252:255],a[204:207],0
s_waitcnt vmcnt(26)
buffer_load_short_d16_hi v239,v246,s[12:15],s72 offen offset:0
M v[64:67],v[216:219],a[208:211],0
buffer_load_short_d16_hi v240,v246,s[8:11],s72 offen offset:0
M v[68:71],v[216:219],a[212:215],0
buffer_load_short_d16_hi v241,v246,s[8:11],s72 offen offset:384
M v[72:75],v[216:219],a[216:219],0
buffer_load_short_d16_hi v242,v246,s[8:11],s72 offen offset:768
M v[76:79],v[216:219],a[220:223],0
buffer_load_short_d16_hi v243,v246,s[8:11],s72 offen offset:1152
M v[80:83],v[216:219],a[192:195],0
buffer_load_short_d16_hi v244,v246,s[16:19],s72 offen offset:1536
M v[84:87],v[216:219],a[196:199],0
buffer_load_dwordx4 a[252:255],v251,s[20:23],s47 offen offset:1024
M v[88:91],v[216:219],a[200:203],0
ds_read_b128 a[208:211],v250 offset:19456
ds_write_b16 v232,v233 offset:0
M v[92:95],v[216:219],a[204:207],0
s_waitcnt vmcnt(27)
buffer_load_dwordx4 v[216:219],v251,s[20:23],s48 offen offset:1024
M v[0:3],v[220:223],a[212:215],v[0:3]
ds_write_b16_d16_hi v232,v233 offset:8704
M v[4:7],v[220:223],a[216:219],v[4:7]
ds_write_b16 v248,v234 offset:0
M v[8:11],v[220:223],a[220:223],v[8:11]
ds_write_b16_d16_hi v248,v234 offset:8704
M v[12:15],v[220:223],a[192:195],v[12:15]
v_add_u32 v232,69632,v248
M v[16:19],v[220:223],a[196:199],v[16:19]
ds_write_b16 v232,v235 offset:0
M v[20:23],v[220:223],a[200:203],v[20:23]
s_add_u32 s34,s33,1179648
buffer_store_dwordx4 v[184:187],v252,s[24:27],s34 offen offset:1408 nt
M v[24:27],v[220:223],a[204:207],v[24:27]
s_waitcnt lgkmcnt(5)
ds_write_b16_d16_hi v232,v235 offset:8704
M v[28:31],v[220:223],a[208:211],v[28:31]
s_waitcnt vmcnt(26)
buffer_load_dwordx4 v[220:223],v251,s[20:23],s46 offen offset:2048
M v[32:35],v[224:227],a[212:215],v[32:35]
v_lshlrev_b32 v234,16,v196
v_lshlrev_b32 v232,16,v192
M v[36:39],v[224:227],a[216:219],v[36:39]
v_lshlrev_b32 v233,16,v194
v_lshlrev_b32 v237,16,v202
M v[40:43],v[224:227],a[220:223],v[40:43]
v_lshlrev_b32 v236,16,v200
v_lshlrev_b32 v235,16,v198
M v[44:47],v[224:227],a[192:195],v[44:47]
v_fmac_f32 v232,s43,v234
v_fmac_f32 v237,4.0,v233
M v[48:51],v[224:227],a[196:199],v[48:51]
v_fma_f32 v238,-4.0,v234,v236
v_fmac_f32 v232,s45,v236
M v[52:55],v[224:227],a[200:203],v[52:55]
v_fmac_f32 v237,s40,v235
v_sub_f32 v236,v236,v234
M v[56:59],v[224:227],a[204:207],v[56:59]
v_fma_f32 v234,-4.0,v233,v235
v_sub_f32 v235,v235,v233
M v[60:63],v[224:227],a[208:211],v[60:63]
s_waitcnt vmcnt(26)
buffer_load_dwordx4 v[224:227],v251,s[20:23],s47 offen offset:2048
M v[64:67],v[228:231],a[212:215],v[64:67]
ds_read_b128 a[212:215],v249 offset:19712
v_add_f32 v233,v238,v234
M v[68:71],v[228:231],a[216:219],v[68:71]
v_sub_f32 v238,v238,v234
v_fma_f32 v234,2.0,v235,v236
M v[72:75],v[228:231],a[220:223],v[72:75]
v_fmac_f32 v236,-2.0,v235
v_and_b32 v196,s42,v196
M v[76:79],v[228:231],a[192:195],v[76:79]
v_and_b32 v192,s42,v192
v_and_b32 v194,s42,v194
M v[80:83],v[228:231],a[196:199],v[80:83]
v_and_b32 v202,s42,v202
v_and_b32 v200,s42,v200
M v[84:87],v[228:231],a[200:203],v[84:87]
v_and_b32 v198,s42,v198
v_fmac_f32 v192,s43,v196
M v[88:91],v[228:231],a[204:207],v[88:91]
v_fmac_f32 v202,4.0,v194
v_fma_f32 v235,-4.0,v196,v200
M v[92:95],v[228:231],a[208:211],v[92:95]
s_waitcnt vmcnt(25)
buffer_load_dwordx4 v[228:231],v251,s[20:23],s48 offen offset:2048
M v[0:3],a[224:227],a[216:219],v[0:3]
v_fmac_f32 v192,s45,v200
v_fmac_f32 v202,s40,v198
M v[4:7],a[224:227],a[220:223],v[4:7]
s_add_u32 s46,s77,9216
v_sub_f32 v200,v200,v196
v_fma_f32 v196,-4.0,v194,v198
M v[8:11],a[224:227],a[192:195],v[8:11]
v_sub_f32 v198,v198,v194
v_add_f32 v194,v235,v196
M v[12:15],a[224:227],a[196:199],v[12:15]
v_sub_f32 v235,v235,v196
v_fma_f32 v196,2.0,v198,v200
M v[16:19],a[224:227],a[200:203],v[16:19]
v_fmac_f32 v200,-2.0,v198
v_cvt_pk_bf16_f32 v192,v232,v192
M v[20:23],a[224:227],a[204:207],v[20:23]
v_cvt_pk_bf16_f32 v202,v237,v202
v_cvt_pk_bf16_f32 v194,v233,v194
M v[24:27],a[224:227],a[208:211],v[24:27]
s_waitcnt lgkmcnt(0)
v_cvt_pk_bf16_f32 v198,v234,v196
v_cvt_pk_bf16_f32 v196,v238,v235
M v[28:31],a[224:227],a[212:215],v[28:31]
s_waitcnt vmcnt(25)
buffer_load_dwordx4 a[224:227],v251,s[20:23],s46 offen offset:0
M v[32:35],a[228:231],a[216:219],v[32:35]
v_cvt_pk_bf16_f32 v200,v236,v200
v_lshlrev_b32 v234,16,v197
M v[36:39],a[228:231],a[220:223],v[36:39]
s_add_u32 s47,s77,12288
v_lshlrev_b32 v232,16,v193
v_lshlrev_b32 v233,16,v195
M v[40:43],a[228:231],a[192:195],v[40:43]
v_lshlrev_b32 v237,16,v203
v_lshlrev_b32 v236,16,v201
M v[44:47],a[228:231],a[196:199],v[44:47]
v_lshlrev_b32 v235,16,v199
v_fmac_f32 v232,s43,v234
M v[48:51],a[228:231],a[200:203],v[48:51]
v_fmac_f32 v237,4.0,v233
v_fma_f32 v238,-4.0,v234,v236
M v[52:55],a[228:231],a[204:207],v[52:55]
v_fmac_f32 v232,s45,v236
v_fmac_f32 v237,s40,v235
M v[56:59],a[228:231],a[208:211],v[56:59]
v_sub_f32 v236,v236,v234
v_fma_f32 v234,-4.0,v233,v235
M v[60:63],a[228:231],a[212:215],v[60:63]
s_waitcnt vmcnt(25)
buffer_load_dwordx4 a[228:231],v251,s[20:23],s47 offen offset:0
M v[64:67],a[232:235],a[216:219],v[64:67]
ds_read_b128 a[216:219],v249 offset:26112
v_sub_f32 v235,v235,v233
M v[68:71],a[232:235],a[220:223],v[68:71]
s_add_u32 s48,s77,15360
ds_read_b128 a[220:223],v250 offset:26368
v_add_f32 v233,v238,v234
M v[72:75],a[232:235],a[192:195],v[72:75]
ds_read_b128 a[192:195],v250 offset:26624
v_sub_f32 v238,v238,v234
M v[76:79],a[232:235],a[196:199],v[76:79]
ds_read_b128 a[196:199],v250 offset:26880
v_fma_f32 v234,2.0,v235,v236
M v[80:83],a[232:235],a[200:203],v[80:83]
ds_read_b128 a[200:203],v250 offset:27136
v_fmac_f32 v236,-2.0,v235
M v[84:87],a[232:235],a[204:207],v[84:87]
ds_read_b128 a[204:207],v250 offset:27392
v_and_b32 v197,s42,v197
M v[88:91],a[232:235],a[208:211],v[88:91]
ds_read_b128 a[208:211],v250 offset:27648
v_and_b32 v193,s42,v193
M v[92:95],a[232:235],a[212:215],v[92:95]
s_waitcnt vmcnt(24) lgkmcnt(6)
buffer_load_dwordx4 a[232:235],v251,s[20:23],s48 offen offset:0
M v[96:99],a[236:239],a[216:219],0
s_waitcnt lgkmcnt(5)
ds_read_b128 a[212:215],v250 offset:27904
v_and_b32 v195,s42,v195
M v[100:103],a[236:239],a[220:223],0
s_waitcnt lgkmcnt(5)
v_and_b32 v203,s42,v203
v_and_b32 v201,s42,v201
M v[104:107],a[236:239],a[192:195],0
s_waitcnt lgkmcnt(4)
v_and_b32 v199,s42,v199
v_fmac_f32 v193,s43,v197
M v[108:111],a[236:239],a[196:199],0
s_waitcnt lgkmcnt(3)
v_fmac_f32 v203,4.0,v195
v_fma_f32 v235,-4.0,v197,v201
M v[112:115],a[236:239],a[200:203],0
s_waitcnt lgkmcnt(2)
v_fmac_f32 v193,s45,v201
v_fmac_f32 v203,s40,v199
M v[116:119],a[236:239],a[204:207],0
s_waitcnt lgkmcnt(1)
v_sub_f32 v201,v201,v197
v_fma_f32 v197,-4.0,v195,v199
M v[120:123],a[236:239],a[208:211],0
s_waitcnt lgkmcnt(0)
v_sub_f32 v199,v199,v195
v_add_f32 v195,v235,v197
M v[124:127],a[236:239],a[212:215],0
s_waitcnt vmcnt(24)
buffer_load_dwordx4 a[236:239],v251,s[20:23],s46 offen offset:1024
M v[128:131],a[240:243],a[216:219],0
v_sub_f32 v235,v235,v197
v_fma_f32 v197,2.0,v199,v201
M v[132:135],a[240:243],a[220:223],0
v_fmac_f32 v201,-2.0,v199
v_cvt_pk_bf16_f32 v193,v232,v193
M v[136:139],a[240:243],a[192:195],0
v_cvt_pk_bf16_f32 v203,v237,v203
v_cvt_pk_bf16_f32 v195,v233,v195
M v[140:143],a[240:243],a[196:199],0
v_cvt_pk_bf16_f32 v199,v234,v197
v_cvt_pk_bf16_f32 v197,v238,v235
M v[144:147],a[240:243],a[200:203],0
v_cvt_pk_bf16_f32 v201,v236,v201
M v[148:151],a[240:243],a[204:207],0
ds_write2st64_b64 v247,v[192:193],v[202:203] offset0:172 offset1:189
M v[152:155],a[240:243],a[208:211],0
s_add_u32 s28,s66,6291456
buffer_load_dwordx2 v[192:193],v245,s[12:15],s28 offen offset:0
M v[156:159],a[240:243],a[212:215],0
s_waitcnt vmcnt(21)
buffer_load_dwordx2 v[202:203],v245,s[16:19],s28 offen offset:1536
M v[160:163],a[244:247],a[216:219],0
buffer_load_dwordx4 a[240:243],v251,s[20:23],s47 offen offset:1024
M v[164:167],a[244:247],a[220:223],0
ds_read_b128 a[216:219],v250 offset:28160
ds_write2st64_b64 v247,v[194:195],v[196:197] offset0:2 offset1:19
M v[168:171],a[244:247],a[192:195],0
buffer_load_dwordx2 v[194:195],v245,s[8:11],s28 offen offset:0
M v[172:175],a[244:247],a[196:199],0
buffer_load_dwordx2 v[196:197],v245,s[8:11],s28 offen offset:384
M v[176:179],a[244:247],a[200:203],0
ds_write2st64_b64 v247,v[198:199],v[200:201] offset0:138 offset1:155
M v[180:183],a[244:247],a[204:207],0
buffer_load_dwordx2 v[198:199],v245,s[8:11],s28 offen offset:768
M v[184:187],a[244:247],a[208:211],0
buffer_load_dwordx2 v[200:201],v245,s[8:11],s28 offen offset:1152
M v[188:191],a[244:247],a[212:215],0
s_waitcnt vmcnt(23)
buffer_load_dwordx4 a[244:247],v251,s[20:23],s48 offen offset:1024
M v[96:99],a[248:251],a[220:223],v[96:99]
v_lshlrev_b32 v234,16,v208
v_lshlrev_b32 v232,16,v204
M v[100:103],a[248:251],a[192:195],v[100:103]
v_lshlrev_b32 v233,16,v206
v_lshlrev_b32 v237,16,v214
M v[104:107],a[248:251],a[196:199],v[104:107]
v_lshlrev_b32 v236,16,v212
v_lshlrev_b32 v235,16,v210
M v[108:111],a[248:251],a[200:203],v[108:111]
v_fmac_f32 v232,s43,v234
v_fmac_f32 v237,4.0,v233
M v[112:115],a[248:251],a[204:207],v[112:115]
v_fma_f32 v238,-4.0,v234,v236
v_fmac_f32 v232,s45,v236
M v[116:119],a[248:251],a[208:211],v[116:119]
v_fmac_f32 v237,s40,v235
v_sub_f32 v236,v236,v234
M v[120:123],a[248:251],a[212:215],v[120:123]
s_waitcnt lgkmcnt(2)
v_fma_f32 v234,-4.0,v233,v235
v_sub_f32 v235,v235,v233
M v[124:127],a[248:251],a[216:219],v[124:127]
s_waitcnt vmcnt(17)
buffer_load_dwordx4 a[248:251],v251,s[20:23],s46 offen offset:2048
M v[128:131],a[252:255],a[220:223],v[128:131]
v_add_f32 v233,v238,v234
v_sub_f32 v238,v238,v234
M v[132:135],a[252:255],a[192:195],v[132:135]
v_fma_f32 v234,2.0,v235,v236
v_fmac_f32 v236,-2.0,v235
M v[136:139],a[252:255],a[196:199],v[136:139]
v_and_b32 v208,s42,v208
v_and_b32 v204,s42,v204
M v[140:143],a[252:255],a[200:203],v[140:143]
v_and_b32 v206,s42,v206
v_and_b32 v214,s42,v214
M v[144:147],a[252:255],a[204:207],v[144:147]
v_and_b32 v212,s42,v212
v_and_b32 v210,s42,v210
M v[148:151],a[252:255],a[208:211],v[148:151]
v_fmac_f32 v204,s43,v208
v_fmac_f32 v214,4.0,v206
M v[152:155],a[252:255],a[212:215],v[152:155]
v_fma_f32 v235,-4.0,v208,v212
v_fmac_f32 v204,s45,v212
M v[156:159],a[252:255],a[216:219],v[156:159]
s_waitcnt vmcnt(17)
buffer_load_dwordx4 a[252:255],v251,s[20:23],s47 offen offset:2048
M v[160:163],v[216:219],a[220:223],v[160:163]
ds_read_b128 a[220:223],v249 offset:28416
v_fmac_f32 v214,s40,v210
M v[164:167],v[216:219],a[192:195],v[164:167]
v_sub_f32 v212,v212,v208
v_fma_f32 v208,-4.0,v206,v210
M v[168:171],v[216:219],a[196:199],v[168:171]
v_sub_f32 v210,v210,v206
v_add_f32 v206,v235,v208
M v[172:175],v[216:219],a[200:203],v[172:175]
v_sub_f32 v235,v235,v208
v_fma_f32 v208,2.0,v210,v212
v_fmac_f32 v212,-2.0,v210
v_cvt_pk_bf16_f32 v204,v232,v204
M v[176:179],v[216:219],a[204:207],v[176:179]
v_cvt_pk_bf16_f32 v214,v237,v214
v_cvt_pk_bf16_f32 v206,v233,v206
v_cvt_pk_bf16_f32 v210,v234,v208
v_cvt_pk_bf16_f32 v208,v238,v235
M v[180:183],v[216:219],a[208:211],v[180:183]
v_cvt_pk_bf16_f32 v212,v236,v212
v_lshlrev_b32 v234,16,v209
v_lshlrev_b32 v232,16,v205
v_lshlrev_b32 v233,16,v207
M v[184:187],v[216:219],a[212:215],v[184:187]
v_lshlrev_b32 v237,16,v215
v_lshlrev_b32 v236,16,v213
v_lshlrev_b32 v235,16,v211
v_fmac_f32 v232,s43,v234
M v[188:191],v[216:219],a[216:219],v[188:191]
s_waitcnt vmcnt(16)
buffer_load_dwordx4 v[216:219],v251,s[20:23],s48 offen offset:2048
v_fmac_f32 v237,4.0,v233
v_fma_f32 v238,-4.0,v234,v236
v_fmac_f32 v232,s45,v236
v_fmac_f32 v237,s40,v235
M v[96:99],v[220:223],a[192:195],v[96:99]
v_sub_f32 v236,v236,v234
v_fma_f32 v234,-4.0,v233,v235
v_sub_f32 v235,v235,v233
v_add_f32 v233,v238,v234
M v[100:103],v[220:223],a[196:199],v[100:103]
s_add_u32 s46,s77,18432
v_sub_f32 v238,v238,v234
v_fma_f32 v234,2.0,v235,v236
v_fmac_f32 v236,-2.0,v235
v_and_b32 v209,s42,v209
M v[104:107],v[220:223],a[200:203],v[104:107]
v_and_b32 v205,s42,v205
v_and_b32 v207,s42,v207
v_and_b32 v215,s42,v215
v_and_b32 v213,s42,v213
M v[108:111],v[220:223],a[204:207],v[108:111]
v_and_b32 v211,s42,v211
v_fmac_f32 v205,s43,v209
v_fmac_f32 v215,4.0,v207
v_fma_f32 v235,-4.0,v209,v213
M v[112:115],v[220:223],a[208:211],v[112:115]
v_fmac_f32 v205,s45,v213
v_fmac_f32 v215,s40,v211
v_sub_f32 v213,v213,v209
v_fma_f32 v209,-4.0,v207,v211
M v[116:119],v[220:223],a[212:215],v[116:119]
v_sub_f32 v211,v211,v207
v_add_f32 v207,v235,v209
v_sub_f32 v235,v235,v209
v_fma_f32 v209,2.0,v211,v213
M v[120:123],v[220:223],a[216:219],v[120:123]
s_waitcnt lgkmcnt(0)
v_fmac_f32 v213,-2.0,v211
v_cvt_pk_bf16_f32 v205,v232,v205
v_cvt_pk_bf16_f32 v215,v237,v215
v_cvt_pk_bf16_f32 v207,v233,v207
M v[124:127],v[220:223],a[220:223],v[124:127]
s_waitcnt vmcnt(16)
buffer_load_dwordx4 v[220:223],v251,s[20:23],s46 offen offset:0
v_cvt_pk_bf16_f32 v211,v234,v209
v_cvt_pk_bf16_f32 v209,v238,v235
v_cvt_pk_bf16_f32 v213,v236,v213
M v[128:131],v[224:227],a[192:195],v[128:131]
ds_write2st64_b64 v247,v[204:205],v[214:215] offset0:173 offset1:190
M v[132:135],v[224:227],a[196:199],v[132:135]
s_add_u32 s28,s66,6684672
buffer_load_dwordx2 v[204:205],v245,s[12:15],s28 offen offset:0
ds_write2st64_b64 v247,v[206:207],v[208:209] offset0:3 offset1:20
M v[136:139],v[224:227],a[200:203],v[136:139]
s_add_u32 s47,s77,21504
buffer_load_dwordx2 v[214:215],v245,s[16:19],s28 offen offset:1536
M v[140:143],v[224:227],a[204:207],v[140:143]
buffer_load_dwordx2 v[206:207],v245,s[8:11],s28 offen offset:0
ds_write2st64_b64 v247,v[210:211],v[212:213] offset0:139 offset1:156
M v[144:147],v[224:227],a[208:211],v[144:147]
buffer_load_dwordx2 v[208:209],v245,s[8:11],s28 offen offset:384
M v[148:151],v[224:227],a[212:215],v[148:151]
buffer_load_dwordx2 v[210:211],v245,s[8:11],s28 offen offset:768
M v[152:155],v[224:227],a[216:219],v[152:155]
s_waitcnt lgkmcnt(0)
s_barrier
v_add_u32 v249,0xffffbc00,v249
M v[156:159],v[224:227],a[220:223],v[156:159]
s_waitcnt vmcnt(21)
buffer_load_dwordx2 v[212:213],v245,s[8:11],s28 offen offset:1152
M v[160:163],v[228:231],a[192:195],v[160:163]
buffer_load_dwordx4 v[224:227],v251,s[20:23],s47 offen offset:0
M v[164:167],v[228:231],a[196:199],v[164:167]
s_waitcnt vmcnt(14)
s_add_u32 s48,s77,24576
v_add_u32 v250,0xffffbc00,v250
v_lshlrev_b32 v234,16,v196
M v[168:171],v[228:231],a[200:203],v[168:171]
ds_read_b128 a[192:195],v249 offset:0
ds_read_b128 a[196:199],v250 offset:256
M v[172:175],v[228:231],a[204:207],v[172:175]
ds_read_b128 a[200:203],v250 offset:512
ds_read_b128 a[204:207],v250 offset:768
M v[176:179],v[228:231],a[208:211],v[176:179]
ds_read_b128 a[208:211],v250 offset:1024
v_lshlrev_b32 v232,16,v192
M v[180:183],v[228:231],a[212:215],v[180:183]
ds_read_b128 a[212:215],v250 offset:1280
v_lshlrev_b32 v233,16,v194
M v[184:187],v[228:231],a[216:219],v[184:187]
ds_read_b128 a[216:219],v250 offset:1536
v_lshlrev_b32 v237,16,v202
M v[188:191],v[228:231],a[220:223],v[188:191]
s_waitcnt lgkmcnt(6)
buffer_load_dwordx4 v[228:231],v251,s[20:23],s48 offen offset:0
M a[0:3],a[224:227],a[192:195],a[0:3]
s_waitcnt vmcnt(13) lgkmcnt(5)
ds_read_b128 a[220:223],v250 offset:1792
v_lshlrev_b32 v236,16,v200
M a[4:7],a[224:227],a[196:199],a[4:7]
s_waitcnt lgkmcnt(5)
v_lshlrev_b32 v235,16,v198
v_fmac_f32 v232,s43,v234
M a[8:11],a[224:227],a[200:203],a[8:11]
s_waitcnt lgkmcnt(4)
v_fmac_f32 v237,4.0,v233
v_fma_f32 v238,-4.0,v234,v236
M a[12:15],a[224:227],a[204:207],a[12:15]
s_waitcnt lgkmcnt(3)
v_fmac_f32 v232,s45,v236
v_fmac_f32 v237,s40,v235
M a[16:19],a[224:227],a[208:211],a[16:19]
s_waitcnt lgkmcnt(2)
v_sub_f32 v236,v236,v234
v_fma_f32 v234,-4.0,v233,v235
M a[20:23],a[224:227],a[212:215],a[20:23]
s_waitcnt lgkmcnt(1)
v_sub_f32 v235,v235,v233
v_add_f32 v233,v238,v234
M a[24:27],a[224:227],a[216:219],a[24:27]
s_waitcnt lgkmcnt(0)
v_sub_f32 v238,v238,v234
v_fma_f32 v234,2.0,v235,v236
M a[28:31],a[224:227],a[220:223],a[28:31]
buffer_load_dwordx4 a[224:227],v251,s[20:23],s46 offen offset:1024
M a[32:35],a[228:231],a[192:195],a[32:35]
v_fmac_f32 v236,-2.0,v235
v_and_b32 v196,s42,v196
M a[36:39],a[228:231],a[196:199],a[36:39]
v_and_b32 v192,s42,v192
v_and_b32 v194,s42,v194
M a[40:43],a[228:231],a[200:203],a[40:43]
v_and_b32 v202,s42,v202
v_and_b32 v200,s42,v200
M a[44:47],a[228:231],a[204:207],a[44:47]
v_and_b32 v198,s42,v198
v_fmac_f32 v192,s43,v196
M a[48:51],a[228:231],a[208:211],a[48:51]
v_fmac_f32 v202,4.0,v194
v_fma_f32 v235,-4.0,v196,v200
M a[52:55],a[228:231],a[212:215],a[52:55]
v_fmac_f32 v192,s45,v200
v_fmac_f32 v202,s40,v198
M a[56:59],a[228:231],a[216:219],a[56:59]
v_sub_f32 v200,v200,v196
v_fma_f32 v196,-4.0,v194,v198
M a[60:63],a[228:231],a[220:223],a[60:63]
buffer_load_dwordx4 a[228:231],v251,s[20:23],s47 offen offset:1024
M a[64:67],a[232:235],a[192:195],a[64:67]
ds_read_b128 a[192:195],v250 offset:2048
v_sub_f32 v198,v198,v194
M a[68:71],a[232:235],a[196:199],a[68:71]
v_add_f32 v194,v235,v196
v_sub_f32 v235,v235,v196
M a[72:75],a[232:235],a[200:203],a[72:75]
v_fma_f32 v196,2.0,v198,v200
v_fmac_f32 v200,-2.0,v198
M a[76:79],a[232:235],a[204:207],a[76:79]
v_cvt_pk_bf16_f32 v192,v232,v192
v_cvt_pk_bf16_f32 v202,v237,v202
M a[80:83],a[232:235],a[208:211],a[80:83]
v_cvt_pk_bf16_f32 v194,v233,v194
v_cvt_pk_bf16_f32 v198,v234,v196
M a[84:87],a[232:235],a[212:215],a[84:87]
v_cvt_pk_bf16_f32 v196,v238,v235
v_cvt_pk_bf16_f32 v200,v236,v200
M a[88:91],a[232:235],a[216:219],a[88:91]
v_lshlrev_b32 v234,16,v197
v_lshlrev_b32 v232,16,v193
M a[92:95],a[232:235],a[220:223],a[92:95]
buffer_load_dwordx4 a[232:235],v251,s[20:23],s48 offen offset:1024
M a[0:3],a[236:239],a[196:199],a[0:3]
v_lshlrev_b32 v233,16,v195
v_lshlrev_b32 v237,16,v203
M a[4:7],a[236:239],a[200:203],a[4:7]
v_lshlrev_b32 v236,16,v201
v_lshlrev_b32 v235,16,v199
M a[8:11],a[236:239],a[204:207],a[8:11]
v_fmac_f32 v232,s43,v234
v_fmac_f32 v237,4.0,v233
M a[12:15],a[236:239],a[208:211],a[12:15]
v_fma_f32 v238,-4.0,v234,v236
v_fmac_f32 v232,s45,v236
M a[16:19],a[236:239],a[212:215],a[16:19]
v_fmac_f32 v237,s40,v235
v_sub_f32 v236,v236,v234
M a[20:23],a[236:239],a[216:219],a[20:23]
v_fma_f32 v234,-4.0,v233,v235
v_sub_f32 v235,v235,v233
M a[24:27],a[236:239],a[220:223],a[24:27]
s_waitcnt lgkmcnt(0)
v_add_f32 v233,v238,v234
v_sub_f32 v238,v238,v234
M a[28:31],a[236:239],a[192:195],a[28:31]
buffer_load_dwordx4 a[236:239],v251,s[20:23],s46 offen offset:2048
M a[32:35],a[240:243],a[196:199],a[32:35]
v_fma_f32 v234,2.0,v235,v236
v_fmac_f32 v236,-2.0,v235
M a[36:39],a[240:243],a[200:203],a[36:39]
v_and_b32 v197,s42,v197
v_and_b32 v193,s42,v193
M a[40:43],a[240:243],a[204:207],a[40:43]
v_and_b32 v195,s42,v195
v_and_b32 v203,s42,v203
M a[44:47],a[240:243],a[208:211],a[44:47]
v_and_b32 v201,s42,v201
v_and_b32 v199,s42,v199
M a[48:51],a[240:243],a[212:215],a[48:51]
v_fmac_f32 v193,s43,v197
v_fmac_f32 v203,4.0,v195
M a[52:55],a[240:243],a[216:219],a[52:55]
v_fma_f32 v235,-4.0,v197,v201
v_fmac_f32 v193,s45,v201
M a[56:59],a[240:243],a[220:223],a[56:59]
v_fmac_f32 v203,s40,v199
v_sub_f32 v201,v201,v197
M a[60:63],a[240:243],a[192:195],a[60:63]
s_waitcnt vmcnt(16)
buffer_load_dwordx4 a[240:243],v251,s[20:23],s47 offen offset:2048
M a[64:67],a[244:247],a[196:199],a[64:67]
ds_read_b128 a[196:199],v249 offset:2304
v_fma_f32 v197,-4.0,v195,v199
M a[68:71],a[244:247],a[200:203],a[68:71]
v_sub_f32 v199,v199,v195
v_add_f32 v195,v235,v197
M a[72:75],a[244:247],a[204:207],a[72:75]
v_sub_f32 v235,v235,v197
v_fma_f32 v197,2.0,v199,v201
M a[76:79],a[244:247],a[208:211],a[76:79]
v_fmac_f32 v201,-2.0,v199
v_cvt_pk_bf16_f32 v193,v232,v193
M a[80:83],a[244:247],a[212:215],a[80:83]
v_cvt_pk_bf16_f32 v203,v237,v203
v_cvt_pk_bf16_f32 v195,v233,v195
M a[84:87],a[244:247],a[216:219],a[84:87]
v_cvt_pk_bf16_f32 v199,v234,v197
v_cvt_pk_bf16_f32 v197,v238,v235
M a[88:91],a[244:247],a[220:223],a[88:91]
v_cvt_pk_bf16_f32 v201,v236,v201
M a[92:95],a[244:247],a[192:195],a[92:95]
s_waitcnt vmcnt(16)
buffer_load_dwordx4 a[244:247],v251,s[20:23],s48 offen offset:2048
M a[0:3],a[248:251],a[200:203],a[0:3]
ds_write2st64_b64 v247,v[192:193],v[202:203] offset0:204 offset1:221
M a[4:7],a[248:251],a[204:207],a[4:7]
s_add_u32 s28,s66,7077888
buffer_load_dwordx2 v[192:193],v245,s[12:15],s28 offen offset:0
M a[8:11],a[248:251],a[208:211],a[8:11]
s_add_u32 s46,s77,27648
buffer_load_dwordx2 v[202:203],v245,s[16:19],s28 offen offset:1536
M a[12:15],a[248:251],a[212:215],a[12:15]
ds_write2st64_b64 v247,v[194:195],v[196:197] offset0:34 offset1:51
M a[16:19],a[248:251],a[216:219],a[16:19]
buffer_load_dwordx2 v[194:195],v245,s[8:11],s28 offen offset:0
M a[20:23],a[248:251],a[220:223],a[20:23]
buffer_load_dwordx2 v[196:197],v245,s[8:11],s28 offen offset:384
M a[24:27],a[248:251],a[192:195],a[24:27]
s_waitcnt lgkmcnt(2)
ds_write2st64_b64 v247,v[198:199],v[200:201] offset0:68 offset1:85
M a[28:31],a[248:251],a[196:199],a[28:31]
s_waitcnt vmcnt(20)
buffer_load_dwordx2 v[198:199],v245,s[8:11],s28 offen offset:768
M a[32:35],a[252:255],a[200:203],a[32:35]
buffer_load_dwordx2 v[200:201],v245,s[8:11],s28 offen offset:1152
M a[36:39],a[252:255],a[204:207],a[36:39]
buffer_load_dwordx4 a[248:251],v251,s[20:23],s46 offen offset:0
M a[40:43],a[252:255],a[208:211],a[40:43]
s_waitcnt vmcnt(17)
s_add_u32 s47,s77,30720
v_lshlrev_b32 v234,16,v208
v_lshlrev_b32 v232,16,v204
M a[44:47],a[252:255],a[212:215],a[44:47]
v_lshlrev_b32 v233,16,v206
v_lshlrev_b32 v237,16,v214
M a[48:51],a[252:255],a[216:219],a[48:51]
s_waitcnt vmcnt(15)
v_lshlrev_b32 v236,16,v212
v_lshlrev_b32 v235,16,v210
M a[52:55],a[252:255],a[220:223],a[52:55]
v_fmac_f32 v232,s43,v234
v_fmac_f32 v237,4.0,v233
M a[56:59],a[252:255],a[192:195],a[56:59]
v_fma_f32 v238,-4.0,v234,v236
v_fmac_f32 v232,s45,v236
M a[60:63],a[252:255],a[196:199],a[60:63]
buffer_load_dwordx4 a[252:255],v251,s[20:23],s47 offen offset:0
M a[64:67],v[216:219],a[200:203],a[64:67]
ds_read_b128 a[200:203],v249 offset:8704
v_fmac_f32 v237,s40,v235
M a[68:71],v[216:219],a[204:207],a[68:71]
s_add_u32 s48,s77,33792
ds_read_b128 a[204:207],v250 offset:8960
v_sub_f32 v236,v236,v234
M a[72:75],v[216:219],a[208:211],a[72:75]
ds_read_b128 a[208:211],v250 offset:9216
v_fma_f32 v234,-4.0,v233,v235
M a[76:79],v[216:219],a[212:215],a[76:79]
ds_read_b128 a[212:215],v250 offset:9472
v_sub_f32 v235,v235,v233
M a[80:83],v[216:219],a[216:219],a[80:83]
ds_read_b128 a[216:219],v250 offset:9728
v_add_f32 v233,v238,v234
M a[84:87],v[216:219],a[220:223],a[84:87]
ds_read_b128 a[220:223],v250 offset:9984
v_sub_f32 v238,v238,v234
M a[88:91],v[216:219],a[192:195],a[88:91]
ds_read_b128 a[192:195],v250 offset:10240
v_fma_f32 v234,2.0,v235,v236
M a[92:95],v[216:219],a[196:199],a[92:95]
s_waitcnt lgkmcnt(6)
buffer_load_dwordx4 v[216:219],v251,s[20:23],s48 offen offset:0
M a[96:99],v[220:223],a[200:203],a[96:99]
s_waitcnt lgkmcnt(5)
ds_read_b128 a[196:199],v250 offset:10496
v_fmac_f32 v236,-2.0,v235
M a[100:103],v[220:223],a[204:207],a[100:103]
s_waitcnt lgkmcnt(5)
v_and_b32 v208,s42,v208
v_and_b32 v204,s42,v204
M a[104:107],v[220:223],a[208:211],a[104:107]
s_waitcnt lgkmcnt(4)
v_and_b32 v206,s42,v206
v_and_b32 v214,s42,v214
M a[108:111],v[220:223],a[212:215],a[108:111]
s_waitcnt lgkmcnt(3)
v_and_b32 v212,s42,v212
v_and_b32 v210,s42,v210
M a[112:115],v[220:223],a[216:219],a[112:115]
s_waitcnt lgkmcnt(2)
v_fmac_f32 v204,s43,v208
v_fmac_f32 v214,4.0,v206
M a[116:119],v[220:223],a[220:223],a[116:119]
s_waitcnt lgkmcnt(1)
v_fma_f32 v235,-4.0,v208,v212
v_fmac_f32 v204,s45,v212
M a[120:123],v[220:223],a[192:195],a[120:123]
s_waitcnt lgkmcnt(0)
v_fmac_f32 v214,s40,v210
v_sub_f32 v212,v212,v208
M a[124:127],v[220:223],a[196:199],a[124:127]
s_waitcnt vmcnt(16)
buffer_load_dwordx4 v[220:223],v251,s[20:23],s46 offen offset:1024
M a[128:131],v[224:227],a[200:203],a[128:131]
v_fma_f32 v208,-4.0,v206,v210
v_sub_f32 v210,v210,v206
M a[132:135],v[224:227],a[204:207],a[132:135]
v_add_f32 v206,v235,v208
v_sub_f32 v235,v235,v208
M a[136:139],v[224:227],a[208:211],a[136:139]
v_fma_f32 v208,2.0,v210,v212
v_fmac_f32 v212,-2.0,v210
M a[140:143],v[224:227],a[212:215],a[140:143]
v_cvt_pk_bf16_f32 v204,v232,v204
v_cvt_pk_bf16_f32 v214,v237,v214
M a[144:147],v[224:227],a[216:219],a[144:147]
v_cvt_pk_bf16_f32 v206,v233,v206
v_cvt_pk_bf16_f32 v210,v234,v208
M a[148:151],v[224:227],a[220:223],a[148:151]
v_cvt_pk_bf16_f32 v208,v238,v235
v_cvt_pk_bf16_f32 v212,v236,v212
M a[152:155],v[224:227],a[192:195],a[152:155]
v_lshlrev_b32 v234,16,v209
v_lshlrev_b32 v232,16,v205
M a[156:159],v[224:227],a[196:199],a[156:159]
s_waitcnt vmcnt(16)
buffer_load_dwordx4 v[224:227],v251,s[20:23],s47 offen offset:1024
M a[160:163],v[228:231],a[200:203],a[160:163]
ds_read_b128 a[200:203],v250 offset:10752
v_lshlrev_b32 v233,16,v207
M a[164:167],v[228:231],a[204:207],a[164:167]
v_lshlrev_b32 v237,16,v215
v_lshlrev_b32 v236,16,v213
M a[168:171],v[228:231],a[208:211],a[168:171]
v_lshlrev_b32 v235,16,v211
v_fmac_f32 v232,s43,v234
M a[172:175],v[228:231],a[212:215],a[172:175]
v_fmac_f32 v237,4.0,v233
v_fma_f32 v238,-4.0,v234,v236
M a[176:179],v[228:231],a[216:219],a[176:179]
v_fmac_f32 v232,s45,v236
v_fmac_f32 v237,s40,v235
M a[180:183],v[228:231],a[220:223],a[180:183]
v_sub_f32 v236,v236,v234
v_fma_f32 v234,-4.0,v233,v235
M a[184:187],v[228:231],a[192:195],a[184:187]
v_sub_f32 v235,v235,v233
v_add_f32 v233,v238,v234
M a[188:191],v[228:231],a[196:199],a[188:191]
s_waitcnt vmcnt(16)
buffer_load_dwordx4 v[228:231],v251,s[20:23],s48 offen offset:1024
M a[96:99],a[224:227],a[204:207],a[96:99]
v_sub_f32 v238,v238,v234
v_fma_f32 v234,2.0,v235,v236
M a[100:103],a[224:227],a[208:211],a[100:103]
v_fmac_f32 v236,-2.0,v235
v_and_b32 v209,s42,v209
M a[104:107],a[224:227],a[212:215],a[104:107]
v_and_b32 v205,s42,v205
v_and_b32 v207,s42,v207
M a[108:111],a[224:227],a[216:219],a[108:111]
v_and_b32 v215,s42,v215
v_and_b32 v213,s42,v213
M a[112:115],a[224:227],a[220:223],a[112:115]
v_and_b32 v211,s42,v211
v_fmac_f32 v205,s43,v209
M a[116:119],a[224:227],a[192:195],a[116:119]
v_fmac_f32 v215,4.0,v207
v_fma_f32 v235,-4.0,v209,v213
M a[120:123],a[224:227],a[196:199],a[120:123]
s_waitcnt lgkmcnt(0)
v_fmac_f32 v205,s45,v213
v_fmac_f32 v215,s40,v211
M a[124:127],a[224:227],a[200:203],a[124:127]
s_waitcnt vmcnt(16)
buffer_load_dwordx4 a[224:227],v251,s[20:23],s46 offen offset:2048
M a[128:131],a[228:231],a[204:207],a[128:131]
v_sub_f32 v213,v213,v209
v_fma_f32 v209,-4.0,v207,v211
M a[132:135],a[228:231],a[208:211],a[132:135]
v_sub_f32 v211,v211,v207
v_add_f32 v207,v235,v209
M a[136:139],a[228:231],a[212:215],a[136:139]
v_sub_f32 v235,v235,v209
v_fma_f32 v209,2.0,v211,v213
M a[140:143],a[228:231],a[216:219],a[140:143]
v_fmac_f32 v213,-2.0,v211
v_cvt_pk_bf16_f32 v205,v232,v205
M a[144:147],a[228:231],a[220:223],a[144:147]
v_cvt_pk_bf16_f32 v215,v237,v215
v_cvt_pk_bf16_f32 v207,v233,v207
M a[148:151],a[228:231],a[192:195],a[148:151]
v_cvt_pk_bf16_f32 v211,v234,v209
v_cvt_pk_bf16_f32 v209,v238,v235
M a[152:155],a[228:231],a[196:199],a[152:155]
v_cvt_pk_bf16_f32 v213,v236,v213
M a[156:159],a[228:231],a[200:203],a[156:159]
s_waitcnt vmcnt(16)
buffer_load_dwordx4 a[228:231],v251,s[20:23],s47 offen offset:2048
M a[160:163],a[232:235],a[204:207],a[160:163]
ds_read_b128 a[204:207],v249 offset:11008
ds_write2st64_b64 v247,v[204:205],v[214:215] offset0:205 offset1:222
M a[164:167],a[232:235],a[208:211],a[164:167]
s_add_u32 s28,s66,7471104
buffer_load_dwordx2 v[204:205],v245,s[12:15],s28 offen offset:0
M a[168:171],a[232:235],a[212:215],a[168:171]
buffer_load_dwordx2 v[214:215],v245,s[16:19],s28 offen offset:1536
M a[172:175],a[232:235],a[216:219],a[172:175]
ds_write2st64_b64 v247,v[206:207],v[208:209] offset0:35 offset1:52
M a[176:179],a[232:235],a[220:223],a[176:179]
buffer_load_dwordx2 v[206:207],v245,s[8:11],s28 offen offset:0
M a[180:183],a[232:235],a[192:195],a[180:183]
buffer_load_dwordx2 v[208:209],v245,s[8:11],s28 offen offset:384
M a[184:187],a[232:235],a[196:199],a[184:187]
ds_write2st64_b64 v247,v[210:211],v[212:213] offset0:69 offset1:86
M a[188:191],a[232:235],a[200:203],a[188:191]
s_waitcnt vmcnt(20)
buffer_load_dwordx2 v[210:211],v245,s[8:11],s28 offen offset:768
M a[96:99],a[236:239],a[208:211],a[96:99]
buffer_load_dwordx2 v[212:213],v245,s[8:11],s28 offen offset:1152
M a[100:103],a[236:239],a[212:215],a[100:103]
buffer_load_dwordx4 a[232:235],v251,s[20:23],s48 offen offset:2048
M a[104:107],a[236:239],a[216:219],a[104:107]
s_add_u32 s46,s77,36864
v_fmac_f32 v239,s43,v241
v_fmac_f32 v244,4.0,v240
M a[108:111],a[236:239],a[220:223],a[108:111]
v_fma_f32 v232,-4.0,v241,v243
v_fmac_f32 v239,s45,v243
M a[112:115],a[236:239],a[192:195],a[112:115]
v_fmac_f32 v244,s40,v242
v_sub_f32 v243,v243,v241
M a[116:119],a[236:239],a[196:199],a[116:119]
v_fma_f32 v241,-4.0,v240,v242
v_sub_f32 v242,v242,v240
M a[120:123],a[236:239],a[200:203],a[120:123]
s_waitcnt lgkmcnt(3)
v_add_f32 v240,v232,v241
v_sub_f32 v232,v232,v241
M a[124:127],a[236:239],a[204:207],a[124:127]
s_waitcnt vmcnt(22)
buffer_load_dwordx4 a[236:239],v251,s[20:23],s46 offen offset:0
M a[128:131],a[240:243],a[208:211],a[128:131]
v_fma_f32 v241,2.0,v242,v243
v_fmac_f32 v243,-2.0,v242
M a[132:135],a[240:243],a[212:215],a[132:135]
s_add_u32 s47,s77,39936
v_cvt_pk_bf16_f32 v233,v239,v244
v_cvt_pk_bf16_f32 v234,v240,v232
M a[136:139],a[240:243],a[216:219],a[136:139]
v_cvt_pk_bf16_f32 v235,v241,v243
v_add_u32 v232,104448,v248
M a[140:143],a[240:243],a[220:223],a[140:143]
buffer_load_short_d16_hi v239,v246,s[12:15],s73 offen offset:0
M a[144:147],a[240:243],a[192:195],a[144:147]
buffer_load_short_d16_hi v240,v246,s[8:11],s73 offen offset:0
M a[148:151],a[240:243],a[196:199],a[148:151]
buffer_load_short_d16_hi v241,v246,s[8:11],s73 offen offset:384
M a[152:155],a[240:243],a[200:203],a[152:155]
buffer_load_short_d16_hi v242,v246,s[8:11],s73 offen offset:768
M a[156:159],a[240:243],a[204:207],a[156:159]
s_waitcnt vmcnt(26)
buffer_load_short_d16_hi v243,v246,s[8:11],s73 offen offset:1152
M a[160:163],a[244:247],a[208:211],a[160:163]
buffer_load_short_d16_hi v244,v246,s[16:19],s73 offen offset:1536
M a[164:167],a[244:247],a[212:215],a[164:167]
buffer_load_dwordx4 a[240:243],v251,s[20:23],s47 offen offset:0
v_add_u32 v249,0x4400,v249
v_add_u32 v250,0x4400,v250
M a[168:171],a[244:247],a[216:219],a[168:171]
s_add_u32 s48,s77,43008
ds_read_b128 a[208:211],v249 offset:52224
ds_read_b128 a[212:215],v250 offset:52480
M a[172:175],a[244:247],a[220:223],a[172:175]
ds_read_b128 a[216:219],v250 offset:52736
ds_read_b128 a[220:223],v250 offset:52992
M a[176:179],a[244:247],a[192:195],a[176:179]
ds_read_b128 a[192:195],v250 offset:53248
ds_write_b16 v232,v233 offset:0
M a[180:183],a[244:247],a[196:199],a[180:183]
ds_read_b128 a[196:199],v250 offset:53504
ds_write_b16_d16_hi v232,v233 offset:8704
M a[184:187],a[244:247],a[200:203],a[184:187]
ds_read_b128 a[200:203],v250 offset:53760
ds_write_b16 v248,v234 offset:17408
M a[188:191],a[244:247],a[204:207],a[188:191]
s_waitcnt vmcnt(22) lgkmcnt(9)
buffer_load_dwordx4 a[244:247],v251,s[20:23],s48 offen offset:0
M v[0:3],a[248:251],a[208:211],v[0:3]
s_waitcnt lgkmcnt(8)
ds_read_b128 a[204:207],v250 offset:54016
ds_write_b16_d16_hi v248,v234 offset:26112
M v[4:7],a[248:251],a[212:215],v[4:7]
s_waitcnt lgkmcnt(9)
ds_write_b16 v248,v235 offset:34816
M v[8:11],a[248:251],a[216:219],v[8:11]
s_waitcnt lgkmcnt(9)
ds_write_b16_d16_hi v248,v235 offset:43520
M v[12:15],a[248:251],a[220:223],v[12:15]
s_waitcnt lgkmcnt(9)
v_lshlrev_b32 v234,16,v196
v_lshlrev_b32 v232,16,v192
M v[16:19],a[248:251],a[192:195],v[16:19]
s_waitcnt lgkmcnt(7)
v_lshlrev_b32 v233,16,v194
v_lshlrev_b32 v237,16,v202
M v[20:23],a[248:251],a[196:199],v[20:23]
s_waitcnt lgkmcnt(5)
v_lshlrev_b32 v236,16,v200
v_lshlrev_b32 v235,16,v198
M v[24:27],a[248:251],a[200:203],v[24:27]
s_waitcnt lgkmcnt(3)
v_fmac_f32 v232,s43,v234
v_fmac_f32 v237,4.0,v233
M v[28:31],a[248:251],a[204:207],v[28:31]
s_waitcnt vmcnt(22)
buffer_load_dwordx4 a[248:251],v251,s[20:23],s46 offen offset:1024
M v[32:35],a[252:255],a[208:211],v[32:35]
v_fma_f32 v238,-4.0,v234,v236
v_fmac_f32 v232,s45,v236
M v[36:39],a[252:255],a[212:215],v[36:39]
v_fmac_f32 v237,s40,v235
v_sub_f32 v236,v236,v234
M v[40:43],a[252:255],a[216:219],v[40:43]
v_fma_f32 v234,-4.0,v233,v235
v_sub_f32 v235,v235,v233
M v[44:47],a[252:255],a[220:223],v[44:47]
v_add_f32 v233,v238,v234
v_sub_f32 v238,v238,v234
M v[48:51],a[252:255],a[192:195],v[48:51]
v_fma_f32 v234,2.0,v235,v236
v_fmac_f32 v236,-2.0,v235
M v[52:55],a[252:255],a[196:199],v[52:55]
v_and_b32 v196,s42,v196
v_and_b32 v192,s42,v192
M v[56:59],a[252:255],a[200:203],v[56:59]
v_and_b32 v194,s42,v194
v_and_b32 v202,s42,v202
M v[60:63],a[252:255],a[204:207],v[60:63]
s_waitcnt vmcnt(22)
buffer_load_dwordx4 a[252:255],v251,s[20:23],s47 offen offset:1024
M v[64:67],v[216:219],a[208:211],v[64:67]
ds_read_b128 a[208:211],v250 offset:54272
v_and_b32 v200,s42,v200
M v[68:71],v[216:219],a[212:215],v[68:71]
v_and_b32 v198,s42,v198
v_fmac_f32 v192,s43,v196
M v[72:75],v[216:219],a[216:219],v[72:75]
v_fmac_f32 v202,4.0,v194
v_fma_f32 v235,-4.0,v196,v200
M v[76:79],v[216:219],a[220:223],v[76:79]
v_fmac_f32 v192,s45,v200
v_fmac_f32 v202,s40,v198
M v[80:83],v[216:219],a[192:195],v[80:83]
v_sub_f32 v200,v200,v196
v_fma_f32 v196,-4.0,v194,v198
M v[84:87],v[216:219],a[196:199],v[84:87]
v_sub_f32 v198,v198,v194
v_add_f32 v194,v235,v196
M v[88:91],v[216:219],a[200:203],v[88:91]
v_sub_f32 v235,v235,v196
v_fma_f32 v196,2.0,v198,v200
M v[92:95],v[216:219],a[204:207],v[92:95]
s_waitcnt vmcnt(22)
buffer_load_dwordx4 v[216:219],v251,s[20:23],s48 offen offset:1024
M v[0:3],v[220:223],a[212:215],v[0:3]
v_fmac_f32 v200,-2.0,v198
v_cvt_pk_bf16_f32 v192,v232,v192
M v[4:7],v[220:223],a[216:219],v[4:7]
v_cvt_pk_bf16_f32 v202,v237,v202
v_cvt_pk_bf16_f32 v194,v233,v194
M v[8:11],v[220:223],a[220:223],v[8:11]
v_cvt_pk_bf16_f32 v198,v234,v196
v_cvt_pk_bf16_f32 v196,v238,v235
M v[12:15],v[220:223],a[192:195],v[12:15]
v_cvt_pk_bf16_f32 v200,v236,v200
v_lshlrev_b32 v234,16,v197
M v[16:19],v[220:223],a[196:199],v[16:19]
v_lshlrev_b32 v232,16,v193
v_lshlrev_b32 v233,16,v195
M v[20:23],v[220:223],a[200:203],v[20:23]
v_lshlrev_b32 v237,16,v203
v_lshlrev_b32 v236,16,v201
M v[24:27],v[220:223],a[204:207],v[24:27]
s_waitcnt lgkmcnt(0)
v_lshlrev_b32 v235,16,v199
v_fmac_f32 v232,s43,v234
M v[28:31],v[220:223],a[208:211],v[28:31]
s_waitcnt vmcnt(22)
buffer_load_dwordx4 v[220:223],v251,s[20:23],s46 offen offset:2048
M v[32:35],v[224:227],a[212:215],v[32:35]
v_fmac_f32 v237,4.0,v233
v_fma_f32 v238,-4.0,v234,v236
M v[36:39],v[224:227],a[216:219],v[36:39]
v_fmac_f32 v232,s45,v236
v_fmac_f32 v237,s40,v235
M v[40:43],v[224:227],a[220:223],v[40:43]
v_sub_f32 v236,v236,v234
v_fma_f32 v234,-4.0,v233,v235
M v[44:47],v[224:227],a[192:195],v[44:47]
v_sub_f32 v235,v235,v233
v_add_f32 v233,v238,v234
M v[48:51],v[224:227],a[196:199],v[48:51]
v_sub_f32 v238,v238,v234
v_fma_f32 v234,2.0,v235,v236
M v[52:55],v[224:227],a[200:203],v[52:55]
v_fmac_f32 v236,-2.0,v235
v_and_b32 v197,s42,v197
M v[56:59],v[224:227],a[204:207],v[56:59]
v_and_b32 v193,s42,v193
v_and_b32 v195,s42,v195
M v[60:63],v[224:227],a[208:211],v[60:63]
s_waitcnt vmcnt(22)
buffer_load_dwordx4 v[224:227],v251,s[20:23],s47 offen offset:2048
M v[64:67],v[228:231],a[212:215],v[64:67]
ds_read_b128 a[212:215],v249 offset:54528
v_and_b32 v203,s42,v203
M v[68:71],v[228:231],a[216:219],v[68:71]
v_and_b32 v201,s42,v201
v_and_b32 v199,s42,v199
M v[72:75],v[228:231],a[220:223],v[72:75]
v_fmac_f32 v193,s43,v197
v_fmac_f32 v203,4.0,v195
M v[76:79],v[228:231],a[192:195],v[76:79]
v_fma_f32 v235,-4.0,v197,v201
v_fmac_f32 v193,s45,v201
M v[80:83],v[228:231],a[196:199],v[80:83]
v_fmac_f32 v203,s40,v199
v_sub_f32 v201,v201,v197
M v[84:87],v[228:231],a[200:203],v[84:87]
v_fma_f32 v197,-4.0,v195,v199
v_sub_f32 v199,v199,v195
M v[88:91],v[228:231],a[204:207],v[88:91]
v_add_f32 v195,v235,v197
v_sub_f32 v235,v235,v197
M v[92:95],v[228:231],a[208:211],v[92:95]
s_waitcnt vmcnt(22)
buffer_load_dwordx4 v[228:231],v251,s[20:23],s48 offen offset:2048
M v[0:3],a[224:227],a[216:219],v[0:3]
v_fma_f32 v197,2.0,v199,v201
v_fmac_f32 v201,-2.0,v199
M v[4:7],a[224:227],a[220:223],v[4:7]
s_add_u32 s46,s78,9216
v_cvt_pk_bf16_f32 v193,v232,v193
v_cvt_pk_bf16_f32 v203,v237,v203
M v[8:11],a[224:227],a[192:195],v[8:11]
v_cvt_pk_bf16_f32 v195,v233,v195
v_cvt_pk_bf16_f32 v199,v234,v197
M v[12:15],a[224:227],a[196:199],v[12:15]
v_cvt_pk_bf16_f32 v197,v238,v235
v_cvt_pk_bf16_f32 v201,v236,v201
M v[16:19],a[224:227],a[200:203],v[16:19]
ds_write2st64_b64 v247,v[192:193],v[202:203] offset0:206 offset1:223
M v[20:23],a[224:227],a[204:207],v[20:23]
s_add_u32 s28,s67,6291456
buffer_load_dwordx2 v[192:193],v245,s[12:15],s28 offen offset:0
M v[24:27],a[224:227],a[208:211],v[24:27]
s_waitcnt lgkmcnt(1)
buffer_load_dwordx2 v[202:203],v245,s[16:19],s28 offen offset:1536
M v[28:31],a[224:227],a[212:215],v[28:31]
s_waitcnt vmcnt(24)
buffer_load_dwordx4 a[224:227],v251,s[20:23],s46 offen offset:0
M v[32:35],a[228:231],a[216:219],v[32:35]
ds_write2st64_b64 v247,v[194:195],v[196:197] offset0:36 offset1:53
M v[36:39],a[228:231],a[220:223],v[36:39]
s_add_u32 s47,s78,12288
buffer_load_dwordx2 v[194:195],v245,s[8:11],s28 offen offset:0
M v[40:43],a[228:231],a[192:195],v[40:43]
buffer_load_dwordx2 v[196:197],v245,s[8:11],s28 offen offset:384
M v[44:47],a[228:231],a[196:199],v[44:47]
ds_write2st64_b64 v247,v[198:199],v[200:201] offset0:70 offset1:87
M v[48:51],a[228:231],a[200:203],v[48:51]
buffer_load_dwordx2 v[198:199],v245,s[8:11],s28 offen offset:768
M v[52:55],a[228:231],a[204:207],v[52:55]
buffer_load_dwordx2 v[200:201],v245,s[8:11],s28 offen offset:1152
M v[56:59],a[228:231],a[208:211],v[56:59]
s_waitcnt vmcnt(25)
v_lshlrev_b32 v234,16,v208
v_lshlrev_b32 v232,16,v204
M v[60:63],a[228:231],a[212:215],v[60:63]
s_waitcnt vmcnt(22)
buffer_load_dwordx4 a[228:231],v251,s[20:23],s47 offen offset:0
M v[64:67],a[232:235],a[216:219],v[64:67]
ds_read_b128 a[216:219],v249 offset:60928
v_lshlrev_b32 v233,16,v206
M v[68:71],a[232:235],a[220:223],v[68:71]
s_add_u32 s48,s78,15360
ds_read_b128 a[220:223],v250 offset:61184
v_lshlrev_b32 v237,16,v214
M v[72:75],a[232:235],a[192:195],v[72:75]
ds_read_b128 a[192:195],v250 offset:61440
v_lshlrev_b32 v236,16,v212
M v[76:79],a[232:235],a[196:199],v[76:79]
ds_read_b128 a[196:199],v250 offset:61696
v_lshlrev_b32 v235,16,v210
M v[80:83],a[232:235],a[200:203],v[80:83]
ds_read_b128 a[200:203],v250 offset:61952
v_fmac_f32 v232,s43,v234
M v[84:87],a[232:235],a[204:207],v[84:87]
ds_read_b128 a[204:207],v250 offset:62208
v_fmac_f32 v237,4.0,v233
M v[88:91],a[232:235],a[208:211],v[88:91]
ds_read_b128 a[208:211],v250 offset:62464
v_fma_f32 v238,-4.0,v234,v236
M v[92:95],a[232:235],a[212:215],v[92:95]
s_waitcnt vmcnt(22) lgkmcnt(6)
buffer_load_dwordx4 a[232:235],v251,s[20:23],s48 offen offset:0
M v[96:99],a[236:239],a[216:219],v[96:99]
s_waitcnt lgkmcnt(5)
ds_read_b128 a[212:215],v250 offset:62720
v_fmac_f32 v232,s45,v236
M v[100:103],a[236:239],a[220:223],v[100:103]
s_waitcnt lgkmcnt(5)
v_fmac_f32 v237,s40,v235
v_sub_f32 v236,v236,v234
M v[104:107],a[236:239],a[192:195],v[104:107]
s_waitcnt lgkmcnt(4)
v_fma_f32 v234,-4.0,v233,v235
v_sub_f32 v235,v235,v233
M v[108:111],a[236:239],a[196:199],v[108:111]
s_waitcnt lgkmcnt(3)
v_add_f32 v233,v238,v234
v_sub_f32 v238,v238,v234
M v[112:115],a[236:239],a[200:203],v[112:115]
s_waitcnt lgkmcnt(2)
v_fma_f32 v234,2.0,v235,v236
v_fmac_f32 v236,-2.0,v235
M v[116:119],a[236:239],a[204:207],v[116:119]
s_waitcnt lgkmcnt(1)
v_and_b32 v208,s42,v208
v_and_b32 v204,s42,v204
M v[120:123],a[236:239],a[208:211],v[120:123]
s_waitcnt lgkmcnt(0)
v_and_b32 v206,s42,v206
v_and_b32 v214,s42,v214
M v[124:127],a[236:239],a[212:215],v[124:127]
s_waitcnt vmcnt(16)
buffer_load_dwordx4 a[236:239],v251,s[20:23],s46 offen offset:1024
M v[128:131],a[240:243],a[216:219],v[128:131]
v_and_b32 v212,s42,v212
v_and_b32 v210,s42,v210
M v[132:135],a[240:243],a[220:223],v[132:135]
v_fmac_f32 v204,s43,v208
v_fmac_f32 v214,4.0,v206
M v[136:139],a[240:243],a[192:195],v[136:139]
v_fma_f32 v235,-4.0,v208,v212
v_fmac_f32 v204,s45,v212
M v[140:143],a[240:243],a[196:199],v[140:143]
v_fmac_f32 v214,s40,v210
v_sub_f32 v212,v212,v208
M v[144:147],a[240:243],a[200:203],v[144:147]
v_fma_f32 v208,-4.0,v206,v210
v_sub_f32 v210,v210,v206
M v[148:151],a[240:243],a[204:207],v[148:151]
v_add_f32 v206,v235,v208
v_sub_f32 v235,v235,v208
M v[152:155],a[240:243],a[208:211],v[152:155]
v_fma_f32 v208,2.0,v210,v212
v_fmac_f32 v212,-2.0,v210
M v[156:159],a[240:243],a[212:215],v[156:159]
s_waitcnt vmcnt(16)
buffer_load_dwordx4 a[240:243],v251,s[20:23],s47 offen offset:1024
M v[160:163],a[244:247],a[216:219],v[160:163]
ds_read_b128 a[216:219],v250 offset:62976
v_cvt_pk_bf16_f32 v204,v232,v204
M v[164:167],a[244:247],a[220:223],v[164:167]
v_cvt_pk_bf16_f32 v214,v237,v214
v_cvt_pk_bf16_f32 v206,v233,v206
M v[168:171],a[244:247],a[192:195],v[168:171]
v_cvt_pk_bf16_f32 v210,v234,v208
v_cvt_pk_bf16_f32 v208,v238,v235
M v[172:175],a[244:247],a[196:199],v[172:175]
v_cvt_pk_bf16_f32 v212,v236,v212
v_lshlrev_b32 v234,16,v209
M v[176:179],a[244:247],a[200:203],v[176:179]
v_lshlrev_b32 v232,16,v205
v_lshlrev_b32 v233,16,v207
M v[180:183],a[244:247],a[204:207],v[180:183]
v_lshlrev_b32 v237,16,v215
v_lshlrev_b32 v236,16,v213
M v[184:187],a[244:247],a[208:211],v[184:187]
v_lshlrev_b32 v235,16,v211
v_fmac_f32 v232,s43,v234
M v[188:191],a[244:247],a[212:215],v[188:191]
s_waitcnt vmcnt(16)
buffer_load_dwordx4 a[244:247],v251,s[20:23],s48 offen offset:1024
M v[96:99],a[248:251],a[220:223],v[96:99]
v_fmac_f32 v237,4.0,v233
v_fma_f32 v238,-4.0,v234,v236
M v[100:103],a[248:251],a[192:195],v[100:103]
v_fmac_f32 v232,s45,v236
v_fmac_f32 v237,s40,v235
M v[104:107],a[248:251],a[196:199],v[104:107]
v_sub_f32 v236,v236,v234
v_fma_f32 v234,-4.0,v233,v235
M v[108:111],a[248:251],a[200:203],v[108:111]
v_sub_f32 v235,v235,v233
v_add_f32 v233,v238,v234
M v[112:115],a[248:251],a[204:207],v[112:115]
v_sub_f32 v238,v238,v234
v_fma_f32 v234,2.0,v235,v236
M v[116:119],a[248:251],a[208:211],v[116:119]
v_fmac_f32 v236,-2.0,v235
v_and_b32 v209,s42,v209
M v[120:123],a[248:251],a[212:215],v[120:123]
s_waitcnt lgkmcnt(0)
v_and_b32 v205,s42,v205
v_and_b32 v207,s42,v207
M v[124:127],a[248:251],a[216:219],v[124:127]
s_waitcnt vmcnt(16)
buffer_load_dwordx4 a[248:251],v251,s[20:23],s46 offen offset:2048
M v[128:131],a[252:255],a[220:223],v[128:131]
v_and_b32 v215,s42,v215
v_and_b32 v213,s42,v213
M v[132:135],a[252:255],a[192:195],v[132:135]
v_and_b32 v211,s42,v211
v_fmac_f32 v205,s43,v209
M v[136:139],a[252:255],a[196:199],v[136:139]
v_fmac_f32 v215,4.0,v207
v_fma_f32 v235,-4.0,v209,v213
M v[140:143],a[252:255],a[200:203],v[140:143]
v_fmac_f32 v205,s45,v213
v_fmac_f32 v215,s40,v211
M v[144:147],a[252:255],a[204:207],v[144:147]
v_sub_f32 v213,v213,v209
v_fma_f32 v209,-4.0,v207,v211
M v[148:151],a[252:255],a[208:211],v[148:151]
v_sub_f32 v211,v211,v207
v_add_f32 v207,v235,v209
M v[152:155],a[252:255],a[212:215],v[152:155]
v_sub_f32 v235,v235,v209
v_fma_f32 v209,2.0,v211,v213
M v[156:159],a[252:255],a[216:219],v[156:159]
s_waitcnt vmcnt(16)
buffer_load_dwordx4 a[252:255],v251,s[20:23],s47 offen offset:2048
M v[160:163],v[216:219],a[220:223],v[160:163]
ds_read_b128 a[220:223],v249 offset:63232
v_fmac_f32 v213,-2.0,v211
M v[164:167],v[216:219],a[192:195],v[164:167]
v_cvt_pk_bf16_f32 v205,v232,v205
v_cvt_pk_bf16_f32 v215,v237,v215
M v[168:171],v[216:219],a[196:199],v[168:171]
v_cvt_pk_bf16_f32 v207,v233,v207
v_cvt_pk_bf16_f32 v211,v234,v209
M v[172:175],v[216:219],a[200:203],v[172:175]
v_cvt_pk_bf16_f32 v209,v238,v235
v_cvt_pk_bf16_f32 v213,v236,v213
M v[176:179],v[216:219],a[204:207],v[176:179]
ds_write2st64_b64 v247,v[204:205],v[214:215] offset0:207 offset1:224
M v[180:183],v[216:219],a[208:211],v[180:183]
s_add_u32 s28,s67,6684672
buffer_load_dwordx2 v[204:205],v245,s[12:15],s28 offen offset:0
M v[184:187],v[216:219],a[212:215],v[184:187]
buffer_load_dwordx2 v[214:215],v245,s[16:19],s28 offen offset:1536
M v[188:191],v[216:219],a[216:219],v[188:191]
s_waitcnt vmcnt(18)
buffer_load_dwordx4 v[216:219],v251,s[20:23],s48 offen offset:2048
M v[96:99],v[220:223],a[192:195],v[96:99]
ds_write2st64_b64 v247,v[206:207],v[208:209] offset0:37 offset1:54
M v[100:103],v[220:223],a[196:199],v[100:103]
s_add_u32 s46,s78,18432
buffer_load_dwordx2 v[206:207],v245,s[8:11],s28 offen offset:0
M v[104:107],v[220:223],a[200:203],v[104:107]
buffer_load_dwordx2 v[208:209],v245,s[8:11],s28 offen offset:384
M v[108:111],v[220:223],a[204:207],v[108:111]
ds_write2st64_b64 v247,v[210:211],v[212:213] offset0:71 offset1:88
M v[112:115],v[220:223],a[208:211],v[112:115]
buffer_load_dwordx2 v[210:211],v245,s[8:11],s28 offen offset:768
M v[116:119],v[220:223],a[212:215],v[116:119]
buffer_load_dwordx2 v[212:213],v245,s[8:11],s28 offen offset:1152
M v[120:123],v[220:223],a[216:219],v[120:123]
s_waitcnt vmcnt(16) lgkmcnt(3)
v_lshlrev_b32 v234,16,v196
v_lshlrev_b32 v232,16,v192
M v[124:127],v[220:223],a[220:223],v[124:127]
buffer_load_dwordx4 v[220:223],v251,s[20:23],s46 offen offset:0
M v[128:131],v[224:227],a[192:195],v[128:131]
v_lshlrev_b32 v233,16,v194
v_lshlrev_b32 v237,16,v202
M v[132:135],v[224:227],a[196:199],v[132:135]
s_waitcnt vmcnt(15)
s_add_u32 s47,s78,21504
v_lshlrev_b32 v236,16,v200
v_lshlrev_b32 v235,16,v198
M v[136:139],v[224:227],a[200:203],v[136:139]
v_fmac_f32 v232,s43,v234
v_fmac_f32 v237,4.0,v233
M v[140:143],v[224:227],a[204:207],v[140:143]
v_fma_f32 v238,-4.0,v234,v236
v_fmac_f32 v232,s45,v236
M v[144:147],v[224:227],a[208:211],v[144:147]
v_fmac_f32 v237,s40,v235
v_sub_f32 v236,v236,v234
M v[148:151],v[224:227],a[212:215],v[148:151]
v_fma_f32 v234,-4.0,v233,v235
v_sub_f32 v235,v235,v233
M v[152:155],v[224:227],a[216:219],v[152:155]
s_waitcnt lgkmcnt(0)
s_barrier
v_add_f32 v233,v238,v234
M v[156:159],v[224:227],a[220:223],v[156:159]
buffer_load_dwordx4 v[224:227],v251,s[20:23],s47 offen offset:0
M v[160:163],v[228:231],a[192:195],v[160:163]
ds_read_b128 a[192:195],v249 offset:0
v_sub_f32 v238,v238,v234
M v[164:167],v[228:231],a[196:199],v[164:167]
s_add_u32 s48,s78,24576
ds_read_b128 a[196:199],v250 offset:256
v_fma_f32 v234,2.0,v235,v236
M v[168:171],v[228:231],a[200:203],v[168:171]
ds_read_b128 a[200:203],v250 offset:512
v_fmac_f32 v236,-2.0,v235
M v[172:175],v[228:231],a[204:207],v[172:175]
ds_read_b128 a[204:207],v250 offset:768
v_and_b32 v196,s42,v196
M v[176:179],v[228:231],a[208:211],v[176:179]
ds_read_b128 a[208:211],v250 offset:1024
v_and_b32 v192,s42,v192
M v[180:183],v[228:231],a[212:215],v[180:183]
ds_read_b128 a[212:215],v250 offset:1280
v_and_b32 v194,s42,v194
M v[184:187],v[228:231],a[216:219],v[184:187]
ds_read_b128 a[216:219],v250 offset:1536
v_and_b32 v202,s42,v202
M v[188:191],v[228:231],a[220:223],v[188:191]
s_waitcnt lgkmcnt(6)
buffer_load_dwordx4 v[228:231],v251,s[20:23],s48 offen offset:0
M a[0:3],a[224:227],a[192:195],a[0:3]
s_waitcnt lgkmcnt(5)
ds_read_b128 a[220:223],v250 offset:1792
v_and_b32 v200,s42,v200
M a[4:7],a[224:227],a[196:199],a[4:7]
s_waitcnt lgkmcnt(5)
v_and_b32 v198,s42,v198
v_fmac_f32 v192,s43,v196
M a[8:11],a[224:227],a[200:203],a[8:11]
s_waitcnt lgkmcnt(4)
v_fmac_f32 v202,4.0,v194
v_fma_f32 v235,-4.0,v196,v200
M a[12:15],a[224:227],a[204:207],a[12:15]
s_waitcnt lgkmcnt(3)
v_fmac_f32 v192,s45,v200
v_fmac_f32 v202,s40,v198
M a[16:19],a[224:227],a[208:211],a[16:19]
s_waitcnt lgkmcnt(2)
v_sub_f32 v200,v200,v196
v_fma_f32 v196,-4.0,v194,v198
M a[20:23],a[224:227],a[212:215],a[20:23]
s_waitcnt lgkmcnt(1)
v_sub_f32 v198,v198,v194
v_add_f32 v194,v235,v196
M a[24:27],a[224:227],a[216:219],a[24:27]
s_waitcnt lgkmcnt(0)
v_sub_f32 v235,v235,v196
v_fma_f32 v196,2.0,v198,v200
M a[28:31],a[224:227],a[220:223],a[28:31]
s_waitcnt vmcnt(16)
buffer_load_dwordx4 a[224:227],v251,s[20:23],s46 offen offset:1024
M a[32:35],a[228:231],a[192:195],a[32:35]
v_fmac_f32 v200,-2.0,v198
v_cvt_pk_bf16_f32 v192,v232,v192
M a[36:39],a[228:231],a[196:199],a[36:39]
v_cvt_pk_bf16_f32 v202,v237,v202
v_cvt_pk_bf16_f32 v194,v233,v194
M a[40:43],a[228:231],a[200:203],a[40:43]
v_cvt_pk_bf16_f32 v198,v234,v196
v_cvt_pk_bf16_f32 v196,v238,v235
M a[44:47],a[228:231],a[204:207],a[44:47]
v_cvt_pk_bf16_f32 v200,v236,v200
v_lshlrev_b32 v234,16,v197
M a[48:51],a[228:231],a[208:211],a[48:51]
v_lshlrev_b32 v232,16,v193
v_lshlrev_b32 v233,16,v195
M a[52:55],a[228:231],a[212:215],a[52:55]
v_lshlrev_b32 v237,16,v203
v_lshlrev_b32 v236,16,v201
M a[56:59],a[228:231],a[216:219],a[56:59]
v_lshlrev_b32 v235,16,v199
v_fmac_f32 v232,s43,v234
M a[60:63],a[228:231],a[220:223],a[60:63]
s_waitcnt vmcnt(16)
buffer_load_dwordx4 a[228:231],v251,s[20:23],s47 offen offset:1024
M a[64:67],a[232:235],a[192:195],a[64:67]
ds_read_b128 a[192:195],v250 offset:2048
v_fmac_f32 v237,4.0,v233
M a[68:71],a[232:235],a[196:199],a[68:71]
v_fma_f32 v238,-4.0,v234,v236
v_fmac_f32 v232,s45,v236
M a[72:75],a[232:235],a[200:203],a[72:75]
v_fmac_f32 v237,s40,v235
v_sub_f32 v236,v236,v234
M a[76:79],a[232:235],a[204:207],a[76:79]
v_fma_f32 v234,-4.0,v233,v235
v_sub_f32 v235,v235,v233
M a[80:83],a[232:235],a[208:211],a[80:83]
v_add_f32 v233,v238,v234
v_sub_f32 v238,v238,v234
M a[84:87],a[232:235],a[212:215],a[84:87]
v_fma_f32 v234,2.0,v235,v236
v_fmac_f32 v236,-2.0,v235
M a[88:91],a[232:235],a[216:219],a[88:91]
v_and_b32 v197,s42,v197
v_and_b32 v193,s42,v193
M a[92:95],a[232:235],a[220:223],a[92:95]
s_waitcnt vmcnt(16)
buffer_load_dwordx4 a[232:235],v251,s[20:23],s48 offen offset:1024
M a[0:3],a[236:239],a[196:199],a[0:3]
v_and_b32 v195,s42,v195
v_and_b32 v203,s42,v203
M a[4:7],a[236:239],a[200:203],a[4:7]
v_and_b32 v201,s42,v201
v_and_b32 v199,s42,v199
M a[8:11],a[236:239],a[204:207],a[8:11]
v_fmac_f32 v193,s43,v197
v_fmac_f32 v203,4.0,v195
M a[12:15],a[236:239],a[208:211],a[12:15]
v_fma_f32 v235,-4.0,v197,v201
v_fmac_f32 v193,s45,v201
M a[16:19],a[236:239],a[212:215],a[16:19]
v_fmac_f32 v203,s40,v199
v_sub_f32 v201,v201,v197
M a[20:23],a[236:239],a[216:219],a[20:23]
v_fma_f32 v197,-4.0,v195,v199
v_sub_f32 v199,v199,v195
M a[24:27],a[236:239],a[220:223],a[24:27]
s_waitcnt lgkmcnt(0)
v_add_f32 v195,v235,v197
v_sub_f32 v235,v235,v197
M a[28:31],a[236:239],a[192:195],a[28:31]
s_waitcnt vmcnt(16)
buffer_load_dwordx4 a[236:239],v251,s[20:23],s46 offen offset:2048
M a[32:35],a[240:243],a[196:199],a[32:35]
v_fma_f32 v197,2.0,v199,v201
v_fmac_f32 v201,-2.0,v199
M a[36:39],a[240:243],a[200:203],a[36:39]
v_cvt_pk_bf16_f32 v193,v232,v193
v_cvt_pk_bf16_f32 v203,v237,v203
M a[40:43],a[240:243],a[204:207],a[40:43]
v_cvt_pk_bf16_f32 v195,v233,v195
v_cvt_pk_bf16_f32 v199,v234,v197
M a[44:47],a[240:243],a[208:211],a[44:47]
v_cvt_pk_bf16_f32 v197,v238,v235
v_cvt_pk_bf16_f32 v201,v236,v201
M a[48:51],a[240:243],a[212:215],a[48:51]
ds_write2st64_b64 v247,v[192:193],v[202:203] offset0:238 offset1:255
M a[52:55],a[240:243],a[216:219],a[52:55]
s_add_u32 s28,s67,7077888
buffer_load_dwordx2 v[192:193],v245,s[12:15],s28 offen offset:0
M a[56:59],a[240:243],a[220:223],a[56:59]
buffer_load_dwordx2 v[202:203],v245,s[16:19],s28 offen offset:1536
M a[60:63],a[240:243],a[192:195],a[60:63]
s_waitcnt vmcnt(18)
buffer_load_dwordx4 a[240:243],v251,s[20:23],s47 offen offset:2048
M a[64:67],a[244:247],a[196:199],a[64:67]
ds_read_b128 a[196:199],v249 offset:2304
ds_write2st64_b64 v247,v[194:195],v[196:197] offset0:0 offset1:17
M a[68:71],a[244:247],a[200:203],a[68:71]
buffer_load_dwordx2 v[194:195],v245,s[8:11],s28 offen offset:0
M a[72:75],a[244:247],a[204:207],a[72:75]
buffer_load_dwordx2 v[196:197],v245,s[8:11],s28 offen offset:384
M a[76:79],a[244:247],a[208:211],a[76:79]
ds_write2st64_b64 v247,v[198:199],v[200:201] offset0:136 offset1:153
M a[80:83],a[244:247],a[212:215],a[80:83]
buffer_load_dwordx2 v[198:199],v245,s[8:11],s28 offen offset:768
M a[84:87],a[244:247],a[216:219],a[84:87]
buffer_load_dwordx2 v[200:201],v245,s[8:11],s28 offen offset:1152
M a[88:91],a[244:247],a[220:223],a[88:91]
s_waitcnt vmcnt(16)
v_lshlrev_b32 v234,16,v208
v_lshlrev_b32 v232,16,v204
M a[92:95],a[244:247],a[192:195],a[92:95]
buffer_load_dwordx4 a[244:247],v251,s[20:23],s48 offen offset:2048
M a[0:3],a[248:251],a[200:203],a[0:3]
v_lshlrev_b32 v233,16,v206
v_lshlrev_b32 v237,16,v214
M a[4:7],a[248:251],a[204:207],a[4:7]
s_waitcnt vmcnt(15)
s_add_u32 s46,s78,27648
v_lshlrev_b32 v236,16,v212
v_lshlrev_b32 v235,16,v210
M a[8:11],a[248:251],a[208:211],a[8:11]
v_fmac_f32 v232,s43,v234
v_fmac_f32 v237,4.0,v233
M a[12:15],a[248:251],a[212:215],a[12:15]
v_fma_f32 v238,-4.0,v234,v236
v_fmac_f32 v232,s45,v236
M a[16:19],a[248:251],a[216:219],a[16:19]
v_fmac_f32 v237,s40,v235
v_sub_f32 v236,v236,v234
M a[20:23],a[248:251],a[220:223],a[20:23]
v_fma_f32 v234,-4.0,v233,v235
v_sub_f32 v235,v235,v233
M a[24:27],a[248:251],a[192:195],a[24:27]
s_waitcnt lgkmcnt(2)
v_add_f32 v233,v238,v234
v_sub_f32 v238,v238,v234
M a[28:31],a[248:251],a[196:199],a[28:31]
buffer_load_dwordx4 a[248:251],v251,s[20:23],s46 offen offset:0
M a[32:35],a[252:255],a[200:203],a[32:35]
v_fma_f32 v234,2.0,v235,v236
v_fmac_f32 v236,-2.0,v235
M a[36:39],a[252:255],a[204:207],a[36:39]
s_add_u32 s47,s78,30720
v_and_b32 v208,s42,v208
v_and_b32 v204,s42,v204
M a[40:43],a[252:255],a[208:211],a[40:43]
v_and_b32 v206,s42,v206
v_and_b32 v214,s42,v214
M a[44:47],a[252:255],a[212:215],a[44:47]
v_and_b32 v212,s42,v212
v_and_b32 v210,s42,v210
M a[48:51],a[252:255],a[216:219],a[48:51]
v_fmac_f32 v204,s43,v208
v_fmac_f32 v214,4.0,v206
M a[52:55],a[252:255],a[220:223],a[52:55]
v_fma_f32 v235,-4.0,v208,v212
v_fmac_f32 v204,s45,v212
M a[56:59],a[252:255],a[192:195],a[56:59]
v_fmac_f32 v214,s40,v210
v_sub_f32 v212,v212,v208
M a[60:63],a[252:255],a[196:199],a[60:63]
buffer_load_dwordx4 a[252:255],v251,s[20:23],s47 offen offset:0
M a[64:67],v[216:219],a[200:203],a[64:67]
ds_read_b128 a[200:203],v249 offset:8704
v_fma_f32 v208,-4.0,v206,v210
M a[68:71],v[216:219],a[204:207],a[68:71]
s_add_u32 s48,s78,33792
ds_read_b128 a[204:207],v250 offset:8960
v_sub_f32 v210,v210,v206
M a[72:75],v[216:219],a[208:211],a[72:75]
ds_read_b128 a[208:211],v250 offset:9216
v_add_f32 v206,v235,v208
M a[76:79],v[216:219],a[212:215],a[76:79]
ds_read_b128 a[212:215],v250 offset:9472
v_sub_f32 v235,v235,v208
M a[80:83],v[216:219],a[216:219],a[80:83]
ds_read_b128 a[216:219],v250 offset:9728
v_fma_f32 v208,2.0,v210,v212
M a[84:87],v[216:219],a[220:223],a[84:87]
ds_read_b128 a[220:223],v250 offset:9984
v_fmac_f32 v212,-2.0,v210
M a[88:91],v[216:219],a[192:195],a[88:91]
ds_read_b128 a[192:195],v250 offset:10240
v_cvt_pk_bf16_f32 v204,v232,v204
M a[92:95],v[216:219],a[196:199],a[92:95]
s_waitcnt vmcnt(16) lgkmcnt(6)
buffer_load_dwordx4 v[216:219],v251,s[20:23],s48 offen offset:0
M a[96:99],v[220:223],a[200:203],a[96:99]
s_waitcnt lgkmcnt(5)
ds_read_b128 a[196:199],v250 offset:10496
v_cvt_pk_bf16_f32 v214,v237,v214
M a[100:103],v[220:223],a[204:207],a[100:103]
s_waitcnt lgkmcnt(5)
v_cvt_pk_bf16_f32 v206,v233,v206
v_cvt_pk_bf16_f32 v210,v234,v208
M a[104:107],v[220:223],a[208:211],a[104:107]
s_waitcnt lgkmcnt(4)
v_cvt_pk_bf16_f32 v208,v238,v235
v_cvt_pk_bf16_f32 v212,v236,v212
M a[108:111],v[220:223],a[212:215],a[108:111]
s_waitcnt lgkmcnt(3)
v_lshlrev_b32 v234,16,v209
v_lshlrev_b32 v232,16,v205
M a[112:115],v[220:223],a[216:219],a[112:115]
s_waitcnt lgkmcnt(2)
v_lshlrev_b32 v233,16,v207
v_lshlrev_b32 v237,16,v215
M a[116:119],v[220:223],a[220:223],a[116:119]
s_waitcnt lgkmcnt(1)
v_lshlrev_b32 v236,16,v213
v_lshlrev_b32 v235,16,v211
M a[120:123],v[220:223],a[192:195],a[120:123]
s_waitcnt lgkmcnt(0)
v_fmac_f32 v232,s43,v234
v_fmac_f32 v237,4.0,v233
M a[124:127],v[220:223],a[196:199],a[124:127]
s_waitcnt vmcnt(16)
buffer_load_dwordx4 v[220:223],v251,s[20:23],s46 offen offset:1024
M a[128:131],v[224:227],a[200:203],a[128:131]
v_fma_f32 v238,-4.0,v234,v236
v_fmac_f32 v232,s45,v236
M a[132:135],v[224:227],a[204:207],a[132:135]
v_fmac_f32 v237,s40,v235
v_sub_f32 v236,v236,v234
M a[136:139],v[224:227],a[208:211],a[136:139]
v_fma_f32 v234,-4.0,v233,v235
v_sub_f32 v235,v235,v233
M a[140:143],v[224:227],a[212:215],a[140:143]
v_add_f32 v233,v238,v234
v_sub_f32 v238,v238,v234
M a[144:147],v[224:227],a[216:219],a[144:147]
v_fma_f32 v234,2.0,v235,v236
v_fmac_f32 v236,-2.0,v235
M a[148:151],v[224:227],a[220:223],a[148:151]
v_and_b32 v209,s42,v209
v_and_b32 v205,s42,v205
M a[152:155],v[224:227],a[192:195],a[152:155]
v_and_b32 v207,s42,v207
v_and_b32 v215,s42,v215
M a[156:159],v[224:227],a[196:199],a[156:159]
s_waitcnt vmcnt(16)
buffer_load_dwordx4 v[224:227],v251,s[20:23],s47 offen offset:1024
M a[160:163],v[228:231],a[200:203],a[160:163]
ds_read_b128 a[200:203],v250 offset:10752
v_and_b32 v213,s42,v213
M a[164:167],v[228:231],a[204:207],a[164:167]
v_and_b32 v211,s42,v211
v_fmac_f32 v205,s43,v209
M a[168:171],v[228:231],a[208:211],a[168:171]
v_fmac_f32 v215,4.0,v207
v_fma_f32 v235,-4.0,v209,v213
M a[172:175],v[228:231],a[212:215],a[172:175]
v_fmac_f32 v205,s45,v213
v_fmac_f32 v215,s40,v211
M a[176:179],v[228:231],a[216:219],a[176:179]
v_sub_f32 v213,v213,v209
v_fma_f32 v209,-4.0,v207,v211
M a[180:183],v[228:231],a[220:223],a[180:183]
v_sub_f32 v211,v211,v207
v_add_f32 v207,v235,v209
M a[184:187],v[228:231],a[192:195],a[184:187]
v_sub_f32 v235,v235,v209
v_fma_f32 v209,2.0,v211,v213
M a[188:191],v[228:231],a[196:199],a[188:191]
s_waitcnt vmcnt(16)
buffer_load_dwordx4 v[228:231],v251,s[20:23],s48 offen offset:1024
M a[96:99],a[224:227],a[204:207],a[96:99]
v_fmac_f32 v213,-2.0,v211
v_cvt_pk_bf16_f32 v205,v232,v205
M a[100:103],a[224:227],a[208:211],a[100:103]
v_cvt_pk_bf16_f32 v215,v237,v215
v_cvt_pk_bf16_f32 v207,v233,v207
M a[104:107],a[224:227],a[212:215],a[104:107]
v_cvt_pk_bf16_f32 v211,v234,v209
v_cvt_pk_bf16_f32 v209,v238,v235
M a[108:111],a[224:227],a[216:219],a[108:111]
v_cvt_pk_bf16_f32 v213,v236,v213
v_add_u32 v232,121856,v247
M a[112:115],a[224:227],a[220:223],a[112:115]
ds_write2st64_b64 v232,v[204:205],v[214:215] offset0:1 offset1:18
M a[116:119],a[224:227],a[192:195],a[116:119]
s_add_u32 s28,s67,7471104
buffer_load_dwordx2 v[204:205],v245,s[12:15],s28 offen offset:0
M a[120:123],a[224:227],a[196:199],a[120:123]
s_waitcnt lgkmcnt(1)
buffer_load_dwordx2 v[214:215],v245,s[16:19],s28 offen offset:1536
M a[124:127],a[224:227],a[200:203],a[124:127]
s_waitcnt vmcnt(18)
buffer_load_dwordx4 a[224:227],v251,s[20:23],s46 offen offset:2048
M a[128:131],a[228:231],a[204:207],a[128:131]
ds_write2st64_b64 v247,v[206:207],v[208:209] offset0:1 offset1:18
M a[132:135],a[228:231],a[208:211],a[132:135]
buffer_load_dwordx2 v[206:207],v245,s[8:11],s28 offen offset:0
M a[136:139],a[228:231],a[212:215],a[136:139]
buffer_load_dwordx2 v[208:209],v245,s[8:11],s28 offen offset:384
M a[140:143],a[228:231],a[216:219],a[140:143]
ds_write2st64_b64 v247,v[210:211],v[212:213] offset0:137 offset1:154
M a[144:147],a[228:231],a[220:223],a[144:147]
buffer_load_dwordx2 v[210:211],v245,s[8:11],s28 offen offset:768
M a[148:151],a[228:231],a[192:195],a[148:151]
buffer_load_dwordx2 v[212:213],v245,s[8:11],s28 offen offset:1152
M a[152:155],a[228:231],a[196:199],a[152:155]
v_fmac_f32 v239,s43,v241
v_fmac_f32 v244,4.0,v240
M a[156:159],a[228:231],a[200:203],a[156:159]
s_waitcnt vmcnt(22)
buffer_load_dwordx4 a[228:231],v251,s[20:23],s47 offen offset:2048
M a[160:163],a[232:235],a[204:207],a[160:163]
ds_read_b128 a[204:207],v249 offset:11008
v_fma_f32 v232,-4.0,v241,v243
M a[164:167],a[232:235],a[208:211],a[164:167]
v_fmac_f32 v239,s45,v243
v_fmac_f32 v244,s40,v242
M a[168:171],a[232:235],a[212:215],a[168:171]
v_sub_f32 v243,v243,v241
v_fma_f32 v241,-4.0,v240,v242
M a[172:175],a[232:235],a[216:219],a[172:175]
v_sub_f32 v242,v242,v240
v_add_f32 v240,v232,v241
M a[176:179],a[232:235],a[220:223],a[176:179]
v_sub_f32 v232,v232,v241
v_fma_f32 v241,2.0,v242,v243
M a[180:183],a[232:235],a[192:195],a[180:183]
v_fmac_f32 v243,-2.0,v242
v_cvt_pk_bf16_f32 v233,v239,v244
M a[184:187],a[232:235],a[196:199],a[184:187]
v_cvt_pk_bf16_f32 v234,v240,v232
v_cvt_pk_bf16_f32 v235,v241,v243
M a[188:191],a[232:235],a[200:203],a[188:191]
s_waitcnt vmcnt(22)
buffer_load_short_d16_hi v239,v246,s[12:15],s74 offen offset:0
M a[96:99],a[236:239],a[208:211],a[96:99]
buffer_load_short_d16_hi v240,v246,s[8:11],s74 offen offset:0
M a[100:103],a[236:239],a[212:215],a[100:103]
buffer_load_short_d16_hi v241,v246,s[8:11],s74 offen offset:384
M a[104:107],a[236:239],a[216:219],a[104:107]
buffer_load_short_d16_hi v242,v246,s[8:11],s74 offen offset:768
M a[108:111],a[236:239],a[220:223],a[108:111]
buffer_load_short_d16_hi v243,v246,s[8:11],s74 offen offset:1152
M a[112:115],a[236:239],a[192:195],a[112:115]
buffer_load_short_d16_hi v244,v246,s[16:19],s74 offen offset:1536
M a[116:119],a[236:239],a[196:199],a[116:119]
buffer_load_dwordx4 a[232:235],v251,s[20:23],s48 offen offset:2048
M a[120:123],a[236:239],a[200:203],a[120:123]
s_waitcnt lgkmcnt(0)
s_add_u32 s46,s78,36864
v_add_u32 v232,121856,v248
M a[124:127],a[236:239],a[204:207],a[124:127]
s_waitcnt vmcnt(26)
buffer_load_dwordx4 a[236:239],v251,s[20:23],s46 offen offset:0
M a[128:131],a[240:243],a[208:211],a[128:131]
ds_write_b16 v232,v233 offset:0
M a[132:135],a[240:243],a[212:215],a[132:135]
s_add_u32 s47,s78,39936
ds_write_b16_d16_hi v232,v233 offset:8704
M a[136:139],a[240:243],a[216:219],a[136:139]
ds_write_b16 v248,v234 offset:0
M a[140:143],a[240:243],a[220:223],a[140:143]
ds_write_b16_d16_hi v248,v234 offset:8704
M a[144:147],a[240:243],a[192:195],a[144:147]
v_add_u32 v232,69632,v248
M a[148:151],a[240:243],a[196:199],a[148:151]
ds_write_b16 v232,v235 offset:0
M a[152:155],a[240:243],a[200:203],a[152:155]
ds_write_b16_d16_hi v232,v235 offset:8704
M a[156:159],a[240:243],a[204:207],a[156:159]
s_waitcnt vmcnt(22)
buffer_load_dwordx4 a[240:243],v251,s[20:23],s47 offen offset:0
M a[160:163],a[244:247],a[208:211],a[160:163]
ds_read_b128 a[208:211],v249 offset:17408
v_lshlrev_b32 v234,16,v196
M a[164:167],a[244:247],a[212:215],a[164:167]
s_add_u32 s48,s78,43008
ds_read_b128 a[212:215],v250 offset:17664
v_lshlrev_b32 v232,16,v192
M a[168:171],a[244:247],a[216:219],a[168:171]
ds_read_b128 a[216:219],v250 offset:17920
v_lshlrev_b32 v233,16,v194
M a[172:175],a[244:247],a[220:223],a[172:175]
ds_read_b128 a[220:223],v250 offset:18176
v_lshlrev_b32 v237,16,v202
M a[176:179],a[244:247],a[192:195],a[176:179]
ds_read_b128 a[192:195],v250 offset:18432
v_lshlrev_b32 v236,16,v200
M a[180:183],a[244:247],a[196:199],a[180:183]
ds_read_b128 a[196:199],v250 offset:18688
v_lshlrev_b32 v235,16,v198
M a[184:187],a[244:247],a[200:203],a[184:187]
ds_read_b128 a[200:203],v250 offset:18944
v_fmac_f32 v232,s43,v234
M a[188:191],a[244:247],a[204:207],a[188:191]
s_waitcnt vmcnt(22) lgkmcnt(6)
buffer_load_dwordx4 a[244:247],v251,s[20:23],s48 offen offset:0
M v[0:3],a[248:251],a[208:211],v[0:3]
s_waitcnt lgkmcnt(5)
ds_read_b128 a[204:207],v250 offset:19200
v_fmac_f32 v237,4.0,v233
M v[4:7],a[248:251],a[212:215],v[4:7]
s_waitcnt lgkmcnt(5)
v_fma_f32 v238,-4.0,v234,v236
v_fmac_f32 v232,s45,v236
M v[8:11],a[248:251],a[216:219],v[8:11]
s_waitcnt lgkmcnt(4)
v_fmac_f32 v237,s40,v235
v_sub_f32 v236,v236,v234
M v[12:15],a[248:251],a[220:223],v[12:15]
s_waitcnt lgkmcnt(3)
v_fma_f32 v234,-4.0,v233,v235
v_sub_f32 v235,v235,v233
M v[16:19],a[248:251],a[192:195],v[16:19]
s_waitcnt lgkmcnt(2)
v_add_f32 v233,v238,v234
v_sub_f32 v238,v238,v234
M v[20:23],a[248:251],a[196:199],v[20:23]
s_waitcnt lgkmcnt(1)
v_fma_f32 v234,2.0,v235,v236
v_fmac_f32 v236,-2.0,v235
M v[24:27],a[248:251],a[200:203],v[24:27]
s_waitcnt lgkmcnt(0)
v_and_b32 v196,s42,v196
v_and_b32 v192,s42,v192
M v[28:31],a[248:251],a[204:207],v[28:31]
s_waitcnt vmcnt(22)
buffer_load_dwordx4 a[248:251],v251,s[20:23],s46 offen offset:1024
M v[32:35],a[252:255],a[208:211],v[32:35]
v_and_b32 v194,s42,v194
v_and_b32 v202,s42,v202
M v[36:39],a[252:255],a[212:215],v[36:39]
v_and_b32 v200,s42,v200
v_and_b32 v198,s42,v198
M v[40:43],a[252:255],a[216:219],v[40:43]
v_fmac_f32 v192,s43,v196
v_fmac_f32 v202,4.0,v194
M v[44:47],a[252:255],a[220:223],v[44:47]
v_fma_f32 v235,-4.0,v196,v200
v_fmac_f32 v192,s45,v200
M v[48:51],a[252:255],a[192:195],v[48:51]
v_fmac_f32 v202,s40,v198
v_sub_f32 v200,v200,v196
M v[52:55],a[252:255],a[196:199],v[52:55]
v_fma_f32 v196,-4.0,v194,v198
v_sub_f32 v198,v198,v194
M v[56:59],a[252:255],a[200:203],v[56:59]
v_add_f32 v194,v235,v196
v_sub_f32 v235,v235,v196
M v[60:63],a[252:255],a[204:207],v[60:63]
s_waitcnt vmcnt(22)
buffer_load_dwordx4 a[252:255],v251,s[20:23],s47 offen offset:1024
M v[64:67],v[216:219],a[208:211],v[64:67]
ds_read_b128 a[208:211],v250 offset:19456
v_fma_f32 v196,2.0,v198,v200
M v[68:71],v[216:219],a[212:215],v[68:71]
v_fmac_f32 v200,-2.0,v198
v_cvt_pk_bf16_f32 v192,v232,v192
M v[72:75],v[216:219],a[216:219],v[72:75]
v_cvt_pk_bf16_f32 v202,v237,v202
v_cvt_pk_bf16_f32 v194,v233,v194
M v[76:79],v[216:219],a[220:223],v[76:79]
v_cvt_pk_bf16_f32 v198,v234,v196
v_cvt_pk_bf16_f32 v196,v238,v235
M v[80:83],v[216:219],a[192:195],v[80:83]
v_cvt_pk_bf16_f32 v200,v236,v200
v_lshlrev_b32 v234,16,v197
M v[84:87],v[216:219],a[196:199],v[84:87]
v_lshlrev_b32 v232,16,v193
v_lshlrev_b32 v233,16,v195
M v[88:91],v[216:219],a[200:203],v[88:91]
v_lshlrev_b32 v237,16,v203
v_lshlrev_b32 v236,16,v201
M v[92:95],v[216:219],a[204:207],v[92:95]
s_waitcnt vmcnt(22)
buffer_load_dwordx4 v[216:219],v251,s[20:23],s48 offen offset:1024
M v[0:3],v[220:223],a[212:215],v[0:3]
v_lshlrev_b32 v235,16,v199
v_fmac_f32 v232,s43,v234
M v[4:7],v[220:223],a[216:219],v[4:7]
v_fmac_f32 v237,4.0,v233
v_fma_f32 v238,-4.0,v234,v236
M v[8:11],v[220:223],a[220:223],v[8:11]
v_fmac_f32 v232,s45,v236
v_fmac_f32 v237,s40,v235
M v[12:15],v[220:223],a[192:195],v[12:15]
v_sub_f32 v236,v236,v234
v_fma_f32 v234,-4.0,v233,v235
M v[16:19],v[220:223],a[196:199],v[16:19]
v_sub_f32 v235,v235,v233
v_add_f32 v233,v238,v234
M v[20:23],v[220:223],a[200:203],v[20:23]
v_sub_f32 v238,v238,v234
v_fma_f32 v234,2.0,v235,v236
M v[24:27],v[220:223],a[204:207],v[24:27]
s_waitcnt lgkmcnt(0)
v_fmac_f32 v236,-2.0,v235
v_and_b32 v197,s42,v197
M v[28:31],v[220:223],a[208:211],v[28:31]
s_waitcnt vmcnt(22)
buffer_load_dwordx4 v[220:223],v251,s[20:23],s46 offen offset:2048
M v[32:35],v[224:227],a[212:215],v[32:35]
v_and_b32 v193,s42,v193
v_and_b32 v195,s42,v195
M v[36:39],v[224:227],a[216:219],v[36:39]
v_and_b32 v203,s42,v203
v_and_b32 v201,s42,v201
M v[40:43],v[224:227],a[220:223],v[40:43]
v_and_b32 v199,s42,v199
v_fmac_f32 v193,s43,v197
M v[44:47],v[224:227],a[192:195],v[44:47]
v_fmac_f32 v203,4.0,v195
v_fma_f32 v235,-4.0,v197,v201
M v[48:51],v[224:227],a[196:199],v[48:51]
v_fmac_f32 v193,s45,v201
v_fmac_f32 v203,s40,v199
M v[52:55],v[224:227],a[200:203],v[52:55]
v_sub_f32 v201,v201,v197
v_fma_f32 v197,-4.0,v195,v199
M v[56:59],v[224:227],a[204:207],v[56:59]
v_sub_f32 v199,v199,v195
v_add_f32 v195,v235,v197
M v[60:63],v[224:227],a[208:211],v[60:63]
s_waitcnt vmcnt(22)
buffer_load_dwordx4 v[224:227],v251,s[20:23],s47 offen offset:2048
M v[64:67],v[228:231],a[212:215],v[64:67]
ds_read_b128 a[212:215],v249 offset:19712
v_sub_f32 v235,v235,v197
M v[68:71],v[228:231],a[216:219],v[68:71]
v_fma_f32 v197,2.0,v199,v201
v_fmac_f32 v201,-2.0,v199
M v[72:75],v[228:231],a[220:223],v[72:75]
v_cvt_pk_bf16_f32 v193,v232,v193
v_cvt_pk_bf16_f32 v203,v237,v203
M v[76:79],v[228:231],a[192:195],v[76:79]
v_cvt_pk_bf16_f32 v195,v233,v195
v_cvt_pk_bf16_f32 v199,v234,v197
M v[80:83],v[228:231],a[196:199],v[80:83]
v_cvt_pk_bf16_f32 v197,v238,v235
v_cvt_pk_bf16_f32 v201,v236,v201
M v[84:87],v[228:231],a[200:203],v[84:87]
v_add_u32 v232,121856,v247
M v[88:91],v[228:231],a[204:207],v[88:91]
ds_write2st64_b64 v232,v[192:193],v[202:203] offset0:2 offset1:19
M v[92:95],v[228:231],a[208:211],v[92:95]
s_waitcnt vmcnt(20)
s_add_u32 s28,s68,6291456
buffer_load_dwordx2 v[192:193],v245,s[12:15],s28 offen offset:0
M v[0:3],a[224:227],a[216:219],v[0:3]
buffer_load_dwordx2 v[202:203],v245,s[16:19],s28 offen offset:1536
M v[4:7],a[224:227],a[220:223],v[4:7]
buffer_load_dwordx4 v[228:231],v251,s[20:23],s48 offen offset:2048
M v[8:11],a[224:227],a[192:195],v[8:11]
s_add_u32 s46,s79,9216
ds_write2st64_b64 v247,v[194:195],v[196:197] offset0:2 offset1:19
M v[12:15],a[224:227],a[196:199],v[12:15]
buffer_load_dwordx2 v[194:195],v245,s[8:11],s28 offen offset:0
M v[16:19],a[224:227],a[200:203],v[16:19]
buffer_load_dwordx2 v[196:197],v245,s[8:11],s28 offen offset:384
M v[20:23],a[224:227],a[204:207],v[20:23]
ds_write2st64_b64 v247,v[198:199],v[200:201] offset0:138 offset1:155
M v[24:27],a[224:227],a[208:211],v[24:27]
s_waitcnt lgkmcnt(3)
buffer_load_dwordx2 v[198:199],v245,s[8:11],s28 offen offset:768
M v[28:31],a[224:227],a[212:215],v[28:31]
s_waitcnt vmcnt(21)
buffer_load_dwordx2 v[200:201],v245,s[8:11],s28 offen offset:1152
M v[32:35],a[228:231],a[216:219],v[32:35]
buffer_load_dwordx4 a[224:227],v251,s[20:23],s46 offen offset:0
M v[36:39],a[228:231],a[220:223],v[36:39]
s_add_u32 s47,s79,12288
v_lshlrev_b32 v234,16,v208
v_lshlrev_b32 v232,16,v204
M v[40:43],a[228:231],a[192:195],v[40:43]
v_lshlrev_b32 v233,16,v206
v_lshlrev_b32 v237,16,v214
M v[44:47],a[228:231],a[196:199],v[44:47]
v_lshlrev_b32 v236,16,v212
v_lshlrev_b32 v235,16,v210
M v[48:51],a[228:231],a[200:203],v[48:51]
v_fmac_f32 v232,s43,v234
v_fmac_f32 v237,4.0,v233
M v[52:55],a[228:231],a[204:207],v[52:55]
v_fma_f32 v238,-4.0,v234,v236
v_fmac_f32 v232,s45,v236
M v[56:59],a[228:231],a[208:211],v[56:59]
v_fmac_f32 v237,s40,v235
v_sub_f32 v236,v236,v234
M v[60:63],a[228:231],a[212:215],v[60:63]
s_waitcnt vmcnt(16)
buffer_load_dwordx4 a[228:231],v251,s[20:23],s47 offen offset:0
M v[64:67],a[232:235],a[216:219],v[64:67]
ds_read_b128 a[216:219],v249 offset:26112
v_fma_f32 v234,-4.0,v233,v235
M v[68:71],a[232:235],a[220:223],v[68:71]
s_add_u32 s48,s79,15360
ds_read_b128 a[220:223],v250 offset:26368
v_sub_f32 v235,v235,v233
M v[72:75],a[232:235],a[192:195],v[72:75]
ds_read_b128 a[192:195],v250 offset:26624
v_add_f32 v233,v238,v234
M v[76:79],a[232:235],a[196:199],v[76:79]
ds_read_b128 a[196:199],v250 offset:26880
v_sub_f32 v238,v238,v234
M v[80:83],a[232:235],a[200:203],v[80:83]
ds_read_b128 a[200:203],v250 offset:27136
v_fma_f32 v234,2.0,v235,v236
M v[84:87],a[232:235],a[204:207],v[84:87]
ds_read_b128 a[204:207],v250 offset:27392
v_fmac_f32 v236,-2.0,v235
M v[88:91],a[232:235],a[208:211],v[88:91]
ds_read_b128 a[208:211],v250 offset:27648
v_and_b32 v208,s42,v208
M v[92:95],a[232:235],a[212:215],v[92:95]
s_waitcnt vmcnt(16) lgkmcnt(6)
buffer_load_dwordx4 a[232:235],v251,s[20:23],s48 offen offset:0
M v[96:99],a[236:239],a[216:219],v[96:99]
s_waitcnt lgkmcnt(5)
ds_read_b128 a[212:215],v250 offset:27904
v_and_b32 v204,s42,v204
M v[100:103],a[236:239],a[220:223],v[100:103]
s_waitcnt lgkmcnt(5)
v_and_b32 v206,s42,v206
v_and_b32 v214,s42,v214
M v[104:107],a[236:239],a[192:195],v[104:107]
s_waitcnt lgkmcnt(4)
v_and_b32 v212,s42,v212
v_and_b32 v210,s42,v210
M v[108:111],a[236:239],a[196:199],v[108:111]
s_waitcnt lgkmcnt(3)
v_fmac_f32 v204,s43,v208
v_fmac_f32 v214,4.0,v206
M v[112:115],a[236:239],a[200:203],v[112:115]
s_waitcnt lgkmcnt(2)
v_fma_f32 v235,-4.0,v208,v212
v_fmac_f32 v204,s45,v212
M v[116:119],a[236:239],a[204:207],v[116:119]
s_waitcnt lgkmcnt(1)
v_fmac_f32 v214,s40,v210
v_sub_f32 v212,v212,v208
M v[120:123],a[236:239],a[208:211],v[120:123]
s_waitcnt lgkmcnt(0)
v_fma_f32 v208,-4.0,v206,v210
v_sub_f32 v210,v210,v206
M v[124:127],a[236:239],a[212:215],v[124:127]
s_waitcnt vmcnt(16)
buffer_load_dwordx4 a[236:239],v251,s[20:23],s46 offen offset:1024
M v[128:131],a[240:243],a[216:219],v[128:131]
v_add_f32 v206,v235,v208
v_sub_f32 v235,v235,v208
M v[132:135],a[240:243],a[220:223],v[132:135]
v_fma_f32 v208,2.0,v210,v212
v_fmac_f32 v212,-2.0,v210
M v[136:139],a[240:243],a[192:195],v[136:139]
v_cvt_pk_bf16_f32 v204,v232,v204
v_cvt_pk_bf16_f32 v214,v237,v214
M v[140:143],a[240:243],a[196:199],v[140:143]
v_cvt_pk_bf16_f32 v206,v233,v206
v_cvt_pk_bf16_f32 v210,v234,v208
M v[144:147],a[240:243],a[200:203],v[144:147]
v_cvt_pk_bf16_f32 v208,v238,v235
v_cvt_pk_bf16_f32 v212,v236,v212
M v[148:151],a[240:243],a[204:207],v[148:151]
v_lshlrev_b32 v234,16,v209
v_lshlrev_b32 v232,16,v205
M v[152:155],a[240:243],a[208:211],v[152:155]
v_lshlrev_b32 v233,16,v207
v_lshlrev_b32 v237,16,v215
M v[156:159],a[240:243],a[212:215],v[156:159]
s_waitcnt vmcnt(16)
buffer_load_dwordx4 a[240:243],v251,s[20:23],s47 offen offset:1024
M v[160:163],a[244:247],a[216:219],v[160:163]
ds_read_b128 a[216:219],v250 offset:28160
v_lshlrev_b32 v236,16,v213
M v[164:167],a[244:247],a[220:223],v[164:167]
v_lshlrev_b32 v235,16,v211
v_fmac_f32 v232,s43,v234
M v[168:171],a[244:247],a[192:195],v[168:171]
v_fmac_f32 v237,4.0,v233
v_fma_f32 v238,-4.0,v234,v236
M v[172:175],a[244:247],a[196:199],v[172:175]
v_fmac_f32 v232,s45,v236
v_fmac_f32 v237,s40,v235
M v[176:179],a[244:247],a[200:203],v[176:179]
v_sub_f32 v236,v236,v234
v_fma_f32 v234,-4.0,v233,v235
M v[180:183],a[244:247],a[204:207],v[180:183]
v_sub_f32 v235,v235,v233
v_add_f32 v233,v238,v234
M v[184:187],a[244:247],a[208:211],v[184:187]
v_sub_f32 v238,v238,v234
v_fma_f32 v234,2.0,v235,v236
M v[188:191],a[244:247],a[212:215],v[188:191]
s_waitcnt vmcnt(16)
buffer_load_dwordx4 a[244:247],v251,s[20:23],s48 offen offset:1024
M v[96:99],a[248:251],a[220:223],v[96:99]
v_fmac_f32 v236,-2.0,v235
v_and_b32 v209,s42,v209
M v[100:103],a[248:251],a[192:195],v[100:103]
v_and_b32 v205,s42,v205
v_and_b32 v207,s42,v207
M v[104:107],a[248:251],a[196:199],v[104:107]
v_and_b32 v215,s42,v215
v_and_b32 v213,s42,v213
M v[108:111],a[248:251],a[200:203],v[108:111]
v_and_b32 v211,s42,v211
v_fmac_f32 v205,s43,v209
M v[112:115],a[248:251],a[204:207],v[112:115]
v_fmac_f32 v215,4.0,v207
v_fma_f32 v235,-4.0,v209,v213
M v[116:119],a[248:251],a[208:211],v[116:119]
v_fmac_f32 v205,s45,v213
v_fmac_f32 v215,s40,v211
M v[120:123],a[248:251],a[212:215],v[120:123]
s_waitcnt lgkmcnt(0)
v_sub_f32 v213,v213,v209
v_fma_f32 v209,-4.0,v207,v211
M v[124:127],a[248:251],a[216:219],v[124:127]
s_waitcnt vmcnt(16)
buffer_load_dwordx4 a[248:251],v251,s[20:23],s46 offen offset:2048
M v[128:131],a[252:255],a[220:223],v[128:131]
v_sub_f32 v211,v211,v207
v_add_f32 v207,v235,v209
M v[132:135],a[252:255],a[192:195],v[132:135]
v_sub_f32 v235,v235,v209
v_fma_f32 v209,2.0,v211,v213
M v[136:139],a[252:255],a[196:199],v[136:139]
v_fmac_f32 v213,-2.0,v211
v_cvt_pk_bf16_f32 v205,v232,v205
M v[140:143],a[252:255],a[200:203],v[140:143]
v_cvt_pk_bf16_f32 v215,v237,v215
v_cvt_pk_bf16_f32 v207,v233,v207
M v[144:147],a[252:255],a[204:207],v[144:147]
v_cvt_pk_bf16_f32 v211,v234,v209
v_cvt_pk_bf16_f32 v209,v238,v235
M v[148:151],a[252:255],a[208:211],v[148:151]
v_cvt_pk_bf16_f32 v213,v236,v213
v_add_u32 v232,121856,v247
M v[152:155],a[252:255],a[212:215],v[152:155]
ds_write2st64_b64 v232,v[204:205],v[214:215] offset0:3 offset1:20
M v[156:159],a[252:255],a[216:219],v[156:159]
s_waitcnt vmcnt(16)
s_add_u32 s28,s68,6684672
buffer_load_dwordx2 v[204:205],v245,s[12:15],s28 offen offset:0
M v[160:163],v[216:219],a[220:223],v[160:163]
buffer_load_dwordx2 v[214:215],v245,s[16:19],s28 offen offset:1536
M v[164:167],v[216:219],a[192:195],v[164:167]
buffer_load_dwordx4 a[252:255],v251,s[20:23],s47 offen offset:2048
M v[168:171],v[216:219],a[196:199],v[168:171]
ds_read_b128 a[220:223],v249 offset:28416
ds_write2st64_b64 v247,v[206:207],v[208:209] offset0:3 offset1:20
M v[172:175],v[216:219],a[200:203],v[172:175]
buffer_load_dwordx2 v[206:207],v245,s[8:11],s28 offen offset:0
M v[176:179],v[216:219],a[204:207],v[176:179]
buffer_load_dwordx2 v[208:209],v245,s[8:11],s28 offen offset:384
M v[180:183],v[216:219],a[208:211],v[180:183]
ds_write2st64_b64 v247,v[210:211],v[212:213] offset0:139 offset1:156
M v[184:187],v[216:219],a[212:215],v[184:187]
buffer_load_dwordx2 v[210:211],v245,s[8:11],s28 offen offset:768
M v[188:191],v[216:219],a[216:219],v[188:191]
s_waitcnt vmcnt(21)
buffer_load_dwordx2 v[212:213],v245,s[8:11],s28 offen offset:1152
M v[96:99],v[220:223],a[192:195],v[96:99]
buffer_load_dwordx4 v[216:219],v251,s[20:23],s48 offen offset:2048
M v[100:103],v[220:223],a[196:199],v[100:103]
s_waitcnt vmcnt(17)
s_add_u32 s46,s79,18432
v_lshlrev_b32 v234,16,v196
v_lshlrev_b32 v232,16,v192
M v[104:107],v[220:223],a[200:203],v[104:107]
v_lshlrev_b32 v233,16,v194
v_lshlrev_b32 v237,16,v202
M v[108:111],v[220:223],a[204:207],v[108:111]
s_waitcnt vmcnt(15)
v_lshlrev_b32 v236,16,v200
v_lshlrev_b32 v235,16,v198
M v[112:115],v[220:223],a[208:211],v[112:115]
v_fmac_f32 v232,s43,v234
v_fmac_f32 v237,4.0,v233
M v[116:119],v[220:223],a[212:215],v[116:119]
v_fma_f32 v238,-4.0,v234,v236
v_fmac_f32 v232,s45,v236
M v[120:123],v[220:223],a[216:219],v[120:123]
s_waitcnt lgkmcnt(2)
v_fmac_f32 v237,s40,v235
v_sub_f32 v236,v236,v234
M v[124:127],v[220:223],a[220:223],v[124:127]
buffer_load_dwordx4 v[220:223],v251,s[20:23],s46 offen offset:0
M v[128:131],v[224:227],a[192:195],v[128:131]
v_fma_f32 v234,-4.0,v233,v235
v_sub_f32 v235,v235,v233
M v[132:135],v[224:227],a[196:199],v[132:135]
s_add_u32 s47,s79,21504
v_add_f32 v233,v238,v234
v_sub_f32 v238,v238,v234
M v[136:139],v[224:227],a[200:203],v[136:139]
v_fma_f32 v234,2.0,v235,v236
v_fmac_f32 v236,-2.0,v235
M v[140:143],v[224:227],a[204:207],v[140:143]
v_and_b32 v196,s42,v196
v_and_b32 v192,s42,v192
M v[144:147],v[224:227],a[208:211],v[144:147]
v_and_b32 v194,s42,v194
v_and_b32 v202,s42,v202
M v[148:151],v[224:227],a[212:215],v[148:151]
v_add_u32 v249,0xffffbc00,v249
v_add_u32 v250,0xffffbc00,v250
M v[152:155],v[224:227],a[216:219],v[152:155]
s_waitcnt lgkmcnt(0)
s_barrier
v_and_b32 v200,s42,v200
M v[156:159],v[224:227],a[220:223],v[156:159]
buffer_load_dwordx4 v[224:227],v251,s[20:23],s47 offen offset:0
M v[160:163],v[228:231],a[192:195],v[160:163]
ds_read_b128 a[192:195],v249 offset:0
v_and_b32 v198,s42,v198
M v[164:167],v[228:231],a[196:199],v[164:167]
s_add_u32 s48,s79,24576
ds_read_b128 a[196:199],v250 offset:256
v_fmac_f32 v192,s43,v196
M v[168:171],v[228:231],a[200:203],v[168:171]
ds_read_b128 a[200:203],v250 offset:512
v_fmac_f32 v202,4.0,v194
M v[172:175],v[228:231],a[204:207],v[172:175]
ds_read_b128 a[204:207],v250 offset:768
v_fma_f32 v235,-4.0,v196,v200
M v[176:179],v[228:231],a[208:211],v[176:179]
ds_read_b128 a[208:211],v250 offset:1024
v_fmac_f32 v192,s45,v200
M v[180:183],v[228:231],a[212:215],v[180:183]
ds_read_b128 a[212:215],v250 offset:1280
v_fmac_f32 v202,s40,v198
M v[184:187],v[228:231],a[216:219],v[184:187]
ds_read_b128 a[216:219],v250 offset:1536
v_sub_f32 v200,v200,v196
M v[188:191],v[228:231],a[220:223],v[188:191]
s_waitcnt vmcnt(16) lgkmcnt(6)
buffer_load_dwordx4 v[228:231],v251,s[20:23],s48 offen offset:0
M a[0:3],a[224:227],a[192:195],a[0:3]
s_waitcnt lgkmcnt(5)
ds_read_b128 a[220:223],v250 offset:1792
v_fma_f32 v196,-4.0,v194,v198
M a[4:7],a[224:227],a[196:199],a[4:7]
s_waitcnt lgkmcnt(5)
v_sub_f32 v198,v198,v194
v_add_f32 v194,v235,v196
M a[8:11],a[224:227],a[200:203],a[8:11]
s_waitcnt lgkmcnt(4)
v_sub_f32 v235,v235,v196
v_fma_f32 v196,2.0,v198,v200
M a[12:15],a[224:227],a[204:207],a[12:15]
s_waitcnt lgkmcnt(3)
v_fmac_f32 v200,-2.0,v198
v_cvt_pk_bf16_f32 v192,v232,v192
M a[16:19],a[224:227],a[208:211],a[16:19]
s_waitcnt lgkmcnt(2)
v_cvt_pk_bf16_f32 v202,v237,v202
v_cvt_pk_bf16_f32 v194,v233,v194
M a[20:23],a[224:227],a[212:215],a[20:23]
s_waitcnt lgkmcnt(1)
v_cvt_pk_bf16_f32 v198,v234,v196
v_cvt_pk_bf16_f32 v196,v238,v235
M a[24:27],a[224:227],a[216:219],a[24:27]
s_waitcnt lgkmcnt(0)
v_cvt_pk_bf16_f32 v200,v236,v200
v_lshlrev_b32 v234,16,v197
M a[28:31],a[224:227],a[220:223],a[28:31]
s_waitcnt vmcnt(16)
buffer_load_dwordx4 a[224:227],v251,s[20:23],s46 offen offset:1024
M a[32:35],a[228:231],a[192:195],a[32:35]
v_lshlrev_b32 v232,16,v193
v_lshlrev_b32 v233,16,v195
M a[36:39],a[228:231],a[196:199],a[36:39]
v_lshlrev_b32 v237,16,v203
v_lshlrev_b32 v236,16,v201
M a[40:43],a[228:231],a[200:203],a[40:43]
v_lshlrev_b32 v235,16,v199
v_fmac_f32 v232,s43,v234
M a[44:47],a[228:231],a[204:207],a[44:47]
v_fmac_f32 v237,4.0,v233
v_fma_f32 v238,-4.0,v234,v236
M a[48:51],a[228:231],a[208:211],a[48:51]
v_fmac_f32 v232,s45,v236
v_fmac_f32 v237,s40,v235
M a[52:55],a[228:231],a[212:215],a[52:55]
v_sub_f32 v236,v236,v234
v_fma_f32 v234,-4.0,v233,v235
M a[56:59],a[228:231],a[216:219],a[56:59]
v_sub_f32 v235,v235,v233
v_add_f32 v233,v238,v234
M a[60:63],a[228:231],a[220:223],a[60:63]
s_waitcnt vmcnt(16)
buffer_load_dwordx4 a[228:231],v251,s[20:23],s47 offen offset:1024
M a[64:67],a[232:235],a[192:195],a[64:67]
ds_read_b128 a[192:195],v250 offset:2048
v_sub_f32 v238,v238,v234
M a[68:71],a[232:235],a[196:199],a[68:71]
v_fma_f32 v234,2.0,v235,v236
v_fmac_f32 v236,-2.0,v235
M a[72:75],a[232:235],a[200:203],a[72:75]
v_and_b32 v197,s42,v197
v_and_b32 v193,s42,v193
M a[76:79],a[232:235],a[204:207],a[76:79]
v_and_b32 v195,s42,v195
v_and_b32 v203,s42,v203
M a[80:83],a[232:235],a[208:211],a[80:83]
v_and_b32 v201,s42,v201
v_and_b32 v199,s42,v199
M a[84:87],a[232:235],a[212:215],a[84:87]
v_fmac_f32 v193,s43,v197
v_fmac_f32 v203,4.0,v195
M a[88:91],a[232:235],a[216:219],a[88:91]
v_fma_f32 v235,-4.0,v197,v201
v_fmac_f32 v193,s45,v201
M a[92:95],a[232:235],a[220:223],a[92:95]
s_waitcnt vmcnt(16)
buffer_load_dwordx4 a[232:235],v251,s[20:23],s48 offen offset:1024
M a[0:3],a[236:239],a[196:199],a[0:3]
v_fmac_f32 v203,s40,v199
v_sub_f32 v201,v201,v197
M a[4:7],a[236:239],a[200:203],a[4:7]
v_fma_f32 v197,-4.0,v195,v199
v_sub_f32 v199,v199,v195
M a[8:11],a[236:239],a[204:207],a[8:11]
v_add_f32 v195,v235,v197
v_sub_f32 v235,v235,v197
M a[12:15],a[236:239],a[208:211],a[12:15]
v_fma_f32 v197,2.0,v199,v201
v_fmac_f32 v201,-2.0,v199
M a[16:19],a[236:239],a[212:215],a[16:19]
v_cvt_pk_bf16_f32 v193,v232,v193
v_cvt_pk_bf16_f32 v203,v237,v203
M a[20:23],a[236:239],a[216:219],a[20:23]
v_cvt_pk_bf16_f32 v195,v233,v195
v_cvt_pk_bf16_f32 v199,v234,v197
M a[24:27],a[236:239],a[220:223],a[24:27]
s_waitcnt lgkmcnt(0)
v_cvt_pk_bf16_f32 v197,v238,v235
v_cvt_pk_bf16_f32 v201,v236,v201
M a[28:31],a[236:239],a[192:195],a[28:31]
s_waitcnt vmcnt(16)
buffer_load_dwordx4 a[236:239],v251,s[20:23],s46 offen offset:2048
M a[32:35],a[240:243],a[196:199],a[32:35]
v_add_u32 v232,139264,v247
M a[36:39],a[240:243],a[200:203],a[36:39]
ds_write2st64_b64 v232,v[192:193],v[202:203] offset0:0 offset1:17
M a[40:43],a[240:243],a[204:207],a[40:43]
s_add_u32 s28,s68,7077888
buffer_load_dwordx2 v[192:193],v245,s[12:15],s28 offen offset:0
M a[44:47],a[240:243],a[208:211],a[44:47]
buffer_load_dwordx2 v[202:203],v245,s[16:19],s28 offen offset:1536
M a[48:51],a[240:243],a[212:215],a[48:51]
ds_write2st64_b64 v247,v[194:195],v[196:197] offset0:34 offset1:51
M a[52:55],a[240:243],a[216:219],a[52:55]
buffer_load_dwordx2 v[194:195],v245,s[8:11],s28 offen offset:0
M a[56:59],a[240:243],a[220:223],a[56:59]
buffer_load_dwordx2 v[196:197],v245,s[8:11],s28 offen offset:384
M a[60:63],a[240:243],a[192:195],a[60:63]
s_waitcnt vmcnt(20)
buffer_load_dwordx4 a[240:243],v251,s[20:23],s47 offen offset:2048
M a[64:67],a[244:247],a[196:199],a[64:67]
ds_read_b128 a[196:199],v249 offset:2304
ds_write2st64_b64 v247,v[198:199],v[200:201] offset0:68 offset1:85
M a[68:71],a[244:247],a[200:203],a[68:71]
buffer_load_dwordx2 v[198:199],v245,s[8:11],s28 offen offset:768
M a[72:75],a[244:247],a[204:207],a[72:75]
buffer_load_dwordx2 v[200:201],v245,s[8:11],s28 offen offset:1152
M a[76:79],a[244:247],a[208:211],a[76:79]
s_waitcnt vmcnt(17)
v_lshlrev_b32 v234,16,v208
v_lshlrev_b32 v232,16,v204
M a[80:83],a[244:247],a[212:215],a[80:83]
v_lshlrev_b32 v233,16,v206
v_lshlrev_b32 v237,16,v214
M a[84:87],a[244:247],a[216:219],a[84:87]
s_waitcnt vmcnt(15)
v_lshlrev_b32 v236,16,v212
v_lshlrev_b32 v235,16,v210
M a[88:91],a[244:247],a[220:223],a[88:91]
v_fmac_f32 v232,s43,v234
v_fmac_f32 v237,4.0,v233
M a[92:95],a[244:247],a[192:195],a[92:95]
buffer_load_dwordx4 a[244:247],v251,s[20:23],s48 offen offset:2048
M a[0:3],a[248:251],a[200:203],a[0:3]
v_fma_f32 v238,-4.0,v234,v236
v_fmac_f32 v232,s45,v236
M a[4:7],a[248:251],a[204:207],a[4:7]
s_add_u32 s46,s79,27648
v_fmac_f32 v237,s40,v235
v_sub_f32 v236,v236,v234
M a[8:11],a[248:251],a[208:211],a[8:11]
v_fma_f32 v234,-4.0,v233,v235
v_sub_f32 v235,v235,v233
M a[12:15],a[248:251],a[212:215],a[12:15]
v_add_f32 v233,v238,v234
v_sub_f32 v238,v238,v234
M a[16:19],a[248:251],a[216:219],a[16:19]
v_fma_f32 v234,2.0,v235,v236
v_fmac_f32 v236,-2.0,v235
M a[20:23],a[248:251],a[220:223],a[20:23]
v_and_b32 v208,s42,v208
v_and_b32 v204,s42,v204
M a[24:27],a[248:251],a[192:195],a[24:27]
s_waitcnt lgkmcnt(1)
v_and_b32 v206,s42,v206
v_and_b32 v214,s42,v214
M a[28:31],a[248:251],a[196:199],a[28:31]
buffer_load_dwordx4 a[248:251],v251,s[20:23],s46 offen offset:0
M a[32:35],a[252:255],a[200:203],a[32:35]
v_and_b32 v212,s42,v212
v_and_b32 v210,s42,v210
M a[36:39],a[252:255],a[204:207],a[36:39]
s_add_u32 s47,s79,30720
v_fmac_f32 v204,s43,v208
v_fmac_f32 v214,4.0,v206
M a[40:43],a[252:255],a[208:211],a[40:43]
v_fma_f32 v235,-4.0,v208,v212
v_fmac_f32 v204,s45,v212
M a[44:47],a[252:255],a[212:215],a[44:47]
v_fmac_f32 v214,s40,v210
v_sub_f32 v212,v212,v208
M a[48:51],a[252:255],a[216:219],a[48:51]
v_fma_f32 v208,-4.0,v206,v210
v_sub_f32 v210,v210,v206
M a[52:55],a[252:255],a[220:223],a[52:55]
v_add_f32 v206,v235,v208
v_sub_f32 v235,v235,v208
M a[56:59],a[252:255],a[192:195],a[56:59]
v_fma_f32 v208,2.0,v210,v212
v_fmac_f32 v212,-2.0,v210
M a[60:63],a[252:255],a[196:199],a[60:63]
s_waitcnt vmcnt(16)
buffer_load_dwordx4 a[252:255],v251,s[20:23],s47 offen offset:0
M a[64:67],v[216:219],a[200:203],a[64:67]
ds_read_b128 a[200:203],v249 offset:8704
v_cvt_pk_bf16_f32 v204,v232,v204
M a[68:71],v[216:219],a[204:207],a[68:71]
s_add_u32 s48,s79,33792
ds_read_b128 a[204:207],v250 offset:8960
v_cvt_pk_bf16_f32 v214,v237,v214
M a[72:75],v[216:219],a[208:211],a[72:75]
ds_read_b128 a[208:211],v250 offset:9216
v_cvt_pk_bf16_f32 v206,v233,v206
M a[76:79],v[216:219],a[212:215],a[76:79]
ds_read_b128 a[212:215],v250 offset:9472
v_cvt_pk_bf16_f32 v210,v234,v208
M a[80:83],v[216:219],a[216:219],a[80:83]
ds_read_b128 a[216:219],v250 offset:9728
v_cvt_pk_bf16_f32 v208,v238,v235
M a[84:87],v[216:219],a[220:223],a[84:87]
ds_read_b128 a[220:223],v250 offset:9984
v_cvt_pk_bf16_f32 v212,v236,v212
M a[88:91],v[216:219],a[192:195],a[88:91]
ds_read_b128 a[192:195],v250 offset:10240
v_lshlrev_b32 v234,16,v209
M a[92:95],v[216:219],a[196:199],a[92:95]
s_waitcnt vmcnt(16) lgkmcnt(6)
buffer_load_dwordx4 v[216:219],v251,s[20:23],s48 offen offset:0
M a[96:99],v[220:223],a[200:203],a[96:99]
s_waitcnt lgkmcnt(5)
ds_read_b128 a[196:199],v250 offset:10496
v_lshlrev_b32 v232,16,v205
M a[100:103],v[220:223],a[204:207],a[100:103]
s_waitcnt lgkmcnt(5)
v_lshlrev_b32 v233,16,v207
v_lshlrev_b32 v237,16,v215
M a[104:107],v[220:223],a[208:211],a[104:107]
s_waitcnt lgkmcnt(4)
v_lshlrev_b32 v236,16,v213
v_lshlrev_b32 v235,16,v211
M a[108:111],v[220:223],a[212:215],a[108:111]
s_waitcnt lgkmcnt(3)
v_fmac_f32 v232,s43,v234
v_fmac_f32 v237,4.0,v233
M a[112:115],v[220:223],a[216:219],a[112:115]
s_waitcnt lgkmcnt(2)
v_fma_f32 v238,-4.0,v234,v236
v_fmac_f32 v232,s45,v236
M a[116:119],v[220:223],a[220:223],a[116:119]
s_waitcnt lgkmcnt(1)
v_fmac_f32 v237,s40,v235
v_sub_f32 v236,v236,v234
M a[120:123],v[220:223],a[192:195],a[120:123]
s_waitcnt lgkmcnt(0)
v_fma_f32 v234,-4.0,v233,v235
v_sub_f32 v235,v235,v233
M a[124:127],v[220:223],a[196:199],a[124:127]
s_waitcnt vmcnt(16)
buffer_load_dwordx4 v[220:223],v251,s[20:23],s46 offen offset:1024
M a[128:131],v[224:227],a[200:203],a[128:131]
v_add_f32 v233,v238,v234
v_sub_f32 v238,v238,v234
M a[132:135],v[224:227],a[204:207],a[132:135]
v_fma_f32 v234,2.0,v235,v236
v_fmac_f32 v236,-2.0,v235
M a[136:139],v[224:227],a[208:211],a[136:139]
v_and_b32 v209,s42,v209
v_and_b32 v205,s42,v205
M a[140:143],v[224:227],a[212:215],a[140:143]
v_and_b32 v207,s42,v207
v_and_b32 v215,s42,v215
M a[144:147],v[224:227],a[216:219],a[144:147]
v_and_b32 v213,s42,v213
v_and_b32 v211,s42,v211
M a[148:151],v[224:227],a[220:223],a[148:151]
v_fmac_f32 v205,s43,v209
v_fmac_f32 v215,4.0,v207
M a[152:155],v[224:227],a[192:195],a[152:155]
v_fma_f32 v235,-4.0,v209,v213
v_fmac_f32 v205,s45,v213
M a[156:159],v[224:227],a[196:199],a[156:159]
s_waitcnt vmcnt(16)
buffer_load_dwordx4 v[224:227],v251,s[20:23],s47 offen offset:1024
M a[160:163],v[228:231],a[200:203],a[160:163]
ds_read_b128 a[200:203],v250 offset:10752
v_fmac_f32 v215,s40,v211
M a[164:167],v[228:231],a[204:207],a[164:167]
v_sub_f32 v213,v213,v209
v_fma_f32 v209,-4.0,v207,v211
M a[168:171],v[228:231],a[208:211],a[168:171]
v_sub_f32 v211,v211,v207
v_add_f32 v207,v235,v209
M a[172:175],v[228:231],a[212:215],a[172:175]
v_sub_f32 v235,v235,v209
v_fma_f32 v209,2.0,v211,v213
M a[176:179],v[228:231],a[216:219],a[176:179]
v_fmac_f32 v213,-2.0,v211
v_cvt_pk_bf16_f32 v205,v232,v205
M a[180:183],v[228:231],a[220:223],a[180:183]
v_cvt_pk_bf16_f32 v215,v237,v215
v_cvt_pk_bf16_f32 v207,v233,v207
M a[184:187],v[228:231],a[192:195],a[184:187]
v_cvt_pk_bf16_f32 v211,v234,v209
v_cvt_pk_bf16_f32 v209,v238,v235
M a[188:191],v[228:231],a[196:199],a[188:191]
s_waitcnt vmcnt(16)
buffer_load_dwordx4 v[228:231],v251,s[20:23],s48 offen offset:1024
M a[96:99],a[224:227],a[204:207],a[96:99]
v_cvt_pk_bf16_f32 v213,v236,v213
v_add_u32 v232,139264,v247
M a[100:103],a[224:227],a[208:211],a[100:103]
ds_write2st64_b64 v232,v[204:205],v[214:215] offset0:1 offset1:18
M a[104:107],a[224:227],a[212:215],a[104:107]
s_add_u32 s28,s68,7471104
buffer_load_dwordx2 v[204:205],v245,s[12:15],s28 offen offset:0
M a[108:111],a[224:227],a[216:219],a[108:111]
buffer_load_dwordx2 v[214:215],v245,s[16:19],s28 offen offset:1536
M a[112:115],a[224:227],a[220:223],a[112:115]
ds_write2st64_b64 v247,v[206:207],v[208:209] offset0:35 offset1:52
M a[116:119],a[224:227],a[192:195],a[116:119]
buffer_load_dwordx2 v[206:207],v245,s[8:11],s28 offen offset:0
M a[120:123],a[224:227],a[196:199],a[120:123]
s_waitcnt lgkmcnt(2)
buffer_load_dwordx2 v[208:209],v245,s[8:11],s28 offen offset:384
M a[124:127],a[224:227],a[200:203],a[124:127]
s_waitcnt vmcnt(20)
buffer_load_dwordx4 a[224:227],v251,s[20:23],s46 offen offset:2048
M a[128:131],a[228:231],a[204:207],a[128:131]
ds_write2st64_b64 v247,v[210:211],v[212:213] offset0:69 offset1:86
M a[132:135],a[228:231],a[208:211],a[132:135]
buffer_load_dwordx2 v[210:211],v245,s[8:11],s28 offen offset:768
M a[136:139],a[228:231],a[212:215],a[136:139]
buffer_load_dwordx2 v[212:213],v245,s[8:11],s28 offen offset:1152
M a[140:143],a[228:231],a[216:219],a[140:143]
v_fmac_f32 v239,s43,v241
v_fmac_f32 v244,4.0,v240
M a[144:147],a[228:231],a[220:223],a[144:147]
v_fma_f32 v232,-4.0,v241,v243
v_fmac_f32 v239,s45,v243
M a[148:151],a[228:231],a[192:195],a[148:151]
v_fmac_f32 v244,s40,v242
v_sub_f32 v243,v243,v241
M a[152:155],a[228:231],a[196:199],a[152:155]
v_fma_f32 v241,-4.0,v240,v242
v_sub_f32 v242,v242,v240
M a[156:159],a[228:231],a[200:203],a[156:159]
s_waitcnt vmcnt(22)
buffer_load_dwordx4 a[228:231],v251,s[20:23],s47 offen offset:2048
M a[160:163],a[232:235],a[204:207],a[160:163]
ds_read_b128 a[204:207],v249 offset:11008
v_add_f32 v240,v232,v241
M a[164:167],a[232:235],a[208:211],a[164:167]
v_sub_f32 v232,v232,v241
v_fma_f32 v241,2.0,v242,v243
M a[168:171],a[232:235],a[212:215],a[168:171]
v_fmac_f32 v243,-2.0,v242
v_cvt_pk_bf16_f32 v233,v239,v244
M a[172:175],a[232:235],a[216:219],a[172:175]
v_cvt_pk_bf16_f32 v234,v240,v232
v_cvt_pk_bf16_f32 v235,v241,v243
M a[176:179],a[232:235],a[220:223],a[176:179]
buffer_load_short_d16_hi v239,v246,s[12:15],s75 offen offset:0
M a[180:183],a[232:235],a[192:195],a[180:183]
buffer_load_short_d16_hi v240,v246,s[8:11],s75 offen offset:0
M a[184:187],a[232:235],a[196:199],a[184:187]
buffer_load_short_d16_hi v241,v246,s[8:11],s75 offen offset:384
M a[188:191],a[232:235],a[200:203],a[188:191]
s_waitcnt vmcnt(25)
buffer_load_short_d16_hi v242,v246,s[8:11],s75 offen offset:768
M a[96:99],a[236:239],a[208:211],a[96:99]
buffer_load_short_d16_hi v243,v246,s[8:11],s75 offen offset:1152
M a[100:103],a[236:239],a[212:215],a[100:103]
buffer_load_short_d16_hi v244,v246,s[16:19],s75 offen offset:1536
M a[104:107],a[236:239],a[216:219],a[104:107]
buffer_load_dwordx4 a[232:235],v251,s[20:23],s48 offen offset:2048
M a[108:111],a[236:239],a[220:223],a[108:111]
s_add_u32 s46,s79,36864
v_add_u32 v232,139264,v248
M a[112:115],a[236:239],a[192:195],a[112:115]
ds_write_b16 v232,v233 offset:0
M a[116:119],a[236:239],a[196:199],a[116:119]
ds_write_b16_d16_hi v232,v233 offset:8704
M a[120:123],a[236:239],a[200:203],a[120:123]
s_waitcnt lgkmcnt(2)
ds_write_b16 v248,v234 offset:17408
M a[124:127],a[236:239],a[204:207],a[124:127]
s_waitcnt vmcnt(24)
buffer_load_dwordx4 a[236:239],v251,s[20:23],s46 offen offset:0
M a[128:131],a[240:243],a[208:211],a[128:131]
ds_write_b16_d16_hi v248,v234 offset:26112
M a[132:135],a[240:243],a[212:215],a[132:135]
s_add_u32 s47,s79,39936
ds_write_b16 v248,v235 offset:34816
M a[136:139],a[240:243],a[216:219],a[136:139]
ds_write_b16_d16_hi v248,v235 offset:43520
M a[140:143],a[240:243],a[220:223],a[140:143]
v_lshlrev_b32 v234,16,v196
v_lshlrev_b32 v232,16,v192
M a[144:147],a[240:243],a[192:195],a[144:147]
v_lshlrev_b32 v233,16,v194
v_lshlrev_b32 v237,16,v202
M a[148:151],a[240:243],a[196:199],a[148:151]
v_add_u32 v249,0x4400,v249
v_add_u32 v250,0x4400,v250
M a[152:155],a[240:243],a[200:203],a[152:155]
s_waitcnt vmcnt(23)
v_lshlrev_b32 v236,16,v200
v_lshlrev_b32 v235,16,v198
M a[156:159],a[240:243],a[204:207],a[156:159]
s_waitcnt vmcnt(22)
buffer_load_dwordx4 a[240:243],v251,s[20:23],s47 offen offset:0
M a[160:163],a[244:247],a[208:211],a[160:163]
ds_read_b128 a[208:211],v249 offset:52224
v_fmac_f32 v232,s43,v234
M a[164:167],a[244:247],a[212:215],a[164:167]
s_add_u32 s48,s79,43008
ds_read_b128 a[212:215],v250 offset:52480
v_fmac_f32 v237,4.0,v233
M a[168:171],a[244:247],a[216:219],a[168:171]
ds_read_b128 a[216:219],v250 offset:52736
v_fma_f32 v238,-4.0,v234,v236
M a[172:175],a[244:247],a[220:223],a[172:175]
ds_read_b128 a[220:223],v250 offset:52992
v_fmac_f32 v232,s45,v236
M a[176:179],a[244:247],a[192:195],a[176:179]
ds_read_b128 a[192:195],v250 offset:53248
v_fmac_f32 v237,s40,v235
M a[180:183],a[244:247],a[196:199],a[180:183]
ds_read_b128 a[196:199],v250 offset:53504
v_sub_f32 v236,v236,v234
M a[184:187],a[244:247],a[200:203],a[184:187]
ds_read_b128 a[200:203],v250 offset:53760
v_fma_f32 v234,-4.0,v233,v235
M a[188:191],a[244:247],a[204:207],a[188:191]
s_waitcnt vmcnt(22) lgkmcnt(6)
buffer_load_dwordx4 a[244:247],v251,s[20:23],s48 offen offset:0
M v[0:3],a[248:251],a[208:211],v[0:3]
s_waitcnt lgkmcnt(5)
ds_read_b128 a[204:207],v250 offset:54016
v_sub_f32 v235,v235,v233
M v[4:7],a[248:251],a[212:215],v[4:7]
s_waitcnt lgkmcnt(5)
v_add_f32 v233,v238,v234
v_sub_f32 v238,v238,v234
M v[8:11],a[248:251],a[216:219],v[8:11]
s_waitcnt lgkmcnt(4)
v_fma_f32 v234,2.0,v235,v236
v_fmac_f32 v236,-2.0,v235
M v[12:15],a[248:251],a[220:223],v[12:15]
s_waitcnt lgkmcnt(3)
v_and_b32 v196,s42,v196
v_and_b32 v192,s42,v192
M v[16:19],a[248:251],a[192:195],v[16:19]
s_waitcnt lgkmcnt(2)
v_and_b32 v194,s42,v194
v_and_b32 v202,s42,v202
M v[20:23],a[248:251],a[196:199],v[20:23]
s_waitcnt lgkmcnt(1)
v_and_b32 v200,s42,v200
v_and_b32 v198,s42,v198
M v[24:27],a[248:251],a[200:203],v[24:27]
s_waitcnt lgkmcnt(0)
v_fmac_f32 v192,s43,v196
v_fmac_f32 v202,4.0,v194
M v[28:31],a[248:251],a[204:207],v[28:31]
s_waitcnt vmcnt(22)
buffer_load_dwordx4 a[248:251],v251,s[20:23],s46 offen offset:1024
M v[32:35],a[252:255],a[208:211],v[32:35]
v_fma_f32 v235,-4.0,v196,v200
v_fmac_f32 v192,s45,v200
M v[36:39],a[252:255],a[212:215],v[36:39]
v_fmac_f32 v202,s40,v198
v_sub_f32 v200,v200,v196
M v[40:43],a[252:255],a[216:219],v[40:43]
v_fma_f32 v196,-4.0,v194,v198
v_sub_f32 v198,v198,v194
M v[44:47],a[252:255],a[220:223],v[44:47]
v_add_f32 v194,v235,v196
v_sub_f32 v235,v235,v196
M v[48:51],a[252:255],a[192:195],v[48:51]
v_fma_f32 v196,2.0,v198,v200
v_fmac_f32 v200,-2.0,v198
M v[52:55],a[252:255],a[196:199],v[52:55]
v_cvt_pk_bf16_f32 v192,v232,v192
v_cvt_pk_bf16_f32 v202,v237,v202
M v[56:59],a[252:255],a[200:203],v[56:59]
v_cvt_pk_bf16_f32 v194,v233,v194
v_cvt_pk_bf16_f32 v198,v234,v196
M v[60:63],a[252:255],a[204:207],v[60:63]
s_waitcnt vmcnt(22)
buffer_load_dwordx4 a[252:255],v251,s[20:23],s47 offen offset:1024
M v[64:67],v[216:219],a[208:211],v[64:67]
ds_read_b128 a[208:211],v250 offset:54272
v_cvt_pk_bf16_f32 v196,v238,v235
M v[68:71],v[216:219],a[212:215],v[68:71]
v_cvt_pk_bf16_f32 v200,v236,v200
v_lshlrev_b32 v234,16,v197
M v[72:75],v[216:219],a[216:219],v[72:75]
v_lshlrev_b32 v232,16,v193
v_lshlrev_b32 v233,16,v195
M v[76:79],v[216:219],a[220:223],v[76:79]
v_lshlrev_b32 v237,16,v203
v_lshlrev_b32 v236,16,v201
M v[80:83],v[216:219],a[192:195],v[80:83]
v_lshlrev_b32 v235,16,v199
v_fmac_f32 v232,s43,v234
M v[84:87],v[216:219],a[196:199],v[84:87]
v_fmac_f32 v237,4.0,v233
v_fma_f32 v238,-4.0,v234,v236
M v[88:91],v[216:219],a[200:203],v[88:91]
v_fmac_f32 v232,s45,v236
v_fmac_f32 v237,s40,v235
M v[92:95],v[216:219],a[204:207],v[92:95]
s_waitcnt vmcnt(22)
buffer_load_dwordx4 v[216:219],v251,s[20:23],s48 offen offset:1024
M v[0:3],v[220:223],a[212:215],v[0:3]
v_sub_f32 v236,v236,v234
v_fma_f32 v234,-4.0,v233,v235
M v[4:7],v[220:223],a[216:219],v[4:7]
v_sub_f32 v235,v235,v233
v_add_f32 v233,v238,v234
M v[8:11],v[220:223],a[220:223],v[8:11]
v_sub_f32 v238,v238,v234
v_fma_f32 v234,2.0,v235,v236
M v[12:15],v[220:223],a[192:195],v[12:15]
v_fmac_f32 v236,-2.0,v235
v_and_b32 v197,s42,v197
M v[16:19],v[220:223],a[196:199],v[16:19]
v_and_b32 v193,s42,v193
v_and_b32 v195,s42,v195
M v[20:23],v[220:223],a[200:203],v[20:23]
v_and_b32 v203,s42,v203
v_and_b32 v201,s42,v201
M v[24:27],v[220:223],a[204:207],v[24:27]
s_waitcnt lgkmcnt(0)
v_and_b32 v199,s42,v199
v_fmac_f32 v193,s43,v197
M v[28:31],v[220:223],a[208:211],v[28:31]
s_waitcnt vmcnt(22)
buffer_load_dwordx4 v[220:223],v251,s[20:23],s46 offen offset:2048
M v[32:35],v[224:227],a[212:215],v[32:35]
v_fmac_f32 v203,4.0,v195
v_fma_f32 v235,-4.0,v197,v201
M v[36:39],v[224:227],a[216:219],v[36:39]
v_fmac_f32 v193,s45,v201
v_fmac_f32 v203,s40,v199
M v[40:43],v[224:227],a[220:223],v[40:43]
v_sub_f32 v201,v201,v197
v_fma_f32 v197,-4.0,v195,v199
M v[44:47],v[224:227],a[192:195],v[44:47]
v_sub_f32 v199,v199,v195
v_add_f32 v195,v235,v197
M v[48:51],v[224:227],a[196:199],v[48:51]
v_sub_f32 v235,v235,v197
v_fma_f32 v197,2.0,v199,v201
M v[52:55],v[224:227],a[200:203],v[52:55]
v_fmac_f32 v201,-2.0,v199
v_cvt_pk_bf16_f32 v193,v232,v193
M v[56:59],v[224:227],a[204:207],v[56:59]
v_cvt_pk_bf16_f32 v203,v237,v203
v_cvt_pk_bf16_f32 v195,v233,v195
M v[60:63],v[224:227],a[208:211],v[60:63]
s_waitcnt vmcnt(22)
buffer_load_dwordx4 v[224:227],v251,s[20:23],s47 offen offset:2048
M v[64:67],v[228:231],a[212:215],v[64:67]
ds_read_b128 a[212:215],v249 offset:54528
v_cvt_pk_bf16_f32 v199,v234,v197
M v[68:71],v[228:231],a[216:219],v[68:71]
v_cvt_pk_bf16_f32 v197,v238,v235
v_cvt_pk_bf16_f32 v201,v236,v201
M v[72:75],v[228:231],a[220:223],v[72:75]
v_add_u32 v232,139264,v247
M v[76:79],v[228:231],a[192:195],v[76:79]
ds_write2st64_b64 v232,v[192:193],v[202:203] offset0:2 offset1:19
M v[80:83],v[228:231],a[196:199],v[80:83]
s_add_u32 s28,s69,6291456
buffer_load_dwordx2 v[192:193],v245,s[12:15],s28 offen offset:0
M v[84:87],v[228:231],a[200:203],v[84:87]
buffer_load_dwordx2 v[202:203],v245,s[16:19],s28 offen offset:1536
M v[88:91],v[228:231],a[204:207],v[88:91]
ds_write2st64_b64 v247,v[194:195],v[196:197] offset0:36 offset1:53
M v[92:95],v[228:231],a[208:211],v[92:95]
s_waitcnt vmcnt(20)
buffer_load_dwordx2 v[194:195],v245,s[8:11],s28 offen offset:0
M v[0:3],a[224:227],a[216:219],v[0:3]
buffer_load_dwordx2 v[196:197],v245,s[8:11],s28 offen offset:384
M v[4:7],a[224:227],a[220:223],v[4:7]
buffer_load_dwordx4 v[228:231],v251,s[20:23],s48 offen offset:2048
M v[8:11],a[224:227],a[192:195],v[8:11]
s_add_u32 s46,s80,9216
ds_write2st64_b64 v247,v[198:199],v[200:201] offset0:70 offset1:87
M v[12:15],a[224:227],a[196:199],v[12:15]
buffer_load_dwordx2 v[198:199],v245,s[8:11],s28 offen offset:768
M v[16:19],a[224:227],a[200:203],v[16:19]
buffer_load_dwordx2 v[200:201],v245,s[8:11],s28 offen offset:1152
M v[20:23],a[224:227],a[204:207],v[20:23]
v_lshlrev_b32 v234,16,v208
v_lshlrev_b32 v232,16,v204
M v[24:27],a[224:227],a[208:211],v[24:27]
s_waitcnt lgkmcnt(3)
v_lshlrev_b32 v233,16,v206
v_lshlrev_b32 v237,16,v214
M v[28:31],a[224:227],a[212:215],v[28:31]
s_waitcnt vmcnt(22)
buffer_load_dwordx4 a[224:227],v251,s[20:23],s46 offen offset:0
M v[32:35],a[228:231],a[216:219],v[32:35]
v_lshlrev_b32 v236,16,v212
v_lshlrev_b32 v235,16,v210
M v[36:39],a[228:231],a[220:223],v[36:39]
s_add_u32 s47,s80,12288
v_fmac_f32 v232,s43,v234
v_fmac_f32 v237,4.0,v233
M v[40:43],a[228:231],a[192:195],v[40:43]
v_fma_f32 v238,-4.0,v234,v236
v_fmac_f32 v232,s45,v236
M v[44:47],a[228:231],a[196:199],v[44:47]
v_fmac_f32 v237,s40,v235
v_sub_f32 v236,v236,v234
M v[48:51],a[228:231],a[200:203],v[48:51]
v_fma_f32 v234,-4.0,v233,v235
v_sub_f32 v235,v235,v233
M v[52:55],a[228:231],a[204:207],v[52:55]
v_add_f32 v233,v238,v234
v_sub_f32 v238,v238,v234
M v[56:59],a[228:231],a[208:211],v[56:59]
v_fma_f32 v234,2.0,v235,v236
v_fmac_f32 v236,-2.0,v235
M v[60:63],a[228:231],a[212:215],v[60:63]
s_waitcnt vmcnt(16)
buffer_load_dwordx4 a[228:231],v251,s[20:23],s47 offen offset:0
M v[64:67],a[232:235],a[216:219],v[64:67]
ds_read_b128 a[216:219],v249 offset:60928
v_and_b32 v208,s42,v208
M v[68:71],a[232:235],a[220:223],v[68:71]
s_add_u32 s48,s80,15360
ds_read_b128 a[220:223],v250 offset:61184
v_and_b32 v204,s42,v204
M v[72:75],a[232:235],a[192:195],v[72:75]
ds_read_b128 a[192:195],v250 offset:61440
v_and_b32 v206,s42,v206
M v[76:79],a[232:235],a[196:199],v[76:79]
ds_read_b128 a[196:199],v250 offset:61696
v_and_b32 v214,s42,v214
M v[80:83],a[232:235],a[200:203],v[80:83]
ds_read_b128 a[200:203],v250 offset:61952
v_and_b32 v212,s42,v212
M v[84:87],a[232:235],a[204:207],v[84:87]
ds_read_b128 a[204:207],v250 offset:62208
v_and_b32 v210,s42,v210
M v[88:91],a[232:235],a[208:211],v[88:91]
ds_read_b128 a[208:211],v250 offset:62464
v_fmac_f32 v204,s43,v208
M v[92:95],a[232:235],a[212:215],v[92:95]
s_waitcnt vmcnt(16) lgkmcnt(6)
buffer_load_dwordx4 a[232:235],v251,s[20:23],s48 offen offset:0
M v[96:99],a[236:239],a[216:219],v[96:99]
s_waitcnt lgkmcnt(5)
ds_read_b128 a[212:215],v250 offset:62720
v_fmac_f32 v214,4.0,v206
M v[100:103],a[236:239],a[220:223],v[100:103]
s_waitcnt lgkmcnt(5)
v_fma_f32 v235,-4.0,v208,v212
v_fmac_f32 v204,s45,v212
M v[104:107],a[236:239],a[192:195],v[104:107]
s_waitcnt lgkmcnt(4)
v_fmac_f32 v214,s40,v210
v_sub_f32 v212,v212,v208
M v[108:111],a[236:239],a[196:199],v[108:111]
s_waitcnt lgkmcnt(3)
v_fma_f32 v208,-4.0,v206,v210
v_sub_f32 v210,v210,v206
M v[112:115],a[236:239],a[200:203],v[112:115]
s_waitcnt lgkmcnt(2)
v_add_f32 v206,v235,v208
v_sub_f32 v235,v235,v208
M v[116:119],a[236:239],a[204:207],v[116:119]
s_waitcnt lgkmcnt(1)
v_fma_f32 v208,2.0,v210,v212
v_fmac_f32 v212,-2.0,v210
M v[120:123],a[236:239],a[208:211],v[120:123]
s_waitcnt lgkmcnt(0)
v_cvt_pk_bf16_f32 v204,v232,v204
v_cvt_pk_bf16_f32 v214,v237,v214
M v[124:127],a[236:239],a[212:215],v[124:127]
s_waitcnt vmcnt(16)
buffer_load_dwordx4 a[236:239],v251,s[20:23],s46 offen offset:1024
M v[128:131],a[240:243],a[216:219],v[128:131]
v_cvt_pk_bf16_f32 v206,v233,v206
v_cvt_pk_bf16_f32 v210,v234,v208
M v[132:135],a[240:243],a[220:223],v[132:135]
v_cvt_pk_bf16_f32 v208,v238,v235
v_cvt_pk_bf16_f32 v212,v236,v212
M v[136:139],a[240:243],a[192:195],v[136:139]
v_lshlrev_b32 v234,16,v209
v_lshlrev_b32 v232,16,v205
M v[140:143],a[240:243],a[196:199],v[140:143]
v_lshlrev_b32 v233,16,v207
v_lshlrev_b32 v237,16,v215
M v[144:147],a[240:243],a[200:203],v[144:147]
v_lshlrev_b32 v236,16,v213
v_lshlrev_b32 v235,16,v211
M v[148:151],a[240:243],a[204:207],v[148:151]
v_fmac_f32 v232,s43,v234
v_fmac_f32 v237,4.0,v233
M v[152:155],a[240:243],a[208:211],v[152:155]
v_fma_f32 v238,-4.0,v234,v236
v_fmac_f32 v232,s45,v236
M v[156:159],a[240:243],a[212:215],v[156:159]
s_waitcnt vmcnt(16)
buffer_load_dwordx4 a[240:243],v251,s[20:23],s47 offen offset:1024
M v[160:163],a[244:247],a[216:219],v[160:163]
ds_read_b128 a[216:219],v250 offset:62976
v_fmac_f32 v237,s40,v235
M v[164:167],a[244:247],a[220:223],v[164:167]
v_sub_f32 v236,v236,v234
v_fma_f32 v234,-4.0,v233,v235
M v[168:171],a[244:247],a[192:195],v[168:171]
v_sub_f32 v235,v235,v233
v_add_f32 v233,v238,v234
M v[172:175],a[244:247],a[196:199],v[172:175]
v_sub_f32 v238,v238,v234
v_fma_f32 v234,2.0,v235,v236
M v[176:179],a[244:247],a[200:203],v[176:179]
v_fmac_f32 v236,-2.0,v235
v_and_b32 v209,s42,v209
M v[180:183],a[244:247],a[204:207],v[180:183]
v_and_b32 v205,s42,v205
v_and_b32 v207,s42,v207
M v[184:187],a[244:247],a[208:211],v[184:187]
v_and_b32 v215,s42,v215
v_and_b32 v213,s42,v213
M v[188:191],a[244:247],a[212:215],v[188:191]
s_waitcnt vmcnt(16)
buffer_load_dwordx4 a[244:247],v251,s[20:23],s48 offen offset:1024
M v[96:99],a[248:251],a[220:223],v[96:99]
v_and_b32 v211,s42,v211
v_fmac_f32 v205,s43,v209
M v[100:103],a[248:251],a[192:195],v[100:103]
v_fmac_f32 v215,4.0,v207
v_fma_f32 v235,-4.0,v209,v213
M v[104:107],a[248:251],a[196:199],v[104:107]
v_fmac_f32 v205,s45,v213
v_fmac_f32 v215,s40,v211
M v[108:111],a[248:251],a[200:203],v[108:111]
v_sub_f32 v213,v213,v209
v_fma_f32 v209,-4.0,v207,v211
M v[112:115],a[248:251],a[204:207],v[112:115]
v_sub_f32 v211,v211,v207
v_add_f32 v207,v235,v209
M v[116:119],a[248:251],a[208:211],v[116:119]
v_sub_f32 v235,v235,v209
v_fma_f32 v209,2.0,v211,v213
M v[120:123],a[248:251],a[212:215],v[120:123]
s_waitcnt lgkmcnt(0)
v_fmac_f32 v213,-2.0,v211
v_cvt_pk_bf16_f32 v205,v232,v205
M v[124:127],a[248:251],a[216:219],v[124:127]
s_waitcnt vmcnt(16)
buffer_load_dwordx4 a[248:251],v251,s[20:23],s46 offen offset:2048
M v[128:131],a[252:255],a[220:223],v[128:131]
v_cvt_pk_bf16_f32 v215,v237,v215
v_cvt_pk_bf16_f32 v207,v233,v207
M v[132:135],a[252:255],a[192:195],v[132:135]
v_cvt_pk_bf16_f32 v211,v234,v209
v_cvt_pk_bf16_f32 v209,v238,v235
M v[136:139],a[252:255],a[196:199],v[136:139]
v_cvt_pk_bf16_f32 v213,v236,v213
v_add_u32 v232,139264,v247
M v[140:143],a[252:255],a[200:203],v[140:143]
ds_write2st64_b64 v232,v[204:205],v[214:215] offset0:3 offset1:20
M v[144:147],a[252:255],a[204:207],v[144:147]
s_add_u32 s28,s69,6684672
buffer_load_dwordx2 v[204:205],v245,s[12:15],s28 offen offset:0
M v[148:151],a[252:255],a[208:211],v[148:151]
buffer_load_dwordx2 v[214:215],v245,s[16:19],s28 offen offset:1536
M v[152:155],a[252:255],a[212:215],v[152:155]
ds_write2st64_b64 v247,v[206:207],v[208:209] offset0:37 offset1:54
M v[156:159],a[252:255],a[216:219],v[156:159]
s_waitcnt vmcnt(18)
buffer_load_dwordx2 v[206:207],v245,s[8:11],s28 offen offset:0
M v[160:163],v[216:219],a[220:223],v[160:163]
buffer_load_dwordx2 v[208:209],v245,s[8:11],s28 offen offset:384
M v[164:167],v[216:219],a[192:195],v[164:167]
buffer_load_dwordx4 a[252:255],v251,s[20:23],s47 offen offset:2048
M v[168:171],v[216:219],a[196:199],v[168:171]
ds_read_b128 a[220:223],v249 offset:63232
ds_write2st64_b64 v247,v[210:211],v[212:213] offset0:71 offset1:88
M v[172:175],v[216:219],a[200:203],v[172:175]
buffer_load_dwordx2 v[210:211],v245,s[8:11],s28 offen offset:768
M v[176:179],v[216:219],a[204:207],v[176:179]
buffer_load_dwordx2 v[212:213],v245,s[8:11],s28 offen offset:1152
M v[180:183],v[216:219],a[208:211],v[180:183]
s_waitcnt vmcnt(17)
v_lshlrev_b32 v234,16,v196
v_lshlrev_b32 v232,16,v192
M v[184:187],v[216:219],a[212:215],v[184:187]
v_lshlrev_b32 v233,16,v194
v_lshlrev_b32 v237,16,v202
M v[188:191],v[216:219],a[216:219],v[188:191]
buffer_load_dwordx4 v[216:219],v251,s[20:23],s48 offen offset:2048
M v[96:99],v[220:223],a[192:195],v[96:99]
s_waitcnt vmcnt(15)
v_lshlrev_b32 v236,16,v200
v_lshlrev_b32 v235,16,v198
M v[100:103],v[220:223],a[196:199],v[100:103]
s_add_u32 s46,s80,18432
v_fmac_f32 v232,s43,v234
v_fmac_f32 v237,4.0,v233
M v[104:107],v[220:223],a[200:203],v[104:107]
v_fma_f32 v238,-4.0,v234,v236
v_fmac_f32 v232,s45,v236
M v[108:111],v[220:223],a[204:207],v[108:111]
v_fmac_f32 v237,s40,v235
v_sub_f32 v236,v236,v234
M v[112:115],v[220:223],a[208:211],v[112:115]
v_fma_f32 v234,-4.0,v233,v235
v_sub_f32 v235,v235,v233
M v[116:119],v[220:223],a[212:215],v[116:119]
v_add_f32 v233,v238,v234
v_sub_f32 v238,v238,v234
M v[120:123],v[220:223],a[216:219],v[120:123]
s_waitcnt lgkmcnt(1)
v_fma_f32 v234,2.0,v235,v236
v_fmac_f32 v236,-2.0,v235
M v[124:127],v[220:223],a[220:223],v[124:127]
buffer_load_dwordx4 v[220:223],v251,s[20:23],s46 offen offset:0
M v[128:131],v[224:227],a[192:195],v[128:131]
v_and_b32 v196,s42,v196
v_and_b32 v192,s42,v192
M v[132:135],v[224:227],a[196:199],v[132:135]
s_add_u32 s47,s80,21504
v_and_b32 v194,s42,v194
v_and_b32 v202,s42,v202
M v[136:139],v[224:227],a[200:203],v[136:139]
v_and_b32 v200,s42,v200
v_and_b32 v198,s42,v198
M v[140:143],v[224:227],a[204:207],v[140:143]
v_fmac_f32 v192,s43,v196
v_fmac_f32 v202,4.0,v194
M v[144:147],v[224:227],a[208:211],v[144:147]
v_fma_f32 v235,-4.0,v196,v200
v_fmac_f32 v192,s45,v200
M v[148:151],v[224:227],a[212:215],v[148:151]
v_fmac_f32 v202,s40,v198
v_sub_f32 v200,v200,v196
M v[152:155],v[224:227],a[216:219],v[152:155]
s_waitcnt lgkmcnt(0)
s_barrier
v_fma_f32 v196,-4.0,v194,v198
M v[156:159],v[224:227],a[220:223],v[156:159]
buffer_load_dwordx4 v[224:227],v251,s[20:23],s47 offen offset:0
M v[160:163],v[228:231],a[192:195],v[160:163]
ds_read_b128 a[192:195],v249 offset:0
v_sub_f32 v198,v198,v194
M v[164:167],v[228:231],a[196:199],v[164:167]
s_add_u32 s48,s80,24576
ds_read_b128 a[196:199],v250 offset:256
v_add_f32 v194,v235,v196
M v[168:171],v[228:231],a[200:203],v[168:171]
ds_read_b128 a[200:203],v250 offset:512
v_sub_f32 v235,v235,v196
M v[172:175],v[228:231],a[204:207],v[172:175]
ds_read_b128 a[204:207],v250 offset:768
v_fma_f32 v196,2.0,v198,v200
M v[176:179],v[228:231],a[208:211],v[176:179]
ds_read_b128 a[208:211],v250 offset:1024
v_fmac_f32 v200,-2.0,v198
M v[180:183],v[228:231],a[212:215],v[180:183]
ds_read_b128 a[212:215],v250 offset:1280
v_cvt_pk_bf16_f32 v192,v232,v192
M v[184:187],v[228:231],a[216:219],v[184:187]
ds_read_b128 a[216:219],v250 offset:1536
v_cvt_pk_bf16_f32 v202,v237,v202
M v[188:191],v[228:231],a[220:223],v[188:191]
s_waitcnt vmcnt(16) lgkmcnt(6)
buffer_load_dwordx4 v[228:231],v251,s[20:23],s48 offen offset:0
M a[0:3],a[224:227],a[192:195],a[0:3]
s_waitcnt lgkmcnt(5)
ds_read_b128 a[220:223],v250 offset:1792
v_cvt_pk_bf16_f32 v194,v233,v194
M a[4:7],a[224:227],a[196:199],a[4:7]
s_waitcnt lgkmcnt(5)
v_cvt_pk_bf16_f32 v198,v234,v196
v_cvt_pk_bf16_f32 v196,v238,v235
M a[8:11],a[224:227],a[200:203],a[8:11]
s_waitcnt lgkmcnt(4)
v_cvt_pk_bf16_f32 v200,v236,v200
v_lshlrev_b32 v234,16,v197
M a[12:15],a[224:227],a[204:207],a[12:15]
s_waitcnt lgkmcnt(3)
v_lshlrev_b32 v232,16,v193
v_lshlrev_b32 v233,16,v195
M a[16:19],a[224:227],a[208:211],a[16:19]
s_waitcnt lgkmcnt(2)
v_lshlrev_b32 v237,16,v203
v_lshlrev_b32 v236,16,v201
M a[20:23],a[224:227],a[212:215],a[20:23]
s_waitcnt lgkmcnt(1)
v_lshlrev_b32 v235,16,v199
v_fmac_f32 v232,s43,v234
M a[24:27],a[224:227],a[216:219],a[24:27]
s_waitcnt lgkmcnt(0)
v_fmac_f32 v237,4.0,v233
v_fma_f32 v238,-4.0,v234,v236
M a[28:31],a[224:227],a[220:223],a[28:31]
s_waitcnt vmcnt(16)
buffer_load_dwordx4 a[224:227],v251,s[20:23],s46 offen offset:1024
M a[32:35],a[228:231],a[192:195],a[32:35]
v_fmac_f32 v232,s45,v236
v_fmac_f32 v237,s40,v235
M a[36:39],a[228:231],a[196:199],a[36:39]
v_sub_f32 v236,v236,v234
v_fma_f32 v234,-4.0,v233,v235
M a[40:43],a[228:231],a[200:203],a[40:43]
v_sub_f32 v235,v235,v233
v_add_f32 v233,v238,v234
M a[44:47],a[228:231],a[204:207],a[44:47]
v_sub_f32 v238,v238,v234
v_fma_f32 v234,2.0,v235,v236
M a[48:51],a[228:231],a[208:211],a[48:51]
v_fmac_f32 v236,-2.0,v235
v_and_b32 v197,s42,v197
M a[52:55],a[228:231],a[212:215],a[52:55]
v_and_b32 v193,s42,v193
v_and_b32 v195,s42,v195
M a[56:59],a[228:231],a[216:219],a[56:59]
v_and_b32 v203,s42,v203
v_and_b32 v201,s42,v201
M a[60:63],a[228:231],a[220:223],a[60:63]
s_waitcnt vmcnt(16)
buffer_load_dwordx4 a[228:231],v251,s[20:23],s47 offen offset:1024
M a[64:67],a[232:235],a[192:195],a[64:67]
ds_read_b128 a[192:195],v250 offset:2048
v_and_b32 v199,s42,v199
M a[68:71],a[232:235],a[196:199],a[68:71]
v_fmac_f32 v193,s43,v197
v_fmac_f32 v203,4.0,v195
M a[72:75],a[232:235],a[200:203],a[72:75]
v_fma_f32 v235,-4.0,v197,v201
v_fmac_f32 v193,s45,v201
M a[76:79],a[232:235],a[204:207],a[76:79]
v_fmac_f32 v203,s40,v199
v_sub_f32 v201,v201,v197
M a[80:83],a[232:235],a[208:211],a[80:83]
v_fma_f32 v197,-4.0,v195,v199
v_sub_f32 v199,v199,v195
M a[84:87],a[232:235],a[212:215],a[84:87]
v_add_f32 v195,v235,v197
v_sub_f32 v235,v235,v197
M a[88:91],a[232:235],a[216:219],a[88:91]
v_fma_f32 v197,2.0,v199,v201
v_fmac_f32 v201,-2.0,v199
M a[92:95],a[232:235],a[220:223],a[92:95]
s_waitcnt vmcnt(16)
buffer_load_dwordx4 a[232:235],v251,s[20:23],s48 offen offset:1024
M a[0:3],a[236:239],a[196:199],a[0:3]
v_cvt_pk_bf16_f32 v193,v232,v193
v_cvt_pk_bf16_f32 v203,v237,v203
M a[4:7],a[236:239],a[200:203],a[4:7]
v_cvt_pk_bf16_f32 v195,v233,v195
v_cvt_pk_bf16_f32 v199,v234,v197
M a[8:11],a[236:239],a[204:207],a[8:11]
v_cvt_pk_bf16_f32 v197,v238,v235
v_cvt_pk_bf16_f32 v201,v236,v201
M a[12:15],a[236:239],a[208:211],a[12:15]
ds_write2st64_b64 v247,v[192:193],v[202:203] offset0:136 offset1:153
M a[16:19],a[236:239],a[212:215],a[16:19]
s_add_u32 s28,s69,7077888
buffer_load_dwordx2 v[192:193],v245,s[12:15],s28 offen offset:0
M a[20:23],a[236:239],a[216:219],a[20:23]
buffer_load_dwordx2 v[202:203],v245,s[16:19],s28 offen offset:1536
M a[24:27],a[236:239],a[220:223],a[24:27]
s_waitcnt lgkmcnt(1)
ds_write2st64_b64 v247,v[194:195],v[196:197] offset0:0 offset1:17
M a[28:31],a[236:239],a[192:195],a[28:31]
s_waitcnt vmcnt(18)
buffer_load_dwordx2 v[194:195],v245,s[8:11],s28 offen offset:0
M a[32:35],a[240:243],a[196:199],a[32:35]
buffer_load_dwordx2 v[196:197],v245,s[8:11],s28 offen offset:384
M a[36:39],a[240:243],a[200:203],a[36:39]
buffer_load_dwordx4 a[236:239],v251,s[20:23],s46 offen offset:2048
M a[40:43],a[240:243],a[204:207],a[40:43]
M a[44:47],a[240:243],a[208:211],a[44:47]
M a[48:51],a[240:243],a[212:215],a[48:51]
M a[52:55],a[240:243],a[216:219],a[52:55]
M a[56:59],a[240:243],a[220:223],a[56:59]
M a[60:63],a[240:243],a[192:195],a[60:63]
s_waitcnt vmcnt(20)
buffer_load_dwordx4 a[240:243],v251,s[20:23],s47 offen offset:2048
M a[64:67],a[244:247],a[196:199],a[64:67]
ds_read_b128 a[196:199],v249 offset:2304
M a[68:71],a[244:247],a[200:203],a[68:71]
M a[72:75],a[244:247],a[204:207],a[72:75]
M a[76:79],a[244:247],a[208:211],a[76:79]
M a[80:83],a[244:247],a[212:215],a[80:83]
M a[84:87],a[244:247],a[216:219],a[84:87]
M a[88:91],a[244:247],a[220:223],a[88:91]
M a[92:95],a[244:247],a[192:195],a[92:95]
s_waitcnt vmcnt(20)
buffer_load_dwordx4 a[244:247],v251,s[20:23],s48 offen offset:2048
M a[0:3],a[248:251],a[200:203],a[0:3]
M a[4:7],a[248:251],a[204:207],a[4:7]
s_add_u32 s46,s80,27648
M a[8:11],a[248:251],a[208:211],a[8:11]
M a[12:15],a[248:251],a[212:215],a[12:15]
M a[16:19],a[248:251],a[216:219],a[16:19]
M a[20:23],a[248:251],a[220:223],a[20:23]
M a[24:27],a[248:251],a[192:195],a[24:27]
s_waitcnt lgkmcnt(0)
M a[28:31],a[248:251],a[196:199],a[28:31]
s_waitcnt vmcnt(16)
buffer_load_dwordx4 a[248:251],v251,s[20:23],s46 offen offset:0
M a[32:35],a[252:255],a[200:203],a[32:35]
M a[36:39],a[252:255],a[204:207],a[36:39]
s_add_u32 s47,s80,30720
M a[40:43],a[252:255],a[208:211],a[40:43]
M a[44:47],a[252:255],a[212:215],a[44:47]
M a[48:51],a[252:255],a[216:219],a[48:51]
M a[52:55],a[252:255],a[220:223],a[52:55]
M a[56:59],a[252:255],a[192:195],a[56:59]
M a[60:63],a[252:255],a[196:199],a[60:63]
s_waitcnt vmcnt(14)
buffer_load_dwordx4 a[252:255],v251,s[20:23],s47 offen offset:0
M a[64:67],v[216:219],a[200:203],a[64:67]
ds_read_b128 a[200:203],v249 offset:8704
M a[68:71],v[216:219],a[204:207],a[68:71]
s_add_u32 s48,s80,33792
ds_read_b128 a[204:207],v250 offset:8960
M a[72:75],v[216:219],a[208:211],a[72:75]
ds_read_b128 a[208:211],v250 offset:9216
M a[76:79],v[216:219],a[212:215],a[76:79]
ds_read_b128 a[212:215],v250 offset:9472
M a[80:83],v[216:219],a[216:219],a[80:83]
ds_read_b128 a[216:219],v250 offset:9728
M a[84:87],v[216:219],a[220:223],a[84:87]
ds_read_b128 a[220:223],v250 offset:9984
M a[88:91],v[216:219],a[192:195],a[88:91]
ds_read_b128 a[192:195],v250 offset:10240
M a[92:95],v[216:219],a[196:199],a[92:95]
s_waitcnt vmcnt(14) lgkmcnt(6)
buffer_load_dwordx4 v[216:219],v251,s[20:23],s48 offen offset:0
M a[96:99],v[220:223],a[200:203],a[96:99]
s_waitcnt lgkmcnt(5)
ds_read_b128 a[196:199],v250 offset:10496
M a[100:103],v[220:223],a[204:207],a[100:103]
s_waitcnt lgkmcnt(5)
M a[104:107],v[220:223],a[208:211],a[104:107]
s_waitcnt lgkmcnt(4)
M a[108:111],v[220:223],a[212:215],a[108:111]
s_waitcnt lgkmcnt(3)
M a[112:115],v[220:223],a[216:219],a[112:115]
s_waitcnt lgkmcnt(2)
M a[116:119],v[220:223],a[220:223],a[116:119]
s_waitcnt lgkmcnt(1)
M a[120:123],v[220:223],a[192:195],a[120:123]
s_waitcnt lgkmcnt(0)
M a[124:127],v[220:223],a[196:199],a[124:127]
s_waitcnt vmcnt(14)
buffer_load_dwordx4 v[220:223],v251,s[20:23],s46 offen offset:1024
M a[128:131],v[224:227],a[200:203],a[128:131]
M a[132:135],v[224:227],a[204:207],a[132:135]
M a[136:139],v[224:227],a[208:211],a[136:139]
M a[140:143],v[224:227],a[212:215],a[140:143]
M a[144:147],v[224:227],a[216:219],a[144:147]
M a[148:151],v[224:227],a[220:223],a[148:151]
M a[152:155],v[224:227],a[192:195],a[152:155]
M a[156:159],v[224:227],a[196:199],a[156:159]
s_waitcnt vmcnt(14)
buffer_load_dwordx4 v[224:227],v251,s[20:23],s47 offen offset:1024
M a[160:163],v[228:231],a[200:203],a[160:163]
ds_read_b128 a[200:203],v250 offset:10752
M a[164:167],v[228:231],a[204:207],a[164:167]
M a[168:171],v[228:231],a[208:211],a[168:171]
M a[172:175],v[228:231],a[212:215],a[172:175]
M a[176:179],v[228:231],a[216:219],a[176:179]
M a[180:183],v[228:231],a[220:223],a[180:183]
M a[184:187],v[228:231],a[192:195],a[184:187]
M a[188:191],v[228:231],a[196:199],a[188:191]
s_waitcnt vmcnt(14)
buffer_load_dwordx4 v[228:231],v251,s[20:23],s48 offen offset:1024
M a[96:99],a[224:227],a[204:207],a[96:99]
M a[100:103],a[224:227],a[208:211],a[100:103]
M a[104:107],a[224:227],a[212:215],a[104:107]
M a[108:111],a[224:227],a[216:219],a[108:111]
M a[112:115],a[224:227],a[220:223],a[112:115]
M a[116:119],a[224:227],a[192:195],a[116:119]
M a[120:123],a[224:227],a[196:199],a[120:123]
s_waitcnt lgkmcnt(0)
M a[124:127],a[224:227],a[200:203],a[124:127]
s_waitcnt vmcnt(14)
buffer_load_dwordx4 a[224:227],v251,s[20:23],s46 offen offset:2048
M a[128:131],a[228:231],a[204:207],a[128:131]
M a[132:135],a[228:231],a[208:211],a[132:135]
M a[136:139],a[228:231],a[212:215],a[136:139]
M a[140:143],a[228:231],a[216:219],a[140:143]
M a[144:147],a[228:231],a[220:223],a[144:147]
M a[148:151],a[228:231],a[192:195],a[148:151]
M a[152:155],a[228:231],a[196:199],a[152:155]
M a[156:159],a[228:231],a[200:203],a[156:159]
s_waitcnt vmcnt(14)
buffer_load_dwordx4 a[228:231],v251,s[20:23],s47 offen offset:2048
M a[160:163],a[232:235],a[204:207],a[160:163]
ds_read_b128 a[204:207],v249 offset:11008
M a[164:167],a[232:235],a[208:211],a[164:167]
M a[168:171],a[232:235],a[212:215],a[168:171]
M a[172:175],a[232:235],a[216:219],a[172:175]
M a[176:179],a[232:235],a[220:223],a[176:179]
M a[180:183],a[232:235],a[192:195],a[180:183]
M a[184:187],a[232:235],a[196:199],a[184:187]
M a[188:191],a[232:235],a[200:203],a[188:191]
s_waitcnt vmcnt(10)
buffer_load_dwordx4 a[232:235],v251,s[20:23],s48 offen offset:2048
M a[96:99],a[236:239],a[208:211],a[96:99]
M a[100:103],a[236:239],a[212:215],a[100:103]
s_add_u32 s46,s80,36864
M a[104:107],a[236:239],a[216:219],a[104:107]
M a[108:111],a[236:239],a[220:223],a[108:111]
M a[112:115],a[236:239],a[192:195],a[112:115]
M a[116:119],a[236:239],a[196:199],a[116:119]
M a[120:123],a[236:239],a[200:203],a[120:123]
s_waitcnt lgkmcnt(0)
M a[124:127],a[236:239],a[204:207],a[124:127]
s_waitcnt vmcnt(10)
buffer_load_dwordx4 a[236:239],v251,s[20:23],s46 offen offset:0
M a[128:131],a[240:243],a[208:211],a[128:131]
M a[132:135],a[240:243],a[212:215],a[132:135]
s_barrier
ds_write2st64_b64 v247,v[198:199],v[200:201] offset0:34 offset1:51
M a[136:139],a[240:243],a[216:219],a[136:139]
s_add_u32 s47,s80,39936
buffer_load_dwordx2 v[198:199],v245,s[8:11],s28 offen offset:768
M a[140:143],a[240:243],a[220:223],a[140:143]
buffer_load_dwordx2 v[200:201],v245,s[8:11],s28 offen offset:1152
M a[144:147],a[240:243],a[192:195],a[144:147]
v_lshlrev_b32 v234,16,v208
v_lshlrev_b32 v232,16,v204
M a[148:151],a[240:243],a[196:199],a[148:151]
v_lshlrev_b32 v233,16,v206
v_lshlrev_b32 v237,16,v214
M a[152:155],a[240:243],a[200:203],a[152:155]
v_lshlrev_b32 v236,16,v212
v_lshlrev_b32 v235,16,v210
M a[156:159],a[240:243],a[204:207],a[156:159]
s_waitcnt vmcnt(12)
buffer_load_dwordx4 a[240:243],v251,s[20:23],s47 offen offset:0
M a[160:163],a[244:247],a[208:211],a[160:163]
ds_read_b128 a[208:211],v249 offset:17408
v_fmac_f32 v232,s43,v234
M a[164:167],a[244:247],a[212:215],a[164:167]
s_add_u32 s48,s80,43008
ds_read_b128 a[212:215],v250 offset:17664
v_fmac_f32 v237,4.0,v233
M a[168:171],a[244:247],a[216:219],a[168:171]
ds_read_b128 a[216:219],v250 offset:17920
v_fma_f32 v238,-4.0,v234,v236
M a[172:175],a[244:247],a[220:223],a[172:175]
ds_read_b128 a[220:223],v250 offset:18176
v_fmac_f32 v232,s45,v236
M a[176:179],a[244:247],a[192:195],a[176:179]
ds_read_b128 a[192:195],v250 offset:18432
v_fmac_f32 v237,s40,v235
M a[180:183],a[244:247],a[196:199],a[180:183]
ds_read_b128 a[196:199],v250 offset:18688
v_sub_f32 v236,v236,v234
M a[184:187],a[244:247],a[200:203],a[184:187]
ds_read_b128 a[200:203],v250 offset:18944
v_fma_f32 v234,-4.0,v233,v235
M a[188:191],a[244:247],a[204:207],a[188:191]
s_waitcnt vmcnt(12) lgkmcnt(6)
buffer_load_dwordx4 a[244:247],v251,s[20:23],s48 offen offset:0
M v[0:3],a[248:251],a[208:211],v[0:3]
s_waitcnt lgkmcnt(5)
ds_read_b128 a[204:207],v250 offset:19200
v_sub_f32 v235,v235,v233
M v[4:7],a[248:251],a[212:215],v[4:7]
s_waitcnt lgkmcnt(5)
v_add_f32 v233,v238,v234
v_sub_f32 v238,v238,v234
M v[8:11],a[248:251],a[216:219],v[8:11]
s_waitcnt lgkmcnt(4)
v_fma_f32 v234,2.0,v235,v236
v_fmac_f32 v236,-2.0,v235
M v[12:15],a[248:251],a[220:223],v[12:15]
s_waitcnt lgkmcnt(3)
v_and_b32 v208,s42,v208
v_and_b32 v204,s42,v204
M v[16:19],a[248:251],a[192:195],v[16:19]
s_waitcnt lgkmcnt(2)
v_and_b32 v206,s42,v206
v_and_b32 v214,s42,v214
M v[20:23],a[248:251],a[196:199],v[20:23]
s_waitcnt lgkmcnt(1)
v_and_b32 v212,s42,v212
v_and_b32 v210,s42,v210
M v[24:27],a[248:251],a[200:203],v[24:27]
s_waitcnt lgkmcnt(0)
v_fmac_f32 v204,s43,v208
v_fmac_f32 v214,4.0,v206
M v[28:31],a[248:251],a[204:207],v[28:31]
s_waitcnt vmcnt(12)
buffer_load_dwordx4 a[248:251],v251,s[20:23],s46 offen offset:1024
M v[32:35],a[252:255],a[208:211],v[32:35]
v_fma_f32 v235,-4.0,v208,v212
v_fmac_f32 v204,s45,v212
M v[36:39],a[252:255],a[212:215],v[36:39]
v_fmac_f32 v214,s40,v210
v_sub_f32 v212,v212,v208
M v[40:43],a[252:255],a[216:219],v[40:43]
v_fma_f32 v208,-4.0,v206,v210
v_sub_f32 v210,v210,v206
M v[44:47],a[252:255],a[220:223],v[44:47]
v_add_f32 v206,v235,v208
v_sub_f32 v235,v235,v208
M v[48:51],a[252:255],a[192:195],v[48:51]
v_fma_f32 v208,2.0,v210,v212
v_fmac_f32 v212,-2.0,v210
M v[52:55],a[252:255],a[196:199],v[52:55]
v_cvt_pk_bf16_f32 v204,v232,v204
v_cvt_pk_bf16_f32 v214,v237,v214
M v[56:59],a[252:255],a[200:203],v[56:59]
v_cvt_pk_bf16_f32 v206,v233,v206
v_cvt_pk_bf16_f32 v210,v234,v208
M v[60:63],a[252:255],a[204:207],v[60:63]
s_waitcnt vmcnt(12)
buffer_load_dwordx4 a[252:255],v251,s[20:23],s47 offen offset:1024
M v[64:67],v[216:219],a[208:211],v[64:67]
ds_read_b128 a[208:211],v250 offset:19456
v_cvt_pk_bf16_f32 v208,v238,v235
M v[68:71],v[216:219],a[212:215],v[68:71]
v_cvt_pk_bf16_f32 v212,v236,v212
v_lshlrev_b32 v234,16,v209
M v[72:75],v[216:219],a[216:219],v[72:75]
v_lshlrev_b32 v232,16,v205
v_lshlrev_b32 v233,16,v207
M v[76:79],v[216:219],a[220:223],v[76:79]
v_lshlrev_b32 v237,16,v215
v_lshlrev_b32 v236,16,v213
M v[80:83],v[216:219],a[192:195],v[80:83]
v_lshlrev_b32 v235,16,v211
v_fmac_f32 v232,s43,v234
M v[84:87],v[216:219],a[196:199],v[84:87]
v_fmac_f32 v237,4.0,v233
v_fma_f32 v238,-4.0,v234,v236
M v[88:91],v[216:219],a[200:203],v[88:91]
v_fmac_f32 v232,s45,v236
v_fmac_f32 v237,s40,v235
M v[92:95],v[216:219],a[204:207],v[92:95]
s_waitcnt vmcnt(12)
buffer_load_dwordx4 v[216:219],v251,s[20:23],s48 offen offset:1024
M v[0:3],v[220:223],a[212:215],v[0:3]
v_sub_f32 v236,v236,v234
v_fma_f32 v234,-4.0,v233,v235
M v[4:7],v[220:223],a[216:219],v[4:7]
v_sub_f32 v235,v235,v233
v_add_f32 v233,v238,v234
M v[8:11],v[220:223],a[220:223],v[8:11]
v_sub_f32 v238,v238,v234
v_fma_f32 v234,2.0,v235,v236
M v[12:15],v[220:223],a[192:195],v[12:15]
v_fmac_f32 v236,-2.0,v235
v_and_b32 v209,s42,v209
M v[16:19],v[220:223],a[196:199],v[16:19]
v_and_b32 v205,s42,v205
v_and_b32 v207,s42,v207
M v[20:23],v[220:223],a[200:203],v[20:23]
v_and_b32 v215,s42,v215
v_and_b32 v213,s42,v213
M v[24:27],v[220:223],a[204:207],v[24:27]
s_waitcnt lgkmcnt(0)
v_and_b32 v211,s42,v211
v_fmac_f32 v205,s43,v209
M v[28:31],v[220:223],a[208:211],v[28:31]
s_waitcnt vmcnt(12)
buffer_load_dwordx4 v[220:223],v251,s[20:23],s46 offen offset:2048
M v[32:35],v[224:227],a[212:215],v[32:35]
v_fmac_f32 v215,4.0,v207
v_fma_f32 v235,-4.0,v209,v213
M v[36:39],v[224:227],a[216:219],v[36:39]
v_fmac_f32 v205,s45,v213
v_fmac_f32 v215,s40,v211
M v[40:43],v[224:227],a[220:223],v[40:43]
v_sub_f32 v213,v213,v209
v_fma_f32 v209,-4.0,v207,v211
M v[44:47],v[224:227],a[192:195],v[44:47]
v_sub_f32 v211,v211,v207
v_add_f32 v207,v235,v209
M v[48:51],v[224:227],a[196:199],v[48:51]
v_sub_f32 v235,v235,v209
v_fma_f32 v209,2.0,v211,v213
M v[52:55],v[224:227],a[200:203],v[52:55]
v_fmac_f32 v213,-2.0,v211
v_cvt_pk_bf16_f32 v205,v232,v205
M v[56:59],v[224:227],a[204:207],v[56:59]
v_cvt_pk_bf16_f32 v215,v237,v215
v_cvt_pk_bf16_f32 v207,v233,v207
M v[60:63],v[224:227],a[208:211],v[60:63]
s_waitcnt vmcnt(12)
buffer_load_dwordx4 v[224:227],v251,s[20:23],s47 offen offset:2048
M v[64:67],v[228:231],a[212:215],v[64:67]
ds_read_b128 a[212:215],v249 offset:19712
v_cvt_pk_bf16_f32 v211,v234,v209
M v[68:71],v[228:231],a[216:219],v[68:71]
v_cvt_pk_bf16_f32 v209,v238,v235
v_cvt_pk_bf16_f32 v213,v236,v213
M v[72:75],v[228:231],a[220:223],v[72:75]
ds_write2st64_b64 v247,v[204:205],v[214:215] offset0:137 offset1:154
M v[76:79],v[228:231],a[192:195],v[76:79]
s_add_u32 s28,s69,7471104
buffer_load_dwordx2 v[204:205],v245,s[12:15],s28 offen offset:0
M v[80:83],v[228:231],a[196:199],v[80:83]
buffer_load_dwordx2 v[214:215],v245,s[16:19],s28 offen offset:1536
M v[84:87],v[228:231],a[200:203],v[84:87]
ds_write2st64_b64 v247,v[206:207],v[208:209] offset0:1 offset1:18
M v[88:91],v[228:231],a[204:207],v[88:91]
buffer_load_dwordx2 v[206:207],v245,s[8:11],s28 offen offset:0
M v[92:95],v[228:231],a[208:211],v[92:95]
s_waitcnt vmcnt(15)
buffer_load_dwordx2 v[208:209],v245,s[8:11],s28 offen offset:384
M v[0:3],a[224:227],a[216:219],v[0:3]
buffer_load_dwordx4 v[228:231],v251,s[20:23],s48 offen offset:2048
M v[4:7],a[224:227],a[220:223],v[4:7]
s_add_u32 s46,s81,9216
ds_write2st64_b64 v247,v[210:211],v[212:213] offset0:35 offset1:52
M v[8:11],a[224:227],a[192:195],v[8:11]
buffer_load_dwordx2 v[210:211],v245,s[8:11],s28 offen offset:768
M v[12:15],a[224:227],a[196:199],v[12:15]
buffer_load_dwordx2 v[212:213],v245,s[8:11],s28 offen offset:1152
M v[16:19],a[224:227],a[200:203],v[16:19]
v_fmac_f32 v239,s43,v241
v_fmac_f32 v244,4.0,v240
M v[20:23],a[224:227],a[204:207],v[20:23]
v_fma_f32 v232,-4.0,v241,v243
v_fmac_f32 v239,s45,v243
M v[24:27],a[224:227],a[208:211],v[24:27]
s_waitcnt lgkmcnt(3)
v_fmac_f32 v244,s40,v242
v_sub_f32 v243,v243,v241
M v[28:31],a[224:227],a[212:215],v[28:31]
s_waitcnt vmcnt(18)
buffer_load_dwordx4 a[224:227],v251,s[20:23],s46 offen offset:0
M v[32:35],a[228:231],a[216:219],v[32:35]
v_fma_f32 v241,-4.0,v240,v242
v_sub_f32 v242,v242,v240
M v[36:39],a[228:231],a[220:223],v[36:39]
v_add_f32 v240,v232,v241
v_sub_f32 v232,v232,v241
M v[40:43],a[228:231],a[192:195],v[40:43]
v_fma_f32 v241,2.0,v242,v243
v_fmac_f32 v243,-2.0,v242
M v[44:47],a[228:231],a[196:199],v[44:47]
v_cvt_pk_bf16_f32 v233,v239,v244
v_cvt_pk_bf16_f32 v234,v240,v232
M v[48:51],a[228:231],a[200:203],v[48:51]
v_cvt_pk_bf16_f32 v235,v241,v243
v_add_u32 v232,69632,v248
M v[52:55],a[228:231],a[204:207],v[52:55]
ds_write_b16 v232,v233 offset:0
M v[56:59],a[228:231],a[208:211],v[56:59]
ds_write_b16_d16_hi v232,v233 offset:8704
M v[60:63],a[228:231],a[212:215],v[60:63]
s_waitcnt vmcnt(18)
buffer_load_dwordx4 a[228:231],v251,s[20:23],s46 offen offset:1024
M v[64:67],a[232:235],a[216:219],v[64:67]
ds_read_b128 a[216:219],v249 offset:26112
ds_write_b16 v248,v234 offset:0
M v[68:71],a[232:235],a[220:223],v[68:71]
ds_read_b128 a[220:223],v250 offset:26368
ds_write_b16_d16_hi v248,v234 offset:8704
M v[72:75],a[232:235],a[192:195],v[72:75]
ds_read_b128 a[192:195],v250 offset:26624
ds_write_b16 v248,v235 offset:17408
M v[76:79],a[232:235],a[196:199],v[76:79]
ds_read_b128 a[196:199],v250 offset:26880
ds_write_b16_d16_hi v248,v235 offset:26112
M v[80:83],a[232:235],a[200:203],v[80:83]
ds_read_b128 a[200:203],v250 offset:27136
v_lshlrev_b32 v234,16,v196
M v[84:87],a[232:235],a[204:207],v[84:87]
ds_read_b128 a[204:207],v250 offset:27392
v_lshlrev_b32 v232,16,v192
M v[88:91],a[232:235],a[208:211],v[88:91]
ds_read_b128 a[208:211],v250 offset:27648
v_lshlrev_b32 v233,16,v194
M v[92:95],a[232:235],a[212:215],v[92:95]
s_waitcnt vmcnt(18) lgkmcnt(10)
buffer_load_dwordx4 a[232:235],v251,s[20:23],s46 offen offset:2048
M v[96:99],a[236:239],a[216:219],v[96:99]
s_waitcnt lgkmcnt(8)
ds_read_b128 a[212:215],v250 offset:27904
v_lshlrev_b32 v237,16,v202
M v[100:103],a[236:239],a[220:223],v[100:103]
s_waitcnt vmcnt(17) lgkmcnt(7)
s_add_u32 s46,s81,18432
v_lshlrev_b32 v236,16,v200
v_lshlrev_b32 v235,16,v198
M v[104:107],a[236:239],a[192:195],v[104:107]
s_waitcnt lgkmcnt(5)
v_fmac_f32 v232,s43,v234
v_fmac_f32 v237,4.0,v233
M v[108:111],a[236:239],a[196:199],v[108:111]
s_waitcnt lgkmcnt(3)
v_fma_f32 v238,-4.0,v234,v236
v_fmac_f32 v232,s45,v236
M v[112:115],a[236:239],a[200:203],v[112:115]
s_waitcnt lgkmcnt(2)
v_fmac_f32 v237,s40,v235
v_sub_f32 v236,v236,v234
M v[116:119],a[236:239],a[204:207],v[116:119]
s_waitcnt lgkmcnt(1)
v_fma_f32 v234,-4.0,v233,v235
v_sub_f32 v235,v235,v233
M v[120:123],a[236:239],a[208:211],v[120:123]
s_waitcnt lgkmcnt(0)
v_add_f32 v233,v238,v234
v_sub_f32 v238,v238,v234
M v[124:127],a[236:239],a[212:215],v[124:127]
s_waitcnt vmcnt(16)
buffer_load_dwordx4 a[236:239],v251,s[20:23],s46 offen offset:0
M v[128:131],a[240:243],a[216:219],v[128:131]
v_fma_f32 v234,2.0,v235,v236
v_fmac_f32 v236,-2.0,v235
M v[132:135],a[240:243],a[220:223],v[132:135]
v_and_b32 v196,s42,v196
v_and_b32 v192,s42,v192
M v[136:139],a[240:243],a[192:195],v[136:139]
v_and_b32 v194,s42,v194
v_and_b32 v202,s42,v202
M v[140:143],a[240:243],a[196:199],v[140:143]
v_and_b32 v200,s42,v200
v_and_b32 v198,s42,v198
M v[144:147],a[240:243],a[200:203],v[144:147]
v_fmac_f32 v192,s43,v196
v_fmac_f32 v202,4.0,v194
M v[148:151],a[240:243],a[204:207],v[148:151]
v_fma_f32 v235,-4.0,v196,v200
v_fmac_f32 v192,s45,v200
M v[152:155],a[240:243],a[208:211],v[152:155]
v_fmac_f32 v202,s40,v198
v_sub_f32 v200,v200,v196
M v[156:159],a[240:243],a[212:215],v[156:159]
s_waitcnt vmcnt(16)
buffer_load_dwordx4 a[240:243],v251,s[20:23],s46 offen offset:1024
M v[160:163],a[244:247],a[216:219],v[160:163]
ds_read_b128 a[216:219],v250 offset:28160
v_fma_f32 v196,-4.0,v194,v198
v_sub_f32 v198,v198,v194
M v[164:167],a[244:247],a[220:223],v[164:167]
v_add_f32 v194,v235,v196
v_sub_f32 v235,v235,v196
v_fma_f32 v196,2.0,v198,v200
v_fmac_f32 v200,-2.0,v198
M v[168:171],a[244:247],a[192:195],v[168:171]
v_cvt_pk_bf16_f32 v192,v232,v192
v_cvt_pk_bf16_f32 v202,v237,v202
v_cvt_pk_bf16_f32 v194,v233,v194
v_cvt_pk_bf16_f32 v198,v234,v196
M v[172:175],a[244:247],a[196:199],v[172:175]
v_cvt_pk_bf16_f32 v196,v238,v235
v_cvt_pk_bf16_f32 v200,v236,v200
v_lshlrev_b32 v234,16,v197
v_lshlrev_b32 v232,16,v193
M v[176:179],a[244:247],a[200:203],v[176:179]
v_lshlrev_b32 v233,16,v195
v_lshlrev_b32 v237,16,v203
v_lshlrev_b32 v236,16,v201
v_lshlrev_b32 v235,16,v199
M v[180:183],a[244:247],a[204:207],v[180:183]
v_fmac_f32 v232,s43,v234
v_fmac_f32 v237,4.0,v233
v_fma_f32 v238,-4.0,v234,v236
v_fmac_f32 v232,s45,v236
M v[184:187],a[244:247],a[208:211],v[184:187]
v_fmac_f32 v237,s40,v235
v_sub_f32 v236,v236,v234
v_fma_f32 v234,-4.0,v233,v235
v_sub_f32 v235,v235,v233
M v[188:191],a[244:247],a[212:215],v[188:191]
s_waitcnt vmcnt(16)
buffer_load_dwordx4 a[244:247],v251,s[20:23],s46 offen offset:2048
v_add_f32 v233,v238,v234
v_sub_f32 v238,v238,v234
v_fma_f32 v234,2.0,v235,v236
v_fmac_f32 v236,-2.0,v235
M v[96:99],a[248:251],a[220:223],v[96:99]
v_and_b32 v197,s42,v197
v_and_b32 v193,s42,v193
v_and_b32 v195,s42,v195
v_and_b32 v203,s42,v203
M v[100:103],a[248:251],a[192:195],v[100:103]
s_add_u32 s46,s81,27648
v_and_b32 v201,s42,v201
v_and_b32 v199,s42,v199
v_fmac_f32 v193,s43,v197
v_fmac_f32 v203,4.0,v195
M v[104:107],a[248:251],a[196:199],v[104:107]
v_fma_f32 v235,-4.0,v197,v201
v_fmac_f32 v193,s45,v201
v_fmac_f32 v203,s40,v199
v_sub_f32 v201,v201,v197
M v[108:111],a[248:251],a[200:203],v[108:111]
v_fma_f32 v197,-4.0,v195,v199
v_sub_f32 v199,v199,v195
v_add_f32 v195,v235,v197
v_sub_f32 v235,v235,v197
M v[112:115],a[248:251],a[204:207],v[112:115]
v_fma_f32 v197,2.0,v199,v201
v_fmac_f32 v201,-2.0,v199
v_cvt_pk_bf16_f32 v193,v232,v193
v_cvt_pk_bf16_f32 v203,v237,v203
M v[116:119],a[248:251],a[208:211],v[116:119]
v_cvt_pk_bf16_f32 v195,v233,v195
v_cvt_pk_bf16_f32 v199,v234,v197
v_cvt_pk_bf16_f32 v197,v238,v235
v_cvt_pk_bf16_f32 v201,v236,v201
M v[120:123],a[248:251],a[212:215],v[120:123]
s_waitcnt lgkmcnt(0)
ds_write2st64_b64 v247,v[192:193],v[202:203] offset0:138 offset1:155
M v[124:127],a[248:251],a[216:219],v[124:127]
s_waitcnt vmcnt(16)
buffer_load_dwordx4 a[248:251],v251,s[20:23],s46 offen offset:0
ds_write2st64_b64 v247,v[194:195],v[196:197] offset0:2 offset1:19
M v[128:131],a[252:255],a[220:223],v[128:131]
ds_write2st64_b64 v247,v[198:199],v[200:201] offset0:36 offset1:53
M v[132:135],a[252:255],a[192:195],v[132:135]
s_waitcnt vmcnt(10)
v_lshlrev_b32 v234,16,v208
v_lshlrev_b32 v232,16,v204
M v[136:139],a[252:255],a[196:199],v[136:139]
v_lshlrev_b32 v233,16,v206
v_lshlrev_b32 v237,16,v214
M v[140:143],a[252:255],a[200:203],v[140:143]
s_waitcnt vmcnt(7)
v_lshlrev_b32 v236,16,v212
v_lshlrev_b32 v235,16,v210
M v[144:147],a[252:255],a[204:207],v[144:147]
v_fmac_f32 v232,s43,v234
v_fmac_f32 v237,4.0,v233
v_fma_f32 v238,-4.0,v234,v236
M v[148:151],a[252:255],a[208:211],v[148:151]
v_fmac_f32 v232,s45,v236
v_fmac_f32 v237,s40,v235
v_sub_f32 v236,v236,v234
v_fma_f32 v234,-4.0,v233,v235
M v[152:155],a[252:255],a[212:215],v[152:155]
v_sub_f32 v235,v235,v233
v_add_f32 v233,v238,v234
v_sub_f32 v238,v238,v234
v_fma_f32 v234,2.0,v235,v236
M v[156:159],a[252:255],a[216:219],v[156:159]
buffer_load_dwordx4 a[252:255],v251,s[20:23],s46 offen offset:1024
v_fmac_f32 v236,-2.0,v235
v_and_b32 v208,s42,v208
v_and_b32 v204,s42,v204
v_and_b32 v206,s42,v206
M v[160:163],v[216:219],a[220:223],v[160:163]
ds_read_b128 a[220:223],v249 offset:28416
v_and_b32 v214,s42,v214
v_and_b32 v212,s42,v212
v_and_b32 v210,s42,v210
v_fmac_f32 v204,s43,v208
M v[164:167],v[216:219],a[192:195],v[164:167]
v_fmac_f32 v214,4.0,v206
v_fma_f32 v235,-4.0,v208,v212
v_fmac_f32 v204,s45,v212
v_fmac_f32 v214,s40,v210
M v[168:171],v[216:219],a[196:199],v[168:171]
v_sub_f32 v212,v212,v208
v_fma_f32 v208,-4.0,v206,v210
v_sub_f32 v210,v210,v206
v_add_f32 v206,v235,v208
M v[172:175],v[216:219],a[200:203],v[172:175]
v_sub_f32 v235,v235,v208
v_fma_f32 v208,2.0,v210,v212
v_fmac_f32 v212,-2.0,v210
v_cvt_pk_bf16_f32 v204,v232,v204
M v[176:179],v[216:219],a[204:207],v[176:179]
v_cvt_pk_bf16_f32 v214,v237,v214
v_cvt_pk_bf16_f32 v206,v233,v206
v_cvt_pk_bf16_f32 v210,v234,v208
v_cvt_pk_bf16_f32 v208,v238,v235
M v[180:183],v[216:219],a[208:211],v[180:183]
v_cvt_pk_bf16_f32 v212,v236,v212
v_lshlrev_b32 v234,16,v209
v_lshlrev_b32 v232,16,v205
v_lshlrev_b32 v233,16,v207
M v[184:187],v[216:219],a[212:215],v[184:187]
v_lshlrev_b32 v237,16,v215
v_lshlrev_b32 v236,16,v213
v_lshlrev_b32 v235,16,v211
v_fmac_f32 v232,s43,v234
M v[188:191],v[216:219],a[216:219],v[188:191]
buffer_load_dwordx4 v[216:219],v251,s[20:23],s46 offen offset:2048
v_fmac_f32 v237,4.0,v233
v_fma_f32 v238,-4.0,v234,v236
v_fmac_f32 v232,s45,v236
v_fmac_f32 v237,s40,v235
M v[96:99],v[220:223],a[192:195],v[96:99]
v_sub_f32 v236,v236,v234
v_fma_f32 v234,-4.0,v233,v235
v_sub_f32 v235,v235,v233
v_add_f32 v233,v238,v234
M v[100:103],v[220:223],a[196:199],v[100:103]
s_add_u32 s46,s81,36864
v_sub_f32 v238,v238,v234
v_fma_f32 v234,2.0,v235,v236
v_fmac_f32 v236,-2.0,v235
v_and_b32 v209,s42,v209
M v[104:107],v[220:223],a[200:203],v[104:107]
v_and_b32 v205,s42,v205
v_and_b32 v207,s42,v207
v_and_b32 v215,s42,v215
v_and_b32 v213,s42,v213
M v[108:111],v[220:223],a[204:207],v[108:111]
v_and_b32 v211,s42,v211
v_fmac_f32 v205,s43,v209
v_fmac_f32 v215,4.0,v207
v_fma_f32 v235,-4.0,v209,v213
M v[112:115],v[220:223],a[208:211],v[112:115]
v_fmac_f32 v205,s45,v213
v_fmac_f32 v215,s40,v211
v_sub_f32 v213,v213,v209
v_fma_f32 v209,-4.0,v207,v211
M v[116:119],v[220:223],a[212:215],v[116:119]
v_sub_f32 v211,v211,v207
v_add_f32 v207,v235,v209
v_sub_f32 v235,v235,v209
v_fma_f32 v209,2.0,v211,v213
M v[120:123],v[220:223],a[216:219],v[120:123]
s_waitcnt lgkmcnt(0)
v_fmac_f32 v213,-2.0,v211
v_cvt_pk_bf16_f32 v205,v232,v205
v_cvt_pk_bf16_f32 v215,v237,v215
v_cvt_pk_bf16_f32 v207,v233,v207
M v[124:127],v[220:223],a[220:223],v[124:127]
buffer_load_dwordx4 v[220:223],v251,s[20:23],s46 offen offset:0
v_cvt_pk_bf16_f32 v211,v234,v209
v_cvt_pk_bf16_f32 v209,v238,v235
v_cvt_pk_bf16_f32 v213,v236,v213
M v[128:131],v[224:227],a[192:195],v[128:131]
ds_write2st64_b64 v247,v[204:205],v[214:215] offset0:139 offset1:156
M v[132:135],v[224:227],a[196:199],v[132:135]
ds_write2st64_b64 v247,v[206:207],v[208:209] offset0:3 offset1:20
M v[136:139],v[224:227],a[200:203],v[136:139]
ds_write2st64_b64 v247,v[210:211],v[212:213] offset0:37 offset1:54
M v[140:143],v[224:227],a[204:207],v[140:143]
M v[144:147],v[224:227],a[208:211],v[144:147]
M v[148:151],v[224:227],a[212:215],v[148:151]
v_add_u32 v249,0xffffbc00,v249
v_add_u32 v250,0xffffbc00,v250
M v[152:155],v[224:227],a[216:219],v[152:155]
s_waitcnt lgkmcnt(0)
s_barrier
M v[156:159],v[224:227],a[220:223],v[156:159]
buffer_load_dwordx4 v[224:227],v251,s[20:23],s46 offen offset:1024
M v[160:163],v[228:231],a[192:195],v[160:163]
ds_read_b128 a[192:195],v249 offset:0
M v[164:167],v[228:231],a[196:199],v[164:167]
ds_read_b128 a[196:199],v250 offset:256
M v[168:171],v[228:231],a[200:203],v[168:171]
ds_read_b128 a[200:203],v250 offset:512
M v[172:175],v[228:231],a[204:207],v[172:175]
ds_read_b128 a[204:207],v250 offset:768
M v[176:179],v[228:231],a[208:211],v[176:179]
ds_read_b128 a[208:211],v250 offset:1024
M v[180:183],v[228:231],a[212:215],v[180:183]
ds_read_b128 a[212:215],v250 offset:1280
M v[184:187],v[228:231],a[216:219],v[184:187]
ds_read_b128 a[216:219],v250 offset:1536
M v[188:191],v[228:231],a[220:223],v[188:191]
s_waitcnt vmcnt(10) lgkmcnt(6)
buffer_load_dwordx4 v[228:231],v251,s[20:23],s46 offen offset:2048
M a[0:3],a[224:227],a[192:195],a[0:3]
s_waitcnt lgkmcnt(5)
ds_read_b128 a[220:223],v250 offset:1792
ds_read_b128 a[192:195],v250 offset:2048
M a[4:7],a[224:227],a[196:199],a[4:7]
s_waitcnt lgkmcnt(6)
s_add_u32 s47,s81,12288
M a[8:11],a[224:227],a[200:203],a[8:11]
s_waitcnt lgkmcnt(5)
M a[12:15],a[224:227],a[204:207],a[12:15]
s_waitcnt lgkmcnt(4)
M a[16:19],a[224:227],a[208:211],a[16:19]
s_waitcnt lgkmcnt(3)
M a[20:23],a[224:227],a[212:215],a[20:23]
s_waitcnt lgkmcnt(2)
M a[24:27],a[224:227],a[216:219],a[24:27]
s_waitcnt lgkmcnt(1)
M a[28:31],a[224:227],a[220:223],a[28:31]
s_waitcnt vmcnt(10)
buffer_load_dwordx4 a[224:227],v251,s[20:23],s47 offen offset:0
M a[0:3],a[228:231],a[196:199],a[0:3]
ds_read_b128 a[196:199],v249 offset:2304
M a[4:7],a[228:231],a[200:203],a[4:7]
s_add_u32 s48,s81,15360
M a[8:11],a[228:231],a[204:207],a[8:11]
M a[12:15],a[228:231],a[208:211],a[12:15]
M a[16:19],a[228:231],a[212:215],a[16:19]
M a[20:23],a[228:231],a[216:219],a[20:23]
M a[24:27],a[228:231],a[220:223],a[24:27]
s_waitcnt lgkmcnt(1)
M a[28:31],a[228:231],a[192:195],a[28:31]
s_waitcnt vmcnt(10)
buffer_load_dwordx4 a[228:231],v251,s[20:23],s48 offen offset:0
M a[0:3],a[232:235],a[200:203],a[0:3]
ds_read_b128 a[200:203],v249 offset:8704
M a[4:7],a[232:235],a[204:207],a[4:7]
ds_read_b128 a[204:207],v250 offset:8960
M a[8:11],a[232:235],a[208:211],a[8:11]
ds_read_b128 a[208:211],v250 offset:9216
M a[12:15],a[232:235],a[212:215],a[12:15]
ds_read_b128 a[212:215],v250 offset:9472
M a[16:19],a[232:235],a[216:219],a[16:19]
ds_read_b128 a[216:219],v250 offset:9728
M a[20:23],a[232:235],a[220:223],a[20:23]
ds_read_b128 a[220:223],v250 offset:9984
M a[24:27],a[232:235],a[192:195],a[24:27]
s_waitcnt lgkmcnt(6)
ds_read_b128 a[192:195],v250 offset:10240
M a[28:31],a[232:235],a[196:199],a[28:31]
s_waitcnt vmcnt(10) lgkmcnt(6)
buffer_load_dwordx4 a[232:235],v251,s[20:23],s47 offen offset:1024
M a[96:99],a[236:239],a[200:203],a[96:99]
s_waitcnt lgkmcnt(5)
ds_read_b128 a[196:199],v250 offset:10496
ds_read_b128 a[200:203],v250 offset:10752
M a[100:103],a[236:239],a[204:207],a[100:103]
s_waitcnt lgkmcnt(6)
M a[104:107],a[236:239],a[208:211],a[104:107]
s_waitcnt lgkmcnt(5)
M a[108:111],a[236:239],a[212:215],a[108:111]
s_waitcnt lgkmcnt(4)
M a[112:115],a[236:239],a[216:219],a[112:115]
s_waitcnt lgkmcnt(3)
M a[116:119],a[236:239],a[220:223],a[116:119]
s_waitcnt lgkmcnt(2)
M a[120:123],a[236:239],a[192:195],a[120:123]
s_waitcnt lgkmcnt(1)
M a[124:127],a[236:239],a[196:199],a[124:127]
s_waitcnt vmcnt(10)
buffer_load_dwordx4 a[236:239],v251,s[20:23],s48 offen offset:1024
M a[96:99],a[240:243],a[204:207],a[96:99]
ds_read_b128 a[204:207],v249 offset:11008
M a[100:103],a[240:243],a[208:211],a[100:103]
M a[104:107],a[240:243],a[212:215],a[104:107]
M a[108:111],a[240:243],a[216:219],a[108:111]
M a[112:115],a[240:243],a[220:223],a[112:115]
M a[116:119],a[240:243],a[192:195],a[116:119]
M a[120:123],a[240:243],a[196:199],a[120:123]
s_waitcnt lgkmcnt(1)
M a[124:127],a[240:243],a[200:203],a[124:127]
s_waitcnt vmcnt(10)
buffer_load_dwordx4 a[240:243],v251,s[20:23],s47 offen offset:2048
M a[96:99],a[244:247],a[208:211],a[96:99]
ds_read_b128 a[208:211],v249 offset:17408
M a[100:103],a[244:247],a[212:215],a[100:103]
ds_read_b128 a[212:215],v250 offset:17664
M a[104:107],a[244:247],a[216:219],a[104:107]
ds_read_b128 a[216:219],v250 offset:17920
M a[108:111],a[244:247],a[220:223],a[108:111]
ds_read_b128 a[220:223],v250 offset:18176
M a[112:115],a[244:247],a[192:195],a[112:115]
ds_read_b128 a[192:195],v250 offset:18432
M a[116:119],a[244:247],a[196:199],a[116:119]
ds_read_b128 a[196:199],v250 offset:18688
M a[120:123],a[244:247],a[200:203],a[120:123]
s_waitcnt lgkmcnt(6)
ds_read_b128 a[200:203],v250 offset:18944
M a[124:127],a[244:247],a[204:207],a[124:127]
s_waitcnt vmcnt(10) lgkmcnt(6)
buffer_load_dwordx4 a[244:247],v251,s[20:23],s48 offen offset:2048
M v[0:3],a[248:251],a[208:211],v[0:3]
s_waitcnt lgkmcnt(5)
ds_read_b128 a[204:207],v250 offset:19200
ds_read_b128 a[208:211],v250 offset:19456
M v[4:7],a[248:251],a[212:215],v[4:7]
s_waitcnt lgkmcnt(6)
s_add_u32 s47,s81,21504
M v[8:11],a[248:251],a[216:219],v[8:11]
s_waitcnt lgkmcnt(5)
M v[12:15],a[248:251],a[220:223],v[12:15]
s_waitcnt lgkmcnt(4)
M v[16:19],a[248:251],a[192:195],v[16:19]
s_waitcnt lgkmcnt(3)
M v[20:23],a[248:251],a[196:199],v[20:23]
s_waitcnt lgkmcnt(2)
M v[24:27],a[248:251],a[200:203],v[24:27]
s_waitcnt lgkmcnt(1)
M v[28:31],a[248:251],a[204:207],v[28:31]
s_waitcnt vmcnt(10)
buffer_load_dwordx4 a[248:251],v251,s[20:23],s47 offen offset:0
M v[0:3],a[252:255],a[212:215],v[0:3]
ds_read_b128 a[212:215],v249 offset:19712
M v[4:7],a[252:255],a[216:219],v[4:7]
s_add_u32 s48,s81,24576
M v[8:11],a[252:255],a[220:223],v[8:11]
M v[12:15],a[252:255],a[192:195],v[12:15]
M v[16:19],a[252:255],a[196:199],v[16:19]
M v[20:23],a[252:255],a[200:203],v[20:23]
M v[24:27],a[252:255],a[204:207],v[24:27]
s_waitcnt lgkmcnt(1)
M v[28:31],a[252:255],a[208:211],v[28:31]
s_waitcnt vmcnt(10)
buffer_load_dwordx4 a[252:255],v251,s[20:23],s48 offen offset:0
M v[0:3],v[216:219],a[216:219],v[0:3]
ds_read_b128 a[216:219],v249 offset:26112
M v[4:7],v[216:219],a[220:223],v[4:7]
ds_read_b128 a[220:223],v250 offset:26368
M v[8:11],v[216:219],a[192:195],v[8:11]
ds_read_b128 a[192:195],v250 offset:26624
M v[12:15],v[216:219],a[196:199],v[12:15]
ds_read_b128 a[196:199],v250 offset:26880
M v[16:19],v[216:219],a[200:203],v[16:19]
ds_read_b128 a[200:203],v250 offset:27136
M v[20:23],v[216:219],a[204:207],v[20:23]
ds_read_b128 a[204:207],v250 offset:27392
M v[24:27],v[216:219],a[208:211],v[24:27]
s_waitcnt lgkmcnt(6)
ds_read_b128 a[208:211],v250 offset:27648
M v[28:31],v[216:219],a[212:215],v[28:31]
s_waitcnt vmcnt(10) lgkmcnt(6)
buffer_load_dwordx4 v[216:219],v251,s[20:23],s47 offen offset:1024
M v[96:99],v[220:223],a[216:219],v[96:99]
s_waitcnt lgkmcnt(5)
ds_read_b128 a[212:215],v250 offset:27904
ds_read_b128 a[216:219],v250 offset:28160
M v[100:103],v[220:223],a[220:223],v[100:103]
s_waitcnt lgkmcnt(6)
M v[104:107],v[220:223],a[192:195],v[104:107]
s_waitcnt lgkmcnt(5)
M v[108:111],v[220:223],a[196:199],v[108:111]
s_waitcnt lgkmcnt(4)
M v[112:115],v[220:223],a[200:203],v[112:115]
s_waitcnt lgkmcnt(3)
M v[116:119],v[220:223],a[204:207],v[116:119]
s_waitcnt lgkmcnt(2)
M v[120:123],v[220:223],a[208:211],v[120:123]
s_waitcnt lgkmcnt(1)
M v[124:127],v[220:223],a[212:215],v[124:127]
s_waitcnt vmcnt(10)
buffer_load_dwordx4 v[220:223],v251,s[20:23],s48 offen offset:1024
M v[96:99],v[224:227],a[220:223],v[96:99]
ds_read_b128 a[220:223],v249 offset:28416
M v[100:103],v[224:227],a[192:195],v[100:103]
M v[104:107],v[224:227],a[196:199],v[104:107]
M v[108:111],v[224:227],a[200:203],v[108:111]
M v[112:115],v[224:227],a[204:207],v[112:115]
M v[116:119],v[224:227],a[208:211],v[116:119]
M v[120:123],v[224:227],a[212:215],v[120:123]
s_waitcnt lgkmcnt(1)
M v[124:127],v[224:227],a[216:219],v[124:127]
s_waitcnt vmcnt(10)
buffer_load_dwordx4 v[224:227],v251,s[20:23],s47 offen offset:2048
M v[96:99],v[228:231],a[192:195],v[96:99]
ds_read_b128 a[192:195],v249 offset:0
M v[100:103],v[228:231],a[196:199],v[100:103]
ds_read_b128 a[196:199],v250 offset:256
M v[104:107],v[228:231],a[200:203],v[104:107]
ds_read_b128 a[200:203],v250 offset:512
M v[108:111],v[228:231],a[204:207],v[108:111]
ds_read_b128 a[204:207],v250 offset:768
v_accvgpr_read_b32 v238,a0
M v[112:115],v[228:231],a[208:211],v[112:115]
ds_read_b128 a[208:211],v250 offset:1024
v_accvgpr_read_b32 v232,a96
M v[116:119],v[228:231],a[212:215],v[116:119]
ds_read_b128 a[212:215],v250 offset:1280
v_add_f32 v234,v238,v232
M v[120:123],v[228:231],a[216:219],v[120:123]
s_waitcnt lgkmcnt(6)
ds_read_b128 a[216:219],v250 offset:1536
v_sub_f32 v238,v238,v232
M v[124:127],v[228:231],a[220:223],v[124:127]
s_waitcnt vmcnt(10) lgkmcnt(6)
buffer_load_dwordx4 v[228:231],v251,s[20:23],s48 offen offset:2048
M a[32:35],a[224:227],a[192:195],a[32:35]
s_waitcnt lgkmcnt(5)
ds_read_b128 a[220:223],v250 offset:1792
v_add_f32 v232,v0,v96
M a[36:39],a[224:227],a[196:199],a[36:39]
s_waitcnt lgkmcnt(5)
s_add_u32 s47,s81,30720
v_sub_f32 v96,v0,v96
v_add_f32 v0,v234,v232
M a[40:43],a[224:227],a[200:203],a[40:43]
s_waitcnt lgkmcnt(4)
v_fmac_f32 v234,4.0,v232
v_fma_f32 v232,2.0,v96,v238
M a[44:47],a[224:227],a[204:207],a[44:47]
s_waitcnt lgkmcnt(3)
v_fma_f32 v96,s41,v96,v238
v_accvgpr_read_b32 v238,a1
M a[48:51],a[224:227],a[208:211],a[48:51]
s_waitcnt lgkmcnt(2)
v_accvgpr_read_b32 v237,a97
v_add_f32 v236,v238,v237
M a[52:55],a[224:227],a[212:215],a[52:55]
s_waitcnt lgkmcnt(1)
v_sub_f32 v238,v238,v237
v_add_f32 v237,v1,v97
M a[56:59],a[224:227],a[216:219],a[56:59]
s_waitcnt lgkmcnt(0)
v_sub_f32 v97,v1,v97
v_add_f32 v1,v236,v237
M a[60:63],a[224:227],a[220:223],a[60:63]
s_waitcnt vmcnt(10)
buffer_load_dwordx4 a[224:227],v251,s[20:23],s47 offen offset:0
M a[64:67],a[228:231],a[192:195],a[64:67]
ds_read_b128 a[192:195],v250 offset:2048
v_fmac_f32 v236,4.0,v237
M a[68:71],a[228:231],a[196:199],a[68:71]
s_add_u32 s48,s81,33792
v_fma_f32 v237,2.0,v97,v238
v_fma_f32 v97,s41,v97,v238
M a[72:75],a[228:231],a[200:203],a[72:75]
v_cvt_pk_bf16_f32 v232,v232,v237
v_cvt_pk_bf16_f32 v234,v234,v236
M a[76:79],a[228:231],a[204:207],a[76:79]
v_accvgpr_read_b32 v238,a2
v_accvgpr_read_b32 v233,a98
M a[80:83],a[228:231],a[208:211],a[80:83]
v_add_f32 v235,v238,v233
v_sub_f32 v238,v238,v233
M a[84:87],a[228:231],a[212:215],a[84:87]
v_add_f32 v233,v2,v98
v_sub_f32 v98,v2,v98
M a[88:91],a[228:231],a[216:219],a[88:91]
v_add_f32 v2,v235,v233
v_fmac_f32 v235,4.0,v233
M a[92:95],a[228:231],a[220:223],a[92:95]
s_waitcnt vmcnt(10)
buffer_load_dwordx4 a[228:231],v251,s[20:23],s48 offen offset:0
M a[32:35],a[232:235],a[196:199],a[32:35]
v_fma_f32 v233,2.0,v98,v238
v_fma_f32 v98,s41,v98,v238
M a[36:39],a[232:235],a[200:203],a[36:39]
v_accvgpr_read_b32 v238,a3
v_accvgpr_read_b32 v237,a99
M a[40:43],a[232:235],a[204:207],a[40:43]
v_add_f32 v236,v238,v237
v_sub_f32 v238,v238,v237
M a[44:47],a[232:235],a[208:211],a[44:47]
v_add_f32 v237,v3,v99
v_sub_f32 v99,v3,v99
M a[48:51],a[232:235],a[212:215],a[48:51]
v_add_f32 v3,v236,v237
v_fmac_f32 v236,4.0,v237
M a[52:55],a[232:235],a[216:219],a[52:55]
v_fma_f32 v237,2.0,v99,v238
v_fma_f32 v99,s41,v99,v238
M a[56:59],a[232:235],a[220:223],a[56:59]
s_waitcnt lgkmcnt(0)
v_cvt_pk_bf16_f32 v233,v233,v237
v_cvt_pk_bf16_f32 v235,v235,v236
M a[60:63],a[232:235],a[192:195],a[60:63]
s_waitcnt vmcnt(10)
buffer_load_dwordx4 a[232:235],v251,s[20:23],s47 offen offset:1024
M a[64:67],a[236:239],a[196:199],a[64:67]
ds_read_b128 a[196:199],v249 offset:2304
ds_write2st64_b64 v253,v[232:233],v[234:235] offset0:68 offset1:72
M a[68:71],a[236:239],a[200:203],a[68:71]
v_accvgpr_read_b32 v238,a4
v_accvgpr_read_b32 v232,a100
M a[72:75],a[236:239],a[204:207],a[72:75]
v_add_f32 v234,v238,v232
v_sub_f32 v238,v238,v232
M a[76:79],a[236:239],a[208:211],a[76:79]
v_add_f32 v232,v4,v100
v_sub_f32 v100,v4,v100
M a[80:83],a[236:239],a[212:215],a[80:83]
v_add_f32 v4,v234,v232
v_fmac_f32 v234,4.0,v232
M a[84:87],a[236:239],a[216:219],a[84:87]
v_fma_f32 v232,2.0,v100,v238
v_fma_f32 v100,s41,v100,v238
M a[88:91],a[236:239],a[220:223],a[88:91]
v_accvgpr_read_b32 v238,a5
v_accvgpr_read_b32 v237,a101
M a[92:95],a[236:239],a[192:195],a[92:95]
s_waitcnt vmcnt(10)
buffer_load_dwordx4 a[236:239],v251,s[20:23],s48 offen offset:1024
M a[32:35],a[240:243],a[200:203],a[32:35]
v_add_f32 v236,v238,v237
v_sub_f32 v238,v238,v237
M a[36:39],a[240:243],a[204:207],a[36:39]
v_add_f32 v237,v5,v101
v_sub_f32 v101,v5,v101
M a[40:43],a[240:243],a[208:211],a[40:43]
v_add_f32 v5,v236,v237
v_fmac_f32 v236,4.0,v237
M a[44:47],a[240:243],a[212:215],a[44:47]
v_fma_f32 v237,2.0,v101,v238
v_fma_f32 v101,s41,v101,v238
M a[48:51],a[240:243],a[216:219],a[48:51]
v_cvt_pk_bf16_f32 v232,v232,v237
v_cvt_pk_bf16_f32 v234,v234,v236
M a[52:55],a[240:243],a[220:223],a[52:55]
v_accvgpr_read_b32 v238,a6
v_accvgpr_read_b32 v233,a102
M a[56:59],a[240:243],a[192:195],a[56:59]
s_waitcnt lgkmcnt(1)
v_add_f32 v235,v238,v233
v_sub_f32 v238,v238,v233
M a[60:63],a[240:243],a[196:199],a[60:63]
s_waitcnt vmcnt(10)
buffer_load_dwordx4 a[240:243],v251,s[20:23],s47 offen offset:2048
M a[64:67],a[244:247],a[200:203],a[64:67]
ds_read_b128 a[200:203],v249 offset:8704
v_add_f32 v233,v6,v102
M a[68:71],a[244:247],a[204:207],a[68:71]
ds_read_b128 a[204:207],v250 offset:8960
v_sub_f32 v102,v6,v102
M a[72:75],a[244:247],a[208:211],a[72:75]
ds_read_b128 a[208:211],v250 offset:9216
v_add_f32 v6,v235,v233
M a[76:79],a[244:247],a[212:215],a[76:79]
ds_read_b128 a[212:215],v250 offset:9472
v_fmac_f32 v235,4.0,v233
M a[80:83],a[244:247],a[216:219],a[80:83]
ds_read_b128 a[216:219],v250 offset:9728
v_fma_f32 v233,2.0,v102,v238
M a[84:87],a[244:247],a[220:223],a[84:87]
ds_read_b128 a[220:223],v250 offset:9984
v_fma_f32 v102,s41,v102,v238
M a[88:91],a[244:247],a[192:195],a[88:91]
ds_read_b128 a[192:195],v250 offset:10240
v_accvgpr_read_b32 v238,a7
M a[92:95],a[244:247],a[196:199],a[92:95]
s_waitcnt vmcnt(10) lgkmcnt(6)
buffer_load_dwordx4 a[244:247],v251,s[20:23],s48 offen offset:2048
M a[128:131],a[248:251],a[200:203],a[128:131]
s_waitcnt lgkmcnt(5)
ds_read_b128 a[196:199],v250 offset:10496
v_accvgpr_read_b32 v237,a103
M a[132:135],a[248:251],a[204:207],a[132:135]
s_waitcnt lgkmcnt(5)
s_add_u32 s47,s81,39936
v_add_f32 v236,v238,v237
v_sub_f32 v238,v238,v237
M a[136:139],a[248:251],a[208:211],a[136:139]
s_waitcnt lgkmcnt(4)
v_add_f32 v237,v7,v103
v_sub_f32 v103,v7,v103
M a[140:143],a[248:251],a[212:215],a[140:143]
s_waitcnt lgkmcnt(3)
v_add_f32 v7,v236,v237
v_fmac_f32 v236,4.0,v237
M a[144:147],a[248:251],a[216:219],a[144:147]
s_waitcnt lgkmcnt(2)
v_fma_f32 v237,2.0,v103,v238
v_fma_f32 v103,s41,v103,v238
M a[148:151],a[248:251],a[220:223],a[148:151]
s_waitcnt lgkmcnt(1)
v_cvt_pk_bf16_f32 v233,v233,v237
v_cvt_pk_bf16_f32 v235,v235,v236
M a[152:155],a[248:251],a[192:195],a[152:155]
s_waitcnt lgkmcnt(0)
ds_write2st64_b64 v253,v[232:233],v[234:235] offset0:76 offset1:80
M a[156:159],a[248:251],a[196:199],a[156:159]
s_waitcnt vmcnt(10)
buffer_load_dwordx4 a[248:251],v251,s[20:23],s47 offen offset:0
M a[160:163],a[252:255],a[200:203],a[160:163]
ds_read_b128 a[200:203],v250 offset:10752
v_accvgpr_read_b32 v238,a8
M a[164:167],a[252:255],a[204:207],a[164:167]
s_add_u32 s48,s81,43008
v_accvgpr_read_b32 v232,a104
v_add_f32 v234,v238,v232
M a[168:171],a[252:255],a[208:211],a[168:171]
v_sub_f32 v238,v238,v232
v_add_f32 v232,v8,v104
M a[172:175],a[252:255],a[212:215],a[172:175]
v_sub_f32 v104,v8,v104
M a[176:179],a[252:255],a[216:219],a[176:179]
s_waitcnt lgkmcnt(1)
s_barrier
ds_read_b128 a[0:3],v251 offset:34816
M a[180:183],a[252:255],a[220:223],a[180:183]
ds_read_b128 a[4:7],v251 offset:38912
v_add_f32 v8,v234,v232
M a[184:187],a[252:255],a[192:195],a[184:187]
v_fmac_f32 v234,4.0,v232
v_fma_f32 v232,2.0,v104,v238
M a[188:191],a[252:255],a[196:199],a[188:191]
s_waitcnt vmcnt(10)
buffer_load_dwordx4 a[252:255],v251,s[20:23],s48 offen offset:0
M a[128:131],v[216:219],a[204:207],a[128:131]
v_fma_f32 v104,s41,v104,v238
v_accvgpr_read_b32 v238,a9
M a[132:135],v[216:219],a[208:211],a[132:135]
s_waitcnt lgkmcnt(1)
s_add_u32 s34,s32,6291456
buffer_store_dwordx4 a[0:3],v252,s[24:27],s34 offen offset:384 nt
M a[136:139],v[216:219],a[212:215],a[136:139]
v_accvgpr_read_b32 v237,a105
v_add_f32 v236,v238,v237
M a[140:143],v[216:219],a[216:219],a[140:143]
v_sub_f32 v238,v238,v237
v_add_f32 v237,v9,v105
M a[144:147],v[216:219],a[220:223],a[144:147]
v_sub_f32 v105,v9,v105
v_add_f32 v9,v236,v237
M a[148:151],v[216:219],a[192:195],a[148:151]
v_fmac_f32 v236,4.0,v237
v_fma_f32 v237,2.0,v105,v238
M a[152:155],v[216:219],a[196:199],a[152:155]
v_fma_f32 v105,s41,v105,v238
v_cvt_pk_bf16_f32 v232,v232,v237
M a[156:159],v[216:219],a[200:203],a[156:159]
s_waitcnt vmcnt(11)
buffer_load_dwordx4 v[216:219],v251,s[20:23],s47 offen offset:1024
M a[160:163],v[220:223],a[204:207],a[160:163]
ds_read_b128 a[204:207],v249 offset:11008
v_cvt_pk_bf16_f32 v234,v234,v236
M a[164:167],v[220:223],a[208:211],a[164:167]
v_accvgpr_read_b32 v238,a10
v_accvgpr_read_b32 v233,a106
M a[168:171],v[220:223],a[212:215],a[168:171]
v_add_f32 v235,v238,v233
v_sub_f32 v238,v238,v233
M a[172:175],v[220:223],a[216:219],a[172:175]
v_add_f32 v233,v10,v106
v_sub_f32 v106,v10,v106
M a[176:179],v[220:223],a[220:223],a[176:179]
s_waitcnt lgkmcnt(1)
s_add_u32 s34,s32,6488064
buffer_store_dwordx4 a[4:7],v252,s[24:27],s34 offen offset:384 nt
M a[180:183],v[220:223],a[192:195],a[180:183]
v_add_f32 v10,v235,v233
v_fmac_f32 v235,4.0,v233
M a[184:187],v[220:223],a[196:199],a[184:187]
v_fma_f32 v233,2.0,v106,v238
v_fma_f32 v106,s41,v106,v238
M a[188:191],v[220:223],a[200:203],a[188:191]
s_waitcnt vmcnt(12)
buffer_load_dwordx4 v[220:223],v251,s[20:23],s48 offen offset:1024
M a[128:131],v[224:227],a[208:211],a[128:131]
v_accvgpr_read_b32 v238,a11
v_accvgpr_read_b32 v237,a107
M a[132:135],v[224:227],a[212:215],a[132:135]
v_add_f32 v236,v238,v237
v_sub_f32 v238,v238,v237
M a[136:139],v[224:227],a[216:219],a[136:139]
v_add_f32 v237,v11,v107
v_sub_f32 v107,v11,v107
M a[140:143],v[224:227],a[220:223],a[140:143]
v_add_f32 v11,v236,v237
v_fmac_f32 v236,4.0,v237
M a[144:147],v[224:227],a[192:195],a[144:147]
v_fma_f32 v237,2.0,v107,v238
v_fma_f32 v107,s41,v107,v238
M a[148:151],v[224:227],a[196:199],a[148:151]
v_cvt_pk_bf16_f32 v233,v233,v237
v_cvt_pk_bf16_f32 v235,v235,v236
M a[152:155],v[224:227],a[200:203],a[152:155]
s_waitcnt lgkmcnt(0)
ds_write2st64_b64 v253,v[232:233],v[234:235] offset0:85 offset1:89
M a[156:159],v[224:227],a[204:207],a[156:159]
s_waitcnt vmcnt(12)
buffer_load_dwordx4 v[224:227],v251,s[20:23],s47 offen offset:2048
M a[160:163],v[228:231],a[208:211],a[160:163]
ds_read_b128 a[208:211],v249 offset:17408
v_accvgpr_read_b32 v238,a12
M a[164:167],v[228:231],a[212:215],a[164:167]
ds_read_b128 a[212:215],v250 offset:17664
v_accvgpr_read_b32 v232,a108
M a[168:171],v[228:231],a[216:219],a[168:171]
ds_read_b128 a[216:219],v250 offset:17920
v_add_f32 v234,v238,v232
M a[172:175],v[228:231],a[220:223],a[172:175]
ds_read_b128 a[220:223],v250 offset:18176
v_sub_f32 v238,v238,v232
M a[176:179],v[228:231],a[192:195],a[176:179]
ds_read_b128 a[192:195],v250 offset:18432
v_add_f32 v232,v12,v108
M a[180:183],v[228:231],a[196:199],a[180:183]
ds_read_b128 a[196:199],v250 offset:18688
v_sub_f32 v108,v12,v108
M a[184:187],v[228:231],a[200:203],a[184:187]
ds_read_b128 a[200:203],v250 offset:18944
v_add_f32 v12,v234,v232
M a[188:191],v[228:231],a[204:207],a[188:191]
s_waitcnt vmcnt(12) lgkmcnt(6)
buffer_load_dwordx4 v[228:231],v251,s[20:23],s48 offen offset:2048
M v[32:35],a[224:227],a[208:211],v[32:35]
s_waitcnt lgkmcnt(5)
ds_read_b128 a[204:207],v250 offset:19200
v_fmac_f32 v234,4.0,v232
M v[36:39],a[224:227],a[212:215],v[36:39]
s_waitcnt lgkmcnt(5)
s_add_u32 s46,s76,0
v_fma_f32 v232,2.0,v108,v238
v_fma_f32 v108,s41,v108,v238
M v[40:43],a[224:227],a[216:219],v[40:43]
s_waitcnt lgkmcnt(4)
v_accvgpr_read_b32 v238,a13
v_accvgpr_read_b32 v237,a109
M v[44:47],a[224:227],a[220:223],v[44:47]
s_waitcnt lgkmcnt(3)
v_add_f32 v236,v238,v237
v_sub_f32 v238,v238,v237
M v[48:51],a[224:227],a[192:195],v[48:51]
s_waitcnt lgkmcnt(2)
v_add_f32 v237,v13,v109
v_sub_f32 v109,v13,v109
M v[52:55],a[224:227],a[196:199],v[52:55]
s_waitcnt lgkmcnt(1)
v_add_f32 v13,v236,v237
v_fmac_f32 v236,4.0,v237
M v[56:59],a[224:227],a[200:203],v[56:59]
s_waitcnt lgkmcnt(0)
v_fma_f32 v237,2.0,v109,v238
v_fma_f32 v109,s41,v109,v238
M v[60:63],a[224:227],a[204:207],v[60:63]
s_waitcnt vmcnt(12)
buffer_load_dwordx4 a[224:227],v251,s[20:23],s46 offen offset:0
M v[64:67],a[228:231],a[208:211],v[64:67]
ds_read_b128 a[208:211],v250 offset:19456
v_cvt_pk_bf16_f32 v232,v232,v237
M v[68:71],a[228:231],a[212:215],v[68:71]
v_cvt_pk_bf16_f32 v234,v234,v236
v_accvgpr_read_b32 v238,a14
M v[72:75],a[228:231],a[216:219],v[72:75]
v_accvgpr_read_b32 v233,a110
v_add_f32 v235,v238,v233
M v[76:79],a[228:231],a[220:223],v[76:79]
v_sub_f32 v238,v238,v233
v_add_f32 v233,v14,v110
M v[80:83],a[228:231],a[192:195],v[80:83]
v_sub_f32 v110,v14,v110
v_add_f32 v14,v235,v233
M v[84:87],a[228:231],a[196:199],v[84:87]
v_fmac_f32 v235,4.0,v233
v_fma_f32 v233,2.0,v110,v238
M v[88:91],a[228:231],a[200:203],v[88:91]
v_fma_f32 v110,s41,v110,v238
v_accvgpr_read_b32 v238,a15
M v[92:95],a[228:231],a[204:207],v[92:95]
s_waitcnt vmcnt(12)
buffer_load_dwordx4 a[228:231],v251,s[20:23],s46 offen offset:1024
M v[32:35],a[232:235],a[212:215],v[32:35]
v_accvgpr_read_b32 v237,a111
v_add_f32 v236,v238,v237
M v[36:39],a[232:235],a[216:219],v[36:39]
v_sub_f32 v238,v238,v237
v_add_f32 v237,v15,v111
M v[40:43],a[232:235],a[220:223],v[40:43]
v_sub_f32 v111,v15,v111
v_add_f32 v15,v236,v237
M v[44:47],a[232:235],a[192:195],v[44:47]
v_fmac_f32 v236,4.0,v237
v_fma_f32 v237,2.0,v111,v238
M v[48:51],a[232:235],a[196:199],v[48:51]
v_fma_f32 v111,s41,v111,v238
v_cvt_pk_bf16_f32 v233,v233,v237
M v[52:55],a[232:235],a[200:203],v[52:55]
v_cvt_pk_bf16_f32 v235,v235,v236
M v[56:59],a[232:235],a[204:207],v[56:59]
s_waitcnt lgkmcnt(0)
ds_write2st64_b64 v253,v[232:233],v[234:235] offset0:93 offset1:97
M v[60:63],a[232:235],a[208:211],v[60:63]
s_waitcnt vmcnt(12)
buffer_load_dwordx4 a[232:235],v251,s[20:23],s46 offen offset:2048
M v[64:67],a[236:239],a[212:215],v[64:67]
ds_read_b128 a[212:215],v249 offset:19712
v_accvgpr_read_b32 v238,a16
M v[68:71],a[236:239],a[216:219],v[68:71]
s_add_u32 s46,s77,0
v_accvgpr_read_b32 v232,a112
v_add_f32 v234,v238,v232
M v[72:75],a[236:239],a[220:223],v[72:75]
v_sub_f32 v238,v238,v232
v_add_f32 v232,v16,v112
M v[76:79],a[236:239],a[192:195],v[76:79]
v_sub_f32 v112,v16,v112
M v[80:83],a[236:239],a[196:199],v[80:83]
s_waitcnt lgkmcnt(1)
s_barrier
ds_read_b128 a[8:11],v251 offset:43520
M v[84:87],a[236:239],a[200:203],v[84:87]
ds_read_b128 a[12:15],v251 offset:47616
v_add_f32 v16,v234,v232
M v[88:91],a[236:239],a[204:207],v[88:91]
v_fmac_f32 v234,4.0,v232
v_fma_f32 v232,2.0,v112,v238
M v[92:95],a[236:239],a[208:211],v[92:95]
s_waitcnt vmcnt(12)
buffer_load_dwordx4 a[236:239],v251,s[20:23],s46 offen offset:0
M v[32:35],a[240:243],a[216:219],v[32:35]
v_fma_f32 v112,s41,v112,v238
v_accvgpr_read_b32 v238,a17
M v[36:39],a[240:243],a[220:223],v[36:39]
s_waitcnt lgkmcnt(1)
s_add_u32 s34,s32,6684672
buffer_store_dwordx4 a[8:11],v252,s[24:27],s34 offen offset:384 nt
M v[40:43],a[240:243],a[192:195],v[40:43]
s_waitcnt lgkmcnt(0)
s_add_u32 s34,s32,6881280
buffer_store_dwordx4 a[12:15],v252,s[24:27],s34 offen offset:384 nt
M v[44:47],a[240:243],a[196:199],v[44:47]
v_accvgpr_read_b32 v237,a113
v_add_f32 v236,v238,v237
M v[48:51],a[240:243],a[200:203],v[48:51]
v_sub_f32 v238,v238,v237
v_add_f32 v237,v17,v113
M v[52:55],a[240:243],a[204:207],v[52:55]
v_sub_f32 v113,v17,v113
v_add_f32 v17,v236,v237
M v[56:59],a[240:243],a[208:211],v[56:59]
v_fmac_f32 v236,4.0,v237
v_fma_f32 v237,2.0,v113,v238
M v[60:63],a[240:243],a[212:215],v[60:63]
s_waitcnt vmcnt(14)
buffer_load_dwordx4 a[240:243],v251,s[20:23],s46 offen offset:1024
M v[64:67],a[244:247],a[216:219],v[64:67]
ds_read_b128 a[216:219],v249 offset:26112
v_fma_f32 v113,s41,v113,v238
M v[68:71],a[244:247],a[220:223],v[68:71]
ds_read_b128 a[220:223],v250 offset:26368
v_cvt_pk_bf16_f32 v232,v232,v237
M v[72:75],a[244:247],a[192:195],v[72:75]
ds_read_b128 a[192:195],v250 offset:26624
v_cvt_pk_bf16_f32 v234,v234,v236
M v[76:79],a[244:247],a[196:199],v[76:79]
ds_read_b128 a[196:199],v250 offset:26880
v_accvgpr_read_b32 v238,a18
M v[80:83],a[244:247],a[200:203],v[80:83]
ds_read_b128 a[200:203],v250 offset:27136
v_accvgpr_read_b32 v233,a114
M v[84:87],a[244:247],a[204:207],v[84:87]
ds_read_b128 a[204:207],v250 offset:27392
v_add_f32 v235,v238,v233
M v[88:91],a[244:247],a[208:211],v[88:91]
ds_read_b128 a[208:211],v250 offset:27648
v_sub_f32 v238,v238,v233
M v[92:95],a[244:247],a[212:215],v[92:95]
s_waitcnt vmcnt(14) lgkmcnt(6)
buffer_load_dwordx4 a[244:247],v251,s[20:23],s46 offen offset:2048
M v[128:131],a[248:251],a[216:219],v[128:131]
s_waitcnt lgkmcnt(5)
ds_read_b128 a[212:215],v250 offset:27904
v_add_f32 v233,v18,v114
M v[132:135],a[248:251],a[220:223],v[132:135]
s_waitcnt lgkmcnt(5)
s_add_u32 s46,s78,0
v_sub_f32 v114,v18,v114
v_add_f32 v18,v235,v233
M v[136:139],a[248:251],a[192:195],v[136:139]
s_waitcnt lgkmcnt(4)
v_fmac_f32 v235,4.0,v233
v_fma_f32 v233,2.0,v114,v238
M v[140:143],a[248:251],a[196:199],v[140:143]
s_waitcnt lgkmcnt(3)
v_fma_f32 v114,s41,v114,v238
v_accvgpr_read_b32 v238,a19
M v[144:147],a[248:251],a[200:203],v[144:147]
s_waitcnt lgkmcnt(2)
v_accvgpr_read_b32 v237,a115
v_add_f32 v236,v238,v237
M v[148:151],a[248:251],a[204:207],v[148:151]
s_waitcnt lgkmcnt(1)
v_sub_f32 v238,v238,v237
v_add_f32 v237,v19,v115
M v[152:155],a[248:251],a[208:211],v[152:155]
s_waitcnt lgkmcnt(0)
v_sub_f32 v115,v19,v115
v_add_f32 v19,v236,v237
M v[156:159],a[248:251],a[212:215],v[156:159]
s_waitcnt vmcnt(14)
buffer_load_dwordx4 a[248:251],v251,s[20:23],s46 offen offset:0
M v[160:163],a[252:255],a[216:219],v[160:163]
ds_read_b128 a[216:219],v250 offset:28160
v_fmac_f32 v236,4.0,v237
M v[164:167],a[252:255],a[220:223],v[164:167]
v_fma_f32 v237,2.0,v115,v238
v_fma_f32 v115,s41,v115,v238
M v[168:171],a[252:255],a[192:195],v[168:171]
v_cvt_pk_bf16_f32 v233,v233,v237
v_cvt_pk_bf16_f32 v235,v235,v236
M v[172:175],a[252:255],a[196:199],v[172:175]
ds_write2st64_b64 v253,v[232:233],v[234:235] offset0:68 offset1:72
M v[176:179],a[252:255],a[200:203],v[176:179]
v_accvgpr_read_b32 v238,a20
v_accvgpr_read_b32 v232,a116
M v[180:183],a[252:255],a[204:207],v[180:183]
v_add_f32 v234,v238,v232
v_sub_f32 v238,v238,v232
M v[184:187],a[252:255],a[208:211],v[184:187]
v_add_f32 v232,v20,v116
v_sub_f32 v116,v20,v116
M v[188:191],a[252:255],a[212:215],v[188:191]
s_waitcnt vmcnt(13)
buffer_load_dwordx4 a[252:255],v251,s[20:23],s46 offen offset:1024
M v[128:131],v[216:219],a[220:223],v[128:131]
v_add_f32 v20,v234,v232
v_fmac_f32 v234,4.0,v232
M v[132:135],v[216:219],a[192:195],v[132:135]
v_fma_f32 v232,2.0,v116,v238
v_fma_f32 v116,s41,v116,v238
M v[136:139],v[216:219],a[196:199],v[136:139]
v_accvgpr_read_b32 v238,a21
v_accvgpr_read_b32 v237,a117
M v[140:143],v[216:219],a[200:203],v[140:143]
v_add_f32 v236,v238,v237
v_sub_f32 v238,v238,v237
M v[144:147],v[216:219],a[204:207],v[144:147]
v_add_f32 v237,v21,v117
v_sub_f32 v117,v21,v117
M v[148:151],v[216:219],a[208:211],v[148:151]
v_add_f32 v21,v236,v237
v_fmac_f32 v236,4.0,v237
M v[152:155],v[216:219],a[212:215],v[152:155]
s_waitcnt lgkmcnt(1)
v_fma_f32 v237,2.0,v117,v238
v_fma_f32 v117,s41,v117,v238
v_cvt_pk_bf16_f32 v232,v232,v237
M v[156:159],v[216:219],a[216:219],v[156:159]
s_waitcnt vmcnt(12)
buffer_load_dwordx4 v[216:219],v251,s[20:23],s46 offen offset:2048
v_cvt_pk_bf16_f32 v234,v234,v236
v_accvgpr_read_b32 v238,a22
v_accvgpr_read_b32 v233,a118
v_add_f32 v235,v238,v233
M v[160:163],v[220:223],a[220:223],v[160:163]
ds_read_b128 a[220:223],v249 offset:28416
v_sub_f32 v238,v238,v233
v_add_f32 v233,v22,v118
v_sub_f32 v118,v22,v118
v_add_f32 v22,v235,v233
M v[164:167],v[220:223],a[192:195],v[164:167]
s_add_u32 s46,s79,0
v_fmac_f32 v235,4.0,v233
v_fma_f32 v233,2.0,v118,v238
v_fma_f32 v118,s41,v118,v238
v_accvgpr_read_b32 v238,a23
M v[168:171],v[220:223],a[196:199],v[168:171]
v_accvgpr_read_b32 v237,a119
v_add_f32 v236,v238,v237
v_sub_f32 v238,v238,v237
v_add_f32 v237,v23,v119
M v[172:175],v[220:223],a[200:203],v[172:175]
v_sub_f32 v119,v23,v119
v_add_f32 v23,v236,v237
v_fmac_f32 v236,4.0,v237
v_fma_f32 v237,2.0,v119,v238
M v[176:179],v[220:223],a[204:207],v[176:179]
v_fma_f32 v119,s41,v119,v238
v_cvt_pk_bf16_f32 v233,v233,v237
v_cvt_pk_bf16_f32 v235,v235,v236
M v[180:183],v[220:223],a[208:211],v[180:183]
ds_write2st64_b64 v253,v[232:233],v[234:235] offset0:76 offset1:80
M v[184:187],v[220:223],a[212:215],v[184:187]
v_accvgpr_read_b32 v238,a24
v_accvgpr_read_b32 v232,a120
M v[188:191],v[220:223],a[216:219],v[188:191]
s_waitcnt vmcnt(12)
buffer_load_dwordx4 v[220:223],v251,s[20:23],s46 offen offset:0
v_add_f32 v234,v238,v232
v_sub_f32 v238,v238,v232
v_add_f32 v232,v24,v120
v_sub_f32 v120,v24,v120
M v[128:131],v[224:227],a[192:195],v[128:131]
s_waitcnt lgkmcnt(0)
s_barrier
ds_read_b128 a[16:19],v251 offset:34816
v_add_f32 v24,v234,v232
v_fmac_f32 v234,4.0,v232
v_fma_f32 v232,2.0,v120,v238
M v[132:135],v[224:227],a[196:199],v[132:135]
ds_read_b128 a[20:23],v251 offset:38912
v_fma_f32 v120,s41,v120,v238
v_accvgpr_read_b32 v238,a25
v_accvgpr_read_b32 v237,a121
v_add_f32 v236,v238,v237
M v[136:139],v[224:227],a[200:203],v[136:139]
v_sub_f32 v238,v238,v237
v_add_f32 v237,v25,v121
v_sub_f32 v121,v25,v121
v_add_f32 v25,v236,v237
M v[140:143],v[224:227],a[204:207],v[140:143]
v_fmac_f32 v236,4.0,v237
v_fma_f32 v237,2.0,v121,v238
v_fma_f32 v121,s41,v121,v238
v_cvt_pk_bf16_f32 v232,v232,v237
M v[144:147],v[224:227],a[208:211],v[144:147]
v_cvt_pk_bf16_f32 v234,v234,v236
v_accvgpr_read_b32 v238,a26
v_accvgpr_read_b32 v233,a122
v_add_f32 v235,v238,v233
M v[148:151],v[224:227],a[212:215],v[148:151]
s_waitcnt lgkmcnt(1)
s_add_u32 s34,s32,7077888
buffer_store_dwordx4 a[16:19],v252,s[24:27],s34 offen offset:384 nt
v_sub_f32 v238,v238,v233
v_add_f32 v233,v26,v122
v_sub_f32 v122,v26,v122
v_add_f32 v26,v235,v233
M v[152:155],v[224:227],a[216:219],v[152:155]
s_waitcnt lgkmcnt(0)
s_add_u32 s34,s32,7274496
buffer_store_dwordx4 a[20:23],v252,s[24:27],s34 offen offset:384 nt
v_fmac_f32 v235,4.0,v233
v_fma_f32 v233,2.0,v122,v238
v_fma_f32 v122,s41,v122,v238
v_accvgpr_read_b32 v238,a27
M v[156:159],v[224:227],a[220:223],v[156:159]
s_waitcnt vmcnt(14)
buffer_load_dwordx4 v[224:227],v251,s[20:23],s46 offen offset:1024
v_accvgpr_read_b32 v237,a123
v_add_f32 v236,v238,v237
v_sub_f32 v238,v238,v237
v_add_f32 v237,v27,v123
M v[160:163],v[228:231],a[192:195],v[160:163]
ds_read_b128 a[192:195],v249 offset:52224
v_sub_f32 v123,v27,v123
v_add_f32 v27,v236,v237
v_fmac_f32 v236,4.0,v237
v_fma_f32 v237,2.0,v123,v238
M v[164:167],v[228:231],a[196:199],v[164:167]
ds_read_b128 a[196:199],v250 offset:52480
v_fma_f32 v123,s41,v123,v238
v_cvt_pk_bf16_f32 v233,v233,v237
v_cvt_pk_bf16_f32 v235,v235,v236
M v[168:171],v[228:231],a[200:203],v[168:171]
s_waitcnt lgkmcnt(0)
s_barrier
ds_write2st64_b64 v253,v[232:233],v[234:235] offset0:85 offset1:89
M v[172:175],v[228:231],a[204:207],v[172:175]
ds_read_b128 a[200:203],v250 offset:52736
ds_read_b128 a[204:207],v250 offset:52992
v_accvgpr_read_b32 v238,a28
v_accvgpr_read_b32 v232,a124
M v[176:179],v[228:231],a[208:211],v[176:179]
ds_read_b128 a[208:211],v250 offset:53248
v_add_f32 v234,v238,v232
v_sub_f32 v238,v238,v232
v_add_f32 v232,v28,v124
v_sub_f32 v124,v28,v124
M v[180:183],v[228:231],a[212:215],v[180:183]
ds_read_b128 a[212:215],v250 offset:53504
v_add_f32 v28,v234,v232
v_fmac_f32 v234,4.0,v232
v_fma_f32 v232,2.0,v124,v238
v_fma_f32 v124,s41,v124,v238
M v[184:187],v[228:231],a[216:219],v[184:187]
ds_read_b128 a[216:219],v250 offset:53760
v_accvgpr_read_b32 v238,a29
v_accvgpr_read_b32 v237,a125
v_add_f32 v236,v238,v237
v_sub_f32 v238,v238,v237
M v[188:191],v[228:231],a[220:223],v[188:191]
s_waitcnt vmcnt(14)
buffer_load_dwordx4 v[228:231],v251,s[20:23],s46 offen offset:2048
v_add_f32 v237,v29,v125
v_sub_f32 v125,v29,v125
v_add_f32 v29,v236,v237
v_fmac_f32 v236,4.0,v237
M v[0:3],a[224:227],a[192:195],v[0:3]
ds_read_b128 a[220:223],v250 offset:54016
ds_read_b128 a[192:195],v250 offset:54272
v_fma_f32 v237,2.0,v125,v238
v_fma_f32 v125,s41,v125,v238
v_cvt_pk_bf16_f32 v232,v232,v237
v_cvt_pk_bf16_f32 v234,v234,v236
M v[4:7],a[224:227],a[196:199],v[4:7]
s_waitcnt lgkmcnt(6)
s_add_u32 s46,s80,0
v_accvgpr_read_b32 v238,a30
v_accvgpr_read_b32 v233,a126
v_add_f32 v235,v238,v233
v_sub_f32 v238,v238,v233
M v[8:11],a[224:227],a[200:203],v[8:11]
s_waitcnt lgkmcnt(5)
v_add_f32 v233,v30,v126
v_sub_f32 v126,v30,v126
v_add_f32 v30,v235,v233
v_fmac_f32 v235,4.0,v233
M v[12:15],a[224:227],a[204:207],v[12:15]
s_waitcnt lgkmcnt(4)
v_fma_f32 v233,2.0,v126,v238
v_fma_f32 v126,s41,v126,v238
v_accvgpr_read_b32 v238,a31
v_accvgpr_read_b32 v237,a127
M v[16:19],a[224:227],a[208:211],v[16:19]
s_waitcnt lgkmcnt(3)
v_add_f32 v236,v238,v237
v_sub_f32 v238,v238,v237
v_add_f32 v237,v31,v127
v_sub_f32 v127,v31,v127
M v[20:23],a[224:227],a[212:215],v[20:23]
s_waitcnt lgkmcnt(2)
v_add_f32 v31,v236,v237
v_fmac_f32 v236,4.0,v237
M v[24:27],a[224:227],a[216:219],v[24:27]
s_waitcnt lgkmcnt(1)
v_fma_f32 v237,2.0,v127,v238
v_fma_f32 v127,s41,v127,v238
M v[28:31],a[224:227],a[220:223],v[28:31]
s_waitcnt vmcnt(14)
buffer_load_dwordx4 a[224:227],v251,s[20:23],s46 offen offset:0
M v[0:3],a[228:231],a[196:199],v[0:3]
ds_read_b128 a[196:199],v249 offset:54528
v_cvt_pk_bf16_f32 v233,v233,v237
M v[4:7],a[228:231],a[200:203],v[4:7]
v_cvt_pk_bf16_f32 v235,v235,v236
M v[8:11],a[228:231],a[204:207],v[8:11]
ds_write2st64_b64 v253,v[232:233],v[234:235] offset0:93 offset1:97
M v[12:15],a[228:231],a[208:211],v[12:15]
v_accvgpr_read_b32 v238,a32
v_accvgpr_read_b32 v232,a128
M v[16:19],a[228:231],a[212:215],v[16:19]
v_add_f32 v234,v238,v232
v_sub_f32 v238,v238,v232
M v[20:23],a[228:231],a[216:219],v[20:23]
v_add_u32 v249,0x15400,v249
v_add_u32 v250,0x15400,v250
M v[24:27],a[228:231],a[220:223],v[24:27]
s_waitcnt lgkmcnt(2)
v_add_f32 v232,v32,v128
v_sub_f32 v128,v32,v128
M v[28:31],a[228:231],a[192:195],v[28:31]
s_waitcnt vmcnt(14) lgkmcnt(0)
s_barrier
ds_read_b128 a[24:27],v251 offset:43520
M v[0:3],a[232:235],a[200:203],v[0:3]
ds_read_b128 a[28:31],v251 offset:47616
ds_read_b128 a[200:203],v249 offset:0
M v[4:7],a[232:235],a[204:207],v[4:7]
buffer_load_dwordx4 a[228:231],v251,s[20:23],s46 offen offset:1024
M v[8:11],a[232:235],a[208:211],v[8:11]
ds_read_b128 a[204:207],v250 offset:256
ds_read_b128 a[208:211],v250 offset:512
M v[12:15],a[232:235],a[212:215],v[12:15]
ds_read_b128 a[212:215],v250 offset:768
v_add_f32 v32,v234,v232
M v[16:19],a[232:235],a[216:219],v[16:19]
s_waitcnt lgkmcnt(5)
s_add_u32 s34,s32,7471104
buffer_store_dwordx4 a[24:27],v252,s[24:27],s34 offen offset:384 nt
M v[20:23],a[232:235],a[220:223],v[20:23]
s_waitcnt lgkmcnt(4)
s_add_u32 s34,s32,7667712
buffer_store_dwordx4 a[28:31],v252,s[24:27],s34 offen offset:384 nt
M v[24:27],a[232:235],a[192:195],v[24:27]
ds_read_b128 a[216:219],v250 offset:1024
ds_read_b128 a[220:223],v250 offset:1280
M v[28:31],a[232:235],a[196:199],v[28:31]
s_waitcnt vmcnt(16) lgkmcnt(5)
buffer_load_dwordx4 a[232:235],v251,s[20:23],s46 offen offset:2048
M v[0:3],a[236:239],a[200:203],v[0:3]
s_waitcnt lgkmcnt(4)
ds_read_b128 a[192:195],v250 offset:1536
ds_read_b128 a[196:199],v250 offset:1792
M v[4:7],a[236:239],a[204:207],v[4:7]
s_waitcnt lgkmcnt(5)
s_add_u32 s46,s81,0
ds_read_b128 a[200:203],v250 offset:2048
v_fmac_f32 v234,4.0,v232
M v[8:11],a[236:239],a[208:211],v[8:11]
s_waitcnt lgkmcnt(5)
v_fma_f32 v232,2.0,v128,v238
v_fma_f32 v128,s41,v128,v238
M v[12:15],a[236:239],a[212:215],v[12:15]
s_waitcnt lgkmcnt(4)
v_accvgpr_read_b32 v238,a33
v_accvgpr_read_b32 v237,a129
M v[16:19],a[236:239],a[216:219],v[16:19]
s_waitcnt lgkmcnt(3)
v_add_f32 v236,v238,v237
v_sub_f32 v238,v238,v237
M v[20:23],a[236:239],a[220:223],v[20:23]
s_waitcnt lgkmcnt(2)
v_add_f32 v237,v33,v129
v_sub_f32 v129,v33,v129
M v[24:27],a[236:239],a[192:195],v[24:27]
s_waitcnt lgkmcnt(1)
v_add_f32 v33,v236,v237
v_fmac_f32 v236,4.0,v237
M v[28:31],a[236:239],a[196:199],v[28:31]
s_waitcnt vmcnt(14)
buffer_load_dwordx4 a[236:239],v251,s[20:23],s46 offen offset:0
M v[0:3],a[240:243],a[204:207],v[0:3]
ds_read_b128 a[204:207],v249 offset:2304
v_fma_f32 v237,2.0,v129,v238
M v[4:7],a[240:243],a[208:211],v[4:7]
v_fma_f32 v129,s41,v129,v238
v_cvt_pk_bf16_f32 v232,v232,v237
M v[8:11],a[240:243],a[212:215],v[8:11]
v_cvt_pk_bf16_f32 v234,v234,v236
v_accvgpr_read_b32 v238,a34
M v[12:15],a[240:243],a[216:219],v[12:15]
v_accvgpr_read_b32 v233,a130
v_add_f32 v235,v238,v233
M v[16:19],a[240:243],a[220:223],v[16:19]
v_sub_f32 v238,v238,v233
v_add_f32 v233,v34,v130
M v[20:23],a[240:243],a[192:195],v[20:23]
v_sub_f32 v130,v34,v130
v_add_f32 v34,v235,v233
M v[24:27],a[240:243],a[196:199],v[24:27]
s_waitcnt lgkmcnt(1)
v_fmac_f32 v235,4.0,v233
v_fma_f32 v233,2.0,v130,v238
M v[28:31],a[240:243],a[200:203],v[28:31]
s_waitcnt vmcnt(14)
buffer_load_dwordx4 a[240:243],v251,s[20:23],s46 offen offset:1024
M v[0:3],a[244:247],a[208:211],v[0:3]
ds_read_b128 a[208:211],v249 offset:17408
v_fma_f32 v130,s41,v130,v238
M v[4:7],a[244:247],a[212:215],v[4:7]
ds_read_b128 a[212:215],v250 offset:17664
v_accvgpr_read_b32 v238,a35
M v[8:11],a[244:247],a[216:219],v[8:11]
ds_read_b128 a[216:219],v250 offset:17920
v_accvgpr_read_b32 v237,a131
M v[12:15],a[244:247],a[220:223],v[12:15]
ds_read_b128 a[220:223],v250 offset:18176
v_add_f32 v236,v238,v237
M v[16:19],a[244:247],a[192:195],v[16:19]
ds_read_b128 a[192:195],v250 offset:18432
v_sub_f32 v238,v238,v237
M v[20:23],a[244:247],a[196:199],v[20:23]
ds_read_b128 a[196:199],v250 offset:18688
v_add_f32 v237,v35,v131
M v[24:27],a[244:247],a[200:203],v[24:27]
s_waitcnt lgkmcnt(6)
ds_read_b128 a[200:203],v250 offset:18944
v_sub_f32 v131,v35,v131
M v[28:31],a[244:247],a[204:207],v[28:31]
s_waitcnt vmcnt(14) lgkmcnt(6)
buffer_load_dwordx4 a[244:247],v251,s[20:23],s46 offen offset:2048
M v[0:3],a[248:251],a[208:211],v[0:3]
s_waitcnt lgkmcnt(5)
ds_read_b128 a[204:207],v250 offset:19200
ds_read_b128 a[208:211],v250 offset:19456
M v[4:7],a[248:251],a[212:215],v[4:7]
s_waitcnt lgkmcnt(6)
s_add_u32 s46,s76,46080
v_add_f32 v35,v236,v237
v_fmac_f32 v236,4.0,v237
M v[8:11],a[248:251],a[216:219],v[8:11]
s_waitcnt lgkmcnt(5)
v_fma_f32 v237,2.0,v131,v238
v_fma_f32 v131,s41,v131,v238
M v[12:15],a[248:251],a[220:223],v[12:15]
s_waitcnt lgkmcnt(4)
v_cvt_pk_bf16_f32 v233,v233,v237
v_cvt_pk_bf16_f32 v235,v235,v236
M v[16:19],a[248:251],a[192:195],v[16:19]
s_waitcnt lgkmcnt(3)
ds_write2st64_b64 v253,v[232:233],v[234:235] offset0:34 offset1:38
M v[20:23],a[248:251],a[196:199],v[20:23]
s_waitcnt lgkmcnt(3)
v_accvgpr_read_b32 v238,a36
v_accvgpr_read_b32 v232,a132
M v[24:27],a[248:251],a[200:203],v[24:27]
s_waitcnt lgkmcnt(2)
v_add_f32 v234,v238,v232
v_sub_f32 v238,v238,v232
M v[28:31],a[248:251],a[204:207],v[28:31]
s_waitcnt vmcnt(14)
buffer_load_dwordx4 a[248:251],v251,s[20:23],s46 offen offset:0
M v[0:3],a[252:255],a[212:215],v[0:3]
ds_read_b128 a[212:215],v249 offset:19712
v_add_f32 v232,v36,v132
M v[4:7],a[252:255],a[216:219],v[4:7]
v_sub_f32 v132,v36,v132
v_add_f32 v36,v234,v232
M v[8:11],a[252:255],a[220:223],v[8:11]
v_fmac_f32 v234,4.0,v232
v_fma_f32 v232,2.0,v132,v238
M v[12:15],a[252:255],a[192:195],v[12:15]
v_fma_f32 v132,s41,v132,v238
v_accvgpr_read_b32 v238,a37
M v[16:19],a[252:255],a[196:199],v[16:19]
v_accvgpr_read_b32 v237,a133
v_add_f32 v236,v238,v237
M v[20:23],a[252:255],a[200:203],v[20:23]
v_sub_f32 v238,v238,v237
v_add_f32 v237,v37,v133
M v[24:27],a[252:255],a[204:207],v[24:27]
s_waitcnt lgkmcnt(2)
v_sub_f32 v133,v37,v133
v_add_f32 v37,v236,v237
M v[28:31],a[252:255],a[208:211],v[28:31]
s_waitcnt vmcnt(14)
buffer_load_dwordx4 a[252:255],v251,s[20:23],s46 offen offset:1024
M v[0:3],v[216:219],a[216:219],v[0:3]
ds_read_b128 a[216:219],v249 offset:34816
v_fmac_f32 v236,4.0,v237
M v[4:7],v[216:219],a[220:223],v[4:7]
ds_read_b128 a[220:223],v250 offset:35072
v_fma_f32 v237,2.0,v133,v238
M v[8:11],v[216:219],a[192:195],v[8:11]
ds_read_b128 a[192:195],v250 offset:35328
v_fma_f32 v133,s41,v133,v238
M v[12:15],v[216:219],a[196:199],v[12:15]
ds_read_b128 a[196:199],v250 offset:35584
v_cvt_pk_bf16_f32 v232,v232,v237
M v[16:19],v[216:219],a[200:203],v[16:19]
ds_read_b128 a[200:203],v250 offset:35840
v_cvt_pk_bf16_f32 v234,v234,v236
M v[20:23],v[216:219],a[204:207],v[20:23]
ds_read_b128 a[204:207],v250 offset:36096
v_accvgpr_read_b32 v238,a38
M v[24:27],v[216:219],a[208:211],v[24:27]
s_waitcnt lgkmcnt(6)
ds_read_b128 a[208:211],v250 offset:36352
v_accvgpr_read_b32 v233,a134
M v[28:31],v[216:219],a[212:215],v[28:31]
s_waitcnt vmcnt(14) lgkmcnt(6)
buffer_load_dwordx4 v[216:219],v251,s[20:23],s46 offen offset:2048
M v[0:3],v[220:223],a[216:219],v[0:3]
s_waitcnt lgkmcnt(5)
ds_read_b128 a[212:215],v250 offset:36608
ds_read_b128 a[216:219],v250 offset:36864
M v[4:7],v[220:223],a[220:223],v[4:7]
s_waitcnt lgkmcnt(6)
s_add_u32 s46,s77,46080
v_add_f32 v235,v238,v233
v_sub_f32 v238,v238,v233
M v[8:11],v[220:223],a[192:195],v[8:11]
s_waitcnt lgkmcnt(5)
v_add_f32 v233,v38,v134
v_sub_f32 v134,v38,v134
M v[12:15],v[220:223],a[196:199],v[12:15]
s_waitcnt lgkmcnt(4)
v_add_f32 v38,v235,v233
v_fmac_f32 v235,4.0,v233
M v[16:19],v[220:223],a[200:203],v[16:19]
s_waitcnt lgkmcnt(3)
v_fma_f32 v233,2.0,v134,v238
v_fma_f32 v134,s41,v134,v238
M v[20:23],v[220:223],a[204:207],v[20:23]
s_waitcnt lgkmcnt(2)
v_accvgpr_read_b32 v238,a39
v_accvgpr_read_b32 v237,a135
M v[24:27],v[220:223],a[208:211],v[24:27]
s_waitcnt lgkmcnt(1)
v_add_f32 v236,v238,v237
v_sub_f32 v238,v238,v237
M v[28:31],v[220:223],a[212:215],v[28:31]
s_waitcnt vmcnt(12)
buffer_load_dwordx4 v[220:223],v251,s[20:23],s46 offen offset:0
M v[0:3],v[224:227],a[220:223],v[0:3]
ds_read_b128 a[220:223],v249 offset:37120
v_add_f32 v237,v39,v135
M v[4:7],v[224:227],a[192:195],v[4:7]
v_sub_f32 v135,v39,v135
v_add_f32 v39,v236,v237
M v[8:11],v[224:227],a[196:199],v[8:11]
v_fmac_f32 v236,4.0,v237
v_fma_f32 v237,2.0,v135,v238
M v[12:15],v[224:227],a[200:203],v[12:15]
v_fma_f32 v135,s41,v135,v238
v_cvt_pk_bf16_f32 v233,v233,v237
M v[16:19],v[224:227],a[204:207],v[16:19]
v_cvt_pk_bf16_f32 v235,v235,v236
M v[20:23],v[224:227],a[208:211],v[20:23]
ds_write2st64_b64 v253,v[232:233],v[234:235] offset0:42 offset1:46
M v[24:27],v[224:227],a[212:215],v[24:27]
s_waitcnt lgkmcnt(2)
v_accvgpr_read_b32 v238,a40
v_accvgpr_read_b32 v232,a136
M v[28:31],v[224:227],a[216:219],v[28:31]
s_waitcnt vmcnt(12)
buffer_load_dwordx4 v[224:227],v251,s[20:23],s46 offen offset:1024
M v[0:3],v[228:231],a[192:195],v[0:3]
ds_read_b128 a[192:195],v249 offset:52224
v_add_f32 v234,v238,v232
M v[4:7],v[228:231],a[196:199],v[4:7]
ds_read_b128 a[196:199],v250 offset:52480
v_sub_f32 v238,v238,v232
M v[8:11],v[228:231],a[200:203],v[8:11]
ds_read_b128 a[200:203],v250 offset:52736
v_add_f32 v232,v40,v136
M v[12:15],v[228:231],a[204:207],v[12:15]
ds_read_b128 a[204:207],v250 offset:52992
v_sub_f32 v136,v40,v136
M v[16:19],v[228:231],a[208:211],v[16:19]
ds_read_b128 a[208:211],v250 offset:53248
v_add_f32 v40,v234,v232
M v[20:23],v[228:231],a[212:215],v[20:23]
ds_read_b128 a[212:215],v250 offset:53504
v_fmac_f32 v234,4.0,v232
M v[24:27],v[228:231],a[216:219],v[24:27]
s_waitcnt lgkmcnt(7)
ds_read_b128 a[216:219],v250 offset:53760
v_fma_f32 v232,2.0,v136,v238
M v[28:31],v[228:231],a[220:223],v[28:31]
s_waitcnt vmcnt(12) lgkmcnt(6)
buffer_load_dwordx4 v[228:231],v251,s[20:23],s46 offen offset:2048
M v[0:3],a[224:227],a[192:195],v[0:3]
s_waitcnt lgkmcnt(5)
ds_read_b128 a[220:223],v250 offset:54016
ds_read_b128 a[192:195],v250 offset:54272
M v[4:7],a[224:227],a[196:199],v[4:7]
s_waitcnt lgkmcnt(6)
s_add_u32 s46,s78,46080
v_fma_f32 v136,s41,v136,v238
v_accvgpr_read_b32 v238,a41
M v[8:11],a[224:227],a[200:203],v[8:11]
s_waitcnt lgkmcnt(5)
v_accvgpr_read_b32 v237,a137
v_add_f32 v236,v238,v237
M v[12:15],a[224:227],a[204:207],v[12:15]
s_waitcnt lgkmcnt(4)
v_sub_f32 v238,v238,v237
v_add_f32 v237,v41,v137
M v[16:19],a[224:227],a[208:211],v[16:19]
s_waitcnt lgkmcnt(3)
v_sub_f32 v137,v41,v137
v_add_f32 v41,v236,v237
M v[20:23],a[224:227],a[212:215],v[20:23]
s_waitcnt lgkmcnt(2)
v_fmac_f32 v236,4.0,v237
v_fma_f32 v237,2.0,v137,v238
M v[24:27],a[224:227],a[216:219],v[24:27]
s_waitcnt lgkmcnt(1)
v_fma_f32 v137,s41,v137,v238
v_cvt_pk_bf16_f32 v232,v232,v237
M v[28:31],a[224:227],a[220:223],v[28:31]
s_waitcnt vmcnt(12)
buffer_load_dwordx4 a[224:227],v251,s[20:23],s46 offen offset:0
M v[0:3],a[228:231],a[196:199],v[0:3]
ds_read_b128 a[196:199],v249 offset:54528
v_cvt_pk_bf16_f32 v234,v234,v236
M v[4:7],a[228:231],a[200:203],v[4:7]
v_accvgpr_read_b32 v238,a42
v_accvgpr_read_b32 v233,a138
M v[8:11],a[228:231],a[204:207],v[8:11]
v_add_f32 v235,v238,v233
v_sub_f32 v238,v238,v233
M v[12:15],a[228:231],a[208:211],v[12:15]
v_add_f32 v233,v42,v138
v_sub_f32 v138,v42,v138
M v[16:19],a[228:231],a[212:215],v[16:19]
v_add_f32 v42,v235,v233
v_fmac_f32 v235,4.0,v233
M v[20:23],a[228:231],a[216:219],v[20:23]
v_add_u32 v249,0xffff9a00,v249
v_add_u32 v250,0xffff9a00,v250
M v[24:27],a[228:231],a[220:223],v[24:27]
s_waitcnt lgkmcnt(1)
v_fma_f32 v233,2.0,v138,v238
v_fma_f32 v138,s41,v138,v238
M v[28:31],a[228:231],a[192:195],v[28:31]
s_waitcnt vmcnt(10)
buffer_load_dwordx4 a[228:231],v251,s[20:23],s46 offen offset:1024
M v[0:3],a[232:235],a[200:203],v[0:3]
ds_read_b128 a[200:203],v249 offset:8704
v_accvgpr_read_b32 v238,a43
M v[4:7],a[232:235],a[204:207],v[4:7]
ds_read_b128 a[204:207],v250 offset:8960
v_accvgpr_read_b32 v237,a139
M v[8:11],a[232:235],a[208:211],v[8:11]
ds_read_b128 a[208:211],v250 offset:9216
v_add_f32 v236,v238,v237
M v[12:15],a[232:235],a[212:215],v[12:15]
ds_read_b128 a[212:215],v250 offset:9472
v_sub_f32 v238,v238,v237
M v[16:19],a[232:235],a[216:219],v[16:19]
ds_read_b128 a[216:219],v250 offset:9728
v_add_f32 v237,v43,v139
M v[20:23],a[232:235],a[220:223],v[20:23]
ds_read_b128 a[220:223],v250 offset:9984
v_sub_f32 v139,v43,v139
M v[24:27],a[232:235],a[192:195],v[24:27]
s_waitcnt lgkmcnt(6)
ds_read_b128 a[192:195],v250 offset:10240
v_add_f32 v43,v236,v237
M v[28:31],a[232:235],a[196:199],v[28:31]
s_waitcnt vmcnt(10) lgkmcnt(6)
buffer_load_dwordx4 a[232:235],v251,s[20:23],s46 offen offset:2048
M v[0:3],a[236:239],a[200:203],v[0:3]
s_waitcnt lgkmcnt(5)
ds_read_b128 a[196:199],v250 offset:10496
ds_read_b128 a[200:203],v250 offset:10752
M v[4:7],a[236:239],a[204:207],v[4:7]
s_waitcnt lgkmcnt(6)
s_add_u32 s46,s79,46080
v_fmac_f32 v236,4.0,v237
v_fma_f32 v237,2.0,v139,v238
M v[8:11],a[236:239],a[208:211],v[8:11]
s_waitcnt lgkmcnt(5)
v_fma_f32 v139,s41,v139,v238
v_cvt_pk_bf16_f32 v233,v233,v237
M v[12:15],a[236:239],a[212:215],v[12:15]
s_waitcnt lgkmcnt(4)
v_cvt_pk_bf16_f32 v235,v235,v236
M v[16:19],a[236:239],a[216:219],v[16:19]
s_waitcnt lgkmcnt(3)
ds_write2st64_b64 v253,v[232:233],v[234:235] offset0:51 offset1:55
M v[20:23],a[236:239],a[220:223],v[20:23]
s_waitcnt lgkmcnt(3)
v_accvgpr_read_b32 v238,a44
v_accvgpr_read_b32 v232,a140
M v[24:27],a[236:239],a[192:195],v[24:27]
s_waitcnt lgkmcnt(2)
v_add_f32 v234,v238,v232
v_sub_f32 v238,v238,v232
M v[28:31],a[236:239],a[196:199],v[28:31]
s_waitcnt vmcnt(10)
buffer_load_dwordx4 a[236:239],v251,s[20:23],s46 offen offset:0
M v[0:3],a[240:243],a[204:207],v[0:3]
ds_read_b128 a[204:207],v249 offset:11008
v_add_f32 v232,v44,v140
M v[4:7],a[240:243],a[208:211],v[4:7]
v_sub_f32 v140,v44,v140
v_add_f32 v44,v234,v232
M v[8:11],a[240:243],a[212:215],v[8:11]
v_fmac_f32 v234,4.0,v232
v_fma_f32 v232,2.0,v140,v238
M v[12:15],a[240:243],a[216:219],v[12:15]
v_fma_f32 v140,s41,v140,v238
v_accvgpr_read_b32 v238,a45
M v[16:19],a[240:243],a[220:223],v[16:19]
v_accvgpr_read_b32 v237,a141
v_add_f32 v236,v238,v237
M v[20:23],a[240:243],a[192:195],v[20:23]
v_sub_f32 v238,v238,v237
v_add_f32 v237,v45,v141
M v[24:27],a[240:243],a[196:199],v[24:27]
s_waitcnt lgkmcnt(2)
v_sub_f32 v141,v45,v141
v_add_f32 v45,v236,v237
M v[28:31],a[240:243],a[200:203],v[28:31]
s_waitcnt vmcnt(10)
buffer_load_dwordx4 a[240:243],v251,s[20:23],s46 offen offset:1024
M v[0:3],a[244:247],a[208:211],v[0:3]
ds_read_b128 a[208:211],v249 offset:0
v_fmac_f32 v236,4.0,v237
M v[4:7],a[244:247],a[212:215],v[4:7]
ds_read_b128 a[212:215],v250 offset:256
v_fma_f32 v237,2.0,v141,v238
M v[8:11],a[244:247],a[216:219],v[8:11]
ds_read_b128 a[216:219],v250 offset:512
v_fma_f32 v141,s41,v141,v238
M v[12:15],a[244:247],a[220:223],v[12:15]
ds_read_b128 a[220:223],v250 offset:768
v_cvt_pk_bf16_f32 v232,v232,v237
M v[16:19],a[244:247],a[192:195],v[16:19]
ds_read_b128 a[192:195],v250 offset:1024
v_cvt_pk_bf16_f32 v234,v234,v236
M v[20:23],a[244:247],a[196:199],v[20:23]
ds_read_b128 a[196:199],v250 offset:1280
v_accvgpr_read_b32 v238,a46
M v[24:27],a[244:247],a[200:203],v[24:27]
s_waitcnt lgkmcnt(6)
ds_read_b128 a[200:203],v250 offset:1536
v_accvgpr_read_b32 v233,a142
M v[28:31],a[244:247],a[204:207],v[28:31]
s_waitcnt vmcnt(10) lgkmcnt(6)
buffer_load_dwordx4 a[244:247],v251,s[20:23],s46 offen offset:2048
M v[96:99],a[248:251],a[208:211],v[96:99]
s_waitcnt lgkmcnt(5)
ds_read_b128 a[204:207],v250 offset:1792
ds_read_b128 a[208:211],v250 offset:2048
M v[100:103],a[248:251],a[212:215],v[100:103]
s_waitcnt lgkmcnt(6)
s_add_u32 s46,s80,46080
v_add_f32 v235,v238,v233
v_sub_f32 v238,v238,v233
M v[104:107],a[248:251],a[216:219],v[104:107]
s_waitcnt lgkmcnt(5)
v_add_f32 v233,v46,v142
v_sub_f32 v142,v46,v142
M v[108:111],a[248:251],a[220:223],v[108:111]
s_waitcnt lgkmcnt(4)
v_add_f32 v46,v235,v233
v_fmac_f32 v235,4.0,v233
M v[112:115],a[248:251],a[192:195],v[112:115]
s_waitcnt lgkmcnt(3)
v_fma_f32 v233,2.0,v142,v238
v_fma_f32 v142,s41,v142,v238
M v[116:119],a[248:251],a[196:199],v[116:119]
s_waitcnt lgkmcnt(2)
v_accvgpr_read_b32 v238,a47
v_accvgpr_read_b32 v237,a143
M v[120:123],a[248:251],a[200:203],v[120:123]
s_waitcnt lgkmcnt(1)
v_add_f32 v236,v238,v237
v_sub_f32 v238,v238,v237
M v[124:127],a[248:251],a[204:207],v[124:127]
s_waitcnt vmcnt(10)
buffer_load_dwordx4 a[248:251],v251,s[20:23],s46 offen offset:0
M v[96:99],a[252:255],a[212:215],v[96:99]
ds_read_b128 a[212:215],v249 offset:2304
v_add_f32 v237,v47,v143
M v[100:103],a[252:255],a[216:219],v[100:103]
v_sub_f32 v143,v47,v143
v_add_f32 v47,v236,v237
M v[104:107],a[252:255],a[220:223],v[104:107]
v_fmac_f32 v236,4.0,v237
v_fma_f32 v237,2.0,v143,v238
M v[108:111],a[252:255],a[192:195],v[108:111]
v_fma_f32 v143,s41,v143,v238
v_cvt_pk_bf16_f32 v233,v233,v237
M v[112:115],a[252:255],a[196:199],v[112:115]
v_cvt_pk_bf16_f32 v235,v235,v236
M v[116:119],a[252:255],a[200:203],v[116:119]
ds_write2st64_b64 v253,v[232:233],v[234:235] offset0:59 offset1:63
M v[120:123],a[252:255],a[204:207],v[120:123]
s_waitcnt lgkmcnt(2)
v_cvt_pk_bf16_f32 v0,v0,v1
v_cvt_pk_bf16_f32 v1,v2,v3
M v[124:127],a[252:255],a[208:211],v[124:127]
s_waitcnt vmcnt(10)
buffer_load_dwordx4 a[252:255],v251,s[20:23],s46 offen offset:1024
M v[96:99],v[216:219],a[216:219],v[96:99]
ds_read_b128 a[216:219],v249 offset:34816
v_cvt_pk_bf16_f32 v4,v4,v5
M v[100:103],v[216:219],a[220:223],v[100:103]
ds_read_b128 a[220:223],v250 offset:35072
v_cvt_pk_bf16_f32 v5,v6,v7
M v[104:107],v[216:219],a[192:195],v[104:107]
s_waitcnt lgkmcnt(2)
s_barrier
ds_read_b128 a[32:35],v251 offset:17408
M v[108:111],v[216:219],a[196:199],v[108:111]
ds_read_b128 a[36:39],v251 offset:21504
ds_read_b128 a[40:43],v251 offset:26112
M v[112:115],v[216:219],a[200:203],v[112:115]
ds_read_b128 a[44:47],v251 offset:30208
ds_read_b128 a[192:195],v250 offset:35328
M v[116:119],v[216:219],a[204:207],v[116:119]
ds_read_b128 a[196:199],v250 offset:35584
ds_read_b128 a[200:203],v250 offset:35840
M v[120:123],v[216:219],a[208:211],v[120:123]
ds_read_b128 a[204:207],v250 offset:36096
ds_read_b128 a[208:211],v250 offset:36352
M v[124:127],v[216:219],a[212:215],v[124:127]
s_waitcnt vmcnt(10) lgkmcnt(8)
s_add_u32 s34,s32,6291456
buffer_store_dwordx4 a[32:35],v252,s[24:27],s34 offen offset:512 nt
M v[96:99],v[220:223],a[216:219],v[96:99]
s_waitcnt lgkmcnt(7)
s_add_u32 s34,s32,6488064
buffer_store_dwordx4 a[36:39],v252,s[24:27],s34 offen offset:512 nt
M v[100:103],v[220:223],a[220:223],v[100:103]
s_waitcnt lgkmcnt(4)
s_add_u32 s34,s32,6684672
buffer_load_dwordx4 v[216:219],v251,s[20:23],s46 offen offset:2048
M v[104:107],v[220:223],a[192:195],v[104:107]
s_waitcnt lgkmcnt(3)
s_add_u32 s46,s81,46080
buffer_store_dwordx4 a[40:43],v252,s[24:27],s34 offen offset:512 nt
ds_read_b128 a[212:215],v250 offset:36608
M v[108:111],v[220:223],a[196:199],v[108:111]
s_waitcnt lgkmcnt(3)
s_add_u32 s34,s32,6881280
buffer_store_dwordx4 a[44:47],v252,s[24:27],s34 offen offset:512 nt
M v[112:115],v[220:223],a[200:203],v[112:115]
s_waitcnt lgkmcnt(2)
ds_read_b128 a[216:219],v250 offset:36864
ds_write2st64_b64 v253,v[0:1],v[4:5] offset0:17 offset1:21
M v[116:119],v[220:223],a[204:207],v[116:119]
s_waitcnt lgkmcnt(3)
v_cvt_pk_bf16_f32 v8,v8,v9
v_cvt_pk_bf16_f32 v9,v10,v11
M v[120:123],v[220:223],a[208:211],v[120:123]
s_waitcnt lgkmcnt(2)
v_cvt_pk_bf16_f32 v12,v12,v13
v_cvt_pk_bf16_f32 v13,v14,v15
M v[124:127],v[220:223],a[212:215],v[124:127]
s_waitcnt vmcnt(14)
buffer_load_dwordx4 v[220:223],v251,s[20:23],s46 offen offset:0
M v[96:99],v[224:227],a[220:223],v[96:99]
ds_read_b128 a[220:223],v249 offset:37120
ds_write2st64_b64 v253,v[8:9],v[12:13] offset0:25 offset1:29
M v[100:103],v[224:227],a[192:195],v[100:103]
v_cvt_pk_bf16_f32 v16,v16,v17
v_cvt_pk_bf16_f32 v17,v18,v19
M v[104:107],v[224:227],a[196:199],v[104:107]
v_cvt_pk_bf16_f32 v20,v20,v21
v_cvt_pk_bf16_f32 v21,v22,v23
M v[108:111],v[224:227],a[200:203],v[108:111]
ds_write2st64_b64 v253,v[16:17],v[20:21] offset0:68 offset1:72
M v[112:115],v[224:227],a[204:207],v[112:115]
v_cvt_pk_bf16_f32 v24,v24,v25
v_cvt_pk_bf16_f32 v25,v26,v27
M v[116:119],v[224:227],a[208:211],v[116:119]
v_cvt_pk_bf16_f32 v28,v28,v29
v_cvt_pk_bf16_f32 v29,v30,v31
M v[120:123],v[224:227],a[212:215],v[120:123]
s_waitcnt lgkmcnt(4)
ds_write2st64_b64 v253,v[24:25],v[28:29] offset0:76 offset1:80
M v[124:127],v[224:227],a[216:219],v[124:127]
s_waitcnt vmcnt(14)
buffer_load_dwordx4 v[224:227],v251,s[20:23],s46 offen offset:1024
M v[96:99],v[228:231],a[192:195],v[96:99]
ds_read_b128 a[192:195],v249 offset:52224
v_accvgpr_read_b32 v238,a48
M v[100:103],v[228:231],a[196:199],v[100:103]
ds_read_b128 a[196:199],v250 offset:52480
v_accvgpr_read_b32 v232,a144
M v[104:107],v[228:231],a[200:203],v[104:107]
ds_read_b128 a[200:203],v250 offset:52736
v_add_f32 v234,v238,v232
M v[108:111],v[228:231],a[204:207],v[108:111]
ds_read_b128 a[204:207],v250 offset:52992
v_sub_f32 v238,v238,v232
M v[112:115],v[228:231],a[208:211],v[112:115]
ds_read_b128 a[208:211],v250 offset:53248
v_add_f32 v232,v48,v144
M v[116:119],v[228:231],a[212:215],v[116:119]
ds_read_b128 a[212:215],v250 offset:53504
v_sub_f32 v144,v48,v144
M v[120:123],v[228:231],a[216:219],v[120:123]
s_waitcnt lgkmcnt(9)
ds_read_b128 a[216:219],v250 offset:53760
v_add_f32 v48,v234,v232
M v[124:127],v[228:231],a[220:223],v[124:127]
s_waitcnt vmcnt(14) lgkmcnt(6)
buffer_load_dwordx4 v[228:231],v251,s[20:23],s46 offen offset:2048
M v[96:99],a[224:227],a[192:195],v[96:99]
s_waitcnt lgkmcnt(5)
ds_read_b128 a[220:223],v250 offset:54016
ds_read_b128 a[192:195],v250 offset:54272
M v[100:103],a[224:227],a[196:199],v[100:103]
s_waitcnt lgkmcnt(6)
s_add_u32 s47,s76,3072
v_fmac_f32 v234,4.0,v232
v_fma_f32 v232,2.0,v144,v238
M v[104:107],a[224:227],a[200:203],v[104:107]
s_waitcnt lgkmcnt(5)
v_fma_f32 v144,s41,v144,v238
v_accvgpr_read_b32 v238,a49
M v[108:111],a[224:227],a[204:207],v[108:111]
s_waitcnt lgkmcnt(4)
v_accvgpr_read_b32 v237,a145
v_add_f32 v236,v238,v237
M v[112:115],a[224:227],a[208:211],v[112:115]
s_waitcnt lgkmcnt(3)
v_sub_f32 v238,v238,v237
v_add_f32 v237,v49,v145
M v[116:119],a[224:227],a[212:215],v[116:119]
s_waitcnt lgkmcnt(2)
v_sub_f32 v145,v49,v145
v_add_f32 v49,v236,v237
M v[120:123],a[224:227],a[216:219],v[120:123]
s_waitcnt lgkmcnt(1)
v_fmac_f32 v236,4.0,v237
v_fma_f32 v237,2.0,v145,v238
M v[124:127],a[224:227],a[220:223],v[124:127]
s_waitcnt vmcnt(14)
buffer_load_dwordx4 a[224:227],v251,s[20:23],s47 offen offset:0
M v[96:99],a[228:231],a[196:199],v[96:99]
ds_read_b128 a[196:199],v249 offset:54528
v_fma_f32 v145,s41,v145,v238
M v[100:103],a[228:231],a[200:203],v[100:103]
v_cvt_pk_bf16_f32 v232,v232,v237
v_cvt_pk_bf16_f32 v234,v234,v236
M v[104:107],a[228:231],a[204:207],v[104:107]
v_accvgpr_read_b32 v238,a50
v_accvgpr_read_b32 v233,a146
M v[108:111],a[228:231],a[208:211],v[108:111]
v_add_f32 v235,v238,v233
v_sub_f32 v238,v238,v233
M v[112:115],a[228:231],a[212:215],v[112:115]
v_add_f32 v233,v50,v146
v_sub_f32 v146,v50,v146
M v[116:119],a[228:231],a[216:219],v[116:119]
v_add_u32 v249,0x11000,v249
v_add_u32 v250,0x11000,v250
M v[120:123],a[228:231],a[220:223],v[120:123]
s_waitcnt lgkmcnt(1)
v_add_f32 v50,v235,v233
v_fmac_f32 v235,4.0,v233
M v[124:127],a[228:231],a[192:195],v[124:127]
s_waitcnt vmcnt(14)
buffer_load_dwordx4 a[228:231],v251,s[20:23],s47 offen offset:1024
M v[96:99],a[232:235],a[200:203],v[96:99]
ds_read_b128 a[200:203],v249 offset:0
v_fma_f32 v233,2.0,v146,v238
M v[100:103],a[232:235],a[204:207],v[100:103]
ds_read_b128 a[204:207],v250 offset:256
v_fma_f32 v146,s41,v146,v238
M v[104:107],a[232:235],a[208:211],v[104:107]
ds_read_b128 a[208:211],v250 offset:512
v_accvgpr_read_b32 v238,a51
M v[108:111],a[232:235],a[212:215],v[108:111]
ds_read_b128 a[212:215],v250 offset:768
v_accvgpr_read_b32 v237,a147
M v[112:115],a[232:235],a[216:219],v[112:115]
ds_read_b128 a[216:219],v250 offset:1024
v_add_f32 v236,v238,v237
M v[116:119],a[232:235],a[220:223],v[116:119]
ds_read_b128 a[220:223],v250 offset:1280
v_sub_f32 v238,v238,v237
M v[120:123],a[232:235],a[192:195],v[120:123]
s_waitcnt lgkmcnt(6)
ds_read_b128 a[192:195],v250 offset:1536
v_add_f32 v237,v51,v147
M v[124:127],a[232:235],a[196:199],v[124:127]
s_waitcnt vmcnt(14) lgkmcnt(6)
buffer_load_dwordx4 a[232:235],v251,s[20:23],s47 offen offset:2048
M v[96:99],a[236:239],a[200:203],v[96:99]
s_waitcnt lgkmcnt(5)
ds_read_b128 a[196:199],v250 offset:1792
ds_read_b128 a[200:203],v250 offset:2048
M v[100:103],a[236:239],a[204:207],v[100:103]
s_waitcnt lgkmcnt(6)
s_add_u32 s47,s77,3072
v_sub_f32 v147,v51,v147
v_add_f32 v51,v236,v237
M v[104:107],a[236:239],a[208:211],v[104:107]
s_waitcnt lgkmcnt(5)
v_fmac_f32 v236,4.0,v237
v_fma_f32 v237,2.0,v147,v238
M v[108:111],a[236:239],a[212:215],v[108:111]
s_waitcnt lgkmcnt(4)
v_fma_f32 v147,s41,v147,v238
v_cvt_pk_bf16_f32 v233,v233,v237
M v[112:115],a[236:239],a[216:219],v[112:115]
s_waitcnt lgkmcnt(3)
v_cvt_pk_bf16_f32 v235,v235,v236
M v[116:119],a[236:239],a[220:223],v[116:119]
s_waitcnt lgkmcnt(2)
ds_write2st64_b64 v253,v[232:233],v[234:235] offset0:85 offset1:89
M v[120:123],a[236:239],a[192:195],v[120:123]
s_waitcnt lgkmcnt(2)
v_accvgpr_read_b32 v238,a52
v_accvgpr_read_b32 v232,a148
M v[124:127],a[236:239],a[196:199],v[124:127]
s_waitcnt vmcnt(14)
buffer_load_dwordx4 a[236:239],v251,s[20:23],s47 offen offset:0
M v[96:99],a[240:243],a[204:207],v[96:99]
ds_read_b128 a[204:207],v249 offset:2304
v_add_f32 v234,v238,v232
M v[100:103],a[240:243],a[208:211],v[100:103]
v_sub_f32 v238,v238,v232
v_add_f32 v232,v52,v148
M v[104:107],a[240:243],a[212:215],v[104:107]
v_sub_f32 v148,v52,v148
v_add_f32 v52,v234,v232
M v[108:111],a[240:243],a[216:219],v[108:111]
v_fmac_f32 v234,4.0,v232
v_fma_f32 v232,2.0,v148,v238
M v[112:115],a[240:243],a[220:223],v[112:115]
v_fma_f32 v148,s41,v148,v238
v_accvgpr_read_b32 v238,a53
M v[116:119],a[240:243],a[192:195],v[116:119]
v_accvgpr_read_b32 v237,a149
v_add_f32 v236,v238,v237
M v[120:123],a[240:243],a[196:199],v[120:123]
s_waitcnt lgkmcnt(2)
v_sub_f32 v238,v238,v237
v_add_f32 v237,v53,v149
M v[124:127],a[240:243],a[200:203],v[124:127]
s_waitcnt vmcnt(14)
buffer_load_dwordx4 a[240:243],v251,s[20:23],s47 offen offset:1024
M v[96:99],a[244:247],a[208:211],v[96:99]
ds_read_b128 a[208:211],v249 offset:17408
v_sub_f32 v149,v53,v149
M v[100:103],a[244:247],a[212:215],v[100:103]
ds_read_b128 a[212:215],v250 offset:17664
v_add_f32 v53,v236,v237
M v[104:107],a[244:247],a[216:219],v[104:107]
ds_read_b128 a[216:219],v250 offset:17920
v_fmac_f32 v236,4.0,v237
M v[108:111],a[244:247],a[220:223],v[108:111]
ds_read_b128 a[220:223],v250 offset:18176
v_fma_f32 v237,2.0,v149,v238
M v[112:115],a[244:247],a[192:195],v[112:115]
ds_read_b128 a[192:195],v250 offset:18432
v_fma_f32 v149,s41,v149,v238
M v[116:119],a[244:247],a[196:199],v[116:119]
ds_read_b128 a[196:199],v250 offset:18688
v_cvt_pk_bf16_f32 v232,v232,v237
M v[120:123],a[244:247],a[200:203],v[120:123]
s_waitcnt lgkmcnt(6)
ds_read_b128 a[200:203],v250 offset:18944
v_cvt_pk_bf16_f32 v234,v234,v236
M v[124:127],a[244:247],a[204:207],v[124:127]
s_waitcnt vmcnt(14) lgkmcnt(6)
buffer_load_dwordx4 a[244:247],v251,s[20:23],s47 offen offset:2048
M v[96:99],a[248:251],a[208:211],v[96:99]
s_waitcnt lgkmcnt(5)
ds_read_b128 a[204:207],v250 offset:19200
ds_read_b128 a[208:211],v250 offset:19456
M v[100:103],a[248:251],a[212:215],v[100:103]
s_waitcnt lgkmcnt(6)
s_add_u32 s47,s78,3072
v_accvgpr_read_b32 v238,a54
v_accvgpr_read_b32 v233,a150
M v[104:107],a[248:251],a[216:219],v[104:107]
s_waitcnt lgkmcnt(5)
v_add_f32 v235,v238,v233
v_sub_f32 v238,v238,v233
M v[108:111],a[248:251],a[220:223],v[108:111]
s_waitcnt lgkmcnt(4)
v_add_f32 v233,v54,v150
v_sub_f32 v150,v54,v150
M v[112:115],a[248:251],a[192:195],v[112:115]
s_waitcnt lgkmcnt(3)
v_add_f32 v54,v235,v233
v_fmac_f32 v235,4.0,v233
M v[116:119],a[248:251],a[196:199],v[116:119]
s_waitcnt lgkmcnt(2)
v_fma_f32 v233,2.0,v150,v238
v_fma_f32 v150,s41,v150,v238
M v[120:123],a[248:251],a[200:203],v[120:123]
s_waitcnt lgkmcnt(1)
v_accvgpr_read_b32 v238,a55
v_accvgpr_read_b32 v237,a151
M v[124:127],a[248:251],a[204:207],v[124:127]
s_waitcnt vmcnt(14)
buffer_load_dwordx4 a[248:251],v251,s[20:23],s47 offen offset:0
M v[96:99],a[252:255],a[212:215],v[96:99]
ds_read_b128 a[212:215],v249 offset:19712
v_add_f32 v236,v238,v237
M v[100:103],a[252:255],a[216:219],v[100:103]
v_sub_f32 v238,v238,v237
v_add_f32 v237,v55,v151
M v[104:107],a[252:255],a[220:223],v[104:107]
v_sub_f32 v151,v55,v151
v_add_f32 v55,v236,v237
M v[108:111],a[252:255],a[192:195],v[108:111]
v_fmac_f32 v236,4.0,v237
v_fma_f32 v237,2.0,v151,v238
M v[112:115],a[252:255],a[196:199],v[112:115]
v_fma_f32 v151,s41,v151,v238
v_cvt_pk_bf16_f32 v233,v233,v237
M v[116:119],a[252:255],a[200:203],v[116:119]
v_add_u32 v249,0xfffece00,v249
v_add_u32 v250,0xfffece00,v250
M v[120:123],a[252:255],a[204:207],v[120:123]
s_waitcnt lgkmcnt(1)
v_cvt_pk_bf16_f32 v235,v235,v236
M v[124:127],a[252:255],a[208:211],v[124:127]
s_waitcnt vmcnt(12)
buffer_load_dwordx4 a[252:255],v251,s[20:23],s47 offen offset:1024
M v[96:99],v[216:219],a[216:219],v[96:99]
ds_read_b128 a[216:219],v249 offset:26112
ds_write2st64_b64 v253,v[232:233],v[234:235] offset0:93 offset1:97
M v[100:103],v[216:219],a[220:223],v[100:103]
ds_read_b128 a[220:223],v250 offset:26368
v_accvgpr_read_b32 v238,a56
M v[104:107],v[216:219],a[192:195],v[104:107]
ds_read_b128 a[192:195],v250 offset:26624
v_accvgpr_read_b32 v232,a152
M v[108:111],v[216:219],a[196:199],v[108:111]
ds_read_b128 a[196:199],v250 offset:26880
v_add_f32 v234,v238,v232
M v[112:115],v[216:219],a[200:203],v[112:115]
ds_read_b128 a[200:203],v250 offset:27136
v_sub_f32 v238,v238,v232
M v[116:119],v[216:219],a[204:207],v[116:119]
ds_read_b128 a[204:207],v250 offset:27392
v_add_f32 v232,v56,v152
M v[120:123],v[216:219],a[208:211],v[120:123]
s_waitcnt lgkmcnt(7)
ds_read_b128 a[208:211],v250 offset:27648
v_sub_f32 v152,v56,v152
M v[124:127],v[216:219],a[212:215],v[124:127]
s_waitcnt vmcnt(10) lgkmcnt(6)
s_barrier
ds_read_b128 a[96:99],v251 offset:8704
M v[96:99],v[220:223],a[216:219],v[96:99]
s_waitcnt lgkmcnt(6)
ds_read_b128 a[100:103],v251 offset:12800
ds_read_b128 a[104:107],v251 offset:34816
M v[100:103],v[220:223],a[220:223],v[100:103]
s_waitcnt lgkmcnt(7)
ds_read_b128 a[108:111],v251 offset:38912
ds_read_b128 a[48:51],v251 offset:43520
M v[104:107],v[220:223],a[192:195],v[104:107]
s_waitcnt lgkmcnt(8)
ds_read_b128 a[52:55],v251 offset:47616
ds_read_b128 a[212:215],v250 offset:27904
M v[108:111],v[220:223],a[196:199],v[108:111]
s_waitcnt lgkmcnt(9)
buffer_load_dwordx4 v[216:219],v251,s[20:23],s47 offen offset:2048
M v[112:115],v[220:223],a[200:203],v[112:115]
s_waitcnt lgkmcnt(6)
s_add_u32 s34,s33,6291456
buffer_store_dwordx4 a[96:99],v252,s[24:27],s34 offen offset:0 nt
M v[116:119],v[220:223],a[204:207],v[116:119]
s_waitcnt lgkmcnt(5)
s_add_u32 s34,s33,6684672
buffer_store_dwordx4 a[100:103],v252,s[24:27],s34 offen offset:0 nt
M v[120:123],v[220:223],a[208:211],v[120:123]
s_waitcnt lgkmcnt(0)
s_add_u32 s34,s33,7077888
buffer_store_dwordx4 a[104:107],v252,s[24:27],s34 offen offset:0 nt
M v[124:127],v[220:223],a[212:215],v[124:127]
s_waitcnt vmcnt(13)
s_add_u32 s34,s33,7471104
buffer_store_dwordx4 a[108:111],v252,s[24:27],s34 offen offset:0 nt
M v[96:99],v[224:227],a[220:223],v[96:99]
s_nop 0
s_add_u32 s34,s32,7077888
buffer_store_dwordx4 a[48:51],v252,s[24:27],s34 offen offset:512 nt
v_add_f32 v56,v234,v232
v_fmac_f32 v234,4.0,v232
v_fma_f32 v232,2.0,v152,v238
M v[100:103],v[224:227],a[192:195],v[100:103]
s_add_u32 s34,s32,7274496
buffer_store_dwordx4 a[52:55],v252,s[24:27],s34 offen offset:512 nt
v_fma_f32 v152,s41,v152,v238
v_accvgpr_read_b32 v238,a57
v_accvgpr_read_b32 v237,a153
v_add_f32 v236,v238,v237
M v[104:107],v[224:227],a[196:199],v[104:107]
s_add_u32 s47,s79,3072
buffer_load_dwordx4 v[220:223],v251,s[20:23],s47 offen offset:0
ds_read_b128 a[216:219],v250 offset:28160
v_sub_f32 v238,v238,v237
v_add_f32 v237,v57,v153
v_sub_f32 v153,v57,v153
v_add_f32 v57,v236,v237
M v[108:111],v[224:227],a[200:203],v[108:111]
ds_read_b128 a[220:223],v249 offset:28416
v_fmac_f32 v236,4.0,v237
v_fma_f32 v237,2.0,v153,v238
v_fma_f32 v153,s41,v153,v238
v_cvt_pk_bf16_f32 v232,v232,v237
M v[112:115],v[224:227],a[204:207],v[112:115]
v_cvt_pk_bf16_f32 v234,v234,v236
v_accvgpr_read_b32 v238,a58
v_accvgpr_read_b32 v233,a154
v_add_f32 v235,v238,v233
M v[116:119],v[224:227],a[208:211],v[116:119]
v_sub_f32 v238,v238,v233
v_add_f32 v233,v58,v154
v_sub_f32 v154,v58,v154
v_add_f32 v58,v235,v233
M v[120:123],v[224:227],a[212:215],v[120:123]
s_waitcnt lgkmcnt(1)
v_fmac_f32 v235,4.0,v233
v_fma_f32 v233,2.0,v154,v238
v_fma_f32 v154,s41,v154,v238
v_accvgpr_read_b32 v238,a59
M v[124:127],v[224:227],a[216:219],v[124:127]
s_waitcnt vmcnt(16)
buffer_load_dwordx4 v[224:227],v251,s[20:23],s47 offen offset:1024
v_accvgpr_read_b32 v237,a155
v_add_f32 v236,v238,v237
v_sub_f32 v238,v238,v237
v_add_f32 v237,v59,v155
M v[96:99],v[228:231],a[192:195],v[96:99]
ds_read_b128 a[192:195],v249 offset:0
v_sub_f32 v155,v59,v155
v_add_f32 v59,v236,v237
v_fmac_f32 v236,4.0,v237
v_fma_f32 v237,2.0,v155,v238
M v[100:103],v[228:231],a[196:199],v[100:103]
ds_read_b128 a[196:199],v250 offset:256
v_fma_f32 v155,s41,v155,v238
v_cvt_pk_bf16_f32 v233,v233,v237
v_cvt_pk_bf16_f32 v235,v235,v236
M v[104:107],v[228:231],a[200:203],v[104:107]
ds_write2st64_b64 v253,v[232:233],v[234:235] offset0:34 offset1:38
M v[108:111],v[228:231],a[204:207],v[108:111]
ds_read_b128 a[200:203],v250 offset:512
ds_read_b128 a[204:207],v250 offset:768
v_accvgpr_read_b32 v238,a60
v_accvgpr_read_b32 v232,a156
M v[112:115],v[228:231],a[208:211],v[112:115]
ds_read_b128 a[208:211],v250 offset:1024
v_add_f32 v234,v238,v232
v_sub_f32 v238,v238,v232
v_add_f32 v232,v60,v156
v_sub_f32 v156,v60,v156
M v[116:119],v[228:231],a[212:215],v[116:119]
ds_read_b128 a[212:215],v250 offset:1280
v_add_f32 v60,v234,v232
v_fmac_f32 v234,4.0,v232
v_fma_f32 v232,2.0,v156,v238
v_fma_f32 v156,s41,v156,v238
M v[120:123],v[228:231],a[216:219],v[120:123]
s_waitcnt lgkmcnt(7)
ds_read_b128 a[216:219],v250 offset:1536
v_accvgpr_read_b32 v238,a61
v_accvgpr_read_b32 v237,a157
v_add_f32 v236,v238,v237
v_sub_f32 v238,v238,v237
M v[124:127],v[228:231],a[220:223],v[124:127]
s_waitcnt vmcnt(16) lgkmcnt(7)
buffer_load_dwordx4 v[228:231],v251,s[20:23],s47 offen offset:2048
v_add_f32 v237,v61,v157
v_sub_f32 v157,v61,v157
v_add_f32 v61,v236,v237
v_fmac_f32 v236,4.0,v237
M v[32:35],a[224:227],a[192:195],v[32:35]
s_waitcnt lgkmcnt(6)
ds_read_b128 a[220:223],v250 offset:1792
ds_read_b128 a[192:195],v250 offset:2048
v_fma_f32 v237,2.0,v157,v238
v_fma_f32 v157,s41,v157,v238
v_cvt_pk_bf16_f32 v232,v232,v237
v_cvt_pk_bf16_f32 v234,v234,v236
M v[36:39],a[224:227],a[196:199],v[36:39]
s_waitcnt lgkmcnt(6)
s_add_u32 s47,s80,3072
v_accvgpr_read_b32 v238,a62
v_accvgpr_read_b32 v233,a158
v_add_f32 v235,v238,v233
v_sub_f32 v238,v238,v233
M v[40:43],a[224:227],a[200:203],v[40:43]
s_waitcnt lgkmcnt(5)
v_add_f32 v233,v62,v158
v_sub_f32 v158,v62,v158
v_add_f32 v62,v235,v233
v_fmac_f32 v235,4.0,v233
M v[44:47],a[224:227],a[204:207],v[44:47]
s_waitcnt lgkmcnt(4)
v_fma_f32 v233,2.0,v158,v238
v_fma_f32 v158,s41,v158,v238
v_accvgpr_read_b32 v238,a63
v_accvgpr_read_b32 v237,a159
M v[48:51],a[224:227],a[208:211],v[48:51]
s_waitcnt lgkmcnt(3)
v_add_f32 v236,v238,v237
v_sub_f32 v238,v238,v237
v_add_f32 v237,v63,v159
v_sub_f32 v159,v63,v159
M v[52:55],a[224:227],a[212:215],v[52:55]
s_waitcnt lgkmcnt(2)
v_add_f32 v63,v236,v237
v_fmac_f32 v236,4.0,v237
M v[56:59],a[224:227],a[216:219],v[56:59]
s_waitcnt lgkmcnt(1)
v_fma_f32 v237,2.0,v159,v238
v_fma_f32 v159,s41,v159,v238
M v[60:63],a[224:227],a[220:223],v[60:63]
s_waitcnt vmcnt(16)
buffer_load_dwordx4 a[224:227],v251,s[20:23],s47 offen offset:0
M v[32:35],a[228:231],a[196:199],v[32:35]
ds_read_b128 a[196:199],v249 offset:2304
v_cvt_pk_bf16_f32 v233,v233,v237
M v[36:39],a[228:231],a[200:203],v[36:39]
v_cvt_pk_bf16_f32 v235,v235,v236
M v[40:43],a[228:231],a[204:207],v[40:43]
ds_write2st64_b64 v253,v[232:233],v[234:235] offset0:42 offset1:46
M v[44:47],a[228:231],a[208:211],v[44:47]
v_cvt_pk_bf16_f32 v96,v96,v97
v_cvt_pk_bf16_f32 v97,v98,v99
M v[48:51],a[228:231],a[212:215],v[48:51]
v_cvt_pk_bf16_f32 v100,v100,v101
v_cvt_pk_bf16_f32 v101,v102,v103
M v[52:55],a[228:231],a[216:219],v[52:55]
ds_write2st64_b64 v253,v[96:97],v[100:101] offset0:51 offset1:55
M v[56:59],a[228:231],a[220:223],v[56:59]
s_waitcnt lgkmcnt(3)
v_cvt_pk_bf16_f32 v104,v104,v105
v_cvt_pk_bf16_f32 v105,v106,v107
M v[60:63],a[228:231],a[192:195],v[60:63]
s_waitcnt vmcnt(16)
buffer_load_dwordx4 a[228:231],v251,s[20:23],s47 offen offset:1024
M v[32:35],a[232:235],a[200:203],v[32:35]
ds_read_b128 a[200:203],v249 offset:34816
v_cvt_pk_bf16_f32 v108,v108,v109
M v[36:39],a[232:235],a[204:207],v[36:39]
ds_read_b128 a[204:207],v250 offset:35072
v_cvt_pk_bf16_f32 v109,v110,v111
M v[40:43],a[232:235],a[208:211],v[40:43]
ds_read_b128 a[208:211],v250 offset:35328
ds_write2st64_b64 v253,v[104:105],v[108:109] offset0:59 offset1:63
M v[44:47],a[232:235],a[212:215],v[44:47]
ds_read_b128 a[212:215],v250 offset:35584
v_cvt_pk_bf16_f32 v112,v112,v113
M v[48:51],a[232:235],a[216:219],v[48:51]
ds_read_b128 a[216:219],v250 offset:35840
v_cvt_pk_bf16_f32 v113,v114,v115
M v[52:55],a[232:235],a[220:223],v[52:55]
ds_read_b128 a[220:223],v250 offset:36096
v_cvt_pk_bf16_f32 v116,v116,v117
M v[56:59],a[232:235],a[192:195],v[56:59]
s_waitcnt lgkmcnt(9)
ds_read_b128 a[192:195],v250 offset:36352
v_cvt_pk_bf16_f32 v117,v118,v119
M v[60:63],a[232:235],a[196:199],v[60:63]
s_waitcnt vmcnt(16) lgkmcnt(7)
buffer_load_dwordx4 a[232:235],v251,s[20:23],s47 offen offset:2048
M v[32:35],a[236:239],a[200:203],v[32:35]
s_waitcnt lgkmcnt(6)
ds_read_b128 a[196:199],v250 offset:36608
ds_read_b128 a[200:203],v250 offset:36864
M v[36:39],a[236:239],a[204:207],v[36:39]
s_waitcnt lgkmcnt(7)
s_add_u32 s47,s81,3072
ds_write2st64_b64 v253,v[112:113],v[116:117] offset0:0 offset1:4
M v[40:43],a[236:239],a[208:211],v[40:43]
s_waitcnt lgkmcnt(6)
v_cvt_pk_bf16_f32 v120,v120,v121
v_cvt_pk_bf16_f32 v121,v122,v123
M v[44:47],a[236:239],a[212:215],v[44:47]
s_waitcnt lgkmcnt(5)
v_cvt_pk_bf16_f32 v124,v124,v125
v_cvt_pk_bf16_f32 v125,v126,v127
M v[48:51],a[236:239],a[216:219],v[48:51]
s_waitcnt lgkmcnt(4)
ds_write2st64_b64 v253,v[120:121],v[124:125] offset0:8 offset1:12
M v[52:55],a[236:239],a[220:223],v[52:55]
s_waitcnt lgkmcnt(4)
v_accvgpr_read_b32 v238,a64
v_accvgpr_read_b32 v232,a160
M v[56:59],a[236:239],a[192:195],v[56:59]
s_waitcnt lgkmcnt(3)
v_add_f32 v234,v238,v232
v_sub_f32 v238,v238,v232
M v[60:63],a[236:239],a[196:199],v[60:63]
s_waitcnt vmcnt(16)
buffer_load_dwordx4 a[236:239],v251,s[20:23],s47 offen offset:0
M v[32:35],a[240:243],a[204:207],v[32:35]
ds_read_b128 a[204:207],v249 offset:37120
v_add_f32 v232,v64,v160
M v[36:39],a[240:243],a[208:211],v[36:39]
v_sub_f32 v160,v64,v160
M v[40:43],a[240:243],a[212:215],v[40:43]
s_waitcnt lgkmcnt(1)
s_barrier
ds_read_b128 a[56:59],v251 offset:17408
M v[44:47],a[240:243],a[216:219],v[44:47]
ds_read_b128 a[60:63],v251 offset:21504
ds_read_b128 a[112:115],v251 offset:26112
M v[48:51],a[240:243],a[220:223],v[48:51]
ds_read_b128 a[116:119],v251 offset:30208
ds_read_b128 a[120:123],v251 offset:0
M v[52:55],a[240:243],a[192:195],v[52:55]
ds_read_b128 a[124:127],v251 offset:4096
v_add_f32 v64,v234,v232
M v[56:59],a[240:243],a[196:199],v[56:59]
v_fmac_f32 v234,4.0,v232
v_fma_f32 v232,2.0,v160,v238
M v[60:63],a[240:243],a[200:203],v[60:63]
s_waitcnt vmcnt(16)
s_add_u32 s34,s32,7471104
buffer_load_dwordx4 a[240:243],v251,s[20:23],s47 offen offset:1024
M v[32:35],a[244:247],a[208:211],v[32:35]
s_waitcnt lgkmcnt(5)
buffer_store_dwordx4 a[56:59],v252,s[24:27],s34 offen offset:512 nt
M v[36:39],a[244:247],a[212:215],v[36:39]
s_waitcnt lgkmcnt(4)
s_add_u32 s34,s32,7667712
buffer_store_dwordx4 a[60:63],v252,s[24:27],s34 offen offset:512 nt
M v[40:43],a[244:247],a[216:219],v[40:43]
s_waitcnt lgkmcnt(3)
s_add_u32 s34,s33,6291456
buffer_store_dwordx4 a[112:115],v252,s[24:27],s34 offen offset:1152 nt
M v[44:47],a[244:247],a[220:223],v[44:47]
s_waitcnt lgkmcnt(2)
s_add_u32 s34,s33,6684672
buffer_store_dwordx4 a[116:119],v252,s[24:27],s34 offen offset:1152 nt
ds_read_b128 a[208:211],v249 offset:52224
M v[48:51],a[244:247],a[192:195],v[48:51]
ds_read_b128 a[212:215],v250 offset:52480
ds_read_b128 a[216:219],v250 offset:52736
M v[52:55],a[244:247],a[196:199],v[52:55]
ds_read_b128 a[220:223],v250 offset:52992
ds_read_b128 a[192:195],v250 offset:53248
M v[56:59],a[244:247],a[200:203],v[56:59]
ds_read_b128 a[196:199],v250 offset:53504
ds_read_b128 a[200:203],v250 offset:53760
M v[60:63],a[244:247],a[204:207],v[60:63]
s_waitcnt vmcnt(20) lgkmcnt(6)
buffer_load_dwordx4 a[244:247],v251,s[20:23],s47 offen offset:2048
M v[32:35],a[248:251],a[208:211],v[32:35]
s_waitcnt lgkmcnt(5)
ds_read_b128 a[204:207],v250 offset:54016
ds_read_b128 a[208:211],v250 offset:54272
M v[36:39],a[248:251],a[212:215],v[36:39]
s_waitcnt lgkmcnt(6)
s_add_u32 s47,s76,49152
v_fma_f32 v160,s41,v160,v238
v_accvgpr_read_b32 v238,a65
M v[40:43],a[248:251],a[216:219],v[40:43]
s_waitcnt lgkmcnt(5)
v_accvgpr_read_b32 v237,a161
v_add_f32 v236,v238,v237
M v[44:47],a[248:251],a[220:223],v[44:47]
s_waitcnt lgkmcnt(4)
v_sub_f32 v238,v238,v237
v_add_f32 v237,v65,v161
M v[48:51],a[248:251],a[192:195],v[48:51]
s_waitcnt lgkmcnt(3)
v_sub_f32 v161,v65,v161
v_add_f32 v65,v236,v237
M v[52:55],a[248:251],a[196:199],v[52:55]
s_waitcnt lgkmcnt(2)
v_fmac_f32 v236,4.0,v237
v_fma_f32 v237,2.0,v161,v238
M v[56:59],a[248:251],a[200:203],v[56:59]
s_waitcnt lgkmcnt(1)
v_fma_f32 v161,s41,v161,v238
v_cvt_pk_bf16_f32 v232,v232,v237
M v[60:63],a[248:251],a[204:207],v[60:63]
s_waitcnt vmcnt(20)
buffer_load_dwordx4 a[248:251],v251,s[20:23],s47 offen offset:0
M v[32:35],a[252:255],a[212:215],v[32:35]
ds_read_b128 a[212:215],v249 offset:54528
v_cvt_pk_bf16_f32 v234,v234,v236
M v[36:39],a[252:255],a[216:219],v[36:39]
v_accvgpr_read_b32 v238,a66
v_accvgpr_read_b32 v233,a162
M v[40:43],a[252:255],a[220:223],v[40:43]
v_add_f32 v235,v238,v233
v_sub_f32 v238,v238,v233
M v[44:47],a[252:255],a[192:195],v[44:47]
s_add_u32 s34,s33,7077888
buffer_store_dwordx4 a[120:123],v252,s[24:27],s34 offen offset:1152 nt
M v[48:51],a[252:255],a[196:199],v[48:51]
v_add_f32 v233,v66,v162
v_sub_f32 v162,v66,v162
M v[52:55],a[252:255],a[200:203],v[52:55]
v_add_u32 v249,0x11000,v249
v_add_u32 v250,0x11000,v250
M v[56:59],a[252:255],a[204:207],v[56:59]
s_waitcnt lgkmcnt(1)
v_add_f32 v66,v235,v233
v_fmac_f32 v235,4.0,v233
M v[60:63],a[252:255],a[208:211],v[60:63]
s_waitcnt vmcnt(21)
buffer_load_dwordx4 a[252:255],v251,s[20:23],s47 offen offset:1024
M v[32:35],v[216:219],a[216:219],v[32:35]
ds_read_b128 a[216:219],v249 offset:0
v_fma_f32 v233,2.0,v162,v238
M v[36:39],v[216:219],a[220:223],v[36:39]
ds_read_b128 a[220:223],v250 offset:256
v_fma_f32 v162,s41,v162,v238
M v[40:43],v[216:219],a[192:195],v[40:43]
ds_read_b128 a[192:195],v250 offset:512
v_accvgpr_read_b32 v238,a67
M v[44:47],v[216:219],a[196:199],v[44:47]
ds_read_b128 a[196:199],v250 offset:768
v_accvgpr_read_b32 v237,a163
M v[48:51],v[216:219],a[200:203],v[48:51]
ds_read_b128 a[200:203],v250 offset:1024
v_add_f32 v236,v238,v237
M v[52:55],v[216:219],a[204:207],v[52:55]
ds_read_b128 a[204:207],v250 offset:1280
v_sub_f32 v238,v238,v237
M v[56:59],v[216:219],a[208:211],v[56:59]
s_waitcnt lgkmcnt(6)
ds_read_b128 a[208:211],v250 offset:1536
v_add_f32 v237,v67,v163
M v[60:63],v[216:219],a[212:215],v[60:63]
s_waitcnt vmcnt(15) lgkmcnt(6)
buffer_load_dwordx4 v[216:219],v251,s[20:23],s47 offen offset:2048
M v[32:35],v[220:223],a[216:219],v[32:35]
s_waitcnt lgkmcnt(5)
ds_read_b128 a[212:215],v250 offset:1792
ds_read_b128 a[216:219],v250 offset:2048
M v[36:39],v[220:223],a[220:223],v[36:39]
s_waitcnt lgkmcnt(6)
s_add_u32 s47,s77,49152
v_sub_f32 v163,v67,v163
v_add_f32 v67,v236,v237
M v[40:43],v[220:223],a[192:195],v[40:43]
s_waitcnt lgkmcnt(5)
v_fmac_f32 v236,4.0,v237
v_fma_f32 v237,2.0,v163,v238
M v[44:47],v[220:223],a[196:199],v[44:47]
s_waitcnt lgkmcnt(4)
v_fma_f32 v163,s41,v163,v238
v_cvt_pk_bf16_f32 v233,v233,v237
M v[48:51],v[220:223],a[200:203],v[48:51]
s_waitcnt lgkmcnt(3)
v_cvt_pk_bf16_f32 v235,v235,v236
M v[52:55],v[220:223],a[204:207],v[52:55]
s_waitcnt lgkmcnt(2)
ds_write2st64_b64 v253,v[232:233],v[234:235] offset0:17 offset1:21
M v[56:59],v[220:223],a[208:211],v[56:59]
s_waitcnt lgkmcnt(2)
v_accvgpr_read_b32 v238,a68
v_accvgpr_read_b32 v232,a164
M v[60:63],v[220:223],a[212:215],v[60:63]
s_waitcnt vmcnt(15)
buffer_load_dwordx4 v[220:223],v251,s[20:23],s47 offen offset:0
M v[32:35],v[224:227],a[220:223],v[32:35]
ds_read_b128 a[220:223],v249 offset:2304
v_add_f32 v234,v238,v232
M v[36:39],v[224:227],a[192:195],v[36:39]
v_sub_f32 v238,v238,v232
v_add_f32 v232,v68,v164
M v[40:43],v[224:227],a[196:199],v[40:43]
s_add_u32 s34,s33,7471104
buffer_store_dwordx4 a[124:127],v252,s[24:27],s34 offen offset:1152 nt
M v[44:47],v[224:227],a[200:203],v[44:47]
v_sub_f32 v164,v68,v164
v_add_f32 v68,v234,v232
M v[48:51],v[224:227],a[204:207],v[48:51]
v_fmac_f32 v234,4.0,v232
v_fma_f32 v232,2.0,v164,v238
M v[52:55],v[224:227],a[208:211],v[52:55]
v_fma_f32 v164,s41,v164,v238
v_accvgpr_read_b32 v238,a69
M v[56:59],v[224:227],a[212:215],v[56:59]
s_waitcnt lgkmcnt(2)
v_accvgpr_read_b32 v237,a165
v_add_f32 v236,v238,v237
M v[60:63],v[224:227],a[216:219],v[60:63]
s_waitcnt vmcnt(16)
buffer_load_dwordx4 v[224:227],v251,s[20:23],s47 offen offset:1024
M v[32:35],v[228:231],a[192:195],v[32:35]
ds_read_b128 a[192:195],v249 offset:17408
v_sub_f32 v238,v238,v237
M v[36:39],v[228:231],a[196:199],v[36:39]
ds_read_b128 a[196:199],v250 offset:17664
v_add_f32 v237,v69,v165
M v[40:43],v[228:231],a[200:203],v[40:43]
ds_read_b128 a[200:203],v250 offset:17920
v_sub_f32 v165,v69,v165
M v[44:47],v[228:231],a[204:207],v[44:47]
ds_read_b128 a[204:207],v250 offset:18176
v_add_f32 v69,v236,v237
M v[48:51],v[228:231],a[208:211],v[48:51]
ds_read_b128 a[208:211],v250 offset:18432
v_fmac_f32 v236,4.0,v237
M v[52:55],v[228:231],a[212:215],v[52:55]
ds_read_b128 a[212:215],v250 offset:18688
v_fma_f32 v237,2.0,v165,v238
M v[56:59],v[228:231],a[216:219],v[56:59]
s_waitcnt lgkmcnt(6)
ds_read_b128 a[216:219],v250 offset:18944
v_fma_f32 v165,s41,v165,v238
M v[60:63],v[228:231],a[220:223],v[60:63]
s_waitcnt vmcnt(16) lgkmcnt(6)
buffer_load_dwordx4 v[228:231],v251,s[20:23],s47 offen offset:2048
M v[32:35],a[224:227],a[192:195],v[32:35]
s_waitcnt lgkmcnt(5)
ds_read_b128 a[220:223],v250 offset:19200
ds_read_b128 a[192:195],v250 offset:19456
M v[36:39],a[224:227],a[196:199],v[36:39]
s_waitcnt lgkmcnt(6)
s_add_u32 s47,s78,49152
v_cvt_pk_bf16_f32 v232,v232,v237
v_cvt_pk_bf16_f32 v234,v234,v236
M v[40:43],a[224:227],a[200:203],v[40:43]
s_waitcnt lgkmcnt(5)
v_accvgpr_read_b32 v238,a70
v_accvgpr_read_b32 v233,a166
M v[44:47],a[224:227],a[204:207],v[44:47]
s_waitcnt lgkmcnt(4)
v_add_f32 v235,v238,v233
v_sub_f32 v238,v238,v233
M v[48:51],a[224:227],a[208:211],v[48:51]
s_waitcnt lgkmcnt(3)
v_add_f32 v233,v70,v166
v_sub_f32 v166,v70,v166
M v[52:55],a[224:227],a[212:215],v[52:55]
s_waitcnt lgkmcnt(2)
v_add_f32 v70,v235,v233
v_fmac_f32 v235,4.0,v233
M v[56:59],a[224:227],a[216:219],v[56:59]
s_waitcnt lgkmcnt(1)
v_fma_f32 v233,2.0,v166,v238
v_fma_f32 v166,s41,v166,v238
M v[60:63],a[224:227],a[220:223],v[60:63]
s_waitcnt vmcnt(16)
buffer_load_dwordx4 a[224:227],v251,s[20:23],s47 offen offset:0
M v[32:35],a[228:231],a[196:199],v[32:35]
ds_read_b128 a[196:199],v249 offset:19712
v_accvgpr_read_b32 v238,a71
M v[36:39],a[228:231],a[200:203],v[36:39]
v_accvgpr_read_b32 v237,a167
v_add_f32 v236,v238,v237
M v[40:43],a[228:231],a[204:207],v[40:43]
v_sub_f32 v238,v238,v237
v_add_f32 v237,v71,v167
M v[44:47],a[228:231],a[208:211],v[44:47]
v_sub_f32 v167,v71,v167
v_add_f32 v71,v236,v237
M v[48:51],a[228:231],a[212:215],v[48:51]
v_fmac_f32 v236,4.0,v237
v_fma_f32 v237,2.0,v167,v238
M v[52:55],a[228:231],a[216:219],v[52:55]
v_add_u32 v249,0xffff1200,v249
v_add_u32 v250,0xffff1200,v250
M v[56:59],a[228:231],a[220:223],v[56:59]
s_waitcnt lgkmcnt(1)
v_fma_f32 v167,s41,v167,v238
v_cvt_pk_bf16_f32 v233,v233,v237
M v[60:63],a[228:231],a[192:195],v[60:63]
s_waitcnt vmcnt(16)
buffer_load_dwordx4 a[228:231],v251,s[20:23],s47 offen offset:1024
M v[32:35],a[232:235],a[200:203],v[32:35]
ds_read_b128 a[200:203],v249 offset:8704
v_cvt_pk_bf16_f32 v235,v235,v236
M v[36:39],a[232:235],a[204:207],v[36:39]
ds_read_b128 a[204:207],v250 offset:8960
ds_write2st64_b64 v253,v[232:233],v[234:235] offset0:25 offset1:29
M v[40:43],a[232:235],a[208:211],v[40:43]
ds_read_b128 a[208:211],v250 offset:9216
v_accvgpr_read_b32 v238,a72
M v[44:47],a[232:235],a[212:215],v[44:47]
ds_read_b128 a[212:215],v250 offset:9472
v_accvgpr_read_b32 v232,a168
M v[48:51],a[232:235],a[216:219],v[48:51]
ds_read_b128 a[216:219],v250 offset:9728
v_add_f32 v234,v238,v232
M v[52:55],a[232:235],a[220:223],v[52:55]
ds_read_b128 a[220:223],v250 offset:9984
v_sub_f32 v238,v238,v232
M v[56:59],a[232:235],a[192:195],v[56:59]
s_waitcnt lgkmcnt(7)
ds_read_b128 a[192:195],v250 offset:10240
v_add_f32 v232,v72,v168
M v[60:63],a[232:235],a[196:199],v[60:63]
s_waitcnt vmcnt(16) lgkmcnt(7)
buffer_load_dwordx4 a[232:235],v251,s[20:23],s47 offen offset:2048
M v[32:35],a[236:239],a[200:203],v[32:35]
s_waitcnt lgkmcnt(6)
ds_read_b128 a[196:199],v250 offset:10496
ds_read_b128 a[200:203],v250 offset:10752
M v[36:39],a[236:239],a[204:207],v[36:39]
s_waitcnt lgkmcnt(6)
s_add_u32 s47,s79,49152
v_sub_f32 v168,v72,v168
v_add_f32 v72,v234,v232
M v[40:43],a[236:239],a[208:211],v[40:43]
s_waitcnt lgkmcnt(5)
v_fmac_f32 v234,4.0,v232
v_fma_f32 v232,2.0,v168,v238
M v[44:47],a[236:239],a[212:215],v[44:47]
s_waitcnt lgkmcnt(4)
v_fma_f32 v168,s41,v168,v238
v_accvgpr_read_b32 v238,a73
M v[48:51],a[236:239],a[216:219],v[48:51]
s_waitcnt lgkmcnt(3)
v_accvgpr_read_b32 v237,a169
v_add_f32 v236,v238,v237
M v[52:55],a[236:239],a[220:223],v[52:55]
s_waitcnt lgkmcnt(2)
v_sub_f32 v238,v238,v237
v_add_f32 v237,v73,v169
M v[56:59],a[236:239],a[192:195],v[56:59]
s_waitcnt lgkmcnt(1)
v_sub_f32 v169,v73,v169
v_add_f32 v73,v236,v237
M v[60:63],a[236:239],a[196:199],v[60:63]
s_waitcnt vmcnt(16)
buffer_load_dwordx4 a[236:239],v251,s[20:23],s47 offen offset:0
M v[32:35],a[240:243],a[204:207],v[32:35]
ds_read_b128 a[204:207],v249 offset:11008
v_fmac_f32 v236,4.0,v237
M v[36:39],a[240:243],a[208:211],v[36:39]
v_fma_f32 v237,2.0,v169,v238
v_fma_f32 v169,s41,v169,v238
M v[40:43],a[240:243],a[212:215],v[40:43]
v_cvt_pk_bf16_f32 v232,v232,v237
v_cvt_pk_bf16_f32 v234,v234,v236
M v[44:47],a[240:243],a[216:219],v[44:47]
v_accvgpr_read_b32 v238,a74
v_accvgpr_read_b32 v233,a170
M v[48:51],a[240:243],a[220:223],v[48:51]
v_add_f32 v235,v238,v233
v_sub_f32 v238,v238,v233
M v[52:55],a[240:243],a[192:195],v[52:55]
v_add_f32 v233,v74,v170
v_sub_f32 v170,v74,v170
M v[56:59],a[240:243],a[196:199],v[56:59]
s_waitcnt lgkmcnt(1)
v_add_f32 v74,v235,v233
v_fmac_f32 v235,4.0,v233
M v[60:63],a[240:243],a[200:203],v[60:63]
s_waitcnt vmcnt(12)
buffer_load_dwordx4 a[240:243],v251,s[20:23],s47 offen offset:1024
M v[32:35],a[244:247],a[208:211],v[32:35]
ds_read_b128 a[208:211],v249 offset:0
v_fma_f32 v233,2.0,v170,v238
M v[36:39],a[244:247],a[212:215],v[36:39]
ds_read_b128 a[212:215],v250 offset:256
v_fma_f32 v170,s41,v170,v238
M v[40:43],a[244:247],a[216:219],v[40:43]
ds_read_b128 a[216:219],v250 offset:512
v_accvgpr_read_b32 v238,a75
M v[44:47],a[244:247],a[220:223],v[44:47]
ds_read_b128 a[220:223],v250 offset:768
v_accvgpr_read_b32 v237,a171
M v[48:51],a[244:247],a[192:195],v[48:51]
ds_read_b128 a[192:195],v250 offset:1024
v_add_f32 v236,v238,v237
M v[52:55],a[244:247],a[196:199],v[52:55]
ds_read_b128 a[196:199],v250 offset:1280
v_sub_f32 v238,v238,v237
M v[56:59],a[244:247],a[200:203],v[56:59]
s_waitcnt lgkmcnt(6)
ds_read_b128 a[200:203],v250 offset:1536
v_add_f32 v237,v75,v171
M v[60:63],a[244:247],a[204:207],v[60:63]
s_waitcnt vmcnt(12) lgkmcnt(6)
buffer_load_dwordx4 a[244:247],v251,s[20:23],s47 offen offset:2048
M v[128:131],a[248:251],a[208:211],v[128:131]
s_waitcnt lgkmcnt(5)
ds_read_b128 a[204:207],v250 offset:1792
ds_read_b128 a[208:211],v250 offset:2048
M v[132:135],a[248:251],a[212:215],v[132:135]
s_waitcnt lgkmcnt(6)
s_add_u32 s47,s80,49152
v_sub_f32 v171,v75,v171
v_add_f32 v75,v236,v237
M v[136:139],a[248:251],a[216:219],v[136:139]
s_waitcnt lgkmcnt(5)
v_fmac_f32 v236,4.0,v237
v_fma_f32 v237,2.0,v171,v238
M v[140:143],a[248:251],a[220:223],v[140:143]
s_waitcnt lgkmcnt(4)
v_fma_f32 v171,s41,v171,v238
v_cvt_pk_bf16_f32 v233,v233,v237
M v[144:147],a[248:251],a[192:195],v[144:147]
s_waitcnt lgkmcnt(3)
v_cvt_pk_bf16_f32 v235,v235,v236
M v[148:151],a[248:251],a[196:199],v[148:151]
s_waitcnt lgkmcnt(2)
ds_write2st64_b64 v253,v[232:233],v[234:235] offset0:68 offset1:72
M v[152:155],a[248:251],a[200:203],v[152:155]
s_waitcnt lgkmcnt(2)
v_accvgpr_read_b32 v238,a76
v_accvgpr_read_b32 v232,a172
M v[156:159],a[248:251],a[204:207],v[156:159]
s_waitcnt vmcnt(11)
buffer_load_dwordx4 a[248:251],v251,s[20:23],s47 offen offset:0
M v[128:131],a[252:255],a[212:215],v[128:131]
ds_read_b128 a[212:215],v249 offset:2304
v_add_f32 v234,v238,v232
M v[132:135],a[252:255],a[216:219],v[132:135]
v_sub_f32 v238,v238,v232
v_add_f32 v232,v76,v172
M v[136:139],a[252:255],a[220:223],v[136:139]
v_sub_f32 v172,v76,v172
v_add_f32 v76,v234,v232
M v[140:143],a[252:255],a[192:195],v[140:143]
v_fmac_f32 v234,4.0,v232
v_fma_f32 v232,2.0,v172,v238
M v[144:147],a[252:255],a[196:199],v[144:147]
v_fma_f32 v172,s41,v172,v238
v_accvgpr_read_b32 v238,a77
M v[148:151],a[252:255],a[200:203],v[148:151]
v_accvgpr_read_b32 v237,a173
v_add_f32 v236,v238,v237
M v[152:155],a[252:255],a[204:207],v[152:155]
s_waitcnt lgkmcnt(2)
v_sub_f32 v238,v238,v237
v_add_f32 v237,v77,v173
M v[156:159],a[252:255],a[208:211],v[156:159]
s_waitcnt vmcnt(11)
buffer_load_dwordx4 a[252:255],v251,s[20:23],s47 offen offset:1024
M v[128:131],v[216:219],a[216:219],v[128:131]
ds_read_b128 a[216:219],v249 offset:34816
v_sub_f32 v173,v77,v173
M v[132:135],v[216:219],a[220:223],v[132:135]
ds_read_b128 a[220:223],v250 offset:35072
v_add_f32 v77,v236,v237
M v[136:139],v[216:219],a[192:195],v[136:139]
ds_read_b128 a[192:195],v250 offset:35328
v_fmac_f32 v236,4.0,v237
M v[140:143],v[216:219],a[196:199],v[140:143]
ds_read_b128 a[196:199],v250 offset:35584
v_fma_f32 v237,2.0,v173,v238
M v[144:147],v[216:219],a[200:203],v[144:147]
ds_read_b128 a[200:203],v250 offset:35840
v_fma_f32 v173,s41,v173,v238
M v[148:151],v[216:219],a[204:207],v[148:151]
ds_read_b128 a[204:207],v250 offset:36096
v_cvt_pk_bf16_f32 v232,v232,v237
M v[152:155],v[216:219],a[208:211],v[152:155]
s_waitcnt lgkmcnt(6)
ds_read_b128 a[208:211],v250 offset:36352
v_cvt_pk_bf16_f32 v234,v234,v236
M v[156:159],v[216:219],a[212:215],v[156:159]
s_waitcnt vmcnt(11) lgkmcnt(6)
buffer_load_dwordx4 v[216:219],v251,s[20:23],s47 offen offset:2048
M v[128:131],v[220:223],a[216:219],v[128:131]
s_waitcnt lgkmcnt(5)
ds_read_b128 a[212:215],v250 offset:36608
ds_read_b128 a[216:219],v250 offset:36864
M v[132:135],v[220:223],a[220:223],v[132:135]
s_waitcnt lgkmcnt(6)
s_add_u32 s47,s81,49152
v_accvgpr_read_b32 v238,a78
v_accvgpr_read_b32 v233,a174
M v[136:139],v[220:223],a[192:195],v[136:139]
s_waitcnt lgkmcnt(5)
v_add_f32 v235,v238,v233
v_sub_f32 v238,v238,v233
M v[140:143],v[220:223],a[196:199],v[140:143]
s_waitcnt lgkmcnt(4)
v_add_f32 v233,v78,v174
v_sub_f32 v174,v78,v174
M v[144:147],v[220:223],a[200:203],v[144:147]
s_waitcnt lgkmcnt(3)
v_add_f32 v78,v235,v233
v_fmac_f32 v235,4.0,v233
M v[148:151],v[220:223],a[204:207],v[148:151]
s_waitcnt lgkmcnt(2)
v_fma_f32 v233,2.0,v174,v238
v_fma_f32 v174,s41,v174,v238
M v[152:155],v[220:223],a[208:211],v[152:155]
s_waitcnt lgkmcnt(1)
v_accvgpr_read_b32 v238,a79
v_accvgpr_read_b32 v237,a175
M v[156:159],v[220:223],a[212:215],v[156:159]
s_waitcnt vmcnt(10)
buffer_load_dwordx4 v[220:223],v251,s[20:23],s47 offen offset:0
M v[128:131],v[224:227],a[220:223],v[128:131]
ds_read_b128 a[220:223],v249 offset:37120
v_add_f32 v236,v238,v237
M v[132:135],v[224:227],a[192:195],v[132:135]
v_sub_f32 v238,v238,v237
v_add_f32 v237,v79,v175
M v[136:139],v[224:227],a[196:199],v[136:139]
v_sub_f32 v175,v79,v175
v_add_f32 v79,v236,v237
M v[140:143],v[224:227],a[200:203],v[140:143]
v_fmac_f32 v236,4.0,v237
v_fma_f32 v237,2.0,v175,v238
M v[144:147],v[224:227],a[204:207],v[144:147]
v_fma_f32 v175,s41,v175,v238
v_cvt_pk_bf16_f32 v233,v233,v237
M v[148:151],v[224:227],a[208:211],v[148:151]
v_cvt_pk_bf16_f32 v235,v235,v236
M v[152:155],v[224:227],a[212:215],v[152:155]
s_waitcnt lgkmcnt(1)
ds_write2st64_b64 v253,v[232:233],v[234:235] offset0:76 offset1:80
M v[156:159],v[224:227],a[216:219],v[156:159]
s_waitcnt vmcnt(10)
buffer_load_dwordx4 v[224:227],v251,s[20:23],s47 offen offset:1024
M v[128:131],v[228:231],a[192:195],v[128:131]
ds_read_b128 a[192:195],v249 offset:52224
v_cvt_pk_bf16_f32 v32,v32,v33
M v[132:135],v[228:231],a[196:199],v[132:135]
ds_read_b128 a[196:199],v250 offset:52480
v_cvt_pk_bf16_f32 v33,v34,v35
M v[136:139],v[228:231],a[200:203],v[136:139]
ds_read_b128 a[200:203],v250 offset:52736
v_cvt_pk_bf16_f32 v36,v36,v37
M v[140:143],v[228:231],a[204:207],v[140:143]
ds_read_b128 a[204:207],v250 offset:52992
v_cvt_pk_bf16_f32 v37,v38,v39
M v[144:147],v[228:231],a[208:211],v[144:147]
s_waitcnt lgkmcnt(4)
s_barrier
ds_read_b128 a[64:67],v251 offset:8704
M v[148:151],v[228:231],a[212:215],v[148:151]
ds_read_b128 a[68:71],v251 offset:12800
ds_read_b128 a[72:75],v251 offset:34816
M v[152:155],v[228:231],a[216:219],v[152:155]
ds_read_b128 a[76:79],v251 offset:38912
ds_read_b128 a[208:211],v250 offset:53248
M v[156:159],v[228:231],a[220:223],v[156:159]
s_waitcnt vmcnt(10) lgkmcnt(8)
buffer_load_dwordx4 v[228:231],v251,s[20:23],s47 offen offset:2048
M v[128:131],a[224:227],a[192:195],v[128:131]
s_waitcnt lgkmcnt(7)
ds_read_b128 a[212:215],v250 offset:53504
ds_read_b128 a[216:219],v250 offset:53760
M v[132:135],a[224:227],a[196:199],v[132:135]
s_waitcnt lgkmcnt(6)
s_add_u32 s34,s32,6291456
buffer_store_dwordx4 a[64:67],v252,s[24:27],s34 offen offset:640 nt
M v[136:139],a[224:227],a[200:203],v[136:139]
s_waitcnt lgkmcnt(5)
s_add_u32 s34,s32,6488064
buffer_store_dwordx4 a[68:71],v252,s[24:27],s34 offen offset:640 nt
ds_read_b128 a[220:223],v250 offset:54016
M v[140:143],a[224:227],a[204:207],v[140:143]
s_waitcnt lgkmcnt(3)
s_add_u32 s34,s32,6684672
buffer_store_dwordx4 a[72:75],v252,s[24:27],s34 offen offset:640 nt
M v[144:147],a[224:227],a[208:211],v[144:147]
s_waitcnt lgkmcnt(2)
s_add_u32 s34,s32,6881280
buffer_store_dwordx4 a[76:79],v252,s[24:27],s34 offen offset:640 nt
M v[148:151],a[224:227],a[212:215],v[148:151]
s_waitcnt lgkmcnt(1)
s_add_u32 s48,s76,6144
ds_read_b128 a[192:195],v250 offset:54272
ds_write2st64_b64 v253,v[32:33],v[36:37] offset0:34 offset1:38
M v[152:155],a[224:227],a[216:219],v[152:155]
s_waitcnt lgkmcnt(2)
v_cvt_pk_bf16_f32 v40,v40,v41
v_cvt_pk_bf16_f32 v41,v42,v43
M v[156:159],a[224:227],a[220:223],v[156:159]
s_waitcnt vmcnt(14)
buffer_load_dwordx4 a[224:227],v251,s[20:23],s48 offen offset:0
M v[128:131],a[228:231],a[196:199],v[128:131]
ds_read_b128 a[196:199],v249 offset:54528
v_cvt_pk_bf16_f32 v44,v44,v45
M v[132:135],a[228:231],a[200:203],v[132:135]
v_cvt_pk_bf16_f32 v45,v46,v47
M v[136:139],a[228:231],a[204:207],v[136:139]
ds_write2st64_b64 v253,v[40:41],v[44:45] offset0:42 offset1:46
M v[140:143],a[228:231],a[208:211],v[140:143]
v_cvt_pk_bf16_f32 v48,v48,v49
v_cvt_pk_bf16_f32 v49,v50,v51
M v[144:147],a[228:231],a[212:215],v[144:147]
v_cvt_pk_bf16_f32 v52,v52,v53
v_cvt_pk_bf16_f32 v53,v54,v55
M v[148:151],a[228:231],a[216:219],v[148:151]
ds_write2st64_b64 v253,v[48:49],v[52:53] offset0:51 offset1:55
M v[152:155],a[228:231],a[220:223],v[152:155]
s_waitcnt lgkmcnt(4)
v_add_u32 v249,0x11000,v249
v_add_u32 v250,0x11000,v250
M v[156:159],a[228:231],a[192:195],v[156:159]
s_waitcnt vmcnt(14)
buffer_load_dwordx4 a[228:231],v251,s[20:23],s48 offen offset:1024
M v[128:131],a[232:235],a[200:203],v[128:131]
ds_read_b128 a[200:203],v249 offset:0
v_cvt_pk_bf16_f32 v56,v56,v57
M v[132:135],a[232:235],a[204:207],v[132:135]
ds_read_b128 a[204:207],v250 offset:256
v_cvt_pk_bf16_f32 v57,v58,v59
M v[136:139],a[232:235],a[208:211],v[136:139]
ds_read_b128 a[208:211],v250 offset:512
v_cvt_pk_bf16_f32 v60,v60,v61
M v[140:143],a[232:235],a[212:215],v[140:143]
ds_read_b128 a[212:215],v250 offset:768
v_cvt_pk_bf16_f32 v61,v62,v63
M v[144:147],a[232:235],a[216:219],v[144:147]
ds_read_b128 a[216:219],v250 offset:1024
ds_write2st64_b64 v253,v[56:57],v[60:61] offset0:59 offset1:63
M v[148:151],a[232:235],a[220:223],v[148:151]
ds_read_b128 a[220:223],v250 offset:1280
v_accvgpr_read_b32 v238,a80
M v[152:155],a[232:235],a[192:195],v[152:155]
s_waitcnt lgkmcnt(9)
ds_read_b128 a[192:195],v250 offset:1536
v_accvgpr_read_b32 v232,a176
M v[156:159],a[232:235],a[196:199],v[156:159]
s_waitcnt vmcnt(14) lgkmcnt(7)
buffer_load_dwordx4 a[232:235],v251,s[20:23],s48 offen offset:2048
M v[128:131],a[236:239],a[200:203],v[128:131]
s_waitcnt lgkmcnt(6)
ds_read_b128 a[196:199],v250 offset:1792
ds_read_b128 a[200:203],v250 offset:2048
M v[132:135],a[236:239],a[204:207],v[132:135]
s_waitcnt lgkmcnt(7)
s_add_u32 s48,s77,6144
v_add_f32 v234,v238,v232
v_sub_f32 v238,v238,v232
M v[136:139],a[236:239],a[208:211],v[136:139]
s_waitcnt lgkmcnt(6)
v_add_f32 v232,v80,v176
v_sub_f32 v176,v80,v176
M v[140:143],a[236:239],a[212:215],v[140:143]
s_waitcnt lgkmcnt(5)
v_add_f32 v80,v234,v232
v_fmac_f32 v234,4.0,v232
M v[144:147],a[236:239],a[216:219],v[144:147]
s_waitcnt lgkmcnt(3)
v_fma_f32 v232,2.0,v176,v238
v_fma_f32 v176,s41,v176,v238
M v[148:151],a[236:239],a[220:223],v[148:151]
s_waitcnt lgkmcnt(2)
v_accvgpr_read_b32 v238,a81
v_accvgpr_read_b32 v237,a177
M v[152:155],a[236:239],a[192:195],v[152:155]
s_waitcnt lgkmcnt(1)
v_add_f32 v236,v238,v237
v_sub_f32 v238,v238,v237
M v[156:159],a[236:239],a[196:199],v[156:159]
s_waitcnt vmcnt(14)
buffer_load_dwordx4 a[236:239],v251,s[20:23],s48 offen offset:0
M v[128:131],a[240:243],a[204:207],v[128:131]
ds_read_b128 a[204:207],v249 offset:2304
v_add_f32 v237,v81,v177
M v[132:135],a[240:243],a[208:211],v[132:135]
v_sub_f32 v177,v81,v177
v_add_f32 v81,v236,v237
M v[136:139],a[240:243],a[212:215],v[136:139]
v_fmac_f32 v236,4.0,v237
v_fma_f32 v237,2.0,v177,v238
M v[140:143],a[240:243],a[216:219],v[140:143]
v_fma_f32 v177,s41,v177,v238
v_cvt_pk_bf16_f32 v232,v232,v237
M v[144:147],a[240:243],a[220:223],v[144:147]
v_cvt_pk_bf16_f32 v234,v234,v236
v_accvgpr_read_b32 v238,a82
M v[148:151],a[240:243],a[192:195],v[148:151]
v_accvgpr_read_b32 v233,a178
v_add_f32 v235,v238,v233
M v[152:155],a[240:243],a[196:199],v[152:155]
s_waitcnt lgkmcnt(1)
v_sub_f32 v238,v238,v233
v_add_f32 v233,v82,v178
M v[156:159],a[240:243],a[200:203],v[156:159]
s_waitcnt vmcnt(14)
buffer_load_dwordx4 a[240:243],v251,s[20:23],s48 offen offset:1024
M v[128:131],a[244:247],a[208:211],v[128:131]
ds_read_b128 a[208:211],v249 offset:17408
v_sub_f32 v178,v82,v178
M v[132:135],a[244:247],a[212:215],v[132:135]
ds_read_b128 a[212:215],v250 offset:17664
v_add_f32 v82,v235,v233
M v[136:139],a[244:247],a[216:219],v[136:139]
ds_read_b128 a[216:219],v250 offset:17920
v_fmac_f32 v235,4.0,v233
M v[140:143],a[244:247],a[220:223],v[140:143]
ds_read_b128 a[220:223],v250 offset:18176
v_fma_f32 v233,2.0,v178,v238
M v[144:147],a[244:247],a[192:195],v[144:147]
ds_read_b128 a[192:195],v250 offset:18432
v_fma_f32 v178,s41,v178,v238
M v[148:151],a[244:247],a[196:199],v[148:151]
ds_read_b128 a[196:199],v250 offset:18688
v_accvgpr_read_b32 v238,a83
M v[152:155],a[244:247],a[200:203],v[152:155]
s_waitcnt lgkmcnt(6)
ds_read_b128 a[200:203],v250 offset:18944
v_accvgpr_read_b32 v237,a179
M v[156:159],a[244:247],a[204:207],v[156:159]
s_waitcnt vmcnt(14) lgkmcnt(6)
buffer_load_dwordx4 a[244:247],v251,s[20:23],s48 offen offset:2048
M v[128:131],a[248:251],a[208:211],v[128:131]
s_waitcnt lgkmcnt(5)
ds_read_b128 a[204:207],v250 offset:19200
ds_read_b128 a[208:211],v250 offset:19456
M v[132:135],a[248:251],a[212:215],v[132:135]
s_waitcnt lgkmcnt(6)
s_add_u32 s48,s78,6144
v_add_f32 v236,v238,v237
v_sub_f32 v238,v238,v237
M v[136:139],a[248:251],a[216:219],v[136:139]
s_waitcnt lgkmcnt(5)
v_add_f32 v237,v83,v179
v_sub_f32 v179,v83,v179
M v[140:143],a[248:251],a[220:223],v[140:143]
s_waitcnt lgkmcnt(4)
v_add_f32 v83,v236,v237
v_fmac_f32 v236,4.0,v237
M v[144:147],a[248:251],a[192:195],v[144:147]
s_waitcnt lgkmcnt(3)
v_fma_f32 v237,2.0,v179,v238
v_fma_f32 v179,s41,v179,v238
M v[148:151],a[248:251],a[196:199],v[148:151]
s_waitcnt lgkmcnt(2)
v_cvt_pk_bf16_f32 v233,v233,v237
v_cvt_pk_bf16_f32 v235,v235,v236
M v[152:155],a[248:251],a[200:203],v[152:155]
s_waitcnt lgkmcnt(1)
ds_write2st64_b64 v253,v[232:233],v[234:235] offset0:0 offset1:4
M v[156:159],a[248:251],a[204:207],v[156:159]
s_waitcnt vmcnt(14)
buffer_load_dwordx4 a[248:251],v251,s[20:23],s48 offen offset:0
M v[128:131],a[252:255],a[212:215],v[128:131]
ds_read_b128 a[212:215],v249 offset:19712
v_accvgpr_read_b32 v238,a84
M v[132:135],a[252:255],a[216:219],v[132:135]
v_accvgpr_read_b32 v232,a180
v_add_f32 v234,v238,v232
M v[136:139],a[252:255],a[220:223],v[136:139]
v_sub_f32 v238,v238,v232
v_add_f32 v232,v84,v180
M v[140:143],a[252:255],a[192:195],v[140:143]
v_sub_f32 v180,v84,v180
v_add_f32 v84,v234,v232
M v[144:147],a[252:255],a[196:199],v[144:147]
v_fmac_f32 v234,4.0,v232
v_fma_f32 v232,2.0,v180,v238
M v[148:151],a[252:255],a[200:203],v[148:151]
v_add_u32 v249,0xfffece00,v249
v_add_u32 v250,0xfffece00,v250
M v[152:155],a[252:255],a[204:207],v[152:155]
s_waitcnt lgkmcnt(2)
v_fma_f32 v180,s41,v180,v238
v_accvgpr_read_b32 v238,a85
M v[156:159],a[252:255],a[208:211],v[156:159]
s_waitcnt vmcnt(14)
buffer_load_dwordx4 a[252:255],v251,s[20:23],s48 offen offset:1024
M v[128:131],v[216:219],a[216:219],v[128:131]
ds_read_b128 a[216:219],v249 offset:26112
v_accvgpr_read_b32 v237,a181
M v[132:135],v[216:219],a[220:223],v[132:135]
ds_read_b128 a[220:223],v250 offset:26368
v_add_f32 v236,v238,v237
M v[136:139],v[216:219],a[192:195],v[136:139]
ds_read_b128 a[192:195],v250 offset:26624
v_sub_f32 v238,v238,v237
M v[140:143],v[216:219],a[196:199],v[140:143]
ds_read_b128 a[196:199],v250 offset:26880
v_add_f32 v237,v85,v181
M v[144:147],v[216:219],a[200:203],v[144:147]
ds_read_b128 a[200:203],v250 offset:27136
v_sub_f32 v181,v85,v181
M v[148:151],v[216:219],a[204:207],v[148:151]
ds_read_b128 a[204:207],v250 offset:27392
v_add_f32 v85,v236,v237
M v[152:155],v[216:219],a[208:211],v[152:155]
s_waitcnt lgkmcnt(6)
ds_read_b128 a[208:211],v250 offset:27648
v_fmac_f32 v236,4.0,v237
v_fma_f32 v237,2.0,v181,v238
v_fma_f32 v181,s41,v181,v238
v_cvt_pk_bf16_f32 v232,v232,v237
M v[156:159],v[216:219],a[212:215],v[156:159]
s_waitcnt vmcnt(14) lgkmcnt(6)
buffer_load_dwordx4 v[216:219],v251,s[20:23],s48 offen offset:2048
v_cvt_pk_bf16_f32 v234,v234,v236
v_accvgpr_read_b32 v238,a86
v_accvgpr_read_b32 v233,a182
v_add_f32 v235,v238,v233
M v[128:131],v[220:223],a[216:219],v[128:131]
s_waitcnt lgkmcnt(5)
ds_read_b128 a[212:215],v250 offset:27904
ds_read_b128 a[216:219],v250 offset:28160
v_sub_f32 v238,v238,v233
v_add_f32 v233,v86,v182
v_sub_f32 v182,v86,v182
v_add_f32 v86,v235,v233
M v[132:135],v[220:223],a[220:223],v[132:135]
s_waitcnt lgkmcnt(6)
s_add_u32 s48,s79,6144
v_fmac_f32 v235,4.0,v233
v_fma_f32 v233,2.0,v182,v238
v_fma_f32 v182,s41,v182,v238
v_accvgpr_read_b32 v238,a87
M v[136:139],v[220:223],a[192:195],v[136:139]
s_waitcnt lgkmcnt(5)
v_accvgpr_read_b32 v237,a183
v_add_f32 v236,v238,v237
v_sub_f32 v238,v238,v237
v_add_f32 v237,v87,v183
M v[140:143],v[220:223],a[196:199],v[140:143]
s_waitcnt lgkmcnt(4)
v_sub_f32 v183,v87,v183
v_add_f32 v87,v236,v237
v_fmac_f32 v236,4.0,v237
v_fma_f32 v237,2.0,v183,v238
M v[144:147],v[220:223],a[200:203],v[144:147]
s_waitcnt lgkmcnt(3)
v_fma_f32 v183,s41,v183,v238
v_cvt_pk_bf16_f32 v233,v233,v237
v_cvt_pk_bf16_f32 v235,v235,v236
M v[148:151],v[220:223],a[204:207],v[148:151]
s_waitcnt lgkmcnt(2)
ds_write2st64_b64 v253,v[232:233],v[234:235] offset0:8 offset1:12
M v[152:155],v[220:223],a[208:211],v[152:155]
s_waitcnt lgkmcnt(2)
v_accvgpr_read_b32 v238,a88
v_accvgpr_read_b32 v232,a184
M v[156:159],v[220:223],a[212:215],v[156:159]
s_waitcnt vmcnt(14)
buffer_load_dwordx4 v[220:223],v251,s[20:23],s48 offen offset:0
v_add_f32 v234,v238,v232
v_sub_f32 v238,v238,v232
v_add_f32 v232,v88,v184
v_sub_f32 v184,v88,v184
M v[128:131],v[224:227],a[220:223],v[128:131]
s_waitcnt lgkmcnt(0)
s_barrier
ds_read_b128 v[32:35],v251 offset:17408
v_add_f32 v88,v234,v232
v_fmac_f32 v234,4.0,v232
v_fma_f32 v232,2.0,v184,v238
M v[132:135],v[224:227],a[192:195],v[132:135]
ds_read_b128 v[40:43],v251 offset:21504
ds_read_b128 v[48:51],v251 offset:26112
v_fma_f32 v184,s41,v184,v238
v_accvgpr_read_b32 v238,a89
v_accvgpr_read_b32 v237,a185
v_add_f32 v236,v238,v237
M v[136:139],v[224:227],a[196:199],v[136:139]
ds_read_b128 v[56:59],v251 offset:30208
ds_read_b128 a[80:83],v251 offset:0
v_sub_f32 v238,v238,v237
v_add_f32 v237,v89,v185
v_sub_f32 v185,v89,v185
v_add_f32 v89,v236,v237
M v[140:143],v[224:227],a[200:203],v[140:143]
ds_read_b128 a[84:87],v251 offset:4096
ds_read_b128 a[220:223],v249 offset:28416
v_fmac_f32 v236,4.0,v237
v_fma_f32 v237,2.0,v185,v238
v_fma_f32 v185,s41,v185,v238
v_cvt_pk_bf16_f32 v232,v232,v237
M v[144:147],v[224:227],a[204:207],v[144:147]
v_cvt_pk_bf16_f32 v234,v234,v236
v_accvgpr_read_b32 v238,a90
v_accvgpr_read_b32 v233,a186
v_add_f32 v235,v238,v233
M v[148:151],v[224:227],a[208:211],v[148:151]
s_waitcnt lgkmcnt(6)
s_add_u32 s34,s33,6291456
buffer_store_dwordx4 v[32:35],v252,s[24:27],s34 offen offset:128 nt
v_sub_f32 v238,v238,v233
v_add_f32 v233,v90,v186
v_sub_f32 v186,v90,v186
v_add_f32 v90,v235,v233
M v[152:155],v[224:227],a[212:215],v[152:155]
s_waitcnt lgkmcnt(5)
s_add_u32 s34,s33,6684672
buffer_store_dwordx4 v[40:43],v252,s[24:27],s34 offen offset:128 nt
v_fmac_f32 v235,4.0,v233
v_fma_f32 v233,2.0,v186,v238
v_fma_f32 v186,s41,v186,v238
v_accvgpr_read_b32 v238,a91
M v[156:159],v[224:227],a[216:219],v[156:159]
s_waitcnt vmcnt(16)
s_add_u32 s34,s33,7077888
buffer_load_dwordx4 v[224:227],v251,s[20:23],s48 offen offset:1024
v_accvgpr_read_b32 v237,a187
v_add_f32 v236,v238,v237
v_sub_f32 v238,v238,v237
v_add_f32 v237,v91,v187
M v[128:131],v[228:231],a[192:195],v[128:131]
s_waitcnt lgkmcnt(4)
buffer_store_dwordx4 v[48:51],v252,s[24:27],s34 offen offset:128 nt
v_sub_f32 v187,v91,v187
v_add_f32 v91,v236,v237
v_fmac_f32 v236,4.0,v237
v_fma_f32 v237,2.0,v187,v238
M v[132:135],v[228:231],a[196:199],v[132:135]
s_waitcnt lgkmcnt(3)
s_add_u32 s34,s33,7471104
buffer_store_dwordx4 v[56:59],v252,s[24:27],s34 offen offset:128 nt
v_fma_f32 v187,s41,v187,v238
v_cvt_pk_bf16_f32 v233,v233,v237
v_cvt_pk_bf16_f32 v235,v235,v236
M v[136:139],v[228:231],a[200:203],v[136:139]
s_waitcnt lgkmcnt(2)
s_add_u32 s34,s32,7077888
buffer_store_dwordx4 a[80:83],v252,s[24:27],s34 offen offset:640 nt
ds_write2st64_b64 v253,v[232:233],v[234:235] offset0:17 offset1:21
M v[140:143],v[228:231],a[204:207],v[140:143]
ds_read_b128 a[192:195],v249 offset:0
ds_read_b128 a[196:199],v250 offset:256
v_accvgpr_read_b32 v238,a92
v_accvgpr_read_b32 v232,a188
M v[144:147],v[228:231],a[208:211],v[144:147]
ds_read_b128 a[200:203],v250 offset:512
ds_read_b128 a[204:207],v250 offset:768
v_add_f32 v234,v238,v232
v_sub_f32 v238,v238,v232
v_add_f32 v232,v92,v188
v_sub_f32 v188,v92,v188
M v[148:151],v[228:231],a[212:215],v[148:151]
ds_read_b128 a[208:211],v250 offset:1024
ds_read_b128 a[212:215],v250 offset:1280
v_add_f32 v92,v234,v232
v_fmac_f32 v234,4.0,v232
v_fma_f32 v232,2.0,v188,v238
v_fma_f32 v188,s41,v188,v238
M v[152:155],v[228:231],a[216:219],v[152:155]
s_waitcnt lgkmcnt(7)
ds_read_b128 a[216:219],v250 offset:1536
v_accvgpr_read_b32 v238,a93
v_accvgpr_read_b32 v237,a189
v_add_f32 v236,v238,v237
v_sub_f32 v238,v238,v237
M v[156:159],v[228:231],a[220:223],v[156:159]
s_waitcnt vmcnt(15) lgkmcnt(6)
buffer_load_dwordx4 v[228:231],v251,s[20:23],s48 offen offset:2048
v_add_f32 v237,v93,v189
v_sub_f32 v189,v93,v189
v_add_f32 v93,v236,v237
v_fmac_f32 v236,4.0,v237
M v[64:67],a[224:227],a[192:195],v[64:67]
s_waitcnt lgkmcnt(5)
ds_read_b128 a[220:223],v250 offset:1792
ds_read_b128 a[192:195],v250 offset:2048
v_fma_f32 v237,2.0,v189,v238
v_fma_f32 v189,s41,v189,v238
v_cvt_pk_bf16_f32 v232,v232,v237
v_cvt_pk_bf16_f32 v234,v234,v236
M v[68:71],a[224:227],a[196:199],v[68:71]
s_waitcnt lgkmcnt(6)
s_add_u32 s48,s80,6144
v_accvgpr_read_b32 v238,a94
v_accvgpr_read_b32 v233,a190
v_add_f32 v235,v238,v233
v_sub_f32 v238,v238,v233
M v[72:75],a[224:227],a[200:203],v[72:75]
s_waitcnt lgkmcnt(5)
v_add_f32 v233,v94,v190
v_sub_f32 v190,v94,v190
v_add_f32 v94,v235,v233
v_fmac_f32 v235,4.0,v233
M v[76:79],a[224:227],a[204:207],v[76:79]
s_waitcnt lgkmcnt(4)
v_fma_f32 v233,2.0,v190,v238
v_fma_f32 v190,s41,v190,v238
v_accvgpr_read_b32 v238,a95
v_accvgpr_read_b32 v237,a191
M v[80:83],a[224:227],a[208:211],v[80:83]
s_waitcnt lgkmcnt(3)
v_add_f32 v236,v238,v237
v_sub_f32 v238,v238,v237
v_add_f32 v237,v95,v191
v_sub_f32 v191,v95,v191
M v[84:87],a[224:227],a[212:215],v[84:87]
s_waitcnt lgkmcnt(2)
v_add_f32 v95,v236,v237
v_fmac_f32 v236,4.0,v237
M v[88:91],a[224:227],a[216:219],v[88:91]
s_waitcnt lgkmcnt(1)
v_fma_f32 v237,2.0,v191,v238
v_fma_f32 v191,s41,v191,v238
M v[92:95],a[224:227],a[220:223],v[92:95]
s_waitcnt vmcnt(15)
buffer_load_dwordx4 a[224:227],v251,s[20:23],s48 offen offset:0
M v[64:67],a[228:231],a[196:199],v[64:67]
ds_read_b128 a[196:199],v249 offset:2304
v_cvt_pk_bf16_f32 v233,v233,v237
M v[68:71],a[228:231],a[200:203],v[68:71]
v_cvt_pk_bf16_f32 v235,v235,v236
M v[72:75],a[228:231],a[204:207],v[72:75]
ds_write2st64_b64 v253,v[232:233],v[234:235] offset0:25 offset1:29
M v[76:79],a[228:231],a[208:211],v[76:79]
v_cvt_pk_bf16_f32 v128,v128,v129
v_cvt_pk_bf16_f32 v129,v130,v131
M v[80:83],a[228:231],a[212:215],v[80:83]
v_cvt_pk_bf16_f32 v132,v132,v133
v_cvt_pk_bf16_f32 v133,v134,v135
M v[84:87],a[228:231],a[216:219],v[84:87]
ds_write2st64_b64 v253,v[128:129],v[132:133] offset0:68 offset1:72
M v[88:91],a[228:231],a[220:223],v[88:91]
s_waitcnt lgkmcnt(3)
s_add_u32 s34,s32,7274496
buffer_store_dwordx4 a[84:87],v252,s[24:27],s34 offen offset:640 nt
M v[92:95],a[228:231],a[192:195],v[92:95]
s_waitcnt vmcnt(16)
buffer_load_dwordx4 a[228:231],v251,s[20:23],s48 offen offset:1024
M v[64:67],a[232:235],a[200:203],v[64:67]
ds_read_b128 a[200:203],v249 offset:34816
v_cvt_pk_bf16_f32 v136,v136,v137
M v[68:71],a[232:235],a[204:207],v[68:71]
ds_read_b128 a[204:207],v250 offset:35072
v_cvt_pk_bf16_f32 v137,v138,v139
M v[72:75],a[232:235],a[208:211],v[72:75]
ds_read_b128 a[208:211],v250 offset:35328
v_cvt_pk_bf16_f32 v140,v140,v141
M v[76:79],a[232:235],a[212:215],v[76:79]
ds_read_b128 a[212:215],v250 offset:35584
v_cvt_pk_bf16_f32 v141,v142,v143
M v[80:83],a[232:235],a[216:219],v[80:83]
ds_read_b128 a[216:219],v250 offset:35840
ds_write2st64_b64 v253,v[136:137],v[140:141] offset0:76 offset1:80
M v[84:87],a[232:235],a[220:223],v[84:87]
ds_read_b128 a[220:223],v250 offset:36096
v_cvt_pk_bf16_f32 v144,v144,v145
M v[88:91],a[232:235],a[192:195],v[88:91]
s_waitcnt lgkmcnt(9)
ds_read_b128 a[192:195],v250 offset:36352
v_cvt_pk_bf16_f32 v145,v146,v147
M v[92:95],a[232:235],a[196:199],v[92:95]
s_waitcnt vmcnt(16) lgkmcnt(7)
buffer_load_dwordx4 a[232:235],v251,s[20:23],s48 offen offset:2048
M v[64:67],a[236:239],a[200:203],v[64:67]
s_waitcnt lgkmcnt(6)
ds_read_b128 a[196:199],v250 offset:36608
ds_read_b128 a[200:203],v250 offset:36864
M v[68:71],a[236:239],a[204:207],v[68:71]
s_waitcnt lgkmcnt(7)
s_add_u32 s48,s81,6144
v_cvt_pk_bf16_f32 v148,v148,v149
v_cvt_pk_bf16_f32 v149,v150,v151
M v[72:75],a[236:239],a[208:211],v[72:75]
s_waitcnt lgkmcnt(6)
ds_write2st64_b64 v253,v[144:145],v[148:149] offset0:85 offset1:89
M v[76:79],a[236:239],a[212:215],v[76:79]
s_waitcnt lgkmcnt(6)
v_cvt_pk_bf16_f32 v152,v152,v153
v_cvt_pk_bf16_f32 v153,v154,v155
M v[80:83],a[236:239],a[216:219],v[80:83]
s_waitcnt lgkmcnt(4)
v_cvt_pk_bf16_f32 v156,v156,v157
v_cvt_pk_bf16_f32 v157,v158,v159
M v[84:87],a[236:239],a[220:223],v[84:87]
s_waitcnt lgkmcnt(3)
ds_write2st64_b64 v253,v[152:153],v[156:157] offset0:93 offset1:97
M v[88:91],a[236:239],a[192:195],v[88:91]
s_waitcnt lgkmcnt(3)
M v[92:95],a[236:239],a[196:199],v[92:95]
s_waitcnt vmcnt(16)
buffer_load_dwordx4 a[236:239],v251,s[20:23],s48 offen offset:0
M v[64:67],a[240:243],a[204:207],v[64:67]
s_waitcnt lgkmcnt(0)
s_barrier
ds_read_b128 a[88:91],v251 offset:8704
M v[68:71],a[240:243],a[208:211],v[68:71]
ds_read_b128 a[92:95],v251 offset:12800
ds_read_b128 v[128:131],v251 offset:34816
M v[72:75],a[240:243],a[212:215],v[72:75]
ds_read_b128 v[136:139],v251 offset:38912
ds_read_b128 v[144:147],v251 offset:43520
M v[76:79],a[240:243],a[216:219],v[76:79]
ds_read_b128 v[152:155],v251 offset:47616
ds_read_b128 a[204:207],v249 offset:37120
M v[80:83],a[240:243],a[220:223],v[80:83]
M v[84:87],a[240:243],a[192:195],v[84:87]
s_waitcnt lgkmcnt(6)
s_add_u32 s34,s32,7471104
buffer_store_dwordx4 a[88:91],v252,s[24:27],s34 offen offset:640 nt
M v[88:91],a[240:243],a[196:199],v[88:91]
M v[92:95],a[240:243],a[200:203],v[92:95]
s_waitcnt vmcnt(17)
buffer_load_dwordx4 a[240:243],v251,s[20:23],s48 offen offset:1024
M v[64:67],a[244:247],a[208:211],v[64:67]
ds_read_b128 a[208:211],v249 offset:52224
M v[68:71],a[244:247],a[212:215],v[68:71]
ds_read_b128 a[212:215],v250 offset:52480
M v[72:75],a[244:247],a[216:219],v[72:75]
ds_read_b128 a[216:219],v250 offset:52736
M v[76:79],a[244:247],a[220:223],v[76:79]
ds_read_b128 a[220:223],v250 offset:52992
M v[80:83],a[244:247],a[192:195],v[80:83]
ds_read_b128 a[192:195],v250 offset:53248
M v[84:87],a[244:247],a[196:199],v[84:87]
ds_read_b128 a[196:199],v250 offset:53504
M v[88:91],a[244:247],a[200:203],v[88:91]
s_waitcnt lgkmcnt(6)
ds_read_b128 a[200:203],v250 offset:53760
M v[92:95],a[244:247],a[204:207],v[92:95]
s_waitcnt vmcnt(17) lgkmcnt(6)
buffer_load_dwordx4 a[244:247],v251,s[20:23],s48 offen offset:2048
M v[64:67],a[248:251],a[208:211],v[64:67]
s_waitcnt lgkmcnt(5)
ds_read_b128 a[204:207],v250 offset:54016
ds_read_b128 a[208:211],v250 offset:54272
M v[68:71],a[248:251],a[212:215],v[68:71]
s_waitcnt lgkmcnt(6)
s_add_u32 s48,s76,52224
M v[72:75],a[248:251],a[216:219],v[72:75]
s_waitcnt lgkmcnt(5)
M v[76:79],a[248:251],a[220:223],v[76:79]
s_waitcnt lgkmcnt(4)
M v[80:83],a[248:251],a[192:195],v[80:83]
s_waitcnt lgkmcnt(3)
M v[84:87],a[248:251],a[196:199],v[84:87]
s_waitcnt lgkmcnt(2)
M v[88:91],a[248:251],a[200:203],v[88:91]
s_waitcnt lgkmcnt(1)
M v[92:95],a[248:251],a[204:207],v[92:95]
s_waitcnt vmcnt(17)
buffer_load_dwordx4 a[248:251],v251,s[20:23],s48 offen offset:0
M v[64:67],a[252:255],a[212:215],v[64:67]
ds_read_b128 a[212:215],v249 offset:54528
M v[68:71],a[252:255],a[216:219],v[68:71]
M v[72:75],a[252:255],a[220:223],v[72:75]
M v[76:79],a[252:255],a[192:195],v[76:79]
s_add_u32 s34,s32,7667712
buffer_store_dwordx4 a[92:95],v252,s[24:27],s34 offen offset:640 nt
M v[80:83],a[252:255],a[196:199],v[80:83]
M v[84:87],a[252:255],a[200:203],v[84:87]
v_add_u32 v249,0x11000,v249
v_add_u32 v250,0x11000,v250
M v[88:91],a[252:255],a[204:207],v[88:91]
s_waitcnt lgkmcnt(1)
M v[92:95],a[252:255],a[208:211],v[92:95]
s_waitcnt vmcnt(18)
buffer_load_dwordx4 a[252:255],v251,s[20:23],s48 offen offset:1024
M v[64:67],v[216:219],a[216:219],v[64:67]
ds_read_b128 a[216:219],v249 offset:0
M v[68:71],v[216:219],a[220:223],v[68:71]
ds_read_b128 a[220:223],v250 offset:256
M v[72:75],v[216:219],a[192:195],v[72:75]
ds_read_b128 a[192:195],v250 offset:512
M v[76:79],v[216:219],a[196:199],v[76:79]
ds_read_b128 a[196:199],v250 offset:768
M v[80:83],v[216:219],a[200:203],v[80:83]
ds_read_b128 a[200:203],v250 offset:1024
M v[84:87],v[216:219],a[204:207],v[84:87]
ds_read_b128 a[204:207],v250 offset:1280
M v[88:91],v[216:219],a[208:211],v[88:91]
s_waitcnt lgkmcnt(6)
ds_read_b128 a[208:211],v250 offset:1536
M v[92:95],v[216:219],a[212:215],v[92:95]
s_waitcnt vmcnt(18) lgkmcnt(6)
buffer_load_dwordx4 v[216:219],v251,s[20:23],s48 offen offset:2048
M v[64:67],v[220:223],a[216:219],v[64:67]
s_waitcnt lgkmcnt(5)
ds_read_b128 a[212:215],v250 offset:1792
ds_read_b128 a[216:219],v250 offset:2048
M v[68:71],v[220:223],a[220:223],v[68:71]
s_waitcnt lgkmcnt(6)
s_add_u32 s48,s77,52224
M v[72:75],v[220:223],a[192:195],v[72:75]
s_waitcnt lgkmcnt(5)
M v[76:79],v[220:223],a[196:199],v[76:79]
s_waitcnt lgkmcnt(4)
M v[80:83],v[220:223],a[200:203],v[80:83]
s_waitcnt lgkmcnt(3)
M v[84:87],v[220:223],a[204:207],v[84:87]
s_waitcnt lgkmcnt(2)
M v[88:91],v[220:223],a[208:211],v[88:91]
s_waitcnt lgkmcnt(1)
M v[92:95],v[220:223],a[212:215],v[92:95]
s_waitcnt vmcnt(16)
buffer_load_dwordx4 v[220:223],v251,s[20:23],s48 offen offset:0
M v[64:67],v[224:227],a[220:223],v[64:67]
ds_read_b128 a[220:223],v249 offset:2304
M v[68:71],v[224:227],a[192:195],v[68:71]
s_add_u32 s34,s33,6291456
buffer_store_dwordx4 v[128:131],v252,s[24:27],s34 offen offset:1280 nt
M v[72:75],v[224:227],a[196:199],v[72:75]
M v[76:79],v[224:227],a[200:203],v[76:79]
M v[80:83],v[224:227],a[204:207],v[80:83]
M v[84:87],v[224:227],a[208:211],v[84:87]
M v[88:91],v[224:227],a[212:215],v[88:91]
s_waitcnt lgkmcnt(1)
M v[92:95],v[224:227],a[216:219],v[92:95]
s_waitcnt vmcnt(14)
buffer_load_dwordx4 v[224:227],v251,s[20:23],s48 offen offset:1024
M v[64:67],v[228:231],a[192:195],v[64:67]
ds_read_b128 a[192:195],v249 offset:17408
M v[68:71],v[228:231],a[196:199],v[68:71]
ds_read_b128 a[196:199],v250 offset:17664
M v[72:75],v[228:231],a[200:203],v[72:75]
ds_read_b128 a[200:203],v250 offset:17920
M v[76:79],v[228:231],a[204:207],v[76:79]
ds_read_b128 a[204:207],v250 offset:18176
M v[80:83],v[228:231],a[208:211],v[80:83]
ds_read_b128 a[208:211],v250 offset:18432
M v[84:87],v[228:231],a[212:215],v[84:87]
ds_read_b128 a[212:215],v250 offset:18688
M v[88:91],v[228:231],a[216:219],v[88:91]
s_waitcnt lgkmcnt(6)
ds_read_b128 a[216:219],v250 offset:18944
M v[92:95],v[228:231],a[220:223],v[92:95]
s_waitcnt vmcnt(14) lgkmcnt(6)
buffer_load_dwordx4 v[228:231],v251,s[20:23],s48 offen offset:2048
M v[64:67],a[224:227],a[192:195],v[64:67]
s_waitcnt lgkmcnt(5)
ds_read_b128 a[220:223],v250 offset:19200
ds_read_b128 a[192:195],v250 offset:19456
M v[68:71],a[224:227],a[196:199],v[68:71]
s_waitcnt lgkmcnt(6)
s_add_u32 s48,s78,52224
M v[72:75],a[224:227],a[200:203],v[72:75]
s_waitcnt lgkmcnt(5)
M v[76:79],a[224:227],a[204:207],v[76:79]
s_waitcnt lgkmcnt(4)
M v[80:83],a[224:227],a[208:211],v[80:83]
s_waitcnt lgkmcnt(3)
M v[84:87],a[224:227],a[212:215],v[84:87]
s_waitcnt lgkmcnt(2)
M v[88:91],a[224:227],a[216:219],v[88:91]
s_waitcnt lgkmcnt(1)
M v[92:95],a[224:227],a[220:223],v[92:95]
s_waitcnt vmcnt(13)
s_add_u32 s34,s33,6684672
buffer_load_dwordx4 a[224:227],v251,s[20:23],s48 offen offset:0
M v[64:67],a[228:231],a[196:199],v[64:67]
buffer_store_dwordx4 v[136:139],v252,s[24:27],s34 offen offset:1280 nt
M v[68:71],a[228:231],a[200:203],v[68:71]
ds_read_b128 a[196:199],v249 offset:19712
M v[72:75],a[228:231],a[204:207],v[72:75]
M v[76:79],a[228:231],a[208:211],v[76:79]
M v[80:83],a[228:231],a[212:215],v[80:83]
M v[84:87],a[228:231],a[216:219],v[84:87]
v_add_u32 v249,0xffff1200,v249
v_add_u32 v250,0xffff1200,v250
M v[88:91],a[228:231],a[220:223],v[88:91]
s_waitcnt lgkmcnt(1)
M v[92:95],a[228:231],a[192:195],v[92:95]
s_waitcnt vmcnt(14)
buffer_load_dwordx4 a[228:231],v251,s[20:23],s48 offen offset:1024
M v[64:67],a[232:235],a[200:203],v[64:67]
ds_read_b128 a[200:203],v249 offset:8704
M v[68:71],a[232:235],a[204:207],v[68:71]
ds_read_b128 a[204:207],v250 offset:8960
M v[72:75],a[232:235],a[208:211],v[72:75]
ds_read_b128 a[208:211],v250 offset:9216
M v[76:79],a[232:235],a[212:215],v[76:79]
ds_read_b128 a[212:215],v250 offset:9472
M v[80:83],a[232:235],a[216:219],v[80:83]
ds_read_b128 a[216:219],v250 offset:9728
M v[84:87],a[232:235],a[220:223],v[84:87]
ds_read_b128 a[220:223],v250 offset:9984
M v[88:91],a[232:235],a[192:195],v[88:91]
s_waitcnt lgkmcnt(6)
ds_read_b128 a[192:195],v250 offset:10240
M v[92:95],a[232:235],a[196:199],v[92:95]
s_waitcnt vmcnt(14) lgkmcnt(6)
buffer_load_dwordx4 a[232:235],v251,s[20:23],s48 offen offset:2048
M v[64:67],a[236:239],a[200:203],v[64:67]
s_waitcnt lgkmcnt(5)
ds_read_b128 a[196:199],v250 offset:10496
ds_read_b128 a[200:203],v250 offset:10752
M v[68:71],a[236:239],a[204:207],v[68:71]
s_waitcnt lgkmcnt(6)
s_add_u32 s48,s79,52224
M v[72:75],a[236:239],a[208:211],v[72:75]
s_waitcnt lgkmcnt(5)
M v[76:79],a[236:239],a[212:215],v[76:79]
s_waitcnt lgkmcnt(4)
M v[80:83],a[236:239],a[216:219],v[80:83]
s_waitcnt lgkmcnt(3)
M v[84:87],a[236:239],a[220:223],v[84:87]
s_waitcnt lgkmcnt(2)
s_add_u32 s34,s33,7077888
buffer_store_dwordx4 v[144:147],v252,s[24:27],s34 offen offset:1280 nt
M v[88:91],a[236:239],a[192:195],v[88:91]
s_waitcnt lgkmcnt(1)
M v[92:95],a[236:239],a[196:199],v[92:95]
s_waitcnt vmcnt(14)
buffer_load_dwordx4 a[236:239],v251,s[20:23],s48 offen offset:0
M v[64:67],a[240:243],a[204:207],v[64:67]
ds_read_b128 a[204:207],v249 offset:11008
M v[68:71],a[240:243],a[208:211],v[68:71]
M v[72:75],a[240:243],a[212:215],v[72:75]
M v[76:79],a[240:243],a[216:219],v[76:79]
M v[80:83],a[240:243],a[220:223],v[80:83]
M v[84:87],a[240:243],a[192:195],v[84:87]
M v[88:91],a[240:243],a[196:199],v[88:91]
s_waitcnt lgkmcnt(1)
M v[92:95],a[240:243],a[200:203],v[92:95]
s_waitcnt vmcnt(14)
buffer_load_dwordx4 a[240:243],v251,s[20:23],s48 offen offset:1024
M v[64:67],a[244:247],a[208:211],v[64:67]
ds_read_b128 a[208:211],v249 offset:0
M v[68:71],a[244:247],a[212:215],v[68:71]
ds_read_b128 a[212:215],v250 offset:256
M v[72:75],a[244:247],a[216:219],v[72:75]
ds_read_b128 a[216:219],v250 offset:512
M v[76:79],a[244:247],a[220:223],v[76:79]
ds_read_b128 a[220:223],v250 offset:768
s_nop 0
v_cvt_pk_bf16_f32 v64,v64,v65
M v[80:83],a[244:247],a[192:195],v[80:83]
ds_read_b128 a[192:195],v250 offset:1024
v_cvt_pk_bf16_f32 v65,v66,v67
M v[84:87],a[244:247],a[196:199],v[84:87]
ds_read_b128 a[196:199],v250 offset:1280
v_cvt_pk_bf16_f32 v68,v68,v69
M v[88:91],a[244:247],a[200:203],v[88:91]
s_waitcnt lgkmcnt(6)
ds_read_b128 a[200:203],v250 offset:1536
v_cvt_pk_bf16_f32 v69,v70,v71
M v[92:95],a[244:247],a[204:207],v[92:95]
s_waitcnt vmcnt(14) lgkmcnt(6)
buffer_load_dwordx4 a[244:247],v251,s[20:23],s48 offen offset:2048
M v[160:163],a[248:251],a[208:211],v[160:163]
s_waitcnt lgkmcnt(5)
ds_read_b128 a[204:207],v250 offset:1792
ds_read_b128 a[208:211],v250 offset:2048
M v[164:167],a[248:251],a[212:215],v[164:167]
s_waitcnt lgkmcnt(6)
s_add_u32 s48,s80,52224
ds_write2st64_b64 v253,v[64:65],v[68:69] offset0:34 offset1:38
M v[168:171],a[248:251],a[216:219],v[168:171]
s_waitcnt lgkmcnt(6)
v_cvt_pk_bf16_f32 v72,v72,v73
v_cvt_pk_bf16_f32 v73,v74,v75
M v[172:175],a[248:251],a[220:223],v[172:175]
s_waitcnt lgkmcnt(5)
s_add_u32 s34,s33,7471104
buffer_store_dwordx4 v[152:155],v252,s[24:27],s34 offen offset:1280 nt
M v[176:179],a[248:251],a[192:195],v[176:179]
s_waitcnt lgkmcnt(4)
v_cvt_pk_bf16_f32 v76,v76,v77
v_cvt_pk_bf16_f32 v77,v78,v79
M v[180:183],a[248:251],a[196:199],v[180:183]
s_waitcnt lgkmcnt(3)
ds_write2st64_b64 v253,v[72:73],v[76:77] offset0:42 offset1:46
M v[184:187],a[248:251],a[200:203],v[184:187]
s_waitcnt lgkmcnt(3)
v_cvt_pk_bf16_f32 v80,v80,v81
v_cvt_pk_bf16_f32 v81,v82,v83
M v[188:191],a[248:251],a[204:207],v[188:191]
s_waitcnt vmcnt(14)
buffer_load_dwordx4 a[248:251],v251,s[20:23],s48 offen offset:0
M v[160:163],a[252:255],a[212:215],v[160:163]
ds_read_b128 a[212:215],v249 offset:2304
v_cvt_pk_bf16_f32 v84,v84,v85
M v[164:167],a[252:255],a[216:219],v[164:167]
v_cvt_pk_bf16_f32 v85,v86,v87
M v[168:171],a[252:255],a[220:223],v[168:171]
ds_write2st64_b64 v253,v[80:81],v[84:85] offset0:51 offset1:55
M v[172:175],a[252:255],a[192:195],v[172:175]
v_cvt_pk_bf16_f32 v88,v88,v89
v_cvt_pk_bf16_f32 v89,v90,v91
M v[176:179],a[252:255],a[196:199],v[176:179]
v_cvt_pk_bf16_f32 v92,v92,v93
v_cvt_pk_bf16_f32 v93,v94,v95
M v[180:183],a[252:255],a[200:203],v[180:183]
ds_write2st64_b64 v253,v[88:89],v[92:93] offset0:59 offset1:63
M v[184:187],a[252:255],a[204:207],v[184:187]
s_waitcnt lgkmcnt(5)
M v[188:191],a[252:255],a[208:211],v[188:191]
s_waitcnt vmcnt(14)
buffer_load_dwordx4 a[252:255],v251,s[20:23],s48 offen offset:1024
M v[160:163],v[216:219],a[216:219],v[160:163]
s_waitcnt lgkmcnt(0)
s_barrier
ds_read_b128 v[64:67],v251 offset:17408
M v[164:167],v[216:219],a[220:223],v[164:167]
ds_read_b128 v[72:75],v251 offset:21504
ds_read_b128 v[80:83],v251 offset:26112
M v[168:171],v[216:219],a[192:195],v[168:171]
ds_read_b128 v[88:91],v251 offset:30208
ds_read_b128 a[216:219],v249 offset:34816
M v[172:175],v[216:219],a[196:199],v[172:175]
ds_read_b128 a[220:223],v250 offset:35072
ds_read_b128 a[192:195],v250 offset:35328
M v[176:179],v[216:219],a[200:203],v[176:179]
ds_read_b128 a[196:199],v250 offset:35584
ds_read_b128 a[200:203],v250 offset:35840
M v[180:183],v[216:219],a[204:207],v[180:183]
ds_read_b128 a[204:207],v250 offset:36096
M v[184:187],v[216:219],a[208:211],v[184:187]
ds_read_b128 a[208:211],v250 offset:36352
M v[188:191],v[216:219],a[212:215],v[188:191]
s_waitcnt vmcnt(14) lgkmcnt(6)
buffer_load_dwordx4 v[216:219],v251,s[20:23],s48 offen offset:2048
M v[160:163],v[220:223],a[216:219],v[160:163]
s_waitcnt lgkmcnt(5)
ds_read_b128 a[212:215],v250 offset:36608
ds_read_b128 a[216:219],v250 offset:36864
M v[164:167],v[220:223],a[220:223],v[164:167]
s_waitcnt lgkmcnt(6)
s_add_u32 s48,s81,52224
s_add_u32 s34,s33,6291456
M v[168:171],v[220:223],a[192:195],v[168:171]
s_waitcnt lgkmcnt(5)
buffer_store_dwordx4 v[64:67],v252,s[24:27],s34 offen offset:256 nt
M v[172:175],v[220:223],a[196:199],v[172:175]
s_waitcnt lgkmcnt(4)
M v[176:179],v[220:223],a[200:203],v[176:179]
s_waitcnt lgkmcnt(3)
M v[180:183],v[220:223],a[204:207],v[180:183]
s_waitcnt lgkmcnt(2)
M v[184:187],v[220:223],a[208:211],v[184:187]
s_waitcnt lgkmcnt(1)
M v[188:191],v[220:223],a[212:215],v[188:191]
s_waitcnt vmcnt(14)
buffer_load_dwordx4 v[220:223],v251,s[20:23],s48 offen offset:0
M v[160:163],v[224:227],a[220:223],v[160:163]
ds_read_b128 a[220:223],v249 offset:37120
M v[164:167],v[224:227],a[192:195],v[164:167]
M v[168:171],v[224:227],a[196:199],v[168:171]
M v[172:175],v[224:227],a[200:203],v[172:175]
M v[176:179],v[224:227],a[204:207],v[176:179]
M v[180:183],v[224:227],a[208:211],v[180:183]
M v[184:187],v[224:227],a[212:215],v[184:187]
s_waitcnt lgkmcnt(1)
M v[188:191],v[224:227],a[216:219],v[188:191]
s_waitcnt vmcnt(14)
buffer_load_dwordx4 v[224:227],v251,s[20:23],s48 offen offset:1024
M v[160:163],v[228:231],a[192:195],v[160:163]
ds_read_b128 a[192:195],v249 offset:52224
M v[164:167],v[228:231],a[196:199],v[164:167]
ds_read_b128 a[196:199],v250 offset:52480
M v[168:171],v[228:231],a[200:203],v[168:171]
ds_read_b128 a[200:203],v250 offset:52736
M v[172:175],v[228:231],a[204:207],v[172:175]
ds_read_b128 a[204:207],v250 offset:52992
M v[176:179],v[228:231],a[208:211],v[176:179]
ds_read_b128 a[208:211],v250 offset:53248
M v[180:183],v[228:231],a[212:215],v[180:183]
ds_read_b128 a[212:215],v250 offset:53504
M v[184:187],v[228:231],a[216:219],v[184:187]
s_waitcnt lgkmcnt(6)
ds_read_b128 a[216:219],v250 offset:53760
M v[188:191],v[228:231],a[220:223],v[188:191]
s_waitcnt vmcnt(14) lgkmcnt(6)
s_add_u32 s34,s33,6684672
buffer_load_dwordx4 v[228:231],v251,s[20:23],s48 offen offset:2048
M v[160:163],a[224:227],a[192:195],v[160:163]
s_waitcnt lgkmcnt(5)
buffer_store_dwordx4 v[72:75],v252,s[24:27],s34 offen offset:256 nt
M v[164:167],a[224:227],a[196:199],v[164:167]
s_waitcnt lgkmcnt(4)
ds_read_b128 a[220:223],v250 offset:54016
ds_read_b128 a[192:195],v250 offset:54272
M v[168:171],a[224:227],a[200:203],v[168:171]
s_waitcnt lgkmcnt(5)
M v[172:175],a[224:227],a[204:207],v[172:175]
s_waitcnt lgkmcnt(4)
M v[176:179],a[224:227],a[208:211],v[176:179]
s_waitcnt lgkmcnt(3)
M v[180:183],a[224:227],a[212:215],v[180:183]
s_waitcnt lgkmcnt(2)
M v[184:187],a[224:227],a[216:219],v[184:187]
s_waitcnt lgkmcnt(1)
M v[188:191],a[224:227],a[220:223],v[188:191]
s_waitcnt vmcnt(14)
M v[160:163],a[228:231],a[196:199],v[160:163]
ds_read_b128 a[196:199],v249 offset:54528
M v[164:167],a[228:231],a[200:203],v[164:167]
M v[168:171],a[228:231],a[204:207],v[168:171]
M v[172:175],a[228:231],a[208:211],v[172:175]
M v[176:179],a[228:231],a[212:215],v[176:179]
M v[180:183],a[228:231],a[216:219],v[180:183]
v_add_u32 v249,0x11000,v249
v_add_u32 v250,0x11000,v250
M v[184:187],a[228:231],a[220:223],v[184:187]
s_waitcnt lgkmcnt(1)
M v[188:191],a[228:231],a[192:195],v[188:191]
s_waitcnt vmcnt(13)
M v[160:163],a[232:235],a[200:203],v[160:163]
ds_read_b128 a[200:203],v249 offset:0
M v[164:167],a[232:235],a[204:207],v[164:167]
ds_read_b128 a[204:207],v250 offset:256
M v[168:171],a[232:235],a[208:211],v[168:171]
ds_read_b128 a[208:211],v250 offset:512
M v[172:175],a[232:235],a[212:215],v[172:175]
ds_read_b128 a[212:215],v250 offset:768
M v[176:179],a[232:235],a[216:219],v[176:179]
ds_read_b128 a[216:219],v250 offset:1024
M v[180:183],a[232:235],a[220:223],v[180:183]
s_add_u32 s34,s33,7077888
buffer_store_dwordx4 v[80:83],v252,s[24:27],s34 offen offset:256 nt
M v[184:187],a[232:235],a[192:195],v[184:187]
s_waitcnt lgkmcnt(5)
ds_read_b128 a[220:223],v250 offset:1280
ds_read_b128 a[192:195],v250 offset:1536
M v[188:191],a[232:235],a[196:199],v[188:191]
s_waitcnt vmcnt(12) lgkmcnt(6)
ds_read_b128 a[196:199],v250 offset:1792
M v[160:163],a[236:239],a[200:203],v[160:163]
s_waitcnt lgkmcnt(6)
ds_read_b128 a[200:203],v250 offset:2048
M v[164:167],a[236:239],a[204:207],v[164:167]
s_waitcnt lgkmcnt(6)
M v[168:171],a[236:239],a[208:211],v[168:171]
s_waitcnt lgkmcnt(5)
M v[172:175],a[236:239],a[212:215],v[172:175]
s_waitcnt lgkmcnt(4)
M v[176:179],a[236:239],a[216:219],v[176:179]
s_waitcnt lgkmcnt(3)
M v[180:183],a[236:239],a[220:223],v[180:183]
s_waitcnt lgkmcnt(2)
M v[184:187],a[236:239],a[192:195],v[184:187]
s_waitcnt lgkmcnt(1)
M v[188:191],a[236:239],a[196:199],v[188:191]
s_waitcnt vmcnt(11)
M v[160:163],a[240:243],a[204:207],v[160:163]
ds_read_b128 a[204:207],v249 offset:2304
M v[164:167],a[240:243],a[208:211],v[164:167]
M v[168:171],a[240:243],a[212:215],v[168:171]
M v[172:175],a[240:243],a[216:219],v[172:175]
M v[176:179],a[240:243],a[220:223],v[176:179]
M v[180:183],a[240:243],a[192:195],v[180:183]
M v[184:187],a[240:243],a[196:199],v[184:187]
s_waitcnt lgkmcnt(1)
M v[188:191],a[240:243],a[200:203],v[188:191]
s_waitcnt vmcnt(10)
M v[160:163],a[244:247],a[208:211],v[160:163]
ds_read_b128 a[208:211],v249 offset:17408
M v[164:167],a[244:247],a[212:215],v[164:167]
ds_read_b128 a[212:215],v250 offset:17664
M v[168:171],a[244:247],a[216:219],v[168:171]
ds_read_b128 a[216:219],v250 offset:17920
M v[172:175],a[244:247],a[220:223],v[172:175]
s_add_u32 s34,s33,7471104
buffer_store_dwordx4 v[88:91],v252,s[24:27],s34 offen offset:256 nt
M v[176:179],a[244:247],a[192:195],v[176:179]
ds_read_b128 a[220:223],v250 offset:18176
ds_read_b128 a[192:195],v250 offset:18432
M v[180:183],a[244:247],a[196:199],v[180:183]
ds_read_b128 a[196:199],v250 offset:18688
M v[184:187],a[244:247],a[200:203],v[184:187]
s_waitcnt lgkmcnt(6)
ds_read_b128 a[200:203],v250 offset:18944
M v[188:191],a[244:247],a[204:207],v[188:191]
s_waitcnt vmcnt(9) lgkmcnt(6)
ds_read_b128 a[204:207],v250 offset:19200
M v[160:163],a[248:251],a[208:211],v[160:163]
s_waitcnt lgkmcnt(6)
ds_read_b128 a[208:211],v250 offset:19456
M v[164:167],a[248:251],a[212:215],v[164:167]
s_waitcnt lgkmcnt(6)
M v[168:171],a[248:251],a[216:219],v[168:171]
s_waitcnt lgkmcnt(5)
M v[172:175],a[248:251],a[220:223],v[172:175]
s_waitcnt lgkmcnt(4)
M v[176:179],a[248:251],a[192:195],v[176:179]
s_waitcnt lgkmcnt(3)
M v[180:183],a[248:251],a[196:199],v[180:183]
s_waitcnt lgkmcnt(2)
M v[184:187],a[248:251],a[200:203],v[184:187]
s_waitcnt lgkmcnt(1)
M v[188:191],a[248:251],a[204:207],v[188:191]
s_waitcnt vmcnt(8)
M v[160:163],a[252:255],a[212:215],v[160:163]
ds_read_b128 a[212:215],v249 offset:19712
M v[164:167],a[252:255],a[216:219],v[164:167]
M v[168:171],a[252:255],a[220:223],v[168:171]
M v[172:175],a[252:255],a[192:195],v[172:175]
M v[176:179],a[252:255],a[196:199],v[176:179]
M v[180:183],a[252:255],a[200:203],v[180:183]
v_add_u32 v249,0xffff3400,v249
v_add_u32 v250,0xffff3400,v250
M v[184:187],a[252:255],a[204:207],v[184:187]
s_waitcnt lgkmcnt(1)
M v[188:191],a[252:255],a[208:211],v[188:191]
s_waitcnt vmcnt(7)
M v[160:163],v[216:219],a[216:219],v[160:163]
ds_read_b128 a[216:219],v249 offset:0
M v[164:167],v[216:219],a[220:223],v[164:167]
ds_read_b128 a[220:223],v250 offset:256
M v[168:171],v[216:219],a[192:195],v[168:171]
ds_read_b128 a[192:195],v250 offset:512
M v[172:175],v[216:219],a[196:199],v[172:175]
ds_read_b128 a[196:199],v250 offset:768
M v[176:179],v[216:219],a[200:203],v[176:179]
ds_read_b128 a[200:203],v250 offset:1024
M v[180:183],v[216:219],a[204:207],v[180:183]
ds_read_b128 a[204:207],v250 offset:1280
M v[184:187],v[216:219],a[208:211],v[184:187]
s_waitcnt lgkmcnt(6)
ds_read_b128 a[208:211],v250 offset:1536
M v[188:191],v[216:219],a[212:215],v[188:191]
s_waitcnt vmcnt(5) lgkmcnt(6)
ds_read_b128 a[212:215],v250 offset:1792
M v[160:163],v[220:223],a[216:219],v[160:163]
s_waitcnt lgkmcnt(6)
ds_read_b128 a[216:219],v250 offset:2048
M v[164:167],v[220:223],a[220:223],v[164:167]
s_waitcnt lgkmcnt(6)
M v[168:171],v[220:223],a[192:195],v[168:171]
s_waitcnt lgkmcnt(5)
M v[172:175],v[220:223],a[196:199],v[172:175]
s_waitcnt lgkmcnt(4)
M v[176:179],v[220:223],a[200:203],v[176:179]
s_waitcnt lgkmcnt(3)
M v[180:183],v[220:223],a[204:207],v[180:183]
s_waitcnt lgkmcnt(2)
M v[184:187],v[220:223],a[208:211],v[184:187]
s_waitcnt lgkmcnt(1)
M v[188:191],v[220:223],a[212:215],v[188:191]
s_waitcnt vmcnt(4)
M v[160:163],v[224:227],a[220:223],v[160:163]
ds_read_b128 a[220:223],v249 offset:2304
M v[164:167],v[224:227],a[192:195],v[164:167]
M v[168:171],v[224:227],a[196:199],v[168:171]
M v[172:175],v[224:227],a[200:203],v[172:175]
M v[176:179],v[224:227],a[204:207],v[176:179]
M v[180:183],v[224:227],a[208:211],v[180:183]
M v[184:187],v[224:227],a[212:215],v[184:187]
s_waitcnt lgkmcnt(1)
M v[188:191],v[224:227],a[216:219],v[188:191]
s_waitcnt vmcnt(3)
M v[160:163],v[228:231],a[192:195],v[160:163]
M v[164:167],v[228:231],a[196:199],v[164:167]
M v[168:171],v[228:231],a[200:203],v[168:171]
M v[172:175],v[228:231],a[204:207],v[172:175]
s_nop 4
v_cvt_pk_bf16_f32 v160,v160,v161
v_cvt_pk_bf16_f32 v161,v162,v163
M v[176:179],v[228:231],a[208:211],v[176:179]
v_cvt_pk_bf16_f32 v164,v164,v165
v_cvt_pk_bf16_f32 v165,v166,v167
M v[180:183],v[228:231],a[212:215],v[180:183]
ds_write2st64_b64 v253,v[160:161],v[164:165] offset0:17 offset1:21
M v[184:187],v[228:231],a[216:219],v[184:187]
s_waitcnt lgkmcnt(1)
v_cvt_pk_bf16_f32 v168,v168,v169
v_cvt_pk_bf16_f32 v169,v170,v171
M v[188:191],v[228:231],a[220:223],v[188:191]
v_cvt_pk_bf16_f32 v172,v172,v173
v_cvt_pk_bf16_f32 v173,v174,v175
ds_write2st64_b64 v253,v[168:169],v[172:173] offset0:25 offset1:29
v_cvt_pk_bf16_f32 v176,v176,v177
v_cvt_pk_bf16_f32 v177,v178,v179
v_cvt_pk_bf16_f32 v180,v180,v181
v_cvt_pk_bf16_f32 v181,v182,v183
ds_write2st64_b64 v253,v[176:177],v[180:181] offset0:68 offset1:72
v_cvt_pk_bf16_f32 v184,v184,v185
v_cvt_pk_bf16_f32 v185,v186,v187
v_cvt_pk_bf16_f32 v188,v188,v189
v_cvt_pk_bf16_f32 v189,v190,v191
ds_write2st64_b64 v253,v[184:185],v[188:189] offset0:76 offset1:80
s_waitcnt lgkmcnt(0)
s_barrier
ds_read_b128 v[160:163],v251 offset:8704
ds_read_b128 v[168:171],v251 offset:12800
ds_read_b128 v[176:179],v251 offset:34816
ds_read_b128 v[184:187],v251 offset:38912
s_add_u32 s34,s33,6291456
s_waitcnt lgkmcnt(3)
buffer_store_dwordx4 v[160:163],v252,s[24:27],s34 offen offset:1408 nt
s_nop 1
s_add_u32 s34,s33,6684672
s_waitcnt lgkmcnt(2)
buffer_store_dwordx4 v[168:171],v252,s[24:27],s34 offen offset:1408 nt
s_nop 1
s_add_u32 s34,s33,7077888
s_waitcnt lgkmcnt(1)
buffer_store_dwordx4 v[176:179],v252,s[24:27],s34 offen offset:1408 nt
s_nop 1
s_add_u32 s34,s33,7471104
s_waitcnt lgkmcnt(0)
buffer_store_dwordx4 v[184:187],v252,s[24:27],s34 offen offset:1408 nt
s_endpgm
L_code_end:
.section .rodata,"a"
.p2align 6
.amdhsa_kernel wtrans_kernel
  .amdhsa_next_free_vgpr 96
  .amdhsa_next_free_sgpr 48
  .amdhsa_accum_offset 96
  .amdhsa_group_segment_fixed_size 0
  .amdhsa_kernarg_size 40
  .amdhsa_user_sgpr_count 2
  .amdhsa_user_sgpr_kernarg_segment_ptr 1
  .amdhsa_system_sgpr_workgroup_id_x 1
  .amdhsa_float_denorm_mode_32 3
.end_amdhsa_kernel
.p2align 6
.amdhsa_kernel standalone__winograd__vision_kernel
  .amdhsa_next_free_vgpr 512
  .amdhsa_next_free_sgpr 84
  .amdhsa_accum_offset 256
  .amdhsa_group_segment_fixed_size 0
  .amdhsa_kernarg_size 40
  .amdhsa_user_sgpr_count 2
  .amdhsa_user_sgpr_kernarg_segment_ptr 1
  .amdhsa_system_sgpr_workgroup_id_x 1
  .amdhsa_float_denorm_mode_32 3
.end_amdhsa_kernel
```

```asm
; @launch grid=(256,1,1) block=(256,1,1) lds=156672
.amdgcn_target "amdgcn-amd-amdhsa--gfx950"
.macro M d,a,b,c
v_mfma_f32_16x16x32_bf16 \d,\a,\b,\c
.endm
.text
.globl standalone__winograd__vision_kernel
.p2align 8
.type standalone__winograd__vision_kernel,@function
standalone__winograd__vision_kernel:
s_cmp_ge_u32 s2,256
s_cbranch_scc0 L_go
s_endpgm
L_fallback:
s_mov_b32 s84,0
L_itemF:
s_and_b32 s85,s84,3
s_lshr_b32 s86,s84,2
s_mul_hi_u32 s87,s86,0x55555556
s_mul_i32 s88,s87,3
s_sub_u32 s86,s86,s88
s_mul_hi_u32 s88,s87,0x2aaaaaab
s_mul_i32 s89,s88,6
s_sub_u32 s87,s87,s89
s_mul_i32 s89,s86,221184
s_mul_i32 s90,s87,12288
s_add_u32 s89,s89,s90
s_mul_i32 s90,s85,3072
s_add_u32 s89,s89,s90
s_lshl_b32 s90,s88,7
s_add_u32 s89,s89,s90
s_add_u32 s90,s89,73728
s_add_u32 s91,s90,73728
v_lshlrev_b32 v149,1,v64
buffer_load_short_d16_hi v68,v149,s[36:39],s89 offen offset:0
buffer_load_short_d16_hi v69,v149,s[36:39],s89 offen offset:384
buffer_load_short_d16_hi v70,v149,s[36:39],s89 offen offset:768
buffer_load_short_d16_hi v71,v149,s[36:39],s89 offen offset:1152
buffer_load_short_d16_hi v72,v149,s[36:39],s89 offen offset:1536
buffer_load_short_d16_hi v73,v149,s[36:39],s89 offen offset:1920
buffer_load_short_d16_hi v74,v149,s[36:39],s89 offen offset:2304
buffer_load_short_d16_hi v75,v149,s[36:39],s89 offen offset:2688
buffer_load_short_d16_hi v76,v149,s[36:39],s90 offen offset:0
buffer_load_short_d16_hi v77,v149,s[36:39],s90 offen offset:384
buffer_load_short_d16_hi v78,v149,s[36:39],s90 offen offset:768
buffer_load_short_d16_hi v79,v149,s[36:39],s90 offen offset:1152
buffer_load_short_d16_hi v80,v149,s[36:39],s90 offen offset:1536
buffer_load_short_d16_hi v81,v149,s[36:39],s90 offen offset:1920
buffer_load_short_d16_hi v82,v149,s[36:39],s90 offen offset:2304
buffer_load_short_d16_hi v83,v149,s[36:39],s90 offen offset:2688
buffer_load_short_d16_hi v84,v149,s[36:39],s91 offen offset:0
buffer_load_short_d16_hi v85,v149,s[36:39],s91 offen offset:384
buffer_load_short_d16_hi v86,v149,s[36:39],s91 offen offset:768
buffer_load_short_d16_hi v87,v149,s[36:39],s91 offen offset:1152
buffer_load_short_d16_hi v88,v149,s[36:39],s91 offen offset:1536
buffer_load_short_d16_hi v89,v149,s[36:39],s91 offen offset:1920
buffer_load_short_d16_hi v90,v149,s[36:39],s91 offen offset:2304
buffer_load_short_d16_hi v91,v149,s[36:39],s91 offen offset:2688
v_lshrrev_b32 v150,4,v64
v_mul_u32_u24 v150,331776,v150
v_and_b32 v148,15,v64
v_lshl_add_u32 v150,v148,4,v150
s_mul_i32 s87,s87,55296
s_mul_i32 s88,s88,3072
s_add_u32 s87,s87,s88
s_lshl_b32 s86,s86,10
s_add_u32 s87,s87,s86
s_lshl_b32 s85,s85,8
s_add_u32 s87,s87,s85
s_mov_b32 s85,0xbe2aaaab
s_mov_b32 s86,0x3d2aaaab
s_mov_b32 s88,0x3e2aaaab
s_mov_b32 s92,0x3daaaaab
s_waitcnt vmcnt(0)
v_add_f32 v148,v68,v84
v_add_f32 v92,v148,v76
v_sub_f32 v100,v148,v76
v_mul_f32 v92,s85,v92
v_mul_f32 v100,s85,v100
v_mul_f32 v148,s86,v68
v_fmac_f32 v148,s88,v84
v_fma_f32 v108,s92,v76,v148
v_fma_f32 v116,-s92,v76,v148
v_add_f32 v148,v69,v85
v_add_f32 v93,v148,v77
v_sub_f32 v101,v148,v77
v_mul_f32 v93,s85,v93
v_mul_f32 v101,s85,v101
v_mul_f32 v148,s86,v69
v_fmac_f32 v148,s88,v85
v_fma_f32 v109,s92,v77,v148
v_fma_f32 v117,-s92,v77,v148
v_add_f32 v148,v70,v86
v_add_f32 v94,v148,v78
v_sub_f32 v102,v148,v78
v_mul_f32 v94,s85,v94
v_mul_f32 v102,s85,v102
v_mul_f32 v148,s86,v70
v_fmac_f32 v148,s88,v86
v_fma_f32 v110,s92,v78,v148
v_fma_f32 v118,-s92,v78,v148
v_add_f32 v148,v71,v87
v_add_f32 v95,v148,v79
v_sub_f32 v103,v148,v79
v_mul_f32 v95,s85,v95
v_mul_f32 v103,s85,v103
v_mul_f32 v148,s86,v71
v_fmac_f32 v148,s88,v87
v_fma_f32 v111,s92,v79,v148
v_fma_f32 v119,-s92,v79,v148
v_add_f32 v148,v72,v88
v_add_f32 v96,v148,v80
v_sub_f32 v104,v148,v80
v_mul_f32 v96,s85,v96
v_mul_f32 v104,s85,v104
v_mul_f32 v148,s86,v72
v_fmac_f32 v148,s88,v88
v_fma_f32 v112,s92,v80,v148
v_fma_f32 v120,-s92,v80,v148
v_add_f32 v148,v73,v89
v_add_f32 v97,v148,v81
v_sub_f32 v105,v148,v81
v_mul_f32 v97,s85,v97
v_mul_f32 v105,s85,v105
v_mul_f32 v148,s86,v73
v_fmac_f32 v148,s88,v89
v_fma_f32 v113,s92,v81,v148
v_fma_f32 v121,-s92,v81,v148
v_add_f32 v148,v74,v90
v_add_f32 v98,v148,v82
v_sub_f32 v106,v148,v82
v_mul_f32 v98,s85,v98
v_mul_f32 v106,s85,v106
v_mul_f32 v148,s86,v74
v_fmac_f32 v148,s88,v90
v_fma_f32 v114,s92,v82,v148
v_fma_f32 v122,-s92,v82,v148
v_add_f32 v148,v75,v91
v_add_f32 v99,v148,v83
v_sub_f32 v107,v148,v83
v_mul_f32 v99,s85,v99
v_mul_f32 v107,s85,v107
v_mul_f32 v148,s86,v75
v_fmac_f32 v148,s88,v91
v_fma_f32 v115,s92,v83,v148
v_fma_f32 v123,-s92,v83,v148
v_cvt_pk_bf16_f32 v124,v68,v69
v_cvt_pk_bf16_f32 v125,v70,v71
v_cvt_pk_bf16_f32 v126,v72,v73
v_cvt_pk_bf16_f32 v127,v74,v75
s_add_u32 s89,s87,0
buffer_store_dwordx4 v[124:127],v150,s[20:23],s89 offen sc1
v_cvt_pk_bf16_f32 v144,v84,v85
v_cvt_pk_bf16_f32 v145,v86,v87
v_cvt_pk_bf16_f32 v146,v88,v89
v_cvt_pk_bf16_f32 v147,v90,v91
s_add_u32 s89,s87,46080
buffer_store_dwordx4 v[144:147],v150,s[20:23],s89 offen sc1
v_cvt_pk_bf16_f32 v128,v92,v93
v_cvt_pk_bf16_f32 v129,v94,v95
v_cvt_pk_bf16_f32 v130,v96,v97
v_cvt_pk_bf16_f32 v131,v98,v99
s_add_u32 s89,s87,9216
buffer_store_dwordx4 v[128:131],v150,s[20:23],s89 offen sc1
v_cvt_pk_bf16_f32 v132,v100,v101
v_cvt_pk_bf16_f32 v133,v102,v103
v_cvt_pk_bf16_f32 v134,v104,v105
v_cvt_pk_bf16_f32 v135,v106,v107
s_add_u32 s89,s87,18432
buffer_store_dwordx4 v[132:135],v150,s[20:23],s89 offen sc1
v_cvt_pk_bf16_f32 v136,v108,v109
v_cvt_pk_bf16_f32 v137,v110,v111
v_cvt_pk_bf16_f32 v138,v112,v113
v_cvt_pk_bf16_f32 v139,v114,v115
s_add_u32 s89,s87,27648
buffer_store_dwordx4 v[136:139],v150,s[20:23],s89 offen sc1
v_cvt_pk_bf16_f32 v140,v116,v117
v_cvt_pk_bf16_f32 v141,v118,v119
v_cvt_pk_bf16_f32 v142,v120,v121
v_cvt_pk_bf16_f32 v143,v122,v123
s_add_u32 s89,s87,36864
buffer_store_dwordx4 v[140:143],v150,s[20:23],s89 offen sc1
s_waitcnt vmcnt(0)
s_add_u32 s84,s84,1
s_cmp_lt_u32 s84,216
s_cbranch_scc1 L_itemF
s_branch L_uready
L_go:
s_load_dwordx4 s[4:7],s[0:1],0
s_load_dwordx4 s[24:27],s[0:1],16
s_load_dwordx2 s[52:53],s[0:1],32
v_lshrrev_b32 v60,6,v0
v_and_b32 v64,63,v0
v_readfirstlane_b32 s50,v60
v_lshrrev_b32 v60,4,v64
v_bfe_u32 v61,v64,3,1
v_lshl_add_u32 v61,v60,3,v61
v_and_b32 v62,7,v64
v_mul_u32_u24 v245,196608,v61
v_lshl_add_u32 v245,v62,3,v245
v_lshlrev_b32 v251,4,v0
v_bfe_u32 v63,v64,2,1
v_mul_u32_u24 v63,768,v63
v_mul_u32_u24 v254,196608,v61
v_add_u32 v254,v254,v63
s_and_b32 s54,s2,7
s_lshr_b32 s55,s2,3
s_lshl_b32 s49,s54,6
s_lshl_b32 s55,s55,4
s_lshl_b32 s56,s50,2
s_add_u32 s56,s56,s55
s_mul_i32 s31,s56,384
s_mul_i32 s57,s49,196608
s_add_u32 s30,s57,s31
s_mul_i32 s44,s50,330752
s_mov_b32 s58,0
s_add_u32 s59,s58,0
s_mul_i32 s60,s59,55296
s_lshl_b32 s59,s59,6
s_add_u32 s64,s30,s59
s_add_u32 s70,s31,s59
s_add_u32 s76,s44,s60
s_add_u32 s59,s58,1
s_mul_i32 s60,s59,55296
s_lshl_b32 s59,s59,6
s_add_u32 s65,s30,s59
s_add_u32 s71,s31,s59
s_add_u32 s77,s44,s60
s_add_u32 s59,s58,2
s_mul_i32 s60,s59,55296
s_lshl_b32 s59,s59,6
s_add_u32 s66,s30,s59
s_add_u32 s72,s31,s59
s_add_u32 s78,s44,s60
s_add_u32 s59,s58,3
s_mul_i32 s60,s59,55296
s_lshl_b32 s59,s59,6
s_add_u32 s67,s30,s59
s_add_u32 s73,s31,s59
s_add_u32 s79,s44,s60
s_add_u32 s59,s58,4
s_mul_i32 s60,s59,55296
s_lshl_b32 s59,s59,6
s_add_u32 s68,s30,s59
s_add_u32 s74,s31,s59
s_add_u32 s80,s44,s60
s_add_u32 s59,s58,5
s_cmp_eq_u32 s59,6
s_cselect_b32 s59,0,s59
s_mul_i32 s60,s59,55296
s_lshl_b32 s59,s59,6
s_add_u32 s69,s30,s59
s_add_u32 s75,s31,s59
s_add_u32 s81,s44,s60
s_waitcnt lgkmcnt(0)
s_mov_b32 s20,s52
s_and_b32 s21,s53,0xffff
s_mov_b32 s22,1327104
s_mov_b32 s23,0x20000
s_mov_b32 s36,s6
s_and_b32 s37,s7,0xffff
s_mov_b32 s38,663552
s_mov_b32 s39,0x20000
s_mov_b32 s60,s26
s_and_b32 s61,s27,0xffff
s_mov_b32 s62,0
s_mov_b32 s63,0x20000
s_mov_b32 s52,s26
s_mov_b32 s53,s27
s_cmp_lt_u32 s2,216
s_cselect_b32 s84,s50,0
s_cmp_eq_u32 s84,3
s_cbranch_scc0 L_noitem
s_mov_b32 s84,s2
s_mov_b32 s62,256
L_itemP:
s_and_b32 s85,s84,3
s_lshr_b32 s86,s84,2
s_mul_hi_u32 s87,s86,0x55555556
s_mul_i32 s88,s87,3
s_sub_u32 s86,s86,s88
s_mul_hi_u32 s88,s87,0x2aaaaaab
s_mul_i32 s89,s88,6
s_sub_u32 s87,s87,s89
s_mul_i32 s89,s86,221184
s_mul_i32 s90,s87,12288
s_add_u32 s89,s89,s90
s_mul_i32 s90,s85,3072
s_add_u32 s89,s89,s90
s_lshl_b32 s90,s88,7
s_add_u32 s89,s89,s90
s_add_u32 s90,s89,73728
s_add_u32 s91,s90,73728
v_lshlrev_b32 v149,1,v64
buffer_load_short_d16_hi v68,v149,s[36:39],s89 offen offset:0
buffer_load_short_d16_hi v69,v149,s[36:39],s89 offen offset:384
buffer_load_short_d16_hi v70,v149,s[36:39],s89 offen offset:768
buffer_load_short_d16_hi v71,v149,s[36:39],s89 offen offset:1152
buffer_load_short_d16_hi v72,v149,s[36:39],s89 offen offset:1536
buffer_load_short_d16_hi v73,v149,s[36:39],s89 offen offset:1920
buffer_load_short_d16_hi v74,v149,s[36:39],s89 offen offset:2304
buffer_load_short_d16_hi v75,v149,s[36:39],s89 offen offset:2688
buffer_load_short_d16_hi v76,v149,s[36:39],s90 offen offset:0
buffer_load_short_d16_hi v77,v149,s[36:39],s90 offen offset:384
buffer_load_short_d16_hi v78,v149,s[36:39],s90 offen offset:768
buffer_load_short_d16_hi v79,v149,s[36:39],s90 offen offset:1152
buffer_load_short_d16_hi v80,v149,s[36:39],s90 offen offset:1536
buffer_load_short_d16_hi v81,v149,s[36:39],s90 offen offset:1920
buffer_load_short_d16_hi v82,v149,s[36:39],s90 offen offset:2304
buffer_load_short_d16_hi v83,v149,s[36:39],s90 offen offset:2688
buffer_load_short_d16_hi v84,v149,s[36:39],s91 offen offset:0
buffer_load_short_d16_hi v85,v149,s[36:39],s91 offen offset:384
buffer_load_short_d16_hi v86,v149,s[36:39],s91 offen offset:768
buffer_load_short_d16_hi v87,v149,s[36:39],s91 offen offset:1152
buffer_load_short_d16_hi v88,v149,s[36:39],s91 offen offset:1536
buffer_load_short_d16_hi v89,v149,s[36:39],s91 offen offset:1920
buffer_load_short_d16_hi v90,v149,s[36:39],s91 offen offset:2304
buffer_load_short_d16_hi v91,v149,s[36:39],s91 offen offset:2688
v_lshrrev_b32 v150,4,v64
v_mul_u32_u24 v150,331776,v150
v_and_b32 v148,15,v64
v_lshl_add_u32 v150,v148,4,v150
s_mul_i32 s87,s87,55296
s_mul_i32 s88,s88,3072
s_add_u32 s87,s87,s88
s_lshl_b32 s86,s86,10
s_add_u32 s87,s87,s86
s_lshl_b32 s85,s85,8
s_add_u32 s87,s87,s85
s_mov_b32 s85,0xbe2aaaab
s_mov_b32 s86,0x3d2aaaab
s_mov_b32 s88,0x3e2aaaab
s_mov_b32 s92,0x3daaaaab
s_waitcnt vmcnt(0)
v_add_f32 v148,v68,v84
v_add_f32 v92,v148,v76
v_sub_f32 v100,v148,v76
v_mul_f32 v92,s85,v92
v_mul_f32 v100,s85,v100
v_mul_f32 v148,s86,v68
v_fmac_f32 v148,s88,v84
v_fma_f32 v108,s92,v76,v148
v_fma_f32 v116,-s92,v76,v148
v_add_f32 v148,v69,v85
v_add_f32 v93,v148,v77
v_sub_f32 v101,v148,v77
v_mul_f32 v93,s85,v93
v_mul_f32 v101,s85,v101
v_mul_f32 v148,s86,v69
v_fmac_f32 v148,s88,v85
v_fma_f32 v109,s92,v77,v148
v_fma_f32 v117,-s92,v77,v148
v_add_f32 v148,v70,v86
v_add_f32 v94,v148,v78
v_sub_f32 v102,v148,v78
v_mul_f32 v94,s85,v94
v_mul_f32 v102,s85,v102
v_mul_f32 v148,s86,v70
v_fmac_f32 v148,s88,v86
v_fma_f32 v110,s92,v78,v148
v_fma_f32 v118,-s92,v78,v148
v_add_f32 v148,v71,v87
v_add_f32 v95,v148,v79
v_sub_f32 v103,v148,v79
v_mul_f32 v95,s85,v95
v_mul_f32 v103,s85,v103
v_mul_f32 v148,s86,v71
v_fmac_f32 v148,s88,v87
v_fma_f32 v111,s92,v79,v148
v_fma_f32 v119,-s92,v79,v148
v_add_f32 v148,v72,v88
v_add_f32 v96,v148,v80
v_sub_f32 v104,v148,v80
v_mul_f32 v96,s85,v96
v_mul_f32 v104,s85,v104
v_mul_f32 v148,s86,v72
v_fmac_f32 v148,s88,v88
v_fma_f32 v112,s92,v80,v148
v_fma_f32 v120,-s92,v80,v148
v_add_f32 v148,v73,v89
v_add_f32 v97,v148,v81
v_sub_f32 v105,v148,v81
v_mul_f32 v97,s85,v97
v_mul_f32 v105,s85,v105
v_mul_f32 v148,s86,v73
v_fmac_f32 v148,s88,v89
v_fma_f32 v113,s92,v81,v148
v_fma_f32 v121,-s92,v81,v148
v_add_f32 v148,v74,v90
v_add_f32 v98,v148,v82
v_sub_f32 v106,v148,v82
v_mul_f32 v98,s85,v98
v_mul_f32 v106,s85,v106
v_mul_f32 v148,s86,v74
v_fmac_f32 v148,s88,v90
v_fma_f32 v114,s92,v82,v148
v_fma_f32 v122,-s92,v82,v148
v_add_f32 v148,v75,v91
v_add_f32 v99,v148,v83
v_sub_f32 v107,v148,v83
v_mul_f32 v99,s85,v99
v_mul_f32 v107,s85,v107
v_mul_f32 v148,s86,v75
v_fmac_f32 v148,s88,v91
v_fma_f32 v115,s92,v83,v148
v_fma_f32 v123,-s92,v83,v148
v_cvt_pk_bf16_f32 v124,v68,v69
v_cvt_pk_bf16_f32 v125,v70,v71
v_cvt_pk_bf16_f32 v126,v72,v73
v_cvt_pk_bf16_f32 v127,v74,v75
s_add_u32 s89,s87,0
buffer_store_dwordx4 v[124:127],v150,s[20:23],s89 offen sc1
v_cvt_pk_bf16_f32 v144,v84,v85
v_cvt_pk_bf16_f32 v145,v86,v87
v_cvt_pk_bf16_f32 v146,v88,v89
v_cvt_pk_bf16_f32 v147,v90,v91
s_add_u32 s89,s87,46080
buffer_store_dwordx4 v[144:147],v150,s[20:23],s89 offen sc1
v_cvt_pk_bf16_f32 v128,v92,v93
v_cvt_pk_bf16_f32 v129,v94,v95
v_cvt_pk_bf16_f32 v130,v96,v97
v_cvt_pk_bf16_f32 v131,v98,v99
s_add_u32 s89,s87,9216
buffer_store_dwordx4 v[128:131],v150,s[20:23],s89 offen sc1
v_cvt_pk_bf16_f32 v132,v100,v101
v_cvt_pk_bf16_f32 v133,v102,v103
v_cvt_pk_bf16_f32 v134,v104,v105
v_cvt_pk_bf16_f32 v135,v106,v107
s_add_u32 s89,s87,18432
buffer_store_dwordx4 v[132:135],v150,s[20:23],s89 offen sc1
v_cvt_pk_bf16_f32 v136,v108,v109
v_cvt_pk_bf16_f32 v137,v110,v111
v_cvt_pk_bf16_f32 v138,v112,v113
v_cvt_pk_bf16_f32 v139,v114,v115
s_add_u32 s89,s87,27648
buffer_store_dwordx4 v[136:139],v150,s[20:23],s89 offen sc1
v_cvt_pk_bf16_f32 v140,v116,v117
v_cvt_pk_bf16_f32 v141,v118,v119
v_cvt_pk_bf16_f32 v142,v120,v121
v_cvt_pk_bf16_f32 v143,v122,v123
s_add_u32 s89,s87,36864
buffer_store_dwordx4 v[140:143],v150,s[20:23],s89 offen sc1
L_noitem:
s_mov_b32 s8,s4
s_and_b32 s9,s5,0xffff
s_mov_b32 s10,100663296
s_mov_b32 s11,0x20000
s_sub_u32 s12,s4,384
s_subb_u32 s13,s9,0
s_cmp_eq_u32 s56,0
s_cselect_b32 s14,0,100663680
s_mov_b32 s15,0x20000
s_mov_b32 s16,s4
s_mov_b32 s17,s9
s_cmp_eq_u32 s56,508
s_cselect_b32 s18,0,100663296
s_mov_b32 s19,0x20000
v_bfe_u32 v232,v251,9,1
v_mul_u32_u24 v232,33,v232
v_add_u32 v232,s49,v232
v_add_u32 v232,-1,v232
v_mul_u32_u24 v233,196608,v232
v_cmp_gt_u32 vcc,512,v232
v_bfe_u32 v232,v251,3,6
v_add_u32 v233,v233,v232
v_bfrev_b32 v232,1
v_cndmask_b32 v246,v232,v233,vcc
s_add_u32 s28,s64,0
buffer_load_dwordx2 v[0:1],v245,s[12:15],s28 offen offset:0
buffer_load_dwordx2 v[10:11],v245,s[16:19],s28 offen offset:1536
buffer_load_dwordx2 v[2:3],v245,s[8:11],s28 offen offset:0
buffer_load_dwordx2 v[4:5],v245,s[8:11],s28 offen offset:384
buffer_load_dwordx2 v[6:7],v245,s[8:11],s28 offen offset:768
buffer_load_dwordx2 v[8:9],v245,s[8:11],s28 offen offset:1152
s_waitcnt vmcnt(6)
s_and_b32 s84,s2,3
s_lshl_b32 s84,s84,6
s_mov_b64 exec,1
v_mov_b32 v66,1
buffer_atomic_add v66,off,s[60:63],s84 sc1
s_mov_b64 exec,-1
s_add_u32 s28,s64,393216
buffer_load_dwordx2 v[12:13],v245,s[12:15],s28 offen offset:0
buffer_load_dwordx2 v[22:23],v245,s[16:19],s28 offen offset:1536
buffer_load_dwordx2 v[14:15],v245,s[8:11],s28 offen offset:0
buffer_load_dwordx2 v[16:17],v245,s[8:11],s28 offen offset:384
buffer_load_dwordx2 v[18:19],v245,s[8:11],s28 offen offset:768
buffer_load_dwordx2 v[20:21],v245,s[8:11],s28 offen offset:1152
s_add_u32 s28,s64,786432
buffer_load_dwordx2 v[24:25],v245,s[12:15],s28 offen offset:0
buffer_load_dwordx2 v[34:35],v245,s[16:19],s28 offen offset:1536
buffer_load_dwordx2 v[26:27],v245,s[8:11],s28 offen offset:0
buffer_load_dwordx2 v[28:29],v245,s[8:11],s28 offen offset:384
buffer_load_dwordx2 v[30:31],v245,s[8:11],s28 offen offset:768
buffer_load_dwordx2 v[32:33],v245,s[8:11],s28 offen offset:1152
s_add_u32 s28,s64,1179648
buffer_load_dwordx2 v[36:37],v245,s[12:15],s28 offen offset:0
buffer_load_dwordx2 v[46:47],v245,s[16:19],s28 offen offset:1536
buffer_load_dwordx2 v[38:39],v245,s[8:11],s28 offen offset:0
buffer_load_dwordx2 v[40:41],v245,s[8:11],s28 offen offset:384
buffer_load_dwordx2 v[42:43],v245,s[8:11],s28 offen offset:768
buffer_load_dwordx2 v[44:45],v245,s[8:11],s28 offen offset:1152
buffer_load_short_d16_hi v48,v246,s[12:15],s70 offen offset:0
buffer_load_short_d16_hi v49,v246,s[8:11],s70 offen offset:0
buffer_load_short_d16_hi v50,v246,s[8:11],s70 offen offset:384
buffer_load_short_d16_hi v51,v246,s[8:11],s70 offen offset:768
buffer_load_short_d16_hi v52,v246,s[8:11],s70 offen offset:1152
buffer_load_short_d16_hi v53,v246,s[16:19],s70 offen offset:1536
s_getpc_b64 s[58:59]
s_lshr_b32 s84,s2,3
s_lshl_b32 s84,s84,2
s_add_u32 s84,s84,s50
s_lshl_b32 s84,s84,10
v_and_b32 v65,7,v64
v_lshl_add_u32 v65,v65,7,s84
v_min_u32 v65,L_code_end-L_go-4096,v65
global_load_dword v67,v65,s[58:59]
s_and_b32 s25,s25,0xffff
s_mov_b32 s26,100663296
s_mov_b32 s27,0x20000
s_mov_b32 s40,0xc0a00000
s_mov_b32 s41,0x41000000
s_mov_b32 s42,0xffff0000
s_mov_b32 s43,0xbfa00000
s_mov_b32 s45,0x3e800000
s_mul_i32 s58,s55,384
s_add_u32 s58,s57,s58
s_lshr_b32 s59,s50,1
s_mul_i32 s32,s59,384
s_mul_i32 s33,s59,196608
s_add_u32 s32,s32,s58
s_add_u32 s33,s33,s58
s_lshl_b32 s59,s50,6
v_lshlrev_b32 v247,8,v61
v_and_b32 v63,1,v60
v_xor_b32 v63,1,v63
v_lshlrev_b32 v63,2,v63
v_xor_b32 v63,v63,v62
v_lshl_add_u32 v247,v63,3,v247
v_add_u32 v247,s59,v247
v_add_u32 v247,256,v247
v_lshrrev_b32 v60,5,v64
v_mul_u32_u24 v248,8448,v60
v_lshlrev_b32 v60,5,v60
v_bfe_u32 v61,v251,3,6
v_xor_b32 v61,v61,v60
v_add3_u32 v248,v248,v61,s59
v_bfe_u32 v60,v64,2,2
v_and_b32 v61,3,v64
v_lshrrev_b32 v62,4,v64
v_lshlrev_b32 v249,11,v60
v_lshl_add_u32 v249,v61,6,v249
v_and_b32 v63,1,v60
v_lshlrev_b32 v63,1,v63
v_xor_b32 v63,v63,v62
v_lshl_add_u32 v249,v63,4,v249
v_xor_b32 v250,32,v249
v_lshrrev_b32 v60,1,v62
v_lshl_add_u32 v60,s50,1,v60
v_and_b32 v61,7,v64
v_xor_b32 v60,v60,v61
v_and_b32 v63,15,v64
v_lshlrev_b32 v253,7,v63
v_lshl_add_u32 v253,v60,4,v253
v_and_b32 v63,1,v62
v_lshl_add_u32 v253,v63,3,v253
v_bfe_u32 v60,v251,7,4
v_lshrrev_b32 v62,2,v60
v_mul_u32_u24 v252,1572864,v62
v_and_b32 v62,3,v60
v_mul_u32_u24 v62,1536,v62
v_and_b32 v60,7,v60
v_xor_b32 v60,v60,v61
v_lshl_add_u32 v60,v60,4,v62
v_add_u32 v252,v252,v60
s_waitcnt vmcnt(28)
v_lshlrev_b32 v234,16,v4
v_lshlrev_b32 v232,16,v0
v_lshlrev_b32 v233,16,v2
v_lshlrev_b32 v237,16,v10
s_waitcnt vmcnt(26)
v_lshlrev_b32 v236,16,v8
v_lshlrev_b32 v235,16,v6
v_fmac_f32 v232,s43,v234
v_fmac_f32 v237,4.0,v233
v_fma_f32 v238,-4.0,v234,v236
v_fmac_f32 v232,s45,v236
v_fmac_f32 v237,s40,v235
v_sub_f32 v236,v236,v234
v_fma_f32 v234,-4.0,v233,v235
v_sub_f32 v235,v235,v233
v_add_f32 v233,v238,v234
v_sub_f32 v238,v238,v234
v_fma_f32 v234,2.0,v235,v236
v_fmac_f32 v236,-2.0,v235
v_and_b32 v4,s42,v4
v_and_b32 v0,s42,v0
v_and_b32 v2,s42,v2
v_and_b32 v10,s42,v10
v_and_b32 v8,s42,v8
v_and_b32 v6,s42,v6
v_fmac_f32 v0,s43,v4
v_fmac_f32 v10,4.0,v2
v_fma_f32 v235,-4.0,v4,v8
v_fmac_f32 v0,s45,v8
v_fmac_f32 v10,s40,v6
v_sub_f32 v8,v8,v4
v_fma_f32 v4,-4.0,v2,v6
v_sub_f32 v6,v6,v2
v_add_f32 v2,v235,v4
v_sub_f32 v235,v235,v4
v_fma_f32 v4,2.0,v6,v8
v_fmac_f32 v8,-2.0,v6
v_cvt_pk_bf16_f32 v0,v232,v0
v_cvt_pk_bf16_f32 v10,v237,v10
v_cvt_pk_bf16_f32 v2,v233,v2
v_cvt_pk_bf16_f32 v6,v234,v4
v_cvt_pk_bf16_f32 v4,v238,v235
v_cvt_pk_bf16_f32 v8,v236,v8
v_lshlrev_b32 v234,16,v5
v_lshlrev_b32 v232,16,v1
v_lshlrev_b32 v233,16,v3
v_lshlrev_b32 v237,16,v11
v_lshlrev_b32 v236,16,v9
v_lshlrev_b32 v235,16,v7
v_fmac_f32 v232,s43,v234
v_fmac_f32 v237,4.0,v233
v_fma_f32 v238,-4.0,v234,v236
v_fmac_f32 v232,s45,v236
v_fmac_f32 v237,s40,v235
v_sub_f32 v236,v236,v234
v_fma_f32 v234,-4.0,v233,v235
v_sub_f32 v235,v235,v233
v_add_f32 v233,v238,v234
v_sub_f32 v238,v238,v234
v_fma_f32 v234,2.0,v235,v236
v_fmac_f32 v236,-2.0,v235
v_and_b32 v5,s42,v5
v_and_b32 v1,s42,v1
v_and_b32 v3,s42,v3
v_and_b32 v11,s42,v11
v_and_b32 v9,s42,v9
v_and_b32 v7,s42,v7
v_fmac_f32 v1,s43,v5
v_fmac_f32 v11,4.0,v3
v_fma_f32 v235,-4.0,v5,v9
v_fmac_f32 v1,s45,v9
v_fmac_f32 v11,s40,v7
v_sub_f32 v9,v9,v5
v_fma_f32 v5,-4.0,v3,v7
v_sub_f32 v7,v7,v3
v_add_f32 v3,v235,v5
v_sub_f32 v235,v235,v5
v_fma_f32 v5,2.0,v7,v9
v_fmac_f32 v9,-2.0,v7
v_cvt_pk_bf16_f32 v1,v232,v1
v_cvt_pk_bf16_f32 v11,v237,v11
v_cvt_pk_bf16_f32 v3,v233,v3
v_cvt_pk_bf16_f32 v7,v234,v5
v_cvt_pk_bf16_f32 v5,v238,v235
v_cvt_pk_bf16_f32 v9,v236,v9
ds_write2st64_b64 v247,v[0:1],v[10:11] offset0:0 offset1:17
ds_write2st64_b64 v247,v[2:3],v[4:5] offset0:34 offset1:51
ds_write2st64_b64 v247,v[6:7],v[8:9] offset0:68 offset1:85
s_waitcnt vmcnt(21)
v_lshlrev_b32 v234,16,v16
v_lshlrev_b32 v232,16,v12
v_lshlrev_b32 v233,16,v14
v_lshlrev_b32 v237,16,v22
s_waitcnt vmcnt(19)
v_lshlrev_b32 v236,16,v20
v_lshlrev_b32 v235,16,v18
v_fmac_f32 v232,s43,v234
v_fmac_f32 v237,4.0,v233
v_fma_f32 v238,-4.0,v234,v236
v_fmac_f32 v232,s45,v236
v_fmac_f32 v237,s40,v235
v_sub_f32 v236,v236,v234
v_fma_f32 v234,-4.0,v233,v235
v_sub_f32 v235,v235,v233
v_add_f32 v233,v238,v234
v_sub_f32 v238,v238,v234
v_fma_f32 v234,2.0,v235,v236
v_fmac_f32 v236,-2.0,v235
v_and_b32 v16,s42,v16
v_and_b32 v12,s42,v12
v_and_b32 v14,s42,v14
v_and_b32 v22,s42,v22
v_and_b32 v20,s42,v20
v_and_b32 v18,s42,v18
v_fmac_f32 v12,s43,v16
v_fmac_f32 v22,4.0,v14
v_fma_f32 v235,-4.0,v16,v20
v_fmac_f32 v12,s45,v20
v_fmac_f32 v22,s40,v18
v_sub_f32 v20,v20,v16
v_fma_f32 v16,-4.0,v14,v18
v_sub_f32 v18,v18,v14
v_add_f32 v14,v235,v16
v_sub_f32 v235,v235,v16
v_fma_f32 v16,2.0,v18,v20
v_fmac_f32 v20,-2.0,v18
v_cvt_pk_bf16_f32 v12,v232,v12
v_cvt_pk_bf16_f32 v22,v237,v22
v_cvt_pk_bf16_f32 v14,v233,v14
v_cvt_pk_bf16_f32 v18,v234,v16
v_cvt_pk_bf16_f32 v16,v238,v235
v_cvt_pk_bf16_f32 v20,v236,v20
v_lshlrev_b32 v234,16,v17
v_lshlrev_b32 v232,16,v13
v_lshlrev_b32 v233,16,v15
v_lshlrev_b32 v237,16,v23
v_lshlrev_b32 v236,16,v21
v_lshlrev_b32 v235,16,v19
v_fmac_f32 v232,s43,v234
v_fmac_f32 v237,4.0,v233
v_fma_f32 v238,-4.0,v234,v236
v_fmac_f32 v232,s45,v236
v_fmac_f32 v237,s40,v235
v_sub_f32 v236,v236,v234
v_fma_f32 v234,-4.0,v233,v235
v_sub_f32 v235,v235,v233
v_add_f32 v233,v238,v234
v_sub_f32 v238,v238,v234
v_fma_f32 v234,2.0,v235,v236
v_fmac_f32 v236,-2.0,v235
v_and_b32 v17,s42,v17
v_and_b32 v13,s42,v13
v_and_b32 v15,s42,v15
v_and_b32 v23,s42,v23
v_and_b32 v21,s42,v21
v_and_b32 v19,s42,v19
v_fmac_f32 v13,s43,v17
v_fmac_f32 v23,4.0,v15
v_fma_f32 v235,-4.0,v17,v21
v_fmac_f32 v13,s45,v21
v_fmac_f32 v23,s40,v19
v_sub_f32 v21,v21,v17
v_fma_f32 v17,-4.0,v15,v19
v_sub_f32 v19,v19,v15
v_add_f32 v15,v235,v17
v_sub_f32 v235,v235,v17
v_fma_f32 v17,2.0,v19,v21
v_fmac_f32 v21,-2.0,v19
v_cvt_pk_bf16_f32 v13,v232,v13
v_cvt_pk_bf16_f32 v23,v237,v23
v_cvt_pk_bf16_f32 v15,v233,v15
v_cvt_pk_bf16_f32 v19,v234,v17
v_cvt_pk_bf16_f32 v17,v238,v235
v_cvt_pk_bf16_f32 v21,v236,v21
ds_write2st64_b64 v247,v[12:13],v[22:23] offset0:1 offset1:18
ds_write2st64_b64 v247,v[14:15],v[16:17] offset0:35 offset1:52
ds_write2st64_b64 v247,v[18:19],v[20:21] offset0:69 offset1:86
v_and_b32 v65,3,v64
v_lshlrev_b32 v65,6,v65
s_mov_b32 s84,0
L_poll:
global_load_dword v66,v65,s[52:53] sc1
s_add_u32 s84,s84,1
s_waitcnt vmcnt(0)
v_cmp_ne_u32 vcc,54,v66
s_cmp_gt_u32 s84,0x4000
s_cbranch_scc1 L_fallback
s_cbranch_vccnz L_poll
L_uready:
s_add_u32 s46,s76,9216
buffer_load_dwordx4 a[224:227],v251,s[20:23],s46 offen offset:0 sc1
s_add_u32 s47,s76,12288
buffer_load_dwordx4 a[228:231],v251,s[20:23],s47 offen offset:0 sc1
s_add_u32 s48,s76,15360
buffer_load_dwordx4 a[232:235],v251,s[20:23],s48 offen offset:0 sc1
buffer_load_dwordx4 a[236:239],v251,s[20:23],s46 offen offset:1024 sc1
buffer_load_dwordx4 a[240:243],v251,s[20:23],s47 offen offset:1024 sc1
buffer_load_dwordx4 a[244:247],v251,s[20:23],s48 offen offset:1024 sc1
buffer_load_dwordx4 a[248:251],v251,s[20:23],s46 offen offset:2048 sc1
buffer_load_dwordx4 a[252:255],v251,s[20:23],s47 offen offset:2048 sc1
buffer_load_dwordx4 v[216:219],v251,s[20:23],s48 offen offset:2048 sc1
s_add_u32 s46,s76,18432
buffer_load_dwordx4 v[220:223],v251,s[20:23],s46 offen offset:0 sc1
s_add_u32 s47,s76,21504
buffer_load_dwordx4 v[224:227],v251,s[20:23],s47 offen offset:0 sc1
s_add_u32 s48,s76,24576
buffer_load_dwordx4 v[228:231],v251,s[20:23],s48 offen offset:0 sc1
s_add_u32 s28,s65,0
buffer_load_dwordx2 v[192:193],v245,s[12:15],s28 offen offset:0
buffer_load_dwordx2 v[202:203],v245,s[16:19],s28 offen offset:1536
buffer_load_dwordx2 v[194:195],v245,s[8:11],s28 offen offset:0
buffer_load_dwordx2 v[196:197],v245,s[8:11],s28 offen offset:384
buffer_load_dwordx2 v[198:199],v245,s[8:11],s28 offen offset:768
buffer_load_dwordx2 v[200:201],v245,s[8:11],s28 offen offset:1152
s_add_u32 s28,s65,393216
buffer_load_dwordx2 v[204:205],v245,s[12:15],s28 offen offset:0
buffer_load_dwordx2 v[214:215],v245,s[16:19],s28 offen offset:1536
buffer_load_dwordx2 v[206:207],v245,s[8:11],s28 offen offset:0
buffer_load_dwordx2 v[208:209],v245,s[8:11],s28 offen offset:384
buffer_load_dwordx2 v[210:211],v245,s[8:11],s28 offen offset:768
buffer_load_dwordx2 v[212:213],v245,s[8:11],s28 offen offset:1152
buffer_load_short_d16_hi v239,v246,s[12:15],s71 offen offset:0
buffer_load_short_d16_hi v240,v246,s[8:11],s71 offen offset:0
buffer_load_short_d16_hi v241,v246,s[8:11],s71 offen offset:384
buffer_load_short_d16_hi v242,v246,s[8:11],s71 offen offset:768
buffer_load_short_d16_hi v243,v246,s[8:11],s71 offen offset:1152
buffer_load_short_d16_hi v244,v246,s[16:19],s71 offen offset:1536
v_lshlrev_b32 v234,16,v28
v_lshlrev_b32 v232,16,v24
v_lshlrev_b32 v233,16,v26
v_lshlrev_b32 v237,16,v34
v_lshlrev_b32 v236,16,v32
v_lshlrev_b32 v235,16,v30
v_fmac_f32 v232,s43,v234
v_fmac_f32 v237,4.0,v233
v_fma_f32 v238,-4.0,v234,v236
v_fmac_f32 v232,s45,v236
v_fmac_f32 v237,s40,v235
v_sub_f32 v236,v236,v234
v_fma_f32 v234,-4.0,v233,v235
v_sub_f32 v235,v235,v233
v_add_f32 v233,v238,v234
v_sub_f32 v238,v238,v234
v_fma_f32 v234,2.0,v235,v236
v_fmac_f32 v236,-2.0,v235
v_and_b32 v28,s42,v28
v_and_b32 v24,s42,v24
v_and_b32 v26,s42,v26
v_and_b32 v34,s42,v34
v_and_b32 v32,s42,v32
v_and_b32 v30,s42,v30
v_fmac_f32 v24,s43,v28
v_fmac_f32 v34,4.0,v26
v_fma_f32 v235,-4.0,v28,v32
v_fmac_f32 v24,s45,v32
v_fmac_f32 v34,s40,v30
v_sub_f32 v32,v32,v28
v_fma_f32 v28,-4.0,v26,v30
v_sub_f32 v30,v30,v26
v_add_f32 v26,v235,v28
v_sub_f32 v235,v235,v28
v_fma_f32 v28,2.0,v30,v32
v_fmac_f32 v32,-2.0,v30
v_cvt_pk_bf16_f32 v24,v232,v24
v_cvt_pk_bf16_f32 v34,v237,v34
v_cvt_pk_bf16_f32 v26,v233,v26
v_cvt_pk_bf16_f32 v30,v234,v28
v_cvt_pk_bf16_f32 v28,v238,v235
v_cvt_pk_bf16_f32 v32,v236,v32
v_lshlrev_b32 v234,16,v29
v_lshlrev_b32 v232,16,v25
v_lshlrev_b32 v233,16,v27
v_lshlrev_b32 v237,16,v35
v_lshlrev_b32 v236,16,v33
v_lshlrev_b32 v235,16,v31
v_fmac_f32 v232,s43,v234
v_fmac_f32 v237,4.0,v233
v_fma_f32 v238,-4.0,v234,v236
v_fmac_f32 v232,s45,v236
v_fmac_f32 v237,s40,v235
v_sub_f32 v236,v236,v234
v_fma_f32 v234,-4.0,v233,v235
v_sub_f32 v235,v235,v233
v_add_f32 v233,v238,v234
v_sub_f32 v238,v238,v234
v_fma_f32 v234,2.0,v235,v236
v_fmac_f32 v236,-2.0,v235
v_and_b32 v29,s42,v29
v_and_b32 v25,s42,v25
v_and_b32 v27,s42,v27
v_and_b32 v35,s42,v35
v_and_b32 v33,s42,v33
v_and_b32 v31,s42,v31
v_fmac_f32 v25,s43,v29
v_fmac_f32 v35,4.0,v27
v_fma_f32 v235,-4.0,v29,v33
v_fmac_f32 v25,s45,v33
v_fmac_f32 v35,s40,v31
v_sub_f32 v33,v33,v29
v_fma_f32 v29,-4.0,v27,v31
v_sub_f32 v31,v31,v27
v_add_f32 v27,v235,v29
v_sub_f32 v235,v235,v29
v_fma_f32 v29,2.0,v31,v33
v_fmac_f32 v33,-2.0,v31
v_cvt_pk_bf16_f32 v25,v232,v25
v_cvt_pk_bf16_f32 v35,v237,v35
v_cvt_pk_bf16_f32 v27,v233,v27
v_cvt_pk_bf16_f32 v31,v234,v29
v_cvt_pk_bf16_f32 v29,v238,v235
v_cvt_pk_bf16_f32 v33,v236,v33
ds_write2st64_b64 v247,v[24:25],v[34:35] offset0:2 offset1:19
ds_write2st64_b64 v247,v[26:27],v[28:29] offset0:36 offset1:53
ds_write2st64_b64 v247,v[30:31],v[32:33] offset0:70 offset1:87
v_lshlrev_b32 v234,16,v40
v_lshlrev_b32 v232,16,v36
v_lshlrev_b32 v233,16,v38
v_lshlrev_b32 v237,16,v46
v_lshlrev_b32 v236,16,v44
v_lshlrev_b32 v235,16,v42
v_fmac_f32 v232,s43,v234
v_fmac_f32 v237,4.0,v233
v_fma_f32 v238,-4.0,v234,v236
v_fmac_f32 v232,s45,v236
v_fmac_f32 v237,s40,v235
v_sub_f32 v236,v236,v234
v_fma_f32 v234,-4.0,v233,v235
v_sub_f32 v235,v235,v233
v_add_f32 v233,v238,v234
v_sub_f32 v238,v238,v234
v_fma_f32 v234,2.0,v235,v236
v_fmac_f32 v236,-2.0,v235
v_and_b32 v40,s42,v40
v_and_b32 v36,s42,v36
v_and_b32 v38,s42,v38
v_and_b32 v46,s42,v46
v_and_b32 v44,s42,v44
v_and_b32 v42,s42,v42
v_fmac_f32 v36,s43,v40
v_fmac_f32 v46,4.0,v38
v_fma_f32 v235,-4.0,v40,v44
v_fmac_f32 v36,s45,v44
v_fmac_f32 v46,s40,v42
v_sub_f32 v44,v44,v40
v_fma_f32 v40,-4.0,v38,v42
v_sub_f32 v42,v42,v38
v_add_f32 v38,v235,v40
v_sub_f32 v235,v235,v40
v_fma_f32 v40,2.0,v42,v44
v_fmac_f32 v44,-2.0,v42
v_cvt_pk_bf16_f32 v36,v232,v36
v_cvt_pk_bf16_f32 v46,v237,v46
v_cvt_pk_bf16_f32 v38,v233,v38
v_cvt_pk_bf16_f32 v42,v234,v40
v_cvt_pk_bf16_f32 v40,v238,v235
v_cvt_pk_bf16_f32 v44,v236,v44
v_lshlrev_b32 v234,16,v41
v_lshlrev_b32 v232,16,v37
v_lshlrev_b32 v233,16,v39
v_lshlrev_b32 v237,16,v47
v_lshlrev_b32 v236,16,v45
v_lshlrev_b32 v235,16,v43
v_fmac_f32 v232,s43,v234
v_fmac_f32 v237,4.0,v233
v_fma_f32 v238,-4.0,v234,v236
v_fmac_f32 v232,s45,v236
v_fmac_f32 v237,s40,v235
v_sub_f32 v236,v236,v234
v_fma_f32 v234,-4.0,v233,v235
v_sub_f32 v235,v235,v233
v_add_f32 v233,v238,v234
v_sub_f32 v238,v238,v234
v_fma_f32 v234,2.0,v235,v236
v_fmac_f32 v236,-2.0,v235
v_and_b32 v41,s42,v41
v_and_b32 v37,s42,v37
v_and_b32 v39,s42,v39
v_and_b32 v47,s42,v47
v_and_b32 v45,s42,v45
v_and_b32 v43,s42,v43
v_fmac_f32 v37,s43,v41
v_fmac_f32 v47,4.0,v39
v_fma_f32 v235,-4.0,v41,v45
v_fmac_f32 v37,s45,v45
v_fmac_f32 v47,s40,v43
v_sub_f32 v45,v45,v41
v_fma_f32 v41,-4.0,v39,v43
v_sub_f32 v43,v43,v39
v_add_f32 v39,v235,v41
v_sub_f32 v235,v235,v41
v_fma_f32 v41,2.0,v43,v45
v_fmac_f32 v45,-2.0,v43
v_cvt_pk_bf16_f32 v37,v232,v37
v_cvt_pk_bf16_f32 v47,v237,v47
v_cvt_pk_bf16_f32 v39,v233,v39
v_cvt_pk_bf16_f32 v43,v234,v41
v_cvt_pk_bf16_f32 v41,v238,v235
v_cvt_pk_bf16_f32 v45,v236,v45
ds_write2st64_b64 v247,v[36:37],v[46:47] offset0:3 offset1:20
ds_write2st64_b64 v247,v[38:39],v[40:41] offset0:37 offset1:54
ds_write2st64_b64 v247,v[42:43],v[44:45] offset0:71 offset1:88
v_fmac_f32 v48,s43,v50
v_fmac_f32 v53,4.0,v49
v_fma_f32 v232,-4.0,v50,v52
v_fmac_f32 v48,s45,v52
v_fmac_f32 v53,s40,v51
v_sub_f32 v52,v52,v50
v_fma_f32 v50,-4.0,v49,v51
v_sub_f32 v51,v51,v49
v_add_f32 v49,v232,v50
v_sub_f32 v232,v232,v50
v_fma_f32 v50,2.0,v51,v52
v_fmac_f32 v52,-2.0,v51
v_cvt_pk_bf16_f32 v233,v48,v53
v_cvt_pk_bf16_f32 v234,v49,v232
v_cvt_pk_bf16_f32 v235,v50,v52
ds_write_b16 v248,v233 offset:0
ds_write_b16_d16_hi v248,v233 offset:8704
ds_write_b16 v248,v234 offset:17408
ds_write_b16_d16_hi v248,v234 offset:26112
ds_write_b16 v248,v235 offset:34816
ds_write_b16_d16_hi v248,v235 offset:43520
s_waitcnt lgkmcnt(0)
s_barrier
ds_read_b128 a[192:195],v249 offset:17408
ds_read_b128 a[196:199],v250 offset:17664
ds_read_b128 a[200:203],v250 offset:17920
ds_read_b128 a[204:207],v250 offset:18176
ds_read_b128 a[208:211],v250 offset:18432
ds_read_b128 a[212:215],v250 offset:18688
ds_read_b128 a[216:219],v250 offset:18944
ds_read_b128 a[220:223],v250 offset:19200
s_waitcnt vmcnt(29) lgkmcnt(7)
M a[0:3],a[224:227],a[192:195],0
s_waitcnt vmcnt(14) lgkmcnt(6)
v_lshlrev_b32 v234,16,v196
v_lshlrev_b32 v232,16,v192
M a[4:7],a[224:227],a[196:199],0
s_waitcnt lgkmcnt(5)
v_lshlrev_b32 v233,16,v194
v_lshlrev_b32 v237,16,v202
M a[8:11],a[224:227],a[200:203],0
s_waitcnt vmcnt(12) lgkmcnt(4)
v_lshlrev_b32 v236,16,v200
v_lshlrev_b32 v235,16,v198
M a[12:15],a[224:227],a[204:207],0
s_waitcnt lgkmcnt(3)
v_fmac_f32 v232,s43,v234
v_fmac_f32 v237,4.0,v233
M a[16:19],a[224:227],a[208:211],0
s_waitcnt lgkmcnt(2)
v_fma_f32 v238,-4.0,v234,v236
v_fmac_f32 v232,s45,v236
M a[20:23],a[224:227],a[212:215],0
s_waitcnt lgkmcnt(1)
v_fmac_f32 v237,s40,v235
v_sub_f32 v236,v236,v234
M a[24:27],a[224:227],a[216:219],0
s_waitcnt lgkmcnt(0)
v_fma_f32 v234,-4.0,v233,v235
v_sub_f32 v235,v235,v233
v_add_f32 v233,v238,v234
M a[28:31],a[224:227],a[220:223],0
buffer_load_dwordx4 a[224:227],v251,s[20:23],s46 offen offset:1024 sc1
M a[32:35],a[228:231],a[192:195],0
v_sub_f32 v238,v238,v234
v_fma_f32 v234,2.0,v235,v236
M a[36:39],a[228:231],a[196:199],0
v_fmac_f32 v236,-2.0,v235
v_and_b32 v196,s42,v196
M a[40:43],a[228:231],a[200:203],0
v_and_b32 v192,s42,v192
v_and_b32 v194,s42,v194
M a[44:47],a[228:231],a[204:207],0
v_and_b32 v202,s42,v202
v_and_b32 v200,s42,v200
M a[48:51],a[228:231],a[208:211],0
v_and_b32 v198,s42,v198
v_fmac_f32 v192,s43,v196
M a[52:55],a[228:231],a[212:215],0
v_fmac_f32 v202,4.0,v194
v_fma_f32 v235,-4.0,v196,v200
v_fmac_f32 v192,s45,v200
M a[56:59],a[228:231],a[216:219],0
v_fmac_f32 v202,s40,v198
v_sub_f32 v200,v200,v196
M a[60:63],a[228:231],a[220:223],0
buffer_load_dwordx4 a[228:231],v251,s[20:23],s47 offen offset:1024 sc1
M a[64:67],a[232:235],a[192:195],0
ds_read_b128 a[192:195],v250 offset:19456
v_fma_f32 v196,-4.0,v194,v198
M a[68:71],a[232:235],a[196:199],0
v_sub_f32 v198,v198,v194
v_add_f32 v194,v235,v196
M a[72:75],a[232:235],a[200:203],0
v_sub_f32 v235,v235,v196
v_fma_f32 v196,2.0,v198,v200
M a[76:79],a[232:235],a[204:207],0
v_fmac_f32 v200,-2.0,v198
v_cvt_pk_bf16_f32 v192,v232,v192
v_cvt_pk_bf16_f32 v202,v237,v202
M a[80:83],a[232:235],a[208:211],0
v_cvt_pk_bf16_f32 v194,v233,v194
v_cvt_pk_bf16_f32 v198,v234,v196
M a[84:87],a[232:235],a[212:215],0
v_cvt_pk_bf16_f32 v196,v238,v235
v_cvt_pk_bf16_f32 v200,v236,v200
M a[88:91],a[232:235],a[216:219],0
v_lshlrev_b32 v234,16,v197
v_lshlrev_b32 v232,16,v193
M a[92:95],a[232:235],a[220:223],0
buffer_load_dwordx4 a[232:235],v251,s[20:23],s48 offen offset:1024 sc1
M a[0:3],a[236:239],a[196:199],a[0:3]
v_lshlrev_b32 v233,16,v195
v_lshlrev_b32 v237,16,v203
M a[4:7],a[236:239],a[200:203],a[4:7]
v_lshlrev_b32 v236,16,v201
v_lshlrev_b32 v235,16,v199
M a[8:11],a[236:239],a[204:207],a[8:11]
v_fmac_f32 v232,s43,v234
v_fmac_f32 v237,4.0,v233
v_fma_f32 v238,-4.0,v234,v236
M a[12:15],a[236:239],a[208:211],a[12:15]
v_fmac_f32 v232,s45,v236
v_fmac_f32 v237,s40,v235
M a[16:19],a[236:239],a[212:215],a[16:19]
v_sub_f32 v236,v236,v234
v_fma_f32 v234,-4.0,v233,v235
M a[20:23],a[236:239],a[216:219],a[20:23]
v_sub_f32 v235,v235,v233
v_add_f32 v233,v238,v234
M a[24:27],a[236:239],a[220:223],a[24:27]
s_waitcnt lgkmcnt(0)
v_sub_f32 v238,v238,v234
v_fma_f32 v234,2.0,v235,v236
M a[28:31],a[236:239],a[192:195],a[28:31]
buffer_load_dwordx4 a[236:239],v251,s[20:23],s46 offen offset:2048 sc1
M a[32:35],a[240:243],a[196:199],a[32:35]
v_fmac_f32 v236,-2.0,v235
v_and_b32 v197,s42,v197
v_and_b32 v193,s42,v193
M a[36:39],a[240:243],a[200:203],a[36:39]
v_and_b32 v195,s42,v195
v_and_b32 v203,s42,v203
M a[40:43],a[240:243],a[204:207],a[40:43]
v_and_b32 v201,s42,v201
v_and_b32 v199,s42,v199
M a[44:47],a[240:243],a[208:211],a[44:47]
v_fmac_f32 v193,s43,v197
v_fmac_f32 v203,4.0,v195
M a[48:51],a[240:243],a[212:215],a[48:51]
v_fma_f32 v235,-4.0,v197,v201
v_fmac_f32 v193,s45,v201
M a[52:55],a[240:243],a[216:219],a[52:55]
v_fmac_f32 v203,s40,v199
v_sub_f32 v201,v201,v197
M a[56:59],a[240:243],a[220:223],a[56:59]
v_fma_f32 v197,-4.0,v195,v199
v_sub_f32 v199,v199,v195
M a[60:63],a[240:243],a[192:195],a[60:63]
buffer_load_dwordx4 a[240:243],v251,s[20:23],s47 offen offset:2048 sc1
v_add_f32 v195,v235,v197
M a[64:67],a[244:247],a[196:199],a[64:67]
ds_read_b128 a[196:199],v249 offset:19712
v_sub_f32 v235,v235,v197
M a[68:71],a[244:247],a[200:203],a[68:71]
v_fma_f32 v197,2.0,v199,v201
v_fmac_f32 v201,-2.0,v199
M a[72:75],a[244:247],a[204:207],a[72:75]
v_cvt_pk_bf16_f32 v193,v232,v193
v_cvt_pk_bf16_f32 v203,v237,v203
M a[76:79],a[244:247],a[208:211],a[76:79]
v_cvt_pk_bf16_f32 v195,v233,v195
v_cvt_pk_bf16_f32 v199,v234,v197
M a[80:83],a[244:247],a[212:215],a[80:83]
v_cvt_pk_bf16_f32 v197,v238,v235
v_cvt_pk_bf16_f32 v201,v236,v201
M a[84:87],a[244:247],a[216:219],a[84:87]
ds_write2st64_b64 v247,v[192:193],v[202:203] offset0:170 offset1:187
M a[88:91],a[244:247],a[220:223],a[88:91]
s_add_u32 s28,s65,786432
buffer_load_dwordx2 v[192:193],v245,s[12:15],s28 offen offset:0
M a[92:95],a[244:247],a[192:195],a[92:95]
buffer_load_dwordx2 v[202:203],v245,s[16:19],s28 offen offset:1536
M a[0:3],a[248:251],a[200:203],a[0:3]
buffer_load_dwordx4 a[244:247],v251,s[20:23],s48 offen offset:2048 sc1
M a[4:7],a[248:251],a[204:207],a[4:7]
s_add_u32 s46,s76,27648
ds_write2st64_b64 v247,v[194:195],v[196:197] offset0:102 offset1:119
M a[8:11],a[248:251],a[208:211],a[8:11]
buffer_load_dwordx2 v[194:195],v245,s[8:11],s28 offen offset:0
M a[12:15],a[248:251],a[212:215],a[12:15]
buffer_load_dwordx2 v[196:197],v245,s[8:11],s28 offen offset:384
M a[16:19],a[248:251],a[216:219],a[16:19]
ds_write2st64_b64 v247,v[198:199],v[200:201] offset0:136 offset1:153
M a[20:23],a[248:251],a[220:223],a[20:23]
buffer_load_dwordx2 v[198:199],v245,s[8:11],s28 offen offset:768
M a[24:27],a[248:251],a[192:195],a[24:27]
s_waitcnt lgkmcnt(3)
buffer_load_dwordx2 v[200:201],v245,s[8:11],s28 offen offset:1152
M a[28:31],a[248:251],a[196:199],a[28:31]
buffer_load_dwordx4 a[248:251],v251,s[20:23],s46 offen offset:0 sc1
M a[32:35],a[252:255],a[200:203],a[32:35]
s_waitcnt vmcnt(21)
v_lshlrev_b32 v234,16,v208
v_lshlrev_b32 v232,16,v204
M a[36:39],a[252:255],a[204:207],a[36:39]
s_add_u32 s47,s76,30720
v_lshlrev_b32 v233,16,v206
v_lshlrev_b32 v237,16,v214
M a[40:43],a[252:255],a[208:211],a[40:43]
s_waitcnt vmcnt(19)
v_lshlrev_b32 v236,16,v212
v_lshlrev_b32 v235,16,v210
M a[44:47],a[252:255],a[212:215],a[44:47]
v_fmac_f32 v232,s43,v234
v_fmac_f32 v237,4.0,v233
M a[48:51],a[252:255],a[216:219],a[48:51]
v_fma_f32 v238,-4.0,v234,v236
v_fmac_f32 v232,s45,v236
M a[52:55],a[252:255],a[220:223],a[52:55]
v_fmac_f32 v237,s40,v235
v_sub_f32 v236,v236,v234
M a[56:59],a[252:255],a[192:195],a[56:59]
v_fma_f32 v234,-4.0,v233,v235
v_sub_f32 v235,v235,v233
M a[60:63],a[252:255],a[196:199],a[60:63]
buffer_load_dwordx4 a[252:255],v251,s[20:23],s47 offen offset:0 sc1
M a[64:67],v[216:219],a[200:203],a[64:67]
ds_read_b128 a[200:203],v249 offset:26112
v_add_f32 v233,v238,v234
M a[68:71],v[216:219],a[204:207],a[68:71]
s_add_u32 s48,s76,33792
ds_read_b128 a[204:207],v250 offset:26368
v_sub_f32 v238,v238,v234
M a[72:75],v[216:219],a[208:211],a[72:75]
ds_read_b128 a[208:211],v250 offset:26624
v_fma_f32 v234,2.0,v235,v236
M a[76:79],v[216:219],a[212:215],a[76:79]
ds_read_b128 a[212:215],v250 offset:26880
v_fmac_f32 v236,-2.0,v235
M a[80:83],v[216:219],a[216:219],a[80:83]
ds_read_b128 a[216:219],v250 offset:27136
v_and_b32 v208,s42,v208
M a[84:87],v[216:219],a[220:223],a[84:87]
ds_read_b128 a[220:223],v250 offset:27392
v_and_b32 v204,s42,v204
M a[88:91],v[216:219],a[192:195],a[88:91]
ds_read_b128 a[192:195],v250 offset:27648
v_and_b32 v206,s42,v206
M a[92:95],v[216:219],a[196:199],a[92:95]
s_waitcnt lgkmcnt(6)
buffer_load_dwordx4 v[216:219],v251,s[20:23],s48 offen offset:0 sc1
M a[96:99],v[220:223],a[200:203],0
s_waitcnt lgkmcnt(5)
ds_read_b128 a[196:199],v250 offset:27904
v_and_b32 v214,s42,v214
M a[100:103],v[220:223],a[204:207],0
s_waitcnt lgkmcnt(5)
v_and_b32 v212,s42,v212
v_and_b32 v210,s42,v210
M a[104:107],v[220:223],a[208:211],0
s_waitcnt lgkmcnt(4)
v_fmac_f32 v204,s43,v208
v_fmac_f32 v214,4.0,v206
M a[108:111],v[220:223],a[212:215],0
s_waitcnt lgkmcnt(3)
v_fma_f32 v235,-4.0,v208,v212
v_fmac_f32 v204,s45,v212
M a[112:115],v[220:223],a[216:219],0
s_waitcnt lgkmcnt(2)
v_fmac_f32 v214,s40,v210
v_sub_f32 v212,v212,v208
M a[116:119],v[220:223],a[220:223],0
s_waitcnt lgkmcnt(1)
v_fma_f32 v208,-4.0,v206,v210
v_sub_f32 v210,v210,v206
M a[120:123],v[220:223],a[192:195],0
s_waitcnt lgkmcnt(0)
v_add_f32 v206,v235,v208
v_sub_f32 v235,v235,v208
M a[124:127],v[220:223],a[196:199],0
buffer_load_dwordx4 v[220:223],v251,s[20:23],s46 offen offset:1024 sc1
M a[128:131],v[224:227],a[200:203],0
v_fma_f32 v208,2.0,v210,v212
v_fmac_f32 v212,-2.0,v210
M a[132:135],v[224:227],a[204:207],0
v_cvt_pk_bf16_f32 v204,v232,v204
v_cvt_pk_bf16_f32 v214,v237,v214
M a[136:139],v[224:227],a[208:211],0
v_cvt_pk_bf16_f32 v206,v233,v206
v_cvt_pk_bf16_f32 v210,v234,v208
M a[140:143],v[224:227],a[212:215],0
v_cvt_pk_bf16_f32 v208,v238,v235
v_cvt_pk_bf16_f32 v212,v236,v212
M a[144:147],v[224:227],a[216:219],0
v_lshlrev_b32 v234,16,v209
v_lshlrev_b32 v232,16,v205
M a[148:151],v[224:227],a[220:223],0
v_lshlrev_b32 v233,16,v207
v_lshlrev_b32 v237,16,v215
M a[152:155],v[224:227],a[192:195],0
v_lshlrev_b32 v236,16,v213
v_lshlrev_b32 v235,16,v211
M a[156:159],v[224:227],a[196:199],0
buffer_load_dwordx4 v[224:227],v251,s[20:23],s47 offen offset:1024 sc1
M a[160:163],v[228:231],a[200:203],0
ds_read_b128 a[200:203],v250 offset:28160
v_fmac_f32 v232,s43,v234
M a[164:167],v[228:231],a[204:207],0
v_fmac_f32 v237,4.0,v233
v_fma_f32 v238,-4.0,v234,v236
M a[168:171],v[228:231],a[208:211],0
v_fmac_f32 v232,s45,v236
v_fmac_f32 v237,s40,v235
M a[172:175],v[228:231],a[212:215],0
v_sub_f32 v236,v236,v234
v_fma_f32 v234,-4.0,v233,v235
M a[176:179],v[228:231],a[216:219],0
v_sub_f32 v235,v235,v233
v_add_f32 v233,v238,v234
M a[180:183],v[228:231],a[220:223],0
v_sub_f32 v238,v238,v234
v_fma_f32 v234,2.0,v235,v236
M a[184:187],v[228:231],a[192:195],0
v_fmac_f32 v236,-2.0,v235
v_and_b32 v209,s42,v209
M a[188:191],v[228:231],a[196:199],0
s_waitcnt vmcnt(16)
buffer_load_dwordx4 v[228:231],v251,s[20:23],s48 offen offset:1024 sc1
M a[96:99],a[224:227],a[204:207],a[96:99]
v_and_b32 v205,s42,v205
v_and_b32 v207,s42,v207
M a[100:103],a[224:227],a[208:211],a[100:103]
v_and_b32 v215,s42,v215
v_and_b32 v213,s42,v213
M a[104:107],a[224:227],a[212:215],a[104:107]
v_and_b32 v211,s42,v211
v_fmac_f32 v205,s43,v209
M a[108:111],a[224:227],a[216:219],a[108:111]
v_fmac_f32 v215,4.0,v207
v_fma_f32 v235,-4.0,v209,v213
M a[112:115],a[224:227],a[220:223],a[112:115]
v_fmac_f32 v205,s45,v213
v_fmac_f32 v215,s40,v211
M a[116:119],a[224:227],a[192:195],a[116:119]
v_sub_f32 v213,v213,v209
v_fma_f32 v209,-4.0,v207,v211
M a[120:123],a[224:227],a[196:199],a[120:123]
s_waitcnt lgkmcnt(0)
v_sub_f32 v211,v211,v207
v_add_f32 v207,v235,v209
M a[124:127],a[224:227],a[200:203],a[124:127]
s_waitcnt vmcnt(16)
buffer_load_dwordx4 a[224:227],v251,s[20:23],s46 offen offset:2048 sc1
M a[128:131],a[228:231],a[204:207],a[128:131]
v_sub_f32 v235,v235,v209
v_fma_f32 v209,2.0,v211,v213
v_fmac_f32 v213,-2.0,v211
M a[132:135],a[228:231],a[208:211],a[132:135]
v_cvt_pk_bf16_f32 v205,v232,v205
v_cvt_pk_bf16_f32 v215,v237,v215
M a[136:139],a[228:231],a[212:215],a[136:139]
v_cvt_pk_bf16_f32 v207,v233,v207
v_cvt_pk_bf16_f32 v211,v234,v209
M a[140:143],a[228:231],a[216:219],a[140:143]
v_cvt_pk_bf16_f32 v209,v238,v235
v_cvt_pk_bf16_f32 v213,v236,v213
M a[144:147],a[228:231],a[220:223],a[144:147]
ds_write2st64_b64 v247,v[204:205],v[214:215] offset0:171 offset1:188
M a[148:151],a[228:231],a[192:195],a[148:151]
s_add_u32 s28,s65,1179648
buffer_load_dwordx2 v[204:205],v245,s[12:15],s28 offen offset:0
M a[152:155],a[228:231],a[196:199],a[152:155]
buffer_load_dwordx2 v[214:215],v245,s[16:19],s28 offen offset:1536
M a[156:159],a[228:231],a[200:203],a[156:159]
s_waitcnt vmcnt(18)
buffer_load_dwordx4 a[228:231],v251,s[20:23],s47 offen offset:2048 sc1
M a[160:163],a[232:235],a[204:207],a[160:163]
ds_read_b128 a[204:207],v249 offset:28416
ds_write2st64_b64 v247,v[206:207],v[208:209] offset0:103 offset1:120
M a[164:167],a[232:235],a[208:211],a[164:167]
buffer_load_dwordx2 v[206:207],v245,s[8:11],s28 offen offset:0
M a[168:171],a[232:235],a[212:215],a[168:171]
buffer_load_dwordx2 v[208:209],v245,s[8:11],s28 offen offset:384
M a[172:175],a[232:235],a[216:219],a[172:175]
ds_write2st64_b64 v247,v[210:211],v[212:213] offset0:137 offset1:154
M a[176:179],a[232:235],a[220:223],a[176:179]
buffer_load_dwordx2 v[210:211],v245,s[8:11],s28 offen offset:768
M a[180:183],a[232:235],a[192:195],a[180:183]
buffer_load_dwordx2 v[212:213],v245,s[8:11],s28 offen offset:1152
M a[184:187],a[232:235],a[196:199],a[184:187]
v_fmac_f32 v239,s43,v241
v_fmac_f32 v244,4.0,v240
M a[188:191],a[232:235],a[200:203],a[188:191]
s_waitcnt vmcnt(22)
buffer_load_dwordx4 a[232:235],v251,s[20:23],s48 offen offset:2048 sc1
M a[96:99],a[236:239],a[208:211],a[96:99]
v_fma_f32 v232,-4.0,v241,v243
v_fmac_f32 v239,s45,v243
M a[100:103],a[236:239],a[212:215],a[100:103]
s_add_u32 s46,s76,36864
v_fmac_f32 v244,s40,v242
v_sub_f32 v243,v243,v241
M a[104:107],a[236:239],a[216:219],a[104:107]
v_fma_f32 v241,-4.0,v240,v242
v_sub_f32 v242,v242,v240
M a[108:111],a[236:239],a[220:223],a[108:111]
v_add_f32 v240,v232,v241
v_sub_f32 v232,v232,v241
M a[112:115],a[236:239],a[192:195],a[112:115]
v_fma_f32 v241,2.0,v242,v243
v_fmac_f32 v243,-2.0,v242
M a[116:119],a[236:239],a[196:199],a[116:119]
v_cvt_pk_bf16_f32 v233,v239,v244
v_cvt_pk_bf16_f32 v234,v240,v232
M a[120:123],a[236:239],a[200:203],a[120:123]
s_waitcnt lgkmcnt(2)
v_cvt_pk_bf16_f32 v235,v241,v243
v_add_u32 v232,87040,v248
M a[124:127],a[236:239],a[204:207],a[124:127]
s_waitcnt vmcnt(22)
buffer_load_short_d16_hi v239,v246,s[12:15],s72 offen offset:0
M a[128:131],a[240:243],a[208:211],a[128:131]
buffer_load_short_d16_hi v240,v246,s[8:11],s72 offen offset:0
M a[132:135],a[240:243],a[212:215],a[132:135]
buffer_load_short_d16_hi v241,v246,s[8:11],s72 offen offset:384
M a[136:139],a[240:243],a[216:219],a[136:139]
buffer_load_short_d16_hi v242,v246,s[8:11],s72 offen offset:768
M a[140:143],a[240:243],a[220:223],a[140:143]
buffer_load_short_d16_hi v243,v246,s[8:11],s72 offen offset:1152
M a[144:147],a[240:243],a[192:195],a[144:147]
buffer_load_short_d16_hi v244,v246,s[16:19],s72 offen offset:1536
M a[148:151],a[240:243],a[196:199],a[148:151]
buffer_load_dwordx4 a[236:239],v251,s[20:23],s46 offen offset:0 sc1
M a[152:155],a[240:243],a[200:203],a[152:155]
s_add_u32 s47,s76,39936
ds_write_b16 v232,v233 offset:0
M a[156:159],a[240:243],a[204:207],a[156:159]
s_waitcnt vmcnt(26)
buffer_load_dwordx4 a[240:243],v251,s[20:23],s47 offen offset:0 sc1
M a[160:163],a[244:247],a[208:211],a[160:163]
ds_read_b128 a[208:211],v249 offset:34816
ds_write_b16_d16_hi v232,v233 offset:8704
M a[164:167],a[244:247],a[212:215],a[164:167]
s_add_u32 s48,s76,43008
ds_read_b128 a[212:215],v250 offset:35072
ds_write_b16 v248,v234 offset:52224
M a[168:171],a[244:247],a[216:219],a[168:171]
ds_read_b128 a[216:219],v250 offset:35328
ds_write_b16_d16_hi v248,v234 offset:60928
M a[172:175],a[244:247],a[220:223],a[172:175]
ds_read_b128 a[220:223],v250 offset:35584
v_add_u32 v232,69632,v248
M a[176:179],a[244:247],a[192:195],a[176:179]
ds_read_b128 a[192:195],v250 offset:35840
ds_write_b16 v232,v235 offset:0
M a[180:183],a[244:247],a[196:199],a[180:183]
ds_read_b128 a[196:199],v250 offset:36096
ds_write_b16_d16_hi v232,v235 offset:8704
M a[184:187],a[244:247],a[200:203],a[184:187]
s_waitcnt vmcnt(25)
ds_read_b128 a[200:203],v250 offset:36352
v_lshlrev_b32 v234,16,v196
M a[188:191],a[244:247],a[204:207],a[188:191]
s_waitcnt vmcnt(22) lgkmcnt(11)
buffer_load_dwordx4 a[244:247],v251,s[20:23],s48 offen offset:0 sc1
M v[0:3],a[248:251],a[208:211],0
s_waitcnt lgkmcnt(9)
ds_read_b128 a[204:207],v250 offset:36608
v_lshlrev_b32 v232,16,v192
M v[4:7],a[248:251],a[212:215],0
s_waitcnt lgkmcnt(8)
v_lshlrev_b32 v233,16,v194
v_lshlrev_b32 v237,16,v202
M v[8:11],a[248:251],a[216:219],0
s_waitcnt lgkmcnt(6)
v_lshlrev_b32 v236,16,v200
v_lshlrev_b32 v235,16,v198
M v[12:15],a[248:251],a[220:223],0
s_waitcnt lgkmcnt(5)
v_fmac_f32 v232,s43,v234
v_fmac_f32 v237,4.0,v233
M v[16:19],a[248:251],a[192:195],0
s_waitcnt lgkmcnt(3)
v_fma_f32 v238,-4.0,v234,v236
v_fmac_f32 v232,s45,v236
M v[20:23],a[248:251],a[196:199],0
s_waitcnt lgkmcnt(1)
v_fmac_f32 v237,s40,v235
v_sub_f32 v236,v236,v234
M v[24:27],a[248:251],a[200:203],0
s_waitcnt lgkmcnt(0)
v_fma_f32 v234,-4.0,v233,v235
v_sub_f32 v235,v235,v233
M v[28:31],a[248:251],a[204:207],0
s_waitcnt vmcnt(22)
buffer_load_dwordx4 a[248:251],v251,s[20:23],s46 offen offset:1024 sc1
M v[32:35],a[252:255],a[208:211],0
v_add_f32 v233,v238,v234
v_sub_f32 v238,v238,v234
M v[36:39],a[252:255],a[212:215],0
v_fma_f32 v234,2.0,v235,v236
v_fmac_f32 v236,-2.0,v235
M v[40:43],a[252:255],a[216:219],0
v_and_b32 v196,s42,v196
v_and_b32 v192,s42,v192
M v[44:47],a[252:255],a[220:223],0
v_and_b32 v194,s42,v194
v_and_b32 v202,s42,v202
M v[48:51],a[252:255],a[192:195],0
v_and_b32 v200,s42,v200
v_and_b32 v198,s42,v198
M v[52:55],a[252:255],a[196:199],0
v_fmac_f32 v192,s43,v196
v_fmac_f32 v202,4.0,v194
M v[56:59],a[252:255],a[200:203],0
v_fma_f32 v235,-4.0,v196,v200
v_fmac_f32 v192,s45,v200
M v[60:63],a[252:255],a[204:207],0
s_waitcnt vmcnt(22)
buffer_load_dwordx4 a[252:255],v251,s[20:23],s47 offen offset:1024 sc1
M v[64:67],v[216:219],a[208:211],0
ds_read_b128 a[208:211],v250 offset:36864
v_fmac_f32 v202,s40,v198
M v[68:71],v[216:219],a[212:215],0
v_sub_f32 v200,v200,v196
v_fma_f32 v196,-4.0,v194,v198
M v[72:75],v[216:219],a[216:219],0
v_sub_f32 v198,v198,v194
v_add_f32 v194,v235,v196
M v[76:79],v[216:219],a[220:223],0
v_sub_f32 v235,v235,v196
v_fma_f32 v196,2.0,v198,v200
M v[80:83],v[216:219],a[192:195],0
v_fmac_f32 v200,-2.0,v198
v_cvt_pk_bf16_f32 v192,v232,v192
M v[84:87],v[216:219],a[196:199],0
v_cvt_pk_bf16_f32 v202,v237,v202
v_cvt_pk_bf16_f32 v194,v233,v194
M v[88:91],v[216:219],a[200:203],0
v_cvt_pk_bf16_f32 v198,v234,v196
v_cvt_pk_bf16_f32 v196,v238,v235
M v[92:95],v[216:219],a[204:207],0
s_waitcnt vmcnt(22)
buffer_load_dwordx4 v[216:219],v251,s[20:23],s48 offen offset:1024 sc1
M v[0:3],v[220:223],a[212:215],v[0:3]
v_cvt_pk_bf16_f32 v200,v236,v200
v_lshlrev_b32 v234,16,v197
M v[4:7],v[220:223],a[216:219],v[4:7]
v_lshlrev_b32 v232,16,v193
v_lshlrev_b32 v233,16,v195
M v[8:11],v[220:223],a[220:223],v[8:11]
v_lshlrev_b32 v237,16,v203
v_lshlrev_b32 v236,16,v201
M v[12:15],v[220:223],a[192:195],v[12:15]
v_lshlrev_b32 v235,16,v199
v_fmac_f32 v232,s43,v234
M v[16:19],v[220:223],a[196:199],v[16:19]
v_fmac_f32 v237,4.0,v233
v_fma_f32 v238,-4.0,v234,v236
M v[20:23],v[220:223],a[200:203],v[20:23]
v_fmac_f32 v232,s45,v236
v_fmac_f32 v237,s40,v235
M v[24:27],v[220:223],a[204:207],v[24:27]
s_waitcnt lgkmcnt(0)
v_sub_f32 v236,v236,v234
v_fma_f32 v234,-4.0,v233,v235
M v[28:31],v[220:223],a[208:211],v[28:31]
s_waitcnt vmcnt(22)
buffer_load_dwordx4 v[220:223],v251,s[20:23],s46 offen offset:2048 sc1
M v[32:35],v[224:227],a[212:215],v[32:35]
v_sub_f32 v235,v235,v233
v_add_f32 v233,v238,v234
M v[36:39],v[224:227],a[216:219],v[36:39]
v_sub_f32 v238,v238,v234
v_fma_f32 v234,2.0,v235,v236
M v[40:43],v[224:227],a[220:223],v[40:43]
v_fmac_f32 v236,-2.0,v235
v_and_b32 v197,s42,v197
M v[44:47],v[224:227],a[192:195],v[44:47]
v_and_b32 v193,s42,v193
v_and_b32 v195,s42,v195
M v[48:51],v[224:227],a[196:199],v[48:51]
v_and_b32 v203,s42,v203
v_and_b32 v201,s42,v201
M v[52:55],v[224:227],a[200:203],v[52:55]
v_and_b32 v199,s42,v199
v_fmac_f32 v193,s43,v197
M v[56:59],v[224:227],a[204:207],v[56:59]
v_fmac_f32 v203,4.0,v195
v_fma_f32 v235,-4.0,v197,v201
M v[60:63],v[224:227],a[208:211],v[60:63]
s_waitcnt vmcnt(22)
buffer_load_dwordx4 v[224:227],v251,s[20:23],s47 offen offset:2048 sc1
M v[64:67],v[228:231],a[212:215],v[64:67]
ds_read_b128 a[212:215],v249 offset:37120
v_fmac_f32 v193,s45,v201
M v[68:71],v[228:231],a[216:219],v[68:71]
v_fmac_f32 v203,s40,v199
v_sub_f32 v201,v201,v197
M v[72:75],v[228:231],a[220:223],v[72:75]
v_fma_f32 v197,-4.0,v195,v199
v_sub_f32 v199,v199,v195
M v[76:79],v[228:231],a[192:195],v[76:79]
v_add_f32 v195,v235,v197
v_sub_f32 v235,v235,v197
M v[80:83],v[228:231],a[196:199],v[80:83]
v_fma_f32 v197,2.0,v199,v201
v_fmac_f32 v201,-2.0,v199
M v[84:87],v[228:231],a[200:203],v[84:87]
v_cvt_pk_bf16_f32 v193,v232,v193
v_cvt_pk_bf16_f32 v203,v237,v203
M v[88:91],v[228:231],a[204:207],v[88:91]
v_cvt_pk_bf16_f32 v195,v233,v195
v_cvt_pk_bf16_f32 v199,v234,v197
M v[92:95],v[228:231],a[208:211],v[92:95]
s_waitcnt vmcnt(22)
buffer_load_dwordx4 v[228:231],v251,s[20:23],s48 offen offset:2048 sc1
M v[0:3],a[224:227],a[216:219],v[0:3]
v_cvt_pk_bf16_f32 v197,v238,v235
v_cvt_pk_bf16_f32 v201,v236,v201
M v[4:7],a[224:227],a[220:223],v[4:7]
s_add_u32 s46,s77,9216
ds_write2st64_b64 v247,v[192:193],v[202:203] offset0:172 offset1:189
M v[8:11],a[224:227],a[192:195],v[8:11]
s_add_u32 s28,s66,0
buffer_load_dwordx2 v[192:193],v245,s[12:15],s28 offen offset:0
M v[12:15],a[224:227],a[196:199],v[12:15]
buffer_load_dwordx2 v[202:203],v245,s[16:19],s28 offen offset:1536
M v[16:19],a[224:227],a[200:203],v[16:19]
ds_write2st64_b64 v247,v[194:195],v[196:197] offset0:104 offset1:121
M v[20:23],a[224:227],a[204:207],v[20:23]
buffer_load_dwordx2 v[194:195],v245,s[8:11],s28 offen offset:0
M v[24:27],a[224:227],a[208:211],v[24:27]
s_waitcnt lgkmcnt(2)
buffer_load_dwordx2 v[196:197],v245,s[8:11],s28 offen offset:384
M v[28:31],a[224:227],a[212:215],v[28:31]
s_waitcnt vmcnt(24)
buffer_load_dwordx4 a[224:227],v251,s[20:23],s46 offen offset:0 sc1
M v[32:35],a[228:231],a[216:219],v[32:35]
ds_write2st64_b64 v247,v[198:199],v[200:201] offset0:138 offset1:155
M v[36:39],a[228:231],a[220:223],v[36:39]
s_add_u32 s47,s77,12288
buffer_load_dwordx2 v[198:199],v245,s[8:11],s28 offen offset:768
M v[40:43],a[228:231],a[192:195],v[40:43]
buffer_load_dwordx2 v[200:201],v245,s[8:11],s28 offen offset:1152
M v[44:47],a[228:231],a[196:199],v[44:47]
s_waitcnt vmcnt(25)
v_lshlrev_b32 v234,16,v208
v_lshlrev_b32 v232,16,v204
M v[48:51],a[228:231],a[200:203],v[48:51]
v_lshlrev_b32 v233,16,v206
v_lshlrev_b32 v237,16,v214
M v[52:55],a[228:231],a[204:207],v[52:55]
s_waitcnt vmcnt(23)
v_lshlrev_b32 v236,16,v212
v_lshlrev_b32 v235,16,v210
M v[56:59],a[228:231],a[208:211],v[56:59]
v_fmac_f32 v232,s43,v234
v_fmac_f32 v237,4.0,v233
M v[60:63],a[228:231],a[212:215],v[60:63]
s_waitcnt vmcnt(22)
buffer_load_dwordx4 a[228:231],v251,s[20:23],s47 offen offset:0 sc1
M v[64:67],a[232:235],a[216:219],v[64:67]
ds_read_b128 a[216:219],v249 offset:43520
v_fma_f32 v238,-4.0,v234,v236
M v[68:71],a[232:235],a[220:223],v[68:71]
s_add_u32 s48,s77,15360
ds_read_b128 a[220:223],v250 offset:43776
v_fmac_f32 v232,s45,v236
M v[72:75],a[232:235],a[192:195],v[72:75]
ds_read_b128 a[192:195],v250 offset:44032
v_fmac_f32 v237,s40,v235
M v[76:79],a[232:235],a[196:199],v[76:79]
ds_read_b128 a[196:199],v250 offset:44288
v_sub_f32 v236,v236,v234
M v[80:83],a[232:235],a[200:203],v[80:83]
ds_read_b128 a[200:203],v250 offset:44544
v_fma_f32 v234,-4.0,v233,v235
M v[84:87],a[232:235],a[204:207],v[84:87]
ds_read_b128 a[204:207],v250 offset:44800
v_sub_f32 v235,v235,v233
M v[88:91],a[232:235],a[208:211],v[88:91]
ds_read_b128 a[208:211],v250 offset:45056
v_add_f32 v233,v238,v234
M v[92:95],a[232:235],a[212:215],v[92:95]
s_waitcnt vmcnt(16) lgkmcnt(6)
buffer_load_dwordx4 a[232:235],v251,s[20:23],s48 offen offset:0 sc1
M v[96:99],a[236:239],a[216:219],0
s_waitcnt lgkmcnt(5)
ds_read_b128 a[212:215],v250 offset:45312
v_sub_f32 v238,v238,v234
M v[100:103],a[236:239],a[220:223],0
s_waitcnt lgkmcnt(5)
v_fma_f32 v234,2.0,v235,v236
v_fmac_f32 v236,-2.0,v235
M v[104:107],a[236:239],a[192:195],0
s_waitcnt lgkmcnt(4)
v_and_b32 v208,s42,v208
v_and_b32 v204,s42,v204
M v[108:111],a[236:239],a[196:199],0
s_waitcnt lgkmcnt(3)
v_and_b32 v206,s42,v206
v_and_b32 v214,s42,v214
M v[112:115],a[236:239],a[200:203],0
s_waitcnt lgkmcnt(2)
v_and_b32 v212,s42,v212
v_and_b32 v210,s42,v210
M v[116:119],a[236:239],a[204:207],0
s_waitcnt lgkmcnt(1)
v_fmac_f32 v204,s43,v208
v_fmac_f32 v214,4.0,v206
M v[120:123],a[236:239],a[208:211],0
s_waitcnt lgkmcnt(0)
v_fma_f32 v235,-4.0,v208,v212
v_fmac_f32 v204,s45,v212
M v[124:127],a[236:239],a[212:215],0
s_waitcnt vmcnt(16)
buffer_load_dwordx4 a[236:239],v251,s[20:23],s46 offen offset:1024 sc1
M v[128:131],a[240:243],a[216:219],0
v_fmac_f32 v214,s40,v210
v_sub_f32 v212,v212,v208
M v[132:135],a[240:243],a[220:223],0
v_fma_f32 v208,-4.0,v206,v210
v_sub_f32 v210,v210,v206
M v[136:139],a[240:243],a[192:195],0
v_add_f32 v206,v235,v208
v_sub_f32 v235,v235,v208
M v[140:143],a[240:243],a[196:199],0
v_fma_f32 v208,2.0,v210,v212
v_fmac_f32 v212,-2.0,v210
M v[144:147],a[240:243],a[200:203],0
v_cvt_pk_bf16_f32 v204,v232,v204
v_cvt_pk_bf16_f32 v214,v237,v214
M v[148:151],a[240:243],a[204:207],0
v_cvt_pk_bf16_f32 v206,v233,v206
v_cvt_pk_bf16_f32 v210,v234,v208
M v[152:155],a[240:243],a[208:211],0
v_cvt_pk_bf16_f32 v208,v238,v235
v_cvt_pk_bf16_f32 v212,v236,v212
M v[156:159],a[240:243],a[212:215],0
s_waitcnt vmcnt(16)
buffer_load_dwordx4 a[240:243],v251,s[20:23],s47 offen offset:1024 sc1
M v[160:163],a[244:247],a[216:219],0
ds_read_b128 a[216:219],v250 offset:45568
v_lshlrev_b32 v234,16,v209
M v[164:167],a[244:247],a[220:223],0
v_lshlrev_b32 v232,16,v205
v_lshlrev_b32 v233,16,v207
M v[168:171],a[244:247],a[192:195],0
v_lshlrev_b32 v237,16,v215
v_lshlrev_b32 v236,16,v213
M v[172:175],a[244:247],a[196:199],0
v_lshlrev_b32 v235,16,v211
v_fmac_f32 v232,s43,v234
M v[176:179],a[244:247],a[200:203],0
v_fmac_f32 v237,4.0,v233
v_fma_f32 v238,-4.0,v234,v236
M v[180:183],a[244:247],a[204:207],0
v_fmac_f32 v232,s45,v236
v_fmac_f32 v237,s40,v235
M v[184:187],a[244:247],a[208:211],0
v_sub_f32 v236,v236,v234
v_fma_f32 v234,-4.0,v233,v235
M v[188:191],a[244:247],a[212:215],0
s_waitcnt vmcnt(16)
buffer_load_dwordx4 a[244:247],v251,s[20:23],s48 offen offset:1024 sc1
M v[96:99],a[248:251],a[220:223],v[96:99]
v_sub_f32 v235,v235,v233
v_add_f32 v233,v238,v234
M v[100:103],a[248:251],a[192:195],v[100:103]
v_sub_f32 v238,v238,v234
v_fma_f32 v234,2.0,v235,v236
M v[104:107],a[248:251],a[196:199],v[104:107]
v_fmac_f32 v236,-2.0,v235
v_and_b32 v209,s42,v209
M v[108:111],a[248:251],a[200:203],v[108:111]
v_and_b32 v205,s42,v205
v_and_b32 v207,s42,v207
M v[112:115],a[248:251],a[204:207],v[112:115]
v_and_b32 v215,s42,v215
v_and_b32 v213,s42,v213
M v[116:119],a[248:251],a[208:211],v[116:119]
v_and_b32 v211,s42,v211
v_fmac_f32 v205,s43,v209
M v[120:123],a[248:251],a[212:215],v[120:123]
s_waitcnt lgkmcnt(0)
v_fmac_f32 v215,4.0,v207
v_fma_f32 v235,-4.0,v209,v213
M v[124:127],a[248:251],a[216:219],v[124:127]
s_waitcnt vmcnt(16)
buffer_load_dwordx4 a[248:251],v251,s[20:23],s46 offen offset:2048 sc1
M v[128:131],a[252:255],a[220:223],v[128:131]
v_fmac_f32 v205,s45,v213
v_fmac_f32 v215,s40,v211
M v[132:135],a[252:255],a[192:195],v[132:135]
v_sub_f32 v213,v213,v209
v_fma_f32 v209,-4.0,v207,v211
M v[136:139],a[252:255],a[196:199],v[136:139]
v_sub_f32 v211,v211,v207
v_add_f32 v207,v235,v209
M v[140:143],a[252:255],a[200:203],v[140:143]
v_sub_f32 v235,v235,v209
v_fma_f32 v209,2.0,v211,v213
M v[144:147],a[252:255],a[204:207],v[144:147]
v_fmac_f32 v213,-2.0,v211
v_cvt_pk_bf16_f32 v205,v232,v205
M v[148:151],a[252:255],a[208:211],v[148:151]
v_cvt_pk_bf16_f32 v215,v237,v215
v_cvt_pk_bf16_f32 v207,v233,v207
M v[152:155],a[252:255],a[212:215],v[152:155]
v_cvt_pk_bf16_f32 v211,v234,v209
v_cvt_pk_bf16_f32 v209,v238,v235
M v[156:159],a[252:255],a[216:219],v[156:159]
s_waitcnt vmcnt(16)
buffer_load_dwordx4 a[252:255],v251,s[20:23],s47 offen offset:2048 sc1
M v[160:163],v[216:219],a[220:223],v[160:163]
ds_read_b128 a[220:223],v249 offset:45824
v_cvt_pk_bf16_f32 v213,v236,v213
M v[164:167],v[216:219],a[192:195],v[164:167]
ds_write2st64_b64 v247,v[204:205],v[214:215] offset0:173 offset1:190
M v[168:171],v[216:219],a[196:199],v[168:171]
s_add_u32 s28,s66,393216
buffer_load_dwordx2 v[204:205],v245,s[12:15],s28 offen offset:0
M v[172:175],v[216:219],a[200:203],v[172:175]
buffer_load_dwordx2 v[214:215],v245,s[16:19],s28 offen offset:1536
M v[176:179],v[216:219],a[204:207],v[176:179]
ds_write2st64_b64 v247,v[206:207],v[208:209] offset0:105 offset1:122
M v[180:183],v[216:219],a[208:211],v[180:183]
buffer_load_dwordx2 v[206:207],v245,s[8:11],s28 offen offset:0
M v[184:187],v[216:219],a[212:215],v[184:187]
buffer_load_dwordx2 v[208:209],v245,s[8:11],s28 offen offset:384
M v[188:191],v[216:219],a[216:219],v[188:191]
s_waitcnt vmcnt(20)
buffer_load_dwordx4 v[216:219],v251,s[20:23],s48 offen offset:2048 sc1
M v[96:99],v[220:223],a[192:195],v[96:99]
ds_write2st64_b64 v247,v[210:211],v[212:213] offset0:139 offset1:156
M v[100:103],v[220:223],a[196:199],v[100:103]
s_add_u32 s46,s77,18432
buffer_load_dwordx2 v[210:211],v245,s[8:11],s28 offen offset:768
M v[104:107],v[220:223],a[200:203],v[104:107]
buffer_load_dwordx2 v[212:213],v245,s[8:11],s28 offen offset:1152
M v[108:111],v[220:223],a[204:207],v[108:111]
s_waitcnt vmcnt(17)
v_lshlrev_b32 v234,16,v196
v_lshlrev_b32 v232,16,v192
M v[112:115],v[220:223],a[208:211],v[112:115]
v_lshlrev_b32 v233,16,v194
v_lshlrev_b32 v237,16,v202
M v[116:119],v[220:223],a[212:215],v[116:119]
s_waitcnt vmcnt(14)
v_lshlrev_b32 v236,16,v200
v_lshlrev_b32 v235,16,v198
M v[120:123],v[220:223],a[216:219],v[120:123]
s_waitcnt lgkmcnt(3)
v_fmac_f32 v232,s43,v234
v_fmac_f32 v237,4.0,v233
M v[124:127],v[220:223],a[220:223],v[124:127]
buffer_load_dwordx4 v[220:223],v251,s[20:23],s46 offen offset:0 sc1
M v[128:131],v[224:227],a[192:195],v[128:131]
v_fma_f32 v238,-4.0,v234,v236
v_fmac_f32 v232,s45,v236
M v[132:135],v[224:227],a[196:199],v[132:135]
s_add_u32 s47,s77,21504
v_fmac_f32 v237,s40,v235
v_sub_f32 v236,v236,v234
M v[136:139],v[224:227],a[200:203],v[136:139]
v_fma_f32 v234,-4.0,v233,v235
v_sub_f32 v235,v235,v233
M v[140:143],v[224:227],a[204:207],v[140:143]
v_add_f32 v233,v238,v234
v_sub_f32 v238,v238,v234
M v[144:147],v[224:227],a[208:211],v[144:147]
v_fma_f32 v234,2.0,v235,v236
v_fmac_f32 v236,-2.0,v235
M v[148:151],v[224:227],a[212:215],v[148:151]
v_and_b32 v196,s42,v196
v_and_b32 v192,s42,v192
M v[152:155],v[224:227],a[216:219],v[152:155]
s_waitcnt lgkmcnt(0)
s_barrier
v_and_b32 v194,s42,v194
M v[156:159],v[224:227],a[220:223],v[156:159]
buffer_load_dwordx4 v[224:227],v251,s[20:23],s47 offen offset:0 sc1
M v[160:163],v[228:231],a[192:195],v[160:163]
ds_read_b128 a[192:195],v249 offset:52224
v_and_b32 v202,s42,v202
M v[164:167],v[228:231],a[196:199],v[164:167]
s_add_u32 s48,s77,24576
ds_read_b128 a[196:199],v250 offset:52480
v_and_b32 v200,s42,v200
M v[168:171],v[228:231],a[200:203],v[168:171]
ds_read_b128 a[200:203],v250 offset:52736
v_and_b32 v198,s42,v198
M v[172:175],v[228:231],a[204:207],v[172:175]
ds_read_b128 a[204:207],v250 offset:52992
v_fmac_f32 v192,s43,v196
M v[176:179],v[228:231],a[208:211],v[176:179]
ds_read_b128 a[208:211],v250 offset:53248
v_fmac_f32 v202,4.0,v194
M v[180:183],v[228:231],a[212:215],v[180:183]
ds_read_b128 a[212:215],v250 offset:53504
v_fma_f32 v235,-4.0,v196,v200
M v[184:187],v[228:231],a[216:219],v[184:187]
ds_read_b128 a[216:219],v250 offset:53760
v_fmac_f32 v192,s45,v200
M v[188:191],v[228:231],a[220:223],v[188:191]
s_waitcnt lgkmcnt(6)
buffer_load_dwordx4 v[228:231],v251,s[20:23],s48 offen offset:0 sc1
M a[0:3],a[224:227],a[192:195],a[0:3]
s_waitcnt lgkmcnt(5)
ds_read_b128 a[220:223],v250 offset:54016
v_fmac_f32 v202,s40,v198
M a[4:7],a[224:227],a[196:199],a[4:7]
s_waitcnt lgkmcnt(5)
v_sub_f32 v200,v200,v196
v_fma_f32 v196,-4.0,v194,v198
M a[8:11],a[224:227],a[200:203],a[8:11]
s_waitcnt lgkmcnt(4)
v_sub_f32 v198,v198,v194
v_add_f32 v194,v235,v196
M a[12:15],a[224:227],a[204:207],a[12:15]
s_waitcnt lgkmcnt(3)
v_sub_f32 v235,v235,v196
v_fma_f32 v196,2.0,v198,v200
M a[16:19],a[224:227],a[208:211],a[16:19]
s_waitcnt lgkmcnt(2)
v_fmac_f32 v200,-2.0,v198
v_cvt_pk_bf16_f32 v192,v232,v192
M a[20:23],a[224:227],a[212:215],a[20:23]
s_waitcnt lgkmcnt(1)
v_cvt_pk_bf16_f32 v202,v237,v202
v_cvt_pk_bf16_f32 v194,v233,v194
M a[24:27],a[224:227],a[216:219],a[24:27]
s_waitcnt lgkmcnt(0)
v_cvt_pk_bf16_f32 v198,v234,v196
v_cvt_pk_bf16_f32 v196,v238,v235
M a[28:31],a[224:227],a[220:223],a[28:31]
s_waitcnt vmcnt(16)
buffer_load_dwordx4 a[224:227],v251,s[20:23],s46 offen offset:1024 sc1
M a[32:35],a[228:231],a[192:195],a[32:35]
v_cvt_pk_bf16_f32 v200,v236,v200
v_lshlrev_b32 v234,16,v197
M a[36:39],a[228:231],a[196:199],a[36:39]
v_lshlrev_b32 v232,16,v193
v_lshlrev_b32 v233,16,v195
M a[40:43],a[228:231],a[200:203],a[40:43]
v_lshlrev_b32 v237,16,v203
v_lshlrev_b32 v236,16,v201
M a[44:47],a[228:231],a[204:207],a[44:47]
v_lshlrev_b32 v235,16,v199
v_fmac_f32 v232,s43,v234
M a[48:51],a[228:231],a[208:211],a[48:51]
v_fmac_f32 v237,4.0,v233
v_fma_f32 v238,-4.0,v234,v236
M a[52:55],a[228:231],a[212:215],a[52:55]
v_fmac_f32 v232,s45,v236
v_fmac_f32 v237,s40,v235
M a[56:59],a[228:231],a[216:219],a[56:59]
v_sub_f32 v236,v236,v234
v_fma_f32 v234,-4.0,v233,v235
M a[60:63],a[228:231],a[220:223],a[60:63]
s_waitcnt vmcnt(16)
buffer_load_dwordx4 a[228:231],v251,s[20:23],s47 offen offset:1024 sc1
M a[64:67],a[232:235],a[192:195],a[64:67]
ds_read_b128 a[192:195],v250 offset:54272
v_sub_f32 v235,v235,v233
M a[68:71],a[232:235],a[196:199],a[68:71]
v_add_f32 v233,v238,v234
v_sub_f32 v238,v238,v234
M a[72:75],a[232:235],a[200:203],a[72:75]
v_fma_f32 v234,2.0,v235,v236
v_fmac_f32 v236,-2.0,v235
M a[76:79],a[232:235],a[204:207],a[76:79]
v_and_b32 v197,s42,v197
v_and_b32 v193,s42,v193
M a[80:83],a[232:235],a[208:211],a[80:83]
v_and_b32 v195,s42,v195
v_and_b32 v203,s42,v203
M a[84:87],a[232:235],a[212:215],a[84:87]
v_and_b32 v201,s42,v201
v_and_b32 v199,s42,v199
M a[88:91],a[232:235],a[216:219],a[88:91]
v_fmac_f32 v193,s43,v197
v_fmac_f32 v203,4.0,v195
M a[92:95],a[232:235],a[220:223],a[92:95]
s_waitcnt vmcnt(16)
buffer_load_dwordx4 a[232:235],v251,s[20:23],s48 offen offset:1024 sc1
M a[0:3],a[236:239],a[196:199],a[0:3]
v_fma_f32 v235,-4.0,v197,v201
v_fmac_f32 v193,s45,v201
M a[4:7],a[236:239],a[200:203],a[4:7]
v_fmac_f32 v203,s40,v199
v_sub_f32 v201,v201,v197
M a[8:11],a[236:239],a[204:207],a[8:11]
v_fma_f32 v197,-4.0,v195,v199
v_sub_f32 v199,v199,v195
M a[12:15],a[236:239],a[208:211],a[12:15]
v_add_f32 v195,v235,v197
v_sub_f32 v235,v235,v197
M a[16:19],a[236:239],a[212:215],a[16:19]
v_fma_f32 v197,2.0,v199,v201
v_fmac_f32 v201,-2.0,v199
M a[20:23],a[236:239],a[216:219],a[20:23]
v_cvt_pk_bf16_f32 v193,v232,v193
v_cvt_pk_bf16_f32 v203,v237,v203
M a[24:27],a[236:239],a[220:223],a[24:27]
s_waitcnt lgkmcnt(0)
v_cvt_pk_bf16_f32 v195,v233,v195
v_cvt_pk_bf16_f32 v199,v234,v197
M a[28:31],a[236:239],a[192:195],a[28:31]
s_waitcnt vmcnt(16)
buffer_load_dwordx4 a[236:239],v251,s[20:23],s46 offen offset:2048 sc1
M a[32:35],a[240:243],a[196:199],a[32:35]
v_cvt_pk_bf16_f32 v197,v238,v235
v_cvt_pk_bf16_f32 v201,v236,v201
M a[36:39],a[240:243],a[200:203],a[36:39]
ds_write2st64_b64 v247,v[192:193],v[202:203] offset0:204 offset1:221
M a[40:43],a[240:243],a[204:207],a[40:43]
s_add_u32 s28,s66,786432
buffer_load_dwordx2 v[192:193],v245,s[12:15],s28 offen offset:0
M a[44:47],a[240:243],a[208:211],a[44:47]
buffer_load_dwordx2 v[202:203],v245,s[16:19],s28 offen offset:1536
M a[48:51],a[240:243],a[212:215],a[48:51]
ds_write2st64_b64 v247,v[194:195],v[196:197] offset0:34 offset1:51
M a[52:55],a[240:243],a[216:219],a[52:55]
buffer_load_dwordx2 v[194:195],v245,s[8:11],s28 offen offset:0
M a[56:59],a[240:243],a[220:223],a[56:59]
buffer_load_dwordx2 v[196:197],v245,s[8:11],s28 offen offset:384
M a[60:63],a[240:243],a[192:195],a[60:63]
s_waitcnt vmcnt(20)
buffer_load_dwordx4 a[240:243],v251,s[20:23],s47 offen offset:2048 sc1
M a[64:67],a[244:247],a[196:199],a[64:67]
ds_read_b128 a[196:199],v249 offset:54528
ds_write2st64_b64 v247,v[198:199],v[200:201] offset0:68 offset1:85
M a[68:71],a[244:247],a[200:203],a[68:71]
buffer_load_dwordx2 v[198:199],v245,s[8:11],s28 offen offset:768
M a[72:75],a[244:247],a[204:207],a[72:75]
buffer_load_dwordx2 v[200:201],v245,s[8:11],s28 offen offset:1152
M a[76:79],a[244:247],a[208:211],a[76:79]
s_waitcnt vmcnt(17)
v_lshlrev_b32 v234,16,v208
v_lshlrev_b32 v232,16,v204
M a[80:83],a[244:247],a[212:215],a[80:83]
v_lshlrev_b32 v233,16,v206
v_lshlrev_b32 v237,16,v214
M a[84:87],a[244:247],a[216:219],a[84:87]
s_waitcnt vmcnt(14)
v_lshlrev_b32 v236,16,v212
v_lshlrev_b32 v235,16,v210
M a[88:91],a[244:247],a[220:223],a[88:91]
v_fmac_f32 v232,s43,v234
v_fmac_f32 v237,4.0,v233
M a[92:95],a[244:247],a[192:195],a[92:95]
buffer_load_dwordx4 a[244:247],v251,s[20:23],s48 offen offset:2048 sc1
M a[0:3],a[248:251],a[200:203],a[0:3]
v_fma_f32 v238,-4.0,v234,v236
v_fmac_f32 v232,s45,v236
M a[4:7],a[248:251],a[204:207],a[4:7]
s_add_u32 s46,s77,27648
v_fmac_f32 v237,s40,v235
v_sub_f32 v236,v236,v234
M a[8:11],a[248:251],a[208:211],a[8:11]
v_fma_f32 v234,-4.0,v233,v235
v_sub_f32 v235,v235,v233
M a[12:15],a[248:251],a[212:215],a[12:15]
v_add_f32 v233,v238,v234
v_sub_f32 v238,v238,v234
M a[16:19],a[248:251],a[216:219],a[16:19]
v_fma_f32 v234,2.0,v235,v236
v_fmac_f32 v236,-2.0,v235
M a[20:23],a[248:251],a[220:223],a[20:23]
v_and_b32 v208,s42,v208
v_and_b32 v204,s42,v204
M a[24:27],a[248:251],a[192:195],a[24:27]
s_waitcnt lgkmcnt(1)
v_and_b32 v206,s42,v206
v_and_b32 v214,s42,v214
M a[28:31],a[248:251],a[196:199],a[28:31]
buffer_load_dwordx4 a[248:251],v251,s[20:23],s46 offen offset:0 sc1
M a[32:35],a[252:255],a[200:203],a[32:35]
v_and_b32 v212,s42,v212
v_and_b32 v210,s42,v210
M a[36:39],a[252:255],a[204:207],a[36:39]
s_add_u32 s47,s77,30720
v_fmac_f32 v204,s43,v208
v_fmac_f32 v214,4.0,v206
M a[40:43],a[252:255],a[208:211],a[40:43]
v_fma_f32 v235,-4.0,v208,v212
v_fmac_f32 v204,s45,v212
M a[44:47],a[252:255],a[212:215],a[44:47]
v_fmac_f32 v214,s40,v210
v_sub_f32 v212,v212,v208
M a[48:51],a[252:255],a[216:219],a[48:51]
v_fma_f32 v208,-4.0,v206,v210
v_sub_f32 v210,v210,v206
M a[52:55],a[252:255],a[220:223],a[52:55]
v_add_f32 v206,v235,v208
v_sub_f32 v235,v235,v208
M a[56:59],a[252:255],a[192:195],a[56:59]
v_fma_f32 v208,2.0,v210,v212
v_fmac_f32 v212,-2.0,v210
M a[60:63],a[252:255],a[196:199],a[60:63]
buffer_load_dwordx4 a[252:255],v251,s[20:23],s47 offen offset:0 sc1
M a[64:67],v[216:219],a[200:203],a[64:67]
ds_read_b128 a[200:203],v249 offset:60928
v_cvt_pk_bf16_f32 v204,v232,v204
M a[68:71],v[216:219],a[204:207],a[68:71]
s_add_u32 s48,s77,33792
ds_read_b128 a[204:207],v250 offset:61184
v_cvt_pk_bf16_f32 v214,v237,v214
M a[72:75],v[216:219],a[208:211],a[72:75]
ds_read_b128 a[208:211],v250 offset:61440
v_cvt_pk_bf16_f32 v206,v233,v206
M a[76:79],v[216:219],a[212:215],a[76:79]
ds_read_b128 a[212:215],v250 offset:61696
v_cvt_pk_bf16_f32 v210,v234,v208
M a[80:83],v[216:219],a[216:219],a[80:83]
ds_read_b128 a[216:219],v250 offset:61952
v_cvt_pk_bf16_f32 v208,v238,v235
M a[84:87],v[216:219],a[220:223],a[84:87]
ds_read_b128 a[220:223],v250 offset:62208
v_cvt_pk_bf16_f32 v212,v236,v212
M a[88:91],v[216:219],a[192:195],a[88:91]
ds_read_b128 a[192:195],v250 offset:62464
v_lshlrev_b32 v234,16,v209
M a[92:95],v[216:219],a[196:199],a[92:95]
s_waitcnt vmcnt(16) lgkmcnt(6)
buffer_load_dwordx4 v[216:219],v251,s[20:23],s48 offen offset:0 sc1
M a[96:99],v[220:223],a[200:203],a[96:99]
s_waitcnt lgkmcnt(5)
ds_read_b128 a[196:199],v250 offset:62720
v_lshlrev_b32 v232,16,v205
M a[100:103],v[220:223],a[204:207],a[100:103]
s_waitcnt lgkmcnt(5)
v_lshlrev_b32 v233,16,v207
v_lshlrev_b32 v237,16,v215
M a[104:107],v[220:223],a[208:211],a[104:107]
s_waitcnt lgkmcnt(4)
v_lshlrev_b32 v236,16,v213
v_lshlrev_b32 v235,16,v211
M a[108:111],v[220:223],a[212:215],a[108:111]
s_waitcnt lgkmcnt(3)
v_fmac_f32 v232,s43,v234
v_fmac_f32 v237,4.0,v233
M a[112:115],v[220:223],a[216:219],a[112:115]
s_waitcnt lgkmcnt(2)
v_fma_f32 v238,-4.0,v234,v236
v_fmac_f32 v232,s45,v236
M a[116:119],v[220:223],a[220:223],a[116:119]
s_waitcnt lgkmcnt(1)
v_fmac_f32 v237,s40,v235
v_sub_f32 v236,v236,v234
M a[120:123],v[220:223],a[192:195],a[120:123]
s_waitcnt lgkmcnt(0)
v_fma_f32 v234,-4.0,v233,v235
v_sub_f32 v235,v235,v233
M a[124:127],v[220:223],a[196:199],a[124:127]
s_waitcnt vmcnt(16)
buffer_load_dwordx4 v[220:223],v251,s[20:23],s46 offen offset:1024 sc1
M a[128:131],v[224:227],a[200:203],a[128:131]
v_add_f32 v233,v238,v234
v_sub_f32 v238,v238,v234
M a[132:135],v[224:227],a[204:207],a[132:135]
v_fma_f32 v234,2.0,v235,v236
v_fmac_f32 v236,-2.0,v235
M a[136:139],v[224:227],a[208:211],a[136:139]
v_and_b32 v209,s42,v209
v_and_b32 v205,s42,v205
M a[140:143],v[224:227],a[212:215],a[140:143]
v_and_b32 v207,s42,v207
v_and_b32 v215,s42,v215
M a[144:147],v[224:227],a[216:219],a[144:147]
v_and_b32 v213,s42,v213
v_and_b32 v211,s42,v211
M a[148:151],v[224:227],a[220:223],a[148:151]
v_fmac_f32 v205,s43,v209
v_fmac_f32 v215,4.0,v207
M a[152:155],v[224:227],a[192:195],a[152:155]
v_fma_f32 v235,-4.0,v209,v213
v_fmac_f32 v205,s45,v213
M a[156:159],v[224:227],a[196:199],a[156:159]
s_waitcnt vmcnt(16)
buffer_load_dwordx4 v[224:227],v251,s[20:23],s47 offen offset:1024 sc1
M a[160:163],v[228:231],a[200:203],a[160:163]
ds_read_b128 a[200:203],v250 offset:62976
v_fmac_f32 v215,s40,v211
M a[164:167],v[228:231],a[204:207],a[164:167]
v_sub_f32 v213,v213,v209
v_fma_f32 v209,-4.0,v207,v211
M a[168:171],v[228:231],a[208:211],a[168:171]
v_sub_f32 v211,v211,v207
v_add_f32 v207,v235,v209
M a[172:175],v[228:231],a[212:215],a[172:175]
v_sub_f32 v235,v235,v209
v_fma_f32 v209,2.0,v211,v213
M a[176:179],v[228:231],a[216:219],a[176:179]
v_fmac_f32 v213,-2.0,v211
v_cvt_pk_bf16_f32 v205,v232,v205
M a[180:183],v[228:231],a[220:223],a[180:183]
v_cvt_pk_bf16_f32 v215,v237,v215
v_cvt_pk_bf16_f32 v207,v233,v207
M a[184:187],v[228:231],a[192:195],a[184:187]
v_cvt_pk_bf16_f32 v211,v234,v209
v_cvt_pk_bf16_f32 v209,v238,v235
M a[188:191],v[228:231],a[196:199],a[188:191]
s_waitcnt vmcnt(16)
buffer_load_dwordx4 v[228:231],v251,s[20:23],s48 offen offset:1024 sc1
M a[96:99],a[224:227],a[204:207],a[96:99]
v_cvt_pk_bf16_f32 v213,v236,v213
M a[100:103],a[224:227],a[208:211],a[100:103]
ds_write2st64_b64 v247,v[204:205],v[214:215] offset0:205 offset1:222
M a[104:107],a[224:227],a[212:215],a[104:107]
s_add_u32 s28,s66,1179648
buffer_load_dwordx2 v[204:205],v245,s[12:15],s28 offen offset:0
M a[108:111],a[224:227],a[216:219],a[108:111]
buffer_load_dwordx2 v[214:215],v245,s[16:19],s28 offen offset:1536
M a[112:115],a[224:227],a[220:223],a[112:115]
ds_write2st64_b64 v247,v[206:207],v[208:209] offset0:35 offset1:52
M a[116:119],a[224:227],a[192:195],a[116:119]
buffer_load_dwordx2 v[206:207],v245,s[8:11],s28 offen offset:0
M a[120:123],a[224:227],a[196:199],a[120:123]
s_waitcnt lgkmcnt(2)
buffer_load_dwordx2 v[208:209],v245,s[8:11],s28 offen offset:384
M a[124:127],a[224:227],a[200:203],a[124:127]
s_waitcnt vmcnt(20)
buffer_load_dwordx4 a[224:227],v251,s[20:23],s46 offen offset:2048 sc1
M a[128:131],a[228:231],a[204:207],a[128:131]
ds_write2st64_b64 v247,v[210:211],v[212:213] offset0:69 offset1:86
M a[132:135],a[228:231],a[208:211],a[132:135]
buffer_load_dwordx2 v[210:211],v245,s[8:11],s28 offen offset:768
M a[136:139],a[228:231],a[212:215],a[136:139]
buffer_load_dwordx2 v[212:213],v245,s[8:11],s28 offen offset:1152
M a[140:143],a[228:231],a[216:219],a[140:143]
v_fmac_f32 v239,s43,v241
v_fmac_f32 v244,4.0,v240
M a[144:147],a[228:231],a[220:223],a[144:147]
v_fma_f32 v232,-4.0,v241,v243
v_fmac_f32 v239,s45,v243
M a[148:151],a[228:231],a[192:195],a[148:151]
v_fmac_f32 v244,s40,v242
v_sub_f32 v243,v243,v241
M a[152:155],a[228:231],a[196:199],a[152:155]
v_fma_f32 v241,-4.0,v240,v242
v_sub_f32 v242,v242,v240
M a[156:159],a[228:231],a[200:203],a[156:159]
s_waitcnt vmcnt(22)
buffer_load_dwordx4 a[228:231],v251,s[20:23],s47 offen offset:2048 sc1
M a[160:163],a[232:235],a[204:207],a[160:163]
ds_read_b128 a[204:207],v249 offset:63232
v_add_f32 v240,v232,v241
M a[164:167],a[232:235],a[208:211],a[164:167]
v_sub_f32 v232,v232,v241
v_fma_f32 v241,2.0,v242,v243
M a[168:171],a[232:235],a[212:215],a[168:171]
v_fmac_f32 v243,-2.0,v242
v_cvt_pk_bf16_f32 v233,v239,v244
M a[172:175],a[232:235],a[216:219],a[172:175]
v_cvt_pk_bf16_f32 v234,v240,v232
v_cvt_pk_bf16_f32 v235,v241,v243
M a[176:179],a[232:235],a[220:223],a[176:179]
buffer_load_short_d16_hi v239,v246,s[12:15],s73 offen offset:0
M a[180:183],a[232:235],a[192:195],a[180:183]
buffer_load_short_d16_hi v240,v246,s[8:11],s73 offen offset:0
M a[184:187],a[232:235],a[196:199],a[184:187]
buffer_load_short_d16_hi v241,v246,s[8:11],s73 offen offset:384
M a[188:191],a[232:235],a[200:203],a[188:191]
s_waitcnt vmcnt(25)
buffer_load_short_d16_hi v242,v246,s[8:11],s73 offen offset:768
M a[96:99],a[236:239],a[208:211],a[96:99]
buffer_load_short_d16_hi v243,v246,s[8:11],s73 offen offset:1152
M a[100:103],a[236:239],a[212:215],a[100:103]
buffer_load_short_d16_hi v244,v246,s[16:19],s73 offen offset:1536
M a[104:107],a[236:239],a[216:219],a[104:107]
buffer_load_dwordx4 a[232:235],v251,s[20:23],s48 offen offset:2048 sc1
M a[108:111],a[236:239],a[220:223],a[108:111]
s_add_u32 s46,s77,36864
v_add_u32 v232,104448,v248
M a[112:115],a[236:239],a[192:195],a[112:115]
ds_write_b16 v232,v233 offset:0
M a[116:119],a[236:239],a[196:199],a[116:119]
ds_write_b16_d16_hi v232,v233 offset:8704
M a[120:123],a[236:239],a[200:203],a[120:123]
s_waitcnt lgkmcnt(2)
ds_write_b16 v248,v234 offset:17408
M a[124:127],a[236:239],a[204:207],a[124:127]
s_waitcnt vmcnt(24)
buffer_load_dwordx4 a[236:239],v251,s[20:23],s46 offen offset:0 sc1
M a[128:131],a[240:243],a[208:211],a[128:131]
ds_write_b16_d16_hi v248,v234 offset:26112
M a[132:135],a[240:243],a[212:215],a[132:135]
s_add_u32 s47,s77,39936
ds_write_b16 v248,v235 offset:34816
M a[136:139],a[240:243],a[216:219],a[136:139]
ds_write_b16_d16_hi v248,v235 offset:43520
M a[140:143],a[240:243],a[220:223],a[140:143]
v_lshlrev_b32 v234,16,v196
v_lshlrev_b32 v232,16,v192
M a[144:147],a[240:243],a[192:195],a[144:147]
v_lshlrev_b32 v233,16,v194
v_lshlrev_b32 v237,16,v202
M a[148:151],a[240:243],a[196:199],a[148:151]
v_add_u32 v249,0x4400,v249
v_add_u32 v250,0x4400,v250
M a[152:155],a[240:243],a[200:203],a[152:155]
s_waitcnt vmcnt(23)
v_lshlrev_b32 v236,16,v200
v_lshlrev_b32 v235,16,v198
M a[156:159],a[240:243],a[204:207],a[156:159]
s_waitcnt vmcnt(22)
buffer_load_dwordx4 a[240:243],v251,s[20:23],s47 offen offset:0 sc1
M a[160:163],a[244:247],a[208:211],a[160:163]
ds_read_b128 a[208:211],v249 offset:52224
v_fmac_f32 v232,s43,v234
M a[164:167],a[244:247],a[212:215],a[164:167]
s_add_u32 s48,s77,43008
ds_read_b128 a[212:215],v250 offset:52480
v_fmac_f32 v237,4.0,v233
M a[168:171],a[244:247],a[216:219],a[168:171]
ds_read_b128 a[216:219],v250 offset:52736
v_fma_f32 v238,-4.0,v234,v236
M a[172:175],a[244:247],a[220:223],a[172:175]
ds_read_b128 a[220:223],v250 offset:52992
v_fmac_f32 v232,s45,v236
M a[176:179],a[244:247],a[192:195],a[176:179]
ds_read_b128 a[192:195],v250 offset:53248
v_fmac_f32 v237,s40,v235
M a[180:183],a[244:247],a[196:199],a[180:183]
ds_read_b128 a[196:199],v250 offset:53504
v_sub_f32 v236,v236,v234
M a[184:187],a[244:247],a[200:203],a[184:187]
ds_read_b128 a[200:203],v250 offset:53760
v_fma_f32 v234,-4.0,v233,v235
M a[188:191],a[244:247],a[204:207],a[188:191]
s_waitcnt vmcnt(22) lgkmcnt(6)
buffer_load_dwordx4 a[244:247],v251,s[20:23],s48 offen offset:0 sc1
M v[0:3],a[248:251],a[208:211],v[0:3]
s_waitcnt lgkmcnt(5)
ds_read_b128 a[204:207],v250 offset:54016
v_sub_f32 v235,v235,v233
M v[4:7],a[248:251],a[212:215],v[4:7]
s_waitcnt lgkmcnt(5)
v_add_f32 v233,v238,v234
v_sub_f32 v238,v238,v234
M v[8:11],a[248:251],a[216:219],v[8:11]
s_waitcnt lgkmcnt(4)
v_fma_f32 v234,2.0,v235,v236
v_fmac_f32 v236,-2.0,v235
M v[12:15],a[248:251],a[220:223],v[12:15]
s_waitcnt lgkmcnt(3)
v_and_b32 v196,s42,v196
v_and_b32 v192,s42,v192
M v[16:19],a[248:251],a[192:195],v[16:19]
s_waitcnt lgkmcnt(2)
v_and_b32 v194,s42,v194
v_and_b32 v202,s42,v202
M v[20:23],a[248:251],a[196:199],v[20:23]
s_waitcnt lgkmcnt(1)
v_and_b32 v200,s42,v200
v_and_b32 v198,s42,v198
M v[24:27],a[248:251],a[200:203],v[24:27]
s_waitcnt lgkmcnt(0)
v_fmac_f32 v192,s43,v196
v_fmac_f32 v202,4.0,v194
M v[28:31],a[248:251],a[204:207],v[28:31]
s_waitcnt vmcnt(22)
buffer_load_dwordx4 a[248:251],v251,s[20:23],s46 offen offset:1024 sc1
M v[32:35],a[252:255],a[208:211],v[32:35]
v_fma_f32 v235,-4.0,v196,v200
v_fmac_f32 v192,s45,v200
M v[36:39],a[252:255],a[212:215],v[36:39]
v_fmac_f32 v202,s40,v198
v_sub_f32 v200,v200,v196
M v[40:43],a[252:255],a[216:219],v[40:43]
v_fma_f32 v196,-4.0,v194,v198
v_sub_f32 v198,v198,v194
M v[44:47],a[252:255],a[220:223],v[44:47]
v_add_f32 v194,v235,v196
v_sub_f32 v235,v235,v196
M v[48:51],a[252:255],a[192:195],v[48:51]
v_fma_f32 v196,2.0,v198,v200
v_fmac_f32 v200,-2.0,v198
M v[52:55],a[252:255],a[196:199],v[52:55]
v_cvt_pk_bf16_f32 v192,v232,v192
v_cvt_pk_bf16_f32 v202,v237,v202
M v[56:59],a[252:255],a[200:203],v[56:59]
v_cvt_pk_bf16_f32 v194,v233,v194
v_cvt_pk_bf16_f32 v198,v234,v196
M v[60:63],a[252:255],a[204:207],v[60:63]
s_waitcnt vmcnt(22)
buffer_load_dwordx4 a[252:255],v251,s[20:23],s47 offen offset:1024 sc1
M v[64:67],v[216:219],a[208:211],v[64:67]
ds_read_b128 a[208:211],v250 offset:54272
v_cvt_pk_bf16_f32 v196,v238,v235
M v[68:71],v[216:219],a[212:215],v[68:71]
v_cvt_pk_bf16_f32 v200,v236,v200
v_lshlrev_b32 v234,16,v197
M v[72:75],v[216:219],a[216:219],v[72:75]
v_lshlrev_b32 v232,16,v193
v_lshlrev_b32 v233,16,v195
M v[76:79],v[216:219],a[220:223],v[76:79]
v_lshlrev_b32 v237,16,v203
v_lshlrev_b32 v236,16,v201
M v[80:83],v[216:219],a[192:195],v[80:83]
v_lshlrev_b32 v235,16,v199
v_fmac_f32 v232,s43,v234
M v[84:87],v[216:219],a[196:199],v[84:87]
v_fmac_f32 v237,4.0,v233
v_fma_f32 v238,-4.0,v234,v236
M v[88:91],v[216:219],a[200:203],v[88:91]
v_fmac_f32 v232,s45,v236
v_fmac_f32 v237,s40,v235
M v[92:95],v[216:219],a[204:207],v[92:95]
s_waitcnt vmcnt(22)
buffer_load_dwordx4 v[216:219],v251,s[20:23],s48 offen offset:1024 sc1
M v[0:3],v[220:223],a[212:215],v[0:3]
v_sub_f32 v236,v236,v234
v_fma_f32 v234,-4.0,v233,v235
M v[4:7],v[220:223],a[216:219],v[4:7]
v_sub_f32 v235,v235,v233
v_add_f32 v233,v238,v234
M v[8:11],v[220:223],a[220:223],v[8:11]
v_sub_f32 v238,v238,v234
v_fma_f32 v234,2.0,v235,v236
M v[12:15],v[220:223],a[192:195],v[12:15]
v_fmac_f32 v236,-2.0,v235
v_and_b32 v197,s42,v197
M v[16:19],v[220:223],a[196:199],v[16:19]
v_and_b32 v193,s42,v193
v_and_b32 v195,s42,v195
M v[20:23],v[220:223],a[200:203],v[20:23]
v_and_b32 v203,s42,v203
v_and_b32 v201,s42,v201
M v[24:27],v[220:223],a[204:207],v[24:27]
s_waitcnt lgkmcnt(0)
v_and_b32 v199,s42,v199
v_fmac_f32 v193,s43,v197
M v[28:31],v[220:223],a[208:211],v[28:31]
s_waitcnt vmcnt(22)
buffer_load_dwordx4 v[220:223],v251,s[20:23],s46 offen offset:2048 sc1
M v[32:35],v[224:227],a[212:215],v[32:35]
v_fmac_f32 v203,4.0,v195
v_fma_f32 v235,-4.0,v197,v201
M v[36:39],v[224:227],a[216:219],v[36:39]
v_fmac_f32 v193,s45,v201
v_fmac_f32 v203,s40,v199
M v[40:43],v[224:227],a[220:223],v[40:43]
v_sub_f32 v201,v201,v197
v_fma_f32 v197,-4.0,v195,v199
M v[44:47],v[224:227],a[192:195],v[44:47]
v_sub_f32 v199,v199,v195
v_add_f32 v195,v235,v197
M v[48:51],v[224:227],a[196:199],v[48:51]
v_sub_f32 v235,v235,v197
v_fma_f32 v197,2.0,v199,v201
M v[52:55],v[224:227],a[200:203],v[52:55]
v_fmac_f32 v201,-2.0,v199
v_cvt_pk_bf16_f32 v193,v232,v193
M v[56:59],v[224:227],a[204:207],v[56:59]
v_cvt_pk_bf16_f32 v203,v237,v203
v_cvt_pk_bf16_f32 v195,v233,v195
M v[60:63],v[224:227],a[208:211],v[60:63]
s_waitcnt vmcnt(22)
buffer_load_dwordx4 v[224:227],v251,s[20:23],s47 offen offset:2048 sc1
M v[64:67],v[228:231],a[212:215],v[64:67]
ds_read_b128 a[212:215],v249 offset:54528
v_cvt_pk_bf16_f32 v199,v234,v197
M v[68:71],v[228:231],a[216:219],v[68:71]
v_cvt_pk_bf16_f32 v197,v238,v235
v_cvt_pk_bf16_f32 v201,v236,v201
M v[72:75],v[228:231],a[220:223],v[72:75]
ds_write2st64_b64 v247,v[192:193],v[202:203] offset0:206 offset1:223
M v[76:79],v[228:231],a[192:195],v[76:79]
s_add_u32 s28,s67,0
buffer_load_dwordx2 v[192:193],v245,s[12:15],s28 offen offset:0
M v[80:83],v[228:231],a[196:199],v[80:83]
buffer_load_dwordx2 v[202:203],v245,s[16:19],s28 offen offset:1536
M v[84:87],v[228:231],a[200:203],v[84:87]
ds_write2st64_b64 v247,v[194:195],v[196:197] offset0:36 offset1:53
M v[88:91],v[228:231],a[204:207],v[88:91]
buffer_load_dwordx2 v[194:195],v245,s[8:11],s28 offen offset:0
M v[92:95],v[228:231],a[208:211],v[92:95]
s_waitcnt vmcnt(21)
buffer_load_dwordx2 v[196:197],v245,s[8:11],s28 offen offset:384
M v[0:3],a[224:227],a[216:219],v[0:3]
buffer_load_dwordx4 v[228:231],v251,s[20:23],s48 offen offset:2048 sc1
M v[4:7],a[224:227],a[220:223],v[4:7]
s_add_u32 s46,s78,9216
ds_write2st64_b64 v247,v[198:199],v[200:201] offset0:70 offset1:87
M v[8:11],a[224:227],a[192:195],v[8:11]
buffer_load_dwordx2 v[198:199],v245,s[8:11],s28 offen offset:768
M v[12:15],a[224:227],a[196:199],v[12:15]
buffer_load_dwordx2 v[200:201],v245,s[8:11],s28 offen offset:1152
M v[16:19],a[224:227],a[200:203],v[16:19]
v_lshlrev_b32 v234,16,v208
v_lshlrev_b32 v232,16,v204
M v[20:23],a[224:227],a[204:207],v[20:23]
v_lshlrev_b32 v233,16,v206
v_lshlrev_b32 v237,16,v214
M v[24:27],a[224:227],a[208:211],v[24:27]
s_waitcnt vmcnt(23) lgkmcnt(3)
v_lshlrev_b32 v236,16,v212
v_lshlrev_b32 v235,16,v210
M v[28:31],a[224:227],a[212:215],v[28:31]
s_waitcnt vmcnt(22)
buffer_load_dwordx4 a[224:227],v251,s[20:23],s46 offen offset:0 sc1
M v[32:35],a[228:231],a[216:219],v[32:35]
v_fmac_f32 v232,s43,v234
v_fmac_f32 v237,4.0,v233
M v[36:39],a[228:231],a[220:223],v[36:39]
s_add_u32 s47,s78,12288
v_fma_f32 v238,-4.0,v234,v236
v_fmac_f32 v232,s45,v236
M v[40:43],a[228:231],a[192:195],v[40:43]
v_fmac_f32 v237,s40,v235
v_sub_f32 v236,v236,v234
M v[44:47],a[228:231],a[196:199],v[44:47]
v_fma_f32 v234,-4.0,v233,v235
v_sub_f32 v235,v235,v233
M v[48:51],a[228:231],a[200:203],v[48:51]
v_add_f32 v233,v238,v234
v_sub_f32 v238,v238,v234
M v[52:55],a[228:231],a[204:207],v[52:55]
v_fma_f32 v234,2.0,v235,v236
v_fmac_f32 v236,-2.0,v235
M v[56:59],a[228:231],a[208:211],v[56:59]
v_and_b32 v208,s42,v208
v_and_b32 v204,s42,v204
M v[60:63],a[228:231],a[212:215],v[60:63]
s_waitcnt vmcnt(16)
buffer_load_dwordx4 a[228:231],v251,s[20:23],s47 offen offset:0 sc1
M v[64:67],a[232:235],a[216:219],v[64:67]
ds_read_b128 a[216:219],v249 offset:60928
v_and_b32 v206,s42,v206
M v[68:71],a[232:235],a[220:223],v[68:71]
s_add_u32 s48,s78,15360
ds_read_b128 a[220:223],v250 offset:61184
v_and_b32 v214,s42,v214
M v[72:75],a[232:235],a[192:195],v[72:75]
ds_read_b128 a[192:195],v250 offset:61440
v_and_b32 v212,s42,v212
M v[76:79],a[232:235],a[196:199],v[76:79]
ds_read_b128 a[196:199],v250 offset:61696
v_and_b32 v210,s42,v210
M v[80:83],a[232:235],a[200:203],v[80:83]
ds_read_b128 a[200:203],v250 offset:61952
v_fmac_f32 v204,s43,v208
M v[84:87],a[232:235],a[204:207],v[84:87]
ds_read_b128 a[204:207],v250 offset:62208
v_fmac_f32 v214,4.0,v206
M v[88:91],a[232:235],a[208:211],v[88:91]
ds_read_b128 a[208:211],v250 offset:62464
v_fma_f32 v235,-4.0,v208,v212
M v[92:95],a[232:235],a[212:215],v[92:95]
s_waitcnt vmcnt(16) lgkmcnt(6)
buffer_load_dwordx4 a[232:235],v251,s[20:23],s48 offen offset:0 sc1
M v[96:99],a[236:239],a[216:219],v[96:99]
s_waitcnt lgkmcnt(5)
ds_read_b128 a[212:215],v250 offset:62720
v_fmac_f32 v204,s45,v212
M v[100:103],a[236:239],a[220:223],v[100:103]
s_waitcnt lgkmcnt(5)
v_fmac_f32 v214,s40,v210
v_sub_f32 v212,v212,v208
M v[104:107],a[236:239],a[192:195],v[104:107]
s_waitcnt lgkmcnt(4)
v_fma_f32 v208,-4.0,v206,v210
v_sub_f32 v210,v210,v206
M v[108:111],a[236:239],a[196:199],v[108:111]
s_waitcnt lgkmcnt(3)
v_add_f32 v206,v235,v208
v_sub_f32 v235,v235,v208
M v[112:115],a[236:239],a[200:203],v[112:115]
s_waitcnt lgkmcnt(2)
v_fma_f32 v208,2.0,v210,v212
v_fmac_f32 v212,-2.0,v210
M v[116:119],a[236:239],a[204:207],v[116:119]
s_waitcnt lgkmcnt(1)
v_cvt_pk_bf16_f32 v204,v232,v204
v_cvt_pk_bf16_f32 v214,v237,v214
M v[120:123],a[236:239],a[208:211],v[120:123]
s_waitcnt lgkmcnt(0)
v_cvt_pk_bf16_f32 v206,v233,v206
v_cvt_pk_bf16_f32 v210,v234,v208
M v[124:127],a[236:239],a[212:215],v[124:127]
s_waitcnt vmcnt(16)
buffer_load_dwordx4 a[236:239],v251,s[20:23],s46 offen offset:1024 sc1
M v[128:131],a[240:243],a[216:219],v[128:131]
v_cvt_pk_bf16_f32 v208,v238,v235
v_cvt_pk_bf16_f32 v212,v236,v212
M v[132:135],a[240:243],a[220:223],v[132:135]
v_lshlrev_b32 v234,16,v209
v_lshlrev_b32 v232,16,v205
M v[136:139],a[240:243],a[192:195],v[136:139]
v_lshlrev_b32 v233,16,v207
v_lshlrev_b32 v237,16,v215
M v[140:143],a[240:243],a[196:199],v[140:143]
v_lshlrev_b32 v236,16,v213
v_lshlrev_b32 v235,16,v211
M v[144:147],a[240:243],a[200:203],v[144:147]
v_fmac_f32 v232,s43,v234
v_fmac_f32 v237,4.0,v233
M v[148:151],a[240:243],a[204:207],v[148:151]
v_fma_f32 v238,-4.0,v234,v236
v_fmac_f32 v232,s45,v236
M v[152:155],a[240:243],a[208:211],v[152:155]
v_fmac_f32 v237,s40,v235
v_sub_f32 v236,v236,v234
M v[156:159],a[240:243],a[212:215],v[156:159]
s_waitcnt vmcnt(16)
buffer_load_dwordx4 a[240:243],v251,s[20:23],s47 offen offset:1024 sc1
M v[160:163],a[244:247],a[216:219],v[160:163]
ds_read_b128 a[216:219],v250 offset:62976
v_fma_f32 v234,-4.0,v233,v235
M v[164:167],a[244:247],a[220:223],v[164:167]
v_sub_f32 v235,v235,v233
v_add_f32 v233,v238,v234
M v[168:171],a[244:247],a[192:195],v[168:171]
v_sub_f32 v238,v238,v234
v_fma_f32 v234,2.0,v235,v236
M v[172:175],a[244:247],a[196:199],v[172:175]
v_fmac_f32 v236,-2.0,v235
v_and_b32 v209,s42,v209
M v[176:179],a[244:247],a[200:203],v[176:179]
v_and_b32 v205,s42,v205
v_and_b32 v207,s42,v207
M v[180:183],a[244:247],a[204:207],v[180:183]
v_and_b32 v215,s42,v215
v_and_b32 v213,s42,v213
M v[184:187],a[244:247],a[208:211],v[184:187]
v_and_b32 v211,s42,v211
v_fmac_f32 v205,s43,v209
M v[188:191],a[244:247],a[212:215],v[188:191]
s_waitcnt vmcnt(16)
buffer_load_dwordx4 a[244:247],v251,s[20:23],s48 offen offset:1024 sc1
M v[96:99],a[248:251],a[220:223],v[96:99]
v_fmac_f32 v215,4.0,v207
v_fma_f32 v235,-4.0,v209,v213
M v[100:103],a[248:251],a[192:195],v[100:103]
v_fmac_f32 v205,s45,v213
v_fmac_f32 v215,s40,v211
M v[104:107],a[248:251],a[196:199],v[104:107]
v_sub_f32 v213,v213,v209
v_fma_f32 v209,-4.0,v207,v211
M v[108:111],a[248:251],a[200:203],v[108:111]
v_sub_f32 v211,v211,v207
v_add_f32 v207,v235,v209
M v[112:115],a[248:251],a[204:207],v[112:115]
v_sub_f32 v235,v235,v209
v_fma_f32 v209,2.0,v211,v213
M v[116:119],a[248:251],a[208:211],v[116:119]
v_fmac_f32 v213,-2.0,v211
v_cvt_pk_bf16_f32 v205,v232,v205
M v[120:123],a[248:251],a[212:215],v[120:123]
s_waitcnt lgkmcnt(0)
v_cvt_pk_bf16_f32 v215,v237,v215
v_cvt_pk_bf16_f32 v207,v233,v207
M v[124:127],a[248:251],a[216:219],v[124:127]
s_waitcnt vmcnt(16)
buffer_load_dwordx4 a[248:251],v251,s[20:23],s46 offen offset:2048 sc1
M v[128:131],a[252:255],a[220:223],v[128:131]
v_cvt_pk_bf16_f32 v211,v234,v209
v_cvt_pk_bf16_f32 v209,v238,v235
M v[132:135],a[252:255],a[192:195],v[132:135]
v_cvt_pk_bf16_f32 v213,v236,v213
M v[136:139],a[252:255],a[196:199],v[136:139]
ds_write2st64_b64 v247,v[204:205],v[214:215] offset0:207 offset1:224
M v[140:143],a[252:255],a[200:203],v[140:143]
s_add_u32 s28,s67,393216
buffer_load_dwordx2 v[204:205],v245,s[12:15],s28 offen offset:0
M v[144:147],a[252:255],a[204:207],v[144:147]
buffer_load_dwordx2 v[214:215],v245,s[16:19],s28 offen offset:1536
M v[148:151],a[252:255],a[208:211],v[148:151]
ds_write2st64_b64 v247,v[206:207],v[208:209] offset0:37 offset1:54
M v[152:155],a[252:255],a[212:215],v[152:155]
buffer_load_dwordx2 v[206:207],v245,s[8:11],s28 offen offset:0
M v[156:159],a[252:255],a[216:219],v[156:159]
s_waitcnt vmcnt(19)
buffer_load_dwordx2 v[208:209],v245,s[8:11],s28 offen offset:384
M v[160:163],v[216:219],a[220:223],v[160:163]
buffer_load_dwordx4 a[252:255],v251,s[20:23],s47 offen offset:2048 sc1
M v[164:167],v[216:219],a[192:195],v[164:167]
ds_read_b128 a[220:223],v249 offset:63232
ds_write2st64_b64 v247,v[210:211],v[212:213] offset0:71 offset1:88
M v[168:171],v[216:219],a[196:199],v[168:171]
buffer_load_dwordx2 v[210:211],v245,s[8:11],s28 offen offset:768
M v[172:175],v[216:219],a[200:203],v[172:175]
buffer_load_dwordx2 v[212:213],v245,s[8:11],s28 offen offset:1152
M v[176:179],v[216:219],a[204:207],v[176:179]
s_waitcnt vmcnt(17)
v_lshlrev_b32 v234,16,v196
v_lshlrev_b32 v232,16,v192
M v[180:183],v[216:219],a[208:211],v[180:183]
v_lshlrev_b32 v233,16,v194
v_lshlrev_b32 v237,16,v202
M v[184:187],v[216:219],a[212:215],v[184:187]
s_waitcnt vmcnt(14)
v_lshlrev_b32 v236,16,v200
v_lshlrev_b32 v235,16,v198
M v[188:191],v[216:219],a[216:219],v[188:191]
buffer_load_dwordx4 v[216:219],v251,s[20:23],s48 offen offset:2048 sc1
M v[96:99],v[220:223],a[192:195],v[96:99]
v_fmac_f32 v232,s43,v234
v_fmac_f32 v237,4.0,v233
M v[100:103],v[220:223],a[196:199],v[100:103]
s_add_u32 s46,s78,18432
v_fma_f32 v238,-4.0,v234,v236
v_fmac_f32 v232,s45,v236
M v[104:107],v[220:223],a[200:203],v[104:107]
v_fmac_f32 v237,s40,v235
v_sub_f32 v236,v236,v234
M v[108:111],v[220:223],a[204:207],v[108:111]
v_fma_f32 v234,-4.0,v233,v235
v_sub_f32 v235,v235,v233
M v[112:115],v[220:223],a[208:211],v[112:115]
v_add_f32 v233,v238,v234
v_sub_f32 v238,v238,v234
M v[116:119],v[220:223],a[212:215],v[116:119]
v_fma_f32 v234,2.0,v235,v236
v_fmac_f32 v236,-2.0,v235
M v[120:123],v[220:223],a[216:219],v[120:123]
s_waitcnt lgkmcnt(1)
v_and_b32 v196,s42,v196
v_and_b32 v192,s42,v192
M v[124:127],v[220:223],a[220:223],v[124:127]
buffer_load_dwordx4 v[220:223],v251,s[20:23],s46 offen offset:0 sc1
M v[128:131],v[224:227],a[192:195],v[128:131]
v_and_b32 v194,s42,v194
v_and_b32 v202,s42,v202
M v[132:135],v[224:227],a[196:199],v[132:135]
s_add_u32 s47,s78,21504
v_and_b32 v200,s42,v200
v_and_b32 v198,s42,v198
M v[136:139],v[224:227],a[200:203],v[136:139]
v_fmac_f32 v192,s43,v196
v_fmac_f32 v202,4.0,v194
M v[140:143],v[224:227],a[204:207],v[140:143]
v_fma_f32 v235,-4.0,v196,v200
v_fmac_f32 v192,s45,v200
M v[144:147],v[224:227],a[208:211],v[144:147]
v_fmac_f32 v202,s40,v198
v_sub_f32 v200,v200,v196
M v[148:151],v[224:227],a[212:215],v[148:151]
v_fma_f32 v196,-4.0,v194,v198
v_sub_f32 v198,v198,v194
M v[152:155],v[224:227],a[216:219],v[152:155]
s_waitcnt lgkmcnt(0)
s_barrier
v_add_f32 v194,v235,v196
M v[156:159],v[224:227],a[220:223],v[156:159]
buffer_load_dwordx4 v[224:227],v251,s[20:23],s47 offen offset:0 sc1
M v[160:163],v[228:231],a[192:195],v[160:163]
ds_read_b128 a[192:195],v249 offset:0
v_sub_f32 v235,v235,v196
M v[164:167],v[228:231],a[196:199],v[164:167]
s_add_u32 s48,s78,24576
ds_read_b128 a[196:199],v250 offset:256
v_fma_f32 v196,2.0,v198,v200
M v[168:171],v[228:231],a[200:203],v[168:171]
ds_read_b128 a[200:203],v250 offset:512
v_fmac_f32 v200,-2.0,v198
M v[172:175],v[228:231],a[204:207],v[172:175]
ds_read_b128 a[204:207],v250 offset:768
v_cvt_pk_bf16_f32 v192,v232,v192
M v[176:179],v[228:231],a[208:211],v[176:179]
ds_read_b128 a[208:211],v250 offset:1024
v_cvt_pk_bf16_f32 v202,v237,v202
M v[180:183],v[228:231],a[212:215],v[180:183]
ds_read_b128 a[212:215],v250 offset:1280
v_cvt_pk_bf16_f32 v194,v233,v194
M v[184:187],v[228:231],a[216:219],v[184:187]
ds_read_b128 a[216:219],v250 offset:1536
v_cvt_pk_bf16_f32 v198,v234,v196
M v[188:191],v[228:231],a[220:223],v[188:191]
s_waitcnt vmcnt(16) lgkmcnt(6)
buffer_load_dwordx4 v[228:231],v251,s[20:23],s48 offen offset:0 sc1
M a[0:3],a[224:227],a[192:195],a[0:3]
s_waitcnt lgkmcnt(5)
ds_read_b128 a[220:223],v250 offset:1792
v_cvt_pk_bf16_f32 v196,v238,v235
M a[4:7],a[224:227],a[196:199],a[4:7]
s_waitcnt lgkmcnt(5)
v_cvt_pk_bf16_f32 v200,v236,v200
v_lshlrev_b32 v234,16,v197
M a[8:11],a[224:227],a[200:203],a[8:11]
s_waitcnt lgkmcnt(4)
v_lshlrev_b32 v232,16,v193
v_lshlrev_b32 v233,16,v195
M a[12:15],a[224:227],a[204:207],a[12:15]
s_waitcnt lgkmcnt(3)
v_lshlrev_b32 v237,16,v203
v_lshlrev_b32 v236,16,v201
M a[16:19],a[224:227],a[208:211],a[16:19]
s_waitcnt lgkmcnt(2)
v_lshlrev_b32 v235,16,v199
v_fmac_f32 v232,s43,v234
M a[20:23],a[224:227],a[212:215],a[20:23]
s_waitcnt lgkmcnt(1)
v_fmac_f32 v237,4.0,v233
v_fma_f32 v238,-4.0,v234,v236
M a[24:27],a[224:227],a[216:219],a[24:27]
s_waitcnt lgkmcnt(0)
v_fmac_f32 v232,s45,v236
v_fmac_f32 v237,s40,v235
M a[28:31],a[224:227],a[220:223],a[28:31]
s_waitcnt vmcnt(16)
buffer_load_dwordx4 a[224:227],v251,s[20:23],s46 offen offset:1024 sc1
M a[32:35],a[228:231],a[192:195],a[32:35]
v_sub_f32 v236,v236,v234
v_fma_f32 v234,-4.0,v233,v235
M a[36:39],a[228:231],a[196:199],a[36:39]
v_sub_f32 v235,v235,v233
v_add_f32 v233,v238,v234
M a[40:43],a[228:231],a[200:203],a[40:43]
v_sub_f32 v238,v238,v234
v_fma_f32 v234,2.0,v235,v236
M a[44:47],a[228:231],a[204:207],a[44:47]
v_fmac_f32 v236,-2.0,v235
v_and_b32 v197,s42,v197
M a[48:51],a[228:231],a[208:211],a[48:51]
v_and_b32 v193,s42,v193
v_and_b32 v195,s42,v195
M a[52:55],a[228:231],a[212:215],a[52:55]
v_and_b32 v203,s42,v203
v_and_b32 v201,s42,v201
M a[56:59],a[228:231],a[216:219],a[56:59]
v_and_b32 v199,s42,v199
v_fmac_f32 v193,s43,v197
M a[60:63],a[228:231],a[220:223],a[60:63]
s_waitcnt vmcnt(16)
buffer_load_dwordx4 a[228:231],v251,s[20:23],s47 offen offset:1024 sc1
M a[64:67],a[232:235],a[192:195],a[64:67]
ds_read_b128 a[192:195],v250 offset:2048
v_fmac_f32 v203,4.0,v195
M a[68:71],a[232:235],a[196:199],a[68:71]
v_fma_f32 v235,-4.0,v197,v201
v_fmac_f32 v193,s45,v201
M a[72:75],a[232:235],a[200:203],a[72:75]
v_fmac_f32 v203,s40,v199
v_sub_f32 v201,v201,v197
M a[76:79],a[232:235],a[204:207],a[76:79]
v_fma_f32 v197,-4.0,v195,v199
v_sub_f32 v199,v199,v195
M a[80:83],a[232:235],a[208:211],a[80:83]
v_add_f32 v195,v235,v197
v_sub_f32 v235,v235,v197
M a[84:87],a[232:235],a[212:215],a[84:87]
v_fma_f32 v197,2.0,v199,v201
v_fmac_f32 v201,-2.0,v199
M a[88:91],a[232:235],a[216:219],a[88:91]
v_cvt_pk_bf16_f32 v193,v232,v193
v_cvt_pk_bf16_f32 v203,v237,v203
M a[92:95],a[232:235],a[220:223],a[92:95]
s_waitcnt vmcnt(16)
buffer_load_dwordx4 a[232:235],v251,s[20:23],s48 offen offset:1024 sc1
M a[0:3],a[236:239],a[196:199],a[0:3]
v_cvt_pk_bf16_f32 v195,v233,v195
v_cvt_pk_bf16_f32 v199,v234,v197
M a[4:7],a[236:239],a[200:203],a[4:7]
v_cvt_pk_bf16_f32 v197,v238,v235
v_cvt_pk_bf16_f32 v201,v236,v201
M a[8:11],a[236:239],a[204:207],a[8:11]
ds_write2st64_b64 v247,v[192:193],v[202:203] offset0:238 offset1:255
M a[12:15],a[236:239],a[208:211],a[12:15]
s_add_u32 s28,s67,786432
buffer_load_dwordx2 v[192:193],v245,s[12:15],s28 offen offset:0
M a[16:19],a[236:239],a[212:215],a[16:19]
buffer_load_dwordx2 v[202:203],v245,s[16:19],s28 offen offset:1536
M a[20:23],a[236:239],a[216:219],a[20:23]
ds_write2st64_b64 v247,v[194:195],v[196:197] offset0:102 offset1:119
M a[24:27],a[236:239],a[220:223],a[24:27]
s_waitcnt lgkmcnt(2)
buffer_load_dwordx2 v[194:195],v245,s[8:11],s28 offen offset:0
M a[28:31],a[236:239],a[192:195],a[28:31]
s_waitcnt vmcnt(19)
buffer_load_dwordx2 v[196:197],v245,s[8:11],s28 offen offset:384
M a[32:35],a[240:243],a[196:199],a[32:35]
buffer_load_dwordx4 a[236:239],v251,s[20:23],s46 offen offset:2048 sc1
M a[36:39],a[240:243],a[200:203],a[36:39]
ds_write2st64_b64 v247,v[198:199],v[200:201] offset0:136 offset1:153
M a[40:43],a[240:243],a[204:207],a[40:43]
buffer_load_dwordx2 v[198:199],v245,s[8:11],s28 offen offset:768
M a[44:47],a[240:243],a[208:211],a[44:47]
buffer_load_dwordx2 v[200:201],v245,s[8:11],s28 offen offset:1152
M a[48:51],a[240:243],a[212:215],a[48:51]
s_waitcnt vmcnt(17)
v_lshlrev_b32 v234,16,v208
v_lshlrev_b32 v232,16,v204
M a[52:55],a[240:243],a[216:219],a[52:55]
v_lshlrev_b32 v233,16,v206
v_lshlrev_b32 v237,16,v214
M a[56:59],a[240:243],a[220:223],a[56:59]
s_waitcnt vmcnt(14)
v_lshlrev_b32 v236,16,v212
v_lshlrev_b32 v235,16,v210
M a[60:63],a[240:243],a[192:195],a[60:63]
buffer_load_dwordx4 a[240:243],v251,s[20:23],s47 offen offset:2048 sc1
M a[64:67],a[244:247],a[196:199],a[64:67]
ds_read_b128 a[196:199],v249 offset:2304
v_fmac_f32 v232,s43,v234
M a[68:71],a[244:247],a[200:203],a[68:71]
v_fmac_f32 v237,4.0,v233
v_fma_f32 v238,-4.0,v234,v236
M a[72:75],a[244:247],a[204:207],a[72:75]
v_fmac_f32 v232,s45,v236
v_fmac_f32 v237,s40,v235
M a[76:79],a[244:247],a[208:211],a[76:79]
v_sub_f32 v236,v236,v234
v_fma_f32 v234,-4.0,v233,v235
M a[80:83],a[244:247],a[212:215],a[80:83]
v_sub_f32 v235,v235,v233
v_add_f32 v233,v238,v234
M a[84:87],a[244:247],a[216:219],a[84:87]
v_sub_f32 v238,v238,v234
v_fma_f32 v234,2.0,v235,v236
M a[88:91],a[244:247],a[220:223],a[88:91]
v_fmac_f32 v236,-2.0,v235
v_and_b32 v208,s42,v208
M a[92:95],a[244:247],a[192:195],a[92:95]
buffer_load_dwordx4 a[244:247],v251,s[20:23],s48 offen offset:2048 sc1
M a[0:3],a[248:251],a[200:203],a[0:3]
v_and_b32 v204,s42,v204
v_and_b32 v206,s42,v206
M a[4:7],a[248:251],a[204:207],a[4:7]
s_add_u32 s46,s78,27648
v_and_b32 v214,s42,v214
v_and_b32 v212,s42,v212
M a[8:11],a[248:251],a[208:211],a[8:11]
v_and_b32 v210,s42,v210
v_fmac_f32 v204,s43,v208
M a[12:15],a[248:251],a[212:215],a[12:15]
v_fmac_f32 v214,4.0,v206
v_fma_f32 v235,-4.0,v208,v212
M a[16:19],a[248:251],a[216:219],a[16:19]
v_fmac_f32 v204,s45,v212
v_fmac_f32 v214,s40,v210
M a[20:23],a[248:251],a[220:223],a[20:23]
v_sub_f32 v212,v212,v208
v_fma_f32 v208,-4.0,v206,v210
M a[24:27],a[248:251],a[192:195],a[24:27]
s_waitcnt lgkmcnt(0)
v_sub_f32 v210,v210,v206
v_add_f32 v206,v235,v208
M a[28:31],a[248:251],a[196:199],a[28:31]
buffer_load_dwordx4 a[248:251],v251,s[20:23],s46 offen offset:0 sc1
M a[32:35],a[252:255],a[200:203],a[32:35]
v_sub_f32 v235,v235,v208
v_fma_f32 v208,2.0,v210,v212
M a[36:39],a[252:255],a[204:207],a[36:39]
s_add_u32 s47,s78,30720
v_fmac_f32 v212,-2.0,v210
v_cvt_pk_bf16_f32 v204,v232,v204
M a[40:43],a[252:255],a[208:211],a[40:43]
v_cvt_pk_bf16_f32 v214,v237,v214
v_cvt_pk_bf16_f32 v206,v233,v206
M a[44:47],a[252:255],a[212:215],a[44:47]
v_cvt_pk_bf16_f32 v210,v234,v208
v_cvt_pk_bf16_f32 v208,v238,v235
M a[48:51],a[252:255],a[216:219],a[48:51]
v_cvt_pk_bf16_f32 v212,v236,v212
v_lshlrev_b32 v234,16,v209
M a[52:55],a[252:255],a[220:223],a[52:55]
v_lshlrev_b32 v232,16,v205
v_lshlrev_b32 v233,16,v207
M a[56:59],a[252:255],a[192:195],a[56:59]
v_lshlrev_b32 v237,16,v215
v_lshlrev_b32 v236,16,v213
M a[60:63],a[252:255],a[196:199],a[60:63]
s_waitcnt vmcnt(16)
buffer_load_dwordx4 a[252:255],v251,s[20:23],s47 offen offset:0 sc1
M a[64:67],v[216:219],a[200:203],a[64:67]
ds_read_b128 a[200:203],v249 offset:8704
v_lshlrev_b32 v235,16,v211
M a[68:71],v[216:219],a[204:207],a[68:71]
s_add_u32 s48,s78,33792
ds_read_b128 a[204:207],v250 offset:8960
v_fmac_f32 v232,s43,v234
M a[72:75],v[216:219],a[208:211],a[72:75]
ds_read_b128 a[208:211],v250 offset:9216
v_fmac_f32 v237,4.0,v233
M a[76:79],v[216:219],a[212:215],a[76:79]
ds_read_b128 a[212:215],v250 offset:9472
v_fma_f32 v238,-4.0,v234,v236
M a[80:83],v[216:219],a[216:219],a[80:83]
ds_read_b128 a[216:219],v250 offset:9728
v_fmac_f32 v232,s45,v236
M a[84:87],v[216:219],a[220:223],a[84:87]
ds_read_b128 a[220:223],v250 offset:9984
v_fmac_f32 v237,s40,v235
M a[88:91],v[216:219],a[192:195],a[88:91]
ds_read_b128 a[192:195],v250 offset:10240
v_sub_f32 v236,v236,v234
M a[92:95],v[216:219],a[196:199],a[92:95]
s_waitcnt vmcnt(16) lgkmcnt(6)
buffer_load_dwordx4 v[216:219],v251,s[20:23],s48 offen offset:0 sc1
M a[96:99],v[220:223],a[200:203],a[96:99]
s_waitcnt lgkmcnt(5)
ds_read_b128 a[196:199],v250 offset:10496
v_fma_f32 v234,-4.0,v233,v235
M a[100:103],v[220:223],a[204:207],a[100:103]
s_waitcnt lgkmcnt(5)
v_sub_f32 v235,v235,v233
v_add_f32 v233,v238,v234
M a[104:107],v[220:223],a[208:211],a[104:107]
s_waitcnt lgkmcnt(4)
v_sub_f32 v238,v238,v234
v_fma_f32 v234,2.0,v235,v236
M a[108:111],v[220:223],a[212:215],a[108:111]
s_waitcnt lgkmcnt(3)
v_fmac_f32 v236,-2.0,v235
v_and_b32 v209,s42,v209
M a[112:115],v[220:223],a[216:219],a[112:115]
s_waitcnt lgkmcnt(2)
v_and_b32 v205,s42,v205
v_and_b32 v207,s42,v207
M a[116:119],v[220:223],a[220:223],a[116:119]
s_waitcnt lgkmcnt(1)
v_and_b32 v215,s42,v215
v_and_b32 v213,s42,v213
M a[120:123],v[220:223],a[192:195],a[120:123]
s_waitcnt lgkmcnt(0)
v_and_b32 v211,s42,v211
v_fmac_f32 v205,s43,v209
M a[124:127],v[220:223],a[196:199],a[124:127]
s_waitcnt vmcnt(16)
buffer_load_dwordx4 v[220:223],v251,s[20:23],s46 offen offset:1024 sc1
M a[128:131],v[224:227],a[200:203],a[128:131]
v_fmac_f32 v215,4.0,v207
v_fma_f32 v235,-4.0,v209,v213
M a[132:135],v[224:227],a[204:207],a[132:135]
v_fmac_f32 v205,s45,v213
v_fmac_f32 v215,s40,v211
M a[136:139],v[224:227],a[208:211],a[136:139]
v_sub_f32 v213,v213,v209
v_fma_f32 v209,-4.0,v207,v211
M a[140:143],v[224:227],a[212:215],a[140:143]
v_sub_f32 v211,v211,v207
v_add_f32 v207,v235,v209
M a[144:147],v[224:227],a[216:219],a[144:147]
v_sub_f32 v235,v235,v209
v_fma_f32 v209,2.0,v211,v213
M a[148:151],v[224:227],a[220:223],a[148:151]
v_fmac_f32 v213,-2.0,v211
v_cvt_pk_bf16_f32 v205,v232,v205
M a[152:155],v[224:227],a[192:195],a[152:155]
v_cvt_pk_bf16_f32 v215,v237,v215
v_cvt_pk_bf16_f32 v207,v233,v207
M a[156:159],v[224:227],a[196:199],a[156:159]
s_waitcnt vmcnt(16)
buffer_load_dwordx4 v[224:227],v251,s[20:23],s47 offen offset:1024 sc1
M a[160:163],v[228:231],a[200:203],a[160:163]
ds_read_b128 a[200:203],v250 offset:10752
v_cvt_pk_bf16_f32 v211,v234,v209
M a[164:167],v[228:231],a[204:207],a[164:167]
v_cvt_pk_bf16_f32 v209,v238,v235
v_cvt_pk_bf16_f32 v213,v236,v213
M a[168:171],v[228:231],a[208:211],a[168:171]
v_add_u32 v232,121856,v247
M a[172:175],v[228:231],a[212:215],a[172:175]
ds_write2st64_b64 v232,v[204:205],v[214:215] offset0:1 offset1:18
M a[176:179],v[228:231],a[216:219],a[176:179]
s_add_u32 s28,s67,1179648
buffer_load_dwordx2 v[204:205],v245,s[12:15],s28 offen offset:0
M a[180:183],v[228:231],a[220:223],a[180:183]
buffer_load_dwordx2 v[214:215],v245,s[16:19],s28 offen offset:1536
M a[184:187],v[228:231],a[192:195],a[184:187]
ds_write2st64_b64 v247,v[206:207],v[208:209] offset0:103 offset1:120
M a[188:191],v[228:231],a[196:199],a[188:191]
s_waitcnt vmcnt(18)
buffer_load_dwordx2 v[206:207],v245,s[8:11],s28 offen offset:0
M a[96:99],a[224:227],a[204:207],a[96:99]
buffer_load_dwordx2 v[208:209],v245,s[8:11],s28 offen offset:384
M a[100:103],a[224:227],a[208:211],a[100:103]
buffer_load_dwordx4 v[228:231],v251,s[20:23],s48 offen offset:1024 sc1
M a[104:107],a[224:227],a[212:215],a[104:107]
ds_write2st64_b64 v247,v[210:211],v[212:213] offset0:137 offset1:154
M a[108:111],a[224:227],a[216:219],a[108:111]
buffer_load_dwordx2 v[210:211],v245,s[8:11],s28 offen offset:768
M a[112:115],a[224:227],a[220:223],a[112:115]
buffer_load_dwordx2 v[212:213],v245,s[8:11],s28 offen offset:1152
M a[116:119],a[224:227],a[192:195],a[116:119]
v_fmac_f32 v239,s43,v241
v_fmac_f32 v244,4.0,v240
M a[120:123],a[224:227],a[196:199],a[120:123]
s_waitcnt lgkmcnt(3)
v_fma_f32 v232,-4.0,v241,v243
v_fmac_f32 v239,s45,v243
M a[124:127],a[224:227],a[200:203],a[124:127]
s_waitcnt vmcnt(22)
buffer_load_dwordx4 a[224:227],v251,s[20:23],s46 offen offset:2048 sc1
M a[128:131],a[228:231],a[204:207],a[128:131]
v_fmac_f32 v244,s40,v242
v_sub_f32 v243,v243,v241
M a[132:135],a[228:231],a[208:211],a[132:135]
v_fma_f32 v241,-4.0,v240,v242
v_sub_f32 v242,v242,v240
M a[136:139],a[228:231],a[212:215],a[136:139]
v_add_f32 v240,v232,v241
v_sub_f32 v232,v232,v241
M a[140:143],a[228:231],a[216:219],a[140:143]
v_fma_f32 v241,2.0,v242,v243
v_fmac_f32 v243,-2.0,v242
M a[144:147],a[228:231],a[220:223],a[144:147]
v_cvt_pk_bf16_f32 v233,v239,v244
v_cvt_pk_bf16_f32 v234,v240,v232
M a[148:151],a[228:231],a[192:195],a[148:151]
v_cvt_pk_bf16_f32 v235,v241,v243
v_add_u32 v232,121856,v248
M a[152:155],a[228:231],a[196:199],a[152:155]
buffer_load_short_d16_hi v239,v246,s[12:15],s74 offen offset:0
M a[156:159],a[228:231],a[200:203],a[156:159]
s_waitcnt vmcnt(23)
buffer_load_short_d16_hi v240,v246,s[8:11],s74 offen offset:0
M a[160:163],a[232:235],a[204:207],a[160:163]
buffer_load_short_d16_hi v241,v246,s[8:11],s74 offen offset:384
M a[164:167],a[232:235],a[208:211],a[164:167]
buffer_load_short_d16_hi v242,v246,s[8:11],s74 offen offset:768
M a[168:171],a[232:235],a[212:215],a[168:171]
buffer_load_short_d16_hi v243,v246,s[8:11],s74 offen offset:1152
M a[172:175],a[232:235],a[216:219],a[172:175]
buffer_load_short_d16_hi v244,v246,s[16:19],s74 offen offset:1536
M a[176:179],a[232:235],a[220:223],a[176:179]
buffer_load_dwordx4 a[228:231],v251,s[20:23],s47 offen offset:2048 sc1
M a[180:183],a[232:235],a[192:195],a[180:183]
ds_read_b128 a[204:207],v249 offset:11008
ds_write_b16 v232,v233 offset:0
M a[184:187],a[232:235],a[196:199],a[184:187]
ds_write_b16_d16_hi v232,v233 offset:8704
M a[188:191],a[232:235],a[200:203],a[188:191]
s_waitcnt vmcnt(24)
buffer_load_dwordx4 a[232:235],v251,s[20:23],s48 offen offset:2048 sc1
M a[96:99],a[236:239],a[208:211],a[96:99]
ds_write_b16 v248,v234 offset:52224
M a[100:103],a[236:239],a[212:215],a[100:103]
s_add_u32 s46,s78,36864
ds_write_b16_d16_hi v248,v234 offset:60928
M a[104:107],a[236:239],a[216:219],a[104:107]
v_add_u32 v232,69632,v248
M a[108:111],a[236:239],a[220:223],a[108:111]
ds_write_b16 v232,v235 offset:0
M a[112:115],a[236:239],a[192:195],a[112:115]
ds_write_b16_d16_hi v232,v235 offset:8704
M a[116:119],a[236:239],a[196:199],a[116:119]
v_lshlrev_b32 v234,16,v196
v_lshlrev_b32 v232,16,v192
M a[120:123],a[236:239],a[200:203],a[120:123]
s_waitcnt lgkmcnt(6)
v_lshlrev_b32 v233,16,v194
v_lshlrev_b32 v237,16,v202
M a[124:127],a[236:239],a[204:207],a[124:127]
s_waitcnt vmcnt(22)
buffer_load_dwordx4 a[236:239],v251,s[20:23],s46 offen offset:0 sc1
M a[128:131],a[240:243],a[208:211],a[128:131]
v_lshlrev_b32 v236,16,v200
v_lshlrev_b32 v235,16,v198
M a[132:135],a[240:243],a[212:215],a[132:135]
s_add_u32 s47,s78,39936
v_fmac_f32 v232,s43,v234
v_fmac_f32 v237,4.0,v233
M a[136:139],a[240:243],a[216:219],a[136:139]
v_fma_f32 v238,-4.0,v234,v236
v_fmac_f32 v232,s45,v236
M a[140:143],a[240:243],a[220:223],a[140:143]
v_fmac_f32 v237,s40,v235
v_sub_f32 v236,v236,v234
M a[144:147],a[240:243],a[192:195],a[144:147]
v_fma_f32 v234,-4.0,v233,v235
v_sub_f32 v235,v235,v233
M a[148:151],a[240:243],a[196:199],a[148:151]
v_add_f32 v233,v238,v234
v_sub_f32 v238,v238,v234
M a[152:155],a[240:243],a[200:203],a[152:155]
v_fma_f32 v234,2.0,v235,v236
v_fmac_f32 v236,-2.0,v235
M a[156:159],a[240:243],a[204:207],a[156:159]
s_waitcnt vmcnt(22)
buffer_load_dwordx4 a[240:243],v251,s[20:23],s47 offen offset:0 sc1
M a[160:163],a[244:247],a[208:211],a[160:163]
ds_read_b128 a[208:211],v249 offset:17408
v_and_b32 v196,s42,v196
M a[164:167],a[244:247],a[212:215],a[164:167]
s_add_u32 s48,s78,43008
ds_read_b128 a[212:215],v250 offset:17664
v_and_b32 v192,s42,v192
M a[168:171],a[244:247],a[216:219],a[168:171]
ds_read_b128 a[216:219],v250 offset:17920
v_and_b32 v194,s42,v194
M a[172:175],a[244:247],a[220:223],a[172:175]
ds_read_b128 a[220:223],v250 offset:18176
v_and_b32 v202,s42,v202
M a[176:179],a[244:247],a[192:195],a[176:179]
ds_read_b128 a[192:195],v250 offset:18432
v_and_b32 v200,s42,v200
M a[180:183],a[244:247],a[196:199],a[180:183]
ds_read_b128 a[196:199],v250 offset:18688
v_and_b32 v198,s42,v198
M a[184:187],a[244:247],a[200:203],a[184:187]
ds_read_b128 a[200:203],v250 offset:18944
v_fmac_f32 v192,s43,v196
M a[188:191],a[244:247],a[204:207],a[188:191]
s_waitcnt vmcnt(22) lgkmcnt(6)
buffer_load_dwordx4 a[244:247],v251,s[20:23],s48 offen offset:0 sc1
M v[0:3],a[248:251],a[208:211],v[0:3]
s_waitcnt lgkmcnt(5)
ds_read_b128 a[204:207],v250 offset:19200
v_fmac_f32 v202,4.0,v194
M v[4:7],a[248:251],a[212:215],v[4:7]
s_waitcnt lgkmcnt(5)
v_fma_f32 v235,-4.0,v196,v200
v_fmac_f32 v192,s45,v200
M v[8:11],a[248:251],a[216:219],v[8:11]
s_waitcnt lgkmcnt(4)
v_fmac_f32 v202,s40,v198
v_sub_f32 v200,v200,v196
M v[12:15],a[248:251],a[220:223],v[12:15]
s_waitcnt lgkmcnt(3)
v_fma_f32 v196,-4.0,v194,v198
v_sub_f32 v198,v198,v194
M v[16:19],a[248:251],a[192:195],v[16:19]
s_waitcnt lgkmcnt(2)
v_add_f32 v194,v235,v196
v_sub_f32 v235,v235,v196
M v[20:23],a[248:251],a[196:199],v[20:23]
s_waitcnt lgkmcnt(1)
v_fma_f32 v196,2.0,v198,v200
v_fmac_f32 v200,-2.0,v198
M v[24:27],a[248:251],a[200:203],v[24:27]
s_waitcnt lgkmcnt(0)
v_cvt_pk_bf16_f32 v192,v232,v192
v_cvt_pk_bf16_f32 v202,v237,v202
M v[28:31],a[248:251],a[204:207],v[28:31]
s_waitcnt vmcnt(22)
buffer_load_dwordx4 a[248:251],v251,s[20:23],s46 offen offset:1024 sc1
M v[32:35],a[252:255],a[208:211],v[32:35]
v_cvt_pk_bf16_f32 v194,v233,v194
v_cvt_pk_bf16_f32 v198,v234,v196
M v[36:39],a[252:255],a[212:215],v[36:39]
v_cvt_pk_bf16_f32 v196,v238,v235
v_cvt_pk_bf16_f32 v200,v236,v200
M v[40:43],a[252:255],a[216:219],v[40:43]
v_lshlrev_b32 v234,16,v197
v_lshlrev_b32 v232,16,v193
M v[44:47],a[252:255],a[220:223],v[44:47]
v_lshlrev_b32 v233,16,v195
v_lshlrev_b32 v237,16,v203
M v[48:51],a[252:255],a[192:195],v[48:51]
v_lshlrev_b32 v236,16,v201
v_lshlrev_b32 v235,16,v199
M v[52:55],a[252:255],a[196:199],v[52:55]
v_fmac_f32 v232,s43,v234
v_fmac_f32 v237,4.0,v233
M v[56:59],a[252:255],a[200:203],v[56:59]
v_fma_f32 v238,-4.0,v234,v236
v_fmac_f32 v232,s45,v236
M v[60:63],a[252:255],a[204:207],v[60:63]
s_waitcnt vmcnt(22)
buffer_load_dwordx4 a[252:255],v251,s[20:23],s47 offen offset:1024 sc1
M v[64:67],v[216:219],a[208:211],v[64:67]
ds_read_b128 a[208:211],v250 offset:19456
v_fmac_f32 v237,s40,v235
M v[68:71],v[216:219],a[212:215],v[68:71]
v_sub_f32 v236,v236,v234
v_fma_f32 v234,-4.0,v233,v235
M v[72:75],v[216:219],a[216:219],v[72:75]
v_sub_f32 v235,v235,v233
v_add_f32 v233,v238,v234
M v[76:79],v[216:219],a[220:223],v[76:79]
v_sub_f32 v238,v238,v234
v_fma_f32 v234,2.0,v235,v236
M v[80:83],v[216:219],a[192:195],v[80:83]
v_fmac_f32 v236,-2.0,v235
v_and_b32 v197,s42,v197
M v[84:87],v[216:219],a[196:199],v[84:87]
v_and_b32 v193,s42,v193
v_and_b32 v195,s42,v195
M v[88:91],v[216:219],a[200:203],v[88:91]
v_and_b32 v203,s42,v203
v_and_b32 v201,s42,v201
M v[92:95],v[216:219],a[204:207],v[92:95]
s_waitcnt vmcnt(22)
buffer_load_dwordx4 v[216:219],v251,s[20:23],s48 offen offset:1024 sc1
M v[0:3],v[220:223],a[212:215],v[0:3]
v_and_b32 v199,s42,v199
v_fmac_f32 v193,s43,v197
M v[4:7],v[220:223],a[216:219],v[4:7]
v_fmac_f32 v203,4.0,v195
v_fma_f32 v235,-4.0,v197,v201
M v[8:11],v[220:223],a[220:223],v[8:11]
v_fmac_f32 v193,s45,v201
v_fmac_f32 v203,s40,v199
M v[12:15],v[220:223],a[192:195],v[12:15]
v_sub_f32 v201,v201,v197
v_fma_f32 v197,-4.0,v195,v199
M v[16:19],v[220:223],a[196:199],v[16:19]
v_sub_f32 v199,v199,v195
v_add_f32 v195,v235,v197
M v[20:23],v[220:223],a[200:203],v[20:23]
v_sub_f32 v235,v235,v197
v_fma_f32 v197,2.0,v199,v201
M v[24:27],v[220:223],a[204:207],v[24:27]
s_waitcnt lgkmcnt(0)
v_fmac_f32 v201,-2.0,v199
v_cvt_pk_bf16_f32 v193,v232,v193
M v[28:31],v[220:223],a[208:211],v[28:31]
s_waitcnt vmcnt(22)
buffer_load_dwordx4 v[220:223],v251,s[20:23],s46 offen offset:2048 sc1
M v[32:35],v[224:227],a[212:215],v[32:35]
v_cvt_pk_bf16_f32 v203,v237,v203
v_cvt_pk_bf16_f32 v195,v233,v195
M v[36:39],v[224:227],a[216:219],v[36:39]
v_cvt_pk_bf16_f32 v199,v234,v197
v_cvt_pk_bf16_f32 v197,v238,v235
M v[40:43],v[224:227],a[220:223],v[40:43]
v_cvt_pk_bf16_f32 v201,v236,v201
v_add_u32 v232,121856,v247
M v[44:47],v[224:227],a[192:195],v[44:47]
ds_write2st64_b64 v232,v[192:193],v[202:203] offset0:2 offset1:19
M v[48:51],v[224:227],a[196:199],v[48:51]
s_add_u32 s28,s68,0
buffer_load_dwordx2 v[192:193],v245,s[12:15],s28 offen offset:0
M v[52:55],v[224:227],a[200:203],v[52:55]
buffer_load_dwordx2 v[202:203],v245,s[16:19],s28 offen offset:1536
M v[56:59],v[224:227],a[204:207],v[56:59]
ds_write2st64_b64 v247,v[194:195],v[196:197] offset0:104 offset1:121
M v[60:63],v[224:227],a[208:211],v[60:63]
s_waitcnt vmcnt(20)
buffer_load_dwordx2 v[194:195],v245,s[8:11],s28 offen offset:0
M v[64:67],v[228:231],a[212:215],v[64:67]
buffer_load_dwordx2 v[196:197],v245,s[8:11],s28 offen offset:384
M v[68:71],v[228:231],a[216:219],v[68:71]
buffer_load_dwordx4 v[224:227],v251,s[20:23],s47 offen offset:2048 sc1
M v[72:75],v[228:231],a[220:223],v[72:75]
ds_read_b128 a[212:215],v249 offset:19712
ds_write2st64_b64 v247,v[198:199],v[200:201] offset0:138 offset1:155
M v[76:79],v[228:231],a[192:195],v[76:79]
buffer_load_dwordx2 v[198:199],v245,s[8:11],s28 offen offset:768
M v[80:83],v[228:231],a[196:199],v[80:83]
buffer_load_dwordx2 v[200:201],v245,s[8:11],s28 offen offset:1152
M v[84:87],v[228:231],a[200:203],v[84:87]
v_lshlrev_b32 v234,16,v208
v_lshlrev_b32 v232,16,v204
M v[88:91],v[228:231],a[204:207],v[88:91]
v_lshlrev_b32 v233,16,v206
v_lshlrev_b32 v237,16,v214
M v[92:95],v[228:231],a[208:211],v[92:95]
s_waitcnt vmcnt(22)
buffer_load_dwordx4 v[228:231],v251,s[20:23],s48 offen offset:2048 sc1
M v[0:3],a[224:227],a[216:219],v[0:3]
v_lshlrev_b32 v236,16,v212
v_lshlrev_b32 v235,16,v210
M v[4:7],a[224:227],a[220:223],v[4:7]
s_add_u32 s46,s79,9216
v_fmac_f32 v232,s43,v234
v_fmac_f32 v237,4.0,v233
M v[8:11],a[224:227],a[192:195],v[8:11]
v_fma_f32 v238,-4.0,v234,v236
v_fmac_f32 v232,s45,v236
M v[12:15],a[224:227],a[196:199],v[12:15]
v_fmac_f32 v237,s40,v235
v_sub_f32 v236,v236,v234
M v[16:19],a[224:227],a[200:203],v[16:19]
v_fma_f32 v234,-4.0,v233,v235
v_sub_f32 v235,v235,v233
M v[20:23],a[224:227],a[204:207],v[20:23]
v_add_f32 v233,v238,v234
v_sub_f32 v238,v238,v234
M v[24:27],a[224:227],a[208:211],v[24:27]
s_waitcnt lgkmcnt(1)
v_fma_f32 v234,2.0,v235,v236
v_fmac_f32 v236,-2.0,v235
M v[28:31],a[224:227],a[212:215],v[28:31]
s_waitcnt vmcnt(16)
buffer_load_dwordx4 a[224:227],v251,s[20:23],s46 offen offset:0 sc1
M v[32:35],a[228:231],a[216:219],v[32:35]
v_and_b32 v208,s42,v208
v_and_b32 v204,s42,v204
M v[36:39],a[228:231],a[220:223],v[36:39]
s_add_u32 s47,s79,12288
v_and_b32 v206,s42,v206
v_and_b32 v214,s42,v214
M v[40:43],a[228:231],a[192:195],v[40:43]
v_and_b32 v212,s42,v212
v_and_b32 v210,s42,v210
M v[44:47],a[228:231],a[196:199],v[44:47]
v_fmac_f32 v204,s43,v208
v_fmac_f32 v214,4.0,v206
M v[48:51],a[228:231],a[200:203],v[48:51]
v_fma_f32 v235,-4.0,v208,v212
v_fmac_f32 v204,s45,v212
M v[52:55],a[228:231],a[204:207],v[52:55]
v_fmac_f32 v214,s40,v210
v_sub_f32 v212,v212,v208
M v[56:59],a[228:231],a[208:211],v[56:59]
v_fma_f32 v208,-4.0,v206,v210
v_sub_f32 v210,v210,v206
M v[60:63],a[228:231],a[212:215],v[60:63]
s_waitcnt vmcnt(16)
buffer_load_dwordx4 a[228:231],v251,s[20:23],s47 offen offset:0 sc1
M v[64:67],a[232:235],a[216:219],v[64:67]
ds_read_b128 a[216:219],v249 offset:26112
v_add_f32 v206,v235,v208
M v[68:71],a[232:235],a[220:223],v[68:71]
s_add_u32 s48,s79,15360
ds_read_b128 a[220:223],v250 offset:26368
v_sub_f32 v235,v235,v208
M v[72:75],a[232:235],a[192:195],v[72:75]
ds_read_b128 a[192:195],v250 offset:26624
v_fma_f32 v208,2.0,v210,v212
M v[76:79],a[232:235],a[196:199],v[76:79]
ds_read_b128 a[196:199],v250 offset:26880
v_fmac_f32 v212,-2.0,v210
M v[80:83],a[232:235],a[200:203],v[80:83]
ds_read_b128 a[200:203],v250 offset:27136
v_cvt_pk_bf16_f32 v204,v232,v204
M v[84:87],a[232:235],a[204:207],v[84:87]
ds_read_b128 a[204:207],v250 offset:27392
v_cvt_pk_bf16_f32 v214,v237,v214
M v[88:91],a[232:235],a[208:211],v[88:91]
ds_read_b128 a[208:211],v250 offset:27648
v_cvt_pk_bf16_f32 v206,v233,v206
M v[92:95],a[232:235],a[212:215],v[92:95]
s_waitcnt vmcnt(16) lgkmcnt(6)
buffer_load_dwordx4 a[232:235],v251,s[20:23],s48 offen offset:0 sc1
M v[96:99],a[236:239],a[216:219],v[96:99]
s_waitcnt lgkmcnt(5)
ds_read_b128 a[212:215],v250 offset:27904
v_cvt_pk_bf16_f32 v210,v234,v208
M v[100:103],a[236:239],a[220:223],v[100:103]
s_waitcnt lgkmcnt(5)
v_cvt_pk_bf16_f32 v208,v238,v235
v_cvt_pk_bf16_f32 v212,v236,v212
M v[104:107],a[236:239],a[192:195],v[104:107]
s_waitcnt lgkmcnt(4)
v_lshlrev_b32 v234,16,v209
v_lshlrev_b32 v232,16,v205
M v[108:111],a[236:239],a[196:199],v[108:111]
s_waitcnt lgkmcnt(3)
v_lshlrev_b32 v233,16,v207
v_lshlrev_b32 v237,16,v215
M v[112:115],a[236:239],a[200:203],v[112:115]
s_waitcnt lgkmcnt(2)
v_lshlrev_b32 v236,16,v213
v_lshlrev_b32 v235,16,v211
M v[116:119],a[236:239],a[204:207],v[116:119]
s_waitcnt lgkmcnt(1)
v_fmac_f32 v232,s43,v234
v_fmac_f32 v237,4.0,v233
M v[120:123],a[236:239],a[208:211],v[120:123]
s_waitcnt lgkmcnt(0)
v_fma_f32 v238,-4.0,v234,v236
v_fmac_f32 v232,s45,v236
M v[124:127],a[236:239],a[212:215],v[124:127]
s_waitcnt vmcnt(16)
buffer_load_dwordx4 a[236:239],v251,s[20:23],s46 offen offset:1024 sc1
M v[128:131],a[240:243],a[216:219],v[128:131]
v_fmac_f32 v237,s40,v235
v_sub_f32 v236,v236,v234
M v[132:135],a[240:243],a[220:223],v[132:135]
v_fma_f32 v234,-4.0,v233,v235
v_sub_f32 v235,v235,v233
M v[136:139],a[240:243],a[192:195],v[136:139]
v_add_f32 v233,v238,v234
v_sub_f32 v238,v238,v234
M v[140:143],a[240:243],a[196:199],v[140:143]
v_fma_f32 v234,2.0,v235,v236
v_fmac_f32 v236,-2.0,v235
M v[144:147],a[240:243],a[200:203],v[144:147]
v_and_b32 v209,s42,v209
v_and_b32 v205,s42,v205
M v[148:151],a[240:243],a[204:207],v[148:151]
v_and_b32 v207,s42,v207
v_and_b32 v215,s42,v215
M v[152:155],a[240:243],a[208:211],v[152:155]
v_and_b32 v213,s42,v213
v_and_b32 v211,s42,v211
M v[156:159],a[240:243],a[212:215],v[156:159]
s_waitcnt vmcnt(16)
buffer_load_dwordx4 a[240:243],v251,s[20:23],s47 offen offset:1024 sc1
M v[160:163],a[244:247],a[216:219],v[160:163]
ds_read_b128 a[216:219],v250 offset:28160
v_fmac_f32 v205,s43,v209
M v[164:167],a[244:247],a[220:223],v[164:167]
v_fmac_f32 v215,4.0,v207
v_fma_f32 v235,-4.0,v209,v213
M v[168:171],a[244:247],a[192:195],v[168:171]
v_fmac_f32 v205,s45,v213
v_fmac_f32 v215,s40,v211
M v[172:175],a[244:247],a[196:199],v[172:175]
v_sub_f32 v213,v213,v209
v_fma_f32 v209,-4.0,v207,v211
M v[176:179],a[244:247],a[200:203],v[176:179]
v_sub_f32 v211,v211,v207
v_add_f32 v207,v235,v209
M v[180:183],a[244:247],a[204:207],v[180:183]
v_sub_f32 v235,v235,v209
v_fma_f32 v209,2.0,v211,v213
M v[184:187],a[244:247],a[208:211],v[184:187]
v_fmac_f32 v213,-2.0,v211
v_cvt_pk_bf16_f32 v205,v232,v205
M v[188:191],a[244:247],a[212:215],v[188:191]
s_waitcnt vmcnt(16)
buffer_load_dwordx4 a[244:247],v251,s[20:23],s48 offen offset:1024 sc1
M v[96:99],a[248:251],a[220:223],v[96:99]
v_cvt_pk_bf16_f32 v215,v237,v215
v_cvt_pk_bf16_f32 v207,v233,v207
M v[100:103],a[248:251],a[192:195],v[100:103]
v_cvt_pk_bf16_f32 v211,v234,v209
v_cvt_pk_bf16_f32 v209,v238,v235
M v[104:107],a[248:251],a[196:199],v[104:107]
v_cvt_pk_bf16_f32 v213,v236,v213
v_add_u32 v232,121856,v247
M v[108:111],a[248:251],a[200:203],v[108:111]
ds_write2st64_b64 v232,v[204:205],v[214:215] offset0:3 offset1:20
M v[112:115],a[248:251],a[204:207],v[112:115]
s_add_u32 s28,s68,393216
buffer_load_dwordx2 v[204:205],v245,s[12:15],s28 offen offset:0
M v[116:119],a[248:251],a[208:211],v[116:119]
buffer_load_dwordx2 v[214:215],v245,s[16:19],s28 offen offset:1536
M v[120:123],a[248:251],a[212:215],v[120:123]
s_waitcnt lgkmcnt(1)
ds_write2st64_b64 v247,v[206:207],v[208:209] offset0:105 offset1:122
M v[124:127],a[248:251],a[216:219],v[124:127]
s_waitcnt vmcnt(18)
buffer_load_dwordx2 v[206:207],v245,s[8:11],s28 offen offset:0
M v[128:131],a[252:255],a[220:223],v[128:131]
buffer_load_dwordx2 v[208:209],v245,s[8:11],s28 offen offset:384
M v[132:135],a[252:255],a[192:195],v[132:135]
buffer_load_dwordx4 a[248:251],v251,s[20:23],s46 offen offset:2048 sc1
M v[136:139],a[252:255],a[196:199],v[136:139]
ds_write2st64_b64 v247,v[210:211],v[212:213] offset0:139 offset1:156
M v[140:143],a[252:255],a[200:203],v[140:143]
buffer_load_dwordx2 v[210:211],v245,s[8:11],s28 offen offset:768
M v[144:147],a[252:255],a[204:207],v[144:147]
buffer_load_dwordx2 v[212:213],v245,s[8:11],s28 offen offset:1152
M v[148:151],a[252:255],a[208:211],v[148:151]
s_waitcnt vmcnt(17)
v_lshlrev_b32 v234,16,v196
v_lshlrev_b32 v232,16,v192
M v[152:155],a[252:255],a[212:215],v[152:155]
v_lshlrev_b32 v233,16,v194
v_lshlrev_b32 v237,16,v202
M v[156:159],a[252:255],a[216:219],v[156:159]
buffer_load_dwordx4 a[252:255],v251,s[20:23],s47 offen offset:2048 sc1
M v[160:163],v[216:219],a[220:223],v[160:163]
s_waitcnt vmcnt(15)
ds_read_b128 a[220:223],v249 offset:28416
v_lshlrev_b32 v236,16,v200
M v[164:167],v[216:219],a[192:195],v[164:167]
v_lshlrev_b32 v235,16,v198
v_fmac_f32 v232,s43,v234
M v[168:171],v[216:219],a[196:199],v[168:171]
v_fmac_f32 v237,4.0,v233
v_fma_f32 v238,-4.0,v234,v236
M v[172:175],v[216:219],a[200:203],v[172:175]
v_fmac_f32 v232,s45,v236
v_fmac_f32 v237,s40,v235
M v[176:179],v[216:219],a[204:207],v[176:179]
v_sub_f32 v236,v236,v234
v_fma_f32 v234,-4.0,v233,v235
M v[180:183],v[216:219],a[208:211],v[180:183]
v_sub_f32 v235,v235,v233
v_add_f32 v233,v238,v234
M v[184:187],v[216:219],a[212:215],v[184:187]
v_sub_f32 v238,v238,v234
v_fma_f32 v234,2.0,v235,v236
M v[188:191],v[216:219],a[216:219],v[188:191]
buffer_load_dwordx4 v[216:219],v251,s[20:23],s48 offen offset:2048 sc1
M v[96:99],v[220:223],a[192:195],v[96:99]
v_fmac_f32 v236,-2.0,v235
v_and_b32 v196,s42,v196
M v[100:103],v[220:223],a[196:199],v[100:103]
s_add_u32 s46,s79,18432
v_and_b32 v192,s42,v192
v_and_b32 v194,s42,v194
M v[104:107],v[220:223],a[200:203],v[104:107]
v_and_b32 v202,s42,v202
v_and_b32 v200,s42,v200
M v[108:111],v[220:223],a[204:207],v[108:111]
v_and_b32 v198,s42,v198
v_fmac_f32 v192,s43,v196
M v[112:115],v[220:223],a[208:211],v[112:115]
v_fmac_f32 v202,4.0,v194
v_fma_f32 v235,-4.0,v196,v200
M v[116:119],v[220:223],a[212:215],v[116:119]
v_fmac_f32 v192,s45,v200
v_fmac_f32 v202,s40,v198
M v[120:123],v[220:223],a[216:219],v[120:123]
s_waitcnt lgkmcnt(0)
v_sub_f32 v200,v200,v196
v_fma_f32 v196,-4.0,v194,v198
M v[124:127],v[220:223],a[220:223],v[124:127]
buffer_load_dwordx4 v[220:223],v251,s[20:23],s46 offen offset:0 sc1
M v[128:131],v[224:227],a[192:195],v[128:131]
v_sub_f32 v198,v198,v194
v_add_f32 v194,v235,v196
M v[132:135],v[224:227],a[196:199],v[132:135]
s_add_u32 s47,s79,21504
v_sub_f32 v235,v235,v196
v_fma_f32 v196,2.0,v198,v200
M v[136:139],v[224:227],a[200:203],v[136:139]
v_fmac_f32 v200,-2.0,v198
v_cvt_pk_bf16_f32 v192,v232,v192
M v[140:143],v[224:227],a[204:207],v[140:143]
v_cvt_pk_bf16_f32 v202,v237,v202
v_cvt_pk_bf16_f32 v194,v233,v194
M v[144:147],v[224:227],a[208:211],v[144:147]
v_cvt_pk_bf16_f32 v198,v234,v196
v_cvt_pk_bf16_f32 v196,v238,v235
M v[148:151],v[224:227],a[212:215],v[148:151]
v_cvt_pk_bf16_f32 v200,v236,v200
v_lshlrev_b32 v234,16,v197
M v[152:155],v[224:227],a[216:219],v[152:155]
s_barrier
v_lshlrev_b32 v232,16,v193
M v[156:159],v[224:227],a[220:223],v[156:159]
s_waitcnt vmcnt(16)
buffer_load_dwordx4 v[224:227],v251,s[20:23],s47 offen offset:0 sc1
M v[160:163],v[228:231],a[192:195],v[160:163]
ds_read_b128 a[192:195],v249 offset:34816
v_lshlrev_b32 v233,16,v195
M v[164:167],v[228:231],a[196:199],v[164:167]
s_add_u32 s48,s79,24576
ds_read_b128 a[196:199],v250 offset:35072
v_lshlrev_b32 v237,16,v203
M v[168:171],v[228:231],a[200:203],v[168:171]
ds_read_b128 a[200:203],v250 offset:35328
v_lshlrev_b32 v236,16,v201
M v[172:175],v[228:231],a[204:207],v[172:175]
ds_read_b128 a[204:207],v250 offset:35584
v_lshlrev_b32 v235,16,v199
M v[176:179],v[228:231],a[208:211],v[176:179]
ds_read_b128 a[208:211],v250 offset:35840
v_fmac_f32 v232,s43,v234
M v[180:183],v[228:231],a[212:215],v[180:183]
ds_read_b128 a[212:215],v250 offset:36096
v_fmac_f32 v237,4.0,v233
M v[184:187],v[228:231],a[216:219],v[184:187]
ds_read_b128 a[216:219],v250 offset:36352
v_fma_f32 v238,-4.0,v234,v236
M v[188:191],v[228:231],a[220:223],v[188:191]
s_waitcnt vmcnt(16) lgkmcnt(6)
buffer_load_dwordx4 v[228:231],v251,s[20:23],s48 offen offset:0 sc1
M a[0:3],a[224:227],a[192:195],a[0:3]
s_waitcnt lgkmcnt(5)
ds_read_b128 a[220:223],v250 offset:36608
v_fmac_f32 v232,s45,v236
M a[4:7],a[224:227],a[196:199],a[4:7]
s_waitcnt lgkmcnt(5)
v_fmac_f32 v237,s40,v235
v_sub_f32 v236,v236,v234
M a[8:11],a[224:227],a[200:203],a[8:11]
s_waitcnt lgkmcnt(4)
v_fma_f32 v234,-4.0,v233,v235
v_sub_f32 v235,v235,v233
M a[12:15],a[224:227],a[204:207],a[12:15]
s_waitcnt lgkmcnt(3)
v_add_f32 v233,v238,v234
v_sub_f32 v238,v238,v234
M a[16:19],a[224:227],a[208:211],a[16:19]
s_waitcnt lgkmcnt(2)
v_fma_f32 v234,2.0,v235,v236
v_fmac_f32 v236,-2.0,v235
M a[20:23],a[224:227],a[212:215],a[20:23]
s_waitcnt lgkmcnt(1)
v_and_b32 v197,s42,v197
v_and_b32 v193,s42,v193
M a[24:27],a[224:227],a[216:219],a[24:27]
s_waitcnt lgkmcnt(0)
v_and_b32 v195,s42,v195
v_and_b32 v203,s42,v203
M a[28:31],a[224:227],a[220:223],a[28:31]
s_waitcnt vmcnt(16)
buffer_load_dwordx4 a[224:227],v251,s[20:23],s46 offen offset:1024 sc1
M a[32:35],a[228:231],a[192:195],a[32:35]
v_and_b32 v201,s42,v201
v_and_b32 v199,s42,v199
M a[36:39],a[228:231],a[196:199],a[36:39]
v_fmac_f32 v193,s43,v197
v_fmac_f32 v203,4.0,v195
M a[40:43],a[228:231],a[200:203],a[40:43]
v_fma_f32 v235,-4.0,v197,v201
v_fmac_f32 v193,s45,v201
M a[44:47],a[228:231],a[204:207],a[44:47]
v_fmac_f32 v203,s40,v199
v_sub_f32 v201,v201,v197
M a[48:51],a[228:231],a[208:211],a[48:51]
v_fma_f32 v197,-4.0,v195,v199
v_sub_f32 v199,v199,v195
M a[52:55],a[228:231],a[212:215],a[52:55]
v_add_f32 v195,v235,v197
v_sub_f32 v235,v235,v197
M a[56:59],a[228:231],a[216:219],a[56:59]
v_fma_f32 v197,2.0,v199,v201
v_fmac_f32 v201,-2.0,v199
M a[60:63],a[228:231],a[220:223],a[60:63]
s_waitcnt vmcnt(16)
buffer_load_dwordx4 a[228:231],v251,s[20:23],s47 offen offset:1024 sc1
M a[64:67],a[232:235],a[192:195],a[64:67]
ds_read_b128 a[192:195],v250 offset:36864
v_cvt_pk_bf16_f32 v193,v232,v193
M a[68:71],a[232:235],a[196:199],a[68:71]
v_cvt_pk_bf16_f32 v203,v237,v203
v_cvt_pk_bf16_f32 v195,v233,v195
M a[72:75],a[232:235],a[200:203],a[72:75]
v_cvt_pk_bf16_f32 v199,v234,v197
v_cvt_pk_bf16_f32 v197,v238,v235
M a[76:79],a[232:235],a[204:207],a[76:79]
v_cvt_pk_bf16_f32 v201,v236,v201
v_add_u32 v232,139264,v247
M a[80:83],a[232:235],a[208:211],a[80:83]
ds_write2st64_b64 v232,v[192:193],v[202:203] offset0:0 offset1:17
M a[84:87],a[232:235],a[212:215],a[84:87]
s_add_u32 s28,s68,786432
buffer_load_dwordx2 v[192:193],v245,s[12:15],s28 offen offset:0
M a[88:91],a[232:235],a[216:219],a[88:91]
buffer_load_dwordx2 v[202:203],v245,s[16:19],s28 offen offset:1536
M a[92:95],a[232:235],a[220:223],a[92:95]
s_waitcnt vmcnt(18)
buffer_load_dwordx4 a[232:235],v251,s[20:23],s48 offen offset:1024 sc1
M a[0:3],a[236:239],a[196:199],a[0:3]
ds_write2st64_b64 v247,v[194:195],v[196:197] offset0:34 offset1:51
M a[4:7],a[236:239],a[200:203],a[4:7]
buffer_load_dwordx2 v[194:195],v245,s[8:11],s28 offen offset:0
M a[8:11],a[236:239],a[204:207],a[8:11]
buffer_load_dwordx2 v[196:197],v245,s[8:11],s28 offen offset:384
M a[12:15],a[236:239],a[208:211],a[12:15]
ds_write2st64_b64 v247,v[198:199],v[200:201] offset0:68 offset1:85
M a[16:19],a[236:239],a[212:215],a[16:19]
buffer_load_dwordx2 v[198:199],v245,s[8:11],s28 offen offset:768
M a[20:23],a[236:239],a[216:219],a[20:23]
buffer_load_dwordx2 v[200:201],v245,s[8:11],s28 offen offset:1152
M a[24:27],a[236:239],a[220:223],a[24:27]
s_waitcnt vmcnt(17) lgkmcnt(3)
v_lshlrev_b32 v234,16,v208
v_lshlrev_b32 v232,16,v204
M a[28:31],a[236:239],a[192:195],a[28:31]
buffer_load_dwordx4 a[236:239],v251,s[20:23],s46 offen offset:2048 sc1
M a[32:35],a[240:243],a[196:199],a[32:35]
v_lshlrev_b32 v233,16,v206
v_lshlrev_b32 v237,16,v214
M a[36:39],a[240:243],a[200:203],a[36:39]
s_waitcnt vmcnt(15)
v_lshlrev_b32 v236,16,v212
v_lshlrev_b32 v235,16,v210
M a[40:43],a[240:243],a[204:207],a[40:43]
v_fmac_f32 v232,s43,v234
v_fmac_f32 v237,4.0,v233
M a[44:47],a[240:243],a[208:211],a[44:47]
v_fma_f32 v238,-4.0,v234,v236
v_fmac_f32 v232,s45,v236
M a[48:51],a[240:243],a[212:215],a[48:51]
v_fmac_f32 v237,s40,v235
v_sub_f32 v236,v236,v234
M a[52:55],a[240:243],a[216:219],a[52:55]
v_fma_f32 v234,-4.0,v233,v235
v_sub_f32 v235,v235,v233
M a[56:59],a[240:243],a[220:223],a[56:59]
v_add_f32 v233,v238,v234
v_sub_f32 v238,v238,v234
M a[60:63],a[240:243],a[192:195],a[60:63]
buffer_load_dwordx4 a[240:243],v251,s[20:23],s47 offen offset:2048 sc1
M a[64:67],a[244:247],a[196:199],a[64:67]
ds_read_b128 a[196:199],v249 offset:37120
v_fma_f32 v234,2.0,v235,v236
M a[68:71],a[244:247],a[200:203],a[68:71]
v_fmac_f32 v236,-2.0,v235
v_and_b32 v208,s42,v208
M a[72:75],a[244:247],a[204:207],a[72:75]
v_and_b32 v204,s42,v204
v_and_b32 v206,s42,v206
M a[76:79],a[244:247],a[208:211],a[76:79]
v_and_b32 v214,s42,v214
v_and_b32 v212,s42,v212
M a[80:83],a[244:247],a[212:215],a[80:83]
v_and_b32 v210,s42,v210
v_fmac_f32 v204,s43,v208
M a[84:87],a[244:247],a[216:219],a[84:87]
v_fmac_f32 v214,4.0,v206
v_fma_f32 v235,-4.0,v208,v212
M a[88:91],a[244:247],a[220:223],a[88:91]
v_fmac_f32 v204,s45,v212
v_fmac_f32 v214,s40,v210
M a[92:95],a[244:247],a[192:195],a[92:95]
buffer_load_dwordx4 a[244:247],v251,s[20:23],s48 offen offset:2048 sc1
M a[0:3],a[248:251],a[200:203],a[0:3]
v_sub_f32 v212,v212,v208
v_fma_f32 v208,-4.0,v206,v210
M a[4:7],a[248:251],a[204:207],a[4:7]
s_add_u32 s46,s79,27648
v_sub_f32 v210,v210,v206
v_add_f32 v206,v235,v208
M a[8:11],a[248:251],a[208:211],a[8:11]
v_sub_f32 v235,v235,v208
v_fma_f32 v208,2.0,v210,v212
M a[12:15],a[248:251],a[212:215],a[12:15]
v_fmac_f32 v212,-2.0,v210
v_cvt_pk_bf16_f32 v204,v232,v204
M a[16:19],a[248:251],a[216:219],a[16:19]
v_cvt_pk_bf16_f32 v214,v237,v214
v_cvt_pk_bf16_f32 v206,v233,v206
M a[20:23],a[248:251],a[220:223],a[20:23]
v_cvt_pk_bf16_f32 v210,v234,v208
v_cvt_pk_bf16_f32 v208,v238,v235
M a[24:27],a[248:251],a[192:195],a[24:27]
s_waitcnt lgkmcnt(0)
v_cvt_pk_bf16_f32 v212,v236,v212
v_lshlrev_b32 v234,16,v209
M a[28:31],a[248:251],a[196:199],a[28:31]
s_waitcnt vmcnt(16)
buffer_load_dwordx4 a[248:251],v251,s[20:23],s46 offen offset:0 sc1
M a[32:35],a[252:255],a[200:203],a[32:35]
v_lshlrev_b32 v232,16,v205
v_lshlrev_b32 v233,16,v207
M a[36:39],a[252:255],a[204:207],a[36:39]
s_add_u32 s47,s79,30720
v_lshlrev_b32 v237,16,v215
v_lshlrev_b32 v236,16,v213
M a[40:43],a[252:255],a[208:211],a[40:43]
v_lshlrev_b32 v235,16,v211
v_fmac_f32 v232,s43,v234
M a[44:47],a[252:255],a[212:215],a[44:47]
v_fmac_f32 v237,4.0,v233
v_fma_f32 v238,-4.0,v234,v236
M a[48:51],a[252:255],a[216:219],a[48:51]
v_fmac_f32 v232,s45,v236
v_fmac_f32 v237,s40,v235
M a[52:55],a[252:255],a[220:223],a[52:55]
v_sub_f32 v236,v236,v234
v_fma_f32 v234,-4.0,v233,v235
M a[56:59],a[252:255],a[192:195],a[56:59]
v_sub_f32 v235,v235,v233
v_add_f32 v233,v238,v234
M a[60:63],a[252:255],a[196:199],a[60:63]
s_waitcnt vmcnt(16)
buffer_load_dwordx4 a[252:255],v251,s[20:23],s47 offen offset:0 sc1
M a[64:67],v[216:219],a[200:203],a[64:67]
ds_read_b128 a[200:203],v249 offset:43520
v_sub_f32 v238,v238,v234
M a[68:71],v[216:219],a[204:207],a[68:71]
s_add_u32 s48,s79,33792
ds_read_b128 a[204:207],v250 offset:43776
v_fma_f32 v234,2.0,v235,v236
M a[72:75],v[216:219],a[208:211],a[72:75]
ds_read_b128 a[208:211],v250 offset:44032
v_fmac_f32 v236,-2.0,v235
M a[76:79],v[216:219],a[212:215],a[76:79]
ds_read_b128 a[212:215],v250 offset:44288
v_and_b32 v209,s42,v209
M a[80:83],v[216:219],a[216:219],a[80:83]
ds_read_b128 a[216:219],v250 offset:44544
v_and_b32 v205,s42,v205
M a[84:87],v[216:219],a[220:223],a[84:87]
ds_read_b128 a[220:223],v250 offset:44800
v_and_b32 v207,s42,v207
M a[88:91],v[216:219],a[192:195],a[88:91]
ds_read_b128 a[192:195],v250 offset:45056
v_and_b32 v215,s42,v215
M a[92:95],v[216:219],a[196:199],a[92:95]
s_waitcnt vmcnt(16) lgkmcnt(6)
buffer_load_dwordx4 v[216:219],v251,s[20:23],s48 offen offset:0 sc1
M a[96:99],v[220:223],a[200:203],a[96:99]
s_waitcnt lgkmcnt(5)
ds_read_b128 a[196:199],v250 offset:45312
v_and_b32 v213,s42,v213
M a[100:103],v[220:223],a[204:207],a[100:103]
s_waitcnt lgkmcnt(5)
v_and_b32 v211,s42,v211
v_fmac_f32 v205,s43,v209
M a[104:107],v[220:223],a[208:211],a[104:107]
s_waitcnt lgkmcnt(4)
v_fmac_f32 v215,4.0,v207
v_fma_f32 v235,-4.0,v209,v213
M a[108:111],v[220:223],a[212:215],a[108:111]
s_waitcnt lgkmcnt(3)
v_fmac_f32 v205,s45,v213
v_fmac_f32 v215,s40,v211
M a[112:115],v[220:223],a[216:219],a[112:115]
s_waitcnt lgkmcnt(2)
v_sub_f32 v213,v213,v209
v_fma_f32 v209,-4.0,v207,v211
M a[116:119],v[220:223],a[220:223],a[116:119]
s_waitcnt lgkmcnt(1)
v_sub_f32 v211,v211,v207
v_add_f32 v207,v235,v209
M a[120:123],v[220:223],a[192:195],a[120:123]
s_waitcnt lgkmcnt(0)
v_sub_f32 v235,v235,v209
v_fma_f32 v209,2.0,v211,v213
M a[124:127],v[220:223],a[196:199],a[124:127]
s_waitcnt vmcnt(16)
buffer_load_dwordx4 v[220:223],v251,s[20:23],s46 offen offset:1024 sc1
M a[128:131],v[224:227],a[200:203],a[128:131]
v_fmac_f32 v213,-2.0,v211
v_cvt_pk_bf16_f32 v205,v232,v205
M a[132:135],v[224:227],a[204:207],a[132:135]
v_cvt_pk_bf16_f32 v215,v237,v215
v_cvt_pk_bf16_f32 v207,v233,v207
M a[136:139],v[224:227],a[208:211],a[136:139]
v_cvt_pk_bf16_f32 v211,v234,v209
v_cvt_pk_bf16_f32 v209,v238,v235
M a[140:143],v[224:227],a[212:215],a[140:143]
v_cvt_pk_bf16_f32 v213,v236,v213
v_add_u32 v232,139264,v247
M a[144:147],v[224:227],a[216:219],a[144:147]
ds_write2st64_b64 v232,v[204:205],v[214:215] offset0:1 offset1:18
M a[148:151],v[224:227],a[220:223],a[148:151]
s_add_u32 s28,s68,1179648
buffer_load_dwordx2 v[204:205],v245,s[12:15],s28 offen offset:0
M a[152:155],v[224:227],a[192:195],a[152:155]
buffer_load_dwordx2 v[214:215],v245,s[16:19],s28 offen offset:1536
M a[156:159],v[224:227],a[196:199],a[156:159]
s_waitcnt vmcnt(18)
buffer_load_dwordx4 v[224:227],v251,s[20:23],s47 offen offset:1024 sc1
M a[160:163],v[228:231],a[200:203],a[160:163]
ds_read_b128 a[200:203],v250 offset:45568
ds_write2st64_b64 v247,v[206:207],v[208:209] offset0:35 offset1:52
M a[164:167],v[228:231],a[204:207],a[164:167]
buffer_load_dwordx2 v[206:207],v245,s[8:11],s28 offen offset:0
M a[168:171],v[228:231],a[208:211],a[168:171]
buffer_load_dwordx2 v[208:209],v245,s[8:11],s28 offen offset:384
M a[172:175],v[228:231],a[212:215],a[172:175]
ds_write2st64_b64 v247,v[210:211],v[212:213] offset0:69 offset1:86
M a[176:179],v[228:231],a[216:219],a[176:179]
buffer_load_dwordx2 v[210:211],v245,s[8:11],s28 offen offset:768
M a[180:183],v[228:231],a[220:223],a[180:183]
buffer_load_dwordx2 v[212:213],v245,s[8:11],s28 offen offset:1152
M a[184:187],v[228:231],a[192:195],a[184:187]
v_fmac_f32 v239,s43,v241
v_fmac_f32 v244,4.0,v240
M a[188:191],v[228:231],a[196:199],a[188:191]
s_waitcnt vmcnt(22)
buffer_load_dwordx4 v[228:231],v251,s[20:23],s48 offen offset:1024 sc1
M a[96:99],a[224:227],a[204:207],a[96:99]
v_fma_f32 v232,-4.0,v241,v243
v_fmac_f32 v239,s45,v243
M a[100:103],a[224:227],a[208:211],a[100:103]
v_fmac_f32 v244,s40,v242
v_sub_f32 v243,v243,v241
M a[104:107],a[224:227],a[212:215],a[104:107]
v_fma_f32 v241,-4.0,v240,v242
v_sub_f32 v242,v242,v240
M a[108:111],a[224:227],a[216:219],a[108:111]
v_add_f32 v240,v232,v241
v_sub_f32 v232,v232,v241
M a[112:115],a[224:227],a[220:223],a[112:115]
v_fma_f32 v241,2.0,v242,v243
v_fmac_f32 v243,-2.0,v242
M a[116:119],a[224:227],a[192:195],a[116:119]
v_cvt_pk_bf16_f32 v233,v239,v244
v_cvt_pk_bf16_f32 v234,v240,v232
M a[120:123],a[224:227],a[196:199],a[120:123]
s_waitcnt lgkmcnt(2)
v_cvt_pk_bf16_f32 v235,v241,v243
v_add_u32 v232,139264,v248
M a[124:127],a[224:227],a[200:203],a[124:127]
s_waitcnt vmcnt(22)
buffer_load_short_d16_hi v239,v246,s[12:15],s75 offen offset:0
M a[128:131],a[228:231],a[204:207],a[128:131]
buffer_load_short_d16_hi v240,v246,s[8:11],s75 offen offset:0
M a[132:135],a[228:231],a[208:211],a[132:135]
buffer_load_short_d16_hi v241,v246,s[8:11],s75 offen offset:384
M a[136:139],a[228:231],a[212:215],a[136:139]
buffer_load_short_d16_hi v242,v246,s[8:11],s75 offen offset:768
M a[140:143],a[228:231],a[216:219],a[140:143]
buffer_load_short_d16_hi v243,v246,s[8:11],s75 offen offset:1152
M a[144:147],a[228:231],a[220:223],a[144:147]
buffer_load_short_d16_hi v244,v246,s[16:19],s75 offen offset:1536
M a[148:151],a[228:231],a[192:195],a[148:151]
buffer_load_dwordx4 a[224:227],v251,s[20:23],s46 offen offset:2048 sc1
M a[152:155],a[228:231],a[196:199],a[152:155]
ds_write_b16 v232,v233 offset:0
M a[156:159],a[228:231],a[200:203],a[156:159]
s_waitcnt vmcnt(26)
buffer_load_dwordx4 a[228:231],v251,s[20:23],s47 offen offset:2048 sc1
M a[160:163],a[232:235],a[204:207],a[160:163]
ds_read_b128 a[204:207],v249 offset:45824
ds_write_b16_d16_hi v232,v233 offset:8704
M a[164:167],a[232:235],a[208:211],a[164:167]
ds_write_b16 v248,v234 offset:17408
M a[168:171],a[232:235],a[212:215],a[168:171]
ds_write_b16_d16_hi v248,v234 offset:26112
M a[172:175],a[232:235],a[216:219],a[172:175]
ds_write_b16 v248,v235 offset:34816
M a[176:179],a[232:235],a[220:223],a[176:179]
ds_write_b16_d16_hi v248,v235 offset:43520
M a[180:183],a[232:235],a[192:195],a[180:183]
s_waitcnt vmcnt(25)
v_lshlrev_b32 v234,16,v196
v_lshlrev_b32 v232,16,v192
M a[184:187],a[232:235],a[196:199],a[184:187]
v_lshlrev_b32 v233,16,v194
v_lshlrev_b32 v237,16,v202
M a[188:191],a[232:235],a[200:203],a[188:191]
s_waitcnt vmcnt(22)
buffer_load_dwordx4 a[232:235],v251,s[20:23],s48 offen offset:2048 sc1
M a[96:99],a[236:239],a[208:211],a[96:99]
v_lshlrev_b32 v236,16,v200
v_lshlrev_b32 v235,16,v198
M a[100:103],a[236:239],a[212:215],a[100:103]
s_add_u32 s46,s79,36864
v_fmac_f32 v232,s43,v234
v_fmac_f32 v237,4.0,v233
M a[104:107],a[236:239],a[216:219],a[104:107]
v_fma_f32 v238,-4.0,v234,v236
v_fmac_f32 v232,s45,v236
M a[108:111],a[236:239],a[220:223],a[108:111]
v_fmac_f32 v237,s40,v235
v_sub_f32 v236,v236,v234
M a[112:115],a[236:239],a[192:195],a[112:115]
v_fma_f32 v234,-4.0,v233,v235
v_sub_f32 v235,v235,v233
M a[116:119],a[236:239],a[196:199],a[116:119]
v_add_f32 v233,v238,v234
v_sub_f32 v238,v238,v234
M a[120:123],a[236:239],a[200:203],a[120:123]
s_waitcnt lgkmcnt(5)
v_fma_f32 v234,2.0,v235,v236
v_fmac_f32 v236,-2.0,v235
M a[124:127],a[236:239],a[204:207],a[124:127]
s_waitcnt vmcnt(22)
buffer_load_dwordx4 a[236:239],v251,s[20:23],s46 offen offset:0 sc1
M a[128:131],a[240:243],a[208:211],a[128:131]
v_and_b32 v196,s42,v196
v_and_b32 v192,s42,v192
M a[132:135],a[240:243],a[212:215],a[132:135]
s_add_u32 s47,s79,39936
v_and_b32 v194,s42,v194
v_and_b32 v202,s42,v202
M a[136:139],a[240:243],a[216:219],a[136:139]
v_and_b32 v200,s42,v200
v_and_b32 v198,s42,v198
M a[140:143],a[240:243],a[220:223],a[140:143]
v_fmac_f32 v192,s43,v196
v_fmac_f32 v202,4.0,v194
M a[144:147],a[240:243],a[192:195],a[144:147]
v_fma_f32 v235,-4.0,v196,v200
v_fmac_f32 v192,s45,v200
M a[148:151],a[240:243],a[196:199],a[148:151]
v_fmac_f32 v202,s40,v198
v_sub_f32 v200,v200,v196
M a[152:155],a[240:243],a[200:203],a[152:155]
v_fma_f32 v196,-4.0,v194,v198
v_sub_f32 v198,v198,v194
M a[156:159],a[240:243],a[204:207],a[156:159]
s_waitcnt vmcnt(22)
buffer_load_dwordx4 a[240:243],v251,s[20:23],s47 offen offset:0 sc1
M a[160:163],a[244:247],a[208:211],a[160:163]
ds_read_b128 a[208:211],v249 offset:52224
v_add_f32 v194,v235,v196
M a[164:167],a[244:247],a[212:215],a[164:167]
s_add_u32 s48,s79,43008
ds_read_b128 a[212:215],v250 offset:52480
v_sub_f32 v235,v235,v196
M a[168:171],a[244:247],a[216:219],a[168:171]
ds_read_b128 a[216:219],v250 offset:52736
v_fma_f32 v196,2.0,v198,v200
M a[172:175],a[244:247],a[220:223],a[172:175]
ds_read_b128 a[220:223],v250 offset:52992
v_fmac_f32 v200,-2.0,v198
M a[176:179],a[244:247],a[192:195],a[176:179]
ds_read_b128 a[192:195],v250 offset:53248
v_cvt_pk_bf16_f32 v192,v232,v192
M a[180:183],a[244:247],a[196:199],a[180:183]
ds_read_b128 a[196:199],v250 offset:53504
v_cvt_pk_bf16_f32 v202,v237,v202
M a[184:187],a[244:247],a[200:203],a[184:187]
ds_read_b128 a[200:203],v250 offset:53760
v_cvt_pk_bf16_f32 v194,v233,v194
M a[188:191],a[244:247],a[204:207],a[188:191]
s_waitcnt vmcnt(22) lgkmcnt(6)
buffer_load_dwordx4 a[244:247],v251,s[20:23],s48 offen offset:0 sc1
M v[0:3],a[248:251],a[208:211],v[0:3]
s_waitcnt lgkmcnt(5)
ds_read_b128 a[204:207],v250 offset:54016
v_cvt_pk_bf16_f32 v198,v234,v196
M v[4:7],a[248:251],a[212:215],v[4:7]
s_waitcnt lgkmcnt(5)
v_cvt_pk_bf16_f32 v196,v238,v235
v_cvt_pk_bf16_f32 v200,v236,v200
M v[8:11],a[248:251],a[216:219],v[8:11]
s_waitcnt lgkmcnt(4)
v_lshlrev_b32 v234,16,v197
v_lshlrev_b32 v232,16,v193
M v[12:15],a[248:251],a[220:223],v[12:15]
s_waitcnt lgkmcnt(3)
v_lshlrev_b32 v233,16,v195
v_lshlrev_b32 v237,16,v203
M v[16:19],a[248:251],a[192:195],v[16:19]
s_waitcnt lgkmcnt(2)
v_lshlrev_b32 v236,16,v201
v_lshlrev_b32 v235,16,v199
M v[20:23],a[248:251],a[196:199],v[20:23]
s_waitcnt lgkmcnt(1)
v_fmac_f32 v232,s43,v234
v_fmac_f32 v237,4.0,v233
M v[24:27],a[248:251],a[200:203],v[24:27]
s_waitcnt lgkmcnt(0)
v_fma_f32 v238,-4.0,v234,v236
v_fmac_f32 v232,s45,v236
M v[28:31],a[248:251],a[204:207],v[28:31]
s_waitcnt vmcnt(22)
buffer_load_dwordx4 a[248:251],v251,s[20:23],s46 offen offset:1024 sc1
M v[32:35],a[252:255],a[208:211],v[32:35]
v_fmac_f32 v237,s40,v235
v_sub_f32 v236,v236,v234
M v[36:39],a[252:255],a[212:215],v[36:39]
v_fma_f32 v234,-4.0,v233,v235
v_sub_f32 v235,v235,v233
M v[40:43],a[252:255],a[216:219],v[40:43]
v_add_f32 v233,v238,v234
v_sub_f32 v238,v238,v234
M v[44:47],a[252:255],a[220:223],v[44:47]
v_fma_f32 v234,2.0,v235,v236
v_fmac_f32 v236,-2.0,v235
M v[48:51],a[252:255],a[192:195],v[48:51]
v_and_b32 v197,s42,v197
v_and_b32 v193,s42,v193
M v[52:55],a[252:255],a[196:199],v[52:55]
v_and_b32 v195,s42,v195
v_and_b32 v203,s42,v203
M v[56:59],a[252:255],a[200:203],v[56:59]
v_and_b32 v201,s42,v201
v_and_b32 v199,s42,v199
M v[60:63],a[252:255],a[204:207],v[60:63]
s_waitcnt vmcnt(22)
buffer_load_dwordx4 a[252:255],v251,s[20:23],s47 offen offset:1024 sc1
M v[64:67],v[216:219],a[208:211],v[64:67]
ds_read_b128 a[208:211],v250 offset:54272
v_fmac_f32 v193,s43,v197
M v[68:71],v[216:219],a[212:215],v[68:71]
v_fmac_f32 v203,4.0,v195
v_fma_f32 v235,-4.0,v197,v201
M v[72:75],v[216:219],a[216:219],v[72:75]
v_fmac_f32 v193,s45,v201
v_fmac_f32 v203,s40,v199
M v[76:79],v[216:219],a[220:223],v[76:79]
v_sub_f32 v201,v201,v197
v_fma_f32 v197,-4.0,v195,v199
M v[80:83],v[216:219],a[192:195],v[80:83]
v_sub_f32 v199,v199,v195
v_add_f32 v195,v235,v197
M v[84:87],v[216:219],a[196:199],v[84:87]
v_sub_f32 v235,v235,v197
v_fma_f32 v197,2.0,v199,v201
M v[88:91],v[216:219],a[200:203],v[88:91]
v_fmac_f32 v201,-2.0,v199
v_cvt_pk_bf16_f32 v193,v232,v193
M v[92:95],v[216:219],a[204:207],v[92:95]
s_waitcnt vmcnt(22)
buffer_load_dwordx4 v[216:219],v251,s[20:23],s48 offen offset:1024 sc1
M v[0:3],v[220:223],a[212:215],v[0:3]
v_cvt_pk_bf16_f32 v203,v237,v203
v_cvt_pk_bf16_f32 v195,v233,v195
M v[4:7],v[220:223],a[216:219],v[4:7]
v_cvt_pk_bf16_f32 v199,v234,v197
v_cvt_pk_bf16_f32 v197,v238,v235
M v[8:11],v[220:223],a[220:223],v[8:11]
v_cvt_pk_bf16_f32 v201,v236,v201
v_add_u32 v232,139264,v247
M v[12:15],v[220:223],a[192:195],v[12:15]
ds_write2st64_b64 v232,v[192:193],v[202:203] offset0:2 offset1:19
M v[16:19],v[220:223],a[196:199],v[16:19]
s_add_u32 s28,s69,0
buffer_load_dwordx2 v[192:193],v245,s[12:15],s28 offen offset:0
M v[20:23],v[220:223],a[200:203],v[20:23]
buffer_load_dwordx2 v[202:203],v245,s[16:19],s28 offen offset:1536
M v[24:27],v[220:223],a[204:207],v[24:27]
s_waitcnt lgkmcnt(1)
ds_write2st64_b64 v247,v[194:195],v[196:197] offset0:36 offset1:53
M v[28:31],v[220:223],a[208:211],v[28:31]
s_waitcnt vmcnt(22)
buffer_load_dwordx2 v[194:195],v245,s[8:11],s28 offen offset:0
M v[32:35],v[224:227],a[212:215],v[32:35]
buffer_load_dwordx2 v[196:197],v245,s[8:11],s28 offen offset:384
M v[36:39],v[224:227],a[216:219],v[36:39]
buffer_load_dwordx4 v[220:223],v251,s[20:23],s46 offen offset:2048 sc1
M v[40:43],v[224:227],a[220:223],v[40:43]
ds_write2st64_b64 v247,v[198:199],v[200:201] offset0:70 offset1:87
M v[44:47],v[224:227],a[192:195],v[44:47]
buffer_load_dwordx2 v[198:199],v245,s[8:11],s28 offen offset:768
M v[48:51],v[224:227],a[196:199],v[48:51]
buffer_load_dwordx2 v[200:201],v245,s[8:11],s28 offen offset:1152
M v[52:55],v[224:227],a[200:203],v[52:55]
s_waitcnt vmcnt(25)
v_lshlrev_b32 v234,16,v208
v_lshlrev_b32 v232,16,v204
M v[56:59],v[224:227],a[204:207],v[56:59]
v_lshlrev_b32 v233,16,v206
v_lshlrev_b32 v237,16,v214
M v[60:63],v[224:227],a[208:211],v[60:63]
s_waitcnt vmcnt(22)
buffer_load_dwordx4 v[224:227],v251,s[20:23],s47 offen offset:2048 sc1
M v[64:67],v[228:231],a[212:215],v[64:67]
ds_read_b128 a[212:215],v249 offset:54528
v_lshlrev_b32 v236,16,v212
M v[68:71],v[228:231],a[216:219],v[68:71]
v_lshlrev_b32 v235,16,v210
v_fmac_f32 v232,s43,v234
M v[72:75],v[228:231],a[220:223],v[72:75]
v_fmac_f32 v237,4.0,v233
v_fma_f32 v238,-4.0,v234,v236
M v[76:79],v[228:231],a[192:195],v[76:79]
v_fmac_f32 v232,s45,v236
v_fmac_f32 v237,s40,v235
M v[80:83],v[228:231],a[196:199],v[80:83]
v_sub_f32 v236,v236,v234
v_fma_f32 v234,-4.0,v233,v235
M v[84:87],v[228:231],a[200:203],v[84:87]
v_sub_f32 v235,v235,v233
v_add_f32 v233,v238,v234
M v[88:91],v[228:231],a[204:207],v[88:91]
v_sub_f32 v238,v238,v234
v_fma_f32 v234,2.0,v235,v236
M v[92:95],v[228:231],a[208:211],v[92:95]
s_waitcnt vmcnt(16)
buffer_load_dwordx4 v[228:231],v251,s[20:23],s48 offen offset:2048 sc1
M v[0:3],a[224:227],a[216:219],v[0:3]
v_fmac_f32 v236,-2.0,v235
v_and_b32 v208,s42,v208
M v[4:7],a[224:227],a[220:223],v[4:7]
s_add_u32 s46,s80,9216
v_and_b32 v204,s42,v204
v_and_b32 v206,s42,v206
M v[8:11],a[224:227],a[192:195],v[8:11]
v_and_b32 v214,s42,v214
v_and_b32 v212,s42,v212
M v[12:15],a[224:227],a[196:199],v[12:15]
v_and_b32 v210,s42,v210
v_fmac_f32 v204,s43,v208
M v[16:19],a[224:227],a[200:203],v[16:19]
v_fmac_f32 v214,4.0,v206
v_fma_f32 v235,-4.0,v208,v212
M v[20:23],a[224:227],a[204:207],v[20:23]
v_fmac_f32 v204,s45,v212
v_fmac_f32 v214,s40,v210
M v[24:27],a[224:227],a[208:211],v[24:27]
s_waitcnt lgkmcnt(0)
v_sub_f32 v212,v212,v208
v_fma_f32 v208,-4.0,v206,v210
M v[28:31],a[224:227],a[212:215],v[28:31]
s_waitcnt vmcnt(16)
buffer_load_dwordx4 a[224:227],v251,s[20:23],s46 offen offset:0 sc1
M v[32:35],a[228:231],a[216:219],v[32:35]
v_sub_f32 v210,v210,v206
v_add_f32 v206,v235,v208
M v[36:39],a[228:231],a[220:223],v[36:39]
s_add_u32 s47,s80,12288
v_sub_f32 v235,v235,v208
v_fma_f32 v208,2.0,v210,v212
M v[40:43],a[228:231],a[192:195],v[40:43]
v_fmac_f32 v212,-2.0,v210
v_cvt_pk_bf16_f32 v204,v232,v204
M v[44:47],a[228:231],a[196:199],v[44:47]
v_cvt_pk_bf16_f32 v214,v237,v214
v_cvt_pk_bf16_f32 v206,v233,v206
M v[48:51],a[228:231],a[200:203],v[48:51]
v_cvt_pk_bf16_f32 v210,v234,v208
v_cvt_pk_bf16_f32 v208,v238,v235
M v[52:55],a[228:231],a[204:207],v[52:55]
v_cvt_pk_bf16_f32 v212,v236,v212
v_lshlrev_b32 v234,16,v209
M v[56:59],a[228:231],a[208:211],v[56:59]
v_lshlrev_b32 v232,16,v205
v_lshlrev_b32 v233,16,v207
M v[60:63],a[228:231],a[212:215],v[60:63]
s_waitcnt vmcnt(16)
buffer_load_dwordx4 a[228:231],v251,s[20:23],s47 offen offset:0 sc1
M v[64:67],a[232:235],a[216:219],v[64:67]
ds_read_b128 a[216:219],v249 offset:60928
v_lshlrev_b32 v237,16,v215
M v[68:71],a[232:235],a[220:223],v[68:71]
s_add_u32 s48,s80,15360
ds_read_b128 a[220:223],v250 offset:61184
v_lshlrev_b32 v236,16,v213
M v[72:75],a[232:235],a[192:195],v[72:75]
ds_read_b128 a[192:195],v250 offset:61440
v_lshlrev_b32 v235,16,v211
M v[76:79],a[232:235],a[196:199],v[76:79]
ds_read_b128 a[196:199],v250 offset:61696
v_fmac_f32 v232,s43,v234
M v[80:83],a[232:235],a[200:203],v[80:83]
ds_read_b128 a[200:203],v250 offset:61952
v_fmac_f32 v237,4.0,v233
M v[84:87],a[232:235],a[204:207],v[84:87]
ds_read_b128 a[204:207],v250 offset:62208
v_fma_f32 v238,-4.0,v234,v236
M v[88:91],a[232:235],a[208:211],v[88:91]
ds_read_b128 a[208:211],v250 offset:62464
v_fmac_f32 v232,s45,v236
M v[92:95],a[232:235],a[212:215],v[92:95]
s_waitcnt vmcnt(16) lgkmcnt(6)
buffer_load_dwordx4 a[232:235],v251,s[20:23],s48 offen offset:0 sc1
M v[96:99],a[236:239],a[216:219],v[96:99]
s_waitcnt lgkmcnt(5)
ds_read_b128 a[212:215],v250 offset:62720
v_fmac_f32 v237,s40,v235
M v[100:103],a[236:239],a[220:223],v[100:103]
s_waitcnt lgkmcnt(5)
v_sub_f32 v236,v236,v234
v_fma_f32 v234,-4.0,v233,v235
M v[104:107],a[236:239],a[192:195],v[104:107]
s_waitcnt lgkmcnt(4)
v_sub_f32 v235,v235,v233
v_add_f32 v233,v238,v234
M v[108:111],a[236:239],a[196:199],v[108:111]
s_waitcnt lgkmcnt(3)
v_sub_f32 v238,v238,v234
v_fma_f32 v234,2.0,v235,v236
M v[112:115],a[236:239],a[200:203],v[112:115]
s_waitcnt lgkmcnt(2)
v_fmac_f32 v236,-2.0,v235
v_and_b32 v209,s42,v209
M v[116:119],a[236:239],a[204:207],v[116:119]
s_waitcnt lgkmcnt(1)
v_and_b32 v205,s42,v205
v_and_b32 v207,s42,v207
M v[120:123],a[236:239],a[208:211],v[120:123]
s_waitcnt lgkmcnt(0)
v_and_b32 v215,s42,v215
v_and_b32 v213,s42,v213
M v[124:127],a[236:239],a[212:215],v[124:127]
s_waitcnt vmcnt(16)
buffer_load_dwordx4 a[236:239],v251,s[20:23],s46 offen offset:1024 sc1
M v[128:131],a[240:243],a[216:219],v[128:131]
v_and_b32 v211,s42,v211
v_fmac_f32 v205,s43,v209
M v[132:135],a[240:243],a[220:223],v[132:135]
v_fmac_f32 v215,4.0,v207
v_fma_f32 v235,-4.0,v209,v213
M v[136:139],a[240:243],a[192:195],v[136:139]
v_fmac_f32 v205,s45,v213
v_fmac_f32 v215,s40,v211
M v[140:143],a[240:243],a[196:199],v[140:143]
v_sub_f32 v213,v213,v209
v_fma_f32 v209,-4.0,v207,v211
M v[144:147],a[240:243],a[200:203],v[144:147]
v_sub_f32 v211,v211,v207
v_add_f32 v207,v235,v209
M v[148:151],a[240:243],a[204:207],v[148:151]
v_sub_f32 v235,v235,v209
v_fma_f32 v209,2.0,v211,v213
M v[152:155],a[240:243],a[208:211],v[152:155]
v_fmac_f32 v213,-2.0,v211
v_cvt_pk_bf16_f32 v205,v232,v205
M v[156:159],a[240:243],a[212:215],v[156:159]
s_waitcnt vmcnt(16)
buffer_load_dwordx4 a[240:243],v251,s[20:23],s47 offen offset:1024 sc1
M v[160:163],a[244:247],a[216:219],v[160:163]
ds_read_b128 a[216:219],v250 offset:62976
v_cvt_pk_bf16_f32 v215,v237,v215
M v[164:167],a[244:247],a[220:223],v[164:167]
v_cvt_pk_bf16_f32 v207,v233,v207
v_cvt_pk_bf16_f32 v211,v234,v209
M v[168:171],a[244:247],a[192:195],v[168:171]
v_cvt_pk_bf16_f32 v209,v238,v235
v_cvt_pk_bf16_f32 v213,v236,v213
M v[172:175],a[244:247],a[196:199],v[172:175]
v_add_u32 v232,139264,v247
M v[176:179],a[244:247],a[200:203],v[176:179]
ds_write2st64_b64 v232,v[204:205],v[214:215] offset0:3 offset1:20
M v[180:183],a[244:247],a[204:207],v[180:183]
s_add_u32 s28,s69,393216
buffer_load_dwordx2 v[204:205],v245,s[12:15],s28 offen offset:0
M v[184:187],a[244:247],a[208:211],v[184:187]
buffer_load_dwordx2 v[214:215],v245,s[16:19],s28 offen offset:1536
M v[188:191],a[244:247],a[212:215],v[188:191]
s_waitcnt vmcnt(18)
buffer_load_dwordx4 a[244:247],v251,s[20:23],s48 offen offset:1024 sc1
M v[96:99],a[248:251],a[220:223],v[96:99]
ds_write2st64_b64 v247,v[206:207],v[208:209] offset0:37 offset1:54
M v[100:103],a[248:251],a[192:195],v[100:103]
buffer_load_dwordx2 v[206:207],v245,s[8:11],s28 offen offset:0
M v[104:107],a[248:251],a[196:199],v[104:107]
buffer_load_dwordx2 v[208:209],v245,s[8:11],s28 offen offset:384
M v[108:111],a[248:251],a[200:203],v[108:111]
ds_write2st64_b64 v247,v[210:211],v[212:213] offset0:71 offset1:88
M v[112:115],a[248:251],a[204:207],v[112:115]
buffer_load_dwordx2 v[210:211],v245,s[8:11],s28 offen offset:768
M v[116:119],a[248:251],a[208:211],v[116:119]
buffer_load_dwordx2 v[212:213],v245,s[8:11],s28 offen offset:1152
M v[120:123],a[248:251],a[212:215],v[120:123]
s_waitcnt vmcnt(17) lgkmcnt(3)
v_lshlrev_b32 v234,16,v196
v_lshlrev_b32 v232,16,v192
M v[124:127],a[248:251],a[216:219],v[124:127]
buffer_load_dwordx4 a[248:251],v251,s[20:23],s46 offen offset:2048 sc1
M v[128:131],a[252:255],a[220:223],v[128:131]
v_lshlrev_b32 v233,16,v194
v_lshlrev_b32 v237,16,v202
M v[132:135],a[252:255],a[192:195],v[132:135]
s_waitcnt vmcnt(15)
v_lshlrev_b32 v236,16,v200
v_lshlrev_b32 v235,16,v198
M v[136:139],a[252:255],a[196:199],v[136:139]
v_fmac_f32 v232,s43,v234
v_fmac_f32 v237,4.0,v233
M v[140:143],a[252:255],a[200:203],v[140:143]
v_fma_f32 v238,-4.0,v234,v236
v_fmac_f32 v232,s45,v236
M v[144:147],a[252:255],a[204:207],v[144:147]
v_fmac_f32 v237,s40,v235
v_sub_f32 v236,v236,v234
M v[148:151],a[252:255],a[208:211],v[148:151]
v_fma_f32 v234,-4.0,v233,v235
v_sub_f32 v235,v235,v233
M v[152:155],a[252:255],a[212:215],v[152:155]
v_add_f32 v233,v238,v234
v_sub_f32 v238,v238,v234
M v[156:159],a[252:255],a[216:219],v[156:159]
buffer_load_dwordx4 a[252:255],v251,s[20:23],s47 offen offset:2048 sc1
M v[160:163],v[216:219],a[220:223],v[160:163]
ds_read_b128 a[220:223],v249 offset:63232
v_fma_f32 v234,2.0,v235,v236
M v[164:167],v[216:219],a[192:195],v[164:167]
v_fmac_f32 v236,-2.0,v235
v_and_b32 v196,s42,v196
M v[168:171],v[216:219],a[196:199],v[168:171]
v_and_b32 v192,s42,v192
v_and_b32 v194,s42,v194
M v[172:175],v[216:219],a[200:203],v[172:175]
v_and_b32 v202,s42,v202
v_and_b32 v200,s42,v200
M v[176:179],v[216:219],a[204:207],v[176:179]
v_and_b32 v198,s42,v198
v_fmac_f32 v192,s43,v196
M v[180:183],v[216:219],a[208:211],v[180:183]
v_fmac_f32 v202,4.0,v194
v_fma_f32 v235,-4.0,v196,v200
M v[184:187],v[216:219],a[212:215],v[184:187]
v_fmac_f32 v192,s45,v200
v_fmac_f32 v202,s40,v198
M v[188:191],v[216:219],a[216:219],v[188:191]
buffer_load_dwordx4 v[216:219],v251,s[20:23],s48 offen offset:2048 sc1
M v[96:99],v[220:223],a[192:195],v[96:99]
v_sub_f32 v200,v200,v196
v_fma_f32 v196,-4.0,v194,v198
M v[100:103],v[220:223],a[196:199],v[100:103]
s_add_u32 s46,s80,18432
v_sub_f32 v198,v198,v194
v_add_f32 v194,v235,v196
M v[104:107],v[220:223],a[200:203],v[104:107]
v_sub_f32 v235,v235,v196
v_fma_f32 v196,2.0,v198,v200
M v[108:111],v[220:223],a[204:207],v[108:111]
v_fmac_f32 v200,-2.0,v198
v_cvt_pk_bf16_f32 v192,v232,v192
M v[112:115],v[220:223],a[208:211],v[112:115]
v_cvt_pk_bf16_f32 v202,v237,v202
v_cvt_pk_bf16_f32 v194,v233,v194
M v[116:119],v[220:223],a[212:215],v[116:119]
v_cvt_pk_bf16_f32 v198,v234,v196
v_cvt_pk_bf16_f32 v196,v238,v235
M v[120:123],v[220:223],a[216:219],v[120:123]
s_waitcnt lgkmcnt(0)
v_cvt_pk_bf16_f32 v200,v236,v200
v_lshlrev_b32 v234,16,v197
M v[124:127],v[220:223],a[220:223],v[124:127]
s_waitcnt vmcnt(16)
buffer_load_dwordx4 v[220:223],v251,s[20:23],s46 offen offset:0 sc1
M v[128:131],v[224:227],a[192:195],v[128:131]
v_lshlrev_b32 v232,16,v193
v_lshlrev_b32 v233,16,v195
M v[132:135],v[224:227],a[196:199],v[132:135]
s_add_u32 s47,s80,21504
v_lshlrev_b32 v237,16,v203
v_lshlrev_b32 v236,16,v201
M v[136:139],v[224:227],a[200:203],v[136:139]
v_lshlrev_b32 v235,16,v199
v_fmac_f32 v232,s43,v234
M v[140:143],v[224:227],a[204:207],v[140:143]
v_fmac_f32 v237,4.0,v233
v_fma_f32 v238,-4.0,v234,v236
M v[144:147],v[224:227],a[208:211],v[144:147]
v_fmac_f32 v232,s45,v236
v_fmac_f32 v237,s40,v235
M v[148:151],v[224:227],a[212:215],v[148:151]
v_sub_f32 v236,v236,v234
v_fma_f32 v234,-4.0,v233,v235
M v[152:155],v[224:227],a[216:219],v[152:155]
s_barrier
v_sub_f32 v235,v235,v233
M v[156:159],v[224:227],a[220:223],v[156:159]
s_waitcnt vmcnt(16)
buffer_load_dwordx4 v[224:227],v251,s[20:23],s47 offen offset:0 sc1
M v[160:163],v[228:231],a[192:195],v[160:163]
ds_read_b128 a[192:195],v249 offset:0
v_add_f32 v233,v238,v234
M v[164:167],v[228:231],a[196:199],v[164:167]
s_add_u32 s48,s80,24576
ds_read_b128 a[196:199],v250 offset:256
v_sub_f32 v238,v238,v234
M v[168:171],v[228:231],a[200:203],v[168:171]
ds_read_b128 a[200:203],v250 offset:512
v_fma_f32 v234,2.0,v235,v236
M v[172:175],v[228:231],a[204:207],v[172:175]
ds_read_b128 a[204:207],v250 offset:768
v_fmac_f32 v236,-2.0,v235
M v[176:179],v[228:231],a[208:211],v[176:179]
ds_read_b128 a[208:211],v250 offset:1024
v_and_b32 v197,s42,v197
M v[180:183],v[228:231],a[212:215],v[180:183]
ds_read_b128 a[212:215],v250 offset:1280
v_and_b32 v193,s42,v193
M v[184:187],v[228:231],a[216:219],v[184:187]
ds_read_b128 a[216:219],v250 offset:1536
v_and_b32 v195,s42,v195
M v[188:191],v[228:231],a[220:223],v[188:191]
s_waitcnt vmcnt(16) lgkmcnt(6)
buffer_load_dwordx4 v[228:231],v251,s[20:23],s48 offen offset:0 sc1
M a[0:3],a[224:227],a[192:195],a[0:3]
s_waitcnt lgkmcnt(5)
ds_read_b128 a[220:223],v250 offset:1792
v_and_b32 v203,s42,v203
M a[4:7],a[224:227],a[196:199],a[4:7]
s_waitcnt lgkmcnt(5)
v_and_b32 v201,s42,v201
v_and_b32 v199,s42,v199
M a[8:11],a[224:227],a[200:203],a[8:11]
s_waitcnt lgkmcnt(4)
v_fmac_f32 v193,s43,v197
v_fmac_f32 v203,4.0,v195
M a[12:15],a[224:227],a[204:207],a[12:15]
s_waitcnt lgkmcnt(3)
v_fma_f32 v235,-4.0,v197,v201
v_fmac_f32 v193,s45,v201
M a[16:19],a[224:227],a[208:211],a[16:19]
s_waitcnt lgkmcnt(2)
v_fmac_f32 v203,s40,v199
v_sub_f32 v201,v201,v197
M a[20:23],a[224:227],a[212:215],a[20:23]
s_waitcnt lgkmcnt(1)
v_fma_f32 v197,-4.0,v195,v199
v_sub_f32 v199,v199,v195
M a[24:27],a[224:227],a[216:219],a[24:27]
s_waitcnt lgkmcnt(0)
v_add_f32 v195,v235,v197
v_sub_f32 v235,v235,v197
M a[28:31],a[224:227],a[220:223],a[28:31]
s_waitcnt vmcnt(16)
buffer_load_dwordx4 a[224:227],v251,s[20:23],s46 offen offset:1024 sc1
M a[32:35],a[228:231],a[192:195],a[32:35]
v_fma_f32 v197,2.0,v199,v201
v_fmac_f32 v201,-2.0,v199
M a[36:39],a[228:231],a[196:199],a[36:39]
v_cvt_pk_bf16_f32 v193,v232,v193
v_cvt_pk_bf16_f32 v203,v237,v203
M a[40:43],a[228:231],a[200:203],a[40:43]
v_cvt_pk_bf16_f32 v195,v233,v195
v_cvt_pk_bf16_f32 v199,v234,v197
M a[44:47],a[228:231],a[204:207],a[44:47]
v_cvt_pk_bf16_f32 v197,v238,v235
v_cvt_pk_bf16_f32 v201,v236,v201
M a[48:51],a[228:231],a[208:211],a[48:51]
ds_write2st64_b64 v247,v[192:193],v[202:203] offset0:136 offset1:153
M a[52:55],a[228:231],a[212:215],a[52:55]
s_add_u32 s28,s69,786432
buffer_load_dwordx2 v[192:193],v245,s[12:15],s28 offen offset:0
M a[56:59],a[228:231],a[216:219],a[56:59]
buffer_load_dwordx2 v[202:203],v245,s[16:19],s28 offen offset:1536
M a[60:63],a[228:231],a[220:223],a[60:63]
s_waitcnt vmcnt(18)
buffer_load_dwordx4 a[228:231],v251,s[20:23],s47 offen offset:1024 sc1
M a[64:67],a[232:235],a[192:195],a[64:67]
ds_read_b128 a[192:195],v250 offset:2048
ds_write2st64_b64 v247,v[194:195],v[196:197] offset0:102 offset1:119
M a[68:71],a[232:235],a[196:199],a[68:71]
buffer_load_dwordx2 v[194:195],v245,s[8:11],s28 offen offset:0
M a[72:75],a[232:235],a[200:203],a[72:75]
buffer_load_dwordx2 v[196:197],v245,s[8:11],s28 offen offset:384
M a[76:79],a[232:235],a[204:207],a[76:79]
M a[80:83],a[232:235],a[208:211],a[80:83]
M a[84:87],a[232:235],a[212:215],a[84:87]
M a[88:91],a[232:235],a[216:219],a[88:91]
M a[92:95],a[232:235],a[220:223],a[92:95]
s_waitcnt vmcnt(20)
buffer_load_dwordx4 a[232:235],v251,s[20:23],s48 offen offset:1024 sc1
M a[0:3],a[236:239],a[196:199],a[0:3]
M a[4:7],a[236:239],a[200:203],a[4:7]
M a[8:11],a[236:239],a[204:207],a[8:11]
M a[12:15],a[236:239],a[208:211],a[12:15]
M a[16:19],a[236:239],a[212:215],a[16:19]
M a[20:23],a[236:239],a[216:219],a[20:23]
M a[24:27],a[236:239],a[220:223],a[24:27]
s_waitcnt lgkmcnt(1)
M a[28:31],a[236:239],a[192:195],a[28:31]
s_waitcnt vmcnt(20)
buffer_load_dwordx4 a[236:239],v251,s[20:23],s46 offen offset:2048 sc1
M a[32:35],a[240:243],a[196:199],a[32:35]
M a[36:39],a[240:243],a[200:203],a[36:39]
M a[40:43],a[240:243],a[204:207],a[40:43]
M a[44:47],a[240:243],a[208:211],a[44:47]
M a[48:51],a[240:243],a[212:215],a[48:51]
M a[52:55],a[240:243],a[216:219],a[52:55]
M a[56:59],a[240:243],a[220:223],a[56:59]
M a[60:63],a[240:243],a[192:195],a[60:63]
s_waitcnt vmcnt(18)
buffer_load_dwordx4 a[240:243],v251,s[20:23],s47 offen offset:2048 sc1
M a[64:67],a[244:247],a[196:199],a[64:67]
ds_read_b128 a[196:199],v249 offset:2304
M a[68:71],a[244:247],a[200:203],a[68:71]
M a[72:75],a[244:247],a[204:207],a[72:75]
M a[76:79],a[244:247],a[208:211],a[76:79]
M a[80:83],a[244:247],a[212:215],a[80:83]
M a[84:87],a[244:247],a[216:219],a[84:87]
M a[88:91],a[244:247],a[220:223],a[88:91]
M a[92:95],a[244:247],a[192:195],a[92:95]
s_waitcnt vmcnt(14)
buffer_load_dwordx4 a[244:247],v251,s[20:23],s48 offen offset:2048 sc1
M a[0:3],a[248:251],a[200:203],a[0:3]
M a[4:7],a[248:251],a[204:207],a[4:7]
s_add_u32 s46,s80,27648
M a[8:11],a[248:251],a[208:211],a[8:11]
M a[12:15],a[248:251],a[212:215],a[12:15]
M a[16:19],a[248:251],a[216:219],a[16:19]
M a[20:23],a[248:251],a[220:223],a[20:23]
M a[24:27],a[248:251],a[192:195],a[24:27]
s_waitcnt lgkmcnt(0)
M a[28:31],a[248:251],a[196:199],a[28:31]
s_waitcnt vmcnt(14)
buffer_load_dwordx4 a[248:251],v251,s[20:23],s46 offen offset:0 sc1
M a[32:35],a[252:255],a[200:203],a[32:35]
M a[36:39],a[252:255],a[204:207],a[36:39]
s_add_u32 s47,s80,30720
M a[40:43],a[252:255],a[208:211],a[40:43]
M a[44:47],a[252:255],a[212:215],a[44:47]
M a[48:51],a[252:255],a[216:219],a[48:51]
M a[52:55],a[252:255],a[220:223],a[52:55]
M a[56:59],a[252:255],a[192:195],a[56:59]
M a[60:63],a[252:255],a[196:199],a[60:63]
s_waitcnt vmcnt(14)
buffer_load_dwordx4 a[252:255],v251,s[20:23],s47 offen offset:0 sc1
M a[64:67],v[216:219],a[200:203],a[64:67]
ds_read_b128 a[200:203],v249 offset:8704
M a[68:71],v[216:219],a[204:207],a[68:71]
s_add_u32 s48,s80,33792
ds_read_b128 a[204:207],v250 offset:8960
M a[72:75],v[216:219],a[208:211],a[72:75]
ds_read_b128 a[208:211],v250 offset:9216
M a[76:79],v[216:219],a[212:215],a[76:79]
ds_read_b128 a[212:215],v250 offset:9472
M a[80:83],v[216:219],a[216:219],a[80:83]
ds_read_b128 a[216:219],v250 offset:9728
M a[84:87],v[216:219],a[220:223],a[84:87]
ds_read_b128 a[220:223],v250 offset:9984
M a[88:91],v[216:219],a[192:195],a[88:91]
ds_read_b128 a[192:195],v250 offset:10240
M a[92:95],v[216:219],a[196:199],a[92:95]
s_waitcnt vmcnt(14) lgkmcnt(6)
buffer_load_dwordx4 v[216:219],v251,s[20:23],s48 offen offset:0 sc1
M a[96:99],v[220:223],a[200:203],a[96:99]
s_waitcnt lgkmcnt(5)
ds_read_b128 a[196:199],v250 offset:10496
M a[100:103],v[220:223],a[204:207],a[100:103]
s_waitcnt lgkmcnt(5)
M a[104:107],v[220:223],a[208:211],a[104:107]
s_waitcnt lgkmcnt(4)
M a[108:111],v[220:223],a[212:215],a[108:111]
s_waitcnt lgkmcnt(3)
M a[112:115],v[220:223],a[216:219],a[112:115]
s_waitcnt lgkmcnt(2)
M a[116:119],v[220:223],a[220:223],a[116:119]
s_waitcnt lgkmcnt(1)
M a[120:123],v[220:223],a[192:195],a[120:123]
s_waitcnt lgkmcnt(0)
M a[124:127],v[220:223],a[196:199],a[124:127]
s_waitcnt vmcnt(14)
buffer_load_dwordx4 v[220:223],v251,s[20:23],s46 offen offset:1024 sc1
M a[128:131],v[224:227],a[200:203],a[128:131]
M a[132:135],v[224:227],a[204:207],a[132:135]
M a[136:139],v[224:227],a[208:211],a[136:139]
M a[140:143],v[224:227],a[212:215],a[140:143]
M a[144:147],v[224:227],a[216:219],a[144:147]
M a[148:151],v[224:227],a[220:223],a[148:151]
M a[152:155],v[224:227],a[192:195],a[152:155]
M a[156:159],v[224:227],a[196:199],a[156:159]
s_waitcnt vmcnt(14)
buffer_load_dwordx4 v[224:227],v251,s[20:23],s47 offen offset:1024 sc1
M a[160:163],v[228:231],a[200:203],a[160:163]
ds_read_b128 a[200:203],v250 offset:10752
M a[164:167],v[228:231],a[204:207],a[164:167]
M a[168:171],v[228:231],a[208:211],a[168:171]
M a[172:175],v[228:231],a[212:215],a[172:175]
M a[176:179],v[228:231],a[216:219],a[176:179]
M a[180:183],v[228:231],a[220:223],a[180:183]
M a[184:187],v[228:231],a[192:195],a[184:187]
M a[188:191],v[228:231],a[196:199],a[188:191]
s_waitcnt vmcnt(14)
buffer_load_dwordx4 v[228:231],v251,s[20:23],s48 offen offset:1024 sc1
M a[96:99],a[224:227],a[204:207],a[96:99]
M a[100:103],a[224:227],a[208:211],a[100:103]
M a[104:107],a[224:227],a[212:215],a[104:107]
M a[108:111],a[224:227],a[216:219],a[108:111]
M a[112:115],a[224:227],a[220:223],a[112:115]
M a[116:119],a[224:227],a[192:195],a[116:119]
M a[120:123],a[224:227],a[196:199],a[120:123]
s_waitcnt lgkmcnt(0)
M a[124:127],a[224:227],a[200:203],a[124:127]
s_waitcnt vmcnt(12)
buffer_load_dwordx4 a[224:227],v251,s[20:23],s46 offen offset:2048 sc1
M a[128:131],a[228:231],a[204:207],a[128:131]
M a[132:135],a[228:231],a[208:211],a[132:135]
M a[136:139],a[228:231],a[212:215],a[136:139]
M a[140:143],a[228:231],a[216:219],a[140:143]
M a[144:147],a[228:231],a[220:223],a[144:147]
M a[148:151],a[228:231],a[192:195],a[148:151]
M a[152:155],a[228:231],a[196:199],a[152:155]
M a[156:159],a[228:231],a[200:203],a[156:159]
s_waitcnt vmcnt(10)
buffer_load_dwordx4 a[228:231],v251,s[20:23],s47 offen offset:2048 sc1
M a[160:163],a[232:235],a[204:207],a[160:163]
ds_read_b128 a[204:207],v249 offset:11008
M a[164:167],a[232:235],a[208:211],a[164:167]
M a[168:171],a[232:235],a[212:215],a[168:171]
M a[172:175],a[232:235],a[216:219],a[172:175]
M a[176:179],a[232:235],a[220:223],a[176:179]
M a[180:183],a[232:235],a[192:195],a[180:183]
M a[184:187],a[232:235],a[196:199],a[184:187]
M a[188:191],a[232:235],a[200:203],a[188:191]
s_waitcnt vmcnt(10)
buffer_load_dwordx4 a[232:235],v251,s[20:23],s48 offen offset:2048 sc1
M a[96:99],a[236:239],a[208:211],a[96:99]
M a[100:103],a[236:239],a[212:215],a[100:103]
s_add_u32 s46,s80,36864
M a[104:107],a[236:239],a[216:219],a[104:107]
M a[108:111],a[236:239],a[220:223],a[108:111]
M a[112:115],a[236:239],a[192:195],a[112:115]
M a[116:119],a[236:239],a[196:199],a[116:119]
M a[120:123],a[236:239],a[200:203],a[120:123]
s_waitcnt lgkmcnt(0)
M a[124:127],a[236:239],a[204:207],a[124:127]
s_waitcnt vmcnt(10)
buffer_load_dwordx4 a[236:239],v251,s[20:23],s46 offen offset:0 sc1
M a[128:131],a[240:243],a[208:211],a[128:131]
M a[132:135],a[240:243],a[212:215],a[132:135]
s_barrier
ds_write2st64_b64 v247,v[198:199],v[200:201] offset0:34 offset1:51
M a[136:139],a[240:243],a[216:219],a[136:139]
s_add_u32 s47,s80,39936
buffer_load_dwordx2 v[198:199],v245,s[8:11],s28 offen offset:768
M a[140:143],a[240:243],a[220:223],a[140:143]
buffer_load_dwordx2 v[200:201],v245,s[8:11],s28 offen offset:1152
M a[144:147],a[240:243],a[192:195],a[144:147]
v_lshlrev_b32 v234,16,v208
v_lshlrev_b32 v232,16,v204
M a[148:151],a[240:243],a[196:199],a[148:151]
v_lshlrev_b32 v233,16,v206
v_lshlrev_b32 v237,16,v214
M a[152:155],a[240:243],a[200:203],a[152:155]
v_lshlrev_b32 v236,16,v212
v_lshlrev_b32 v235,16,v210
M a[156:159],a[240:243],a[204:207],a[156:159]
s_waitcnt vmcnt(12)
buffer_load_dwordx4 a[240:243],v251,s[20:23],s47 offen offset:0 sc1
M a[160:163],a[244:247],a[208:211],a[160:163]
ds_read_b128 a[208:211],v249 offset:17408
v_fmac_f32 v232,s43,v234
M a[164:167],a[244:247],a[212:215],a[164:167]
s_add_u32 s48,s80,43008
ds_read_b128 a[212:215],v250 offset:17664
v_fmac_f32 v237,4.0,v233
M a[168:171],a[244:247],a[216:219],a[168:171]
ds_read_b128 a[216:219],v250 offset:17920
v_fma_f32 v238,-4.0,v234,v236
M a[172:175],a[244:247],a[220:223],a[172:175]
ds_read_b128 a[220:223],v250 offset:18176
v_fmac_f32 v232,s45,v236
M a[176:179],a[244:247],a[192:195],a[176:179]
ds_read_b128 a[192:195],v250 offset:18432
v_fmac_f32 v237,s40,v235
M a[180:183],a[244:247],a[196:199],a[180:183]
ds_read_b128 a[196:199],v250 offset:18688
v_sub_f32 v236,v236,v234
M a[184:187],a[244:247],a[200:203],a[184:187]
ds_read_b128 a[200:203],v250 offset:18944
v_fma_f32 v234,-4.0,v233,v235
M a[188:191],a[244:247],a[204:207],a[188:191]
s_waitcnt vmcnt(12) lgkmcnt(6)
buffer_load_dwordx4 a[244:247],v251,s[20:23],s48 offen offset:0 sc1
M v[0:3],a[248:251],a[208:211],v[0:3]
s_waitcnt lgkmcnt(5)
ds_read_b128 a[204:207],v250 offset:19200
v_sub_f32 v235,v235,v233
M v[4:7],a[248:251],a[212:215],v[4:7]
s_waitcnt lgkmcnt(5)
v_add_f32 v233,v238,v234
v_sub_f32 v238,v238,v234
M v[8:11],a[248:251],a[216:219],v[8:11]
s_waitcnt lgkmcnt(4)
v_fma_f32 v234,2.0,v235,v236
v_fmac_f32 v236,-2.0,v235
M v[12:15],a[248:251],a[220:223],v[12:15]
s_waitcnt lgkmcnt(3)
v_and_b32 v208,s42,v208
v_and_b32 v204,s42,v204
M v[16:19],a[248:251],a[192:195],v[16:19]
s_waitcnt lgkmcnt(2)
v_and_b32 v206,s42,v206
v_and_b32 v214,s42,v214
M v[20:23],a[248:251],a[196:199],v[20:23]
s_waitcnt lgkmcnt(1)
v_and_b32 v212,s42,v212
v_and_b32 v210,s42,v210
M v[24:27],a[248:251],a[200:203],v[24:27]
s_waitcnt lgkmcnt(0)
v_fmac_f32 v204,s43,v208
v_fmac_f32 v214,4.0,v206
M v[28:31],a[248:251],a[204:207],v[28:31]
s_waitcnt vmcnt(12)
buffer_load_dwordx4 a[248:251],v251,s[20:23],s46 offen offset:1024 sc1
M v[32:35],a[252:255],a[208:211],v[32:35]
v_fma_f32 v235,-4.0,v208,v212
v_fmac_f32 v204,s45,v212
M v[36:39],a[252:255],a[212:215],v[36:39]
v_fmac_f32 v214,s40,v210
v_sub_f32 v212,v212,v208
M v[40:43],a[252:255],a[216:219],v[40:43]
v_fma_f32 v208,-4.0,v206,v210
v_sub_f32 v210,v210,v206
M v[44:47],a[252:255],a[220:223],v[44:47]
v_add_f32 v206,v235,v208
v_sub_f32 v235,v235,v208
M v[48:51],a[252:255],a[192:195],v[48:51]
v_fma_f32 v208,2.0,v210,v212
v_fmac_f32 v212,-2.0,v210
M v[52:55],a[252:255],a[196:199],v[52:55]
v_cvt_pk_bf16_f32 v204,v232,v204
v_cvt_pk_bf16_f32 v214,v237,v214
M v[56:59],a[252:255],a[200:203],v[56:59]
v_cvt_pk_bf16_f32 v206,v233,v206
v_cvt_pk_bf16_f32 v210,v234,v208
M v[60:63],a[252:255],a[204:207],v[60:63]
s_waitcnt vmcnt(12)
buffer_load_dwordx4 a[252:255],v251,s[20:23],s47 offen offset:1024 sc1
M v[64:67],v[216:219],a[208:211],v[64:67]
ds_read_b128 a[208:211],v250 offset:19456
v_cvt_pk_bf16_f32 v208,v238,v235
M v[68:71],v[216:219],a[212:215],v[68:71]
v_cvt_pk_bf16_f32 v212,v236,v212
v_lshlrev_b32 v234,16,v209
M v[72:75],v[216:219],a[216:219],v[72:75]
v_lshlrev_b32 v232,16,v205
v_lshlrev_b32 v233,16,v207
M v[76:79],v[216:219],a[220:223],v[76:79]
v_lshlrev_b32 v237,16,v215
v_lshlrev_b32 v236,16,v213
M v[80:83],v[216:219],a[192:195],v[80:83]
v_lshlrev_b32 v235,16,v211
v_fmac_f32 v232,s43,v234
M v[84:87],v[216:219],a[196:199],v[84:87]
v_fmac_f32 v237,4.0,v233
v_fma_f32 v238,-4.0,v234,v236
M v[88:91],v[216:219],a[200:203],v[88:91]
v_fmac_f32 v232,s45,v236
v_fmac_f32 v237,s40,v235
M v[92:95],v[216:219],a[204:207],v[92:95]
s_waitcnt vmcnt(12)
buffer_load_dwordx4 v[216:219],v251,s[20:23],s48 offen offset:1024 sc1
M v[0:3],v[220:223],a[212:215],v[0:3]
v_sub_f32 v236,v236,v234
v_fma_f32 v234,-4.0,v233,v235
M v[4:7],v[220:223],a[216:219],v[4:7]
v_sub_f32 v235,v235,v233
v_add_f32 v233,v238,v234
M v[8:11],v[220:223],a[220:223],v[8:11]
v_sub_f32 v238,v238,v234
v_fma_f32 v234,2.0,v235,v236
M v[12:15],v[220:223],a[192:195],v[12:15]
v_fmac_f32 v236,-2.0,v235
v_and_b32 v209,s42,v209
M v[16:19],v[220:223],a[196:199],v[16:19]
v_and_b32 v205,s42,v205
v_and_b32 v207,s42,v207
M v[20:23],v[220:223],a[200:203],v[20:23]
v_and_b32 v215,s42,v215
v_and_b32 v213,s42,v213
M v[24:27],v[220:223],a[204:207],v[24:27]
s_waitcnt lgkmcnt(0)
v_and_b32 v211,s42,v211
v_fmac_f32 v205,s43,v209
M v[28:31],v[220:223],a[208:211],v[28:31]
s_waitcnt vmcnt(12)
buffer_load_dwordx4 v[220:223],v251,s[20:23],s46 offen offset:2048 sc1
M v[32:35],v[224:227],a[212:215],v[32:35]
v_fmac_f32 v215,4.0,v207
v_fma_f32 v235,-4.0,v209,v213
M v[36:39],v[224:227],a[216:219],v[36:39]
v_fmac_f32 v205,s45,v213
v_fmac_f32 v215,s40,v211
M v[40:43],v[224:227],a[220:223],v[40:43]
v_sub_f32 v213,v213,v209
v_fma_f32 v209,-4.0,v207,v211
M v[44:47],v[224:227],a[192:195],v[44:47]
v_sub_f32 v211,v211,v207
v_add_f32 v207,v235,v209
M v[48:51],v[224:227],a[196:199],v[48:51]
v_sub_f32 v235,v235,v209
v_fma_f32 v209,2.0,v211,v213
M v[52:55],v[224:227],a[200:203],v[52:55]
v_fmac_f32 v213,-2.0,v211
v_cvt_pk_bf16_f32 v205,v232,v205
M v[56:59],v[224:227],a[204:207],v[56:59]
v_cvt_pk_bf16_f32 v215,v237,v215
v_cvt_pk_bf16_f32 v207,v233,v207
M v[60:63],v[224:227],a[208:211],v[60:63]
s_waitcnt vmcnt(12)
buffer_load_dwordx4 v[224:227],v251,s[20:23],s47 offen offset:2048 sc1
M v[64:67],v[228:231],a[212:215],v[64:67]
ds_read_b128 a[212:215],v249 offset:19712
v_cvt_pk_bf16_f32 v211,v234,v209
M v[68:71],v[228:231],a[216:219],v[68:71]
v_cvt_pk_bf16_f32 v209,v238,v235
v_cvt_pk_bf16_f32 v213,v236,v213
M v[72:75],v[228:231],a[220:223],v[72:75]
ds_write2st64_b64 v247,v[204:205],v[214:215] offset0:137 offset1:154
M v[76:79],v[228:231],a[192:195],v[76:79]
s_add_u32 s28,s69,1179648
buffer_load_dwordx2 v[204:205],v245,s[12:15],s28 offen offset:0
M v[80:83],v[228:231],a[196:199],v[80:83]
buffer_load_dwordx2 v[214:215],v245,s[16:19],s28 offen offset:1536
M v[84:87],v[228:231],a[200:203],v[84:87]
ds_write2st64_b64 v247,v[206:207],v[208:209] offset0:103 offset1:120
M v[88:91],v[228:231],a[204:207],v[88:91]
buffer_load_dwordx2 v[206:207],v245,s[8:11],s28 offen offset:0
M v[92:95],v[228:231],a[208:211],v[92:95]
s_waitcnt vmcnt(15)
buffer_load_dwordx2 v[208:209],v245,s[8:11],s28 offen offset:384
M v[0:3],a[224:227],a[216:219],v[0:3]
buffer_load_dwordx4 v[228:231],v251,s[20:23],s48 offen offset:2048 sc1
M v[4:7],a[224:227],a[220:223],v[4:7]
s_add_u32 s46,s81,9216
ds_write2st64_b64 v247,v[210:211],v[212:213] offset0:35 offset1:52
M v[8:11],a[224:227],a[192:195],v[8:11]
buffer_load_dwordx2 v[210:211],v245,s[8:11],s28 offen offset:768
M v[12:15],a[224:227],a[196:199],v[12:15]
buffer_load_dwordx2 v[212:213],v245,s[8:11],s28 offen offset:1152
M v[16:19],a[224:227],a[200:203],v[16:19]
v_fmac_f32 v239,s43,v241
v_fmac_f32 v244,4.0,v240
M v[20:23],a[224:227],a[204:207],v[20:23]
v_fma_f32 v232,-4.0,v241,v243
v_fmac_f32 v239,s45,v243
M v[24:27],a[224:227],a[208:211],v[24:27]
s_waitcnt lgkmcnt(3)
v_fmac_f32 v244,s40,v242
v_sub_f32 v243,v243,v241
M v[28:31],a[224:227],a[212:215],v[28:31]
s_waitcnt vmcnt(18)
buffer_load_dwordx4 a[224:227],v251,s[20:23],s46 offen offset:0 sc1
M v[32:35],a[228:231],a[216:219],v[32:35]
v_fma_f32 v241,-4.0,v240,v242
v_sub_f32 v242,v242,v240
M v[36:39],a[228:231],a[220:223],v[36:39]
v_add_f32 v240,v232,v241
v_sub_f32 v232,v232,v241
M v[40:43],a[228:231],a[192:195],v[40:43]
v_fma_f32 v241,2.0,v242,v243
v_fmac_f32 v243,-2.0,v242
M v[44:47],a[228:231],a[196:199],v[44:47]
v_cvt_pk_bf16_f32 v233,v239,v244
v_cvt_pk_bf16_f32 v234,v240,v232
M v[48:51],a[228:231],a[200:203],v[48:51]
v_cvt_pk_bf16_f32 v235,v241,v243
v_add_u32 v232,69632,v248
M v[52:55],a[228:231],a[204:207],v[52:55]
ds_write_b16 v232,v233 offset:0
M v[56:59],a[228:231],a[208:211],v[56:59]
ds_write_b16_d16_hi v232,v233 offset:8704
M v[60:63],a[228:231],a[212:215],v[60:63]
s_waitcnt vmcnt(18)
buffer_load_dwordx4 a[228:231],v251,s[20:23],s46 offen offset:1024 sc1
M v[64:67],a[232:235],a[216:219],v[64:67]
ds_read_b128 a[216:219],v249 offset:26112
ds_write_b16 v248,v234 offset:52224
M v[68:71],a[232:235],a[220:223],v[68:71]
ds_read_b128 a[220:223],v250 offset:26368
ds_write_b16_d16_hi v248,v234 offset:60928
M v[72:75],a[232:235],a[192:195],v[72:75]
ds_read_b128 a[192:195],v250 offset:26624
ds_write_b16 v248,v235 offset:17408
M v[76:79],a[232:235],a[196:199],v[76:79]
ds_read_b128 a[196:199],v250 offset:26880
ds_write_b16_d16_hi v248,v235 offset:26112
M v[80:83],a[232:235],a[200:203],v[80:83]
ds_read_b128 a[200:203],v250 offset:27136
v_bfe_u32 v232,v251,9,1
M v[84:87],a[232:235],a[204:207],v[84:87]
ds_read_b128 a[204:207],v250 offset:27392
v_mul_u32_u24 v232,33,v232
M v[88:91],a[232:235],a[208:211],v[88:91]
ds_read_b128 a[208:211],v250 offset:27648
v_add_u32 v232,s49,v232
M v[92:95],a[232:235],a[212:215],v[92:95]
s_waitcnt vmcnt(18) lgkmcnt(10)
buffer_load_dwordx4 a[232:235],v251,s[20:23],s46 offen offset:2048 sc1
M v[96:99],a[236:239],a[216:219],v[96:99]
s_waitcnt lgkmcnt(8)
ds_read_b128 a[212:215],v250 offset:27904
v_add_u32 v232,31,v232
M v[100:103],a[236:239],a[220:223],v[100:103]
s_waitcnt lgkmcnt(7)
s_add_u32 s46,s81,18432
v_mul_u32_u24 v233,196608,v232
v_cmp_gt_u32 vcc,512,v232
M v[104:107],a[236:239],a[192:195],v[104:107]
s_waitcnt lgkmcnt(5)
v_bfe_u32 v232,v251,3,6
v_add_u32 v233,v233,v232
M v[108:111],a[236:239],a[196:199],v[108:111]
s_waitcnt lgkmcnt(3)
v_bfrev_b32 v232,1
v_cndmask_b32 v246,v232,v233,vcc
M v[112:115],a[236:239],a[200:203],v[112:115]
s_waitcnt lgkmcnt(2)
buffer_load_short_d16_hi v239,v246,s[12:15],s70 offen offset:0
M v[116:119],a[236:239],a[204:207],v[116:119]
s_waitcnt lgkmcnt(1)
buffer_load_short_d16_hi v240,v246,s[8:11],s70 offen offset:0
M v[120:123],a[236:239],a[208:211],v[120:123]
s_waitcnt lgkmcnt(0)
buffer_load_short_d16_hi v241,v246,s[8:11],s70 offen offset:384
M v[124:127],a[236:239],a[212:215],v[124:127]
s_waitcnt vmcnt(19)
buffer_load_short_d16_hi v242,v246,s[8:11],s70 offen offset:768
M v[128:131],a[240:243],a[216:219],v[128:131]
buffer_load_short_d16_hi v243,v246,s[8:11],s70 offen offset:1152
M v[132:135],a[240:243],a[220:223],v[132:135]
buffer_load_short_d16_hi v244,v246,s[16:19],s70 offen offset:1536
v_lshlrev_b32 v234,16,v196
v_lshlrev_b32 v232,16,v192
v_lshlrev_b32 v233,16,v194
v_lshlrev_b32 v237,16,v202
M v[136:139],a[240:243],a[192:195],v[136:139]
buffer_load_dwordx4 a[236:239],v251,s[20:23],s46 offen offset:0 sc1
v_lshlrev_b32 v236,16,v200
v_lshlrev_b32 v235,16,v198
v_fmac_f32 v232,s43,v234
v_fmac_f32 v237,4.0,v233
M v[140:143],a[240:243],a[196:199],v[140:143]
v_fma_f32 v238,-4.0,v234,v236
v_fmac_f32 v232,s45,v236
v_fmac_f32 v237,s40,v235
v_sub_f32 v236,v236,v234
M v[144:147],a[240:243],a[200:203],v[144:147]
v_fma_f32 v234,-4.0,v233,v235
v_sub_f32 v235,v235,v233
v_add_f32 v233,v238,v234
v_sub_f32 v238,v238,v234
M v[148:151],a[240:243],a[204:207],v[148:151]
v_fma_f32 v234,2.0,v235,v236
v_fmac_f32 v236,-2.0,v235
v_and_b32 v196,s42,v196
v_and_b32 v192,s42,v192
M v[152:155],a[240:243],a[208:211],v[152:155]
v_and_b32 v194,s42,v194
v_and_b32 v202,s42,v202
v_and_b32 v200,s42,v200
v_and_b32 v198,s42,v198
M v[156:159],a[240:243],a[212:215],v[156:159]
s_waitcnt vmcnt(22)
buffer_load_dwordx4 a[240:243],v251,s[20:23],s46 offen offset:1024 sc1
v_fmac_f32 v192,s43,v196
v_fmac_f32 v202,4.0,v194
v_fma_f32 v235,-4.0,v196,v200
v_fmac_f32 v192,s45,v200
M v[160:163],a[244:247],a[216:219],v[160:163]
ds_read_b128 a[216:219],v250 offset:28160
v_fmac_f32 v202,s40,v198
v_sub_f32 v200,v200,v196
v_fma_f32 v196,-4.0,v194,v198
v_sub_f32 v198,v198,v194
M v[164:167],a[244:247],a[220:223],v[164:167]
v_add_f32 v194,v235,v196
v_sub_f32 v235,v235,v196
v_fma_f32 v196,2.0,v198,v200
v_fmac_f32 v200,-2.0,v198
M v[168:171],a[244:247],a[192:195],v[168:171]
v_cvt_pk_bf16_f32 v192,v232,v192
v_cvt_pk_bf16_f32 v202,v237,v202
v_cvt_pk_bf16_f32 v194,v233,v194
v_cvt_pk_bf16_f32 v198,v234,v196
M v[172:175],a[244:247],a[196:199],v[172:175]
v_cvt_pk_bf16_f32 v196,v238,v235
v_cvt_pk_bf16_f32 v200,v236,v200
v_lshlrev_b32 v234,16,v197
v_lshlrev_b32 v232,16,v193
M v[176:179],a[244:247],a[200:203],v[176:179]
v_lshlrev_b32 v233,16,v195
v_lshlrev_b32 v237,16,v203
v_lshlrev_b32 v236,16,v201
v_lshlrev_b32 v235,16,v199
M v[180:183],a[244:247],a[204:207],v[180:183]
v_fmac_f32 v232,s43,v234
v_fmac_f32 v237,4.0,v233
v_fma_f32 v238,-4.0,v234,v236
v_fmac_f32 v232,s45,v236
M v[184:187],a[244:247],a[208:211],v[184:187]
v_fmac_f32 v237,s40,v235
v_sub_f32 v236,v236,v234
v_fma_f32 v234,-4.0,v233,v235
v_sub_f32 v235,v235,v233
M v[188:191],a[244:247],a[212:215],v[188:191]
s_waitcnt vmcnt(22)
buffer_load_dwordx4 a[244:247],v251,s[20:23],s46 offen offset:2048 sc1
v_add_f32 v233,v238,v234
v_sub_f32 v238,v238,v234
v_fma_f32 v234,2.0,v235,v236
v_fmac_f32 v236,-2.0,v235
M v[96:99],a[248:251],a[220:223],v[96:99]
v_and_b32 v197,s42,v197
v_and_b32 v193,s42,v193
v_and_b32 v195,s42,v195
v_and_b32 v203,s42,v203
M v[100:103],a[248:251],a[192:195],v[100:103]
s_add_u32 s46,s81,27648
v_and_b32 v201,s42,v201
v_and_b32 v199,s42,v199
v_fmac_f32 v193,s43,v197
v_fmac_f32 v203,4.0,v195
M v[104:107],a[248:251],a[196:199],v[104:107]
v_fma_f32 v235,-4.0,v197,v201
v_fmac_f32 v193,s45,v201
v_fmac_f32 v203,s40,v199
v_sub_f32 v201,v201,v197
M v[108:111],a[248:251],a[200:203],v[108:111]
v_fma_f32 v197,-4.0,v195,v199
v_sub_f32 v199,v199,v195
v_add_f32 v195,v235,v197
v_sub_f32 v235,v235,v197
M v[112:115],a[248:251],a[204:207],v[112:115]
v_fma_f32 v197,2.0,v199,v201
v_fmac_f32 v201,-2.0,v199
v_cvt_pk_bf16_f32 v193,v232,v193
v_cvt_pk_bf16_f32 v203,v237,v203
M v[116:119],a[248:251],a[208:211],v[116:119]
v_cvt_pk_bf16_f32 v195,v233,v195
v_cvt_pk_bf16_f32 v199,v234,v197
v_cvt_pk_bf16_f32 v197,v238,v235
v_cvt_pk_bf16_f32 v201,v236,v201
M v[120:123],a[248:251],a[212:215],v[120:123]
s_waitcnt lgkmcnt(0)
ds_write2st64_b64 v247,v[192:193],v[202:203] offset0:138 offset1:155
M v[124:127],a[248:251],a[216:219],v[124:127]
s_waitcnt vmcnt(22)
s_add_u32 s28,s64,6291456
buffer_load_dwordx2 v[192:193],v245,s[12:15],s28 offen offset:0
ds_write2st64_b64 v247,v[194:195],v[196:197] offset0:104 offset1:121
M v[128:131],a[252:255],a[220:223],v[128:131]
buffer_load_dwordx2 v[202:203],v245,s[16:19],s28 offen offset:1536
M v[132:135],a[252:255],a[192:195],v[132:135]
buffer_load_dwordx2 v[194:195],v245,s[8:11],s28 offen offset:0
ds_write2st64_b64 v247,v[198:199],v[200:201] offset0:36 offset1:53
M v[136:139],a[252:255],a[196:199],v[136:139]
s_waitcnt vmcnt(18)
buffer_load_dwordx2 v[196:197],v245,s[8:11],s28 offen offset:384
v_lshlrev_b32 v234,16,v208
M v[140:143],a[252:255],a[200:203],v[140:143]
s_waitcnt vmcnt(16)
buffer_load_dwordx2 v[198:199],v245,s[8:11],s28 offen offset:768
v_lshlrev_b32 v232,16,v204
v_lshlrev_b32 v233,16,v206
v_lshlrev_b32 v237,16,v214
v_lshlrev_b32 v236,16,v212
M v[144:147],a[252:255],a[204:207],v[144:147]
buffer_load_dwordx2 v[200:201],v245,s[8:11],s28 offen offset:1152
v_lshlrev_b32 v235,16,v210
v_fmac_f32 v232,s43,v234
v_fmac_f32 v237,4.0,v233
v_fma_f32 v238,-4.0,v234,v236
M v[148:151],a[252:255],a[208:211],v[148:151]
buffer_load_dwordx4 a[248:251],v251,s[20:23],s46 offen offset:0 sc1
v_fmac_f32 v232,s45,v236
v_fmac_f32 v237,s40,v235
v_sub_f32 v236,v236,v234
v_fma_f32 v234,-4.0,v233,v235
M v[152:155],a[252:255],a[212:215],v[152:155]
v_sub_f32 v235,v235,v233
v_add_f32 v233,v238,v234
v_sub_f32 v238,v238,v234
v_fma_f32 v234,2.0,v235,v236
M v[156:159],a[252:255],a[216:219],v[156:159]
buffer_load_dwordx4 a[252:255],v251,s[20:23],s46 offen offset:1024 sc1
v_fmac_f32 v236,-2.0,v235
v_and_b32 v208,s42,v208
v_and_b32 v204,s42,v204
v_and_b32 v206,s42,v206
M v[160:163],v[216:219],a[220:223],v[160:163]
ds_read_b128 a[220:223],v249 offset:28416
v_and_b32 v214,s42,v214
v_and_b32 v212,s42,v212
v_and_b32 v210,s42,v210
v_fmac_f32 v204,s43,v208
M v[164:167],v[216:219],a[192:195],v[164:167]
v_fmac_f32 v214,4.0,v206
v_fma_f32 v235,-4.0,v208,v212
v_fmac_f32 v204,s45,v212
v_fmac_f32 v214,s40,v210
M v[168:171],v[216:219],a[196:199],v[168:171]
v_sub_f32 v212,v212,v208
v_fma_f32 v208,-4.0,v206,v210
v_sub_f32 v210,v210,v206
v_add_f32 v206,v235,v208
M v[172:175],v[216:219],a[200:203],v[172:175]
v_sub_f32 v235,v235,v208
v_fma_f32 v208,2.0,v210,v212
v_fmac_f32 v212,-2.0,v210
v_cvt_pk_bf16_f32 v204,v232,v204
M v[176:179],v[216:219],a[204:207],v[176:179]
v_cvt_pk_bf16_f32 v214,v237,v214
v_cvt_pk_bf16_f32 v206,v233,v206
v_cvt_pk_bf16_f32 v210,v234,v208
v_cvt_pk_bf16_f32 v208,v238,v235
M v[180:183],v[216:219],a[208:211],v[180:183]
v_cvt_pk_bf16_f32 v212,v236,v212
v_lshlrev_b32 v234,16,v209
v_lshlrev_b32 v232,16,v205
v_lshlrev_b32 v233,16,v207
M v[184:187],v[216:219],a[212:215],v[184:187]
v_lshlrev_b32 v237,16,v215
v_lshlrev_b32 v236,16,v213
v_lshlrev_b32 v235,16,v211
v_fmac_f32 v232,s43,v234
M v[188:191],v[216:219],a[216:219],v[188:191]
buffer_load_dwordx4 v[216:219],v251,s[20:23],s46 offen offset:2048 sc1
v_fmac_f32 v237,4.0,v233
v_fma_f32 v238,-4.0,v234,v236
v_fmac_f32 v232,s45,v236
v_fmac_f32 v237,s40,v235
M v[96:99],v[220:223],a[192:195],v[96:99]
v_sub_f32 v236,v236,v234
v_fma_f32 v234,-4.0,v233,v235
v_sub_f32 v235,v235,v233
v_add_f32 v233,v238,v234
M v[100:103],v[220:223],a[196:199],v[100:103]
s_add_u32 s46,s81,36864
v_sub_f32 v238,v238,v234
v_fma_f32 v234,2.0,v235,v236
v_fmac_f32 v236,-2.0,v235
v_and_b32 v209,s42,v209
M v[104:107],v[220:223],a[200:203],v[104:107]
v_and_b32 v205,s42,v205
v_and_b32 v207,s42,v207
v_and_b32 v215,s42,v215
v_and_b32 v213,s42,v213
M v[108:111],v[220:223],a[204:207],v[108:111]
v_and_b32 v211,s42,v211
v_fmac_f32 v205,s43,v209
v_fmac_f32 v215,4.0,v207
v_fma_f32 v235,-4.0,v209,v213
M v[112:115],v[220:223],a[208:211],v[112:115]
v_fmac_f32 v205,s45,v213
v_fmac_f32 v215,s40,v211
v_sub_f32 v213,v213,v209
v_fma_f32 v209,-4.0,v207,v211
M v[116:119],v[220:223],a[212:215],v[116:119]
v_sub_f32 v211,v211,v207
v_add_f32 v207,v235,v209
v_sub_f32 v235,v235,v209
v_fma_f32 v209,2.0,v211,v213
M v[120:123],v[220:223],a[216:219],v[120:123]
s_waitcnt lgkmcnt(0)
v_fmac_f32 v213,-2.0,v211
v_cvt_pk_bf16_f32 v205,v232,v205
v_cvt_pk_bf16_f32 v215,v237,v215
v_cvt_pk_bf16_f32 v207,v233,v207
M v[124:127],v[220:223],a[220:223],v[124:127]
buffer_load_dwordx4 v[220:223],v251,s[20:23],s46 offen offset:0 sc1
v_cvt_pk_bf16_f32 v211,v234,v209
v_cvt_pk_bf16_f32 v209,v238,v235
v_cvt_pk_bf16_f32 v213,v236,v213
M v[128:131],v[224:227],a[192:195],v[128:131]
ds_write2st64_b64 v247,v[204:205],v[214:215] offset0:139 offset1:156
M v[132:135],v[224:227],a[196:199],v[132:135]
s_add_u32 s28,s64,6684672
buffer_load_dwordx2 v[204:205],v245,s[12:15],s28 offen offset:0
ds_write2st64_b64 v247,v[206:207],v[208:209] offset0:105 offset1:122
M v[136:139],v[224:227],a[200:203],v[136:139]
buffer_load_dwordx2 v[214:215],v245,s[16:19],s28 offen offset:1536
M v[140:143],v[224:227],a[204:207],v[140:143]
buffer_load_dwordx2 v[206:207],v245,s[8:11],s28 offen offset:0
ds_write2st64_b64 v247,v[210:211],v[212:213] offset0:37 offset1:54
M v[144:147],v[224:227],a[208:211],v[144:147]
buffer_load_dwordx2 v[208:209],v245,s[8:11],s28 offen offset:384
M v[148:151],v[224:227],a[212:215],v[148:151]
buffer_load_dwordx2 v[210:211],v245,s[8:11],s28 offen offset:768
M v[152:155],v[224:227],a[216:219],v[152:155]
s_waitcnt lgkmcnt(0)
s_barrier
buffer_load_dwordx2 v[212:213],v245,s[8:11],s28 offen offset:1152
M v[156:159],v[224:227],a[220:223],v[156:159]
buffer_load_dwordx4 v[224:227],v251,s[20:23],s46 offen offset:1024 sc1
M v[160:163],v[228:231],a[192:195],v[160:163]
ds_read_b128 a[192:195],v249 offset:34816
M v[164:167],v[228:231],a[196:199],v[164:167]
ds_read_b128 a[196:199],v250 offset:35072
M v[168:171],v[228:231],a[200:203],v[168:171]
s_waitcnt vmcnt(13)
ds_read_b128 a[200:203],v250 offset:35328
v_lshlrev_b32 v234,16,v196
M v[172:175],v[228:231],a[204:207],v[172:175]
ds_read_b128 a[204:207],v250 offset:35584
v_lshlrev_b32 v232,16,v192
M v[176:179],v[228:231],a[208:211],v[176:179]
ds_read_b128 a[208:211],v250 offset:35840
v_lshlrev_b32 v233,16,v194
M v[180:183],v[228:231],a[212:215],v[180:183]
ds_read_b128 a[212:215],v250 offset:36096
v_lshlrev_b32 v237,16,v202
M v[184:187],v[228:231],a[216:219],v[184:187]
s_waitcnt vmcnt(11)
ds_read_b128 a[216:219],v250 offset:36352
v_lshlrev_b32 v236,16,v200
M v[188:191],v[228:231],a[220:223],v[188:191]
s_waitcnt lgkmcnt(6)
buffer_load_dwordx4 v[228:231],v251,s[20:23],s46 offen offset:2048 sc1
M a[0:3],a[224:227],a[192:195],a[0:3]
s_waitcnt lgkmcnt(5)
ds_read_b128 a[220:223],v250 offset:36608
ds_read_b128 a[192:195],v250 offset:36864
M a[4:7],a[224:227],a[196:199],a[4:7]
s_waitcnt lgkmcnt(6)
s_add_u32 s47,s81,12288
v_lshlrev_b32 v235,16,v198
v_fmac_f32 v232,s43,v234
M a[8:11],a[224:227],a[200:203],a[8:11]
s_waitcnt lgkmcnt(5)
v_fmac_f32 v237,4.0,v233
v_fma_f32 v238,-4.0,v234,v236
M a[12:15],a[224:227],a[204:207],a[12:15]
s_waitcnt lgkmcnt(4)
v_fmac_f32 v232,s45,v236
v_fmac_f32 v237,s40,v235
M a[16:19],a[224:227],a[208:211],a[16:19]
s_waitcnt lgkmcnt(3)
v_sub_f32 v236,v236,v234
v_fma_f32 v234,-4.0,v233,v235
M a[20:23],a[224:227],a[212:215],a[20:23]
s_waitcnt lgkmcnt(2)
v_sub_f32 v235,v235,v233
v_add_f32 v233,v238,v234
M a[24:27],a[224:227],a[216:219],a[24:27]
s_waitcnt lgkmcnt(1)
v_sub_f32 v238,v238,v234
v_fma_f32 v234,2.0,v235,v236
M a[28:31],a[224:227],a[220:223],a[28:31]
buffer_load_dwordx4 a[224:227],v251,s[20:23],s47 offen offset:0 sc1
M a[0:3],a[228:231],a[196:199],a[0:3]
ds_read_b128 a[196:199],v249 offset:37120
v_fmac_f32 v236,-2.0,v235
M a[4:7],a[228:231],a[200:203],a[4:7]
s_add_u32 s48,s81,15360
v_and_b32 v196,s42,v196
v_and_b32 v192,s42,v192
M a[8:11],a[228:231],a[204:207],a[8:11]
v_and_b32 v194,s42,v194
v_and_b32 v202,s42,v202
M a[12:15],a[228:231],a[208:211],a[12:15]
v_and_b32 v200,s42,v200
v_and_b32 v198,s42,v198
M a[16:19],a[228:231],a[212:215],a[16:19]
v_fmac_f32 v192,s43,v196
v_fmac_f32 v202,4.0,v194
M a[20:23],a[228:231],a[216:219],a[20:23]
v_fma_f32 v235,-4.0,v196,v200
v_fmac_f32 v192,s45,v200
M a[24:27],a[228:231],a[220:223],a[24:27]
s_waitcnt lgkmcnt(1)
v_fmac_f32 v202,s40,v198
v_sub_f32 v200,v200,v196
M a[28:31],a[228:231],a[192:195],a[28:31]
buffer_load_dwordx4 a[228:231],v251,s[20:23],s48 offen offset:0 sc1
M a[0:3],a[232:235],a[200:203],a[0:3]
ds_read_b128 a[200:203],v249 offset:43520
v_fma_f32 v196,-4.0,v194,v198
M a[4:7],a[232:235],a[204:207],a[4:7]
ds_read_b128 a[204:207],v250 offset:43776
v_sub_f32 v198,v198,v194
M a[8:11],a[232:235],a[208:211],a[8:11]
ds_read_b128 a[208:211],v250 offset:44032
v_add_f32 v194,v235,v196
M a[12:15],a[232:235],a[212:215],a[12:15]
ds_read_b128 a[212:215],v250 offset:44288
v_sub_f32 v235,v235,v196
M a[16:19],a[232:235],a[216:219],a[16:19]
ds_read_b128 a[216:219],v250 offset:44544
v_fma_f32 v196,2.0,v198,v200
M a[20:23],a[232:235],a[220:223],a[20:23]
ds_read_b128 a[220:223],v250 offset:44800
v_fmac_f32 v200,-2.0,v198
M a[24:27],a[232:235],a[192:195],a[24:27]
s_waitcnt lgkmcnt(6)
ds_read_b128 a[192:195],v250 offset:45056
v_cvt_pk_bf16_f32 v192,v232,v192
M a[28:31],a[232:235],a[196:199],a[28:31]
s_waitcnt lgkmcnt(6)
buffer_load_dwordx4 a[232:235],v251,s[20:23],s47 offen offset:1024 sc1
M a[96:99],a[236:239],a[200:203],a[96:99]
s_waitcnt lgkmcnt(5)
ds_read_b128 a[196:199],v250 offset:45312
ds_read_b128 a[200:203],v250 offset:45568
M a[100:103],a[236:239],a[204:207],a[100:103]
s_waitcnt lgkmcnt(6)
v_cvt_pk_bf16_f32 v202,v237,v202
v_cvt_pk_bf16_f32 v194,v233,v194
M a[104:107],a[236:239],a[208:211],a[104:107]
s_waitcnt lgkmcnt(5)
v_cvt_pk_bf16_f32 v198,v234,v196
v_cvt_pk_bf16_f32 v196,v238,v235
M a[108:111],a[236:239],a[212:215],a[108:111]
s_waitcnt lgkmcnt(4)
v_cvt_pk_bf16_f32 v200,v236,v200
v_lshlrev_b32 v234,16,v197
M a[112:115],a[236:239],a[216:219],a[112:115]
s_waitcnt lgkmcnt(3)
v_lshlrev_b32 v232,16,v193
v_lshlrev_b32 v233,16,v195
M a[116:119],a[236:239],a[220:223],a[116:119]
s_waitcnt lgkmcnt(2)
v_lshlrev_b32 v237,16,v203
v_lshlrev_b32 v236,16,v201
M a[120:123],a[236:239],a[192:195],a[120:123]
s_waitcnt lgkmcnt(1)
v_lshlrev_b32 v235,16,v199
v_fmac_f32 v232,s43,v234
M a[124:127],a[236:239],a[196:199],a[124:127]
buffer_load_dwordx4 a[236:239],v251,s[20:23],s48 offen offset:1024 sc1
M a[96:99],a[240:243],a[204:207],a[96:99]
ds_read_b128 a[204:207],v249 offset:45824
v_fmac_f32 v237,4.0,v233
M a[100:103],a[240:243],a[208:211],a[100:103]
v_fma_f32 v238,-4.0,v234,v236
v_fmac_f32 v232,s45,v236
M a[104:107],a[240:243],a[212:215],a[104:107]
v_fmac_f32 v237,s40,v235
v_sub_f32 v236,v236,v234
M a[108:111],a[240:243],a[216:219],a[108:111]
v_fma_f32 v234,-4.0,v233,v235
v_sub_f32 v235,v235,v233
M a[112:115],a[240:243],a[220:223],a[112:115]
v_add_f32 v233,v238,v234
v_sub_f32 v238,v238,v234
M a[116:119],a[240:243],a[192:195],a[116:119]
v_fma_f32 v234,2.0,v235,v236
v_fmac_f32 v236,-2.0,v235
M a[120:123],a[240:243],a[196:199],a[120:123]
s_waitcnt lgkmcnt(1)
v_and_b32 v197,s42,v197
v_and_b32 v193,s42,v193
M a[124:127],a[240:243],a[200:203],a[124:127]
buffer_load_dwordx4 a[240:243],v251,s[20:23],s47 offen offset:2048 sc1
M a[96:99],a[244:247],a[208:211],a[96:99]
ds_read_b128 a[208:211],v249 offset:0
v_and_b32 v195,s42,v195
M a[100:103],a[244:247],a[212:215],a[100:103]
ds_read_b128 a[212:215],v250 offset:256
v_and_b32 v203,s42,v203
M a[104:107],a[244:247],a[216:219],a[104:107]
ds_read_b128 a[216:219],v250 offset:512
v_and_b32 v201,s42,v201
M a[108:111],a[244:247],a[220:223],a[108:111]
ds_read_b128 a[220:223],v250 offset:768
v_and_b32 v199,s42,v199
M a[112:115],a[244:247],a[192:195],a[112:115]
ds_read_b128 a[192:195],v250 offset:1024
v_fmac_f32 v193,s43,v197
M a[116:119],a[244:247],a[196:199],a[116:119]
ds_read_b128 a[196:199],v250 offset:1280
v_fmac_f32 v203,4.0,v195
M a[120:123],a[244:247],a[200:203],a[120:123]
s_waitcnt lgkmcnt(6)
ds_read_b128 a[200:203],v250 offset:1536
v_fma_f32 v235,-4.0,v197,v201
M a[124:127],a[244:247],a[204:207],a[124:127]
s_waitcnt vmcnt(16) lgkmcnt(6)
buffer_load_dwordx4 a[244:247],v251,s[20:23],s48 offen offset:2048 sc1
M v[0:3],a[248:251],a[208:211],v[0:3]
s_waitcnt lgkmcnt(5)
ds_read_b128 a[204:207],v250 offset:1792
ds_read_b128 a[208:211],v250 offset:2048
M v[4:7],a[248:251],a[212:215],v[4:7]
s_waitcnt lgkmcnt(6)
s_add_u32 s47,s81,21504
v_fmac_f32 v193,s45,v201
v_fmac_f32 v203,s40,v199
M v[8:11],a[248:251],a[216:219],v[8:11]
s_waitcnt lgkmcnt(5)
v_sub_f32 v201,v201,v197
v_fma_f32 v197,-4.0,v195,v199
M v[12:15],a[248:251],a[220:223],v[12:15]
s_waitcnt lgkmcnt(4)
v_sub_f32 v199,v199,v195
v_add_f32 v195,v235,v197
M v[16:19],a[248:251],a[192:195],v[16:19]
s_waitcnt lgkmcnt(3)
v_sub_f32 v235,v235,v197
v_fma_f32 v197,2.0,v199,v201
M v[20:23],a[248:251],a[196:199],v[20:23]
s_waitcnt lgkmcnt(2)
v_fmac_f32 v201,-2.0,v199
v_cvt_pk_bf16_f32 v193,v232,v193
M v[24:27],a[248:251],a[200:203],v[24:27]
s_waitcnt lgkmcnt(1)
v_cvt_pk_bf16_f32 v203,v237,v203
v_cvt_pk_bf16_f32 v195,v233,v195
M v[28:31],a[248:251],a[204:207],v[28:31]
s_waitcnt vmcnt(16)
buffer_load_dwordx4 a[248:251],v251,s[20:23],s47 offen offset:0 sc1
M v[0:3],a[252:255],a[212:215],v[0:3]
ds_read_b128 a[212:215],v249 offset:2304
v_cvt_pk_bf16_f32 v199,v234,v197
M v[4:7],a[252:255],a[216:219],v[4:7]
s_add_u32 s48,s81,24576
v_cvt_pk_bf16_f32 v197,v238,v235
v_cvt_pk_bf16_f32 v201,v236,v201
M v[8:11],a[252:255],a[220:223],v[8:11]
M v[12:15],a[252:255],a[192:195],v[12:15]
M v[16:19],a[252:255],a[196:199],v[16:19]
M v[20:23],a[252:255],a[200:203],v[20:23]
M v[24:27],a[252:255],a[204:207],v[24:27]
s_waitcnt lgkmcnt(1)
M v[28:31],a[252:255],a[208:211],v[28:31]
s_waitcnt vmcnt(16)
buffer_load_dwordx4 a[252:255],v251,s[20:23],s48 offen offset:0 sc1
M v[0:3],v[216:219],a[216:219],v[0:3]
ds_read_b128 a[216:219],v249 offset:8704
M v[4:7],v[216:219],a[220:223],v[4:7]
ds_read_b128 a[220:223],v250 offset:8960
M v[8:11],v[216:219],a[192:195],v[8:11]
ds_read_b128 a[192:195],v250 offset:9216
M v[12:15],v[216:219],a[196:199],v[12:15]
ds_read_b128 a[196:199],v250 offset:9472
M v[16:19],v[216:219],a[200:203],v[16:19]
ds_read_b128 a[200:203],v250 offset:9728
M v[20:23],v[216:219],a[204:207],v[20:23]
ds_read_b128 a[204:207],v250 offset:9984
M v[24:27],v[216:219],a[208:211],v[24:27]
s_waitcnt lgkmcnt(6)
ds_read_b128 a[208:211],v250 offset:10240
M v[28:31],v[216:219],a[212:215],v[28:31]
s_waitcnt vmcnt(16) lgkmcnt(6)
buffer_load_dwordx4 v[216:219],v251,s[20:23],s47 offen offset:1024 sc1
M v[96:99],v[220:223],a[216:219],v[96:99]
s_waitcnt lgkmcnt(5)
ds_read_b128 a[212:215],v250 offset:10496
ds_read_b128 a[216:219],v250 offset:10752
M v[100:103],v[220:223],a[220:223],v[100:103]
s_waitcnt lgkmcnt(6)
M v[104:107],v[220:223],a[192:195],v[104:107]
s_waitcnt lgkmcnt(5)
M v[108:111],v[220:223],a[196:199],v[108:111]
s_waitcnt lgkmcnt(4)
M v[112:115],v[220:223],a[200:203],v[112:115]
s_waitcnt lgkmcnt(3)
M v[116:119],v[220:223],a[204:207],v[116:119]
s_waitcnt lgkmcnt(2)
M v[120:123],v[220:223],a[208:211],v[120:123]
s_waitcnt lgkmcnt(1)
M v[124:127],v[220:223],a[212:215],v[124:127]
s_waitcnt vmcnt(10)
buffer_load_dwordx4 v[220:223],v251,s[20:23],s48 offen offset:1024 sc1
M v[96:99],v[224:227],a[220:223],v[96:99]
ds_read_b128 a[220:223],v249 offset:11008
M v[100:103],v[224:227],a[192:195],v[100:103]
M v[104:107],v[224:227],a[196:199],v[104:107]
M v[108:111],v[224:227],a[200:203],v[108:111]
M v[112:115],v[224:227],a[204:207],v[112:115]
M v[116:119],v[224:227],a[208:211],v[116:119]
M v[120:123],v[224:227],a[212:215],v[120:123]
s_waitcnt lgkmcnt(1)
M v[124:127],v[224:227],a[216:219],v[124:127]
s_waitcnt vmcnt(10)
buffer_load_dwordx4 v[224:227],v251,s[20:23],s47 offen offset:2048 sc1
M v[96:99],v[228:231],a[192:195],v[96:99]
ds_read_b128 a[192:195],v249 offset:34816
M v[100:103],v[228:231],a[196:199],v[100:103]
ds_read_b128 a[196:199],v250 offset:35072
M v[104:107],v[228:231],a[200:203],v[104:107]
ds_read_b128 a[200:203],v250 offset:35328
M v[108:111],v[228:231],a[204:207],v[108:111]
ds_read_b128 a[204:207],v250 offset:35584
v_accvgpr_read_b32 v238,a0
M v[112:115],v[228:231],a[208:211],v[112:115]
ds_read_b128 a[208:211],v250 offset:35840
v_accvgpr_read_b32 v232,a96
M v[116:119],v[228:231],a[212:215],v[116:119]
ds_read_b128 a[212:215],v250 offset:36096
v_add_f32 v234,v238,v232
M v[120:123],v[228:231],a[216:219],v[120:123]
s_waitcnt lgkmcnt(6)
ds_read_b128 a[216:219],v250 offset:36352
v_sub_f32 v238,v238,v232
M v[124:127],v[228:231],a[220:223],v[124:127]
s_waitcnt vmcnt(10) lgkmcnt(6)
buffer_load_dwordx4 v[228:231],v251,s[20:23],s48 offen offset:2048 sc1
M a[32:35],a[224:227],a[192:195],a[32:35]
s_waitcnt lgkmcnt(5)
ds_read_b128 a[220:223],v250 offset:36608
v_add_f32 v232,v0,v96
M a[36:39],a[224:227],a[196:199],a[36:39]
s_waitcnt lgkmcnt(5)
s_add_u32 s47,s81,30720
v_sub_f32 v96,v0,v96
v_add_f32 v0,v234,v232
M a[40:43],a[224:227],a[200:203],a[40:43]
s_waitcnt lgkmcnt(4)
v_fmac_f32 v234,4.0,v232
v_fma_f32 v232,2.0,v96,v238
M a[44:47],a[224:227],a[204:207],a[44:47]
s_waitcnt lgkmcnt(3)
v_fma_f32 v96,s41,v96,v238
v_accvgpr_read_b32 v238,a1
M a[48:51],a[224:227],a[208:211],a[48:51]
s_waitcnt lgkmcnt(2)
v_accvgpr_read_b32 v237,a97
v_add_f32 v236,v238,v237
M a[52:55],a[224:227],a[212:215],a[52:55]
s_waitcnt lgkmcnt(1)
v_sub_f32 v238,v238,v237
v_add_f32 v237,v1,v97
M a[56:59],a[224:227],a[216:219],a[56:59]
s_waitcnt lgkmcnt(0)
v_sub_f32 v97,v1,v97
v_add_f32 v1,v236,v237
M a[60:63],a[224:227],a[220:223],a[60:63]
s_waitcnt vmcnt(10)
buffer_load_dwordx4 a[224:227],v251,s[20:23],s47 offen offset:0 sc1
M a[64:67],a[228:231],a[192:195],a[64:67]
ds_read_b128 a[192:195],v250 offset:36864
v_fmac_f32 v236,4.0,v237
M a[68:71],a[228:231],a[196:199],a[68:71]
s_add_u32 s48,s81,33792
v_fma_f32 v237,2.0,v97,v238
v_fma_f32 v97,s41,v97,v238
M a[72:75],a[228:231],a[200:203],a[72:75]
v_cvt_pk_bf16_f32 v232,v232,v237
v_cvt_pk_bf16_f32 v234,v234,v236
M a[76:79],a[228:231],a[204:207],a[76:79]
v_accvgpr_read_b32 v238,a2
v_accvgpr_read_b32 v233,a98
M a[80:83],a[228:231],a[208:211],a[80:83]
v_add_f32 v235,v238,v233
v_sub_f32 v238,v238,v233
M a[84:87],a[228:231],a[212:215],a[84:87]
v_add_f32 v233,v2,v98
v_sub_f32 v98,v2,v98
M a[88:91],a[228:231],a[216:219],a[88:91]
v_add_f32 v2,v235,v233
v_fmac_f32 v235,4.0,v233
M a[92:95],a[228:231],a[220:223],a[92:95]
s_waitcnt vmcnt(10)
buffer_load_dwordx4 a[228:231],v251,s[20:23],s48 offen offset:0 sc1
M a[32:35],a[232:235],a[196:199],a[32:35]
v_fma_f32 v233,2.0,v98,v238
v_fma_f32 v98,s41,v98,v238
M a[36:39],a[232:235],a[200:203],a[36:39]
v_accvgpr_read_b32 v238,a3
v_accvgpr_read_b32 v237,a99
M a[40:43],a[232:235],a[204:207],a[40:43]
v_add_f32 v236,v238,v237
v_sub_f32 v238,v238,v237
M a[44:47],a[232:235],a[208:211],a[44:47]
v_add_f32 v237,v3,v99
v_sub_f32 v99,v3,v99
M a[48:51],a[232:235],a[212:215],a[48:51]
v_add_f32 v3,v236,v237
v_fmac_f32 v236,4.0,v237
M a[52:55],a[232:235],a[216:219],a[52:55]
v_fma_f32 v237,2.0,v99,v238
v_fma_f32 v99,s41,v99,v238
M a[56:59],a[232:235],a[220:223],a[56:59]
s_waitcnt lgkmcnt(0)
v_cvt_pk_bf16_f32 v233,v233,v237
v_cvt_pk_bf16_f32 v235,v235,v236
M a[60:63],a[232:235],a[192:195],a[60:63]
s_waitcnt vmcnt(10)
buffer_load_dwordx4 a[232:235],v251,s[20:23],s47 offen offset:1024 sc1
M a[64:67],a[236:239],a[196:199],a[64:67]
ds_read_b128 a[196:199],v249 offset:37120
ds_write2st64_b64 v253,v[232:233],v[234:235] offset0:68 offset1:72
M a[68:71],a[236:239],a[200:203],a[68:71]
v_accvgpr_read_b32 v238,a4
v_accvgpr_read_b32 v232,a100
M a[72:75],a[236:239],a[204:207],a[72:75]
v_add_f32 v234,v238,v232
v_sub_f32 v238,v238,v232
M a[76:79],a[236:239],a[208:211],a[76:79]
v_add_f32 v232,v4,v100
v_sub_f32 v100,v4,v100
M a[80:83],a[236:239],a[212:215],a[80:83]
v_add_f32 v4,v234,v232
v_fmac_f32 v234,4.0,v232
M a[84:87],a[236:239],a[216:219],a[84:87]
v_fma_f32 v232,2.0,v100,v238
v_fma_f32 v100,s41,v100,v238
M a[88:91],a[236:239],a[220:223],a[88:91]
v_accvgpr_read_b32 v238,a5
v_accvgpr_read_b32 v237,a101
M a[92:95],a[236:239],a[192:195],a[92:95]
s_waitcnt vmcnt(10)
buffer_load_dwordx4 a[236:239],v251,s[20:23],s48 offen offset:1024 sc1
M a[32:35],a[240:243],a[200:203],a[32:35]
v_add_f32 v236,v238,v237
v_sub_f32 v238,v238,v237
M a[36:39],a[240:243],a[204:207],a[36:39]
v_add_f32 v237,v5,v101
v_sub_f32 v101,v5,v101
M a[40:43],a[240:243],a[208:211],a[40:43]
v_add_f32 v5,v236,v237
v_fmac_f32 v236,4.0,v237
M a[44:47],a[240:243],a[212:215],a[44:47]
v_fma_f32 v237,2.0,v101,v238
v_fma_f32 v101,s41,v101,v238
M a[48:51],a[240:243],a[216:219],a[48:51]
v_cvt_pk_bf16_f32 v232,v232,v237
v_cvt_pk_bf16_f32 v234,v234,v236
M a[52:55],a[240:243],a[220:223],a[52:55]
v_accvgpr_read_b32 v238,a6
v_accvgpr_read_b32 v233,a102
M a[56:59],a[240:243],a[192:195],a[56:59]
s_waitcnt lgkmcnt(1)
v_add_f32 v235,v238,v233
v_sub_f32 v238,v238,v233
M a[60:63],a[240:243],a[196:199],a[60:63]
s_waitcnt vmcnt(10)
buffer_load_dwordx4 a[240:243],v251,s[20:23],s47 offen offset:2048 sc1
M a[64:67],a[244:247],a[200:203],a[64:67]
ds_read_b128 a[200:203],v249 offset:43520
v_add_f32 v233,v6,v102
M a[68:71],a[244:247],a[204:207],a[68:71]
ds_read_b128 a[204:207],v250 offset:43776
v_sub_f32 v102,v6,v102
M a[72:75],a[244:247],a[208:211],a[72:75]
ds_read_b128 a[208:211],v250 offset:44032
v_add_f32 v6,v235,v233
M a[76:79],a[244:247],a[212:215],a[76:79]
ds_read_b128 a[212:215],v250 offset:44288
v_fmac_f32 v235,4.0,v233
M a[80:83],a[244:247],a[216:219],a[80:83]
ds_read_b128 a[216:219],v250 offset:44544
v_fma_f32 v233,2.0,v102,v238
M a[84:87],a[244:247],a[220:223],a[84:87]
ds_read_b128 a[220:223],v250 offset:44800
v_fma_f32 v102,s41,v102,v238
M a[88:91],a[244:247],a[192:195],a[88:91]
ds_read_b128 a[192:195],v250 offset:45056
v_accvgpr_read_b32 v238,a7
M a[92:95],a[244:247],a[196:199],a[92:95]
s_waitcnt vmcnt(10) lgkmcnt(6)
buffer_load_dwordx4 a[244:247],v251,s[20:23],s48 offen offset:2048 sc1
M a[128:131],a[248:251],a[200:203],a[128:131]
s_waitcnt lgkmcnt(5)
ds_read_b128 a[196:199],v250 offset:45312
v_accvgpr_read_b32 v237,a103
M a[132:135],a[248:251],a[204:207],a[132:135]
s_waitcnt lgkmcnt(5)
s_add_u32 s47,s81,39936
v_add_f32 v236,v238,v237
v_sub_f32 v238,v238,v237
M a[136:139],a[248:251],a[208:211],a[136:139]
s_waitcnt lgkmcnt(4)
v_add_f32 v237,v7,v103
v_sub_f32 v103,v7,v103
M a[140:143],a[248:251],a[212:215],a[140:143]
s_waitcnt lgkmcnt(3)
v_add_f32 v7,v236,v237
v_fmac_f32 v236,4.0,v237
M a[144:147],a[248:251],a[216:219],a[144:147]
s_waitcnt lgkmcnt(2)
v_fma_f32 v237,2.0,v103,v238
v_fma_f32 v103,s41,v103,v238
M a[148:151],a[248:251],a[220:223],a[148:151]
s_waitcnt lgkmcnt(1)
v_cvt_pk_bf16_f32 v233,v233,v237
v_cvt_pk_bf16_f32 v235,v235,v236
M a[152:155],a[248:251],a[192:195],a[152:155]
s_waitcnt lgkmcnt(0)
ds_write2st64_b64 v253,v[232:233],v[234:235] offset0:76 offset1:80
M a[156:159],a[248:251],a[196:199],a[156:159]
s_waitcnt vmcnt(10)
buffer_load_dwordx4 a[248:251],v251,s[20:23],s47 offen offset:0 sc1
M a[160:163],a[252:255],a[200:203],a[160:163]
ds_read_b128 a[200:203],v250 offset:45568
v_accvgpr_read_b32 v238,a8
M a[164:167],a[252:255],a[204:207],a[164:167]
s_add_u32 s48,s81,43008
v_accvgpr_read_b32 v232,a104
v_add_f32 v234,v238,v232
M a[168:171],a[252:255],a[208:211],a[168:171]
v_sub_f32 v238,v238,v232
v_add_f32 v232,v8,v104
M a[172:175],a[252:255],a[212:215],a[172:175]
v_sub_f32 v104,v8,v104
M a[176:179],a[252:255],a[216:219],a[176:179]
s_waitcnt lgkmcnt(1)
s_barrier
ds_read_b128 a[0:3],v251 offset:34816
M a[180:183],a[252:255],a[220:223],a[180:183]
ds_read_b128 a[4:7],v251 offset:38912
v_add_f32 v8,v234,v232
M a[184:187],a[252:255],a[192:195],a[184:187]
v_fmac_f32 v234,4.0,v232
v_fma_f32 v232,2.0,v104,v238
M a[188:191],a[252:255],a[196:199],a[188:191]
s_waitcnt vmcnt(10)
buffer_load_dwordx4 a[252:255],v251,s[20:23],s48 offen offset:0 sc1
M a[128:131],v[216:219],a[204:207],a[128:131]
v_fma_f32 v104,s41,v104,v238
v_accvgpr_read_b32 v238,a9
M a[132:135],v[216:219],a[208:211],a[132:135]
s_waitcnt lgkmcnt(1)
s_add_u32 s34,s32,0
buffer_store_dwordx4 a[0:3],v252,s[24:27],s34 offen offset:384 nt
M a[136:139],v[216:219],a[212:215],a[136:139]
v_accvgpr_read_b32 v237,a105
v_add_f32 v236,v238,v237
M a[140:143],v[216:219],a[216:219],a[140:143]
v_sub_f32 v238,v238,v237
v_add_f32 v237,v9,v105
M a[144:147],v[216:219],a[220:223],a[144:147]
v_sub_f32 v105,v9,v105
v_add_f32 v9,v236,v237
M a[148:151],v[216:219],a[192:195],a[148:151]
v_fmac_f32 v236,4.0,v237
v_fma_f32 v237,2.0,v105,v238
M a[152:155],v[216:219],a[196:199],a[152:155]
v_fma_f32 v105,s41,v105,v238
v_cvt_pk_bf16_f32 v232,v232,v237
M a[156:159],v[216:219],a[200:203],a[156:159]
s_waitcnt vmcnt(11)
buffer_load_dwordx4 v[216:219],v251,s[20:23],s47 offen offset:1024 sc1
M a[160:163],v[220:223],a[204:207],a[160:163]
ds_read_b128 a[204:207],v249 offset:45824
v_cvt_pk_bf16_f32 v234,v234,v236
M a[164:167],v[220:223],a[208:211],a[164:167]
v_accvgpr_read_b32 v238,a10
v_accvgpr_read_b32 v233,a106
M a[168:171],v[220:223],a[212:215],a[168:171]
v_add_f32 v235,v238,v233
v_sub_f32 v238,v238,v233
M a[172:175],v[220:223],a[216:219],a[172:175]
v_add_f32 v233,v10,v106
v_sub_f32 v106,v10,v106
M a[176:179],v[220:223],a[220:223],a[176:179]
v_add_f32 v10,v235,v233
v_fmac_f32 v235,4.0,v233
M a[180:183],v[220:223],a[192:195],a[180:183]
v_fma_f32 v233,2.0,v106,v238
v_fma_f32 v106,s41,v106,v238
M a[184:187],v[220:223],a[196:199],a[184:187]
v_accvgpr_read_b32 v238,a11
v_accvgpr_read_b32 v237,a107
M a[188:191],v[220:223],a[200:203],a[188:191]
s_waitcnt vmcnt(11)
s_add_u32 s34,s32,196608
buffer_load_dwordx4 v[220:223],v251,s[20:23],s48 offen offset:1024 sc1
M a[128:131],v[224:227],a[208:211],a[128:131]
s_waitcnt lgkmcnt(1)
buffer_store_dwordx4 a[4:7],v252,s[24:27],s34 offen offset:384 nt
M a[132:135],v[224:227],a[212:215],a[132:135]
v_add_f32 v236,v238,v237
v_sub_f32 v238,v238,v237
M a[136:139],v[224:227],a[216:219],a[136:139]
v_add_f32 v237,v11,v107
v_sub_f32 v107,v11,v107
M a[140:143],v[224:227],a[220:223],a[140:143]
v_add_f32 v11,v236,v237
v_fmac_f32 v236,4.0,v237
M a[144:147],v[224:227],a[192:195],a[144:147]
v_fma_f32 v237,2.0,v107,v238
v_fma_f32 v107,s41,v107,v238
M a[148:151],v[224:227],a[196:199],a[148:151]
v_cvt_pk_bf16_f32 v233,v233,v237
v_cvt_pk_bf16_f32 v235,v235,v236
M a[152:155],v[224:227],a[200:203],a[152:155]
s_waitcnt lgkmcnt(0)
ds_write2st64_b64 v253,v[232:233],v[234:235] offset0:85 offset1:89
M a[156:159],v[224:227],a[204:207],a[156:159]
s_waitcnt vmcnt(12)
buffer_load_dwordx4 v[224:227],v251,s[20:23],s47 offen offset:2048 sc1
M a[160:163],v[228:231],a[208:211],a[160:163]
ds_read_b128 a[208:211],v249 offset:0
v_accvgpr_read_b32 v238,a12
M a[164:167],v[228:231],a[212:215],a[164:167]
ds_read_b128 a[212:215],v250 offset:256
v_accvgpr_read_b32 v232,a108
M a[168:171],v[228:231],a[216:219],a[168:171]
ds_read_b128 a[216:219],v250 offset:512
v_add_f32 v234,v238,v232
M a[172:175],v[228:231],a[220:223],a[172:175]
ds_read_b128 a[220:223],v250 offset:768
v_sub_f32 v238,v238,v232
M a[176:179],v[228:231],a[192:195],a[176:179]
ds_read_b128 a[192:195],v250 offset:1024
v_add_f32 v232,v12,v108
M a[180:183],v[228:231],a[196:199],a[180:183]
ds_read_b128 a[196:199],v250 offset:1280
v_sub_f32 v108,v12,v108
M a[184:187],v[228:231],a[200:203],a[184:187]
ds_read_b128 a[200:203],v250 offset:1536
v_add_f32 v12,v234,v232
M a[188:191],v[228:231],a[204:207],a[188:191]
s_waitcnt vmcnt(12) lgkmcnt(6)
buffer_load_dwordx4 v[228:231],v251,s[20:23],s48 offen offset:2048 sc1
M v[32:35],a[224:227],a[208:211],v[32:35]
s_waitcnt lgkmcnt(5)
ds_read_b128 a[204:207],v250 offset:1792
v_fmac_f32 v234,4.0,v232
M v[36:39],a[224:227],a[212:215],v[36:39]
s_waitcnt lgkmcnt(5)
s_add_u32 s46,s76,0
v_fma_f32 v232,2.0,v108,v238
v_fma_f32 v108,s41,v108,v238
M v[40:43],a[224:227],a[216:219],v[40:43]
s_waitcnt lgkmcnt(4)
v_accvgpr_read_b32 v238,a13
v_accvgpr_read_b32 v237,a109
M v[44:47],a[224:227],a[220:223],v[44:47]
s_waitcnt lgkmcnt(3)
v_add_f32 v236,v238,v237
v_sub_f32 v238,v238,v237
M v[48:51],a[224:227],a[192:195],v[48:51]
s_waitcnt lgkmcnt(2)
v_add_f32 v237,v13,v109
v_sub_f32 v109,v13,v109
M v[52:55],a[224:227],a[196:199],v[52:55]
s_waitcnt lgkmcnt(1)
v_add_f32 v13,v236,v237
v_fmac_f32 v236,4.0,v237
M v[56:59],a[224:227],a[200:203],v[56:59]
s_waitcnt lgkmcnt(0)
v_fma_f32 v237,2.0,v109,v238
v_fma_f32 v109,s41,v109,v238
M v[60:63],a[224:227],a[204:207],v[60:63]
s_waitcnt vmcnt(12)
buffer_load_dwordx4 a[224:227],v251,s[20:23],s46 offen offset:0 sc1
M v[64:67],a[228:231],a[208:211],v[64:67]
ds_read_b128 a[208:211],v250 offset:2048
v_cvt_pk_bf16_f32 v232,v232,v237
M v[68:71],a[228:231],a[212:215],v[68:71]
v_cvt_pk_bf16_f32 v234,v234,v236
v_accvgpr_read_b32 v238,a14
M v[72:75],a[228:231],a[216:219],v[72:75]
v_accvgpr_read_b32 v233,a110
v_add_f32 v235,v238,v233
M v[76:79],a[228:231],a[220:223],v[76:79]
v_sub_f32 v238,v238,v233
v_add_f32 v233,v14,v110
M v[80:83],a[228:231],a[192:195],v[80:83]
v_sub_f32 v110,v14,v110
v_add_f32 v14,v235,v233
M v[84:87],a[228:231],a[196:199],v[84:87]
v_fmac_f32 v235,4.0,v233
v_fma_f32 v233,2.0,v110,v238
M v[88:91],a[228:231],a[200:203],v[88:91]
v_fma_f32 v110,s41,v110,v238
v_accvgpr_read_b32 v238,a15
M v[92:95],a[228:231],a[204:207],v[92:95]
s_waitcnt vmcnt(12)
buffer_load_dwordx4 a[228:231],v251,s[20:23],s46 offen offset:1024 sc1
M v[32:35],a[232:235],a[212:215],v[32:35]
v_accvgpr_read_b32 v237,a111
v_add_f32 v236,v238,v237
M v[36:39],a[232:235],a[216:219],v[36:39]
v_sub_f32 v238,v238,v237
v_add_f32 v237,v15,v111
M v[40:43],a[232:235],a[220:223],v[40:43]
v_sub_f32 v111,v15,v111
v_add_f32 v15,v236,v237
M v[44:47],a[232:235],a[192:195],v[44:47]
v_fmac_f32 v236,4.0,v237
v_fma_f32 v237,2.0,v111,v238
M v[48:51],a[232:235],a[196:199],v[48:51]
v_fma_f32 v111,s41,v111,v238
v_cvt_pk_bf16_f32 v233,v233,v237
M v[52:55],a[232:235],a[200:203],v[52:55]
v_cvt_pk_bf16_f32 v235,v235,v236
M v[56:59],a[232:235],a[204:207],v[56:59]
s_waitcnt lgkmcnt(0)
ds_write2st64_b64 v253,v[232:233],v[234:235] offset0:93 offset1:97
M v[60:63],a[232:235],a[208:211],v[60:63]
s_waitcnt vmcnt(12)
buffer_load_dwordx4 a[232:235],v251,s[20:23],s46 offen offset:2048 sc1
M v[64:67],a[236:239],a[212:215],v[64:67]
ds_read_b128 a[212:215],v249 offset:2304
v_accvgpr_read_b32 v238,a16
M v[68:71],a[236:239],a[216:219],v[68:71]
s_add_u32 s46,s77,0
v_accvgpr_read_b32 v232,a112
v_add_f32 v234,v238,v232
M v[72:75],a[236:239],a[220:223],v[72:75]
v_sub_f32 v238,v238,v232
v_add_f32 v232,v16,v112
M v[76:79],a[236:239],a[192:195],v[76:79]
v_sub_f32 v112,v16,v112
M v[80:83],a[236:239],a[196:199],v[80:83]
s_waitcnt lgkmcnt(1)
s_barrier
ds_read_b128 a[8:11],v251 offset:43520
M v[84:87],a[236:239],a[200:203],v[84:87]
ds_read_b128 a[12:15],v251 offset:47616
v_add_f32 v16,v234,v232
M v[88:91],a[236:239],a[204:207],v[88:91]
v_fmac_f32 v234,4.0,v232
v_fma_f32 v232,2.0,v112,v238
M v[92:95],a[236:239],a[208:211],v[92:95]
s_waitcnt vmcnt(12)
buffer_load_dwordx4 a[236:239],v251,s[20:23],s46 offen offset:0 sc1
M v[32:35],a[240:243],a[216:219],v[32:35]
v_fma_f32 v112,s41,v112,v238
v_accvgpr_read_b32 v238,a17
M v[36:39],a[240:243],a[220:223],v[36:39]
s_waitcnt lgkmcnt(1)
s_add_u32 s34,s32,393216
buffer_store_dwordx4 a[8:11],v252,s[24:27],s34 offen offset:384 nt
M v[40:43],a[240:243],a[192:195],v[40:43]
s_waitcnt lgkmcnt(0)
s_add_u32 s34,s32,589824
buffer_store_dwordx4 a[12:15],v252,s[24:27],s34 offen offset:384 nt
M v[44:47],a[240:243],a[196:199],v[44:47]
v_accvgpr_read_b32 v237,a113
v_add_f32 v236,v238,v237
M v[48:51],a[240:243],a[200:203],v[48:51]
v_sub_f32 v238,v238,v237
v_add_f32 v237,v17,v113
M v[52:55],a[240:243],a[204:207],v[52:55]
v_sub_f32 v113,v17,v113
v_add_f32 v17,v236,v237
M v[56:59],a[240:243],a[208:211],v[56:59]
v_fmac_f32 v236,4.0,v237
v_fma_f32 v237,2.0,v113,v238
M v[60:63],a[240:243],a[212:215],v[60:63]
s_waitcnt vmcnt(14)
buffer_load_dwordx4 a[240:243],v251,s[20:23],s46 offen offset:1024 sc1
M v[64:67],a[244:247],a[216:219],v[64:67]
ds_read_b128 a[216:219],v249 offset:8704
v_fma_f32 v113,s41,v113,v238
M v[68:71],a[244:247],a[220:223],v[68:71]
ds_read_b128 a[220:223],v250 offset:8960
v_cvt_pk_bf16_f32 v232,v232,v237
M v[72:75],a[244:247],a[192:195],v[72:75]
ds_read_b128 a[192:195],v250 offset:9216
v_cvt_pk_bf16_f32 v234,v234,v236
M v[76:79],a[244:247],a[196:199],v[76:79]
ds_read_b128 a[196:199],v250 offset:9472
v_accvgpr_read_b32 v238,a18
M v[80:83],a[244:247],a[200:203],v[80:83]
ds_read_b128 a[200:203],v250 offset:9728
v_accvgpr_read_b32 v233,a114
M v[84:87],a[244:247],a[204:207],v[84:87]
ds_read_b128 a[204:207],v250 offset:9984
v_add_f32 v235,v238,v233
M v[88:91],a[244:247],a[208:211],v[88:91]
ds_read_b128 a[208:211],v250 offset:10240
v_sub_f32 v238,v238,v233
M v[92:95],a[244:247],a[212:215],v[92:95]
s_waitcnt vmcnt(14) lgkmcnt(6)
buffer_load_dwordx4 a[244:247],v251,s[20:23],s46 offen offset:2048 sc1
M v[128:131],a[248:251],a[216:219],v[128:131]
s_waitcnt lgkmcnt(5)
ds_read_b128 a[212:215],v250 offset:10496
v_add_f32 v233,v18,v114
M v[132:135],a[248:251],a[220:223],v[132:135]
s_waitcnt lgkmcnt(5)
s_add_u32 s46,s78,0
v_sub_f32 v114,v18,v114
v_add_f32 v18,v235,v233
M v[136:139],a[248:251],a[192:195],v[136:139]
s_waitcnt lgkmcnt(4)
v_fmac_f32 v235,4.0,v233
v_fma_f32 v233,2.0,v114,v238
M v[140:143],a[248:251],a[196:199],v[140:143]
s_waitcnt lgkmcnt(3)
v_fma_f32 v114,s41,v114,v238
v_accvgpr_read_b32 v238,a19
M v[144:147],a[248:251],a[200:203],v[144:147]
s_waitcnt lgkmcnt(2)
v_accvgpr_read_b32 v237,a115
v_add_f32 v236,v238,v237
M v[148:151],a[248:251],a[204:207],v[148:151]
s_waitcnt lgkmcnt(1)
v_sub_f32 v238,v238,v237
v_add_f32 v237,v19,v115
M v[152:155],a[248:251],a[208:211],v[152:155]
s_waitcnt lgkmcnt(0)
v_sub_f32 v115,v19,v115
v_add_f32 v19,v236,v237
M v[156:159],a[248:251],a[212:215],v[156:159]
s_waitcnt vmcnt(14)
buffer_load_dwordx4 a[248:251],v251,s[20:23],s46 offen offset:0 sc1
M v[160:163],a[252:255],a[216:219],v[160:163]
ds_read_b128 a[216:219],v250 offset:10752
v_fmac_f32 v236,4.0,v237
M v[164:167],a[252:255],a[220:223],v[164:167]
v_fma_f32 v237,2.0,v115,v238
v_fma_f32 v115,s41,v115,v238
M v[168:171],a[252:255],a[192:195],v[168:171]
v_cvt_pk_bf16_f32 v233,v233,v237
v_cvt_pk_bf16_f32 v235,v235,v236
M v[172:175],a[252:255],a[196:199],v[172:175]
ds_write2st64_b64 v253,v[232:233],v[234:235] offset0:68 offset1:72
M v[176:179],a[252:255],a[200:203],v[176:179]
v_accvgpr_read_b32 v238,a20
v_accvgpr_read_b32 v232,a116
M v[180:183],a[252:255],a[204:207],v[180:183]
v_add_f32 v234,v238,v232
v_sub_f32 v238,v238,v232
M v[184:187],a[252:255],a[208:211],v[184:187]
v_add_f32 v232,v20,v116
v_sub_f32 v116,v20,v116
M v[188:191],a[252:255],a[212:215],v[188:191]
s_waitcnt vmcnt(13)
buffer_load_dwordx4 a[252:255],v251,s[20:23],s46 offen offset:1024 sc1
M v[128:131],v[216:219],a[220:223],v[128:131]
v_add_f32 v20,v234,v232
v_fmac_f32 v234,4.0,v232
M v[132:135],v[216:219],a[192:195],v[132:135]
v_fma_f32 v232,2.0,v116,v238
v_fma_f32 v116,s41,v116,v238
M v[136:139],v[216:219],a[196:199],v[136:139]
v_accvgpr_read_b32 v238,a21
v_accvgpr_read_b32 v237,a117
M v[140:143],v[216:219],a[200:203],v[140:143]
v_add_f32 v236,v238,v237
v_sub_f32 v238,v238,v237
M v[144:147],v[216:219],a[204:207],v[144:147]
v_add_f32 v237,v21,v117
v_sub_f32 v117,v21,v117
M v[148:151],v[216:219],a[208:211],v[148:151]
v_add_f32 v21,v236,v237
v_fmac_f32 v236,4.0,v237
M v[152:155],v[216:219],a[212:215],v[152:155]
s_waitcnt lgkmcnt(1)
v_fma_f32 v237,2.0,v117,v238
v_fma_f32 v117,s41,v117,v238
v_cvt_pk_bf16_f32 v232,v232,v237
M v[156:159],v[216:219],a[216:219],v[156:159]
s_waitcnt vmcnt(13)
buffer_load_dwordx4 v[216:219],v251,s[20:23],s46 offen offset:2048 sc1
v_cvt_pk_bf16_f32 v234,v234,v236
v_accvgpr_read_b32 v238,a22
v_accvgpr_read_b32 v233,a118
v_add_f32 v235,v238,v233
M v[160:163],v[220:223],a[220:223],v[160:163]
ds_read_b128 a[220:223],v249 offset:11008
v_sub_f32 v238,v238,v233
v_add_f32 v233,v22,v118
v_sub_f32 v118,v22,v118
v_add_f32 v22,v235,v233
M v[164:167],v[220:223],a[192:195],v[164:167]
s_add_u32 s46,s79,0
v_fmac_f32 v235,4.0,v233
v_fma_f32 v233,2.0,v118,v238
v_fma_f32 v118,s41,v118,v238
v_accvgpr_read_b32 v238,a23
M v[168:171],v[220:223],a[196:199],v[168:171]
v_accvgpr_read_b32 v237,a119
v_add_f32 v236,v238,v237
v_sub_f32 v238,v238,v237
v_add_f32 v237,v23,v119
M v[172:175],v[220:223],a[200:203],v[172:175]
v_sub_f32 v119,v23,v119
v_add_f32 v23,v236,v237
v_fmac_f32 v236,4.0,v237
v_fma_f32 v237,2.0,v119,v238
M v[176:179],v[220:223],a[204:207],v[176:179]
v_fma_f32 v119,s41,v119,v238
v_cvt_pk_bf16_f32 v233,v233,v237
v_cvt_pk_bf16_f32 v235,v235,v236
M v[180:183],v[220:223],a[208:211],v[180:183]
ds_write2st64_b64 v253,v[232:233],v[234:235] offset0:76 offset1:80
M v[184:187],v[220:223],a[212:215],v[184:187]
v_accvgpr_read_b32 v238,a24
v_accvgpr_read_b32 v232,a120
M v[188:191],v[220:223],a[216:219],v[188:191]
s_waitcnt vmcnt(12)
buffer_load_dwordx4 v[220:223],v251,s[20:23],s46 offen offset:0 sc1
v_add_f32 v234,v238,v232
v_sub_f32 v238,v238,v232
v_add_f32 v232,v24,v120
v_sub_f32 v120,v24,v120
M v[128:131],v[224:227],a[192:195],v[128:131]
s_waitcnt lgkmcnt(0)
s_barrier
ds_read_b128 a[16:19],v251 offset:34816
v_add_f32 v24,v234,v232
v_fmac_f32 v234,4.0,v232
v_fma_f32 v232,2.0,v120,v238
M v[132:135],v[224:227],a[196:199],v[132:135]
ds_read_b128 a[20:23],v251 offset:38912
v_fma_f32 v120,s41,v120,v238
v_accvgpr_read_b32 v238,a25
v_accvgpr_read_b32 v237,a121
v_add_f32 v236,v238,v237
M v[136:139],v[224:227],a[200:203],v[136:139]
v_sub_f32 v238,v238,v237
v_add_f32 v237,v25,v121
v_sub_f32 v121,v25,v121
v_add_f32 v25,v236,v237
M v[140:143],v[224:227],a[204:207],v[140:143]
v_fmac_f32 v236,4.0,v237
v_fma_f32 v237,2.0,v121,v238
v_fma_f32 v121,s41,v121,v238
v_cvt_pk_bf16_f32 v232,v232,v237
M v[144:147],v[224:227],a[208:211],v[144:147]
v_cvt_pk_bf16_f32 v234,v234,v236
v_accvgpr_read_b32 v238,a26
v_accvgpr_read_b32 v233,a122
v_add_f32 v235,v238,v233
M v[148:151],v[224:227],a[212:215],v[148:151]
s_waitcnt lgkmcnt(1)
s_add_u32 s34,s32,786432
buffer_store_dwordx4 a[16:19],v252,s[24:27],s34 offen offset:384 nt
v_sub_f32 v238,v238,v233
v_add_f32 v233,v26,v122
v_sub_f32 v122,v26,v122
v_add_f32 v26,v235,v233
M v[152:155],v[224:227],a[216:219],v[152:155]
s_waitcnt lgkmcnt(0)
s_add_u32 s34,s32,983040
buffer_store_dwordx4 a[20:23],v252,s[24:27],s34 offen offset:384 nt
v_fmac_f32 v235,4.0,v233
v_fma_f32 v233,2.0,v122,v238
v_fma_f32 v122,s41,v122,v238
v_accvgpr_read_b32 v238,a27
M v[156:159],v[224:227],a[220:223],v[156:159]
s_waitcnt vmcnt(14)
buffer_load_dwordx4 v[224:227],v251,s[20:23],s46 offen offset:1024 sc1
v_accvgpr_read_b32 v237,a123
v_add_f32 v236,v238,v237
v_sub_f32 v238,v238,v237
v_add_f32 v237,v27,v123
M v[160:163],v[228:231],a[192:195],v[160:163]
v_add_u32 v249,0xffffbc00,v249
v_add_u32 v250,0xffffbc00,v250
v_sub_f32 v123,v27,v123
v_add_f32 v27,v236,v237
v_fmac_f32 v236,4.0,v237
v_fma_f32 v237,2.0,v123,v238
M v[164:167],v[228:231],a[196:199],v[164:167]
ds_read_b128 a[192:195],v249 offset:0
ds_read_b128 a[196:199],v250 offset:256
v_fma_f32 v123,s41,v123,v238
v_cvt_pk_bf16_f32 v233,v233,v237
v_cvt_pk_bf16_f32 v235,v235,v236
M v[168:171],v[228:231],a[200:203],v[168:171]
s_waitcnt lgkmcnt(0)
s_barrier
ds_write2st64_b64 v253,v[232:233],v[234:235] offset0:85 offset1:89
M v[172:175],v[228:231],a[204:207],v[172:175]
ds_read_b128 a[200:203],v250 offset:512
ds_read_b128 a[204:207],v250 offset:768
v_accvgpr_read_b32 v238,a28
v_accvgpr_read_b32 v232,a124
M v[176:179],v[228:231],a[208:211],v[176:179]
ds_read_b128 a[208:211],v250 offset:1024
v_add_f32 v234,v238,v232
v_sub_f32 v238,v238,v232
v_add_f32 v232,v28,v124
v_sub_f32 v124,v28,v124
M v[180:183],v[228:231],a[212:215],v[180:183]
ds_read_b128 a[212:215],v250 offset:1280
v_add_f32 v28,v234,v232
v_fmac_f32 v234,4.0,v232
v_fma_f32 v232,2.0,v124,v238
v_fma_f32 v124,s41,v124,v238
M v[184:187],v[228:231],a[216:219],v[184:187]
ds_read_b128 a[216:219],v250 offset:1536
v_accvgpr_read_b32 v238,a29
v_accvgpr_read_b32 v237,a125
v_add_f32 v236,v238,v237
v_sub_f32 v238,v238,v237
M v[188:191],v[228:231],a[220:223],v[188:191]
s_waitcnt vmcnt(14)
buffer_load_dwordx4 v[228:231],v251,s[20:23],s46 offen offset:2048 sc1
v_add_f32 v237,v29,v125
v_sub_f32 v125,v29,v125
v_add_f32 v29,v236,v237
v_fmac_f32 v236,4.0,v237
M v[0:3],a[224:227],a[192:195],v[0:3]
ds_read_b128 a[220:223],v250 offset:1792
ds_read_b128 a[192:195],v250 offset:2048
v_fma_f32 v237,2.0,v125,v238
v_fma_f32 v125,s41,v125,v238
v_cvt_pk_bf16_f32 v232,v232,v237
v_cvt_pk_bf16_f32 v234,v234,v236
M v[4:7],a[224:227],a[196:199],v[4:7]
s_waitcnt lgkmcnt(6)
s_add_u32 s46,s80,0
v_accvgpr_read_b32 v238,a30
v_accvgpr_read_b32 v233,a126
v_add_f32 v235,v238,v233
v_sub_f32 v238,v238,v233
M v[8:11],a[224:227],a[200:203],v[8:11]
s_waitcnt lgkmcnt(5)
v_add_f32 v233,v30,v126
v_sub_f32 v126,v30,v126
v_add_f32 v30,v235,v233
v_fmac_f32 v235,4.0,v233
M v[12:15],a[224:227],a[204:207],v[12:15]
s_waitcnt lgkmcnt(4)
v_fma_f32 v233,2.0,v126,v238
v_fma_f32 v126,s41,v126,v238
v_accvgpr_read_b32 v238,a31
v_accvgpr_read_b32 v237,a127
M v[16:19],a[224:227],a[208:211],v[16:19]
s_waitcnt lgkmcnt(3)
v_add_f32 v236,v238,v237
v_sub_f32 v238,v238,v237
v_add_f32 v237,v31,v127
v_sub_f32 v127,v31,v127
M v[20:23],a[224:227],a[212:215],v[20:23]
s_waitcnt lgkmcnt(2)
v_add_f32 v31,v236,v237
v_fmac_f32 v236,4.0,v237
M v[24:27],a[224:227],a[216:219],v[24:27]
s_waitcnt lgkmcnt(1)
v_fma_f32 v237,2.0,v127,v238
v_fma_f32 v127,s41,v127,v238
M v[28:31],a[224:227],a[220:223],v[28:31]
s_waitcnt vmcnt(14)
buffer_load_dwordx4 a[224:227],v251,s[20:23],s46 offen offset:0 sc1
M v[0:3],a[228:231],a[196:199],v[0:3]
ds_read_b128 a[196:199],v249 offset:2304
v_cvt_pk_bf16_f32 v233,v233,v237
M v[4:7],a[228:231],a[200:203],v[4:7]
v_cvt_pk_bf16_f32 v235,v235,v236
M v[8:11],a[228:231],a[204:207],v[8:11]
ds_write2st64_b64 v253,v[232:233],v[234:235] offset0:93 offset1:97
M v[12:15],a[228:231],a[208:211],v[12:15]
v_accvgpr_read_b32 v238,a32
v_accvgpr_read_b32 v232,a128
M v[16:19],a[228:231],a[212:215],v[16:19]
v_add_f32 v234,v238,v232
v_sub_f32 v238,v238,v232
M v[20:23],a[228:231],a[216:219],v[20:23]
v_add_u32 v249,0x15400,v249
v_add_u32 v250,0x15400,v250
M v[24:27],a[228:231],a[220:223],v[24:27]
s_waitcnt lgkmcnt(2)
v_add_f32 v232,v32,v128
v_sub_f32 v128,v32,v128
M v[28:31],a[228:231],a[192:195],v[28:31]
s_waitcnt vmcnt(14) lgkmcnt(0)
s_barrier
ds_read_b128 a[24:27],v251 offset:43520
M v[0:3],a[232:235],a[200:203],v[0:3]
ds_read_b128 a[28:31],v251 offset:47616
ds_read_b128 a[200:203],v249 offset:0
M v[4:7],a[232:235],a[204:207],v[4:7]
buffer_load_dwordx4 a[228:231],v251,s[20:23],s46 offen offset:1024 sc1
M v[8:11],a[232:235],a[208:211],v[8:11]
ds_read_b128 a[204:207],v250 offset:256
ds_read_b128 a[208:211],v250 offset:512
M v[12:15],a[232:235],a[212:215],v[12:15]
ds_read_b128 a[212:215],v250 offset:768
v_add_f32 v32,v234,v232
M v[16:19],a[232:235],a[216:219],v[16:19]
s_waitcnt lgkmcnt(5)
s_add_u32 s34,s32,1179648
buffer_store_dwordx4 a[24:27],v252,s[24:27],s34 offen offset:384 nt
M v[20:23],a[232:235],a[220:223],v[20:23]
ds_read_b128 a[216:219],v250 offset:1024
ds_read_b128 a[220:223],v250 offset:1280
M v[24:27],a[232:235],a[192:195],v[24:27]
ds_read_b128 a[192:195],v250 offset:1536
v_fmac_f32 v234,4.0,v232
M v[28:31],a[232:235],a[196:199],v[28:31]
s_waitcnt vmcnt(15) lgkmcnt(6)
buffer_load_dwordx4 a[232:235],v251,s[20:23],s46 offen offset:2048 sc1
M v[0:3],a[236:239],a[200:203],v[0:3]
s_waitcnt lgkmcnt(5)
ds_read_b128 a[196:199],v250 offset:1792
ds_read_b128 a[200:203],v250 offset:2048
M v[4:7],a[236:239],a[204:207],v[4:7]
s_waitcnt lgkmcnt(6)
s_add_u32 s46,s81,0
v_fma_f32 v232,2.0,v128,v238
v_fma_f32 v128,s41,v128,v238
M v[8:11],a[236:239],a[208:211],v[8:11]
s_waitcnt lgkmcnt(5)
v_accvgpr_read_b32 v238,a33
v_accvgpr_read_b32 v237,a129
M v[12:15],a[236:239],a[212:215],v[12:15]
s_waitcnt lgkmcnt(4)
v_add_f32 v236,v238,v237
v_sub_f32 v238,v238,v237
M v[16:19],a[236:239],a[216:219],v[16:19]
s_waitcnt lgkmcnt(3)
v_add_f32 v237,v33,v129
v_sub_f32 v129,v33,v129
M v[20:23],a[236:239],a[220:223],v[20:23]
s_waitcnt lgkmcnt(2)
v_add_f32 v33,v236,v237
v_fmac_f32 v236,4.0,v237
M v[24:27],a[236:239],a[192:195],v[24:27]
s_waitcnt lgkmcnt(1)
v_fma_f32 v237,2.0,v129,v238
v_fma_f32 v129,s41,v129,v238
M v[28:31],a[236:239],a[196:199],v[28:31]
s_waitcnt vmcnt(13)
buffer_load_dwordx4 a[236:239],v251,s[20:23],s46 offen offset:0 sc1
M v[0:3],a[240:243],a[204:207],v[0:3]
ds_read_b128 a[204:207],v249 offset:2304
v_cvt_pk_bf16_f32 v232,v232,v237
M v[4:7],a[240:243],a[208:211],v[4:7]
v_cvt_pk_bf16_f32 v234,v234,v236
v_accvgpr_read_b32 v238,a34
M v[8:11],a[240:243],a[212:215],v[8:11]
v_accvgpr_read_b32 v233,a130
v_add_f32 v235,v238,v233
M v[12:15],a[240:243],a[216:219],v[12:15]
v_sub_f32 v238,v238,v233
v_add_f32 v233,v34,v130
M v[16:19],a[240:243],a[220:223],v[16:19]
v_sub_f32 v130,v34,v130
v_add_f32 v34,v235,v233
M v[20:23],a[240:243],a[192:195],v[20:23]
s_add_u32 s34,s32,1376256
buffer_store_dwordx4 a[28:31],v252,s[24:27],s34 offen offset:384 nt
M v[24:27],a[240:243],a[196:199],v[24:27]
s_waitcnt lgkmcnt(1)
v_fmac_f32 v235,4.0,v233
v_fma_f32 v233,2.0,v130,v238
M v[28:31],a[240:243],a[200:203],v[28:31]
s_waitcnt vmcnt(14)
buffer_load_dwordx4 a[240:243],v251,s[20:23],s46 offen offset:1024 sc1
M v[0:3],a[244:247],a[208:211],v[0:3]
ds_read_b128 a[208:211],v249 offset:17408
v_fma_f32 v130,s41,v130,v238
M v[4:7],a[244:247],a[212:215],v[4:7]
ds_read_b128 a[212:215],v250 offset:17664
v_accvgpr_read_b32 v238,a35
M v[8:11],a[244:247],a[216:219],v[8:11]
ds_read_b128 a[216:219],v250 offset:17920
v_accvgpr_read_b32 v237,a131
M v[12:15],a[244:247],a[220:223],v[12:15]
ds_read_b128 a[220:223],v250 offset:18176
v_add_f32 v236,v238,v237
M v[16:19],a[244:247],a[192:195],v[16:19]
ds_read_b128 a[192:195],v250 offset:18432
v_sub_f32 v238,v238,v237
M v[20:23],a[244:247],a[196:199],v[20:23]
ds_read_b128 a[196:199],v250 offset:18688
v_add_f32 v237,v35,v131
M v[24:27],a[244:247],a[200:203],v[24:27]
s_waitcnt lgkmcnt(6)
ds_read_b128 a[200:203],v250 offset:18944
v_sub_f32 v131,v35,v131
M v[28:31],a[244:247],a[204:207],v[28:31]
s_waitcnt vmcnt(14) lgkmcnt(6)
buffer_load_dwordx4 a[244:247],v251,s[20:23],s46 offen offset:2048 sc1
M v[0:3],a[248:251],a[208:211],v[0:3]
s_waitcnt lgkmcnt(5)
ds_read_b128 a[204:207],v250 offset:19200
ds_read_b128 a[208:211],v250 offset:19456
M v[4:7],a[248:251],a[212:215],v[4:7]
s_waitcnt lgkmcnt(6)
s_add_u32 s46,s76,46080
v_add_f32 v35,v236,v237
v_fmac_f32 v236,4.0,v237
M v[8:11],a[248:251],a[216:219],v[8:11]
s_waitcnt lgkmcnt(5)
v_fma_f32 v237,2.0,v131,v238
v_fma_f32 v131,s41,v131,v238
M v[12:15],a[248:251],a[220:223],v[12:15]
s_waitcnt lgkmcnt(4)
v_cvt_pk_bf16_f32 v233,v233,v237
v_cvt_pk_bf16_f32 v235,v235,v236
M v[16:19],a[248:251],a[192:195],v[16:19]
s_waitcnt lgkmcnt(3)
ds_write2st64_b64 v253,v[232:233],v[234:235] offset0:34 offset1:38
M v[20:23],a[248:251],a[196:199],v[20:23]
s_waitcnt lgkmcnt(3)
v_accvgpr_read_b32 v238,a36
v_accvgpr_read_b32 v232,a132
M v[24:27],a[248:251],a[200:203],v[24:27]
s_waitcnt lgkmcnt(2)
v_add_f32 v234,v238,v232
v_sub_f32 v238,v238,v232
M v[28:31],a[248:251],a[204:207],v[28:31]
s_waitcnt vmcnt(14)
buffer_load_dwordx4 a[248:251],v251,s[20:23],s46 offen offset:0 sc1
M v[0:3],a[252:255],a[212:215],v[0:3]
ds_read_b128 a[212:215],v249 offset:19712
v_add_f32 v232,v36,v132
M v[4:7],a[252:255],a[216:219],v[4:7]
v_sub_f32 v132,v36,v132
v_add_f32 v36,v234,v232
M v[8:11],a[252:255],a[220:223],v[8:11]
v_fmac_f32 v234,4.0,v232
v_fma_f32 v232,2.0,v132,v238
M v[12:15],a[252:255],a[192:195],v[12:15]
v_fma_f32 v132,s41,v132,v238
v_accvgpr_read_b32 v238,a37
M v[16:19],a[252:255],a[196:199],v[16:19]
v_accvgpr_read_b32 v237,a133
v_add_f32 v236,v238,v237
M v[20:23],a[252:255],a[200:203],v[20:23]
v_sub_f32 v238,v238,v237
v_add_f32 v237,v37,v133
M v[24:27],a[252:255],a[204:207],v[24:27]
s_waitcnt lgkmcnt(2)
v_sub_f32 v133,v37,v133
v_add_f32 v37,v236,v237
M v[28:31],a[252:255],a[208:211],v[28:31]
s_waitcnt vmcnt(14)
buffer_load_dwordx4 a[252:255],v251,s[20:23],s46 offen offset:1024 sc1
M v[0:3],v[216:219],a[216:219],v[0:3]
ds_read_b128 a[216:219],v249 offset:34816
v_fmac_f32 v236,4.0,v237
M v[4:7],v[216:219],a[220:223],v[4:7]
ds_read_b128 a[220:223],v250 offset:35072
v_fma_f32 v237,2.0,v133,v238
M v[8:11],v[216:219],a[192:195],v[8:11]
ds_read_b128 a[192:195],v250 offset:35328
v_fma_f32 v133,s41,v133,v238
M v[12:15],v[216:219],a[196:199],v[12:15]
ds_read_b128 a[196:199],v250 offset:35584
v_cvt_pk_bf16_f32 v232,v232,v237
M v[16:19],v[216:219],a[200:203],v[16:19]
ds_read_b128 a[200:203],v250 offset:35840
v_cvt_pk_bf16_f32 v234,v234,v236
M v[20:23],v[216:219],a[204:207],v[20:23]
ds_read_b128 a[204:207],v250 offset:36096
v_accvgpr_read_b32 v238,a38
M v[24:27],v[216:219],a[208:211],v[24:27]
s_waitcnt lgkmcnt(6)
ds_read_b128 a[208:211],v250 offset:36352
v_accvgpr_read_b32 v233,a134
M v[28:31],v[216:219],a[212:215],v[28:31]
s_waitcnt vmcnt(14) lgkmcnt(6)
buffer_load_dwordx4 v[216:219],v251,s[20:23],s46 offen offset:2048 sc1
M v[0:3],v[220:223],a[216:219],v[0:3]
s_waitcnt lgkmcnt(5)
ds_read_b128 a[212:215],v250 offset:36608
ds_read_b128 a[216:219],v250 offset:36864
M v[4:7],v[220:223],a[220:223],v[4:7]
s_waitcnt lgkmcnt(6)
s_add_u32 s46,s77,46080
v_add_f32 v235,v238,v233
v_sub_f32 v238,v238,v233
M v[8:11],v[220:223],a[192:195],v[8:11]
s_waitcnt lgkmcnt(5)
v_add_f32 v233,v38,v134
v_sub_f32 v134,v38,v134
M v[12:15],v[220:223],a[196:199],v[12:15]
s_waitcnt lgkmcnt(4)
v_add_f32 v38,v235,v233
v_fmac_f32 v235,4.0,v233
M v[16:19],v[220:223],a[200:203],v[16:19]
s_waitcnt lgkmcnt(3)
v_fma_f32 v233,2.0,v134,v238
v_fma_f32 v134,s41,v134,v238
M v[20:23],v[220:223],a[204:207],v[20:23]
s_waitcnt lgkmcnt(2)
v_accvgpr_read_b32 v238,a39
v_accvgpr_read_b32 v237,a135
M v[24:27],v[220:223],a[208:211],v[24:27]
s_waitcnt lgkmcnt(1)
v_add_f32 v236,v238,v237
v_sub_f32 v238,v238,v237
M v[28:31],v[220:223],a[212:215],v[28:31]
s_waitcnt vmcnt(12)
buffer_load_dwordx4 v[220:223],v251,s[20:23],s46 offen offset:0 sc1
M v[0:3],v[224:227],a[220:223],v[0:3]
ds_read_b128 a[220:223],v249 offset:37120
v_add_f32 v237,v39,v135
M v[4:7],v[224:227],a[192:195],v[4:7]
v_sub_f32 v135,v39,v135
v_add_f32 v39,v236,v237
M v[8:11],v[224:227],a[196:199],v[8:11]
v_fmac_f32 v236,4.0,v237
v_fma_f32 v237,2.0,v135,v238
M v[12:15],v[224:227],a[200:203],v[12:15]
v_fma_f32 v135,s41,v135,v238
v_cvt_pk_bf16_f32 v233,v233,v237
M v[16:19],v[224:227],a[204:207],v[16:19]
v_cvt_pk_bf16_f32 v235,v235,v236
M v[20:23],v[224:227],a[208:211],v[20:23]
ds_write2st64_b64 v253,v[232:233],v[234:235] offset0:42 offset1:46
M v[24:27],v[224:227],a[212:215],v[24:27]
s_waitcnt lgkmcnt(2)
v_accvgpr_read_b32 v238,a40
v_accvgpr_read_b32 v232,a136
M v[28:31],v[224:227],a[216:219],v[28:31]
s_waitcnt vmcnt(12)
buffer_load_dwordx4 v[224:227],v251,s[20:23],s46 offen offset:1024 sc1
M v[0:3],v[228:231],a[192:195],v[0:3]
ds_read_b128 a[192:195],v249 offset:52224
v_add_f32 v234,v238,v232
M v[4:7],v[228:231],a[196:199],v[4:7]
ds_read_b128 a[196:199],v250 offset:52480
v_sub_f32 v238,v238,v232
M v[8:11],v[228:231],a[200:203],v[8:11]
ds_read_b128 a[200:203],v250 offset:52736
v_add_f32 v232,v40,v136
M v[12:15],v[228:231],a[204:207],v[12:15]
ds_read_b128 a[204:207],v250 offset:52992
v_sub_f32 v136,v40,v136
M v[16:19],v[228:231],a[208:211],v[16:19]
ds_read_b128 a[208:211],v250 offset:53248
v_add_f32 v40,v234,v232
M v[20:23],v[228:231],a[212:215],v[20:23]
ds_read_b128 a[212:215],v250 offset:53504
v_fmac_f32 v234,4.0,v232
M v[24:27],v[228:231],a[216:219],v[24:27]
s_waitcnt lgkmcnt(7)
ds_read_b128 a[216:219],v250 offset:53760
v_fma_f32 v232,2.0,v136,v238
M v[28:31],v[228:231],a[220:223],v[28:31]
s_waitcnt vmcnt(12) lgkmcnt(6)
buffer_load_dwordx4 v[228:231],v251,s[20:23],s46 offen offset:2048 sc1
M v[0:3],a[224:227],a[192:195],v[0:3]
s_waitcnt lgkmcnt(5)
ds_read_b128 a[220:223],v250 offset:54016
ds_read_b128 a[192:195],v250 offset:54272
M v[4:7],a[224:227],a[196:199],v[4:7]
s_waitcnt lgkmcnt(6)
s_add_u32 s46,s78,46080
v_fma_f32 v136,s41,v136,v238
v_accvgpr_read_b32 v238,a41
M v[8:11],a[224:227],a[200:203],v[8:11]
s_waitcnt lgkmcnt(5)
v_accvgpr_read_b32 v237,a137
v_add_f32 v236,v238,v237
M v[12:15],a[224:227],a[204:207],v[12:15]
s_waitcnt lgkmcnt(4)
v_sub_f32 v238,v238,v237
v_add_f32 v237,v41,v137
M v[16:19],a[224:227],a[208:211],v[16:19]
s_waitcnt lgkmcnt(3)
v_sub_f32 v137,v41,v137
v_add_f32 v41,v236,v237
M v[20:23],a[224:227],a[212:215],v[20:23]
s_waitcnt lgkmcnt(2)
v_fmac_f32 v236,4.0,v237
v_fma_f32 v237,2.0,v137,v238
M v[24:27],a[224:227],a[216:219],v[24:27]
s_waitcnt lgkmcnt(1)
v_fma_f32 v137,s41,v137,v238
v_cvt_pk_bf16_f32 v232,v232,v237
M v[28:31],a[224:227],a[220:223],v[28:31]
s_waitcnt vmcnt(12)
buffer_load_dwordx4 a[224:227],v251,s[20:23],s46 offen offset:0 sc1
M v[0:3],a[228:231],a[196:199],v[0:3]
ds_read_b128 a[196:199],v249 offset:54528
v_cvt_pk_bf16_f32 v234,v234,v236
M v[4:7],a[228:231],a[200:203],v[4:7]
v_accvgpr_read_b32 v238,a42
v_accvgpr_read_b32 v233,a138
M v[8:11],a[228:231],a[204:207],v[8:11]
v_add_f32 v235,v238,v233
v_sub_f32 v238,v238,v233
M v[12:15],a[228:231],a[208:211],v[12:15]
v_add_f32 v233,v42,v138
v_sub_f32 v138,v42,v138
M v[16:19],a[228:231],a[212:215],v[16:19]
v_add_f32 v42,v235,v233
v_fmac_f32 v235,4.0,v233
M v[20:23],a[228:231],a[216:219],v[20:23]
v_add_u32 v249,0xfffece00,v249
v_add_u32 v250,0xfffece00,v250
M v[24:27],a[228:231],a[220:223],v[24:27]
s_waitcnt lgkmcnt(1)
v_fma_f32 v233,2.0,v138,v238
v_fma_f32 v138,s41,v138,v238
M v[28:31],a[228:231],a[192:195],v[28:31]
s_waitcnt vmcnt(11)
buffer_load_dwordx4 a[228:231],v251,s[20:23],s46 offen offset:1024 sc1
M v[0:3],a[232:235],a[200:203],v[0:3]
ds_read_b128 a[200:203],v249 offset:60928
v_accvgpr_read_b32 v238,a43
M v[4:7],a[232:235],a[204:207],v[4:7]
ds_read_b128 a[204:207],v250 offset:61184
v_accvgpr_read_b32 v237,a139
M v[8:11],a[232:235],a[208:211],v[8:11]
ds_read_b128 a[208:211],v250 offset:61440
v_add_f32 v236,v238,v237
M v[12:15],a[232:235],a[212:215],v[12:15]
ds_read_b128 a[212:215],v250 offset:61696
v_sub_f32 v238,v238,v237
M v[16:19],a[232:235],a[216:219],v[16:19]
ds_read_b128 a[216:219],v250 offset:61952
v_add_f32 v237,v43,v139
M v[20:23],a[232:235],a[220:223],v[20:23]
ds_read_b128 a[220:223],v250 offset:62208
v_sub_f32 v139,v43,v139
M v[24:27],a[232:235],a[192:195],v[24:27]
s_waitcnt lgkmcnt(6)
ds_read_b128 a[192:195],v250 offset:62464
v_add_f32 v43,v236,v237
M v[28:31],a[232:235],a[196:199],v[28:31]
s_waitcnt vmcnt(11) lgkmcnt(6)
buffer_load_dwordx4 a[232:235],v251,s[20:23],s46 offen offset:2048 sc1
M v[0:3],a[236:239],a[200:203],v[0:3]
s_waitcnt lgkmcnt(5)
ds_read_b128 a[196:199],v250 offset:62720
ds_read_b128 a[200:203],v250 offset:62976
M v[4:7],a[236:239],a[204:207],v[4:7]
s_waitcnt lgkmcnt(6)
s_add_u32 s46,s79,46080
v_fmac_f32 v236,4.0,v237
v_fma_f32 v237,2.0,v139,v238
M v[8:11],a[236:239],a[208:211],v[8:11]
s_waitcnt lgkmcnt(5)
v_fma_f32 v139,s41,v139,v238
v_cvt_pk_bf16_f32 v233,v233,v237
M v[12:15],a[236:239],a[212:215],v[12:15]
s_waitcnt lgkmcnt(4)
v_cvt_pk_bf16_f32 v235,v235,v236
M v[16:19],a[236:239],a[216:219],v[16:19]
s_waitcnt lgkmcnt(3)
ds_write2st64_b64 v253,v[232:233],v[234:235] offset0:51 offset1:55
M v[20:23],a[236:239],a[220:223],v[20:23]
s_waitcnt lgkmcnt(3)
v_accvgpr_read_b32 v238,a44
v_accvgpr_read_b32 v232,a140
M v[24:27],a[236:239],a[192:195],v[24:27]
s_waitcnt lgkmcnt(2)
v_add_f32 v234,v238,v232
v_sub_f32 v238,v238,v232
M v[28:31],a[236:239],a[196:199],v[28:31]
s_waitcnt vmcnt(10)
buffer_load_dwordx4 a[236:239],v251,s[20:23],s46 offen offset:0 sc1
M v[0:3],a[240:243],a[204:207],v[0:3]
ds_read_b128 a[204:207],v249 offset:63232
v_add_f32 v232,v44,v140
M v[4:7],a[240:243],a[208:211],v[4:7]
v_sub_f32 v140,v44,v140
v_add_f32 v44,v234,v232
M v[8:11],a[240:243],a[212:215],v[8:11]
v_fmac_f32 v234,4.0,v232
v_fma_f32 v232,2.0,v140,v238
M v[12:15],a[240:243],a[216:219],v[12:15]
v_fma_f32 v140,s41,v140,v238
v_accvgpr_read_b32 v238,a45
M v[16:19],a[240:243],a[220:223],v[16:19]
v_accvgpr_read_b32 v237,a141
v_add_f32 v236,v238,v237
M v[20:23],a[240:243],a[192:195],v[20:23]
v_sub_f32 v238,v238,v237
v_add_f32 v237,v45,v141
M v[24:27],a[240:243],a[196:199],v[24:27]
s_waitcnt lgkmcnt(2)
v_sub_f32 v141,v45,v141
v_add_f32 v45,v236,v237
M v[28:31],a[240:243],a[200:203],v[28:31]
s_waitcnt vmcnt(10)
buffer_load_dwordx4 a[240:243],v251,s[20:23],s46 offen offset:1024 sc1
M v[0:3],a[244:247],a[208:211],v[0:3]
ds_read_b128 a[208:211],v249 offset:0
v_fmac_f32 v236,4.0,v237
M v[4:7],a[244:247],a[212:215],v[4:7]
ds_read_b128 a[212:215],v250 offset:256
v_fma_f32 v237,2.0,v141,v238
M v[8:11],a[244:247],a[216:219],v[8:11]
ds_read_b128 a[216:219],v250 offset:512
v_fma_f32 v141,s41,v141,v238
M v[12:15],a[244:247],a[220:223],v[12:15]
ds_read_b128 a[220:223],v250 offset:768
v_cvt_pk_bf16_f32 v232,v232,v237
M v[16:19],a[244:247],a[192:195],v[16:19]
ds_read_b128 a[192:195],v250 offset:1024
v_cvt_pk_bf16_f32 v234,v234,v236
M v[20:23],a[244:247],a[196:199],v[20:23]
ds_read_b128 a[196:199],v250 offset:1280
v_accvgpr_read_b32 v238,a46
M v[24:27],a[244:247],a[200:203],v[24:27]
s_waitcnt lgkmcnt(6)
ds_read_b128 a[200:203],v250 offset:1536
v_accvgpr_read_b32 v233,a142
M v[28:31],a[244:247],a[204:207],v[28:31]
s_waitcnt vmcnt(10) lgkmcnt(6)
buffer_load_dwordx4 a[244:247],v251,s[20:23],s46 offen offset:2048 sc1
M v[96:99],a[248:251],a[208:211],v[96:99]
s_waitcnt lgkmcnt(5)
ds_read_b128 a[204:207],v250 offset:1792
ds_read_b128 a[208:211],v250 offset:2048
M v[100:103],a[248:251],a[212:215],v[100:103]
s_waitcnt lgkmcnt(6)
s_add_u32 s46,s80,46080
v_add_f32 v235,v238,v233
v_sub_f32 v238,v238,v233
M v[104:107],a[248:251],a[216:219],v[104:107]
s_waitcnt lgkmcnt(5)
v_add_f32 v233,v46,v142
v_sub_f32 v142,v46,v142
M v[108:111],a[248:251],a[220:223],v[108:111]
s_waitcnt lgkmcnt(4)
v_add_f32 v46,v235,v233
v_fmac_f32 v235,4.0,v233
M v[112:115],a[248:251],a[192:195],v[112:115]
s_waitcnt lgkmcnt(3)
v_fma_f32 v233,2.0,v142,v238
v_fma_f32 v142,s41,v142,v238
M v[116:119],a[248:251],a[196:199],v[116:119]
s_waitcnt lgkmcnt(2)
v_accvgpr_read_b32 v238,a47
v_accvgpr_read_b32 v237,a143
M v[120:123],a[248:251],a[200:203],v[120:123]
s_waitcnt lgkmcnt(1)
v_add_f32 v236,v238,v237
v_sub_f32 v238,v238,v237
M v[124:127],a[248:251],a[204:207],v[124:127]
s_waitcnt vmcnt(10)
buffer_load_dwordx4 a[248:251],v251,s[20:23],s46 offen offset:0 sc1
M v[96:99],a[252:255],a[212:215],v[96:99]
ds_read_b128 a[212:215],v249 offset:2304
v_add_f32 v237,v47,v143
M v[100:103],a[252:255],a[216:219],v[100:103]
v_sub_f32 v143,v47,v143
v_add_f32 v47,v236,v237
M v[104:107],a[252:255],a[220:223],v[104:107]
v_fmac_f32 v236,4.0,v237
v_fma_f32 v237,2.0,v143,v238
M v[108:111],a[252:255],a[192:195],v[108:111]
v_fma_f32 v143,s41,v143,v238
v_cvt_pk_bf16_f32 v233,v233,v237
M v[112:115],a[252:255],a[196:199],v[112:115]
v_cvt_pk_bf16_f32 v235,v235,v236
M v[116:119],a[252:255],a[200:203],v[116:119]
ds_write2st64_b64 v253,v[232:233],v[234:235] offset0:59 offset1:63
M v[120:123],a[252:255],a[204:207],v[120:123]
s_waitcnt lgkmcnt(2)
v_add_u32 v249,0x15400,v249
v_add_u32 v250,0x15400,v250
M v[124:127],a[252:255],a[208:211],v[124:127]
s_waitcnt vmcnt(10)
buffer_load_dwordx4 a[252:255],v251,s[20:23],s46 offen offset:1024 sc1
M v[96:99],v[216:219],a[216:219],v[96:99]
ds_read_b128 a[216:219],v249 offset:0
v_cvt_pk_bf16_f32 v0,v0,v1
M v[100:103],v[216:219],a[220:223],v[100:103]
ds_read_b128 a[220:223],v250 offset:256
v_cvt_pk_bf16_f32 v1,v2,v3
M v[104:107],v[216:219],a[192:195],v[104:107]
ds_read_b128 a[192:195],v250 offset:512
v_cvt_pk_bf16_f32 v4,v4,v5
M v[108:111],v[216:219],a[196:199],v[108:111]
ds_read_b128 a[196:199],v250 offset:768
v_cvt_pk_bf16_f32 v5,v6,v7
M v[112:115],v[216:219],a[200:203],v[112:115]
s_waitcnt lgkmcnt(4)
s_barrier
ds_read_b128 a[32:35],v251 offset:17408
M v[116:119],v[216:219],a[204:207],v[116:119]
ds_read_b128 a[36:39],v251 offset:21504
ds_read_b128 a[40:43],v251 offset:26112
M v[120:123],v[216:219],a[208:211],v[120:123]
ds_read_b128 a[44:47],v251 offset:30208
ds_read_b128 a[200:203],v250 offset:1024
M v[124:127],v[216:219],a[212:215],v[124:127]
s_waitcnt vmcnt(10) lgkmcnt(8)
buffer_load_dwordx4 v[216:219],v251,s[20:23],s46 offen offset:2048 sc1
M v[96:99],v[220:223],a[216:219],v[96:99]
s_waitcnt lgkmcnt(7)
ds_read_b128 a[204:207],v250 offset:1280
ds_read_b128 a[208:211],v250 offset:1536
M v[100:103],v[220:223],a[220:223],v[100:103]
s_waitcnt lgkmcnt(6)
s_add_u32 s34,s32,0
buffer_store_dwordx4 a[32:35],v252,s[24:27],s34 offen offset:512 nt
M v[104:107],v[220:223],a[192:195],v[104:107]
s_waitcnt lgkmcnt(5)
s_add_u32 s34,s32,196608
buffer_store_dwordx4 a[36:39],v252,s[24:27],s34 offen offset:512 nt
ds_read_b128 a[212:215],v250 offset:1792
M v[108:111],v[220:223],a[196:199],v[108:111]
s_waitcnt lgkmcnt(3)
s_add_u32 s34,s32,393216
buffer_store_dwordx4 a[40:43],v252,s[24:27],s34 offen offset:512 nt
M v[112:115],v[220:223],a[200:203],v[112:115]
s_waitcnt lgkmcnt(2)
s_add_u32 s34,s32,589824
buffer_store_dwordx4 a[44:47],v252,s[24:27],s34 offen offset:512 nt
M v[116:119],v[220:223],a[204:207],v[116:119]
s_waitcnt lgkmcnt(1)
s_add_u32 s46,s81,46080
ds_read_b128 a[216:219],v250 offset:2048
ds_write2st64_b64 v253,v[0:1],v[4:5] offset0:119 offset1:123
M v[120:123],v[220:223],a[208:211],v[120:123]
s_waitcnt lgkmcnt(2)
v_cvt_pk_bf16_f32 v8,v8,v9
v_cvt_pk_bf16_f32 v9,v10,v11
M v[124:127],v[220:223],a[212:215],v[124:127]
s_waitcnt vmcnt(14)
buffer_load_dwordx4 v[220:223],v251,s[20:23],s46 offen offset:0 sc1
M v[96:99],v[224:227],a[220:223],v[96:99]
ds_read_b128 a[220:223],v249 offset:2304
v_cvt_pk_bf16_f32 v12,v12,v13
M v[100:103],v[224:227],a[192:195],v[100:103]
v_cvt_pk_bf16_f32 v13,v14,v15
M v[104:107],v[224:227],a[196:199],v[104:107]
ds_write2st64_b64 v253,v[8:9],v[12:13] offset0:127 offset1:131
M v[108:111],v[224:227],a[200:203],v[108:111]
v_cvt_pk_bf16_f32 v16,v16,v17
v_cvt_pk_bf16_f32 v17,v18,v19
M v[112:115],v[224:227],a[204:207],v[112:115]
v_cvt_pk_bf16_f32 v20,v20,v21
v_cvt_pk_bf16_f32 v21,v22,v23
M v[116:119],v[224:227],a[208:211],v[116:119]
ds_write2st64_b64 v253,v[16:17],v[20:21] offset0:68 offset1:72
M v[120:123],v[224:227],a[212:215],v[120:123]
s_waitcnt lgkmcnt(4)
v_cvt_pk_bf16_f32 v24,v24,v25
v_cvt_pk_bf16_f32 v25,v26,v27
M v[124:127],v[224:227],a[216:219],v[124:127]
s_waitcnt vmcnt(14)
buffer_load_dwordx4 v[224:227],v251,s[20:23],s46 offen offset:1024 sc1
M v[96:99],v[228:231],a[192:195],v[96:99]
ds_read_b128 a[192:195],v249 offset:17408
v_cvt_pk_bf16_f32 v28,v28,v29
M v[100:103],v[228:231],a[196:199],v[100:103]
ds_read_b128 a[196:199],v250 offset:17664
v_cvt_pk_bf16_f32 v29,v30,v31
M v[104:107],v[228:231],a[200:203],v[104:107]
ds_read_b128 a[200:203],v250 offset:17920
ds_write2st64_b64 v253,v[24:25],v[28:29] offset0:76 offset1:80
M v[108:111],v[228:231],a[204:207],v[108:111]
ds_read_b128 a[204:207],v250 offset:18176
v_accvgpr_read_b32 v238,a48
M v[112:115],v[228:231],a[208:211],v[112:115]
ds_read_b128 a[208:211],v250 offset:18432
v_accvgpr_read_b32 v232,a144
M v[116:119],v[228:231],a[212:215],v[116:119]
ds_read_b128 a[212:215],v250 offset:18688
v_add_f32 v234,v238,v232
M v[120:123],v[228:231],a[216:219],v[120:123]
s_waitcnt lgkmcnt(9)
ds_read_b128 a[216:219],v250 offset:18944
v_sub_f32 v238,v238,v232
M v[124:127],v[228:231],a[220:223],v[124:127]
s_waitcnt vmcnt(14) lgkmcnt(7)
buffer_load_dwordx4 v[228:231],v251,s[20:23],s46 offen offset:2048 sc1
M v[96:99],a[224:227],a[192:195],v[96:99]
s_waitcnt lgkmcnt(6)
ds_read_b128 a[220:223],v250 offset:19200
ds_read_b128 a[192:195],v250 offset:19456
M v[100:103],a[224:227],a[196:199],v[100:103]
s_waitcnt lgkmcnt(7)
s_add_u32 s47,s76,3072
v_add_f32 v232,v48,v144
v_sub_f32 v144,v48,v144
M v[104:107],a[224:227],a[200:203],v[104:107]
s_waitcnt lgkmcnt(5)
v_add_f32 v48,v234,v232
v_fmac_f32 v234,4.0,v232
M v[108:111],a[224:227],a[204:207],v[108:111]
s_waitcnt lgkmcnt(4)
v_fma_f32 v232,2.0,v144,v238
v_fma_f32 v144,s41,v144,v238
M v[112:115],a[224:227],a[208:211],v[112:115]
s_waitcnt lgkmcnt(3)
v_accvgpr_read_b32 v238,a49
v_accvgpr_read_b32 v237,a145
M v[116:119],a[224:227],a[212:215],v[116:119]
s_waitcnt lgkmcnt(2)
v_add_f32 v236,v238,v237
v_sub_f32 v238,v238,v237
M v[120:123],a[224:227],a[216:219],v[120:123]
s_waitcnt lgkmcnt(1)
v_add_f32 v237,v49,v145
v_sub_f32 v145,v49,v145
M v[124:127],a[224:227],a[220:223],v[124:127]
s_waitcnt vmcnt(14)
buffer_load_dwordx4 a[224:227],v251,s[20:23],s47 offen offset:0 sc1
M v[96:99],a[228:231],a[196:199],v[96:99]
ds_read_b128 a[196:199],v249 offset:19712
v_add_f32 v49,v236,v237
M v[100:103],a[228:231],a[200:203],v[100:103]
v_fmac_f32 v236,4.0,v237
v_fma_f32 v237,2.0,v145,v238
M v[104:107],a[228:231],a[204:207],v[104:107]
v_fma_f32 v145,s41,v145,v238
v_cvt_pk_bf16_f32 v232,v232,v237
M v[108:111],a[228:231],a[208:211],v[108:111]
v_cvt_pk_bf16_f32 v234,v234,v236
v_accvgpr_read_b32 v238,a50
M v[112:115],a[228:231],a[212:215],v[112:115]
v_accvgpr_read_b32 v233,a146
v_add_f32 v235,v238,v233
M v[116:119],a[228:231],a[216:219],v[116:119]
v_sub_f32 v238,v238,v233
v_add_f32 v233,v50,v146
M v[120:123],a[228:231],a[220:223],v[120:123]
s_waitcnt lgkmcnt(1)
v_sub_f32 v146,v50,v146
v_add_f32 v50,v235,v233
M v[124:127],a[228:231],a[192:195],v[124:127]
s_waitcnt vmcnt(14)
buffer_load_dwordx4 a[228:231],v251,s[20:23],s47 offen offset:1024 sc1
M v[96:99],a[232:235],a[200:203],v[96:99]
ds_read_b128 a[200:203],v249 offset:34816
v_fmac_f32 v235,4.0,v233
M v[100:103],a[232:235],a[204:207],v[100:103]
ds_read_b128 a[204:207],v250 offset:35072
v_fma_f32 v233,2.0,v146,v238
M v[104:107],a[232:235],a[208:211],v[104:107]
ds_read_b128 a[208:211],v250 offset:35328
v_fma_f32 v146,s41,v146,v238
M v[108:111],a[232:235],a[212:215],v[108:111]
ds_read_b128 a[212:215],v250 offset:35584
v_accvgpr_read_b32 v238,a51
M v[112:115],a[232:235],a[216:219],v[112:115]
ds_read_b128 a[216:219],v250 offset:35840
v_accvgpr_read_b32 v237,a147
M v[116:119],a[232:235],a[220:223],v[116:119]
ds_read_b128 a[220:223],v250 offset:36096
v_add_f32 v236,v238,v237
M v[120:123],a[232:235],a[192:195],v[120:123]
s_waitcnt lgkmcnt(6)
ds_read_b128 a[192:195],v250 offset:36352
v_sub_f32 v238,v238,v237
M v[124:127],a[232:235],a[196:199],v[124:127]
s_waitcnt vmcnt(14) lgkmcnt(6)
buffer_load_dwordx4 a[232:235],v251,s[20:23],s47 offen offset:2048 sc1
M v[96:99],a[236:239],a[200:203],v[96:99]
s_waitcnt lgkmcnt(5)
ds_read_b128 a[196:199],v250 offset:36608
ds_read_b128 a[200:203],v250 offset:36864
M v[100:103],a[236:239],a[204:207],v[100:103]
s_waitcnt lgkmcnt(6)
s_add_u32 s47,s77,3072
v_add_f32 v237,v51,v147
v_sub_f32 v147,v51,v147
M v[104:107],a[236:239],a[208:211],v[104:107]
s_waitcnt lgkmcnt(5)
v_add_f32 v51,v236,v237
v_fmac_f32 v236,4.0,v237
M v[108:111],a[236:239],a[212:215],v[108:111]
s_waitcnt lgkmcnt(4)
v_fma_f32 v237,2.0,v147,v238
v_fma_f32 v147,s41,v147,v238
M v[112:115],a[236:239],a[216:219],v[112:115]
s_waitcnt lgkmcnt(3)
v_cvt_pk_bf16_f32 v233,v233,v237
v_cvt_pk_bf16_f32 v235,v235,v236
M v[116:119],a[236:239],a[220:223],v[116:119]
s_waitcnt lgkmcnt(2)
ds_write2st64_b64 v253,v[232:233],v[234:235] offset0:85 offset1:89
M v[120:123],a[236:239],a[192:195],v[120:123]
s_waitcnt lgkmcnt(2)
v_accvgpr_read_b32 v238,a52
v_accvgpr_read_b32 v232,a148
M v[124:127],a[236:239],a[196:199],v[124:127]
s_waitcnt vmcnt(14)
buffer_load_dwordx4 a[236:239],v251,s[20:23],s47 offen offset:0 sc1
M v[96:99],a[240:243],a[204:207],v[96:99]
ds_read_b128 a[204:207],v249 offset:37120
v_add_f32 v234,v238,v232
M v[100:103],a[240:243],a[208:211],v[100:103]
v_sub_f32 v238,v238,v232
v_add_f32 v232,v52,v148
M v[104:107],a[240:243],a[212:215],v[104:107]
v_sub_f32 v148,v52,v148
v_add_f32 v52,v234,v232
M v[108:111],a[240:243],a[216:219],v[108:111]
v_fmac_f32 v234,4.0,v232
v_fma_f32 v232,2.0,v148,v238
M v[112:115],a[240:243],a[220:223],v[112:115]
v_fma_f32 v148,s41,v148,v238
v_accvgpr_read_b32 v238,a53
M v[116:119],a[240:243],a[192:195],v[116:119]
v_accvgpr_read_b32 v237,a149
v_add_f32 v236,v238,v237
M v[120:123],a[240:243],a[196:199],v[120:123]
s_waitcnt lgkmcnt(2)
v_sub_f32 v238,v238,v237
v_add_f32 v237,v53,v149
M v[124:127],a[240:243],a[200:203],v[124:127]
s_waitcnt vmcnt(14)
buffer_load_dwordx4 a[240:243],v251,s[20:23],s47 offen offset:1024 sc1
M v[96:99],a[244:247],a[208:211],v[96:99]
ds_read_b128 a[208:211],v249 offset:52224
v_sub_f32 v149,v53,v149
M v[100:103],a[244:247],a[212:215],v[100:103]
ds_read_b128 a[212:215],v250 offset:52480
v_add_f32 v53,v236,v237
M v[104:107],a[244:247],a[216:219],v[104:107]
ds_read_b128 a[216:219],v250 offset:52736
v_fmac_f32 v236,4.0,v237
M v[108:111],a[244:247],a[220:223],v[108:111]
ds_read_b128 a[220:223],v250 offset:52992
v_fma_f32 v237,2.0,v149,v238
M v[112:115],a[244:247],a[192:195],v[112:115]
ds_read_b128 a[192:195],v250 offset:53248
v_fma_f32 v149,s41,v149,v238
M v[116:119],a[244:247],a[196:199],v[116:119]
ds_read_b128 a[196:199],v250 offset:53504
v_cvt_pk_bf16_f32 v232,v232,v237
M v[120:123],a[244:247],a[200:203],v[120:123]
s_waitcnt lgkmcnt(6)
ds_read_b128 a[200:203],v250 offset:53760
v_cvt_pk_bf16_f32 v234,v234,v236
M v[124:127],a[244:247],a[204:207],v[124:127]
s_waitcnt vmcnt(14) lgkmcnt(6)
buffer_load_dwordx4 a[244:247],v251,s[20:23],s47 offen offset:2048 sc1
M v[96:99],a[248:251],a[208:211],v[96:99]
s_waitcnt lgkmcnt(5)
ds_read_b128 a[204:207],v250 offset:54016
ds_read_b128 a[208:211],v250 offset:54272
M v[100:103],a[248:251],a[212:215],v[100:103]
s_waitcnt lgkmcnt(6)
s_add_u32 s47,s78,3072
v_accvgpr_read_b32 v238,a54
v_accvgpr_read_b32 v233,a150
M v[104:107],a[248:251],a[216:219],v[104:107]
s_waitcnt lgkmcnt(5)
v_add_f32 v235,v238,v233
v_sub_f32 v238,v238,v233
M v[108:111],a[248:251],a[220:223],v[108:111]
s_waitcnt lgkmcnt(4)
v_add_f32 v233,v54,v150
v_sub_f32 v150,v54,v150
M v[112:115],a[248:251],a[192:195],v[112:115]
s_waitcnt lgkmcnt(3)
v_add_f32 v54,v235,v233
v_fmac_f32 v235,4.0,v233
M v[116:119],a[248:251],a[196:199],v[116:119]
s_waitcnt lgkmcnt(2)
v_fma_f32 v233,2.0,v150,v238
v_fma_f32 v150,s41,v150,v238
M v[120:123],a[248:251],a[200:203],v[120:123]
s_waitcnt lgkmcnt(1)
v_accvgpr_read_b32 v238,a55
v_accvgpr_read_b32 v237,a151
M v[124:127],a[248:251],a[204:207],v[124:127]
s_waitcnt vmcnt(14)
buffer_load_dwordx4 a[248:251],v251,s[20:23],s47 offen offset:0 sc1
M v[96:99],a[252:255],a[212:215],v[96:99]
ds_read_b128 a[212:215],v249 offset:54528
v_add_f32 v236,v238,v237
M v[100:103],a[252:255],a[216:219],v[100:103]
v_sub_f32 v238,v238,v237
v_add_f32 v237,v55,v151
M v[104:107],a[252:255],a[220:223],v[104:107]
v_sub_f32 v151,v55,v151
v_add_f32 v55,v236,v237
M v[108:111],a[252:255],a[192:195],v[108:111]
v_fmac_f32 v236,4.0,v237
v_fma_f32 v237,2.0,v151,v238
M v[112:115],a[252:255],a[196:199],v[112:115]
v_fma_f32 v151,s41,v151,v238
v_cvt_pk_bf16_f32 v233,v233,v237
M v[116:119],a[252:255],a[200:203],v[116:119]
v_add_u32 v249,0xffffbc00,v249
v_add_u32 v250,0xffffbc00,v250
M v[120:123],a[252:255],a[204:207],v[120:123]
s_waitcnt lgkmcnt(1)
v_cvt_pk_bf16_f32 v235,v235,v236
M v[124:127],a[252:255],a[208:211],v[124:127]
s_waitcnt vmcnt(14)
buffer_load_dwordx4 a[252:255],v251,s[20:23],s47 offen offset:1024 sc1
M v[96:99],v[216:219],a[216:219],v[96:99]
ds_read_b128 a[216:219],v249 offset:0
ds_write2st64_b64 v253,v[232:233],v[234:235] offset0:93 offset1:97
M v[100:103],v[216:219],a[220:223],v[100:103]
ds_read_b128 a[220:223],v250 offset:256
v_accvgpr_read_b32 v238,a56
M v[104:107],v[216:219],a[192:195],v[104:107]
ds_read_b128 a[192:195],v250 offset:512
v_accvgpr_read_b32 v232,a152
M v[108:111],v[216:219],a[196:199],v[108:111]
ds_read_b128 a[196:199],v250 offset:768
v_add_f32 v234,v238,v232
M v[112:115],v[216:219],a[200:203],v[112:115]
ds_read_b128 a[200:203],v250 offset:1024
v_sub_f32 v238,v238,v232
M v[116:119],v[216:219],a[204:207],v[116:119]
ds_read_b128 a[204:207],v250 offset:1280
v_add_f32 v232,v56,v152
M v[120:123],v[216:219],a[208:211],v[120:123]
s_waitcnt lgkmcnt(7)
ds_read_b128 a[208:211],v250 offset:1536
v_sub_f32 v152,v56,v152
M v[124:127],v[216:219],a[212:215],v[124:127]
s_waitcnt vmcnt(10) lgkmcnt(6)
s_barrier
ds_read_b128 a[96:99],v251 offset:60928
M v[96:99],v[220:223],a[216:219],v[96:99]
s_waitcnt lgkmcnt(6)
ds_read_b128 a[100:103],v251 offset:65024
ds_read_b128 a[104:107],v251 offset:34816
M v[100:103],v[220:223],a[220:223],v[100:103]
s_waitcnt lgkmcnt(7)
ds_read_b128 a[108:111],v251 offset:38912
ds_read_b128 a[48:51],v251 offset:43520
M v[104:107],v[220:223],a[192:195],v[104:107]
s_waitcnt lgkmcnt(8)
ds_read_b128 a[52:55],v251 offset:47616
ds_read_b128 a[212:215],v250 offset:1792
M v[108:111],v[220:223],a[196:199],v[108:111]
s_waitcnt lgkmcnt(9)
buffer_load_dwordx4 v[216:219],v251,s[20:23],s47 offen offset:2048 sc1
M v[112:115],v[220:223],a[200:203],v[112:115]
s_waitcnt lgkmcnt(6)
s_add_u32 s34,s33,0
buffer_store_dwordx4 a[96:99],v252,s[24:27],s34 offen offset:0 nt
M v[116:119],v[220:223],a[204:207],v[116:119]
s_waitcnt lgkmcnt(5)
s_add_u32 s34,s33,393216
buffer_store_dwordx4 a[100:103],v252,s[24:27],s34 offen offset:0 nt
M v[120:123],v[220:223],a[208:211],v[120:123]
s_waitcnt lgkmcnt(0)
s_add_u32 s34,s33,786432
buffer_store_dwordx4 a[104:107],v252,s[24:27],s34 offen offset:0 nt
M v[124:127],v[220:223],a[212:215],v[124:127]
s_waitcnt vmcnt(13)
s_add_u32 s34,s33,1179648
buffer_store_dwordx4 a[108:111],v252,s[24:27],s34 offen offset:0 nt
M v[96:99],v[224:227],a[220:223],v[96:99]
s_nop 0
s_add_u32 s34,s32,786432
buffer_store_dwordx4 a[48:51],v252,s[24:27],s34 offen offset:512 nt
v_add_f32 v56,v234,v232
v_fmac_f32 v234,4.0,v232
v_fma_f32 v232,2.0,v152,v238
M v[100:103],v[224:227],a[192:195],v[100:103]
s_add_u32 s47,s79,3072
buffer_load_dwordx4 v[220:223],v251,s[20:23],s47 offen offset:0 sc1
v_fma_f32 v152,s41,v152,v238
v_accvgpr_read_b32 v238,a57
v_accvgpr_read_b32 v237,a153
v_add_f32 v236,v238,v237
M v[104:107],v[224:227],a[196:199],v[104:107]
ds_read_b128 a[216:219],v250 offset:2048
ds_read_b128 a[220:223],v249 offset:2304
v_sub_f32 v238,v238,v237
v_add_f32 v237,v57,v153
v_sub_f32 v153,v57,v153
v_add_f32 v57,v236,v237
M v[108:111],v[224:227],a[200:203],v[108:111]
v_fmac_f32 v236,4.0,v237
v_fma_f32 v237,2.0,v153,v238
v_fma_f32 v153,s41,v153,v238
v_cvt_pk_bf16_f32 v232,v232,v237
M v[112:115],v[224:227],a[204:207],v[112:115]
v_cvt_pk_bf16_f32 v234,v234,v236
v_accvgpr_read_b32 v238,a58
v_accvgpr_read_b32 v233,a154
v_add_f32 v235,v238,v233
M v[116:119],v[224:227],a[208:211],v[116:119]
v_sub_f32 v238,v238,v233
v_add_f32 v233,v58,v154
v_sub_f32 v154,v58,v154
v_add_f32 v58,v235,v233
M v[120:123],v[224:227],a[212:215],v[120:123]
s_waitcnt lgkmcnt(1)
v_add_u32 v249,0xfffece00,v249
v_add_u32 v250,0xfffece00,v250
v_fmac_f32 v235,4.0,v233
v_fma_f32 v233,2.0,v154,v238
v_fma_f32 v154,s41,v154,v238
v_accvgpr_read_b32 v238,a59
M v[124:127],v[224:227],a[216:219],v[124:127]
s_waitcnt vmcnt(15)
buffer_load_dwordx4 v[224:227],v251,s[20:23],s47 offen offset:1024 sc1
v_accvgpr_read_b32 v237,a155
v_add_f32 v236,v238,v237
v_sub_f32 v238,v238,v237
v_add_f32 v237,v59,v155
M v[96:99],v[228:231],a[192:195],v[96:99]
ds_read_b128 a[192:195],v249 offset:0
v_sub_f32 v155,v59,v155
v_add_f32 v59,v236,v237
v_fmac_f32 v236,4.0,v237
v_fma_f32 v237,2.0,v155,v238
M v[100:103],v[228:231],a[196:199],v[100:103]
ds_read_b128 a[196:199],v250 offset:256
v_fma_f32 v155,s41,v155,v238
v_cvt_pk_bf16_f32 v233,v233,v237
v_cvt_pk_bf16_f32 v235,v235,v236
M v[104:107],v[228:231],a[200:203],v[104:107]
ds_write2st64_b64 v253,v[232:233],v[234:235] offset0:34 offset1:38
M v[108:111],v[228:231],a[204:207],v[108:111]
ds_read_b128 a[200:203],v250 offset:512
ds_read_b128 a[204:207],v250 offset:768
v_accvgpr_read_b32 v238,a60
v_accvgpr_read_b32 v232,a156
M v[112:115],v[228:231],a[208:211],v[112:115]
ds_read_b128 a[208:211],v250 offset:1024
v_add_f32 v234,v238,v232
v_sub_f32 v238,v238,v232
v_add_f32 v232,v60,v156
v_sub_f32 v156,v60,v156
M v[116:119],v[228:231],a[212:215],v[116:119]
ds_read_b128 a[212:215],v250 offset:1280
v_add_f32 v60,v234,v232
v_fmac_f32 v234,4.0,v232
v_fma_f32 v232,2.0,v156,v238
v_fma_f32 v156,s41,v156,v238
M v[120:123],v[228:231],a[216:219],v[120:123]
s_waitcnt lgkmcnt(7)
ds_read_b128 a[216:219],v250 offset:1536
v_accvgpr_read_b32 v238,a61
v_accvgpr_read_b32 v237,a157
v_add_f32 v236,v238,v237
v_sub_f32 v238,v238,v237
M v[124:127],v[228:231],a[220:223],v[124:127]
s_waitcnt vmcnt(15) lgkmcnt(7)
s_add_u32 s34,s32,983040
buffer_load_dwordx4 v[228:231],v251,s[20:23],s47 offen offset:2048 sc1
v_add_f32 v237,v61,v157
v_sub_f32 v157,v61,v157
v_add_f32 v61,v236,v237
v_fmac_f32 v236,4.0,v237
M v[32:35],a[224:227],a[192:195],v[32:35]
s_waitcnt lgkmcnt(6)
buffer_store_dwordx4 a[52:55],v252,s[24:27],s34 offen offset:512 nt
v_fma_f32 v237,2.0,v157,v238
v_fma_f32 v157,s41,v157,v238
v_cvt_pk_bf16_f32 v232,v232,v237
v_cvt_pk_bf16_f32 v234,v234,v236
M v[36:39],a[224:227],a[196:199],v[36:39]
s_waitcnt lgkmcnt(4)
s_add_u32 s47,s80,3072
ds_read_b128 a[220:223],v250 offset:1792
ds_read_b128 a[192:195],v250 offset:2048
v_accvgpr_read_b32 v238,a62
v_accvgpr_read_b32 v233,a158
v_add_f32 v235,v238,v233
v_sub_f32 v238,v238,v233
M v[40:43],a[224:227],a[200:203],v[40:43]
s_waitcnt lgkmcnt(5)
v_add_f32 v233,v62,v158
v_sub_f32 v158,v62,v158
v_add_f32 v62,v235,v233
v_fmac_f32 v235,4.0,v233
M v[44:47],a[224:227],a[204:207],v[44:47]
s_waitcnt lgkmcnt(4)
v_fma_f32 v233,2.0,v158,v238
v_fma_f32 v158,s41,v158,v238
v_accvgpr_read_b32 v238,a63
v_accvgpr_read_b32 v237,a159
M v[48:51],a[224:227],a[208:211],v[48:51]
s_waitcnt lgkmcnt(3)
v_add_f32 v236,v238,v237
v_sub_f32 v238,v238,v237
v_add_f32 v237,v63,v159
v_sub_f32 v159,v63,v159
M v[52:55],a[224:227],a[212:215],v[52:55]
s_waitcnt lgkmcnt(2)
v_add_f32 v63,v236,v237
v_fmac_f32 v236,4.0,v237
M v[56:59],a[224:227],a[216:219],v[56:59]
s_waitcnt lgkmcnt(1)
v_fma_f32 v237,2.0,v159,v238
v_fma_f32 v159,s41,v159,v238
M v[60:63],a[224:227],a[220:223],v[60:63]
s_waitcnt vmcnt(16)
buffer_load_dwordx4 a[224:227],v251,s[20:23],s47 offen offset:0 sc1
M v[32:35],a[228:231],a[196:199],v[32:35]
ds_read_b128 a[196:199],v249 offset:2304
v_cvt_pk_bf16_f32 v233,v233,v237
M v[36:39],a[228:231],a[200:203],v[36:39]
v_cvt_pk_bf16_f32 v235,v235,v236
M v[40:43],a[228:231],a[204:207],v[40:43]
ds_write2st64_b64 v253,v[232:233],v[234:235] offset0:42 offset1:46
M v[44:47],a[228:231],a[208:211],v[44:47]
v_cvt_pk_bf16_f32 v96,v96,v97
v_cvt_pk_bf16_f32 v97,v98,v99
M v[48:51],a[228:231],a[212:215],v[48:51]
v_cvt_pk_bf16_f32 v100,v100,v101
v_cvt_pk_bf16_f32 v101,v102,v103
M v[52:55],a[228:231],a[216:219],v[52:55]
ds_write2st64_b64 v253,v[96:97],v[100:101] offset0:51 offset1:55
M v[56:59],a[228:231],a[220:223],v[56:59]
s_waitcnt lgkmcnt(3)
v_add_u32 v249,0x15400,v249
v_add_u32 v250,0x15400,v250
M v[60:63],a[228:231],a[192:195],v[60:63]
s_waitcnt vmcnt(16)
buffer_load_dwordx4 a[228:231],v251,s[20:23],s47 offen offset:1024 sc1
M v[32:35],a[232:235],a[200:203],v[32:35]
ds_read_b128 a[200:203],v249 offset:0
v_cvt_pk_bf16_f32 v104,v104,v105
M v[36:39],a[232:235],a[204:207],v[36:39]
ds_read_b128 a[204:207],v250 offset:256
v_cvt_pk_bf16_f32 v105,v106,v107
M v[40:43],a[232:235],a[208:211],v[40:43]
ds_read_b128 a[208:211],v250 offset:512
v_cvt_pk_bf16_f32 v108,v108,v109
M v[44:47],a[232:235],a[212:215],v[44:47]
ds_read_b128 a[212:215],v250 offset:768
v_cvt_pk_bf16_f32 v109,v110,v111
M v[48:51],a[232:235],a[216:219],v[48:51]
ds_read_b128 a[216:219],v250 offset:1024
ds_write2st64_b64 v253,v[104:105],v[108:109] offset0:59 offset1:63
M v[52:55],a[232:235],a[220:223],v[52:55]
ds_read_b128 a[220:223],v250 offset:1280
v_cvt_pk_bf16_f32 v112,v112,v113
M v[56:59],a[232:235],a[192:195],v[56:59]
s_waitcnt lgkmcnt(9)
ds_read_b128 a[192:195],v250 offset:1536
v_cvt_pk_bf16_f32 v113,v114,v115
M v[60:63],a[232:235],a[196:199],v[60:63]
s_waitcnt vmcnt(16) lgkmcnt(7)
buffer_load_dwordx4 a[232:235],v251,s[20:23],s47 offen offset:2048 sc1
M v[32:35],a[236:239],a[200:203],v[32:35]
s_waitcnt lgkmcnt(6)
ds_read_b128 a[196:199],v250 offset:1792
ds_read_b128 a[200:203],v250 offset:2048
M v[36:39],a[236:239],a[204:207],v[36:39]
s_waitcnt lgkmcnt(7)
s_add_u32 s47,s81,3072
v_cvt_pk_bf16_f32 v116,v116,v117
v_cvt_pk_bf16_f32 v117,v118,v119
M v[40:43],a[236:239],a[208:211],v[40:43]
s_waitcnt lgkmcnt(6)
ds_write2st64_b64 v253,v[112:113],v[116:117] offset0:102 offset1:106
M v[44:47],a[236:239],a[212:215],v[44:47]
s_waitcnt lgkmcnt(6)
v_cvt_pk_bf16_f32 v120,v120,v121
v_cvt_pk_bf16_f32 v121,v122,v123
M v[48:51],a[236:239],a[216:219],v[48:51]
s_waitcnt lgkmcnt(4)
v_cvt_pk_bf16_f32 v124,v124,v125
v_cvt_pk_bf16_f32 v125,v126,v127
M v[52:55],a[236:239],a[220:223],v[52:55]
s_waitcnt lgkmcnt(3)
ds_write2st64_b64 v253,v[120:121],v[124:125] offset0:110 offset1:114
M v[56:59],a[236:239],a[192:195],v[56:59]
s_waitcnt lgkmcnt(3)
v_accvgpr_read_b32 v238,a64
v_accvgpr_read_b32 v232,a160
M v[60:63],a[236:239],a[196:199],v[60:63]
s_waitcnt vmcnt(16)
buffer_load_dwordx4 a[236:239],v251,s[20:23],s47 offen offset:0 sc1
M v[32:35],a[240:243],a[204:207],v[32:35]
ds_read_b128 a[204:207],v249 offset:2304
v_add_f32 v234,v238,v232
M v[36:39],a[240:243],a[208:211],v[36:39]
v_sub_f32 v238,v238,v232
v_add_f32 v232,v64,v160
M v[40:43],a[240:243],a[212:215],v[40:43]
v_sub_f32 v160,v64,v160
M v[44:47],a[240:243],a[216:219],v[44:47]
s_waitcnt lgkmcnt(1)
s_barrier
ds_read_b128 a[56:59],v251 offset:17408
M v[48:51],a[240:243],a[220:223],v[48:51]
ds_read_b128 a[60:63],v251 offset:21504
ds_read_b128 a[112:115],v251 offset:26112
M v[52:55],a[240:243],a[192:195],v[52:55]
ds_read_b128 a[116:119],v251 offset:30208
ds_read_b128 a[120:123],v251 offset:52224
M v[56:59],a[240:243],a[196:199],v[56:59]
ds_read_b128 a[124:127],v251 offset:56320
v_add_f32 v64,v234,v232
M v[60:63],a[240:243],a[200:203],v[60:63]
s_waitcnt vmcnt(16)
buffer_load_dwordx4 a[240:243],v251,s[20:23],s47 offen offset:1024 sc1
M v[32:35],a[244:247],a[208:211],v[32:35]
s_waitcnt lgkmcnt(5)
s_add_u32 s34,s32,1179648
buffer_store_dwordx4 a[56:59],v252,s[24:27],s34 offen offset:512 nt
M v[36:39],a[244:247],a[212:215],v[36:39]
ds_read_b128 a[208:211],v249 offset:17408
ds_read_b128 a[212:215],v250 offset:17664
M v[40:43],a[244:247],a[216:219],v[40:43]
ds_read_b128 a[216:219],v250 offset:17920
v_fmac_f32 v234,4.0,v232
M v[44:47],a[244:247],a[220:223],v[44:47]
ds_read_b128 a[220:223],v250 offset:18176
v_fma_f32 v232,2.0,v160,v238
M v[48:51],a[244:247],a[192:195],v[48:51]
ds_read_b128 a[192:195],v250 offset:18432
v_fma_f32 v160,s41,v160,v238
M v[52:55],a[244:247],a[196:199],v[52:55]
ds_read_b128 a[196:199],v250 offset:18688
v_accvgpr_read_b32 v238,a65
M v[56:59],a[244:247],a[200:203],v[56:59]
ds_read_b128 a[200:203],v250 offset:18944
v_accvgpr_read_b32 v237,a161
M v[60:63],a[244:247],a[204:207],v[60:63]
s_waitcnt vmcnt(17) lgkmcnt(6)
buffer_load_dwordx4 a[244:247],v251,s[20:23],s47 offen offset:2048 sc1
M v[32:35],a[248:251],a[208:211],v[32:35]
s_waitcnt lgkmcnt(5)
ds_read_b128 a[204:207],v250 offset:19200
ds_read_b128 a[208:211],v250 offset:19456
M v[36:39],a[248:251],a[212:215],v[36:39]
s_waitcnt lgkmcnt(6)
s_add_u32 s47,s76,49152
s_add_u32 s34,s32,1376256
v_add_f32 v236,v238,v237
M v[40:43],a[248:251],a[216:219],v[40:43]
s_waitcnt lgkmcnt(5)
buffer_store_dwordx4 a[60:63],v252,s[24:27],s34 offen offset:512 nt
M v[44:47],a[248:251],a[220:223],v[44:47]
s_waitcnt lgkmcnt(4)
v_sub_f32 v238,v238,v237
v_add_f32 v237,v65,v161
M v[48:51],a[248:251],a[192:195],v[48:51]
s_waitcnt lgkmcnt(3)
v_sub_f32 v161,v65,v161
v_add_f32 v65,v236,v237
M v[52:55],a[248:251],a[196:199],v[52:55]
s_waitcnt lgkmcnt(2)
v_fmac_f32 v236,4.0,v237
v_fma_f32 v237,2.0,v161,v238
M v[56:59],a[248:251],a[200:203],v[56:59]
s_waitcnt lgkmcnt(1)
v_fma_f32 v161,s41,v161,v238
v_cvt_pk_bf16_f32 v232,v232,v237
M v[60:63],a[248:251],a[204:207],v[60:63]
s_waitcnt vmcnt(18)
buffer_load_dwordx4 a[248:251],v251,s[20:23],s47 offen offset:0 sc1
M v[32:35],a[252:255],a[212:215],v[32:35]
ds_read_b128 a[212:215],v249 offset:19712
v_cvt_pk_bf16_f32 v234,v234,v236
M v[36:39],a[252:255],a[216:219],v[36:39]
v_accvgpr_read_b32 v238,a66
v_accvgpr_read_b32 v233,a162
M v[40:43],a[252:255],a[220:223],v[40:43]
v_add_f32 v235,v238,v233
v_sub_f32 v238,v238,v233
M v[44:47],a[252:255],a[192:195],v[44:47]
v_add_f32 v233,v66,v162
v_sub_f32 v162,v66,v162
M v[48:51],a[252:255],a[196:199],v[48:51]
v_add_f32 v66,v235,v233
v_fmac_f32 v235,4.0,v233
M v[52:55],a[252:255],a[200:203],v[52:55]
v_fma_f32 v233,2.0,v162,v238
v_fma_f32 v162,s41,v162,v238
M v[56:59],a[252:255],a[204:207],v[56:59]
s_waitcnt lgkmcnt(1)
v_accvgpr_read_b32 v238,a67
v_accvgpr_read_b32 v237,a163
M v[60:63],a[252:255],a[208:211],v[60:63]
s_waitcnt vmcnt(18)
buffer_load_dwordx4 a[252:255],v251,s[20:23],s47 offen offset:1024 sc1
M v[32:35],v[216:219],a[216:219],v[32:35]
ds_read_b128 a[216:219],v249 offset:34816
v_add_f32 v236,v238,v237
M v[36:39],v[216:219],a[220:223],v[36:39]
ds_read_b128 a[220:223],v250 offset:35072
v_sub_f32 v238,v238,v237
M v[40:43],v[216:219],a[192:195],v[40:43]
ds_read_b128 a[192:195],v250 offset:35328
v_add_f32 v237,v67,v163
M v[44:47],v[216:219],a[196:199],v[44:47]
ds_read_b128 a[196:199],v250 offset:35584
v_sub_f32 v163,v67,v163
M v[48:51],v[216:219],a[200:203],v[48:51]
ds_read_b128 a[200:203],v250 offset:35840
v_add_f32 v67,v236,v237
M v[52:55],v[216:219],a[204:207],v[52:55]
ds_read_b128 a[204:207],v250 offset:36096
v_fmac_f32 v236,4.0,v237
M v[56:59],v[216:219],a[208:211],v[56:59]
s_waitcnt lgkmcnt(6)
ds_read_b128 a[208:211],v250 offset:36352
v_fma_f32 v237,2.0,v163,v238
M v[60:63],v[216:219],a[212:215],v[60:63]
s_waitcnt vmcnt(13) lgkmcnt(6)
buffer_load_dwordx4 v[216:219],v251,s[20:23],s47 offen offset:2048 sc1
M v[32:35],v[220:223],a[216:219],v[32:35]
s_waitcnt lgkmcnt(5)
ds_read_b128 a[212:215],v250 offset:36608
ds_read_b128 a[216:219],v250 offset:36864
M v[36:39],v[220:223],a[220:223],v[36:39]
s_waitcnt lgkmcnt(6)
s_add_u32 s47,s77,49152
v_fma_f32 v163,s41,v163,v238
v_cvt_pk_bf16_f32 v233,v233,v237
M v[40:43],v[220:223],a[192:195],v[40:43]
s_waitcnt lgkmcnt(5)
s_add_u32 s34,s33,0
buffer_store_dwordx4 a[112:115],v252,s[24:27],s34 offen offset:1152 nt
M v[44:47],v[220:223],a[196:199],v[44:47]
s_waitcnt lgkmcnt(4)
v_cvt_pk_bf16_f32 v235,v235,v236
v_add_u32 v0,69632,v251
M v[48:51],v[220:223],a[200:203],v[48:51]
s_waitcnt lgkmcnt(3)
ds_write2st64_b64 v253,v[232:233],v[234:235] offset0:119 offset1:123
M v[52:55],v[220:223],a[204:207],v[52:55]
s_waitcnt lgkmcnt(3)
v_accvgpr_read_b32 v238,a68
v_accvgpr_read_b32 v232,a164
M v[56:59],v[220:223],a[208:211],v[56:59]
s_waitcnt lgkmcnt(2)
v_add_f32 v234,v238,v232
v_sub_f32 v238,v238,v232
M v[60:63],v[220:223],a[212:215],v[60:63]
s_waitcnt vmcnt(14)
buffer_load_dwordx4 v[220:223],v251,s[20:23],s47 offen offset:0 sc1
M v[32:35],v[224:227],a[220:223],v[32:35]
ds_read_b128 a[220:223],v249 offset:37120
v_add_f32 v232,v68,v164
M v[36:39],v[224:227],a[192:195],v[36:39]
v_sub_f32 v164,v68,v164
v_add_f32 v68,v234,v232
M v[40:43],v[224:227],a[196:199],v[40:43]
v_fmac_f32 v234,4.0,v232
v_fma_f32 v232,2.0,v164,v238
M v[44:47],v[224:227],a[200:203],v[44:47]
v_fma_f32 v164,s41,v164,v238
v_accvgpr_read_b32 v238,a69
M v[48:51],v[224:227],a[204:207],v[48:51]
v_accvgpr_read_b32 v237,a165
v_add_f32 v236,v238,v237
M v[52:55],v[224:227],a[208:211],v[52:55]
v_sub_f32 v238,v238,v237
v_add_f32 v237,v69,v165
M v[56:59],v[224:227],a[212:215],v[56:59]
s_waitcnt lgkmcnt(2)
v_sub_f32 v165,v69,v165
v_add_f32 v69,v236,v237
M v[60:63],v[224:227],a[216:219],v[60:63]
s_waitcnt vmcnt(14)
buffer_load_dwordx4 v[224:227],v251,s[20:23],s47 offen offset:1024 sc1
M v[32:35],v[228:231],a[192:195],v[32:35]
ds_read_b128 a[192:195],v249 offset:52224
v_fmac_f32 v236,4.0,v237
M v[36:39],v[228:231],a[196:199],v[36:39]
ds_read_b128 a[196:199],v250 offset:52480
v_fma_f32 v237,2.0,v165,v238
M v[40:43],v[228:231],a[200:203],v[40:43]
ds_read_b128 a[200:203],v250 offset:52736
v_fma_f32 v165,s41,v165,v238
M v[44:47],v[228:231],a[204:207],v[44:47]
ds_read_b128 a[204:207],v250 offset:52992
v_cvt_pk_bf16_f32 v232,v232,v237
M v[48:51],v[228:231],a[208:211],v[48:51]
ds_read_b128 a[208:211],v250 offset:53248
v_cvt_pk_bf16_f32 v234,v234,v236
M v[52:55],v[228:231],a[212:215],v[52:55]
ds_read_b128 a[212:215],v250 offset:53504
v_accvgpr_read_b32 v238,a70
M v[56:59],v[228:231],a[216:219],v[56:59]
s_waitcnt lgkmcnt(6)
ds_read_b128 a[216:219],v250 offset:53760
v_accvgpr_read_b32 v233,a166
M v[60:63],v[228:231],a[220:223],v[60:63]
s_waitcnt vmcnt(13) lgkmcnt(6)
buffer_load_dwordx4 v[228:231],v251,s[20:23],s47 offen offset:2048 sc1
M v[32:35],a[224:227],a[192:195],v[32:35]
s_waitcnt lgkmcnt(5)
ds_read_b128 a[220:223],v250 offset:54016
ds_read_b128 a[192:195],v250 offset:54272
M v[36:39],a[224:227],a[196:199],v[36:39]
s_waitcnt lgkmcnt(6)
s_add_u32 s47,s78,49152
v_add_f32 v235,v238,v233
v_sub_f32 v238,v238,v233
M v[40:43],a[224:227],a[200:203],v[40:43]
s_waitcnt lgkmcnt(5)
v_add_f32 v233,v70,v166
v_sub_f32 v166,v70,v166
M v[44:47],a[224:227],a[204:207],v[44:47]
s_waitcnt lgkmcnt(4)
s_add_u32 s34,s33,393216
buffer_store_dwordx4 a[116:119],v252,s[24:27],s34 offen offset:1152 nt
M v[48:51],a[224:227],a[208:211],v[48:51]
s_waitcnt lgkmcnt(3)
v_add_f32 v70,v235,v233
v_fmac_f32 v235,4.0,v233
M v[52:55],a[224:227],a[212:215],v[52:55]
s_waitcnt lgkmcnt(2)
v_fma_f32 v233,2.0,v166,v238
v_fma_f32 v166,s41,v166,v238
M v[56:59],a[224:227],a[216:219],v[56:59]
s_waitcnt lgkmcnt(1)
v_accvgpr_read_b32 v238,a71
v_accvgpr_read_b32 v237,a167
M v[60:63],a[224:227],a[220:223],v[60:63]
s_waitcnt vmcnt(14)
buffer_load_dwordx4 a[224:227],v251,s[20:23],s47 offen offset:0 sc1
M v[32:35],a[228:231],a[196:199],v[32:35]
ds_read_b128 a[196:199],v249 offset:54528
v_add_f32 v236,v238,v237
M v[36:39],a[228:231],a[200:203],v[36:39]
v_sub_f32 v238,v238,v237
v_add_f32 v237,v71,v167
M v[40:43],a[228:231],a[204:207],v[40:43]
v_sub_f32 v167,v71,v167
v_add_f32 v71,v236,v237
M v[44:47],a[228:231],a[208:211],v[44:47]
v_fmac_f32 v236,4.0,v237
v_fma_f32 v237,2.0,v167,v238
M v[48:51],a[228:231],a[212:215],v[48:51]
v_fma_f32 v167,s41,v167,v238
v_cvt_pk_bf16_f32 v233,v233,v237
M v[52:55],a[228:231],a[216:219],v[52:55]
v_add_u32 v249,0xfffece00,v249
v_add_u32 v250,0xfffece00,v250
M v[56:59],a[228:231],a[220:223],v[56:59]
s_waitcnt lgkmcnt(1)
v_cvt_pk_bf16_f32 v235,v235,v236
M v[60:63],a[228:231],a[192:195],v[60:63]
s_waitcnt vmcnt(14)
buffer_load_dwordx4 a[228:231],v251,s[20:23],s47 offen offset:1024 sc1
M v[32:35],a[232:235],a[200:203],v[32:35]
ds_read_b128 a[200:203],v249 offset:60928
ds_write2st64_b64 v253,v[232:233],v[234:235] offset0:127 offset1:131
M v[36:39],a[232:235],a[204:207],v[36:39]
ds_read_b128 a[204:207],v250 offset:61184
v_accvgpr_read_b32 v238,a72
M v[40:43],a[232:235],a[208:211],v[40:43]
ds_read_b128 a[208:211],v250 offset:61440
v_accvgpr_read_b32 v232,a168
M v[44:47],a[232:235],a[212:215],v[44:47]
ds_read_b128 a[212:215],v250 offset:61696
v_add_f32 v234,v238,v232
M v[48:51],a[232:235],a[216:219],v[48:51]
ds_read_b128 a[216:219],v250 offset:61952
v_sub_f32 v238,v238,v232
M v[52:55],a[232:235],a[220:223],v[52:55]
ds_read_b128 a[220:223],v250 offset:62208
v_add_f32 v232,v72,v168
M v[56:59],a[232:235],a[192:195],v[56:59]
s_waitcnt lgkmcnt(7)
ds_read_b128 a[192:195],v250 offset:62464
v_sub_f32 v168,v72,v168
M v[60:63],a[232:235],a[196:199],v[60:63]
s_waitcnt vmcnt(14) lgkmcnt(7)
buffer_load_dwordx4 a[232:235],v251,s[20:23],s47 offen offset:2048 sc1
M v[32:35],a[236:239],a[200:203],v[32:35]
s_waitcnt lgkmcnt(5)
ds_read_b128 a[196:199],v250 offset:62720
ds_read_b128 a[200:203],v250 offset:62976
M v[36:39],a[236:239],a[204:207],v[36:39]
s_waitcnt lgkmcnt(6)
s_add_u32 s47,s79,49152
v_add_f32 v72,v234,v232
v_fmac_f32 v234,4.0,v232
M v[40:43],a[236:239],a[208:211],v[40:43]
s_waitcnt lgkmcnt(5)
v_fma_f32 v232,2.0,v168,v238
v_fma_f32 v168,s41,v168,v238
M v[44:47],a[236:239],a[212:215],v[44:47]
s_waitcnt lgkmcnt(4)
v_accvgpr_read_b32 v238,a73
v_accvgpr_read_b32 v237,a169
M v[48:51],a[236:239],a[216:219],v[48:51]
s_waitcnt lgkmcnt(3)
s_add_u32 s34,s33,786432
buffer_store_dwordx4 a[120:123],v252,s[24:27],s34 offen offset:1152 nt
M v[52:55],a[236:239],a[220:223],v[52:55]
s_waitcnt lgkmcnt(2)
v_add_f32 v236,v238,v237
v_sub_f32 v238,v238,v237
M v[56:59],a[236:239],a[192:195],v[56:59]
s_waitcnt lgkmcnt(1)
v_add_f32 v237,v73,v169
v_sub_f32 v169,v73,v169
M v[60:63],a[236:239],a[196:199],v[60:63]
s_waitcnt vmcnt(15)
buffer_load_dwordx4 a[236:239],v251,s[20:23],s47 offen offset:0 sc1
M v[32:35],a[240:243],a[204:207],v[32:35]
ds_read_b128 a[204:207],v249 offset:63232
v_add_f32 v73,v236,v237
M v[36:39],a[240:243],a[208:211],v[36:39]
v_fmac_f32 v236,4.0,v237
v_fma_f32 v237,2.0,v169,v238
M v[40:43],a[240:243],a[212:215],v[40:43]
v_fma_f32 v169,s41,v169,v238
v_cvt_pk_bf16_f32 v232,v232,v237
M v[44:47],a[240:243],a[216:219],v[44:47]
v_cvt_pk_bf16_f32 v234,v234,v236
v_accvgpr_read_b32 v238,a74
M v[48:51],a[240:243],a[220:223],v[48:51]
v_accvgpr_read_b32 v233,a170
v_add_f32 v235,v238,v233
M v[52:55],a[240:243],a[192:195],v[52:55]
v_sub_f32 v238,v238,v233
v_add_f32 v233,v74,v170
M v[56:59],a[240:243],a[196:199],v[56:59]
s_waitcnt lgkmcnt(1)
v_sub_f32 v170,v74,v170
v_add_f32 v74,v235,v233
M v[60:63],a[240:243],a[200:203],v[60:63]
s_waitcnt vmcnt(14)
buffer_load_dwordx4 a[240:243],v251,s[20:23],s47 offen offset:1024 sc1
M v[32:35],a[244:247],a[208:211],v[32:35]
ds_read_b128 a[208:211],v249 offset:0
v_fmac_f32 v235,4.0,v233
M v[36:39],a[244:247],a[212:215],v[36:39]
ds_read_b128 a[212:215],v250 offset:256
v_fma_f32 v233,2.0,v170,v238
M v[40:43],a[244:247],a[216:219],v[40:43]
ds_read_b128 a[216:219],v250 offset:512
v_fma_f32 v170,s41,v170,v238
M v[44:47],a[244:247],a[220:223],v[44:47]
ds_read_b128 a[220:223],v250 offset:768
v_accvgpr_read_b32 v238,a75
M v[48:51],a[244:247],a[192:195],v[48:51]
ds_read_b128 a[192:195],v250 offset:1024
v_accvgpr_read_b32 v237,a171
M v[52:55],a[244:247],a[196:199],v[52:55]
ds_read_b128 a[196:199],v250 offset:1280
v_add_f32 v236,v238,v237
M v[56:59],a[244:247],a[200:203],v[56:59]
s_waitcnt lgkmcnt(6)
ds_read_b128 a[200:203],v250 offset:1536
v_sub_f32 v238,v238,v237
M v[60:63],a[244:247],a[204:207],v[60:63]
s_waitcnt vmcnt(13) lgkmcnt(6)
buffer_load_dwordx4 a[244:247],v251,s[20:23],s47 offen offset:2048 sc1
M v[128:131],a[248:251],a[208:211],v[128:131]
s_waitcnt lgkmcnt(5)
ds_read_b128 a[204:207],v250 offset:1792
ds_read_b128 a[208:211],v250 offset:2048
M v[132:135],a[248:251],a[212:215],v[132:135]
s_waitcnt lgkmcnt(6)
s_add_u32 s47,s80,49152
v_add_f32 v237,v75,v171
v_sub_f32 v171,v75,v171
M v[136:139],a[248:251],a[216:219],v[136:139]
s_waitcnt lgkmcnt(5)
v_add_f32 v75,v236,v237
v_fmac_f32 v236,4.0,v237
M v[140:143],a[248:251],a[220:223],v[140:143]
s_waitcnt lgkmcnt(4)
v_fma_f32 v237,2.0,v171,v238
v_fma_f32 v171,s41,v171,v238
M v[144:147],a[248:251],a[192:195],v[144:147]
s_waitcnt lgkmcnt(3)
v_cvt_pk_bf16_f32 v233,v233,v237
v_cvt_pk_bf16_f32 v235,v235,v236
M v[148:151],a[248:251],a[196:199],v[148:151]
s_waitcnt lgkmcnt(2)
s_add_u32 s34,s33,1179648
buffer_store_dwordx4 a[124:127],v252,s[24:27],s34 offen offset:1152 nt
M v[152:155],a[248:251],a[200:203],v[152:155]
s_waitcnt lgkmcnt(1)
ds_write2st64_b64 v253,v[232:233],v[234:235] offset0:68 offset1:72
M v[156:159],a[248:251],a[204:207],v[156:159]
s_waitcnt vmcnt(14)
buffer_load_dwordx4 a[248:251],v251,s[20:23],s47 offen offset:0 sc1
M v[128:131],a[252:255],a[212:215],v[128:131]
ds_read_b128 a[212:215],v249 offset:2304
v_accvgpr_read_b32 v238,a76
M v[132:135],a[252:255],a[216:219],v[132:135]
v_accvgpr_read_b32 v232,a172
v_add_f32 v234,v238,v232
M v[136:139],a[252:255],a[220:223],v[136:139]
v_sub_f32 v238,v238,v232
v_add_f32 v232,v76,v172
M v[140:143],a[252:255],a[192:195],v[140:143]
v_sub_f32 v172,v76,v172
v_add_f32 v76,v234,v232
M v[144:147],a[252:255],a[196:199],v[144:147]
v_fmac_f32 v234,4.0,v232
v_fma_f32 v232,2.0,v172,v238
M v[148:151],a[252:255],a[200:203],v[148:151]
v_add_u32 v249,0x15400,v249
v_add_u32 v250,0x15400,v250
M v[152:155],a[252:255],a[204:207],v[152:155]
s_waitcnt lgkmcnt(2)
v_fma_f32 v172,s41,v172,v238
v_accvgpr_read_b32 v238,a77
M v[156:159],a[252:255],a[208:211],v[156:159]
s_waitcnt vmcnt(14)
buffer_load_dwordx4 a[252:255],v251,s[20:23],s47 offen offset:1024 sc1
M v[128:131],v[216:219],a[216:219],v[128:131]
ds_read_b128 a[216:219],v249 offset:0
v_accvgpr_read_b32 v237,a173
M v[132:135],v[216:219],a[220:223],v[132:135]
ds_read_b128 a[220:223],v250 offset:256
v_add_f32 v236,v238,v237
M v[136:139],v[216:219],a[192:195],v[136:139]
ds_read_b128 a[192:195],v250 offset:512
v_sub_f32 v238,v238,v237
M v[140:143],v[216:219],a[196:199],v[140:143]
ds_read_b128 a[196:199],v250 offset:768
v_add_f32 v237,v77,v173
M v[144:147],v[216:219],a[200:203],v[144:147]
ds_read_b128 a[200:203],v250 offset:1024
v_sub_f32 v173,v77,v173
M v[148:151],v[216:219],a[204:207],v[148:151]
ds_read_b128 a[204:207],v250 offset:1280
v_add_f32 v77,v236,v237
M v[152:155],v[216:219],a[208:211],v[152:155]
s_waitcnt lgkmcnt(6)
ds_read_b128 a[208:211],v250 offset:1536
v_fmac_f32 v236,4.0,v237
M v[156:159],v[216:219],a[212:215],v[156:159]
s_waitcnt vmcnt(13) lgkmcnt(6)
buffer_load_dwordx4 v[216:219],v251,s[20:23],s47 offen offset:2048 sc1
M v[128:131],v[220:223],a[216:219],v[128:131]
s_waitcnt lgkmcnt(5)
ds_read_b128 a[212:215],v250 offset:1792
ds_read_b128 a[216:219],v250 offset:2048
M v[132:135],v[220:223],a[220:223],v[132:135]
s_waitcnt lgkmcnt(6)
s_add_u32 s47,s81,49152
v_fma_f32 v237,2.0,v173,v238
v_fma_f32 v173,s41,v173,v238
M v[136:139],v[220:223],a[192:195],v[136:139]
s_waitcnt lgkmcnt(5)
v_cvt_pk_bf16_f32 v232,v232,v237
v_cvt_pk_bf16_f32 v234,v234,v236
M v[140:143],v[220:223],a[196:199],v[140:143]
s_waitcnt lgkmcnt(4)
v_accvgpr_read_b32 v238,a78
v_accvgpr_read_b32 v233,a174
M v[144:147],v[220:223],a[200:203],v[144:147]
s_waitcnt lgkmcnt(3)
v_add_f32 v235,v238,v233
v_sub_f32 v238,v238,v233
M v[148:151],v[220:223],a[204:207],v[148:151]
s_waitcnt lgkmcnt(2)
v_add_f32 v233,v78,v174
v_sub_f32 v174,v78,v174
M v[152:155],v[220:223],a[208:211],v[152:155]
s_waitcnt lgkmcnt(1)
v_add_f32 v78,v235,v233
v_fmac_f32 v235,4.0,v233
M v[156:159],v[220:223],a[212:215],v[156:159]
s_waitcnt vmcnt(13)
buffer_load_dwordx4 v[220:223],v251,s[20:23],s47 offen offset:0 sc1
M v[128:131],v[224:227],a[220:223],v[128:131]
ds_read_b128 a[220:223],v249 offset:2304
v_fma_f32 v233,2.0,v174,v238
M v[132:135],v[224:227],a[192:195],v[132:135]
v_fma_f32 v174,s41,v174,v238
v_accvgpr_read_b32 v238,a79
M v[136:139],v[224:227],a[196:199],v[136:139]
v_accvgpr_read_b32 v237,a175
v_add_f32 v236,v238,v237
M v[140:143],v[224:227],a[200:203],v[140:143]
v_sub_f32 v238,v238,v237
v_add_f32 v237,v79,v175
M v[144:147],v[224:227],a[204:207],v[144:147]
v_sub_f32 v175,v79,v175
v_add_f32 v79,v236,v237
M v[148:151],v[224:227],a[208:211],v[148:151]
v_fmac_f32 v236,4.0,v237
v_fma_f32 v237,2.0,v175,v238
M v[152:155],v[224:227],a[212:215],v[152:155]
s_waitcnt lgkmcnt(1)
v_fma_f32 v175,s41,v175,v238
v_cvt_pk_bf16_f32 v233,v233,v237
M v[156:159],v[224:227],a[216:219],v[156:159]
s_waitcnt vmcnt(13)
buffer_load_dwordx4 v[224:227],v251,s[20:23],s47 offen offset:1024 sc1
M v[128:131],v[228:231],a[192:195],v[128:131]
ds_read_b128 a[192:195],v249 offset:17408
v_cvt_pk_bf16_f32 v235,v235,v236
M v[132:135],v[228:231],a[196:199],v[132:135]
ds_read_b128 a[196:199],v250 offset:17664
ds_write2st64_b64 v253,v[232:233],v[234:235] offset0:76 offset1:80
M v[136:139],v[228:231],a[200:203],v[136:139]
ds_read_b128 a[200:203],v250 offset:17920
v_cvt_pk_bf16_f32 v32,v32,v33
M v[140:143],v[228:231],a[204:207],v[140:143]
ds_read_b128 a[204:207],v250 offset:18176
v_cvt_pk_bf16_f32 v33,v34,v35
M v[144:147],v[228:231],a[208:211],v[144:147]
ds_read_b128 a[208:211],v250 offset:18432
v_cvt_pk_bf16_f32 v36,v36,v37
M v[148:151],v[228:231],a[212:215],v[148:151]
ds_read_b128 a[212:215],v250 offset:18688
v_cvt_pk_bf16_f32 v37,v38,v39
M v[152:155],v[228:231],a[216:219],v[152:155]
s_waitcnt lgkmcnt(4)
s_barrier
ds_read_b128 a[64:67],v251 offset:60928
M v[156:159],v[228:231],a[220:223],v[156:159]
s_waitcnt vmcnt(12)
ds_read_b128 a[68:71],v251 offset:65024
ds_read_b128 a[72:75],v251 offset:34816
M v[128:131],a[224:227],a[192:195],v[128:131]
ds_read_b128 a[76:79],v251 offset:38912
buffer_load_dwordx4 v[228:231],v251,s[20:23],s47 offen offset:2048 sc1
M v[132:135],a[224:227],a[196:199],v[132:135]
s_waitcnt lgkmcnt(7)
s_add_u32 s48,s76,6144
ds_read_b128 a[216:219],v250 offset:18944
ds_read_b128 a[220:223],v250 offset:19200
M v[136:139],a[224:227],a[200:203],v[136:139]
s_waitcnt lgkmcnt(8)
ds_read_b128 a[192:195],v250 offset:19456
ds_write2st64_b64 v253,v[32:33],v[36:37] offset0:34 offset1:38
M v[140:143],a[224:227],a[204:207],v[140:143]
s_waitcnt lgkmcnt(7)
s_add_u32 s34,s32,0
buffer_store_dwordx4 a[64:67],v252,s[24:27],s34 offen offset:640 nt
M v[144:147],a[224:227],a[208:211],v[144:147]
v_cvt_pk_bf16_f32 v40,v40,v41
v_cvt_pk_bf16_f32 v41,v42,v43
M v[148:151],a[224:227],a[212:215],v[148:151]
s_waitcnt lgkmcnt(3)
v_cvt_pk_bf16_f32 v44,v44,v45
v_cvt_pk_bf16_f32 v45,v46,v47
M v[152:155],a[224:227],a[216:219],v[152:155]
s_waitcnt lgkmcnt(2)
ds_write2st64_b64 v253,v[40:41],v[44:45] offset0:42 offset1:46
M v[156:159],a[224:227],a[220:223],v[156:159]
s_waitcnt vmcnt(13)
s_add_u32 s34,s32,196608
buffer_load_dwordx4 a[224:227],v251,s[20:23],s48 offen offset:0 sc1
M v[128:131],a[228:231],a[196:199],v[128:131]
buffer_store_dwordx4 a[68:71],v252,s[24:27],s34 offen offset:640 nt
M v[132:135],a[228:231],a[200:203],v[132:135]
ds_read_b128 a[196:199],v249 offset:19712
v_cvt_pk_bf16_f32 v48,v48,v49
M v[136:139],a[228:231],a[204:207],v[136:139]
v_cvt_pk_bf16_f32 v49,v50,v51
v_cvt_pk_bf16_f32 v52,v52,v53
M v[140:143],a[228:231],a[208:211],v[140:143]
v_cvt_pk_bf16_f32 v53,v54,v55
M v[144:147],a[228:231],a[212:215],v[144:147]
ds_write2st64_b64 v253,v[48:49],v[52:53] offset0:51 offset1:55
M v[148:151],a[228:231],a[216:219],v[148:151]
v_cvt_pk_bf16_f32 v56,v56,v57
v_cvt_pk_bf16_f32 v57,v58,v59
M v[152:155],a[228:231],a[220:223],v[152:155]
s_waitcnt lgkmcnt(4)
v_cvt_pk_bf16_f32 v60,v60,v61
v_cvt_pk_bf16_f32 v61,v62,v63
M v[156:159],a[228:231],a[192:195],v[156:159]
s_waitcnt vmcnt(14)
buffer_load_dwordx4 a[228:231],v251,s[20:23],s48 offen offset:1024 sc1
M v[128:131],a[232:235],a[200:203],v[128:131]
ds_read_b128 a[200:203],v249 offset:34816
ds_write2st64_b64 v253,v[56:57],v[60:61] offset0:59 offset1:63
M v[132:135],a[232:235],a[204:207],v[132:135]
ds_read_b128 a[204:207],v250 offset:35072
v_accvgpr_read_b32 v238,a80
M v[136:139],a[232:235],a[208:211],v[136:139]
ds_read_b128 a[208:211],v250 offset:35328
v_accvgpr_read_b32 v232,a176
M v[140:143],a[232:235],a[212:215],v[140:143]
ds_read_b128 a[212:215],v250 offset:35584
v_add_f32 v234,v238,v232
M v[144:147],a[232:235],a[216:219],v[144:147]
ds_read_b128 a[216:219],v250 offset:35840
v_sub_f32 v238,v238,v232
M v[148:151],a[232:235],a[220:223],v[148:151]
ds_read_b128 a[220:223],v250 offset:36096
v_add_f32 v232,v80,v176
M v[152:155],a[232:235],a[192:195],v[152:155]
s_waitcnt lgkmcnt(8)
ds_read_b128 a[192:195],v250 offset:36352
v_sub_f32 v176,v80,v176
M v[156:159],a[232:235],a[196:199],v[156:159]
s_waitcnt vmcnt(13) lgkmcnt(7)
buffer_load_dwordx4 a[232:235],v251,s[20:23],s48 offen offset:2048 sc1
M v[128:131],a[236:239],a[200:203],v[128:131]
s_waitcnt lgkmcnt(5)
ds_read_b128 a[196:199],v250 offset:36608
ds_read_b128 a[200:203],v250 offset:36864
M v[132:135],a[236:239],a[204:207],v[132:135]
s_waitcnt lgkmcnt(6)
s_add_u32 s48,s77,6144
v_add_f32 v80,v234,v232
v_fmac_f32 v234,4.0,v232
M v[136:139],a[236:239],a[208:211],v[136:139]
s_waitcnt lgkmcnt(5)
v_fma_f32 v232,2.0,v176,v238
v_fma_f32 v176,s41,v176,v238
M v[140:143],a[236:239],a[212:215],v[140:143]
s_waitcnt lgkmcnt(4)
v_accvgpr_read_b32 v238,a81
v_accvgpr_read_b32 v237,a177
M v[144:147],a[236:239],a[216:219],v[144:147]
s_waitcnt lgkmcnt(3)
v_add_f32 v236,v238,v237
v_sub_f32 v238,v238,v237
M v[148:151],a[236:239],a[220:223],v[148:151]
s_waitcnt lgkmcnt(2)
v_add_f32 v237,v81,v177
v_sub_f32 v177,v81,v177
M v[152:155],a[236:239],a[192:195],v[152:155]
s_waitcnt lgkmcnt(1)
v_add_f32 v81,v236,v237
v_fmac_f32 v236,4.0,v237
M v[156:159],a[236:239],a[196:199],v[156:159]
s_waitcnt vmcnt(13)
buffer_load_dwordx4 a[236:239],v251,s[20:23],s48 offen offset:0 sc1
M v[128:131],a[240:243],a[204:207],v[128:131]
s_add_u32 s34,s32,393216
buffer_store_dwordx4 a[72:75],v252,s[24:27],s34 offen offset:640 nt
M v[132:135],a[240:243],a[208:211],v[132:135]
ds_read_b128 a[204:207],v249 offset:37120
v_fma_f32 v237,2.0,v177,v238
M v[136:139],a[240:243],a[212:215],v[136:139]
v_fma_f32 v177,s41,v177,v238
v_cvt_pk_bf16_f32 v232,v232,v237
M v[140:143],a[240:243],a[216:219],v[140:143]
v_cvt_pk_bf16_f32 v234,v234,v236
v_accvgpr_read_b32 v238,a82
M v[144:147],a[240:243],a[220:223],v[144:147]
v_accvgpr_read_b32 v233,a178
v_add_f32 v235,v238,v233
M v[148:151],a[240:243],a[192:195],v[148:151]
v_sub_f32 v238,v238,v233
v_add_f32 v233,v82,v178
M v[152:155],a[240:243],a[196:199],v[152:155]
s_waitcnt lgkmcnt(1)
v_sub_f32 v178,v82,v178
v_add_f32 v82,v235,v233
M v[156:159],a[240:243],a[200:203],v[156:159]
s_waitcnt vmcnt(14)
buffer_load_dwordx4 a[240:243],v251,s[20:23],s48 offen offset:1024 sc1
M v[128:131],a[244:247],a[208:211],v[128:131]
ds_read_b128 a[208:211],v249 offset:52224
v_fmac_f32 v235,4.0,v233
M v[132:135],a[244:247],a[212:215],v[132:135]
ds_read_b128 a[212:215],v250 offset:52480
v_fma_f32 v233,2.0,v178,v238
M v[136:139],a[244:247],a[216:219],v[136:139]
ds_read_b128 a[216:219],v250 offset:52736
v_fma_f32 v178,s41,v178,v238
M v[140:143],a[244:247],a[220:223],v[140:143]
ds_read_b128 a[220:223],v250 offset:52992
v_accvgpr_read_b32 v238,a83
M v[144:147],a[244:247],a[192:195],v[144:147]
ds_read_b128 a[192:195],v250 offset:53248
v_accvgpr_read_b32 v237,a179
M v[148:151],a[244:247],a[196:199],v[148:151]
ds_read_b128 a[196:199],v250 offset:53504
v_add_f32 v236,v238,v237
M v[152:155],a[244:247],a[200:203],v[152:155]
s_waitcnt lgkmcnt(6)
ds_read_b128 a[200:203],v250 offset:53760
v_sub_f32 v238,v238,v237
M v[156:159],a[244:247],a[204:207],v[156:159]
s_waitcnt vmcnt(13) lgkmcnt(6)
buffer_load_dwordx4 a[244:247],v251,s[20:23],s48 offen offset:2048 sc1
M v[128:131],a[248:251],a[208:211],v[128:131]
s_waitcnt lgkmcnt(5)
ds_read_b128 a[204:207],v250 offset:54016
ds_read_b128 a[208:211],v250 offset:54272
M v[132:135],a[248:251],a[212:215],v[132:135]
s_waitcnt lgkmcnt(6)
s_add_u32 s48,s78,6144
v_add_f32 v237,v83,v179
v_sub_f32 v179,v83,v179
M v[136:139],a[248:251],a[216:219],v[136:139]
s_waitcnt lgkmcnt(5)
v_add_f32 v83,v236,v237
v_fmac_f32 v236,4.0,v237
M v[140:143],a[248:251],a[220:223],v[140:143]
s_waitcnt lgkmcnt(4)
v_fma_f32 v237,2.0,v179,v238
v_fma_f32 v179,s41,v179,v238
M v[144:147],a[248:251],a[192:195],v[144:147]
s_waitcnt lgkmcnt(3)
v_cvt_pk_bf16_f32 v233,v233,v237
v_cvt_pk_bf16_f32 v235,v235,v236
M v[148:151],a[248:251],a[196:199],v[148:151]
s_waitcnt lgkmcnt(2)
ds_write2st64_b64 v253,v[232:233],v[234:235] offset0:102 offset1:106
M v[152:155],a[248:251],a[200:203],v[152:155]
s_waitcnt lgkmcnt(2)
v_accvgpr_read_b32 v238,a84
v_accvgpr_read_b32 v232,a180
M v[156:159],a[248:251],a[204:207],v[156:159]
s_waitcnt vmcnt(13)
buffer_load_dwordx4 a[248:251],v251,s[20:23],s48 offen offset:0 sc1
M v[128:131],a[252:255],a[212:215],v[128:131]
ds_read_b128 a[212:215],v249 offset:54528
v_add_f32 v234,v238,v232
M v[132:135],a[252:255],a[216:219],v[132:135]
s_add_u32 s34,s32,589824
buffer_store_dwordx4 a[76:79],v252,s[24:27],s34 offen offset:640 nt
M v[136:139],a[252:255],a[220:223],v[136:139]
v_sub_f32 v238,v238,v232
v_add_f32 v232,v84,v180
M v[140:143],a[252:255],a[192:195],v[140:143]
v_sub_f32 v180,v84,v180
v_add_f32 v84,v234,v232
M v[144:147],a[252:255],a[196:199],v[144:147]
v_fmac_f32 v234,4.0,v232
v_fma_f32 v232,2.0,v180,v238
M v[148:151],a[252:255],a[200:203],v[148:151]
v_add_u32 v249,0xffffbc00,v249
v_add_u32 v250,0xffffbc00,v250
M v[152:155],a[252:255],a[204:207],v[152:155]
s_waitcnt lgkmcnt(2)
v_fma_f32 v180,s41,v180,v238
v_accvgpr_read_b32 v238,a85
M v[156:159],a[252:255],a[208:211],v[156:159]
s_waitcnt vmcnt(14)
buffer_load_dwordx4 a[252:255],v251,s[20:23],s48 offen offset:1024 sc1
M v[128:131],v[216:219],a[216:219],v[128:131]
ds_read_b128 a[216:219],v249 offset:0
v_accvgpr_read_b32 v237,a181
M v[132:135],v[216:219],a[220:223],v[132:135]
ds_read_b128 a[220:223],v250 offset:256
v_add_f32 v236,v238,v237
M v[136:139],v[216:219],a[192:195],v[136:139]
ds_read_b128 a[192:195],v250 offset:512
v_sub_f32 v238,v238,v237
M v[140:143],v[216:219],a[196:199],v[140:143]
ds_read_b128 a[196:199],v250 offset:768
v_add_f32 v237,v85,v181
M v[144:147],v[216:219],a[200:203],v[144:147]
ds_read_b128 a[200:203],v250 offset:1024
v_sub_f32 v181,v85,v181
M v[148:151],v[216:219],a[204:207],v[148:151]
ds_read_b128 a[204:207],v250 offset:1280
v_add_f32 v85,v236,v237
M v[152:155],v[216:219],a[208:211],v[152:155]
s_waitcnt lgkmcnt(6)
ds_read_b128 a[208:211],v250 offset:1536
v_fmac_f32 v236,4.0,v237
v_fma_f32 v237,2.0,v181,v238
v_fma_f32 v181,s41,v181,v238
v_cvt_pk_bf16_f32 v232,v232,v237
M v[156:159],v[216:219],a[212:215],v[156:159]
s_waitcnt vmcnt(14) lgkmcnt(6)
buffer_load_dwordx4 v[216:219],v251,s[20:23],s48 offen offset:2048 sc1
v_cvt_pk_bf16_f32 v234,v234,v236
v_accvgpr_read_b32 v238,a86
v_accvgpr_read_b32 v233,a182
v_add_f32 v235,v238,v233
M v[128:131],v[220:223],a[216:219],v[128:131]
s_waitcnt lgkmcnt(5)
ds_read_b128 a[212:215],v250 offset:1792
ds_read_b128 a[216:219],v250 offset:2048
v_sub_f32 v238,v238,v233
v_add_f32 v233,v86,v182
v_sub_f32 v182,v86,v182
v_add_f32 v86,v235,v233
M v[132:135],v[220:223],a[220:223],v[132:135]
s_waitcnt lgkmcnt(6)
s_add_u32 s48,s79,6144
v_fmac_f32 v235,4.0,v233
v_fma_f32 v233,2.0,v182,v238
v_fma_f32 v182,s41,v182,v238
v_accvgpr_read_b32 v238,a87
M v[136:139],v[220:223],a[192:195],v[136:139]
s_waitcnt lgkmcnt(5)
v_accvgpr_read_b32 v237,a183
v_add_f32 v236,v238,v237
v_sub_f32 v238,v238,v237
v_add_f32 v237,v87,v183
M v[140:143],v[220:223],a[196:199],v[140:143]
s_waitcnt lgkmcnt(4)
v_sub_f32 v183,v87,v183
v_add_f32 v87,v236,v237
v_fmac_f32 v236,4.0,v237
v_fma_f32 v237,2.0,v183,v238
M v[144:147],v[220:223],a[200:203],v[144:147]
s_waitcnt lgkmcnt(3)
v_fma_f32 v183,s41,v183,v238
v_cvt_pk_bf16_f32 v233,v233,v237
v_cvt_pk_bf16_f32 v235,v235,v236
M v[148:151],v[220:223],a[204:207],v[148:151]
s_waitcnt lgkmcnt(2)
ds_write2st64_b64 v253,v[232:233],v[234:235] offset0:110 offset1:114
M v[152:155],v[220:223],a[208:211],v[152:155]
s_waitcnt lgkmcnt(2)
v_accvgpr_read_b32 v238,a88
v_accvgpr_read_b32 v232,a184
M v[156:159],v[220:223],a[212:215],v[156:159]
s_waitcnt vmcnt(14)
buffer_load_dwordx4 v[220:223],v251,s[20:23],s48 offen offset:0 sc1
v_add_f32 v234,v238,v232
v_sub_f32 v238,v238,v232
v_add_f32 v232,v88,v184
v_sub_f32 v184,v88,v184
M v[128:131],v[224:227],a[220:223],v[128:131]
s_waitcnt lgkmcnt(0)
s_barrier
ds_read_b128 v[32:35],v251 offset:17408
v_add_f32 v88,v234,v232
v_fmac_f32 v234,4.0,v232
v_fma_f32 v232,2.0,v184,v238
M v[132:135],v[224:227],a[192:195],v[132:135]
ds_read_b128 v[40:43],v251 offset:21504
ds_read_b128 v[48:51],v251 offset:26112
v_fma_f32 v184,s41,v184,v238
v_accvgpr_read_b32 v238,a89
v_accvgpr_read_b32 v237,a185
v_add_f32 v236,v238,v237
M v[136:139],v[224:227],a[196:199],v[136:139]
ds_read_b128 v[56:59],v251 offset:30208
ds_read_b128 a[80:83],v251 offset:52224
v_sub_f32 v238,v238,v237
v_add_f32 v237,v89,v185
v_sub_f32 v185,v89,v185
v_add_f32 v89,v236,v237
M v[140:143],v[224:227],a[200:203],v[140:143]
ds_read_b128 a[84:87],v251 offset:56320
ds_read_b128 a[220:223],v249 offset:2304
v_fmac_f32 v236,4.0,v237
v_fma_f32 v237,2.0,v185,v238
v_fma_f32 v185,s41,v185,v238
v_cvt_pk_bf16_f32 v232,v232,v237
M v[144:147],v[224:227],a[204:207],v[144:147]
v_cvt_pk_bf16_f32 v234,v234,v236
v_accvgpr_read_b32 v238,a90
v_accvgpr_read_b32 v233,a186
v_add_f32 v235,v238,v233
M v[148:151],v[224:227],a[208:211],v[148:151]
s_waitcnt lgkmcnt(6)
s_add_u32 s34,s33,0
buffer_store_dwordx4 v[32:35],v252,s[24:27],s34 offen offset:128 nt
v_sub_f32 v238,v238,v233
v_add_f32 v233,v90,v186
v_sub_f32 v186,v90,v186
v_add_f32 v90,v235,v233
M v[152:155],v[224:227],a[212:215],v[152:155]
v_add_u32 v249,0xfffece00,v249
v_add_u32 v250,0xfffece00,v250
v_fmac_f32 v235,4.0,v233
v_fma_f32 v233,2.0,v186,v238
v_fma_f32 v186,s41,v186,v238
v_accvgpr_read_b32 v238,a91
M v[156:159],v[224:227],a[216:219],v[156:159]
s_waitcnt vmcnt(15)
buffer_load_dwordx4 v[224:227],v251,s[20:23],s48 offen offset:1024 sc1
v_accvgpr_read_b32 v237,a187
v_add_f32 v236,v238,v237
v_sub_f32 v238,v238,v237
v_add_f32 v237,v91,v187
M v[128:131],v[228:231],a[192:195],v[128:131]
ds_read_b128 a[192:195],v249 offset:0
v_sub_f32 v187,v91,v187
v_add_f32 v91,v236,v237
v_fmac_f32 v236,4.0,v237
v_fma_f32 v237,2.0,v187,v238
M v[132:135],v[228:231],a[196:199],v[132:135]
ds_read_b128 a[196:199],v250 offset:256
v_fma_f32 v187,s41,v187,v238
v_cvt_pk_bf16_f32 v233,v233,v237
v_cvt_pk_bf16_f32 v235,v235,v236
M v[136:139],v[228:231],a[200:203],v[136:139]
ds_write2st64_b64 v253,v[232:233],v[234:235] offset0:119 offset1:123
M v[140:143],v[228:231],a[204:207],v[140:143]
ds_read_b128 a[200:203],v250 offset:512
ds_read_b128 a[204:207],v250 offset:768
v_accvgpr_read_b32 v238,a92
v_accvgpr_read_b32 v232,a188
M v[144:147],v[228:231],a[208:211],v[144:147]
ds_read_b128 a[208:211],v250 offset:1024
v_add_f32 v234,v238,v232
v_sub_f32 v238,v238,v232
v_add_f32 v232,v92,v188
v_sub_f32 v188,v92,v188
M v[148:151],v[228:231],a[212:215],v[148:151]
ds_read_b128 a[212:215],v250 offset:1280
v_add_f32 v92,v234,v232
v_fmac_f32 v234,4.0,v232
v_fma_f32 v232,2.0,v188,v238
v_fma_f32 v188,s41,v188,v238
M v[152:155],v[228:231],a[216:219],v[152:155]
s_waitcnt lgkmcnt(7)
ds_read_b128 a[216:219],v250 offset:1536
v_accvgpr_read_b32 v238,a93
v_accvgpr_read_b32 v237,a189
v_add_f32 v236,v238,v237
v_sub_f32 v238,v238,v237
M v[156:159],v[228:231],a[220:223],v[156:159]
s_waitcnt vmcnt(14) lgkmcnt(7)
buffer_load_dwordx4 v[228:231],v251,s[20:23],s48 offen offset:2048 sc1
v_add_f32 v237,v93,v189
v_sub_f32 v189,v93,v189
v_add_f32 v93,v236,v237
v_fmac_f32 v236,4.0,v237
M v[64:67],a[224:227],a[192:195],v[64:67]
s_waitcnt lgkmcnt(6)
ds_read_b128 a[220:223],v250 offset:1792
ds_read_b128 a[192:195],v250 offset:2048
v_fma_f32 v237,2.0,v189,v238
v_fma_f32 v189,s41,v189,v238
v_cvt_pk_bf16_f32 v232,v232,v237
v_cvt_pk_bf16_f32 v234,v234,v236
M v[68:71],a[224:227],a[196:199],v[68:71]
s_waitcnt lgkmcnt(6)
s_add_u32 s48,s80,6144
v_accvgpr_read_b32 v238,a94
v_accvgpr_read_b32 v233,a190
v_add_f32 v235,v238,v233
v_sub_f32 v238,v238,v233
M v[72:75],a[224:227],a[200:203],v[72:75]
s_waitcnt lgkmcnt(5)
v_add_f32 v233,v94,v190
v_sub_f32 v190,v94,v190
v_add_f32 v94,v235,v233
v_fmac_f32 v235,4.0,v233
M v[76:79],a[224:227],a[204:207],v[76:79]
s_waitcnt lgkmcnt(4)
v_fma_f32 v233,2.0,v190,v238
v_fma_f32 v190,s41,v190,v238
v_accvgpr_read_b32 v238,a95
v_accvgpr_read_b32 v237,a191
M v[80:83],a[224:227],a[208:211],v[80:83]
s_waitcnt lgkmcnt(3)
v_add_f32 v236,v238,v237
v_sub_f32 v238,v238,v237
v_add_f32 v237,v95,v191
v_sub_f32 v191,v95,v191
M v[84:87],a[224:227],a[212:215],v[84:87]
s_waitcnt lgkmcnt(2)
v_add_f32 v95,v236,v237
v_fmac_f32 v236,4.0,v237
M v[88:91],a[224:227],a[216:219],v[88:91]
s_waitcnt lgkmcnt(1)
v_fma_f32 v237,2.0,v191,v238
v_fma_f32 v191,s41,v191,v238
M v[92:95],a[224:227],a[220:223],v[92:95]
s_waitcnt vmcnt(13)
buffer_load_dwordx4 a[224:227],v251,s[20:23],s48 offen offset:0 sc1
M v[64:67],a[228:231],a[196:199],v[64:67]
ds_read_b128 a[196:199],v249 offset:2304
v_cvt_pk_bf16_f32 v233,v233,v237
M v[68:71],a[228:231],a[200:203],v[68:71]
v_cvt_pk_bf16_f32 v235,v235,v236
M v[72:75],a[228:231],a[204:207],v[72:75]
ds_write2st64_b64 v253,v[232:233],v[234:235] offset0:127 offset1:131
M v[76:79],a[228:231],a[208:211],v[76:79]
s_add_u32 s34,s33,393216
buffer_store_dwordx4 v[40:43],v252,s[24:27],s34 offen offset:128 nt
M v[80:83],a[228:231],a[212:215],v[80:83]
v_cvt_pk_bf16_f32 v128,v128,v129
v_cvt_pk_bf16_f32 v129,v130,v131
M v[84:87],a[228:231],a[216:219],v[84:87]
v_add_u32 v249,0x15400,v249
v_add_u32 v250,0x15400,v250
M v[88:91],a[228:231],a[220:223],v[88:91]
s_waitcnt lgkmcnt(2)
v_cvt_pk_bf16_f32 v132,v132,v133
v_cvt_pk_bf16_f32 v133,v134,v135
M v[92:95],a[228:231],a[192:195],v[92:95]
s_waitcnt vmcnt(14)
buffer_load_dwordx4 a[228:231],v251,s[20:23],s48 offen offset:1024 sc1
M v[64:67],a[232:235],a[200:203],v[64:67]
ds_read_b128 a[200:203],v249 offset:0
ds_write2st64_b64 v253,v[128:129],v[132:133] offset0:68 offset1:72
M v[68:71],a[232:235],a[204:207],v[68:71]
ds_read_b128 a[204:207],v250 offset:256
v_cvt_pk_bf16_f32 v136,v136,v137
M v[72:75],a[232:235],a[208:211],v[72:75]
ds_read_b128 a[208:211],v250 offset:512
v_cvt_pk_bf16_f32 v137,v138,v139
M v[76:79],a[232:235],a[212:215],v[76:79]
ds_read_b128 a[212:215],v250 offset:768
v_cvt_pk_bf16_f32 v140,v140,v141
M v[80:83],a[232:235],a[216:219],v[80:83]
ds_read_b128 a[216:219],v250 offset:1024
v_cvt_pk_bf16_f32 v141,v142,v143
M v[84:87],a[232:235],a[220:223],v[84:87]
ds_read_b128 a[220:223],v250 offset:1280
ds_write2st64_b64 v253,v[136:137],v[140:141] offset0:76 offset1:80
M v[88:91],a[232:235],a[192:195],v[88:91]
s_waitcnt lgkmcnt(9)
ds_read_b128 a[192:195],v250 offset:1536
v_cvt_pk_bf16_f32 v144,v144,v145
M v[92:95],a[232:235],a[196:199],v[92:95]
s_waitcnt vmcnt(14) lgkmcnt(8)
buffer_load_dwordx4 a[232:235],v251,s[20:23],s48 offen offset:2048 sc1
M v[64:67],a[236:239],a[200:203],v[64:67]
s_waitcnt lgkmcnt(6)
ds_read_b128 a[196:199],v250 offset:1792
ds_read_b128 a[200:203],v250 offset:2048
M v[68:71],a[236:239],a[204:207],v[68:71]
s_waitcnt lgkmcnt(7)
s_add_u32 s48,s81,6144
v_cvt_pk_bf16_f32 v145,v146,v147
v_cvt_pk_bf16_f32 v148,v148,v149
M v[72:75],a[236:239],a[208:211],v[72:75]
s_waitcnt lgkmcnt(6)
v_cvt_pk_bf16_f32 v149,v150,v151
M v[76:79],a[236:239],a[212:215],v[76:79]
s_waitcnt lgkmcnt(5)
ds_write2st64_b64 v253,v[144:145],v[148:149] offset0:85 offset1:89
M v[80:83],a[236:239],a[216:219],v[80:83]
s_waitcnt lgkmcnt(5)
v_cvt_pk_bf16_f32 v152,v152,v153
v_cvt_pk_bf16_f32 v153,v154,v155
M v[84:87],a[236:239],a[220:223],v[84:87]
s_waitcnt lgkmcnt(3)
v_cvt_pk_bf16_f32 v156,v156,v157
v_cvt_pk_bf16_f32 v157,v158,v159
M v[88:91],a[236:239],a[192:195],v[88:91]
s_waitcnt lgkmcnt(2)
ds_write2st64_b64 v253,v[152:153],v[156:157] offset0:93 offset1:97
M v[92:95],a[236:239],a[196:199],v[92:95]
s_waitcnt vmcnt(13)
buffer_load_dwordx4 a[236:239],v251,s[20:23],s48 offen offset:0 sc1
M v[64:67],a[240:243],a[204:207],v[64:67]
ds_read_b128 a[204:207],v249 offset:2304
v_lshlrev_b32 v234,16,v208
M v[68:71],a[240:243],a[208:211],v[68:71]
v_lshlrev_b32 v232,16,v204
v_lshlrev_b32 v233,16,v206
M v[72:75],a[240:243],a[212:215],v[72:75]
v_lshlrev_b32 v237,16,v214
v_lshlrev_b32 v236,16,v212
M v[76:79],a[240:243],a[216:219],v[76:79]
v_lshlrev_b32 v235,16,v210
M v[80:83],a[240:243],a[220:223],v[80:83]
s_add_u32 s34,s33,786432
buffer_store_dwordx4 v[48:51],v252,s[24:27],s34 offen offset:128 nt
M v[84:87],a[240:243],a[192:195],v[84:87]
s_waitcnt lgkmcnt(1)
s_barrier
ds_read_b128 a[88:91],v251 offset:60928
M v[88:91],a[240:243],a[196:199],v[88:91]
ds_read_b128 a[92:95],v251 offset:65024
ds_read_b128 v[128:131],v251 offset:34816
M v[92:95],a[240:243],a[200:203],v[92:95]
s_waitcnt vmcnt(14)
ds_read_b128 v[136:139],v251 offset:38912
ds_read_b128 v[144:147],v251 offset:43520
M v[64:67],a[244:247],a[208:211],v[64:67]
ds_read_b128 v[152:155],v251 offset:47616
ds_read_b128 a[208:211],v249 offset:17408
M v[68:71],a[244:247],a[212:215],v[68:71]
buffer_load_dwordx4 a[240:243],v251,s[20:23],s48 offen offset:1024 sc1
M v[72:75],a[244:247],a[216:219],v[72:75]
ds_read_b128 a[212:215],v250 offset:17664
ds_read_b128 a[216:219],v250 offset:17920
M v[76:79],a[244:247],a[220:223],v[76:79]
ds_read_b128 a[220:223],v250 offset:18176
v_fmac_f32 v232,s43,v234
M v[80:83],a[244:247],a[192:195],v[80:83]
ds_read_b128 a[192:195],v250 offset:18432
v_fmac_f32 v237,4.0,v233
M v[84:87],a[244:247],a[196:199],v[84:87]
ds_read_b128 a[196:199],v250 offset:18688
v_fma_f32 v238,-4.0,v234,v236
M v[88:91],a[244:247],a[200:203],v[88:91]
s_waitcnt lgkmcnt(12)
ds_read_b128 a[200:203],v250 offset:18944
v_fmac_f32 v232,s45,v236
M v[92:95],a[244:247],a[204:207],v[92:95]
s_waitcnt vmcnt(14) lgkmcnt(6)
buffer_load_dwordx4 a[244:247],v251,s[20:23],s48 offen offset:2048 sc1
M v[64:67],a[248:251],a[208:211],v[64:67]
s_waitcnt lgkmcnt(5)
ds_read_b128 a[204:207],v250 offset:19200
ds_read_b128 a[208:211],v250 offset:19456
M v[68:71],a[248:251],a[212:215],v[68:71]
s_waitcnt lgkmcnt(6)
s_add_u32 s48,s76,52224
v_fmac_f32 v237,s40,v235
v_sub_f32 v236,v236,v234
M v[72:75],a[248:251],a[216:219],v[72:75]
s_waitcnt lgkmcnt(5)
v_fma_f32 v234,-4.0,v233,v235
v_sub_f32 v235,v235,v233
M v[76:79],a[248:251],a[220:223],v[76:79]
s_waitcnt lgkmcnt(4)
v_add_f32 v233,v238,v234
v_sub_f32 v238,v238,v234
M v[80:83],a[248:251],a[192:195],v[80:83]
s_waitcnt lgkmcnt(3)
v_fma_f32 v234,2.0,v235,v236
v_fmac_f32 v236,-2.0,v235
M v[84:87],a[248:251],a[196:199],v[84:87]
s_waitcnt lgkmcnt(2)
v_and_b32 v208,s42,v208
v_and_b32 v204,s42,v204
M v[88:91],a[248:251],a[200:203],v[88:91]
s_waitcnt lgkmcnt(1)
v_and_b32 v206,s42,v206
v_and_b32 v214,s42,v214
M v[92:95],a[248:251],a[204:207],v[92:95]
s_waitcnt vmcnt(13)
buffer_load_dwordx4 a[248:251],v251,s[20:23],s48 offen offset:0 sc1
M v[64:67],a[252:255],a[212:215],v[64:67]
ds_read_b128 a[212:215],v249 offset:19712
v_and_b32 v212,s42,v212
M v[68:71],a[252:255],a[216:219],v[68:71]
v_and_b32 v210,s42,v210
v_fmac_f32 v204,s43,v208
M v[72:75],a[252:255],a[220:223],v[72:75]
v_fmac_f32 v214,4.0,v206
v_fma_f32 v235,-4.0,v208,v212
M v[76:79],a[252:255],a[192:195],v[76:79]
v_fmac_f32 v204,s45,v212
v_fmac_f32 v214,s40,v210
M v[80:83],a[252:255],a[196:199],v[80:83]
v_sub_f32 v212,v212,v208
v_fma_f32 v208,-4.0,v206,v210
M v[84:87],a[252:255],a[200:203],v[84:87]
s_add_u32 s34,s33,1179648
buffer_store_dwordx4 v[56:59],v252,s[24:27],s34 offen offset:128 nt
M v[88:91],a[252:255],a[204:207],v[88:91]
s_waitcnt lgkmcnt(1)
v_sub_f32 v210,v210,v206
v_add_f32 v206,v235,v208
M v[92:95],a[252:255],a[208:211],v[92:95]
s_waitcnt vmcnt(14)
buffer_load_dwordx4 a[252:255],v251,s[20:23],s48 offen offset:1024 sc1
M v[64:67],v[216:219],a[216:219],v[64:67]
ds_read_b128 a[216:219],v249 offset:34816
v_sub_f32 v235,v235,v208
M v[68:71],v[216:219],a[220:223],v[68:71]
ds_read_b128 a[220:223],v250 offset:35072
v_fma_f32 v208,2.0,v210,v212
M v[72:75],v[216:219],a[192:195],v[72:75]
ds_read_b128 a[192:195],v250 offset:35328
v_fmac_f32 v212,-2.0,v210
M v[76:79],v[216:219],a[196:199],v[76:79]
ds_read_b128 a[196:199],v250 offset:35584
v_cvt_pk_bf16_f32 v204,v232,v204
M v[80:83],v[216:219],a[200:203],v[80:83]
ds_read_b128 a[200:203],v250 offset:35840
v_cvt_pk_bf16_f32 v214,v237,v214
M v[84:87],v[216:219],a[204:207],v[84:87]
ds_read_b128 a[204:207],v250 offset:36096
v_cvt_pk_bf16_f32 v206,v233,v206
M v[88:91],v[216:219],a[208:211],v[88:91]
s_waitcnt lgkmcnt(6)
ds_read_b128 a[208:211],v250 offset:36352
v_cvt_pk_bf16_f32 v210,v234,v208
M v[92:95],v[216:219],a[212:215],v[92:95]
s_waitcnt vmcnt(14) lgkmcnt(6)
buffer_load_dwordx4 v[216:219],v251,s[20:23],s48 offen offset:2048 sc1
M v[64:67],v[220:223],a[216:219],v[64:67]
s_waitcnt lgkmcnt(5)
ds_read_b128 a[212:215],v250 offset:36608
ds_read_b128 a[216:219],v250 offset:36864
M v[68:71],v[220:223],a[220:223],v[68:71]
s_waitcnt lgkmcnt(6)
s_add_u32 s48,s77,52224
v_cvt_pk_bf16_f32 v208,v238,v235
v_cvt_pk_bf16_f32 v212,v236,v212
M v[72:75],v[220:223],a[192:195],v[72:75]
s_waitcnt lgkmcnt(5)
v_lshlrev_b32 v234,16,v209
v_lshlrev_b32 v232,16,v205
M v[76:79],v[220:223],a[196:199],v[76:79]
s_waitcnt lgkmcnt(4)
v_lshlrev_b32 v233,16,v207
v_lshlrev_b32 v237,16,v215
M v[80:83],v[220:223],a[200:203],v[80:83]
s_waitcnt lgkmcnt(3)
v_lshlrev_b32 v236,16,v213
v_lshlrev_b32 v235,16,v211
M v[84:87],v[220:223],a[204:207],v[84:87]
s_waitcnt lgkmcnt(2)
v_fmac_f32 v232,s43,v234
v_fmac_f32 v237,4.0,v233
M v[88:91],v[220:223],a[208:211],v[88:91]
s_waitcnt lgkmcnt(1)
v_fma_f32 v238,-4.0,v234,v236
v_fmac_f32 v232,s45,v236
M v[92:95],v[220:223],a[212:215],v[92:95]
s_waitcnt vmcnt(13)
buffer_load_dwordx4 v[220:223],v251,s[20:23],s48 offen offset:0 sc1
M v[64:67],v[224:227],a[220:223],v[64:67]
ds_read_b128 a[220:223],v249 offset:37120
v_fmac_f32 v237,s40,v235
M v[68:71],v[224:227],a[192:195],v[68:71]
v_sub_f32 v236,v236,v234
v_fma_f32 v234,-4.0,v233,v235
M v[72:75],v[224:227],a[196:199],v[72:75]
v_sub_f32 v235,v235,v233
v_add_f32 v233,v238,v234
M v[76:79],v[224:227],a[200:203],v[76:79]
v_sub_f32 v238,v238,v234
v_fma_f32 v234,2.0,v235,v236
M v[80:83],v[224:227],a[204:207],v[80:83]
v_fmac_f32 v236,-2.0,v235
v_and_b32 v209,s42,v209
M v[84:87],v[224:227],a[208:211],v[84:87]
v_and_b32 v205,s42,v205
v_and_b32 v207,s42,v207
M v[88:91],v[224:227],a[212:215],v[88:91]
s_waitcnt lgkmcnt(1)
s_add_u32 s34,s32,786432
buffer_store_dwordx4 a[80:83],v252,s[24:27],s34 offen offset:640 nt
M v[92:95],v[224:227],a[216:219],v[92:95]
s_waitcnt vmcnt(14)
buffer_load_dwordx4 v[224:227],v251,s[20:23],s48 offen offset:1024 sc1
M v[64:67],v[228:231],a[192:195],v[64:67]
ds_read_b128 a[192:195],v249 offset:52224
v_and_b32 v215,s42,v215
M v[68:71],v[228:231],a[196:199],v[68:71]
ds_read_b128 a[196:199],v250 offset:52480
v_and_b32 v213,s42,v213
M v[72:75],v[228:231],a[200:203],v[72:75]
ds_read_b128 a[200:203],v250 offset:52736
v_and_b32 v211,s42,v211
M v[76:79],v[228:231],a[204:207],v[76:79]
ds_read_b128 a[204:207],v250 offset:52992
v_fmac_f32 v205,s43,v209
M v[80:83],v[228:231],a[208:211],v[80:83]
ds_read_b128 a[208:211],v250 offset:53248
v_fmac_f32 v215,4.0,v207
M v[84:87],v[228:231],a[212:215],v[84:87]
ds_read_b128 a[212:215],v250 offset:53504
v_fma_f32 v235,-4.0,v209,v213
M v[88:91],v[228:231],a[216:219],v[88:91]
s_waitcnt lgkmcnt(6)
ds_read_b128 a[216:219],v250 offset:53760
v_fmac_f32 v205,s45,v213
M v[92:95],v[228:231],a[220:223],v[92:95]
s_waitcnt vmcnt(14) lgkmcnt(6)
buffer_load_dwordx4 v[228:231],v251,s[20:23],s48 offen offset:2048 sc1
M v[64:67],a[224:227],a[192:195],v[64:67]
s_waitcnt lgkmcnt(5)
ds_read_b128 a[220:223],v250 offset:54016
ds_read_b128 a[192:195],v250 offset:54272
M v[68:71],a[224:227],a[196:199],v[68:71]
s_waitcnt lgkmcnt(6)
s_add_u32 s48,s78,52224
v_fmac_f32 v215,s40,v211
v_sub_f32 v213,v213,v209
M v[72:75],a[224:227],a[200:203],v[72:75]
s_waitcnt lgkmcnt(5)
v_fma_f32 v209,-4.0,v207,v211
v_sub_f32 v211,v211,v207
M v[76:79],a[224:227],a[204:207],v[76:79]
s_waitcnt lgkmcnt(4)
v_add_f32 v207,v235,v209
v_sub_f32 v235,v235,v209
M v[80:83],a[224:227],a[208:211],v[80:83]
s_waitcnt lgkmcnt(3)
v_fma_f32 v209,2.0,v211,v213
v_fmac_f32 v213,-2.0,v211
M v[84:87],a[224:227],a[212:215],v[84:87]
s_waitcnt lgkmcnt(2)
v_cvt_pk_bf16_f32 v205,v232,v205
v_cvt_pk_bf16_f32 v215,v237,v215
M v[88:91],a[224:227],a[216:219],v[88:91]
s_waitcnt lgkmcnt(1)
v_cvt_pk_bf16_f32 v207,v233,v207
v_cvt_pk_bf16_f32 v211,v234,v209
M v[92:95],a[224:227],a[220:223],v[92:95]
s_waitcnt vmcnt(13)
buffer_load_dwordx4 a[224:227],v251,s[20:23],s48 offen offset:0 sc1
M v[64:67],a[228:231],a[196:199],v[64:67]
ds_read_b128 a[196:199],v249 offset:54528
v_cvt_pk_bf16_f32 v209,v238,v235
M v[68:71],a[228:231],a[200:203],v[68:71]
v_cvt_pk_bf16_f32 v213,v236,v213
M v[72:75],a[228:231],a[204:207],v[72:75]
s_barrier
ds_write2st64_b64 v247,v[192:193],v[202:203] offset0:102 offset1:119
M v[76:79],a[228:231],a[208:211],v[76:79]
s_add_u32 s28,s64,7077888
buffer_load_dwordx2 v[192:193],v245,s[12:15],s28 offen offset:0
M v[80:83],a[228:231],a[212:215],v[80:83]
buffer_load_dwordx2 v[202:203],v245,s[16:19],s28 offen offset:1536
M v[84:87],a[228:231],a[216:219],v[84:87]
ds_write2st64_b64 v247,v[194:195],v[196:197] offset0:34 offset1:51
M v[88:91],a[228:231],a[220:223],v[88:91]
s_waitcnt lgkmcnt(3)
buffer_load_dwordx2 v[194:195],v245,s[8:11],s28 offen offset:0
M v[92:95],a[228:231],a[192:195],v[92:95]
s_waitcnt vmcnt(16)
s_add_u32 s34,s32,983040
buffer_load_dwordx2 v[196:197],v245,s[8:11],s28 offen offset:384
M v[64:67],a[232:235],a[200:203],v[64:67]
buffer_load_dwordx4 a[228:231],v251,s[20:23],s48 offen offset:1024 sc1
M v[68:71],a[232:235],a[204:207],v[68:71]
buffer_store_dwordx4 a[84:87],v252,s[24:27],s34 offen offset:640 nt
v_add_u32 v249,0xfffece00,v249
v_add_u32 v250,0xfffece00,v250
M v[72:75],a[232:235],a[208:211],v[72:75]
ds_read_b128 a[200:203],v249 offset:60928
ds_read_b128 a[204:207],v250 offset:61184
M v[76:79],a[232:235],a[212:215],v[76:79]
ds_read_b128 a[208:211],v250 offset:61440
ds_read_b128 a[212:215],v250 offset:61696
M v[80:83],a[232:235],a[216:219],v[80:83]
ds_read_b128 a[216:219],v250 offset:61952
ds_write2st64_b64 v247,v[198:199],v[200:201] offset0:68 offset1:85
M v[84:87],a[232:235],a[220:223],v[84:87]
buffer_load_dwordx2 v[198:199],v245,s[8:11],s28 offen offset:768
M v[88:91],a[232:235],a[192:195],v[88:91]
s_waitcnt lgkmcnt(8)
buffer_load_dwordx2 v[200:201],v245,s[8:11],s28 offen offset:1152
M v[92:95],a[232:235],a[196:199],v[92:95]
s_waitcnt vmcnt(20) lgkmcnt(5)
buffer_load_dwordx4 a[232:235],v251,s[20:23],s48 offen offset:2048 sc1
M v[64:67],a[236:239],a[200:203],v[64:67]
s_waitcnt lgkmcnt(4)
ds_read_b128 a[220:223],v250 offset:62208
ds_read_b128 a[192:195],v250 offset:62464
M v[68:71],a[236:239],a[204:207],v[68:71]
s_waitcnt lgkmcnt(5)
s_add_u32 s48,s79,52224
ds_read_b128 a[196:199],v250 offset:62720
ds_read_b128 a[200:203],v250 offset:62976
M v[72:75],a[236:239],a[208:211],v[72:75]
s_waitcnt lgkmcnt(6)
ds_write2st64_b64 v247,v[204:205],v[214:215] offset0:103 offset1:120
M v[76:79],a[236:239],a[212:215],v[76:79]
s_waitcnt lgkmcnt(6)
s_add_u32 s28,s64,7471104
buffer_load_dwordx2 v[204:205],v245,s[12:15],s28 offen offset:0
M v[80:83],a[236:239],a[216:219],v[80:83]
s_waitcnt lgkmcnt(4)
buffer_load_dwordx2 v[214:215],v245,s[16:19],s28 offen offset:1536
M v[84:87],a[236:239],a[220:223],v[84:87]
s_waitcnt lgkmcnt(3)
ds_write2st64_b64 v247,v[206:207],v[208:209] offset0:35 offset1:52
M v[88:91],a[236:239],a[192:195],v[88:91]
s_waitcnt lgkmcnt(3)
buffer_load_dwordx2 v[206:207],v245,s[8:11],s28 offen offset:0
M v[92:95],a[236:239],a[196:199],v[92:95]
s_waitcnt vmcnt(22)
buffer_load_dwordx2 v[208:209],v245,s[8:11],s28 offen offset:384
M v[64:67],a[240:243],a[204:207],v[64:67]
buffer_load_dwordx4 a[236:239],v251,s[20:23],s48 offen offset:0 sc1
M v[68:71],a[240:243],a[208:211],v[68:71]
ds_read_b128 a[204:207],v249 offset:63232
ds_write2st64_b64 v247,v[210:211],v[212:213] offset0:69 offset1:86
M v[72:75],a[240:243],a[212:215],v[72:75]
buffer_load_dwordx2 v[210:211],v245,s[8:11],s28 offen offset:768
M v[76:79],a[240:243],a[216:219],v[76:79]
buffer_load_dwordx2 v[212:213],v245,s[8:11],s28 offen offset:1152
M v[80:83],a[240:243],a[220:223],v[80:83]
v_fmac_f32 v239,s43,v241
v_fmac_f32 v244,4.0,v240
M v[84:87],a[240:243],a[192:195],v[84:87]
v_fma_f32 v232,-4.0,v241,v243
v_fmac_f32 v239,s45,v243
M v[88:91],a[240:243],a[196:199],v[88:91]
s_waitcnt lgkmcnt(4)
v_fmac_f32 v244,s40,v242
v_sub_f32 v243,v243,v241
M v[92:95],a[240:243],a[200:203],v[92:95]
s_waitcnt vmcnt(25)
buffer_load_dwordx4 a[240:243],v251,s[20:23],s48 offen offset:1024 sc1
M v[64:67],a[244:247],a[208:211],v[64:67]
s_add_u32 s34,s32,1179648
buffer_store_dwordx4 a[88:91],v252,s[24:27],s34 offen offset:640 nt
M v[68:71],a[244:247],a[212:215],v[68:71]
ds_read_b128 a[208:211],v249 offset:0
ds_read_b128 a[212:215],v250 offset:256
M v[72:75],a[244:247],a[216:219],v[72:75]
ds_read_b128 a[216:219],v250 offset:512
v_fma_f32 v241,-4.0,v240,v242
M v[76:79],a[244:247],a[220:223],v[76:79]
ds_read_b128 a[220:223],v250 offset:768
v_sub_f32 v242,v242,v240
M v[80:83],a[244:247],a[192:195],v[80:83]
ds_read_b128 a[192:195],v250 offset:1024
v_add_f32 v240,v232,v241
M v[84:87],a[244:247],a[196:199],v[84:87]
ds_read_b128 a[196:199],v250 offset:1280
v_sub_f32 v232,v232,v241
M v[88:91],a[244:247],a[200:203],v[88:91]
s_waitcnt lgkmcnt(7)
ds_read_b128 a[200:203],v250 offset:1536
v_fma_f32 v241,2.0,v242,v243
M v[92:95],a[244:247],a[204:207],v[92:95]
s_waitcnt vmcnt(26) lgkmcnt(6)
buffer_load_dwordx4 a[244:247],v251,s[20:23],s48 offen offset:2048 sc1
M v[160:163],a[248:251],a[208:211],v[160:163]
s_waitcnt lgkmcnt(5)
ds_read_b128 a[204:207],v250 offset:1792
ds_read_b128 a[208:211],v250 offset:2048
M v[164:167],a[248:251],a[212:215],v[164:167]
s_waitcnt lgkmcnt(6)
s_add_u32 s48,s80,52224
v_fmac_f32 v243,-2.0,v242
v_cvt_pk_bf16_f32 v233,v239,v244
M v[168:171],a[248:251],a[216:219],v[168:171]
s_waitcnt lgkmcnt(5)
v_cvt_pk_bf16_f32 v234,v240,v232
v_cvt_pk_bf16_f32 v235,v241,v243
M v[172:175],a[248:251],a[220:223],v[172:175]
s_waitcnt lgkmcnt(4)
buffer_load_short_d16_hi v239,v246,s[12:15],s71 offen offset:0
M v[176:179],a[248:251],a[192:195],v[176:179]
s_waitcnt lgkmcnt(3)
buffer_load_short_d16_hi v240,v246,s[8:11],s71 offen offset:0
M v[180:183],a[248:251],a[196:199],v[180:183]
s_waitcnt lgkmcnt(2)
buffer_load_short_d16_hi v241,v246,s[8:11],s71 offen offset:384
M v[184:187],a[248:251],a[200:203],v[184:187]
s_waitcnt lgkmcnt(1)
buffer_load_short_d16_hi v242,v246,s[8:11],s71 offen offset:768
M v[188:191],a[248:251],a[204:207],v[188:191]
s_waitcnt vmcnt(29)
buffer_load_short_d16_hi v243,v246,s[8:11],s71 offen offset:1152
M v[160:163],a[252:255],a[212:215],v[160:163]
buffer_load_short_d16_hi v244,v246,s[16:19],s71 offen offset:1536
M v[164:167],a[252:255],a[216:219],v[164:167]
buffer_load_dwordx4 a[248:251],v251,s[20:23],s48 offen offset:0 sc1
M v[168:171],a[252:255],a[220:223],v[168:171]
ds_read_b128 a[212:215],v249 offset:2304
ds_write_b16 v248,v233 offset:52224
M v[172:175],a[252:255],a[192:195],v[172:175]
ds_write_b16_d16_hi v248,v233 offset:60928
M v[176:179],a[252:255],a[196:199],v[176:179]
ds_write_b16 v248,v234 offset:17408
M v[180:183],a[252:255],a[200:203],v[180:183]
ds_write_b16_d16_hi v248,v234 offset:26112
M v[184:187],a[252:255],a[204:207],v[184:187]
s_waitcnt lgkmcnt(5)
ds_write_b16 v248,v235 offset:34816
M v[188:191],a[252:255],a[208:211],v[188:191]
s_waitcnt vmcnt(31)
buffer_load_dwordx4 a[252:255],v251,s[20:23],s48 offen offset:1024 sc1
M v[160:163],v[216:219],a[216:219],v[160:163]
ds_write_b16_d16_hi v248,v235 offset:43520
M v[164:167],v[216:219],a[220:223],v[164:167]
s_add_u32 s34,s32,1376256
buffer_store_dwordx4 a[92:95],v252,s[24:27],s34 offen offset:640 nt
v_add_u32 v249,0x15400,v249
v_add_u32 v250,0x15400,v250
M v[168:171],v[216:219],a[192:195],v[168:171]
ds_read_b128 a[216:219],v249 offset:0
ds_read_b128 a[220:223],v250 offset:256
M v[172:175],v[216:219],a[196:199],v[172:175]
ds_read_b128 a[192:195],v250 offset:512
ds_read_b128 a[196:199],v250 offset:768
M v[176:179],v[216:219],a[200:203],v[176:179]
s_waitcnt vmcnt(24)
ds_read_b128 a[200:203],v250 offset:1024
v_lshlrev_b32 v234,16,v196
M v[180:183],v[216:219],a[204:207],v[180:183]
ds_read_b128 a[204:207],v250 offset:1280
v_lshlrev_b32 v232,16,v192
M v[184:187],v[216:219],a[208:211],v[184:187]
s_waitcnt lgkmcnt(12)
ds_read_b128 a[208:211],v250 offset:1536
v_lshlrev_b32 v233,16,v194
M v[188:191],v[216:219],a[212:215],v[188:191]
s_waitcnt lgkmcnt(6)
buffer_load_dwordx4 v[216:219],v251,s[20:23],s48 offen offset:2048 sc1
M v[160:163],v[220:223],a[216:219],v[160:163]
s_waitcnt lgkmcnt(5)
ds_read_b128 a[212:215],v250 offset:1792
ds_read_b128 a[216:219],v250 offset:2048
M v[164:167],v[220:223],a[220:223],v[164:167]
s_waitcnt vmcnt(21) lgkmcnt(6)
s_add_u32 s48,s81,52224
v_lshlrev_b32 v237,16,v202
v_lshlrev_b32 v236,16,v200
M v[168:171],v[220:223],a[192:195],v[168:171]
s_waitcnt lgkmcnt(5)
v_lshlrev_b32 v235,16,v198
v_fmac_f32 v232,s43,v234
M v[172:175],v[220:223],a[196:199],v[172:175]
s_waitcnt lgkmcnt(4)
v_fmac_f32 v237,4.0,v233
v_fma_f32 v238,-4.0,v234,v236
M v[176:179],v[220:223],a[200:203],v[176:179]
s_waitcnt lgkmcnt(3)
v_fmac_f32 v232,s45,v236
v_fmac_f32 v237,s40,v235
M v[180:183],v[220:223],a[204:207],v[180:183]
s_waitcnt lgkmcnt(2)
v_sub_f32 v236,v236,v234
v_fma_f32 v234,-4.0,v233,v235
M v[184:187],v[220:223],a[208:211],v[184:187]
s_waitcnt lgkmcnt(1)
v_sub_f32 v235,v235,v233
v_add_f32 v233,v238,v234
M v[188:191],v[220:223],a[212:215],v[188:191]
buffer_load_dwordx4 v[220:223],v251,s[20:23],s48 offen offset:0 sc1
M v[160:163],v[224:227],a[220:223],v[160:163]
ds_read_b128 a[220:223],v249 offset:2304
v_sub_f32 v238,v238,v234
M v[164:167],v[224:227],a[192:195],v[164:167]
v_fma_f32 v234,2.0,v235,v236
v_fmac_f32 v236,-2.0,v235
M v[168:171],v[224:227],a[196:199],v[168:171]
v_and_b32 v196,s42,v196
v_and_b32 v192,s42,v192
M v[172:175],v[224:227],a[200:203],v[172:175]
v_and_b32 v194,s42,v194
v_and_b32 v202,s42,v202
M v[176:179],v[224:227],a[204:207],v[176:179]
v_and_b32 v200,s42,v200
v_and_b32 v198,s42,v198
M v[180:183],v[224:227],a[208:211],v[180:183]
v_fmac_f32 v192,s43,v196
v_fmac_f32 v202,4.0,v194
M v[184:187],v[224:227],a[212:215],v[184:187]
s_waitcnt lgkmcnt(1)
v_fma_f32 v235,-4.0,v196,v200
v_fmac_f32 v192,s45,v200
M v[188:191],v[224:227],a[216:219],v[188:191]
buffer_load_dwordx4 v[224:227],v251,s[20:23],s48 offen offset:1024 sc1
M v[160:163],v[228:231],a[192:195],v[160:163]
ds_read_b128 a[192:195],v249 offset:17408
v_fmac_f32 v202,s40,v198
M v[164:167],v[228:231],a[196:199],v[164:167]
ds_read_b128 a[196:199],v250 offset:17664
v_sub_f32 v200,v200,v196
M v[168:171],v[228:231],a[200:203],v[168:171]
s_add_u32 s34,s33,0
buffer_store_dwordx4 v[128:131],v252,s[24:27],s34 offen offset:1280 nt
M v[172:175],v[228:231],a[204:207],v[172:175]
ds_read_b128 a[200:203],v250 offset:17920
ds_read_b128 a[204:207],v250 offset:18176
M v[176:179],v[228:231],a[208:211],v[176:179]
ds_read_b128 a[208:211],v250 offset:18432
v_fma_f32 v196,-4.0,v194,v198
M v[180:183],v[228:231],a[212:215],v[180:183]
ds_read_b128 a[212:215],v250 offset:18688
v_sub_f32 v198,v198,v194
M v[184:187],v[228:231],a[216:219],v[184:187]
s_waitcnt lgkmcnt(6)
ds_read_b128 a[216:219],v250 offset:18944
v_add_f32 v194,v235,v196
M v[188:191],v[228:231],a[220:223],v[188:191]
s_waitcnt lgkmcnt(6)
buffer_load_dwordx4 v[228:231],v251,s[20:23],s48 offen offset:2048 sc1
M v[160:163],a[224:227],a[192:195],v[160:163]
s_waitcnt lgkmcnt(5)
ds_read_b128 a[220:223],v250 offset:19200
ds_read_b128 a[192:195],v250 offset:19456
M v[164:167],a[224:227],a[196:199],v[164:167]
s_waitcnt lgkmcnt(6)
s_add_u32 s46,s76,9216
v_sub_f32 v235,v235,v196
v_fma_f32 v196,2.0,v198,v200
M v[168:171],a[224:227],a[200:203],v[168:171]
s_waitcnt lgkmcnt(5)
v_fmac_f32 v200,-2.0,v198
v_cvt_pk_bf16_f32 v192,v232,v192
M v[172:175],a[224:227],a[204:207],v[172:175]
s_waitcnt lgkmcnt(4)
v_cvt_pk_bf16_f32 v202,v237,v202
v_cvt_pk_bf16_f32 v194,v233,v194
M v[176:179],a[224:227],a[208:211],v[176:179]
s_waitcnt lgkmcnt(3)
v_cvt_pk_bf16_f32 v198,v234,v196
v_cvt_pk_bf16_f32 v196,v238,v235
M v[180:183],a[224:227],a[212:215],v[180:183]
s_waitcnt lgkmcnt(2)
v_cvt_pk_bf16_f32 v200,v236,v200
v_lshlrev_b32 v234,16,v197
M v[184:187],a[224:227],a[216:219],v[184:187]
s_waitcnt lgkmcnt(1)
v_lshlrev_b32 v232,16,v193
v_lshlrev_b32 v233,16,v195
M v[188:191],a[224:227],a[220:223],v[188:191]
buffer_load_dwordx4 a[224:227],v251,s[20:23],s46 offen offset:0 sc1
M v[160:163],a[228:231],a[196:199],v[160:163]
ds_read_b128 a[196:199],v249 offset:19712
v_lshlrev_b32 v237,16,v203
M v[164:167],a[228:231],a[200:203],v[164:167]
s_add_u32 s47,s76,12288
v_lshlrev_b32 v236,16,v201
v_lshlrev_b32 v235,16,v199
M v[168:171],a[228:231],a[204:207],v[168:171]
v_fmac_f32 v232,s43,v234
v_fmac_f32 v237,4.0,v233
M v[172:175],a[228:231],a[208:211],v[172:175]
v_fma_f32 v238,-4.0,v234,v236
v_fmac_f32 v232,s45,v236
M v[176:179],a[228:231],a[212:215],v[176:179]
v_fmac_f32 v237,s40,v235
v_sub_f32 v236,v236,v234
M v[180:183],a[228:231],a[216:219],v[180:183]
v_fma_f32 v234,-4.0,v233,v235
v_sub_f32 v235,v235,v233
M v[184:187],a[228:231],a[220:223],v[184:187]
s_waitcnt lgkmcnt(1)
v_add_f32 v233,v238,v234
v_sub_f32 v238,v238,v234
M v[188:191],a[228:231],a[192:195],v[188:191]
s_waitcnt vmcnt(25)
buffer_load_dwordx4 a[228:231],v251,s[20:23],s47 offen offset:0 sc1
M v[160:163],a[232:235],a[200:203],v[160:163]
ds_read_b128 a[200:203],v249 offset:34816
v_fma_f32 v234,2.0,v235,v236
M v[164:167],a[232:235],a[204:207],v[164:167]
s_add_u32 s48,s76,15360
ds_read_b128 a[204:207],v250 offset:35072
v_fmac_f32 v236,-2.0,v235
M v[168:171],a[232:235],a[208:211],v[168:171]
ds_read_b128 a[208:211],v250 offset:35328
v_and_b32 v197,s42,v197
M v[172:175],a[232:235],a[212:215],v[172:175]
s_add_u32 s34,s33,393216
buffer_store_dwordx4 v[136:139],v252,s[24:27],s34 offen offset:1280 nt
M v[176:179],a[232:235],a[216:219],v[176:179]
ds_read_b128 a[212:215],v250 offset:35584
ds_read_b128 a[216:219],v250 offset:35840
M v[180:183],a[232:235],a[220:223],v[180:183]
ds_read_b128 a[220:223],v250 offset:36096
v_and_b32 v193,s42,v193
M v[184:187],a[232:235],a[192:195],v[184:187]
s_waitcnt lgkmcnt(6)
ds_read_b128 a[192:195],v250 offset:36352
v_and_b32 v195,s42,v195
M v[188:191],a[232:235],a[196:199],v[188:191]
s_waitcnt vmcnt(22) lgkmcnt(6)
buffer_load_dwordx4 a[232:235],v251,s[20:23],s48 offen offset:0 sc1
M v[160:163],a[236:239],a[200:203],v[160:163]
s_waitcnt lgkmcnt(5)
ds_read_b128 a[196:199],v250 offset:36608
ds_read_b128 a[200:203],v250 offset:36864
M v[164:167],a[236:239],a[204:207],v[164:167]
s_waitcnt lgkmcnt(6)
v_and_b32 v203,s42,v203
v_and_b32 v201,s42,v201
M v[168:171],a[236:239],a[208:211],v[168:171]
s_waitcnt lgkmcnt(5)
v_and_b32 v199,s42,v199
v_fmac_f32 v193,s43,v197
M v[172:175],a[236:239],a[212:215],v[172:175]
s_waitcnt lgkmcnt(4)
v_fmac_f32 v203,4.0,v195
v_fma_f32 v235,-4.0,v197,v201
M v[176:179],a[236:239],a[216:219],v[176:179]
s_waitcnt lgkmcnt(3)
v_fmac_f32 v193,s45,v201
v_fmac_f32 v203,s40,v199
M v[180:183],a[236:239],a[220:223],v[180:183]
s_waitcnt lgkmcnt(2)
v_sub_f32 v201,v201,v197
v_fma_f32 v197,-4.0,v195,v199
M v[184:187],a[236:239],a[192:195],v[184:187]
s_waitcnt lgkmcnt(1)
v_sub_f32 v199,v199,v195
v_add_f32 v195,v235,v197
M v[188:191],a[236:239],a[196:199],v[188:191]
s_waitcnt vmcnt(20)
buffer_load_dwordx4 a[236:239],v251,s[20:23],s46 offen offset:1024 sc1
M v[160:163],a[240:243],a[204:207],v[160:163]
ds_read_b128 a[204:207],v249 offset:37120
v_sub_f32 v235,v235,v197
M v[164:167],a[240:243],a[208:211],v[164:167]
v_fma_f32 v197,2.0,v199,v201
v_fmac_f32 v201,-2.0,v199
M v[168:171],a[240:243],a[212:215],v[168:171]
v_cvt_pk_bf16_f32 v193,v232,v193
v_cvt_pk_bf16_f32 v203,v237,v203
M v[172:175],a[240:243],a[216:219],v[172:175]
v_cvt_pk_bf16_f32 v195,v233,v195
v_cvt_pk_bf16_f32 v199,v234,v197
M v[176:179],a[240:243],a[220:223],v[176:179]
v_cvt_pk_bf16_f32 v197,v238,v235
v_cvt_pk_bf16_f32 v201,v236,v201
M v[180:183],a[240:243],a[192:195],v[180:183]
ds_write2st64_b64 v247,v[192:193],v[202:203] offset0:104 offset1:121
M v[184:187],a[240:243],a[196:199],v[184:187]
s_waitcnt lgkmcnt(2)
s_add_u32 s28,s65,6291456
buffer_load_dwordx2 v[192:193],v245,s[12:15],s28 offen offset:0
M v[188:191],a[240:243],a[200:203],v[188:191]
s_waitcnt vmcnt(20)
buffer_load_dwordx2 v[202:203],v245,s[16:19],s28 offen offset:1536
M v[160:163],a[244:247],a[208:211],v[160:163]
buffer_load_dwordx4 a[240:243],v251,s[20:23],s47 offen offset:1024 sc1
M v[164:167],a[244:247],a[212:215],v[164:167]
ds_read_b128 a[208:211],v249 offset:52224
ds_read_b128 a[212:215],v250 offset:52480
M v[168:171],a[244:247],a[216:219],v[168:171]
ds_read_b128 a[216:219],v250 offset:52736
ds_write2st64_b64 v247,v[194:195],v[196:197] offset0:36 offset1:53
M v[172:175],a[244:247],a[220:223],v[172:175]
buffer_load_dwordx2 v[194:195],v245,s[8:11],s28 offen offset:0
M v[176:179],a[244:247],a[192:195],v[176:179]
s_add_u32 s34,s33,786432
buffer_load_dwordx2 v[196:197],v245,s[8:11],s28 offen offset:384
M v[180:183],a[244:247],a[196:199],v[180:183]
ds_read_b128 a[220:223],v250 offset:52992
buffer_store_dwordx4 v[144:147],v252,s[24:27],s34 offen offset:1280 nt
M v[184:187],a[244:247],a[200:203],v[184:187]
s_waitcnt lgkmcnt(6)
ds_read_b128 a[192:195],v250 offset:53248
ds_read_b128 a[196:199],v250 offset:53504
ds_write2st64_b64 v247,v[198:199],v[200:201] offset0:70 offset1:87
M v[188:191],a[244:247],a[204:207],v[188:191]
s_waitcnt vmcnt(18) lgkmcnt(7)
s_barrier
ds_read_b128 a[200:203],v250 offset:53760
M v[160:163],a[248:251],a[208:211],v[160:163]
s_waitcnt lgkmcnt(7)
buffer_load_dwordx2 v[198:199],v245,s[8:11],s28 offen offset:768
v_cvt_pk_bf16_f32 v64,v64,v65
v_cvt_pk_bf16_f32 v65,v66,v67
v_cvt_pk_bf16_f32 v68,v68,v69
v_cvt_pk_bf16_f32 v69,v70,v71
M v[164:167],a[248:251],a[212:215],v[164:167]
s_waitcnt lgkmcnt(6)
buffer_load_dwordx2 v[200:201],v245,s[8:11],s28 offen offset:1152
ds_write2st64_b64 v253,v[64:65],v[68:69] offset0:136 offset1:140
M v[168:171],a[248:251],a[216:219],v[168:171]
s_waitcnt lgkmcnt(5)
buffer_load_dwordx4 a[244:247],v251,s[20:23],s48 offen offset:1024 sc1
ds_read_b128 a[204:207],v250 offset:54016
v_cvt_pk_bf16_f32 v72,v72,v73
v_cvt_pk_bf16_f32 v73,v74,v75
M v[172:175],a[248:251],a[220:223],v[172:175]
s_waitcnt lgkmcnt(5)
ds_read_b128 a[208:211],v250 offset:54272
v_cvt_pk_bf16_f32 v76,v76,v77
v_cvt_pk_bf16_f32 v77,v78,v79
M v[176:179],a[248:251],a[192:195],v[176:179]
s_waitcnt lgkmcnt(5)
ds_write2st64_b64 v253,v[72:73],v[76:77] offset0:144 offset1:148
M v[180:183],a[248:251],a[196:199],v[180:183]
s_waitcnt lgkmcnt(4)
v_cvt_pk_bf16_f32 v80,v80,v81
v_cvt_pk_bf16_f32 v81,v82,v83
v_cvt_pk_bf16_f32 v84,v84,v85
M v[184:187],a[248:251],a[200:203],v[184:187]
s_waitcnt lgkmcnt(2)
v_cvt_pk_bf16_f32 v85,v86,v87
M v[188:191],a[248:251],a[204:207],v[188:191]
s_waitcnt vmcnt(20)
buffer_load_dwordx4 a[248:251],v251,s[20:23],s46 offen offset:2048 sc1
ds_write2st64_b64 v253,v[80:81],v[84:85] offset0:170 offset1:174
v_cvt_pk_bf16_f32 v88,v88,v89
M v[160:163],a[252:255],a[212:215],v[160:163]
ds_read_b128 a[212:215],v249 offset:54528
v_cvt_pk_bf16_f32 v89,v90,v91
v_cvt_pk_bf16_f32 v92,v92,v93
v_cvt_pk_bf16_f32 v93,v94,v95
M v[164:167],a[252:255],a[216:219],v[164:167]
ds_write2st64_b64 v253,v[88:89],v[92:93] offset0:178 offset1:182
M v[168:171],a[252:255],a[220:223],v[168:171]
v_lshlrev_b32 v234,16,v208
v_lshlrev_b32 v232,16,v204
v_lshlrev_b32 v233,16,v206
M v[172:175],a[252:255],a[192:195],v[172:175]
v_lshlrev_b32 v237,16,v214
v_lshlrev_b32 v236,16,v212
v_lshlrev_b32 v235,16,v210
M v[176:179],a[252:255],a[196:199],v[176:179]
s_waitcnt lgkmcnt(0)
s_barrier
ds_read_b128 v[64:67],v0 offset:0
v_fmac_f32 v232,s43,v234
v_fmac_f32 v237,4.0,v233
v_fma_f32 v238,-4.0,v234,v236
M v[180:183],a[252:255],a[200:203],v[180:183]
ds_read_b128 v[72:75],v0 offset:4096
ds_read_b128 v[80:83],v0 offset:17408
v_fmac_f32 v232,s45,v236
v_fmac_f32 v237,s40,v235
v_sub_f32 v236,v236,v234
v_fma_f32 v234,-4.0,v233,v235
M v[184:187],a[252:255],a[204:207],v[184:187]
ds_read_b128 v[88:91],v0 offset:21504
v_add_u32 v249,0xfffece00,v249
v_sub_f32 v235,v235,v233
v_add_f32 v233,v238,v234
v_sub_f32 v238,v238,v234
v_fma_f32 v234,2.0,v235,v236
M v[188:191],a[252:255],a[208:211],v[188:191]
s_waitcnt vmcnt(19)
buffer_load_dwordx4 a[252:255],v251,s[20:23],s47 offen offset:2048 sc1
v_fmac_f32 v236,-2.0,v235
v_and_b32 v208,s42,v208
v_and_b32 v204,s42,v204
v_and_b32 v206,s42,v206
M v[160:163],v[216:219],a[216:219],v[160:163]
v_add_u32 v250,0xfffece00,v250
v_and_b32 v214,s42,v214
v_and_b32 v212,s42,v212
v_and_b32 v210,s42,v210
v_fmac_f32 v204,s43,v208
M v[164:167],v[216:219],a[220:223],v[164:167]
ds_read_b128 a[216:219],v249 offset:60928
ds_read_b128 a[220:223],v250 offset:61184
v_fmac_f32 v214,4.0,v206
v_fma_f32 v235,-4.0,v208,v212
v_fmac_f32 v204,s45,v212
v_fmac_f32 v214,s40,v210
M v[168:171],v[216:219],a[192:195],v[168:171]
ds_read_b128 a[192:195],v250 offset:61440
v_sub_f32 v212,v212,v208
v_fma_f32 v208,-4.0,v206,v210
v_sub_f32 v210,v210,v206
v_add_f32 v206,v235,v208
M v[172:175],v[216:219],a[196:199],v[172:175]
ds_read_b128 a[196:199],v250 offset:61696
v_sub_f32 v235,v235,v208
v_fma_f32 v208,2.0,v210,v212
v_fmac_f32 v212,-2.0,v210
v_cvt_pk_bf16_f32 v204,v232,v204
M v[176:179],v[216:219],a[200:203],v[176:179]
ds_read_b128 a[200:203],v250 offset:61952
v_cvt_pk_bf16_f32 v214,v237,v214
v_cvt_pk_bf16_f32 v206,v233,v206
v_cvt_pk_bf16_f32 v210,v234,v208
v_cvt_pk_bf16_f32 v208,v238,v235
M v[180:183],v[216:219],a[204:207],v[180:183]
s_add_u32 s34,s33,1179648
buffer_store_dwordx4 v[152:155],v252,s[24:27],s34 offen offset:1280 nt
v_cvt_pk_bf16_f32 v212,v236,v212
v_lshlrev_b32 v234,16,v209
v_lshlrev_b32 v232,16,v205
v_lshlrev_b32 v233,16,v207
M v[184:187],v[216:219],a[208:211],v[184:187]
ds_read_b128 a[204:207],v250 offset:62208
ds_read_b128 a[208:211],v250 offset:62464
v_lshlrev_b32 v237,16,v215
v_lshlrev_b32 v236,16,v213
v_lshlrev_b32 v235,16,v211
v_fmac_f32 v232,s43,v234
M v[188:191],v[216:219],a[212:215],v[188:191]
s_waitcnt vmcnt(20) lgkmcnt(6)
buffer_load_dwordx4 v[216:219],v251,s[20:23],s48 offen offset:2048 sc1
v_fmac_f32 v237,4.0,v233
v_fma_f32 v238,-4.0,v234,v236
v_fmac_f32 v232,s45,v236
v_fmac_f32 v237,s40,v235
M v[160:163],v[220:223],a[216:219],v[160:163]
s_waitcnt lgkmcnt(5)
ds_read_b128 a[212:215],v250 offset:62720
ds_read_b128 a[216:219],v250 offset:62976
v_sub_f32 v236,v236,v234
v_fma_f32 v234,-4.0,v233,v235
v_sub_f32 v235,v235,v233
v_add_f32 v233,v238,v234
M v[164:167],v[220:223],a[220:223],v[164:167]
s_waitcnt lgkmcnt(6)
s_add_u32 s46,s76,18432
v_sub_f32 v238,v238,v234
v_fma_f32 v234,2.0,v235,v236
v_fmac_f32 v236,-2.0,v235
v_and_b32 v209,s42,v209
M v[168:171],v[220:223],a[192:195],v[168:171]
s_waitcnt lgkmcnt(5)
v_and_b32 v205,s42,v205
v_and_b32 v207,s42,v207
v_and_b32 v215,s42,v215
v_and_b32 v213,s42,v213
M v[172:175],v[220:223],a[196:199],v[172:175]
s_waitcnt lgkmcnt(4)
v_and_b32 v211,s42,v211
v_fmac_f32 v205,s43,v209
v_fmac_f32 v215,4.0,v207
v_fma_f32 v235,-4.0,v209,v213
M v[176:179],v[220:223],a[200:203],v[176:179]
s_waitcnt lgkmcnt(3)
v_fmac_f32 v205,s45,v213
v_fmac_f32 v215,s40,v211
v_sub_f32 v213,v213,v209
v_fma_f32 v209,-4.0,v207,v211
M v[180:183],v[220:223],a[204:207],v[180:183]
s_waitcnt lgkmcnt(2)
v_sub_f32 v211,v211,v207
v_add_f32 v207,v235,v209
v_sub_f32 v235,v235,v209
v_fma_f32 v209,2.0,v211,v213
M v[184:187],v[220:223],a[208:211],v[184:187]
s_waitcnt lgkmcnt(1)
v_fmac_f32 v213,-2.0,v211
v_cvt_pk_bf16_f32 v205,v232,v205
v_cvt_pk_bf16_f32 v215,v237,v215
v_cvt_pk_bf16_f32 v207,v233,v207
M v[188:191],v[220:223],a[212:215],v[188:191]
s_waitcnt vmcnt(20)
buffer_load_dwordx4 v[220:223],v251,s[20:23],s46 offen offset:0 sc1
v_cvt_pk_bf16_f32 v211,v234,v209
v_cvt_pk_bf16_f32 v209,v238,v235
v_cvt_pk_bf16_f32 v213,v236,v213
M v[160:163],v[224:227],a[220:223],v[160:163]
ds_write2st64_b64 v247,v[204:205],v[214:215] offset0:105 offset1:122
M v[164:167],v[224:227],a[192:195],v[164:167]
s_add_u32 s28,s65,6684672
buffer_load_dwordx2 v[204:205],v245,s[12:15],s28 offen offset:0
ds_write2st64_b64 v247,v[206:207],v[208:209] offset0:37 offset1:54
M v[168:171],v[224:227],a[196:199],v[168:171]
s_add_u32 s47,s76,21504
buffer_load_dwordx2 v[214:215],v245,s[16:19],s28 offen offset:1536
M v[172:175],v[224:227],a[200:203],v[172:175]
buffer_load_dwordx2 v[206:207],v245,s[8:11],s28 offen offset:0
ds_write2st64_b64 v247,v[210:211],v[212:213] offset0:71 offset1:88
M v[176:179],v[224:227],a[204:207],v[176:179]
buffer_load_dwordx2 v[208:209],v245,s[8:11],s28 offen offset:384
M v[180:183],v[224:227],a[208:211],v[180:183]
buffer_load_dwordx2 v[210:211],v245,s[8:11],s28 offen offset:768
ds_read_b128 a[220:223],v249 offset:63232
M v[184:187],v[224:227],a[212:215],v[184:187]
s_waitcnt lgkmcnt(0)
s_barrier
buffer_load_dwordx2 v[212:213],v245,s[8:11],s28 offen offset:1152
M v[188:191],v[224:227],a[216:219],v[188:191]
s_waitcnt vmcnt(25)
buffer_load_dwordx4 v[224:227],v251,s[20:23],s47 offen offset:0 sc1
M v[160:163],v[228:231],a[192:195],v[160:163]
ds_read_b128 a[192:195],v249 offset:0
M v[164:167],v[228:231],a[196:199],v[164:167]
s_add_u32 s48,s76,24576
ds_read_b128 a[196:199],v250 offset:256
M v[168:171],v[228:231],a[200:203],v[168:171]
ds_read_b128 a[200:203],v250 offset:512
M v[172:175],v[228:231],a[204:207],v[172:175]
ds_read_b128 a[204:207],v250 offset:768
v_cvt_pk_bf16_f32 v160,v160,v161
M v[176:179],v[228:231],a[208:211],v[176:179]
ds_read_b128 a[208:211],v250 offset:1024
v_cvt_pk_bf16_f32 v161,v162,v163
M v[180:183],v[228:231],a[212:215],v[180:183]
ds_read_b128 a[212:215],v250 offset:1280
v_cvt_pk_bf16_f32 v164,v164,v165
M v[184:187],v[228:231],a[216:219],v[184:187]
s_add_u32 s34,s33,0
buffer_store_dwordx4 v[64:67],v252,s[24:27],s34 offen offset:256 nt
M v[188:191],v[228:231],a[220:223],v[188:191]
s_waitcnt vmcnt(26) lgkmcnt(5)
buffer_load_dwordx4 v[228:231],v251,s[20:23],s48 offen offset:0 sc1
M a[0:3],a[224:227],a[192:195],0
s_waitcnt lgkmcnt(4)
ds_read_b128 a[216:219],v250 offset:1536
ds_read_b128 a[220:223],v250 offset:1792
M a[4:7],a[224:227],a[196:199],0
s_waitcnt lgkmcnt(5)
v_cvt_pk_bf16_f32 v165,v166,v167
M a[8:11],a[224:227],a[200:203],0
s_waitcnt lgkmcnt(4)
ds_write2st64_b64 v253,v[160:161],v[164:165] offset0:204 offset1:208
M a[12:15],a[224:227],a[204:207],0
s_waitcnt lgkmcnt(4)
v_cvt_pk_bf16_f32 v168,v168,v169
v_cvt_pk_bf16_f32 v169,v170,v171
M a[16:19],a[224:227],a[208:211],0
s_waitcnt lgkmcnt(3)
v_cvt_pk_bf16_f32 v172,v172,v173
v_cvt_pk_bf16_f32 v173,v174,v175
M a[20:23],a[224:227],a[212:215],0
s_waitcnt lgkmcnt(2)
ds_write2st64_b64 v253,v[168:169],v[172:173] offset0:212 offset1:216
M a[24:27],a[224:227],a[216:219],0
s_waitcnt lgkmcnt(2)
v_cvt_pk_bf16_f32 v176,v176,v177
v_cvt_pk_bf16_f32 v177,v178,v179
M a[28:31],a[224:227],a[220:223],0
s_waitcnt vmcnt(26)
buffer_load_dwordx4 a[224:227],v251,s[20:23],s46 offen offset:1024 sc1
M a[32:35],a[228:231],a[192:195],0
v_cvt_pk_bf16_f32 v180,v180,v181
v_cvt_pk_bf16_f32 v181,v182,v183
M a[36:39],a[228:231],a[196:199],0
ds_write2st64_b64 v253,v[176:177],v[180:181] offset0:238 offset1:242
M a[40:43],a[228:231],a[200:203],0
v_cvt_pk_bf16_f32 v184,v184,v185
v_cvt_pk_bf16_f32 v185,v186,v187
M a[44:47],a[228:231],a[204:207],0
v_cvt_pk_bf16_f32 v188,v188,v189
v_cvt_pk_bf16_f32 v189,v190,v191
M a[48:51],a[228:231],a[208:211],0
ds_write2st64_b64 v253,v[184:185],v[188:189] offset0:246 offset1:250
M a[52:55],a[228:231],a[212:215],0
s_waitcnt vmcnt(19)
v_lshlrev_b32 v234,16,v196
v_lshlrev_b32 v232,16,v192
M a[56:59],a[228:231],a[216:219],0
v_lshlrev_b32 v233,16,v194
v_lshlrev_b32 v237,16,v202
M a[60:63],a[228:231],a[220:223],0
buffer_load_dwordx4 a[228:231],v251,s[20:23],s47 offen offset:1024 sc1
M a[64:67],a[232:235],a[192:195],0
s_waitcnt vmcnt(17)
ds_read_b128 a[192:195],v250 offset:2048
v_lshlrev_b32 v236,16,v200
M a[68:71],a[232:235],a[196:199],0
v_lshlrev_b32 v235,16,v198
M a[72:75],a[232:235],a[200:203],0
s_waitcnt lgkmcnt(1)
s_barrier
ds_read_b128 v[160:163],v0 offset:34816
M a[76:79],a[232:235],a[204:207],0
ds_read_b128 v[168:171],v0 offset:38912
ds_read_b128 v[176:179],v0 offset:52224
M a[80:83],a[232:235],a[208:211],0
ds_read_b128 v[184:187],v0 offset:56320
v_fmac_f32 v232,s43,v234
M a[84:87],a[232:235],a[212:215],0
v_fmac_f32 v237,4.0,v233
v_fma_f32 v238,-4.0,v234,v236
M a[88:91],a[232:235],a[216:219],0
v_fmac_f32 v232,s45,v236
v_fmac_f32 v237,s40,v235
M a[92:95],a[232:235],a[220:223],0
s_add_u32 s34,s33,393216
buffer_load_dwordx4 a[232:235],v251,s[20:23],s48 offen offset:1024 sc1
M a[0:3],a[236:239],a[196:199],a[0:3]
buffer_store_dwordx4 v[72:75],v252,s[24:27],s34 offen offset:256 nt
M a[4:7],a[236:239],a[200:203],a[4:7]
v_sub_f32 v236,v236,v234
v_fma_f32 v234,-4.0,v233,v235
M a[8:11],a[236:239],a[204:207],a[8:11]
v_sub_f32 v235,v235,v233
v_add_f32 v233,v238,v234
M a[12:15],a[236:239],a[208:211],a[12:15]
v_sub_f32 v238,v238,v234
v_fma_f32 v234,2.0,v235,v236
M a[16:19],a[236:239],a[212:215],a[16:19]
v_fmac_f32 v236,-2.0,v235
v_and_b32 v196,s42,v196
M a[20:23],a[236:239],a[216:219],a[20:23]
v_and_b32 v192,s42,v192
v_and_b32 v194,s42,v194
M a[24:27],a[236:239],a[220:223],a[24:27]
s_waitcnt lgkmcnt(4)
v_and_b32 v202,s42,v202
v_and_b32 v200,s42,v200
M a[28:31],a[236:239],a[192:195],a[28:31]
buffer_load_dwordx4 a[236:239],v251,s[20:23],s46 offen offset:2048 sc1
M a[32:35],a[240:243],a[196:199],a[32:35]
v_and_b32 v198,s42,v198
v_fmac_f32 v192,s43,v196
M a[36:39],a[240:243],a[200:203],a[36:39]
v_fmac_f32 v202,4.0,v194
v_fma_f32 v235,-4.0,v196,v200
M a[40:43],a[240:243],a[204:207],a[40:43]
v_fmac_f32 v192,s45,v200
v_fmac_f32 v202,s40,v198
M a[44:47],a[240:243],a[208:211],a[44:47]
v_sub_f32 v200,v200,v196
v_fma_f32 v196,-4.0,v194,v198
M a[48:51],a[240:243],a[212:215],a[48:51]
v_sub_f32 v198,v198,v194
v_add_f32 v194,v235,v196
M a[52:55],a[240:243],a[216:219],a[52:55]
v_sub_f32 v235,v235,v196
v_fma_f32 v196,2.0,v198,v200
M a[56:59],a[240:243],a[220:223],a[56:59]
v_fmac_f32 v200,-2.0,v198
v_cvt_pk_bf16_f32 v192,v232,v192
M a[60:63],a[240:243],a[192:195],a[60:63]
s_waitcnt vmcnt(19)
buffer_load_dwordx4 a[240:243],v251,s[20:23],s47 offen offset:2048 sc1
M a[64:67],a[244:247],a[196:199],a[64:67]
ds_read_b128 a[196:199],v249 offset:2304
v_cvt_pk_bf16_f32 v202,v237,v202
M a[68:71],a[244:247],a[200:203],a[68:71]
v_cvt_pk_bf16_f32 v194,v233,v194
v_cvt_pk_bf16_f32 v198,v234,v196
M a[72:75],a[244:247],a[204:207],a[72:75]
v_cvt_pk_bf16_f32 v196,v238,v235
v_cvt_pk_bf16_f32 v200,v236,v200
M a[76:79],a[244:247],a[208:211],a[76:79]
v_lshlrev_b32 v234,16,v197
v_lshlrev_b32 v232,16,v193
M a[80:83],a[244:247],a[212:215],a[80:83]
v_lshlrev_b32 v233,16,v195
v_lshlrev_b32 v237,16,v203
M a[84:87],a[244:247],a[216:219],a[84:87]
v_lshlrev_b32 v236,16,v201
v_lshlrev_b32 v235,16,v199
M a[88:91],a[244:247],a[220:223],a[88:91]
v_fmac_f32 v232,s43,v234
v_fmac_f32 v237,4.0,v233
M a[92:95],a[244:247],a[192:195],a[92:95]
s_waitcnt vmcnt(19)
buffer_load_dwordx4 a[244:247],v251,s[20:23],s48 offen offset:2048 sc1
M a[0:3],a[248:251],a[200:203],a[0:3]
s_add_u32 s34,s33,786432
buffer_store_dwordx4 v[80:83],v252,s[24:27],s34 offen offset:256 nt
M a[4:7],a[248:251],a[204:207],a[4:7]
s_add_u32 s46,s76,27648
v_fma_f32 v238,-4.0,v234,v236
v_fmac_f32 v232,s45,v236
M a[8:11],a[248:251],a[208:211],a[8:11]
v_fmac_f32 v237,s40,v235
v_sub_f32 v236,v236,v234
M a[12:15],a[248:251],a[212:215],a[12:15]
v_fma_f32 v234,-4.0,v233,v235
v_sub_f32 v235,v235,v233
M a[16:19],a[248:251],a[216:219],a[16:19]
v_add_f32 v233,v238,v234
v_sub_f32 v238,v238,v234
M a[20:23],a[248:251],a[220:223],a[20:23]
v_fma_f32 v234,2.0,v235,v236
v_fmac_f32 v236,-2.0,v235
M a[24:27],a[248:251],a[192:195],a[24:27]
s_waitcnt lgkmcnt(0)
v_and_b32 v197,s42,v197
v_and_b32 v193,s42,v193
M a[28:31],a[248:251],a[196:199],a[28:31]
s_waitcnt vmcnt(20)
buffer_load_dwordx4 a[248:251],v251,s[20:23],s46 offen offset:0 sc1
M a[32:35],a[252:255],a[200:203],a[32:35]
v_and_b32 v195,s42,v195
v_and_b32 v203,s42,v203
M a[36:39],a[252:255],a[204:207],a[36:39]
s_add_u32 s47,s76,30720
v_and_b32 v201,s42,v201
v_and_b32 v199,s42,v199
M a[40:43],a[252:255],a[208:211],a[40:43]
v_fmac_f32 v193,s43,v197
v_fmac_f32 v203,4.0,v195
M a[44:47],a[252:255],a[212:215],a[44:47]
v_fma_f32 v235,-4.0,v197,v201
v_fmac_f32 v193,s45,v201
M a[48:51],a[252:255],a[216:219],a[48:51]
v_fmac_f32 v203,s40,v199
v_sub_f32 v201,v201,v197
M a[52:55],a[252:255],a[220:223],a[52:55]
v_fma_f32 v197,-4.0,v195,v199
v_sub_f32 v199,v199,v195
M a[56:59],a[252:255],a[192:195],a[56:59]
v_add_f32 v195,v235,v197
v_sub_f32 v235,v235,v197
M a[60:63],a[252:255],a[196:199],a[60:63]
s_waitcnt vmcnt(19)
buffer_load_dwordx4 a[252:255],v251,s[20:23],s47 offen offset:0 sc1
M a[64:67],v[216:219],a[200:203],a[64:67]
ds_read_b128 a[200:203],v249 offset:8704
v_fma_f32 v197,2.0,v199,v201
M a[68:71],v[216:219],a[204:207],a[68:71]
s_add_u32 s48,s76,33792
ds_read_b128 a[204:207],v250 offset:8960
v_fmac_f32 v201,-2.0,v199
M a[72:75],v[216:219],a[208:211],a[72:75]
ds_read_b128 a[208:211],v250 offset:9216
v_cvt_pk_bf16_f32 v193,v232,v193
M a[76:79],v[216:219],a[212:215],a[76:79]
ds_read_b128 a[212:215],v250 offset:9472
v_cvt_pk_bf16_f32 v203,v237,v203
M a[80:83],v[216:219],a[216:219],a[80:83]
ds_read_b128 a[216:219],v250 offset:9728
v_cvt_pk_bf16_f32 v195,v233,v195
M a[84:87],v[216:219],a[220:223],a[84:87]
ds_read_b128 a[220:223],v250 offset:9984
v_cvt_pk_bf16_f32 v199,v234,v197
M a[88:91],v[216:219],a[192:195],a[88:91]
ds_read_b128 a[192:195],v250 offset:10240
v_cvt_pk_bf16_f32 v197,v238,v235
M a[92:95],v[216:219],a[196:199],a[92:95]
s_waitcnt vmcnt(19) lgkmcnt(6)
buffer_load_dwordx4 v[216:219],v251,s[20:23],s48 offen offset:0 sc1
M a[96:99],v[220:223],a[200:203],0
s_waitcnt lgkmcnt(5)
ds_read_b128 a[196:199],v250 offset:10496
v_cvt_pk_bf16_f32 v201,v236,v201
M a[100:103],v[220:223],a[204:207],0
s_waitcnt lgkmcnt(5)
s_add_u32 s34,s33,1179648
buffer_store_dwordx4 v[88:91],v252,s[24:27],s34 offen offset:256 nt
M a[104:107],v[220:223],a[208:211],0
s_waitcnt lgkmcnt(4)
ds_write2st64_b64 v247,v[192:193],v[202:203] offset0:170 offset1:187
M a[108:111],v[220:223],a[212:215],0
s_waitcnt lgkmcnt(4)
s_add_u32 s28,s65,7077888
buffer_load_dwordx2 v[192:193],v245,s[12:15],s28 offen offset:0
M a[112:115],v[220:223],a[216:219],0
s_waitcnt lgkmcnt(3)
buffer_load_dwordx2 v[202:203],v245,s[16:19],s28 offen offset:1536
M a[116:119],v[220:223],a[220:223],0
s_waitcnt lgkmcnt(2)
ds_write2st64_b64 v247,v[194:195],v[196:197] offset0:0 offset1:17
M a[120:123],v[220:223],a[192:195],0
s_waitcnt lgkmcnt(2)
buffer_load_dwordx2 v[194:195],v245,s[8:11],s28 offen offset:0
M a[124:127],v[220:223],a[196:199],0
s_waitcnt vmcnt(17)
buffer_load_dwordx2 v[196:197],v245,s[8:11],s28 offen offset:384
M a[128:131],v[224:227],a[200:203],0
buffer_load_dwordx4 v[220:223],v251,s[20:23],s46 offen offset:1024 sc1
M a[132:135],v[224:227],a[204:207],0
ds_write2st64_b64 v247,v[198:199],v[200:201] offset0:136 offset1:153
M a[136:139],v[224:227],a[208:211],0
buffer_load_dwordx2 v[198:199],v245,s[8:11],s28 offen offset:768
M a[140:143],v[224:227],a[212:215],0
buffer_load_dwordx2 v[200:201],v245,s[8:11],s28 offen offset:1152
M a[144:147],v[224:227],a[216:219],0
v_lshlrev_b32 v234,16,v208
v_lshlrev_b32 v232,16,v204
M a[148:151],v[224:227],a[220:223],0
v_lshlrev_b32 v233,16,v206
v_lshlrev_b32 v237,16,v214
M a[152:155],v[224:227],a[192:195],0
v_lshlrev_b32 v236,16,v212
v_lshlrev_b32 v235,16,v210
M a[156:159],v[224:227],a[196:199],0
s_waitcnt vmcnt(19)
buffer_load_dwordx4 v[224:227],v251,s[20:23],s47 offen offset:1024 sc1
M a[160:163],v[228:231],a[200:203],0
ds_read_b128 a[200:203],v250 offset:10752
v_fmac_f32 v232,s43,v234
M a[164:167],v[228:231],a[204:207],0
v_fmac_f32 v237,4.0,v233
v_fma_f32 v238,-4.0,v234,v236
M a[168:171],v[228:231],a[208:211],0
v_fmac_f32 v232,s45,v236
v_fmac_f32 v237,s40,v235
M a[172:175],v[228:231],a[212:215],0
v_sub_f32 v236,v236,v234
v_fma_f32 v234,-4.0,v233,v235
M a[176:179],v[228:231],a[216:219],0
v_sub_f32 v235,v235,v233
v_add_f32 v233,v238,v234
M a[180:183],v[228:231],a[220:223],0
v_sub_f32 v238,v238,v234
v_fma_f32 v234,2.0,v235,v236
M a[184:187],v[228:231],a[192:195],0
v_fmac_f32 v236,-2.0,v235
v_and_b32 v208,s42,v208
M a[188:191],v[228:231],a[196:199],0
s_waitcnt vmcnt(19)
buffer_load_dwordx4 v[228:231],v251,s[20:23],s48 offen offset:1024 sc1
M a[96:99],a[224:227],a[204:207],a[96:99]
v_and_b32 v204,s42,v204
v_and_b32 v206,s42,v206
M a[100:103],a[224:227],a[208:211],a[100:103]
v_and_b32 v214,s42,v214
v_and_b32 v212,s42,v212
M a[104:107],a[224:227],a[212:215],a[104:107]
s_add_u32 s34,s33,0
buffer_store_dwordx4 v[160:163],v252,s[24:27],s34 offen offset:1408 nt
M a[108:111],a[224:227],a[216:219],a[108:111]
v_and_b32 v210,s42,v210
v_fmac_f32 v204,s43,v208
M a[112:115],a[224:227],a[220:223],a[112:115]
v_fmac_f32 v214,4.0,v206
v_fma_f32 v235,-4.0,v208,v212
M a[116:119],a[224:227],a[192:195],a[116:119]
v_fmac_f32 v204,s45,v212
v_fmac_f32 v214,s40,v210
M a[120:123],a[224:227],a[196:199],a[120:123]
s_waitcnt lgkmcnt(0)
v_sub_f32 v212,v212,v208
v_fma_f32 v208,-4.0,v206,v210
M a[124:127],a[224:227],a[200:203],a[124:127]
s_waitcnt vmcnt(20)
buffer_load_dwordx4 a[224:227],v251,s[20:23],s46 offen offset:2048 sc1
M a[128:131],a[228:231],a[204:207],a[128:131]
v_sub_f32 v210,v210,v206
v_add_f32 v206,v235,v208
M a[132:135],a[228:231],a[208:211],a[132:135]
v_sub_f32 v235,v235,v208
v_fma_f32 v208,2.0,v210,v212
M a[136:139],a[228:231],a[212:215],a[136:139]
v_fmac_f32 v212,-2.0,v210
v_cvt_pk_bf16_f32 v204,v232,v204
M a[140:143],a[228:231],a[216:219],a[140:143]
v_cvt_pk_bf16_f32 v214,v237,v214
v_cvt_pk_bf16_f32 v206,v233,v206
M a[144:147],a[228:231],a[220:223],a[144:147]
v_cvt_pk_bf16_f32 v210,v234,v208
v_cvt_pk_bf16_f32 v208,v238,v235
M a[148:151],a[228:231],a[192:195],a[148:151]
v_cvt_pk_bf16_f32 v212,v236,v212
v_lshlrev_b32 v234,16,v209
M a[152:155],a[228:231],a[196:199],a[152:155]
v_lshlrev_b32 v232,16,v205
v_lshlrev_b32 v233,16,v207
M a[156:159],a[228:231],a[200:203],a[156:159]
s_waitcnt vmcnt(20)
buffer_load_dwordx4 a[228:231],v251,s[20:23],s47 offen offset:2048 sc1
M a[160:163],a[232:235],a[204:207],a[160:163]
ds_read_b128 a[204:207],v249 offset:11008
v_lshlrev_b32 v237,16,v215
M a[164:167],a[232:235],a[208:211],a[164:167]
v_lshlrev_b32 v236,16,v213
v_lshlrev_b32 v235,16,v211
M a[168:171],a[232:235],a[212:215],a[168:171]
v_fmac_f32 v232,s43,v234
v_fmac_f32 v237,4.0,v233
M a[172:175],a[232:235],a[216:219],a[172:175]
v_fma_f32 v238,-4.0,v234,v236
v_fmac_f32 v232,s45,v236
M a[176:179],a[232:235],a[220:223],a[176:179]
v_fmac_f32 v237,s40,v235
v_sub_f32 v236,v236,v234
M a[180:183],a[232:235],a[192:195],a[180:183]
v_fma_f32 v234,-4.0,v233,v235
v_sub_f32 v235,v235,v233
M a[184:187],a[232:235],a[196:199],a[184:187]
v_add_f32 v233,v238,v234
v_sub_f32 v238,v238,v234
M a[188:191],a[232:235],a[200:203],a[188:191]
s_waitcnt vmcnt(19)
buffer_load_dwordx4 a[232:235],v251,s[20:23],s48 offen offset:2048 sc1
M a[96:99],a[236:239],a[208:211],a[96:99]
v_fma_f32 v234,2.0,v235,v236
v_fmac_f32 v236,-2.0,v235
M a[100:103],a[236:239],a[212:215],a[100:103]
s_add_u32 s46,s76,36864
v_and_b32 v209,s42,v209
v_and_b32 v205,s42,v205
M a[104:107],a[236:239],a[216:219],a[104:107]
v_and_b32 v207,s42,v207
v_and_b32 v215,s42,v215
M a[108:111],a[236:239],a[220:223],a[108:111]
s_add_u32 s34,s33,393216
buffer_store_dwordx4 v[168:171],v252,s[24:27],s34 offen offset:1408 nt
M a[112:115],a[236:239],a[192:195],a[112:115]
v_and_b32 v213,s42,v213
v_and_b32 v211,s42,v211
M a[116:119],a[236:239],a[196:199],a[116:119]
v_fmac_f32 v205,s43,v209
v_fmac_f32 v215,4.0,v207
M a[120:123],a[236:239],a[200:203],a[120:123]
s_waitcnt lgkmcnt(0)
v_fma_f32 v235,-4.0,v209,v213
v_fmac_f32 v205,s45,v213
M a[124:127],a[236:239],a[204:207],a[124:127]
s_waitcnt vmcnt(20)
buffer_load_dwordx4 a[236:239],v251,s[20:23],s46 offen offset:0 sc1
M a[128:131],a[240:243],a[208:211],a[128:131]
v_fmac_f32 v215,s40,v211
v_sub_f32 v213,v213,v209
M a[132:135],a[240:243],a[212:215],a[132:135]
s_add_u32 s47,s76,39936
v_fma_f32 v209,-4.0,v207,v211
v_sub_f32 v211,v211,v207
M a[136:139],a[240:243],a[216:219],a[136:139]
v_add_f32 v207,v235,v209
v_sub_f32 v235,v235,v209
M a[140:143],a[240:243],a[220:223],a[140:143]
v_fma_f32 v209,2.0,v211,v213
v_fmac_f32 v213,-2.0,v211
M a[144:147],a[240:243],a[192:195],a[144:147]
v_cvt_pk_bf16_f32 v205,v232,v205
v_cvt_pk_bf16_f32 v215,v237,v215
M a[148:151],a[240:243],a[196:199],a[148:151]
v_cvt_pk_bf16_f32 v207,v233,v207
v_cvt_pk_bf16_f32 v211,v234,v209
M a[152:155],a[240:243],a[200:203],a[152:155]
v_cvt_pk_bf16_f32 v209,v238,v235
v_cvt_pk_bf16_f32 v213,v236,v213
M a[156:159],a[240:243],a[204:207],a[156:159]
s_waitcnt vmcnt(20)
buffer_load_dwordx4 a[240:243],v251,s[20:23],s47 offen offset:0 sc1
M a[160:163],a[244:247],a[208:211],a[160:163]
ds_read_b128 a[208:211],v249 offset:17408
ds_write2st64_b64 v247,v[204:205],v[214:215] offset0:171 offset1:188
M a[164:167],a[244:247],a[212:215],a[164:167]
s_add_u32 s28,s65,7471104
buffer_load_dwordx2 v[204:205],v245,s[12:15],s28 offen offset:0
M a[168:171],a[244:247],a[216:219],a[168:171]
s_add_u32 s48,s76,43008
buffer_load_dwordx2 v[214:215],v245,s[16:19],s28 offen offset:1536
M a[172:175],a[244:247],a[220:223],a[172:175]
ds_read_b128 a[212:215],v250 offset:17664
ds_read_b128 a[216:219],v250 offset:17920
M a[176:179],a[244:247],a[192:195],a[176:179]
ds_read_b128 a[220:223],v250 offset:18176
ds_read_b128 a[192:195],v250 offset:18432
M a[180:183],a[244:247],a[196:199],a[180:183]
ds_read_b128 a[196:199],v250 offset:18688
ds_write2st64_b64 v247,v[206:207],v[208:209] offset0:1 offset1:18
M a[184:187],a[244:247],a[200:203],a[184:187]
buffer_load_dwordx2 v[206:207],v245,s[8:11],s28 offen offset:0
M a[188:191],a[244:247],a[204:207],a[188:191]
s_waitcnt vmcnt(22) lgkmcnt(7)
buffer_load_dwordx2 v[208:209],v245,s[8:11],s28 offen offset:384
M v[0:3],a[248:251],a[208:211],0
s_waitcnt lgkmcnt(5)
buffer_load_dwordx4 a[244:247],v251,s[20:23],s48 offen offset:0 sc1
M v[4:7],a[248:251],a[212:215],0
s_waitcnt lgkmcnt(4)
ds_read_b128 a[200:203],v250 offset:18944
ds_read_b128 a[204:207],v250 offset:19200
M v[8:11],a[248:251],a[216:219],0
s_waitcnt lgkmcnt(5)
ds_write2st64_b64 v247,v[210:211],v[212:213] offset0:137 offset1:154
M v[12:15],a[248:251],a[220:223],0
s_waitcnt lgkmcnt(5)
buffer_load_dwordx2 v[210:211],v245,s[8:11],s28 offen offset:768
M v[16:19],a[248:251],a[192:195],0
s_waitcnt lgkmcnt(4)
s_add_u32 s34,s33,786432
buffer_load_dwordx2 v[212:213],v245,s[8:11],s28 offen offset:1152
M v[20:23],a[248:251],a[196:199],0
s_waitcnt lgkmcnt(2)
buffer_store_dwordx4 v[176:179],v252,s[24:27],s34 offen offset:1408 nt
M v[24:27],a[248:251],a[200:203],0
s_waitcnt lgkmcnt(1)
v_fmac_f32 v239,s43,v241
v_fmac_f32 v244,4.0,v240
M v[28:31],a[248:251],a[204:207],0
s_waitcnt vmcnt(26)
buffer_load_dwordx4 a[248:251],v251,s[20:23],s46 offen offset:1024 sc1
M v[32:35],a[252:255],a[208:211],0
v_fma_f32 v232,-4.0,v241,v243
v_fmac_f32 v239,s45,v243
M v[36:39],a[252:255],a[212:215],0
v_fmac_f32 v244,s40,v242
v_sub_f32 v243,v243,v241
M v[40:43],a[252:255],a[216:219],0
v_fma_f32 v241,-4.0,v240,v242
v_sub_f32 v242,v242,v240
M v[44:47],a[252:255],a[220:223],0
v_add_f32 v240,v232,v241
v_sub_f32 v232,v232,v241
M v[48:51],a[252:255],a[192:195],0
v_fma_f32 v241,2.0,v242,v243
v_fmac_f32 v243,-2.0,v242
M v[52:55],a[252:255],a[196:199],0
v_cvt_pk_bf16_f32 v233,v239,v244
v_cvt_pk_bf16_f32 v234,v240,v232
M v[56:59],a[252:255],a[200:203],0
v_cvt_pk_bf16_f32 v235,v241,v243
v_add_u32 v232,87040,v248
M v[60:63],a[252:255],a[204:207],0
s_waitcnt vmcnt(26)
buffer_load_short_d16_hi v239,v246,s[12:15],s72 offen offset:0
M v[64:67],v[216:219],a[208:211],0
buffer_load_short_d16_hi v240,v246,s[8:11],s72 offen offset:0
M v[68:71],v[216:219],a[212:215],0
buffer_load_short_d16_hi v241,v246,s[8:11],s72 offen offset:384
M v[72:75],v[216:219],a[216:219],0
buffer_load_short_d16_hi v242,v246,s[8:11],s72 offen offset:768
M v[76:79],v[216:219],a[220:223],0
buffer_load_short_d16_hi v243,v246,s[8:11],s72 offen offset:1152
M v[80:83],v[216:219],a[192:195],0
buffer_load_short_d16_hi v244,v246,s[16:19],s72 offen offset:1536
M v[84:87],v[216:219],a[196:199],0
buffer_load_dwordx4 a[252:255],v251,s[20:23],s47 offen offset:1024 sc1
M v[88:91],v[216:219],a[200:203],0
ds_read_b128 a[208:211],v250 offset:19456
ds_write_b16 v232,v233 offset:0
M v[92:95],v[216:219],a[204:207],0
s_waitcnt vmcnt(27)
buffer_load_dwordx4 v[216:219],v251,s[20:23],s48 offen offset:1024 sc1
M v[0:3],v[220:223],a[212:215],v[0:3]
ds_write_b16_d16_hi v232,v233 offset:8704
M v[4:7],v[220:223],a[216:219],v[4:7]
ds_write_b16 v248,v234 offset:0
M v[8:11],v[220:223],a[220:223],v[8:11]
ds_write_b16_d16_hi v248,v234 offset:8704
M v[12:15],v[220:223],a[192:195],v[12:15]
v_add_u32 v232,69632,v248
M v[16:19],v[220:223],a[196:199],v[16:19]
ds_write_b16 v232,v235 offset:0
M v[20:23],v[220:223],a[200:203],v[20:23]
s_add_u32 s34,s33,1179648
buffer_store_dwordx4 v[184:187],v252,s[24:27],s34 offen offset:1408 nt
M v[24:27],v[220:223],a[204:207],v[24:27]
s_waitcnt lgkmcnt(5)
ds_write_b16_d16_hi v232,v235 offset:8704
M v[28:31],v[220:223],a[208:211],v[28:31]
s_waitcnt vmcnt(26)
buffer_load_dwordx4 v[220:223],v251,s[20:23],s46 offen offset:2048 sc1
M v[32:35],v[224:227],a[212:215],v[32:35]
v_lshlrev_b32 v234,16,v196
v_lshlrev_b32 v232,16,v192
M v[36:39],v[224:227],a[216:219],v[36:39]
v_lshlrev_b32 v233,16,v194
v_lshlrev_b32 v237,16,v202
M v[40:43],v[224:227],a[220:223],v[40:43]
v_lshlrev_b32 v236,16,v200
v_lshlrev_b32 v235,16,v198
M v[44:47],v[224:227],a[192:195],v[44:47]
v_fmac_f32 v232,s43,v234
v_fmac_f32 v237,4.0,v233
M v[48:51],v[224:227],a[196:199],v[48:51]
v_fma_f32 v238,-4.0,v234,v236
v_fmac_f32 v232,s45,v236
M v[52:55],v[224:227],a[200:203],v[52:55]
v_fmac_f32 v237,s40,v235
v_sub_f32 v236,v236,v234
M v[56:59],v[224:227],a[204:207],v[56:59]
v_fma_f32 v234,-4.0,v233,v235
v_sub_f32 v235,v235,v233
M v[60:63],v[224:227],a[208:211],v[60:63]
s_waitcnt vmcnt(26)
buffer_load_dwordx4 v[224:227],v251,s[20:23],s47 offen offset:2048 sc1
M v[64:67],v[228:231],a[212:215],v[64:67]
ds_read_b128 a[212:215],v249 offset:19712
v_add_f32 v233,v238,v234
M v[68:71],v[228:231],a[216:219],v[68:71]
v_sub_f32 v238,v238,v234
v_fma_f32 v234,2.0,v235,v236
M v[72:75],v[228:231],a[220:223],v[72:75]
v_fmac_f32 v236,-2.0,v235
v_and_b32 v196,s42,v196
M v[76:79],v[228:231],a[192:195],v[76:79]
v_and_b32 v192,s42,v192
v_and_b32 v194,s42,v194
M v[80:83],v[228:231],a[196:199],v[80:83]
v_and_b32 v202,s42,v202
v_and_b32 v200,s42,v200
M v[84:87],v[228:231],a[200:203],v[84:87]
v_and_b32 v198,s42,v198
v_fmac_f32 v192,s43,v196
M v[88:91],v[228:231],a[204:207],v[88:91]
v_fmac_f32 v202,4.0,v194
v_fma_f32 v235,-4.0,v196,v200
M v[92:95],v[228:231],a[208:211],v[92:95]
s_waitcnt vmcnt(25)
buffer_load_dwordx4 v[228:231],v251,s[20:23],s48 offen offset:2048 sc1
M v[0:3],a[224:227],a[216:219],v[0:3]
v_fmac_f32 v192,s45,v200
v_fmac_f32 v202,s40,v198
M v[4:7],a[224:227],a[220:223],v[4:7]
s_add_u32 s46,s77,9216
v_sub_f32 v200,v200,v196
v_fma_f32 v196,-4.0,v194,v198
M v[8:11],a[224:227],a[192:195],v[8:11]
v_sub_f32 v198,v198,v194
v_add_f32 v194,v235,v196
M v[12:15],a[224:227],a[196:199],v[12:15]
v_sub_f32 v235,v235,v196
v_fma_f32 v196,2.0,v198,v200
M v[16:19],a[224:227],a[200:203],v[16:19]
v_fmac_f32 v200,-2.0,v198
v_cvt_pk_bf16_f32 v192,v232,v192
M v[20:23],a[224:227],a[204:207],v[20:23]
v_cvt_pk_bf16_f32 v202,v237,v202
v_cvt_pk_bf16_f32 v194,v233,v194
M v[24:27],a[224:227],a[208:211],v[24:27]
s_waitcnt lgkmcnt(0)
v_cvt_pk_bf16_f32 v198,v234,v196
v_cvt_pk_bf16_f32 v196,v238,v235
M v[28:31],a[224:227],a[212:215],v[28:31]
s_waitcnt vmcnt(25)
buffer_load_dwordx4 a[224:227],v251,s[20:23],s46 offen offset:0 sc1
M v[32:35],a[228:231],a[216:219],v[32:35]
v_cvt_pk_bf16_f32 v200,v236,v200
v_lshlrev_b32 v234,16,v197
M v[36:39],a[228:231],a[220:223],v[36:39]
s_add_u32 s47,s77,12288
v_lshlrev_b32 v232,16,v193
v_lshlrev_b32 v233,16,v195
M v[40:43],a[228:231],a[192:195],v[40:43]
v_lshlrev_b32 v237,16,v203
v_lshlrev_b32 v236,16,v201
M v[44:47],a[228:231],a[196:199],v[44:47]
v_lshlrev_b32 v235,16,v199
v_fmac_f32 v232,s43,v234
M v[48:51],a[228:231],a[200:203],v[48:51]
v_fmac_f32 v237,4.0,v233
v_fma_f32 v238,-4.0,v234,v236
M v[52:55],a[228:231],a[204:207],v[52:55]
v_fmac_f32 v232,s45,v236
v_fmac_f32 v237,s40,v235
M v[56:59],a[228:231],a[208:211],v[56:59]
v_sub_f32 v236,v236,v234
v_fma_f32 v234,-4.0,v233,v235
M v[60:63],a[228:231],a[212:215],v[60:63]
s_waitcnt vmcnt(25)
buffer_load_dwordx4 a[228:231],v251,s[20:23],s47 offen offset:0 sc1
M v[64:67],a[232:235],a[216:219],v[64:67]
ds_read_b128 a[216:219],v249 offset:26112
v_sub_f32 v235,v235,v233
M v[68:71],a[232:235],a[220:223],v[68:71]
s_add_u32 s48,s77,15360
ds_read_b128 a[220:223],v250 offset:26368
v_add_f32 v233,v238,v234
M v[72:75],a[232:235],a[192:195],v[72:75]
ds_read_b128 a[192:195],v250 offset:26624
v_sub_f32 v238,v238,v234
M v[76:79],a[232:235],a[196:199],v[76:79]
ds_read_b128 a[196:199],v250 offset:26880
v_fma_f32 v234,2.0,v235,v236
M v[80:83],a[232:235],a[200:203],v[80:83]
ds_read_b128 a[200:203],v250 offset:27136
v_fmac_f32 v236,-2.0,v235
M v[84:87],a[232:235],a[204:207],v[84:87]
ds_read_b128 a[204:207],v250 offset:27392
v_and_b32 v197,s42,v197
M v[88:91],a[232:235],a[208:211],v[88:91]
ds_read_b128 a[208:211],v250 offset:27648
v_and_b32 v193,s42,v193
M v[92:95],a[232:235],a[212:215],v[92:95]
s_waitcnt vmcnt(24) lgkmcnt(6)
buffer_load_dwordx4 a[232:235],v251,s[20:23],s48 offen offset:0 sc1
M v[96:99],a[236:239],a[216:219],0
s_waitcnt lgkmcnt(5)
ds_read_b128 a[212:215],v250 offset:27904
v_and_b32 v195,s42,v195
M v[100:103],a[236:239],a[220:223],0
s_waitcnt lgkmcnt(5)
v_and_b32 v203,s42,v203
v_and_b32 v201,s42,v201
M v[104:107],a[236:239],a[192:195],0
s_waitcnt lgkmcnt(4)
v_and_b32 v199,s42,v199
v_fmac_f32 v193,s43,v197
M v[108:111],a[236:239],a[196:199],0
s_waitcnt lgkmcnt(3)
v_fmac_f32 v203,4.0,v195
v_fma_f32 v235,-4.0,v197,v201
M v[112:115],a[236:239],a[200:203],0
s_waitcnt lgkmcnt(2)
v_fmac_f32 v193,s45,v201
v_fmac_f32 v203,s40,v199
M v[116:119],a[236:239],a[204:207],0
s_waitcnt lgkmcnt(1)
v_sub_f32 v201,v201,v197
v_fma_f32 v197,-4.0,v195,v199
M v[120:123],a[236:239],a[208:211],0
s_waitcnt lgkmcnt(0)
v_sub_f32 v199,v199,v195
v_add_f32 v195,v235,v197
M v[124:127],a[236:239],a[212:215],0
s_waitcnt vmcnt(24)
buffer_load_dwordx4 a[236:239],v251,s[20:23],s46 offen offset:1024 sc1
M v[128:131],a[240:243],a[216:219],0
v_sub_f32 v235,v235,v197
v_fma_f32 v197,2.0,v199,v201
M v[132:135],a[240:243],a[220:223],0
v_fmac_f32 v201,-2.0,v199
v_cvt_pk_bf16_f32 v193,v232,v193
M v[136:139],a[240:243],a[192:195],0
v_cvt_pk_bf16_f32 v203,v237,v203
v_cvt_pk_bf16_f32 v195,v233,v195
M v[140:143],a[240:243],a[196:199],0
v_cvt_pk_bf16_f32 v199,v234,v197
v_cvt_pk_bf16_f32 v197,v238,v235
M v[144:147],a[240:243],a[200:203],0
v_cvt_pk_bf16_f32 v201,v236,v201
M v[148:151],a[240:243],a[204:207],0
ds_write2st64_b64 v247,v[192:193],v[202:203] offset0:172 offset1:189
M v[152:155],a[240:243],a[208:211],0
s_add_u32 s28,s66,6291456
buffer_load_dwordx2 v[192:193],v245,s[12:15],s28 offen offset:0
M v[156:159],a[240:243],a[212:215],0
s_waitcnt vmcnt(21)
buffer_load_dwordx2 v[202:203],v245,s[16:19],s28 offen offset:1536
M v[160:163],a[244:247],a[216:219],0
buffer_load_dwordx4 a[240:243],v251,s[20:23],s47 offen offset:1024 sc1
M v[164:167],a[244:247],a[220:223],0
ds_read_b128 a[216:219],v250 offset:28160
ds_write2st64_b64 v247,v[194:195],v[196:197] offset0:2 offset1:19
M v[168:171],a[244:247],a[192:195],0
buffer_load_dwordx2 v[194:195],v245,s[8:11],s28 offen offset:0
M v[172:175],a[244:247],a[196:199],0
buffer_load_dwordx2 v[196:197],v245,s[8:11],s28 offen offset:384
M v[176:179],a[244:247],a[200:203],0
ds_write2st64_b64 v247,v[198:199],v[200:201] offset0:138 offset1:155
M v[180:183],a[244:247],a[204:207],0
buffer_load_dwordx2 v[198:199],v245,s[8:11],s28 offen offset:768
M v[184:187],a[244:247],a[208:211],0
buffer_load_dwordx2 v[200:201],v245,s[8:11],s28 offen offset:1152
M v[188:191],a[244:247],a[212:215],0
s_waitcnt vmcnt(23)
buffer_load_dwordx4 a[244:247],v251,s[20:23],s48 offen offset:1024 sc1
M v[96:99],a[248:251],a[220:223],v[96:99]
v_lshlrev_b32 v234,16,v208
v_lshlrev_b32 v232,16,v204
M v[100:103],a[248:251],a[192:195],v[100:103]
v_lshlrev_b32 v233,16,v206
v_lshlrev_b32 v237,16,v214
M v[104:107],a[248:251],a[196:199],v[104:107]
v_lshlrev_b32 v236,16,v212
v_lshlrev_b32 v235,16,v210
M v[108:111],a[248:251],a[200:203],v[108:111]
v_fmac_f32 v232,s43,v234
v_fmac_f32 v237,4.0,v233
M v[112:115],a[248:251],a[204:207],v[112:115]
v_fma_f32 v238,-4.0,v234,v236
v_fmac_f32 v232,s45,v236
M v[116:119],a[248:251],a[208:211],v[116:119]
v_fmac_f32 v237,s40,v235
v_sub_f32 v236,v236,v234
M v[120:123],a[248:251],a[212:215],v[120:123]
s_waitcnt lgkmcnt(2)
v_fma_f32 v234,-4.0,v233,v235
v_sub_f32 v235,v235,v233
M v[124:127],a[248:251],a[216:219],v[124:127]
s_waitcnt vmcnt(17)
buffer_load_dwordx4 a[248:251],v251,s[20:23],s46 offen offset:2048 sc1
M v[128:131],a[252:255],a[220:223],v[128:131]
v_add_f32 v233,v238,v234
v_sub_f32 v238,v238,v234
M v[132:135],a[252:255],a[192:195],v[132:135]
v_fma_f32 v234,2.0,v235,v236
v_fmac_f32 v236,-2.0,v235
M v[136:139],a[252:255],a[196:199],v[136:139]
v_and_b32 v208,s42,v208
v_and_b32 v204,s42,v204
M v[140:143],a[252:255],a[200:203],v[140:143]
v_and_b32 v206,s42,v206
v_and_b32 v214,s42,v214
M v[144:147],a[252:255],a[204:207],v[144:147]
v_and_b32 v212,s42,v212
v_and_b32 v210,s42,v210
M v[148:151],a[252:255],a[208:211],v[148:151]
v_fmac_f32 v204,s43,v208
v_fmac_f32 v214,4.0,v206
M v[152:155],a[252:255],a[212:215],v[152:155]
v_fma_f32 v235,-4.0,v208,v212
v_fmac_f32 v204,s45,v212
M v[156:159],a[252:255],a[216:219],v[156:159]
s_waitcnt vmcnt(17)
buffer_load_dwordx4 a[252:255],v251,s[20:23],s47 offen offset:2048 sc1
M v[160:163],v[216:219],a[220:223],v[160:163]
ds_read_b128 a[220:223],v249 offset:28416
v_fmac_f32 v214,s40,v210
M v[164:167],v[216:219],a[192:195],v[164:167]
v_sub_f32 v212,v212,v208
v_fma_f32 v208,-4.0,v206,v210
M v[168:171],v[216:219],a[196:199],v[168:171]
v_sub_f32 v210,v210,v206
v_add_f32 v206,v235,v208
M v[172:175],v[216:219],a[200:203],v[172:175]
v_sub_f32 v235,v235,v208
v_fma_f32 v208,2.0,v210,v212
v_fmac_f32 v212,-2.0,v210
v_cvt_pk_bf16_f32 v204,v232,v204
M v[176:179],v[216:219],a[204:207],v[176:179]
v_cvt_pk_bf16_f32 v214,v237,v214
v_cvt_pk_bf16_f32 v206,v233,v206
v_cvt_pk_bf16_f32 v210,v234,v208
v_cvt_pk_bf16_f32 v208,v238,v235
M v[180:183],v[216:219],a[208:211],v[180:183]
v_cvt_pk_bf16_f32 v212,v236,v212
v_lshlrev_b32 v234,16,v209
v_lshlrev_b32 v232,16,v205
v_lshlrev_b32 v233,16,v207
M v[184:187],v[216:219],a[212:215],v[184:187]
v_lshlrev_b32 v237,16,v215
v_lshlrev_b32 v236,16,v213
v_lshlrev_b32 v235,16,v211
v_fmac_f32 v232,s43,v234
M v[188:191],v[216:219],a[216:219],v[188:191]
s_waitcnt vmcnt(16)
buffer_load_dwordx4 v[216:219],v251,s[20:23],s48 offen offset:2048 sc1
v_fmac_f32 v237,4.0,v233
v_fma_f32 v238,-4.0,v234,v236
v_fmac_f32 v232,s45,v236
v_fmac_f32 v237,s40,v235
M v[96:99],v[220:223],a[192:195],v[96:99]
v_sub_f32 v236,v236,v234
v_fma_f32 v234,-4.0,v233,v235
v_sub_f32 v235,v235,v233
v_add_f32 v233,v238,v234
M v[100:103],v[220:223],a[196:199],v[100:103]
s_add_u32 s46,s77,18432
v_sub_f32 v238,v238,v234
v_fma_f32 v234,2.0,v235,v236
v_fmac_f32 v236,-2.0,v235
v_and_b32 v209,s42,v209
M v[104:107],v[220:223],a[200:203],v[104:107]
v_and_b32 v205,s42,v205
v_and_b32 v207,s42,v207
v_and_b32 v215,s42,v215
v_and_b32 v213,s42,v213
M v[108:111],v[220:223],a[204:207],v[108:111]
v_and_b32 v211,s42,v211
v_fmac_f32 v205,s43,v209
v_fmac_f32 v215,4.0,v207
v_fma_f32 v235,-4.0,v209,v213
M v[112:115],v[220:223],a[208:211],v[112:115]
v_fmac_f32 v205,s45,v213
v_fmac_f32 v215,s40,v211
v_sub_f32 v213,v213,v209
v_fma_f32 v209,-4.0,v207,v211
M v[116:119],v[220:223],a[212:215],v[116:119]
v_sub_f32 v211,v211,v207
v_add_f32 v207,v235,v209
v_sub_f32 v235,v235,v209
v_fma_f32 v209,2.0,v211,v213
M v[120:123],v[220:223],a[216:219],v[120:123]
s_waitcnt lgkmcnt(0)
v_fmac_f32 v213,-2.0,v211
v_cvt_pk_bf16_f32 v205,v232,v205
v_cvt_pk_bf16_f32 v215,v237,v215
v_cvt_pk_bf16_f32 v207,v233,v207
M v[124:127],v[220:223],a[220:223],v[124:127]
s_waitcnt vmcnt(16)
buffer_load_dwordx4 v[220:223],v251,s[20:23],s46 offen offset:0 sc1
v_cvt_pk_bf16_f32 v211,v234,v209
v_cvt_pk_bf16_f32 v209,v238,v235
v_cvt_pk_bf16_f32 v213,v236,v213
M v[128:131],v[224:227],a[192:195],v[128:131]
ds_write2st64_b64 v247,v[204:205],v[214:215] offset0:173 offset1:190
M v[132:135],v[224:227],a[196:199],v[132:135]
s_add_u32 s28,s66,6684672
buffer_load_dwordx2 v[204:205],v245,s[12:15],s28 offen offset:0
ds_write2st64_b64 v247,v[206:207],v[208:209] offset0:3 offset1:20
M v[136:139],v[224:227],a[200:203],v[136:139]
s_add_u32 s47,s77,21504
buffer_load_dwordx2 v[214:215],v245,s[16:19],s28 offen offset:1536
M v[140:143],v[224:227],a[204:207],v[140:143]
buffer_load_dwordx2 v[206:207],v245,s[8:11],s28 offen offset:0
ds_write2st64_b64 v247,v[210:211],v[212:213] offset0:139 offset1:156
M v[144:147],v[224:227],a[208:211],v[144:147]
buffer_load_dwordx2 v[208:209],v245,s[8:11],s28 offen offset:384
M v[148:151],v[224:227],a[212:215],v[148:151]
buffer_load_dwordx2 v[210:211],v245,s[8:11],s28 offen offset:768
M v[152:155],v[224:227],a[216:219],v[152:155]
s_waitcnt lgkmcnt(0)
s_barrier
v_add_u32 v249,0xffffbc00,v249
M v[156:159],v[224:227],a[220:223],v[156:159]
s_waitcnt vmcnt(21)
buffer_load_dwordx2 v[212:213],v245,s[8:11],s28 offen offset:1152
M v[160:163],v[228:231],a[192:195],v[160:163]
buffer_load_dwordx4 v[224:227],v251,s[20:23],s47 offen offset:0 sc1
M v[164:167],v[228:231],a[196:199],v[164:167]
s_waitcnt vmcnt(14)
s_add_u32 s48,s77,24576
v_add_u32 v250,0xffffbc00,v250
v_lshlrev_b32 v234,16,v196
M v[168:171],v[228:231],a[200:203],v[168:171]
ds_read_b128 a[192:195],v249 offset:0
ds_read_b128 a[196:199],v250 offset:256
M v[172:175],v[228:231],a[204:207],v[172:175]
ds_read_b128 a[200:203],v250 offset:512
ds_read_b128 a[204:207],v250 offset:768
M v[176:179],v[228:231],a[208:211],v[176:179]
ds_read_b128 a[208:211],v250 offset:1024
v_lshlrev_b32 v232,16,v192
M v[180:183],v[228:231],a[212:215],v[180:183]
ds_read_b128 a[212:215],v250 offset:1280
v_lshlrev_b32 v233,16,v194
M v[184:187],v[228:231],a[216:219],v[184:187]
ds_read_b128 a[216:219],v250 offset:1536
v_lshlrev_b32 v237,16,v202
M v[188:191],v[228:231],a[220:223],v[188:191]
s_waitcnt lgkmcnt(6)
buffer_load_dwordx4 v[228:231],v251,s[20:23],s48 offen offset:0 sc1
M a[0:3],a[224:227],a[192:195],a[0:3]
s_waitcnt vmcnt(13) lgkmcnt(5)
ds_read_b128 a[220:223],v250 offset:1792
v_lshlrev_b32 v236,16,v200
M a[4:7],a[224:227],a[196:199],a[4:7]
s_waitcnt lgkmcnt(5)
v_lshlrev_b32 v235,16,v198
v_fmac_f32 v232,s43,v234
M a[8:11],a[224:227],a[200:203],a[8:11]
s_waitcnt lgkmcnt(4)
v_fmac_f32 v237,4.0,v233
v_fma_f32 v238,-4.0,v234,v236
M a[12:15],a[224:227],a[204:207],a[12:15]
s_waitcnt lgkmcnt(3)
v_fmac_f32 v232,s45,v236
v_fmac_f32 v237,s40,v235
M a[16:19],a[224:227],a[208:211],a[16:19]
s_waitcnt lgkmcnt(2)
v_sub_f32 v236,v236,v234
v_fma_f32 v234,-4.0,v233,v235
M a[20:23],a[224:227],a[212:215],a[20:23]
s_waitcnt lgkmcnt(1)
v_sub_f32 v235,v235,v233
v_add_f32 v233,v238,v234
M a[24:27],a[224:227],a[216:219],a[24:27]
s_waitcnt lgkmcnt(0)
v_sub_f32 v238,v238,v234
v_fma_f32 v234,2.0,v235,v236
M a[28:31],a[224:227],a[220:223],a[28:31]
buffer_load_dwordx4 a[224:227],v251,s[20:23],s46 offen offset:1024 sc1
M a[32:35],a[228:231],a[192:195],a[32:35]
v_fmac_f32 v236,-2.0,v235
v_and_b32 v196,s42,v196
M a[36:39],a[228:231],a[196:199],a[36:39]
v_and_b32 v192,s42,v192
v_and_b32 v194,s42,v194
M a[40:43],a[228:231],a[200:203],a[40:43]
v_and_b32 v202,s42,v202
v_and_b32 v200,s42,v200
M a[44:47],a[228:231],a[204:207],a[44:47]
v_and_b32 v198,s42,v198
v_fmac_f32 v192,s43,v196
M a[48:51],a[228:231],a[208:211],a[48:51]
v_fmac_f32 v202,4.0,v194
v_fma_f32 v235,-4.0,v196,v200
M a[52:55],a[228:231],a[212:215],a[52:55]
v_fmac_f32 v192,s45,v200
v_fmac_f32 v202,s40,v198
M a[56:59],a[228:231],a[216:219],a[56:59]
v_sub_f32 v200,v200,v196
v_fma_f32 v196,-4.0,v194,v198
M a[60:63],a[228:231],a[220:223],a[60:63]
buffer_load_dwordx4 a[228:231],v251,s[20:23],s47 offen offset:1024 sc1
M a[64:67],a[232:235],a[192:195],a[64:67]
ds_read_b128 a[192:195],v250 offset:2048
v_sub_f32 v198,v198,v194
M a[68:71],a[232:235],a[196:199],a[68:71]
v_add_f32 v194,v235,v196
v_sub_f32 v235,v235,v196
M a[72:75],a[232:235],a[200:203],a[72:75]
v_fma_f32 v196,2.0,v198,v200
v_fmac_f32 v200,-2.0,v198
M a[76:79],a[232:235],a[204:207],a[76:79]
v_cvt_pk_bf16_f32 v192,v232,v192
v_cvt_pk_bf16_f32 v202,v237,v202
M a[80:83],a[232:235],a[208:211],a[80:83]
v_cvt_pk_bf16_f32 v194,v233,v194
v_cvt_pk_bf16_f32 v198,v234,v196
M a[84:87],a[232:235],a[212:215],a[84:87]
v_cvt_pk_bf16_f32 v196,v238,v235
v_cvt_pk_bf16_f32 v200,v236,v200
M a[88:91],a[232:235],a[216:219],a[88:91]
v_lshlrev_b32 v234,16,v197
v_lshlrev_b32 v232,16,v193
M a[92:95],a[232:235],a[220:223],a[92:95]
buffer_load_dwordx4 a[232:235],v251,s[20:23],s48 offen offset:1024 sc1
M a[0:3],a[236:239],a[196:199],a[0:3]
v_lshlrev_b32 v233,16,v195
v_lshlrev_b32 v237,16,v203
M a[4:7],a[236:239],a[200:203],a[4:7]
v_lshlrev_b32 v236,16,v201
v_lshlrev_b32 v235,16,v199
M a[8:11],a[236:239],a[204:207],a[8:11]
v_fmac_f32 v232,s43,v234
v_fmac_f32 v237,4.0,v233
M a[12:15],a[236:239],a[208:211],a[12:15]
v_fma_f32 v238,-4.0,v234,v236
v_fmac_f32 v232,s45,v236
M a[16:19],a[236:239],a[212:215],a[16:19]
v_fmac_f32 v237,s40,v235
v_sub_f32 v236,v236,v234
M a[20:23],a[236:239],a[216:219],a[20:23]
v_fma_f32 v234,-4.0,v233,v235
v_sub_f32 v235,v235,v233
M a[24:27],a[236:239],a[220:223],a[24:27]
s_waitcnt lgkmcnt(0)
v_add_f32 v233,v238,v234
v_sub_f32 v238,v238,v234
M a[28:31],a[236:239],a[192:195],a[28:31]
buffer_load_dwordx4 a[236:239],v251,s[20:23],s46 offen offset:2048 sc1
M a[32:35],a[240:243],a[196:199],a[32:35]
v_fma_f32 v234,2.0,v235,v236
v_fmac_f32 v236,-2.0,v235
M a[36:39],a[240:243],a[200:203],a[36:39]
v_and_b32 v197,s42,v197
v_and_b32 v193,s42,v193
M a[40:43],a[240:243],a[204:207],a[40:43]
v_and_b32 v195,s42,v195
v_and_b32 v203,s42,v203
M a[44:47],a[240:243],a[208:211],a[44:47]
v_and_b32 v201,s42,v201
v_and_b32 v199,s42,v199
M a[48:51],a[240:243],a[212:215],a[48:51]
v_fmac_f32 v193,s43,v197
v_fmac_f32 v203,4.0,v195
M a[52:55],a[240:243],a[216:219],a[52:55]
v_fma_f32 v235,-4.0,v197,v201
v_fmac_f32 v193,s45,v201
M a[56:59],a[240:243],a[220:223],a[56:59]
v_fmac_f32 v203,s40,v199
v_sub_f32 v201,v201,v197
M a[60:63],a[240:243],a[192:195],a[60:63]
s_waitcnt vmcnt(16)
buffer_load_dwordx4 a[240:243],v251,s[20:23],s47 offen offset:2048 sc1
M a[64:67],a[244:247],a[196:199],a[64:67]
ds_read_b128 a[196:199],v249 offset:2304
v_fma_f32 v197,-4.0,v195,v199
M a[68:71],a[244:247],a[200:203],a[68:71]
v_sub_f32 v199,v199,v195
v_add_f32 v195,v235,v197
M a[72:75],a[244:247],a[204:207],a[72:75]
v_sub_f32 v235,v235,v197
v_fma_f32 v197,2.0,v199,v201
M a[76:79],a[244:247],a[208:211],a[76:79]
v_fmac_f32 v201,-2.0,v199
v_cvt_pk_bf16_f32 v193,v232,v193
M a[80:83],a[244:247],a[212:215],a[80:83]
v_cvt_pk_bf16_f32 v203,v237,v203
v_cvt_pk_bf16_f32 v195,v233,v195
M a[84:87],a[244:247],a[216:219],a[84:87]
v_cvt_pk_bf16_f32 v199,v234,v197
v_cvt_pk_bf16_f32 v197,v238,v235
M a[88:91],a[244:247],a[220:223],a[88:91]
v_cvt_pk_bf16_f32 v201,v236,v201
M a[92:95],a[244:247],a[192:195],a[92:95]
s_waitcnt vmcnt(16)
buffer_load_dwordx4 a[244:247],v251,s[20:23],s48 offen offset:2048 sc1
M a[0:3],a[248:251],a[200:203],a[0:3]
ds_write2st64_b64 v247,v[192:193],v[202:203] offset0:204 offset1:221
M a[4:7],a[248:251],a[204:207],a[4:7]
s_add_u32 s28,s66,7077888
buffer_load_dwordx2 v[192:193],v245,s[12:15],s28 offen offset:0
M a[8:11],a[248:251],a[208:211],a[8:11]
s_add_u32 s46,s77,27648
buffer_load_dwordx2 v[202:203],v245,s[16:19],s28 offen offset:1536
M a[12:15],a[248:251],a[212:215],a[12:15]
ds_write2st64_b64 v247,v[194:195],v[196:197] offset0:34 offset1:51
M a[16:19],a[248:251],a[216:219],a[16:19]
buffer_load_dwordx2 v[194:195],v245,s[8:11],s28 offen offset:0
M a[20:23],a[248:251],a[220:223],a[20:23]
buffer_load_dwordx2 v[196:197],v245,s[8:11],s28 offen offset:384
M a[24:27],a[248:251],a[192:195],a[24:27]
s_waitcnt lgkmcnt(2)
ds_write2st64_b64 v247,v[198:199],v[200:201] offset0:68 offset1:85
M a[28:31],a[248:251],a[196:199],a[28:31]
s_waitcnt vmcnt(20)
buffer_load_dwordx2 v[198:199],v245,s[8:11],s28 offen offset:768
M a[32:35],a[252:255],a[200:203],a[32:35]
buffer_load_dwordx2 v[200:201],v245,s[8:11],s28 offen offset:1152
M a[36:39],a[252:255],a[204:207],a[36:39]
buffer_load_dwordx4 a[248:251],v251,s[20:23],s46 offen offset:0 sc1
M a[40:43],a[252:255],a[208:211],a[40:43]
s_waitcnt vmcnt(17)
s_add_u32 s47,s77,30720
v_lshlrev_b32 v234,16,v208
v_lshlrev_b32 v232,16,v204
M a[44:47],a[252:255],a[212:215],a[44:47]
v_lshlrev_b32 v233,16,v206
v_lshlrev_b32 v237,16,v214
M a[48:51],a[252:255],a[216:219],a[48:51]
s_waitcnt vmcnt(15)
v_lshlrev_b32 v236,16,v212
v_lshlrev_b32 v235,16,v210
M a[52:55],a[252:255],a[220:223],a[52:55]
v_fmac_f32 v232,s43,v234
v_fmac_f32 v237,4.0,v233
M a[56:59],a[252:255],a[192:195],a[56:59]
v_fma_f32 v238,-4.0,v234,v236
v_fmac_f32 v232,s45,v236
M a[60:63],a[252:255],a[196:199],a[60:63]
buffer_load_dwordx4 a[252:255],v251,s[20:23],s47 offen offset:0 sc1
M a[64:67],v[216:219],a[200:203],a[64:67]
ds_read_b128 a[200:203],v249 offset:8704
v_fmac_f32 v237,s40,v235
M a[68:71],v[216:219],a[204:207],a[68:71]
s_add_u32 s48,s77,33792
ds_read_b128 a[204:207],v250 offset:8960
v_sub_f32 v236,v236,v234
M a[72:75],v[216:219],a[208:211],a[72:75]
ds_read_b128 a[208:211],v250 offset:9216
v_fma_f32 v234,-4.0,v233,v235
M a[76:79],v[216:219],a[212:215],a[76:79]
ds_read_b128 a[212:215],v250 offset:9472
v_sub_f32 v235,v235,v233
M a[80:83],v[216:219],a[216:219],a[80:83]
ds_read_b128 a[216:219],v250 offset:9728
v_add_f32 v233,v238,v234
M a[84:87],v[216:219],a[220:223],a[84:87]
ds_read_b128 a[220:223],v250 offset:9984
v_sub_f32 v238,v238,v234
M a[88:91],v[216:219],a[192:195],a[88:91]
ds_read_b128 a[192:195],v250 offset:10240
v_fma_f32 v234,2.0,v235,v236
M a[92:95],v[216:219],a[196:199],a[92:95]
s_waitcnt lgkmcnt(6)
buffer_load_dwordx4 v[216:219],v251,s[20:23],s48 offen offset:0 sc1
M a[96:99],v[220:223],a[200:203],a[96:99]
s_waitcnt lgkmcnt(5)
ds_read_b128 a[196:199],v250 offset:10496
v_fmac_f32 v236,-2.0,v235
M a[100:103],v[220:223],a[204:207],a[100:103]
s_waitcnt lgkmcnt(5)
v_and_b32 v208,s42,v208
v_and_b32 v204,s42,v204
M a[104:107],v[220:223],a[208:211],a[104:107]
s_waitcnt lgkmcnt(4)
v_and_b32 v206,s42,v206
v_and_b32 v214,s42,v214
M a[108:111],v[220:223],a[212:215],a[108:111]
s_waitcnt lgkmcnt(3)
v_and_b32 v212,s42,v212
v_and_b32 v210,s42,v210
M a[112:115],v[220:223],a[216:219],a[112:115]
s_waitcnt lgkmcnt(2)
v_fmac_f32 v204,s43,v208
v_fmac_f32 v214,4.0,v206
M a[116:119],v[220:223],a[220:223],a[116:119]
s_waitcnt lgkmcnt(1)
v_fma_f32 v235,-4.0,v208,v212
v_fmac_f32 v204,s45,v212
M a[120:123],v[220:223],a[192:195],a[120:123]
s_waitcnt lgkmcnt(0)
v_fmac_f32 v214,s40,v210
v_sub_f32 v212,v212,v208
M a[124:127],v[220:223],a[196:199],a[124:127]
s_waitcnt vmcnt(16)
buffer_load_dwordx4 v[220:223],v251,s[20:23],s46 offen offset:1024 sc1
M a[128:131],v[224:227],a[200:203],a[128:131]
v_fma_f32 v208,-4.0,v206,v210
v_sub_f32 v210,v210,v206
M a[132:135],v[224:227],a[204:207],a[132:135]
v_add_f32 v206,v235,v208
v_sub_f32 v235,v235,v208
M a[136:139],v[224:227],a[208:211],a[136:139]
v_fma_f32 v208,2.0,v210,v212
v_fmac_f32 v212,-2.0,v210
M a[140:143],v[224:227],a[212:215],a[140:143]
v_cvt_pk_bf16_f32 v204,v232,v204
v_cvt_pk_bf16_f32 v214,v237,v214
M a[144:147],v[224:227],a[216:219],a[144:147]
v_cvt_pk_bf16_f32 v206,v233,v206
v_cvt_pk_bf16_f32 v210,v234,v208
M a[148:151],v[224:227],a[220:223],a[148:151]
v_cvt_pk_bf16_f32 v208,v238,v235
v_cvt_pk_bf16_f32 v212,v236,v212
M a[152:155],v[224:227],a[192:195],a[152:155]
v_lshlrev_b32 v234,16,v209
v_lshlrev_b32 v232,16,v205
M a[156:159],v[224:227],a[196:199],a[156:159]
s_waitcnt vmcnt(16)
buffer_load_dwordx4 v[224:227],v251,s[20:23],s47 offen offset:1024 sc1
M a[160:163],v[228:231],a[200:203],a[160:163]
ds_read_b128 a[200:203],v250 offset:10752
v_lshlrev_b32 v233,16,v207
M a[164:167],v[228:231],a[204:207],a[164:167]
v_lshlrev_b32 v237,16,v215
v_lshlrev_b32 v236,16,v213
M a[168:171],v[228:231],a[208:211],a[168:171]
v_lshlrev_b32 v235,16,v211
v_fmac_f32 v232,s43,v234
M a[172:175],v[228:231],a[212:215],a[172:175]
v_fmac_f32 v237,4.0,v233
v_fma_f32 v238,-4.0,v234,v236
M a[176:179],v[228:231],a[216:219],a[176:179]
v_fmac_f32 v232,s45,v236
v_fmac_f32 v237,s40,v235
M a[180:183],v[228:231],a[220:223],a[180:183]
v_sub_f32 v236,v236,v234
v_fma_f32 v234,-4.0,v233,v235
M a[184:187],v[228:231],a[192:195],a[184:187]
v_sub_f32 v235,v235,v233
v_add_f32 v233,v238,v234
M a[188:191],v[228:231],a[196:199],a[188:191]
s_waitcnt vmcnt(16)
buffer_load_dwordx4 v[228:231],v251,s[20:23],s48 offen offset:1024 sc1
M a[96:99],a[224:227],a[204:207],a[96:99]
v_sub_f32 v238,v238,v234
v_fma_f32 v234,2.0,v235,v236
M a[100:103],a[224:227],a[208:211],a[100:103]
v_fmac_f32 v236,-2.0,v235
v_and_b32 v209,s42,v209
M a[104:107],a[224:227],a[212:215],a[104:107]
v_and_b32 v205,s42,v205
v_and_b32 v207,s42,v207
M a[108:111],a[224:227],a[216:219],a[108:111]
v_and_b32 v215,s42,v215
v_and_b32 v213,s42,v213
M a[112:115],a[224:227],a[220:223],a[112:115]
v_and_b32 v211,s42,v211
v_fmac_f32 v205,s43,v209
M a[116:119],a[224:227],a[192:195],a[116:119]
v_fmac_f32 v215,4.0,v207
v_fma_f32 v235,-4.0,v209,v213
M a[120:123],a[224:227],a[196:199],a[120:123]
s_waitcnt lgkmcnt(0)
v_fmac_f32 v205,s45,v213
v_fmac_f32 v215,s40,v211
M a[124:127],a[224:227],a[200:203],a[124:127]
s_waitcnt vmcnt(16)
buffer_load_dwordx4 a[224:227],v251,s[20:23],s46 offen offset:2048 sc1
M a[128:131],a[228:231],a[204:207],a[128:131]
v_sub_f32 v213,v213,v209
v_fma_f32 v209,-4.0,v207,v211
M a[132:135],a[228:231],a[208:211],a[132:135]
v_sub_f32 v211,v211,v207
v_add_f32 v207,v235,v209
M a[136:139],a[228:231],a[212:215],a[136:139]
v_sub_f32 v235,v235,v209
v_fma_f32 v209,2.0,v211,v213
M a[140:143],a[228:231],a[216:219],a[140:143]
v_fmac_f32 v213,-2.0,v211
v_cvt_pk_bf16_f32 v205,v232,v205
M a[144:147],a[228:231],a[220:223],a[144:147]
v_cvt_pk_bf16_f32 v215,v237,v215
v_cvt_pk_bf16_f32 v207,v233,v207
M a[148:151],a[228:231],a[192:195],a[148:151]
v_cvt_pk_bf16_f32 v211,v234,v209
v_cvt_pk_bf16_f32 v209,v238,v235
M a[152:155],a[228:231],a[196:199],a[152:155]
v_cvt_pk_bf16_f32 v213,v236,v213
M a[156:159],a[228:231],a[200:203],a[156:159]
s_waitcnt vmcnt(16)
buffer_load_dwordx4 a[228:231],v251,s[20:23],s47 offen offset:2048 sc1
M a[160:163],a[232:235],a[204:207],a[160:163]
ds_read_b128 a[204:207],v249 offset:11008
ds_write2st64_b64 v247,v[204:205],v[214:215] offset0:205 offset1:222
M a[164:167],a[232:235],a[208:211],a[164:167]
s_add_u32 s28,s66,7471104
buffer_load_dwordx2 v[204:205],v245,s[12:15],s28 offen offset:0
M a[168:171],a[232:235],a[212:215],a[168:171]
buffer_load_dwordx2 v[214:215],v245,s[16:19],s28 offen offset:1536
M a[172:175],a[232:235],a[216:219],a[172:175]
ds_write2st64_b64 v247,v[206:207],v[208:209] offset0:35 offset1:52
M a[176:179],a[232:235],a[220:223],a[176:179]
buffer_load_dwordx2 v[206:207],v245,s[8:11],s28 offen offset:0
M a[180:183],a[232:235],a[192:195],a[180:183]
buffer_load_dwordx2 v[208:209],v245,s[8:11],s28 offen offset:384
M a[184:187],a[232:235],a[196:199],a[184:187]
ds_write2st64_b64 v247,v[210:211],v[212:213] offset0:69 offset1:86
M a[188:191],a[232:235],a[200:203],a[188:191]
s_waitcnt vmcnt(20)
buffer_load_dwordx2 v[210:211],v245,s[8:11],s28 offen offset:768
M a[96:99],a[236:239],a[208:211],a[96:99]
buffer_load_dwordx2 v[212:213],v245,s[8:11],s28 offen offset:1152
M a[100:103],a[236:239],a[212:215],a[100:103]
buffer_load_dwordx4 a[232:235],v251,s[20:23],s48 offen offset:2048 sc1
M a[104:107],a[236:239],a[216:219],a[104:107]
s_add_u32 s46,s77,36864
v_fmac_f32 v239,s43,v241
v_fmac_f32 v244,4.0,v240
M a[108:111],a[236:239],a[220:223],a[108:111]
v_fma_f32 v232,-4.0,v241,v243
v_fmac_f32 v239,s45,v243
M a[112:115],a[236:239],a[192:195],a[112:115]
v_fmac_f32 v244,s40,v242
v_sub_f32 v243,v243,v241
M a[116:119],a[236:239],a[196:199],a[116:119]
v_fma_f32 v241,-4.0,v240,v242
v_sub_f32 v242,v242,v240
M a[120:123],a[236:239],a[200:203],a[120:123]
s_waitcnt lgkmcnt(3)
v_add_f32 v240,v232,v241
v_sub_f32 v232,v232,v241
M a[124:127],a[236:239],a[204:207],a[124:127]
s_waitcnt vmcnt(22)
buffer_load_dwordx4 a[236:239],v251,s[20:23],s46 offen offset:0 sc1
M a[128:131],a[240:243],a[208:211],a[128:131]
v_fma_f32 v241,2.0,v242,v243
v_fmac_f32 v243,-2.0,v242
M a[132:135],a[240:243],a[212:215],a[132:135]
s_add_u32 s47,s77,39936
v_cvt_pk_bf16_f32 v233,v239,v244
v_cvt_pk_bf16_f32 v234,v240,v232
M a[136:139],a[240:243],a[216:219],a[136:139]
v_cvt_pk_bf16_f32 v235,v241,v243
v_add_u32 v232,104448,v248
M a[140:143],a[240:243],a[220:223],a[140:143]
buffer_load_short_d16_hi v239,v246,s[12:15],s73 offen offset:0
M a[144:147],a[240:243],a[192:195],a[144:147]
buffer_load_short_d16_hi v240,v246,s[8:11],s73 offen offset:0
M a[148:151],a[240:243],a[196:199],a[148:151]
buffer_load_short_d16_hi v241,v246,s[8:11],s73 offen offset:384
M a[152:155],a[240:243],a[200:203],a[152:155]
buffer_load_short_d16_hi v242,v246,s[8:11],s73 offen offset:768
M a[156:159],a[240:243],a[204:207],a[156:159]
s_waitcnt vmcnt(26)
buffer_load_short_d16_hi v243,v246,s[8:11],s73 offen offset:1152
M a[160:163],a[244:247],a[208:211],a[160:163]
buffer_load_short_d16_hi v244,v246,s[16:19],s73 offen offset:1536
M a[164:167],a[244:247],a[212:215],a[164:167]
buffer_load_dwordx4 a[240:243],v251,s[20:23],s47 offen offset:0 sc1
v_add_u32 v249,0x4400,v249
v_add_u32 v250,0x4400,v250
M a[168:171],a[244:247],a[216:219],a[168:171]
s_add_u32 s48,s77,43008
ds_read_b128 a[208:211],v249 offset:52224
ds_read_b128 a[212:215],v250 offset:52480
M a[172:175],a[244:247],a[220:223],a[172:175]
ds_read_b128 a[216:219],v250 offset:52736
ds_read_b128 a[220:223],v250 offset:52992
M a[176:179],a[244:247],a[192:195],a[176:179]
ds_read_b128 a[192:195],v250 offset:53248
ds_write_b16 v232,v233 offset:0
M a[180:183],a[244:247],a[196:199],a[180:183]
ds_read_b128 a[196:199],v250 offset:53504
ds_write_b16_d16_hi v232,v233 offset:8704
M a[184:187],a[244:247],a[200:203],a[184:187]
ds_read_b128 a[200:203],v250 offset:53760
ds_write_b16 v248,v234 offset:17408
M a[188:191],a[244:247],a[204:207],a[188:191]
s_waitcnt vmcnt(22) lgkmcnt(9)
buffer_load_dwordx4 a[244:247],v251,s[20:23],s48 offen offset:0 sc1
M v[0:3],a[248:251],a[208:211],v[0:3]
s_waitcnt lgkmcnt(8)
ds_read_b128 a[204:207],v250 offset:54016
ds_write_b16_d16_hi v248,v234 offset:26112
M v[4:7],a[248:251],a[212:215],v[4:7]
s_waitcnt lgkmcnt(9)
ds_write_b16 v248,v235 offset:34816
M v[8:11],a[248:251],a[216:219],v[8:11]
s_waitcnt lgkmcnt(9)
ds_write_b16_d16_hi v248,v235 offset:43520
M v[12:15],a[248:251],a[220:223],v[12:15]
s_waitcnt lgkmcnt(9)
v_lshlrev_b32 v234,16,v196
v_lshlrev_b32 v232,16,v192
M v[16:19],a[248:251],a[192:195],v[16:19]
s_waitcnt lgkmcnt(7)
v_lshlrev_b32 v233,16,v194
v_lshlrev_b32 v237,16,v202
M v[20:23],a[248:251],a[196:199],v[20:23]
s_waitcnt lgkmcnt(5)
v_lshlrev_b32 v236,16,v200
v_lshlrev_b32 v235,16,v198
M v[24:27],a[248:251],a[200:203],v[24:27]
s_waitcnt lgkmcnt(3)
v_fmac_f32 v232,s43,v234
v_fmac_f32 v237,4.0,v233
M v[28:31],a[248:251],a[204:207],v[28:31]
s_waitcnt vmcnt(22)
buffer_load_dwordx4 a[248:251],v251,s[20:23],s46 offen offset:1024 sc1
M v[32:35],a[252:255],a[208:211],v[32:35]
v_fma_f32 v238,-4.0,v234,v236
v_fmac_f32 v232,s45,v236
M v[36:39],a[252:255],a[212:215],v[36:39]
v_fmac_f32 v237,s40,v235
v_sub_f32 v236,v236,v234
M v[40:43],a[252:255],a[216:219],v[40:43]
v_fma_f32 v234,-4.0,v233,v235
v_sub_f32 v235,v235,v233
M v[44:47],a[252:255],a[220:223],v[44:47]
v_add_f32 v233,v238,v234
v_sub_f32 v238,v238,v234
M v[48:51],a[252:255],a[192:195],v[48:51]
v_fma_f32 v234,2.0,v235,v236
v_fmac_f32 v236,-2.0,v235
M v[52:55],a[252:255],a[196:199],v[52:55]
v_and_b32 v196,s42,v196
v_and_b32 v192,s42,v192
M v[56:59],a[252:255],a[200:203],v[56:59]
v_and_b32 v194,s42,v194
v_and_b32 v202,s42,v202
M v[60:63],a[252:255],a[204:207],v[60:63]
s_waitcnt vmcnt(22)
buffer_load_dwordx4 a[252:255],v251,s[20:23],s47 offen offset:1024 sc1
M v[64:67],v[216:219],a[208:211],v[64:67]
ds_read_b128 a[208:211],v250 offset:54272
v_and_b32 v200,s42,v200
M v[68:71],v[216:219],a[212:215],v[68:71]
v_and_b32 v198,s42,v198
v_fmac_f32 v192,s43,v196
M v[72:75],v[216:219],a[216:219],v[72:75]
v_fmac_f32 v202,4.0,v194
v_fma_f32 v235,-4.0,v196,v200
M v[76:79],v[216:219],a[220:223],v[76:79]
v_fmac_f32 v192,s45,v200
v_fmac_f32 v202,s40,v198
M v[80:83],v[216:219],a[192:195],v[80:83]
v_sub_f32 v200,v200,v196
v_fma_f32 v196,-4.0,v194,v198
M v[84:87],v[216:219],a[196:199],v[84:87]
v_sub_f32 v198,v198,v194
v_add_f32 v194,v235,v196
M v[88:91],v[216:219],a[200:203],v[88:91]
v_sub_f32 v235,v235,v196
v_fma_f32 v196,2.0,v198,v200
M v[92:95],v[216:219],a[204:207],v[92:95]
s_waitcnt vmcnt(22)
buffer_load_dwordx4 v[216:219],v251,s[20:23],s48 offen offset:1024 sc1
M v[0:3],v[220:223],a[212:215],v[0:3]
v_fmac_f32 v200,-2.0,v198
v_cvt_pk_bf16_f32 v192,v232,v192
M v[4:7],v[220:223],a[216:219],v[4:7]
v_cvt_pk_bf16_f32 v202,v237,v202
v_cvt_pk_bf16_f32 v194,v233,v194
M v[8:11],v[220:223],a[220:223],v[8:11]
v_cvt_pk_bf16_f32 v198,v234,v196
v_cvt_pk_bf16_f32 v196,v238,v235
M v[12:15],v[220:223],a[192:195],v[12:15]
v_cvt_pk_bf16_f32 v200,v236,v200
v_lshlrev_b32 v234,16,v197
M v[16:19],v[220:223],a[196:199],v[16:19]
v_lshlrev_b32 v232,16,v193
v_lshlrev_b32 v233,16,v195
M v[20:23],v[220:223],a[200:203],v[20:23]
v_lshlrev_b32 v237,16,v203
v_lshlrev_b32 v236,16,v201
M v[24:27],v[220:223],a[204:207],v[24:27]
s_waitcnt lgkmcnt(0)
v_lshlrev_b32 v235,16,v199
v_fmac_f32 v232,s43,v234
M v[28:31],v[220:223],a[208:211],v[28:31]
s_waitcnt vmcnt(22)
buffer_load_dwordx4 v[220:223],v251,s[20:23],s46 offen offset:2048 sc1
M v[32:35],v[224:227],a[212:215],v[32:35]
v_fmac_f32 v237,4.0,v233
v_fma_f32 v238,-4.0,v234,v236
M v[36:39],v[224:227],a[216:219],v[36:39]
v_fmac_f32 v232,s45,v236
v_fmac_f32 v237,s40,v235
M v[40:43],v[224:227],a[220:223],v[40:43]
v_sub_f32 v236,v236,v234
v_fma_f32 v234,-4.0,v233,v235
M v[44:47],v[224:227],a[192:195],v[44:47]
v_sub_f32 v235,v235,v233
v_add_f32 v233,v238,v234
M v[48:51],v[224:227],a[196:199],v[48:51]
v_sub_f32 v238,v238,v234
v_fma_f32 v234,2.0,v235,v236
M v[52:55],v[224:227],a[200:203],v[52:55]
v_fmac_f32 v236,-2.0,v235
v_and_b32 v197,s42,v197
M v[56:59],v[224:227],a[204:207],v[56:59]
v_and_b32 v193,s42,v193
v_and_b32 v195,s42,v195
M v[60:63],v[224:227],a[208:211],v[60:63]
s_waitcnt vmcnt(22)
buffer_load_dwordx4 v[224:227],v251,s[20:23],s47 offen offset:2048 sc1
M v[64:67],v[228:231],a[212:215],v[64:67]
ds_read_b128 a[212:215],v249 offset:54528
v_and_b32 v203,s42,v203
M v[68:71],v[228:231],a[216:219],v[68:71]
v_and_b32 v201,s42,v201
v_and_b32 v199,s42,v199
M v[72:75],v[228:231],a[220:223],v[72:75]
v_fmac_f32 v193,s43,v197
v_fmac_f32 v203,4.0,v195
M v[76:79],v[228:231],a[192:195],v[76:79]
v_fma_f32 v235,-4.0,v197,v201
v_fmac_f32 v193,s45,v201
M v[80:83],v[228:231],a[196:199],v[80:83]
v_fmac_f32 v203,s40,v199
v_sub_f32 v201,v201,v197
M v[84:87],v[228:231],a[200:203],v[84:87]
v_fma_f32 v197,-4.0,v195,v199
v_sub_f32 v199,v199,v195
M v[88:91],v[228:231],a[204:207],v[88:91]
v_add_f32 v195,v235,v197
v_sub_f32 v235,v235,v197
M v[92:95],v[228:231],a[208:211],v[92:95]
s_waitcnt vmcnt(22)
buffer_load_dwordx4 v[228:231],v251,s[20:23],s48 offen offset:2048 sc1
M v[0:3],a[224:227],a[216:219],v[0:3]
v_fma_f32 v197,2.0,v199,v201
v_fmac_f32 v201,-2.0,v199
M v[4:7],a[224:227],a[220:223],v[4:7]
s_add_u32 s46,s78,9216
v_cvt_pk_bf16_f32 v193,v232,v193
v_cvt_pk_bf16_f32 v203,v237,v203
M v[8:11],a[224:227],a[192:195],v[8:11]
v_cvt_pk_bf16_f32 v195,v233,v195
v_cvt_pk_bf16_f32 v199,v234,v197
M v[12:15],a[224:227],a[196:199],v[12:15]
v_cvt_pk_bf16_f32 v197,v238,v235
v_cvt_pk_bf16_f32 v201,v236,v201
M v[16:19],a[224:227],a[200:203],v[16:19]
ds_write2st64_b64 v247,v[192:193],v[202:203] offset0:206 offset1:223
M v[20:23],a[224:227],a[204:207],v[20:23]
s_add_u32 s28,s67,6291456
buffer_load_dwordx2 v[192:193],v245,s[12:15],s28 offen offset:0
M v[24:27],a[224:227],a[208:211],v[24:27]
s_waitcnt lgkmcnt(1)
buffer_load_dwordx2 v[202:203],v245,s[16:19],s28 offen offset:1536
M v[28:31],a[224:227],a[212:215],v[28:31]
s_waitcnt vmcnt(24)
buffer_load_dwordx4 a[224:227],v251,s[20:23],s46 offen offset:0 sc1
M v[32:35],a[228:231],a[216:219],v[32:35]
ds_write2st64_b64 v247,v[194:195],v[196:197] offset0:36 offset1:53
M v[36:39],a[228:231],a[220:223],v[36:39]
s_add_u32 s47,s78,12288
buffer_load_dwordx2 v[194:195],v245,s[8:11],s28 offen offset:0
M v[40:43],a[228:231],a[192:195],v[40:43]
buffer_load_dwordx2 v[196:197],v245,s[8:11],s28 offen offset:384
M v[44:47],a[228:231],a[196:199],v[44:47]
ds_write2st64_b64 v247,v[198:199],v[200:201] offset0:70 offset1:87
M v[48:51],a[228:231],a[200:203],v[48:51]
buffer_load_dwordx2 v[198:199],v245,s[8:11],s28 offen offset:768
M v[52:55],a[228:231],a[204:207],v[52:55]
buffer_load_dwordx2 v[200:201],v245,s[8:11],s28 offen offset:1152
M v[56:59],a[228:231],a[208:211],v[56:59]
s_waitcnt vmcnt(25)
v_lshlrev_b32 v234,16,v208
v_lshlrev_b32 v232,16,v204
M v[60:63],a[228:231],a[212:215],v[60:63]
s_waitcnt vmcnt(22)
buffer_load_dwordx4 a[228:231],v251,s[20:23],s47 offen offset:0 sc1
M v[64:67],a[232:235],a[216:219],v[64:67]
ds_read_b128 a[216:219],v249 offset:60928
v_lshlrev_b32 v233,16,v206
M v[68:71],a[232:235],a[220:223],v[68:71]
s_add_u32 s48,s78,15360
ds_read_b128 a[220:223],v250 offset:61184
v_lshlrev_b32 v237,16,v214
M v[72:75],a[232:235],a[192:195],v[72:75]
ds_read_b128 a[192:195],v250 offset:61440
v_lshlrev_b32 v236,16,v212
M v[76:79],a[232:235],a[196:199],v[76:79]
ds_read_b128 a[196:199],v250 offset:61696
v_lshlrev_b32 v235,16,v210
M v[80:83],a[232:235],a[200:203],v[80:83]
ds_read_b128 a[200:203],v250 offset:61952
v_fmac_f32 v232,s43,v234
M v[84:87],a[232:235],a[204:207],v[84:87]
ds_read_b128 a[204:207],v250 offset:62208
v_fmac_f32 v237,4.0,v233
M v[88:91],a[232:235],a[208:211],v[88:91]
ds_read_b128 a[208:211],v250 offset:62464
v_fma_f32 v238,-4.0,v234,v236
M v[92:95],a[232:235],a[212:215],v[92:95]
s_waitcnt vmcnt(22) lgkmcnt(6)
buffer_load_dwordx4 a[232:235],v251,s[20:23],s48 offen offset:0 sc1
M v[96:99],a[236:239],a[216:219],v[96:99]
s_waitcnt lgkmcnt(5)
ds_read_b128 a[212:215],v250 offset:62720
v_fmac_f32 v232,s45,v236
M v[100:103],a[236:239],a[220:223],v[100:103]
s_waitcnt lgkmcnt(5)
v_fmac_f32 v237,s40,v235
v_sub_f32 v236,v236,v234
M v[104:107],a[236:239],a[192:195],v[104:107]
s_waitcnt lgkmcnt(4)
v_fma_f32 v234,-4.0,v233,v235
v_sub_f32 v235,v235,v233
M v[108:111],a[236:239],a[196:199],v[108:111]
s_waitcnt lgkmcnt(3)
v_add_f32 v233,v238,v234
v_sub_f32 v238,v238,v234
M v[112:115],a[236:239],a[200:203],v[112:115]
s_waitcnt lgkmcnt(2)
v_fma_f32 v234,2.0,v235,v236
v_fmac_f32 v236,-2.0,v235
M v[116:119],a[236:239],a[204:207],v[116:119]
s_waitcnt lgkmcnt(1)
v_and_b32 v208,s42,v208
v_and_b32 v204,s42,v204
M v[120:123],a[236:239],a[208:211],v[120:123]
s_waitcnt lgkmcnt(0)
v_and_b32 v206,s42,v206
v_and_b32 v214,s42,v214
M v[124:127],a[236:239],a[212:215],v[124:127]
s_waitcnt vmcnt(16)
buffer_load_dwordx4 a[236:239],v251,s[20:23],s46 offen offset:1024 sc1
M v[128:131],a[240:243],a[216:219],v[128:131]
v_and_b32 v212,s42,v212
v_and_b32 v210,s42,v210
M v[132:135],a[240:243],a[220:223],v[132:135]
v_fmac_f32 v204,s43,v208
v_fmac_f32 v214,4.0,v206
M v[136:139],a[240:243],a[192:195],v[136:139]
v_fma_f32 v235,-4.0,v208,v212
v_fmac_f32 v204,s45,v212
M v[140:143],a[240:243],a[196:199],v[140:143]
v_fmac_f32 v214,s40,v210
v_sub_f32 v212,v212,v208
M v[144:147],a[240:243],a[200:203],v[144:147]
v_fma_f32 v208,-4.0,v206,v210
v_sub_f32 v210,v210,v206
M v[148:151],a[240:243],a[204:207],v[148:151]
v_add_f32 v206,v235,v208
v_sub_f32 v235,v235,v208
M v[152:155],a[240:243],a[208:211],v[152:155]
v_fma_f32 v208,2.0,v210,v212
v_fmac_f32 v212,-2.0,v210
M v[156:159],a[240:243],a[212:215],v[156:159]
s_waitcnt vmcnt(16)
buffer_load_dwordx4 a[240:243],v251,s[20:23],s47 offen offset:1024 sc1
M v[160:163],a[244:247],a[216:219],v[160:163]
ds_read_b128 a[216:219],v250 offset:62976
v_cvt_pk_bf16_f32 v204,v232,v204
M v[164:167],a[244:247],a[220:223],v[164:167]
v_cvt_pk_bf16_f32 v214,v237,v214
v_cvt_pk_bf16_f32 v206,v233,v206
M v[168:171],a[244:247],a[192:195],v[168:171]
v_cvt_pk_bf16_f32 v210,v234,v208
v_cvt_pk_bf16_f32 v208,v238,v235
M v[172:175],a[244:247],a[196:199],v[172:175]
v_cvt_pk_bf16_f32 v212,v236,v212
v_lshlrev_b32 v234,16,v209
M v[176:179],a[244:247],a[200:203],v[176:179]
v_lshlrev_b32 v232,16,v205
v_lshlrev_b32 v233,16,v207
M v[180:183],a[244:247],a[204:207],v[180:183]
v_lshlrev_b32 v237,16,v215
v_lshlrev_b32 v236,16,v213
M v[184:187],a[244:247],a[208:211],v[184:187]
v_lshlrev_b32 v235,16,v211
v_fmac_f32 v232,s43,v234
M v[188:191],a[244:247],a[212:215],v[188:191]
s_waitcnt vmcnt(16)
buffer_load_dwordx4 a[244:247],v251,s[20:23],s48 offen offset:1024 sc1
M v[96:99],a[248:251],a[220:223],v[96:99]
v_fmac_f32 v237,4.0,v233
v_fma_f32 v238,-4.0,v234,v236
M v[100:103],a[248:251],a[192:195],v[100:103]
v_fmac_f32 v232,s45,v236
v_fmac_f32 v237,s40,v235
M v[104:107],a[248:251],a[196:199],v[104:107]
v_sub_f32 v236,v236,v234
v_fma_f32 v234,-4.0,v233,v235
M v[108:111],a[248:251],a[200:203],v[108:111]
v_sub_f32 v235,v235,v233
v_add_f32 v233,v238,v234
M v[112:115],a[248:251],a[204:207],v[112:115]
v_sub_f32 v238,v238,v234
v_fma_f32 v234,2.0,v235,v236
M v[116:119],a[248:251],a[208:211],v[116:119]
v_fmac_f32 v236,-2.0,v235
v_and_b32 v209,s42,v209
M v[120:123],a[248:251],a[212:215],v[120:123]
s_waitcnt lgkmcnt(0)
v_and_b32 v205,s42,v205
v_and_b32 v207,s42,v207
M v[124:127],a[248:251],a[216:219],v[124:127]
s_waitcnt vmcnt(16)
buffer_load_dwordx4 a[248:251],v251,s[20:23],s46 offen offset:2048 sc1
M v[128:131],a[252:255],a[220:223],v[128:131]
v_and_b32 v215,s42,v215
v_and_b32 v213,s42,v213
M v[132:135],a[252:255],a[192:195],v[132:135]
v_and_b32 v211,s42,v211
v_fmac_f32 v205,s43,v209
M v[136:139],a[252:255],a[196:199],v[136:139]
v_fmac_f32 v215,4.0,v207
v_fma_f32 v235,-4.0,v209,v213
M v[140:143],a[252:255],a[200:203],v[140:143]
v_fmac_f32 v205,s45,v213
v_fmac_f32 v215,s40,v211
M v[144:147],a[252:255],a[204:207],v[144:147]
v_sub_f32 v213,v213,v209
v_fma_f32 v209,-4.0,v207,v211
M v[148:151],a[252:255],a[208:211],v[148:151]
v_sub_f32 v211,v211,v207
v_add_f32 v207,v235,v209
M v[152:155],a[252:255],a[212:215],v[152:155]
v_sub_f32 v235,v235,v209
v_fma_f32 v209,2.0,v211,v213
M v[156:159],a[252:255],a[216:219],v[156:159]
s_waitcnt vmcnt(16)
buffer_load_dwordx4 a[252:255],v251,s[20:23],s47 offen offset:2048 sc1
M v[160:163],v[216:219],a[220:223],v[160:163]
ds_read_b128 a[220:223],v249 offset:63232
v_fmac_f32 v213,-2.0,v211
M v[164:167],v[216:219],a[192:195],v[164:167]
v_cvt_pk_bf16_f32 v205,v232,v205
v_cvt_pk_bf16_f32 v215,v237,v215
M v[168:171],v[216:219],a[196:199],v[168:171]
v_cvt_pk_bf16_f32 v207,v233,v207
v_cvt_pk_bf16_f32 v211,v234,v209
M v[172:175],v[216:219],a[200:203],v[172:175]
v_cvt_pk_bf16_f32 v209,v238,v235
v_cvt_pk_bf16_f32 v213,v236,v213
M v[176:179],v[216:219],a[204:207],v[176:179]
ds_write2st64_b64 v247,v[204:205],v[214:215] offset0:207 offset1:224
M v[180:183],v[216:219],a[208:211],v[180:183]
s_add_u32 s28,s67,6684672
buffer_load_dwordx2 v[204:205],v245,s[12:15],s28 offen offset:0
M v[184:187],v[216:219],a[212:215],v[184:187]
buffer_load_dwordx2 v[214:215],v245,s[16:19],s28 offen offset:1536
M v[188:191],v[216:219],a[216:219],v[188:191]
s_waitcnt vmcnt(18)
buffer_load_dwordx4 v[216:219],v251,s[20:23],s48 offen offset:2048 sc1
M v[96:99],v[220:223],a[192:195],v[96:99]
ds_write2st64_b64 v247,v[206:207],v[208:209] offset0:37 offset1:54
M v[100:103],v[220:223],a[196:199],v[100:103]
s_add_u32 s46,s78,18432
buffer_load_dwordx2 v[206:207],v245,s[8:11],s28 offen offset:0
M v[104:107],v[220:223],a[200:203],v[104:107]
buffer_load_dwordx2 v[208:209],v245,s[8:11],s28 offen offset:384
M v[108:111],v[220:223],a[204:207],v[108:111]
ds_write2st64_b64 v247,v[210:211],v[212:213] offset0:71 offset1:88
M v[112:115],v[220:223],a[208:211],v[112:115]
buffer_load_dwordx2 v[210:211],v245,s[8:11],s28 offen offset:768
M v[116:119],v[220:223],a[212:215],v[116:119]
buffer_load_dwordx2 v[212:213],v245,s[8:11],s28 offen offset:1152
M v[120:123],v[220:223],a[216:219],v[120:123]
s_waitcnt vmcnt(16) lgkmcnt(3)
v_lshlrev_b32 v234,16,v196
v_lshlrev_b32 v232,16,v192
M v[124:127],v[220:223],a[220:223],v[124:127]
buffer_load_dwordx4 v[220:223],v251,s[20:23],s46 offen offset:0 sc1
M v[128:131],v[224:227],a[192:195],v[128:131]
v_lshlrev_b32 v233,16,v194
v_lshlrev_b32 v237,16,v202
M v[132:135],v[224:227],a[196:199],v[132:135]
s_waitcnt vmcnt(15)
s_add_u32 s47,s78,21504
v_lshlrev_b32 v236,16,v200
v_lshlrev_b32 v235,16,v198
M v[136:139],v[224:227],a[200:203],v[136:139]
v_fmac_f32 v232,s43,v234
v_fmac_f32 v237,4.0,v233
M v[140:143],v[224:227],a[204:207],v[140:143]
v_fma_f32 v238,-4.0,v234,v236
v_fmac_f32 v232,s45,v236
M v[144:147],v[224:227],a[208:211],v[144:147]
v_fmac_f32 v237,s40,v235
v_sub_f32 v236,v236,v234
M v[148:151],v[224:227],a[212:215],v[148:151]
v_fma_f32 v234,-4.0,v233,v235
v_sub_f32 v235,v235,v233
M v[152:155],v[224:227],a[216:219],v[152:155]
s_waitcnt lgkmcnt(0)
s_barrier
v_add_f32 v233,v238,v234
M v[156:159],v[224:227],a[220:223],v[156:159]
buffer_load_dwordx4 v[224:227],v251,s[20:23],s47 offen offset:0 sc1
M v[160:163],v[228:231],a[192:195],v[160:163]
ds_read_b128 a[192:195],v249 offset:0
v_sub_f32 v238,v238,v234
M v[164:167],v[228:231],a[196:199],v[164:167]
s_add_u32 s48,s78,24576
ds_read_b128 a[196:199],v250 offset:256
v_fma_f32 v234,2.0,v235,v236
M v[168:171],v[228:231],a[200:203],v[168:171]
ds_read_b128 a[200:203],v250 offset:512
v_fmac_f32 v236,-2.0,v235
M v[172:175],v[228:231],a[204:207],v[172:175]
ds_read_b128 a[204:207],v250 offset:768
v_and_b32 v196,s42,v196
M v[176:179],v[228:231],a[208:211],v[176:179]
ds_read_b128 a[208:211],v250 offset:1024
v_and_b32 v192,s42,v192
M v[180:183],v[228:231],a[212:215],v[180:183]
ds_read_b128 a[212:215],v250 offset:1280
v_and_b32 v194,s42,v194
M v[184:187],v[228:231],a[216:219],v[184:187]
ds_read_b128 a[216:219],v250 offset:1536
v_and_b32 v202,s42,v202
M v[188:191],v[228:231],a[220:223],v[188:191]
s_waitcnt lgkmcnt(6)
buffer_load_dwordx4 v[228:231],v251,s[20:23],s48 offen offset:0 sc1
M a[0:3],a[224:227],a[192:195],a[0:3]
s_waitcnt lgkmcnt(5)
ds_read_b128 a[220:223],v250 offset:1792
v_and_b32 v200,s42,v200
M a[4:7],a[224:227],a[196:199],a[4:7]
s_waitcnt lgkmcnt(5)
v_and_b32 v198,s42,v198
v_fmac_f32 v192,s43,v196
M a[8:11],a[224:227],a[200:203],a[8:11]
s_waitcnt lgkmcnt(4)
v_fmac_f32 v202,4.0,v194
v_fma_f32 v235,-4.0,v196,v200
M a[12:15],a[224:227],a[204:207],a[12:15]
s_waitcnt lgkmcnt(3)
v_fmac_f32 v192,s45,v200
v_fmac_f32 v202,s40,v198
M a[16:19],a[224:227],a[208:211],a[16:19]
s_waitcnt lgkmcnt(2)
v_sub_f32 v200,v200,v196
v_fma_f32 v196,-4.0,v194,v198
M a[20:23],a[224:227],a[212:215],a[20:23]
s_waitcnt lgkmcnt(1)
v_sub_f32 v198,v198,v194
v_add_f32 v194,v235,v196
M a[24:27],a[224:227],a[216:219],a[24:27]
s_waitcnt lgkmcnt(0)
v_sub_f32 v235,v235,v196
v_fma_f32 v196,2.0,v198,v200
M a[28:31],a[224:227],a[220:223],a[28:31]
s_waitcnt vmcnt(16)
buffer_load_dwordx4 a[224:227],v251,s[20:23],s46 offen offset:1024 sc1
M a[32:35],a[228:231],a[192:195],a[32:35]
v_fmac_f32 v200,-2.0,v198
v_cvt_pk_bf16_f32 v192,v232,v192
M a[36:39],a[228:231],a[196:199],a[36:39]
v_cvt_pk_bf16_f32 v202,v237,v202
v_cvt_pk_bf16_f32 v194,v233,v194
M a[40:43],a[228:231],a[200:203],a[40:43]
v_cvt_pk_bf16_f32 v198,v234,v196
v_cvt_pk_bf16_f32 v196,v238,v235
M a[44:47],a[228:231],a[204:207],a[44:47]
v_cvt_pk_bf16_f32 v200,v236,v200
v_lshlrev_b32 v234,16,v197
M a[48:51],a[228:231],a[208:211],a[48:51]
v_lshlrev_b32 v232,16,v193
v_lshlrev_b32 v233,16,v195
M a[52:55],a[228:231],a[212:215],a[52:55]
v_lshlrev_b32 v237,16,v203
v_lshlrev_b32 v236,16,v201
M a[56:59],a[228:231],a[216:219],a[56:59]
v_lshlrev_b32 v235,16,v199
v_fmac_f32 v232,s43,v234
M a[60:63],a[228:231],a[220:223],a[60:63]
s_waitcnt vmcnt(16)
buffer_load_dwordx4 a[228:231],v251,s[20:23],s47 offen offset:1024 sc1
M a[64:67],a[232:235],a[192:195],a[64:67]
ds_read_b128 a[192:195],v250 offset:2048
v_fmac_f32 v237,4.0,v233
M a[68:71],a[232:235],a[196:199],a[68:71]
v_fma_f32 v238,-4.0,v234,v236
v_fmac_f32 v232,s45,v236
M a[72:75],a[232:235],a[200:203],a[72:75]
v_fmac_f32 v237,s40,v235
v_sub_f32 v236,v236,v234
M a[76:79],a[232:235],a[204:207],a[76:79]
v_fma_f32 v234,-4.0,v233,v235
v_sub_f32 v235,v235,v233
M a[80:83],a[232:235],a[208:211],a[80:83]
v_add_f32 v233,v238,v234
v_sub_f32 v238,v238,v234
M a[84:87],a[232:235],a[212:215],a[84:87]
v_fma_f32 v234,2.0,v235,v236
v_fmac_f32 v236,-2.0,v235
M a[88:91],a[232:235],a[216:219],a[88:91]
v_and_b32 v197,s42,v197
v_and_b32 v193,s42,v193
M a[92:95],a[232:235],a[220:223],a[92:95]
s_waitcnt vmcnt(16)
buffer_load_dwordx4 a[232:235],v251,s[20:23],s48 offen offset:1024 sc1
M a[0:3],a[236:239],a[196:199],a[0:3]
v_and_b32 v195,s42,v195
v_and_b32 v203,s42,v203
M a[4:7],a[236:239],a[200:203],a[4:7]
v_and_b32 v201,s42,v201
v_and_b32 v199,s42,v199
M a[8:11],a[236:239],a[204:207],a[8:11]
v_fmac_f32 v193,s43,v197
v_fmac_f32 v203,4.0,v195
M a[12:15],a[236:239],a[208:211],a[12:15]
v_fma_f32 v235,-4.0,v197,v201
v_fmac_f32 v193,s45,v201
M a[16:19],a[236:239],a[212:215],a[16:19]
v_fmac_f32 v203,s40,v199
v_sub_f32 v201,v201,v197
M a[20:23],a[236:239],a[216:219],a[20:23]
v_fma_f32 v197,-4.0,v195,v199
v_sub_f32 v199,v199,v195
M a[24:27],a[236:239],a[220:223],a[24:27]
s_waitcnt lgkmcnt(0)
v_add_f32 v195,v235,v197
v_sub_f32 v235,v235,v197
M a[28:31],a[236:239],a[192:195],a[28:31]
s_waitcnt vmcnt(16)
buffer_load_dwordx4 a[236:239],v251,s[20:23],s46 offen offset:2048 sc1
M a[32:35],a[240:243],a[196:199],a[32:35]
v_fma_f32 v197,2.0,v199,v201
v_fmac_f32 v201,-2.0,v199
M a[36:39],a[240:243],a[200:203],a[36:39]
v_cvt_pk_bf16_f32 v193,v232,v193
v_cvt_pk_bf16_f32 v203,v237,v203
M a[40:43],a[240:243],a[204:207],a[40:43]
v_cvt_pk_bf16_f32 v195,v233,v195
v_cvt_pk_bf16_f32 v199,v234,v197
M a[44:47],a[240:243],a[208:211],a[44:47]
v_cvt_pk_bf16_f32 v197,v238,v235
v_cvt_pk_bf16_f32 v201,v236,v201
M a[48:51],a[240:243],a[212:215],a[48:51]
ds_write2st64_b64 v247,v[192:193],v[202:203] offset0:238 offset1:255
M a[52:55],a[240:243],a[216:219],a[52:55]
s_add_u32 s28,s67,7077888
buffer_load_dwordx2 v[192:193],v245,s[12:15],s28 offen offset:0
M a[56:59],a[240:243],a[220:223],a[56:59]
buffer_load_dwordx2 v[202:203],v245,s[16:19],s28 offen offset:1536
M a[60:63],a[240:243],a[192:195],a[60:63]
s_waitcnt vmcnt(18)
buffer_load_dwordx4 a[240:243],v251,s[20:23],s47 offen offset:2048 sc1
M a[64:67],a[244:247],a[196:199],a[64:67]
ds_read_b128 a[196:199],v249 offset:2304
ds_write2st64_b64 v247,v[194:195],v[196:197] offset0:0 offset1:17
M a[68:71],a[244:247],a[200:203],a[68:71]
buffer_load_dwordx2 v[194:195],v245,s[8:11],s28 offen offset:0
M a[72:75],a[244:247],a[204:207],a[72:75]
buffer_load_dwordx2 v[196:197],v245,s[8:11],s28 offen offset:384
M a[76:79],a[244:247],a[208:211],a[76:79]
ds_write2st64_b64 v247,v[198:199],v[200:201] offset0:136 offset1:153
M a[80:83],a[244:247],a[212:215],a[80:83]
buffer_load_dwordx2 v[198:199],v245,s[8:11],s28 offen offset:768
M a[84:87],a[244:247],a[216:219],a[84:87]
buffer_load_dwordx2 v[200:201],v245,s[8:11],s28 offen offset:1152
M a[88:91],a[244:247],a[220:223],a[88:91]
s_waitcnt vmcnt(16)
v_lshlrev_b32 v234,16,v208
v_lshlrev_b32 v232,16,v204
M a[92:95],a[244:247],a[192:195],a[92:95]
buffer_load_dwordx4 a[244:247],v251,s[20:23],s48 offen offset:2048 sc1
M a[0:3],a[248:251],a[200:203],a[0:3]
v_lshlrev_b32 v233,16,v206
v_lshlrev_b32 v237,16,v214
M a[4:7],a[248:251],a[204:207],a[4:7]
s_waitcnt vmcnt(15)
s_add_u32 s46,s78,27648
v_lshlrev_b32 v236,16,v212
v_lshlrev_b32 v235,16,v210
M a[8:11],a[248:251],a[208:211],a[8:11]
v_fmac_f32 v232,s43,v234
v_fmac_f32 v237,4.0,v233
M a[12:15],a[248:251],a[212:215],a[12:15]
v_fma_f32 v238,-4.0,v234,v236
v_fmac_f32 v232,s45,v236
M a[16:19],a[248:251],a[216:219],a[16:19]
v_fmac_f32 v237,s40,v235
v_sub_f32 v236,v236,v234
M a[20:23],a[248:251],a[220:223],a[20:23]
v_fma_f32 v234,-4.0,v233,v235
v_sub_f32 v235,v235,v233
M a[24:27],a[248:251],a[192:195],a[24:27]
s_waitcnt lgkmcnt(2)
v_add_f32 v233,v238,v234
v_sub_f32 v238,v238,v234
M a[28:31],a[248:251],a[196:199],a[28:31]
buffer_load_dwordx4 a[248:251],v251,s[20:23],s46 offen offset:0 sc1
M a[32:35],a[252:255],a[200:203],a[32:35]
v_fma_f32 v234,2.0,v235,v236
v_fmac_f32 v236,-2.0,v235
M a[36:39],a[252:255],a[204:207],a[36:39]
s_add_u32 s47,s78,30720
v_and_b32 v208,s42,v208
v_and_b32 v204,s42,v204
M a[40:43],a[252:255],a[208:211],a[40:43]
v_and_b32 v206,s42,v206
v_and_b32 v214,s42,v214
M a[44:47],a[252:255],a[212:215],a[44:47]
v_and_b32 v212,s42,v212
v_and_b32 v210,s42,v210
M a[48:51],a[252:255],a[216:219],a[48:51]
v_fmac_f32 v204,s43,v208
v_fmac_f32 v214,4.0,v206
M a[52:55],a[252:255],a[220:223],a[52:55]
v_fma_f32 v235,-4.0,v208,v212
v_fmac_f32 v204,s45,v212
M a[56:59],a[252:255],a[192:195],a[56:59]
v_fmac_f32 v214,s40,v210
v_sub_f32 v212,v212,v208
M a[60:63],a[252:255],a[196:199],a[60:63]
buffer_load_dwordx4 a[252:255],v251,s[20:23],s47 offen offset:0 sc1
M a[64:67],v[216:219],a[200:203],a[64:67]
ds_read_b128 a[200:203],v249 offset:8704
v_fma_f32 v208,-4.0,v206,v210
M a[68:71],v[216:219],a[204:207],a[68:71]
s_add_u32 s48,s78,33792
ds_read_b128 a[204:207],v250 offset:8960
v_sub_f32 v210,v210,v206
M a[72:75],v[216:219],a[208:211],a[72:75]
ds_read_b128 a[208:211],v250 offset:9216
v_add_f32 v206,v235,v208
M a[76:79],v[216:219],a[212:215],a[76:79]
ds_read_b128 a[212:215],v250 offset:9472
v_sub_f32 v235,v235,v208
M a[80:83],v[216:219],a[216:219],a[80:83]
ds_read_b128 a[216:219],v250 offset:9728
v_fma_f32 v208,2.0,v210,v212
M a[84:87],v[216:219],a[220:223],a[84:87]
ds_read_b128 a[220:223],v250 offset:9984
v_fmac_f32 v212,-2.0,v210
M a[88:91],v[216:219],a[192:195],a[88:91]
ds_read_b128 a[192:195],v250 offset:10240
v_cvt_pk_bf16_f32 v204,v232,v204
M a[92:95],v[216:219],a[196:199],a[92:95]
s_waitcnt vmcnt(16) lgkmcnt(6)
buffer_load_dwordx4 v[216:219],v251,s[20:23],s48 offen offset:0 sc1
M a[96:99],v[220:223],a[200:203],a[96:99]
s_waitcnt lgkmcnt(5)
ds_read_b128 a[196:199],v250 offset:10496
v_cvt_pk_bf16_f32 v214,v237,v214
M a[100:103],v[220:223],a[204:207],a[100:103]
s_waitcnt lgkmcnt(5)
v_cvt_pk_bf16_f32 v206,v233,v206
v_cvt_pk_bf16_f32 v210,v234,v208
M a[104:107],v[220:223],a[208:211],a[104:107]
s_waitcnt lgkmcnt(4)
v_cvt_pk_bf16_f32 v208,v238,v235
v_cvt_pk_bf16_f32 v212,v236,v212
M a[108:111],v[220:223],a[212:215],a[108:111]
s_waitcnt lgkmcnt(3)
v_lshlrev_b32 v234,16,v209
v_lshlrev_b32 v232,16,v205
M a[112:115],v[220:223],a[216:219],a[112:115]
s_waitcnt lgkmcnt(2)
v_lshlrev_b32 v233,16,v207
v_lshlrev_b32 v237,16,v215
M a[116:119],v[220:223],a[220:223],a[116:119]
s_waitcnt lgkmcnt(1)
v_lshlrev_b32 v236,16,v213
v_lshlrev_b32 v235,16,v211
M a[120:123],v[220:223],a[192:195],a[120:123]
s_waitcnt lgkmcnt(0)
v_fmac_f32 v232,s43,v234
v_fmac_f32 v237,4.0,v233
M a[124:127],v[220:223],a[196:199],a[124:127]
s_waitcnt vmcnt(16)
buffer_load_dwordx4 v[220:223],v251,s[20:23],s46 offen offset:1024 sc1
M a[128:131],v[224:227],a[200:203],a[128:131]
v_fma_f32 v238,-4.0,v234,v236
v_fmac_f32 v232,s45,v236
M a[132:135],v[224:227],a[204:207],a[132:135]
v_fmac_f32 v237,s40,v235
v_sub_f32 v236,v236,v234
M a[136:139],v[224:227],a[208:211],a[136:139]
v_fma_f32 v234,-4.0,v233,v235
v_sub_f32 v235,v235,v233
M a[140:143],v[224:227],a[212:215],a[140:143]
v_add_f32 v233,v238,v234
v_sub_f32 v238,v238,v234
M a[144:147],v[224:227],a[216:219],a[144:147]
v_fma_f32 v234,2.0,v235,v236
v_fmac_f32 v236,-2.0,v235
M a[148:151],v[224:227],a[220:223],a[148:151]
v_and_b32 v209,s42,v209
v_and_b32 v205,s42,v205
M a[152:155],v[224:227],a[192:195],a[152:155]
v_and_b32 v207,s42,v207
v_and_b32 v215,s42,v215
M a[156:159],v[224:227],a[196:199],a[156:159]
s_waitcnt vmcnt(16)
buffer_load_dwordx4 v[224:227],v251,s[20:23],s47 offen offset:1024 sc1
M a[160:163],v[228:231],a[200:203],a[160:163]
ds_read_b128 a[200:203],v250 offset:10752
v_and_b32 v213,s42,v213
M a[164:167],v[228:231],a[204:207],a[164:167]
v_and_b32 v211,s42,v211
v_fmac_f32 v205,s43,v209
M a[168:171],v[228:231],a[208:211],a[168:171]
v_fmac_f32 v215,4.0,v207
v_fma_f32 v235,-4.0,v209,v213
M a[172:175],v[228:231],a[212:215],a[172:175]
v_fmac_f32 v205,s45,v213
v_fmac_f32 v215,s40,v211
M a[176:179],v[228:231],a[216:219],a[176:179]
v_sub_f32 v213,v213,v209
v_fma_f32 v209,-4.0,v207,v211
M a[180:183],v[228:231],a[220:223],a[180:183]
v_sub_f32 v211,v211,v207
v_add_f32 v207,v235,v209
M a[184:187],v[228:231],a[192:195],a[184:187]
v_sub_f32 v235,v235,v209
v_fma_f32 v209,2.0,v211,v213
M a[188:191],v[228:231],a[196:199],a[188:191]
s_waitcnt vmcnt(16)
buffer_load_dwordx4 v[228:231],v251,s[20:23],s48 offen offset:1024 sc1
M a[96:99],a[224:227],a[204:207],a[96:99]
v_fmac_f32 v213,-2.0,v211
v_cvt_pk_bf16_f32 v205,v232,v205
M a[100:103],a[224:227],a[208:211],a[100:103]
v_cvt_pk_bf16_f32 v215,v237,v215
v_cvt_pk_bf16_f32 v207,v233,v207
M a[104:107],a[224:227],a[212:215],a[104:107]
v_cvt_pk_bf16_f32 v211,v234,v209
v_cvt_pk_bf16_f32 v209,v238,v235
M a[108:111],a[224:227],a[216:219],a[108:111]
v_cvt_pk_bf16_f32 v213,v236,v213
v_add_u32 v232,121856,v247
M a[112:115],a[224:227],a[220:223],a[112:115]
ds_write2st64_b64 v232,v[204:205],v[214:215] offset0:1 offset1:18
M a[116:119],a[224:227],a[192:195],a[116:119]
s_add_u32 s28,s67,7471104
buffer_load_dwordx2 v[204:205],v245,s[12:15],s28 offen offset:0
M a[120:123],a[224:227],a[196:199],a[120:123]
s_waitcnt lgkmcnt(1)
buffer_load_dwordx2 v[214:215],v245,s[16:19],s28 offen offset:1536
M a[124:127],a[224:227],a[200:203],a[124:127]
s_waitcnt vmcnt(18)
buffer_load_dwordx4 a[224:227],v251,s[20:23],s46 offen offset:2048 sc1
M a[128:131],a[228:231],a[204:207],a[128:131]
ds_write2st64_b64 v247,v[206:207],v[208:209] offset0:1 offset1:18
M a[132:135],a[228:231],a[208:211],a[132:135]
buffer_load_dwordx2 v[206:207],v245,s[8:11],s28 offen offset:0
M a[136:139],a[228:231],a[212:215],a[136:139]
buffer_load_dwordx2 v[208:209],v245,s[8:11],s28 offen offset:384
M a[140:143],a[228:231],a[216:219],a[140:143]
ds_write2st64_b64 v247,v[210:211],v[212:213] offset0:137 offset1:154
M a[144:147],a[228:231],a[220:223],a[144:147]
buffer_load_dwordx2 v[210:211],v245,s[8:11],s28 offen offset:768
M a[148:151],a[228:231],a[192:195],a[148:151]
buffer_load_dwordx2 v[212:213],v245,s[8:11],s28 offen offset:1152
M a[152:155],a[228:231],a[196:199],a[152:155]
v_fmac_f32 v239,s43,v241
v_fmac_f32 v244,4.0,v240
M a[156:159],a[228:231],a[200:203],a[156:159]
s_waitcnt vmcnt(22)
buffer_load_dwordx4 a[228:231],v251,s[20:23],s47 offen offset:2048 sc1
M a[160:163],a[232:235],a[204:207],a[160:163]
ds_read_b128 a[204:207],v249 offset:11008
v_fma_f32 v232,-4.0,v241,v243
M a[164:167],a[232:235],a[208:211],a[164:167]
v_fmac_f32 v239,s45,v243
v_fmac_f32 v244,s40,v242
M a[168:171],a[232:235],a[212:215],a[168:171]
v_sub_f32 v243,v243,v241
v_fma_f32 v241,-4.0,v240,v242
M a[172:175],a[232:235],a[216:219],a[172:175]
v_sub_f32 v242,v242,v240
v_add_f32 v240,v232,v241
M a[176:179],a[232:235],a[220:223],a[176:179]
v_sub_f32 v232,v232,v241
v_fma_f32 v241,2.0,v242,v243
M a[180:183],a[232:235],a[192:195],a[180:183]
v_fmac_f32 v243,-2.0,v242
v_cvt_pk_bf16_f32 v233,v239,v244
M a[184:187],a[232:235],a[196:199],a[184:187]
v_cvt_pk_bf16_f32 v234,v240,v232
v_cvt_pk_bf16_f32 v235,v241,v243
M a[188:191],a[232:235],a[200:203],a[188:191]
s_waitcnt vmcnt(22)
buffer_load_short_d16_hi v239,v246,s[12:15],s74 offen offset:0
M a[96:99],a[236:239],a[208:211],a[96:99]
buffer_load_short_d16_hi v240,v246,s[8:11],s74 offen offset:0
M a[100:103],a[236:239],a[212:215],a[100:103]
buffer_load_short_d16_hi v241,v246,s[8:11],s74 offen offset:384
M a[104:107],a[236:239],a[216:219],a[104:107]
buffer_load_short_d16_hi v242,v246,s[8:11],s74 offen offset:768
M a[108:111],a[236:239],a[220:223],a[108:111]
buffer_load_short_d16_hi v243,v246,s[8:11],s74 offen offset:1152
M a[112:115],a[236:239],a[192:195],a[112:115]
buffer_load_short_d16_hi v244,v246,s[16:19],s74 offen offset:1536
M a[116:119],a[236:239],a[196:199],a[116:119]
buffer_load_dwordx4 a[232:235],v251,s[20:23],s48 offen offset:2048 sc1
M a[120:123],a[236:239],a[200:203],a[120:123]
s_waitcnt lgkmcnt(0)
s_add_u32 s46,s78,36864
v_add_u32 v232,121856,v248
M a[124:127],a[236:239],a[204:207],a[124:127]
s_waitcnt vmcnt(26)
buffer_load_dwordx4 a[236:239],v251,s[20:23],s46 offen offset:0 sc1
M a[128:131],a[240:243],a[208:211],a[128:131]
ds_write_b16 v232,v233 offset:0
M a[132:135],a[240:243],a[212:215],a[132:135]
s_add_u32 s47,s78,39936
ds_write_b16_d16_hi v232,v233 offset:8704
M a[136:139],a[240:243],a[216:219],a[136:139]
ds_write_b16 v248,v234 offset:0
M a[140:143],a[240:243],a[220:223],a[140:143]
ds_write_b16_d16_hi v248,v234 offset:8704
M a[144:147],a[240:243],a[192:195],a[144:147]
v_add_u32 v232,69632,v248
M a[148:151],a[240:243],a[196:199],a[148:151]
ds_write_b16 v232,v235 offset:0
M a[152:155],a[240:243],a[200:203],a[152:155]
ds_write_b16_d16_hi v232,v235 offset:8704
M a[156:159],a[240:243],a[204:207],a[156:159]
s_waitcnt vmcnt(22)
buffer_load_dwordx4 a[240:243],v251,s[20:23],s47 offen offset:0 sc1
M a[160:163],a[244:247],a[208:211],a[160:163]
ds_read_b128 a[208:211],v249 offset:17408
v_lshlrev_b32 v234,16,v196
M a[164:167],a[244:247],a[212:215],a[164:167]
s_add_u32 s48,s78,43008
ds_read_b128 a[212:215],v250 offset:17664
v_lshlrev_b32 v232,16,v192
M a[168:171],a[244:247],a[216:219],a[168:171]
ds_read_b128 a[216:219],v250 offset:17920
v_lshlrev_b32 v233,16,v194
M a[172:175],a[244:247],a[220:223],a[172:175]
ds_read_b128 a[220:223],v250 offset:18176
v_lshlrev_b32 v237,16,v202
M a[176:179],a[244:247],a[192:195],a[176:179]
ds_read_b128 a[192:195],v250 offset:18432
v_lshlrev_b32 v236,16,v200
M a[180:183],a[244:247],a[196:199],a[180:183]
ds_read_b128 a[196:199],v250 offset:18688
v_lshlrev_b32 v235,16,v198
M a[184:187],a[244:247],a[200:203],a[184:187]
ds_read_b128 a[200:203],v250 offset:18944
v_fmac_f32 v232,s43,v234
M a[188:191],a[244:247],a[204:207],a[188:191]
s_waitcnt vmcnt(22) lgkmcnt(6)
buffer_load_dwordx4 a[244:247],v251,s[20:23],s48 offen offset:0 sc1
M v[0:3],a[248:251],a[208:211],v[0:3]
s_waitcnt lgkmcnt(5)
ds_read_b128 a[204:207],v250 offset:19200
v_fmac_f32 v237,4.0,v233
M v[4:7],a[248:251],a[212:215],v[4:7]
s_waitcnt lgkmcnt(5)
v_fma_f32 v238,-4.0,v234,v236
v_fmac_f32 v232,s45,v236
M v[8:11],a[248:251],a[216:219],v[8:11]
s_waitcnt lgkmcnt(4)
v_fmac_f32 v237,s40,v235
v_sub_f32 v236,v236,v234
M v[12:15],a[248:251],a[220:223],v[12:15]
s_waitcnt lgkmcnt(3)
v_fma_f32 v234,-4.0,v233,v235
v_sub_f32 v235,v235,v233
M v[16:19],a[248:251],a[192:195],v[16:19]
s_waitcnt lgkmcnt(2)
v_add_f32 v233,v238,v234
v_sub_f32 v238,v238,v234
M v[20:23],a[248:251],a[196:199],v[20:23]
s_waitcnt lgkmcnt(1)
v_fma_f32 v234,2.0,v235,v236
v_fmac_f32 v236,-2.0,v235
M v[24:27],a[248:251],a[200:203],v[24:27]
s_waitcnt lgkmcnt(0)
v_and_b32 v196,s42,v196
v_and_b32 v192,s42,v192
M v[28:31],a[248:251],a[204:207],v[28:31]
s_waitcnt vmcnt(22)
buffer_load_dwordx4 a[248:251],v251,s[20:23],s46 offen offset:1024 sc1
M v[32:35],a[252:255],a[208:211],v[32:35]
v_and_b32 v194,s42,v194
v_and_b32 v202,s42,v202
M v[36:39],a[252:255],a[212:215],v[36:39]
v_and_b32 v200,s42,v200
v_and_b32 v198,s42,v198
M v[40:43],a[252:255],a[216:219],v[40:43]
v_fmac_f32 v192,s43,v196
v_fmac_f32 v202,4.0,v194
M v[44:47],a[252:255],a[220:223],v[44:47]
v_fma_f32 v235,-4.0,v196,v200
v_fmac_f32 v192,s45,v200
M v[48:51],a[252:255],a[192:195],v[48:51]
v_fmac_f32 v202,s40,v198
v_sub_f32 v200,v200,v196
M v[52:55],a[252:255],a[196:199],v[52:55]
v_fma_f32 v196,-4.0,v194,v198
v_sub_f32 v198,v198,v194
M v[56:59],a[252:255],a[200:203],v[56:59]
v_add_f32 v194,v235,v196
v_sub_f32 v235,v235,v196
M v[60:63],a[252:255],a[204:207],v[60:63]
s_waitcnt vmcnt(22)
buffer_load_dwordx4 a[252:255],v251,s[20:23],s47 offen offset:1024 sc1
M v[64:67],v[216:219],a[208:211],v[64:67]
ds_read_b128 a[208:211],v250 offset:19456
v_fma_f32 v196,2.0,v198,v200
M v[68:71],v[216:219],a[212:215],v[68:71]
v_fmac_f32 v200,-2.0,v198
v_cvt_pk_bf16_f32 v192,v232,v192
M v[72:75],v[216:219],a[216:219],v[72:75]
v_cvt_pk_bf16_f32 v202,v237,v202
v_cvt_pk_bf16_f32 v194,v233,v194
M v[76:79],v[216:219],a[220:223],v[76:79]
v_cvt_pk_bf16_f32 v198,v234,v196
v_cvt_pk_bf16_f32 v196,v238,v235
M v[80:83],v[216:219],a[192:195],v[80:83]
v_cvt_pk_bf16_f32 v200,v236,v200
v_lshlrev_b32 v234,16,v197
M v[84:87],v[216:219],a[196:199],v[84:87]
v_lshlrev_b32 v232,16,v193
v_lshlrev_b32 v233,16,v195
M v[88:91],v[216:219],a[200:203],v[88:91]
v_lshlrev_b32 v237,16,v203
v_lshlrev_b32 v236,16,v201
M v[92:95],v[216:219],a[204:207],v[92:95]
s_waitcnt vmcnt(22)
buffer_load_dwordx4 v[216:219],v251,s[20:23],s48 offen offset:1024 sc1
M v[0:3],v[220:223],a[212:215],v[0:3]
v_lshlrev_b32 v235,16,v199
v_fmac_f32 v232,s43,v234
M v[4:7],v[220:223],a[216:219],v[4:7]
v_fmac_f32 v237,4.0,v233
v_fma_f32 v238,-4.0,v234,v236
M v[8:11],v[220:223],a[220:223],v[8:11]
v_fmac_f32 v232,s45,v236
v_fmac_f32 v237,s40,v235
M v[12:15],v[220:223],a[192:195],v[12:15]
v_sub_f32 v236,v236,v234
v_fma_f32 v234,-4.0,v233,v235
M v[16:19],v[220:223],a[196:199],v[16:19]
v_sub_f32 v235,v235,v233
v_add_f32 v233,v238,v234
M v[20:23],v[220:223],a[200:203],v[20:23]
v_sub_f32 v238,v238,v234
v_fma_f32 v234,2.0,v235,v236
M v[24:27],v[220:223],a[204:207],v[24:27]
s_waitcnt lgkmcnt(0)
v_fmac_f32 v236,-2.0,v235
v_and_b32 v197,s42,v197
M v[28:31],v[220:223],a[208:211],v[28:31]
s_waitcnt vmcnt(22)
buffer_load_dwordx4 v[220:223],v251,s[20:23],s46 offen offset:2048 sc1
M v[32:35],v[224:227],a[212:215],v[32:35]
v_and_b32 v193,s42,v193
v_and_b32 v195,s42,v195
M v[36:39],v[224:227],a[216:219],v[36:39]
v_and_b32 v203,s42,v203
v_and_b32 v201,s42,v201
M v[40:43],v[224:227],a[220:223],v[40:43]
v_and_b32 v199,s42,v199
v_fmac_f32 v193,s43,v197
M v[44:47],v[224:227],a[192:195],v[44:47]
v_fmac_f32 v203,4.0,v195
v_fma_f32 v235,-4.0,v197,v201
M v[48:51],v[224:227],a[196:199],v[48:51]
v_fmac_f32 v193,s45,v201
v_fmac_f32 v203,s40,v199
M v[52:55],v[224:227],a[200:203],v[52:55]
v_sub_f32 v201,v201,v197
v_fma_f32 v197,-4.0,v195,v199
M v[56:59],v[224:227],a[204:207],v[56:59]
v_sub_f32 v199,v199,v195
v_add_f32 v195,v235,v197
M v[60:63],v[224:227],a[208:211],v[60:63]
s_waitcnt vmcnt(22)
buffer_load_dwordx4 v[224:227],v251,s[20:23],s47 offen offset:2048 sc1
M v[64:67],v[228:231],a[212:215],v[64:67]
ds_read_b128 a[212:215],v249 offset:19712
v_sub_f32 v235,v235,v197
M v[68:71],v[228:231],a[216:219],v[68:71]
v_fma_f32 v197,2.0,v199,v201
v_fmac_f32 v201,-2.0,v199
M v[72:75],v[228:231],a[220:223],v[72:75]
v_cvt_pk_bf16_f32 v193,v232,v193
v_cvt_pk_bf16_f32 v203,v237,v203
M v[76:79],v[228:231],a[192:195],v[76:79]
v_cvt_pk_bf16_f32 v195,v233,v195
v_cvt_pk_bf16_f32 v199,v234,v197
M v[80:83],v[228:231],a[196:199],v[80:83]
v_cvt_pk_bf16_f32 v197,v238,v235
v_cvt_pk_bf16_f32 v201,v236,v201
M v[84:87],v[228:231],a[200:203],v[84:87]
v_add_u32 v232,121856,v247
M v[88:91],v[228:231],a[204:207],v[88:91]
ds_write2st64_b64 v232,v[192:193],v[202:203] offset0:2 offset1:19
M v[92:95],v[228:231],a[208:211],v[92:95]
s_waitcnt vmcnt(20)
s_add_u32 s28,s68,6291456
buffer_load_dwordx2 v[192:193],v245,s[12:15],s28 offen offset:0
M v[0:3],a[224:227],a[216:219],v[0:3]
buffer_load_dwordx2 v[202:203],v245,s[16:19],s28 offen offset:1536
M v[4:7],a[224:227],a[220:223],v[4:7]
buffer_load_dwordx4 v[228:231],v251,s[20:23],s48 offen offset:2048 sc1
M v[8:11],a[224:227],a[192:195],v[8:11]
s_add_u32 s46,s79,9216
ds_write2st64_b64 v247,v[194:195],v[196:197] offset0:2 offset1:19
M v[12:15],a[224:227],a[196:199],v[12:15]
buffer_load_dwordx2 v[194:195],v245,s[8:11],s28 offen offset:0
M v[16:19],a[224:227],a[200:203],v[16:19]
buffer_load_dwordx2 v[196:197],v245,s[8:11],s28 offen offset:384
M v[20:23],a[224:227],a[204:207],v[20:23]
ds_write2st64_b64 v247,v[198:199],v[200:201] offset0:138 offset1:155
M v[24:27],a[224:227],a[208:211],v[24:27]
s_waitcnt lgkmcnt(3)
buffer_load_dwordx2 v[198:199],v245,s[8:11],s28 offen offset:768
M v[28:31],a[224:227],a[212:215],v[28:31]
s_waitcnt vmcnt(21)
buffer_load_dwordx2 v[200:201],v245,s[8:11],s28 offen offset:1152
M v[32:35],a[228:231],a[216:219],v[32:35]
buffer_load_dwordx4 a[224:227],v251,s[20:23],s46 offen offset:0 sc1
M v[36:39],a[228:231],a[220:223],v[36:39]
s_add_u32 s47,s79,12288
v_lshlrev_b32 v234,16,v208
v_lshlrev_b32 v232,16,v204
M v[40:43],a[228:231],a[192:195],v[40:43]
v_lshlrev_b32 v233,16,v206
v_lshlrev_b32 v237,16,v214
M v[44:47],a[228:231],a[196:199],v[44:47]
v_lshlrev_b32 v236,16,v212
v_lshlrev_b32 v235,16,v210
M v[48:51],a[228:231],a[200:203],v[48:51]
v_fmac_f32 v232,s43,v234
v_fmac_f32 v237,4.0,v233
M v[52:55],a[228:231],a[204:207],v[52:55]
v_fma_f32 v238,-4.0,v234,v236
v_fmac_f32 v232,s45,v236
M v[56:59],a[228:231],a[208:211],v[56:59]
v_fmac_f32 v237,s40,v235
v_sub_f32 v236,v236,v234
M v[60:63],a[228:231],a[212:215],v[60:63]
s_waitcnt vmcnt(16)
buffer_load_dwordx4 a[228:231],v251,s[20:23],s47 offen offset:0 sc1
M v[64:67],a[232:235],a[216:219],v[64:67]
ds_read_b128 a[216:219],v249 offset:26112
v_fma_f32 v234,-4.0,v233,v235
M v[68:71],a[232:235],a[220:223],v[68:71]
s_add_u32 s48,s79,15360
ds_read_b128 a[220:223],v250 offset:26368
v_sub_f32 v235,v235,v233
M v[72:75],a[232:235],a[192:195],v[72:75]
ds_read_b128 a[192:195],v250 offset:26624
v_add_f32 v233,v238,v234
M v[76:79],a[232:235],a[196:199],v[76:79]
ds_read_b128 a[196:199],v250 offset:26880
v_sub_f32 v238,v238,v234
M v[80:83],a[232:235],a[200:203],v[80:83]
ds_read_b128 a[200:203],v250 offset:27136
v_fma_f32 v234,2.0,v235,v236
M v[84:87],a[232:235],a[204:207],v[84:87]
ds_read_b128 a[204:207],v250 offset:27392
v_fmac_f32 v236,-2.0,v235
M v[88:91],a[232:235],a[208:211],v[88:91]
ds_read_b128 a[208:211],v250 offset:27648
v_and_b32 v208,s42,v208
M v[92:95],a[232:235],a[212:215],v[92:95]
s_waitcnt vmcnt(16) lgkmcnt(6)
buffer_load_dwordx4 a[232:235],v251,s[20:23],s48 offen offset:0 sc1
M v[96:99],a[236:239],a[216:219],v[96:99]
s_waitcnt lgkmcnt(5)
ds_read_b128 a[212:215],v250 offset:27904
v_and_b32 v204,s42,v204
M v[100:103],a[236:239],a[220:223],v[100:103]
s_waitcnt lgkmcnt(5)
v_and_b32 v206,s42,v206
v_and_b32 v214,s42,v214
M v[104:107],a[236:239],a[192:195],v[104:107]
s_waitcnt lgkmcnt(4)
v_and_b32 v212,s42,v212
v_and_b32 v210,s42,v210
M v[108:111],a[236:239],a[196:199],v[108:111]
s_waitcnt lgkmcnt(3)
v_fmac_f32 v204,s43,v208
v_fmac_f32 v214,4.0,v206
M v[112:115],a[236:239],a[200:203],v[112:115]
s_waitcnt lgkmcnt(2)
v_fma_f32 v235,-4.0,v208,v212
v_fmac_f32 v204,s45,v212
M v[116:119],a[236:239],a[204:207],v[116:119]
s_waitcnt lgkmcnt(1)
v_fmac_f32 v214,s40,v210
v_sub_f32 v212,v212,v208
M v[120:123],a[236:239],a[208:211],v[120:123]
s_waitcnt lgkmcnt(0)
v_fma_f32 v208,-4.0,v206,v210
v_sub_f32 v210,v210,v206
M v[124:127],a[236:239],a[212:215],v[124:127]
s_waitcnt vmcnt(16)
buffer_load_dwordx4 a[236:239],v251,s[20:23],s46 offen offset:1024 sc1
M v[128:131],a[240:243],a[216:219],v[128:131]
v_add_f32 v206,v235,v208
v_sub_f32 v235,v235,v208
M v[132:135],a[240:243],a[220:223],v[132:135]
v_fma_f32 v208,2.0,v210,v212
v_fmac_f32 v212,-2.0,v210
M v[136:139],a[240:243],a[192:195],v[136:139]
v_cvt_pk_bf16_f32 v204,v232,v204
v_cvt_pk_bf16_f32 v214,v237,v214
M v[140:143],a[240:243],a[196:199],v[140:143]
v_cvt_pk_bf16_f32 v206,v233,v206
v_cvt_pk_bf16_f32 v210,v234,v208
M v[144:147],a[240:243],a[200:203],v[144:147]
v_cvt_pk_bf16_f32 v208,v238,v235
v_cvt_pk_bf16_f32 v212,v236,v212
M v[148:151],a[240:243],a[204:207],v[148:151]
v_lshlrev_b32 v234,16,v209
v_lshlrev_b32 v232,16,v205
M v[152:155],a[240:243],a[208:211],v[152:155]
v_lshlrev_b32 v233,16,v207
v_lshlrev_b32 v237,16,v215
M v[156:159],a[240:243],a[212:215],v[156:159]
s_waitcnt vmcnt(16)
buffer_load_dwordx4 a[240:243],v251,s[20:23],s47 offen offset:1024 sc1
M v[160:163],a[244:247],a[216:219],v[160:163]
ds_read_b128 a[216:219],v250 offset:28160
v_lshlrev_b32 v236,16,v213
M v[164:167],a[244:247],a[220:223],v[164:167]
v_lshlrev_b32 v235,16,v211
v_fmac_f32 v232,s43,v234
M v[168:171],a[244:247],a[192:195],v[168:171]
v_fmac_f32 v237,4.0,v233
v_fma_f32 v238,-4.0,v234,v236
M v[172:175],a[244:247],a[196:199],v[172:175]
v_fmac_f32 v232,s45,v236
v_fmac_f32 v237,s40,v235
M v[176:179],a[244:247],a[200:203],v[176:179]
v_sub_f32 v236,v236,v234
v_fma_f32 v234,-4.0,v233,v235
M v[180:183],a[244:247],a[204:207],v[180:183]
v_sub_f32 v235,v235,v233
v_add_f32 v233,v238,v234
M v[184:187],a[244:247],a[208:211],v[184:187]
v_sub_f32 v238,v238,v234
v_fma_f32 v234,2.0,v235,v236
M v[188:191],a[244:247],a[212:215],v[188:191]
s_waitcnt vmcnt(16)
buffer_load_dwordx4 a[244:247],v251,s[20:23],s48 offen offset:1024 sc1
M v[96:99],a[248:251],a[220:223],v[96:99]
v_fmac_f32 v236,-2.0,v235
v_and_b32 v209,s42,v209
M v[100:103],a[248:251],a[192:195],v[100:103]
v_and_b32 v205,s42,v205
v_and_b32 v207,s42,v207
M v[104:107],a[248:251],a[196:199],v[104:107]
v_and_b32 v215,s42,v215
v_and_b32 v213,s42,v213
M v[108:111],a[248:251],a[200:203],v[108:111]
v_and_b32 v211,s42,v211
v_fmac_f32 v205,s43,v209
M v[112:115],a[248:251],a[204:207],v[112:115]
v_fmac_f32 v215,4.0,v207
v_fma_f32 v235,-4.0,v209,v213
M v[116:119],a[248:251],a[208:211],v[116:119]
v_fmac_f32 v205,s45,v213
v_fmac_f32 v215,s40,v211
M v[120:123],a[248:251],a[212:215],v[120:123]
s_waitcnt lgkmcnt(0)
v_sub_f32 v213,v213,v209
v_fma_f32 v209,-4.0,v207,v211
M v[124:127],a[248:251],a[216:219],v[124:127]
s_waitcnt vmcnt(16)
buffer_load_dwordx4 a[248:251],v251,s[20:23],s46 offen offset:2048 sc1
M v[128:131],a[252:255],a[220:223],v[128:131]
v_sub_f32 v211,v211,v207
v_add_f32 v207,v235,v209
M v[132:135],a[252:255],a[192:195],v[132:135]
v_sub_f32 v235,v235,v209
v_fma_f32 v209,2.0,v211,v213
M v[136:139],a[252:255],a[196:199],v[136:139]
v_fmac_f32 v213,-2.0,v211
v_cvt_pk_bf16_f32 v205,v232,v205
M v[140:143],a[252:255],a[200:203],v[140:143]
v_cvt_pk_bf16_f32 v215,v237,v215
v_cvt_pk_bf16_f32 v207,v233,v207
M v[144:147],a[252:255],a[204:207],v[144:147]
v_cvt_pk_bf16_f32 v211,v234,v209
v_cvt_pk_bf16_f32 v209,v238,v235
M v[148:151],a[252:255],a[208:211],v[148:151]
v_cvt_pk_bf16_f32 v213,v236,v213
v_add_u32 v232,121856,v247
M v[152:155],a[252:255],a[212:215],v[152:155]
ds_write2st64_b64 v232,v[204:205],v[214:215] offset0:3 offset1:20
M v[156:159],a[252:255],a[216:219],v[156:159]
s_waitcnt vmcnt(16)
s_add_u32 s28,s68,6684672
buffer_load_dwordx2 v[204:205],v245,s[12:15],s28 offen offset:0
M v[160:163],v[216:219],a[220:223],v[160:163]
buffer_load_dwordx2 v[214:215],v245,s[16:19],s28 offen offset:1536
M v[164:167],v[216:219],a[192:195],v[164:167]
buffer_load_dwordx4 a[252:255],v251,s[20:23],s47 offen offset:2048 sc1
M v[168:171],v[216:219],a[196:199],v[168:171]
ds_read_b128 a[220:223],v249 offset:28416
ds_write2st64_b64 v247,v[206:207],v[208:209] offset0:3 offset1:20
M v[172:175],v[216:219],a[200:203],v[172:175]
buffer_load_dwordx2 v[206:207],v245,s[8:11],s28 offen offset:0
M v[176:179],v[216:219],a[204:207],v[176:179]
buffer_load_dwordx2 v[208:209],v245,s[8:11],s28 offen offset:384
M v[180:183],v[216:219],a[208:211],v[180:183]
ds_write2st64_b64 v247,v[210:211],v[212:213] offset0:139 offset1:156
M v[184:187],v[216:219],a[212:215],v[184:187]
buffer_load_dwordx2 v[210:211],v245,s[8:11],s28 offen offset:768
M v[188:191],v[216:219],a[216:219],v[188:191]
s_waitcnt vmcnt(21)
buffer_load_dwordx2 v[212:213],v245,s[8:11],s28 offen offset:1152
M v[96:99],v[220:223],a[192:195],v[96:99]
buffer_load_dwordx4 v[216:219],v251,s[20:23],s48 offen offset:2048 sc1
M v[100:103],v[220:223],a[196:199],v[100:103]
s_waitcnt vmcnt(17)
s_add_u32 s46,s79,18432
v_lshlrev_b32 v234,16,v196
v_lshlrev_b32 v232,16,v192
M v[104:107],v[220:223],a[200:203],v[104:107]
v_lshlrev_b32 v233,16,v194
v_lshlrev_b32 v237,16,v202
M v[108:111],v[220:223],a[204:207],v[108:111]
s_waitcnt vmcnt(15)
v_lshlrev_b32 v236,16,v200
v_lshlrev_b32 v235,16,v198
M v[112:115],v[220:223],a[208:211],v[112:115]
v_fmac_f32 v232,s43,v234
v_fmac_f32 v237,4.0,v233
M v[116:119],v[220:223],a[212:215],v[116:119]
v_fma_f32 v238,-4.0,v234,v236
v_fmac_f32 v232,s45,v236
M v[120:123],v[220:223],a[216:219],v[120:123]
s_waitcnt lgkmcnt(2)
v_fmac_f32 v237,s40,v235
v_sub_f32 v236,v236,v234
M v[124:127],v[220:223],a[220:223],v[124:127]
buffer_load_dwordx4 v[220:223],v251,s[20:23],s46 offen offset:0 sc1
M v[128:131],v[224:227],a[192:195],v[128:131]
v_fma_f32 v234,-4.0,v233,v235
v_sub_f32 v235,v235,v233
M v[132:135],v[224:227],a[196:199],v[132:135]
s_add_u32 s47,s79,21504
v_add_f32 v233,v238,v234
v_sub_f32 v238,v238,v234
M v[136:139],v[224:227],a[200:203],v[136:139]
v_fma_f32 v234,2.0,v235,v236
v_fmac_f32 v236,-2.0,v235
M v[140:143],v[224:227],a[204:207],v[140:143]
v_and_b32 v196,s42,v196
v_and_b32 v192,s42,v192
M v[144:147],v[224:227],a[208:211],v[144:147]
v_and_b32 v194,s42,v194
v_and_b32 v202,s42,v202
M v[148:151],v[224:227],a[212:215],v[148:151]
v_add_u32 v249,0xffffbc00,v249
v_add_u32 v250,0xffffbc00,v250
M v[152:155],v[224:227],a[216:219],v[152:155]
s_waitcnt lgkmcnt(0)
s_barrier
v_and_b32 v200,s42,v200
M v[156:159],v[224:227],a[220:223],v[156:159]
buffer_load_dwordx4 v[224:227],v251,s[20:23],s47 offen offset:0 sc1
M v[160:163],v[228:231],a[192:195],v[160:163]
ds_read_b128 a[192:195],v249 offset:0
v_and_b32 v198,s42,v198
M v[164:167],v[228:231],a[196:199],v[164:167]
s_add_u32 s48,s79,24576
ds_read_b128 a[196:199],v250 offset:256
v_fmac_f32 v192,s43,v196
M v[168:171],v[228:231],a[200:203],v[168:171]
ds_read_b128 a[200:203],v250 offset:512
v_fmac_f32 v202,4.0,v194
M v[172:175],v[228:231],a[204:207],v[172:175]
ds_read_b128 a[204:207],v250 offset:768
v_fma_f32 v235,-4.0,v196,v200
M v[176:179],v[228:231],a[208:211],v[176:179]
ds_read_b128 a[208:211],v250 offset:1024
v_fmac_f32 v192,s45,v200
M v[180:183],v[228:231],a[212:215],v[180:183]
ds_read_b128 a[212:215],v250 offset:1280
v_fmac_f32 v202,s40,v198
M v[184:187],v[228:231],a[216:219],v[184:187]
ds_read_b128 a[216:219],v250 offset:1536
v_sub_f32 v200,v200,v196
M v[188:191],v[228:231],a[220:223],v[188:191]
s_waitcnt vmcnt(16) lgkmcnt(6)
buffer_load_dwordx4 v[228:231],v251,s[20:23],s48 offen offset:0 sc1
M a[0:3],a[224:227],a[192:195],a[0:3]
s_waitcnt lgkmcnt(5)
ds_read_b128 a[220:223],v250 offset:1792
v_fma_f32 v196,-4.0,v194,v198
M a[4:7],a[224:227],a[196:199],a[4:7]
s_waitcnt lgkmcnt(5)
v_sub_f32 v198,v198,v194
v_add_f32 v194,v235,v196
M a[8:11],a[224:227],a[200:203],a[8:11]
s_waitcnt lgkmcnt(4)
v_sub_f32 v235,v235,v196
v_fma_f32 v196,2.0,v198,v200
M a[12:15],a[224:227],a[204:207],a[12:15]
s_waitcnt lgkmcnt(3)
v_fmac_f32 v200,-2.0,v198
v_cvt_pk_bf16_f32 v192,v232,v192
M a[16:19],a[224:227],a[208:211],a[16:19]
s_waitcnt lgkmcnt(2)
v_cvt_pk_bf16_f32 v202,v237,v202
v_cvt_pk_bf16_f32 v194,v233,v194
M a[20:23],a[224:227],a[212:215],a[20:23]
s_waitcnt lgkmcnt(1)
v_cvt_pk_bf16_f32 v198,v234,v196
v_cvt_pk_bf16_f32 v196,v238,v235
M a[24:27],a[224:227],a[216:219],a[24:27]
s_waitcnt lgkmcnt(0)
v_cvt_pk_bf16_f32 v200,v236,v200
v_lshlrev_b32 v234,16,v197
M a[28:31],a[224:227],a[220:223],a[28:31]
s_waitcnt vmcnt(16)
buffer_load_dwordx4 a[224:227],v251,s[20:23],s46 offen offset:1024 sc1
M a[32:35],a[228:231],a[192:195],a[32:35]
v_lshlrev_b32 v232,16,v193
v_lshlrev_b32 v233,16,v195
M a[36:39],a[228:231],a[196:199],a[36:39]
v_lshlrev_b32 v237,16,v203
v_lshlrev_b32 v236,16,v201
M a[40:43],a[228:231],a[200:203],a[40:43]
v_lshlrev_b32 v235,16,v199
v_fmac_f32 v232,s43,v234
M a[44:47],a[228:231],a[204:207],a[44:47]
v_fmac_f32 v237,4.0,v233
v_fma_f32 v238,-4.0,v234,v236
M a[48:51],a[228:231],a[208:211],a[48:51]
v_fmac_f32 v232,s45,v236
v_fmac_f32 v237,s40,v235
M a[52:55],a[228:231],a[212:215],a[52:55]
v_sub_f32 v236,v236,v234
v_fma_f32 v234,-4.0,v233,v235
M a[56:59],a[228:231],a[216:219],a[56:59]
v_sub_f32 v235,v235,v233
v_add_f32 v233,v238,v234
M a[60:63],a[228:231],a[220:223],a[60:63]
s_waitcnt vmcnt(16)
buffer_load_dwordx4 a[228:231],v251,s[20:23],s47 offen offset:1024 sc1
M a[64:67],a[232:235],a[192:195],a[64:67]
ds_read_b128 a[192:195],v250 offset:2048
v_sub_f32 v238,v238,v234
M a[68:71],a[232:235],a[196:199],a[68:71]
v_fma_f32 v234,2.0,v235,v236
v_fmac_f32 v236,-2.0,v235
M a[72:75],a[232:235],a[200:203],a[72:75]
v_and_b32 v197,s42,v197
v_and_b32 v193,s42,v193
M a[76:79],a[232:235],a[204:207],a[76:79]
v_and_b32 v195,s42,v195
v_and_b32 v203,s42,v203
M a[80:83],a[232:235],a[208:211],a[80:83]
v_and_b32 v201,s42,v201
v_and_b32 v199,s42,v199
M a[84:87],a[232:235],a[212:215],a[84:87]
v_fmac_f32 v193,s43,v197
v_fmac_f32 v203,4.0,v195
M a[88:91],a[232:235],a[216:219],a[88:91]
v_fma_f32 v235,-4.0,v197,v201
v_fmac_f32 v193,s45,v201
M a[92:95],a[232:235],a[220:223],a[92:95]
s_waitcnt vmcnt(16)
buffer_load_dwordx4 a[232:235],v251,s[20:23],s48 offen offset:1024 sc1
M a[0:3],a[236:239],a[196:199],a[0:3]
v_fmac_f32 v203,s40,v199
v_sub_f32 v201,v201,v197
M a[4:7],a[236:239],a[200:203],a[4:7]
v_fma_f32 v197,-4.0,v195,v199
v_sub_f32 v199,v199,v195
M a[8:11],a[236:239],a[204:207],a[8:11]
v_add_f32 v195,v235,v197
v_sub_f32 v235,v235,v197
M a[12:15],a[236:239],a[208:211],a[12:15]
v_fma_f32 v197,2.0,v199,v201
v_fmac_f32 v201,-2.0,v199
M a[16:19],a[236:239],a[212:215],a[16:19]
v_cvt_pk_bf16_f32 v193,v232,v193
v_cvt_pk_bf16_f32 v203,v237,v203
M a[20:23],a[236:239],a[216:219],a[20:23]
v_cvt_pk_bf16_f32 v195,v233,v195
v_cvt_pk_bf16_f32 v199,v234,v197
M a[24:27],a[236:239],a[220:223],a[24:27]
s_waitcnt lgkmcnt(0)
v_cvt_pk_bf16_f32 v197,v238,v235
v_cvt_pk_bf16_f32 v201,v236,v201
M a[28:31],a[236:239],a[192:195],a[28:31]
s_waitcnt vmcnt(16)
buffer_load_dwordx4 a[236:239],v251,s[20:23],s46 offen offset:2048 sc1
M a[32:35],a[240:243],a[196:199],a[32:35]
v_add_u32 v232,139264,v247
M a[36:39],a[240:243],a[200:203],a[36:39]
ds_write2st64_b64 v232,v[192:193],v[202:203] offset0:0 offset1:17
M a[40:43],a[240:243],a[204:207],a[40:43]
s_add_u32 s28,s68,7077888
buffer_load_dwordx2 v[192:193],v245,s[12:15],s28 offen offset:0
M a[44:47],a[240:243],a[208:211],a[44:47]
buffer_load_dwordx2 v[202:203],v245,s[16:19],s28 offen offset:1536
M a[48:51],a[240:243],a[212:215],a[48:51]
ds_write2st64_b64 v247,v[194:195],v[196:197] offset0:34 offset1:51
M a[52:55],a[240:243],a[216:219],a[52:55]
buffer_load_dwordx2 v[194:195],v245,s[8:11],s28 offen offset:0
M a[56:59],a[240:243],a[220:223],a[56:59]
buffer_load_dwordx2 v[196:197],v245,s[8:11],s28 offen offset:384
M a[60:63],a[240:243],a[192:195],a[60:63]
s_waitcnt vmcnt(20)
buffer_load_dwordx4 a[240:243],v251,s[20:23],s47 offen offset:2048 sc1
M a[64:67],a[244:247],a[196:199],a[64:67]
ds_read_b128 a[196:199],v249 offset:2304
ds_write2st64_b64 v247,v[198:199],v[200:201] offset0:68 offset1:85
M a[68:71],a[244:247],a[200:203],a[68:71]
buffer_load_dwordx2 v[198:199],v245,s[8:11],s28 offen offset:768
M a[72:75],a[244:247],a[204:207],a[72:75]
buffer_load_dwordx2 v[200:201],v245,s[8:11],s28 offen offset:1152
M a[76:79],a[244:247],a[208:211],a[76:79]
s_waitcnt vmcnt(17)
v_lshlrev_b32 v234,16,v208
v_lshlrev_b32 v232,16,v204
M a[80:83],a[244:247],a[212:215],a[80:83]
v_lshlrev_b32 v233,16,v206
v_lshlrev_b32 v237,16,v214
M a[84:87],a[244:247],a[216:219],a[84:87]
s_waitcnt vmcnt(15)
v_lshlrev_b32 v236,16,v212
v_lshlrev_b32 v235,16,v210
M a[88:91],a[244:247],a[220:223],a[88:91]
v_fmac_f32 v232,s43,v234
v_fmac_f32 v237,4.0,v233
M a[92:95],a[244:247],a[192:195],a[92:95]
buffer_load_dwordx4 a[244:247],v251,s[20:23],s48 offen offset:2048 sc1
M a[0:3],a[248:251],a[200:203],a[0:3]
v_fma_f32 v238,-4.0,v234,v236
v_fmac_f32 v232,s45,v236
M a[4:7],a[248:251],a[204:207],a[4:7]
s_add_u32 s46,s79,27648
v_fmac_f32 v237,s40,v235
v_sub_f32 v236,v236,v234
M a[8:11],a[248:251],a[208:211],a[8:11]
v_fma_f32 v234,-4.0,v233,v235
v_sub_f32 v235,v235,v233
M a[12:15],a[248:251],a[212:215],a[12:15]
v_add_f32 v233,v238,v234
v_sub_f32 v238,v238,v234
M a[16:19],a[248:251],a[216:219],a[16:19]
v_fma_f32 v234,2.0,v235,v236
v_fmac_f32 v236,-2.0,v235
M a[20:23],a[248:251],a[220:223],a[20:23]
v_and_b32 v208,s42,v208
v_and_b32 v204,s42,v204
M a[24:27],a[248:251],a[192:195],a[24:27]
s_waitcnt lgkmcnt(1)
v_and_b32 v206,s42,v206
v_and_b32 v214,s42,v214
M a[28:31],a[248:251],a[196:199],a[28:31]
buffer_load_dwordx4 a[248:251],v251,s[20:23],s46 offen offset:0 sc1
M a[32:35],a[252:255],a[200:203],a[32:35]
v_and_b32 v212,s42,v212
v_and_b32 v210,s42,v210
M a[36:39],a[252:255],a[204:207],a[36:39]
s_add_u32 s47,s79,30720
v_fmac_f32 v204,s43,v208
v_fmac_f32 v214,4.0,v206
M a[40:43],a[252:255],a[208:211],a[40:43]
v_fma_f32 v235,-4.0,v208,v212
v_fmac_f32 v204,s45,v212
M a[44:47],a[252:255],a[212:215],a[44:47]
v_fmac_f32 v214,s40,v210
v_sub_f32 v212,v212,v208
M a[48:51],a[252:255],a[216:219],a[48:51]
v_fma_f32 v208,-4.0,v206,v210
v_sub_f32 v210,v210,v206
M a[52:55],a[252:255],a[220:223],a[52:55]
v_add_f32 v206,v235,v208
v_sub_f32 v235,v235,v208
M a[56:59],a[252:255],a[192:195],a[56:59]
v_fma_f32 v208,2.0,v210,v212
v_fmac_f32 v212,-2.0,v210
M a[60:63],a[252:255],a[196:199],a[60:63]
s_waitcnt vmcnt(16)
buffer_load_dwordx4 a[252:255],v251,s[20:23],s47 offen offset:0 sc1
M a[64:67],v[216:219],a[200:203],a[64:67]
ds_read_b128 a[200:203],v249 offset:8704
v_cvt_pk_bf16_f32 v204,v232,v204
M a[68:71],v[216:219],a[204:207],a[68:71]
s_add_u32 s48,s79,33792
ds_read_b128 a[204:207],v250 offset:8960
v_cvt_pk_bf16_f32 v214,v237,v214
M a[72:75],v[216:219],a[208:211],a[72:75]
ds_read_b128 a[208:211],v250 offset:9216
v_cvt_pk_bf16_f32 v206,v233,v206
M a[76:79],v[216:219],a[212:215],a[76:79]
ds_read_b128 a[212:215],v250 offset:9472
v_cvt_pk_bf16_f32 v210,v234,v208
M a[80:83],v[216:219],a[216:219],a[80:83]
ds_read_b128 a[216:219],v250 offset:9728
v_cvt_pk_bf16_f32 v208,v238,v235
M a[84:87],v[216:219],a[220:223],a[84:87]
ds_read_b128 a[220:223],v250 offset:9984
v_cvt_pk_bf16_f32 v212,v236,v212
M a[88:91],v[216:219],a[192:195],a[88:91]
ds_read_b128 a[192:195],v250 offset:10240
v_lshlrev_b32 v234,16,v209
M a[92:95],v[216:219],a[196:199],a[92:95]
s_waitcnt vmcnt(16) lgkmcnt(6)
buffer_load_dwordx4 v[216:219],v251,s[20:23],s48 offen offset:0 sc1
M a[96:99],v[220:223],a[200:203],a[96:99]
s_waitcnt lgkmcnt(5)
ds_read_b128 a[196:199],v250 offset:10496
v_lshlrev_b32 v232,16,v205
M a[100:103],v[220:223],a[204:207],a[100:103]
s_waitcnt lgkmcnt(5)
v_lshlrev_b32 v233,16,v207
v_lshlrev_b32 v237,16,v215
M a[104:107],v[220:223],a[208:211],a[104:107]
s_waitcnt lgkmcnt(4)
v_lshlrev_b32 v236,16,v213
v_lshlrev_b32 v235,16,v211
M a[108:111],v[220:223],a[212:215],a[108:111]
s_waitcnt lgkmcnt(3)
v_fmac_f32 v232,s43,v234
v_fmac_f32 v237,4.0,v233
M a[112:115],v[220:223],a[216:219],a[112:115]
s_waitcnt lgkmcnt(2)
v_fma_f32 v238,-4.0,v234,v236
v_fmac_f32 v232,s45,v236
M a[116:119],v[220:223],a[220:223],a[116:119]
s_waitcnt lgkmcnt(1)
v_fmac_f32 v237,s40,v235
v_sub_f32 v236,v236,v234
M a[120:123],v[220:223],a[192:195],a[120:123]
s_waitcnt lgkmcnt(0)
v_fma_f32 v234,-4.0,v233,v235
v_sub_f32 v235,v235,v233
M a[124:127],v[220:223],a[196:199],a[124:127]
s_waitcnt vmcnt(16)
buffer_load_dwordx4 v[220:223],v251,s[20:23],s46 offen offset:1024 sc1
M a[128:131],v[224:227],a[200:203],a[128:131]
v_add_f32 v233,v238,v234
v_sub_f32 v238,v238,v234
M a[132:135],v[224:227],a[204:207],a[132:135]
v_fma_f32 v234,2.0,v235,v236
v_fmac_f32 v236,-2.0,v235
M a[136:139],v[224:227],a[208:211],a[136:139]
v_and_b32 v209,s42,v209
v_and_b32 v205,s42,v205
M a[140:143],v[224:227],a[212:215],a[140:143]
v_and_b32 v207,s42,v207
v_and_b32 v215,s42,v215
M a[144:147],v[224:227],a[216:219],a[144:147]
v_and_b32 v213,s42,v213
v_and_b32 v211,s42,v211
M a[148:151],v[224:227],a[220:223],a[148:151]
v_fmac_f32 v205,s43,v209
v_fmac_f32 v215,4.0,v207
M a[152:155],v[224:227],a[192:195],a[152:155]
v_fma_f32 v235,-4.0,v209,v213
v_fmac_f32 v205,s45,v213
M a[156:159],v[224:227],a[196:199],a[156:159]
s_waitcnt vmcnt(16)
buffer_load_dwordx4 v[224:227],v251,s[20:23],s47 offen offset:1024 sc1
M a[160:163],v[228:231],a[200:203],a[160:163]
ds_read_b128 a[200:203],v250 offset:10752
v_fmac_f32 v215,s40,v211
M a[164:167],v[228:231],a[204:207],a[164:167]
v_sub_f32 v213,v213,v209
v_fma_f32 v209,-4.0,v207,v211
M a[168:171],v[228:231],a[208:211],a[168:171]
v_sub_f32 v211,v211,v207
v_add_f32 v207,v235,v209
M a[172:175],v[228:231],a[212:215],a[172:175]
v_sub_f32 v235,v235,v209
v_fma_f32 v209,2.0,v211,v213
M a[176:179],v[228:231],a[216:219],a[176:179]
v_fmac_f32 v213,-2.0,v211
v_cvt_pk_bf16_f32 v205,v232,v205
M a[180:183],v[228:231],a[220:223],a[180:183]
v_cvt_pk_bf16_f32 v215,v237,v215
v_cvt_pk_bf16_f32 v207,v233,v207
M a[184:187],v[228:231],a[192:195],a[184:187]
v_cvt_pk_bf16_f32 v211,v234,v209
v_cvt_pk_bf16_f32 v209,v238,v235
M a[188:191],v[228:231],a[196:199],a[188:191]
s_waitcnt vmcnt(16)
buffer_load_dwordx4 v[228:231],v251,s[20:23],s48 offen offset:1024 sc1
M a[96:99],a[224:227],a[204:207],a[96:99]
v_cvt_pk_bf16_f32 v213,v236,v213
v_add_u32 v232,139264,v247
M a[100:103],a[224:227],a[208:211],a[100:103]
ds_write2st64_b64 v232,v[204:205],v[214:215] offset0:1 offset1:18
M a[104:107],a[224:227],a[212:215],a[104:107]
s_add_u32 s28,s68,7471104
buffer_load_dwordx2 v[204:205],v245,s[12:15],s28 offen offset:0
M a[108:111],a[224:227],a[216:219],a[108:111]
buffer_load_dwordx2 v[214:215],v245,s[16:19],s28 offen offset:1536
M a[112:115],a[224:227],a[220:223],a[112:115]
ds_write2st64_b64 v247,v[206:207],v[208:209] offset0:35 offset1:52
M a[116:119],a[224:227],a[192:195],a[116:119]
buffer_load_dwordx2 v[206:207],v245,s[8:11],s28 offen offset:0
M a[120:123],a[224:227],a[196:199],a[120:123]
s_waitcnt lgkmcnt(2)
buffer_load_dwordx2 v[208:209],v245,s[8:11],s28 offen offset:384
M a[124:127],a[224:227],a[200:203],a[124:127]
s_waitcnt vmcnt(20)
buffer_load_dwordx4 a[224:227],v251,s[20:23],s46 offen offset:2048 sc1
M a[128:131],a[228:231],a[204:207],a[128:131]
ds_write2st64_b64 v247,v[210:211],v[212:213] offset0:69 offset1:86
M a[132:135],a[228:231],a[208:211],a[132:135]
buffer_load_dwordx2 v[210:211],v245,s[8:11],s28 offen offset:768
M a[136:139],a[228:231],a[212:215],a[136:139]
buffer_load_dwordx2 v[212:213],v245,s[8:11],s28 offen offset:1152
M a[140:143],a[228:231],a[216:219],a[140:143]
v_fmac_f32 v239,s43,v241
v_fmac_f32 v244,4.0,v240
M a[144:147],a[228:231],a[220:223],a[144:147]
v_fma_f32 v232,-4.0,v241,v243
v_fmac_f32 v239,s45,v243
M a[148:151],a[228:231],a[192:195],a[148:151]
v_fmac_f32 v244,s40,v242
v_sub_f32 v243,v243,v241
M a[152:155],a[228:231],a[196:199],a[152:155]
v_fma_f32 v241,-4.0,v240,v242
v_sub_f32 v242,v242,v240
M a[156:159],a[228:231],a[200:203],a[156:159]
s_waitcnt vmcnt(22)
buffer_load_dwordx4 a[228:231],v251,s[20:23],s47 offen offset:2048 sc1
M a[160:163],a[232:235],a[204:207],a[160:163]
ds_read_b128 a[204:207],v249 offset:11008
v_add_f32 v240,v232,v241
M a[164:167],a[232:235],a[208:211],a[164:167]
v_sub_f32 v232,v232,v241
v_fma_f32 v241,2.0,v242,v243
M a[168:171],a[232:235],a[212:215],a[168:171]
v_fmac_f32 v243,-2.0,v242
v_cvt_pk_bf16_f32 v233,v239,v244
M a[172:175],a[232:235],a[216:219],a[172:175]
v_cvt_pk_bf16_f32 v234,v240,v232
v_cvt_pk_bf16_f32 v235,v241,v243
M a[176:179],a[232:235],a[220:223],a[176:179]
buffer_load_short_d16_hi v239,v246,s[12:15],s75 offen offset:0
M a[180:183],a[232:235],a[192:195],a[180:183]
buffer_load_short_d16_hi v240,v246,s[8:11],s75 offen offset:0
M a[184:187],a[232:235],a[196:199],a[184:187]
buffer_load_short_d16_hi v241,v246,s[8:11],s75 offen offset:384
M a[188:191],a[232:235],a[200:203],a[188:191]
s_waitcnt vmcnt(25)
buffer_load_short_d16_hi v242,v246,s[8:11],s75 offen offset:768
M a[96:99],a[236:239],a[208:211],a[96:99]
buffer_load_short_d16_hi v243,v246,s[8:11],s75 offen offset:1152
M a[100:103],a[236:239],a[212:215],a[100:103]
buffer_load_short_d16_hi v244,v246,s[16:19],s75 offen offset:1536
M a[104:107],a[236:239],a[216:219],a[104:107]
buffer_load_dwordx4 a[232:235],v251,s[20:23],s48 offen offset:2048 sc1
M a[108:111],a[236:239],a[220:223],a[108:111]
s_add_u32 s46,s79,36864
v_add_u32 v232,139264,v248
M a[112:115],a[236:239],a[192:195],a[112:115]
ds_write_b16 v232,v233 offset:0
M a[116:119],a[236:239],a[196:199],a[116:119]
ds_write_b16_d16_hi v232,v233 offset:8704
M a[120:123],a[236:239],a[200:203],a[120:123]
s_waitcnt lgkmcnt(2)
ds_write_b16 v248,v234 offset:17408
M a[124:127],a[236:239],a[204:207],a[124:127]
s_waitcnt vmcnt(24)
buffer_load_dwordx4 a[236:239],v251,s[20:23],s46 offen offset:0 sc1
M a[128:131],a[240:243],a[208:211],a[128:131]
ds_write_b16_d16_hi v248,v234 offset:26112
M a[132:135],a[240:243],a[212:215],a[132:135]
s_add_u32 s47,s79,39936
ds_write_b16 v248,v235 offset:34816
M a[136:139],a[240:243],a[216:219],a[136:139]
ds_write_b16_d16_hi v248,v235 offset:43520
M a[140:143],a[240:243],a[220:223],a[140:143]
v_lshlrev_b32 v234,16,v196
v_lshlrev_b32 v232,16,v192
M a[144:147],a[240:243],a[192:195],a[144:147]
v_lshlrev_b32 v233,16,v194
v_lshlrev_b32 v237,16,v202
M a[148:151],a[240:243],a[196:199],a[148:151]
v_add_u32 v249,0x4400,v249
v_add_u32 v250,0x4400,v250
M a[152:155],a[240:243],a[200:203],a[152:155]
s_waitcnt vmcnt(23)
v_lshlrev_b32 v236,16,v200
v_lshlrev_b32 v235,16,v198
M a[156:159],a[240:243],a[204:207],a[156:159]
s_waitcnt vmcnt(22)
buffer_load_dwordx4 a[240:243],v251,s[20:23],s47 offen offset:0 sc1
M a[160:163],a[244:247],a[208:211],a[160:163]
ds_read_b128 a[208:211],v249 offset:52224
v_fmac_f32 v232,s43,v234
M a[164:167],a[244:247],a[212:215],a[164:167]
s_add_u32 s48,s79,43008
ds_read_b128 a[212:215],v250 offset:52480
v_fmac_f32 v237,4.0,v233
M a[168:171],a[244:247],a[216:219],a[168:171]
ds_read_b128 a[216:219],v250 offset:52736
v_fma_f32 v238,-4.0,v234,v236
M a[172:175],a[244:247],a[220:223],a[172:175]
ds_read_b128 a[220:223],v250 offset:52992
v_fmac_f32 v232,s45,v236
M a[176:179],a[244:247],a[192:195],a[176:179]
ds_read_b128 a[192:195],v250 offset:53248
v_fmac_f32 v237,s40,v235
M a[180:183],a[244:247],a[196:199],a[180:183]
ds_read_b128 a[196:199],v250 offset:53504
v_sub_f32 v236,v236,v234
M a[184:187],a[244:247],a[200:203],a[184:187]
ds_read_b128 a[200:203],v250 offset:53760
v_fma_f32 v234,-4.0,v233,v235
M a[188:191],a[244:247],a[204:207],a[188:191]
s_waitcnt vmcnt(22) lgkmcnt(6)
buffer_load_dwordx4 a[244:247],v251,s[20:23],s48 offen offset:0 sc1
M v[0:3],a[248:251],a[208:211],v[0:3]
s_waitcnt lgkmcnt(5)
ds_read_b128 a[204:207],v250 offset:54016
v_sub_f32 v235,v235,v233
M v[4:7],a[248:251],a[212:215],v[4:7]
s_waitcnt lgkmcnt(5)
v_add_f32 v233,v238,v234
v_sub_f32 v238,v238,v234
M v[8:11],a[248:251],a[216:219],v[8:11]
s_waitcnt lgkmcnt(4)
v_fma_f32 v234,2.0,v235,v236
v_fmac_f32 v236,-2.0,v235
M v[12:15],a[248:251],a[220:223],v[12:15]
s_waitcnt lgkmcnt(3)
v_and_b32 v196,s42,v196
v_and_b32 v192,s42,v192
M v[16:19],a[248:251],a[192:195],v[16:19]
s_waitcnt lgkmcnt(2)
v_and_b32 v194,s42,v194
v_and_b32 v202,s42,v202
M v[20:23],a[248:251],a[196:199],v[20:23]
s_waitcnt lgkmcnt(1)
v_and_b32 v200,s42,v200
v_and_b32 v198,s42,v198
M v[24:27],a[248:251],a[200:203],v[24:27]
s_waitcnt lgkmcnt(0)
v_fmac_f32 v192,s43,v196
v_fmac_f32 v202,4.0,v194
M v[28:31],a[248:251],a[204:207],v[28:31]
s_waitcnt vmcnt(22)
buffer_load_dwordx4 a[248:251],v251,s[20:23],s46 offen offset:1024 sc1
M v[32:35],a[252:255],a[208:211],v[32:35]
v_fma_f32 v235,-4.0,v196,v200
v_fmac_f32 v192,s45,v200
M v[36:39],a[252:255],a[212:215],v[36:39]
v_fmac_f32 v202,s40,v198
v_sub_f32 v200,v200,v196
M v[40:43],a[252:255],a[216:219],v[40:43]
v_fma_f32 v196,-4.0,v194,v198
v_sub_f32 v198,v198,v194
M v[44:47],a[252:255],a[220:223],v[44:47]
v_add_f32 v194,v235,v196
v_sub_f32 v235,v235,v196
M v[48:51],a[252:255],a[192:195],v[48:51]
v_fma_f32 v196,2.0,v198,v200
v_fmac_f32 v200,-2.0,v198
M v[52:55],a[252:255],a[196:199],v[52:55]
v_cvt_pk_bf16_f32 v192,v232,v192
v_cvt_pk_bf16_f32 v202,v237,v202
M v[56:59],a[252:255],a[200:203],v[56:59]
v_cvt_pk_bf16_f32 v194,v233,v194
v_cvt_pk_bf16_f32 v198,v234,v196
M v[60:63],a[252:255],a[204:207],v[60:63]
s_waitcnt vmcnt(22)
buffer_load_dwordx4 a[252:255],v251,s[20:23],s47 offen offset:1024 sc1
M v[64:67],v[216:219],a[208:211],v[64:67]
ds_read_b128 a[208:211],v250 offset:54272
v_cvt_pk_bf16_f32 v196,v238,v235
M v[68:71],v[216:219],a[212:215],v[68:71]
v_cvt_pk_bf16_f32 v200,v236,v200
v_lshlrev_b32 v234,16,v197
M v[72:75],v[216:219],a[216:219],v[72:75]
v_lshlrev_b32 v232,16,v193
v_lshlrev_b32 v233,16,v195
M v[76:79],v[216:219],a[220:223],v[76:79]
v_lshlrev_b32 v237,16,v203
v_lshlrev_b32 v236,16,v201
M v[80:83],v[216:219],a[192:195],v[80:83]
v_lshlrev_b32 v235,16,v199
v_fmac_f32 v232,s43,v234
M v[84:87],v[216:219],a[196:199],v[84:87]
v_fmac_f32 v237,4.0,v233
v_fma_f32 v238,-4.0,v234,v236
M v[88:91],v[216:219],a[200:203],v[88:91]
v_fmac_f32 v232,s45,v236
v_fmac_f32 v237,s40,v235
M v[92:95],v[216:219],a[204:207],v[92:95]
s_waitcnt vmcnt(22)
buffer_load_dwordx4 v[216:219],v251,s[20:23],s48 offen offset:1024 sc1
M v[0:3],v[220:223],a[212:215],v[0:3]
v_sub_f32 v236,v236,v234
v_fma_f32 v234,-4.0,v233,v235
M v[4:7],v[220:223],a[216:219],v[4:7]
v_sub_f32 v235,v235,v233
v_add_f32 v233,v238,v234
M v[8:11],v[220:223],a[220:223],v[8:11]
v_sub_f32 v238,v238,v234
v_fma_f32 v234,2.0,v235,v236
M v[12:15],v[220:223],a[192:195],v[12:15]
v_fmac_f32 v236,-2.0,v235
v_and_b32 v197,s42,v197
M v[16:19],v[220:223],a[196:199],v[16:19]
v_and_b32 v193,s42,v193
v_and_b32 v195,s42,v195
M v[20:23],v[220:223],a[200:203],v[20:23]
v_and_b32 v203,s42,v203
v_and_b32 v201,s42,v201
M v[24:27],v[220:223],a[204:207],v[24:27]
s_waitcnt lgkmcnt(0)
v_and_b32 v199,s42,v199
v_fmac_f32 v193,s43,v197
M v[28:31],v[220:223],a[208:211],v[28:31]
s_waitcnt vmcnt(22)
buffer_load_dwordx4 v[220:223],v251,s[20:23],s46 offen offset:2048 sc1
M v[32:35],v[224:227],a[212:215],v[32:35]
v_fmac_f32 v203,4.0,v195
v_fma_f32 v235,-4.0,v197,v201
M v[36:39],v[224:227],a[216:219],v[36:39]
v_fmac_f32 v193,s45,v201
v_fmac_f32 v203,s40,v199
M v[40:43],v[224:227],a[220:223],v[40:43]
v_sub_f32 v201,v201,v197
v_fma_f32 v197,-4.0,v195,v199
M v[44:47],v[224:227],a[192:195],v[44:47]
v_sub_f32 v199,v199,v195
v_add_f32 v195,v235,v197
M v[48:51],v[224:227],a[196:199],v[48:51]
v_sub_f32 v235,v235,v197
v_fma_f32 v197,2.0,v199,v201
M v[52:55],v[224:227],a[200:203],v[52:55]
v_fmac_f32 v201,-2.0,v199
v_cvt_pk_bf16_f32 v193,v232,v193
M v[56:59],v[224:227],a[204:207],v[56:59]
v_cvt_pk_bf16_f32 v203,v237,v203
v_cvt_pk_bf16_f32 v195,v233,v195
M v[60:63],v[224:227],a[208:211],v[60:63]
s_waitcnt vmcnt(22)
buffer_load_dwordx4 v[224:227],v251,s[20:23],s47 offen offset:2048 sc1
M v[64:67],v[228:231],a[212:215],v[64:67]
ds_read_b128 a[212:215],v249 offset:54528
v_cvt_pk_bf16_f32 v199,v234,v197
M v[68:71],v[228:231],a[216:219],v[68:71]
v_cvt_pk_bf16_f32 v197,v238,v235
v_cvt_pk_bf16_f32 v201,v236,v201
M v[72:75],v[228:231],a[220:223],v[72:75]
v_add_u32 v232,139264,v247
M v[76:79],v[228:231],a[192:195],v[76:79]
ds_write2st64_b64 v232,v[192:193],v[202:203] offset0:2 offset1:19
M v[80:83],v[228:231],a[196:199],v[80:83]
s_add_u32 s28,s69,6291456
buffer_load_dwordx2 v[192:193],v245,s[12:15],s28 offen offset:0
M v[84:87],v[228:231],a[200:203],v[84:87]
buffer_load_dwordx2 v[202:203],v245,s[16:19],s28 offen offset:1536
M v[88:91],v[228:231],a[204:207],v[88:91]
ds_write2st64_b64 v247,v[194:195],v[196:197] offset0:36 offset1:53
M v[92:95],v[228:231],a[208:211],v[92:95]
s_waitcnt vmcnt(20)
buffer_load_dwordx2 v[194:195],v245,s[8:11],s28 offen offset:0
M v[0:3],a[224:227],a[216:219],v[0:3]
buffer_load_dwordx2 v[196:197],v245,s[8:11],s28 offen offset:384
M v[4:7],a[224:227],a[220:223],v[4:7]
buffer_load_dwordx4 v[228:231],v251,s[20:23],s48 offen offset:2048 sc1
M v[8:11],a[224:227],a[192:195],v[8:11]
s_add_u32 s46,s80,9216
ds_write2st64_b64 v247,v[198:199],v[200:201] offset0:70 offset1:87
M v[12:15],a[224:227],a[196:199],v[12:15]
buffer_load_dwordx2 v[198:199],v245,s[8:11],s28 offen offset:768
M v[16:19],a[224:227],a[200:203],v[16:19]
buffer_load_dwordx2 v[200:201],v245,s[8:11],s28 offen offset:1152
M v[20:23],a[224:227],a[204:207],v[20:23]
v_lshlrev_b32 v234,16,v208
v_lshlrev_b32 v232,16,v204
M v[24:27],a[224:227],a[208:211],v[24:27]
s_waitcnt lgkmcnt(3)
v_lshlrev_b32 v233,16,v206
v_lshlrev_b32 v237,16,v214
M v[28:31],a[224:227],a[212:215],v[28:31]
s_waitcnt vmcnt(22)
buffer_load_dwordx4 a[224:227],v251,s[20:23],s46 offen offset:0 sc1
M v[32:35],a[228:231],a[216:219],v[32:35]
v_lshlrev_b32 v236,16,v212
v_lshlrev_b32 v235,16,v210
M v[36:39],a[228:231],a[220:223],v[36:39]
s_add_u32 s47,s80,12288
v_fmac_f32 v232,s43,v234
v_fmac_f32 v237,4.0,v233
M v[40:43],a[228:231],a[192:195],v[40:43]
v_fma_f32 v238,-4.0,v234,v236
v_fmac_f32 v232,s45,v236
M v[44:47],a[228:231],a[196:199],v[44:47]
v_fmac_f32 v237,s40,v235
v_sub_f32 v236,v236,v234
M v[48:51],a[228:231],a[200:203],v[48:51]
v_fma_f32 v234,-4.0,v233,v235
v_sub_f32 v235,v235,v233
M v[52:55],a[228:231],a[204:207],v[52:55]
v_add_f32 v233,v238,v234
v_sub_f32 v238,v238,v234
M v[56:59],a[228:231],a[208:211],v[56:59]
v_fma_f32 v234,2.0,v235,v236
v_fmac_f32 v236,-2.0,v235
M v[60:63],a[228:231],a[212:215],v[60:63]
s_waitcnt vmcnt(16)
buffer_load_dwordx4 a[228:231],v251,s[20:23],s47 offen offset:0 sc1
M v[64:67],a[232:235],a[216:219],v[64:67]
ds_read_b128 a[216:219],v249 offset:60928
v_and_b32 v208,s42,v208
M v[68:71],a[232:235],a[220:223],v[68:71]
s_add_u32 s48,s80,15360
ds_read_b128 a[220:223],v250 offset:61184
v_and_b32 v204,s42,v204
M v[72:75],a[232:235],a[192:195],v[72:75]
ds_read_b128 a[192:195],v250 offset:61440
v_and_b32 v206,s42,v206
M v[76:79],a[232:235],a[196:199],v[76:79]
ds_read_b128 a[196:199],v250 offset:61696
v_and_b32 v214,s42,v214
M v[80:83],a[232:235],a[200:203],v[80:83]
ds_read_b128 a[200:203],v250 offset:61952
v_and_b32 v212,s42,v212
M v[84:87],a[232:235],a[204:207],v[84:87]
ds_read_b128 a[204:207],v250 offset:62208
v_and_b32 v210,s42,v210
M v[88:91],a[232:235],a[208:211],v[88:91]
ds_read_b128 a[208:211],v250 offset:62464
v_fmac_f32 v204,s43,v208
M v[92:95],a[232:235],a[212:215],v[92:95]
s_waitcnt vmcnt(16) lgkmcnt(6)
buffer_load_dwordx4 a[232:235],v251,s[20:23],s48 offen offset:0 sc1
M v[96:99],a[236:239],a[216:219],v[96:99]
s_waitcnt lgkmcnt(5)
ds_read_b128 a[212:215],v250 offset:62720
v_fmac_f32 v214,4.0,v206
M v[100:103],a[236:239],a[220:223],v[100:103]
s_waitcnt lgkmcnt(5)
v_fma_f32 v235,-4.0,v208,v212
v_fmac_f32 v204,s45,v212
M v[104:107],a[236:239],a[192:195],v[104:107]
s_waitcnt lgkmcnt(4)
v_fmac_f32 v214,s40,v210
v_sub_f32 v212,v212,v208
M v[108:111],a[236:239],a[196:199],v[108:111]
s_waitcnt lgkmcnt(3)
v_fma_f32 v208,-4.0,v206,v210
v_sub_f32 v210,v210,v206
M v[112:115],a[236:239],a[200:203],v[112:115]
s_waitcnt lgkmcnt(2)
v_add_f32 v206,v235,v208
v_sub_f32 v235,v235,v208
M v[116:119],a[236:239],a[204:207],v[116:119]
s_waitcnt lgkmcnt(1)
v_fma_f32 v208,2.0,v210,v212
v_fmac_f32 v212,-2.0,v210
M v[120:123],a[236:239],a[208:211],v[120:123]
s_waitcnt lgkmcnt(0)
v_cvt_pk_bf16_f32 v204,v232,v204
v_cvt_pk_bf16_f32 v214,v237,v214
M v[124:127],a[236:239],a[212:215],v[124:127]
s_waitcnt vmcnt(16)
buffer_load_dwordx4 a[236:239],v251,s[20:23],s46 offen offset:1024 sc1
M v[128:131],a[240:243],a[216:219],v[128:131]
v_cvt_pk_bf16_f32 v206,v233,v206
v_cvt_pk_bf16_f32 v210,v234,v208
M v[132:135],a[240:243],a[220:223],v[132:135]
v_cvt_pk_bf16_f32 v208,v238,v235
v_cvt_pk_bf16_f32 v212,v236,v212
M v[136:139],a[240:243],a[192:195],v[136:139]
v_lshlrev_b32 v234,16,v209
v_lshlrev_b32 v232,16,v205
M v[140:143],a[240:243],a[196:199],v[140:143]
v_lshlrev_b32 v233,16,v207
v_lshlrev_b32 v237,16,v215
M v[144:147],a[240:243],a[200:203],v[144:147]
v_lshlrev_b32 v236,16,v213
v_lshlrev_b32 v235,16,v211
M v[148:151],a[240:243],a[204:207],v[148:151]
v_fmac_f32 v232,s43,v234
v_fmac_f32 v237,4.0,v233
M v[152:155],a[240:243],a[208:211],v[152:155]
v_fma_f32 v238,-4.0,v234,v236
v_fmac_f32 v232,s45,v236
M v[156:159],a[240:243],a[212:215],v[156:159]
s_waitcnt vmcnt(16)
buffer_load_dwordx4 a[240:243],v251,s[20:23],s47 offen offset:1024 sc1
M v[160:163],a[244:247],a[216:219],v[160:163]
ds_read_b128 a[216:219],v250 offset:62976
v_fmac_f32 v237,s40,v235
M v[164:167],a[244:247],a[220:223],v[164:167]
v_sub_f32 v236,v236,v234
v_fma_f32 v234,-4.0,v233,v235
M v[168:171],a[244:247],a[192:195],v[168:171]
v_sub_f32 v235,v235,v233
v_add_f32 v233,v238,v234
M v[172:175],a[244:247],a[196:199],v[172:175]
v_sub_f32 v238,v238,v234
v_fma_f32 v234,2.0,v235,v236
M v[176:179],a[244:247],a[200:203],v[176:179]
v_fmac_f32 v236,-2.0,v235
v_and_b32 v209,s42,v209
M v[180:183],a[244:247],a[204:207],v[180:183]
v_and_b32 v205,s42,v205
v_and_b32 v207,s42,v207
M v[184:187],a[244:247],a[208:211],v[184:187]
v_and_b32 v215,s42,v215
v_and_b32 v213,s42,v213
M v[188:191],a[244:247],a[212:215],v[188:191]
s_waitcnt vmcnt(16)
buffer_load_dwordx4 a[244:247],v251,s[20:23],s48 offen offset:1024 sc1
M v[96:99],a[248:251],a[220:223],v[96:99]
v_and_b32 v211,s42,v211
v_fmac_f32 v205,s43,v209
M v[100:103],a[248:251],a[192:195],v[100:103]
v_fmac_f32 v215,4.0,v207
v_fma_f32 v235,-4.0,v209,v213
M v[104:107],a[248:251],a[196:199],v[104:107]
v_fmac_f32 v205,s45,v213
v_fmac_f32 v215,s40,v211
M v[108:111],a[248:251],a[200:203],v[108:111]
v_sub_f32 v213,v213,v209
v_fma_f32 v209,-4.0,v207,v211
M v[112:115],a[248:251],a[204:207],v[112:115]
v_sub_f32 v211,v211,v207
v_add_f32 v207,v235,v209
M v[116:119],a[248:251],a[208:211],v[116:119]
v_sub_f32 v235,v235,v209
v_fma_f32 v209,2.0,v211,v213
M v[120:123],a[248:251],a[212:215],v[120:123]
s_waitcnt lgkmcnt(0)
v_fmac_f32 v213,-2.0,v211
v_cvt_pk_bf16_f32 v205,v232,v205
M v[124:127],a[248:251],a[216:219],v[124:127]
s_waitcnt vmcnt(16)
buffer_load_dwordx4 a[248:251],v251,s[20:23],s46 offen offset:2048 sc1
M v[128:131],a[252:255],a[220:223],v[128:131]
v_cvt_pk_bf16_f32 v215,v237,v215
v_cvt_pk_bf16_f32 v207,v233,v207
M v[132:135],a[252:255],a[192:195],v[132:135]
v_cvt_pk_bf16_f32 v211,v234,v209
v_cvt_pk_bf16_f32 v209,v238,v235
M v[136:139],a[252:255],a[196:199],v[136:139]
v_cvt_pk_bf16_f32 v213,v236,v213
v_add_u32 v232,139264,v247
M v[140:143],a[252:255],a[200:203],v[140:143]
ds_write2st64_b64 v232,v[204:205],v[214:215] offset0:3 offset1:20
M v[144:147],a[252:255],a[204:207],v[144:147]
s_add_u32 s28,s69,6684672
buffer_load_dwordx2 v[204:205],v245,s[12:15],s28 offen offset:0
M v[148:151],a[252:255],a[208:211],v[148:151]
buffer_load_dwordx2 v[214:215],v245,s[16:19],s28 offen offset:1536
M v[152:155],a[252:255],a[212:215],v[152:155]
ds_write2st64_b64 v247,v[206:207],v[208:209] offset0:37 offset1:54
M v[156:159],a[252:255],a[216:219],v[156:159]
s_waitcnt vmcnt(18)
buffer_load_dwordx2 v[206:207],v245,s[8:11],s28 offen offset:0
M v[160:163],v[216:219],a[220:223],v[160:163]
buffer_load_dwordx2 v[208:209],v245,s[8:11],s28 offen offset:384
M v[164:167],v[216:219],a[192:195],v[164:167]
buffer_load_dwordx4 a[252:255],v251,s[20:23],s47 offen offset:2048 sc1
M v[168:171],v[216:219],a[196:199],v[168:171]
ds_read_b128 a[220:223],v249 offset:63232
ds_write2st64_b64 v247,v[210:211],v[212:213] offset0:71 offset1:88
M v[172:175],v[216:219],a[200:203],v[172:175]
buffer_load_dwordx2 v[210:211],v245,s[8:11],s28 offen offset:768
M v[176:179],v[216:219],a[204:207],v[176:179]
buffer_load_dwordx2 v[212:213],v245,s[8:11],s28 offen offset:1152
M v[180:183],v[216:219],a[208:211],v[180:183]
s_waitcnt vmcnt(17)
v_lshlrev_b32 v234,16,v196
v_lshlrev_b32 v232,16,v192
M v[184:187],v[216:219],a[212:215],v[184:187]
v_lshlrev_b32 v233,16,v194
v_lshlrev_b32 v237,16,v202
M v[188:191],v[216:219],a[216:219],v[188:191]
buffer_load_dwordx4 v[216:219],v251,s[20:23],s48 offen offset:2048 sc1
M v[96:99],v[220:223],a[192:195],v[96:99]
s_waitcnt vmcnt(15)
v_lshlrev_b32 v236,16,v200
v_lshlrev_b32 v235,16,v198
M v[100:103],v[220:223],a[196:199],v[100:103]
s_add_u32 s46,s80,18432
v_fmac_f32 v232,s43,v234
v_fmac_f32 v237,4.0,v233
M v[104:107],v[220:223],a[200:203],v[104:107]
v_fma_f32 v238,-4.0,v234,v236
v_fmac_f32 v232,s45,v236
M v[108:111],v[220:223],a[204:207],v[108:111]
v_fmac_f32 v237,s40,v235
v_sub_f32 v236,v236,v234
M v[112:115],v[220:223],a[208:211],v[112:115]
v_fma_f32 v234,-4.0,v233,v235
v_sub_f32 v235,v235,v233
M v[116:119],v[220:223],a[212:215],v[116:119]
v_add_f32 v233,v238,v234
v_sub_f32 v238,v238,v234
M v[120:123],v[220:223],a[216:219],v[120:123]
s_waitcnt lgkmcnt(1)
v_fma_f32 v234,2.0,v235,v236
v_fmac_f32 v236,-2.0,v235
M v[124:127],v[220:223],a[220:223],v[124:127]
buffer_load_dwordx4 v[220:223],v251,s[20:23],s46 offen offset:0 sc1
M v[128:131],v[224:227],a[192:195],v[128:131]
v_and_b32 v196,s42,v196
v_and_b32 v192,s42,v192
M v[132:135],v[224:227],a[196:199],v[132:135]
s_add_u32 s47,s80,21504
v_and_b32 v194,s42,v194
v_and_b32 v202,s42,v202
M v[136:139],v[224:227],a[200:203],v[136:139]
v_and_b32 v200,s42,v200
v_and_b32 v198,s42,v198
M v[140:143],v[224:227],a[204:207],v[140:143]
v_fmac_f32 v192,s43,v196
v_fmac_f32 v202,4.0,v194
M v[144:147],v[224:227],a[208:211],v[144:147]
v_fma_f32 v235,-4.0,v196,v200
v_fmac_f32 v192,s45,v200
M v[148:151],v[224:227],a[212:215],v[148:151]
v_fmac_f32 v202,s40,v198
v_sub_f32 v200,v200,v196
M v[152:155],v[224:227],a[216:219],v[152:155]
s_waitcnt lgkmcnt(0)
s_barrier
v_fma_f32 v196,-4.0,v194,v198
M v[156:159],v[224:227],a[220:223],v[156:159]
buffer_load_dwordx4 v[224:227],v251,s[20:23],s47 offen offset:0 sc1
M v[160:163],v[228:231],a[192:195],v[160:163]
ds_read_b128 a[192:195],v249 offset:0
v_sub_f32 v198,v198,v194
M v[164:167],v[228:231],a[196:199],v[164:167]
s_add_u32 s48,s80,24576
ds_read_b128 a[196:199],v250 offset:256
v_add_f32 v194,v235,v196
M v[168:171],v[228:231],a[200:203],v[168:171]
ds_read_b128 a[200:203],v250 offset:512
v_sub_f32 v235,v235,v196
M v[172:175],v[228:231],a[204:207],v[172:175]
ds_read_b128 a[204:207],v250 offset:768
v_fma_f32 v196,2.0,v198,v200
M v[176:179],v[228:231],a[208:211],v[176:179]
ds_read_b128 a[208:211],v250 offset:1024
v_fmac_f32 v200,-2.0,v198
M v[180:183],v[228:231],a[212:215],v[180:183]
ds_read_b128 a[212:215],v250 offset:1280
v_cvt_pk_bf16_f32 v192,v232,v192
M v[184:187],v[228:231],a[216:219],v[184:187]
ds_read_b128 a[216:219],v250 offset:1536
v_cvt_pk_bf16_f32 v202,v237,v202
M v[188:191],v[228:231],a[220:223],v[188:191]
s_waitcnt vmcnt(16) lgkmcnt(6)
buffer_load_dwordx4 v[228:231],v251,s[20:23],s48 offen offset:0 sc1
M a[0:3],a[224:227],a[192:195],a[0:3]
s_waitcnt lgkmcnt(5)
ds_read_b128 a[220:223],v250 offset:1792
v_cvt_pk_bf16_f32 v194,v233,v194
M a[4:7],a[224:227],a[196:199],a[4:7]
s_waitcnt lgkmcnt(5)
v_cvt_pk_bf16_f32 v198,v234,v196
v_cvt_pk_bf16_f32 v196,v238,v235
M a[8:11],a[224:227],a[200:203],a[8:11]
s_waitcnt lgkmcnt(4)
v_cvt_pk_bf16_f32 v200,v236,v200
v_lshlrev_b32 v234,16,v197
M a[12:15],a[224:227],a[204:207],a[12:15]
s_waitcnt lgkmcnt(3)
v_lshlrev_b32 v232,16,v193
v_lshlrev_b32 v233,16,v195
M a[16:19],a[224:227],a[208:211],a[16:19]
s_waitcnt lgkmcnt(2)
v_lshlrev_b32 v237,16,v203
v_lshlrev_b32 v236,16,v201
M a[20:23],a[224:227],a[212:215],a[20:23]
s_waitcnt lgkmcnt(1)
v_lshlrev_b32 v235,16,v199
v_fmac_f32 v232,s43,v234
M a[24:27],a[224:227],a[216:219],a[24:27]
s_waitcnt lgkmcnt(0)
v_fmac_f32 v237,4.0,v233
v_fma_f32 v238,-4.0,v234,v236
M a[28:31],a[224:227],a[220:223],a[28:31]
s_waitcnt vmcnt(16)
buffer_load_dwordx4 a[224:227],v251,s[20:23],s46 offen offset:1024 sc1
M a[32:35],a[228:231],a[192:195],a[32:35]
v_fmac_f32 v232,s45,v236
v_fmac_f32 v237,s40,v235
M a[36:39],a[228:231],a[196:199],a[36:39]
v_sub_f32 v236,v236,v234
v_fma_f32 v234,-4.0,v233,v235
M a[40:43],a[228:231],a[200:203],a[40:43]
v_sub_f32 v235,v235,v233
v_add_f32 v233,v238,v234
M a[44:47],a[228:231],a[204:207],a[44:47]
v_sub_f32 v238,v238,v234
v_fma_f32 v234,2.0,v235,v236
M a[48:51],a[228:231],a[208:211],a[48:51]
v_fmac_f32 v236,-2.0,v235
v_and_b32 v197,s42,v197
M a[52:55],a[228:231],a[212:215],a[52:55]
v_and_b32 v193,s42,v193
v_and_b32 v195,s42,v195
M a[56:59],a[228:231],a[216:219],a[56:59]
v_and_b32 v203,s42,v203
v_and_b32 v201,s42,v201
M a[60:63],a[228:231],a[220:223],a[60:63]
s_waitcnt vmcnt(16)
buffer_load_dwordx4 a[228:231],v251,s[20:23],s47 offen offset:1024 sc1
M a[64:67],a[232:235],a[192:195],a[64:67]
ds_read_b128 a[192:195],v250 offset:2048
v_and_b32 v199,s42,v199
M a[68:71],a[232:235],a[196:199],a[68:71]
v_fmac_f32 v193,s43,v197
v_fmac_f32 v203,4.0,v195
M a[72:75],a[232:235],a[200:203],a[72:75]
v_fma_f32 v235,-4.0,v197,v201
v_fmac_f32 v193,s45,v201
M a[76:79],a[232:235],a[204:207],a[76:79]
v_fmac_f32 v203,s40,v199
v_sub_f32 v201,v201,v197
M a[80:83],a[232:235],a[208:211],a[80:83]
v_fma_f32 v197,-4.0,v195,v199
v_sub_f32 v199,v199,v195
M a[84:87],a[232:235],a[212:215],a[84:87]
v_add_f32 v195,v235,v197
v_sub_f32 v235,v235,v197
M a[88:91],a[232:235],a[216:219],a[88:91]
v_fma_f32 v197,2.0,v199,v201
v_fmac_f32 v201,-2.0,v199
M a[92:95],a[232:235],a[220:223],a[92:95]
s_waitcnt vmcnt(16)
buffer_load_dwordx4 a[232:235],v251,s[20:23],s48 offen offset:1024 sc1
M a[0:3],a[236:239],a[196:199],a[0:3]
v_cvt_pk_bf16_f32 v193,v232,v193
v_cvt_pk_bf16_f32 v203,v237,v203
M a[4:7],a[236:239],a[200:203],a[4:7]
v_cvt_pk_bf16_f32 v195,v233,v195
v_cvt_pk_bf16_f32 v199,v234,v197
M a[8:11],a[236:239],a[204:207],a[8:11]
v_cvt_pk_bf16_f32 v197,v238,v235
v_cvt_pk_bf16_f32 v201,v236,v201
M a[12:15],a[236:239],a[208:211],a[12:15]
ds_write2st64_b64 v247,v[192:193],v[202:203] offset0:136 offset1:153
M a[16:19],a[236:239],a[212:215],a[16:19]
s_add_u32 s28,s69,7077888
buffer_load_dwordx2 v[192:193],v245,s[12:15],s28 offen offset:0
M a[20:23],a[236:239],a[216:219],a[20:23]
buffer_load_dwordx2 v[202:203],v245,s[16:19],s28 offen offset:1536
M a[24:27],a[236:239],a[220:223],a[24:27]
s_waitcnt lgkmcnt(1)
ds_write2st64_b64 v247,v[194:195],v[196:197] offset0:0 offset1:17
M a[28:31],a[236:239],a[192:195],a[28:31]
s_waitcnt vmcnt(18)
buffer_load_dwordx2 v[194:195],v245,s[8:11],s28 offen offset:0
M a[32:35],a[240:243],a[196:199],a[32:35]
buffer_load_dwordx2 v[196:197],v245,s[8:11],s28 offen offset:384
M a[36:39],a[240:243],a[200:203],a[36:39]
buffer_load_dwordx4 a[236:239],v251,s[20:23],s46 offen offset:2048 sc1
M a[40:43],a[240:243],a[204:207],a[40:43]
M a[44:47],a[240:243],a[208:211],a[44:47]
M a[48:51],a[240:243],a[212:215],a[48:51]
M a[52:55],a[240:243],a[216:219],a[52:55]
M a[56:59],a[240:243],a[220:223],a[56:59]
M a[60:63],a[240:243],a[192:195],a[60:63]
s_waitcnt vmcnt(20)
buffer_load_dwordx4 a[240:243],v251,s[20:23],s47 offen offset:2048 sc1
M a[64:67],a[244:247],a[196:199],a[64:67]
ds_read_b128 a[196:199],v249 offset:2304
M a[68:71],a[244:247],a[200:203],a[68:71]
M a[72:75],a[244:247],a[204:207],a[72:75]
M a[76:79],a[244:247],a[208:211],a[76:79]
M a[80:83],a[244:247],a[212:215],a[80:83]
M a[84:87],a[244:247],a[216:219],a[84:87]
M a[88:91],a[244:247],a[220:223],a[88:91]
M a[92:95],a[244:247],a[192:195],a[92:95]
s_waitcnt vmcnt(20)
buffer_load_dwordx4 a[244:247],v251,s[20:23],s48 offen offset:2048 sc1
M a[0:3],a[248:251],a[200:203],a[0:3]
M a[4:7],a[248:251],a[204:207],a[4:7]
s_add_u32 s46,s80,27648
M a[8:11],a[248:251],a[208:211],a[8:11]
M a[12:15],a[248:251],a[212:215],a[12:15]
M a[16:19],a[248:251],a[216:219],a[16:19]
M a[20:23],a[248:251],a[220:223],a[20:23]
M a[24:27],a[248:251],a[192:195],a[24:27]
s_waitcnt lgkmcnt(0)
M a[28:31],a[248:251],a[196:199],a[28:31]
s_waitcnt vmcnt(16)
buffer_load_dwordx4 a[248:251],v251,s[20:23],s46 offen offset:0 sc1
M a[32:35],a[252:255],a[200:203],a[32:35]
M a[36:39],a[252:255],a[204:207],a[36:39]
s_add_u32 s47,s80,30720
M a[40:43],a[252:255],a[208:211],a[40:43]
M a[44:47],a[252:255],a[212:215],a[44:47]
M a[48:51],a[252:255],a[216:219],a[48:51]
M a[52:55],a[252:255],a[220:223],a[52:55]
M a[56:59],a[252:255],a[192:195],a[56:59]
M a[60:63],a[252:255],a[196:199],a[60:63]
s_waitcnt vmcnt(14)
buffer_load_dwordx4 a[252:255],v251,s[20:23],s47 offen offset:0 sc1
M a[64:67],v[216:219],a[200:203],a[64:67]
ds_read_b128 a[200:203],v249 offset:8704
M a[68:71],v[216:219],a[204:207],a[68:71]
s_add_u32 s48,s80,33792
ds_read_b128 a[204:207],v250 offset:8960
M a[72:75],v[216:219],a[208:211],a[72:75]
ds_read_b128 a[208:211],v250 offset:9216
M a[76:79],v[216:219],a[212:215],a[76:79]
ds_read_b128 a[212:215],v250 offset:9472
M a[80:83],v[216:219],a[216:219],a[80:83]
ds_read_b128 a[216:219],v250 offset:9728
M a[84:87],v[216:219],a[220:223],a[84:87]
ds_read_b128 a[220:223],v250 offset:9984
M a[88:91],v[216:219],a[192:195],a[88:91]
ds_read_b128 a[192:195],v250 offset:10240
M a[92:95],v[216:219],a[196:199],a[92:95]
s_waitcnt vmcnt(14) lgkmcnt(6)
buffer_load_dwordx4 v[216:219],v251,s[20:23],s48 offen offset:0 sc1
M a[96:99],v[220:223],a[200:203],a[96:99]
s_waitcnt lgkmcnt(5)
ds_read_b128 a[196:199],v250 offset:10496
M a[100:103],v[220:223],a[204:207],a[100:103]
s_waitcnt lgkmcnt(5)
M a[104:107],v[220:223],a[208:211],a[104:107]
s_waitcnt lgkmcnt(4)
M a[108:111],v[220:223],a[212:215],a[108:111]
s_waitcnt lgkmcnt(3)
M a[112:115],v[220:223],a[216:219],a[112:115]
s_waitcnt lgkmcnt(2)
M a[116:119],v[220:223],a[220:223],a[116:119]
s_waitcnt lgkmcnt(1)
M a[120:123],v[220:223],a[192:195],a[120:123]
s_waitcnt lgkmcnt(0)
M a[124:127],v[220:223],a[196:199],a[124:127]
s_waitcnt vmcnt(14)
buffer_load_dwordx4 v[220:223],v251,s[20:23],s46 offen offset:1024 sc1
M a[128:131],v[224:227],a[200:203],a[128:131]
M a[132:135],v[224:227],a[204:207],a[132:135]
M a[136:139],v[224:227],a[208:211],a[136:139]
M a[140:143],v[224:227],a[212:215],a[140:143]
M a[144:147],v[224:227],a[216:219],a[144:147]
M a[148:151],v[224:227],a[220:223],a[148:151]
M a[152:155],v[224:227],a[192:195],a[152:155]
M a[156:159],v[224:227],a[196:199],a[156:159]
s_waitcnt vmcnt(14)
buffer_load_dwordx4 v[224:227],v251,s[20:23],s47 offen offset:1024 sc1
M a[160:163],v[228:231],a[200:203],a[160:163]
ds_read_b128 a[200:203],v250 offset:10752
M a[164:167],v[228:231],a[204:207],a[164:167]
M a[168:171],v[228:231],a[208:211],a[168:171]
M a[172:175],v[228:231],a[212:215],a[172:175]
M a[176:179],v[228:231],a[216:219],a[176:179]
M a[180:183],v[228:231],a[220:223],a[180:183]
M a[184:187],v[228:231],a[192:195],a[184:187]
M a[188:191],v[228:231],a[196:199],a[188:191]
s_waitcnt vmcnt(14)
buffer_load_dwordx4 v[228:231],v251,s[20:23],s48 offen offset:1024 sc1
M a[96:99],a[224:227],a[204:207],a[96:99]
M a[100:103],a[224:227],a[208:211],a[100:103]
M a[104:107],a[224:227],a[212:215],a[104:107]
M a[108:111],a[224:227],a[216:219],a[108:111]
M a[112:115],a[224:227],a[220:223],a[112:115]
M a[116:119],a[224:227],a[192:195],a[116:119]
M a[120:123],a[224:227],a[196:199],a[120:123]
s_waitcnt lgkmcnt(0)
M a[124:127],a[224:227],a[200:203],a[124:127]
s_waitcnt vmcnt(14)
buffer_load_dwordx4 a[224:227],v251,s[20:23],s46 offen offset:2048 sc1
M a[128:131],a[228:231],a[204:207],a[128:131]
M a[132:135],a[228:231],a[208:211],a[132:135]
M a[136:139],a[228:231],a[212:215],a[136:139]
M a[140:143],a[228:231],a[216:219],a[140:143]
M a[144:147],a[228:231],a[220:223],a[144:147]
M a[148:151],a[228:231],a[192:195],a[148:151]
M a[152:155],a[228:231],a[196:199],a[152:155]
M a[156:159],a[228:231],a[200:203],a[156:159]
s_waitcnt vmcnt(14)
buffer_load_dwordx4 a[228:231],v251,s[20:23],s47 offen offset:2048 sc1
M a[160:163],a[232:235],a[204:207],a[160:163]
ds_read_b128 a[204:207],v249 offset:11008
M a[164:167],a[232:235],a[208:211],a[164:167]
M a[168:171],a[232:235],a[212:215],a[168:171]
M a[172:175],a[232:235],a[216:219],a[172:175]
M a[176:179],a[232:235],a[220:223],a[176:179]
M a[180:183],a[232:235],a[192:195],a[180:183]
M a[184:187],a[232:235],a[196:199],a[184:187]
M a[188:191],a[232:235],a[200:203],a[188:191]
s_waitcnt vmcnt(10)
buffer_load_dwordx4 a[232:235],v251,s[20:23],s48 offen offset:2048 sc1
M a[96:99],a[236:239],a[208:211],a[96:99]
M a[100:103],a[236:239],a[212:215],a[100:103]
s_add_u32 s46,s80,36864
M a[104:107],a[236:239],a[216:219],a[104:107]
M a[108:111],a[236:239],a[220:223],a[108:111]
M a[112:115],a[236:239],a[192:195],a[112:115]
M a[116:119],a[236:239],a[196:199],a[116:119]
M a[120:123],a[236:239],a[200:203],a[120:123]
s_waitcnt lgkmcnt(0)
M a[124:127],a[236:239],a[204:207],a[124:127]
s_waitcnt vmcnt(10)
buffer_load_dwordx4 a[236:239],v251,s[20:23],s46 offen offset:0 sc1
M a[128:131],a[240:243],a[208:211],a[128:131]
M a[132:135],a[240:243],a[212:215],a[132:135]
s_barrier
ds_write2st64_b64 v247,v[198:199],v[200:201] offset0:34 offset1:51
M a[136:139],a[240:243],a[216:219],a[136:139]
s_add_u32 s47,s80,39936
buffer_load_dwordx2 v[198:199],v245,s[8:11],s28 offen offset:768
M a[140:143],a[240:243],a[220:223],a[140:143]
buffer_load_dwordx2 v[200:201],v245,s[8:11],s28 offen offset:1152
M a[144:147],a[240:243],a[192:195],a[144:147]
v_lshlrev_b32 v234,16,v208
v_lshlrev_b32 v232,16,v204
M a[148:151],a[240:243],a[196:199],a[148:151]
v_lshlrev_b32 v233,16,v206
v_lshlrev_b32 v237,16,v214
M a[152:155],a[240:243],a[200:203],a[152:155]
v_lshlrev_b32 v236,16,v212
v_lshlrev_b32 v235,16,v210
M a[156:159],a[240:243],a[204:207],a[156:159]
s_waitcnt vmcnt(12)
buffer_load_dwordx4 a[240:243],v251,s[20:23],s47 offen offset:0 sc1
M a[160:163],a[244:247],a[208:211],a[160:163]
ds_read_b128 a[208:211],v249 offset:17408
v_fmac_f32 v232,s43,v234
M a[164:167],a[244:247],a[212:215],a[164:167]
s_add_u32 s48,s80,43008
ds_read_b128 a[212:215],v250 offset:17664
v_fmac_f32 v237,4.0,v233
M a[168:171],a[244:247],a[216:219],a[168:171]
ds_read_b128 a[216:219],v250 offset:17920
v_fma_f32 v238,-4.0,v234,v236
M a[172:175],a[244:247],a[220:223],a[172:175]
ds_read_b128 a[220:223],v250 offset:18176
v_fmac_f32 v232,s45,v236
M a[176:179],a[244:247],a[192:195],a[176:179]
ds_read_b128 a[192:195],v250 offset:18432
v_fmac_f32 v237,s40,v235
M a[180:183],a[244:247],a[196:199],a[180:183]
ds_read_b128 a[196:199],v250 offset:18688
v_sub_f32 v236,v236,v234
M a[184:187],a[244:247],a[200:203],a[184:187]
ds_read_b128 a[200:203],v250 offset:18944
v_fma_f32 v234,-4.0,v233,v235
M a[188:191],a[244:247],a[204:207],a[188:191]
s_waitcnt vmcnt(12) lgkmcnt(6)
buffer_load_dwordx4 a[244:247],v251,s[20:23],s48 offen offset:0 sc1
M v[0:3],a[248:251],a[208:211],v[0:3]
s_waitcnt lgkmcnt(5)
ds_read_b128 a[204:207],v250 offset:19200
v_sub_f32 v235,v235,v233
M v[4:7],a[248:251],a[212:215],v[4:7]
s_waitcnt lgkmcnt(5)
v_add_f32 v233,v238,v234
v_sub_f32 v238,v238,v234
M v[8:11],a[248:251],a[216:219],v[8:11]
s_waitcnt lgkmcnt(4)
v_fma_f32 v234,2.0,v235,v236
v_fmac_f32 v236,-2.0,v235
M v[12:15],a[248:251],a[220:223],v[12:15]
s_waitcnt lgkmcnt(3)
v_and_b32 v208,s42,v208
v_and_b32 v204,s42,v204
M v[16:19],a[248:251],a[192:195],v[16:19]
s_waitcnt lgkmcnt(2)
v_and_b32 v206,s42,v206
v_and_b32 v214,s42,v214
M v[20:23],a[248:251],a[196:199],v[20:23]
s_waitcnt lgkmcnt(1)
v_and_b32 v212,s42,v212
v_and_b32 v210,s42,v210
M v[24:27],a[248:251],a[200:203],v[24:27]
s_waitcnt lgkmcnt(0)
v_fmac_f32 v204,s43,v208
v_fmac_f32 v214,4.0,v206
M v[28:31],a[248:251],a[204:207],v[28:31]
s_waitcnt vmcnt(12)
buffer_load_dwordx4 a[248:251],v251,s[20:23],s46 offen offset:1024 sc1
M v[32:35],a[252:255],a[208:211],v[32:35]
v_fma_f32 v235,-4.0,v208,v212
v_fmac_f32 v204,s45,v212
M v[36:39],a[252:255],a[212:215],v[36:39]
v_fmac_f32 v214,s40,v210
v_sub_f32 v212,v212,v208
M v[40:43],a[252:255],a[216:219],v[40:43]
v_fma_f32 v208,-4.0,v206,v210
v_sub_f32 v210,v210,v206
M v[44:47],a[252:255],a[220:223],v[44:47]
v_add_f32 v206,v235,v208
v_sub_f32 v235,v235,v208
M v[48:51],a[252:255],a[192:195],v[48:51]
v_fma_f32 v208,2.0,v210,v212
v_fmac_f32 v212,-2.0,v210
M v[52:55],a[252:255],a[196:199],v[52:55]
v_cvt_pk_bf16_f32 v204,v232,v204
v_cvt_pk_bf16_f32 v214,v237,v214
M v[56:59],a[252:255],a[200:203],v[56:59]
v_cvt_pk_bf16_f32 v206,v233,v206
v_cvt_pk_bf16_f32 v210,v234,v208
M v[60:63],a[252:255],a[204:207],v[60:63]
s_waitcnt vmcnt(12)
buffer_load_dwordx4 a[252:255],v251,s[20:23],s47 offen offset:1024 sc1
M v[64:67],v[216:219],a[208:211],v[64:67]
ds_read_b128 a[208:211],v250 offset:19456
v_cvt_pk_bf16_f32 v208,v238,v235
M v[68:71],v[216:219],a[212:215],v[68:71]
v_cvt_pk_bf16_f32 v212,v236,v212
v_lshlrev_b32 v234,16,v209
M v[72:75],v[216:219],a[216:219],v[72:75]
v_lshlrev_b32 v232,16,v205
v_lshlrev_b32 v233,16,v207
M v[76:79],v[216:219],a[220:223],v[76:79]
v_lshlrev_b32 v237,16,v215
v_lshlrev_b32 v236,16,v213
M v[80:83],v[216:219],a[192:195],v[80:83]
v_lshlrev_b32 v235,16,v211
v_fmac_f32 v232,s43,v234
M v[84:87],v[216:219],a[196:199],v[84:87]
v_fmac_f32 v237,4.0,v233
v_fma_f32 v238,-4.0,v234,v236
M v[88:91],v[216:219],a[200:203],v[88:91]
v_fmac_f32 v232,s45,v236
v_fmac_f32 v237,s40,v235
M v[92:95],v[216:219],a[204:207],v[92:95]
s_waitcnt vmcnt(12)
buffer_load_dwordx4 v[216:219],v251,s[20:23],s48 offen offset:1024 sc1
M v[0:3],v[220:223],a[212:215],v[0:3]
v_sub_f32 v236,v236,v234
v_fma_f32 v234,-4.0,v233,v235
M v[4:7],v[220:223],a[216:219],v[4:7]
v_sub_f32 v235,v235,v233
v_add_f32 v233,v238,v234
M v[8:11],v[220:223],a[220:223],v[8:11]
v_sub_f32 v238,v238,v234
v_fma_f32 v234,2.0,v235,v236
M v[12:15],v[220:223],a[192:195],v[12:15]
v_fmac_f32 v236,-2.0,v235
v_and_b32 v209,s42,v209
M v[16:19],v[220:223],a[196:199],v[16:19]
v_and_b32 v205,s42,v205
v_and_b32 v207,s42,v207
M v[20:23],v[220:223],a[200:203],v[20:23]
v_and_b32 v215,s42,v215
v_and_b32 v213,s42,v213
M v[24:27],v[220:223],a[204:207],v[24:27]
s_waitcnt lgkmcnt(0)
v_and_b32 v211,s42,v211
v_fmac_f32 v205,s43,v209
M v[28:31],v[220:223],a[208:211],v[28:31]
s_waitcnt vmcnt(12)
buffer_load_dwordx4 v[220:223],v251,s[20:23],s46 offen offset:2048 sc1
M v[32:35],v[224:227],a[212:215],v[32:35]
v_fmac_f32 v215,4.0,v207
v_fma_f32 v235,-4.0,v209,v213
M v[36:39],v[224:227],a[216:219],v[36:39]
v_fmac_f32 v205,s45,v213
v_fmac_f32 v215,s40,v211
M v[40:43],v[224:227],a[220:223],v[40:43]
v_sub_f32 v213,v213,v209
v_fma_f32 v209,-4.0,v207,v211
M v[44:47],v[224:227],a[192:195],v[44:47]
v_sub_f32 v211,v211,v207
v_add_f32 v207,v235,v209
M v[48:51],v[224:227],a[196:199],v[48:51]
v_sub_f32 v235,v235,v209
v_fma_f32 v209,2.0,v211,v213
M v[52:55],v[224:227],a[200:203],v[52:55]
v_fmac_f32 v213,-2.0,v211
v_cvt_pk_bf16_f32 v205,v232,v205
M v[56:59],v[224:227],a[204:207],v[56:59]
v_cvt_pk_bf16_f32 v215,v237,v215
v_cvt_pk_bf16_f32 v207,v233,v207
M v[60:63],v[224:227],a[208:211],v[60:63]
s_waitcnt vmcnt(12)
buffer_load_dwordx4 v[224:227],v251,s[20:23],s47 offen offset:2048 sc1
M v[64:67],v[228:231],a[212:215],v[64:67]
ds_read_b128 a[212:215],v249 offset:19712
v_cvt_pk_bf16_f32 v211,v234,v209
M v[68:71],v[228:231],a[216:219],v[68:71]
v_cvt_pk_bf16_f32 v209,v238,v235
v_cvt_pk_bf16_f32 v213,v236,v213
M v[72:75],v[228:231],a[220:223],v[72:75]
ds_write2st64_b64 v247,v[204:205],v[214:215] offset0:137 offset1:154
M v[76:79],v[228:231],a[192:195],v[76:79]
s_add_u32 s28,s69,7471104
buffer_load_dwordx2 v[204:205],v245,s[12:15],s28 offen offset:0
M v[80:83],v[228:231],a[196:199],v[80:83]
buffer_load_dwordx2 v[214:215],v245,s[16:19],s28 offen offset:1536
M v[84:87],v[228:231],a[200:203],v[84:87]
ds_write2st64_b64 v247,v[206:207],v[208:209] offset0:1 offset1:18
M v[88:91],v[228:231],a[204:207],v[88:91]
buffer_load_dwordx2 v[206:207],v245,s[8:11],s28 offen offset:0
M v[92:95],v[228:231],a[208:211],v[92:95]
s_waitcnt vmcnt(15)
buffer_load_dwordx2 v[208:209],v245,s[8:11],s28 offen offset:384
M v[0:3],a[224:227],a[216:219],v[0:3]
buffer_load_dwordx4 v[228:231],v251,s[20:23],s48 offen offset:2048 sc1
M v[4:7],a[224:227],a[220:223],v[4:7]
s_add_u32 s46,s81,9216
ds_write2st64_b64 v247,v[210:211],v[212:213] offset0:35 offset1:52
M v[8:11],a[224:227],a[192:195],v[8:11]
buffer_load_dwordx2 v[210:211],v245,s[8:11],s28 offen offset:768
M v[12:15],a[224:227],a[196:199],v[12:15]
buffer_load_dwordx2 v[212:213],v245,s[8:11],s28 offen offset:1152
M v[16:19],a[224:227],a[200:203],v[16:19]
v_fmac_f32 v239,s43,v241
v_fmac_f32 v244,4.0,v240
M v[20:23],a[224:227],a[204:207],v[20:23]
v_fma_f32 v232,-4.0,v241,v243
v_fmac_f32 v239,s45,v243
M v[24:27],a[224:227],a[208:211],v[24:27]
s_waitcnt lgkmcnt(3)
v_fmac_f32 v244,s40,v242
v_sub_f32 v243,v243,v241
M v[28:31],a[224:227],a[212:215],v[28:31]
s_waitcnt vmcnt(18)
buffer_load_dwordx4 a[224:227],v251,s[20:23],s46 offen offset:0 sc1
M v[32:35],a[228:231],a[216:219],v[32:35]
v_fma_f32 v241,-4.0,v240,v242
v_sub_f32 v242,v242,v240
M v[36:39],a[228:231],a[220:223],v[36:39]
v_add_f32 v240,v232,v241
v_sub_f32 v232,v232,v241
M v[40:43],a[228:231],a[192:195],v[40:43]
v_fma_f32 v241,2.0,v242,v243
v_fmac_f32 v243,-2.0,v242
M v[44:47],a[228:231],a[196:199],v[44:47]
v_cvt_pk_bf16_f32 v233,v239,v244
v_cvt_pk_bf16_f32 v234,v240,v232
M v[48:51],a[228:231],a[200:203],v[48:51]
v_cvt_pk_bf16_f32 v235,v241,v243
v_add_u32 v232,69632,v248
M v[52:55],a[228:231],a[204:207],v[52:55]
ds_write_b16 v232,v233 offset:0
M v[56:59],a[228:231],a[208:211],v[56:59]
ds_write_b16_d16_hi v232,v233 offset:8704
M v[60:63],a[228:231],a[212:215],v[60:63]
s_waitcnt vmcnt(18)
buffer_load_dwordx4 a[228:231],v251,s[20:23],s46 offen offset:1024 sc1
M v[64:67],a[232:235],a[216:219],v[64:67]
ds_read_b128 a[216:219],v249 offset:26112
ds_write_b16 v248,v234 offset:0
M v[68:71],a[232:235],a[220:223],v[68:71]
ds_read_b128 a[220:223],v250 offset:26368
ds_write_b16_d16_hi v248,v234 offset:8704
M v[72:75],a[232:235],a[192:195],v[72:75]
ds_read_b128 a[192:195],v250 offset:26624
ds_write_b16 v248,v235 offset:17408
M v[76:79],a[232:235],a[196:199],v[76:79]
ds_read_b128 a[196:199],v250 offset:26880
ds_write_b16_d16_hi v248,v235 offset:26112
M v[80:83],a[232:235],a[200:203],v[80:83]
ds_read_b128 a[200:203],v250 offset:27136
v_lshlrev_b32 v234,16,v196
M v[84:87],a[232:235],a[204:207],v[84:87]
ds_read_b128 a[204:207],v250 offset:27392
v_lshlrev_b32 v232,16,v192
M v[88:91],a[232:235],a[208:211],v[88:91]
ds_read_b128 a[208:211],v250 offset:27648
v_lshlrev_b32 v233,16,v194
M v[92:95],a[232:235],a[212:215],v[92:95]
s_waitcnt vmcnt(18) lgkmcnt(10)
buffer_load_dwordx4 a[232:235],v251,s[20:23],s46 offen offset:2048 sc1
M v[96:99],a[236:239],a[216:219],v[96:99]
s_waitcnt lgkmcnt(8)
ds_read_b128 a[212:215],v250 offset:27904
v_lshlrev_b32 v237,16,v202
M v[100:103],a[236:239],a[220:223],v[100:103]
s_waitcnt vmcnt(17) lgkmcnt(7)
s_add_u32 s46,s81,18432
v_lshlrev_b32 v236,16,v200
v_lshlrev_b32 v235,16,v198
M v[104:107],a[236:239],a[192:195],v[104:107]
s_waitcnt lgkmcnt(5)
v_fmac_f32 v232,s43,v234
v_fmac_f32 v237,4.0,v233
M v[108:111],a[236:239],a[196:199],v[108:111]
s_waitcnt lgkmcnt(3)
v_fma_f32 v238,-4.0,v234,v236
v_fmac_f32 v232,s45,v236
M v[112:115],a[236:239],a[200:203],v[112:115]
s_waitcnt lgkmcnt(2)
v_fmac_f32 v237,s40,v235
v_sub_f32 v236,v236,v234
M v[116:119],a[236:239],a[204:207],v[116:119]
s_waitcnt lgkmcnt(1)
v_fma_f32 v234,-4.0,v233,v235
v_sub_f32 v235,v235,v233
M v[120:123],a[236:239],a[208:211],v[120:123]
s_waitcnt lgkmcnt(0)
v_add_f32 v233,v238,v234
v_sub_f32 v238,v238,v234
M v[124:127],a[236:239],a[212:215],v[124:127]
s_waitcnt vmcnt(16)
buffer_load_dwordx4 a[236:239],v251,s[20:23],s46 offen offset:0 sc1
M v[128:131],a[240:243],a[216:219],v[128:131]
v_fma_f32 v234,2.0,v235,v236
v_fmac_f32 v236,-2.0,v235
M v[132:135],a[240:243],a[220:223],v[132:135]
v_and_b32 v196,s42,v196
v_and_b32 v192,s42,v192
M v[136:139],a[240:243],a[192:195],v[136:139]
v_and_b32 v194,s42,v194
v_and_b32 v202,s42,v202
M v[140:143],a[240:243],a[196:199],v[140:143]
v_and_b32 v200,s42,v200
v_and_b32 v198,s42,v198
M v[144:147],a[240:243],a[200:203],v[144:147]
v_fmac_f32 v192,s43,v196
v_fmac_f32 v202,4.0,v194
M v[148:151],a[240:243],a[204:207],v[148:151]
v_fma_f32 v235,-4.0,v196,v200
v_fmac_f32 v192,s45,v200
M v[152:155],a[240:243],a[208:211],v[152:155]
v_fmac_f32 v202,s40,v198
v_sub_f32 v200,v200,v196
M v[156:159],a[240:243],a[212:215],v[156:159]
s_waitcnt vmcnt(16)
buffer_load_dwordx4 a[240:243],v251,s[20:23],s46 offen offset:1024 sc1
M v[160:163],a[244:247],a[216:219],v[160:163]
ds_read_b128 a[216:219],v250 offset:28160
v_fma_f32 v196,-4.0,v194,v198
v_sub_f32 v198,v198,v194
M v[164:167],a[244:247],a[220:223],v[164:167]
v_add_f32 v194,v235,v196
v_sub_f32 v235,v235,v196
v_fma_f32 v196,2.0,v198,v200
v_fmac_f32 v200,-2.0,v198
M v[168:171],a[244:247],a[192:195],v[168:171]
v_cvt_pk_bf16_f32 v192,v232,v192
v_cvt_pk_bf16_f32 v202,v237,v202
v_cvt_pk_bf16_f32 v194,v233,v194
v_cvt_pk_bf16_f32 v198,v234,v196
M v[172:175],a[244:247],a[196:199],v[172:175]
v_cvt_pk_bf16_f32 v196,v238,v235
v_cvt_pk_bf16_f32 v200,v236,v200
v_lshlrev_b32 v234,16,v197
v_lshlrev_b32 v232,16,v193
M v[176:179],a[244:247],a[200:203],v[176:179]
v_lshlrev_b32 v233,16,v195
v_lshlrev_b32 v237,16,v203
v_lshlrev_b32 v236,16,v201
v_lshlrev_b32 v235,16,v199
M v[180:183],a[244:247],a[204:207],v[180:183]
v_fmac_f32 v232,s43,v234
v_fmac_f32 v237,4.0,v233
v_fma_f32 v238,-4.0,v234,v236
v_fmac_f32 v232,s45,v236
M v[184:187],a[244:247],a[208:211],v[184:187]
v_fmac_f32 v237,s40,v235
v_sub_f32 v236,v236,v234
v_fma_f32 v234,-4.0,v233,v235
v_sub_f32 v235,v235,v233
M v[188:191],a[244:247],a[212:215],v[188:191]
s_waitcnt vmcnt(16)
buffer_load_dwordx4 a[244:247],v251,s[20:23],s46 offen offset:2048 sc1
v_add_f32 v233,v238,v234
v_sub_f32 v238,v238,v234
v_fma_f32 v234,2.0,v235,v236
v_fmac_f32 v236,-2.0,v235
M v[96:99],a[248:251],a[220:223],v[96:99]
v_and_b32 v197,s42,v197
v_and_b32 v193,s42,v193
v_and_b32 v195,s42,v195
v_and_b32 v203,s42,v203
M v[100:103],a[248:251],a[192:195],v[100:103]
s_add_u32 s46,s81,27648
v_and_b32 v201,s42,v201
v_and_b32 v199,s42,v199
v_fmac_f32 v193,s43,v197
v_fmac_f32 v203,4.0,v195
M v[104:107],a[248:251],a[196:199],v[104:107]
v_fma_f32 v235,-4.0,v197,v201
v_fmac_f32 v193,s45,v201
v_fmac_f32 v203,s40,v199
v_sub_f32 v201,v201,v197
M v[108:111],a[248:251],a[200:203],v[108:111]
v_fma_f32 v197,-4.0,v195,v199
v_sub_f32 v199,v199,v195
v_add_f32 v195,v235,v197
v_sub_f32 v235,v235,v197
M v[112:115],a[248:251],a[204:207],v[112:115]
v_fma_f32 v197,2.0,v199,v201
v_fmac_f32 v201,-2.0,v199
v_cvt_pk_bf16_f32 v193,v232,v193
v_cvt_pk_bf16_f32 v203,v237,v203
M v[116:119],a[248:251],a[208:211],v[116:119]
v_cvt_pk_bf16_f32 v195,v233,v195
v_cvt_pk_bf16_f32 v199,v234,v197
v_cvt_pk_bf16_f32 v197,v238,v235
v_cvt_pk_bf16_f32 v201,v236,v201
M v[120:123],a[248:251],a[212:215],v[120:123]
s_waitcnt lgkmcnt(0)
ds_write2st64_b64 v247,v[192:193],v[202:203] offset0:138 offset1:155
M v[124:127],a[248:251],a[216:219],v[124:127]
s_waitcnt vmcnt(16)
buffer_load_dwordx4 a[248:251],v251,s[20:23],s46 offen offset:0 sc1
ds_write2st64_b64 v247,v[194:195],v[196:197] offset0:2 offset1:19
M v[128:131],a[252:255],a[220:223],v[128:131]
ds_write2st64_b64 v247,v[198:199],v[200:201] offset0:36 offset1:53
M v[132:135],a[252:255],a[192:195],v[132:135]
s_waitcnt vmcnt(10)
v_lshlrev_b32 v234,16,v208
v_lshlrev_b32 v232,16,v204
M v[136:139],a[252:255],a[196:199],v[136:139]
v_lshlrev_b32 v233,16,v206
v_lshlrev_b32 v237,16,v214
M v[140:143],a[252:255],a[200:203],v[140:143]
s_waitcnt vmcnt(7)
v_lshlrev_b32 v236,16,v212
v_lshlrev_b32 v235,16,v210
M v[144:147],a[252:255],a[204:207],v[144:147]
v_fmac_f32 v232,s43,v234
v_fmac_f32 v237,4.0,v233
v_fma_f32 v238,-4.0,v234,v236
M v[148:151],a[252:255],a[208:211],v[148:151]
v_fmac_f32 v232,s45,v236
v_fmac_f32 v237,s40,v235
v_sub_f32 v236,v236,v234
v_fma_f32 v234,-4.0,v233,v235
M v[152:155],a[252:255],a[212:215],v[152:155]
v_sub_f32 v235,v235,v233
v_add_f32 v233,v238,v234
v_sub_f32 v238,v238,v234
v_fma_f32 v234,2.0,v235,v236
M v[156:159],a[252:255],a[216:219],v[156:159]
buffer_load_dwordx4 a[252:255],v251,s[20:23],s46 offen offset:1024 sc1
v_fmac_f32 v236,-2.0,v235
v_and_b32 v208,s42,v208
v_and_b32 v204,s42,v204
v_and_b32 v206,s42,v206
M v[160:163],v[216:219],a[220:223],v[160:163]
ds_read_b128 a[220:223],v249 offset:28416
v_and_b32 v214,s42,v214
v_and_b32 v212,s42,v212
v_and_b32 v210,s42,v210
v_fmac_f32 v204,s43,v208
M v[164:167],v[216:219],a[192:195],v[164:167]
v_fmac_f32 v214,4.0,v206
v_fma_f32 v235,-4.0,v208,v212
v_fmac_f32 v204,s45,v212
v_fmac_f32 v214,s40,v210
M v[168:171],v[216:219],a[196:199],v[168:171]
v_sub_f32 v212,v212,v208
v_fma_f32 v208,-4.0,v206,v210
v_sub_f32 v210,v210,v206
v_add_f32 v206,v235,v208
M v[172:175],v[216:219],a[200:203],v[172:175]
v_sub_f32 v235,v235,v208
v_fma_f32 v208,2.0,v210,v212
v_fmac_f32 v212,-2.0,v210
v_cvt_pk_bf16_f32 v204,v232,v204
M v[176:179],v[216:219],a[204:207],v[176:179]
v_cvt_pk_bf16_f32 v214,v237,v214
v_cvt_pk_bf16_f32 v206,v233,v206
v_cvt_pk_bf16_f32 v210,v234,v208
v_cvt_pk_bf16_f32 v208,v238,v235
M v[180:183],v[216:219],a[208:211],v[180:183]
v_cvt_pk_bf16_f32 v212,v236,v212
v_lshlrev_b32 v234,16,v209
v_lshlrev_b32 v232,16,v205
v_lshlrev_b32 v233,16,v207
M v[184:187],v[216:219],a[212:215],v[184:187]
v_lshlrev_b32 v237,16,v215
v_lshlrev_b32 v236,16,v213
v_lshlrev_b32 v235,16,v211
v_fmac_f32 v232,s43,v234
M v[188:191],v[216:219],a[216:219],v[188:191]
buffer_load_dwordx4 v[216:219],v251,s[20:23],s46 offen offset:2048 sc1
v_fmac_f32 v237,4.0,v233
v_fma_f32 v238,-4.0,v234,v236
v_fmac_f32 v232,s45,v236
v_fmac_f32 v237,s40,v235
M v[96:99],v[220:223],a[192:195],v[96:99]
v_sub_f32 v236,v236,v234
v_fma_f32 v234,-4.0,v233,v235
v_sub_f32 v235,v235,v233
v_add_f32 v233,v238,v234
M v[100:103],v[220:223],a[196:199],v[100:103]
s_add_u32 s46,s81,36864
v_sub_f32 v238,v238,v234
v_fma_f32 v234,2.0,v235,v236
v_fmac_f32 v236,-2.0,v235
v_and_b32 v209,s42,v209
M v[104:107],v[220:223],a[200:203],v[104:107]
v_and_b32 v205,s42,v205
v_and_b32 v207,s42,v207
v_and_b32 v215,s42,v215
v_and_b32 v213,s42,v213
M v[108:111],v[220:223],a[204:207],v[108:111]
v_and_b32 v211,s42,v211
v_fmac_f32 v205,s43,v209
v_fmac_f32 v215,4.0,v207
v_fma_f32 v235,-4.0,v209,v213
M v[112:115],v[220:223],a[208:211],v[112:115]
v_fmac_f32 v205,s45,v213
v_fmac_f32 v215,s40,v211
v_sub_f32 v213,v213,v209
v_fma_f32 v209,-4.0,v207,v211
M v[116:119],v[220:223],a[212:215],v[116:119]
v_sub_f32 v211,v211,v207
v_add_f32 v207,v235,v209
v_sub_f32 v235,v235,v209
v_fma_f32 v209,2.0,v211,v213
M v[120:123],v[220:223],a[216:219],v[120:123]
s_waitcnt lgkmcnt(0)
v_fmac_f32 v213,-2.0,v211
v_cvt_pk_bf16_f32 v205,v232,v205
v_cvt_pk_bf16_f32 v215,v237,v215
v_cvt_pk_bf16_f32 v207,v233,v207
M v[124:127],v[220:223],a[220:223],v[124:127]
buffer_load_dwordx4 v[220:223],v251,s[20:23],s46 offen offset:0 sc1
v_cvt_pk_bf16_f32 v211,v234,v209
v_cvt_pk_bf16_f32 v209,v238,v235
v_cvt_pk_bf16_f32 v213,v236,v213
M v[128:131],v[224:227],a[192:195],v[128:131]
ds_write2st64_b64 v247,v[204:205],v[214:215] offset0:139 offset1:156
M v[132:135],v[224:227],a[196:199],v[132:135]
ds_write2st64_b64 v247,v[206:207],v[208:209] offset0:3 offset1:20
M v[136:139],v[224:227],a[200:203],v[136:139]
ds_write2st64_b64 v247,v[210:211],v[212:213] offset0:37 offset1:54
M v[140:143],v[224:227],a[204:207],v[140:143]
M v[144:147],v[224:227],a[208:211],v[144:147]
M v[148:151],v[224:227],a[212:215],v[148:151]
v_add_u32 v249,0xffffbc00,v249
v_add_u32 v250,0xffffbc00,v250
M v[152:155],v[224:227],a[216:219],v[152:155]
s_waitcnt lgkmcnt(0)
s_barrier
M v[156:159],v[224:227],a[220:223],v[156:159]
buffer_load_dwordx4 v[224:227],v251,s[20:23],s46 offen offset:1024 sc1
M v[160:163],v[228:231],a[192:195],v[160:163]
ds_read_b128 a[192:195],v249 offset:0
M v[164:167],v[228:231],a[196:199],v[164:167]
ds_read_b128 a[196:199],v250 offset:256
M v[168:171],v[228:231],a[200:203],v[168:171]
ds_read_b128 a[200:203],v250 offset:512
M v[172:175],v[228:231],a[204:207],v[172:175]
ds_read_b128 a[204:207],v250 offset:768
M v[176:179],v[228:231],a[208:211],v[176:179]
ds_read_b128 a[208:211],v250 offset:1024
M v[180:183],v[228:231],a[212:215],v[180:183]
ds_read_b128 a[212:215],v250 offset:1280
M v[184:187],v[228:231],a[216:219],v[184:187]
ds_read_b128 a[216:219],v250 offset:1536
M v[188:191],v[228:231],a[220:223],v[188:191]
s_waitcnt vmcnt(10) lgkmcnt(6)
buffer_load_dwordx4 v[228:231],v251,s[20:23],s46 offen offset:2048 sc1
M a[0:3],a[224:227],a[192:195],a[0:3]
s_waitcnt lgkmcnt(5)
ds_read_b128 a[220:223],v250 offset:1792
ds_read_b128 a[192:195],v250 offset:2048
M a[4:7],a[224:227],a[196:199],a[4:7]
s_waitcnt lgkmcnt(6)
s_add_u32 s47,s81,12288
M a[8:11],a[224:227],a[200:203],a[8:11]
s_waitcnt lgkmcnt(5)
M a[12:15],a[224:227],a[204:207],a[12:15]
s_waitcnt lgkmcnt(4)
M a[16:19],a[224:227],a[208:211],a[16:19]
s_waitcnt lgkmcnt(3)
M a[20:23],a[224:227],a[212:215],a[20:23]
s_waitcnt lgkmcnt(2)
M a[24:27],a[224:227],a[216:219],a[24:27]
s_waitcnt lgkmcnt(1)
M a[28:31],a[224:227],a[220:223],a[28:31]
s_waitcnt vmcnt(10)
buffer_load_dwordx4 a[224:227],v251,s[20:23],s47 offen offset:0 sc1
M a[0:3],a[228:231],a[196:199],a[0:3]
ds_read_b128 a[196:199],v249 offset:2304
M a[4:7],a[228:231],a[200:203],a[4:7]
s_add_u32 s48,s81,15360
M a[8:11],a[228:231],a[204:207],a[8:11]
M a[12:15],a[228:231],a[208:211],a[12:15]
M a[16:19],a[228:231],a[212:215],a[16:19]
M a[20:23],a[228:231],a[216:219],a[20:23]
M a[24:27],a[228:231],a[220:223],a[24:27]
s_waitcnt lgkmcnt(1)
M a[28:31],a[228:231],a[192:195],a[28:31]
s_waitcnt vmcnt(10)
buffer_load_dwordx4 a[228:231],v251,s[20:23],s48 offen offset:0 sc1
M a[0:3],a[232:235],a[200:203],a[0:3]
ds_read_b128 a[200:203],v249 offset:8704
M a[4:7],a[232:235],a[204:207],a[4:7]
ds_read_b128 a[204:207],v250 offset:8960
M a[8:11],a[232:235],a[208:211],a[8:11]
ds_read_b128 a[208:211],v250 offset:9216
M a[12:15],a[232:235],a[212:215],a[12:15]
ds_read_b128 a[212:215],v250 offset:9472
M a[16:19],a[232:235],a[216:219],a[16:19]
ds_read_b128 a[216:219],v250 offset:9728
M a[20:23],a[232:235],a[220:223],a[20:23]
ds_read_b128 a[220:223],v250 offset:9984
M a[24:27],a[232:235],a[192:195],a[24:27]
s_waitcnt lgkmcnt(6)
ds_read_b128 a[192:195],v250 offset:10240
M a[28:31],a[232:235],a[196:199],a[28:31]
s_waitcnt vmcnt(10) lgkmcnt(6)
buffer_load_dwordx4 a[232:235],v251,s[20:23],s47 offen offset:1024 sc1
M a[96:99],a[236:239],a[200:203],a[96:99]
s_waitcnt lgkmcnt(5)
ds_read_b128 a[196:199],v250 offset:10496
ds_read_b128 a[200:203],v250 offset:10752
M a[100:103],a[236:239],a[204:207],a[100:103]
s_waitcnt lgkmcnt(6)
M a[104:107],a[236:239],a[208:211],a[104:107]
s_waitcnt lgkmcnt(5)
M a[108:111],a[236:239],a[212:215],a[108:111]
s_waitcnt lgkmcnt(4)
M a[112:115],a[236:239],a[216:219],a[112:115]
s_waitcnt lgkmcnt(3)
M a[116:119],a[236:239],a[220:223],a[116:119]
s_waitcnt lgkmcnt(2)
M a[120:123],a[236:239],a[192:195],a[120:123]
s_waitcnt lgkmcnt(1)
M a[124:127],a[236:239],a[196:199],a[124:127]
s_waitcnt vmcnt(10)
buffer_load_dwordx4 a[236:239],v251,s[20:23],s48 offen offset:1024 sc1
M a[96:99],a[240:243],a[204:207],a[96:99]
ds_read_b128 a[204:207],v249 offset:11008
M a[100:103],a[240:243],a[208:211],a[100:103]
M a[104:107],a[240:243],a[212:215],a[104:107]
M a[108:111],a[240:243],a[216:219],a[108:111]
M a[112:115],a[240:243],a[220:223],a[112:115]
M a[116:119],a[240:243],a[192:195],a[116:119]
M a[120:123],a[240:243],a[196:199],a[120:123]
s_waitcnt lgkmcnt(1)
M a[124:127],a[240:243],a[200:203],a[124:127]
s_waitcnt vmcnt(10)
buffer_load_dwordx4 a[240:243],v251,s[20:23],s47 offen offset:2048 sc1
M a[96:99],a[244:247],a[208:211],a[96:99]
ds_read_b128 a[208:211],v249 offset:17408
M a[100:103],a[244:247],a[212:215],a[100:103]
ds_read_b128 a[212:215],v250 offset:17664
M a[104:107],a[244:247],a[216:219],a[104:107]
ds_read_b128 a[216:219],v250 offset:17920
M a[108:111],a[244:247],a[220:223],a[108:111]
ds_read_b128 a[220:223],v250 offset:18176
M a[112:115],a[244:247],a[192:195],a[112:115]
ds_read_b128 a[192:195],v250 offset:18432
M a[116:119],a[244:247],a[196:199],a[116:119]
ds_read_b128 a[196:199],v250 offset:18688
M a[120:123],a[244:247],a[200:203],a[120:123]
s_waitcnt lgkmcnt(6)
ds_read_b128 a[200:203],v250 offset:18944
M a[124:127],a[244:247],a[204:207],a[124:127]
s_waitcnt vmcnt(10) lgkmcnt(6)
buffer_load_dwordx4 a[244:247],v251,s[20:23],s48 offen offset:2048 sc1
M v[0:3],a[248:251],a[208:211],v[0:3]
s_waitcnt lgkmcnt(5)
ds_read_b128 a[204:207],v250 offset:19200
ds_read_b128 a[208:211],v250 offset:19456
M v[4:7],a[248:251],a[212:215],v[4:7]
s_waitcnt lgkmcnt(6)
s_add_u32 s47,s81,21504
M v[8:11],a[248:251],a[216:219],v[8:11]
s_waitcnt lgkmcnt(5)
M v[12:15],a[248:251],a[220:223],v[12:15]
s_waitcnt lgkmcnt(4)
M v[16:19],a[248:251],a[192:195],v[16:19]
s_waitcnt lgkmcnt(3)
M v[20:23],a[248:251],a[196:199],v[20:23]
s_waitcnt lgkmcnt(2)
M v[24:27],a[248:251],a[200:203],v[24:27]
s_waitcnt lgkmcnt(1)
M v[28:31],a[248:251],a[204:207],v[28:31]
s_waitcnt vmcnt(10)
buffer_load_dwordx4 a[248:251],v251,s[20:23],s47 offen offset:0 sc1
M v[0:3],a[252:255],a[212:215],v[0:3]
ds_read_b128 a[212:215],v249 offset:19712
M v[4:7],a[252:255],a[216:219],v[4:7]
s_add_u32 s48,s81,24576
M v[8:11],a[252:255],a[220:223],v[8:11]
M v[12:15],a[252:255],a[192:195],v[12:15]
M v[16:19],a[252:255],a[196:199],v[16:19]
M v[20:23],a[252:255],a[200:203],v[20:23]
M v[24:27],a[252:255],a[204:207],v[24:27]
s_waitcnt lgkmcnt(1)
M v[28:31],a[252:255],a[208:211],v[28:31]
s_waitcnt vmcnt(10)
buffer_load_dwordx4 a[252:255],v251,s[20:23],s48 offen offset:0 sc1
M v[0:3],v[216:219],a[216:219],v[0:3]
ds_read_b128 a[216:219],v249 offset:26112
M v[4:7],v[216:219],a[220:223],v[4:7]
ds_read_b128 a[220:223],v250 offset:26368
M v[8:11],v[216:219],a[192:195],v[8:11]
ds_read_b128 a[192:195],v250 offset:26624
M v[12:15],v[216:219],a[196:199],v[12:15]
ds_read_b128 a[196:199],v250 offset:26880
M v[16:19],v[216:219],a[200:203],v[16:19]
ds_read_b128 a[200:203],v250 offset:27136
M v[20:23],v[216:219],a[204:207],v[20:23]
ds_read_b128 a[204:207],v250 offset:27392
M v[24:27],v[216:219],a[208:211],v[24:27]
s_waitcnt lgkmcnt(6)
ds_read_b128 a[208:211],v250 offset:27648
M v[28:31],v[216:219],a[212:215],v[28:31]
s_waitcnt vmcnt(10) lgkmcnt(6)
buffer_load_dwordx4 v[216:219],v251,s[20:23],s47 offen offset:1024 sc1
M v[96:99],v[220:223],a[216:219],v[96:99]
s_waitcnt lgkmcnt(5)
ds_read_b128 a[212:215],v250 offset:27904
ds_read_b128 a[216:219],v250 offset:28160
M v[100:103],v[220:223],a[220:223],v[100:103]
s_waitcnt lgkmcnt(6)
M v[104:107],v[220:223],a[192:195],v[104:107]
s_waitcnt lgkmcnt(5)
M v[108:111],v[220:223],a[196:199],v[108:111]
s_waitcnt lgkmcnt(4)
M v[112:115],v[220:223],a[200:203],v[112:115]
s_waitcnt lgkmcnt(3)
M v[116:119],v[220:223],a[204:207],v[116:119]
s_waitcnt lgkmcnt(2)
M v[120:123],v[220:223],a[208:211],v[120:123]
s_waitcnt lgkmcnt(1)
M v[124:127],v[220:223],a[212:215],v[124:127]
s_waitcnt vmcnt(10)
buffer_load_dwordx4 v[220:223],v251,s[20:23],s48 offen offset:1024 sc1
M v[96:99],v[224:227],a[220:223],v[96:99]
ds_read_b128 a[220:223],v249 offset:28416
M v[100:103],v[224:227],a[192:195],v[100:103]
M v[104:107],v[224:227],a[196:199],v[104:107]
M v[108:111],v[224:227],a[200:203],v[108:111]
M v[112:115],v[224:227],a[204:207],v[112:115]
M v[116:119],v[224:227],a[208:211],v[116:119]
M v[120:123],v[224:227],a[212:215],v[120:123]
s_waitcnt lgkmcnt(1)
M v[124:127],v[224:227],a[216:219],v[124:127]
s_waitcnt vmcnt(10)
buffer_load_dwordx4 v[224:227],v251,s[20:23],s47 offen offset:2048 sc1
M v[96:99],v[228:231],a[192:195],v[96:99]
ds_read_b128 a[192:195],v249 offset:0
M v[100:103],v[228:231],a[196:199],v[100:103]
ds_read_b128 a[196:199],v250 offset:256
M v[104:107],v[228:231],a[200:203],v[104:107]
ds_read_b128 a[200:203],v250 offset:512
M v[108:111],v[228:231],a[204:207],v[108:111]
ds_read_b128 a[204:207],v250 offset:768
v_accvgpr_read_b32 v238,a0
M v[112:115],v[228:231],a[208:211],v[112:115]
ds_read_b128 a[208:211],v250 offset:1024
v_accvgpr_read_b32 v232,a96
M v[116:119],v[228:231],a[212:215],v[116:119]
ds_read_b128 a[212:215],v250 offset:1280
v_add_f32 v234,v238,v232
M v[120:123],v[228:231],a[216:219],v[120:123]
s_waitcnt lgkmcnt(6)
ds_read_b128 a[216:219],v250 offset:1536
v_sub_f32 v238,v238,v232
M v[124:127],v[228:231],a[220:223],v[124:127]
s_waitcnt vmcnt(10) lgkmcnt(6)
buffer_load_dwordx4 v[228:231],v251,s[20:23],s48 offen offset:2048 sc1
M a[32:35],a[224:227],a[192:195],a[32:35]
s_waitcnt lgkmcnt(5)
ds_read_b128 a[220:223],v250 offset:1792
v_add_f32 v232,v0,v96
M a[36:39],a[224:227],a[196:199],a[36:39]
s_waitcnt lgkmcnt(5)
s_add_u32 s47,s81,30720
v_sub_f32 v96,v0,v96
v_add_f32 v0,v234,v232
M a[40:43],a[224:227],a[200:203],a[40:43]
s_waitcnt lgkmcnt(4)
v_fmac_f32 v234,4.0,v232
v_fma_f32 v232,2.0,v96,v238
M a[44:47],a[224:227],a[204:207],a[44:47]
s_waitcnt lgkmcnt(3)
v_fma_f32 v96,s41,v96,v238
v_accvgpr_read_b32 v238,a1
M a[48:51],a[224:227],a[208:211],a[48:51]
s_waitcnt lgkmcnt(2)
v_accvgpr_read_b32 v237,a97
v_add_f32 v236,v238,v237
M a[52:55],a[224:227],a[212:215],a[52:55]
s_waitcnt lgkmcnt(1)
v_sub_f32 v238,v238,v237
v_add_f32 v237,v1,v97
M a[56:59],a[224:227],a[216:219],a[56:59]
s_waitcnt lgkmcnt(0)
v_sub_f32 v97,v1,v97
v_add_f32 v1,v236,v237
M a[60:63],a[224:227],a[220:223],a[60:63]
s_waitcnt vmcnt(10)
buffer_load_dwordx4 a[224:227],v251,s[20:23],s47 offen offset:0 sc1
M a[64:67],a[228:231],a[192:195],a[64:67]
ds_read_b128 a[192:195],v250 offset:2048
v_fmac_f32 v236,4.0,v237
M a[68:71],a[228:231],a[196:199],a[68:71]
s_add_u32 s48,s81,33792
v_fma_f32 v237,2.0,v97,v238
v_fma_f32 v97,s41,v97,v238
M a[72:75],a[228:231],a[200:203],a[72:75]
v_cvt_pk_bf16_f32 v232,v232,v237
v_cvt_pk_bf16_f32 v234,v234,v236
M a[76:79],a[228:231],a[204:207],a[76:79]
v_accvgpr_read_b32 v238,a2
v_accvgpr_read_b32 v233,a98
M a[80:83],a[228:231],a[208:211],a[80:83]
v_add_f32 v235,v238,v233
v_sub_f32 v238,v238,v233
M a[84:87],a[228:231],a[212:215],a[84:87]
v_add_f32 v233,v2,v98
v_sub_f32 v98,v2,v98
M a[88:91],a[228:231],a[216:219],a[88:91]
v_add_f32 v2,v235,v233
v_fmac_f32 v235,4.0,v233
M a[92:95],a[228:231],a[220:223],a[92:95]
s_waitcnt vmcnt(10)
buffer_load_dwordx4 a[228:231],v251,s[20:23],s48 offen offset:0 sc1
M a[32:35],a[232:235],a[196:199],a[32:35]
v_fma_f32 v233,2.0,v98,v238
v_fma_f32 v98,s41,v98,v238
M a[36:39],a[232:235],a[200:203],a[36:39]
v_accvgpr_read_b32 v238,a3
v_accvgpr_read_b32 v237,a99
M a[40:43],a[232:235],a[204:207],a[40:43]
v_add_f32 v236,v238,v237
v_sub_f32 v238,v238,v237
M a[44:47],a[232:235],a[208:211],a[44:47]
v_add_f32 v237,v3,v99
v_sub_f32 v99,v3,v99
M a[48:51],a[232:235],a[212:215],a[48:51]
v_add_f32 v3,v236,v237
v_fmac_f32 v236,4.0,v237
M a[52:55],a[232:235],a[216:219],a[52:55]
v_fma_f32 v237,2.0,v99,v238
v_fma_f32 v99,s41,v99,v238
M a[56:59],a[232:235],a[220:223],a[56:59]
s_waitcnt lgkmcnt(0)
v_cvt_pk_bf16_f32 v233,v233,v237
v_cvt_pk_bf16_f32 v235,v235,v236
M a[60:63],a[232:235],a[192:195],a[60:63]
s_waitcnt vmcnt(10)
buffer_load_dwordx4 a[232:235],v251,s[20:23],s47 offen offset:1024 sc1
M a[64:67],a[236:239],a[196:199],a[64:67]
ds_read_b128 a[196:199],v249 offset:2304
ds_write2st64_b64 v253,v[232:233],v[234:235] offset0:68 offset1:72
M a[68:71],a[236:239],a[200:203],a[68:71]
v_accvgpr_read_b32 v238,a4
v_accvgpr_read_b32 v232,a100
M a[72:75],a[236:239],a[204:207],a[72:75]
v_add_f32 v234,v238,v232
v_sub_f32 v238,v238,v232
M a[76:79],a[236:239],a[208:211],a[76:79]
v_add_f32 v232,v4,v100
v_sub_f32 v100,v4,v100
M a[80:83],a[236:239],a[212:215],a[80:83]
v_add_f32 v4,v234,v232
v_fmac_f32 v234,4.0,v232
M a[84:87],a[236:239],a[216:219],a[84:87]
v_fma_f32 v232,2.0,v100,v238
v_fma_f32 v100,s41,v100,v238
M a[88:91],a[236:239],a[220:223],a[88:91]
v_accvgpr_read_b32 v238,a5
v_accvgpr_read_b32 v237,a101
M a[92:95],a[236:239],a[192:195],a[92:95]
s_waitcnt vmcnt(10)
buffer_load_dwordx4 a[236:239],v251,s[20:23],s48 offen offset:1024 sc1
M a[32:35],a[240:243],a[200:203],a[32:35]
v_add_f32 v236,v238,v237
v_sub_f32 v238,v238,v237
M a[36:39],a[240:243],a[204:207],a[36:39]
v_add_f32 v237,v5,v101
v_sub_f32 v101,v5,v101
M a[40:43],a[240:243],a[208:211],a[40:43]
v_add_f32 v5,v236,v237
v_fmac_f32 v236,4.0,v237
M a[44:47],a[240:243],a[212:215],a[44:47]
v_fma_f32 v237,2.0,v101,v238
v_fma_f32 v101,s41,v101,v238
M a[48:51],a[240:243],a[216:219],a[48:51]
v_cvt_pk_bf16_f32 v232,v232,v237
v_cvt_pk_bf16_f32 v234,v234,v236
M a[52:55],a[240:243],a[220:223],a[52:55]
v_accvgpr_read_b32 v238,a6
v_accvgpr_read_b32 v233,a102
M a[56:59],a[240:243],a[192:195],a[56:59]
s_waitcnt lgkmcnt(1)
v_add_f32 v235,v238,v233
v_sub_f32 v238,v238,v233
M a[60:63],a[240:243],a[196:199],a[60:63]
s_waitcnt vmcnt(10)
buffer_load_dwordx4 a[240:243],v251,s[20:23],s47 offen offset:2048 sc1
M a[64:67],a[244:247],a[200:203],a[64:67]
ds_read_b128 a[200:203],v249 offset:8704
v_add_f32 v233,v6,v102
M a[68:71],a[244:247],a[204:207],a[68:71]
ds_read_b128 a[204:207],v250 offset:8960
v_sub_f32 v102,v6,v102
M a[72:75],a[244:247],a[208:211],a[72:75]
ds_read_b128 a[208:211],v250 offset:9216
v_add_f32 v6,v235,v233
M a[76:79],a[244:247],a[212:215],a[76:79]
ds_read_b128 a[212:215],v250 offset:9472
v_fmac_f32 v235,4.0,v233
M a[80:83],a[244:247],a[216:219],a[80:83]
ds_read_b128 a[216:219],v250 offset:9728
v_fma_f32 v233,2.0,v102,v238
M a[84:87],a[244:247],a[220:223],a[84:87]
ds_read_b128 a[220:223],v250 offset:9984
v_fma_f32 v102,s41,v102,v238
M a[88:91],a[244:247],a[192:195],a[88:91]
ds_read_b128 a[192:195],v250 offset:10240
v_accvgpr_read_b32 v238,a7
M a[92:95],a[244:247],a[196:199],a[92:95]
s_waitcnt vmcnt(10) lgkmcnt(6)
buffer_load_dwordx4 a[244:247],v251,s[20:23],s48 offen offset:2048 sc1
M a[128:131],a[248:251],a[200:203],a[128:131]
s_waitcnt lgkmcnt(5)
ds_read_b128 a[196:199],v250 offset:10496
v_accvgpr_read_b32 v237,a103
M a[132:135],a[248:251],a[204:207],a[132:135]
s_waitcnt lgkmcnt(5)
s_add_u32 s47,s81,39936
v_add_f32 v236,v238,v237
v_sub_f32 v238,v238,v237
M a[136:139],a[248:251],a[208:211],a[136:139]
s_waitcnt lgkmcnt(4)
v_add_f32 v237,v7,v103
v_sub_f32 v103,v7,v103
M a[140:143],a[248:251],a[212:215],a[140:143]
s_waitcnt lgkmcnt(3)
v_add_f32 v7,v236,v237
v_fmac_f32 v236,4.0,v237
M a[144:147],a[248:251],a[216:219],a[144:147]
s_waitcnt lgkmcnt(2)
v_fma_f32 v237,2.0,v103,v238
v_fma_f32 v103,s41,v103,v238
M a[148:151],a[248:251],a[220:223],a[148:151]
s_waitcnt lgkmcnt(1)
v_cvt_pk_bf16_f32 v233,v233,v237
v_cvt_pk_bf16_f32 v235,v235,v236
M a[152:155],a[248:251],a[192:195],a[152:155]
s_waitcnt lgkmcnt(0)
ds_write2st64_b64 v253,v[232:233],v[234:235] offset0:76 offset1:80
M a[156:159],a[248:251],a[196:199],a[156:159]
s_waitcnt vmcnt(10)
buffer_load_dwordx4 a[248:251],v251,s[20:23],s47 offen offset:0 sc1
M a[160:163],a[252:255],a[200:203],a[160:163]
ds_read_b128 a[200:203],v250 offset:10752
v_accvgpr_read_b32 v238,a8
M a[164:167],a[252:255],a[204:207],a[164:167]
s_add_u32 s48,s81,43008
v_accvgpr_read_b32 v232,a104
v_add_f32 v234,v238,v232
M a[168:171],a[252:255],a[208:211],a[168:171]
v_sub_f32 v238,v238,v232
v_add_f32 v232,v8,v104
M a[172:175],a[252:255],a[212:215],a[172:175]
v_sub_f32 v104,v8,v104
M a[176:179],a[252:255],a[216:219],a[176:179]
s_waitcnt lgkmcnt(1)
s_barrier
ds_read_b128 a[0:3],v251 offset:34816
M a[180:183],a[252:255],a[220:223],a[180:183]
ds_read_b128 a[4:7],v251 offset:38912
v_add_f32 v8,v234,v232
M a[184:187],a[252:255],a[192:195],a[184:187]
v_fmac_f32 v234,4.0,v232
v_fma_f32 v232,2.0,v104,v238
M a[188:191],a[252:255],a[196:199],a[188:191]
s_waitcnt vmcnt(10)
buffer_load_dwordx4 a[252:255],v251,s[20:23],s48 offen offset:0 sc1
M a[128:131],v[216:219],a[204:207],a[128:131]
v_fma_f32 v104,s41,v104,v238
v_accvgpr_read_b32 v238,a9
M a[132:135],v[216:219],a[208:211],a[132:135]
s_waitcnt lgkmcnt(1)
s_add_u32 s34,s32,6291456
buffer_store_dwordx4 a[0:3],v252,s[24:27],s34 offen offset:384 nt
M a[136:139],v[216:219],a[212:215],a[136:139]
v_accvgpr_read_b32 v237,a105
v_add_f32 v236,v238,v237
M a[140:143],v[216:219],a[216:219],a[140:143]
v_sub_f32 v238,v238,v237
v_add_f32 v237,v9,v105
M a[144:147],v[216:219],a[220:223],a[144:147]
v_sub_f32 v105,v9,v105
v_add_f32 v9,v236,v237
M a[148:151],v[216:219],a[192:195],a[148:151]
v_fmac_f32 v236,4.0,v237
v_fma_f32 v237,2.0,v105,v238
M a[152:155],v[216:219],a[196:199],a[152:155]
v_fma_f32 v105,s41,v105,v238
v_cvt_pk_bf16_f32 v232,v232,v237
M a[156:159],v[216:219],a[200:203],a[156:159]
s_waitcnt vmcnt(11)
buffer_load_dwordx4 v[216:219],v251,s[20:23],s47 offen offset:1024 sc1
M a[160:163],v[220:223],a[204:207],a[160:163]
ds_read_b128 a[204:207],v249 offset:11008
v_cvt_pk_bf16_f32 v234,v234,v236
M a[164:167],v[220:223],a[208:211],a[164:167]
v_accvgpr_read_b32 v238,a10
v_accvgpr_read_b32 v233,a106
M a[168:171],v[220:223],a[212:215],a[168:171]
v_add_f32 v235,v238,v233
v_sub_f32 v238,v238,v233
M a[172:175],v[220:223],a[216:219],a[172:175]
v_add_f32 v233,v10,v106
v_sub_f32 v106,v10,v106
M a[176:179],v[220:223],a[220:223],a[176:179]
s_waitcnt lgkmcnt(1)
s_add_u32 s34,s32,6488064
buffer_store_dwordx4 a[4:7],v252,s[24:27],s34 offen offset:384 nt
M a[180:183],v[220:223],a[192:195],a[180:183]
v_add_f32 v10,v235,v233
v_fmac_f32 v235,4.0,v233
M a[184:187],v[220:223],a[196:199],a[184:187]
v_fma_f32 v233,2.0,v106,v238
v_fma_f32 v106,s41,v106,v238
M a[188:191],v[220:223],a[200:203],a[188:191]
s_waitcnt vmcnt(12)
buffer_load_dwordx4 v[220:223],v251,s[20:23],s48 offen offset:1024 sc1
M a[128:131],v[224:227],a[208:211],a[128:131]
v_accvgpr_read_b32 v238,a11
v_accvgpr_read_b32 v237,a107
M a[132:135],v[224:227],a[212:215],a[132:135]
v_add_f32 v236,v238,v237
v_sub_f32 v238,v238,v237
M a[136:139],v[224:227],a[216:219],a[136:139]
v_add_f32 v237,v11,v107
v_sub_f32 v107,v11,v107
M a[140:143],v[224:227],a[220:223],a[140:143]
v_add_f32 v11,v236,v237
v_fmac_f32 v236,4.0,v237
M a[144:147],v[224:227],a[192:195],a[144:147]
v_fma_f32 v237,2.0,v107,v238
v_fma_f32 v107,s41,v107,v238
M a[148:151],v[224:227],a[196:199],a[148:151]
v_cvt_pk_bf16_f32 v233,v233,v237
v_cvt_pk_bf16_f32 v235,v235,v236
M a[152:155],v[224:227],a[200:203],a[152:155]
s_waitcnt lgkmcnt(0)
ds_write2st64_b64 v253,v[232:233],v[234:235] offset0:85 offset1:89
M a[156:159],v[224:227],a[204:207],a[156:159]
s_waitcnt vmcnt(12)
buffer_load_dwordx4 v[224:227],v251,s[20:23],s47 offen offset:2048 sc1
M a[160:163],v[228:231],a[208:211],a[160:163]
ds_read_b128 a[208:211],v249 offset:17408
v_accvgpr_read_b32 v238,a12
M a[164:167],v[228:231],a[212:215],a[164:167]
ds_read_b128 a[212:215],v250 offset:17664
v_accvgpr_read_b32 v232,a108
M a[168:171],v[228:231],a[216:219],a[168:171]
ds_read_b128 a[216:219],v250 offset:17920
v_add_f32 v234,v238,v232
M a[172:175],v[228:231],a[220:223],a[172:175]
ds_read_b128 a[220:223],v250 offset:18176
v_sub_f32 v238,v238,v232
M a[176:179],v[228:231],a[192:195],a[176:179]
ds_read_b128 a[192:195],v250 offset:18432
v_add_f32 v232,v12,v108
M a[180:183],v[228:231],a[196:199],a[180:183]
ds_read_b128 a[196:199],v250 offset:18688
v_sub_f32 v108,v12,v108
M a[184:187],v[228:231],a[200:203],a[184:187]
ds_read_b128 a[200:203],v250 offset:18944
v_add_f32 v12,v234,v232
M a[188:191],v[228:231],a[204:207],a[188:191]
s_waitcnt vmcnt(12) lgkmcnt(6)
buffer_load_dwordx4 v[228:231],v251,s[20:23],s48 offen offset:2048 sc1
M v[32:35],a[224:227],a[208:211],v[32:35]
s_waitcnt lgkmcnt(5)
ds_read_b128 a[204:207],v250 offset:19200
v_fmac_f32 v234,4.0,v232
M v[36:39],a[224:227],a[212:215],v[36:39]
s_waitcnt lgkmcnt(5)
s_add_u32 s46,s76,0
v_fma_f32 v232,2.0,v108,v238
v_fma_f32 v108,s41,v108,v238
M v[40:43],a[224:227],a[216:219],v[40:43]
s_waitcnt lgkmcnt(4)
v_accvgpr_read_b32 v238,a13
v_accvgpr_read_b32 v237,a109
M v[44:47],a[224:227],a[220:223],v[44:47]
s_waitcnt lgkmcnt(3)
v_add_f32 v236,v238,v237
v_sub_f32 v238,v238,v237
M v[48:51],a[224:227],a[192:195],v[48:51]
s_waitcnt lgkmcnt(2)
v_add_f32 v237,v13,v109
v_sub_f32 v109,v13,v109
M v[52:55],a[224:227],a[196:199],v[52:55]
s_waitcnt lgkmcnt(1)
v_add_f32 v13,v236,v237
v_fmac_f32 v236,4.0,v237
M v[56:59],a[224:227],a[200:203],v[56:59]
s_waitcnt lgkmcnt(0)
v_fma_f32 v237,2.0,v109,v238
v_fma_f32 v109,s41,v109,v238
M v[60:63],a[224:227],a[204:207],v[60:63]
s_waitcnt vmcnt(12)
buffer_load_dwordx4 a[224:227],v251,s[20:23],s46 offen offset:0 sc1
M v[64:67],a[228:231],a[208:211],v[64:67]
ds_read_b128 a[208:211],v250 offset:19456
v_cvt_pk_bf16_f32 v232,v232,v237
M v[68:71],a[228:231],a[212:215],v[68:71]
v_cvt_pk_bf16_f32 v234,v234,v236
v_accvgpr_read_b32 v238,a14
M v[72:75],a[228:231],a[216:219],v[72:75]
v_accvgpr_read_b32 v233,a110
v_add_f32 v235,v238,v233
M v[76:79],a[228:231],a[220:223],v[76:79]
v_sub_f32 v238,v238,v233
v_add_f32 v233,v14,v110
M v[80:83],a[228:231],a[192:195],v[80:83]
v_sub_f32 v110,v14,v110
v_add_f32 v14,v235,v233
M v[84:87],a[228:231],a[196:199],v[84:87]
v_fmac_f32 v235,4.0,v233
v_fma_f32 v233,2.0,v110,v238
M v[88:91],a[228:231],a[200:203],v[88:91]
v_fma_f32 v110,s41,v110,v238
v_accvgpr_read_b32 v238,a15
M v[92:95],a[228:231],a[204:207],v[92:95]
s_waitcnt vmcnt(12)
buffer_load_dwordx4 a[228:231],v251,s[20:23],s46 offen offset:1024 sc1
M v[32:35],a[232:235],a[212:215],v[32:35]
v_accvgpr_read_b32 v237,a111
v_add_f32 v236,v238,v237
M v[36:39],a[232:235],a[216:219],v[36:39]
v_sub_f32 v238,v238,v237
v_add_f32 v237,v15,v111
M v[40:43],a[232:235],a[220:223],v[40:43]
v_sub_f32 v111,v15,v111
v_add_f32 v15,v236,v237
M v[44:47],a[232:235],a[192:195],v[44:47]
v_fmac_f32 v236,4.0,v237
v_fma_f32 v237,2.0,v111,v238
M v[48:51],a[232:235],a[196:199],v[48:51]
v_fma_f32 v111,s41,v111,v238
v_cvt_pk_bf16_f32 v233,v233,v237
M v[52:55],a[232:235],a[200:203],v[52:55]
v_cvt_pk_bf16_f32 v235,v235,v236
M v[56:59],a[232:235],a[204:207],v[56:59]
s_waitcnt lgkmcnt(0)
ds_write2st64_b64 v253,v[232:233],v[234:235] offset0:93 offset1:97
M v[60:63],a[232:235],a[208:211],v[60:63]
s_waitcnt vmcnt(12)
buffer_load_dwordx4 a[232:235],v251,s[20:23],s46 offen offset:2048 sc1
M v[64:67],a[236:239],a[212:215],v[64:67]
ds_read_b128 a[212:215],v249 offset:19712
v_accvgpr_read_b32 v238,a16
M v[68:71],a[236:239],a[216:219],v[68:71]
s_add_u32 s46,s77,0
v_accvgpr_read_b32 v232,a112
v_add_f32 v234,v238,v232
M v[72:75],a[236:239],a[220:223],v[72:75]
v_sub_f32 v238,v238,v232
v_add_f32 v232,v16,v112
M v[76:79],a[236:239],a[192:195],v[76:79]
v_sub_f32 v112,v16,v112
M v[80:83],a[236:239],a[196:199],v[80:83]
s_waitcnt lgkmcnt(1)
s_barrier
ds_read_b128 a[8:11],v251 offset:43520
M v[84:87],a[236:239],a[200:203],v[84:87]
ds_read_b128 a[12:15],v251 offset:47616
v_add_f32 v16,v234,v232
M v[88:91],a[236:239],a[204:207],v[88:91]
v_fmac_f32 v234,4.0,v232
v_fma_f32 v232,2.0,v112,v238
M v[92:95],a[236:239],a[208:211],v[92:95]
s_waitcnt vmcnt(12)
buffer_load_dwordx4 a[236:239],v251,s[20:23],s46 offen offset:0 sc1
M v[32:35],a[240:243],a[216:219],v[32:35]
v_fma_f32 v112,s41,v112,v238
v_accvgpr_read_b32 v238,a17
M v[36:39],a[240:243],a[220:223],v[36:39]
s_waitcnt lgkmcnt(1)
s_add_u32 s34,s32,6684672
buffer_store_dwordx4 a[8:11],v252,s[24:27],s34 offen offset:384 nt
M v[40:43],a[240:243],a[192:195],v[40:43]
s_waitcnt lgkmcnt(0)
s_add_u32 s34,s32,6881280
buffer_store_dwordx4 a[12:15],v252,s[24:27],s34 offen offset:384 nt
M v[44:47],a[240:243],a[196:199],v[44:47]
v_accvgpr_read_b32 v237,a113
v_add_f32 v236,v238,v237
M v[48:51],a[240:243],a[200:203],v[48:51]
v_sub_f32 v238,v238,v237
v_add_f32 v237,v17,v113
M v[52:55],a[240:243],a[204:207],v[52:55]
v_sub_f32 v113,v17,v113
v_add_f32 v17,v236,v237
M v[56:59],a[240:243],a[208:211],v[56:59]
v_fmac_f32 v236,4.0,v237
v_fma_f32 v237,2.0,v113,v238
M v[60:63],a[240:243],a[212:215],v[60:63]
s_waitcnt vmcnt(14)
buffer_load_dwordx4 a[240:243],v251,s[20:23],s46 offen offset:1024 sc1
M v[64:67],a[244:247],a[216:219],v[64:67]
ds_read_b128 a[216:219],v249 offset:26112
v_fma_f32 v113,s41,v113,v238
M v[68:71],a[244:247],a[220:223],v[68:71]
ds_read_b128 a[220:223],v250 offset:26368
v_cvt_pk_bf16_f32 v232,v232,v237
M v[72:75],a[244:247],a[192:195],v[72:75]
ds_read_b128 a[192:195],v250 offset:26624
v_cvt_pk_bf16_f32 v234,v234,v236
M v[76:79],a[244:247],a[196:199],v[76:79]
ds_read_b128 a[196:199],v250 offset:26880
v_accvgpr_read_b32 v238,a18
M v[80:83],a[244:247],a[200:203],v[80:83]
ds_read_b128 a[200:203],v250 offset:27136
v_accvgpr_read_b32 v233,a114
M v[84:87],a[244:247],a[204:207],v[84:87]
ds_read_b128 a[204:207],v250 offset:27392
v_add_f32 v235,v238,v233
M v[88:91],a[244:247],a[208:211],v[88:91]
ds_read_b128 a[208:211],v250 offset:27648
v_sub_f32 v238,v238,v233
M v[92:95],a[244:247],a[212:215],v[92:95]
s_waitcnt vmcnt(14) lgkmcnt(6)
buffer_load_dwordx4 a[244:247],v251,s[20:23],s46 offen offset:2048 sc1
M v[128:131],a[248:251],a[216:219],v[128:131]
s_waitcnt lgkmcnt(5)
ds_read_b128 a[212:215],v250 offset:27904
v_add_f32 v233,v18,v114
M v[132:135],a[248:251],a[220:223],v[132:135]
s_waitcnt lgkmcnt(5)
s_add_u32 s46,s78,0
v_sub_f32 v114,v18,v114
v_add_f32 v18,v235,v233
M v[136:139],a[248:251],a[192:195],v[136:139]
s_waitcnt lgkmcnt(4)
v_fmac_f32 v235,4.0,v233
v_fma_f32 v233,2.0,v114,v238
M v[140:143],a[248:251],a[196:199],v[140:143]
s_waitcnt lgkmcnt(3)
v_fma_f32 v114,s41,v114,v238
v_accvgpr_read_b32 v238,a19
M v[144:147],a[248:251],a[200:203],v[144:147]
s_waitcnt lgkmcnt(2)
v_accvgpr_read_b32 v237,a115
v_add_f32 v236,v238,v237
M v[148:151],a[248:251],a[204:207],v[148:151]
s_waitcnt lgkmcnt(1)
v_sub_f32 v238,v238,v237
v_add_f32 v237,v19,v115
M v[152:155],a[248:251],a[208:211],v[152:155]
s_waitcnt lgkmcnt(0)
v_sub_f32 v115,v19,v115
v_add_f32 v19,v236,v237
M v[156:159],a[248:251],a[212:215],v[156:159]
s_waitcnt vmcnt(14)
buffer_load_dwordx4 a[248:251],v251,s[20:23],s46 offen offset:0 sc1
M v[160:163],a[252:255],a[216:219],v[160:163]
ds_read_b128 a[216:219],v250 offset:28160
v_fmac_f32 v236,4.0,v237
M v[164:167],a[252:255],a[220:223],v[164:167]
v_fma_f32 v237,2.0,v115,v238
v_fma_f32 v115,s41,v115,v238
M v[168:171],a[252:255],a[192:195],v[168:171]
v_cvt_pk_bf16_f32 v233,v233,v237
v_cvt_pk_bf16_f32 v235,v235,v236
M v[172:175],a[252:255],a[196:199],v[172:175]
ds_write2st64_b64 v253,v[232:233],v[234:235] offset0:68 offset1:72
M v[176:179],a[252:255],a[200:203],v[176:179]
v_accvgpr_read_b32 v238,a20
v_accvgpr_read_b32 v232,a116
M v[180:183],a[252:255],a[204:207],v[180:183]
v_add_f32 v234,v238,v232
v_sub_f32 v238,v238,v232
M v[184:187],a[252:255],a[208:211],v[184:187]
v_add_f32 v232,v20,v116
v_sub_f32 v116,v20,v116
M v[188:191],a[252:255],a[212:215],v[188:191]
s_waitcnt vmcnt(13)
buffer_load_dwordx4 a[252:255],v251,s[20:23],s46 offen offset:1024 sc1
M v[128:131],v[216:219],a[220:223],v[128:131]
v_add_f32 v20,v234,v232
v_fmac_f32 v234,4.0,v232
M v[132:135],v[216:219],a[192:195],v[132:135]
v_fma_f32 v232,2.0,v116,v238
v_fma_f32 v116,s41,v116,v238
M v[136:139],v[216:219],a[196:199],v[136:139]
v_accvgpr_read_b32 v238,a21
v_accvgpr_read_b32 v237,a117
M v[140:143],v[216:219],a[200:203],v[140:143]
v_add_f32 v236,v238,v237
v_sub_f32 v238,v238,v237
M v[144:147],v[216:219],a[204:207],v[144:147]
v_add_f32 v237,v21,v117
v_sub_f32 v117,v21,v117
M v[148:151],v[216:219],a[208:211],v[148:151]
v_add_f32 v21,v236,v237
v_fmac_f32 v236,4.0,v237
M v[152:155],v[216:219],a[212:215],v[152:155]
s_waitcnt lgkmcnt(1)
v_fma_f32 v237,2.0,v117,v238
v_fma_f32 v117,s41,v117,v238
v_cvt_pk_bf16_f32 v232,v232,v237
M v[156:159],v[216:219],a[216:219],v[156:159]
s_waitcnt vmcnt(12)
buffer_load_dwordx4 v[216:219],v251,s[20:23],s46 offen offset:2048 sc1
v_cvt_pk_bf16_f32 v234,v234,v236
v_accvgpr_read_b32 v238,a22
v_accvgpr_read_b32 v233,a118
v_add_f32 v235,v238,v233
M v[160:163],v[220:223],a[220:223],v[160:163]
ds_read_b128 a[220:223],v249 offset:28416
v_sub_f32 v238,v238,v233
v_add_f32 v233,v22,v118
v_sub_f32 v118,v22,v118
v_add_f32 v22,v235,v233
M v[164:167],v[220:223],a[192:195],v[164:167]
s_add_u32 s46,s79,0
v_fmac_f32 v235,4.0,v233
v_fma_f32 v233,2.0,v118,v238
v_fma_f32 v118,s41,v118,v238
v_accvgpr_read_b32 v238,a23
M v[168:171],v[220:223],a[196:199],v[168:171]
v_accvgpr_read_b32 v237,a119
v_add_f32 v236,v238,v237
v_sub_f32 v238,v238,v237
v_add_f32 v237,v23,v119
M v[172:175],v[220:223],a[200:203],v[172:175]
v_sub_f32 v119,v23,v119
v_add_f32 v23,v236,v237
v_fmac_f32 v236,4.0,v237
v_fma_f32 v237,2.0,v119,v238
M v[176:179],v[220:223],a[204:207],v[176:179]
v_fma_f32 v119,s41,v119,v238
v_cvt_pk_bf16_f32 v233,v233,v237
v_cvt_pk_bf16_f32 v235,v235,v236
M v[180:183],v[220:223],a[208:211],v[180:183]
ds_write2st64_b64 v253,v[232:233],v[234:235] offset0:76 offset1:80
M v[184:187],v[220:223],a[212:215],v[184:187]
v_accvgpr_read_b32 v238,a24
v_accvgpr_read_b32 v232,a120
M v[188:191],v[220:223],a[216:219],v[188:191]
s_waitcnt vmcnt(12)
buffer_load_dwordx4 v[220:223],v251,s[20:23],s46 offen offset:0 sc1
v_add_f32 v234,v238,v232
v_sub_f32 v238,v238,v232
v_add_f32 v232,v24,v120
v_sub_f32 v120,v24,v120
M v[128:131],v[224:227],a[192:195],v[128:131]
s_waitcnt lgkmcnt(0)
s_barrier
ds_read_b128 a[16:19],v251 offset:34816
v_add_f32 v24,v234,v232
v_fmac_f32 v234,4.0,v232
v_fma_f32 v232,2.0,v120,v238
M v[132:135],v[224:227],a[196:199],v[132:135]
ds_read_b128 a[20:23],v251 offset:38912
v_fma_f32 v120,s41,v120,v238
v_accvgpr_read_b32 v238,a25
v_accvgpr_read_b32 v237,a121
v_add_f32 v236,v238,v237
M v[136:139],v[224:227],a[200:203],v[136:139]
v_sub_f32 v238,v238,v237
v_add_f32 v237,v25,v121
v_sub_f32 v121,v25,v121
v_add_f32 v25,v236,v237
M v[140:143],v[224:227],a[204:207],v[140:143]
v_fmac_f32 v236,4.0,v237
v_fma_f32 v237,2.0,v121,v238
v_fma_f32 v121,s41,v121,v238
v_cvt_pk_bf16_f32 v232,v232,v237
M v[144:147],v[224:227],a[208:211],v[144:147]
v_cvt_pk_bf16_f32 v234,v234,v236
v_accvgpr_read_b32 v238,a26
v_accvgpr_read_b32 v233,a122
v_add_f32 v235,v238,v233
M v[148:151],v[224:227],a[212:215],v[148:151]
s_waitcnt lgkmcnt(1)
s_add_u32 s34,s32,7077888
buffer_store_dwordx4 a[16:19],v252,s[24:27],s34 offen offset:384 nt
v_sub_f32 v238,v238,v233
v_add_f32 v233,v26,v122
v_sub_f32 v122,v26,v122
v_add_f32 v26,v235,v233
M v[152:155],v[224:227],a[216:219],v[152:155]
s_waitcnt lgkmcnt(0)
s_add_u32 s34,s32,7274496
buffer_store_dwordx4 a[20:23],v252,s[24:27],s34 offen offset:384 nt
v_fmac_f32 v235,4.0,v233
v_fma_f32 v233,2.0,v122,v238
v_fma_f32 v122,s41,v122,v238
v_accvgpr_read_b32 v238,a27
M v[156:159],v[224:227],a[220:223],v[156:159]
s_waitcnt vmcnt(14)
buffer_load_dwordx4 v[224:227],v251,s[20:23],s46 offen offset:1024 sc1
v_accvgpr_read_b32 v237,a123
v_add_f32 v236,v238,v237
v_sub_f32 v238,v238,v237
v_add_f32 v237,v27,v123
M v[160:163],v[228:231],a[192:195],v[160:163]
ds_read_b128 a[192:195],v249 offset:52224
v_sub_f32 v123,v27,v123
v_add_f32 v27,v236,v237
v_fmac_f32 v236,4.0,v237
v_fma_f32 v237,2.0,v123,v238
M v[164:167],v[228:231],a[196:199],v[164:167]
ds_read_b128 a[196:199],v250 offset:52480
v_fma_f32 v123,s41,v123,v238
v_cvt_pk_bf16_f32 v233,v233,v237
v_cvt_pk_bf16_f32 v235,v235,v236
M v[168:171],v[228:231],a[200:203],v[168:171]
s_waitcnt lgkmcnt(0)
s_barrier
ds_write2st64_b64 v253,v[232:233],v[234:235] offset0:85 offset1:89
M v[172:175],v[228:231],a[204:207],v[172:175]
ds_read_b128 a[200:203],v250 offset:52736
ds_read_b128 a[204:207],v250 offset:52992
v_accvgpr_read_b32 v238,a28
v_accvgpr_read_b32 v232,a124
M v[176:179],v[228:231],a[208:211],v[176:179]
ds_read_b128 a[208:211],v250 offset:53248
v_add_f32 v234,v238,v232
v_sub_f32 v238,v238,v232
v_add_f32 v232,v28,v124
v_sub_f32 v124,v28,v124
M v[180:183],v[228:231],a[212:215],v[180:183]
ds_read_b128 a[212:215],v250 offset:53504
v_add_f32 v28,v234,v232
v_fmac_f32 v234,4.0,v232
v_fma_f32 v232,2.0,v124,v238
v_fma_f32 v124,s41,v124,v238
M v[184:187],v[228:231],a[216:219],v[184:187]
ds_read_b128 a[216:219],v250 offset:53760
v_accvgpr_read_b32 v238,a29
v_accvgpr_read_b32 v237,a125
v_add_f32 v236,v238,v237
v_sub_f32 v238,v238,v237
M v[188:191],v[228:231],a[220:223],v[188:191]
s_waitcnt vmcnt(14)
buffer_load_dwordx4 v[228:231],v251,s[20:23],s46 offen offset:2048 sc1
v_add_f32 v237,v29,v125
v_sub_f32 v125,v29,v125
v_add_f32 v29,v236,v237
v_fmac_f32 v236,4.0,v237
M v[0:3],a[224:227],a[192:195],v[0:3]
ds_read_b128 a[220:223],v250 offset:54016
ds_read_b128 a[192:195],v250 offset:54272
v_fma_f32 v237,2.0,v125,v238
v_fma_f32 v125,s41,v125,v238
v_cvt_pk_bf16_f32 v232,v232,v237
v_cvt_pk_bf16_f32 v234,v234,v236
M v[4:7],a[224:227],a[196:199],v[4:7]
s_waitcnt lgkmcnt(6)
s_add_u32 s46,s80,0
v_accvgpr_read_b32 v238,a30
v_accvgpr_read_b32 v233,a126
v_add_f32 v235,v238,v233
v_sub_f32 v238,v238,v233
M v[8:11],a[224:227],a[200:203],v[8:11]
s_waitcnt lgkmcnt(5)
v_add_f32 v233,v30,v126
v_sub_f32 v126,v30,v126
v_add_f32 v30,v235,v233
v_fmac_f32 v235,4.0,v233
M v[12:15],a[224:227],a[204:207],v[12:15]
s_waitcnt lgkmcnt(4)
v_fma_f32 v233,2.0,v126,v238
v_fma_f32 v126,s41,v126,v238
v_accvgpr_read_b32 v238,a31
v_accvgpr_read_b32 v237,a127
M v[16:19],a[224:227],a[208:211],v[16:19]
s_waitcnt lgkmcnt(3)
v_add_f32 v236,v238,v237
v_sub_f32 v238,v238,v237
v_add_f32 v237,v31,v127
v_sub_f32 v127,v31,v127
M v[20:23],a[224:227],a[212:215],v[20:23]
s_waitcnt lgkmcnt(2)
v_add_f32 v31,v236,v237
v_fmac_f32 v236,4.0,v237
M v[24:27],a[224:227],a[216:219],v[24:27]
s_waitcnt lgkmcnt(1)
v_fma_f32 v237,2.0,v127,v238
v_fma_f32 v127,s41,v127,v238
M v[28:31],a[224:227],a[220:223],v[28:31]
s_waitcnt vmcnt(14)
buffer_load_dwordx4 a[224:227],v251,s[20:23],s46 offen offset:0 sc1
M v[0:3],a[228:231],a[196:199],v[0:3]
ds_read_b128 a[196:199],v249 offset:54528
v_cvt_pk_bf16_f32 v233,v233,v237
M v[4:7],a[228:231],a[200:203],v[4:7]
v_cvt_pk_bf16_f32 v235,v235,v236
M v[8:11],a[228:231],a[204:207],v[8:11]
ds_write2st64_b64 v253,v[232:233],v[234:235] offset0:93 offset1:97
M v[12:15],a[228:231],a[208:211],v[12:15]
v_accvgpr_read_b32 v238,a32
v_accvgpr_read_b32 v232,a128
M v[16:19],a[228:231],a[212:215],v[16:19]
v_add_f32 v234,v238,v232
v_sub_f32 v238,v238,v232
M v[20:23],a[228:231],a[216:219],v[20:23]
v_add_u32 v249,0x15400,v249
v_add_u32 v250,0x15400,v250
M v[24:27],a[228:231],a[220:223],v[24:27]
s_waitcnt lgkmcnt(2)
v_add_f32 v232,v32,v128
v_sub_f32 v128,v32,v128
M v[28:31],a[228:231],a[192:195],v[28:31]
s_waitcnt vmcnt(14) lgkmcnt(0)
s_barrier
ds_read_b128 a[24:27],v251 offset:43520
M v[0:3],a[232:235],a[200:203],v[0:3]
ds_read_b128 a[28:31],v251 offset:47616
ds_read_b128 a[200:203],v249 offset:0
M v[4:7],a[232:235],a[204:207],v[4:7]
buffer_load_dwordx4 a[228:231],v251,s[20:23],s46 offen offset:1024 sc1
M v[8:11],a[232:235],a[208:211],v[8:11]
ds_read_b128 a[204:207],v250 offset:256
ds_read_b128 a[208:211],v250 offset:512
M v[12:15],a[232:235],a[212:215],v[12:15]
ds_read_b128 a[212:215],v250 offset:768
v_add_f32 v32,v234,v232
M v[16:19],a[232:235],a[216:219],v[16:19]
s_waitcnt lgkmcnt(5)
s_add_u32 s34,s32,7471104
buffer_store_dwordx4 a[24:27],v252,s[24:27],s34 offen offset:384 nt
M v[20:23],a[232:235],a[220:223],v[20:23]
s_waitcnt lgkmcnt(4)
s_add_u32 s34,s32,7667712
buffer_store_dwordx4 a[28:31],v252,s[24:27],s34 offen offset:384 nt
M v[24:27],a[232:235],a[192:195],v[24:27]
ds_read_b128 a[216:219],v250 offset:1024
ds_read_b128 a[220:223],v250 offset:1280
M v[28:31],a[232:235],a[196:199],v[28:31]
s_waitcnt vmcnt(16) lgkmcnt(5)
buffer_load_dwordx4 a[232:235],v251,s[20:23],s46 offen offset:2048 sc1
M v[0:3],a[236:239],a[200:203],v[0:3]
s_waitcnt lgkmcnt(4)
ds_read_b128 a[192:195],v250 offset:1536
ds_read_b128 a[196:199],v250 offset:1792
M v[4:7],a[236:239],a[204:207],v[4:7]
s_waitcnt lgkmcnt(5)
s_add_u32 s46,s81,0
ds_read_b128 a[200:203],v250 offset:2048
v_fmac_f32 v234,4.0,v232
M v[8:11],a[236:239],a[208:211],v[8:11]
s_waitcnt lgkmcnt(5)
v_fma_f32 v232,2.0,v128,v238
v_fma_f32 v128,s41,v128,v238
M v[12:15],a[236:239],a[212:215],v[12:15]
s_waitcnt lgkmcnt(4)
v_accvgpr_read_b32 v238,a33
v_accvgpr_read_b32 v237,a129
M v[16:19],a[236:239],a[216:219],v[16:19]
s_waitcnt lgkmcnt(3)
v_add_f32 v236,v238,v237
v_sub_f32 v238,v238,v237
M v[20:23],a[236:239],a[220:223],v[20:23]
s_waitcnt lgkmcnt(2)
v_add_f32 v237,v33,v129
v_sub_f32 v129,v33,v129
M v[24:27],a[236:239],a[192:195],v[24:27]
s_waitcnt lgkmcnt(1)
v_add_f32 v33,v236,v237
v_fmac_f32 v236,4.0,v237
M v[28:31],a[236:239],a[196:199],v[28:31]
s_waitcnt vmcnt(14)
buffer_load_dwordx4 a[236:239],v251,s[20:23],s46 offen offset:0 sc1
M v[0:3],a[240:243],a[204:207],v[0:3]
ds_read_b128 a[204:207],v249 offset:2304
v_fma_f32 v237,2.0,v129,v238
M v[4:7],a[240:243],a[208:211],v[4:7]
v_fma_f32 v129,s41,v129,v238
v_cvt_pk_bf16_f32 v232,v232,v237
M v[8:11],a[240:243],a[212:215],v[8:11]
v_cvt_pk_bf16_f32 v234,v234,v236
v_accvgpr_read_b32 v238,a34
M v[12:15],a[240:243],a[216:219],v[12:15]
v_accvgpr_read_b32 v233,a130
v_add_f32 v235,v238,v233
M v[16:19],a[240:243],a[220:223],v[16:19]
v_sub_f32 v238,v238,v233
v_add_f32 v233,v34,v130
M v[20:23],a[240:243],a[192:195],v[20:23]
v_sub_f32 v130,v34,v130
v_add_f32 v34,v235,v233
M v[24:27],a[240:243],a[196:199],v[24:27]
s_waitcnt lgkmcnt(1)
v_fmac_f32 v235,4.0,v233
v_fma_f32 v233,2.0,v130,v238
M v[28:31],a[240:243],a[200:203],v[28:31]
s_waitcnt vmcnt(14)
buffer_load_dwordx4 a[240:243],v251,s[20:23],s46 offen offset:1024 sc1
M v[0:3],a[244:247],a[208:211],v[0:3]
ds_read_b128 a[208:211],v249 offset:17408
v_fma_f32 v130,s41,v130,v238
M v[4:7],a[244:247],a[212:215],v[4:7]
ds_read_b128 a[212:215],v250 offset:17664
v_accvgpr_read_b32 v238,a35
M v[8:11],a[244:247],a[216:219],v[8:11]
ds_read_b128 a[216:219],v250 offset:17920
v_accvgpr_read_b32 v237,a131
M v[12:15],a[244:247],a[220:223],v[12:15]
ds_read_b128 a[220:223],v250 offset:18176
v_add_f32 v236,v238,v237
M v[16:19],a[244:247],a[192:195],v[16:19]
ds_read_b128 a[192:195],v250 offset:18432
v_sub_f32 v238,v238,v237
M v[20:23],a[244:247],a[196:199],v[20:23]
ds_read_b128 a[196:199],v250 offset:18688
v_add_f32 v237,v35,v131
M v[24:27],a[244:247],a[200:203],v[24:27]
s_waitcnt lgkmcnt(6)
ds_read_b128 a[200:203],v250 offset:18944
v_sub_f32 v131,v35,v131
M v[28:31],a[244:247],a[204:207],v[28:31]
s_waitcnt vmcnt(14) lgkmcnt(6)
buffer_load_dwordx4 a[244:247],v251,s[20:23],s46 offen offset:2048 sc1
M v[0:3],a[248:251],a[208:211],v[0:3]
s_waitcnt lgkmcnt(5)
ds_read_b128 a[204:207],v250 offset:19200
ds_read_b128 a[208:211],v250 offset:19456
M v[4:7],a[248:251],a[212:215],v[4:7]
s_waitcnt lgkmcnt(6)
s_add_u32 s46,s76,46080
v_add_f32 v35,v236,v237
v_fmac_f32 v236,4.0,v237
M v[8:11],a[248:251],a[216:219],v[8:11]
s_waitcnt lgkmcnt(5)
v_fma_f32 v237,2.0,v131,v238
v_fma_f32 v131,s41,v131,v238
M v[12:15],a[248:251],a[220:223],v[12:15]
s_waitcnt lgkmcnt(4)
v_cvt_pk_bf16_f32 v233,v233,v237
v_cvt_pk_bf16_f32 v235,v235,v236
M v[16:19],a[248:251],a[192:195],v[16:19]
s_waitcnt lgkmcnt(3)
ds_write2st64_b64 v253,v[232:233],v[234:235] offset0:34 offset1:38
M v[20:23],a[248:251],a[196:199],v[20:23]
s_waitcnt lgkmcnt(3)
v_accvgpr_read_b32 v238,a36
v_accvgpr_read_b32 v232,a132
M v[24:27],a[248:251],a[200:203],v[24:27]
s_waitcnt lgkmcnt(2)
v_add_f32 v234,v238,v232
v_sub_f32 v238,v238,v232
M v[28:31],a[248:251],a[204:207],v[28:31]
s_waitcnt vmcnt(14)
buffer_load_dwordx4 a[248:251],v251,s[20:23],s46 offen offset:0 sc1
M v[0:3],a[252:255],a[212:215],v[0:3]
ds_read_b128 a[212:215],v249 offset:19712
v_add_f32 v232,v36,v132
M v[4:7],a[252:255],a[216:219],v[4:7]
v_sub_f32 v132,v36,v132
v_add_f32 v36,v234,v232
M v[8:11],a[252:255],a[220:223],v[8:11]
v_fmac_f32 v234,4.0,v232
v_fma_f32 v232,2.0,v132,v238
M v[12:15],a[252:255],a[192:195],v[12:15]
v_fma_f32 v132,s41,v132,v238
v_accvgpr_read_b32 v238,a37
M v[16:19],a[252:255],a[196:199],v[16:19]
v_accvgpr_read_b32 v237,a133
v_add_f32 v236,v238,v237
M v[20:23],a[252:255],a[200:203],v[20:23]
v_sub_f32 v238,v238,v237
v_add_f32 v237,v37,v133
M v[24:27],a[252:255],a[204:207],v[24:27]
s_waitcnt lgkmcnt(2)
v_sub_f32 v133,v37,v133
v_add_f32 v37,v236,v237
M v[28:31],a[252:255],a[208:211],v[28:31]
s_waitcnt vmcnt(14)
buffer_load_dwordx4 a[252:255],v251,s[20:23],s46 offen offset:1024 sc1
M v[0:3],v[216:219],a[216:219],v[0:3]
ds_read_b128 a[216:219],v249 offset:34816
v_fmac_f32 v236,4.0,v237
M v[4:7],v[216:219],a[220:223],v[4:7]
ds_read_b128 a[220:223],v250 offset:35072
v_fma_f32 v237,2.0,v133,v238
M v[8:11],v[216:219],a[192:195],v[8:11]
ds_read_b128 a[192:195],v250 offset:35328
v_fma_f32 v133,s41,v133,v238
M v[12:15],v[216:219],a[196:199],v[12:15]
ds_read_b128 a[196:199],v250 offset:35584
v_cvt_pk_bf16_f32 v232,v232,v237
M v[16:19],v[216:219],a[200:203],v[16:19]
ds_read_b128 a[200:203],v250 offset:35840
v_cvt_pk_bf16_f32 v234,v234,v236
M v[20:23],v[216:219],a[204:207],v[20:23]
ds_read_b128 a[204:207],v250 offset:36096
v_accvgpr_read_b32 v238,a38
M v[24:27],v[216:219],a[208:211],v[24:27]
s_waitcnt lgkmcnt(6)
ds_read_b128 a[208:211],v250 offset:36352
v_accvgpr_read_b32 v233,a134
M v[28:31],v[216:219],a[212:215],v[28:31]
s_waitcnt vmcnt(14) lgkmcnt(6)
buffer_load_dwordx4 v[216:219],v251,s[20:23],s46 offen offset:2048 sc1
M v[0:3],v[220:223],a[216:219],v[0:3]
s_waitcnt lgkmcnt(5)
ds_read_b128 a[212:215],v250 offset:36608
ds_read_b128 a[216:219],v250 offset:36864
M v[4:7],v[220:223],a[220:223],v[4:7]
s_waitcnt lgkmcnt(6)
s_add_u32 s46,s77,46080
v_add_f32 v235,v238,v233
v_sub_f32 v238,v238,v233
M v[8:11],v[220:223],a[192:195],v[8:11]
s_waitcnt lgkmcnt(5)
v_add_f32 v233,v38,v134
v_sub_f32 v134,v38,v134
M v[12:15],v[220:223],a[196:199],v[12:15]
s_waitcnt lgkmcnt(4)
v_add_f32 v38,v235,v233
v_fmac_f32 v235,4.0,v233
M v[16:19],v[220:223],a[200:203],v[16:19]
s_waitcnt lgkmcnt(3)
v_fma_f32 v233,2.0,v134,v238
v_fma_f32 v134,s41,v134,v238
M v[20:23],v[220:223],a[204:207],v[20:23]
s_waitcnt lgkmcnt(2)
v_accvgpr_read_b32 v238,a39
v_accvgpr_read_b32 v237,a135
M v[24:27],v[220:223],a[208:211],v[24:27]
s_waitcnt lgkmcnt(1)
v_add_f32 v236,v238,v237
v_sub_f32 v238,v238,v237
M v[28:31],v[220:223],a[212:215],v[28:31]
s_waitcnt vmcnt(12)
buffer_load_dwordx4 v[220:223],v251,s[20:23],s46 offen offset:0 sc1
M v[0:3],v[224:227],a[220:223],v[0:3]
ds_read_b128 a[220:223],v249 offset:37120
v_add_f32 v237,v39,v135
M v[4:7],v[224:227],a[192:195],v[4:7]
v_sub_f32 v135,v39,v135
v_add_f32 v39,v236,v237
M v[8:11],v[224:227],a[196:199],v[8:11]
v_fmac_f32 v236,4.0,v237
v_fma_f32 v237,2.0,v135,v238
M v[12:15],v[224:227],a[200:203],v[12:15]
v_fma_f32 v135,s41,v135,v238
v_cvt_pk_bf16_f32 v233,v233,v237
M v[16:19],v[224:227],a[204:207],v[16:19]
v_cvt_pk_bf16_f32 v235,v235,v236
M v[20:23],v[224:227],a[208:211],v[20:23]
ds_write2st64_b64 v253,v[232:233],v[234:235] offset0:42 offset1:46
M v[24:27],v[224:227],a[212:215],v[24:27]
s_waitcnt lgkmcnt(2)
v_accvgpr_read_b32 v238,a40
v_accvgpr_read_b32 v232,a136
M v[28:31],v[224:227],a[216:219],v[28:31]
s_waitcnt vmcnt(12)
buffer_load_dwordx4 v[224:227],v251,s[20:23],s46 offen offset:1024 sc1
M v[0:3],v[228:231],a[192:195],v[0:3]
ds_read_b128 a[192:195],v249 offset:52224
v_add_f32 v234,v238,v232
M v[4:7],v[228:231],a[196:199],v[4:7]
ds_read_b128 a[196:199],v250 offset:52480
v_sub_f32 v238,v238,v232
M v[8:11],v[228:231],a[200:203],v[8:11]
ds_read_b128 a[200:203],v250 offset:52736
v_add_f32 v232,v40,v136
M v[12:15],v[228:231],a[204:207],v[12:15]
ds_read_b128 a[204:207],v250 offset:52992
v_sub_f32 v136,v40,v136
M v[16:19],v[228:231],a[208:211],v[16:19]
ds_read_b128 a[208:211],v250 offset:53248
v_add_f32 v40,v234,v232
M v[20:23],v[228:231],a[212:215],v[20:23]
ds_read_b128 a[212:215],v250 offset:53504
v_fmac_f32 v234,4.0,v232
M v[24:27],v[228:231],a[216:219],v[24:27]
s_waitcnt lgkmcnt(7)
ds_read_b128 a[216:219],v250 offset:53760
v_fma_f32 v232,2.0,v136,v238
M v[28:31],v[228:231],a[220:223],v[28:31]
s_waitcnt vmcnt(12) lgkmcnt(6)
buffer_load_dwordx4 v[228:231],v251,s[20:23],s46 offen offset:2048 sc1
M v[0:3],a[224:227],a[192:195],v[0:3]
s_waitcnt lgkmcnt(5)
ds_read_b128 a[220:223],v250 offset:54016
ds_read_b128 a[192:195],v250 offset:54272
M v[4:7],a[224:227],a[196:199],v[4:7]
s_waitcnt lgkmcnt(6)
s_add_u32 s46,s78,46080
v_fma_f32 v136,s41,v136,v238
v_accvgpr_read_b32 v238,a41
M v[8:11],a[224:227],a[200:203],v[8:11]
s_waitcnt lgkmcnt(5)
v_accvgpr_read_b32 v237,a137
v_add_f32 v236,v238,v237
M v[12:15],a[224:227],a[204:207],v[12:15]
s_waitcnt lgkmcnt(4)
v_sub_f32 v238,v238,v237
v_add_f32 v237,v41,v137
M v[16:19],a[224:227],a[208:211],v[16:19]
s_waitcnt lgkmcnt(3)
v_sub_f32 v137,v41,v137
v_add_f32 v41,v236,v237
M v[20:23],a[224:227],a[212:215],v[20:23]
s_waitcnt lgkmcnt(2)
v_fmac_f32 v236,4.0,v237
v_fma_f32 v237,2.0,v137,v238
M v[24:27],a[224:227],a[216:219],v[24:27]
s_waitcnt lgkmcnt(1)
v_fma_f32 v137,s41,v137,v238
v_cvt_pk_bf16_f32 v232,v232,v237
M v[28:31],a[224:227],a[220:223],v[28:31]
s_waitcnt vmcnt(12)
buffer_load_dwordx4 a[224:227],v251,s[20:23],s46 offen offset:0 sc1
M v[0:3],a[228:231],a[196:199],v[0:3]
ds_read_b128 a[196:199],v249 offset:54528
v_cvt_pk_bf16_f32 v234,v234,v236
M v[4:7],a[228:231],a[200:203],v[4:7]
v_accvgpr_read_b32 v238,a42
v_accvgpr_read_b32 v233,a138
M v[8:11],a[228:231],a[204:207],v[8:11]
v_add_f32 v235,v238,v233
v_sub_f32 v238,v238,v233
M v[12:15],a[228:231],a[208:211],v[12:15]
v_add_f32 v233,v42,v138
v_sub_f32 v138,v42,v138
M v[16:19],a[228:231],a[212:215],v[16:19]
v_add_f32 v42,v235,v233
v_fmac_f32 v235,4.0,v233
M v[20:23],a[228:231],a[216:219],v[20:23]
v_add_u32 v249,0xffff9a00,v249
v_add_u32 v250,0xffff9a00,v250
M v[24:27],a[228:231],a[220:223],v[24:27]
s_waitcnt lgkmcnt(1)
v_fma_f32 v233,2.0,v138,v238
v_fma_f32 v138,s41,v138,v238
M v[28:31],a[228:231],a[192:195],v[28:31]
s_waitcnt vmcnt(10)
buffer_load_dwordx4 a[228:231],v251,s[20:23],s46 offen offset:1024 sc1
M v[0:3],a[232:235],a[200:203],v[0:3]
ds_read_b128 a[200:203],v249 offset:8704
v_accvgpr_read_b32 v238,a43
M v[4:7],a[232:235],a[204:207],v[4:7]
ds_read_b128 a[204:207],v250 offset:8960
v_accvgpr_read_b32 v237,a139
M v[8:11],a[232:235],a[208:211],v[8:11]
ds_read_b128 a[208:211],v250 offset:9216
v_add_f32 v236,v238,v237
M v[12:15],a[232:235],a[212:215],v[12:15]
ds_read_b128 a[212:215],v250 offset:9472
v_sub_f32 v238,v238,v237
M v[16:19],a[232:235],a[216:219],v[16:19]
ds_read_b128 a[216:219],v250 offset:9728
v_add_f32 v237,v43,v139
M v[20:23],a[232:235],a[220:223],v[20:23]
ds_read_b128 a[220:223],v250 offset:9984
v_sub_f32 v139,v43,v139
M v[24:27],a[232:235],a[192:195],v[24:27]
s_waitcnt lgkmcnt(6)
ds_read_b128 a[192:195],v250 offset:10240
v_add_f32 v43,v236,v237
M v[28:31],a[232:235],a[196:199],v[28:31]
s_waitcnt vmcnt(10) lgkmcnt(6)
buffer_load_dwordx4 a[232:235],v251,s[20:23],s46 offen offset:2048 sc1
M v[0:3],a[236:239],a[200:203],v[0:3]
s_waitcnt lgkmcnt(5)
ds_read_b128 a[196:199],v250 offset:10496
ds_read_b128 a[200:203],v250 offset:10752
M v[4:7],a[236:239],a[204:207],v[4:7]
s_waitcnt lgkmcnt(6)
s_add_u32 s46,s79,46080
v_fmac_f32 v236,4.0,v237
v_fma_f32 v237,2.0,v139,v238
M v[8:11],a[236:239],a[208:211],v[8:11]
s_waitcnt lgkmcnt(5)
v_fma_f32 v139,s41,v139,v238
v_cvt_pk_bf16_f32 v233,v233,v237
M v[12:15],a[236:239],a[212:215],v[12:15]
s_waitcnt lgkmcnt(4)
v_cvt_pk_bf16_f32 v235,v235,v236
M v[16:19],a[236:239],a[216:219],v[16:19]
s_waitcnt lgkmcnt(3)
ds_write2st64_b64 v253,v[232:233],v[234:235] offset0:51 offset1:55
M v[20:23],a[236:239],a[220:223],v[20:23]
s_waitcnt lgkmcnt(3)
v_accvgpr_read_b32 v238,a44
v_accvgpr_read_b32 v232,a140
M v[24:27],a[236:239],a[192:195],v[24:27]
s_waitcnt lgkmcnt(2)
v_add_f32 v234,v238,v232
v_sub_f32 v238,v238,v232
M v[28:31],a[236:239],a[196:199],v[28:31]
s_waitcnt vmcnt(10)
buffer_load_dwordx4 a[236:239],v251,s[20:23],s46 offen offset:0 sc1
M v[0:3],a[240:243],a[204:207],v[0:3]
ds_read_b128 a[204:207],v249 offset:11008
v_add_f32 v232,v44,v140
M v[4:7],a[240:243],a[208:211],v[4:7]
v_sub_f32 v140,v44,v140
v_add_f32 v44,v234,v232
M v[8:11],a[240:243],a[212:215],v[8:11]
v_fmac_f32 v234,4.0,v232
v_fma_f32 v232,2.0,v140,v238
M v[12:15],a[240:243],a[216:219],v[12:15]
v_fma_f32 v140,s41,v140,v238
v_accvgpr_read_b32 v238,a45
M v[16:19],a[240:243],a[220:223],v[16:19]
v_accvgpr_read_b32 v237,a141
v_add_f32 v236,v238,v237
M v[20:23],a[240:243],a[192:195],v[20:23]
v_sub_f32 v238,v238,v237
v_add_f32 v237,v45,v141
M v[24:27],a[240:243],a[196:199],v[24:27]
s_waitcnt lgkmcnt(2)
v_sub_f32 v141,v45,v141
v_add_f32 v45,v236,v237
M v[28:31],a[240:243],a[200:203],v[28:31]
s_waitcnt vmcnt(10)
buffer_load_dwordx4 a[240:243],v251,s[20:23],s46 offen offset:1024 sc1
M v[0:3],a[244:247],a[208:211],v[0:3]
ds_read_b128 a[208:211],v249 offset:0
v_fmac_f32 v236,4.0,v237
M v[4:7],a[244:247],a[212:215],v[4:7]
ds_read_b128 a[212:215],v250 offset:256
v_fma_f32 v237,2.0,v141,v238
M v[8:11],a[244:247],a[216:219],v[8:11]
ds_read_b128 a[216:219],v250 offset:512
v_fma_f32 v141,s41,v141,v238
M v[12:15],a[244:247],a[220:223],v[12:15]
ds_read_b128 a[220:223],v250 offset:768
v_cvt_pk_bf16_f32 v232,v232,v237
M v[16:19],a[244:247],a[192:195],v[16:19]
ds_read_b128 a[192:195],v250 offset:1024
v_cvt_pk_bf16_f32 v234,v234,v236
M v[20:23],a[244:247],a[196:199],v[20:23]
ds_read_b128 a[196:199],v250 offset:1280
v_accvgpr_read_b32 v238,a46
M v[24:27],a[244:247],a[200:203],v[24:27]
s_waitcnt lgkmcnt(6)
ds_read_b128 a[200:203],v250 offset:1536
v_accvgpr_read_b32 v233,a142
M v[28:31],a[244:247],a[204:207],v[28:31]
s_waitcnt vmcnt(10) lgkmcnt(6)
buffer_load_dwordx4 a[244:247],v251,s[20:23],s46 offen offset:2048 sc1
M v[96:99],a[248:251],a[208:211],v[96:99]
s_waitcnt lgkmcnt(5)
ds_read_b128 a[204:207],v250 offset:1792
ds_read_b128 a[208:211],v250 offset:2048
M v[100:103],a[248:251],a[212:215],v[100:103]
s_waitcnt lgkmcnt(6)
s_add_u32 s46,s80,46080
v_add_f32 v235,v238,v233
v_sub_f32 v238,v238,v233
M v[104:107],a[248:251],a[216:219],v[104:107]
s_waitcnt lgkmcnt(5)
v_add_f32 v233,v46,v142
v_sub_f32 v142,v46,v142
M v[108:111],a[248:251],a[220:223],v[108:111]
s_waitcnt lgkmcnt(4)
v_add_f32 v46,v235,v233
v_fmac_f32 v235,4.0,v233
M v[112:115],a[248:251],a[192:195],v[112:115]
s_waitcnt lgkmcnt(3)
v_fma_f32 v233,2.0,v142,v238
v_fma_f32 v142,s41,v142,v238
M v[116:119],a[248:251],a[196:199],v[116:119]
s_waitcnt lgkmcnt(2)
v_accvgpr_read_b32 v238,a47
v_accvgpr_read_b32 v237,a143
M v[120:123],a[248:251],a[200:203],v[120:123]
s_waitcnt lgkmcnt(1)
v_add_f32 v236,v238,v237
v_sub_f32 v238,v238,v237
M v[124:127],a[248:251],a[204:207],v[124:127]
s_waitcnt vmcnt(10)
buffer_load_dwordx4 a[248:251],v251,s[20:23],s46 offen offset:0 sc1
M v[96:99],a[252:255],a[212:215],v[96:99]
ds_read_b128 a[212:215],v249 offset:2304
v_add_f32 v237,v47,v143
M v[100:103],a[252:255],a[216:219],v[100:103]
v_sub_f32 v143,v47,v143
v_add_f32 v47,v236,v237
M v[104:107],a[252:255],a[220:223],v[104:107]
v_fmac_f32 v236,4.0,v237
v_fma_f32 v237,2.0,v143,v238
M v[108:111],a[252:255],a[192:195],v[108:111]
v_fma_f32 v143,s41,v143,v238
v_cvt_pk_bf16_f32 v233,v233,v237
M v[112:115],a[252:255],a[196:199],v[112:115]
v_cvt_pk_bf16_f32 v235,v235,v236
M v[116:119],a[252:255],a[200:203],v[116:119]
ds_write2st64_b64 v253,v[232:233],v[234:235] offset0:59 offset1:63
M v[120:123],a[252:255],a[204:207],v[120:123]
s_waitcnt lgkmcnt(2)
v_cvt_pk_bf16_f32 v0,v0,v1
v_cvt_pk_bf16_f32 v1,v2,v3
M v[124:127],a[252:255],a[208:211],v[124:127]
s_waitcnt vmcnt(10)
buffer_load_dwordx4 a[252:255],v251,s[20:23],s46 offen offset:1024 sc1
M v[96:99],v[216:219],a[216:219],v[96:99]
ds_read_b128 a[216:219],v249 offset:34816
v_cvt_pk_bf16_f32 v4,v4,v5
M v[100:103],v[216:219],a[220:223],v[100:103]
ds_read_b128 a[220:223],v250 offset:35072
v_cvt_pk_bf16_f32 v5,v6,v7
M v[104:107],v[216:219],a[192:195],v[104:107]
s_waitcnt lgkmcnt(2)
s_barrier
ds_read_b128 a[32:35],v251 offset:17408
M v[108:111],v[216:219],a[196:199],v[108:111]
ds_read_b128 a[36:39],v251 offset:21504
ds_read_b128 a[40:43],v251 offset:26112
M v[112:115],v[216:219],a[200:203],v[112:115]
ds_read_b128 a[44:47],v251 offset:30208
ds_read_b128 a[192:195],v250 offset:35328
M v[116:119],v[216:219],a[204:207],v[116:119]
ds_read_b128 a[196:199],v250 offset:35584
ds_read_b128 a[200:203],v250 offset:35840
M v[120:123],v[216:219],a[208:211],v[120:123]
ds_read_b128 a[204:207],v250 offset:36096
ds_read_b128 a[208:211],v250 offset:36352
M v[124:127],v[216:219],a[212:215],v[124:127]
s_waitcnt vmcnt(10) lgkmcnt(8)
s_add_u32 s34,s32,6291456
buffer_store_dwordx4 a[32:35],v252,s[24:27],s34 offen offset:512 nt
M v[96:99],v[220:223],a[216:219],v[96:99]
s_waitcnt lgkmcnt(7)
s_add_u32 s34,s32,6488064
buffer_store_dwordx4 a[36:39],v252,s[24:27],s34 offen offset:512 nt
M v[100:103],v[220:223],a[220:223],v[100:103]
s_waitcnt lgkmcnt(4)
s_add_u32 s34,s32,6684672
buffer_load_dwordx4 v[216:219],v251,s[20:23],s46 offen offset:2048 sc1
M v[104:107],v[220:223],a[192:195],v[104:107]
s_waitcnt lgkmcnt(3)
s_add_u32 s46,s81,46080
buffer_store_dwordx4 a[40:43],v252,s[24:27],s34 offen offset:512 nt
ds_read_b128 a[212:215],v250 offset:36608
M v[108:111],v[220:223],a[196:199],v[108:111]
s_waitcnt lgkmcnt(3)
s_add_u32 s34,s32,6881280
buffer_store_dwordx4 a[44:47],v252,s[24:27],s34 offen offset:512 nt
M v[112:115],v[220:223],a[200:203],v[112:115]
s_waitcnt lgkmcnt(2)
ds_read_b128 a[216:219],v250 offset:36864
ds_write2st64_b64 v253,v[0:1],v[4:5] offset0:17 offset1:21
M v[116:119],v[220:223],a[204:207],v[116:119]
s_waitcnt lgkmcnt(3)
v_cvt_pk_bf16_f32 v8,v8,v9
v_cvt_pk_bf16_f32 v9,v10,v11
M v[120:123],v[220:223],a[208:211],v[120:123]
s_waitcnt lgkmcnt(2)
v_cvt_pk_bf16_f32 v12,v12,v13
v_cvt_pk_bf16_f32 v13,v14,v15
M v[124:127],v[220:223],a[212:215],v[124:127]
s_waitcnt vmcnt(14)
buffer_load_dwordx4 v[220:223],v251,s[20:23],s46 offen offset:0 sc1
M v[96:99],v[224:227],a[220:223],v[96:99]
ds_read_b128 a[220:223],v249 offset:37120
ds_write2st64_b64 v253,v[8:9],v[12:13] offset0:25 offset1:29
M v[100:103],v[224:227],a[192:195],v[100:103]
v_cvt_pk_bf16_f32 v16,v16,v17
v_cvt_pk_bf16_f32 v17,v18,v19
M v[104:107],v[224:227],a[196:199],v[104:107]
v_cvt_pk_bf16_f32 v20,v20,v21
v_cvt_pk_bf16_f32 v21,v22,v23
M v[108:111],v[224:227],a[200:203],v[108:111]
ds_write2st64_b64 v253,v[16:17],v[20:21] offset0:68 offset1:72
M v[112:115],v[224:227],a[204:207],v[112:115]
v_cvt_pk_bf16_f32 v24,v24,v25
v_cvt_pk_bf16_f32 v25,v26,v27
M v[116:119],v[224:227],a[208:211],v[116:119]
v_cvt_pk_bf16_f32 v28,v28,v29
v_cvt_pk_bf16_f32 v29,v30,v31
M v[120:123],v[224:227],a[212:215],v[120:123]
s_waitcnt lgkmcnt(4)
ds_write2st64_b64 v253,v[24:25],v[28:29] offset0:76 offset1:80
M v[124:127],v[224:227],a[216:219],v[124:127]
s_waitcnt vmcnt(14)
buffer_load_dwordx4 v[224:227],v251,s[20:23],s46 offen offset:1024 sc1
M v[96:99],v[228:231],a[192:195],v[96:99]
ds_read_b128 a[192:195],v249 offset:52224
v_accvgpr_read_b32 v238,a48
M v[100:103],v[228:231],a[196:199],v[100:103]
ds_read_b128 a[196:199],v250 offset:52480
v_accvgpr_read_b32 v232,a144
M v[104:107],v[228:231],a[200:203],v[104:107]
ds_read_b128 a[200:203],v250 offset:52736
v_add_f32 v234,v238,v232
M v[108:111],v[228:231],a[204:207],v[108:111]
ds_read_b128 a[204:207],v250 offset:52992
v_sub_f32 v238,v238,v232
M v[112:115],v[228:231],a[208:211],v[112:115]
ds_read_b128 a[208:211],v250 offset:53248
v_add_f32 v232,v48,v144
M v[116:119],v[228:231],a[212:215],v[116:119]
ds_read_b128 a[212:215],v250 offset:53504
v_sub_f32 v144,v48,v144
M v[120:123],v[228:231],a[216:219],v[120:123]
s_waitcnt lgkmcnt(9)
ds_read_b128 a[216:219],v250 offset:53760
v_add_f32 v48,v234,v232
M v[124:127],v[228:231],a[220:223],v[124:127]
s_waitcnt vmcnt(14) lgkmcnt(6)
buffer_load_dwordx4 v[228:231],v251,s[20:23],s46 offen offset:2048 sc1
M v[96:99],a[224:227],a[192:195],v[96:99]
s_waitcnt lgkmcnt(5)
ds_read_b128 a[220:223],v250 offset:54016
ds_read_b128 a[192:195],v250 offset:54272
M v[100:103],a[224:227],a[196:199],v[100:103]
s_waitcnt lgkmcnt(6)
s_add_u32 s47,s76,3072
v_fmac_f32 v234,4.0,v232
v_fma_f32 v232,2.0,v144,v238
M v[104:107],a[224:227],a[200:203],v[104:107]
s_waitcnt lgkmcnt(5)
v_fma_f32 v144,s41,v144,v238
v_accvgpr_read_b32 v238,a49
M v[108:111],a[224:227],a[204:207],v[108:111]
s_waitcnt lgkmcnt(4)
v_accvgpr_read_b32 v237,a145
v_add_f32 v236,v238,v237
M v[112:115],a[224:227],a[208:211],v[112:115]
s_waitcnt lgkmcnt(3)
v_sub_f32 v238,v238,v237
v_add_f32 v237,v49,v145
M v[116:119],a[224:227],a[212:215],v[116:119]
s_waitcnt lgkmcnt(2)
v_sub_f32 v145,v49,v145
v_add_f32 v49,v236,v237
M v[120:123],a[224:227],a[216:219],v[120:123]
s_waitcnt lgkmcnt(1)
v_fmac_f32 v236,4.0,v237
v_fma_f32 v237,2.0,v145,v238
M v[124:127],a[224:227],a[220:223],v[124:127]
s_waitcnt vmcnt(14)
buffer_load_dwordx4 a[224:227],v251,s[20:23],s47 offen offset:0 sc1
M v[96:99],a[228:231],a[196:199],v[96:99]
ds_read_b128 a[196:199],v249 offset:54528
v_fma_f32 v145,s41,v145,v238
M v[100:103],a[228:231],a[200:203],v[100:103]
v_cvt_pk_bf16_f32 v232,v232,v237
v_cvt_pk_bf16_f32 v234,v234,v236
M v[104:107],a[228:231],a[204:207],v[104:107]
v_accvgpr_read_b32 v238,a50
v_accvgpr_read_b32 v233,a146
M v[108:111],a[228:231],a[208:211],v[108:111]
v_add_f32 v235,v238,v233
v_sub_f32 v238,v238,v233
M v[112:115],a[228:231],a[212:215],v[112:115]
v_add_f32 v233,v50,v146
v_sub_f32 v146,v50,v146
M v[116:119],a[228:231],a[216:219],v[116:119]
v_add_u32 v249,0x11000,v249
v_add_u32 v250,0x11000,v250
M v[120:123],a[228:231],a[220:223],v[120:123]
s_waitcnt lgkmcnt(1)
v_add_f32 v50,v235,v233
v_fmac_f32 v235,4.0,v233
M v[124:127],a[228:231],a[192:195],v[124:127]
s_waitcnt vmcnt(14)
buffer_load_dwordx4 a[228:231],v251,s[20:23],s47 offen offset:1024 sc1
M v[96:99],a[232:235],a[200:203],v[96:99]
ds_read_b128 a[200:203],v249 offset:0
v_fma_f32 v233,2.0,v146,v238
M v[100:103],a[232:235],a[204:207],v[100:103]
ds_read_b128 a[204:207],v250 offset:256
v_fma_f32 v146,s41,v146,v238
M v[104:107],a[232:235],a[208:211],v[104:107]
ds_read_b128 a[208:211],v250 offset:512
v_accvgpr_read_b32 v238,a51
M v[108:111],a[232:235],a[212:215],v[108:111]
ds_read_b128 a[212:215],v250 offset:768
v_accvgpr_read_b32 v237,a147
M v[112:115],a[232:235],a[216:219],v[112:115]
ds_read_b128 a[216:219],v250 offset:1024
v_add_f32 v236,v238,v237
M v[116:119],a[232:235],a[220:223],v[116:119]
ds_read_b128 a[220:223],v250 offset:1280
v_sub_f32 v238,v238,v237
M v[120:123],a[232:235],a[192:195],v[120:123]
s_waitcnt lgkmcnt(6)
ds_read_b128 a[192:195],v250 offset:1536
v_add_f32 v237,v51,v147
M v[124:127],a[232:235],a[196:199],v[124:127]
s_waitcnt vmcnt(14) lgkmcnt(6)
buffer_load_dwordx4 a[232:235],v251,s[20:23],s47 offen offset:2048 sc1
M v[96:99],a[236:239],a[200:203],v[96:99]
s_waitcnt lgkmcnt(5)
ds_read_b128 a[196:199],v250 offset:1792
ds_read_b128 a[200:203],v250 offset:2048
M v[100:103],a[236:239],a[204:207],v[100:103]
s_waitcnt lgkmcnt(6)
s_add_u32 s47,s77,3072
v_sub_f32 v147,v51,v147
v_add_f32 v51,v236,v237
M v[104:107],a[236:239],a[208:211],v[104:107]
s_waitcnt lgkmcnt(5)
v_fmac_f32 v236,4.0,v237
v_fma_f32 v237,2.0,v147,v238
M v[108:111],a[236:239],a[212:215],v[108:111]
s_waitcnt lgkmcnt(4)
v_fma_f32 v147,s41,v147,v238
v_cvt_pk_bf16_f32 v233,v233,v237
M v[112:115],a[236:239],a[216:219],v[112:115]
s_waitcnt lgkmcnt(3)
v_cvt_pk_bf16_f32 v235,v235,v236
M v[116:119],a[236:239],a[220:223],v[116:119]
s_waitcnt lgkmcnt(2)
ds_write2st64_b64 v253,v[232:233],v[234:235] offset0:85 offset1:89
M v[120:123],a[236:239],a[192:195],v[120:123]
s_waitcnt lgkmcnt(2)
v_accvgpr_read_b32 v238,a52
v_accvgpr_read_b32 v232,a148
M v[124:127],a[236:239],a[196:199],v[124:127]
s_waitcnt vmcnt(14)
buffer_load_dwordx4 a[236:239],v251,s[20:23],s47 offen offset:0 sc1
M v[96:99],a[240:243],a[204:207],v[96:99]
ds_read_b128 a[204:207],v249 offset:2304
v_add_f32 v234,v238,v232
M v[100:103],a[240:243],a[208:211],v[100:103]
v_sub_f32 v238,v238,v232
v_add_f32 v232,v52,v148
M v[104:107],a[240:243],a[212:215],v[104:107]
v_sub_f32 v148,v52,v148
v_add_f32 v52,v234,v232
M v[108:111],a[240:243],a[216:219],v[108:111]
v_fmac_f32 v234,4.0,v232
v_fma_f32 v232,2.0,v148,v238
M v[112:115],a[240:243],a[220:223],v[112:115]
v_fma_f32 v148,s41,v148,v238
v_accvgpr_read_b32 v238,a53
M v[116:119],a[240:243],a[192:195],v[116:119]
v_accvgpr_read_b32 v237,a149
v_add_f32 v236,v238,v237
M v[120:123],a[240:243],a[196:199],v[120:123]
s_waitcnt lgkmcnt(2)
v_sub_f32 v238,v238,v237
v_add_f32 v237,v53,v149
M v[124:127],a[240:243],a[200:203],v[124:127]
s_waitcnt vmcnt(14)
buffer_load_dwordx4 a[240:243],v251,s[20:23],s47 offen offset:1024 sc1
M v[96:99],a[244:247],a[208:211],v[96:99]
ds_read_b128 a[208:211],v249 offset:17408
v_sub_f32 v149,v53,v149
M v[100:103],a[244:247],a[212:215],v[100:103]
ds_read_b128 a[212:215],v250 offset:17664
v_add_f32 v53,v236,v237
M v[104:107],a[244:247],a[216:219],v[104:107]
ds_read_b128 a[216:219],v250 offset:17920
v_fmac_f32 v236,4.0,v237
M v[108:111],a[244:247],a[220:223],v[108:111]
ds_read_b128 a[220:223],v250 offset:18176
v_fma_f32 v237,2.0,v149,v238
M v[112:115],a[244:247],a[192:195],v[112:115]
ds_read_b128 a[192:195],v250 offset:18432
v_fma_f32 v149,s41,v149,v238
M v[116:119],a[244:247],a[196:199],v[116:119]
ds_read_b128 a[196:199],v250 offset:18688
v_cvt_pk_bf16_f32 v232,v232,v237
M v[120:123],a[244:247],a[200:203],v[120:123]
s_waitcnt lgkmcnt(6)
ds_read_b128 a[200:203],v250 offset:18944
v_cvt_pk_bf16_f32 v234,v234,v236
M v[124:127],a[244:247],a[204:207],v[124:127]
s_waitcnt vmcnt(14) lgkmcnt(6)
buffer_load_dwordx4 a[244:247],v251,s[20:23],s47 offen offset:2048 sc1
M v[96:99],a[248:251],a[208:211],v[96:99]
s_waitcnt lgkmcnt(5)
ds_read_b128 a[204:207],v250 offset:19200
ds_read_b128 a[208:211],v250 offset:19456
M v[100:103],a[248:251],a[212:215],v[100:103]
s_waitcnt lgkmcnt(6)
s_add_u32 s47,s78,3072
v_accvgpr_read_b32 v238,a54
v_accvgpr_read_b32 v233,a150
M v[104:107],a[248:251],a[216:219],v[104:107]
s_waitcnt lgkmcnt(5)
v_add_f32 v235,v238,v233
v_sub_f32 v238,v238,v233
M v[108:111],a[248:251],a[220:223],v[108:111]
s_waitcnt lgkmcnt(4)
v_add_f32 v233,v54,v150
v_sub_f32 v150,v54,v150
M v[112:115],a[248:251],a[192:195],v[112:115]
s_waitcnt lgkmcnt(3)
v_add_f32 v54,v235,v233
v_fmac_f32 v235,4.0,v233
M v[116:119],a[248:251],a[196:199],v[116:119]
s_waitcnt lgkmcnt(2)
v_fma_f32 v233,2.0,v150,v238
v_fma_f32 v150,s41,v150,v238
M v[120:123],a[248:251],a[200:203],v[120:123]
s_waitcnt lgkmcnt(1)
v_accvgpr_read_b32 v238,a55
v_accvgpr_read_b32 v237,a151
M v[124:127],a[248:251],a[204:207],v[124:127]
s_waitcnt vmcnt(14)
buffer_load_dwordx4 a[248:251],v251,s[20:23],s47 offen offset:0 sc1
M v[96:99],a[252:255],a[212:215],v[96:99]
ds_read_b128 a[212:215],v249 offset:19712
v_add_f32 v236,v238,v237
M v[100:103],a[252:255],a[216:219],v[100:103]
v_sub_f32 v238,v238,v237
v_add_f32 v237,v55,v151
M v[104:107],a[252:255],a[220:223],v[104:107]
v_sub_f32 v151,v55,v151
v_add_f32 v55,v236,v237
M v[108:111],a[252:255],a[192:195],v[108:111]
v_fmac_f32 v236,4.0,v237
v_fma_f32 v237,2.0,v151,v238
M v[112:115],a[252:255],a[196:199],v[112:115]
v_fma_f32 v151,s41,v151,v238
v_cvt_pk_bf16_f32 v233,v233,v237
M v[116:119],a[252:255],a[200:203],v[116:119]
v_add_u32 v249,0xfffece00,v249
v_add_u32 v250,0xfffece00,v250
M v[120:123],a[252:255],a[204:207],v[120:123]
s_waitcnt lgkmcnt(1)
v_cvt_pk_bf16_f32 v235,v235,v236
M v[124:127],a[252:255],a[208:211],v[124:127]
s_waitcnt vmcnt(12)
buffer_load_dwordx4 a[252:255],v251,s[20:23],s47 offen offset:1024 sc1
M v[96:99],v[216:219],a[216:219],v[96:99]
ds_read_b128 a[216:219],v249 offset:26112
ds_write2st64_b64 v253,v[232:233],v[234:235] offset0:93 offset1:97
M v[100:103],v[216:219],a[220:223],v[100:103]
ds_read_b128 a[220:223],v250 offset:26368
v_accvgpr_read_b32 v238,a56
M v[104:107],v[216:219],a[192:195],v[104:107]
ds_read_b128 a[192:195],v250 offset:26624
v_accvgpr_read_b32 v232,a152
M v[108:111],v[216:219],a[196:199],v[108:111]
ds_read_b128 a[196:199],v250 offset:26880
v_add_f32 v234,v238,v232
M v[112:115],v[216:219],a[200:203],v[112:115]
ds_read_b128 a[200:203],v250 offset:27136
v_sub_f32 v238,v238,v232
M v[116:119],v[216:219],a[204:207],v[116:119]
ds_read_b128 a[204:207],v250 offset:27392
v_add_f32 v232,v56,v152
M v[120:123],v[216:219],a[208:211],v[120:123]
s_waitcnt lgkmcnt(7)
ds_read_b128 a[208:211],v250 offset:27648
v_sub_f32 v152,v56,v152
M v[124:127],v[216:219],a[212:215],v[124:127]
s_waitcnt vmcnt(10) lgkmcnt(6)
s_barrier
ds_read_b128 a[96:99],v251 offset:8704
M v[96:99],v[220:223],a[216:219],v[96:99]
s_waitcnt lgkmcnt(6)
ds_read_b128 a[100:103],v251 offset:12800
ds_read_b128 a[104:107],v251 offset:34816
M v[100:103],v[220:223],a[220:223],v[100:103]
s_waitcnt lgkmcnt(7)
ds_read_b128 a[108:111],v251 offset:38912
ds_read_b128 a[48:51],v251 offset:43520
M v[104:107],v[220:223],a[192:195],v[104:107]
s_waitcnt lgkmcnt(8)
ds_read_b128 a[52:55],v251 offset:47616
ds_read_b128 a[212:215],v250 offset:27904
M v[108:111],v[220:223],a[196:199],v[108:111]
s_waitcnt lgkmcnt(9)
buffer_load_dwordx4 v[216:219],v251,s[20:23],s47 offen offset:2048 sc1
M v[112:115],v[220:223],a[200:203],v[112:115]
s_waitcnt lgkmcnt(6)
s_add_u32 s34,s33,6291456
buffer_store_dwordx4 a[96:99],v252,s[24:27],s34 offen offset:0 nt
M v[116:119],v[220:223],a[204:207],v[116:119]
s_waitcnt lgkmcnt(5)
s_add_u32 s34,s33,6684672
buffer_store_dwordx4 a[100:103],v252,s[24:27],s34 offen offset:0 nt
M v[120:123],v[220:223],a[208:211],v[120:123]
s_waitcnt lgkmcnt(0)
s_add_u32 s34,s33,7077888
buffer_store_dwordx4 a[104:107],v252,s[24:27],s34 offen offset:0 nt
M v[124:127],v[220:223],a[212:215],v[124:127]
s_waitcnt vmcnt(13)
s_add_u32 s34,s33,7471104
buffer_store_dwordx4 a[108:111],v252,s[24:27],s34 offen offset:0 nt
M v[96:99],v[224:227],a[220:223],v[96:99]
s_nop 0
s_add_u32 s34,s32,7077888
buffer_store_dwordx4 a[48:51],v252,s[24:27],s34 offen offset:512 nt
v_add_f32 v56,v234,v232
v_fmac_f32 v234,4.0,v232
v_fma_f32 v232,2.0,v152,v238
M v[100:103],v[224:227],a[192:195],v[100:103]
s_add_u32 s34,s32,7274496
buffer_store_dwordx4 a[52:55],v252,s[24:27],s34 offen offset:512 nt
v_fma_f32 v152,s41,v152,v238
v_accvgpr_read_b32 v238,a57
v_accvgpr_read_b32 v237,a153
v_add_f32 v236,v238,v237
M v[104:107],v[224:227],a[196:199],v[104:107]
s_add_u32 s47,s79,3072
buffer_load_dwordx4 v[220:223],v251,s[20:23],s47 offen offset:0 sc1
ds_read_b128 a[216:219],v250 offset:28160
v_sub_f32 v238,v238,v237
v_add_f32 v237,v57,v153
v_sub_f32 v153,v57,v153
v_add_f32 v57,v236,v237
M v[108:111],v[224:227],a[200:203],v[108:111]
ds_read_b128 a[220:223],v249 offset:28416
v_fmac_f32 v236,4.0,v237
v_fma_f32 v237,2.0,v153,v238
v_fma_f32 v153,s41,v153,v238
v_cvt_pk_bf16_f32 v232,v232,v237
M v[112:115],v[224:227],a[204:207],v[112:115]
v_cvt_pk_bf16_f32 v234,v234,v236
v_accvgpr_read_b32 v238,a58
v_accvgpr_read_b32 v233,a154
v_add_f32 v235,v238,v233
M v[116:119],v[224:227],a[208:211],v[116:119]
v_sub_f32 v238,v238,v233
v_add_f32 v233,v58,v154
v_sub_f32 v154,v58,v154
v_add_f32 v58,v235,v233
M v[120:123],v[224:227],a[212:215],v[120:123]
s_waitcnt lgkmcnt(1)
v_fmac_f32 v235,4.0,v233
v_fma_f32 v233,2.0,v154,v238
v_fma_f32 v154,s41,v154,v238
v_accvgpr_read_b32 v238,a59
M v[124:127],v[224:227],a[216:219],v[124:127]
s_waitcnt vmcnt(16)
buffer_load_dwordx4 v[224:227],v251,s[20:23],s47 offen offset:1024 sc1
v_accvgpr_read_b32 v237,a155
v_add_f32 v236,v238,v237
v_sub_f32 v238,v238,v237
v_add_f32 v237,v59,v155
M v[96:99],v[228:231],a[192:195],v[96:99]
ds_read_b128 a[192:195],v249 offset:0
v_sub_f32 v155,v59,v155
v_add_f32 v59,v236,v237
v_fmac_f32 v236,4.0,v237
v_fma_f32 v237,2.0,v155,v238
M v[100:103],v[228:231],a[196:199],v[100:103]
ds_read_b128 a[196:199],v250 offset:256
v_fma_f32 v155,s41,v155,v238
v_cvt_pk_bf16_f32 v233,v233,v237
v_cvt_pk_bf16_f32 v235,v235,v236
M v[104:107],v[228:231],a[200:203],v[104:107]
ds_write2st64_b64 v253,v[232:233],v[234:235] offset0:34 offset1:38
M v[108:111],v[228:231],a[204:207],v[108:111]
ds_read_b128 a[200:203],v250 offset:512
ds_read_b128 a[204:207],v250 offset:768
v_accvgpr_read_b32 v238,a60
v_accvgpr_read_b32 v232,a156
M v[112:115],v[228:231],a[208:211],v[112:115]
ds_read_b128 a[208:211],v250 offset:1024
v_add_f32 v234,v238,v232
v_sub_f32 v238,v238,v232
v_add_f32 v232,v60,v156
v_sub_f32 v156,v60,v156
M v[116:119],v[228:231],a[212:215],v[116:119]
ds_read_b128 a[212:215],v250 offset:1280
v_add_f32 v60,v234,v232
v_fmac_f32 v234,4.0,v232
v_fma_f32 v232,2.0,v156,v238
v_fma_f32 v156,s41,v156,v238
M v[120:123],v[228:231],a[216:219],v[120:123]
s_waitcnt lgkmcnt(7)
ds_read_b128 a[216:219],v250 offset:1536
v_accvgpr_read_b32 v238,a61
v_accvgpr_read_b32 v237,a157
v_add_f32 v236,v238,v237
v_sub_f32 v238,v238,v237
M v[124:127],v[228:231],a[220:223],v[124:127]
s_waitcnt vmcnt(16) lgkmcnt(7)
buffer_load_dwordx4 v[228:231],v251,s[20:23],s47 offen offset:2048 sc1
v_add_f32 v237,v61,v157
v_sub_f32 v157,v61,v157
v_add_f32 v61,v236,v237
v_fmac_f32 v236,4.0,v237
M v[32:35],a[224:227],a[192:195],v[32:35]
s_waitcnt lgkmcnt(6)
ds_read_b128 a[220:223],v250 offset:1792
ds_read_b128 a[192:195],v250 offset:2048
v_fma_f32 v237,2.0,v157,v238
v_fma_f32 v157,s41,v157,v238
v_cvt_pk_bf16_f32 v232,v232,v237
v_cvt_pk_bf16_f32 v234,v234,v236
M v[36:39],a[224:227],a[196:199],v[36:39]
s_waitcnt lgkmcnt(6)
s_add_u32 s47,s80,3072
v_accvgpr_read_b32 v238,a62
v_accvgpr_read_b32 v233,a158
v_add_f32 v235,v238,v233
v_sub_f32 v238,v238,v233
M v[40:43],a[224:227],a[200:203],v[40:43]
s_waitcnt lgkmcnt(5)
v_add_f32 v233,v62,v158
v_sub_f32 v158,v62,v158
v_add_f32 v62,v235,v233
v_fmac_f32 v235,4.0,v233
M v[44:47],a[224:227],a[204:207],v[44:47]
s_waitcnt lgkmcnt(4)
v_fma_f32 v233,2.0,v158,v238
v_fma_f32 v158,s41,v158,v238
v_accvgpr_read_b32 v238,a63
v_accvgpr_read_b32 v237,a159
M v[48:51],a[224:227],a[208:211],v[48:51]
s_waitcnt lgkmcnt(3)
v_add_f32 v236,v238,v237
v_sub_f32 v238,v238,v237
v_add_f32 v237,v63,v159
v_sub_f32 v159,v63,v159
M v[52:55],a[224:227],a[212:215],v[52:55]
s_waitcnt lgkmcnt(2)
v_add_f32 v63,v236,v237
v_fmac_f32 v236,4.0,v237
M v[56:59],a[224:227],a[216:219],v[56:59]
s_waitcnt lgkmcnt(1)
v_fma_f32 v237,2.0,v159,v238
v_fma_f32 v159,s41,v159,v238
M v[60:63],a[224:227],a[220:223],v[60:63]
s_waitcnt vmcnt(16)
buffer_load_dwordx4 a[224:227],v251,s[20:23],s47 offen offset:0 sc1
M v[32:35],a[228:231],a[196:199],v[32:35]
ds_read_b128 a[196:199],v249 offset:2304
v_cvt_pk_bf16_f32 v233,v233,v237
M v[36:39],a[228:231],a[200:203],v[36:39]
v_cvt_pk_bf16_f32 v235,v235,v236
M v[40:43],a[228:231],a[204:207],v[40:43]
ds_write2st64_b64 v253,v[232:233],v[234:235] offset0:42 offset1:46
M v[44:47],a[228:231],a[208:211],v[44:47]
v_cvt_pk_bf16_f32 v96,v96,v97
v_cvt_pk_bf16_f32 v97,v98,v99
M v[48:51],a[228:231],a[212:215],v[48:51]
v_cvt_pk_bf16_f32 v100,v100,v101
v_cvt_pk_bf16_f32 v101,v102,v103
M v[52:55],a[228:231],a[216:219],v[52:55]
ds_write2st64_b64 v253,v[96:97],v[100:101] offset0:51 offset1:55
M v[56:59],a[228:231],a[220:223],v[56:59]
s_waitcnt lgkmcnt(3)
v_cvt_pk_bf16_f32 v104,v104,v105
v_cvt_pk_bf16_f32 v105,v106,v107
M v[60:63],a[228:231],a[192:195],v[60:63]
s_waitcnt vmcnt(16)
buffer_load_dwordx4 a[228:231],v251,s[20:23],s47 offen offset:1024 sc1
M v[32:35],a[232:235],a[200:203],v[32:35]
ds_read_b128 a[200:203],v249 offset:34816
v_cvt_pk_bf16_f32 v108,v108,v109
M v[36:39],a[232:235],a[204:207],v[36:39]
ds_read_b128 a[204:207],v250 offset:35072
v_cvt_pk_bf16_f32 v109,v110,v111
M v[40:43],a[232:235],a[208:211],v[40:43]
ds_read_b128 a[208:211],v250 offset:35328
ds_write2st64_b64 v253,v[104:105],v[108:109] offset0:59 offset1:63
M v[44:47],a[232:235],a[212:215],v[44:47]
ds_read_b128 a[212:215],v250 offset:35584
v_cvt_pk_bf16_f32 v112,v112,v113
M v[48:51],a[232:235],a[216:219],v[48:51]
ds_read_b128 a[216:219],v250 offset:35840
v_cvt_pk_bf16_f32 v113,v114,v115
M v[52:55],a[232:235],a[220:223],v[52:55]
ds_read_b128 a[220:223],v250 offset:36096
v_cvt_pk_bf16_f32 v116,v116,v117
M v[56:59],a[232:235],a[192:195],v[56:59]
s_waitcnt lgkmcnt(9)
ds_read_b128 a[192:195],v250 offset:36352
v_cvt_pk_bf16_f32 v117,v118,v119
M v[60:63],a[232:235],a[196:199],v[60:63]
s_waitcnt vmcnt(16) lgkmcnt(7)
buffer_load_dwordx4 a[232:235],v251,s[20:23],s47 offen offset:2048 sc1
M v[32:35],a[236:239],a[200:203],v[32:35]
s_waitcnt lgkmcnt(6)
ds_read_b128 a[196:199],v250 offset:36608
ds_read_b128 a[200:203],v250 offset:36864
M v[36:39],a[236:239],a[204:207],v[36:39]
s_waitcnt lgkmcnt(7)
s_add_u32 s47,s81,3072
ds_write2st64_b64 v253,v[112:113],v[116:117] offset0:0 offset1:4
M v[40:43],a[236:239],a[208:211],v[40:43]
s_waitcnt lgkmcnt(6)
v_cvt_pk_bf16_f32 v120,v120,v121
v_cvt_pk_bf16_f32 v121,v122,v123
M v[44:47],a[236:239],a[212:215],v[44:47]
s_waitcnt lgkmcnt(5)
v_cvt_pk_bf16_f32 v124,v124,v125
v_cvt_pk_bf16_f32 v125,v126,v127
M v[48:51],a[236:239],a[216:219],v[48:51]
s_waitcnt lgkmcnt(4)
ds_write2st64_b64 v253,v[120:121],v[124:125] offset0:8 offset1:12
M v[52:55],a[236:239],a[220:223],v[52:55]
s_waitcnt lgkmcnt(4)
v_accvgpr_read_b32 v238,a64
v_accvgpr_read_b32 v232,a160
M v[56:59],a[236:239],a[192:195],v[56:59]
s_waitcnt lgkmcnt(3)
v_add_f32 v234,v238,v232
v_sub_f32 v238,v238,v232
M v[60:63],a[236:239],a[196:199],v[60:63]
s_waitcnt vmcnt(16)
buffer_load_dwordx4 a[236:239],v251,s[20:23],s47 offen offset:0 sc1
M v[32:35],a[240:243],a[204:207],v[32:35]
ds_read_b128 a[204:207],v249 offset:37120
v_add_f32 v232,v64,v160
M v[36:39],a[240:243],a[208:211],v[36:39]
v_sub_f32 v160,v64,v160
M v[40:43],a[240:243],a[212:215],v[40:43]
s_waitcnt lgkmcnt(1)
s_barrier
ds_read_b128 a[56:59],v251 offset:17408
M v[44:47],a[240:243],a[216:219],v[44:47]
ds_read_b128 a[60:63],v251 offset:21504
ds_read_b128 a[112:115],v251 offset:26112
M v[48:51],a[240:243],a[220:223],v[48:51]
ds_read_b128 a[116:119],v251 offset:30208
ds_read_b128 a[120:123],v251 offset:0
M v[52:55],a[240:243],a[192:195],v[52:55]
ds_read_b128 a[124:127],v251 offset:4096
v_add_f32 v64,v234,v232
M v[56:59],a[240:243],a[196:199],v[56:59]
v_fmac_f32 v234,4.0,v232
v_fma_f32 v232,2.0,v160,v238
M v[60:63],a[240:243],a[200:203],v[60:63]
s_waitcnt vmcnt(16)
s_add_u32 s34,s32,7471104
buffer_load_dwordx4 a[240:243],v251,s[20:23],s47 offen offset:1024 sc1
M v[32:35],a[244:247],a[208:211],v[32:35]
s_waitcnt lgkmcnt(5)
buffer_store_dwordx4 a[56:59],v252,s[24:27],s34 offen offset:512 nt
M v[36:39],a[244:247],a[212:215],v[36:39]
s_waitcnt lgkmcnt(4)
s_add_u32 s34,s32,7667712
buffer_store_dwordx4 a[60:63],v252,s[24:27],s34 offen offset:512 nt
M v[40:43],a[244:247],a[216:219],v[40:43]
s_waitcnt lgkmcnt(3)
s_add_u32 s34,s33,6291456
buffer_store_dwordx4 a[112:115],v252,s[24:27],s34 offen offset:1152 nt
M v[44:47],a[244:247],a[220:223],v[44:47]
s_waitcnt lgkmcnt(2)
s_add_u32 s34,s33,6684672
buffer_store_dwordx4 a[116:119],v252,s[24:27],s34 offen offset:1152 nt
ds_read_b128 a[208:211],v249 offset:52224
M v[48:51],a[244:247],a[192:195],v[48:51]
ds_read_b128 a[212:215],v250 offset:52480
ds_read_b128 a[216:219],v250 offset:52736
M v[52:55],a[244:247],a[196:199],v[52:55]
ds_read_b128 a[220:223],v250 offset:52992
ds_read_b128 a[192:195],v250 offset:53248
M v[56:59],a[244:247],a[200:203],v[56:59]
ds_read_b128 a[196:199],v250 offset:53504
ds_read_b128 a[200:203],v250 offset:53760
M v[60:63],a[244:247],a[204:207],v[60:63]
s_waitcnt vmcnt(20) lgkmcnt(6)
buffer_load_dwordx4 a[244:247],v251,s[20:23],s47 offen offset:2048 sc1
M v[32:35],a[248:251],a[208:211],v[32:35]
s_waitcnt lgkmcnt(5)
ds_read_b128 a[204:207],v250 offset:54016
ds_read_b128 a[208:211],v250 offset:54272
M v[36:39],a[248:251],a[212:215],v[36:39]
s_waitcnt lgkmcnt(6)
s_add_u32 s47,s76,49152
v_fma_f32 v160,s41,v160,v238
v_accvgpr_read_b32 v238,a65
M v[40:43],a[248:251],a[216:219],v[40:43]
s_waitcnt lgkmcnt(5)
v_accvgpr_read_b32 v237,a161
v_add_f32 v236,v238,v237
M v[44:47],a[248:251],a[220:223],v[44:47]
s_waitcnt lgkmcnt(4)
v_sub_f32 v238,v238,v237
v_add_f32 v237,v65,v161
M v[48:51],a[248:251],a[192:195],v[48:51]
s_waitcnt lgkmcnt(3)
v_sub_f32 v161,v65,v161
v_add_f32 v65,v236,v237
M v[52:55],a[248:251],a[196:199],v[52:55]
s_waitcnt lgkmcnt(2)
v_fmac_f32 v236,4.0,v237
v_fma_f32 v237,2.0,v161,v238
M v[56:59],a[248:251],a[200:203],v[56:59]
s_waitcnt lgkmcnt(1)
v_fma_f32 v161,s41,v161,v238
v_cvt_pk_bf16_f32 v232,v232,v237
M v[60:63],a[248:251],a[204:207],v[60:63]
s_waitcnt vmcnt(20)
buffer_load_dwordx4 a[248:251],v251,s[20:23],s47 offen offset:0 sc1
M v[32:35],a[252:255],a[212:215],v[32:35]
ds_read_b128 a[212:215],v249 offset:54528
v_cvt_pk_bf16_f32 v234,v234,v236
M v[36:39],a[252:255],a[216:219],v[36:39]
v_accvgpr_read_b32 v238,a66
v_accvgpr_read_b32 v233,a162
M v[40:43],a[252:255],a[220:223],v[40:43]
v_add_f32 v235,v238,v233
v_sub_f32 v238,v238,v233
M v[44:47],a[252:255],a[192:195],v[44:47]
s_add_u32 s34,s33,7077888
buffer_store_dwordx4 a[120:123],v252,s[24:27],s34 offen offset:1152 nt
M v[48:51],a[252:255],a[196:199],v[48:51]
v_add_f32 v233,v66,v162
v_sub_f32 v162,v66,v162
M v[52:55],a[252:255],a[200:203],v[52:55]
v_add_u32 v249,0x11000,v249
v_add_u32 v250,0x11000,v250
M v[56:59],a[252:255],a[204:207],v[56:59]
s_waitcnt lgkmcnt(1)
v_add_f32 v66,v235,v233
v_fmac_f32 v235,4.0,v233
M v[60:63],a[252:255],a[208:211],v[60:63]
s_waitcnt vmcnt(21)
buffer_load_dwordx4 a[252:255],v251,s[20:23],s47 offen offset:1024 sc1
M v[32:35],v[216:219],a[216:219],v[32:35]
ds_read_b128 a[216:219],v249 offset:0
v_fma_f32 v233,2.0,v162,v238
M v[36:39],v[216:219],a[220:223],v[36:39]
ds_read_b128 a[220:223],v250 offset:256
v_fma_f32 v162,s41,v162,v238
M v[40:43],v[216:219],a[192:195],v[40:43]
ds_read_b128 a[192:195],v250 offset:512
v_accvgpr_read_b32 v238,a67
M v[44:47],v[216:219],a[196:199],v[44:47]
ds_read_b128 a[196:199],v250 offset:768
v_accvgpr_read_b32 v237,a163
M v[48:51],v[216:219],a[200:203],v[48:51]
ds_read_b128 a[200:203],v250 offset:1024
v_add_f32 v236,v238,v237
M v[52:55],v[216:219],a[204:207],v[52:55]
ds_read_b128 a[204:207],v250 offset:1280
v_sub_f32 v238,v238,v237
M v[56:59],v[216:219],a[208:211],v[56:59]
s_waitcnt lgkmcnt(6)
ds_read_b128 a[208:211],v250 offset:1536
v_add_f32 v237,v67,v163
M v[60:63],v[216:219],a[212:215],v[60:63]
s_waitcnt vmcnt(15) lgkmcnt(6)
buffer_load_dwordx4 v[216:219],v251,s[20:23],s47 offen offset:2048 sc1
M v[32:35],v[220:223],a[216:219],v[32:35]
s_waitcnt lgkmcnt(5)
ds_read_b128 a[212:215],v250 offset:1792
ds_read_b128 a[216:219],v250 offset:2048
M v[36:39],v[220:223],a[220:223],v[36:39]
s_waitcnt lgkmcnt(6)
s_add_u32 s47,s77,49152
v_sub_f32 v163,v67,v163
v_add_f32 v67,v236,v237
M v[40:43],v[220:223],a[192:195],v[40:43]
s_waitcnt lgkmcnt(5)
v_fmac_f32 v236,4.0,v237
v_fma_f32 v237,2.0,v163,v238
M v[44:47],v[220:223],a[196:199],v[44:47]
s_waitcnt lgkmcnt(4)
v_fma_f32 v163,s41,v163,v238
v_cvt_pk_bf16_f32 v233,v233,v237
M v[48:51],v[220:223],a[200:203],v[48:51]
s_waitcnt lgkmcnt(3)
v_cvt_pk_bf16_f32 v235,v235,v236
M v[52:55],v[220:223],a[204:207],v[52:55]
s_waitcnt lgkmcnt(2)
ds_write2st64_b64 v253,v[232:233],v[234:235] offset0:17 offset1:21
M v[56:59],v[220:223],a[208:211],v[56:59]
s_waitcnt lgkmcnt(2)
v_accvgpr_read_b32 v238,a68
v_accvgpr_read_b32 v232,a164
M v[60:63],v[220:223],a[212:215],v[60:63]
s_waitcnt vmcnt(15)
buffer_load_dwordx4 v[220:223],v251,s[20:23],s47 offen offset:0 sc1
M v[32:35],v[224:227],a[220:223],v[32:35]
ds_read_b128 a[220:223],v249 offset:2304
v_add_f32 v234,v238,v232
M v[36:39],v[224:227],a[192:195],v[36:39]
v_sub_f32 v238,v238,v232
v_add_f32 v232,v68,v164
M v[40:43],v[224:227],a[196:199],v[40:43]
s_add_u32 s34,s33,7471104
buffer_store_dwordx4 a[124:127],v252,s[24:27],s34 offen offset:1152 nt
M v[44:47],v[224:227],a[200:203],v[44:47]
v_sub_f32 v164,v68,v164
v_add_f32 v68,v234,v232
M v[48:51],v[224:227],a[204:207],v[48:51]
v_fmac_f32 v234,4.0,v232
v_fma_f32 v232,2.0,v164,v238
M v[52:55],v[224:227],a[208:211],v[52:55]
v_fma_f32 v164,s41,v164,v238
v_accvgpr_read_b32 v238,a69
M v[56:59],v[224:227],a[212:215],v[56:59]
s_waitcnt lgkmcnt(2)
v_accvgpr_read_b32 v237,a165
v_add_f32 v236,v238,v237
M v[60:63],v[224:227],a[216:219],v[60:63]
s_waitcnt vmcnt(16)
buffer_load_dwordx4 v[224:227],v251,s[20:23],s47 offen offset:1024 sc1
M v[32:35],v[228:231],a[192:195],v[32:35]
ds_read_b128 a[192:195],v249 offset:17408
v_sub_f32 v238,v238,v237
M v[36:39],v[228:231],a[196:199],v[36:39]
ds_read_b128 a[196:199],v250 offset:17664
v_add_f32 v237,v69,v165
M v[40:43],v[228:231],a[200:203],v[40:43]
ds_read_b128 a[200:203],v250 offset:17920
v_sub_f32 v165,v69,v165
M v[44:47],v[228:231],a[204:207],v[44:47]
ds_read_b128 a[204:207],v250 offset:18176
v_add_f32 v69,v236,v237
M v[48:51],v[228:231],a[208:211],v[48:51]
ds_read_b128 a[208:211],v250 offset:18432
v_fmac_f32 v236,4.0,v237
M v[52:55],v[228:231],a[212:215],v[52:55]
ds_read_b128 a[212:215],v250 offset:18688
v_fma_f32 v237,2.0,v165,v238
M v[56:59],v[228:231],a[216:219],v[56:59]
s_waitcnt lgkmcnt(6)
ds_read_b128 a[216:219],v250 offset:18944
v_fma_f32 v165,s41,v165,v238
M v[60:63],v[228:231],a[220:223],v[60:63]
s_waitcnt vmcnt(16) lgkmcnt(6)
buffer_load_dwordx4 v[228:231],v251,s[20:23],s47 offen offset:2048 sc1
M v[32:35],a[224:227],a[192:195],v[32:35]
s_waitcnt lgkmcnt(5)
ds_read_b128 a[220:223],v250 offset:19200
ds_read_b128 a[192:195],v250 offset:19456
M v[36:39],a[224:227],a[196:199],v[36:39]
s_waitcnt lgkmcnt(6)
s_add_u32 s47,s78,49152
v_cvt_pk_bf16_f32 v232,v232,v237
v_cvt_pk_bf16_f32 v234,v234,v236
M v[40:43],a[224:227],a[200:203],v[40:43]
s_waitcnt lgkmcnt(5)
v_accvgpr_read_b32 v238,a70
v_accvgpr_read_b32 v233,a166
M v[44:47],a[224:227],a[204:207],v[44:47]
s_waitcnt lgkmcnt(4)
v_add_f32 v235,v238,v233
v_sub_f32 v238,v238,v233
M v[48:51],a[224:227],a[208:211],v[48:51]
s_waitcnt lgkmcnt(3)
v_add_f32 v233,v70,v166
v_sub_f32 v166,v70,v166
M v[52:55],a[224:227],a[212:215],v[52:55]
s_waitcnt lgkmcnt(2)
v_add_f32 v70,v235,v233
v_fmac_f32 v235,4.0,v233
M v[56:59],a[224:227],a[216:219],v[56:59]
s_waitcnt lgkmcnt(1)
v_fma_f32 v233,2.0,v166,v238
v_fma_f32 v166,s41,v166,v238
M v[60:63],a[224:227],a[220:223],v[60:63]
s_waitcnt vmcnt(16)
buffer_load_dwordx4 a[224:227],v251,s[20:23],s47 offen offset:0 sc1
M v[32:35],a[228:231],a[196:199],v[32:35]
ds_read_b128 a[196:199],v249 offset:19712
v_accvgpr_read_b32 v238,a71
M v[36:39],a[228:231],a[200:203],v[36:39]
v_accvgpr_read_b32 v237,a167
v_add_f32 v236,v238,v237
M v[40:43],a[228:231],a[204:207],v[40:43]
v_sub_f32 v238,v238,v237
v_add_f32 v237,v71,v167
M v[44:47],a[228:231],a[208:211],v[44:47]
v_sub_f32 v167,v71,v167
v_add_f32 v71,v236,v237
M v[48:51],a[228:231],a[212:215],v[48:51]
v_fmac_f32 v236,4.0,v237
v_fma_f32 v237,2.0,v167,v238
M v[52:55],a[228:231],a[216:219],v[52:55]
v_add_u32 v249,0xffff1200,v249
v_add_u32 v250,0xffff1200,v250
M v[56:59],a[228:231],a[220:223],v[56:59]
s_waitcnt lgkmcnt(1)
v_fma_f32 v167,s41,v167,v238
v_cvt_pk_bf16_f32 v233,v233,v237
M v[60:63],a[228:231],a[192:195],v[60:63]
s_waitcnt vmcnt(16)
buffer_load_dwordx4 a[228:231],v251,s[20:23],s47 offen offset:1024 sc1
M v[32:35],a[232:235],a[200:203],v[32:35]
ds_read_b128 a[200:203],v249 offset:8704
v_cvt_pk_bf16_f32 v235,v235,v236
M v[36:39],a[232:235],a[204:207],v[36:39]
ds_read_b128 a[204:207],v250 offset:8960
ds_write2st64_b64 v253,v[232:233],v[234:235] offset0:25 offset1:29
M v[40:43],a[232:235],a[208:211],v[40:43]
ds_read_b128 a[208:211],v250 offset:9216
v_accvgpr_read_b32 v238,a72
M v[44:47],a[232:235],a[212:215],v[44:47]
ds_read_b128 a[212:215],v250 offset:9472
v_accvgpr_read_b32 v232,a168
M v[48:51],a[232:235],a[216:219],v[48:51]
ds_read_b128 a[216:219],v250 offset:9728
v_add_f32 v234,v238,v232
M v[52:55],a[232:235],a[220:223],v[52:55]
ds_read_b128 a[220:223],v250 offset:9984
v_sub_f32 v238,v238,v232
M v[56:59],a[232:235],a[192:195],v[56:59]
s_waitcnt lgkmcnt(7)
ds_read_b128 a[192:195],v250 offset:10240
v_add_f32 v232,v72,v168
M v[60:63],a[232:235],a[196:199],v[60:63]
s_waitcnt vmcnt(16) lgkmcnt(7)
buffer_load_dwordx4 a[232:235],v251,s[20:23],s47 offen offset:2048 sc1
M v[32:35],a[236:239],a[200:203],v[32:35]
s_waitcnt lgkmcnt(6)
ds_read_b128 a[196:199],v250 offset:10496
ds_read_b128 a[200:203],v250 offset:10752
M v[36:39],a[236:239],a[204:207],v[36:39]
s_waitcnt lgkmcnt(6)
s_add_u32 s47,s79,49152
v_sub_f32 v168,v72,v168
v_add_f32 v72,v234,v232
M v[40:43],a[236:239],a[208:211],v[40:43]
s_waitcnt lgkmcnt(5)
v_fmac_f32 v234,4.0,v232
v_fma_f32 v232,2.0,v168,v238
M v[44:47],a[236:239],a[212:215],v[44:47]
s_waitcnt lgkmcnt(4)
v_fma_f32 v168,s41,v168,v238
v_accvgpr_read_b32 v238,a73
M v[48:51],a[236:239],a[216:219],v[48:51]
s_waitcnt lgkmcnt(3)
v_accvgpr_read_b32 v237,a169
v_add_f32 v236,v238,v237
M v[52:55],a[236:239],a[220:223],v[52:55]
s_waitcnt lgkmcnt(2)
v_sub_f32 v238,v238,v237
v_add_f32 v237,v73,v169
M v[56:59],a[236:239],a[192:195],v[56:59]
s_waitcnt lgkmcnt(1)
v_sub_f32 v169,v73,v169
v_add_f32 v73,v236,v237
M v[60:63],a[236:239],a[196:199],v[60:63]
s_waitcnt vmcnt(16)
buffer_load_dwordx4 a[236:239],v251,s[20:23],s47 offen offset:0 sc1
M v[32:35],a[240:243],a[204:207],v[32:35]
ds_read_b128 a[204:207],v249 offset:11008
v_fmac_f32 v236,4.0,v237
M v[36:39],a[240:243],a[208:211],v[36:39]
v_fma_f32 v237,2.0,v169,v238
v_fma_f32 v169,s41,v169,v238
M v[40:43],a[240:243],a[212:215],v[40:43]
v_cvt_pk_bf16_f32 v232,v232,v237
v_cvt_pk_bf16_f32 v234,v234,v236
M v[44:47],a[240:243],a[216:219],v[44:47]
v_accvgpr_read_b32 v238,a74
v_accvgpr_read_b32 v233,a170
M v[48:51],a[240:243],a[220:223],v[48:51]
v_add_f32 v235,v238,v233
v_sub_f32 v238,v238,v233
M v[52:55],a[240:243],a[192:195],v[52:55]
v_add_f32 v233,v74,v170
v_sub_f32 v170,v74,v170
M v[56:59],a[240:243],a[196:199],v[56:59]
s_waitcnt lgkmcnt(1)
v_add_f32 v74,v235,v233
v_fmac_f32 v235,4.0,v233
M v[60:63],a[240:243],a[200:203],v[60:63]
s_waitcnt vmcnt(12)
buffer_load_dwordx4 a[240:243],v251,s[20:23],s47 offen offset:1024 sc1
M v[32:35],a[244:247],a[208:211],v[32:35]
ds_read_b128 a[208:211],v249 offset:0
v_fma_f32 v233,2.0,v170,v238
M v[36:39],a[244:247],a[212:215],v[36:39]
ds_read_b128 a[212:215],v250 offset:256
v_fma_f32 v170,s41,v170,v238
M v[40:43],a[244:247],a[216:219],v[40:43]
ds_read_b128 a[216:219],v250 offset:512
v_accvgpr_read_b32 v238,a75
M v[44:47],a[244:247],a[220:223],v[44:47]
ds_read_b128 a[220:223],v250 offset:768
v_accvgpr_read_b32 v237,a171
M v[48:51],a[244:247],a[192:195],v[48:51]
ds_read_b128 a[192:195],v250 offset:1024
v_add_f32 v236,v238,v237
M v[52:55],a[244:247],a[196:199],v[52:55]
ds_read_b128 a[196:199],v250 offset:1280
v_sub_f32 v238,v238,v237
M v[56:59],a[244:247],a[200:203],v[56:59]
s_waitcnt lgkmcnt(6)
ds_read_b128 a[200:203],v250 offset:1536
v_add_f32 v237,v75,v171
M v[60:63],a[244:247],a[204:207],v[60:63]
s_waitcnt vmcnt(12) lgkmcnt(6)
buffer_load_dwordx4 a[244:247],v251,s[20:23],s47 offen offset:2048 sc1
M v[128:131],a[248:251],a[208:211],v[128:131]
s_waitcnt lgkmcnt(5)
ds_read_b128 a[204:207],v250 offset:1792
ds_read_b128 a[208:211],v250 offset:2048
M v[132:135],a[248:251],a[212:215],v[132:135]
s_waitcnt lgkmcnt(6)
s_add_u32 s47,s80,49152
v_sub_f32 v171,v75,v171
v_add_f32 v75,v236,v237
M v[136:139],a[248:251],a[216:219],v[136:139]
s_waitcnt lgkmcnt(5)
v_fmac_f32 v236,4.0,v237
v_fma_f32 v237,2.0,v171,v238
M v[140:143],a[248:251],a[220:223],v[140:143]
s_waitcnt lgkmcnt(4)
v_fma_f32 v171,s41,v171,v238
v_cvt_pk_bf16_f32 v233,v233,v237
M v[144:147],a[248:251],a[192:195],v[144:147]
s_waitcnt lgkmcnt(3)
v_cvt_pk_bf16_f32 v235,v235,v236
M v[148:151],a[248:251],a[196:199],v[148:151]
s_waitcnt lgkmcnt(2)
ds_write2st64_b64 v253,v[232:233],v[234:235] offset0:68 offset1:72
M v[152:155],a[248:251],a[200:203],v[152:155]
s_waitcnt lgkmcnt(2)
v_accvgpr_read_b32 v238,a76
v_accvgpr_read_b32 v232,a172
M v[156:159],a[248:251],a[204:207],v[156:159]
s_waitcnt vmcnt(11)
buffer_load_dwordx4 a[248:251],v251,s[20:23],s47 offen offset:0 sc1
M v[128:131],a[252:255],a[212:215],v[128:131]
ds_read_b128 a[212:215],v249 offset:2304
v_add_f32 v234,v238,v232
M v[132:135],a[252:255],a[216:219],v[132:135]
v_sub_f32 v238,v238,v232
v_add_f32 v232,v76,v172
M v[136:139],a[252:255],a[220:223],v[136:139]
v_sub_f32 v172,v76,v172
v_add_f32 v76,v234,v232
M v[140:143],a[252:255],a[192:195],v[140:143]
v_fmac_f32 v234,4.0,v232
v_fma_f32 v232,2.0,v172,v238
M v[144:147],a[252:255],a[196:199],v[144:147]
v_fma_f32 v172,s41,v172,v238
v_accvgpr_read_b32 v238,a77
M v[148:151],a[252:255],a[200:203],v[148:151]
v_accvgpr_read_b32 v237,a173
v_add_f32 v236,v238,v237
M v[152:155],a[252:255],a[204:207],v[152:155]
s_waitcnt lgkmcnt(2)
v_sub_f32 v238,v238,v237
v_add_f32 v237,v77,v173
M v[156:159],a[252:255],a[208:211],v[156:159]
s_waitcnt vmcnt(11)
buffer_load_dwordx4 a[252:255],v251,s[20:23],s47 offen offset:1024 sc1
M v[128:131],v[216:219],a[216:219],v[128:131]
ds_read_b128 a[216:219],v249 offset:34816
v_sub_f32 v173,v77,v173
M v[132:135],v[216:219],a[220:223],v[132:135]
ds_read_b128 a[220:223],v250 offset:35072
v_add_f32 v77,v236,v237
M v[136:139],v[216:219],a[192:195],v[136:139]
ds_read_b128 a[192:195],v250 offset:35328
v_fmac_f32 v236,4.0,v237
M v[140:143],v[216:219],a[196:199],v[140:143]
ds_read_b128 a[196:199],v250 offset:35584
v_fma_f32 v237,2.0,v173,v238
M v[144:147],v[216:219],a[200:203],v[144:147]
ds_read_b128 a[200:203],v250 offset:35840
v_fma_f32 v173,s41,v173,v238
M v[148:151],v[216:219],a[204:207],v[148:151]
ds_read_b128 a[204:207],v250 offset:36096
v_cvt_pk_bf16_f32 v232,v232,v237
M v[152:155],v[216:219],a[208:211],v[152:155]
s_waitcnt lgkmcnt(6)
ds_read_b128 a[208:211],v250 offset:36352
v_cvt_pk_bf16_f32 v234,v234,v236
M v[156:159],v[216:219],a[212:215],v[156:159]
s_waitcnt vmcnt(11) lgkmcnt(6)
buffer_load_dwordx4 v[216:219],v251,s[20:23],s47 offen offset:2048 sc1
M v[128:131],v[220:223],a[216:219],v[128:131]
s_waitcnt lgkmcnt(5)
ds_read_b128 a[212:215],v250 offset:36608
ds_read_b128 a[216:219],v250 offset:36864
M v[132:135],v[220:223],a[220:223],v[132:135]
s_waitcnt lgkmcnt(6)
s_add_u32 s47,s81,49152
v_accvgpr_read_b32 v238,a78
v_accvgpr_read_b32 v233,a174
M v[136:139],v[220:223],a[192:195],v[136:139]
s_waitcnt lgkmcnt(5)
v_add_f32 v235,v238,v233
v_sub_f32 v238,v238,v233
M v[140:143],v[220:223],a[196:199],v[140:143]
s_waitcnt lgkmcnt(4)
v_add_f32 v233,v78,v174
v_sub_f32 v174,v78,v174
M v[144:147],v[220:223],a[200:203],v[144:147]
s_waitcnt lgkmcnt(3)
v_add_f32 v78,v235,v233
v_fmac_f32 v235,4.0,v233
M v[148:151],v[220:223],a[204:207],v[148:151]
s_waitcnt lgkmcnt(2)
v_fma_f32 v233,2.0,v174,v238
v_fma_f32 v174,s41,v174,v238
M v[152:155],v[220:223],a[208:211],v[152:155]
s_waitcnt lgkmcnt(1)
v_accvgpr_read_b32 v238,a79
v_accvgpr_read_b32 v237,a175
M v[156:159],v[220:223],a[212:215],v[156:159]
s_waitcnt vmcnt(10)
buffer_load_dwordx4 v[220:223],v251,s[20:23],s47 offen offset:0 sc1
M v[128:131],v[224:227],a[220:223],v[128:131]
ds_read_b128 a[220:223],v249 offset:37120
v_add_f32 v236,v238,v237
M v[132:135],v[224:227],a[192:195],v[132:135]
v_sub_f32 v238,v238,v237
v_add_f32 v237,v79,v175
M v[136:139],v[224:227],a[196:199],v[136:139]
v_sub_f32 v175,v79,v175
v_add_f32 v79,v236,v237
M v[140:143],v[224:227],a[200:203],v[140:143]
v_fmac_f32 v236,4.0,v237
v_fma_f32 v237,2.0,v175,v238
M v[144:147],v[224:227],a[204:207],v[144:147]
v_fma_f32 v175,s41,v175,v238
v_cvt_pk_bf16_f32 v233,v233,v237
M v[148:151],v[224:227],a[208:211],v[148:151]
v_cvt_pk_bf16_f32 v235,v235,v236
M v[152:155],v[224:227],a[212:215],v[152:155]
s_waitcnt lgkmcnt(1)
ds_write2st64_b64 v253,v[232:233],v[234:235] offset0:76 offset1:80
M v[156:159],v[224:227],a[216:219],v[156:159]
s_waitcnt vmcnt(10)
buffer_load_dwordx4 v[224:227],v251,s[20:23],s47 offen offset:1024 sc1
M v[128:131],v[228:231],a[192:195],v[128:131]
ds_read_b128 a[192:195],v249 offset:52224
v_cvt_pk_bf16_f32 v32,v32,v33
M v[132:135],v[228:231],a[196:199],v[132:135]
ds_read_b128 a[196:199],v250 offset:52480
v_cvt_pk_bf16_f32 v33,v34,v35
M v[136:139],v[228:231],a[200:203],v[136:139]
ds_read_b128 a[200:203],v250 offset:52736
v_cvt_pk_bf16_f32 v36,v36,v37
M v[140:143],v[228:231],a[204:207],v[140:143]
ds_read_b128 a[204:207],v250 offset:52992
v_cvt_pk_bf16_f32 v37,v38,v39
M v[144:147],v[228:231],a[208:211],v[144:147]
s_waitcnt lgkmcnt(4)
s_barrier
ds_read_b128 a[64:67],v251 offset:8704
M v[148:151],v[228:231],a[212:215],v[148:151]
ds_read_b128 a[68:71],v251 offset:12800
ds_read_b128 a[72:75],v251 offset:34816
M v[152:155],v[228:231],a[216:219],v[152:155]
ds_read_b128 a[76:79],v251 offset:38912
ds_read_b128 a[208:211],v250 offset:53248
M v[156:159],v[228:231],a[220:223],v[156:159]
s_waitcnt vmcnt(10) lgkmcnt(8)
buffer_load_dwordx4 v[228:231],v251,s[20:23],s47 offen offset:2048 sc1
M v[128:131],a[224:227],a[192:195],v[128:131]
s_waitcnt lgkmcnt(7)
ds_read_b128 a[212:215],v250 offset:53504
ds_read_b128 a[216:219],v250 offset:53760
M v[132:135],a[224:227],a[196:199],v[132:135]
s_waitcnt lgkmcnt(6)
s_add_u32 s34,s32,6291456
buffer_store_dwordx4 a[64:67],v252,s[24:27],s34 offen offset:640 nt
M v[136:139],a[224:227],a[200:203],v[136:139]
s_waitcnt lgkmcnt(5)
s_add_u32 s34,s32,6488064
buffer_store_dwordx4 a[68:71],v252,s[24:27],s34 offen offset:640 nt
ds_read_b128 a[220:223],v250 offset:54016
M v[140:143],a[224:227],a[204:207],v[140:143]
s_waitcnt lgkmcnt(3)
s_add_u32 s34,s32,6684672
buffer_store_dwordx4 a[72:75],v252,s[24:27],s34 offen offset:640 nt
M v[144:147],a[224:227],a[208:211],v[144:147]
s_waitcnt lgkmcnt(2)
s_add_u32 s34,s32,6881280
buffer_store_dwordx4 a[76:79],v252,s[24:27],s34 offen offset:640 nt
M v[148:151],a[224:227],a[212:215],v[148:151]
s_waitcnt lgkmcnt(1)
s_add_u32 s48,s76,6144
ds_read_b128 a[192:195],v250 offset:54272
ds_write2st64_b64 v253,v[32:33],v[36:37] offset0:34 offset1:38
M v[152:155],a[224:227],a[216:219],v[152:155]
s_waitcnt lgkmcnt(2)
v_cvt_pk_bf16_f32 v40,v40,v41
v_cvt_pk_bf16_f32 v41,v42,v43
M v[156:159],a[224:227],a[220:223],v[156:159]
s_waitcnt vmcnt(14)
buffer_load_dwordx4 a[224:227],v251,s[20:23],s48 offen offset:0 sc1
M v[128:131],a[228:231],a[196:199],v[128:131]
ds_read_b128 a[196:199],v249 offset:54528
v_cvt_pk_bf16_f32 v44,v44,v45
M v[132:135],a[228:231],a[200:203],v[132:135]
v_cvt_pk_bf16_f32 v45,v46,v47
M v[136:139],a[228:231],a[204:207],v[136:139]
ds_write2st64_b64 v253,v[40:41],v[44:45] offset0:42 offset1:46
M v[140:143],a[228:231],a[208:211],v[140:143]
v_cvt_pk_bf16_f32 v48,v48,v49
v_cvt_pk_bf16_f32 v49,v50,v51
M v[144:147],a[228:231],a[212:215],v[144:147]
v_cvt_pk_bf16_f32 v52,v52,v53
v_cvt_pk_bf16_f32 v53,v54,v55
M v[148:151],a[228:231],a[216:219],v[148:151]
ds_write2st64_b64 v253,v[48:49],v[52:53] offset0:51 offset1:55
M v[152:155],a[228:231],a[220:223],v[152:155]
s_waitcnt lgkmcnt(4)
v_add_u32 v249,0x11000,v249
v_add_u32 v250,0x11000,v250
M v[156:159],a[228:231],a[192:195],v[156:159]
s_waitcnt vmcnt(14)
buffer_load_dwordx4 a[228:231],v251,s[20:23],s48 offen offset:1024 sc1
M v[128:131],a[232:235],a[200:203],v[128:131]
ds_read_b128 a[200:203],v249 offset:0
v_cvt_pk_bf16_f32 v56,v56,v57
M v[132:135],a[232:235],a[204:207],v[132:135]
ds_read_b128 a[204:207],v250 offset:256
v_cvt_pk_bf16_f32 v57,v58,v59
M v[136:139],a[232:235],a[208:211],v[136:139]
ds_read_b128 a[208:211],v250 offset:512
v_cvt_pk_bf16_f32 v60,v60,v61
M v[140:143],a[232:235],a[212:215],v[140:143]
ds_read_b128 a[212:215],v250 offset:768
v_cvt_pk_bf16_f32 v61,v62,v63
M v[144:147],a[232:235],a[216:219],v[144:147]
ds_read_b128 a[216:219],v250 offset:1024
ds_write2st64_b64 v253,v[56:57],v[60:61] offset0:59 offset1:63
M v[148:151],a[232:235],a[220:223],v[148:151]
ds_read_b128 a[220:223],v250 offset:1280
v_accvgpr_read_b32 v238,a80
M v[152:155],a[232:235],a[192:195],v[152:155]
s_waitcnt lgkmcnt(9)
ds_read_b128 a[192:195],v250 offset:1536
v_accvgpr_read_b32 v232,a176
M v[156:159],a[232:235],a[196:199],v[156:159]
s_waitcnt vmcnt(14) lgkmcnt(7)
buffer_load_dwordx4 a[232:235],v251,s[20:23],s48 offen offset:2048 sc1
M v[128:131],a[236:239],a[200:203],v[128:131]
s_waitcnt lgkmcnt(6)
ds_read_b128 a[196:199],v250 offset:1792
ds_read_b128 a[200:203],v250 offset:2048
M v[132:135],a[236:239],a[204:207],v[132:135]
s_waitcnt lgkmcnt(7)
s_add_u32 s48,s77,6144
v_add_f32 v234,v238,v232
v_sub_f32 v238,v238,v232
M v[136:139],a[236:239],a[208:211],v[136:139]
s_waitcnt lgkmcnt(6)
v_add_f32 v232,v80,v176
v_sub_f32 v176,v80,v176
M v[140:143],a[236:239],a[212:215],v[140:143]
s_waitcnt lgkmcnt(5)
v_add_f32 v80,v234,v232
v_fmac_f32 v234,4.0,v232
M v[144:147],a[236:239],a[216:219],v[144:147]
s_waitcnt lgkmcnt(3)
v_fma_f32 v232,2.0,v176,v238
v_fma_f32 v176,s41,v176,v238
M v[148:151],a[236:239],a[220:223],v[148:151]
s_waitcnt lgkmcnt(2)
v_accvgpr_read_b32 v238,a81
v_accvgpr_read_b32 v237,a177
M v[152:155],a[236:239],a[192:195],v[152:155]
s_waitcnt lgkmcnt(1)
v_add_f32 v236,v238,v237
v_sub_f32 v238,v238,v237
M v[156:159],a[236:239],a[196:199],v[156:159]
s_waitcnt vmcnt(14)
buffer_load_dwordx4 a[236:239],v251,s[20:23],s48 offen offset:0 sc1
M v[128:131],a[240:243],a[204:207],v[128:131]
ds_read_b128 a[204:207],v249 offset:2304
v_add_f32 v237,v81,v177
M v[132:135],a[240:243],a[208:211],v[132:135]
v_sub_f32 v177,v81,v177
v_add_f32 v81,v236,v237
M v[136:139],a[240:243],a[212:215],v[136:139]
v_fmac_f32 v236,4.0,v237
v_fma_f32 v237,2.0,v177,v238
M v[140:143],a[240:243],a[216:219],v[140:143]
v_fma_f32 v177,s41,v177,v238
v_cvt_pk_bf16_f32 v232,v232,v237
M v[144:147],a[240:243],a[220:223],v[144:147]
v_cvt_pk_bf16_f32 v234,v234,v236
v_accvgpr_read_b32 v238,a82
M v[148:151],a[240:243],a[192:195],v[148:151]
v_accvgpr_read_b32 v233,a178
v_add_f32 v235,v238,v233
M v[152:155],a[240:243],a[196:199],v[152:155]
s_waitcnt lgkmcnt(1)
v_sub_f32 v238,v238,v233
v_add_f32 v233,v82,v178
M v[156:159],a[240:243],a[200:203],v[156:159]
s_waitcnt vmcnt(14)
buffer_load_dwordx4 a[240:243],v251,s[20:23],s48 offen offset:1024 sc1
M v[128:131],a[244:247],a[208:211],v[128:131]
ds_read_b128 a[208:211],v249 offset:17408
v_sub_f32 v178,v82,v178
M v[132:135],a[244:247],a[212:215],v[132:135]
ds_read_b128 a[212:215],v250 offset:17664
v_add_f32 v82,v235,v233
M v[136:139],a[244:247],a[216:219],v[136:139]
ds_read_b128 a[216:219],v250 offset:17920
v_fmac_f32 v235,4.0,v233
M v[140:143],a[244:247],a[220:223],v[140:143]
ds_read_b128 a[220:223],v250 offset:18176
v_fma_f32 v233,2.0,v178,v238
M v[144:147],a[244:247],a[192:195],v[144:147]
ds_read_b128 a[192:195],v250 offset:18432
v_fma_f32 v178,s41,v178,v238
M v[148:151],a[244:247],a[196:199],v[148:151]
ds_read_b128 a[196:199],v250 offset:18688
v_accvgpr_read_b32 v238,a83
M v[152:155],a[244:247],a[200:203],v[152:155]
s_waitcnt lgkmcnt(6)
ds_read_b128 a[200:203],v250 offset:18944
v_accvgpr_read_b32 v237,a179
M v[156:159],a[244:247],a[204:207],v[156:159]
s_waitcnt vmcnt(14) lgkmcnt(6)
buffer_load_dwordx4 a[244:247],v251,s[20:23],s48 offen offset:2048 sc1
M v[128:131],a[248:251],a[208:211],v[128:131]
s_waitcnt lgkmcnt(5)
ds_read_b128 a[204:207],v250 offset:19200
ds_read_b128 a[208:211],v250 offset:19456
M v[132:135],a[248:251],a[212:215],v[132:135]
s_waitcnt lgkmcnt(6)
s_add_u32 s48,s78,6144
v_add_f32 v236,v238,v237
v_sub_f32 v238,v238,v237
M v[136:139],a[248:251],a[216:219],v[136:139]
s_waitcnt lgkmcnt(5)
v_add_f32 v237,v83,v179
v_sub_f32 v179,v83,v179
M v[140:143],a[248:251],a[220:223],v[140:143]
s_waitcnt lgkmcnt(4)
v_add_f32 v83,v236,v237
v_fmac_f32 v236,4.0,v237
M v[144:147],a[248:251],a[192:195],v[144:147]
s_waitcnt lgkmcnt(3)
v_fma_f32 v237,2.0,v179,v238
v_fma_f32 v179,s41,v179,v238
M v[148:151],a[248:251],a[196:199],v[148:151]
s_waitcnt lgkmcnt(2)
v_cvt_pk_bf16_f32 v233,v233,v237
v_cvt_pk_bf16_f32 v235,v235,v236
M v[152:155],a[248:251],a[200:203],v[152:155]
s_waitcnt lgkmcnt(1)
ds_write2st64_b64 v253,v[232:233],v[234:235] offset0:0 offset1:4
M v[156:159],a[248:251],a[204:207],v[156:159]
s_waitcnt vmcnt(14)
buffer_load_dwordx4 a[248:251],v251,s[20:23],s48 offen offset:0 sc1
M v[128:131],a[252:255],a[212:215],v[128:131]
ds_read_b128 a[212:215],v249 offset:19712
v_accvgpr_read_b32 v238,a84
M v[132:135],a[252:255],a[216:219],v[132:135]
v_accvgpr_read_b32 v232,a180
v_add_f32 v234,v238,v232
M v[136:139],a[252:255],a[220:223],v[136:139]
v_sub_f32 v238,v238,v232
v_add_f32 v232,v84,v180
M v[140:143],a[252:255],a[192:195],v[140:143]
v_sub_f32 v180,v84,v180
v_add_f32 v84,v234,v232
M v[144:147],a[252:255],a[196:199],v[144:147]
v_fmac_f32 v234,4.0,v232
v_fma_f32 v232,2.0,v180,v238
M v[148:151],a[252:255],a[200:203],v[148:151]
v_add_u32 v249,0xfffece00,v249
v_add_u32 v250,0xfffece00,v250
M v[152:155],a[252:255],a[204:207],v[152:155]
s_waitcnt lgkmcnt(2)
v_fma_f32 v180,s41,v180,v238
v_accvgpr_read_b32 v238,a85
M v[156:159],a[252:255],a[208:211],v[156:159]
s_waitcnt vmcnt(14)
buffer_load_dwordx4 a[252:255],v251,s[20:23],s48 offen offset:1024 sc1
M v[128:131],v[216:219],a[216:219],v[128:131]
ds_read_b128 a[216:219],v249 offset:26112
v_accvgpr_read_b32 v237,a181
M v[132:135],v[216:219],a[220:223],v[132:135]
ds_read_b128 a[220:223],v250 offset:26368
v_add_f32 v236,v238,v237
M v[136:139],v[216:219],a[192:195],v[136:139]
ds_read_b128 a[192:195],v250 offset:26624
v_sub_f32 v238,v238,v237
M v[140:143],v[216:219],a[196:199],v[140:143]
ds_read_b128 a[196:199],v250 offset:26880
v_add_f32 v237,v85,v181
M v[144:147],v[216:219],a[200:203],v[144:147]
ds_read_b128 a[200:203],v250 offset:27136
v_sub_f32 v181,v85,v181
M v[148:151],v[216:219],a[204:207],v[148:151]
ds_read_b128 a[204:207],v250 offset:27392
v_add_f32 v85,v236,v237
M v[152:155],v[216:219],a[208:211],v[152:155]
s_waitcnt lgkmcnt(6)
ds_read_b128 a[208:211],v250 offset:27648
v_fmac_f32 v236,4.0,v237
v_fma_f32 v237,2.0,v181,v238
v_fma_f32 v181,s41,v181,v238
v_cvt_pk_bf16_f32 v232,v232,v237
M v[156:159],v[216:219],a[212:215],v[156:159]
s_waitcnt vmcnt(14) lgkmcnt(6)
buffer_load_dwordx4 v[216:219],v251,s[20:23],s48 offen offset:2048 sc1
v_cvt_pk_bf16_f32 v234,v234,v236
v_accvgpr_read_b32 v238,a86
v_accvgpr_read_b32 v233,a182
v_add_f32 v235,v238,v233
M v[128:131],v[220:223],a[216:219],v[128:131]
s_waitcnt lgkmcnt(5)
ds_read_b128 a[212:215],v250 offset:27904
ds_read_b128 a[216:219],v250 offset:28160
v_sub_f32 v238,v238,v233
v_add_f32 v233,v86,v182
v_sub_f32 v182,v86,v182
v_add_f32 v86,v235,v233
M v[132:135],v[220:223],a[220:223],v[132:135]
s_waitcnt lgkmcnt(6)
s_add_u32 s48,s79,6144
v_fmac_f32 v235,4.0,v233
v_fma_f32 v233,2.0,v182,v238
v_fma_f32 v182,s41,v182,v238
v_accvgpr_read_b32 v238,a87
M v[136:139],v[220:223],a[192:195],v[136:139]
s_waitcnt lgkmcnt(5)
v_accvgpr_read_b32 v237,a183
v_add_f32 v236,v238,v237
v_sub_f32 v238,v238,v237
v_add_f32 v237,v87,v183
M v[140:143],v[220:223],a[196:199],v[140:143]
s_waitcnt lgkmcnt(4)
v_sub_f32 v183,v87,v183
v_add_f32 v87,v236,v237
v_fmac_f32 v236,4.0,v237
v_fma_f32 v237,2.0,v183,v238
M v[144:147],v[220:223],a[200:203],v[144:147]
s_waitcnt lgkmcnt(3)
v_fma_f32 v183,s41,v183,v238
v_cvt_pk_bf16_f32 v233,v233,v237
v_cvt_pk_bf16_f32 v235,v235,v236
M v[148:151],v[220:223],a[204:207],v[148:151]
s_waitcnt lgkmcnt(2)
ds_write2st64_b64 v253,v[232:233],v[234:235] offset0:8 offset1:12
M v[152:155],v[220:223],a[208:211],v[152:155]
s_waitcnt lgkmcnt(2)
v_accvgpr_read_b32 v238,a88
v_accvgpr_read_b32 v232,a184
M v[156:159],v[220:223],a[212:215],v[156:159]
s_waitcnt vmcnt(14)
buffer_load_dwordx4 v[220:223],v251,s[20:23],s48 offen offset:0 sc1
v_add_f32 v234,v238,v232
v_sub_f32 v238,v238,v232
v_add_f32 v232,v88,v184
v_sub_f32 v184,v88,v184
M v[128:131],v[224:227],a[220:223],v[128:131]
s_waitcnt lgkmcnt(0)
s_barrier
ds_read_b128 v[32:35],v251 offset:17408
v_add_f32 v88,v234,v232
v_fmac_f32 v234,4.0,v232
v_fma_f32 v232,2.0,v184,v238
M v[132:135],v[224:227],a[192:195],v[132:135]
ds_read_b128 v[40:43],v251 offset:21504
ds_read_b128 v[48:51],v251 offset:26112
v_fma_f32 v184,s41,v184,v238
v_accvgpr_read_b32 v238,a89
v_accvgpr_read_b32 v237,a185
v_add_f32 v236,v238,v237
M v[136:139],v[224:227],a[196:199],v[136:139]
ds_read_b128 v[56:59],v251 offset:30208
ds_read_b128 a[80:83],v251 offset:0
v_sub_f32 v238,v238,v237
v_add_f32 v237,v89,v185
v_sub_f32 v185,v89,v185
v_add_f32 v89,v236,v237
M v[140:143],v[224:227],a[200:203],v[140:143]
ds_read_b128 a[84:87],v251 offset:4096
ds_read_b128 a[220:223],v249 offset:28416
v_fmac_f32 v236,4.0,v237
v_fma_f32 v237,2.0,v185,v238
v_fma_f32 v185,s41,v185,v238
v_cvt_pk_bf16_f32 v232,v232,v237
M v[144:147],v[224:227],a[204:207],v[144:147]
v_cvt_pk_bf16_f32 v234,v234,v236
v_accvgpr_read_b32 v238,a90
v_accvgpr_read_b32 v233,a186
v_add_f32 v235,v238,v233
M v[148:151],v[224:227],a[208:211],v[148:151]
s_waitcnt lgkmcnt(6)
s_add_u32 s34,s33,6291456
buffer_store_dwordx4 v[32:35],v252,s[24:27],s34 offen offset:128 nt
v_sub_f32 v238,v238,v233
v_add_f32 v233,v90,v186
v_sub_f32 v186,v90,v186
v_add_f32 v90,v235,v233
M v[152:155],v[224:227],a[212:215],v[152:155]
s_waitcnt lgkmcnt(5)
s_add_u32 s34,s33,6684672
buffer_store_dwordx4 v[40:43],v252,s[24:27],s34 offen offset:128 nt
v_fmac_f32 v235,4.0,v233
v_fma_f32 v233,2.0,v186,v238
v_fma_f32 v186,s41,v186,v238
v_accvgpr_read_b32 v238,a91
M v[156:159],v[224:227],a[216:219],v[156:159]
s_waitcnt vmcnt(16)
s_add_u32 s34,s33,7077888
buffer_load_dwordx4 v[224:227],v251,s[20:23],s48 offen offset:1024 sc1
v_accvgpr_read_b32 v237,a187
v_add_f32 v236,v238,v237
v_sub_f32 v238,v238,v237
v_add_f32 v237,v91,v187
M v[128:131],v[228:231],a[192:195],v[128:131]
s_waitcnt lgkmcnt(4)
buffer_store_dwordx4 v[48:51],v252,s[24:27],s34 offen offset:128 nt
v_sub_f32 v187,v91,v187
v_add_f32 v91,v236,v237
v_fmac_f32 v236,4.0,v237
v_fma_f32 v237,2.0,v187,v238
M v[132:135],v[228:231],a[196:199],v[132:135]
s_waitcnt lgkmcnt(3)
s_add_u32 s34,s33,7471104
buffer_store_dwordx4 v[56:59],v252,s[24:27],s34 offen offset:128 nt
v_fma_f32 v187,s41,v187,v238
v_cvt_pk_bf16_f32 v233,v233,v237
v_cvt_pk_bf16_f32 v235,v235,v236
M v[136:139],v[228:231],a[200:203],v[136:139]
s_waitcnt lgkmcnt(2)
s_add_u32 s34,s32,7077888
buffer_store_dwordx4 a[80:83],v252,s[24:27],s34 offen offset:640 nt
ds_write2st64_b64 v253,v[232:233],v[234:235] offset0:17 offset1:21
M v[140:143],v[228:231],a[204:207],v[140:143]
ds_read_b128 a[192:195],v249 offset:0
ds_read_b128 a[196:199],v250 offset:256
v_accvgpr_read_b32 v238,a92
v_accvgpr_read_b32 v232,a188
M v[144:147],v[228:231],a[208:211],v[144:147]
ds_read_b128 a[200:203],v250 offset:512
ds_read_b128 a[204:207],v250 offset:768
v_add_f32 v234,v238,v232
v_sub_f32 v238,v238,v232
v_add_f32 v232,v92,v188
v_sub_f32 v188,v92,v188
M v[148:151],v[228:231],a[212:215],v[148:151]
ds_read_b128 a[208:211],v250 offset:1024
ds_read_b128 a[212:215],v250 offset:1280
v_add_f32 v92,v234,v232
v_fmac_f32 v234,4.0,v232
v_fma_f32 v232,2.0,v188,v238
v_fma_f32 v188,s41,v188,v238
M v[152:155],v[228:231],a[216:219],v[152:155]
s_waitcnt lgkmcnt(7)
ds_read_b128 a[216:219],v250 offset:1536
v_accvgpr_read_b32 v238,a93
v_accvgpr_read_b32 v237,a189
v_add_f32 v236,v238,v237
v_sub_f32 v238,v238,v237
M v[156:159],v[228:231],a[220:223],v[156:159]
s_waitcnt vmcnt(15) lgkmcnt(6)
buffer_load_dwordx4 v[228:231],v251,s[20:23],s48 offen offset:2048 sc1
v_add_f32 v237,v93,v189
v_sub_f32 v189,v93,v189
v_add_f32 v93,v236,v237
v_fmac_f32 v236,4.0,v237
M v[64:67],a[224:227],a[192:195],v[64:67]
s_waitcnt lgkmcnt(5)
ds_read_b128 a[220:223],v250 offset:1792
ds_read_b128 a[192:195],v250 offset:2048
v_fma_f32 v237,2.0,v189,v238
v_fma_f32 v189,s41,v189,v238
v_cvt_pk_bf16_f32 v232,v232,v237
v_cvt_pk_bf16_f32 v234,v234,v236
M v[68:71],a[224:227],a[196:199],v[68:71]
s_waitcnt lgkmcnt(6)
s_add_u32 s48,s80,6144
v_accvgpr_read_b32 v238,a94
v_accvgpr_read_b32 v233,a190
v_add_f32 v235,v238,v233
v_sub_f32 v238,v238,v233
M v[72:75],a[224:227],a[200:203],v[72:75]
s_waitcnt lgkmcnt(5)
v_add_f32 v233,v94,v190
v_sub_f32 v190,v94,v190
v_add_f32 v94,v235,v233
v_fmac_f32 v235,4.0,v233
M v[76:79],a[224:227],a[204:207],v[76:79]
s_waitcnt lgkmcnt(4)
v_fma_f32 v233,2.0,v190,v238
v_fma_f32 v190,s41,v190,v238
v_accvgpr_read_b32 v238,a95
v_accvgpr_read_b32 v237,a191
M v[80:83],a[224:227],a[208:211],v[80:83]
s_waitcnt lgkmcnt(3)
v_add_f32 v236,v238,v237
v_sub_f32 v238,v238,v237
v_add_f32 v237,v95,v191
v_sub_f32 v191,v95,v191
M v[84:87],a[224:227],a[212:215],v[84:87]
s_waitcnt lgkmcnt(2)
v_add_f32 v95,v236,v237
v_fmac_f32 v236,4.0,v237
M v[88:91],a[224:227],a[216:219],v[88:91]
s_waitcnt lgkmcnt(1)
v_fma_f32 v237,2.0,v191,v238
v_fma_f32 v191,s41,v191,v238
M v[92:95],a[224:227],a[220:223],v[92:95]
s_waitcnt vmcnt(15)
buffer_load_dwordx4 a[224:227],v251,s[20:23],s48 offen offset:0 sc1
M v[64:67],a[228:231],a[196:199],v[64:67]
ds_read_b128 a[196:199],v249 offset:2304
v_cvt_pk_bf16_f32 v233,v233,v237
M v[68:71],a[228:231],a[200:203],v[68:71]
v_cvt_pk_bf16_f32 v235,v235,v236
M v[72:75],a[228:231],a[204:207],v[72:75]
ds_write2st64_b64 v253,v[232:233],v[234:235] offset0:25 offset1:29
M v[76:79],a[228:231],a[208:211],v[76:79]
v_cvt_pk_bf16_f32 v128,v128,v129
v_cvt_pk_bf16_f32 v129,v130,v131
M v[80:83],a[228:231],a[212:215],v[80:83]
v_cvt_pk_bf16_f32 v132,v132,v133
v_cvt_pk_bf16_f32 v133,v134,v135
M v[84:87],a[228:231],a[216:219],v[84:87]
ds_write2st64_b64 v253,v[128:129],v[132:133] offset0:68 offset1:72
M v[88:91],a[228:231],a[220:223],v[88:91]
s_waitcnt lgkmcnt(3)
s_add_u32 s34,s32,7274496
buffer_store_dwordx4 a[84:87],v252,s[24:27],s34 offen offset:640 nt
M v[92:95],a[228:231],a[192:195],v[92:95]
s_waitcnt vmcnt(16)
buffer_load_dwordx4 a[228:231],v251,s[20:23],s48 offen offset:1024 sc1
M v[64:67],a[232:235],a[200:203],v[64:67]
ds_read_b128 a[200:203],v249 offset:34816
v_cvt_pk_bf16_f32 v136,v136,v137
M v[68:71],a[232:235],a[204:207],v[68:71]
ds_read_b128 a[204:207],v250 offset:35072
v_cvt_pk_bf16_f32 v137,v138,v139
M v[72:75],a[232:235],a[208:211],v[72:75]
ds_read_b128 a[208:211],v250 offset:35328
v_cvt_pk_bf16_f32 v140,v140,v141
M v[76:79],a[232:235],a[212:215],v[76:79]
ds_read_b128 a[212:215],v250 offset:35584
v_cvt_pk_bf16_f32 v141,v142,v143
M v[80:83],a[232:235],a[216:219],v[80:83]
ds_read_b128 a[216:219],v250 offset:35840
ds_write2st64_b64 v253,v[136:137],v[140:141] offset0:76 offset1:80
M v[84:87],a[232:235],a[220:223],v[84:87]
ds_read_b128 a[220:223],v250 offset:36096
v_cvt_pk_bf16_f32 v144,v144,v145
M v[88:91],a[232:235],a[192:195],v[88:91]
s_waitcnt lgkmcnt(9)
ds_read_b128 a[192:195],v250 offset:36352
v_cvt_pk_bf16_f32 v145,v146,v147
M v[92:95],a[232:235],a[196:199],v[92:95]
s_waitcnt vmcnt(16) lgkmcnt(7)
buffer_load_dwordx4 a[232:235],v251,s[20:23],s48 offen offset:2048 sc1
M v[64:67],a[236:239],a[200:203],v[64:67]
s_waitcnt lgkmcnt(6)
ds_read_b128 a[196:199],v250 offset:36608
ds_read_b128 a[200:203],v250 offset:36864
M v[68:71],a[236:239],a[204:207],v[68:71]
s_waitcnt lgkmcnt(7)
s_add_u32 s48,s81,6144
v_cvt_pk_bf16_f32 v148,v148,v149
v_cvt_pk_bf16_f32 v149,v150,v151
M v[72:75],a[236:239],a[208:211],v[72:75]
s_waitcnt lgkmcnt(6)
ds_write2st64_b64 v253,v[144:145],v[148:149] offset0:85 offset1:89
M v[76:79],a[236:239],a[212:215],v[76:79]
s_waitcnt lgkmcnt(6)
v_cvt_pk_bf16_f32 v152,v152,v153
v_cvt_pk_bf16_f32 v153,v154,v155
M v[80:83],a[236:239],a[216:219],v[80:83]
s_waitcnt lgkmcnt(4)
v_cvt_pk_bf16_f32 v156,v156,v157
v_cvt_pk_bf16_f32 v157,v158,v159
M v[84:87],a[236:239],a[220:223],v[84:87]
s_waitcnt lgkmcnt(3)
ds_write2st64_b64 v253,v[152:153],v[156:157] offset0:93 offset1:97
M v[88:91],a[236:239],a[192:195],v[88:91]
s_waitcnt lgkmcnt(3)
M v[92:95],a[236:239],a[196:199],v[92:95]
s_waitcnt vmcnt(16)
buffer_load_dwordx4 a[236:239],v251,s[20:23],s48 offen offset:0 sc1
M v[64:67],a[240:243],a[204:207],v[64:67]
s_waitcnt lgkmcnt(0)
s_barrier
ds_read_b128 a[88:91],v251 offset:8704
M v[68:71],a[240:243],a[208:211],v[68:71]
ds_read_b128 a[92:95],v251 offset:12800
ds_read_b128 v[128:131],v251 offset:34816
M v[72:75],a[240:243],a[212:215],v[72:75]
ds_read_b128 v[136:139],v251 offset:38912
ds_read_b128 v[144:147],v251 offset:43520
M v[76:79],a[240:243],a[216:219],v[76:79]
ds_read_b128 v[152:155],v251 offset:47616
ds_read_b128 a[204:207],v249 offset:37120
M v[80:83],a[240:243],a[220:223],v[80:83]
M v[84:87],a[240:243],a[192:195],v[84:87]
s_waitcnt lgkmcnt(6)
s_add_u32 s34,s32,7471104
buffer_store_dwordx4 a[88:91],v252,s[24:27],s34 offen offset:640 nt
M v[88:91],a[240:243],a[196:199],v[88:91]
M v[92:95],a[240:243],a[200:203],v[92:95]
s_waitcnt vmcnt(17)
buffer_load_dwordx4 a[240:243],v251,s[20:23],s48 offen offset:1024 sc1
M v[64:67],a[244:247],a[208:211],v[64:67]
ds_read_b128 a[208:211],v249 offset:52224
M v[68:71],a[244:247],a[212:215],v[68:71]
ds_read_b128 a[212:215],v250 offset:52480
M v[72:75],a[244:247],a[216:219],v[72:75]
ds_read_b128 a[216:219],v250 offset:52736
M v[76:79],a[244:247],a[220:223],v[76:79]
ds_read_b128 a[220:223],v250 offset:52992
M v[80:83],a[244:247],a[192:195],v[80:83]
ds_read_b128 a[192:195],v250 offset:53248
M v[84:87],a[244:247],a[196:199],v[84:87]
ds_read_b128 a[196:199],v250 offset:53504
M v[88:91],a[244:247],a[200:203],v[88:91]
s_waitcnt lgkmcnt(6)
ds_read_b128 a[200:203],v250 offset:53760
M v[92:95],a[244:247],a[204:207],v[92:95]
s_waitcnt vmcnt(17) lgkmcnt(6)
buffer_load_dwordx4 a[244:247],v251,s[20:23],s48 offen offset:2048 sc1
M v[64:67],a[248:251],a[208:211],v[64:67]
s_waitcnt lgkmcnt(5)
ds_read_b128 a[204:207],v250 offset:54016
ds_read_b128 a[208:211],v250 offset:54272
M v[68:71],a[248:251],a[212:215],v[68:71]
s_waitcnt lgkmcnt(6)
s_add_u32 s48,s76,52224
M v[72:75],a[248:251],a[216:219],v[72:75]
s_waitcnt lgkmcnt(5)
M v[76:79],a[248:251],a[220:223],v[76:79]
s_waitcnt lgkmcnt(4)
M v[80:83],a[248:251],a[192:195],v[80:83]
s_waitcnt lgkmcnt(3)
M v[84:87],a[248:251],a[196:199],v[84:87]
s_waitcnt lgkmcnt(2)
M v[88:91],a[248:251],a[200:203],v[88:91]
s_waitcnt lgkmcnt(1)
M v[92:95],a[248:251],a[204:207],v[92:95]
s_waitcnt vmcnt(17)
buffer_load_dwordx4 a[248:251],v251,s[20:23],s48 offen offset:0 sc1
M v[64:67],a[252:255],a[212:215],v[64:67]
ds_read_b128 a[212:215],v249 offset:54528
M v[68:71],a[252:255],a[216:219],v[68:71]
M v[72:75],a[252:255],a[220:223],v[72:75]
M v[76:79],a[252:255],a[192:195],v[76:79]
s_add_u32 s34,s32,7667712
buffer_store_dwordx4 a[92:95],v252,s[24:27],s34 offen offset:640 nt
M v[80:83],a[252:255],a[196:199],v[80:83]
M v[84:87],a[252:255],a[200:203],v[84:87]
v_add_u32 v249,0x11000,v249
v_add_u32 v250,0x11000,v250
M v[88:91],a[252:255],a[204:207],v[88:91]
s_waitcnt lgkmcnt(1)
M v[92:95],a[252:255],a[208:211],v[92:95]
s_waitcnt vmcnt(18)
buffer_load_dwordx4 a[252:255],v251,s[20:23],s48 offen offset:1024 sc1
M v[64:67],v[216:219],a[216:219],v[64:67]
ds_read_b128 a[216:219],v249 offset:0
M v[68:71],v[216:219],a[220:223],v[68:71]
ds_read_b128 a[220:223],v250 offset:256
M v[72:75],v[216:219],a[192:195],v[72:75]
ds_read_b128 a[192:195],v250 offset:512
M v[76:79],v[216:219],a[196:199],v[76:79]
ds_read_b128 a[196:199],v250 offset:768
M v[80:83],v[216:219],a[200:203],v[80:83]
ds_read_b128 a[200:203],v250 offset:1024
M v[84:87],v[216:219],a[204:207],v[84:87]
ds_read_b128 a[204:207],v250 offset:1280
M v[88:91],v[216:219],a[208:211],v[88:91]
s_waitcnt lgkmcnt(6)
ds_read_b128 a[208:211],v250 offset:1536
M v[92:95],v[216:219],a[212:215],v[92:95]
s_waitcnt vmcnt(18) lgkmcnt(6)
buffer_load_dwordx4 v[216:219],v251,s[20:23],s48 offen offset:2048 sc1
M v[64:67],v[220:223],a[216:219],v[64:67]
s_waitcnt lgkmcnt(5)
ds_read_b128 a[212:215],v250 offset:1792
ds_read_b128 a[216:219],v250 offset:2048
M v[68:71],v[220:223],a[220:223],v[68:71]
s_waitcnt lgkmcnt(6)
s_add_u32 s48,s77,52224
M v[72:75],v[220:223],a[192:195],v[72:75]
s_waitcnt lgkmcnt(5)
M v[76:79],v[220:223],a[196:199],v[76:79]
s_waitcnt lgkmcnt(4)
M v[80:83],v[220:223],a[200:203],v[80:83]
s_waitcnt lgkmcnt(3)
M v[84:87],v[220:223],a[204:207],v[84:87]
s_waitcnt lgkmcnt(2)
M v[88:91],v[220:223],a[208:211],v[88:91]
s_waitcnt lgkmcnt(1)
M v[92:95],v[220:223],a[212:215],v[92:95]
s_waitcnt vmcnt(16)
buffer_load_dwordx4 v[220:223],v251,s[20:23],s48 offen offset:0 sc1
M v[64:67],v[224:227],a[220:223],v[64:67]
ds_read_b128 a[220:223],v249 offset:2304
M v[68:71],v[224:227],a[192:195],v[68:71]
s_add_u32 s34,s33,6291456
buffer_store_dwordx4 v[128:131],v252,s[24:27],s34 offen offset:1280 nt
M v[72:75],v[224:227],a[196:199],v[72:75]
M v[76:79],v[224:227],a[200:203],v[76:79]
M v[80:83],v[224:227],a[204:207],v[80:83]
M v[84:87],v[224:227],a[208:211],v[84:87]
M v[88:91],v[224:227],a[212:215],v[88:91]
s_waitcnt lgkmcnt(1)
M v[92:95],v[224:227],a[216:219],v[92:95]
s_waitcnt vmcnt(14)
buffer_load_dwordx4 v[224:227],v251,s[20:23],s48 offen offset:1024 sc1
M v[64:67],v[228:231],a[192:195],v[64:67]
ds_read_b128 a[192:195],v249 offset:17408
M v[68:71],v[228:231],a[196:199],v[68:71]
ds_read_b128 a[196:199],v250 offset:17664
M v[72:75],v[228:231],a[200:203],v[72:75]
ds_read_b128 a[200:203],v250 offset:17920
M v[76:79],v[228:231],a[204:207],v[76:79]
ds_read_b128 a[204:207],v250 offset:18176
M v[80:83],v[228:231],a[208:211],v[80:83]
ds_read_b128 a[208:211],v250 offset:18432
M v[84:87],v[228:231],a[212:215],v[84:87]
ds_read_b128 a[212:215],v250 offset:18688
M v[88:91],v[228:231],a[216:219],v[88:91]
s_waitcnt lgkmcnt(6)
ds_read_b128 a[216:219],v250 offset:18944
M v[92:95],v[228:231],a[220:223],v[92:95]
s_waitcnt vmcnt(14) lgkmcnt(6)
buffer_load_dwordx4 v[228:231],v251,s[20:23],s48 offen offset:2048 sc1
M v[64:67],a[224:227],a[192:195],v[64:67]
s_waitcnt lgkmcnt(5)
ds_read_b128 a[220:223],v250 offset:19200
ds_read_b128 a[192:195],v250 offset:19456
M v[68:71],a[224:227],a[196:199],v[68:71]
s_waitcnt lgkmcnt(6)
s_add_u32 s48,s78,52224
M v[72:75],a[224:227],a[200:203],v[72:75]
s_waitcnt lgkmcnt(5)
M v[76:79],a[224:227],a[204:207],v[76:79]
s_waitcnt lgkmcnt(4)
M v[80:83],a[224:227],a[208:211],v[80:83]
s_waitcnt lgkmcnt(3)
M v[84:87],a[224:227],a[212:215],v[84:87]
s_waitcnt lgkmcnt(2)
M v[88:91],a[224:227],a[216:219],v[88:91]
s_waitcnt lgkmcnt(1)
M v[92:95],a[224:227],a[220:223],v[92:95]
s_waitcnt vmcnt(13)
s_add_u32 s34,s33,6684672
buffer_load_dwordx4 a[224:227],v251,s[20:23],s48 offen offset:0 sc1
M v[64:67],a[228:231],a[196:199],v[64:67]
buffer_store_dwordx4 v[136:139],v252,s[24:27],s34 offen offset:1280 nt
M v[68:71],a[228:231],a[200:203],v[68:71]
ds_read_b128 a[196:199],v249 offset:19712
M v[72:75],a[228:231],a[204:207],v[72:75]
M v[76:79],a[228:231],a[208:211],v[76:79]
M v[80:83],a[228:231],a[212:215],v[80:83]
M v[84:87],a[228:231],a[216:219],v[84:87]
v_add_u32 v249,0xffff1200,v249
v_add_u32 v250,0xffff1200,v250
M v[88:91],a[228:231],a[220:223],v[88:91]
s_waitcnt lgkmcnt(1)
M v[92:95],a[228:231],a[192:195],v[92:95]
s_waitcnt vmcnt(14)
buffer_load_dwordx4 a[228:231],v251,s[20:23],s48 offen offset:1024 sc1
M v[64:67],a[232:235],a[200:203],v[64:67]
ds_read_b128 a[200:203],v249 offset:8704
M v[68:71],a[232:235],a[204:207],v[68:71]
ds_read_b128 a[204:207],v250 offset:8960
M v[72:75],a[232:235],a[208:211],v[72:75]
ds_read_b128 a[208:211],v250 offset:9216
M v[76:79],a[232:235],a[212:215],v[76:79]
ds_read_b128 a[212:215],v250 offset:9472
M v[80:83],a[232:235],a[216:219],v[80:83]
ds_read_b128 a[216:219],v250 offset:9728
M v[84:87],a[232:235],a[220:223],v[84:87]
ds_read_b128 a[220:223],v250 offset:9984
M v[88:91],a[232:235],a[192:195],v[88:91]
s_waitcnt lgkmcnt(6)
ds_read_b128 a[192:195],v250 offset:10240
M v[92:95],a[232:235],a[196:199],v[92:95]
s_waitcnt vmcnt(14) lgkmcnt(6)
buffer_load_dwordx4 a[232:235],v251,s[20:23],s48 offen offset:2048 sc1
M v[64:67],a[236:239],a[200:203],v[64:67]
s_waitcnt lgkmcnt(5)
ds_read_b128 a[196:199],v250 offset:10496
ds_read_b128 a[200:203],v250 offset:10752
M v[68:71],a[236:239],a[204:207],v[68:71]
s_waitcnt lgkmcnt(6)
s_add_u32 s48,s79,52224
M v[72:75],a[236:239],a[208:211],v[72:75]
s_waitcnt lgkmcnt(5)
M v[76:79],a[236:239],a[212:215],v[76:79]
s_waitcnt lgkmcnt(4)
M v[80:83],a[236:239],a[216:219],v[80:83]
s_waitcnt lgkmcnt(3)
M v[84:87],a[236:239],a[220:223],v[84:87]
s_waitcnt lgkmcnt(2)
s_add_u32 s34,s33,7077888
buffer_store_dwordx4 v[144:147],v252,s[24:27],s34 offen offset:1280 nt
M v[88:91],a[236:239],a[192:195],v[88:91]
s_waitcnt lgkmcnt(1)
M v[92:95],a[236:239],a[196:199],v[92:95]
s_waitcnt vmcnt(14)
buffer_load_dwordx4 a[236:239],v251,s[20:23],s48 offen offset:0 sc1
M v[64:67],a[240:243],a[204:207],v[64:67]
ds_read_b128 a[204:207],v249 offset:11008
M v[68:71],a[240:243],a[208:211],v[68:71]
M v[72:75],a[240:243],a[212:215],v[72:75]
M v[76:79],a[240:243],a[216:219],v[76:79]
M v[80:83],a[240:243],a[220:223],v[80:83]
M v[84:87],a[240:243],a[192:195],v[84:87]
M v[88:91],a[240:243],a[196:199],v[88:91]
s_waitcnt lgkmcnt(1)
M v[92:95],a[240:243],a[200:203],v[92:95]
s_waitcnt vmcnt(14)
buffer_load_dwordx4 a[240:243],v251,s[20:23],s48 offen offset:1024 sc1
M v[64:67],a[244:247],a[208:211],v[64:67]
ds_read_b128 a[208:211],v249 offset:0
M v[68:71],a[244:247],a[212:215],v[68:71]
ds_read_b128 a[212:215],v250 offset:256
M v[72:75],a[244:247],a[216:219],v[72:75]
ds_read_b128 a[216:219],v250 offset:512
M v[76:79],a[244:247],a[220:223],v[76:79]
ds_read_b128 a[220:223],v250 offset:768
s_nop 0
v_cvt_pk_bf16_f32 v64,v64,v65
M v[80:83],a[244:247],a[192:195],v[80:83]
ds_read_b128 a[192:195],v250 offset:1024
v_cvt_pk_bf16_f32 v65,v66,v67
M v[84:87],a[244:247],a[196:199],v[84:87]
ds_read_b128 a[196:199],v250 offset:1280
v_cvt_pk_bf16_f32 v68,v68,v69
M v[88:91],a[244:247],a[200:203],v[88:91]
s_waitcnt lgkmcnt(6)
ds_read_b128 a[200:203],v250 offset:1536
v_cvt_pk_bf16_f32 v69,v70,v71
M v[92:95],a[244:247],a[204:207],v[92:95]
s_waitcnt vmcnt(14) lgkmcnt(6)
buffer_load_dwordx4 a[244:247],v251,s[20:23],s48 offen offset:2048 sc1
M v[160:163],a[248:251],a[208:211],v[160:163]
s_waitcnt lgkmcnt(5)
ds_read_b128 a[204:207],v250 offset:1792
ds_read_b128 a[208:211],v250 offset:2048
M v[164:167],a[248:251],a[212:215],v[164:167]
s_waitcnt lgkmcnt(6)
s_add_u32 s48,s80,52224
ds_write2st64_b64 v253,v[64:65],v[68:69] offset0:34 offset1:38
M v[168:171],a[248:251],a[216:219],v[168:171]
s_waitcnt lgkmcnt(6)
v_cvt_pk_bf16_f32 v72,v72,v73
v_cvt_pk_bf16_f32 v73,v74,v75
M v[172:175],a[248:251],a[220:223],v[172:175]
s_waitcnt lgkmcnt(5)
s_add_u32 s34,s33,7471104
buffer_store_dwordx4 v[152:155],v252,s[24:27],s34 offen offset:1280 nt
M v[176:179],a[248:251],a[192:195],v[176:179]
s_waitcnt lgkmcnt(4)
v_cvt_pk_bf16_f32 v76,v76,v77
v_cvt_pk_bf16_f32 v77,v78,v79
M v[180:183],a[248:251],a[196:199],v[180:183]
s_waitcnt lgkmcnt(3)
ds_write2st64_b64 v253,v[72:73],v[76:77] offset0:42 offset1:46
M v[184:187],a[248:251],a[200:203],v[184:187]
s_waitcnt lgkmcnt(3)
v_cvt_pk_bf16_f32 v80,v80,v81
v_cvt_pk_bf16_f32 v81,v82,v83
M v[188:191],a[248:251],a[204:207],v[188:191]
s_waitcnt vmcnt(14)
buffer_load_dwordx4 a[248:251],v251,s[20:23],s48 offen offset:0 sc1
M v[160:163],a[252:255],a[212:215],v[160:163]
ds_read_b128 a[212:215],v249 offset:2304
v_cvt_pk_bf16_f32 v84,v84,v85
M v[164:167],a[252:255],a[216:219],v[164:167]
v_cvt_pk_bf16_f32 v85,v86,v87
M v[168:171],a[252:255],a[220:223],v[168:171]
ds_write2st64_b64 v253,v[80:81],v[84:85] offset0:51 offset1:55
M v[172:175],a[252:255],a[192:195],v[172:175]
v_cvt_pk_bf16_f32 v88,v88,v89
v_cvt_pk_bf16_f32 v89,v90,v91
M v[176:179],a[252:255],a[196:199],v[176:179]
v_cvt_pk_bf16_f32 v92,v92,v93
v_cvt_pk_bf16_f32 v93,v94,v95
M v[180:183],a[252:255],a[200:203],v[180:183]
ds_write2st64_b64 v253,v[88:89],v[92:93] offset0:59 offset1:63
M v[184:187],a[252:255],a[204:207],v[184:187]
s_waitcnt lgkmcnt(5)
M v[188:191],a[252:255],a[208:211],v[188:191]
s_waitcnt vmcnt(14)
buffer_load_dwordx4 a[252:255],v251,s[20:23],s48 offen offset:1024 sc1
M v[160:163],v[216:219],a[216:219],v[160:163]
s_waitcnt lgkmcnt(0)
s_barrier
ds_read_b128 v[64:67],v251 offset:17408
M v[164:167],v[216:219],a[220:223],v[164:167]
ds_read_b128 v[72:75],v251 offset:21504
ds_read_b128 v[80:83],v251 offset:26112
M v[168:171],v[216:219],a[192:195],v[168:171]
ds_read_b128 v[88:91],v251 offset:30208
ds_read_b128 a[216:219],v249 offset:34816
M v[172:175],v[216:219],a[196:199],v[172:175]
ds_read_b128 a[220:223],v250 offset:35072
ds_read_b128 a[192:195],v250 offset:35328
M v[176:179],v[216:219],a[200:203],v[176:179]
ds_read_b128 a[196:199],v250 offset:35584
ds_read_b128 a[200:203],v250 offset:35840
M v[180:183],v[216:219],a[204:207],v[180:183]
ds_read_b128 a[204:207],v250 offset:36096
M v[184:187],v[216:219],a[208:211],v[184:187]
ds_read_b128 a[208:211],v250 offset:36352
M v[188:191],v[216:219],a[212:215],v[188:191]
s_waitcnt vmcnt(14) lgkmcnt(6)
buffer_load_dwordx4 v[216:219],v251,s[20:23],s48 offen offset:2048 sc1
M v[160:163],v[220:223],a[216:219],v[160:163]
s_waitcnt lgkmcnt(5)
ds_read_b128 a[212:215],v250 offset:36608
ds_read_b128 a[216:219],v250 offset:36864
M v[164:167],v[220:223],a[220:223],v[164:167]
s_waitcnt lgkmcnt(6)
s_add_u32 s48,s81,52224
s_add_u32 s34,s33,6291456
M v[168:171],v[220:223],a[192:195],v[168:171]
s_waitcnt lgkmcnt(5)
buffer_store_dwordx4 v[64:67],v252,s[24:27],s34 offen offset:256 nt
M v[172:175],v[220:223],a[196:199],v[172:175]
s_waitcnt lgkmcnt(4)
M v[176:179],v[220:223],a[200:203],v[176:179]
s_waitcnt lgkmcnt(3)
M v[180:183],v[220:223],a[204:207],v[180:183]
s_waitcnt lgkmcnt(2)
M v[184:187],v[220:223],a[208:211],v[184:187]
s_waitcnt lgkmcnt(1)
M v[188:191],v[220:223],a[212:215],v[188:191]
s_waitcnt vmcnt(14)
buffer_load_dwordx4 v[220:223],v251,s[20:23],s48 offen offset:0 sc1
M v[160:163],v[224:227],a[220:223],v[160:163]
ds_read_b128 a[220:223],v249 offset:37120
M v[164:167],v[224:227],a[192:195],v[164:167]
M v[168:171],v[224:227],a[196:199],v[168:171]
M v[172:175],v[224:227],a[200:203],v[172:175]
M v[176:179],v[224:227],a[204:207],v[176:179]
M v[180:183],v[224:227],a[208:211],v[180:183]
M v[184:187],v[224:227],a[212:215],v[184:187]
s_waitcnt lgkmcnt(1)
M v[188:191],v[224:227],a[216:219],v[188:191]
s_waitcnt vmcnt(14)
buffer_load_dwordx4 v[224:227],v251,s[20:23],s48 offen offset:1024 sc1
M v[160:163],v[228:231],a[192:195],v[160:163]
ds_read_b128 a[192:195],v249 offset:52224
M v[164:167],v[228:231],a[196:199],v[164:167]
ds_read_b128 a[196:199],v250 offset:52480
M v[168:171],v[228:231],a[200:203],v[168:171]
ds_read_b128 a[200:203],v250 offset:52736
M v[172:175],v[228:231],a[204:207],v[172:175]
ds_read_b128 a[204:207],v250 offset:52992
M v[176:179],v[228:231],a[208:211],v[176:179]
ds_read_b128 a[208:211],v250 offset:53248
M v[180:183],v[228:231],a[212:215],v[180:183]
ds_read_b128 a[212:215],v250 offset:53504
M v[184:187],v[228:231],a[216:219],v[184:187]
s_waitcnt lgkmcnt(6)
ds_read_b128 a[216:219],v250 offset:53760
M v[188:191],v[228:231],a[220:223],v[188:191]
s_waitcnt vmcnt(14) lgkmcnt(6)
s_add_u32 s34,s33,6684672
buffer_load_dwordx4 v[228:231],v251,s[20:23],s48 offen offset:2048 sc1
M v[160:163],a[224:227],a[192:195],v[160:163]
s_waitcnt lgkmcnt(5)
buffer_store_dwordx4 v[72:75],v252,s[24:27],s34 offen offset:256 nt
M v[164:167],a[224:227],a[196:199],v[164:167]
s_waitcnt lgkmcnt(4)
ds_read_b128 a[220:223],v250 offset:54016
ds_read_b128 a[192:195],v250 offset:54272
M v[168:171],a[224:227],a[200:203],v[168:171]
s_waitcnt lgkmcnt(5)
M v[172:175],a[224:227],a[204:207],v[172:175]
s_waitcnt lgkmcnt(4)
M v[176:179],a[224:227],a[208:211],v[176:179]
s_waitcnt lgkmcnt(3)
M v[180:183],a[224:227],a[212:215],v[180:183]
s_waitcnt lgkmcnt(2)
M v[184:187],a[224:227],a[216:219],v[184:187]
s_waitcnt lgkmcnt(1)
M v[188:191],a[224:227],a[220:223],v[188:191]
s_waitcnt vmcnt(14)
M v[160:163],a[228:231],a[196:199],v[160:163]
ds_read_b128 a[196:199],v249 offset:54528
M v[164:167],a[228:231],a[200:203],v[164:167]
M v[168:171],a[228:231],a[204:207],v[168:171]
M v[172:175],a[228:231],a[208:211],v[172:175]
M v[176:179],a[228:231],a[212:215],v[176:179]
M v[180:183],a[228:231],a[216:219],v[180:183]
v_add_u32 v249,0x11000,v249
v_add_u32 v250,0x11000,v250
M v[184:187],a[228:231],a[220:223],v[184:187]
s_waitcnt lgkmcnt(1)
M v[188:191],a[228:231],a[192:195],v[188:191]
s_waitcnt vmcnt(13)
M v[160:163],a[232:235],a[200:203],v[160:163]
ds_read_b128 a[200:203],v249 offset:0
M v[164:167],a[232:235],a[204:207],v[164:167]
ds_read_b128 a[204:207],v250 offset:256
M v[168:171],a[232:235],a[208:211],v[168:171]
ds_read_b128 a[208:211],v250 offset:512
M v[172:175],a[232:235],a[212:215],v[172:175]
ds_read_b128 a[212:215],v250 offset:768
M v[176:179],a[232:235],a[216:219],v[176:179]
ds_read_b128 a[216:219],v250 offset:1024
M v[180:183],a[232:235],a[220:223],v[180:183]
s_add_u32 s34,s33,7077888
buffer_store_dwordx4 v[80:83],v252,s[24:27],s34 offen offset:256 nt
M v[184:187],a[232:235],a[192:195],v[184:187]
s_waitcnt lgkmcnt(5)
ds_read_b128 a[220:223],v250 offset:1280
ds_read_b128 a[192:195],v250 offset:1536
M v[188:191],a[232:235],a[196:199],v[188:191]
s_waitcnt vmcnt(12) lgkmcnt(6)
ds_read_b128 a[196:199],v250 offset:1792
M v[160:163],a[236:239],a[200:203],v[160:163]
s_waitcnt lgkmcnt(6)
ds_read_b128 a[200:203],v250 offset:2048
M v[164:167],a[236:239],a[204:207],v[164:167]
s_waitcnt lgkmcnt(6)
M v[168:171],a[236:239],a[208:211],v[168:171]
s_waitcnt lgkmcnt(5)
M v[172:175],a[236:239],a[212:215],v[172:175]
s_waitcnt lgkmcnt(4)
M v[176:179],a[236:239],a[216:219],v[176:179]
s_waitcnt lgkmcnt(3)
M v[180:183],a[236:239],a[220:223],v[180:183]
s_waitcnt lgkmcnt(2)
M v[184:187],a[236:239],a[192:195],v[184:187]
s_waitcnt lgkmcnt(1)
M v[188:191],a[236:239],a[196:199],v[188:191]
s_waitcnt vmcnt(11)
M v[160:163],a[240:243],a[204:207],v[160:163]
ds_read_b128 a[204:207],v249 offset:2304
M v[164:167],a[240:243],a[208:211],v[164:167]
M v[168:171],a[240:243],a[212:215],v[168:171]
M v[172:175],a[240:243],a[216:219],v[172:175]
M v[176:179],a[240:243],a[220:223],v[176:179]
M v[180:183],a[240:243],a[192:195],v[180:183]
M v[184:187],a[240:243],a[196:199],v[184:187]
s_waitcnt lgkmcnt(1)
M v[188:191],a[240:243],a[200:203],v[188:191]
s_waitcnt vmcnt(10)
M v[160:163],a[244:247],a[208:211],v[160:163]
ds_read_b128 a[208:211],v249 offset:17408
M v[164:167],a[244:247],a[212:215],v[164:167]
ds_read_b128 a[212:215],v250 offset:17664
M v[168:171],a[244:247],a[216:219],v[168:171]
ds_read_b128 a[216:219],v250 offset:17920
M v[172:175],a[244:247],a[220:223],v[172:175]
s_add_u32 s34,s33,7471104
buffer_store_dwordx4 v[88:91],v252,s[24:27],s34 offen offset:256 nt
M v[176:179],a[244:247],a[192:195],v[176:179]
ds_read_b128 a[220:223],v250 offset:18176
ds_read_b128 a[192:195],v250 offset:18432
M v[180:183],a[244:247],a[196:199],v[180:183]
ds_read_b128 a[196:199],v250 offset:18688
M v[184:187],a[244:247],a[200:203],v[184:187]
s_waitcnt lgkmcnt(6)
ds_read_b128 a[200:203],v250 offset:18944
M v[188:191],a[244:247],a[204:207],v[188:191]
s_waitcnt vmcnt(9) lgkmcnt(6)
ds_read_b128 a[204:207],v250 offset:19200
M v[160:163],a[248:251],a[208:211],v[160:163]
s_waitcnt lgkmcnt(6)
ds_read_b128 a[208:211],v250 offset:19456
M v[164:167],a[248:251],a[212:215],v[164:167]
s_waitcnt lgkmcnt(6)
M v[168:171],a[248:251],a[216:219],v[168:171]
s_waitcnt lgkmcnt(5)
M v[172:175],a[248:251],a[220:223],v[172:175]
s_waitcnt lgkmcnt(4)
M v[176:179],a[248:251],a[192:195],v[176:179]
s_waitcnt lgkmcnt(3)
M v[180:183],a[248:251],a[196:199],v[180:183]
s_waitcnt lgkmcnt(2)
M v[184:187],a[248:251],a[200:203],v[184:187]
s_waitcnt lgkmcnt(1)
M v[188:191],a[248:251],a[204:207],v[188:191]
s_waitcnt vmcnt(8)
M v[160:163],a[252:255],a[212:215],v[160:163]
ds_read_b128 a[212:215],v249 offset:19712
M v[164:167],a[252:255],a[216:219],v[164:167]
M v[168:171],a[252:255],a[220:223],v[168:171]
M v[172:175],a[252:255],a[192:195],v[172:175]
M v[176:179],a[252:255],a[196:199],v[176:179]
M v[180:183],a[252:255],a[200:203],v[180:183]
v_add_u32 v249,0xffff3400,v249
v_add_u32 v250,0xffff3400,v250
M v[184:187],a[252:255],a[204:207],v[184:187]
s_waitcnt lgkmcnt(1)
M v[188:191],a[252:255],a[208:211],v[188:191]
s_waitcnt vmcnt(7)
M v[160:163],v[216:219],a[216:219],v[160:163]
ds_read_b128 a[216:219],v249 offset:0
M v[164:167],v[216:219],a[220:223],v[164:167]
ds_read_b128 a[220:223],v250 offset:256
M v[168:171],v[216:219],a[192:195],v[168:171]
ds_read_b128 a[192:195],v250 offset:512
M v[172:175],v[216:219],a[196:199],v[172:175]
ds_read_b128 a[196:199],v250 offset:768
M v[176:179],v[216:219],a[200:203],v[176:179]
ds_read_b128 a[200:203],v250 offset:1024
M v[180:183],v[216:219],a[204:207],v[180:183]
ds_read_b128 a[204:207],v250 offset:1280
M v[184:187],v[216:219],a[208:211],v[184:187]
s_waitcnt lgkmcnt(6)
ds_read_b128 a[208:211],v250 offset:1536
M v[188:191],v[216:219],a[212:215],v[188:191]
s_waitcnt vmcnt(5) lgkmcnt(6)
ds_read_b128 a[212:215],v250 offset:1792
M v[160:163],v[220:223],a[216:219],v[160:163]
s_waitcnt lgkmcnt(6)
ds_read_b128 a[216:219],v250 offset:2048
M v[164:167],v[220:223],a[220:223],v[164:167]
s_waitcnt lgkmcnt(6)
M v[168:171],v[220:223],a[192:195],v[168:171]
s_waitcnt lgkmcnt(5)
M v[172:175],v[220:223],a[196:199],v[172:175]
s_waitcnt lgkmcnt(4)
M v[176:179],v[220:223],a[200:203],v[176:179]
s_waitcnt lgkmcnt(3)
M v[180:183],v[220:223],a[204:207],v[180:183]
s_waitcnt lgkmcnt(2)
M v[184:187],v[220:223],a[208:211],v[184:187]
s_waitcnt lgkmcnt(1)
M v[188:191],v[220:223],a[212:215],v[188:191]
s_waitcnt vmcnt(4)
M v[160:163],v[224:227],a[220:223],v[160:163]
ds_read_b128 a[220:223],v249 offset:2304
M v[164:167],v[224:227],a[192:195],v[164:167]
M v[168:171],v[224:227],a[196:199],v[168:171]
M v[172:175],v[224:227],a[200:203],v[172:175]
M v[176:179],v[224:227],a[204:207],v[176:179]
M v[180:183],v[224:227],a[208:211],v[180:183]
M v[184:187],v[224:227],a[212:215],v[184:187]
s_waitcnt lgkmcnt(1)
M v[188:191],v[224:227],a[216:219],v[188:191]
s_waitcnt vmcnt(3)
M v[160:163],v[228:231],a[192:195],v[160:163]
M v[164:167],v[228:231],a[196:199],v[164:167]
M v[168:171],v[228:231],a[200:203],v[168:171]
M v[172:175],v[228:231],a[204:207],v[172:175]
s_nop 4
v_cvt_pk_bf16_f32 v160,v160,v161
v_cvt_pk_bf16_f32 v161,v162,v163
M v[176:179],v[228:231],a[208:211],v[176:179]
v_cvt_pk_bf16_f32 v164,v164,v165
v_cvt_pk_bf16_f32 v165,v166,v167
M v[180:183],v[228:231],a[212:215],v[180:183]
ds_write2st64_b64 v253,v[160:161],v[164:165] offset0:17 offset1:21
M v[184:187],v[228:231],a[216:219],v[184:187]
s_waitcnt lgkmcnt(1)
v_cvt_pk_bf16_f32 v168,v168,v169
v_cvt_pk_bf16_f32 v169,v170,v171
M v[188:191],v[228:231],a[220:223],v[188:191]
v_cvt_pk_bf16_f32 v172,v172,v173
v_cvt_pk_bf16_f32 v173,v174,v175
ds_write2st64_b64 v253,v[168:169],v[172:173] offset0:25 offset1:29
v_cvt_pk_bf16_f32 v176,v176,v177
v_cvt_pk_bf16_f32 v177,v178,v179
v_cvt_pk_bf16_f32 v180,v180,v181
v_cvt_pk_bf16_f32 v181,v182,v183
ds_write2st64_b64 v253,v[176:177],v[180:181] offset0:68 offset1:72
v_cvt_pk_bf16_f32 v184,v184,v185
v_cvt_pk_bf16_f32 v185,v186,v187
v_cvt_pk_bf16_f32 v188,v188,v189
v_cvt_pk_bf16_f32 v189,v190,v191
ds_write2st64_b64 v253,v[184:185],v[188:189] offset0:76 offset1:80
s_waitcnt lgkmcnt(0)
s_barrier
ds_read_b128 v[160:163],v251 offset:8704
ds_read_b128 v[168:171],v251 offset:12800
ds_read_b128 v[176:179],v251 offset:34816
ds_read_b128 v[184:187],v251 offset:38912
s_add_u32 s34,s33,6291456
s_waitcnt lgkmcnt(3)
buffer_store_dwordx4 v[160:163],v252,s[24:27],s34 offen offset:1408 nt
s_nop 1
s_add_u32 s34,s33,6684672
s_waitcnt lgkmcnt(2)
buffer_store_dwordx4 v[168:171],v252,s[24:27],s34 offen offset:1408 nt
s_nop 1
s_add_u32 s34,s33,7077888
s_waitcnt lgkmcnt(1)
buffer_store_dwordx4 v[176:179],v252,s[24:27],s34 offen offset:1408 nt
s_nop 1
s_add_u32 s34,s33,7471104
s_waitcnt lgkmcnt(0)
buffer_store_dwordx4 v[184:187],v252,s[24:27],s34 offen offset:1408 nt
s_endpgm
L_code_end:
.section .rodata,"a"
.p2align 6
.amdhsa_kernel standalone__winograd__vision_kernel
  .amdhsa_next_free_vgpr 512
  .amdhsa_next_free_sgpr 94
  .amdhsa_accum_offset 256
  .amdhsa_group_segment_fixed_size 0
  .amdhsa_kernarg_size 40
  .amdhsa_user_sgpr_count 2
  .amdhsa_user_sgpr_kernarg_segment_ptr 1
  .amdhsa_system_sgpr_workgroup_id_x 1
  .amdhsa_float_denorm_mode_32 3
.end_amdhsa_kernel
```

```asm
; @launch grid=(256,1,1) block=(256,1,1) lds=156672
.amdgcn_target "amdgcn-amd-amdhsa--gfx950"
.macro M d,a,b,c
v_mfma_f32_16x16x32_bf16 \d,\a,\b,\c
.endm
.text
.globl standalone__winograd__vision_kernel
.p2align 8
.type standalone__winograd__vision_kernel,@function
standalone__winograd__vision_kernel:
s_cmp_ge_u32 s2,256
s_cbranch_scc0 L_go
s_endpgm
L_go:
s_load_dwordx4 s[4:7],s[0:1],0
s_load_dwordx4 s[24:27],s[0:1],16
s_load_dwordx2 s[52:53],s[0:1],32
v_lshrrev_b32 v60,6,v0
v_and_b32 v64,63,v0
v_readfirstlane_b32 s50,v60
v_lshrrev_b32 v60,4,v64
v_bfe_u32 v61,v64,3,1
v_lshl_add_u32 v61,v60,3,v61
v_and_b32 v62,7,v64
v_mul_u32_u24 v241,196608,v61
v_lshl_add_u32 v241,v62,3,v241
v_lshlrev_b32 v247,4,v0
v_bfe_u32 v63,v64,2,1
v_mul_u32_u24 v63,768,v63
v_mul_u32_u24 v250,196608,v61
v_add_u32 v250,v250,v63
s_and_b32 s54,s2,7
s_lshr_b32 s55,s2,3
s_lshl_b32 s49,s54,6
s_lshl_b32 s55,s55,4
s_lshl_b32 s56,s50,2
s_add_u32 s56,s56,s55
s_mul_i32 s31,s56,384
s_mul_i32 s57,s49,196608
s_add_u32 s30,s57,s31
s_mul_i32 s44,s50,330752
s_mov_b32 s58,0
s_add_u32 s59,s58,0
s_mul_i32 s60,s59,55296
s_lshl_b32 s59,s59,6
s_add_u32 s64,s30,s59
s_add_u32 s70,s31,s59
s_add_u32 s76,s44,s60
s_add_u32 s59,s58,1
s_mul_i32 s60,s59,55296
s_lshl_b32 s59,s59,6
s_add_u32 s65,s30,s59
s_add_u32 s71,s31,s59
s_add_u32 s77,s44,s60
s_add_u32 s59,s58,2
s_mul_i32 s60,s59,55296
s_lshl_b32 s59,s59,6
s_add_u32 s66,s30,s59
s_add_u32 s72,s31,s59
s_add_u32 s78,s44,s60
s_add_u32 s59,s58,3
s_mul_i32 s60,s59,55296
s_lshl_b32 s59,s59,6
s_add_u32 s67,s30,s59
s_add_u32 s73,s31,s59
s_add_u32 s79,s44,s60
s_add_u32 s59,s58,4
s_mul_i32 s60,s59,55296
s_lshl_b32 s59,s59,6
s_add_u32 s68,s30,s59
s_add_u32 s74,s31,s59
s_add_u32 s80,s44,s60
s_add_u32 s59,s58,5
s_cmp_eq_u32 s59,6
s_cselect_b32 s59,0,s59
s_mul_i32 s60,s59,55296
s_lshl_b32 s59,s59,6
s_add_u32 s69,s30,s59
s_add_u32 s75,s31,s59
s_add_u32 s81,s44,s60
s_waitcnt lgkmcnt(0)
s_mov_b32 s20,s52
s_and_b32 s21,s53,0xffff
s_mov_b32 s22,1327104
s_mov_b32 s23,0x20000
s_mov_b32 s36,s6
s_and_b32 s37,s7,0xffff
s_mov_b32 s38,663552
s_mov_b32 s39,0x20000
s_mov_b32 s60,s26
s_and_b32 s61,s27,0xffff
s_mov_b32 s62,0
s_mov_b32 s63,0x20000
s_mov_b32 s52,s26
s_mov_b32 s53,s27
v_mov_b32 v66,1
s_cmp_lt_u32 s2,54
s_cbranch_scc0 L_noitem
s_lshl_b32 s84,s2,2
s_add_u32 s84,s84,s50
s_mov_b32 s62,256
L_itemP:
s_and_b32 s85,s84,3
s_lshr_b32 s86,s84,2
s_mul_hi_u32 s87,s86,0x55555556
s_mul_i32 s88,s87,3
s_sub_u32 s86,s86,s88
s_mul_hi_u32 s88,s87,0x2aaaaaab
s_mul_i32 s89,s88,6
s_sub_u32 s87,s87,s89
s_mul_i32 s89,s86,221184
s_mul_i32 s90,s87,12288
s_add_u32 s89,s89,s90
s_mul_i32 s90,s85,3072
s_add_u32 s89,s89,s90
s_lshl_b32 s90,s88,7
s_add_u32 s89,s89,s90
s_add_u32 s90,s89,73728
s_add_u32 s91,s90,73728
v_lshlrev_b32 v149,1,v64
buffer_load_short_d16_hi v68,v149,s[36:39],s89 offen offset:0
buffer_load_short_d16_hi v69,v149,s[36:39],s89 offen offset:384
buffer_load_short_d16_hi v70,v149,s[36:39],s89 offen offset:768
buffer_load_short_d16_hi v71,v149,s[36:39],s89 offen offset:1152
buffer_load_short_d16_hi v72,v149,s[36:39],s89 offen offset:1536
buffer_load_short_d16_hi v73,v149,s[36:39],s89 offen offset:1920
buffer_load_short_d16_hi v74,v149,s[36:39],s89 offen offset:2304
buffer_load_short_d16_hi v75,v149,s[36:39],s89 offen offset:2688
buffer_load_short_d16_hi v76,v149,s[36:39],s90 offen offset:0
buffer_load_short_d16_hi v77,v149,s[36:39],s90 offen offset:384
buffer_load_short_d16_hi v78,v149,s[36:39],s90 offen offset:768
buffer_load_short_d16_hi v79,v149,s[36:39],s90 offen offset:1152
buffer_load_short_d16_hi v80,v149,s[36:39],s90 offen offset:1536
buffer_load_short_d16_hi v81,v149,s[36:39],s90 offen offset:1920
buffer_load_short_d16_hi v82,v149,s[36:39],s90 offen offset:2304
buffer_load_short_d16_hi v83,v149,s[36:39],s90 offen offset:2688
buffer_load_short_d16_hi v84,v149,s[36:39],s91 offen offset:0
buffer_load_short_d16_hi v85,v149,s[36:39],s91 offen offset:384
buffer_load_short_d16_hi v86,v149,s[36:39],s91 offen offset:768
buffer_load_short_d16_hi v87,v149,s[36:39],s91 offen offset:1152
buffer_load_short_d16_hi v88,v149,s[36:39],s91 offen offset:1536
buffer_load_short_d16_hi v89,v149,s[36:39],s91 offen offset:1920
buffer_load_short_d16_hi v90,v149,s[36:39],s91 offen offset:2304
buffer_load_short_d16_hi v91,v149,s[36:39],s91 offen offset:2688
v_lshrrev_b32 v150,4,v64
v_mul_u32_u24 v150,331776,v150
v_and_b32 v148,15,v64
v_lshl_add_u32 v150,v148,4,v150
s_mul_i32 s87,s87,55296
s_mul_i32 s88,s88,3072
s_add_u32 s87,s87,s88
s_lshl_b32 s86,s86,10
s_add_u32 s87,s87,s86
s_lshl_b32 s85,s85,8
s_add_u32 s87,s87,s85
s_mov_b32 s85,0xbe2aaaab
s_mov_b32 s86,0x3d2aaaab
s_mov_b32 s88,0x3e2aaaab
s_mov_b32 s92,0x3daaaaab
s_waitcnt vmcnt(0)
v_add_f32 v148,v68,v84
v_add_f32 v92,v148,v76
v_sub_f32 v100,v148,v76
v_mul_f32 v92,s85,v92
v_mul_f32 v100,s85,v100
v_mul_f32 v148,s86,v68
v_fmac_f32 v148,s88,v84
v_fma_f32 v108,s92,v76,v148
v_fma_f32 v116,-s92,v76,v148
v_add_f32 v148,v69,v85
v_add_f32 v93,v148,v77
v_sub_f32 v101,v148,v77
v_mul_f32 v93,s85,v93
v_mul_f32 v101,s85,v101
v_mul_f32 v148,s86,v69
v_fmac_f32 v148,s88,v85
v_fma_f32 v109,s92,v77,v148
v_fma_f32 v117,-s92,v77,v148
v_add_f32 v148,v70,v86
v_add_f32 v94,v148,v78
v_sub_f32 v102,v148,v78
v_mul_f32 v94,s85,v94
v_mul_f32 v102,s85,v102
v_mul_f32 v148,s86,v70
v_fmac_f32 v148,s88,v86
v_fma_f32 v110,s92,v78,v148
v_fma_f32 v118,-s92,v78,v148
v_add_f32 v148,v71,v87
v_add_f32 v95,v148,v79
v_sub_f32 v103,v148,v79
v_mul_f32 v95,s85,v95
v_mul_f32 v103,s85,v103
v_mul_f32 v148,s86,v71
v_fmac_f32 v148,s88,v87
v_fma_f32 v111,s92,v79,v148
v_fma_f32 v119,-s92,v79,v148
v_add_f32 v148,v72,v88
v_add_f32 v96,v148,v80
v_sub_f32 v104,v148,v80
v_mul_f32 v96,s85,v96
v_mul_f32 v104,s85,v104
v_mul_f32 v148,s86,v72
v_fmac_f32 v148,s88,v88
v_fma_f32 v112,s92,v80,v148
v_fma_f32 v120,-s92,v80,v148
v_add_f32 v148,v73,v89
v_add_f32 v97,v148,v81
v_sub_f32 v105,v148,v81
v_mul_f32 v97,s85,v97
v_mul_f32 v105,s85,v105
v_mul_f32 v148,s86,v73
v_fmac_f32 v148,s88,v89
v_fma_f32 v113,s92,v81,v148
v_fma_f32 v121,-s92,v81,v148
v_add_f32 v148,v74,v90
v_add_f32 v98,v148,v82
v_sub_f32 v106,v148,v82
v_mul_f32 v98,s85,v98
v_mul_f32 v106,s85,v106
v_mul_f32 v148,s86,v74
v_fmac_f32 v148,s88,v90
v_fma_f32 v114,s92,v82,v148
v_fma_f32 v122,-s92,v82,v148
v_add_f32 v148,v75,v91
v_add_f32 v99,v148,v83
v_sub_f32 v107,v148,v83
v_mul_f32 v99,s85,v99
v_mul_f32 v107,s85,v107
v_mul_f32 v148,s86,v75
v_fmac_f32 v148,s88,v91
v_fma_f32 v115,s92,v83,v148
v_fma_f32 v123,-s92,v83,v148
v_cvt_pk_bf16_f32 v124,v68,v69
v_cvt_pk_bf16_f32 v125,v70,v71
v_cvt_pk_bf16_f32 v126,v72,v73
v_cvt_pk_bf16_f32 v127,v74,v75
s_add_u32 s89,s87,0
buffer_store_dwordx4 v[124:127],v150,s[20:23],s89 offen sc1
v_cvt_pk_bf16_f32 v144,v84,v85
v_cvt_pk_bf16_f32 v145,v86,v87
v_cvt_pk_bf16_f32 v146,v88,v89
v_cvt_pk_bf16_f32 v147,v90,v91
s_add_u32 s89,s87,46080
buffer_store_dwordx4 v[144:147],v150,s[20:23],s89 offen sc1
v_cvt_pk_bf16_f32 v128,v92,v93
v_cvt_pk_bf16_f32 v129,v94,v95
v_cvt_pk_bf16_f32 v130,v96,v97
v_cvt_pk_bf16_f32 v131,v98,v99
s_add_u32 s89,s87,9216
buffer_store_dwordx4 v[128:131],v150,s[20:23],s89 offen sc1
v_cvt_pk_bf16_f32 v132,v100,v101
v_cvt_pk_bf16_f32 v133,v102,v103
v_cvt_pk_bf16_f32 v134,v104,v105
v_cvt_pk_bf16_f32 v135,v106,v107
s_add_u32 s89,s87,18432
buffer_store_dwordx4 v[132:135],v150,s[20:23],s89 offen sc1
v_cvt_pk_bf16_f32 v136,v108,v109
v_cvt_pk_bf16_f32 v137,v110,v111
v_cvt_pk_bf16_f32 v138,v112,v113
v_cvt_pk_bf16_f32 v139,v114,v115
s_add_u32 s89,s87,27648
buffer_store_dwordx4 v[136:139],v150,s[20:23],s89 offen sc1
v_cvt_pk_bf16_f32 v140,v116,v117
v_cvt_pk_bf16_f32 v141,v118,v119
v_cvt_pk_bf16_f32 v142,v120,v121
v_cvt_pk_bf16_f32 v143,v122,v123
s_add_u32 s89,s87,36864
buffer_store_dwordx4 v[140:143],v150,s[20:23],s89 offen sc1
L_noitem:
s_and_b32 s94,s50,1
s_waitcnt vmcnt(0)
s_lshl_b32 s85,s94,6
s_lshl_b32 s84,s94,2
s_mov_b64 exec,1
buffer_atomic_add v66,off,s[60:63],s85 sc0 sc1
s_mov_b64 exec,-1
s_mov_b32 s8,s4
s_and_b32 s9,s5,0xffff
s_mov_b32 s10,100663296
s_mov_b32 s11,0x20000
s_sub_u32 s12,s4,384
s_subb_u32 s13,s9,0
s_cmp_eq_u32 s56,0
s_cselect_b32 s14,0,100663680
s_mov_b32 s15,0x20000
s_mov_b32 s16,s4
s_mov_b32 s17,s9
s_cmp_eq_u32 s56,508
s_cselect_b32 s18,0,100663296
s_mov_b32 s19,0x20000
v_bfe_u32 v228,v247,9,1
v_mul_u32_u24 v228,33,v228
v_add_u32 v228,s49,v228
v_add_u32 v228,-1,v228
v_mul_u32_u24 v229,196608,v228
v_cmp_gt_u32 vcc,512,v228
v_bfe_u32 v228,v247,3,6
v_add_u32 v229,v229,v228
v_bfrev_b32 v228,1
v_cndmask_b32 v242,v228,v229,vcc
s_add_u32 s28,s64,0
buffer_load_dwordx2 v[0:1],v241,s[12:15],s28 offen offset:0
buffer_load_dwordx2 v[10:11],v241,s[16:19],s28 offen offset:1536
buffer_load_dwordx2 v[2:3],v241,s[8:11],s28 offen offset:0
buffer_load_dwordx2 v[4:5],v241,s[8:11],s28 offen offset:384
buffer_load_dwordx2 v[6:7],v241,s[8:11],s28 offen offset:768
buffer_load_dwordx2 v[8:9],v241,s[8:11],s28 offen offset:1152
s_mov_b64 exec,1
s_waitcnt vmcnt(6)
v_cmp_eq_u32 vcc,107,v66
v_mov_b32 v65,1
s_nop 2
s_and_b64 exec,exec,vcc
s_cselect_b32 s62,s62,0
s_mov_b64 exec,1
buffer_store_dword v65,off,s[60:63],s84 offset:128 sc1
s_mov_b64 exec,-1
s_add_u32 s28,s64,393216
buffer_load_dwordx2 v[12:13],v241,s[12:15],s28 offen offset:0
buffer_load_dwordx2 v[22:23],v241,s[16:19],s28 offen offset:1536
buffer_load_dwordx2 v[14:15],v241,s[8:11],s28 offen offset:0
buffer_load_dwordx2 v[16:17],v241,s[8:11],s28 offen offset:384
buffer_load_dwordx2 v[18:19],v241,s[8:11],s28 offen offset:768
buffer_load_dwordx2 v[20:21],v241,s[8:11],s28 offen offset:1152
s_add_u32 s28,s64,786432
buffer_load_dwordx2 v[24:25],v241,s[12:15],s28 offen offset:0
buffer_load_dwordx2 v[34:35],v241,s[16:19],s28 offen offset:1536
buffer_load_dwordx2 v[26:27],v241,s[8:11],s28 offen offset:0
buffer_load_dwordx2 v[28:29],v241,s[8:11],s28 offen offset:384
buffer_load_dwordx2 v[30:31],v241,s[8:11],s28 offen offset:768
buffer_load_dwordx2 v[32:33],v241,s[8:11],s28 offen offset:1152
s_add_u32 s28,s64,1179648
buffer_load_dwordx2 v[36:37],v241,s[12:15],s28 offen offset:0
buffer_load_dwordx2 v[46:47],v241,s[16:19],s28 offen offset:1536
buffer_load_dwordx2 v[38:39],v241,s[8:11],s28 offen offset:0
buffer_load_dwordx2 v[40:41],v241,s[8:11],s28 offen offset:384
buffer_load_dwordx2 v[42:43],v241,s[8:11],s28 offen offset:768
buffer_load_dwordx2 v[44:45],v241,s[8:11],s28 offen offset:1152
buffer_load_short_d16_hi v48,v242,s[12:15],s70 offen offset:0
buffer_load_short_d16_hi v49,v242,s[8:11],s70 offen offset:0
buffer_load_short_d16_hi v50,v242,s[8:11],s70 offen offset:384
buffer_load_short_d16_hi v51,v242,s[8:11],s70 offen offset:768
buffer_load_short_d16_hi v52,v242,s[8:11],s70 offen offset:1152
buffer_load_short_d16_hi v53,v242,s[16:19],s70 offen offset:1536
s_getpc_b64 s[82:83]
L_pc:
s_lshr_b32 s84,s2,3
s_lshl_b32 s84,s84,2
s_add_u32 s84,s84,s50
s_lshl_b32 s84,s84,10
v_and_b32 v65,7,v64
v_lshl_add_u32 v65,v65,7,s84
v_min_u32 v65,L_code_end-L_pc-4,v65
global_load_dword v67,v65,s[82:83]
v_mov_b32 v252,v65
s_and_b32 s25,s25,0xffff
s_mov_b32 s26,100663296
s_mov_b32 s27,0x20000
s_mov_b32 s41,0xc0a00000
s_mov_b32 s40,0x41000000
s_mov_b32 s42,0xffff0000
s_mov_b32 s43,0xbfa00000
s_mov_b32 s45,0x3e800000
s_mul_i32 s58,s55,384
s_add_u32 s58,s57,s58
s_lshr_b32 s59,s50,1
s_mul_i32 s32,s59,384
s_mul_i32 s33,s59,196608
s_add_u32 s32,s32,s58
s_add_u32 s33,s33,s58
s_lshl_b32 s59,s50,6
v_lshlrev_b32 v243,8,v61
v_and_b32 v63,1,v60
v_xor_b32 v63,1,v63
v_lshlrev_b32 v63,2,v63
v_xor_b32 v63,v63,v62
v_lshl_add_u32 v243,v63,3,v243
v_add_u32 v243,s59,v243
v_add_u32 v243,256,v243
v_lshrrev_b32 v60,5,v64
v_mul_u32_u24 v244,8448,v60
v_lshlrev_b32 v60,5,v60
v_bfe_u32 v61,v247,3,6
v_xor_b32 v61,v61,v60
v_add3_u32 v244,v244,v61,s59
v_bfe_u32 v60,v64,2,2
v_and_b32 v61,3,v64
v_lshrrev_b32 v62,4,v64
v_lshlrev_b32 v245,11,v60
v_lshl_add_u32 v245,v61,6,v245
v_and_b32 v63,1,v60
v_lshlrev_b32 v63,1,v63
v_xor_b32 v63,v63,v62
v_lshl_add_u32 v245,v63,4,v245
v_xor_b32 v246,32,v245
v_lshrrev_b32 v60,1,v62
v_lshl_add_u32 v60,s50,1,v60
v_and_b32 v61,7,v64
v_xor_b32 v60,v60,v61
v_and_b32 v63,15,v64
v_lshlrev_b32 v249,7,v63
v_lshl_add_u32 v249,v60,4,v249
v_and_b32 v63,1,v62
v_lshl_add_u32 v249,v63,3,v249
v_bfe_u32 v60,v247,7,4
v_lshrrev_b32 v62,2,v60
v_mul_u32_u24 v248,1572864,v62
v_and_b32 v62,3,v60
v_mul_u32_u24 v62,1536,v62
v_and_b32 v60,7,v60
v_xor_b32 v60,v60,v61
v_lshl_add_u32 v60,v60,4,v62
v_add_u32 v248,v248,v60
s_waitcnt vmcnt(28)
v_lshlrev_b32 v230,16,v4
v_lshlrev_b32 v228,16,v0
v_lshlrev_b32 v229,16,v2
v_lshlrev_b32 v233,16,v10
s_waitcnt vmcnt(26)
v_lshlrev_b32 v232,16,v8
v_lshlrev_b32 v231,16,v6
v_fmac_f32 v228,s43,v230
v_fmac_f32 v233,4.0,v229
v_fma_f32 v234,-4.0,v230,v232
v_fmac_f32 v228,s45,v232
v_fmac_f32 v233,s41,v231
v_sub_f32 v232,v232,v230
v_fma_f32 v230,-4.0,v229,v231
v_sub_f32 v231,v231,v229
v_add_f32 v229,v234,v230
v_sub_f32 v234,v234,v230
v_fma_f32 v230,2.0,v231,v232
v_fmac_f32 v232,-2.0,v231
v_and_b32 v4,s42,v4
v_and_b32 v0,s42,v0
v_and_b32 v2,s42,v2
v_and_b32 v10,s42,v10
v_and_b32 v8,s42,v8
v_and_b32 v6,s42,v6
v_fmac_f32 v0,s43,v4
v_fmac_f32 v10,4.0,v2
v_fma_f32 v231,-4.0,v4,v8
v_fmac_f32 v0,s45,v8
v_fmac_f32 v10,s41,v6
v_sub_f32 v8,v8,v4
v_fma_f32 v4,-4.0,v2,v6
v_sub_f32 v6,v6,v2
v_add_f32 v2,v231,v4
v_sub_f32 v231,v231,v4
v_fma_f32 v4,2.0,v6,v8
v_fmac_f32 v8,-2.0,v6
v_cvt_pk_bf16_f32 v0,v228,v0
v_cvt_pk_bf16_f32 v10,v233,v10
v_cvt_pk_bf16_f32 v2,v229,v2
v_cvt_pk_bf16_f32 v6,v230,v4
v_cvt_pk_bf16_f32 v4,v234,v231
v_cvt_pk_bf16_f32 v8,v232,v8
v_lshlrev_b32 v230,16,v5
v_lshlrev_b32 v228,16,v1
v_lshlrev_b32 v229,16,v3
v_lshlrev_b32 v233,16,v11
v_lshlrev_b32 v232,16,v9
v_lshlrev_b32 v231,16,v7
v_fmac_f32 v228,s43,v230
v_fmac_f32 v233,4.0,v229
v_fma_f32 v234,-4.0,v230,v232
v_fmac_f32 v228,s45,v232
v_fmac_f32 v233,s41,v231
v_sub_f32 v232,v232,v230
v_fma_f32 v230,-4.0,v229,v231
v_sub_f32 v231,v231,v229
v_add_f32 v229,v234,v230
v_sub_f32 v234,v234,v230
v_fma_f32 v230,2.0,v231,v232
v_fmac_f32 v232,-2.0,v231
v_and_b32 v5,s42,v5
v_and_b32 v1,s42,v1
v_and_b32 v3,s42,v3
v_and_b32 v11,s42,v11
v_and_b32 v9,s42,v9
v_and_b32 v7,s42,v7
v_fmac_f32 v1,s43,v5
v_fmac_f32 v11,4.0,v3
v_fma_f32 v231,-4.0,v5,v9
v_fmac_f32 v1,s45,v9
v_fmac_f32 v11,s41,v7
v_sub_f32 v9,v9,v5
v_fma_f32 v5,-4.0,v3,v7
v_sub_f32 v7,v7,v3
v_add_f32 v3,v231,v5
v_sub_f32 v231,v231,v5
v_fma_f32 v5,2.0,v7,v9
v_fmac_f32 v9,-2.0,v7
v_cvt_pk_bf16_f32 v1,v228,v1
v_cvt_pk_bf16_f32 v11,v233,v11
v_cvt_pk_bf16_f32 v3,v229,v3
v_cvt_pk_bf16_f32 v7,v230,v5
v_cvt_pk_bf16_f32 v5,v234,v231
v_cvt_pk_bf16_f32 v9,v232,v9
ds_write2st64_b64 v243,v[0:1],v[10:11] offset0:0 offset1:17
ds_write2st64_b64 v243,v[2:3],v[4:5] offset0:34 offset1:51
ds_write2st64_b64 v243,v[6:7],v[8:9] offset0:68 offset1:85
s_waitcnt vmcnt(21)
v_lshlrev_b32 v230,16,v16
v_lshlrev_b32 v228,16,v12
v_lshlrev_b32 v229,16,v14
v_lshlrev_b32 v233,16,v22
s_waitcnt vmcnt(19)
v_lshlrev_b32 v232,16,v20
v_lshlrev_b32 v231,16,v18
v_fmac_f32 v228,s43,v230
v_fmac_f32 v233,4.0,v229
v_fma_f32 v234,-4.0,v230,v232
v_fmac_f32 v228,s45,v232
v_fmac_f32 v233,s41,v231
v_sub_f32 v232,v232,v230
v_fma_f32 v230,-4.0,v229,v231
v_sub_f32 v231,v231,v229
v_add_f32 v229,v234,v230
v_sub_f32 v234,v234,v230
v_fma_f32 v230,2.0,v231,v232
v_fmac_f32 v232,-2.0,v231
v_and_b32 v16,s42,v16
v_and_b32 v12,s42,v12
v_and_b32 v14,s42,v14
v_and_b32 v22,s42,v22
v_and_b32 v20,s42,v20
v_and_b32 v18,s42,v18
v_fmac_f32 v12,s43,v16
v_fmac_f32 v22,4.0,v14
v_fma_f32 v231,-4.0,v16,v20
v_fmac_f32 v12,s45,v20
v_fmac_f32 v22,s41,v18
v_sub_f32 v20,v20,v16
v_fma_f32 v16,-4.0,v14,v18
v_sub_f32 v18,v18,v14
v_add_f32 v14,v231,v16
v_sub_f32 v231,v231,v16
v_fma_f32 v16,2.0,v18,v20
v_fmac_f32 v20,-2.0,v18
v_cvt_pk_bf16_f32 v12,v228,v12
v_cvt_pk_bf16_f32 v22,v233,v22
v_cvt_pk_bf16_f32 v14,v229,v14
v_cvt_pk_bf16_f32 v18,v230,v16
v_cvt_pk_bf16_f32 v16,v234,v231
v_cvt_pk_bf16_f32 v20,v232,v20
v_lshlrev_b32 v230,16,v17
v_lshlrev_b32 v228,16,v13
v_lshlrev_b32 v229,16,v15
v_lshlrev_b32 v233,16,v23
v_lshlrev_b32 v232,16,v21
v_lshlrev_b32 v231,16,v19
v_fmac_f32 v228,s43,v230
v_fmac_f32 v233,4.0,v229
v_fma_f32 v234,-4.0,v230,v232
v_fmac_f32 v228,s45,v232
v_fmac_f32 v233,s41,v231
v_sub_f32 v232,v232,v230
v_fma_f32 v230,-4.0,v229,v231
v_sub_f32 v231,v231,v229
v_add_f32 v229,v234,v230
v_sub_f32 v234,v234,v230
v_fma_f32 v230,2.0,v231,v232
v_fmac_f32 v232,-2.0,v231
v_and_b32 v17,s42,v17
v_and_b32 v13,s42,v13
v_and_b32 v15,s42,v15
v_and_b32 v23,s42,v23
v_and_b32 v21,s42,v21
v_and_b32 v19,s42,v19
v_fmac_f32 v13,s43,v17
v_fmac_f32 v23,4.0,v15
v_fma_f32 v231,-4.0,v17,v21
v_fmac_f32 v13,s45,v21
v_fmac_f32 v23,s41,v19
v_sub_f32 v21,v21,v17
v_fma_f32 v17,-4.0,v15,v19
v_sub_f32 v19,v19,v15
v_add_f32 v15,v231,v17
v_sub_f32 v231,v231,v17
v_fma_f32 v17,2.0,v19,v21
v_fmac_f32 v21,-2.0,v19
v_cvt_pk_bf16_f32 v13,v228,v13
v_cvt_pk_bf16_f32 v23,v233,v23
v_cvt_pk_bf16_f32 v15,v229,v15
v_cvt_pk_bf16_f32 v19,v230,v17
v_cvt_pk_bf16_f32 v17,v234,v231
v_cvt_pk_bf16_f32 v21,v232,v21
ds_write2st64_b64 v243,v[12:13],v[22:23] offset0:1 offset1:18
ds_write2st64_b64 v243,v[14:15],v[16:17] offset0:35 offset1:52
ds_write2st64_b64 v243,v[18:19],v[20:21] offset0:69 offset1:86
s_add_u32 s28,s65,0
buffer_load_dwordx2 v[192:193],v241,s[12:15],s28 offen offset:0
buffer_load_dwordx2 v[202:203],v241,s[16:19],s28 offen offset:1536
buffer_load_dwordx2 v[194:195],v241,s[8:11],s28 offen offset:0
buffer_load_dwordx2 v[196:197],v241,s[8:11],s28 offen offset:384
buffer_load_dwordx2 v[198:199],v241,s[8:11],s28 offen offset:768
buffer_load_dwordx2 v[200:201],v241,s[8:11],s28 offen offset:1152
s_add_u32 s28,s65,393216
buffer_load_dwordx2 v[204:205],v241,s[12:15],s28 offen offset:0
buffer_load_dwordx2 v[214:215],v241,s[16:19],s28 offen offset:1536
buffer_load_dwordx2 v[206:207],v241,s[8:11],s28 offen offset:0
buffer_load_dwordx2 v[208:209],v241,s[8:11],s28 offen offset:384
buffer_load_dwordx2 v[210:211],v241,s[8:11],s28 offen offset:768
buffer_load_dwordx2 v[212:213],v241,s[8:11],s28 offen offset:1152
buffer_load_short_d16_hi v235,v242,s[12:15],s71 offen offset:0
buffer_load_short_d16_hi v236,v242,s[8:11],s71 offen offset:0
buffer_load_short_d16_hi v237,v242,s[8:11],s71 offen offset:384
buffer_load_short_d16_hi v238,v242,s[8:11],s71 offen offset:768
buffer_load_short_d16_hi v239,v242,s[8:11],s71 offen offset:1152
buffer_load_short_d16_hi v240,v242,s[16:19],s71 offen offset:1536
s_waitcnt vmcnt(33)
v_lshlrev_b32 v230,16,v28
v_lshlrev_b32 v228,16,v24
v_lshlrev_b32 v229,16,v26
v_lshlrev_b32 v233,16,v34
s_waitcnt vmcnt(31)
v_lshlrev_b32 v232,16,v32
v_lshlrev_b32 v231,16,v30
v_fmac_f32 v228,s43,v230
v_fmac_f32 v233,4.0,v229
v_fma_f32 v234,-4.0,v230,v232
v_fmac_f32 v228,s45,v232
v_fmac_f32 v233,s41,v231
v_sub_f32 v232,v232,v230
v_fma_f32 v230,-4.0,v229,v231
v_sub_f32 v231,v231,v229
v_add_f32 v229,v234,v230
v_sub_f32 v234,v234,v230
v_fma_f32 v230,2.0,v231,v232
v_fmac_f32 v232,-2.0,v231
v_and_b32 v28,s42,v28
v_and_b32 v24,s42,v24
v_and_b32 v26,s42,v26
v_and_b32 v34,s42,v34
v_and_b32 v32,s42,v32
v_and_b32 v30,s42,v30
v_fmac_f32 v24,s43,v28
v_fmac_f32 v34,4.0,v26
v_fma_f32 v231,-4.0,v28,v32
v_fmac_f32 v24,s45,v32
v_fmac_f32 v34,s41,v30
v_sub_f32 v32,v32,v28
v_fma_f32 v28,-4.0,v26,v30
v_sub_f32 v30,v30,v26
v_add_f32 v26,v231,v28
v_sub_f32 v231,v231,v28
v_fma_f32 v28,2.0,v30,v32
v_fmac_f32 v32,-2.0,v30
v_cvt_pk_bf16_f32 v24,v228,v24
v_cvt_pk_bf16_f32 v34,v233,v34
v_cvt_pk_bf16_f32 v26,v229,v26
v_cvt_pk_bf16_f32 v30,v230,v28
v_cvt_pk_bf16_f32 v28,v234,v231
v_cvt_pk_bf16_f32 v32,v232,v32
v_lshlrev_b32 v230,16,v29
v_lshlrev_b32 v228,16,v25
v_lshlrev_b32 v229,16,v27
v_lshlrev_b32 v233,16,v35
v_lshlrev_b32 v232,16,v33
v_lshlrev_b32 v231,16,v31
v_fmac_f32 v228,s43,v230
v_fmac_f32 v233,4.0,v229
v_fma_f32 v234,-4.0,v230,v232
v_fmac_f32 v228,s45,v232
v_fmac_f32 v233,s41,v231
v_sub_f32 v232,v232,v230
v_fma_f32 v230,-4.0,v229,v231
v_sub_f32 v231,v231,v229
v_add_f32 v229,v234,v230
v_sub_f32 v234,v234,v230
v_fma_f32 v230,2.0,v231,v232
v_fmac_f32 v232,-2.0,v231
v_and_b32 v29,s42,v29
v_and_b32 v25,s42,v25
v_and_b32 v27,s42,v27
v_and_b32 v35,s42,v35
v_and_b32 v33,s42,v33
v_and_b32 v31,s42,v31
v_fmac_f32 v25,s43,v29
v_fmac_f32 v35,4.0,v27
v_fma_f32 v231,-4.0,v29,v33
v_fmac_f32 v25,s45,v33
v_fmac_f32 v35,s41,v31
v_sub_f32 v33,v33,v29
v_fma_f32 v29,-4.0,v27,v31
v_sub_f32 v31,v31,v27
v_add_f32 v27,v231,v29
v_sub_f32 v231,v231,v29
v_fma_f32 v29,2.0,v31,v33
v_fmac_f32 v33,-2.0,v31
v_cvt_pk_bf16_f32 v25,v228,v25
v_cvt_pk_bf16_f32 v35,v233,v35
v_cvt_pk_bf16_f32 v27,v229,v27
v_cvt_pk_bf16_f32 v31,v230,v29
v_cvt_pk_bf16_f32 v29,v234,v231
v_cvt_pk_bf16_f32 v33,v232,v33
ds_write2st64_b64 v243,v[24:25],v[34:35] offset0:2 offset1:19
ds_write2st64_b64 v243,v[26:27],v[28:29] offset0:36 offset1:53
ds_write2st64_b64 v243,v[30:31],v[32:33] offset0:70 offset1:87
s_waitcnt vmcnt(27)
v_lshlrev_b32 v230,16,v40
v_lshlrev_b32 v228,16,v36
v_lshlrev_b32 v229,16,v38
v_lshlrev_b32 v233,16,v46
s_waitcnt vmcnt(25)
v_lshlrev_b32 v232,16,v44
v_lshlrev_b32 v231,16,v42
v_fmac_f32 v228,s43,v230
v_fmac_f32 v233,4.0,v229
v_fma_f32 v234,-4.0,v230,v232
v_fmac_f32 v228,s45,v232
v_fmac_f32 v233,s41,v231
v_sub_f32 v232,v232,v230
v_fma_f32 v230,-4.0,v229,v231
v_sub_f32 v231,v231,v229
v_add_f32 v229,v234,v230
v_sub_f32 v234,v234,v230
v_fma_f32 v230,2.0,v231,v232
v_fmac_f32 v232,-2.0,v231
v_and_b32 v40,s42,v40
v_and_b32 v36,s42,v36
v_and_b32 v38,s42,v38
v_and_b32 v46,s42,v46
v_and_b32 v44,s42,v44
v_and_b32 v42,s42,v42
v_fmac_f32 v36,s43,v40
v_fmac_f32 v46,4.0,v38
v_fma_f32 v231,-4.0,v40,v44
v_fmac_f32 v36,s45,v44
v_fmac_f32 v46,s41,v42
v_sub_f32 v44,v44,v40
v_fma_f32 v40,-4.0,v38,v42
v_sub_f32 v42,v42,v38
v_add_f32 v38,v231,v40
v_sub_f32 v231,v231,v40
v_fma_f32 v40,2.0,v42,v44
v_fmac_f32 v44,-2.0,v42
v_cvt_pk_bf16_f32 v36,v228,v36
v_cvt_pk_bf16_f32 v46,v233,v46
v_cvt_pk_bf16_f32 v38,v229,v38
v_cvt_pk_bf16_f32 v42,v230,v40
v_cvt_pk_bf16_f32 v40,v234,v231
v_cvt_pk_bf16_f32 v44,v232,v44
v_lshlrev_b32 v230,16,v41
v_lshlrev_b32 v228,16,v37
v_lshlrev_b32 v229,16,v39
v_lshlrev_b32 v233,16,v47
v_lshlrev_b32 v232,16,v45
v_lshlrev_b32 v231,16,v43
v_fmac_f32 v228,s43,v230
v_fmac_f32 v233,4.0,v229
v_fma_f32 v234,-4.0,v230,v232
v_fmac_f32 v228,s45,v232
v_fmac_f32 v233,s41,v231
v_sub_f32 v232,v232,v230
v_fma_f32 v230,-4.0,v229,v231
v_sub_f32 v231,v231,v229
v_add_f32 v229,v234,v230
v_sub_f32 v234,v234,v230
v_fma_f32 v230,2.0,v231,v232
v_fmac_f32 v232,-2.0,v231
v_and_b32 v41,s42,v41
v_and_b32 v37,s42,v37
v_and_b32 v39,s42,v39
v_and_b32 v47,s42,v47
v_and_b32 v45,s42,v45
v_and_b32 v43,s42,v43
v_fmac_f32 v37,s43,v41
v_fmac_f32 v47,4.0,v39
v_fma_f32 v231,-4.0,v41,v45
v_fmac_f32 v37,s45,v45
v_fmac_f32 v47,s41,v43
v_sub_f32 v45,v45,v41
v_fma_f32 v41,-4.0,v39,v43
v_sub_f32 v43,v43,v39
v_add_f32 v39,v231,v41
v_sub_f32 v231,v231,v41
v_fma_f32 v41,2.0,v43,v45
v_fmac_f32 v45,-2.0,v43
v_cvt_pk_bf16_f32 v37,v228,v37
v_cvt_pk_bf16_f32 v47,v233,v47
v_cvt_pk_bf16_f32 v39,v229,v39
v_cvt_pk_bf16_f32 v43,v230,v41
v_cvt_pk_bf16_f32 v41,v234,v231
v_cvt_pk_bf16_f32 v45,v232,v45
ds_write2st64_b64 v243,v[36:37],v[46:47] offset0:3 offset1:20
ds_write2st64_b64 v243,v[38:39],v[40:41] offset0:37 offset1:54
ds_write2st64_b64 v243,v[42:43],v[44:45] offset0:71 offset1:88
s_waitcnt vmcnt(22)
v_fmac_f32 v48,s43,v50
s_waitcnt vmcnt(19)
v_fmac_f32 v53,4.0,v49
v_fma_f32 v228,-4.0,v50,v52
v_fmac_f32 v48,s45,v52
v_fmac_f32 v53,s41,v51
v_sub_f32 v52,v52,v50
v_fma_f32 v50,-4.0,v49,v51
v_sub_f32 v51,v51,v49
v_add_f32 v49,v228,v50
v_sub_f32 v228,v228,v50
v_fma_f32 v50,2.0,v51,v52
v_fmac_f32 v52,-2.0,v51
v_cvt_pk_bf16_f32 v229,v48,v53
v_cvt_pk_bf16_f32 v230,v49,v228
v_cvt_pk_bf16_f32 v231,v50,v52
ds_write_b16 v244,v229 offset:0
ds_write_b16_d16_hi v244,v229 offset:8704
ds_write_b16 v244,v230 offset:17408
ds_write_b16_d16_hi v244,v230 offset:26112
ds_write_b16 v244,v231 offset:34816
ds_write_b16_d16_hi v244,v231 offset:43520
s_waitcnt lgkmcnt(0)
s_barrier
ds_read_b128 a[192:195],v245 offset:17408
ds_read_b128 a[196:199],v246 offset:17664
ds_read_b128 a[200:203],v246 offset:17920
ds_read_b128 a[204:207],v246 offset:18176
ds_read_b128 a[208:211],v246 offset:18432
ds_read_b128 a[212:215],v246 offset:18688
ds_read_b128 a[216:219],v246 offset:18944
ds_read_b128 a[220:223],v246 offset:19200
v_and_b32 v65,1,v64
v_lshlrev_b32 v65,2,v65
s_mov_b32 s84,0
L_poll:
global_load_dword v66,v65,s[52:53] offset:128 sc1
s_add_u32 s84,s84,1
s_waitcnt vmcnt(0)
v_cmp_eq_u32 vcc,0,v66
s_cmp_gt_u32 s84,0x4000
s_cbranch_scc1 L_fallback
s_cbranch_vccnz L_poll
L_uready:
s_add_u32 s46,s76,9216
buffer_load_dwordx4 a[224:227],v247,s[20:23],s46 offen offset:0 sc1
s_add_u32 s47,s76,12288
buffer_load_dwordx4 a[228:231],v247,s[20:23],s47 offen offset:0 sc1
s_add_u32 s48,s76,15360
buffer_load_dwordx4 a[232:235],v247,s[20:23],s48 offen offset:0 sc1
buffer_load_dwordx4 a[236:239],v247,s[20:23],s46 offen offset:1024 sc1
s_waitcnt vmcnt(3) lgkmcnt(7)
M a[0:3],a[224:227],a[192:195],0
s_waitcnt lgkmcnt(6)
buffer_load_dwordx4 a[240:243],v247,s[20:23],s47 offen offset:1024 sc1
M a[4:7],a[224:227],a[196:199],0
s_waitcnt lgkmcnt(5)
v_lshlrev_b32 v230,16,v196
v_lshlrev_b32 v228,16,v192
M a[8:11],a[224:227],a[200:203],0
s_waitcnt lgkmcnt(4)
buffer_load_dwordx4 a[244:247],v247,s[20:23],s48 offen offset:1024 sc1
M a[12:15],a[224:227],a[204:207],0
s_waitcnt lgkmcnt(3)
v_lshlrev_b32 v229,16,v194
v_lshlrev_b32 v233,16,v202
M a[16:19],a[224:227],a[208:211],0
s_waitcnt lgkmcnt(2)
v_lshlrev_b32 v232,16,v200
v_lshlrev_b32 v231,16,v198
M a[20:23],a[224:227],a[212:215],0
s_waitcnt lgkmcnt(1)
v_fmac_f32 v228,s43,v230
v_fmac_f32 v233,4.0,v229
M a[24:27],a[224:227],a[216:219],0
s_waitcnt lgkmcnt(0)
buffer_load_dwordx4 a[248:251],v247,s[20:23],s46 offen offset:2048 sc1
v_fma_f32 v234,-4.0,v230,v232
M a[28:31],a[224:227],a[220:223],0
s_waitcnt vmcnt(5)
v_fmac_f32 v228,s45,v232
v_fmac_f32 v233,s41,v231
M a[32:35],a[228:231],a[192:195],0
v_sub_f32 v232,v232,v230
v_fma_f32 v230,-4.0,v229,v231
M a[36:39],a[228:231],a[196:199],0
v_sub_f32 v231,v231,v229
v_add_f32 v229,v234,v230
M a[40:43],a[228:231],a[200:203],0
buffer_load_dwordx4 a[252:255],v247,s[20:23],s47 offen offset:2048 sc1
M a[44:47],a[228:231],a[204:207],0
v_sub_f32 v234,v234,v230
v_fma_f32 v230,2.0,v231,v232
M a[48:51],a[228:231],a[208:211],0
v_fmac_f32 v232,-2.0,v231
v_and_b32 v196,s42,v196
M a[52:55],a[228:231],a[212:215],0
v_and_b32 v192,s42,v192
v_and_b32 v194,s42,v194
v_and_b32 v202,s42,v202
M a[56:59],a[228:231],a[216:219],0
buffer_load_dwordx4 a[224:227],v247,s[20:23],s48 offen offset:2048 sc1
M a[60:63],a[228:231],a[220:223],0
s_waitcnt vmcnt(6)
s_add_u32 s46,s76,18432
v_and_b32 v200,s42,v200
v_and_b32 v198,s42,v198
M a[64:67],a[232:235],a[192:195],0
ds_read_b128 a[192:195],v246 offset:19456
v_fmac_f32 v192,s43,v196
M a[68:71],a[232:235],a[196:199],0
v_fmac_f32 v202,4.0,v194
v_fma_f32 v231,-4.0,v196,v200
M a[72:75],a[232:235],a[200:203],0
buffer_load_dwordx4 v[216:219],v247,s[20:23],s46 offen offset:0 sc1
M a[76:79],a[232:235],a[204:207],0
s_add_u32 s47,s76,21504
v_fmac_f32 v192,s45,v200
v_fmac_f32 v202,s41,v198
M a[80:83],a[232:235],a[208:211],0
v_sub_f32 v200,v200,v196
v_fma_f32 v196,-4.0,v194,v198
v_sub_f32 v198,v198,v194
M a[84:87],a[232:235],a[212:215],0
v_add_f32 v194,v231,v196
v_sub_f32 v231,v231,v196
M a[88:91],a[232:235],a[216:219],0
buffer_load_dwordx4 v[220:223],v247,s[20:23],s47 offen offset:0 sc1
M a[92:95],a[232:235],a[220:223],0
s_waitcnt vmcnt(7)
s_add_u32 s48,s76,24576
v_fma_f32 v196,2.0,v198,v200
v_fmac_f32 v200,-2.0,v198
M a[0:3],a[236:239],a[196:199],a[0:3]
v_cvt_pk_bf16_f32 v192,v228,v192
v_cvt_pk_bf16_f32 v202,v233,v202
M a[4:7],a[236:239],a[200:203],a[4:7]
v_cvt_pk_bf16_f32 v194,v229,v194
v_cvt_pk_bf16_f32 v198,v230,v196
M a[8:11],a[236:239],a[204:207],a[8:11]
buffer_load_dwordx4 v[224:227],v247,s[20:23],s48 offen offset:0 sc1
M a[12:15],a[236:239],a[208:211],a[12:15]
v_cvt_pk_bf16_f32 v196,v234,v231
v_cvt_pk_bf16_f32 v200,v232,v200
v_lshlrev_b32 v230,16,v197
M a[16:19],a[236:239],a[212:215],a[16:19]
v_lshlrev_b32 v228,16,v193
v_lshlrev_b32 v229,16,v195
M a[20:23],a[236:239],a[216:219],a[20:23]
buffer_load_dwordx4 a[228:231],v247,s[20:23],s46 offen offset:1024 sc1
M a[24:27],a[236:239],a[220:223],a[24:27]
s_waitcnt lgkmcnt(0)
v_lshlrev_b32 v233,16,v203
v_lshlrev_b32 v232,16,v201
M a[28:31],a[236:239],a[192:195],a[28:31]
s_waitcnt vmcnt(8)
v_lshlrev_b32 v231,16,v199
v_fmac_f32 v228,s43,v230
M a[32:35],a[240:243],a[196:199],a[32:35]
v_fmac_f32 v233,4.0,v229
v_fma_f32 v234,-4.0,v230,v232
M a[36:39],a[240:243],a[200:203],a[36:39]
buffer_load_dwordx4 a[232:235],v247,s[20:23],s47 offen offset:1024 sc1
M a[40:43],a[240:243],a[204:207],a[40:43]
v_fmac_f32 v228,s45,v232
v_fmac_f32 v233,s41,v231
v_sub_f32 v232,v232,v230
M a[44:47],a[240:243],a[208:211],a[44:47]
v_fma_f32 v230,-4.0,v229,v231
v_sub_f32 v231,v231,v229
M a[48:51],a[240:243],a[212:215],a[48:51]
v_add_f32 v229,v234,v230
v_sub_f32 v234,v234,v230
M a[52:55],a[240:243],a[216:219],a[52:55]
buffer_load_dwordx4 a[236:239],v247,s[20:23],s48 offen offset:1024 sc1
M a[56:59],a[240:243],a[220:223],a[56:59]
v_fma_f32 v230,2.0,v231,v232
v_fmac_f32 v232,-2.0,v231
M a[60:63],a[240:243],a[192:195],a[60:63]
s_waitcnt vmcnt(9)
v_and_b32 v197,s42,v197
v_and_b32 v193,s42,v193
M a[64:67],a[244:247],a[196:199],a[64:67]
ds_read_b128 a[196:199],v245 offset:19712
v_and_b32 v195,s42,v195
M a[68:71],a[244:247],a[200:203],a[68:71]
buffer_load_dwordx4 a[240:243],v247,s[20:23],s46 offen offset:2048 sc1
v_and_b32 v203,s42,v203
M a[72:75],a[244:247],a[204:207],a[72:75]
v_and_b32 v201,s42,v201
v_and_b32 v199,s42,v199
M a[76:79],a[244:247],a[208:211],a[76:79]
v_fmac_f32 v193,s43,v197
v_fmac_f32 v203,4.0,v195
M a[80:83],a[244:247],a[212:215],a[80:83]
v_fma_f32 v231,-4.0,v197,v201
v_fmac_f32 v193,s45,v201
M a[84:87],a[244:247],a[216:219],a[84:87]
v_fmac_f32 v203,s41,v199
v_sub_f32 v201,v201,v197
M a[88:91],a[244:247],a[220:223],a[88:91]
v_fma_f32 v197,-4.0,v195,v199
v_sub_f32 v199,v199,v195
M a[92:95],a[244:247],a[192:195],a[92:95]
s_waitcnt vmcnt(9)
buffer_load_dwordx4 a[244:247],v247,s[20:23],s47 offen offset:2048 sc1
M a[0:3],a[248:251],a[200:203],a[0:3]
v_add_f32 v195,v231,v197
v_sub_f32 v231,v231,v197
v_fma_f32 v197,2.0,v199,v201
M a[4:7],a[248:251],a[204:207],a[4:7]
v_fmac_f32 v201,-2.0,v199
v_cvt_pk_bf16_f32 v193,v228,v193
M a[8:11],a[248:251],a[208:211],a[8:11]
v_cvt_pk_bf16_f32 v203,v233,v203
v_cvt_pk_bf16_f32 v195,v229,v195
M a[12:15],a[248:251],a[212:215],a[12:15]
v_cvt_pk_bf16_f32 v199,v230,v197
v_cvt_pk_bf16_f32 v197,v234,v231
M a[16:19],a[248:251],a[216:219],a[16:19]
v_cvt_pk_bf16_f32 v201,v232,v201
M a[20:23],a[248:251],a[220:223],a[20:23]
ds_write2st64_b64 v243,v[192:193],v[202:203] offset0:170 offset1:187
M a[24:27],a[248:251],a[192:195],a[24:27]
s_waitcnt lgkmcnt(1)
s_add_u32 s28,s65,786432
buffer_load_dwordx2 v[192:193],v241,s[12:15],s28 offen offset:0
M a[28:31],a[248:251],a[196:199],a[28:31]
s_waitcnt vmcnt(10)
ds_write2st64_b64 v243,v[194:195],v[196:197] offset0:102 offset1:119
M a[32:35],a[252:255],a[200:203],a[32:35]
buffer_load_dwordx2 v[202:203],v241,s[16:19],s28 offen offset:1536
M a[36:39],a[252:255],a[204:207],a[36:39]
ds_write2st64_b64 v243,v[198:199],v[200:201] offset0:136 offset1:153
M a[40:43],a[252:255],a[208:211],a[40:43]
v_lshlrev_b32 v230,16,v208
v_lshlrev_b32 v228,16,v204
M a[44:47],a[252:255],a[212:215],a[44:47]
buffer_load_dwordx2 v[194:195],v241,s[8:11],s28 offen offset:0
M a[48:51],a[252:255],a[216:219],a[48:51]
v_lshlrev_b32 v229,16,v206
v_lshlrev_b32 v233,16,v214
M a[52:55],a[252:255],a[220:223],a[52:55]
v_lshlrev_b32 v232,16,v212
v_lshlrev_b32 v231,16,v210
M a[56:59],a[252:255],a[192:195],a[56:59]
v_fmac_f32 v228,s43,v230
v_fmac_f32 v233,4.0,v229
M a[60:63],a[252:255],a[196:199],a[60:63]
s_waitcnt vmcnt(11)
buffer_load_dwordx2 v[196:197],v241,s[8:11],s28 offen offset:384
M a[64:67],a[224:227],a[200:203],a[64:67]
ds_read_b128 a[200:203],v245 offset:26112
v_fma_f32 v234,-4.0,v230,v232
M a[68:71],a[224:227],a[204:207],a[68:71]
ds_read_b128 a[204:207],v246 offset:26368
v_fmac_f32 v228,s45,v232
M a[72:75],a[224:227],a[208:211],a[72:75]
ds_read_b128 a[208:211],v246 offset:26624
v_fmac_f32 v233,s41,v231
M a[76:79],a[224:227],a[212:215],a[76:79]
buffer_load_dwordx2 v[198:199],v241,s[8:11],s28 offen offset:768
M a[80:83],a[224:227],a[216:219],a[80:83]
ds_read_b128 a[212:215],v246 offset:26880
ds_read_b128 a[216:219],v246 offset:27136
M a[84:87],a[224:227],a[220:223],a[84:87]
ds_read_b128 a[220:223],v246 offset:27392
v_sub_f32 v232,v232,v230
M a[88:91],a[224:227],a[192:195],a[88:91]
ds_read_b128 a[192:195],v246 offset:27648
v_fma_f32 v230,-4.0,v229,v231
M a[92:95],a[224:227],a[196:199],a[92:95]
s_waitcnt vmcnt(12) lgkmcnt(6)
buffer_load_dwordx2 v[200:201],v241,s[8:11],s28 offen offset:1152
M a[96:99],v[216:219],a[200:203],0
s_waitcnt lgkmcnt(5)
ds_read_b128 a[196:199],v246 offset:27904
v_sub_f32 v231,v231,v229
M a[100:103],v[216:219],a[204:207],0
s_waitcnt lgkmcnt(5)
v_add_f32 v229,v234,v230
v_sub_f32 v234,v234,v230
M a[104:107],v[216:219],a[208:211],0
s_waitcnt lgkmcnt(4)
v_fma_f32 v230,2.0,v231,v232
v_fmac_f32 v232,-2.0,v231
M a[108:111],v[216:219],a[212:215],0
s_waitcnt lgkmcnt(3)
buffer_load_dwordx4 a[248:251],v247,s[20:23],s48 offen offset:2048 sc1
M a[112:115],v[216:219],a[216:219],0
s_waitcnt lgkmcnt(2)
s_add_u32 s46,s76,27648
v_and_b32 v208,s42,v208
v_and_b32 v204,s42,v204
M a[116:119],v[216:219],a[220:223],0
s_waitcnt lgkmcnt(1)
v_and_b32 v206,s42,v206
v_and_b32 v214,s42,v214
M a[120:123],v[216:219],a[192:195],0
s_waitcnt lgkmcnt(0)
v_and_b32 v212,s42,v212
v_and_b32 v210,s42,v210
M a[124:127],v[216:219],a[196:199],0
s_waitcnt vmcnt(13)
buffer_load_dwordx4 a[252:255],v247,s[20:23],s46 offen offset:0 sc1
M a[128:131],v[220:223],a[200:203],0
s_add_u32 s47,s76,30720
v_fmac_f32 v204,s43,v208
v_fmac_f32 v214,4.0,v206
M a[132:135],v[220:223],a[204:207],0
v_fma_f32 v231,-4.0,v208,v212
v_fmac_f32 v204,s45,v212
M a[136:139],v[220:223],a[208:211],0
v_fmac_f32 v214,s41,v210
v_sub_f32 v212,v212,v208
M a[140:143],v[220:223],a[212:215],0
buffer_load_dwordx4 a[224:227],v247,s[20:23],s47 offen offset:0 sc1
M a[144:147],v[220:223],a[216:219],0
s_add_u32 s48,s76,33792
v_fma_f32 v208,-4.0,v206,v210
v_sub_f32 v210,v210,v206
M a[148:151],v[220:223],a[220:223],0
v_add_f32 v206,v231,v208
v_sub_f32 v231,v231,v208
M a[152:155],v[220:223],a[192:195],0
v_fma_f32 v208,2.0,v210,v212
v_fmac_f32 v212,-2.0,v210
M a[156:159],v[220:223],a[196:199],0
s_waitcnt vmcnt(14)
buffer_load_dwordx4 v[216:219],v247,s[20:23],s48 offen offset:0 sc1
M a[160:163],v[224:227],a[200:203],0
ds_read_b128 a[200:203],v246 offset:28160
v_cvt_pk_bf16_f32 v204,v228,v204
M a[164:167],v[224:227],a[204:207],0
v_cvt_pk_bf16_f32 v214,v233,v214
v_cvt_pk_bf16_f32 v206,v229,v206
M a[168:171],v[224:227],a[208:211],0
v_cvt_pk_bf16_f32 v210,v230,v208
v_cvt_pk_bf16_f32 v208,v234,v231
M a[172:175],v[224:227],a[212:215],0
buffer_load_dwordx4 v[220:223],v247,s[20:23],s46 offen offset:1024 sc1
M a[176:179],v[224:227],a[216:219],0
v_cvt_pk_bf16_f32 v212,v232,v212
v_lshlrev_b32 v230,16,v209
M a[180:183],v[224:227],a[220:223],0
v_lshlrev_b32 v228,16,v205
v_lshlrev_b32 v229,16,v207
M a[184:187],v[224:227],a[192:195],0
v_lshlrev_b32 v233,16,v215
v_lshlrev_b32 v232,16,v213
M a[188:191],v[224:227],a[196:199],0
s_waitcnt vmcnt(15)
buffer_load_dwordx4 v[224:227],v247,s[20:23],s47 offen offset:1024 sc1
M a[96:99],a[228:231],a[204:207],a[96:99]
v_lshlrev_b32 v231,16,v211
v_fmac_f32 v228,s43,v230
M a[100:103],a[228:231],a[208:211],a[100:103]
v_fmac_f32 v233,4.0,v229
v_fma_f32 v234,-4.0,v230,v232
M a[104:107],a[228:231],a[212:215],a[104:107]
v_fmac_f32 v228,s45,v232
v_fmac_f32 v233,s41,v231
M a[108:111],a[228:231],a[216:219],a[108:111]
v_sub_f32 v232,v232,v230
v_fma_f32 v230,-4.0,v229,v231
M a[112:115],a[228:231],a[220:223],a[112:115]
v_sub_f32 v231,v231,v229
v_add_f32 v229,v234,v230
M a[116:119],a[228:231],a[192:195],a[116:119]
v_sub_f32 v234,v234,v230
v_fma_f32 v230,2.0,v231,v232
M a[120:123],a[228:231],a[196:199],a[120:123]
s_waitcnt lgkmcnt(0)
v_fmac_f32 v232,-2.0,v231
v_and_b32 v209,s42,v209
M a[124:127],a[228:231],a[200:203],a[124:127]
s_waitcnt vmcnt(15)
buffer_load_dwordx4 a[228:231],v247,s[20:23],s48 offen offset:1024 sc1
M a[128:131],a[232:235],a[204:207],a[128:131]
v_and_b32 v205,s42,v205
v_and_b32 v207,s42,v207
M a[132:135],a[232:235],a[208:211],a[132:135]
v_and_b32 v215,s42,v215
v_and_b32 v213,s42,v213
M a[136:139],a[232:235],a[212:215],a[136:139]
v_and_b32 v211,s42,v211
v_fmac_f32 v205,s43,v209
M a[140:143],a[232:235],a[216:219],a[140:143]
v_fmac_f32 v215,4.0,v207
v_fma_f32 v231,-4.0,v209,v213
M a[144:147],a[232:235],a[220:223],a[144:147]
v_fmac_f32 v205,s45,v213
v_fmac_f32 v215,s41,v211
M a[148:151],a[232:235],a[192:195],a[148:151]
v_sub_f32 v213,v213,v209
v_fma_f32 v209,-4.0,v207,v211
M a[152:155],a[232:235],a[196:199],a[152:155]
v_sub_f32 v211,v211,v207
v_add_f32 v207,v231,v209
M a[156:159],a[232:235],a[200:203],a[156:159]
s_waitcnt vmcnt(15)
buffer_load_dwordx4 a[232:235],v247,s[20:23],s46 offen offset:2048 sc1
M a[160:163],a[236:239],a[204:207],a[160:163]
ds_read_b128 a[204:207],v245 offset:28416
v_sub_f32 v231,v231,v209
M a[164:167],a[236:239],a[208:211],a[164:167]
v_fma_f32 v209,2.0,v211,v213
v_fmac_f32 v213,-2.0,v211
M a[168:171],a[236:239],a[212:215],a[168:171]
v_cvt_pk_bf16_f32 v205,v228,v205
v_cvt_pk_bf16_f32 v215,v233,v215
M a[172:175],a[236:239],a[216:219],a[172:175]
v_cvt_pk_bf16_f32 v207,v229,v207
v_cvt_pk_bf16_f32 v211,v230,v209
M a[176:179],a[236:239],a[220:223],a[176:179]
v_cvt_pk_bf16_f32 v209,v234,v231
v_cvt_pk_bf16_f32 v213,v232,v213
M a[180:183],a[236:239],a[192:195],a[180:183]
ds_write2st64_b64 v243,v[204:205],v[214:215] offset0:171 offset1:188
M a[184:187],a[236:239],a[196:199],a[184:187]
s_add_u32 s28,s65,1179648
buffer_load_dwordx2 v[204:205],v241,s[12:15],s28 offen offset:0
M a[188:191],a[236:239],a[200:203],a[188:191]
s_waitcnt vmcnt(16)
ds_write2st64_b64 v243,v[206:207],v[208:209] offset0:103 offset1:120
M a[96:99],a[240:243],a[208:211],a[96:99]
buffer_load_dwordx2 v[214:215],v241,s[16:19],s28 offen offset:1536
M a[100:103],a[240:243],a[212:215],a[100:103]
ds_write2st64_b64 v243,v[210:211],v[212:213] offset0:137 offset1:154
M a[104:107],a[240:243],a[216:219],a[104:107]
v_fmac_f32 v235,s43,v237
v_fmac_f32 v240,4.0,v236
M a[108:111],a[240:243],a[220:223],a[108:111]
buffer_load_dwordx2 v[206:207],v241,s[8:11],s28 offen offset:0
M a[112:115],a[240:243],a[192:195],a[112:115]
v_fma_f32 v228,-4.0,v237,v239
v_fmac_f32 v235,s45,v239
M a[116:119],a[240:243],a[196:199],a[116:119]
v_fmac_f32 v240,s41,v238
v_sub_f32 v239,v239,v237
M a[120:123],a[240:243],a[200:203],a[120:123]
s_waitcnt lgkmcnt(3)
v_fma_f32 v237,-4.0,v236,v238
v_sub_f32 v238,v238,v236
M a[124:127],a[240:243],a[204:207],a[124:127]
s_waitcnt vmcnt(17)
buffer_load_dwordx2 v[208:209],v241,s[8:11],s28 offen offset:384
M a[128:131],a[244:247],a[208:211],a[128:131]
v_add_f32 v236,v228,v237
v_sub_f32 v228,v228,v237
M a[132:135],a[244:247],a[212:215],a[132:135]
v_fma_f32 v237,2.0,v238,v239
v_fmac_f32 v239,-2.0,v238
M a[136:139],a[244:247],a[216:219],a[136:139]
v_cvt_pk_bf16_f32 v229,v235,v240
v_cvt_pk_bf16_f32 v230,v236,v228
M a[140:143],a[244:247],a[220:223],a[140:143]
buffer_load_dwordx2 v[210:211],v241,s[8:11],s28 offen offset:768
M a[144:147],a[244:247],a[192:195],a[144:147]
v_cvt_pk_bf16_f32 v231,v237,v239
v_add_u32 v228,87040,v244
M a[148:151],a[244:247],a[196:199],a[148:151]
ds_write_b16 v228,v229 offset:0
M a[152:155],a[244:247],a[200:203],a[152:155]
ds_write_b16_d16_hi v228,v229 offset:8704
M a[156:159],a[244:247],a[204:207],a[156:159]
s_waitcnt vmcnt(12)
buffer_load_dwordx2 v[212:213],v241,s[8:11],s28 offen offset:1152
M a[160:163],a[248:251],a[208:211],a[160:163]
ds_read_b128 a[208:211],v245 offset:34816
ds_write_b16 v244,v230 offset:52224
M a[164:167],a[248:251],a[212:215],a[164:167]
ds_read_b128 a[212:215],v246 offset:35072
ds_write_b16_d16_hi v244,v230 offset:60928
M a[168:171],a[248:251],a[216:219],a[168:171]
buffer_load_short_d16_hi v235,v242,s[12:15],s72 offen offset:0
M a[172:175],a[248:251],a[220:223],a[172:175]
ds_read_b128 a[216:219],v246 offset:35328
ds_read_b128 a[220:223],v246 offset:35584
M a[176:179],a[248:251],a[192:195],a[176:179]
buffer_load_short_d16_hi v236,v242,s[8:11],s72 offen offset:0
M a[180:183],a[248:251],a[196:199],a[180:183]
ds_read_b128 a[192:195],v246 offset:35840
ds_read_b128 a[196:199],v246 offset:36096
M a[184:187],a[248:251],a[200:203],a[184:187]
buffer_load_short_d16_hi v237,v242,s[8:11],s72 offen offset:384
M a[188:191],a[248:251],a[204:207],a[188:191]
s_waitcnt vmcnt(15) lgkmcnt(7)
ds_read_b128 a[200:203],v246 offset:36352
ds_read_b128 a[204:207],v246 offset:36608
M v[0:3],a[252:255],a[208:211],0
s_waitcnt lgkmcnt(7)
buffer_load_short_d16_hi v238,v242,s[8:11],s72 offen offset:768
M v[4:7],a[252:255],a[212:215],0
s_waitcnt lgkmcnt(5)
v_add_u32 v228,69632,v244
M v[8:11],a[252:255],a[216:219],0
s_waitcnt lgkmcnt(4)
buffer_load_short_d16_hi v239,v242,s[8:11],s72 offen offset:1152
M v[12:15],a[252:255],a[220:223],0
s_waitcnt lgkmcnt(3)
ds_write_b16 v228,v231 offset:0
M v[16:19],a[252:255],a[192:195],0
s_waitcnt lgkmcnt(3)
buffer_load_short_d16_hi v240,v242,s[16:19],s72 offen offset:1536
M v[20:23],a[252:255],a[196:199],0
s_waitcnt lgkmcnt(2)
ds_write_b16_d16_hi v228,v231 offset:8704
M v[24:27],a[252:255],a[200:203],0
s_waitcnt lgkmcnt(2)
buffer_load_dwordx4 a[236:239],v247,s[20:23],s47 offen offset:2048 sc1
M v[28:31],a[252:255],a[204:207],0
s_waitcnt vmcnt(18)
v_lshlrev_b32 v230,16,v196
v_lshlrev_b32 v228,16,v192
M v[32:35],a[224:227],a[208:211],0
v_lshlrev_b32 v229,16,v194
v_lshlrev_b32 v233,16,v202
M v[36:39],a[224:227],a[212:215],0
v_lshlrev_b32 v232,16,v200
v_lshlrev_b32 v231,16,v198
M v[40:43],a[224:227],a[216:219],0
buffer_load_dwordx4 a[240:243],v247,s[20:23],s48 offen offset:2048 sc1
M v[44:47],a[224:227],a[220:223],0
s_add_u32 s46,s76,36864
v_fmac_f32 v228,s43,v230
v_fmac_f32 v233,4.0,v229
M v[48:51],a[224:227],a[192:195],0
v_fma_f32 v234,-4.0,v230,v232
v_fmac_f32 v228,s45,v232
M v[52:55],a[224:227],a[196:199],0
v_fmac_f32 v233,s41,v231
v_sub_f32 v232,v232,v230
M v[56:59],a[224:227],a[200:203],0
buffer_load_dwordx4 a[244:247],v247,s[20:23],s46 offen offset:0 sc1
M v[60:63],a[224:227],a[204:207],0
s_waitcnt vmcnt(19)
s_add_u32 s47,s76,39936
v_fma_f32 v230,-4.0,v229,v231
v_sub_f32 v231,v231,v229
M v[64:67],v[216:219],a[208:211],0
ds_read_b128 a[208:211],v246 offset:36864
v_add_f32 v229,v234,v230
M v[68:71],v[216:219],a[212:215],0
v_sub_f32 v234,v234,v230
v_fma_f32 v230,2.0,v231,v232
M v[72:75],v[216:219],a[216:219],0
buffer_load_dwordx4 a[248:251],v247,s[20:23],s47 offen offset:0 sc1
M v[76:79],v[216:219],a[220:223],0
s_add_u32 s48,s76,43008
v_fmac_f32 v232,-2.0,v231
v_and_b32 v196,s42,v196
M v[80:83],v[216:219],a[192:195],0
v_and_b32 v192,s42,v192
v_and_b32 v194,s42,v194
M v[84:87],v[216:219],a[196:199],0
v_and_b32 v202,s42,v202
v_and_b32 v200,s42,v200
M v[88:91],v[216:219],a[200:203],0
global_load_dword v251,v252,s[82:83]
M v[92:95],v[216:219],a[204:207],0
s_waitcnt vmcnt(20)
v_and_b32 v198,s42,v198
v_fmac_f32 v192,s43,v196
M v[0:3],v[220:223],a[212:215],v[0:3]
buffer_load_dwordx4 a[252:255],v247,s[20:23],s48 offen offset:0 sc1
M v[4:7],v[220:223],a[216:219],v[4:7]
v_fmac_f32 v202,4.0,v194
v_fma_f32 v231,-4.0,v196,v200
M v[8:11],v[220:223],a[220:223],v[8:11]
v_fmac_f32 v192,s45,v200
v_fmac_f32 v202,s41,v198
M v[12:15],v[220:223],a[192:195],v[12:15]
v_sub_f32 v200,v200,v196
v_fma_f32 v196,-4.0,v194,v198
M v[16:19],v[220:223],a[196:199],v[16:19]
buffer_load_dwordx4 a[224:227],v247,s[20:23],s46 offen offset:1024 sc1
M v[20:23],v[220:223],a[200:203],v[20:23]
v_sub_f32 v198,v198,v194
v_add_f32 v194,v231,v196
M v[24:27],v[220:223],a[204:207],v[24:27]
s_waitcnt lgkmcnt(0)
v_sub_f32 v231,v231,v196
v_fma_f32 v196,2.0,v198,v200
M v[28:31],v[220:223],a[208:211],v[28:31]
s_waitcnt vmcnt(21)
v_fmac_f32 v200,-2.0,v198
v_cvt_pk_bf16_f32 v192,v228,v192
M v[32:35],v[224:227],a[212:215],v[32:35]
buffer_load_dwordx4 v[216:219],v247,s[20:23],s47 offen offset:1024 sc1
M v[36:39],v[224:227],a[216:219],v[36:39]
v_cvt_pk_bf16_f32 v202,v233,v202
v_cvt_pk_bf16_f32 v194,v229,v194
M v[40:43],v[224:227],a[220:223],v[40:43]
v_cvt_pk_bf16_f32 v198,v230,v196
v_cvt_pk_bf16_f32 v196,v234,v231
M v[44:47],v[224:227],a[192:195],v[44:47]
v_cvt_pk_bf16_f32 v200,v232,v200
v_lshlrev_b32 v230,16,v197
M v[48:51],v[224:227],a[196:199],v[48:51]
buffer_load_dwordx4 v[220:223],v247,s[20:23],s48 offen offset:1024 sc1
M v[52:55],v[224:227],a[200:203],v[52:55]
v_lshlrev_b32 v228,16,v193
v_lshlrev_b32 v229,16,v195
M v[56:59],v[224:227],a[204:207],v[56:59]
v_lshlrev_b32 v233,16,v203
v_lshlrev_b32 v232,16,v201
M v[60:63],v[224:227],a[208:211],v[60:63]
s_waitcnt vmcnt(22)
v_lshlrev_b32 v231,16,v199
v_fmac_f32 v228,s43,v230
M v[64:67],a[228:231],a[212:215],v[64:67]
buffer_load_dwordx4 v[224:227],v247,s[20:23],s46 offen offset:2048 sc1
M v[68:71],a[228:231],a[216:219],v[68:71]
ds_read_b128 a[212:215],v245 offset:37120
v_fmac_f32 v233,4.0,v229
M v[72:75],a[228:231],a[220:223],v[72:75]
v_fma_f32 v234,-4.0,v230,v232
v_fmac_f32 v228,s45,v232
M v[76:79],a[228:231],a[192:195],v[76:79]
v_fmac_f32 v233,s41,v231
v_sub_f32 v232,v232,v230
M v[80:83],a[228:231],a[196:199],v[80:83]
v_fma_f32 v230,-4.0,v229,v231
v_sub_f32 v231,v231,v229
M v[84:87],a[228:231],a[200:203],v[84:87]
v_add_f32 v229,v234,v230
v_sub_f32 v234,v234,v230
M v[88:91],a[228:231],a[204:207],v[88:91]
v_fma_f32 v230,2.0,v231,v232
v_fmac_f32 v232,-2.0,v231
M v[92:95],a[228:231],a[208:211],v[92:95]
s_waitcnt vmcnt(22)
buffer_load_dwordx4 a[228:231],v247,s[20:23],s47 offen offset:2048 sc1
M v[0:3],a[232:235],a[216:219],v[0:3]
v_and_b32 v197,s42,v197
v_and_b32 v193,s42,v193
M v[4:7],a[232:235],a[220:223],v[4:7]
v_and_b32 v195,s42,v195
v_and_b32 v203,s42,v203
v_and_b32 v201,s42,v201
M v[8:11],a[232:235],a[192:195],v[8:11]
v_and_b32 v199,s42,v199
v_fmac_f32 v193,s43,v197
M v[12:15],a[232:235],a[196:199],v[12:15]
v_fmac_f32 v203,4.0,v195
v_fma_f32 v231,-4.0,v197,v201
M v[16:19],a[232:235],a[200:203],v[16:19]
v_fmac_f32 v193,s45,v201
v_fmac_f32 v203,s41,v199
M v[20:23],a[232:235],a[204:207],v[20:23]
v_sub_f32 v201,v201,v197
v_fma_f32 v197,-4.0,v195,v199
M v[24:27],a[232:235],a[208:211],v[24:27]
s_waitcnt lgkmcnt(0)
v_sub_f32 v199,v199,v195
v_add_f32 v195,v231,v197
M v[28:31],a[232:235],a[212:215],v[28:31]
s_waitcnt vmcnt(10)
buffer_load_dwordx4 a[232:235],v247,s[20:23],s48 offen offset:2048 sc1
M v[32:35],a[236:239],a[216:219],v[32:35]
v_sub_f32 v231,v231,v197
v_fma_f32 v197,2.0,v199,v201
v_fmac_f32 v201,-2.0,v199
M v[36:39],a[236:239],a[220:223],v[36:39]
s_add_u32 s46,s77,9216
v_cvt_pk_bf16_f32 v193,v228,v193
v_cvt_pk_bf16_f32 v203,v233,v203
M v[40:43],a[236:239],a[192:195],v[40:43]
v_cvt_pk_bf16_f32 v195,v229,v195
v_cvt_pk_bf16_f32 v199,v230,v197
M v[44:47],a[236:239],a[196:199],v[44:47]
v_cvt_pk_bf16_f32 v197,v234,v231
v_cvt_pk_bf16_f32 v201,v232,v201
M v[48:51],a[236:239],a[200:203],v[48:51]
ds_write2st64_b64 v243,v[192:193],v[202:203] offset0:172 offset1:189
M v[52:55],a[236:239],a[204:207],v[52:55]
s_add_u32 s28,s66,0
buffer_load_dwordx2 v[192:193],v241,s[12:15],s28 offen offset:0
M v[56:59],a[236:239],a[208:211],v[56:59]
ds_write2st64_b64 v243,v[194:195],v[196:197] offset0:104 offset1:121
M v[60:63],a[236:239],a[212:215],v[60:63]
s_waitcnt vmcnt(11)
buffer_load_dwordx2 v[202:203],v241,s[16:19],s28 offen offset:1536
M v[64:67],a[240:243],a[216:219],v[64:67]
ds_read_b128 a[216:219],v245 offset:43520
ds_write2st64_b64 v243,v[198:199],v[200:201] offset0:138 offset1:155
M v[68:71],a[240:243],a[220:223],v[68:71]
ds_read_b128 a[220:223],v246 offset:43776
v_lshlrev_b32 v230,16,v208
M v[72:75],a[240:243],a[192:195],v[72:75]
buffer_load_dwordx2 v[194:195],v241,s[8:11],s28 offen offset:0
M v[76:79],a[240:243],a[196:199],v[76:79]
ds_read_b128 a[192:195],v246 offset:44032
ds_read_b128 a[196:199],v246 offset:44288
M v[80:83],a[240:243],a[200:203],v[80:83]
ds_read_b128 a[200:203],v246 offset:44544
v_lshlrev_b32 v228,16,v204
M v[84:87],a[240:243],a[204:207],v[84:87]
ds_read_b128 a[204:207],v246 offset:44800
v_lshlrev_b32 v229,16,v206
M v[88:91],a[240:243],a[208:211],v[88:91]
buffer_load_dwordx2 v[196:197],v241,s[8:11],s28 offen offset:384
M v[92:95],a[240:243],a[212:215],v[92:95]
s_waitcnt vmcnt(13) lgkmcnt(6)
ds_read_b128 a[208:211],v246 offset:45056
ds_read_b128 a[212:215],v246 offset:45312
M v[96:99],a[244:247],a[216:219],0
s_waitcnt lgkmcnt(6)
v_lshlrev_b32 v233,16,v214
v_lshlrev_b32 v232,16,v212
M v[100:103],a[244:247],a[220:223],0
s_waitcnt lgkmcnt(5)
v_lshlrev_b32 v231,16,v210
v_fmac_f32 v228,s43,v230
M v[104:107],a[244:247],a[192:195],0
s_waitcnt lgkmcnt(4)
buffer_load_dwordx2 v[198:199],v241,s[8:11],s28 offen offset:768
M v[108:111],a[244:247],a[196:199],0
s_waitcnt lgkmcnt(3)
v_fmac_f32 v233,4.0,v229
v_fma_f32 v234,-4.0,v230,v232
M v[112:115],a[244:247],a[200:203],0
s_waitcnt lgkmcnt(2)
v_fmac_f32 v228,s45,v232
v_fmac_f32 v233,s41,v231
M v[116:119],a[244:247],a[204:207],0
s_waitcnt lgkmcnt(1)
v_sub_f32 v232,v232,v230
v_fma_f32 v230,-4.0,v229,v231
M v[120:123],a[244:247],a[208:211],0
s_waitcnt lgkmcnt(0)
buffer_load_dwordx2 v[200:201],v241,s[8:11],s28 offen offset:1152
M v[124:127],a[244:247],a[212:215],0
s_waitcnt vmcnt(14)
v_sub_f32 v231,v231,v229
v_add_f32 v229,v234,v230
M v[128:131],a[248:251],a[216:219],0
v_sub_f32 v234,v234,v230
v_fma_f32 v230,2.0,v231,v232
M v[132:135],a[248:251],a[220:223],0
v_fmac_f32 v232,-2.0,v231
v_and_b32 v208,s42,v208
M v[136:139],a[248:251],a[192:195],0
buffer_load_dwordx4 a[236:239],v247,s[20:23],s46 offen offset:0 sc1
M v[140:143],a[248:251],a[196:199],0
s_add_u32 s47,s77,12288
v_and_b32 v204,s42,v204
v_and_b32 v206,s42,v206
M v[144:147],a[248:251],a[200:203],0
v_and_b32 v214,s42,v214
v_and_b32 v212,s42,v212
M v[148:151],a[248:251],a[204:207],0
v_and_b32 v210,s42,v210
v_fmac_f32 v204,s43,v208
M v[152:155],a[248:251],a[208:211],0
buffer_load_dwordx4 a[240:243],v247,s[20:23],s47 offen offset:0 sc1
M v[156:159],a[248:251],a[212:215],0
s_waitcnt vmcnt(14)
s_add_u32 s48,s77,15360
v_fmac_f32 v214,4.0,v206
v_fma_f32 v231,-4.0,v208,v212
M v[160:163],a[252:255],a[216:219],0
ds_read_b128 a[216:219],v246 offset:45568
v_fmac_f32 v204,s45,v212
M v[164:167],a[252:255],a[220:223],0
v_fmac_f32 v214,s41,v210
v_sub_f32 v212,v212,v208
M v[168:171],a[252:255],a[192:195],0
buffer_load_dwordx4 a[244:247],v247,s[20:23],s48 offen offset:0 sc1
M v[172:175],a[252:255],a[196:199],0
v_fma_f32 v208,-4.0,v206,v210
v_sub_f32 v210,v210,v206
M v[176:179],a[252:255],a[200:203],0
v_add_f32 v206,v231,v208
v_sub_f32 v231,v231,v208
M v[180:183],a[252:255],a[204:207],0
v_fma_f32 v208,2.0,v210,v212
v_fmac_f32 v212,-2.0,v210
M v[184:187],a[252:255],a[208:211],0
buffer_load_dwordx4 a[248:251],v247,s[20:23],s46 offen offset:1024 sc1
M v[188:191],a[252:255],a[212:215],0
s_waitcnt vmcnt(15)
v_cvt_pk_bf16_f32 v204,v228,v204
v_cvt_pk_bf16_f32 v214,v233,v214
M v[96:99],a[224:227],a[220:223],v[96:99]
v_cvt_pk_bf16_f32 v206,v229,v206
v_cvt_pk_bf16_f32 v210,v230,v208
M v[100:103],a[224:227],a[192:195],v[100:103]
v_cvt_pk_bf16_f32 v208,v234,v231
v_cvt_pk_bf16_f32 v212,v232,v212
M v[104:107],a[224:227],a[196:199],v[104:107]
buffer_load_dwordx4 a[252:255],v247,s[20:23],s47 offen offset:1024 sc1
M v[108:111],a[224:227],a[200:203],v[108:111]
v_lshlrev_b32 v230,16,v209
v_lshlrev_b32 v228,16,v205
M v[112:115],a[224:227],a[204:207],v[112:115]
v_lshlrev_b32 v229,16,v207
v_lshlrev_b32 v233,16,v215
M v[116:119],a[224:227],a[208:211],v[116:119]
v_lshlrev_b32 v232,16,v213
v_lshlrev_b32 v231,16,v211
M v[120:123],a[224:227],a[212:215],v[120:123]
s_waitcnt lgkmcnt(0)
v_fmac_f32 v228,s43,v230
v_fmac_f32 v233,4.0,v229
M v[124:127],a[224:227],a[216:219],v[124:127]
s_waitcnt vmcnt(15)
buffer_load_dwordx4 a[224:227],v247,s[20:23],s48 offen offset:1024 sc1
M v[128:131],v[216:219],a[220:223],v[128:131]
v_fma_f32 v234,-4.0,v230,v232
v_fmac_f32 v228,s45,v232
M v[132:135],v[216:219],a[192:195],v[132:135]
v_fmac_f32 v233,s41,v231
v_sub_f32 v232,v232,v230
M v[136:139],v[216:219],a[196:199],v[136:139]
v_fma_f32 v230,-4.0,v229,v231
v_sub_f32 v231,v231,v229
M v[140:143],v[216:219],a[200:203],v[140:143]
v_add_f32 v229,v234,v230
v_sub_f32 v234,v234,v230
M v[144:147],v[216:219],a[204:207],v[144:147]
v_fma_f32 v230,2.0,v231,v232
v_fmac_f32 v232,-2.0,v231
M v[148:151],v[216:219],a[208:211],v[148:151]
v_and_b32 v209,s42,v209
v_and_b32 v205,s42,v205
M v[152:155],v[216:219],a[212:215],v[152:155]
v_and_b32 v207,s42,v207
v_and_b32 v215,s42,v215
M v[156:159],v[216:219],a[216:219],v[156:159]
s_waitcnt vmcnt(15)
buffer_load_dwordx4 v[216:219],v247,s[20:23],s46 offen offset:2048 sc1
M v[160:163],v[220:223],a[220:223],v[160:163]
ds_read_b128 a[220:223],v245 offset:45824
v_and_b32 v213,s42,v213
M v[164:167],v[220:223],a[192:195],v[164:167]
v_and_b32 v211,s42,v211
v_fmac_f32 v205,s43,v209
M v[168:171],v[220:223],a[196:199],v[168:171]
v_fmac_f32 v215,4.0,v207
v_fma_f32 v231,-4.0,v209,v213
M v[172:175],v[220:223],a[200:203],v[172:175]
v_fmac_f32 v205,s45,v213
v_fmac_f32 v215,s41,v211
M v[176:179],v[220:223],a[204:207],v[176:179]
v_sub_f32 v213,v213,v209
v_fma_f32 v209,-4.0,v207,v211
M v[180:183],v[220:223],a[208:211],v[180:183]
v_sub_f32 v211,v211,v207
v_add_f32 v207,v231,v209
M v[184:187],v[220:223],a[212:215],v[184:187]
v_sub_f32 v231,v231,v209
v_fma_f32 v209,2.0,v211,v213
M v[188:191],v[220:223],a[216:219],v[188:191]
s_waitcnt vmcnt(15)
buffer_load_dwordx4 v[220:223],v247,s[20:23],s47 offen offset:2048 sc1
M v[96:99],v[224:227],a[192:195],v[96:99]
v_fmac_f32 v213,-2.0,v211
v_cvt_pk_bf16_f32 v205,v228,v205
M v[100:103],v[224:227],a[196:199],v[100:103]
v_cvt_pk_bf16_f32 v215,v233,v215
v_cvt_pk_bf16_f32 v207,v229,v207
M v[104:107],v[224:227],a[200:203],v[104:107]
v_cvt_pk_bf16_f32 v211,v230,v209
v_cvt_pk_bf16_f32 v209,v234,v231
M v[108:111],v[224:227],a[204:207],v[108:111]
v_cvt_pk_bf16_f32 v213,v232,v213
M v[112:115],v[224:227],a[208:211],v[112:115]
ds_write2st64_b64 v243,v[204:205],v[214:215] offset0:173 offset1:190
M v[116:119],v[224:227],a[212:215],v[116:119]
s_add_u32 s28,s66,393216
buffer_load_dwordx2 v[204:205],v241,s[12:15],s28 offen offset:0
M v[120:123],v[224:227],a[216:219],v[120:123]
s_waitcnt lgkmcnt(1)
ds_write2st64_b64 v243,v[206:207],v[208:209] offset0:105 offset1:122
M v[124:127],v[224:227],a[220:223],v[124:127]
s_waitcnt vmcnt(16)
buffer_load_dwordx2 v[214:215],v241,s[16:19],s28 offen offset:1536
M v[128:131],a[228:231],a[192:195],v[128:131]
ds_write2st64_b64 v243,v[210:211],v[212:213] offset0:139 offset1:156
M v[132:135],a[228:231],a[196:199],v[132:135]
s_waitcnt vmcnt(12)
v_lshlrev_b32 v230,16,v196
v_lshlrev_b32 v228,16,v192
M v[136:139],a[228:231],a[200:203],v[136:139]
buffer_load_dwordx2 v[206:207],v241,s[8:11],s28 offen offset:0
M v[140:143],a[228:231],a[204:207],v[140:143]
v_lshlrev_b32 v229,16,v194
v_lshlrev_b32 v233,16,v202
M v[144:147],a[228:231],a[208:211],v[144:147]
s_waitcnt vmcnt(11)
v_lshlrev_b32 v232,16,v200
v_lshlrev_b32 v231,16,v198
M v[148:151],a[228:231],a[212:215],v[148:151]
v_fmac_f32 v228,s43,v230
v_fmac_f32 v233,4.0,v229
M v[152:155],a[228:231],a[216:219],v[152:155]
s_waitcnt lgkmcnt(0)
s_barrier
v_fma_f32 v234,-4.0,v230,v232
M v[156:159],a[228:231],a[220:223],v[156:159]
buffer_load_dwordx2 v[208:209],v241,s[8:11],s28 offen offset:384
M v[160:163],a[232:235],a[192:195],v[160:163]
ds_read_b128 a[192:195],v245 offset:52224
v_fmac_f32 v228,s45,v232
M v[164:167],a[232:235],a[196:199],v[164:167]
ds_read_b128 a[196:199],v246 offset:52480
v_fmac_f32 v233,s41,v231
M v[168:171],a[232:235],a[200:203],v[168:171]
buffer_load_dwordx2 v[210:211],v241,s[8:11],s28 offen offset:768
M v[172:175],a[232:235],a[204:207],v[172:175]
ds_read_b128 a[200:203],v246 offset:52736
ds_read_b128 a[204:207],v246 offset:52992
M v[176:179],a[232:235],a[208:211],v[176:179]
ds_read_b128 a[208:211],v246 offset:53248
v_sub_f32 v232,v232,v230
M v[180:183],a[232:235],a[212:215],v[180:183]
ds_read_b128 a[212:215],v246 offset:53504
v_fma_f32 v230,-4.0,v229,v231
M v[184:187],a[232:235],a[216:219],v[184:187]
buffer_load_dwordx2 v[212:213],v241,s[8:11],s28 offen offset:1152
M v[188:191],a[232:235],a[220:223],v[188:191]
s_waitcnt vmcnt(13) lgkmcnt(5)
ds_read_b128 a[216:219],v246 offset:53760
ds_read_b128 a[220:223],v246 offset:54016
M a[0:3],a[236:239],a[192:195],a[0:3]
s_waitcnt lgkmcnt(6)
v_sub_f32 v231,v231,v229
v_add_f32 v229,v234,v230
M a[4:7],a[236:239],a[196:199],a[4:7]
s_waitcnt lgkmcnt(5)
v_sub_f32 v234,v234,v230
v_fma_f32 v230,2.0,v231,v232
M a[8:11],a[236:239],a[200:203],a[8:11]
s_waitcnt lgkmcnt(4)
buffer_load_dwordx4 v[224:227],v247,s[20:23],s48 offen offset:2048 sc1
M a[12:15],a[236:239],a[204:207],a[12:15]
s_waitcnt lgkmcnt(3)
s_add_u32 s46,s77,18432
v_fmac_f32 v232,-2.0,v231
v_and_b32 v196,s42,v196
M a[16:19],a[236:239],a[208:211],a[16:19]
s_waitcnt lgkmcnt(2)
v_and_b32 v192,s42,v192
v_and_b32 v194,s42,v194
M a[20:23],a[236:239],a[212:215],a[20:23]
s_waitcnt lgkmcnt(1)
v_and_b32 v202,s42,v202
v_and_b32 v200,s42,v200
M a[24:27],a[236:239],a[216:219],a[24:27]
s_waitcnt lgkmcnt(0)
buffer_load_dwordx4 a[228:231],v247,s[20:23],s46 offen offset:0 sc1
M a[28:31],a[236:239],a[220:223],a[28:31]
s_waitcnt vmcnt(14)
s_add_u32 s47,s77,21504
v_and_b32 v198,s42,v198
v_fmac_f32 v192,s43,v196
M a[32:35],a[240:243],a[192:195],a[32:35]
v_fmac_f32 v202,4.0,v194
v_fma_f32 v231,-4.0,v196,v200
M a[36:39],a[240:243],a[196:199],a[36:39]
v_fmac_f32 v192,s45,v200
v_fmac_f32 v202,s41,v198
M a[40:43],a[240:243],a[200:203],a[40:43]
buffer_load_dwordx4 a[232:235],v247,s[20:23],s47 offen offset:0 sc1
M a[44:47],a[240:243],a[204:207],a[44:47]
s_add_u32 s48,s77,24576
v_sub_f32 v200,v200,v196
v_fma_f32 v196,-4.0,v194,v198
M a[48:51],a[240:243],a[208:211],a[48:51]
v_sub_f32 v198,v198,v194
v_add_f32 v194,v231,v196
M a[52:55],a[240:243],a[212:215],a[52:55]
v_sub_f32 v231,v231,v196
v_fma_f32 v196,2.0,v198,v200
M a[56:59],a[240:243],a[216:219],a[56:59]
buffer_load_dwordx4 a[236:239],v247,s[20:23],s48 offen offset:0 sc1
M a[60:63],a[240:243],a[220:223],a[60:63]
s_waitcnt vmcnt(15)
v_fmac_f32 v200,-2.0,v198
v_cvt_pk_bf16_f32 v192,v228,v192
M a[64:67],a[244:247],a[192:195],a[64:67]
ds_read_b128 a[192:195],v246 offset:54272
v_cvt_pk_bf16_f32 v202,v233,v202
M a[68:71],a[244:247],a[196:199],a[68:71]
v_cvt_pk_bf16_f32 v194,v229,v194
v_cvt_pk_bf16_f32 v198,v230,v196
M a[72:75],a[244:247],a[200:203],a[72:75]
buffer_load_dwordx4 a[240:243],v247,s[20:23],s46 offen offset:1024 sc1
M a[76:79],a[244:247],a[204:207],a[76:79]
v_cvt_pk_bf16_f32 v196,v234,v231
v_cvt_pk_bf16_f32 v200,v232,v200
M a[80:83],a[244:247],a[208:211],a[80:83]
v_lshlrev_b32 v230,16,v197
v_lshlrev_b32 v228,16,v193
M a[84:87],a[244:247],a[212:215],a[84:87]
v_lshlrev_b32 v229,16,v195
v_lshlrev_b32 v233,16,v203
M a[88:91],a[244:247],a[216:219],a[88:91]
v_lshlrev_b32 v232,16,v201
v_lshlrev_b32 v231,16,v199
M a[92:95],a[244:247],a[220:223],a[92:95]
s_waitcnt vmcnt(15)
buffer_load_dwordx4 a[244:247],v247,s[20:23],s47 offen offset:1024 sc1
M a[0:3],a[248:251],a[196:199],a[0:3]
v_fmac_f32 v228,s43,v230
v_fmac_f32 v233,4.0,v229
M a[4:7],a[248:251],a[200:203],a[4:7]
v_fma_f32 v234,-4.0,v230,v232
v_fmac_f32 v228,s45,v232
M a[8:11],a[248:251],a[204:207],a[8:11]
v_fmac_f32 v233,s41,v231
v_sub_f32 v232,v232,v230
M a[12:15],a[248:251],a[208:211],a[12:15]
v_fma_f32 v230,-4.0,v229,v231
v_sub_f32 v231,v231,v229
M a[16:19],a[248:251],a[212:215],a[16:19]
v_add_f32 v229,v234,v230
v_sub_f32 v234,v234,v230
M a[20:23],a[248:251],a[216:219],a[20:23]
v_fma_f32 v230,2.0,v231,v232
v_fmac_f32 v232,-2.0,v231
M a[24:27],a[248:251],a[220:223],a[24:27]
s_waitcnt lgkmcnt(0)
v_and_b32 v197,s42,v197
v_and_b32 v193,s42,v193
M a[28:31],a[248:251],a[192:195],a[28:31]
s_waitcnt vmcnt(15)
buffer_load_dwordx4 a[248:251],v247,s[20:23],s48 offen offset:1024 sc1
M a[32:35],a[252:255],a[196:199],a[32:35]
v_and_b32 v195,s42,v195
v_and_b32 v203,s42,v203
M a[36:39],a[252:255],a[200:203],a[36:39]
v_and_b32 v201,s42,v201
v_and_b32 v199,s42,v199
M a[40:43],a[252:255],a[204:207],a[40:43]
v_fmac_f32 v193,s43,v197
v_fmac_f32 v203,4.0,v195
M a[44:47],a[252:255],a[208:211],a[44:47]
v_fma_f32 v231,-4.0,v197,v201
v_fmac_f32 v193,s45,v201
M a[48:51],a[252:255],a[212:215],a[48:51]
v_fmac_f32 v203,s41,v199
v_sub_f32 v201,v201,v197
M a[52:55],a[252:255],a[216:219],a[52:55]
v_fma_f32 v197,-4.0,v195,v199
v_sub_f32 v199,v199,v195
M a[56:59],a[252:255],a[220:223],a[56:59]
v_add_f32 v195,v231,v197
v_sub_f32 v231,v231,v197
M a[60:63],a[252:255],a[192:195],a[60:63]
s_waitcnt vmcnt(15)
buffer_load_dwordx4 a[252:255],v247,s[20:23],s46 offen offset:2048 sc1
M a[64:67],a[224:227],a[196:199],a[64:67]
ds_read_b128 a[196:199],v245 offset:54528
v_fma_f32 v197,2.0,v199,v201
M a[68:71],a[224:227],a[200:203],a[68:71]
v_fmac_f32 v201,-2.0,v199
v_cvt_pk_bf16_f32 v193,v228,v193
M a[72:75],a[224:227],a[204:207],a[72:75]
v_cvt_pk_bf16_f32 v203,v233,v203
v_cvt_pk_bf16_f32 v195,v229,v195
M a[76:79],a[224:227],a[208:211],a[76:79]
v_cvt_pk_bf16_f32 v199,v230,v197
v_cvt_pk_bf16_f32 v197,v234,v231
M a[80:83],a[224:227],a[212:215],a[80:83]
v_cvt_pk_bf16_f32 v201,v232,v201
M a[84:87],a[224:227],a[216:219],a[84:87]
ds_write2st64_b64 v243,v[192:193],v[202:203] offset0:204 offset1:221
M a[88:91],a[224:227],a[220:223],a[88:91]
s_add_u32 s28,s66,786432
buffer_load_dwordx2 v[192:193],v241,s[12:15],s28 offen offset:0
M a[92:95],a[224:227],a[192:195],a[92:95]
s_waitcnt vmcnt(16)
ds_write2st64_b64 v243,v[194:195],v[196:197] offset0:34 offset1:51
M a[0:3],v[216:219],a[200:203],a[0:3]
buffer_load_dwordx2 v[202:203],v241,s[16:19],s28 offen offset:1536
M a[4:7],v[216:219],a[204:207],a[4:7]
ds_write2st64_b64 v243,v[198:199],v[200:201] offset0:68 offset1:85
M a[8:11],v[216:219],a[208:211],a[8:11]
s_waitcnt vmcnt(12)
v_lshlrev_b32 v230,16,v208
v_lshlrev_b32 v228,16,v204
M a[12:15],v[216:219],a[212:215],a[12:15]
buffer_load_dwordx2 v[194:195],v241,s[8:11],s28 offen offset:0
M a[16:19],v[216:219],a[216:219],a[16:19]
v_lshlrev_b32 v229,16,v206
v_lshlrev_b32 v233,16,v214
M a[20:23],v[216:219],a[220:223],a[20:23]
s_waitcnt vmcnt(11)
v_lshlrev_b32 v232,16,v212
v_lshlrev_b32 v231,16,v210
M a[24:27],v[216:219],a[192:195],a[24:27]
s_waitcnt lgkmcnt(3)
v_fmac_f32 v228,s43,v230
v_fmac_f32 v233,4.0,v229
M a[28:31],v[216:219],a[196:199],a[28:31]
buffer_load_dwordx2 v[196:197],v241,s[8:11],s28 offen offset:384
M a[32:35],v[220:223],a[200:203],a[32:35]
v_fma_f32 v234,-4.0,v230,v232
v_fmac_f32 v228,s45,v232
M a[36:39],v[220:223],a[204:207],a[36:39]
v_fmac_f32 v233,s41,v231
v_sub_f32 v232,v232,v230
M a[40:43],v[220:223],a[208:211],a[40:43]
v_fma_f32 v230,-4.0,v229,v231
v_sub_f32 v231,v231,v229
M a[44:47],v[220:223],a[212:215],a[44:47]
buffer_load_dwordx2 v[198:199],v241,s[8:11],s28 offen offset:768
M a[48:51],v[220:223],a[216:219],a[48:51]
v_add_f32 v229,v234,v230
v_sub_f32 v234,v234,v230
M a[52:55],v[220:223],a[220:223],a[52:55]
v_fma_f32 v230,2.0,v231,v232
v_fmac_f32 v232,-2.0,v231
M a[56:59],v[220:223],a[192:195],a[56:59]
v_and_b32 v208,s42,v208
v_and_b32 v204,s42,v204
M a[60:63],v[220:223],a[196:199],a[60:63]
s_waitcnt vmcnt(12)
buffer_load_dwordx2 v[200:201],v241,s[8:11],s28 offen offset:1152
M a[64:67],v[224:227],a[200:203],a[64:67]
ds_read_b128 a[200:203],v245 offset:60928
v_and_b32 v206,s42,v206
M a[68:71],v[224:227],a[204:207],a[68:71]
ds_read_b128 a[204:207],v246 offset:61184
v_and_b32 v214,s42,v214
M a[72:75],v[224:227],a[208:211],a[72:75]
ds_read_b128 a[208:211],v246 offset:61440
v_and_b32 v212,s42,v212
M a[76:79],v[224:227],a[212:215],a[76:79]
buffer_load_dwordx4 a[224:227],v247,s[20:23],s47 offen offset:2048 sc1
M a[80:83],v[224:227],a[216:219],a[80:83]
ds_read_b128 a[212:215],v246 offset:61696
ds_read_b128 a[216:219],v246 offset:61952
M a[84:87],v[224:227],a[220:223],a[84:87]
ds_read_b128 a[220:223],v246 offset:62208
v_and_b32 v210,s42,v210
M a[88:91],v[224:227],a[192:195],a[88:91]
ds_read_b128 a[192:195],v246 offset:62464
v_fmac_f32 v204,s43,v208
M a[92:95],v[224:227],a[196:199],a[92:95]
s_waitcnt vmcnt(13) lgkmcnt(6)
buffer_load_dwordx4 v[216:219],v247,s[20:23],s48 offen offset:2048 sc1
M a[96:99],a[228:231],a[200:203],a[96:99]
s_waitcnt lgkmcnt(5)
s_add_u32 s46,s77,27648
ds_read_b128 a[196:199],v246 offset:62720
v_fmac_f32 v214,4.0,v206
M a[100:103],a[228:231],a[204:207],a[100:103]
s_waitcnt lgkmcnt(5)
v_fma_f32 v231,-4.0,v208,v212
v_fmac_f32 v204,s45,v212
M a[104:107],a[228:231],a[208:211],a[104:107]
s_waitcnt lgkmcnt(4)
v_fmac_f32 v214,s41,v210
v_sub_f32 v212,v212,v208
M a[108:111],a[228:231],a[212:215],a[108:111]
s_waitcnt lgkmcnt(3)
buffer_load_dwordx4 v[220:223],v247,s[20:23],s46 offen offset:0 sc1
M a[112:115],a[228:231],a[216:219],a[112:115]
s_waitcnt lgkmcnt(2)
s_add_u32 s47,s77,30720
v_fma_f32 v208,-4.0,v206,v210
v_sub_f32 v210,v210,v206
M a[116:119],a[228:231],a[220:223],a[116:119]
s_waitcnt lgkmcnt(1)
v_add_f32 v206,v231,v208
v_sub_f32 v231,v231,v208
M a[120:123],a[228:231],a[192:195],a[120:123]
s_waitcnt lgkmcnt(0)
v_fma_f32 v208,2.0,v210,v212
v_fmac_f32 v212,-2.0,v210
M a[124:127],a[228:231],a[196:199],a[124:127]
s_waitcnt vmcnt(14)
buffer_load_dwordx4 v[224:227],v247,s[20:23],s47 offen offset:0 sc1
M a[128:131],a[232:235],a[200:203],a[128:131]
s_add_u32 s48,s77,33792
v_cvt_pk_bf16_f32 v204,v228,v204
v_cvt_pk_bf16_f32 v214,v233,v214
M a[132:135],a[232:235],a[204:207],a[132:135]
v_cvt_pk_bf16_f32 v206,v229,v206
v_cvt_pk_bf16_f32 v210,v230,v208
M a[136:139],a[232:235],a[208:211],a[136:139]
v_cvt_pk_bf16_f32 v208,v234,v231
v_cvt_pk_bf16_f32 v212,v232,v212
M a[140:143],a[232:235],a[212:215],a[140:143]
buffer_load_dwordx4 a[228:231],v247,s[20:23],s48 offen offset:0 sc1
M a[144:147],a[232:235],a[216:219],a[144:147]
v_lshlrev_b32 v230,16,v209
v_lshlrev_b32 v228,16,v205
M a[148:151],a[232:235],a[220:223],a[148:151]
v_lshlrev_b32 v229,16,v207
v_lshlrev_b32 v233,16,v215
M a[152:155],a[232:235],a[192:195],a[152:155]
v_lshlrev_b32 v232,16,v213
v_lshlrev_b32 v231,16,v211
M a[156:159],a[232:235],a[196:199],a[156:159]
s_waitcnt vmcnt(15)
buffer_load_dwordx4 a[232:235],v247,s[20:23],s46 offen offset:1024 sc1
M a[160:163],a[236:239],a[200:203],a[160:163]
ds_read_b128 a[200:203],v246 offset:62976
v_fmac_f32 v228,s43,v230
M a[164:167],a[236:239],a[204:207],a[164:167]
v_fmac_f32 v233,4.0,v229
v_fma_f32 v234,-4.0,v230,v232
M a[168:171],a[236:239],a[208:211],a[168:171]
v_fmac_f32 v228,s45,v232
v_fmac_f32 v233,s41,v231
M a[172:175],a[236:239],a[212:215],a[172:175]
v_sub_f32 v232,v232,v230
v_fma_f32 v230,-4.0,v229,v231
M a[176:179],a[236:239],a[216:219],a[176:179]
v_sub_f32 v231,v231,v229
v_add_f32 v229,v234,v230
M a[180:183],a[236:239],a[220:223],a[180:183]
v_sub_f32 v234,v234,v230
v_fma_f32 v230,2.0,v231,v232
M a[184:187],a[236:239],a[192:195],a[184:187]
v_fmac_f32 v232,-2.0,v231
v_and_b32 v209,s42,v209
M a[188:191],a[236:239],a[196:199],a[188:191]
s_waitcnt vmcnt(15)
buffer_load_dwordx4 a[236:239],v247,s[20:23],s47 offen offset:1024 sc1
M a[96:99],a[240:243],a[204:207],a[96:99]
v_and_b32 v205,s42,v205
v_and_b32 v207,s42,v207
M a[100:103],a[240:243],a[208:211],a[100:103]
v_and_b32 v215,s42,v215
v_and_b32 v213,s42,v213
M a[104:107],a[240:243],a[212:215],a[104:107]
v_and_b32 v211,s42,v211
v_fmac_f32 v205,s43,v209
M a[108:111],a[240:243],a[216:219],a[108:111]
v_fmac_f32 v215,4.0,v207
v_fma_f32 v231,-4.0,v209,v213
M a[112:115],a[240:243],a[220:223],a[112:115]
v_fmac_f32 v205,s45,v213
v_fmac_f32 v215,s41,v211
M a[116:119],a[240:243],a[192:195],a[116:119]
v_sub_f32 v213,v213,v209
v_fma_f32 v209,-4.0,v207,v211
M a[120:123],a[240:243],a[196:199],a[120:123]
s_waitcnt lgkmcnt(0)
v_sub_f32 v211,v211,v207
v_add_f32 v207,v231,v209
M a[124:127],a[240:243],a[200:203],a[124:127]
s_waitcnt vmcnt(15)
buffer_load_dwordx4 a[240:243],v247,s[20:23],s48 offen offset:1024 sc1
M a[128:131],a[244:247],a[204:207],a[128:131]
v_sub_f32 v231,v231,v209
v_fma_f32 v209,2.0,v211,v213
M a[132:135],a[244:247],a[208:211],a[132:135]
v_fmac_f32 v213,-2.0,v211
v_cvt_pk_bf16_f32 v205,v228,v205
M a[136:139],a[244:247],a[212:215],a[136:139]
v_cvt_pk_bf16_f32 v215,v233,v215
v_cvt_pk_bf16_f32 v207,v229,v207
M a[140:143],a[244:247],a[216:219],a[140:143]
v_cvt_pk_bf16_f32 v211,v230,v209
v_cvt_pk_bf16_f32 v209,v234,v231
M a[144:147],a[244:247],a[220:223],a[144:147]
v_cvt_pk_bf16_f32 v213,v232,v213
M a[148:151],a[244:247],a[192:195],a[148:151]
ds_write2st64_b64 v243,v[204:205],v[214:215] offset0:205 offset1:222
M a[152:155],a[244:247],a[196:199],a[152:155]
s_add_u32 s28,s66,1179648
buffer_load_dwordx2 v[204:205],v241,s[12:15],s28 offen offset:0
M a[156:159],a[244:247],a[200:203],a[156:159]
s_waitcnt vmcnt(16)
ds_write2st64_b64 v243,v[206:207],v[208:209] offset0:35 offset1:52
M a[160:163],a[248:251],a[204:207],a[160:163]
buffer_load_dwordx2 v[214:215],v241,s[16:19],s28 offen offset:1536
M a[164:167],a[248:251],a[208:211],a[164:167]
ds_read_b128 a[204:207],v245 offset:63232
ds_write2st64_b64 v243,v[210:211],v[212:213] offset0:69 offset1:86
M a[168:171],a[248:251],a[212:215],a[168:171]
v_fmac_f32 v235,s43,v237
v_fmac_f32 v240,4.0,v236
M a[172:175],a[248:251],a[216:219],a[172:175]
buffer_load_dwordx2 v[206:207],v241,s[8:11],s28 offen offset:0
M a[176:179],a[248:251],a[220:223],a[176:179]
v_fma_f32 v228,-4.0,v237,v239
v_fmac_f32 v235,s45,v239
M a[180:183],a[248:251],a[192:195],a[180:183]
v_fmac_f32 v240,s41,v238
v_sub_f32 v239,v239,v237
M a[184:187],a[248:251],a[196:199],a[184:187]
v_fma_f32 v237,-4.0,v236,v238
v_sub_f32 v238,v238,v236
M a[188:191],a[248:251],a[200:203],a[188:191]
s_waitcnt vmcnt(17)
buffer_load_dwordx2 v[208:209],v241,s[8:11],s28 offen offset:384
M a[96:99],a[252:255],a[208:211],a[96:99]
v_add_f32 v236,v228,v237
v_sub_f32 v228,v228,v237
M a[100:103],a[252:255],a[212:215],a[100:103]
v_fma_f32 v237,2.0,v238,v239
v_fmac_f32 v239,-2.0,v238
M a[104:107],a[252:255],a[216:219],a[104:107]
v_cvt_pk_bf16_f32 v229,v235,v240
v_cvt_pk_bf16_f32 v230,v236,v228
M a[108:111],a[252:255],a[220:223],a[108:111]
buffer_load_dwordx2 v[210:211],v241,s[8:11],s28 offen offset:768
M a[112:115],a[252:255],a[192:195],a[112:115]
v_cvt_pk_bf16_f32 v231,v237,v239
v_add_u32 v228,104448,v244
M a[116:119],a[252:255],a[196:199],a[116:119]
ds_write_b16 v228,v229 offset:0
M a[120:123],a[252:255],a[200:203],a[120:123]
s_waitcnt lgkmcnt(2)
ds_write_b16_d16_hi v228,v229 offset:8704
M a[124:127],a[252:255],a[204:207],a[124:127]
s_waitcnt vmcnt(12)
buffer_load_dwordx2 v[212:213],v241,s[8:11],s28 offen offset:1152
M a[128:131],a[224:227],a[208:211],a[128:131]
ds_write_b16 v244,v230 offset:17408
M a[132:135],a[224:227],a[212:215],a[132:135]
ds_write_b16_d16_hi v244,v230 offset:26112
M a[136:139],a[224:227],a[216:219],a[136:139]
ds_write_b16 v244,v231 offset:34816
M a[140:143],a[224:227],a[220:223],a[140:143]
buffer_load_short_d16_hi v235,v242,s[12:15],s73 offen offset:0
M a[144:147],a[224:227],a[192:195],a[144:147]
ds_write_b16_d16_hi v244,v231 offset:43520
M a[148:151],a[224:227],a[196:199],a[148:151]
buffer_load_short_d16_hi v236,v242,s[8:11],s73 offen offset:0
M a[152:155],a[224:227],a[200:203],a[152:155]
v_add_u32 v245,0x4400,v245
v_add_u32 v246,0x4400,v246
M a[156:159],a[224:227],a[204:207],a[156:159]
s_waitcnt vmcnt(14)
buffer_load_short_d16_hi v237,v242,s[8:11],s73 offen offset:384
M a[160:163],v[216:219],a[208:211],a[160:163]
ds_read_b128 a[208:211],v245 offset:52224
v_lshlrev_b32 v230,16,v196
M a[164:167],v[216:219],a[212:215],a[164:167]
buffer_load_short_d16_hi v238,v242,s[8:11],s73 offen offset:768
M a[168:171],v[216:219],a[216:219],a[168:171]
ds_read_b128 a[212:215],v246 offset:52480
ds_read_b128 a[216:219],v246 offset:52736
M a[172:175],v[216:219],a[220:223],a[172:175]
buffer_load_short_d16_hi v239,v242,s[8:11],s73 offen offset:1152
M a[176:179],v[216:219],a[192:195],a[176:179]
ds_read_b128 a[220:223],v246 offset:52992
ds_read_b128 a[192:195],v246 offset:53248
M a[180:183],v[216:219],a[196:199],a[180:183]
buffer_load_short_d16_hi v240,v242,s[16:19],s73 offen offset:1536
M a[184:187],v[216:219],a[200:203],a[184:187]
ds_read_b128 a[196:199],v246 offset:53504
ds_read_b128 a[200:203],v246 offset:53760
M a[188:191],v[216:219],a[204:207],a[188:191]
s_waitcnt vmcnt(17) lgkmcnt(6)
buffer_load_dwordx4 a[244:247],v247,s[20:23],s46 offen offset:2048 sc1
M v[0:3],v[220:223],a[208:211],v[0:3]
s_waitcnt lgkmcnt(5)
ds_read_b128 a[204:207],v246 offset:54016
v_lshlrev_b32 v228,16,v192
M v[4:7],v[220:223],a[212:215],v[4:7]
s_waitcnt lgkmcnt(5)
v_lshlrev_b32 v229,16,v194
v_lshlrev_b32 v233,16,v202
M v[8:11],v[220:223],a[216:219],v[8:11]
s_waitcnt lgkmcnt(4)
v_lshlrev_b32 v232,16,v200
v_lshlrev_b32 v231,16,v198
M v[12:15],v[220:223],a[220:223],v[12:15]
s_waitcnt lgkmcnt(3)
buffer_load_dwordx4 a[248:251],v247,s[20:23],s47 offen offset:2048 sc1
M v[16:19],v[220:223],a[192:195],v[16:19]
s_waitcnt lgkmcnt(2)
v_fmac_f32 v228,s43,v230
v_fmac_f32 v233,4.0,v229
M v[20:23],v[220:223],a[196:199],v[20:23]
s_waitcnt lgkmcnt(1)
v_fma_f32 v234,-4.0,v230,v232
v_fmac_f32 v228,s45,v232
M v[24:27],v[220:223],a[200:203],v[24:27]
s_waitcnt lgkmcnt(0)
v_fmac_f32 v233,s41,v231
v_sub_f32 v232,v232,v230
M v[28:31],v[220:223],a[204:207],v[28:31]
s_waitcnt vmcnt(18)
buffer_load_dwordx4 a[252:255],v247,s[20:23],s48 offen offset:2048 sc1
M v[32:35],v[224:227],a[208:211],v[32:35]
s_add_u32 s46,s77,36864
v_fma_f32 v230,-4.0,v229,v231
v_sub_f32 v231,v231,v229
M v[36:39],v[224:227],a[212:215],v[36:39]
v_add_f32 v229,v234,v230
v_sub_f32 v234,v234,v230
M v[40:43],v[224:227],a[216:219],v[40:43]
v_fma_f32 v230,2.0,v231,v232
v_fmac_f32 v232,-2.0,v231
M v[44:47],v[224:227],a[220:223],v[44:47]
buffer_load_dwordx4 a[224:227],v247,s[20:23],s46 offen offset:0 sc1
M v[48:51],v[224:227],a[192:195],v[48:51]
s_add_u32 s47,s77,39936
v_and_b32 v196,s42,v196
v_and_b32 v192,s42,v192
M v[52:55],v[224:227],a[196:199],v[52:55]
v_and_b32 v194,s42,v194
v_and_b32 v202,s42,v202
M v[56:59],v[224:227],a[200:203],v[56:59]
v_and_b32 v200,s42,v200
v_and_b32 v198,s42,v198
M v[60:63],v[224:227],a[204:207],v[60:63]
s_waitcnt vmcnt(19)
buffer_load_dwordx4 v[216:219],v247,s[20:23],s47 offen offset:0 sc1
M v[64:67],a[228:231],a[208:211],v[64:67]
s_add_u32 s48,s77,43008
ds_read_b128 a[208:211],v246 offset:54272
v_fmac_f32 v192,s43,v196
M v[68:71],a[228:231],a[212:215],v[68:71]
v_fmac_f32 v202,4.0,v194
v_fma_f32 v231,-4.0,v196,v200
M v[72:75],a[228:231],a[216:219],v[72:75]
v_fmac_f32 v192,s45,v200
v_fmac_f32 v202,s41,v198
M v[76:79],a[228:231],a[220:223],v[76:79]
global_load_dword v251,v252,s[82:83]
M v[80:83],a[228:231],a[192:195],v[80:83]
v_sub_f32 v200,v200,v196
v_fma_f32 v196,-4.0,v194,v198
M v[84:87],a[228:231],a[196:199],v[84:87]
buffer_load_dwordx4 v[220:223],v247,s[20:23],s48 offen offset:0 sc1
M v[88:91],a[228:231],a[200:203],v[88:91]
v_sub_f32 v198,v198,v194
v_add_f32 v194,v231,v196
M v[92:95],a[228:231],a[204:207],v[92:95]
s_waitcnt vmcnt(21)
v_sub_f32 v231,v231,v196
v_fma_f32 v196,2.0,v198,v200
M v[0:3],a[232:235],a[212:215],v[0:3]
v_fmac_f32 v200,-2.0,v198
v_cvt_pk_bf16_f32 v192,v228,v192
M v[4:7],a[232:235],a[216:219],v[4:7]
buffer_load_dwordx4 v[224:227],v247,s[20:23],s46 offen offset:1024 sc1
M v[8:11],a[232:235],a[220:223],v[8:11]
v_cvt_pk_bf16_f32 v202,v233,v202
v_cvt_pk_bf16_f32 v194,v229,v194
M v[12:15],a[232:235],a[192:195],v[12:15]
v_cvt_pk_bf16_f32 v198,v230,v196
v_cvt_pk_bf16_f32 v196,v234,v231
M v[16:19],a[232:235],a[196:199],v[16:19]
v_cvt_pk_bf16_f32 v200,v232,v200
v_lshlrev_b32 v230,16,v197
M v[20:23],a[232:235],a[200:203],v[20:23]
buffer_load_dwordx4 a[228:231],v247,s[20:23],s47 offen offset:1024 sc1
M v[24:27],a[232:235],a[204:207],v[24:27]
s_waitcnt lgkmcnt(0)
v_lshlrev_b32 v228,16,v193
v_lshlrev_b32 v229,16,v195
M v[28:31],a[232:235],a[208:211],v[28:31]
s_waitcnt vmcnt(22)
v_lshlrev_b32 v233,16,v203
v_lshlrev_b32 v232,16,v201
M v[32:35],a[236:239],a[212:215],v[32:35]
v_lshlrev_b32 v231,16,v199
v_fmac_f32 v228,s43,v230
M v[36:39],a[236:239],a[216:219],v[36:39]
buffer_load_dwordx4 a[232:235],v247,s[20:23],s48 offen offset:1024 sc1
M v[40:43],a[236:239],a[220:223],v[40:43]
v_fmac_f32 v233,4.0,v229
v_fma_f32 v234,-4.0,v230,v232
M v[44:47],a[236:239],a[192:195],v[44:47]
v_fmac_f32 v228,s45,v232
v_fmac_f32 v233,s41,v231
M v[48:51],a[236:239],a[196:199],v[48:51]
v_sub_f32 v232,v232,v230
v_fma_f32 v230,-4.0,v229,v231
M v[52:55],a[236:239],a[200:203],v[52:55]
v_sub_f32 v231,v231,v229
v_add_f32 v229,v234,v230
M v[56:59],a[236:239],a[204:207],v[56:59]
v_sub_f32 v234,v234,v230
v_fma_f32 v230,2.0,v231,v232
M v[60:63],a[236:239],a[208:211],v[60:63]
s_waitcnt vmcnt(22)
buffer_load_dwordx4 a[236:239],v247,s[20:23],s46 offen offset:2048 sc1
M v[64:67],a[240:243],a[212:215],v[64:67]
ds_read_b128 a[212:215],v245 offset:54528
v_fmac_f32 v232,-2.0,v231
M v[68:71],a[240:243],a[216:219],v[68:71]
v_and_b32 v197,s42,v197
v_and_b32 v193,s42,v193
M v[72:75],a[240:243],a[220:223],v[72:75]
v_and_b32 v195,s42,v195
v_and_b32 v203,s42,v203
M v[76:79],a[240:243],a[192:195],v[76:79]
v_and_b32 v201,s42,v201
v_and_b32 v199,s42,v199
M v[80:83],a[240:243],a[196:199],v[80:83]
v_fmac_f32 v193,s43,v197
v_fmac_f32 v203,4.0,v195
M v[84:87],a[240:243],a[200:203],v[84:87]
v_fma_f32 v231,-4.0,v197,v201
v_fmac_f32 v193,s45,v201
M v[88:91],a[240:243],a[204:207],v[88:91]
v_fmac_f32 v203,s41,v199
v_sub_f32 v201,v201,v197
M v[92:95],a[240:243],a[208:211],v[92:95]
s_waitcnt vmcnt(10)
buffer_load_dwordx4 a[240:243],v247,s[20:23],s47 offen offset:2048 sc1
M v[0:3],a[244:247],a[216:219],v[0:3]
v_fma_f32 v197,-4.0,v195,v199
v_sub_f32 v199,v199,v195
M v[4:7],a[244:247],a[220:223],v[4:7]
v_add_f32 v195,v231,v197
v_sub_f32 v231,v231,v197
M v[8:11],a[244:247],a[192:195],v[8:11]
v_fma_f32 v197,2.0,v199,v201
v_fmac_f32 v201,-2.0,v199
M v[12:15],a[244:247],a[196:199],v[12:15]
v_cvt_pk_bf16_f32 v193,v228,v193
v_cvt_pk_bf16_f32 v203,v233,v203
M v[16:19],a[244:247],a[200:203],v[16:19]
v_cvt_pk_bf16_f32 v195,v229,v195
v_cvt_pk_bf16_f32 v199,v230,v197
M v[20:23],a[244:247],a[204:207],v[20:23]
v_cvt_pk_bf16_f32 v197,v234,v231
v_cvt_pk_bf16_f32 v201,v232,v201
M v[24:27],a[244:247],a[208:211],v[24:27]
s_waitcnt lgkmcnt(0)
ds_write2st64_b64 v243,v[192:193],v[202:203] offset0:206 offset1:223
M v[28:31],a[244:247],a[212:215],v[28:31]
s_waitcnt vmcnt(10)
s_add_u32 s28,s67,0
buffer_load_dwordx2 v[192:193],v241,s[12:15],s28 offen offset:0
M v[32:35],a[248:251],a[216:219],v[32:35]
ds_write2st64_b64 v243,v[194:195],v[196:197] offset0:36 offset1:53
M v[36:39],a[248:251],a[220:223],v[36:39]
buffer_load_dwordx2 v[202:203],v241,s[16:19],s28 offen offset:1536
M v[40:43],a[248:251],a[192:195],v[40:43]
ds_write2st64_b64 v243,v[198:199],v[200:201] offset0:70 offset1:87
M v[44:47],a[248:251],a[196:199],v[44:47]
v_lshlrev_b32 v230,16,v208
v_lshlrev_b32 v228,16,v204
M v[48:51],a[248:251],a[200:203],v[48:51]
buffer_load_dwordx2 v[194:195],v241,s[8:11],s28 offen offset:0
M v[52:55],a[248:251],a[204:207],v[52:55]
v_lshlrev_b32 v229,16,v206
v_lshlrev_b32 v233,16,v214
M v[56:59],a[248:251],a[208:211],v[56:59]
v_lshlrev_b32 v232,16,v212
v_lshlrev_b32 v231,16,v210
M v[60:63],a[248:251],a[212:215],v[60:63]
s_waitcnt vmcnt(12)
v_fmac_f32 v228,s43,v230
v_fmac_f32 v233,4.0,v229
M v[64:67],a[252:255],a[216:219],v[64:67]
buffer_load_dwordx2 v[196:197],v241,s[8:11],s28 offen offset:384
M v[68:71],a[252:255],a[220:223],v[68:71]
ds_read_b128 a[216:219],v245 offset:60928
ds_read_b128 a[220:223],v246 offset:61184
M v[72:75],a[252:255],a[192:195],v[72:75]
ds_read_b128 a[192:195],v246 offset:61440
v_fma_f32 v234,-4.0,v230,v232
M v[76:79],a[252:255],a[196:199],v[76:79]
ds_read_b128 a[196:199],v246 offset:61696
v_fmac_f32 v228,s45,v232
M v[80:83],a[252:255],a[200:203],v[80:83]
buffer_load_dwordx2 v[198:199],v241,s[8:11],s28 offen offset:768
M v[84:87],a[252:255],a[204:207],v[84:87]
ds_read_b128 a[200:203],v246 offset:61952
ds_read_b128 a[204:207],v246 offset:62208
M v[88:91],a[252:255],a[208:211],v[88:91]
ds_read_b128 a[208:211],v246 offset:62464
v_fmac_f32 v233,s41,v231
M v[92:95],a[252:255],a[212:215],v[92:95]
s_waitcnt vmcnt(13) lgkmcnt(6)
ds_read_b128 a[212:215],v246 offset:62720
v_sub_f32 v232,v232,v230
M v[96:99],a[224:227],a[216:219],v[96:99]
s_waitcnt lgkmcnt(6)
buffer_load_dwordx2 v[200:201],v241,s[8:11],s28 offen offset:1152
M v[100:103],a[224:227],a[220:223],v[100:103]
s_waitcnt lgkmcnt(5)
v_fma_f32 v230,-4.0,v229,v231
v_sub_f32 v231,v231,v229
M v[104:107],a[224:227],a[192:195],v[104:107]
s_waitcnt lgkmcnt(4)
v_add_f32 v229,v234,v230
v_sub_f32 v234,v234,v230
M v[108:111],a[224:227],a[196:199],v[108:111]
s_waitcnt lgkmcnt(3)
v_fma_f32 v230,2.0,v231,v232
v_fmac_f32 v232,-2.0,v231
M v[112:115],a[224:227],a[200:203],v[112:115]
s_waitcnt lgkmcnt(2)
buffer_load_dwordx4 a[244:247],v247,s[20:23],s48 offen offset:2048 sc1
M v[116:119],a[224:227],a[204:207],v[116:119]
s_waitcnt lgkmcnt(1)
s_add_u32 s46,s78,9216
v_and_b32 v208,s42,v208
v_and_b32 v204,s42,v204
M v[120:123],a[224:227],a[208:211],v[120:123]
s_waitcnt lgkmcnt(0)
v_and_b32 v206,s42,v206
v_and_b32 v214,s42,v214
M v[124:127],a[224:227],a[212:215],v[124:127]
s_waitcnt vmcnt(14)
v_and_b32 v212,s42,v212
v_and_b32 v210,s42,v210
M v[128:131],v[216:219],a[216:219],v[128:131]
buffer_load_dwordx4 a[248:251],v247,s[20:23],s46 offen offset:0 sc1
M v[132:135],v[216:219],a[220:223],v[132:135]
s_add_u32 s47,s78,12288
v_fmac_f32 v204,s43,v208
v_fmac_f32 v214,4.0,v206
M v[136:139],v[216:219],a[192:195],v[136:139]
v_fma_f32 v231,-4.0,v208,v212
v_fmac_f32 v204,s45,v212
M v[140:143],v[216:219],a[196:199],v[140:143]
v_fmac_f32 v214,s41,v210
v_sub_f32 v212,v212,v208
M v[144:147],v[216:219],a[200:203],v[144:147]
buffer_load_dwordx4 a[252:255],v247,s[20:23],s47 offen offset:0 sc1
M v[148:151],v[216:219],a[204:207],v[148:151]
s_add_u32 s48,s78,15360
v_fma_f32 v208,-4.0,v206,v210
v_sub_f32 v210,v210,v206
M v[152:155],v[216:219],a[208:211],v[152:155]
v_add_f32 v206,v231,v208
v_sub_f32 v231,v231,v208
M v[156:159],v[216:219],a[212:215],v[156:159]
s_waitcnt vmcnt(14)
v_fma_f32 v208,2.0,v210,v212
v_fmac_f32 v212,-2.0,v210
M v[160:163],v[220:223],a[216:219],v[160:163]
buffer_load_dwordx4 a[224:227],v247,s[20:23],s48 offen offset:0 sc1
M v[164:167],v[220:223],a[220:223],v[164:167]
ds_read_b128 a[216:219],v246 offset:62976
v_cvt_pk_bf16_f32 v204,v228,v204
M v[168:171],v[220:223],a[192:195],v[168:171]
v_cvt_pk_bf16_f32 v214,v233,v214
v_cvt_pk_bf16_f32 v206,v229,v206
M v[172:175],v[220:223],a[196:199],v[172:175]
v_cvt_pk_bf16_f32 v210,v230,v208
v_cvt_pk_bf16_f32 v208,v234,v231
M v[176:179],v[220:223],a[200:203],v[176:179]
buffer_load_dwordx4 v[216:219],v247,s[20:23],s46 offen offset:1024 sc1
M v[180:183],v[220:223],a[204:207],v[180:183]
v_cvt_pk_bf16_f32 v212,v232,v212
v_lshlrev_b32 v230,16,v209
M v[184:187],v[220:223],a[208:211],v[184:187]
v_lshlrev_b32 v228,16,v205
v_lshlrev_b32 v229,16,v207
M v[188:191],v[220:223],a[212:215],v[188:191]
s_waitcnt vmcnt(15)
v_lshlrev_b32 v233,16,v215
v_lshlrev_b32 v232,16,v213
M v[96:99],v[224:227],a[220:223],v[96:99]
buffer_load_dwordx4 v[220:223],v247,s[20:23],s47 offen offset:1024 sc1
M v[100:103],v[224:227],a[192:195],v[100:103]
v_lshlrev_b32 v231,16,v211
v_fmac_f32 v228,s43,v230
M v[104:107],v[224:227],a[196:199],v[104:107]
v_fmac_f32 v233,4.0,v229
v_fma_f32 v234,-4.0,v230,v232
M v[108:111],v[224:227],a[200:203],v[108:111]
v_fmac_f32 v228,s45,v232
v_fmac_f32 v233,s41,v231
M v[112:115],v[224:227],a[204:207],v[112:115]
v_sub_f32 v232,v232,v230
v_fma_f32 v230,-4.0,v229,v231
M v[116:119],v[224:227],a[208:211],v[116:119]
v_sub_f32 v231,v231,v229
v_add_f32 v229,v234,v230
M v[120:123],v[224:227],a[212:215],v[120:123]
s_waitcnt lgkmcnt(0)
v_sub_f32 v234,v234,v230
v_fma_f32 v230,2.0,v231,v232
M v[124:127],v[224:227],a[216:219],v[124:127]
s_waitcnt vmcnt(15)
buffer_load_dwordx4 v[224:227],v247,s[20:23],s48 offen offset:1024 sc1
M v[128:131],a[228:231],a[220:223],v[128:131]
v_fmac_f32 v232,-2.0,v231
v_and_b32 v209,s42,v209
M v[132:135],a[228:231],a[192:195],v[132:135]
v_and_b32 v205,s42,v205
v_and_b32 v207,s42,v207
M v[136:139],a[228:231],a[196:199],v[136:139]
v_and_b32 v215,s42,v215
v_and_b32 v213,s42,v213
M v[140:143],a[228:231],a[200:203],v[140:143]
v_and_b32 v211,s42,v211
v_fmac_f32 v205,s43,v209
M v[144:147],a[228:231],a[204:207],v[144:147]
v_fmac_f32 v215,4.0,v207
v_fma_f32 v231,-4.0,v209,v213
M v[148:151],a[228:231],a[208:211],v[148:151]
v_fmac_f32 v205,s45,v213
v_fmac_f32 v215,s41,v211
M v[152:155],a[228:231],a[212:215],v[152:155]
v_sub_f32 v213,v213,v209
v_fma_f32 v209,-4.0,v207,v211
M v[156:159],a[228:231],a[216:219],v[156:159]
s_waitcnt vmcnt(15)
buffer_load_dwordx4 a[228:231],v247,s[20:23],s46 offen offset:2048 sc1
M v[160:163],a[232:235],a[220:223],v[160:163]
ds_read_b128 a[220:223],v245 offset:63232
v_sub_f32 v211,v211,v207
M v[164:167],a[232:235],a[192:195],v[164:167]
v_add_f32 v207,v231,v209
v_sub_f32 v231,v231,v209
M v[168:171],a[232:235],a[196:199],v[168:171]
v_fma_f32 v209,2.0,v211,v213
v_fmac_f32 v213,-2.0,v211
M v[172:175],a[232:235],a[200:203],v[172:175]
v_cvt_pk_bf16_f32 v205,v228,v205
v_cvt_pk_bf16_f32 v215,v233,v215
M v[176:179],a[232:235],a[204:207],v[176:179]
v_cvt_pk_bf16_f32 v207,v229,v207
v_cvt_pk_bf16_f32 v211,v230,v209
M v[180:183],a[232:235],a[208:211],v[180:183]
v_cvt_pk_bf16_f32 v209,v234,v231
v_cvt_pk_bf16_f32 v213,v232,v213
M v[184:187],a[232:235],a[212:215],v[184:187]
ds_write2st64_b64 v243,v[204:205],v[214:215] offset0:207 offset1:224
M v[188:191],a[232:235],a[216:219],v[188:191]
s_waitcnt vmcnt(15)
s_add_u32 s28,s67,393216
buffer_load_dwordx2 v[204:205],v241,s[12:15],s28 offen offset:0
M v[96:99],a[236:239],a[192:195],v[96:99]
ds_write2st64_b64 v243,v[206:207],v[208:209] offset0:37 offset1:54
M v[100:103],a[236:239],a[196:199],v[100:103]
buffer_load_dwordx2 v[214:215],v241,s[16:19],s28 offen offset:1536
M v[104:107],a[236:239],a[200:203],v[104:107]
ds_write2st64_b64 v243,v[210:211],v[212:213] offset0:71 offset1:88
M v[108:111],a[236:239],a[204:207],v[108:111]
s_waitcnt vmcnt(12)
v_lshlrev_b32 v230,16,v196
v_lshlrev_b32 v228,16,v192
M v[112:115],a[236:239],a[208:211],v[112:115]
buffer_load_dwordx2 v[206:207],v241,s[8:11],s28 offen offset:0
M v[116:119],a[236:239],a[212:215],v[116:119]
v_lshlrev_b32 v229,16,v194
v_lshlrev_b32 v233,16,v202
M v[120:123],a[236:239],a[216:219],v[120:123]
s_waitcnt vmcnt(11) lgkmcnt(3)
v_lshlrev_b32 v232,16,v200
v_lshlrev_b32 v231,16,v198
M v[124:127],a[236:239],a[220:223],v[124:127]
v_fmac_f32 v228,s43,v230
v_fmac_f32 v233,4.0,v229
M v[128:131],a[240:243],a[192:195],v[128:131]
buffer_load_dwordx2 v[208:209],v241,s[8:11],s28 offen offset:384
M v[132:135],a[240:243],a[196:199],v[132:135]
v_fma_f32 v234,-4.0,v230,v232
v_fmac_f32 v228,s45,v232
M v[136:139],a[240:243],a[200:203],v[136:139]
v_fmac_f32 v233,s41,v231
v_sub_f32 v232,v232,v230
M v[140:143],a[240:243],a[204:207],v[140:143]
v_fma_f32 v230,-4.0,v229,v231
v_sub_f32 v231,v231,v229
M v[144:147],a[240:243],a[208:211],v[144:147]
buffer_load_dwordx2 v[210:211],v241,s[8:11],s28 offen offset:768
M v[148:151],a[240:243],a[212:215],v[148:151]
v_add_f32 v229,v234,v230
v_sub_f32 v234,v234,v230
M v[152:155],a[240:243],a[216:219],v[152:155]
s_waitcnt lgkmcnt(0)
s_barrier
v_fma_f32 v230,2.0,v231,v232
M v[156:159],a[240:243],a[220:223],v[156:159]
s_waitcnt vmcnt(12)
v_fmac_f32 v232,-2.0,v231
v_and_b32 v196,s42,v196
M v[160:163],a[244:247],a[192:195],v[160:163]
buffer_load_dwordx2 v[212:213],v241,s[8:11],s28 offen offset:1152
M v[164:167],a[244:247],a[196:199],v[164:167]
ds_read_b128 a[192:195],v245 offset:0
ds_read_b128 a[196:199],v246 offset:256
M v[168:171],a[244:247],a[200:203],v[168:171]
ds_read_b128 a[200:203],v246 offset:512
v_and_b32 v192,s42,v192
M v[172:175],a[244:247],a[204:207],v[172:175]
ds_read_b128 a[204:207],v246 offset:768
v_and_b32 v194,s42,v194
M v[176:179],a[244:247],a[208:211],v[176:179]
buffer_load_dwordx4 a[232:235],v247,s[20:23],s47 offen offset:2048 sc1
M v[180:183],a[244:247],a[212:215],v[180:183]
ds_read_b128 a[208:211],v246 offset:1024
ds_read_b128 a[212:215],v246 offset:1280
M v[184:187],a[244:247],a[216:219],v[184:187]
ds_read_b128 a[216:219],v246 offset:1536
v_and_b32 v202,s42,v202
M v[188:191],a[244:247],a[220:223],v[188:191]
s_waitcnt vmcnt(13) lgkmcnt(6)
ds_read_b128 a[220:223],v246 offset:1792
v_and_b32 v200,s42,v200
M a[0:3],a[248:251],a[192:195],a[0:3]
s_waitcnt lgkmcnt(6)
buffer_load_dwordx4 a[236:239],v247,s[20:23],s48 offen offset:2048 sc1
M a[4:7],a[248:251],a[196:199],a[4:7]
s_waitcnt lgkmcnt(5)
s_add_u32 s46,s78,18432
v_and_b32 v198,s42,v198
v_fmac_f32 v192,s43,v196
M a[8:11],a[248:251],a[200:203],a[8:11]
s_waitcnt lgkmcnt(4)
v_fmac_f32 v202,4.0,v194
v_fma_f32 v231,-4.0,v196,v200
M a[12:15],a[248:251],a[204:207],a[12:15]
s_waitcnt lgkmcnt(3)
v_fmac_f32 v192,s45,v200
v_fmac_f32 v202,s41,v198
M a[16:19],a[248:251],a[208:211],a[16:19]
s_waitcnt lgkmcnt(2)
buffer_load_dwordx4 a[240:243],v247,s[20:23],s46 offen offset:0 sc1
M a[20:23],a[248:251],a[212:215],a[20:23]
s_waitcnt lgkmcnt(1)
s_add_u32 s47,s78,21504
v_sub_f32 v200,v200,v196
v_fma_f32 v196,-4.0,v194,v198
M a[24:27],a[248:251],a[216:219],a[24:27]
s_waitcnt lgkmcnt(0)
v_sub_f32 v198,v198,v194
v_add_f32 v194,v231,v196
M a[28:31],a[248:251],a[220:223],a[28:31]
s_waitcnt vmcnt(14)
v_sub_f32 v231,v231,v196
v_fma_f32 v196,2.0,v198,v200
M a[32:35],a[252:255],a[192:195],a[32:35]
buffer_load_dwordx4 a[244:247],v247,s[20:23],s47 offen offset:0 sc1
M a[36:39],a[252:255],a[196:199],a[36:39]
s_add_u32 s48,s78,24576
v_fmac_f32 v200,-2.0,v198
v_cvt_pk_bf16_f32 v192,v228,v192
M a[40:43],a[252:255],a[200:203],a[40:43]
v_cvt_pk_bf16_f32 v202,v233,v202
v_cvt_pk_bf16_f32 v194,v229,v194
M a[44:47],a[252:255],a[204:207],a[44:47]
v_cvt_pk_bf16_f32 v198,v230,v196
v_cvt_pk_bf16_f32 v196,v234,v231
M a[48:51],a[252:255],a[208:211],a[48:51]
buffer_load_dwordx4 a[248:251],v247,s[20:23],s48 offen offset:0 sc1
M a[52:55],a[252:255],a[212:215],a[52:55]
v_cvt_pk_bf16_f32 v200,v232,v200
v_lshlrev_b32 v230,16,v197
M a[56:59],a[252:255],a[216:219],a[56:59]
v_lshlrev_b32 v228,16,v193
v_lshlrev_b32 v229,16,v195
M a[60:63],a[252:255],a[220:223],a[60:63]
s_waitcnt vmcnt(15)
v_lshlrev_b32 v233,16,v203
v_lshlrev_b32 v232,16,v201
M a[64:67],a[224:227],a[192:195],a[64:67]
buffer_load_dwordx4 a[252:255],v247,s[20:23],s46 offen offset:1024 sc1
M a[68:71],a[224:227],a[196:199],a[68:71]
ds_read_b128 a[192:195],v246 offset:2048
v_lshlrev_b32 v231,16,v199
M a[72:75],a[224:227],a[200:203],a[72:75]
v_fmac_f32 v228,s43,v230
v_fmac_f32 v233,4.0,v229
M a[76:79],a[224:227],a[204:207],a[76:79]
v_fma_f32 v234,-4.0,v230,v232
v_fmac_f32 v228,s45,v232
M a[80:83],a[224:227],a[208:211],a[80:83]
v_fmac_f32 v233,s41,v231
v_sub_f32 v232,v232,v230
M a[84:87],a[224:227],a[212:215],a[84:87]
v_fma_f32 v230,-4.0,v229,v231
v_sub_f32 v231,v231,v229
M a[88:91],a[224:227],a[216:219],a[88:91]
v_add_f32 v229,v234,v230
v_sub_f32 v234,v234,v230
M a[92:95],a[224:227],a[220:223],a[92:95]
s_waitcnt vmcnt(15)
buffer_load_dwordx4 a[224:227],v247,s[20:23],s47 offen offset:1024 sc1
M a[0:3],v[216:219],a[196:199],a[0:3]
v_fma_f32 v230,2.0,v231,v232
v_fmac_f32 v232,-2.0,v231
M a[4:7],v[216:219],a[200:203],a[4:7]
v_and_b32 v197,s42,v197
v_and_b32 v193,s42,v193
M a[8:11],v[216:219],a[204:207],a[8:11]
v_and_b32 v195,s42,v195
v_and_b32 v203,s42,v203
M a[12:15],v[216:219],a[208:211],a[12:15]
v_and_b32 v201,s42,v201
v_and_b32 v199,s42,v199
M a[16:19],v[216:219],a[212:215],a[16:19]
v_fmac_f32 v193,s43,v197
v_fmac_f32 v203,4.0,v195
M a[20:23],v[216:219],a[216:219],a[20:23]
v_fma_f32 v231,-4.0,v197,v201
v_fmac_f32 v193,s45,v201
M a[24:27],v[216:219],a[220:223],a[24:27]
s_waitcnt lgkmcnt(0)
v_fmac_f32 v203,s41,v199
v_sub_f32 v201,v201,v197
M a[28:31],v[216:219],a[192:195],a[28:31]
s_waitcnt vmcnt(15)
buffer_load_dwordx4 v[216:219],v247,s[20:23],s48 offen offset:1024 sc1
M a[32:35],v[220:223],a[196:199],a[32:35]
v_fma_f32 v197,-4.0,v195,v199
v_sub_f32 v199,v199,v195
M a[36:39],v[220:223],a[200:203],a[36:39]
v_add_f32 v195,v231,v197
v_sub_f32 v231,v231,v197
M a[40:43],v[220:223],a[204:207],a[40:43]
v_fma_f32 v197,2.0,v199,v201
v_fmac_f32 v201,-2.0,v199
M a[44:47],v[220:223],a[208:211],a[44:47]
v_cvt_pk_bf16_f32 v193,v228,v193
v_cvt_pk_bf16_f32 v203,v233,v203
M a[48:51],v[220:223],a[212:215],a[48:51]
v_cvt_pk_bf16_f32 v195,v229,v195
v_cvt_pk_bf16_f32 v199,v230,v197
M a[52:55],v[220:223],a[216:219],a[52:55]
v_cvt_pk_bf16_f32 v197,v234,v231
v_cvt_pk_bf16_f32 v201,v232,v201
M a[56:59],v[220:223],a[220:223],a[56:59]
ds_write2st64_b64 v243,v[192:193],v[202:203] offset0:238 offset1:255
M a[60:63],v[220:223],a[192:195],a[60:63]
s_waitcnt vmcnt(15)
s_add_u32 s28,s67,786432
buffer_load_dwordx2 v[192:193],v241,s[12:15],s28 offen offset:0
M a[64:67],v[224:227],a[196:199],a[64:67]
ds_read_b128 a[196:199],v245 offset:2304
ds_write2st64_b64 v243,v[194:195],v[196:197] offset0:102 offset1:119
M a[68:71],v[224:227],a[200:203],a[68:71]
buffer_load_dwordx2 v[202:203],v241,s[16:19],s28 offen offset:1536
M a[72:75],v[224:227],a[204:207],a[72:75]
ds_write2st64_b64 v243,v[198:199],v[200:201] offset0:136 offset1:153
M a[76:79],v[224:227],a[208:211],a[76:79]
s_waitcnt vmcnt(12)
v_lshlrev_b32 v230,16,v208
v_lshlrev_b32 v228,16,v204
M a[80:83],v[224:227],a[212:215],a[80:83]
buffer_load_dwordx2 v[194:195],v241,s[8:11],s28 offen offset:0
M a[84:87],v[224:227],a[216:219],a[84:87]
v_lshlrev_b32 v229,16,v206
v_lshlrev_b32 v233,16,v214
M a[88:91],v[224:227],a[220:223],a[88:91]
s_waitcnt vmcnt(11)
v_lshlrev_b32 v232,16,v212
v_lshlrev_b32 v231,16,v210
M a[92:95],v[224:227],a[192:195],a[92:95]
v_fmac_f32 v228,s43,v230
v_fmac_f32 v233,4.0,v229
M a[0:3],a[228:231],a[200:203],a[0:3]
buffer_load_dwordx2 v[196:197],v241,s[8:11],s28 offen offset:384
M a[4:7],a[228:231],a[204:207],a[4:7]
v_fma_f32 v234,-4.0,v230,v232
v_fmac_f32 v228,s45,v232
M a[8:11],a[228:231],a[208:211],a[8:11]
v_fmac_f32 v233,s41,v231
v_sub_f32 v232,v232,v230
M a[12:15],a[228:231],a[212:215],a[12:15]
v_fma_f32 v230,-4.0,v229,v231
v_sub_f32 v231,v231,v229
M a[16:19],a[228:231],a[216:219],a[16:19]
buffer_load_dwordx2 v[198:199],v241,s[8:11],s28 offen offset:768
M a[20:23],a[228:231],a[220:223],a[20:23]
v_add_f32 v229,v234,v230
v_sub_f32 v234,v234,v230
M a[24:27],a[228:231],a[192:195],a[24:27]
s_waitcnt lgkmcnt(2)
v_fma_f32 v230,2.0,v231,v232
v_fmac_f32 v232,-2.0,v231
M a[28:31],a[228:231],a[196:199],a[28:31]
s_waitcnt vmcnt(12)
v_and_b32 v208,s42,v208
v_and_b32 v204,s42,v204
M a[32:35],a[232:235],a[200:203],a[32:35]
buffer_load_dwordx2 v[200:201],v241,s[8:11],s28 offen offset:1152
M a[36:39],a[232:235],a[204:207],a[36:39]
v_and_b32 v206,s42,v206
v_and_b32 v214,s42,v214
M a[40:43],a[232:235],a[208:211],a[40:43]
v_and_b32 v212,s42,v212
v_and_b32 v210,s42,v210
M a[44:47],a[232:235],a[212:215],a[44:47]
v_fmac_f32 v204,s43,v208
v_fmac_f32 v214,4.0,v206
M a[48:51],a[232:235],a[216:219],a[48:51]
buffer_load_dwordx4 v[220:223],v247,s[20:23],s46 offen offset:2048 sc1
M a[52:55],a[232:235],a[220:223],a[52:55]
v_fma_f32 v231,-4.0,v208,v212
v_fmac_f32 v204,s45,v212
M a[56:59],a[232:235],a[192:195],a[56:59]
v_fmac_f32 v214,s41,v210
v_sub_f32 v212,v212,v208
M a[60:63],a[232:235],a[196:199],a[60:63]
s_waitcnt vmcnt(13)
v_fma_f32 v208,-4.0,v206,v210
v_sub_f32 v210,v210,v206
M a[64:67],a[236:239],a[200:203],a[64:67]
buffer_load_dwordx4 v[224:227],v247,s[20:23],s47 offen offset:2048 sc1
M a[68:71],a[236:239],a[204:207],a[68:71]
ds_read_b128 a[200:203],v245 offset:8704
ds_read_b128 a[204:207],v246 offset:8960
M a[72:75],a[236:239],a[208:211],a[72:75]
ds_read_b128 a[208:211],v246 offset:9216
v_add_f32 v206,v231,v208
M a[76:79],a[236:239],a[212:215],a[76:79]
ds_read_b128 a[212:215],v246 offset:9472
v_sub_f32 v231,v231,v208
M a[80:83],a[236:239],a[216:219],a[80:83]
buffer_load_dwordx4 a[228:231],v247,s[20:23],s48 offen offset:2048 sc1
M a[84:87],a[236:239],a[220:223],a[84:87]
s_add_u32 s46,s78,27648
ds_read_b128 a[216:219],v246 offset:9728
ds_read_b128 a[220:223],v246 offset:9984
M a[88:91],a[236:239],a[192:195],a[88:91]
ds_read_b128 a[192:195],v246 offset:10240
v_fma_f32 v208,2.0,v210,v212
M a[92:95],a[236:239],a[196:199],a[92:95]
s_waitcnt vmcnt(14) lgkmcnt(6)
ds_read_b128 a[196:199],v246 offset:10496
v_fmac_f32 v212,-2.0,v210
M a[96:99],a[240:243],a[200:203],a[96:99]
s_waitcnt lgkmcnt(6)
buffer_load_dwordx4 a[232:235],v247,s[20:23],s46 offen offset:0 sc1
M a[100:103],a[240:243],a[204:207],a[100:103]
s_waitcnt lgkmcnt(5)
s_add_u32 s47,s78,30720
v_cvt_pk_bf16_f32 v204,v228,v204
v_cvt_pk_bf16_f32 v214,v233,v214
M a[104:107],a[240:243],a[208:211],a[104:107]
s_waitcnt lgkmcnt(4)
v_cvt_pk_bf16_f32 v206,v229,v206
v_cvt_pk_bf16_f32 v210,v230,v208
M a[108:111],a[240:243],a[212:215],a[108:111]
s_waitcnt lgkmcnt(3)
v_cvt_pk_bf16_f32 v208,v234,v231
v_cvt_pk_bf16_f32 v212,v232,v212
M a[112:115],a[240:243],a[216:219],a[112:115]
s_waitcnt lgkmcnt(2)
buffer_load_dwordx4 a[236:239],v247,s[20:23],s47 offen offset:0 sc1
M a[116:119],a[240:243],a[220:223],a[116:119]
s_waitcnt lgkmcnt(1)
s_add_u32 s48,s78,33792
v_lshlrev_b32 v230,16,v209
v_lshlrev_b32 v228,16,v205
M a[120:123],a[240:243],a[192:195],a[120:123]
s_waitcnt lgkmcnt(0)
v_lshlrev_b32 v229,16,v207
v_lshlrev_b32 v233,16,v215
M a[124:127],a[240:243],a[196:199],a[124:127]
s_waitcnt vmcnt(15)
v_lshlrev_b32 v232,16,v213
v_lshlrev_b32 v231,16,v211
M a[128:131],a[244:247],a[200:203],a[128:131]
buffer_load_dwordx4 a[240:243],v247,s[20:23],s48 offen offset:0 sc1
M a[132:135],a[244:247],a[204:207],a[132:135]
v_fmac_f32 v228,s43,v230
v_fmac_f32 v233,4.0,v229
M a[136:139],a[244:247],a[208:211],a[136:139]
v_fma_f32 v234,-4.0,v230,v232
v_fmac_f32 v228,s45,v232
M a[140:143],a[244:247],a[212:215],a[140:143]
v_fmac_f32 v233,s41,v231
v_sub_f32 v232,v232,v230
M a[144:147],a[244:247],a[216:219],a[144:147]
v_fma_f32 v230,-4.0,v229,v231
v_sub_f32 v231,v231,v229
M a[148:151],a[244:247],a[220:223],a[148:151]
v_add_f32 v229,v234,v230
v_sub_f32 v234,v234,v230
M a[152:155],a[244:247],a[192:195],a[152:155]
v_fma_f32 v230,2.0,v231,v232
v_fmac_f32 v232,-2.0,v231
M a[156:159],a[244:247],a[196:199],a[156:159]
s_waitcnt vmcnt(15)
buffer_load_dwordx4 a[244:247],v247,s[20:23],s46 offen offset:1024 sc1
M a[160:163],a[248:251],a[200:203],a[160:163]
ds_read_b128 a[200:203],v246 offset:10752
v_and_b32 v209,s42,v209
M a[164:167],a[248:251],a[204:207],a[164:167]
v_and_b32 v205,s42,v205
v_and_b32 v207,s42,v207
M a[168:171],a[248:251],a[208:211],a[168:171]
v_and_b32 v215,s42,v215
v_and_b32 v213,s42,v213
M a[172:175],a[248:251],a[212:215],a[172:175]
v_and_b32 v211,s42,v211
v_fmac_f32 v205,s43,v209
M a[176:179],a[248:251],a[216:219],a[176:179]
v_fmac_f32 v215,4.0,v207
v_fma_f32 v231,-4.0,v209,v213
M a[180:183],a[248:251],a[220:223],a[180:183]
v_fmac_f32 v205,s45,v213
v_fmac_f32 v215,s41,v211
M a[184:187],a[248:251],a[192:195],a[184:187]
v_sub_f32 v213,v213,v209
v_fma_f32 v209,-4.0,v207,v211
M a[188:191],a[248:251],a[196:199],a[188:191]
s_waitcnt vmcnt(15)
buffer_load_dwordx4 a[248:251],v247,s[20:23],s47 offen offset:1024 sc1
M a[96:99],a[252:255],a[204:207],a[96:99]
v_sub_f32 v211,v211,v207
v_add_f32 v207,v231,v209
M a[100:103],a[252:255],a[208:211],a[100:103]
v_sub_f32 v231,v231,v209
v_fma_f32 v209,2.0,v211,v213
M a[104:107],a[252:255],a[212:215],a[104:107]
v_fmac_f32 v213,-2.0,v211
v_cvt_pk_bf16_f32 v205,v228,v205
M a[108:111],a[252:255],a[216:219],a[108:111]
v_cvt_pk_bf16_f32 v215,v233,v215
v_cvt_pk_bf16_f32 v207,v229,v207
M a[112:115],a[252:255],a[220:223],a[112:115]
v_cvt_pk_bf16_f32 v211,v230,v209
v_cvt_pk_bf16_f32 v209,v234,v231
M a[116:119],a[252:255],a[192:195],a[116:119]
v_cvt_pk_bf16_f32 v213,v232,v213
v_add_u32 v228,121856,v243
M a[120:123],a[252:255],a[196:199],a[120:123]
s_waitcnt lgkmcnt(0)
ds_write2st64_b64 v228,v[204:205],v[214:215] offset0:1 offset1:18
M a[124:127],a[252:255],a[200:203],a[124:127]
s_waitcnt vmcnt(15)
s_add_u32 s28,s67,1179648
buffer_load_dwordx2 v[204:205],v241,s[12:15],s28 offen offset:0
M a[128:131],a[224:227],a[204:207],a[128:131]
ds_write2st64_b64 v243,v[206:207],v[208:209] offset0:103 offset1:120
M a[132:135],a[224:227],a[208:211],a[132:135]
buffer_load_dwordx2 v[214:215],v241,s[16:19],s28 offen offset:1536
M a[136:139],a[224:227],a[212:215],a[136:139]
ds_write2st64_b64 v243,v[210:211],v[212:213] offset0:137 offset1:154
M a[140:143],a[224:227],a[216:219],a[140:143]
v_fmac_f32 v235,s43,v237
v_fmac_f32 v240,4.0,v236
M a[144:147],a[224:227],a[220:223],a[144:147]
buffer_load_dwordx2 v[206:207],v241,s[8:11],s28 offen offset:0
M a[148:151],a[224:227],a[192:195],a[148:151]
v_fma_f32 v228,-4.0,v237,v239
v_fmac_f32 v235,s45,v239
M a[152:155],a[224:227],a[196:199],a[152:155]
v_fmac_f32 v240,s41,v238
v_sub_f32 v239,v239,v237
M a[156:159],a[224:227],a[200:203],a[156:159]
s_waitcnt vmcnt(17)
v_fma_f32 v237,-4.0,v236,v238
v_sub_f32 v238,v238,v236
M a[160:163],v[216:219],a[204:207],a[160:163]
buffer_load_dwordx2 v[208:209],v241,s[8:11],s28 offen offset:384
M a[164:167],v[216:219],a[208:211],a[164:167]
ds_read_b128 a[204:207],v245 offset:11008
v_add_f32 v236,v228,v237
M a[168:171],v[216:219],a[212:215],a[168:171]
v_sub_f32 v228,v228,v237
v_fma_f32 v237,2.0,v238,v239
M a[172:175],v[216:219],a[216:219],a[172:175]
v_fmac_f32 v239,-2.0,v238
v_cvt_pk_bf16_f32 v229,v235,v240
M a[176:179],v[216:219],a[220:223],a[176:179]
buffer_load_dwordx2 v[210:211],v241,s[8:11],s28 offen offset:768
M a[180:183],v[216:219],a[192:195],a[180:183]
v_cvt_pk_bf16_f32 v230,v236,v228
v_cvt_pk_bf16_f32 v231,v237,v239
M a[184:187],v[216:219],a[196:199],a[184:187]
v_add_u32 v228,121856,v244
M a[188:191],v[216:219],a[200:203],a[188:191]
s_waitcnt vmcnt(12)
ds_write_b16 v228,v229 offset:0
M a[96:99],v[220:223],a[208:211],a[96:99]
buffer_load_dwordx2 v[212:213],v241,s[8:11],s28 offen offset:1152
M a[100:103],v[220:223],a[212:215],a[100:103]
ds_write_b16_d16_hi v228,v229 offset:8704
M a[104:107],v[220:223],a[216:219],a[104:107]
ds_write_b16 v244,v230 offset:52224
M a[108:111],v[220:223],a[220:223],a[108:111]
ds_write_b16_d16_hi v244,v230 offset:60928
M a[112:115],v[220:223],a[192:195],a[112:115]
buffer_load_short_d16_hi v235,v242,s[12:15],s74 offen offset:0
M a[116:119],v[220:223],a[196:199],a[116:119]
v_add_u32 v228,69632,v244
M a[120:123],v[220:223],a[200:203],a[120:123]
s_waitcnt lgkmcnt(4)
buffer_load_short_d16_hi v236,v242,s[8:11],s74 offen offset:0
M a[124:127],v[220:223],a[204:207],a[124:127]
s_waitcnt vmcnt(14)
ds_write_b16 v228,v231 offset:0
M a[128:131],v[224:227],a[208:211],a[128:131]
buffer_load_short_d16_hi v237,v242,s[8:11],s74 offen offset:384
M a[132:135],v[224:227],a[212:215],a[132:135]
ds_write_b16_d16_hi v228,v231 offset:8704
M a[136:139],v[224:227],a[216:219],a[136:139]
buffer_load_short_d16_hi v238,v242,s[8:11],s74 offen offset:768
M a[140:143],v[224:227],a[220:223],a[140:143]
v_lshlrev_b32 v230,16,v196
v_lshlrev_b32 v228,16,v192
M a[144:147],v[224:227],a[192:195],a[144:147]
buffer_load_short_d16_hi v239,v242,s[8:11],s74 offen offset:1152
M a[148:151],v[224:227],a[196:199],a[148:151]
v_lshlrev_b32 v229,16,v194
v_lshlrev_b32 v233,16,v202
M a[152:155],v[224:227],a[200:203],a[152:155]
buffer_load_short_d16_hi v240,v242,s[16:19],s74 offen offset:1536
M a[156:159],v[224:227],a[204:207],a[156:159]
s_waitcnt vmcnt(17)
v_lshlrev_b32 v232,16,v200
v_lshlrev_b32 v231,16,v198
M a[160:163],a[228:231],a[208:211],a[160:163]
buffer_load_dwordx4 a[252:255],v247,s[20:23],s48 offen offset:1024 sc1
M a[164:167],a[228:231],a[212:215],a[164:167]
ds_read_b128 a[208:211],v245 offset:17408
ds_read_b128 a[212:215],v246 offset:17664
M a[168:171],a[228:231],a[216:219],a[168:171]
ds_read_b128 a[216:219],v246 offset:17920
v_fmac_f32 v228,s43,v230
M a[172:175],a[228:231],a[220:223],a[172:175]
ds_read_b128 a[220:223],v246 offset:18176
v_fmac_f32 v233,4.0,v229
M a[176:179],a[228:231],a[192:195],a[176:179]
buffer_load_dwordx4 a[224:227],v247,s[20:23],s46 offen offset:2048 sc1
M a[180:183],a[228:231],a[196:199],a[180:183]
ds_read_b128 a[192:195],v246 offset:18432
ds_read_b128 a[196:199],v246 offset:18688
M a[184:187],a[228:231],a[200:203],a[184:187]
ds_read_b128 a[200:203],v246 offset:18944
v_fma_f32 v234,-4.0,v230,v232
M a[188:191],a[228:231],a[204:207],a[188:191]
s_waitcnt vmcnt(18) lgkmcnt(6)
ds_read_b128 a[204:207],v246 offset:19200
v_fmac_f32 v228,s45,v232
M v[0:3],a[232:235],a[208:211],v[0:3]
s_waitcnt lgkmcnt(6)
buffer_load_dwordx4 v[216:219],v247,s[20:23],s47 offen offset:2048 sc1
M v[4:7],a[232:235],a[212:215],v[4:7]
s_waitcnt lgkmcnt(5)
v_fmac_f32 v233,s41,v231
v_sub_f32 v232,v232,v230
M v[8:11],a[232:235],a[216:219],v[8:11]
s_waitcnt lgkmcnt(4)
v_fma_f32 v230,-4.0,v229,v231
v_sub_f32 v231,v231,v229
M v[12:15],a[232:235],a[220:223],v[12:15]
s_waitcnt lgkmcnt(3)
v_add_f32 v229,v234,v230
v_sub_f32 v234,v234,v230
M v[16:19],a[232:235],a[192:195],v[16:19]
s_waitcnt lgkmcnt(2)
buffer_load_dwordx4 v[220:223],v247,s[20:23],s48 offen offset:2048 sc1
M v[20:23],a[232:235],a[196:199],v[20:23]
s_waitcnt lgkmcnt(1)
s_add_u32 s46,s78,36864
v_fma_f32 v230,2.0,v231,v232
v_fmac_f32 v232,-2.0,v231
M v[24:27],a[232:235],a[200:203],v[24:27]
s_waitcnt lgkmcnt(0)
v_and_b32 v196,s42,v196
v_and_b32 v192,s42,v192
M v[28:31],a[232:235],a[204:207],v[28:31]
s_waitcnt vmcnt(19)
v_and_b32 v194,s42,v194
v_and_b32 v202,s42,v202
M v[32:35],a[236:239],a[208:211],v[32:35]
buffer_load_dwordx4 v[224:227],v247,s[20:23],s46 offen offset:0 sc1
M v[36:39],a[236:239],a[212:215],v[36:39]
s_add_u32 s47,s78,39936
v_and_b32 v200,s42,v200
v_and_b32 v198,s42,v198
M v[40:43],a[236:239],a[216:219],v[40:43]
v_fmac_f32 v192,s43,v196
v_fmac_f32 v202,4.0,v194
M v[44:47],a[236:239],a[220:223],v[44:47]
v_fma_f32 v231,-4.0,v196,v200
v_fmac_f32 v192,s45,v200
M v[48:51],a[236:239],a[192:195],v[48:51]
buffer_load_dwordx4 a[228:231],v247,s[20:23],s47 offen offset:0 sc1
M v[52:55],a[236:239],a[196:199],v[52:55]
s_add_u32 s48,s78,43008
v_fmac_f32 v202,s41,v198
v_sub_f32 v200,v200,v196
M v[56:59],a[236:239],a[200:203],v[56:59]
v_fma_f32 v196,-4.0,v194,v198
v_sub_f32 v198,v198,v194
M v[60:63],a[236:239],a[204:207],v[60:63]
s_waitcnt vmcnt(20)
v_add_f32 v194,v231,v196
v_sub_f32 v231,v231,v196
M v[64:67],a[240:243],a[208:211],v[64:67]
global_load_dword v251,v252,s[82:83]
M v[68:71],a[240:243],a[212:215],v[68:71]
ds_read_b128 a[208:211],v246 offset:19456
v_fma_f32 v196,2.0,v198,v200
M v[72:75],a[240:243],a[216:219],v[72:75]
buffer_load_dwordx4 a[232:235],v247,s[20:23],s48 offen offset:0 sc1
M v[76:79],a[240:243],a[220:223],v[76:79]
v_fmac_f32 v200,-2.0,v198
v_cvt_pk_bf16_f32 v192,v228,v192
M v[80:83],a[240:243],a[192:195],v[80:83]
v_cvt_pk_bf16_f32 v202,v233,v202
v_cvt_pk_bf16_f32 v194,v229,v194
M v[84:87],a[240:243],a[196:199],v[84:87]
v_cvt_pk_bf16_f32 v198,v230,v196
v_cvt_pk_bf16_f32 v196,v234,v231
M v[88:91],a[240:243],a[200:203],v[88:91]
buffer_load_dwordx4 a[236:239],v247,s[20:23],s46 offen offset:1024 sc1
M v[92:95],a[240:243],a[204:207],v[92:95]
s_waitcnt vmcnt(22)
v_cvt_pk_bf16_f32 v200,v232,v200
v_lshlrev_b32 v230,16,v197
M v[0:3],a[244:247],a[212:215],v[0:3]
v_lshlrev_b32 v228,16,v193
v_lshlrev_b32 v229,16,v195
M v[4:7],a[244:247],a[216:219],v[4:7]
v_lshlrev_b32 v233,16,v203
v_lshlrev_b32 v232,16,v201
M v[8:11],a[244:247],a[220:223],v[8:11]
buffer_load_dwordx4 a[240:243],v247,s[20:23],s47 offen offset:1024 sc1
M v[12:15],a[244:247],a[192:195],v[12:15]
v_lshlrev_b32 v231,16,v199
v_fmac_f32 v228,s43,v230
M v[16:19],a[244:247],a[196:199],v[16:19]
v_fmac_f32 v233,4.0,v229
v_fma_f32 v234,-4.0,v230,v232
M v[20:23],a[244:247],a[200:203],v[20:23]
v_fmac_f32 v228,s45,v232
v_fmac_f32 v233,s41,v231
M v[24:27],a[244:247],a[204:207],v[24:27]
s_waitcnt lgkmcnt(0)
v_sub_f32 v232,v232,v230
v_fma_f32 v230,-4.0,v229,v231
M v[28:31],a[244:247],a[208:211],v[28:31]
s_waitcnt vmcnt(22)
buffer_load_dwordx4 a[244:247],v247,s[20:23],s48 offen offset:1024 sc1
M v[32:35],a[248:251],a[212:215],v[32:35]
v_sub_f32 v231,v231,v229
v_add_f32 v229,v234,v230
M v[36:39],a[248:251],a[216:219],v[36:39]
v_sub_f32 v234,v234,v230
v_fma_f32 v230,2.0,v231,v232
M v[40:43],a[248:251],a[220:223],v[40:43]
v_fmac_f32 v232,-2.0,v231
v_and_b32 v197,s42,v197
M v[44:47],a[248:251],a[192:195],v[44:47]
v_and_b32 v193,s42,v193
v_and_b32 v195,s42,v195
M v[48:51],a[248:251],a[196:199],v[48:51]
v_and_b32 v203,s42,v203
v_and_b32 v201,s42,v201
M v[52:55],a[248:251],a[200:203],v[52:55]
v_and_b32 v199,s42,v199
v_fmac_f32 v193,s43,v197
M v[56:59],a[248:251],a[204:207],v[56:59]
v_fmac_f32 v203,4.0,v195
v_fma_f32 v231,-4.0,v197,v201
M v[60:63],a[248:251],a[208:211],v[60:63]
s_waitcnt vmcnt(10)
buffer_load_dwordx4 a[248:251],v247,s[20:23],s46 offen offset:2048 sc1
M v[64:67],a[252:255],a[212:215],v[64:67]
ds_read_b128 a[212:215],v245 offset:19712
v_fmac_f32 v193,s45,v201
M v[68:71],a[252:255],a[216:219],v[68:71]
v_fmac_f32 v203,s41,v199
v_sub_f32 v201,v201,v197
M v[72:75],a[252:255],a[220:223],v[72:75]
v_fma_f32 v197,-4.0,v195,v199
v_sub_f32 v199,v199,v195
M v[76:79],a[252:255],a[192:195],v[76:79]
v_add_f32 v195,v231,v197
v_sub_f32 v231,v231,v197
M v[80:83],a[252:255],a[196:199],v[80:83]
v_fma_f32 v197,2.0,v199,v201
v_fmac_f32 v201,-2.0,v199
M v[84:87],a[252:255],a[200:203],v[84:87]
v_cvt_pk_bf16_f32 v193,v228,v193
v_cvt_pk_bf16_f32 v203,v233,v203
M v[88:91],a[252:255],a[204:207],v[88:91]
v_cvt_pk_bf16_f32 v195,v229,v195
v_cvt_pk_bf16_f32 v199,v230,v197
M v[92:95],a[252:255],a[208:211],v[92:95]
s_waitcnt vmcnt(10)
buffer_load_dwordx4 a[252:255],v247,s[20:23],s47 offen offset:2048 sc1
M v[0:3],a[224:227],a[216:219],v[0:3]
v_cvt_pk_bf16_f32 v197,v234,v231
v_cvt_pk_bf16_f32 v201,v232,v201
M v[4:7],a[224:227],a[220:223],v[4:7]
v_add_u32 v228,121856,v243
M v[8:11],a[224:227],a[192:195],v[8:11]
ds_write2st64_b64 v228,v[192:193],v[202:203] offset0:2 offset1:19
M v[12:15],a[224:227],a[196:199],v[12:15]
s_add_u32 s28,s68,0
buffer_load_dwordx2 v[192:193],v241,s[12:15],s28 offen offset:0
M v[16:19],a[224:227],a[200:203],v[16:19]
ds_write2st64_b64 v243,v[194:195],v[196:197] offset0:104 offset1:121
M v[20:23],a[224:227],a[204:207],v[20:23]
buffer_load_dwordx2 v[202:203],v241,s[16:19],s28 offen offset:1536
M v[24:27],a[224:227],a[208:211],v[24:27]
s_waitcnt lgkmcnt(2)
ds_write2st64_b64 v243,v[198:199],v[200:201] offset0:138 offset1:155
M v[28:31],a[224:227],a[212:215],v[28:31]
s_waitcnt vmcnt(12)
v_lshlrev_b32 v230,16,v208
v_lshlrev_b32 v228,16,v204
M v[32:35],v[216:219],a[216:219],v[32:35]
buffer_load_dwordx2 v[194:195],v241,s[8:11],s28 offen offset:0
M v[36:39],v[216:219],a[220:223],v[36:39]
v_lshlrev_b32 v229,16,v206
v_lshlrev_b32 v233,16,v214
M v[40:43],v[216:219],a[192:195],v[40:43]
v_lshlrev_b32 v232,16,v212
v_lshlrev_b32 v231,16,v210
M v[44:47],v[216:219],a[196:199],v[44:47]
v_fmac_f32 v228,s43,v230
v_fmac_f32 v233,4.0,v229
M v[48:51],v[216:219],a[200:203],v[48:51]
buffer_load_dwordx2 v[196:197],v241,s[8:11],s28 offen offset:384
M v[52:55],v[216:219],a[204:207],v[52:55]
v_fma_f32 v234,-4.0,v230,v232
v_fmac_f32 v228,s45,v232
M v[56:59],v[216:219],a[208:211],v[56:59]
v_fmac_f32 v233,s41,v231
v_sub_f32 v232,v232,v230
M v[60:63],v[216:219],a[212:215],v[60:63]
s_waitcnt vmcnt(13)
v_fma_f32 v230,-4.0,v229,v231
v_sub_f32 v231,v231,v229
M v[64:67],v[220:223],a[216:219],v[64:67]
buffer_load_dwordx2 v[198:199],v241,s[8:11],s28 offen offset:768
M v[68:71],v[220:223],a[220:223],v[68:71]
ds_read_b128 a[216:219],v245 offset:26112
ds_read_b128 a[220:223],v246 offset:26368
M v[72:75],v[220:223],a[192:195],v[72:75]
ds_read_b128 a[192:195],v246 offset:26624
v_add_f32 v229,v234,v230
M v[76:79],v[220:223],a[196:199],v[76:79]
ds_read_b128 a[196:199],v246 offset:26880
v_sub_f32 v234,v234,v230
M v[80:83],v[220:223],a[200:203],v[80:83]
buffer_load_dwordx2 v[200:201],v241,s[8:11],s28 offen offset:1152
M v[84:87],v[220:223],a[204:207],v[84:87]
ds_read_b128 a[200:203],v246 offset:27136
ds_read_b128 a[204:207],v246 offset:27392
M v[88:91],v[220:223],a[208:211],v[88:91]
ds_read_b128 a[208:211],v246 offset:27648
v_fma_f32 v230,2.0,v231,v232
M v[92:95],v[220:223],a[212:215],v[92:95]
s_waitcnt vmcnt(14) lgkmcnt(6)
ds_read_b128 a[212:215],v246 offset:27904
v_fmac_f32 v232,-2.0,v231
M v[96:99],v[224:227],a[216:219],v[96:99]
s_waitcnt lgkmcnt(6)
buffer_load_dwordx4 a[224:227],v247,s[20:23],s48 offen offset:2048 sc1
M v[100:103],v[224:227],a[220:223],v[100:103]
s_waitcnt lgkmcnt(5)
s_add_u32 s46,s79,9216
v_and_b32 v208,s42,v208
v_and_b32 v204,s42,v204
M v[104:107],v[224:227],a[192:195],v[104:107]
s_waitcnt lgkmcnt(4)
v_and_b32 v206,s42,v206
v_and_b32 v214,s42,v214
M v[108:111],v[224:227],a[196:199],v[108:111]
s_waitcnt lgkmcnt(3)
v_and_b32 v212,s42,v212
v_and_b32 v210,s42,v210
M v[112:115],v[224:227],a[200:203],v[112:115]
s_waitcnt lgkmcnt(2)
buffer_load_dwordx4 v[216:219],v247,s[20:23],s46 offen offset:0 sc1
M v[116:119],v[224:227],a[204:207],v[116:119]
s_waitcnt lgkmcnt(1)
s_add_u32 s47,s79,12288
v_fmac_f32 v204,s43,v208
v_fmac_f32 v214,4.0,v206
M v[120:123],v[224:227],a[208:211],v[120:123]
s_waitcnt lgkmcnt(0)
v_fma_f32 v231,-4.0,v208,v212
v_fmac_f32 v204,s45,v212
M v[124:127],v[224:227],a[212:215],v[124:127]
s_waitcnt vmcnt(15)
v_fmac_f32 v214,s41,v210
v_sub_f32 v212,v212,v208
M v[128:131],a[228:231],a[216:219],v[128:131]
buffer_load_dwordx4 v[220:223],v247,s[20:23],s47 offen offset:0 sc1
M v[132:135],a[228:231],a[220:223],v[132:135]
s_add_u32 s48,s79,15360
v_fma_f32 v208,-4.0,v206,v210
v_sub_f32 v210,v210,v206
M v[136:139],a[228:231],a[192:195],v[136:139]
v_add_f32 v206,v231,v208
v_sub_f32 v231,v231,v208
M v[140:143],a[228:231],a[196:199],v[140:143]
v_fma_f32 v208,2.0,v210,v212
v_fmac_f32 v212,-2.0,v210
M v[144:147],a[228:231],a[200:203],v[144:147]
buffer_load_dwordx4 v[224:227],v247,s[20:23],s48 offen offset:0 sc1
M v[148:151],a[228:231],a[204:207],v[148:151]
v_cvt_pk_bf16_f32 v204,v228,v204
v_cvt_pk_bf16_f32 v214,v233,v214
M v[152:155],a[228:231],a[208:211],v[152:155]
v_cvt_pk_bf16_f32 v206,v229,v206
v_cvt_pk_bf16_f32 v210,v230,v208
M v[156:159],a[228:231],a[212:215],v[156:159]
s_waitcnt vmcnt(15)
v_cvt_pk_bf16_f32 v208,v234,v231
v_cvt_pk_bf16_f32 v212,v232,v212
M v[160:163],a[232:235],a[216:219],v[160:163]
buffer_load_dwordx4 a[228:231],v247,s[20:23],s46 offen offset:1024 sc1
M v[164:167],a[232:235],a[220:223],v[164:167]
ds_read_b128 a[216:219],v246 offset:28160
v_lshlrev_b32 v230,16,v209
M v[168:171],a[232:235],a[192:195],v[168:171]
v_lshlrev_b32 v228,16,v205
v_lshlrev_b32 v229,16,v207
M v[172:175],a[232:235],a[196:199],v[172:175]
v_lshlrev_b32 v233,16,v215
v_lshlrev_b32 v232,16,v213
M v[176:179],a[232:235],a[200:203],v[176:179]
v_lshlrev_b32 v231,16,v211
v_fmac_f32 v228,s43,v230
M v[180:183],a[232:235],a[204:207],v[180:183]
v_fmac_f32 v233,4.0,v229
v_fma_f32 v234,-4.0,v230,v232
M v[184:187],a[232:235],a[208:211],v[184:187]
v_fmac_f32 v228,s45,v232
v_fmac_f32 v233,s41,v231
M v[188:191],a[232:235],a[212:215],v[188:191]
s_waitcnt vmcnt(15)
buffer_load_dwordx4 a[232:235],v247,s[20:23],s47 offen offset:1024 sc1
M v[96:99],a[236:239],a[220:223],v[96:99]
v_sub_f32 v232,v232,v230
v_fma_f32 v230,-4.0,v229,v231
M v[100:103],a[236:239],a[192:195],v[100:103]
v_sub_f32 v231,v231,v229
v_add_f32 v229,v234,v230
M v[104:107],a[236:239],a[196:199],v[104:107]
v_sub_f32 v234,v234,v230
v_fma_f32 v230,2.0,v231,v232
M v[108:111],a[236:239],a[200:203],v[108:111]
v_fmac_f32 v232,-2.0,v231
v_and_b32 v209,s42,v209
M v[112:115],a[236:239],a[204:207],v[112:115]
v_and_b32 v205,s42,v205
v_and_b32 v207,s42,v207
M v[116:119],a[236:239],a[208:211],v[116:119]
v_and_b32 v215,s42,v215
v_and_b32 v213,s42,v213
M v[120:123],a[236:239],a[212:215],v[120:123]
s_waitcnt lgkmcnt(0)
v_and_b32 v211,s42,v211
v_fmac_f32 v205,s43,v209
M v[124:127],a[236:239],a[216:219],v[124:127]
s_waitcnt vmcnt(15)
buffer_load_dwordx4 a[236:239],v247,s[20:23],s48 offen offset:1024 sc1
M v[128:131],a[240:243],a[220:223],v[128:131]
v_fmac_f32 v215,4.0,v207
v_fma_f32 v231,-4.0,v209,v213
M v[132:135],a[240:243],a[192:195],v[132:135]
v_fmac_f32 v205,s45,v213
v_fmac_f32 v215,s41,v211
M v[136:139],a[240:243],a[196:199],v[136:139]
v_sub_f32 v213,v213,v209
v_fma_f32 v209,-4.0,v207,v211
M v[140:143],a[240:243],a[200:203],v[140:143]
v_sub_f32 v211,v211,v207
v_add_f32 v207,v231,v209
M v[144:147],a[240:243],a[204:207],v[144:147]
v_sub_f32 v231,v231,v209
v_fma_f32 v209,2.0,v211,v213
M v[148:151],a[240:243],a[208:211],v[148:151]
v_fmac_f32 v213,-2.0,v211
v_cvt_pk_bf16_f32 v205,v228,v205
M v[152:155],a[240:243],a[212:215],v[152:155]
v_cvt_pk_bf16_f32 v215,v233,v215
v_cvt_pk_bf16_f32 v207,v229,v207
M v[156:159],a[240:243],a[216:219],v[156:159]
s_waitcnt vmcnt(15)
buffer_load_dwordx4 a[240:243],v247,s[20:23],s46 offen offset:2048 sc1
M v[160:163],a[244:247],a[220:223],v[160:163]
ds_read_b128 a[220:223],v245 offset:28416
v_cvt_pk_bf16_f32 v211,v230,v209
M v[164:167],a[244:247],a[192:195],v[164:167]
v_cvt_pk_bf16_f32 v209,v234,v231
v_cvt_pk_bf16_f32 v213,v232,v213
M v[168:171],a[244:247],a[196:199],v[168:171]
v_add_u32 v228,121856,v243
M v[172:175],a[244:247],a[200:203],v[172:175]
ds_write2st64_b64 v228,v[204:205],v[214:215] offset0:3 offset1:20
M v[176:179],a[244:247],a[204:207],v[176:179]
s_add_u32 s28,s68,393216
buffer_load_dwordx2 v[204:205],v241,s[12:15],s28 offen offset:0
M v[180:183],a[244:247],a[208:211],v[180:183]
ds_write2st64_b64 v243,v[206:207],v[208:209] offset0:105 offset1:122
M v[184:187],a[244:247],a[212:215],v[184:187]
buffer_load_dwordx2 v[214:215],v241,s[16:19],s28 offen offset:1536
M v[188:191],a[244:247],a[216:219],v[188:191]
s_waitcnt vmcnt(17)
ds_write2st64_b64 v243,v[210:211],v[212:213] offset0:139 offset1:156
M v[96:99],a[248:251],a[192:195],v[96:99]
s_waitcnt vmcnt(12)
v_lshlrev_b32 v230,16,v196
v_lshlrev_b32 v228,16,v192
M v[100:103],a[248:251],a[196:199],v[100:103]
buffer_load_dwordx2 v[206:207],v241,s[8:11],s28 offen offset:0
M v[104:107],a[248:251],a[200:203],v[104:107]
v_lshlrev_b32 v229,16,v194
v_lshlrev_b32 v233,16,v202
M v[108:111],a[248:251],a[204:207],v[108:111]
s_waitcnt vmcnt(11)
v_lshlrev_b32 v232,16,v200
v_lshlrev_b32 v231,16,v198
M v[112:115],a[248:251],a[208:211],v[112:115]
v_fmac_f32 v228,s43,v230
v_fmac_f32 v233,4.0,v229
M v[116:119],a[248:251],a[212:215],v[116:119]
buffer_load_dwordx2 v[208:209],v241,s[8:11],s28 offen offset:384
M v[120:123],a[248:251],a[216:219],v[120:123]
s_waitcnt lgkmcnt(3)
v_fma_f32 v234,-4.0,v230,v232
v_fmac_f32 v228,s45,v232
M v[124:127],a[248:251],a[220:223],v[124:127]
v_fmac_f32 v233,s41,v231
v_sub_f32 v232,v232,v230
M v[128:131],a[252:255],a[192:195],v[128:131]
v_fma_f32 v230,-4.0,v229,v231
v_sub_f32 v231,v231,v229
M v[132:135],a[252:255],a[196:199],v[132:135]
buffer_load_dwordx2 v[210:211],v241,s[8:11],s28 offen offset:768
M v[136:139],a[252:255],a[200:203],v[136:139]
v_add_f32 v229,v234,v230
v_sub_f32 v234,v234,v230
M v[140:143],a[252:255],a[204:207],v[140:143]
v_fma_f32 v230,2.0,v231,v232
v_fmac_f32 v232,-2.0,v231
M v[144:147],a[252:255],a[208:211],v[144:147]
v_and_b32 v196,s42,v196
v_and_b32 v192,s42,v192
M v[148:151],a[252:255],a[212:215],v[148:151]
buffer_load_dwordx2 v[212:213],v241,s[8:11],s28 offen offset:1152
M v[152:155],a[252:255],a[216:219],v[152:155]
s_waitcnt lgkmcnt(0)
s_barrier
v_and_b32 v194,s42,v194
M v[156:159],a[252:255],a[220:223],v[156:159]
s_waitcnt vmcnt(13)
v_and_b32 v202,s42,v202
v_and_b32 v200,s42,v200
M v[160:163],a[224:227],a[192:195],v[160:163]
ds_read_b128 a[192:195],v245 offset:34816
v_and_b32 v198,s42,v198
M v[164:167],a[224:227],a[196:199],v[164:167]
buffer_load_dwordx4 a[244:247],v247,s[20:23],s47 offen offset:2048 sc1
M v[168:171],a[224:227],a[200:203],v[168:171]
ds_read_b128 a[196:199],v246 offset:35072
ds_read_b128 a[200:203],v246 offset:35328
M v[172:175],a[224:227],a[204:207],v[172:175]
ds_read_b128 a[204:207],v246 offset:35584
v_fmac_f32 v192,s43,v196
M v[176:179],a[224:227],a[208:211],v[176:179]
ds_read_b128 a[208:211],v246 offset:35840
v_fmac_f32 v202,4.0,v194
M v[180:183],a[224:227],a[212:215],v[180:183]
buffer_load_dwordx4 a[248:251],v247,s[20:23],s48 offen offset:2048 sc1
M v[184:187],a[224:227],a[216:219],v[184:187]
s_add_u32 s46,s79,18432
ds_read_b128 a[212:215],v246 offset:36096
ds_read_b128 a[216:219],v246 offset:36352
M v[188:191],a[224:227],a[220:223],v[188:191]
s_waitcnt vmcnt(14) lgkmcnt(6)
ds_read_b128 a[220:223],v246 offset:36608
v_fma_f32 v231,-4.0,v196,v200
M a[0:3],v[216:219],a[192:195],a[0:3]
s_waitcnt lgkmcnt(6)
v_fmac_f32 v192,s45,v200
v_fmac_f32 v202,s41,v198
M a[4:7],v[216:219],a[196:199],a[4:7]
s_waitcnt lgkmcnt(5)
buffer_load_dwordx4 a[252:255],v247,s[20:23],s46 offen offset:0 sc1
M a[8:11],v[216:219],a[200:203],a[8:11]
s_waitcnt lgkmcnt(4)
s_add_u32 s47,s79,21504
v_sub_f32 v200,v200,v196
v_fma_f32 v196,-4.0,v194,v198
M a[12:15],v[216:219],a[204:207],a[12:15]
s_waitcnt lgkmcnt(3)
v_sub_f32 v198,v198,v194
v_add_f32 v194,v231,v196
M a[16:19],v[216:219],a[208:211],a[16:19]
s_waitcnt lgkmcnt(2)
v_sub_f32 v231,v231,v196
v_fma_f32 v196,2.0,v198,v200
M a[20:23],v[216:219],a[212:215],a[20:23]
s_waitcnt lgkmcnt(1)
buffer_load_dwordx4 a[224:227],v247,s[20:23],s47 offen offset:0 sc1
M a[24:27],v[216:219],a[216:219],a[24:27]
s_waitcnt lgkmcnt(0)
s_add_u32 s48,s79,24576
v_fmac_f32 v200,-2.0,v198
v_cvt_pk_bf16_f32 v192,v228,v192
M a[28:31],v[216:219],a[220:223],a[28:31]
s_waitcnt vmcnt(15)
v_cvt_pk_bf16_f32 v202,v233,v202
v_cvt_pk_bf16_f32 v194,v229,v194
M a[32:35],v[220:223],a[192:195],a[32:35]
v_cvt_pk_bf16_f32 v198,v230,v196
v_cvt_pk_bf16_f32 v196,v234,v231
M a[36:39],v[220:223],a[196:199],a[36:39]
buffer_load_dwordx4 v[216:219],v247,s[20:23],s48 offen offset:0 sc1
M a[40:43],v[220:223],a[200:203],a[40:43]
v_cvt_pk_bf16_f32 v200,v232,v200
v_lshlrev_b32 v230,16,v197
M a[44:47],v[220:223],a[204:207],a[44:47]
v_lshlrev_b32 v228,16,v193
v_lshlrev_b32 v229,16,v195
M a[48:51],v[220:223],a[208:211],a[48:51]
v_lshlrev_b32 v233,16,v203
v_lshlrev_b32 v232,16,v201
M a[52:55],v[220:223],a[212:215],a[52:55]
v_lshlrev_b32 v231,16,v199
v_fmac_f32 v228,s43,v230
M a[56:59],v[220:223],a[216:219],a[56:59]
v_fmac_f32 v233,4.0,v229
v_fma_f32 v234,-4.0,v230,v232
M a[60:63],v[220:223],a[220:223],a[60:63]
s_waitcnt vmcnt(15)
buffer_load_dwordx4 v[220:223],v247,s[20:23],s46 offen offset:1024 sc1
M a[64:67],v[224:227],a[192:195],a[64:67]
ds_read_b128 a[192:195],v246 offset:36864
v_fmac_f32 v228,s45,v232
M a[68:71],v[224:227],a[196:199],a[68:71]
v_fmac_f32 v233,s41,v231
v_sub_f32 v232,v232,v230
M a[72:75],v[224:227],a[200:203],a[72:75]
v_fma_f32 v230,-4.0,v229,v231
v_sub_f32 v231,v231,v229
M a[76:79],v[224:227],a[204:207],a[76:79]
v_add_f32 v229,v234,v230
v_sub_f32 v234,v234,v230
M a[80:83],v[224:227],a[208:211],a[80:83]
v_fma_f32 v230,2.0,v231,v232
v_fmac_f32 v232,-2.0,v231
M a[84:87],v[224:227],a[212:215],a[84:87]
v_and_b32 v197,s42,v197
v_and_b32 v193,s42,v193
M a[88:91],v[224:227],a[216:219],a[88:91]
v_and_b32 v195,s42,v195
v_and_b32 v203,s42,v203
M a[92:95],v[224:227],a[220:223],a[92:95]
s_waitcnt vmcnt(15)
buffer_load_dwordx4 v[224:227],v247,s[20:23],s47 offen offset:1024 sc1
M a[0:3],a[228:231],a[196:199],a[0:3]
v_and_b32 v201,s42,v201
v_and_b32 v199,s42,v199
M a[4:7],a[228:231],a[200:203],a[4:7]
v_fmac_f32 v193,s43,v197
v_fmac_f32 v203,4.0,v195
M a[8:11],a[228:231],a[204:207],a[8:11]
v_fma_f32 v231,-4.0,v197,v201
v_fmac_f32 v193,s45,v201
M a[12:15],a[228:231],a[208:211],a[12:15]
v_fmac_f32 v203,s41,v199
v_sub_f32 v201,v201,v197
M a[16:19],a[228:231],a[212:215],a[16:19]
v_fma_f32 v197,-4.0,v195,v199
v_sub_f32 v199,v199,v195
M a[20:23],a[228:231],a[216:219],a[20:23]
v_add_f32 v195,v231,v197
v_sub_f32 v231,v231,v197
M a[24:27],a[228:231],a[220:223],a[24:27]
s_waitcnt lgkmcnt(0)
v_fma_f32 v197,2.0,v199,v201
v_fmac_f32 v201,-2.0,v199
M a[28:31],a[228:231],a[192:195],a[28:31]
s_waitcnt vmcnt(15)
buffer_load_dwordx4 a[228:231],v247,s[20:23],s48 offen offset:1024 sc1
M a[32:35],a[232:235],a[196:199],a[32:35]
v_cvt_pk_bf16_f32 v193,v228,v193
v_cvt_pk_bf16_f32 v203,v233,v203
M a[36:39],a[232:235],a[200:203],a[36:39]
v_cvt_pk_bf16_f32 v195,v229,v195
v_cvt_pk_bf16_f32 v199,v230,v197
M a[40:43],a[232:235],a[204:207],a[40:43]
v_cvt_pk_bf16_f32 v197,v234,v231
v_cvt_pk_bf16_f32 v201,v232,v201
M a[44:47],a[232:235],a[208:211],a[44:47]
v_add_u32 v228,139264,v243
M a[48:51],a[232:235],a[212:215],a[48:51]
ds_write2st64_b64 v228,v[192:193],v[202:203] offset0:0 offset1:17
M a[52:55],a[232:235],a[216:219],a[52:55]
s_add_u32 s28,s68,786432
buffer_load_dwordx2 v[192:193],v241,s[12:15],s28 offen offset:0
M a[56:59],a[232:235],a[220:223],a[56:59]
ds_write2st64_b64 v243,v[194:195],v[196:197] offset0:34 offset1:51
M a[60:63],a[232:235],a[192:195],a[60:63]
s_waitcnt vmcnt(16)
buffer_load_dwordx2 v[202:203],v241,s[16:19],s28 offen offset:1536
M a[64:67],a[236:239],a[196:199],a[64:67]
ds_read_b128 a[196:199],v245 offset:37120
ds_write2st64_b64 v243,v[198:199],v[200:201] offset0:68 offset1:85
M a[68:71],a[236:239],a[200:203],a[68:71]
s_waitcnt vmcnt(12)
v_lshlrev_b32 v230,16,v208
v_lshlrev_b32 v228,16,v204
M a[72:75],a[236:239],a[204:207],a[72:75]
buffer_load_dwordx2 v[194:195],v241,s[8:11],s28 offen offset:0
M a[76:79],a[236:239],a[208:211],a[76:79]
v_lshlrev_b32 v229,16,v206
v_lshlrev_b32 v233,16,v214
M a[80:83],a[236:239],a[212:215],a[80:83]
s_waitcnt vmcnt(11)
v_lshlrev_b32 v232,16,v212
v_lshlrev_b32 v231,16,v210
M a[84:87],a[236:239],a[216:219],a[84:87]
v_fmac_f32 v228,s43,v230
v_fmac_f32 v233,4.0,v229
M a[88:91],a[236:239],a[220:223],a[88:91]
buffer_load_dwordx2 v[196:197],v241,s[8:11],s28 offen offset:384
M a[92:95],a[236:239],a[192:195],a[92:95]
v_fma_f32 v234,-4.0,v230,v232
v_fmac_f32 v228,s45,v232
M a[0:3],a[240:243],a[200:203],a[0:3]
v_fmac_f32 v233,s41,v231
v_sub_f32 v232,v232,v230
M a[4:7],a[240:243],a[204:207],a[4:7]
v_fma_f32 v230,-4.0,v229,v231
v_sub_f32 v231,v231,v229
M a[8:11],a[240:243],a[208:211],a[8:11]
buffer_load_dwordx2 v[198:199],v241,s[8:11],s28 offen offset:768
M a[12:15],a[240:243],a[212:215],a[12:15]
v_add_f32 v229,v234,v230
v_sub_f32 v234,v234,v230
M a[16:19],a[240:243],a[216:219],a[16:19]
v_fma_f32 v230,2.0,v231,v232
v_fmac_f32 v232,-2.0,v231
M a[20:23],a[240:243],a[220:223],a[20:23]
v_and_b32 v208,s42,v208
v_and_b32 v204,s42,v204
M a[24:27],a[240:243],a[192:195],a[24:27]
s_waitcnt lgkmcnt(1)
buffer_load_dwordx2 v[200:201],v241,s[8:11],s28 offen offset:1152
M a[28:31],a[240:243],a[196:199],a[28:31]
s_waitcnt vmcnt(13)
v_and_b32 v206,s42,v206
v_and_b32 v214,s42,v214
M a[32:35],a[244:247],a[200:203],a[32:35]
v_and_b32 v212,s42,v212
v_and_b32 v210,s42,v210
M a[36:39],a[244:247],a[204:207],a[36:39]
v_fmac_f32 v204,s43,v208
v_fmac_f32 v214,4.0,v206
M a[40:43],a[244:247],a[208:211],a[40:43]
buffer_load_dwordx4 a[232:235],v247,s[20:23],s46 offen offset:2048 sc1
M a[44:47],a[244:247],a[212:215],a[44:47]
v_fma_f32 v231,-4.0,v208,v212
v_fmac_f32 v204,s45,v212
M a[48:51],a[244:247],a[216:219],a[48:51]
v_fmac_f32 v214,s41,v210
v_sub_f32 v212,v212,v208
M a[52:55],a[244:247],a[220:223],a[52:55]
v_fma_f32 v208,-4.0,v206,v210
v_sub_f32 v210,v210,v206
M a[56:59],a[244:247],a[192:195],a[56:59]
buffer_load_dwordx4 a[236:239],v247,s[20:23],s47 offen offset:2048 sc1
M a[60:63],a[244:247],a[196:199],a[60:63]
s_waitcnt vmcnt(14)
v_add_f32 v206,v231,v208
v_sub_f32 v231,v231,v208
M a[64:67],a[248:251],a[200:203],a[64:67]
ds_read_b128 a[200:203],v245 offset:43520
v_fma_f32 v208,2.0,v210,v212
M a[68:71],a[248:251],a[204:207],a[68:71]
ds_read_b128 a[204:207],v246 offset:43776
v_fmac_f32 v212,-2.0,v210
M a[72:75],a[248:251],a[208:211],a[72:75]
buffer_load_dwordx4 a[240:243],v247,s[20:23],s48 offen offset:2048 sc1
M a[76:79],a[248:251],a[212:215],a[76:79]
s_add_u32 s46,s79,27648
ds_read_b128 a[208:211],v246 offset:44032
ds_read_b128 a[212:215],v246 offset:44288
M a[80:83],a[248:251],a[216:219],a[80:83]
ds_read_b128 a[216:219],v246 offset:44544
v_cvt_pk_bf16_f32 v204,v228,v204
M a[84:87],a[248:251],a[220:223],a[84:87]
ds_read_b128 a[220:223],v246 offset:44800
v_cvt_pk_bf16_f32 v214,v233,v214
M a[88:91],a[248:251],a[192:195],a[88:91]
buffer_load_dwordx4 a[244:247],v247,s[20:23],s46 offen offset:0 sc1
M a[92:95],a[248:251],a[196:199],a[92:95]
s_waitcnt vmcnt(15) lgkmcnt(5)
s_add_u32 s47,s79,30720
ds_read_b128 a[192:195],v246 offset:45056
ds_read_b128 a[196:199],v246 offset:45312
M a[96:99],a[252:255],a[200:203],a[96:99]
s_waitcnt lgkmcnt(6)
v_cvt_pk_bf16_f32 v206,v229,v206
v_cvt_pk_bf16_f32 v210,v230,v208
M a[100:103],a[252:255],a[204:207],a[100:103]
s_waitcnt lgkmcnt(5)
v_cvt_pk_bf16_f32 v208,v234,v231
v_cvt_pk_bf16_f32 v212,v232,v212
M a[104:107],a[252:255],a[208:211],a[104:107]
s_waitcnt lgkmcnt(4)
buffer_load_dwordx4 a[248:251],v247,s[20:23],s47 offen offset:0 sc1
M a[108:111],a[252:255],a[212:215],a[108:111]
s_waitcnt lgkmcnt(3)
s_add_u32 s48,s79,33792
v_lshlrev_b32 v230,16,v209
v_lshlrev_b32 v228,16,v205
M a[112:115],a[252:255],a[216:219],a[112:115]
s_waitcnt lgkmcnt(2)
v_lshlrev_b32 v229,16,v207
v_lshlrev_b32 v233,16,v215
M a[116:119],a[252:255],a[220:223],a[116:119]
s_waitcnt lgkmcnt(1)
v_lshlrev_b32 v232,16,v213
v_lshlrev_b32 v231,16,v211
M a[120:123],a[252:255],a[192:195],a[120:123]
s_waitcnt lgkmcnt(0)
v_fmac_f32 v228,s43,v230
v_fmac_f32 v233,4.0,v229
M a[124:127],a[252:255],a[196:199],a[124:127]
s_waitcnt vmcnt(15)
buffer_load_dwordx4 a[252:255],v247,s[20:23],s48 offen offset:0 sc1
M a[128:131],a[224:227],a[200:203],a[128:131]
v_fma_f32 v234,-4.0,v230,v232
v_fmac_f32 v228,s45,v232
M a[132:135],a[224:227],a[204:207],a[132:135]
v_fmac_f32 v233,s41,v231
v_sub_f32 v232,v232,v230
M a[136:139],a[224:227],a[208:211],a[136:139]
v_fma_f32 v230,-4.0,v229,v231
v_sub_f32 v231,v231,v229
M a[140:143],a[224:227],a[212:215],a[140:143]
v_add_f32 v229,v234,v230
v_sub_f32 v234,v234,v230
M a[144:147],a[224:227],a[216:219],a[144:147]
v_fma_f32 v230,2.0,v231,v232
v_fmac_f32 v232,-2.0,v231
M a[148:151],a[224:227],a[220:223],a[148:151]
v_and_b32 v209,s42,v209
v_and_b32 v205,s42,v205
M a[152:155],a[224:227],a[192:195],a[152:155]
v_and_b32 v207,s42,v207
v_and_b32 v215,s42,v215
M a[156:159],a[224:227],a[196:199],a[156:159]
s_waitcnt vmcnt(15)
buffer_load_dwordx4 a[224:227],v247,s[20:23],s46 offen offset:1024 sc1
M a[160:163],v[216:219],a[200:203],a[160:163]
ds_read_b128 a[200:203],v246 offset:45568
v_and_b32 v213,s42,v213
M a[164:167],v[216:219],a[204:207],a[164:167]
v_and_b32 v211,s42,v211
v_fmac_f32 v205,s43,v209
M a[168:171],v[216:219],a[208:211],a[168:171]
v_fmac_f32 v215,4.0,v207
v_fma_f32 v231,-4.0,v209,v213
M a[172:175],v[216:219],a[212:215],a[172:175]
v_fmac_f32 v205,s45,v213
v_fmac_f32 v215,s41,v211
M a[176:179],v[216:219],a[216:219],a[176:179]
v_sub_f32 v213,v213,v209
v_fma_f32 v209,-4.0,v207,v211
M a[180:183],v[216:219],a[220:223],a[180:183]
v_sub_f32 v211,v211,v207
v_add_f32 v207,v231,v209
M a[184:187],v[216:219],a[192:195],a[184:187]
v_sub_f32 v231,v231,v209
v_fma_f32 v209,2.0,v211,v213
M a[188:191],v[216:219],a[196:199],a[188:191]
s_waitcnt vmcnt(15)
buffer_load_dwordx4 v[216:219],v247,s[20:23],s47 offen offset:1024 sc1
M a[96:99],v[220:223],a[204:207],a[96:99]
v_fmac_f32 v213,-2.0,v211
v_cvt_pk_bf16_f32 v205,v228,v205
M a[100:103],v[220:223],a[208:211],a[100:103]
v_cvt_pk_bf16_f32 v215,v233,v215
v_cvt_pk_bf16_f32 v207,v229,v207
M a[104:107],v[220:223],a[212:215],a[104:107]
v_cvt_pk_bf16_f32 v211,v230,v209
v_cvt_pk_bf16_f32 v209,v234,v231
M a[108:111],v[220:223],a[216:219],a[108:111]
v_cvt_pk_bf16_f32 v213,v232,v213
v_add_u32 v228,139264,v243
M a[112:115],v[220:223],a[220:223],a[112:115]
ds_write2st64_b64 v228,v[204:205],v[214:215] offset0:1 offset1:18
M a[116:119],v[220:223],a[192:195],a[116:119]
s_add_u32 s28,s68,1179648
buffer_load_dwordx2 v[204:205],v241,s[12:15],s28 offen offset:0
M a[120:123],v[220:223],a[196:199],a[120:123]
s_waitcnt lgkmcnt(1)
ds_write2st64_b64 v243,v[206:207],v[208:209] offset0:35 offset1:52
M a[124:127],v[220:223],a[200:203],a[124:127]
s_waitcnt vmcnt(16)
buffer_load_dwordx2 v[214:215],v241,s[16:19],s28 offen offset:1536
M a[128:131],v[224:227],a[204:207],a[128:131]
ds_write2st64_b64 v243,v[210:211],v[212:213] offset0:69 offset1:86
M a[132:135],v[224:227],a[208:211],a[132:135]
v_fmac_f32 v235,s43,v237
v_fmac_f32 v240,4.0,v236
M a[136:139],v[224:227],a[212:215],a[136:139]
buffer_load_dwordx2 v[206:207],v241,s[8:11],s28 offen offset:0
M a[140:143],v[224:227],a[216:219],a[140:143]
v_fma_f32 v228,-4.0,v237,v239
v_fmac_f32 v235,s45,v239
M a[144:147],v[224:227],a[220:223],a[144:147]
v_fmac_f32 v240,s41,v238
v_sub_f32 v239,v239,v237
M a[148:151],v[224:227],a[192:195],a[148:151]
v_fma_f32 v237,-4.0,v236,v238
v_sub_f32 v238,v238,v236
M a[152:155],v[224:227],a[196:199],a[152:155]
buffer_load_dwordx2 v[208:209],v241,s[8:11],s28 offen offset:384
M a[156:159],v[224:227],a[200:203],a[156:159]
s_waitcnt vmcnt(18)
v_add_f32 v236,v228,v237
v_sub_f32 v228,v228,v237
M a[160:163],a[228:231],a[204:207],a[160:163]
ds_read_b128 a[204:207],v245 offset:45824
v_fma_f32 v237,2.0,v238,v239
M a[164:167],a[228:231],a[208:211],a[164:167]
v_fmac_f32 v239,-2.0,v238
v_cvt_pk_bf16_f32 v229,v235,v240
M a[168:171],a[228:231],a[212:215],a[168:171]
buffer_load_dwordx2 v[210:211],v241,s[8:11],s28 offen offset:768
M a[172:175],a[228:231],a[216:219],a[172:175]
v_cvt_pk_bf16_f32 v230,v236,v228
v_cvt_pk_bf16_f32 v231,v237,v239
M a[176:179],a[228:231],a[220:223],a[176:179]
v_add_u32 v228,139264,v244
M a[180:183],a[228:231],a[192:195],a[180:183]
ds_write_b16 v228,v229 offset:0
M a[184:187],a[228:231],a[196:199],a[184:187]
buffer_load_dwordx2 v[212:213],v241,s[8:11],s28 offen offset:1152
M a[188:191],a[228:231],a[200:203],a[188:191]
s_waitcnt vmcnt(13)
ds_write_b16_d16_hi v228,v229 offset:8704
M a[96:99],a[232:235],a[208:211],a[96:99]
ds_write_b16 v244,v230 offset:17408
M a[100:103],a[232:235],a[212:215],a[100:103]
ds_write_b16_d16_hi v244,v230 offset:26112
M a[104:107],a[232:235],a[216:219],a[104:107]
buffer_load_short_d16_hi v235,v242,s[12:15],s75 offen offset:0
M a[108:111],a[232:235],a[220:223],a[108:111]
ds_write_b16 v244,v231 offset:34816
M a[112:115],a[232:235],a[192:195],a[112:115]
buffer_load_short_d16_hi v236,v242,s[8:11],s75 offen offset:0
M a[116:119],a[232:235],a[196:199],a[116:119]
ds_write_b16_d16_hi v244,v231 offset:43520
M a[120:123],a[232:235],a[200:203],a[120:123]
s_waitcnt lgkmcnt(6)
buffer_load_short_d16_hi v237,v242,s[8:11],s75 offen offset:384
M a[124:127],a[232:235],a[204:207],a[124:127]
s_waitcnt vmcnt(15)
v_lshlrev_b32 v230,16,v196
v_lshlrev_b32 v228,16,v192
M a[128:131],a[236:239],a[208:211],a[128:131]
buffer_load_short_d16_hi v238,v242,s[8:11],s75 offen offset:768
M a[132:135],a[236:239],a[212:215],a[132:135]
v_lshlrev_b32 v229,16,v194
v_lshlrev_b32 v233,16,v202
M a[136:139],a[236:239],a[216:219],a[136:139]
buffer_load_short_d16_hi v239,v242,s[8:11],s75 offen offset:1152
M a[140:143],a[236:239],a[220:223],a[140:143]
v_lshlrev_b32 v232,16,v200
v_lshlrev_b32 v231,16,v198
M a[144:147],a[236:239],a[192:195],a[144:147]
buffer_load_short_d16_hi v240,v242,s[16:19],s75 offen offset:1536
M a[148:151],a[236:239],a[196:199],a[148:151]
v_fmac_f32 v228,s43,v230
v_fmac_f32 v233,4.0,v229
M a[152:155],a[236:239],a[200:203],a[152:155]
buffer_load_dwordx4 v[220:223],v247,s[20:23],s48 offen offset:1024 sc1
M a[156:159],a[236:239],a[204:207],a[156:159]
s_waitcnt vmcnt(18)
v_fma_f32 v234,-4.0,v230,v232
v_fmac_f32 v228,s45,v232
M a[160:163],a[240:243],a[208:211],a[160:163]
ds_read_b128 a[208:211],v245 offset:52224
v_fmac_f32 v233,s41,v231
M a[164:167],a[240:243],a[212:215],a[164:167]
ds_read_b128 a[212:215],v246 offset:52480
v_sub_f32 v232,v232,v230
M a[168:171],a[240:243],a[216:219],a[168:171]
buffer_load_dwordx4 v[224:227],v247,s[20:23],s46 offen offset:2048 sc1
M a[172:175],a[240:243],a[220:223],a[172:175]
ds_read_b128 a[216:219],v246 offset:52736
ds_read_b128 a[220:223],v246 offset:52992
M a[176:179],a[240:243],a[192:195],a[176:179]
ds_read_b128 a[192:195],v246 offset:53248
v_fma_f32 v230,-4.0,v229,v231
M a[180:183],a[240:243],a[196:199],a[180:183]
ds_read_b128 a[196:199],v246 offset:53504
v_sub_f32 v231,v231,v229
M a[184:187],a[240:243],a[200:203],a[184:187]
buffer_load_dwordx4 a[228:231],v247,s[20:23],s47 offen offset:2048 sc1
M a[188:191],a[240:243],a[204:207],a[188:191]
s_waitcnt vmcnt(19) lgkmcnt(5)
ds_read_b128 a[200:203],v246 offset:53760
ds_read_b128 a[204:207],v246 offset:54016
M v[0:3],a[244:247],a[208:211],v[0:3]
s_waitcnt lgkmcnt(6)
v_add_f32 v229,v234,v230
v_sub_f32 v234,v234,v230
M v[4:7],a[244:247],a[212:215],v[4:7]
s_waitcnt lgkmcnt(5)
v_fma_f32 v230,2.0,v231,v232
v_fmac_f32 v232,-2.0,v231
M v[8:11],a[244:247],a[216:219],v[8:11]
s_waitcnt lgkmcnt(4)
buffer_load_dwordx4 a[232:235],v247,s[20:23],s48 offen offset:2048 sc1
M v[12:15],a[244:247],a[220:223],v[12:15]
s_waitcnt lgkmcnt(3)
s_add_u32 s46,s79,36864
v_and_b32 v196,s42,v196
v_and_b32 v192,s42,v192
M v[16:19],a[244:247],a[192:195],v[16:19]
s_waitcnt lgkmcnt(2)
v_and_b32 v194,s42,v194
v_and_b32 v202,s42,v202
M v[20:23],a[244:247],a[196:199],v[20:23]
s_waitcnt lgkmcnt(1)
v_and_b32 v200,s42,v200
v_and_b32 v198,s42,v198
M v[24:27],a[244:247],a[200:203],v[24:27]
s_waitcnt lgkmcnt(0)
buffer_load_dwordx4 a[236:239],v247,s[20:23],s46 offen offset:0 sc1
M v[28:31],a[244:247],a[204:207],v[28:31]
s_waitcnt vmcnt(20)
s_add_u32 s47,s79,39936
v_fmac_f32 v192,s43,v196
v_fmac_f32 v202,4.0,v194
M v[32:35],a[248:251],a[208:211],v[32:35]
v_fma_f32 v231,-4.0,v196,v200
v_fmac_f32 v192,s45,v200
M v[36:39],a[248:251],a[212:215],v[36:39]
v_fmac_f32 v202,s41,v198
v_sub_f32 v200,v200,v196
M v[40:43],a[248:251],a[216:219],v[40:43]
buffer_load_dwordx4 a[240:243],v247,s[20:23],s47 offen offset:0 sc1
M v[44:47],a[248:251],a[220:223],v[44:47]
s_add_u32 s48,s79,43008
v_fma_f32 v196,-4.0,v194,v198
v_sub_f32 v198,v198,v194
M v[48:51],a[248:251],a[192:195],v[48:51]
v_add_f32 v194,v231,v196
v_sub_f32 v231,v231,v196
M v[52:55],a[248:251],a[196:199],v[52:55]
v_fma_f32 v196,2.0,v198,v200
v_fmac_f32 v200,-2.0,v198
M v[56:59],a[248:251],a[200:203],v[56:59]
global_load_dword v251,v252,s[82:83]
M v[60:63],a[248:251],a[204:207],v[60:63]
s_waitcnt vmcnt(21)
v_cvt_pk_bf16_f32 v192,v228,v192
v_cvt_pk_bf16_f32 v202,v233,v202
M v[64:67],a[252:255],a[208:211],v[64:67]
buffer_load_dwordx4 a[244:247],v247,s[20:23],s48 offen offset:0 sc1
M v[68:71],a[252:255],a[212:215],v[68:71]
ds_read_b128 a[208:211],v246 offset:54272
v_cvt_pk_bf16_f32 v194,v229,v194
M v[72:75],a[252:255],a[216:219],v[72:75]
v_cvt_pk_bf16_f32 v198,v230,v196
v_cvt_pk_bf16_f32 v196,v234,v231
M v[76:79],a[252:255],a[220:223],v[76:79]
v_cvt_pk_bf16_f32 v200,v232,v200
v_lshlrev_b32 v230,16,v197
M v[80:83],a[252:255],a[192:195],v[80:83]
buffer_load_dwordx4 a[248:251],v247,s[20:23],s46 offen offset:1024 sc1
M v[84:87],a[252:255],a[196:199],v[84:87]
v_lshlrev_b32 v228,16,v193
v_lshlrev_b32 v229,16,v195
M v[88:91],a[252:255],a[200:203],v[88:91]
v_lshlrev_b32 v233,16,v203
v_lshlrev_b32 v232,16,v201
M v[92:95],a[252:255],a[204:207],v[92:95]
s_waitcnt vmcnt(22)
v_lshlrev_b32 v231,16,v199
v_fmac_f32 v228,s43,v230
M v[0:3],a[224:227],a[212:215],v[0:3]
buffer_load_dwordx4 a[252:255],v247,s[20:23],s47 offen offset:1024 sc1
M v[4:7],a[224:227],a[216:219],v[4:7]
v_fmac_f32 v233,4.0,v229
v_fma_f32 v234,-4.0,v230,v232
M v[8:11],a[224:227],a[220:223],v[8:11]
v_fmac_f32 v228,s45,v232
v_fmac_f32 v233,s41,v231
M v[12:15],a[224:227],a[192:195],v[12:15]
v_sub_f32 v232,v232,v230
v_fma_f32 v230,-4.0,v229,v231
M v[16:19],a[224:227],a[196:199],v[16:19]
v_sub_f32 v231,v231,v229
v_add_f32 v229,v234,v230
M v[20:23],a[224:227],a[200:203],v[20:23]
v_sub_f32 v234,v234,v230
v_fma_f32 v230,2.0,v231,v232
M v[24:27],a[224:227],a[204:207],v[24:27]
s_waitcnt lgkmcnt(0)
v_fmac_f32 v232,-2.0,v231
v_and_b32 v197,s42,v197
M v[28:31],a[224:227],a[208:211],v[28:31]
s_waitcnt vmcnt(22)
buffer_load_dwordx4 a[224:227],v247,s[20:23],s48 offen offset:1024 sc1
M v[32:35],v[216:219],a[212:215],v[32:35]
v_and_b32 v193,s42,v193
v_and_b32 v195,s42,v195
M v[36:39],v[216:219],a[216:219],v[36:39]
v_and_b32 v203,s42,v203
v_and_b32 v201,s42,v201
M v[40:43],v[216:219],a[220:223],v[40:43]
v_and_b32 v199,s42,v199
v_fmac_f32 v193,s43,v197
M v[44:47],v[216:219],a[192:195],v[44:47]
v_fmac_f32 v203,4.0,v195
v_fma_f32 v231,-4.0,v197,v201
M v[48:51],v[216:219],a[196:199],v[48:51]
v_fmac_f32 v193,s45,v201
v_fmac_f32 v203,s41,v199
M v[52:55],v[216:219],a[200:203],v[52:55]
v_sub_f32 v201,v201,v197
v_fma_f32 v197,-4.0,v195,v199
M v[56:59],v[216:219],a[204:207],v[56:59]
v_sub_f32 v199,v199,v195
v_add_f32 v195,v231,v197
M v[60:63],v[216:219],a[208:211],v[60:63]
s_waitcnt vmcnt(10)
buffer_load_dwordx4 v[216:219],v247,s[20:23],s46 offen offset:2048 sc1
M v[64:67],v[220:223],a[212:215],v[64:67]
ds_read_b128 a[212:215],v245 offset:54528
v_sub_f32 v231,v231,v197
M v[68:71],v[220:223],a[216:219],v[68:71]
v_fma_f32 v197,2.0,v199,v201
v_fmac_f32 v201,-2.0,v199
M v[72:75],v[220:223],a[220:223],v[72:75]
v_cvt_pk_bf16_f32 v193,v228,v193
v_cvt_pk_bf16_f32 v203,v233,v203
M v[76:79],v[220:223],a[192:195],v[76:79]
v_cvt_pk_bf16_f32 v195,v229,v195
v_cvt_pk_bf16_f32 v199,v230,v197
M v[80:83],v[220:223],a[196:199],v[80:83]
v_cvt_pk_bf16_f32 v197,v234,v231
v_cvt_pk_bf16_f32 v201,v232,v201
M v[84:87],v[220:223],a[200:203],v[84:87]
v_add_u32 v228,139264,v243
M v[88:91],v[220:223],a[204:207],v[88:91]
ds_write2st64_b64 v228,v[192:193],v[202:203] offset0:2 offset1:19
M v[92:95],v[220:223],a[208:211],v[92:95]
s_waitcnt vmcnt(10)
s_add_u32 s28,s69,0
buffer_load_dwordx2 v[192:193],v241,s[12:15],s28 offen offset:0
M v[0:3],v[224:227],a[216:219],v[0:3]
ds_write2st64_b64 v243,v[194:195],v[196:197] offset0:36 offset1:53
M v[4:7],v[224:227],a[220:223],v[4:7]
buffer_load_dwordx2 v[202:203],v241,s[16:19],s28 offen offset:1536
M v[8:11],v[224:227],a[192:195],v[8:11]
ds_write2st64_b64 v243,v[198:199],v[200:201] offset0:70 offset1:87
M v[12:15],v[224:227],a[196:199],v[12:15]
v_lshlrev_b32 v230,16,v208
v_lshlrev_b32 v228,16,v204
M v[16:19],v[224:227],a[200:203],v[16:19]
buffer_load_dwordx2 v[194:195],v241,s[8:11],s28 offen offset:0
M v[20:23],v[224:227],a[204:207],v[20:23]
v_lshlrev_b32 v229,16,v206
v_lshlrev_b32 v233,16,v214
M v[24:27],v[224:227],a[208:211],v[24:27]
s_waitcnt lgkmcnt(3)
v_lshlrev_b32 v232,16,v212
v_lshlrev_b32 v231,16,v210
M v[28:31],v[224:227],a[212:215],v[28:31]
s_waitcnt vmcnt(12)
v_fmac_f32 v228,s43,v230
v_fmac_f32 v233,4.0,v229
M v[32:35],a[228:231],a[216:219],v[32:35]
buffer_load_dwordx2 v[196:197],v241,s[8:11],s28 offen offset:384
M v[36:39],a[228:231],a[220:223],v[36:39]
v_fma_f32 v234,-4.0,v230,v232
v_fmac_f32 v228,s45,v232
M v[40:43],a[228:231],a[192:195],v[40:43]
v_fmac_f32 v233,s41,v231
v_sub_f32 v232,v232,v230
M v[44:47],a[228:231],a[196:199],v[44:47]
v_fma_f32 v230,-4.0,v229,v231
v_sub_f32 v231,v231,v229
M v[48:51],a[228:231],a[200:203],v[48:51]
buffer_load_dwordx2 v[198:199],v241,s[8:11],s28 offen offset:768
M v[52:55],a[228:231],a[204:207],v[52:55]
v_add_f32 v229,v234,v230
v_sub_f32 v234,v234,v230
M v[56:59],a[228:231],a[208:211],v[56:59]
v_fma_f32 v230,2.0,v231,v232
v_fmac_f32 v232,-2.0,v231
M v[60:63],a[228:231],a[212:215],v[60:63]
s_waitcnt vmcnt(13)
v_and_b32 v208,s42,v208
v_and_b32 v204,s42,v204
M v[64:67],a[232:235],a[216:219],v[64:67]
buffer_load_dwordx2 v[200:201],v241,s[8:11],s28 offen offset:1152
M v[68:71],a[232:235],a[220:223],v[68:71]
ds_read_b128 a[216:219],v245 offset:60928
ds_read_b128 a[220:223],v246 offset:61184
M v[72:75],a[232:235],a[192:195],v[72:75]
ds_read_b128 a[192:195],v246 offset:61440
v_and_b32 v206,s42,v206
M v[76:79],a[232:235],a[196:199],v[76:79]
ds_read_b128 a[196:199],v246 offset:61696
v_and_b32 v214,s42,v214
M v[80:83],a[232:235],a[200:203],v[80:83]
buffer_load_dwordx4 v[220:223],v247,s[20:23],s47 offen offset:2048 sc1
M v[84:87],a[232:235],a[204:207],v[84:87]
ds_read_b128 a[200:203],v246 offset:61952
ds_read_b128 a[204:207],v246 offset:62208
M v[88:91],a[232:235],a[208:211],v[88:91]
ds_read_b128 a[208:211],v246 offset:62464
v_and_b32 v212,s42,v212
M v[92:95],a[232:235],a[212:215],v[92:95]
s_waitcnt vmcnt(14) lgkmcnt(6)
ds_read_b128 a[212:215],v246 offset:62720
v_and_b32 v210,s42,v210
M v[96:99],a[236:239],a[216:219],v[96:99]
s_waitcnt lgkmcnt(6)
buffer_load_dwordx4 v[224:227],v247,s[20:23],s48 offen offset:2048 sc1
M v[100:103],a[236:239],a[220:223],v[100:103]
s_waitcnt lgkmcnt(5)
s_add_u32 s46,s80,9216
v_fmac_f32 v204,s43,v208
v_fmac_f32 v214,4.0,v206
M v[104:107],a[236:239],a[192:195],v[104:107]
s_waitcnt lgkmcnt(4)
v_fma_f32 v231,-4.0,v208,v212
v_fmac_f32 v204,s45,v212
M v[108:111],a[236:239],a[196:199],v[108:111]
s_waitcnt lgkmcnt(3)
v_fmac_f32 v214,s41,v210
v_sub_f32 v212,v212,v208
M v[112:115],a[236:239],a[200:203],v[112:115]
s_waitcnt lgkmcnt(2)
buffer_load_dwordx4 a[228:231],v247,s[20:23],s46 offen offset:0 sc1
M v[116:119],a[236:239],a[204:207],v[116:119]
s_waitcnt lgkmcnt(1)
s_add_u32 s47,s80,12288
v_fma_f32 v208,-4.0,v206,v210
v_sub_f32 v210,v210,v206
M v[120:123],a[236:239],a[208:211],v[120:123]
s_waitcnt lgkmcnt(0)
v_add_f32 v206,v231,v208
v_sub_f32 v231,v231,v208
M v[124:127],a[236:239],a[212:215],v[124:127]
s_waitcnt vmcnt(15)
v_fma_f32 v208,2.0,v210,v212
v_fmac_f32 v212,-2.0,v210
M v[128:131],a[240:243],a[216:219],v[128:131]
buffer_load_dwordx4 a[232:235],v247,s[20:23],s47 offen offset:0 sc1
M v[132:135],a[240:243],a[220:223],v[132:135]
s_add_u32 s48,s80,15360
v_cvt_pk_bf16_f32 v204,v228,v204
v_cvt_pk_bf16_f32 v214,v233,v214
M v[136:139],a[240:243],a[192:195],v[136:139]
v_cvt_pk_bf16_f32 v206,v229,v206
v_cvt_pk_bf16_f32 v210,v230,v208
M v[140:143],a[240:243],a[196:199],v[140:143]
v_cvt_pk_bf16_f32 v208,v234,v231
v_cvt_pk_bf16_f32 v212,v232,v212
M v[144:147],a[240:243],a[200:203],v[144:147]
buffer_load_dwordx4 a[236:239],v247,s[20:23],s48 offen offset:0 sc1
M v[148:151],a[240:243],a[204:207],v[148:151]
v_lshlrev_b32 v230,16,v209
v_lshlrev_b32 v228,16,v205
M v[152:155],a[240:243],a[208:211],v[152:155]
v_lshlrev_b32 v229,16,v207
v_lshlrev_b32 v233,16,v215
M v[156:159],a[240:243],a[212:215],v[156:159]
s_waitcnt vmcnt(15)
v_lshlrev_b32 v232,16,v213
v_lshlrev_b32 v231,16,v211
M v[160:163],a[244:247],a[216:219],v[160:163]
buffer_load_dwordx4 a[240:243],v247,s[20:23],s46 offen offset:1024 sc1
M v[164:167],a[244:247],a[220:223],v[164:167]
ds_read_b128 a[216:219],v246 offset:62976
v_fmac_f32 v228,s43,v230
M v[168:171],a[244:247],a[192:195],v[168:171]
v_fmac_f32 v233,4.0,v229
v_fma_f32 v234,-4.0,v230,v232
M v[172:175],a[244:247],a[196:199],v[172:175]
v_fmac_f32 v228,s45,v232
v_fmac_f32 v233,s41,v231
M v[176:179],a[244:247],a[200:203],v[176:179]
v_sub_f32 v232,v232,v230
v_fma_f32 v230,-4.0,v229,v231
M v[180:183],a[244:247],a[204:207],v[180:183]
v_sub_f32 v231,v231,v229
v_add_f32 v229,v234,v230
M v[184:187],a[244:247],a[208:211],v[184:187]
v_sub_f32 v234,v234,v230
v_fma_f32 v230,2.0,v231,v232
M v[188:191],a[244:247],a[212:215],v[188:191]
s_waitcnt vmcnt(15)
buffer_load_dwordx4 a[244:247],v247,s[20:23],s47 offen offset:1024 sc1
M v[96:99],a[248:251],a[220:223],v[96:99]
v_fmac_f32 v232,-2.0,v231
v_and_b32 v209,s42,v209
M v[100:103],a[248:251],a[192:195],v[100:103]
v_and_b32 v205,s42,v205
v_and_b32 v207,s42,v207
M v[104:107],a[248:251],a[196:199],v[104:107]
v_and_b32 v215,s42,v215
v_and_b32 v213,s42,v213
M v[108:111],a[248:251],a[200:203],v[108:111]
v_and_b32 v211,s42,v211
v_fmac_f32 v205,s43,v209
M v[112:115],a[248:251],a[204:207],v[112:115]
v_fmac_f32 v215,4.0,v207
v_fma_f32 v231,-4.0,v209,v213
M v[116:119],a[248:251],a[208:211],v[116:119]
v_fmac_f32 v205,s45,v213
v_fmac_f32 v215,s41,v211
M v[120:123],a[248:251],a[212:215],v[120:123]
s_waitcnt lgkmcnt(0)
v_sub_f32 v213,v213,v209
v_fma_f32 v209,-4.0,v207,v211
M v[124:127],a[248:251],a[216:219],v[124:127]
s_waitcnt vmcnt(15)
buffer_load_dwordx4 a[248:251],v247,s[20:23],s48 offen offset:1024 sc1
M v[128:131],a[252:255],a[220:223],v[128:131]
v_sub_f32 v211,v211,v207
v_add_f32 v207,v231,v209
M v[132:135],a[252:255],a[192:195],v[132:135]
v_sub_f32 v231,v231,v209
v_fma_f32 v209,2.0,v211,v213
M v[136:139],a[252:255],a[196:199],v[136:139]
v_fmac_f32 v213,-2.0,v211
v_cvt_pk_bf16_f32 v205,v228,v205
M v[140:143],a[252:255],a[200:203],v[140:143]
v_cvt_pk_bf16_f32 v215,v233,v215
v_cvt_pk_bf16_f32 v207,v229,v207
M v[144:147],a[252:255],a[204:207],v[144:147]
v_cvt_pk_bf16_f32 v211,v230,v209
v_cvt_pk_bf16_f32 v209,v234,v231
M v[148:151],a[252:255],a[208:211],v[148:151]
v_cvt_pk_bf16_f32 v213,v232,v213
v_add_u32 v228,139264,v243
M v[152:155],a[252:255],a[212:215],v[152:155]
ds_write2st64_b64 v228,v[204:205],v[214:215] offset0:3 offset1:20
M v[156:159],a[252:255],a[216:219],v[156:159]
s_waitcnt vmcnt(15)
s_add_u32 s28,s69,393216
buffer_load_dwordx2 v[204:205],v241,s[12:15],s28 offen offset:0
M v[160:163],a[224:227],a[220:223],v[160:163]
ds_read_b128 a[220:223],v245 offset:63232
ds_write2st64_b64 v243,v[206:207],v[208:209] offset0:37 offset1:54
M v[164:167],a[224:227],a[192:195],v[164:167]
buffer_load_dwordx2 v[214:215],v241,s[16:19],s28 offen offset:1536
M v[168:171],a[224:227],a[196:199],v[168:171]
ds_write2st64_b64 v243,v[210:211],v[212:213] offset0:71 offset1:88
M v[172:175],a[224:227],a[200:203],v[172:175]
s_waitcnt vmcnt(12)
v_lshlrev_b32 v230,16,v196
v_lshlrev_b32 v228,16,v192
M v[176:179],a[224:227],a[204:207],v[176:179]
buffer_load_dwordx2 v[206:207],v241,s[8:11],s28 offen offset:0
M v[180:183],a[224:227],a[208:211],v[180:183]
v_lshlrev_b32 v229,16,v194
v_lshlrev_b32 v233,16,v202
M v[184:187],a[224:227],a[212:215],v[184:187]
s_waitcnt vmcnt(11)
v_lshlrev_b32 v232,16,v200
v_lshlrev_b32 v231,16,v198
M v[188:191],a[224:227],a[216:219],v[188:191]
v_fmac_f32 v228,s43,v230
v_fmac_f32 v233,4.0,v229
M v[96:99],v[216:219],a[192:195],v[96:99]
buffer_load_dwordx2 v[208:209],v241,s[8:11],s28 offen offset:384
M v[100:103],v[216:219],a[196:199],v[100:103]
v_fma_f32 v234,-4.0,v230,v232
v_fmac_f32 v228,s45,v232
M v[104:107],v[216:219],a[200:203],v[104:107]
v_fmac_f32 v233,s41,v231
v_sub_f32 v232,v232,v230
M v[108:111],v[216:219],a[204:207],v[108:111]
v_fma_f32 v230,-4.0,v229,v231
v_sub_f32 v231,v231,v229
M v[112:115],v[216:219],a[208:211],v[112:115]
buffer_load_dwordx2 v[210:211],v241,s[8:11],s28 offen offset:768
M v[116:119],v[216:219],a[212:215],v[116:119]
v_add_f32 v229,v234,v230
v_sub_f32 v234,v234,v230
M v[120:123],v[216:219],a[216:219],v[120:123]
s_waitcnt lgkmcnt(2)
v_fma_f32 v230,2.0,v231,v232
v_fmac_f32 v232,-2.0,v231
M v[124:127],v[216:219],a[220:223],v[124:127]
s_waitcnt vmcnt(12)
v_and_b32 v196,s42,v196
v_and_b32 v192,s42,v192
M v[128:131],v[220:223],a[192:195],v[128:131]
buffer_load_dwordx2 v[212:213],v241,s[8:11],s28 offen offset:1152
M v[132:135],v[220:223],a[196:199],v[132:135]
v_and_b32 v194,s42,v194
v_and_b32 v202,s42,v202
M v[136:139],v[220:223],a[200:203],v[136:139]
v_and_b32 v200,s42,v200
v_and_b32 v198,s42,v198
M v[140:143],v[220:223],a[204:207],v[140:143]
v_fmac_f32 v192,s43,v196
v_fmac_f32 v202,4.0,v194
M v[144:147],v[220:223],a[208:211],v[144:147]
buffer_load_dwordx4 a[252:255],v247,s[20:23],s46 offen offset:2048 sc1
M v[148:151],v[220:223],a[212:215],v[148:151]
v_fma_f32 v231,-4.0,v196,v200
v_fmac_f32 v192,s45,v200
M v[152:155],v[220:223],a[216:219],v[152:155]
s_waitcnt lgkmcnt(0)
s_barrier
v_fmac_f32 v202,s41,v198
M v[156:159],v[220:223],a[220:223],v[156:159]
s_waitcnt vmcnt(13)
v_sub_f32 v200,v200,v196
v_fma_f32 v196,-4.0,v194,v198
M v[160:163],v[224:227],a[192:195],v[160:163]
buffer_load_dwordx4 a[224:227],v247,s[20:23],s47 offen offset:2048 sc1
M v[164:167],v[224:227],a[196:199],v[164:167]
ds_read_b128 a[192:195],v245 offset:0
ds_read_b128 a[196:199],v246 offset:256
M v[168:171],v[224:227],a[200:203],v[168:171]
ds_read_b128 a[200:203],v246 offset:512
v_sub_f32 v198,v198,v194
M v[172:175],v[224:227],a[204:207],v[172:175]
ds_read_b128 a[204:207],v246 offset:768
v_add_f32 v194,v231,v196
M v[176:179],v[224:227],a[208:211],v[176:179]
buffer_load_dwordx4 v[216:219],v247,s[20:23],s48 offen offset:2048 sc1
M v[180:183],v[224:227],a[212:215],v[180:183]
s_add_u32 s46,s80,18432
ds_read_b128 a[208:211],v246 offset:1024
ds_read_b128 a[212:215],v246 offset:1280
M v[184:187],v[224:227],a[216:219],v[184:187]
ds_read_b128 a[216:219],v246 offset:1536
v_sub_f32 v231,v231,v196
M v[188:191],v[224:227],a[220:223],v[188:191]
s_waitcnt vmcnt(14) lgkmcnt(6)
ds_read_b128 a[220:223],v246 offset:1792
v_fma_f32 v196,2.0,v198,v200
M a[0:3],a[228:231],a[192:195],a[0:3]
s_waitcnt lgkmcnt(6)
buffer_load_dwordx4 v[220:223],v247,s[20:23],s46 offen offset:0 sc1
M a[4:7],a[228:231],a[196:199],a[4:7]
s_waitcnt lgkmcnt(5)
s_add_u32 s47,s80,21504
v_fmac_f32 v200,-2.0,v198
v_cvt_pk_bf16_f32 v192,v228,v192
M a[8:11],a[228:231],a[200:203],a[8:11]
s_waitcnt lgkmcnt(4)
v_cvt_pk_bf16_f32 v202,v233,v202
v_cvt_pk_bf16_f32 v194,v229,v194
M a[12:15],a[228:231],a[204:207],a[12:15]
s_waitcnt lgkmcnt(3)
v_cvt_pk_bf16_f32 v198,v230,v196
v_cvt_pk_bf16_f32 v196,v234,v231
M a[16:19],a[228:231],a[208:211],a[16:19]
s_waitcnt lgkmcnt(2)
buffer_load_dwordx4 v[224:227],v247,s[20:23],s47 offen offset:0 sc1
M a[20:23],a[228:231],a[212:215],a[20:23]
s_waitcnt lgkmcnt(1)
s_add_u32 s48,s80,24576
v_cvt_pk_bf16_f32 v254,v232,v200
v_lshlrev_b32 v230,16,v197
M a[24:27],a[228:231],a[216:219],a[24:27]
s_waitcnt lgkmcnt(0)
v_lshlrev_b32 v228,16,v193
v_lshlrev_b32 v229,16,v195
M a[28:31],a[228:231],a[220:223],a[28:31]
s_waitcnt vmcnt(15)
v_lshlrev_b32 v233,16,v203
v_lshlrev_b32 v232,16,v201
M a[32:35],a[232:235],a[192:195],a[32:35]
buffer_load_dwordx4 a[228:231],v247,s[20:23],s48 offen offset:0 sc1
M a[36:39],a[232:235],a[196:199],a[36:39]
v_lshlrev_b32 v231,16,v199
v_fmac_f32 v228,s43,v230
M a[40:43],a[232:235],a[200:203],a[40:43]
v_fmac_f32 v233,4.0,v229
v_fma_f32 v234,-4.0,v230,v232
M a[44:47],a[232:235],a[204:207],a[44:47]
v_fmac_f32 v228,s45,v232
v_fmac_f32 v233,s41,v231
M a[48:51],a[232:235],a[208:211],a[48:51]
v_sub_f32 v232,v232,v230
v_fma_f32 v230,-4.0,v229,v231
M a[52:55],a[232:235],a[212:215],a[52:55]
v_sub_f32 v231,v231,v229
v_add_f32 v229,v234,v230
M a[56:59],a[232:235],a[216:219],a[56:59]
v_sub_f32 v234,v234,v230
v_fma_f32 v230,2.0,v231,v232
M a[60:63],a[232:235],a[220:223],a[60:63]
s_waitcnt vmcnt(15)
buffer_load_dwordx4 a[232:235],v247,s[20:23],s46 offen offset:1024 sc1
M a[64:67],a[236:239],a[192:195],a[64:67]
ds_read_b128 a[192:195],v246 offset:2048
v_fmac_f32 v232,-2.0,v231
M a[68:71],a[236:239],a[196:199],a[68:71]
v_and_b32 v197,s42,v197
v_and_b32 v193,s42,v193
M a[72:75],a[236:239],a[200:203],a[72:75]
v_and_b32 v195,s42,v195
v_and_b32 v203,s42,v203
M a[76:79],a[236:239],a[204:207],a[76:79]
v_and_b32 v201,s42,v201
v_and_b32 v199,s42,v199
M a[80:83],a[236:239],a[208:211],a[80:83]
v_fmac_f32 v193,s43,v197
v_fmac_f32 v203,4.0,v195
M a[84:87],a[236:239],a[212:215],a[84:87]
v_fma_f32 v231,-4.0,v197,v201
v_fmac_f32 v193,s45,v201
M a[88:91],a[236:239],a[216:219],a[88:91]
v_fmac_f32 v203,s41,v199
v_sub_f32 v201,v201,v197
M a[92:95],a[236:239],a[220:223],a[92:95]
s_waitcnt vmcnt(15)
buffer_load_dwordx4 a[236:239],v247,s[20:23],s47 offen offset:1024 sc1
M a[0:3],a[240:243],a[196:199],a[0:3]
v_fma_f32 v197,-4.0,v195,v199
v_sub_f32 v199,v199,v195
M a[4:7],a[240:243],a[200:203],a[4:7]
v_add_f32 v195,v231,v197
v_sub_f32 v231,v231,v197
M a[8:11],a[240:243],a[204:207],a[8:11]
v_fma_f32 v197,2.0,v199,v201
v_fmac_f32 v201,-2.0,v199
M a[12:15],a[240:243],a[208:211],a[12:15]
v_cvt_pk_bf16_f32 v193,v228,v193
v_cvt_pk_bf16_f32 v203,v233,v203
M a[16:19],a[240:243],a[212:215],a[16:19]
v_cvt_pk_bf16_f32 v195,v229,v195
v_cvt_pk_bf16_f32 v199,v230,v197
M a[20:23],a[240:243],a[216:219],a[20:23]
v_cvt_pk_bf16_f32 v197,v234,v231
v_cvt_pk_bf16_f32 v255,v232,v201
M a[24:27],a[240:243],a[220:223],a[24:27]
s_waitcnt lgkmcnt(0)
ds_write2st64_b64 v243,v[192:193],v[202:203] offset0:136 offset1:153
M a[28:31],a[240:243],a[192:195],a[28:31]
s_waitcnt vmcnt(15)
s_add_u32 s28,s69,786432
buffer_load_dwordx2 v[192:193],v241,s[12:15],s28 offen offset:0
M a[32:35],a[244:247],a[196:199],a[32:35]
ds_write2st64_b64 v243,v[194:195],v[196:197] offset0:102 offset1:119
M a[36:39],a[244:247],a[200:203],a[36:39]
buffer_load_dwordx2 v[202:203],v241,s[16:19],s28 offen offset:1536
M a[40:43],a[244:247],a[204:207],a[40:43]
M a[44:47],a[244:247],a[208:211],a[44:47]
M a[48:51],a[244:247],a[212:215],a[48:51]
M a[52:55],a[244:247],a[216:219],a[52:55]
buffer_load_dwordx2 v[194:195],v241,s[8:11],s28 offen offset:0
M a[56:59],a[244:247],a[220:223],a[56:59]
M a[60:63],a[244:247],a[192:195],a[60:63]
s_waitcnt vmcnt(17)
M a[64:67],a[248:251],a[196:199],a[64:67]
ds_read_b128 a[196:199],v245 offset:2304
M a[68:71],a[248:251],a[200:203],a[68:71]
buffer_load_dwordx2 v[196:197],v241,s[8:11],s28 offen offset:384
M a[72:75],a[248:251],a[204:207],a[72:75]
M a[76:79],a[248:251],a[208:211],a[76:79]
M a[80:83],a[248:251],a[212:215],a[80:83]
M a[84:87],a[248:251],a[216:219],a[84:87]
buffer_load_dwordx4 a[240:243],v247,s[20:23],s48 offen offset:1024 sc1
M a[88:91],a[248:251],a[220:223],a[88:91]
M a[92:95],a[248:251],a[192:195],a[92:95]
s_waitcnt vmcnt(12)
M a[0:3],a[252:255],a[200:203],a[0:3]
M a[4:7],a[252:255],a[204:207],a[4:7]
buffer_load_dwordx4 a[244:247],v247,s[20:23],s46 offen offset:2048 sc1
M a[8:11],a[252:255],a[208:211],a[8:11]
M a[12:15],a[252:255],a[212:215],a[12:15]
M a[16:19],a[252:255],a[216:219],a[16:19]
M a[20:23],a[252:255],a[220:223],a[20:23]
buffer_load_dwordx4 a[248:251],v247,s[20:23],s47 offen offset:2048 sc1
M a[24:27],a[252:255],a[192:195],a[24:27]
s_waitcnt lgkmcnt(0)
M a[28:31],a[252:255],a[196:199],a[28:31]
s_waitcnt vmcnt(13)
M a[32:35],a[224:227],a[200:203],a[32:35]
M a[36:39],a[224:227],a[204:207],a[36:39]
s_barrier
buffer_load_dwordx4 a[252:255],v247,s[20:23],s48 offen offset:2048 sc1
M a[40:43],a[224:227],a[208:211],a[40:43]
s_add_u32 s46,s80,27648
ds_write_b64 v243,v[198:199] offset:17408
M a[44:47],a[224:227],a[212:215],a[44:47]
v_lshlrev_b32 v230,16,v208
v_lshlrev_b32 v228,16,v204
M a[48:51],a[224:227],a[216:219],a[48:51]
buffer_load_dwordx2 v[198:199],v241,s[8:11],s28 offen offset:768
M a[52:55],a[224:227],a[220:223],a[52:55]
v_lshlrev_b32 v229,16,v206
v_lshlrev_b32 v233,16,v214
M a[56:59],a[224:227],a[192:195],a[56:59]
v_lshlrev_b32 v232,16,v212
v_lshlrev_b32 v231,16,v210
M a[60:63],a[224:227],a[196:199],a[60:63]
s_waitcnt vmcnt(14)
v_fmac_f32 v228,s43,v230
v_fmac_f32 v233,4.0,v229
M a[64:67],v[216:219],a[200:203],a[64:67]
buffer_load_dwordx2 v[200:201],v241,s[8:11],s28 offen offset:1152
M a[68:71],v[216:219],a[204:207],a[68:71]
ds_read_b128 a[200:203],v245 offset:8704
ds_read_b128 a[204:207],v246 offset:8960
M a[72:75],v[216:219],a[208:211],a[72:75]
ds_read_b128 a[208:211],v246 offset:9216
v_fma_f32 v234,-4.0,v230,v232
M a[76:79],v[216:219],a[212:215],a[76:79]
ds_read_b128 a[212:215],v246 offset:9472
v_fmac_f32 v228,s45,v232
M a[80:83],v[216:219],a[216:219],a[80:83]
buffer_load_dwordx4 a[224:227],v247,s[20:23],s46 offen offset:0 sc1
M a[84:87],v[216:219],a[220:223],a[84:87]
s_add_u32 s47,s80,30720
ds_read_b128 a[216:219],v246 offset:9728
ds_read_b128 a[220:223],v246 offset:9984
M a[88:91],v[216:219],a[192:195],a[88:91]
ds_read_b128 a[192:195],v246 offset:10240
v_fmac_f32 v233,s41,v231
M a[92:95],v[216:219],a[196:199],a[92:95]
s_waitcnt vmcnt(15) lgkmcnt(6)
ds_read_b128 a[196:199],v246 offset:10496
v_sub_f32 v232,v232,v230
M a[96:99],v[220:223],a[200:203],a[96:99]
s_waitcnt lgkmcnt(6)
buffer_load_dwordx4 v[216:219],v247,s[20:23],s47 offen offset:0 sc1
M a[100:103],v[220:223],a[204:207],a[100:103]
s_waitcnt lgkmcnt(5)
s_add_u32 s48,s80,33792
v_fma_f32 v230,-4.0,v229,v231
v_sub_f32 v231,v231,v229
M a[104:107],v[220:223],a[208:211],a[104:107]
s_waitcnt lgkmcnt(4)
v_add_f32 v229,v234,v230
v_sub_f32 v234,v234,v230
M a[108:111],v[220:223],a[212:215],a[108:111]
s_waitcnt lgkmcnt(3)
v_fma_f32 v230,2.0,v231,v232
v_fmac_f32 v232,-2.0,v231
M a[112:115],v[220:223],a[216:219],a[112:115]
s_waitcnt lgkmcnt(2)
v_and_b32 v208,s42,v208
v_and_b32 v204,s42,v204
M a[116:119],v[220:223],a[220:223],a[116:119]
s_waitcnt lgkmcnt(1)
v_and_b32 v206,s42,v206
v_and_b32 v214,s42,v214
M a[120:123],v[220:223],a[192:195],a[120:123]
s_waitcnt lgkmcnt(0)
v_and_b32 v212,s42,v212
v_and_b32 v210,s42,v210
M a[124:127],v[220:223],a[196:199],a[124:127]
s_waitcnt vmcnt(15)
buffer_load_dwordx4 v[220:223],v247,s[20:23],s48 offen offset:0 sc1
M a[128:131],v[224:227],a[200:203],a[128:131]
v_fmac_f32 v204,s43,v208
v_fmac_f32 v214,4.0,v206
M a[132:135],v[224:227],a[204:207],a[132:135]
v_fma_f32 v231,-4.0,v208,v212
v_fmac_f32 v204,s45,v212
M a[136:139],v[224:227],a[208:211],a[136:139]
v_fmac_f32 v214,s41,v210
v_sub_f32 v212,v212,v208
M a[140:143],v[224:227],a[212:215],a[140:143]
v_fma_f32 v208,-4.0,v206,v210
v_sub_f32 v210,v210,v206
M a[144:147],v[224:227],a[216:219],a[144:147]
v_add_f32 v206,v231,v208
v_sub_f32 v231,v231,v208
M a[148:151],v[224:227],a[220:223],a[148:151]
v_fma_f32 v208,2.0,v210,v212
v_fmac_f32 v212,-2.0,v210
M a[152:155],v[224:227],a[192:195],a[152:155]
v_cvt_pk_bf16_f32 v204,v228,v204
v_cvt_pk_bf16_f32 v214,v233,v214
M a[156:159],v[224:227],a[196:199],a[156:159]
s_waitcnt vmcnt(15)
buffer_load_dwordx4 v[224:227],v247,s[20:23],s46 offen offset:1024 sc1
M a[160:163],a[228:231],a[200:203],a[160:163]
ds_read_b128 a[200:203],v246 offset:10752
v_cvt_pk_bf16_f32 v206,v229,v206
M a[164:167],a[228:231],a[204:207],a[164:167]
v_cvt_pk_bf16_f32 v210,v230,v208
v_cvt_pk_bf16_f32 v208,v234,v231
M a[168:171],a[228:231],a[208:211],a[168:171]
v_cvt_pk_bf16_f32 v212,v232,v212
v_lshlrev_b32 v230,16,v209
M a[172:175],a[228:231],a[212:215],a[172:175]
v_lshlrev_b32 v228,16,v205
v_lshlrev_b32 v229,16,v207
M a[176:179],a[228:231],a[216:219],a[176:179]
v_lshlrev_b32 v233,16,v215
v_lshlrev_b32 v232,16,v213
M a[180:183],a[228:231],a[220:223],a[180:183]
v_lshlrev_b32 v231,16,v211
v_fmac_f32 v228,s43,v230
M a[184:187],a[228:231],a[192:195],a[184:187]
v_fmac_f32 v233,4.0,v229
v_fma_f32 v234,-4.0,v230,v232
M a[188:191],a[228:231],a[196:199],a[188:191]
s_waitcnt vmcnt(15)
buffer_load_dwordx4 a[228:231],v247,s[20:23],s47 offen offset:1024 sc1
M a[96:99],a[232:235],a[204:207],a[96:99]
v_fmac_f32 v228,s45,v232
v_fmac_f32 v233,s41,v231
M a[100:103],a[232:235],a[208:211],a[100:103]
v_sub_f32 v232,v232,v230
v_fma_f32 v230,-4.0,v229,v231
M a[104:107],a[232:235],a[212:215],a[104:107]
v_sub_f32 v231,v231,v229
v_add_f32 v229,v234,v230
M a[108:111],a[232:235],a[216:219],a[108:111]
v_sub_f32 v234,v234,v230
v_fma_f32 v230,2.0,v231,v232
M a[112:115],a[232:235],a[220:223],a[112:115]
v_fmac_f32 v232,-2.0,v231
v_and_b32 v209,s42,v209
M a[116:119],a[232:235],a[192:195],a[116:119]
v_and_b32 v205,s42,v205
v_and_b32 v207,s42,v207
M a[120:123],a[232:235],a[196:199],a[120:123]
s_waitcnt lgkmcnt(0)
v_and_b32 v215,s42,v215
v_and_b32 v213,s42,v213
M a[124:127],a[232:235],a[200:203],a[124:127]
s_waitcnt vmcnt(15)
buffer_load_dwordx4 a[232:235],v247,s[20:23],s48 offen offset:1024 sc1
M a[128:131],a[236:239],a[204:207],a[128:131]
v_and_b32 v211,s42,v211
v_fmac_f32 v205,s43,v209
M a[132:135],a[236:239],a[208:211],a[132:135]
v_fmac_f32 v215,4.0,v207
v_fma_f32 v231,-4.0,v209,v213
M a[136:139],a[236:239],a[212:215],a[136:139]
v_fmac_f32 v205,s45,v213
v_fmac_f32 v215,s41,v211
M a[140:143],a[236:239],a[216:219],a[140:143]
v_sub_f32 v213,v213,v209
v_fma_f32 v209,-4.0,v207,v211
M a[144:147],a[236:239],a[220:223],a[144:147]
v_sub_f32 v211,v211,v207
v_add_f32 v207,v231,v209
M a[148:151],a[236:239],a[192:195],a[148:151]
v_sub_f32 v231,v231,v209
v_fma_f32 v209,2.0,v211,v213
M a[152:155],a[236:239],a[196:199],a[152:155]
v_fmac_f32 v213,-2.0,v211
v_cvt_pk_bf16_f32 v205,v228,v205
M a[156:159],a[236:239],a[200:203],a[156:159]
s_waitcnt vmcnt(11)
buffer_load_dwordx4 a[236:239],v247,s[20:23],s46 offen offset:2048 sc1
M a[160:163],a[240:243],a[204:207],a[160:163]
ds_read_b128 a[204:207],v245 offset:11008
v_cvt_pk_bf16_f32 v215,v233,v215
M a[164:167],a[240:243],a[208:211],a[164:167]
v_cvt_pk_bf16_f32 v207,v229,v207
v_cvt_pk_bf16_f32 v211,v230,v209
M a[168:171],a[240:243],a[212:215],a[168:171]
v_cvt_pk_bf16_f32 v209,v234,v231
v_cvt_pk_bf16_f32 v213,v232,v213
M a[172:175],a[240:243],a[216:219],a[172:175]
ds_write2st64_b64 v243,v[204:205],v[214:215] offset0:137 offset1:154
M a[176:179],a[240:243],a[220:223],a[176:179]
s_add_u32 s28,s69,1179648
buffer_load_dwordx2 v[204:205],v241,s[12:15],s28 offen offset:0
M a[180:183],a[240:243],a[192:195],a[180:183]
ds_write2st64_b64 v243,v[206:207],v[208:209] offset0:103 offset1:120
M a[184:187],a[240:243],a[196:199],a[184:187]
buffer_load_dwordx2 v[214:215],v241,s[16:19],s28 offen offset:1536
M a[188:191],a[240:243],a[200:203],a[188:191]
s_waitcnt vmcnt(13)
M a[96:99],a[244:247],a[208:211],a[96:99]
M a[100:103],a[244:247],a[212:215],a[100:103]
M a[104:107],a[244:247],a[216:219],a[104:107]
buffer_load_dwordx2 v[206:207],v241,s[8:11],s28 offen offset:0
M a[108:111],a[244:247],a[220:223],a[108:111]
M a[112:115],a[244:247],a[192:195],a[112:115]
M a[116:119],a[244:247],a[196:199],a[116:119]
M a[120:123],a[244:247],a[200:203],a[120:123]
s_waitcnt lgkmcnt(2)
buffer_load_dwordx2 v[208:209],v241,s[8:11],s28 offen offset:384
M a[124:127],a[244:247],a[204:207],a[124:127]
s_waitcnt vmcnt(14)
M a[128:131],a[248:251],a[208:211],a[128:131]
M a[132:135],a[248:251],a[212:215],a[132:135]
s_waitcnt lgkmcnt(0)
s_barrier
ds_write_b64 v243,v[254:255] offset:26112
M a[136:139],a[248:251],a[216:219],a[136:139]
buffer_load_dwordx4 a[240:243],v247,s[20:23],s47 offen offset:2048 sc1
M a[140:143],a[248:251],a[220:223],a[140:143]
ds_write2st64_b64 v243,v[210:211],v[212:213] offset0:35 offset1:52
M a[144:147],a[248:251],a[192:195],a[144:147]
buffer_load_dwordx2 v[210:211],v241,s[8:11],s28 offen offset:768
M a[148:151],a[248:251],a[196:199],a[148:151]
v_fmac_f32 v235,s43,v237
v_fmac_f32 v240,4.0,v236
M a[152:155],a[248:251],a[200:203],a[152:155]
v_fma_f32 v228,-4.0,v237,v239
v_fmac_f32 v235,s45,v239
M a[156:159],a[248:251],a[204:207],a[156:159]
s_waitcnt vmcnt(15)
v_fmac_f32 v240,s41,v238
v_sub_f32 v239,v239,v237
M a[160:163],a[252:255],a[208:211],a[160:163]
buffer_load_dwordx2 v[212:213],v241,s[8:11],s28 offen offset:1152
M a[164:167],a[252:255],a[212:215],a[164:167]
ds_read_b128 a[208:211],v245 offset:17408
ds_read_b128 a[212:215],v246 offset:17664
M a[168:171],a[252:255],a[216:219],a[168:171]
ds_read_b128 a[216:219],v246 offset:17920
v_fma_f32 v237,-4.0,v236,v238
M a[172:175],a[252:255],a[220:223],a[172:175]
ds_read_b128 a[220:223],v246 offset:18176
v_sub_f32 v238,v238,v236
M a[176:179],a[252:255],a[192:195],a[176:179]
buffer_load_dwordx4 a[244:247],v247,s[20:23],s48 offen offset:2048 sc1
M a[180:183],a[252:255],a[196:199],a[180:183]
s_add_u32 s46,s80,36864
ds_read_b128 a[192:195],v246 offset:18432
ds_read_b128 a[196:199],v246 offset:18688
M a[184:187],a[252:255],a[200:203],a[184:187]
ds_read_b128 a[200:203],v246 offset:18944
v_add_f32 v236,v228,v237
M a[188:191],a[252:255],a[204:207],a[188:191]
s_waitcnt vmcnt(14) lgkmcnt(6)
ds_read_b128 a[204:207],v246 offset:19200
v_sub_f32 v228,v228,v237
M v[0:3],a[224:227],a[208:211],v[0:3]
s_waitcnt lgkmcnt(6)
buffer_load_dwordx4 a[248:251],v247,s[20:23],s46 offen offset:0 sc1
M v[4:7],a[224:227],a[212:215],v[4:7]
s_waitcnt lgkmcnt(5)
s_add_u32 s47,s80,39936
v_fma_f32 v237,2.0,v238,v239
v_fmac_f32 v239,-2.0,v238
M v[8:11],a[224:227],a[216:219],v[8:11]
s_waitcnt lgkmcnt(4)
v_cvt_pk_bf16_f32 v229,v235,v240
v_cvt_pk_bf16_f32 v230,v236,v228
M v[12:15],a[224:227],a[220:223],v[12:15]
s_waitcnt lgkmcnt(3)
v_cvt_pk_bf16_f32 v231,v237,v239
v_add_u32 v228,69632,v244
M v[16:19],a[224:227],a[192:195],v[16:19]
s_waitcnt lgkmcnt(2)
buffer_load_dwordx4 a[252:255],v247,s[20:23],s47 offen offset:0 sc1
M v[20:23],a[224:227],a[196:199],v[20:23]
s_waitcnt lgkmcnt(1)
s_add_u32 s48,s80,43008
ds_write_b16 v228,v229 offset:0
M v[24:27],a[224:227],a[200:203],v[24:27]
s_waitcnt lgkmcnt(1)
ds_write_b16_d16_hi v228,v229 offset:8704
M v[28:31],a[224:227],a[204:207],v[28:31]
s_waitcnt vmcnt(15)
ds_write_b16 v244,v230 offset:52224
M v[32:35],v[216:219],a[208:211],v[32:35]
global_load_dword v251,v252,s[82:83]
M v[36:39],v[216:219],a[212:215],v[36:39]
ds_write_b16_d16_hi v244,v230 offset:60928
M v[40:43],v[216:219],a[216:219],v[40:43]
buffer_load_dwordx4 a[224:227],v247,s[20:23],s48 offen offset:0 sc1
M v[44:47],v[216:219],a[220:223],v[44:47]
ds_write_b16 v244,v231 offset:17408
M v[48:51],v[216:219],a[192:195],v[48:51]
ds_write_b16_d16_hi v244,v231 offset:26112
M v[52:55],v[216:219],a[196:199],v[52:55]
v_bfe_u32 v228,v247,9,1
v_mul_u32_u24 v228,33,v228
M v[56:59],v[216:219],a[200:203],v[56:59]
v_add_u32 v228,s49,v228
v_add_u32 v228,31,v228
M v[60:63],v[216:219],a[204:207],v[60:63]
s_waitcnt vmcnt(16)
buffer_load_dwordx4 v[216:219],v247,s[20:23],s46 offen offset:1024 sc1
M v[64:67],v[220:223],a[208:211],v[64:67]
ds_read_b128 a[208:211],v246 offset:19456
v_mul_u32_u24 v229,196608,v228
M v[68:71],v[220:223],a[212:215],v[68:71]
v_cmp_gt_u32 vcc,512,v228
v_bfe_u32 v228,v247,3,6
M v[72:75],v[220:223],a[216:219],v[72:75]
v_add_u32 v229,v229,v228
v_bfrev_b32 v228,1
M v[76:79],v[220:223],a[220:223],v[76:79]
v_cndmask_b32 v242,v228,v229,vcc
v_lshlrev_b32 v230,16,v196
M v[80:83],v[220:223],a[192:195],v[80:83]
buffer_load_short_d16_hi v235,v242,s[12:15],s70 offen offset:0
M v[84:87],v[220:223],a[196:199],v[84:87]
buffer_load_short_d16_hi v236,v242,s[8:11],s70 offen offset:0
M v[88:91],v[220:223],a[200:203],v[88:91]
buffer_load_short_d16_hi v237,v242,s[8:11],s70 offen offset:384
M v[92:95],v[220:223],a[204:207],v[92:95]
s_waitcnt vmcnt(19)
v_lshlrev_b32 v228,16,v192
v_lshlrev_b32 v229,16,v194
M v[0:3],v[224:227],a[212:215],v[0:3]
buffer_load_short_d16_hi v238,v242,s[8:11],s70 offen offset:768
M v[4:7],v[224:227],a[216:219],v[4:7]
v_lshlrev_b32 v233,16,v202
v_lshlrev_b32 v232,16,v200
M v[8:11],v[224:227],a[220:223],v[8:11]
buffer_load_short_d16_hi v239,v242,s[8:11],s70 offen offset:1152
M v[12:15],v[224:227],a[192:195],v[12:15]
v_lshlrev_b32 v231,16,v198
v_fmac_f32 v228,s43,v230
M v[16:19],v[224:227],a[196:199],v[16:19]
buffer_load_short_d16_hi v240,v242,s[16:19],s70 offen offset:1536
M v[20:23],v[224:227],a[200:203],v[20:23]
v_fmac_f32 v233,4.0,v229
v_fma_f32 v234,-4.0,v230,v232
M v[24:27],v[224:227],a[204:207],v[24:27]
s_waitcnt lgkmcnt(0)
buffer_load_dwordx4 v[220:223],v247,s[20:23],s47 offen offset:1024 sc1
M v[28:31],v[224:227],a[208:211],v[28:31]
s_waitcnt vmcnt(22)
v_fmac_f32 v228,s45,v232
v_fmac_f32 v233,s41,v231
M v[32:35],a[228:231],a[212:215],v[32:35]
v_sub_f32 v232,v232,v230
v_fma_f32 v230,-4.0,v229,v231
M v[36:39],a[228:231],a[216:219],v[36:39]
v_sub_f32 v231,v231,v229
v_add_f32 v229,v234,v230
M v[40:43],a[228:231],a[220:223],v[40:43]
buffer_load_dwordx4 v[224:227],v247,s[20:23],s48 offen offset:1024 sc1
M v[44:47],a[228:231],a[192:195],v[44:47]
v_sub_f32 v234,v234,v230
v_fma_f32 v230,2.0,v231,v232
M v[48:51],a[228:231],a[196:199],v[48:51]
v_fmac_f32 v232,-2.0,v231
v_and_b32 v196,s42,v196
M v[52:55],a[228:231],a[200:203],v[52:55]
v_and_b32 v192,s42,v192
v_and_b32 v194,s42,v194
M v[56:59],a[228:231],a[204:207],v[56:59]
v_and_b32 v202,s42,v202
v_and_b32 v200,s42,v200
M v[60:63],a[228:231],a[208:211],v[60:63]
s_waitcnt vmcnt(22)
buffer_load_dwordx4 a[228:231],v247,s[20:23],s46 offen offset:2048 sc1
M v[64:67],a[232:235],a[212:215],v[64:67]
ds_read_b128 a[212:215],v245 offset:19712
v_and_b32 v198,s42,v198
M v[68:71],a[232:235],a[216:219],v[68:71]
v_fmac_f32 v192,s43,v196
v_fmac_f32 v202,4.0,v194
M v[72:75],a[232:235],a[220:223],v[72:75]
v_fma_f32 v231,-4.0,v196,v200
v_fmac_f32 v192,s45,v200
M v[76:79],a[232:235],a[192:195],v[76:79]
v_fmac_f32 v202,s41,v198
v_sub_f32 v200,v200,v196
M v[80:83],a[232:235],a[196:199],v[80:83]
v_fma_f32 v196,-4.0,v194,v198
v_sub_f32 v198,v198,v194
M v[84:87],a[232:235],a[200:203],v[84:87]
v_add_f32 v194,v231,v196
v_sub_f32 v231,v231,v196
M v[88:91],a[232:235],a[204:207],v[88:91]
v_fma_f32 v196,2.0,v198,v200
v_fmac_f32 v200,-2.0,v198
M v[92:95],a[232:235],a[208:211],v[92:95]
s_waitcnt vmcnt(22)
buffer_load_dwordx4 a[232:235],v247,s[20:23],s47 offen offset:2048 sc1
M v[0:3],a[236:239],a[216:219],v[0:3]
v_cvt_pk_bf16_f32 v192,v228,v192
v_cvt_pk_bf16_f32 v202,v233,v202
M v[4:7],a[236:239],a[220:223],v[4:7]
v_cvt_pk_bf16_f32 v194,v229,v194
v_cvt_pk_bf16_f32 v198,v230,v196
M v[8:11],a[236:239],a[192:195],v[8:11]
v_cvt_pk_bf16_f32 v196,v234,v231
v_cvt_pk_bf16_f32 v200,v232,v200
M v[12:15],a[236:239],a[196:199],v[12:15]
v_lshlrev_b32 v230,16,v197
v_lshlrev_b32 v228,16,v193
M v[16:19],a[236:239],a[200:203],v[16:19]
v_lshlrev_b32 v229,16,v195
v_lshlrev_b32 v233,16,v203
M v[20:23],a[236:239],a[204:207],v[20:23]
v_lshlrev_b32 v232,16,v201
v_lshlrev_b32 v231,16,v199
M v[24:27],a[236:239],a[208:211],v[24:27]
s_waitcnt lgkmcnt(0)
v_fmac_f32 v228,s43,v230
v_fmac_f32 v233,4.0,v229
M v[28:31],a[236:239],a[212:215],v[28:31]
s_waitcnt vmcnt(18)
buffer_load_dwordx4 a[236:239],v247,s[20:23],s48 offen offset:2048 sc1
M v[32:35],a[240:243],a[216:219],v[32:35]
v_fma_f32 v234,-4.0,v230,v232
v_fmac_f32 v228,s45,v232
M v[36:39],a[240:243],a[220:223],v[36:39]
s_add_u32 s46,s81,9216
v_fmac_f32 v233,s41,v231
v_sub_f32 v232,v232,v230
M v[40:43],a[240:243],a[192:195],v[40:43]
v_fma_f32 v230,-4.0,v229,v231
v_sub_f32 v231,v231,v229
M v[44:47],a[240:243],a[196:199],v[44:47]
v_add_f32 v229,v234,v230
v_sub_f32 v234,v234,v230
M v[48:51],a[240:243],a[200:203],v[48:51]
v_fma_f32 v230,2.0,v231,v232
v_fmac_f32 v232,-2.0,v231
M v[52:55],a[240:243],a[204:207],v[52:55]
v_and_b32 v197,s42,v197
v_and_b32 v193,s42,v193
M v[56:59],a[240:243],a[208:211],v[56:59]
v_and_b32 v195,s42,v195
v_and_b32 v203,s42,v203
M v[60:63],a[240:243],a[212:215],v[60:63]
s_waitcnt vmcnt(16)
buffer_load_dwordx4 a[240:243],v247,s[20:23],s46 offen offset:0 sc1
M v[64:67],a[244:247],a[216:219],v[64:67]
ds_read_b128 a[216:219],v245 offset:26112
v_and_b32 v201,s42,v201
M v[68:71],a[244:247],a[220:223],v[68:71]
ds_read_b128 a[220:223],v246 offset:26368
v_and_b32 v199,s42,v199
M v[72:75],a[244:247],a[192:195],v[72:75]
ds_read_b128 a[192:195],v246 offset:26624
v_fmac_f32 v193,s43,v197
M v[76:79],a[244:247],a[196:199],v[76:79]
ds_read_b128 a[196:199],v246 offset:26880
v_fmac_f32 v203,4.0,v195
M v[80:83],a[244:247],a[200:203],v[80:83]
ds_read_b128 a[200:203],v246 offset:27136
v_fma_f32 v231,-4.0,v197,v201
M v[84:87],a[244:247],a[204:207],v[84:87]
ds_read_b128 a[204:207],v246 offset:27392
v_fmac_f32 v193,s45,v201
M v[88:91],a[244:247],a[208:211],v[88:91]
ds_read_b128 a[208:211],v246 offset:27648
v_fmac_f32 v203,s41,v199
M v[92:95],a[244:247],a[212:215],v[92:95]
s_waitcnt vmcnt(16) lgkmcnt(6)
buffer_load_dwordx4 a[244:247],v247,s[20:23],s46 offen offset:1024 sc1
M v[96:99],a[248:251],a[216:219],v[96:99]
s_waitcnt lgkmcnt(5)
ds_read_b128 a[212:215],v246 offset:27904
v_sub_f32 v201,v201,v197
M v[100:103],a[248:251],a[220:223],v[100:103]
s_waitcnt lgkmcnt(5)
v_fma_f32 v197,-4.0,v195,v199
v_sub_f32 v199,v199,v195
M v[104:107],a[248:251],a[192:195],v[104:107]
s_waitcnt lgkmcnt(4)
v_add_f32 v195,v231,v197
v_sub_f32 v231,v231,v197
M v[108:111],a[248:251],a[196:199],v[108:111]
s_waitcnt lgkmcnt(3)
v_fma_f32 v197,2.0,v199,v201
v_fmac_f32 v201,-2.0,v199
M v[112:115],a[248:251],a[200:203],v[112:115]
s_waitcnt lgkmcnt(2)
v_cvt_pk_bf16_f32 v193,v228,v193
v_cvt_pk_bf16_f32 v203,v233,v203
M v[116:119],a[248:251],a[204:207],v[116:119]
s_waitcnt lgkmcnt(1)
v_cvt_pk_bf16_f32 v195,v229,v195
v_cvt_pk_bf16_f32 v199,v230,v197
M v[120:123],a[248:251],a[208:211],v[120:123]
s_waitcnt lgkmcnt(0)
v_cvt_pk_bf16_f32 v197,v234,v231
v_cvt_pk_bf16_f32 v201,v232,v201
M v[124:127],a[248:251],a[212:215],v[124:127]
s_waitcnt vmcnt(16)
buffer_load_dwordx4 a[248:251],v247,s[20:23],s46 offen offset:2048 sc1
M v[128:131],a[252:255],a[216:219],v[128:131]
ds_write2st64_b64 v243,v[192:193],v[202:203] offset0:138 offset1:155
M v[132:135],a[252:255],a[220:223],v[132:135]
s_add_u32 s28,s64,6291456
buffer_load_dwordx2 v[192:193],v241,s[12:15],s28 offen offset:0
M v[136:139],a[252:255],a[192:195],v[136:139]
s_add_u32 s46,s81,18432
ds_write2st64_b64 v243,v[194:195],v[196:197] offset0:104 offset1:121
M v[140:143],a[252:255],a[196:199],v[140:143]
ds_write2st64_b64 v243,v[198:199],v[200:201] offset0:36 offset1:53
M v[144:147],a[252:255],a[200:203],v[144:147]
buffer_load_dwordx2 v[202:203],v241,s[16:19],s28 offen offset:1536
M v[148:151],a[252:255],a[204:207],v[148:151]
v_lshlrev_b32 v230,16,v208
v_lshlrev_b32 v228,16,v204
M v[152:155],a[252:255],a[208:211],v[152:155]
v_lshlrev_b32 v229,16,v206
v_lshlrev_b32 v233,16,v214
M v[156:159],a[252:255],a[212:215],v[156:159]
s_waitcnt vmcnt(17)
buffer_load_dwordx2 v[194:195],v241,s[8:11],s28 offen offset:0
M v[160:163],a[224:227],a[216:219],v[160:163]
ds_read_b128 a[216:219],v246 offset:28160
v_lshlrev_b32 v232,16,v212
M v[164:167],a[224:227],a[220:223],v[164:167]
v_lshlrev_b32 v231,16,v210
v_fmac_f32 v228,s43,v230
M v[168:171],a[224:227],a[192:195],v[168:171]
v_fmac_f32 v233,4.0,v229
v_fma_f32 v234,-4.0,v230,v232
M v[172:175],a[224:227],a[196:199],v[172:175]
buffer_load_dwordx2 v[196:197],v241,s[8:11],s28 offen offset:384
M v[176:179],a[224:227],a[200:203],v[176:179]
v_fmac_f32 v228,s45,v232
v_fmac_f32 v233,s41,v231
M v[180:183],a[224:227],a[204:207],v[180:183]
v_sub_f32 v232,v232,v230
v_fma_f32 v230,-4.0,v229,v231
M v[184:187],a[224:227],a[208:211],v[184:187]
v_sub_f32 v231,v231,v229
v_add_f32 v229,v234,v230
M v[188:191],a[224:227],a[212:215],v[188:191]
s_waitcnt vmcnt(18)
buffer_load_dwordx2 v[198:199],v241,s[8:11],s28 offen offset:768
M v[96:99],v[216:219],a[220:223],v[96:99]
v_sub_f32 v234,v234,v230
v_fma_f32 v230,2.0,v231,v232
M v[100:103],v[216:219],a[192:195],v[100:103]
v_fmac_f32 v232,-2.0,v231
v_and_b32 v208,s42,v208
M v[104:107],v[216:219],a[196:199],v[104:107]
v_and_b32 v204,s42,v204
v_and_b32 v206,s42,v206
M v[108:111],v[216:219],a[200:203],v[108:111]
buffer_load_dwordx2 v[200:201],v241,s[8:11],s28 offen offset:1152
M v[112:115],v[216:219],a[204:207],v[112:115]
v_and_b32 v214,s42,v214
v_and_b32 v212,s42,v212
M v[116:119],v[216:219],a[208:211],v[116:119]
v_and_b32 v210,s42,v210
v_fmac_f32 v204,s43,v208
M v[120:123],v[216:219],a[212:215],v[120:123]
s_waitcnt lgkmcnt(0)
v_fmac_f32 v214,4.0,v206
v_fma_f32 v231,-4.0,v208,v212
M v[124:127],v[216:219],a[216:219],v[124:127]
s_waitcnt vmcnt(13)
buffer_load_dwordx4 a[252:255],v247,s[20:23],s46 offen offset:0 sc1
M v[128:131],v[220:223],a[220:223],v[128:131]
v_fmac_f32 v204,s45,v212
v_fmac_f32 v214,s41,v210
M v[132:135],v[220:223],a[192:195],v[132:135]
v_sub_f32 v212,v212,v208
v_fma_f32 v208,-4.0,v206,v210
M v[136:139],v[220:223],a[196:199],v[136:139]
v_sub_f32 v210,v210,v206
v_add_f32 v206,v231,v208
M v[140:143],v[220:223],a[200:203],v[140:143]
buffer_load_dwordx4 a[224:227],v247,s[20:23],s46 offen offset:1024 sc1
M v[144:147],v[220:223],a[204:207],v[144:147]
v_sub_f32 v231,v231,v208
v_fma_f32 v208,2.0,v210,v212
M v[148:151],v[220:223],a[208:211],v[148:151]
v_fmac_f32 v212,-2.0,v210
v_cvt_pk_bf16_f32 v204,v228,v204
M v[152:155],v[220:223],a[212:215],v[152:155]
v_cvt_pk_bf16_f32 v214,v233,v214
v_cvt_pk_bf16_f32 v206,v229,v206
M v[156:159],v[220:223],a[216:219],v[156:159]
s_waitcnt vmcnt(14)
buffer_load_dwordx4 v[216:219],v247,s[20:23],s46 offen offset:2048 sc1
M v[160:163],v[224:227],a[220:223],v[160:163]
s_add_u32 s46,s81,27648
ds_read_b128 a[220:223],v245 offset:28416
v_cvt_pk_bf16_f32 v210,v230,v208
M v[164:167],v[224:227],a[192:195],v[164:167]
v_cvt_pk_bf16_f32 v208,v234,v231
v_cvt_pk_bf16_f32 v212,v232,v212
M v[168:171],v[224:227],a[196:199],v[168:171]
v_lshlrev_b32 v230,16,v209
v_lshlrev_b32 v228,16,v205
M v[172:175],v[224:227],a[200:203],v[172:175]
buffer_load_dwordx4 v[220:223],v247,s[20:23],s46 offen offset:0 sc1
M v[176:179],v[224:227],a[204:207],v[176:179]
v_lshlrev_b32 v229,16,v207
v_lshlrev_b32 v233,16,v215
M v[180:183],v[224:227],a[208:211],v[180:183]
v_lshlrev_b32 v232,16,v213
v_lshlrev_b32 v231,16,v211
M v[184:187],v[224:227],a[212:215],v[184:187]
v_fmac_f32 v228,s43,v230
v_fmac_f32 v233,4.0,v229
M v[188:191],v[224:227],a[216:219],v[188:191]
s_waitcnt vmcnt(15)
buffer_load_dwordx4 v[224:227],v247,s[20:23],s46 offen offset:1024 sc1
v_fma_f32 v234,-4.0,v230,v232
v_fmac_f32 v228,s45,v232
v_fmac_f32 v233,s41,v231
M v[96:99],a[228:231],a[192:195],v[96:99]
v_sub_f32 v232,v232,v230
v_fma_f32 v230,-4.0,v229,v231
v_sub_f32 v231,v231,v229
v_add_f32 v229,v234,v230
M v[100:103],a[228:231],a[196:199],v[100:103]
v_sub_f32 v234,v234,v230
v_fma_f32 v230,2.0,v231,v232
v_fmac_f32 v232,-2.0,v231
v_and_b32 v209,s42,v209
M v[104:107],a[228:231],a[200:203],v[104:107]
v_and_b32 v205,s42,v205
v_and_b32 v207,s42,v207
v_and_b32 v215,s42,v215
v_and_b32 v213,s42,v213
M v[108:111],a[228:231],a[204:207],v[108:111]
v_and_b32 v211,s42,v211
v_fmac_f32 v205,s43,v209
v_fmac_f32 v215,4.0,v207
v_fma_f32 v231,-4.0,v209,v213
M v[112:115],a[228:231],a[208:211],v[112:115]
v_fmac_f32 v205,s45,v213
v_fmac_f32 v215,s41,v211
v_sub_f32 v213,v213,v209
v_fma_f32 v209,-4.0,v207,v211
M v[116:119],a[228:231],a[212:215],v[116:119]
v_sub_f32 v211,v211,v207
v_add_f32 v207,v231,v209
v_sub_f32 v231,v231,v209
v_fma_f32 v209,2.0,v211,v213
M v[120:123],a[228:231],a[216:219],v[120:123]
s_waitcnt lgkmcnt(0)
v_fmac_f32 v213,-2.0,v211
v_cvt_pk_bf16_f32 v205,v228,v205
v_cvt_pk_bf16_f32 v215,v233,v215
v_cvt_pk_bf16_f32 v207,v229,v207
M v[124:127],a[228:231],a[220:223],v[124:127]
s_waitcnt vmcnt(15)
buffer_load_dwordx4 a[228:231],v247,s[20:23],s46 offen offset:2048 sc1
v_cvt_pk_bf16_f32 v211,v230,v209
v_cvt_pk_bf16_f32 v209,v234,v231
v_cvt_pk_bf16_f32 v213,v232,v213
M v[128:131],a[232:235],a[192:195],v[128:131]
ds_write2st64_b64 v243,v[204:205],v[214:215] offset0:139 offset1:156
M v[132:135],a[232:235],a[196:199],v[132:135]
s_add_u32 s46,s81,36864
ds_write2st64_b64 v243,v[206:207],v[208:209] offset0:105 offset1:122
M v[136:139],a[232:235],a[200:203],v[136:139]
ds_write2st64_b64 v243,v[210:211],v[212:213] offset0:37 offset1:54
M v[140:143],a[232:235],a[204:207],v[140:143]
s_waitcnt vmcnt(8)
v_lshlrev_b32 v230,16,v196
v_lshlrev_b32 v228,16,v192
M v[144:147],a[232:235],a[208:211],v[144:147]
v_lshlrev_b32 v229,16,v194
v_lshlrev_b32 v233,16,v202
M v[148:151],a[232:235],a[212:215],v[148:151]
s_waitcnt vmcnt(6)
v_lshlrev_b32 v232,16,v200
v_lshlrev_b32 v231,16,v198
M v[152:155],a[232:235],a[216:219],v[152:155]
s_waitcnt lgkmcnt(0)
s_barrier
v_fmac_f32 v228,s43,v230
M v[156:159],a[232:235],a[220:223],v[156:159]
buffer_load_dwordx4 a[232:235],v247,s[20:23],s46 offen offset:0 sc1
M v[160:163],a[236:239],a[192:195],v[160:163]
ds_read_b128 a[192:195],v245 offset:34816
v_fmac_f32 v233,4.0,v229
M v[164:167],a[236:239],a[196:199],v[164:167]
ds_read_b128 a[196:199],v246 offset:35072
v_fma_f32 v234,-4.0,v230,v232
M v[168:171],a[236:239],a[200:203],v[168:171]
ds_read_b128 a[200:203],v246 offset:35328
v_fmac_f32 v228,s45,v232
M v[172:175],a[236:239],a[204:207],v[172:175]
ds_read_b128 a[204:207],v246 offset:35584
v_fmac_f32 v233,s41,v231
M v[176:179],a[236:239],a[208:211],v[176:179]
ds_read_b128 a[208:211],v246 offset:35840
v_sub_f32 v232,v232,v230
M v[180:183],a[236:239],a[212:215],v[180:183]
ds_read_b128 a[212:215],v246 offset:36096
v_fma_f32 v230,-4.0,v229,v231
M v[184:187],a[236:239],a[216:219],v[184:187]
ds_read_b128 a[216:219],v246 offset:36352
v_sub_f32 v231,v231,v229
M v[188:191],a[236:239],a[220:223],v[188:191]
s_waitcnt lgkmcnt(6)
buffer_load_dwordx4 a[236:239],v247,s[20:23],s46 offen offset:1024 sc1
M a[0:3],a[240:243],a[192:195],a[0:3]
s_waitcnt lgkmcnt(5)
ds_read_b128 a[220:223],v246 offset:36608
ds_read_b128 a[192:195],v246 offset:36864
M a[4:7],a[240:243],a[196:199],a[4:7]
s_waitcnt lgkmcnt(6)
v_add_f32 v229,v234,v230
v_sub_f32 v234,v234,v230
M a[8:11],a[240:243],a[200:203],a[8:11]
s_waitcnt lgkmcnt(5)
v_fma_f32 v230,2.0,v231,v232
v_fmac_f32 v232,-2.0,v231
M a[12:15],a[240:243],a[204:207],a[12:15]
s_waitcnt lgkmcnt(4)
v_and_b32 v196,s42,v196
v_and_b32 v192,s42,v192
M a[16:19],a[240:243],a[208:211],a[16:19]
s_waitcnt lgkmcnt(3)
v_and_b32 v194,s42,v194
v_and_b32 v202,s42,v202
M a[20:23],a[240:243],a[212:215],a[20:23]
s_waitcnt lgkmcnt(2)
v_and_b32 v200,s42,v200
v_and_b32 v198,s42,v198
M a[24:27],a[240:243],a[216:219],a[24:27]
s_waitcnt lgkmcnt(1)
v_fmac_f32 v192,s43,v196
v_fmac_f32 v202,4.0,v194
M a[28:31],a[240:243],a[220:223],a[28:31]
buffer_load_dwordx4 a[240:243],v247,s[20:23],s46 offen offset:2048 sc1
M a[0:3],a[244:247],a[196:199],a[0:3]
ds_read_b128 a[196:199],v245 offset:37120
v_fma_f32 v231,-4.0,v196,v200
M a[4:7],a[244:247],a[200:203],a[4:7]
s_add_u32 s47,s81,12288
v_fmac_f32 v192,s45,v200
v_fmac_f32 v202,s41,v198
M a[8:11],a[244:247],a[204:207],a[8:11]
v_sub_f32 v200,v200,v196
v_fma_f32 v196,-4.0,v194,v198
M a[12:15],a[244:247],a[208:211],a[12:15]
v_sub_f32 v198,v198,v194
v_add_f32 v194,v231,v196
M a[16:19],a[244:247],a[212:215],a[16:19]
v_sub_f32 v231,v231,v196
v_fma_f32 v196,2.0,v198,v200
M a[20:23],a[244:247],a[216:219],a[20:23]
v_fmac_f32 v200,-2.0,v198
v_cvt_pk_bf16_f32 v192,v228,v192
M a[24:27],a[244:247],a[220:223],a[24:27]
s_waitcnt lgkmcnt(1)
v_cvt_pk_bf16_f32 v202,v233,v202
v_cvt_pk_bf16_f32 v194,v229,v194
M a[28:31],a[244:247],a[192:195],a[28:31]
buffer_load_dwordx4 a[244:247],v247,s[20:23],s47 offen offset:0 sc1
M a[0:3],a[248:251],a[200:203],a[0:3]
ds_read_b128 a[200:203],v245 offset:43520
v_cvt_pk_bf16_f32 v198,v230,v196
M a[4:7],a[248:251],a[204:207],a[4:7]
s_add_u32 s48,s81,15360
ds_read_b128 a[204:207],v246 offset:43776
v_cvt_pk_bf16_f32 v196,v234,v231
M a[8:11],a[248:251],a[208:211],a[8:11]
ds_read_b128 a[208:211],v246 offset:44032
v_cvt_pk_bf16_f32 v200,v232,v200
M a[12:15],a[248:251],a[212:215],a[12:15]
ds_read_b128 a[212:215],v246 offset:44288
v_lshlrev_b32 v230,16,v197
M a[16:19],a[248:251],a[216:219],a[16:19]
ds_read_b128 a[216:219],v246 offset:44544
v_lshlrev_b32 v228,16,v193
M a[20:23],a[248:251],a[220:223],a[20:23]
ds_read_b128 a[220:223],v246 offset:44800
v_lshlrev_b32 v229,16,v195
M a[24:27],a[248:251],a[192:195],a[24:27]
s_waitcnt lgkmcnt(6)
ds_read_b128 a[192:195],v246 offset:45056
v_lshlrev_b32 v233,16,v203
M a[28:31],a[248:251],a[196:199],a[28:31]
s_waitcnt vmcnt(9) lgkmcnt(6)
buffer_load_dwordx4 a[248:251],v247,s[20:23],s48 offen offset:0 sc1
M a[96:99],a[252:255],a[200:203],a[96:99]
s_waitcnt lgkmcnt(5)
ds_read_b128 a[196:199],v246 offset:45312
ds_read_b128 a[200:203],v246 offset:45568
M a[100:103],a[252:255],a[204:207],a[100:103]
s_waitcnt lgkmcnt(6)
v_lshlrev_b32 v232,16,v201
v_lshlrev_b32 v231,16,v199
M a[104:107],a[252:255],a[208:211],a[104:107]
s_waitcnt lgkmcnt(5)
v_fmac_f32 v228,s43,v230
v_fmac_f32 v233,4.0,v229
M a[108:111],a[252:255],a[212:215],a[108:111]
s_waitcnt lgkmcnt(4)
v_fma_f32 v234,-4.0,v230,v232
v_fmac_f32 v228,s45,v232
M a[112:115],a[252:255],a[216:219],a[112:115]
s_waitcnt lgkmcnt(3)
v_fmac_f32 v233,s41,v231
v_sub_f32 v232,v232,v230
M a[116:119],a[252:255],a[220:223],a[116:119]
s_waitcnt lgkmcnt(2)
v_fma_f32 v230,-4.0,v229,v231
v_sub_f32 v231,v231,v229
M a[120:123],a[252:255],a[192:195],a[120:123]
s_waitcnt lgkmcnt(1)
v_add_f32 v229,v234,v230
v_sub_f32 v234,v234,v230
M a[124:127],a[252:255],a[196:199],a[124:127]
s_waitcnt vmcnt(9)
buffer_load_dwordx4 a[252:255],v247,s[20:23],s47 offen offset:1024 sc1
M a[96:99],a[224:227],a[204:207],a[96:99]
ds_read_b128 a[204:207],v245 offset:45824
v_fma_f32 v230,2.0,v231,v232
M a[100:103],a[224:227],a[208:211],a[100:103]
v_fmac_f32 v232,-2.0,v231
v_and_b32 v197,s42,v197
M a[104:107],a[224:227],a[212:215],a[104:107]
v_and_b32 v193,s42,v193
v_and_b32 v195,s42,v195
M a[108:111],a[224:227],a[216:219],a[108:111]
v_and_b32 v203,s42,v203
v_and_b32 v201,s42,v201
M a[112:115],a[224:227],a[220:223],a[112:115]
v_and_b32 v199,s42,v199
v_fmac_f32 v193,s43,v197
M a[116:119],a[224:227],a[192:195],a[116:119]
v_fmac_f32 v203,4.0,v195
v_fma_f32 v231,-4.0,v197,v201
M a[120:123],a[224:227],a[196:199],a[120:123]
s_waitcnt lgkmcnt(1)
v_fmac_f32 v193,s45,v201
v_fmac_f32 v203,s41,v199
M a[124:127],a[224:227],a[200:203],a[124:127]
s_waitcnt vmcnt(9)
buffer_load_dwordx4 a[224:227],v247,s[20:23],s48 offen offset:1024 sc1
M a[96:99],v[216:219],a[208:211],a[96:99]
s_add_u32 s35,s64,6684672
ds_read_b128 a[208:211],v245 offset:0
v_sub_f32 v201,v201,v197
M a[100:103],v[216:219],a[212:215],a[100:103]
buffer_load_dword v251,v250,s[8:11],s35 offen offset:0
M a[104:107],v[216:219],a[216:219],a[104:107]
ds_read_b128 a[212:215],v246 offset:256
ds_read_b128 a[216:219],v246 offset:512
M a[108:111],v[216:219],a[220:223],a[108:111]
ds_read_b128 a[220:223],v246 offset:768
v_fma_f32 v197,-4.0,v195,v199
M a[112:115],v[216:219],a[192:195],a[112:115]
s_add_u32 s35,s64,6684672
ds_read_b128 a[192:195],v246 offset:1024
v_sub_f32 v199,v199,v195
M a[116:119],v[216:219],a[196:199],a[116:119]
buffer_load_dword v251,v250,s[8:11],s35 offen offset:384
M a[120:123],v[216:219],a[200:203],a[120:123]
s_waitcnt lgkmcnt(5)
ds_read_b128 a[196:199],v246 offset:1280
ds_read_b128 a[200:203],v246 offset:1536
M a[124:127],v[216:219],a[204:207],a[124:127]
s_waitcnt vmcnt(11) lgkmcnt(6)
ds_read_b128 a[204:207],v246 offset:1792
v_add_f32 v195,v231,v197
M v[0:3],v[220:223],a[208:211],v[0:3]
s_waitcnt lgkmcnt(6)
ds_read_b128 a[208:211],v246 offset:2048
v_sub_f32 v231,v231,v197
M v[4:7],v[220:223],a[212:215],v[4:7]
s_waitcnt lgkmcnt(6)
v_fma_f32 v197,2.0,v199,v201
v_fmac_f32 v201,-2.0,v199
M v[8:11],v[220:223],a[216:219],v[8:11]
s_waitcnt lgkmcnt(5)
v_cvt_pk_bf16_f32 v193,v228,v193
v_cvt_pk_bf16_f32 v203,v233,v203
M v[12:15],v[220:223],a[220:223],v[12:15]
s_waitcnt lgkmcnt(4)
v_cvt_pk_bf16_f32 v195,v229,v195
v_cvt_pk_bf16_f32 v199,v230,v197
M v[16:19],v[220:223],a[192:195],v[16:19]
s_waitcnt lgkmcnt(3)
v_cvt_pk_bf16_f32 v197,v234,v231
v_cvt_pk_bf16_f32 v201,v232,v201
M v[20:23],v[220:223],a[196:199],v[20:23]
s_waitcnt lgkmcnt(2)
M v[24:27],v[220:223],a[200:203],v[24:27]
s_waitcnt lgkmcnt(1)
M v[28:31],v[220:223],a[204:207],v[28:31]
s_waitcnt vmcnt(10)
M v[0:3],v[224:227],a[212:215],v[0:3]
ds_read_b128 a[212:215],v245 offset:2304
M v[4:7],v[224:227],a[216:219],v[4:7]
M v[8:11],v[224:227],a[220:223],v[8:11]
M v[12:15],v[224:227],a[192:195],v[12:15]
M v[16:19],v[224:227],a[196:199],v[16:19]
M v[20:23],v[224:227],a[200:203],v[20:23]
M v[24:27],v[224:227],a[204:207],v[24:27]
s_waitcnt lgkmcnt(1)
M v[28:31],v[224:227],a[208:211],v[28:31]
s_waitcnt vmcnt(9)
M v[0:3],a[228:231],a[216:219],v[0:3]
ds_read_b128 a[216:219],v245 offset:8704
M v[4:7],a[228:231],a[220:223],v[4:7]
ds_read_b128 a[220:223],v246 offset:8960
M v[8:11],a[228:231],a[192:195],v[8:11]
ds_read_b128 a[192:195],v246 offset:9216
M v[12:15],a[228:231],a[196:199],v[12:15]
ds_read_b128 a[196:199],v246 offset:9472
M v[16:19],a[228:231],a[200:203],v[16:19]
buffer_load_dwordx4 v[216:219],v247,s[20:23],s47 offen offset:2048 sc1
M v[20:23],a[228:231],a[204:207],v[20:23]
ds_read_b128 a[200:203],v246 offset:9728
ds_read_b128 a[204:207],v246 offset:9984
M v[24:27],a[228:231],a[208:211],v[24:27]
s_waitcnt lgkmcnt(6)
ds_read_b128 a[208:211],v246 offset:10240
M v[28:31],a[228:231],a[212:215],v[28:31]
s_waitcnt vmcnt(9) lgkmcnt(6)
ds_read_b128 a[212:215],v246 offset:10496
M v[96:99],a[232:235],a[216:219],v[96:99]
s_waitcnt lgkmcnt(6)
ds_read_b128 a[216:219],v246 offset:10752
M v[100:103],a[232:235],a[220:223],v[100:103]
s_waitcnt lgkmcnt(6)
M v[104:107],a[232:235],a[192:195],v[104:107]
s_waitcnt lgkmcnt(5)
M v[108:111],a[232:235],a[196:199],v[108:111]
s_waitcnt lgkmcnt(4)
buffer_load_dwordx4 v[220:223],v247,s[20:23],s48 offen offset:2048 sc1
M v[112:115],a[232:235],a[200:203],v[112:115]
s_waitcnt lgkmcnt(3)
s_add_u32 s47,s81,21504
M v[116:119],a[232:235],a[204:207],v[116:119]
s_waitcnt lgkmcnt(2)
buffer_load_dwordx4 v[224:227],v247,s[20:23],s47 offen offset:0 sc1
M v[120:123],a[232:235],a[208:211],v[120:123]
s_waitcnt lgkmcnt(1)
s_add_u32 s48,s81,24576
M v[124:127],a[232:235],a[212:215],v[124:127]
s_waitcnt vmcnt(10)
M v[96:99],a[236:239],a[220:223],v[96:99]
ds_read_b128 a[220:223],v245 offset:11008
M v[100:103],a[236:239],a[192:195],v[100:103]
buffer_load_dwordx4 a[228:231],v247,s[20:23],s48 offen offset:0 sc1
M v[104:107],a[236:239],a[196:199],v[104:107]
M v[108:111],a[236:239],a[200:203],v[108:111]
M v[112:115],a[236:239],a[204:207],v[112:115]
M v[116:119],a[236:239],a[208:211],v[116:119]
buffer_load_dwordx4 a[232:235],v247,s[20:23],s47 offen offset:1024 sc1
M v[120:123],a[236:239],a[212:215],v[120:123]
s_waitcnt lgkmcnt(1)
M v[124:127],a[236:239],a[216:219],v[124:127]
s_waitcnt vmcnt(11)
M v[96:99],a[240:243],a[192:195],v[96:99]
ds_read_b128 a[192:195],v245 offset:34816
M v[100:103],a[240:243],a[196:199],v[100:103]
buffer_load_dwordx4 a[236:239],v247,s[20:23],s48 offen offset:1024 sc1
M v[104:107],a[240:243],a[200:203],v[104:107]
ds_read_b128 a[196:199],v246 offset:35072
ds_read_b128 a[200:203],v246 offset:35328
M v[108:111],a[240:243],a[204:207],v[108:111]
ds_read_b128 a[204:207],v246 offset:35584
v_accvgpr_read_b32 v234,a0
M v[112:115],a[240:243],a[208:211],v[112:115]
ds_read_b128 a[208:211],v246 offset:35840
v_accvgpr_read_b32 v228,a96
M v[116:119],a[240:243],a[212:215],v[116:119]
ds_read_b128 a[212:215],v246 offset:36096
v_add_f32 v230,v234,v228
M v[120:123],a[240:243],a[216:219],v[120:123]
s_waitcnt lgkmcnt(6)
ds_read_b128 a[216:219],v246 offset:36352
v_sub_f32 v234,v234,v228
M v[124:127],a[240:243],a[220:223],v[124:127]
s_waitcnt vmcnt(11) lgkmcnt(6)
buffer_load_dwordx4 a[240:243],v247,s[20:23],s47 offen offset:2048 sc1
M a[32:35],a[244:247],a[192:195],a[32:35]
s_waitcnt lgkmcnt(5)
ds_read_b128 a[220:223],v246 offset:36608
v_add_f32 v228,v0,v96
M a[36:39],a[244:247],a[196:199],a[36:39]
s_waitcnt lgkmcnt(5)
v_sub_f32 v96,v0,v96
v_add_f32 v0,v230,v228
M a[40:43],a[244:247],a[200:203],a[40:43]
s_waitcnt lgkmcnt(4)
v_fmac_f32 v230,4.0,v228
v_fma_f32 v228,2.0,v96,v234
M a[44:47],a[244:247],a[204:207],a[44:47]
s_waitcnt lgkmcnt(3)
v_fma_f32 v96,s40,v96,v234
v_accvgpr_read_b32 v234,a1
M a[48:51],a[244:247],a[208:211],a[48:51]
s_waitcnt lgkmcnt(2)
v_accvgpr_read_b32 v233,a97
v_add_f32 v232,v234,v233
M a[52:55],a[244:247],a[212:215],a[52:55]
s_waitcnt lgkmcnt(1)
v_sub_f32 v234,v234,v233
v_add_f32 v233,v1,v97
M a[56:59],a[244:247],a[216:219],a[56:59]
s_waitcnt lgkmcnt(0)
v_sub_f32 v97,v1,v97
v_add_f32 v1,v232,v233
M a[60:63],a[244:247],a[220:223],a[60:63]
s_waitcnt vmcnt(11)
buffer_load_dwordx4 a[244:247],v247,s[20:23],s48 offen offset:2048 sc1
M a[64:67],a[248:251],a[192:195],a[64:67]
ds_read_b128 a[192:195],v246 offset:36864
v_fmac_f32 v232,4.0,v233
M a[68:71],a[248:251],a[196:199],a[68:71]
s_add_u32 s47,s81,30720
v_fma_f32 v233,2.0,v97,v234
v_fma_f32 v97,s40,v97,v234
M a[72:75],a[248:251],a[200:203],a[72:75]
v_cvt_pk_bf16_f32 v228,v228,v233
v_cvt_pk_bf16_f32 v230,v230,v232
M a[76:79],a[248:251],a[204:207],a[76:79]
v_accvgpr_read_b32 v234,a2
v_accvgpr_read_b32 v229,a98
M a[80:83],a[248:251],a[208:211],a[80:83]
v_add_f32 v231,v234,v229
v_sub_f32 v234,v234,v229
M a[84:87],a[248:251],a[212:215],a[84:87]
v_add_f32 v229,v2,v98
v_sub_f32 v98,v2,v98
M a[88:91],a[248:251],a[216:219],a[88:91]
v_add_f32 v2,v231,v229
v_fmac_f32 v231,4.0,v229
M a[92:95],a[248:251],a[220:223],a[92:95]
s_waitcnt vmcnt(11)
buffer_load_dwordx4 a[248:251],v247,s[20:23],s47 offen offset:0 sc1
M a[32:35],a[252:255],a[196:199],a[32:35]
s_add_u32 s48,s81,33792
v_fma_f32 v229,2.0,v98,v234
v_fma_f32 v98,s40,v98,v234
M a[36:39],a[252:255],a[200:203],a[36:39]
v_accvgpr_read_b32 v234,a3
v_accvgpr_read_b32 v233,a99
M a[40:43],a[252:255],a[204:207],a[40:43]
buffer_load_dwordx4 a[96:99],v247,s[20:23],s48 offen offset:0 sc1
M a[44:47],a[252:255],a[208:211],a[44:47]
v_add_f32 v232,v234,v233
v_sub_f32 v234,v234,v233
M a[48:51],a[252:255],a[212:215],a[48:51]
v_add_f32 v233,v3,v99
v_sub_f32 v99,v3,v99
M a[52:55],a[252:255],a[216:219],a[52:55]
v_add_f32 v3,v232,v233
v_fmac_f32 v232,4.0,v233
M a[56:59],a[252:255],a[220:223],a[56:59]
s_waitcnt lgkmcnt(0)
v_fma_f32 v233,2.0,v99,v234
v_fma_f32 v99,s40,v99,v234
M a[60:63],a[252:255],a[192:195],a[60:63]
s_waitcnt vmcnt(12)
buffer_load_dwordx4 a[252:255],v247,s[20:23],s47 offen offset:1024 sc1
M a[64:67],a[224:227],a[196:199],a[64:67]
ds_read_b128 a[196:199],v245 offset:37120
v_cvt_pk_bf16_f32 v229,v229,v233
M a[68:71],a[224:227],a[200:203],a[68:71]
v_cvt_pk_bf16_f32 v231,v231,v232
M a[72:75],a[224:227],a[204:207],a[72:75]
ds_write2st64_b64 v249,v[228:229],v[230:231] offset0:68 offset1:72
M a[76:79],a[224:227],a[208:211],a[76:79]
v_accvgpr_read_b32 v234,a4
v_accvgpr_read_b32 v228,a100
M a[80:83],a[224:227],a[212:215],a[80:83]
v_add_f32 v230,v234,v228
v_sub_f32 v234,v234,v228
M a[84:87],a[224:227],a[216:219],a[84:87]
v_add_f32 v228,v4,v100
v_sub_f32 v100,v4,v100
M a[88:91],a[224:227],a[220:223],a[88:91]
v_add_f32 v4,v230,v228
v_fmac_f32 v230,4.0,v228
M a[92:95],a[224:227],a[192:195],a[92:95]
s_waitcnt vmcnt(10)
buffer_load_dwordx4 a[224:227],v247,s[20:23],s48 offen offset:1024 sc1
M a[32:35],v[216:219],a[200:203],a[32:35]
v_fma_f32 v228,2.0,v100,v234
v_fma_f32 v100,s40,v100,v234
M a[36:39],v[216:219],a[204:207],a[36:39]
v_accvgpr_read_b32 v234,a5
v_accvgpr_read_b32 v233,a101
M a[40:43],v[216:219],a[208:211],a[40:43]
s_add_u32 s35,s64,7077888
buffer_load_dword v251,v250,s[8:11],s35 offen offset:0
M a[44:47],v[216:219],a[212:215],a[44:47]
v_add_f32 v232,v234,v233
v_sub_f32 v234,v234,v233
M a[48:51],v[216:219],a[216:219],a[48:51]
v_add_f32 v233,v5,v101
v_sub_f32 v101,v5,v101
M a[52:55],v[216:219],a[220:223],a[52:55]
v_add_f32 v5,v232,v233
v_fmac_f32 v232,4.0,v233
M a[56:59],v[216:219],a[192:195],a[56:59]
s_waitcnt lgkmcnt(1)
s_add_u32 s35,s64,7077888
buffer_load_dword v251,v250,s[8:11],s35 offen offset:384
M a[60:63],v[216:219],a[196:199],a[60:63]
s_waitcnt vmcnt(12)
v_fma_f32 v233,2.0,v101,v234
v_fma_f32 v101,s40,v101,v234
M a[64:67],v[220:223],a[200:203],a[64:67]
ds_read_b128 a[200:203],v245 offset:43520
v_cvt_pk_bf16_f32 v228,v228,v233
M a[68:71],v[220:223],a[204:207],a[68:71]
ds_read_b128 a[204:207],v246 offset:43776
v_cvt_pk_bf16_f32 v230,v230,v232
M a[72:75],v[220:223],a[208:211],a[72:75]
ds_read_b128 a[208:211],v246 offset:44032
v_accvgpr_read_b32 v234,a6
M a[76:79],v[220:223],a[212:215],a[76:79]
ds_read_b128 a[212:215],v246 offset:44288
v_accvgpr_read_b32 v229,a102
M a[80:83],v[220:223],a[216:219],a[80:83]
ds_read_b128 a[216:219],v246 offset:44544
v_add_f32 v231,v234,v229
M a[84:87],v[220:223],a[220:223],a[84:87]
ds_read_b128 a[220:223],v246 offset:44800
v_sub_f32 v234,v234,v229
M a[88:91],v[220:223],a[192:195],a[88:91]
ds_read_b128 a[192:195],v246 offset:45056
v_add_f32 v229,v6,v102
M a[92:95],v[220:223],a[196:199],a[92:95]
s_waitcnt vmcnt(11) lgkmcnt(6)
ds_read_b128 a[196:199],v246 offset:45312
v_sub_f32 v102,v6,v102
M a[128:131],v[224:227],a[200:203],a[128:131]
s_waitcnt lgkmcnt(6)
v_add_f32 v6,v231,v229
v_fmac_f32 v231,4.0,v229
M a[132:135],v[224:227],a[204:207],a[132:135]
s_waitcnt lgkmcnt(5)
v_fma_f32 v229,2.0,v102,v234
v_fma_f32 v102,s40,v102,v234
M a[136:139],v[224:227],a[208:211],a[136:139]
s_waitcnt lgkmcnt(4)
v_accvgpr_read_b32 v234,a7
v_accvgpr_read_b32 v233,a103
M a[140:143],v[224:227],a[212:215],a[140:143]
s_waitcnt lgkmcnt(3)
v_add_f32 v232,v234,v233
v_sub_f32 v234,v234,v233
M a[144:147],v[224:227],a[216:219],a[144:147]
s_waitcnt lgkmcnt(2)
global_load_dword v251,v252,s[82:83]
M a[148:151],v[224:227],a[220:223],a[148:151]
s_waitcnt lgkmcnt(1)
v_add_f32 v233,v7,v103
v_sub_f32 v103,v7,v103
M a[152:155],v[224:227],a[192:195],a[152:155]
s_waitcnt lgkmcnt(0)
v_add_f32 v7,v232,v233
v_fmac_f32 v232,4.0,v233
M a[156:159],v[224:227],a[196:199],a[156:159]
s_waitcnt vmcnt(11)
v_fma_f32 v233,2.0,v103,v234
v_fma_f32 v103,s40,v103,v234
M a[160:163],a[228:231],a[200:203],a[160:163]
ds_read_b128 a[200:203],v246 offset:45568
v_cvt_pk_bf16_f32 v229,v229,v233
M a[164:167],a[228:231],a[204:207],a[164:167]
v_cvt_pk_bf16_f32 v231,v231,v232
M a[168:171],a[228:231],a[208:211],a[168:171]
ds_write2st64_b64 v249,v[228:229],v[230:231] offset0:76 offset1:80
M a[172:175],a[228:231],a[212:215],a[172:175]
v_accvgpr_read_b32 v234,a8
v_accvgpr_read_b32 v228,a104
M a[176:179],a[228:231],a[216:219],a[176:179]
v_add_f32 v230,v234,v228
v_sub_f32 v234,v234,v228
M a[180:183],a[228:231],a[220:223],a[180:183]
v_add_f32 v228,v8,v104
v_sub_f32 v104,v8,v104
M a[184:187],a[228:231],a[192:195],a[184:187]
s_waitcnt lgkmcnt(0)
s_barrier
ds_read_b128 a[0:3],v247 offset:34816
M a[188:191],a[228:231],a[196:199],a[188:191]
s_waitcnt vmcnt(10)
ds_read_b128 a[4:7],v247 offset:38912
v_add_f32 v8,v230,v228
M a[128:131],a[232:235],a[204:207],a[128:131]
v_fmac_f32 v230,4.0,v228
v_fma_f32 v228,2.0,v104,v234
M a[132:135],a[232:235],a[208:211],a[132:135]
v_fma_f32 v104,s40,v104,v234
v_accvgpr_read_b32 v234,a9
M a[136:139],a[232:235],a[212:215],a[136:139]
v_accvgpr_read_b32 v233,a105
v_add_f32 v232,v234,v233
M a[140:143],a[232:235],a[216:219],a[140:143]
v_sub_f32 v234,v234,v233
v_add_f32 v233,v9,v105
M a[144:147],a[232:235],a[220:223],a[144:147]
buffer_load_dwordx4 v[216:219],v247,s[20:23],s47 offen offset:2048 sc1
M a[148:151],a[232:235],a[192:195],a[148:151]
v_sub_f32 v105,v9,v105
v_add_f32 v9,v232,v233
M a[152:155],a[232:235],a[196:199],a[152:155]
buffer_load_dwordx4 v[220:223],v247,s[20:23],s48 offen offset:2048 sc1
M a[156:159],a[232:235],a[200:203],a[156:159]
s_waitcnt vmcnt(11)
s_add_u32 s47,s81,39936
v_fmac_f32 v232,4.0,v233
v_fma_f32 v233,2.0,v105,v234
M a[160:163],a[236:239],a[204:207],a[160:163]
ds_read_b128 a[204:207],v245 offset:45824
v_fma_f32 v105,s40,v105,v234
M a[164:167],a[236:239],a[208:211],a[164:167]
v_cvt_pk_bf16_f32 v228,v228,v233
v_cvt_pk_bf16_f32 v230,v230,v232
M a[168:171],a[236:239],a[212:215],a[168:171]
buffer_load_dwordx4 a[100:103],v247,s[20:23],s47 offen offset:0 sc1
M a[172:175],a[236:239],a[216:219],a[172:175]
s_add_u32 s48,s81,43008
v_accvgpr_read_b32 v234,a10
v_accvgpr_read_b32 v229,a106
M a[176:179],a[236:239],a[220:223],a[176:179]
v_add_f32 v231,v234,v229
v_sub_f32 v234,v234,v229
M a[180:183],a[236:239],a[192:195],a[180:183]
v_add_f32 v229,v10,v106
v_sub_f32 v106,v10,v106
M a[184:187],a[236:239],a[196:199],a[184:187]
buffer_load_dwordx4 v[224:227],v247,s[20:23],s48 offen offset:0 sc1
M a[188:191],a[236:239],a[200:203],a[188:191]
s_waitcnt vmcnt(12)
v_add_f32 v10,v231,v229
v_fmac_f32 v231,4.0,v229
M a[128:131],a[240:243],a[208:211],a[128:131]
v_fma_f32 v229,2.0,v106,v234
v_fma_f32 v106,s40,v106,v234
M a[132:135],a[240:243],a[212:215],a[132:135]
v_accvgpr_read_b32 v234,a11
v_accvgpr_read_b32 v233,a107
M a[136:139],a[240:243],a[216:219],a[136:139]
buffer_load_dwordx4 a[228:231],v247,s[20:23],s47 offen offset:1024 sc1
M a[140:143],a[240:243],a[220:223],a[140:143]
v_add_f32 v232,v234,v233
v_sub_f32 v234,v234,v233
M a[144:147],a[240:243],a[192:195],a[144:147]
v_add_f32 v233,v11,v107
v_sub_f32 v107,v11,v107
M a[148:151],a[240:243],a[196:199],a[148:151]
v_add_f32 v11,v232,v233
v_fmac_f32 v232,4.0,v233
M a[152:155],a[240:243],a[200:203],a[152:155]
s_waitcnt lgkmcnt(0)
buffer_load_dwordx4 a[232:235],v247,s[20:23],s48 offen offset:1024 sc1
M a[156:159],a[240:243],a[204:207],a[156:159]
s_waitcnt vmcnt(13)
v_fma_f32 v233,2.0,v107,v234
v_fma_f32 v107,s40,v107,v234
M a[160:163],a[244:247],a[208:211],a[160:163]
ds_read_b128 a[208:211],v245 offset:0
v_cvt_pk_bf16_f32 v229,v229,v233
M a[164:167],a[244:247],a[212:215],a[164:167]
ds_read_b128 a[212:215],v246 offset:256
v_cvt_pk_bf16_f32 v231,v231,v232
M a[168:171],a[244:247],a[216:219],a[168:171]
buffer_load_dwordx4 a[236:239],v247,s[20:23],s47 offen offset:2048 sc1
M a[172:175],a[244:247],a[220:223],a[172:175]
ds_read_b128 a[216:219],v246 offset:512
ds_read_b128 a[220:223],v246 offset:768
M a[176:179],a[244:247],a[192:195],a[176:179]
ds_read_b128 a[192:195],v246 offset:1024
ds_write2st64_b64 v249,v[228:229],v[230:231] offset0:85 offset1:89
M a[180:183],a[244:247],a[196:199],a[180:183]
buffer_load_dwordx4 a[104:107],v247,s[20:23],s48 offen offset:2048 sc1
M a[184:187],a[244:247],a[200:203],a[184:187]
s_add_u32 s46,s76,0
ds_read_b128 a[196:199],v246 offset:1280
ds_read_b128 a[200:203],v246 offset:1536
M a[188:191],a[244:247],a[204:207],a[188:191]
s_waitcnt vmcnt(14) lgkmcnt(7)
ds_read_b128 a[204:207],v246 offset:1792
v_accvgpr_read_b32 v204,a12
M v[32:35],a[248:251],a[208:211],v[32:35]
s_waitcnt lgkmcnt(7)
v_accvgpr_read_b32 v208,a108
v_accvgpr_read_b32 v205,a13
M v[36:39],a[248:251],a[212:215],v[36:39]
s_waitcnt lgkmcnt(6)
buffer_load_dwordx4 a[240:243],v247,s[20:23],s46 offen offset:0 sc1
M v[40:43],a[248:251],a[216:219],v[40:43]
s_waitcnt lgkmcnt(5)
v_accvgpr_read_b32 v209,a109
v_accvgpr_read_b32 v206,a14
M v[44:47],a[248:251],a[220:223],v[44:47]
s_waitcnt lgkmcnt(4)
v_accvgpr_read_b32 v210,a110
v_accvgpr_read_b32 v207,a15
v_accvgpr_read_b32 v211,a111
v_pk_add_f32 v[212:213],v[204:205],v[208:209]
v_pk_add_f32 v[214:215],v[206:207],v[210:211]
v_pk_add_f32 v[204:205],v[204:205],v[208:209] neg_lo:[0,1] neg_hi:[0,1]
v_pk_add_f32 v[206:207],v[206:207],v[210:211] neg_lo:[0,1] neg_hi:[0,1]
v_pk_add_f32 v[208:209],v[12:13],v[108:109]
v_pk_add_f32 v[210:211],v[14:15],v[110:111]
v_pk_add_f32 v[108:109],v[12:13],v[108:109] neg_lo:[0,1] neg_hi:[0,1]
v_pk_add_f32 v[110:111],v[14:15],v[110:111] neg_lo:[0,1] neg_hi:[0,1]
v_pk_add_f32 v[12:13],v[212:213],v[208:209]
v_pk_add_f32 v[14:15],v[214:215],v[210:211]
v_pk_fma_f32 v[212:213],v[208:209],4.0,v[212:213] op_sel_hi:[1,0,1]
v_pk_fma_f32 v[214:215],v[210:211],4.0,v[214:215] op_sel_hi:[1,0,1]
v_pk_fma_f32 v[208:209],v[108:109],2.0,v[204:205] op_sel_hi:[1,0,1]
v_pk_fma_f32 v[210:211],v[110:111],2.0,v[206:207] op_sel_hi:[1,0,1]
v_pk_fma_f32 v[108:109],v[108:109],s[40:41],v[204:205] op_sel_hi:[1,0,1]
v_pk_fma_f32 v[110:111],v[110:111],s[40:41],v[206:207] op_sel_hi:[1,0,1]
M v[48:51],a[248:251],a[192:195],v[48:51]
s_waitcnt lgkmcnt(2)
buffer_load_dwordx4 a[244:247],v247,s[20:23],s46 offen offset:1024 sc1
M v[52:55],a[248:251],a[196:199],v[52:55]
s_waitcnt lgkmcnt(1)
v_cvt_pk_bf16_f32 v208,v208,v209
v_cvt_pk_bf16_f32 v209,v210,v211
M v[56:59],a[248:251],a[200:203],v[56:59]
s_waitcnt lgkmcnt(0)
buffer_load_dwordx4 a[108:111],v247,s[20:23],s46 offen offset:2048 sc1
M v[60:63],a[248:251],a[204:207],v[60:63]
s_waitcnt vmcnt(16)
s_add_u32 s46,s77,0
v_cvt_pk_bf16_f32 v212,v212,v213
v_cvt_pk_bf16_f32 v213,v214,v215
M v[64:67],a[96:99],a[208:211],v[64:67]
ds_read_b128 a[208:211],v246 offset:2048
ds_write2st64_b64 v249,v[208:209],v[212:213] offset0:93 offset1:97
M v[68:71],a[96:99],a[212:215],v[68:71]
buffer_load_dwordx4 a[248:251],v247,s[20:23],s46 offen offset:0 sc1
M v[72:75],a[96:99],a[216:219],v[72:75]
v_accvgpr_read_b32 v234,a16
v_accvgpr_read_b32 v228,a112
M v[76:79],a[96:99],a[220:223],v[76:79]
v_add_f32 v230,v234,v228
v_sub_f32 v234,v234,v228
M v[80:83],a[96:99],a[192:195],v[80:83]
v_add_f32 v228,v16,v112
v_sub_f32 v112,v16,v112
M v[84:87],a[96:99],a[196:199],v[84:87]
s_waitcnt lgkmcnt(0)
s_barrier
ds_read_b128 a[8:11],v247 offset:43520
M v[88:91],a[96:99],a[200:203],v[88:91]
ds_read_b128 a[12:15],v247 offset:47616
v_add_f32 v16,v230,v228
M v[92:95],a[96:99],a[204:207],v[92:95]
s_waitcnt vmcnt(16)
buffer_load_dwordx4 a[96:99],v247,s[20:23],s46 offen offset:1024 sc1
M v[32:35],a[252:255],a[212:215],v[32:35]
v_fmac_f32 v230,4.0,v228
v_fma_f32 v228,2.0,v112,v234
M v[36:39],a[252:255],a[216:219],v[36:39]
v_fma_f32 v112,s40,v112,v234
v_accvgpr_read_b32 v234,a17
M v[40:43],a[252:255],a[220:223],v[40:43]
v_accvgpr_read_b32 v233,a113
v_add_f32 v232,v234,v233
M v[44:47],a[252:255],a[192:195],v[44:47]
v_sub_f32 v234,v234,v233
v_add_f32 v233,v17,v113
M v[48:51],a[252:255],a[196:199],v[48:51]
v_sub_f32 v113,v17,v113
v_add_f32 v17,v232,v233
M v[52:55],a[252:255],a[200:203],v[52:55]
v_fmac_f32 v232,4.0,v233
v_fma_f32 v233,2.0,v113,v234
M v[56:59],a[252:255],a[204:207],v[56:59]
v_fma_f32 v113,s40,v113,v234
v_cvt_pk_bf16_f32 v228,v228,v233
M v[60:63],a[252:255],a[208:211],v[60:63]
s_waitcnt vmcnt(16)
buffer_load_dwordx4 a[252:255],v247,s[20:23],s46 offen offset:2048 sc1
M v[64:67],a[224:227],a[212:215],v[64:67]
ds_read_b128 a[212:215],v245 offset:2304
v_cvt_pk_bf16_f32 v230,v230,v232
M v[68:71],a[224:227],a[216:219],v[68:71]
v_accvgpr_read_b32 v234,a18
v_accvgpr_read_b32 v229,a114
M v[72:75],a[224:227],a[220:223],v[72:75]
v_add_f32 v231,v234,v229
v_sub_f32 v234,v234,v229
M v[76:79],a[224:227],a[192:195],v[76:79]
v_add_f32 v229,v18,v114
v_sub_f32 v114,v18,v114
M v[80:83],a[224:227],a[196:199],v[80:83]
s_add_u32 s35,s64,7471104
buffer_load_dword v251,v250,s[8:11],s35 offen offset:0
M v[84:87],a[224:227],a[200:203],v[84:87]
v_add_f32 v18,v231,v229
v_fmac_f32 v231,4.0,v229
M v[88:91],a[224:227],a[204:207],v[88:91]
v_fma_f32 v229,2.0,v114,v234
v_fma_f32 v114,s40,v114,v234
M v[92:95],a[224:227],a[208:211],v[92:95]
s_waitcnt vmcnt(14)
v_accvgpr_read_b32 v234,a19
v_accvgpr_read_b32 v233,a115
M v[32:35],v[216:219],a[216:219],v[32:35]
s_add_u32 s35,s64,7471104
buffer_load_dword v251,v250,s[8:11],s35 offen offset:384
M v[36:39],v[216:219],a[220:223],v[36:39]
v_add_f32 v232,v234,v233
v_sub_f32 v234,v234,v233
M v[40:43],v[216:219],a[192:195],v[40:43]
v_add_f32 v233,v19,v115
v_sub_f32 v115,v19,v115
M v[44:47],v[216:219],a[196:199],v[44:47]
v_add_f32 v19,v232,v233
v_fmac_f32 v232,4.0,v233
M v[48:51],v[216:219],a[200:203],v[48:51]
v_fma_f32 v233,2.0,v115,v234
v_fma_f32 v115,s40,v115,v234
M v[52:55],v[216:219],a[204:207],v[52:55]
v_cvt_pk_bf16_f32 v229,v229,v233
v_cvt_pk_bf16_f32 v231,v231,v232
M v[56:59],v[216:219],a[208:211],v[56:59]
s_waitcnt lgkmcnt(0)
ds_write2st64_b64 v249,v[228:229],v[230:231] offset0:68 offset1:72
M v[60:63],v[216:219],a[212:215],v[60:63]
s_waitcnt vmcnt(14)
v_accvgpr_read_b32 v234,a20
v_accvgpr_read_b32 v228,a116
M v[64:67],v[220:223],a[216:219],v[64:67]
ds_read_b128 a[216:219],v245 offset:8704
v_add_f32 v230,v234,v228
M v[68:71],v[220:223],a[220:223],v[68:71]
ds_read_b128 a[220:223],v246 offset:8960
v_sub_f32 v234,v234,v228
M v[72:75],v[220:223],a[192:195],v[72:75]
ds_read_b128 a[192:195],v246 offset:9216
v_add_f32 v228,v20,v116
M v[76:79],v[220:223],a[196:199],v[76:79]
ds_read_b128 a[196:199],v246 offset:9472
v_sub_f32 v116,v20,v116
M v[80:83],v[220:223],a[200:203],v[80:83]
ds_read_b128 a[200:203],v246 offset:9728
v_add_f32 v20,v230,v228
M v[84:87],v[220:223],a[204:207],v[84:87]
ds_read_b128 a[204:207],v246 offset:9984
v_fmac_f32 v230,4.0,v228
M v[88:91],v[220:223],a[208:211],v[88:91]
ds_read_b128 a[208:211],v246 offset:10240
v_fma_f32 v228,2.0,v116,v234
M v[92:95],v[220:223],a[212:215],v[92:95]
s_waitcnt vmcnt(13) lgkmcnt(6)
ds_read_b128 a[212:215],v246 offset:10496
v_fma_f32 v116,s40,v116,v234
M v[128:131],a[100:103],a[216:219],v[128:131]
s_waitcnt lgkmcnt(6)
v_accvgpr_read_b32 v234,a21
v_accvgpr_read_b32 v233,a117
M v[132:135],a[100:103],a[220:223],v[132:135]
s_waitcnt lgkmcnt(5)
v_add_f32 v232,v234,v233
v_sub_f32 v234,v234,v233
M v[136:139],a[100:103],a[192:195],v[136:139]
s_waitcnt lgkmcnt(4)
v_add_f32 v233,v21,v117
v_sub_f32 v117,v21,v117
M v[140:143],a[100:103],a[196:199],v[140:143]
s_waitcnt lgkmcnt(3)
v_add_f32 v21,v232,v233
v_fmac_f32 v232,4.0,v233
M v[144:147],a[100:103],a[200:203],v[144:147]
s_waitcnt lgkmcnt(2)
v_fma_f32 v233,2.0,v117,v234
v_fma_f32 v117,s40,v117,v234
M v[148:151],a[100:103],a[204:207],v[148:151]
s_waitcnt lgkmcnt(1)
v_cvt_pk_bf16_f32 v228,v228,v233
v_cvt_pk_bf16_f32 v230,v230,v232
M v[152:155],a[100:103],a[208:211],v[152:155]
s_waitcnt lgkmcnt(0)
v_accvgpr_read_b32 v234,a22
v_accvgpr_read_b32 v229,a118
M v[156:159],a[100:103],a[212:215],v[156:159]
s_waitcnt vmcnt(12)
v_add_f32 v231,v234,v229
v_sub_f32 v234,v234,v229
M v[160:163],v[224:227],a[216:219],v[160:163]
ds_read_b128 a[216:219],v246 offset:10752
v_add_f32 v229,v22,v118
M v[164:167],v[224:227],a[220:223],v[164:167]
s_add_u32 s46,s78,0
v_sub_f32 v118,v22,v118
v_add_f32 v22,v231,v229
M v[168:171],v[224:227],a[192:195],v[168:171]
v_fmac_f32 v231,4.0,v229
v_fma_f32 v229,2.0,v118,v234
M v[172:175],v[224:227],a[196:199],v[172:175]
v_fma_f32 v118,s40,v118,v234
v_accvgpr_read_b32 v234,a23
M v[176:179],v[224:227],a[200:203],v[176:179]
v_accvgpr_read_b32 v233,a119
v_add_f32 v232,v234,v233
M v[180:183],v[224:227],a[204:207],v[180:183]
v_sub_f32 v234,v234,v233
v_add_f32 v233,v23,v119
M v[184:187],v[224:227],a[208:211],v[184:187]
v_sub_f32 v119,v23,v119
v_add_f32 v23,v232,v233
M v[188:191],v[224:227],a[212:215],v[188:191]
s_waitcnt vmcnt(11)
buffer_load_dwordx4 a[224:227],v247,s[20:23],s46 offen offset:0 sc1
M v[128:131],a[228:231],a[220:223],v[128:131]
v_fmac_f32 v232,4.0,v233
v_fma_f32 v233,2.0,v119,v234
M v[132:135],a[228:231],a[192:195],v[132:135]
buffer_load_dwordx4 a[112:115],v247,s[20:23],s46 offen offset:1024 sc1
M v[136:139],a[228:231],a[196:199],v[136:139]
v_fma_f32 v119,s40,v119,v234
v_cvt_pk_bf16_f32 v229,v229,v233
M v[140:143],a[228:231],a[200:203],v[140:143]
v_cvt_pk_bf16_f32 v231,v231,v232
M v[144:147],a[228:231],a[204:207],v[144:147]
ds_write2st64_b64 v249,v[228:229],v[230:231] offset0:76 offset1:80
M v[148:151],a[228:231],a[208:211],v[148:151]
buffer_load_dwordx4 v[216:219],v247,s[20:23],s46 offen offset:2048 sc1
M v[152:155],a[228:231],a[212:215],v[152:155]
s_waitcnt lgkmcnt(1)
s_add_u32 s46,s79,0
v_accvgpr_read_b32 v234,a24
v_accvgpr_read_b32 v228,a120
M v[156:159],a[228:231],a[216:219],v[156:159]
s_waitcnt vmcnt(13)
v_add_f32 v230,v234,v228
v_sub_f32 v234,v234,v228
M v[160:163],a[232:235],a[220:223],v[160:163]
ds_read_b128 a[220:223],v245 offset:11008
v_add_f32 v228,v24,v120
M v[164:167],a[232:235],a[192:195],v[164:167]
buffer_load_dwordx4 v[220:223],v247,s[20:23],s46 offen offset:0 sc1
M v[168:171],a[232:235],a[196:199],v[168:171]
v_sub_f32 v120,v24,v120
M v[172:175],a[232:235],a[200:203],v[172:175]
s_waitcnt lgkmcnt(1)
s_barrier
ds_read_b128 a[16:19],v247 offset:34816
M v[176:179],a[232:235],a[204:207],v[176:179]
ds_read_b128 a[20:23],v247 offset:38912
v_add_f32 v24,v230,v228
M v[180:183],a[232:235],a[208:211],v[180:183]
buffer_load_dwordx4 a[100:103],v247,s[20:23],s46 offen offset:1024 sc1
M v[184:187],a[232:235],a[212:215],v[184:187]
v_fmac_f32 v230,4.0,v228
v_fma_f32 v228,2.0,v120,v234
M v[188:191],a[232:235],a[216:219],v[188:191]
s_waitcnt vmcnt(14)
v_fma_f32 v120,s40,v120,v234
v_accvgpr_read_b32 v234,a25
M v[128:131],a[236:239],a[192:195],v[128:131]
v_accvgpr_read_b32 v233,a121
v_add_f32 v232,v234,v233
M v[132:135],a[236:239],a[196:199],v[132:135]
buffer_load_dwordx4 a[116:119],v247,s[20:23],s46 offen offset:2048 sc1
M v[136:139],a[236:239],a[200:203],v[136:139]
s_add_u32 s46,s80,0
v_sub_f32 v234,v234,v233
v_add_f32 v233,v25,v121
M v[140:143],a[236:239],a[204:207],v[140:143]
v_sub_f32 v121,v25,v121
v_add_f32 v25,v232,v233
M v[144:147],a[236:239],a[208:211],v[144:147]
v_fmac_f32 v232,4.0,v233
v_fma_f32 v233,2.0,v121,v234
M v[148:151],a[236:239],a[212:215],v[148:151]
buffer_load_dwordx4 v[224:227],v247,s[20:23],s46 offen offset:0 sc1
M v[152:155],a[236:239],a[216:219],v[152:155]
s_waitcnt lgkmcnt(2)
v_add_u32 v245,0xffffbc00,v245
v_add_u32 v246,0xffffbc00,v246
M v[156:159],a[236:239],a[220:223],v[156:159]
s_waitcnt vmcnt(15)
v_fma_f32 v121,s40,v121,v234
v_cvt_pk_bf16_f32 v228,v228,v233
M v[160:163],a[104:107],a[192:195],v[160:163]
ds_read_b128 a[192:195],v245 offset:0
v_cvt_pk_bf16_f32 v230,v230,v232
M v[164:167],a[104:107],a[196:199],v[164:167]
buffer_load_dwordx4 a[228:231],v247,s[20:23],s46 offen offset:1024 sc1
M v[168:171],a[104:107],a[200:203],v[168:171]
s_waitcnt lgkmcnt(0)
s_barrier
ds_read_b128 a[196:199],v246 offset:256
M v[172:175],a[104:107],a[204:207],v[172:175]
ds_read_b128 a[200:203],v246 offset:512
ds_read_b128 a[204:207],v246 offset:768
M v[176:179],a[104:107],a[208:211],v[176:179]
ds_read_b128 a[208:211],v246 offset:1024
v_accvgpr_read_b32 v234,a26
v_accvgpr_read_b32 v229,a122
v_add_f32 v231,v234,v229
M v[180:183],a[104:107],a[212:215],v[180:183]
buffer_load_dwordx4 a[232:235],v247,s[20:23],s46 offen offset:2048 sc1
v_sub_f32 v234,v234,v229
v_add_f32 v229,v26,v122
v_sub_f32 v122,v26,v122
v_add_f32 v26,v231,v229
M v[184:187],a[104:107],a[216:219],v[184:187]
s_add_u32 s46,s81,0
ds_read_b128 a[212:215],v246 offset:1280
ds_read_b128 a[216:219],v246 offset:1536
v_fmac_f32 v231,4.0,v229
v_fma_f32 v229,2.0,v122,v234
v_fma_f32 v122,s40,v122,v234
v_accvgpr_read_b32 v234,a27
M v[188:191],a[104:107],a[220:223],v[188:191]
s_waitcnt vmcnt(16)
buffer_load_dwordx4 a[236:239],v247,s[20:23],s46 offen offset:0 sc1
v_accvgpr_read_b32 v233,a123
v_add_f32 v232,v234,v233
v_sub_f32 v234,v234,v233
v_add_f32 v233,v27,v123
M v[0:3],a[240:243],a[192:195],v[0:3]
s_waitcnt lgkmcnt(5)
ds_read_b128 a[220:223],v246 offset:1792
ds_read_b128 a[192:195],v246 offset:2048
v_sub_f32 v123,v27,v123
v_add_f32 v27,v232,v233
v_fmac_f32 v232,4.0,v233
v_fma_f32 v233,2.0,v123,v234
M v[4:7],a[240:243],a[196:199],v[4:7]
s_waitcnt lgkmcnt(6)
buffer_load_dwordx4 a[104:107],v247,s[20:23],s46 offen offset:1024 sc1
v_fma_f32 v123,s40,v123,v234
v_cvt_pk_bf16_f32 v229,v229,v233
v_cvt_pk_bf16_f32 v231,v231,v232
M v[8:11],a[240:243],a[200:203],v[8:11]
s_waitcnt lgkmcnt(5)
ds_write2st64_b64 v249,v[228:229],v[230:231] offset0:85 offset1:89
M v[12:15],a[240:243],a[204:207],v[12:15]
s_waitcnt lgkmcnt(5)
buffer_load_dwordx4 a[120:123],v247,s[20:23],s46 offen offset:2048 sc1
v_accvgpr_read_b32 v204,a28
v_accvgpr_read_b32 v208,a124
M v[16:19],a[240:243],a[208:211],v[16:19]
s_waitcnt lgkmcnt(4)
s_add_u32 s46,s76,46080
v_accvgpr_read_b32 v205,a29
v_accvgpr_read_b32 v209,a125
v_accvgpr_read_b32 v206,a30
v_accvgpr_read_b32 v210,a126
v_accvgpr_read_b32 v207,a31
v_accvgpr_read_b32 v211,a127
v_pk_add_f32 v[212:213],v[204:205],v[208:209]
v_pk_add_f32 v[214:215],v[206:207],v[210:211]
v_pk_add_f32 v[204:205],v[204:205],v[208:209] neg_lo:[0,1] neg_hi:[0,1]
v_pk_add_f32 v[206:207],v[206:207],v[210:211] neg_lo:[0,1] neg_hi:[0,1]
v_pk_add_f32 v[208:209],v[28:29],v[124:125]
v_pk_add_f32 v[210:211],v[30:31],v[126:127]
v_pk_add_f32 v[124:125],v[28:29],v[124:125] neg_lo:[0,1] neg_hi:[0,1]
v_pk_add_f32 v[126:127],v[30:31],v[126:127] neg_lo:[0,1] neg_hi:[0,1]
v_pk_add_f32 v[28:29],v[212:213],v[208:209]
v_pk_add_f32 v[30:31],v[214:215],v[210:211]
v_pk_fma_f32 v[212:213],v[208:209],4.0,v[212:213] op_sel_hi:[1,0,1]
v_pk_fma_f32 v[214:215],v[210:211],4.0,v[214:215] op_sel_hi:[1,0,1]
v_pk_fma_f32 v[208:209],v[124:125],2.0,v[204:205] op_sel_hi:[1,0,1]
v_pk_fma_f32 v[210:211],v[126:127],2.0,v[206:207] op_sel_hi:[1,0,1]
v_pk_fma_f32 v[124:125],v[124:125],s[40:41],v[204:205] op_sel_hi:[1,0,1]
v_pk_fma_f32 v[126:127],v[126:127],s[40:41],v[206:207] op_sel_hi:[1,0,1]
M v[20:23],a[240:243],a[212:215],v[20:23]
s_waitcnt lgkmcnt(3)
buffer_load_dwordx4 a[124:127],v247,s[20:23],s46 offen offset:0 sc1
M v[24:27],a[240:243],a[216:219],v[24:27]
s_waitcnt lgkmcnt(2)
v_cvt_pk_bf16_f32 v208,v208,v209
v_cvt_pk_bf16_f32 v209,v210,v211
M v[28:31],a[240:243],a[220:223],v[28:31]
s_waitcnt vmcnt(19)
buffer_load_dwordx4 a[240:243],v247,s[20:23],s46 offen offset:1024 sc1
M v[0:3],a[244:247],a[196:199],v[0:3]
ds_read_b128 a[196:199],v245 offset:2304
v_cvt_pk_bf16_f32 v212,v212,v213
M v[4:7],a[244:247],a[200:203],v[4:7]
v_cvt_pk_bf16_f32 v213,v214,v215
M v[8:11],a[244:247],a[204:207],v[8:11]
ds_write2st64_b64 v249,v[208:209],v[212:213] offset0:93 offset1:97
M v[12:15],a[244:247],a[208:211],v[12:15]
v_accvgpr_read_b32 v234,a32
v_accvgpr_read_b32 v228,a128
M v[16:19],a[244:247],a[212:215],v[16:19]
v_add_f32 v230,v234,v228
v_sub_f32 v234,v234,v228
M v[20:23],a[244:247],a[216:219],v[20:23]
v_add_u32 v245,0x15400,v245
v_add_u32 v246,0x15400,v246
M v[24:27],a[244:247],a[220:223],v[24:27]
s_waitcnt lgkmcnt(3)
v_add_f32 v228,v32,v128
v_sub_f32 v128,v32,v128
M v[28:31],a[244:247],a[192:195],v[28:31]
s_waitcnt vmcnt(19) lgkmcnt(0)
s_barrier
ds_read_b128 a[24:27],v247 offset:43520
M v[0:3],a[108:111],a[200:203],v[0:3]
ds_read_b128 a[28:31],v247 offset:47616
ds_read_b128 a[200:203],v245 offset:0
M v[4:7],a[108:111],a[204:207],v[4:7]
buffer_load_dwordx4 a[244:247],v247,s[20:23],s46 offen offset:2048 sc1
M v[8:11],a[108:111],a[208:211],v[8:11]
s_add_u32 s46,s77,46080
ds_read_b128 a[204:207],v246 offset:256
ds_read_b128 a[208:211],v246 offset:512
M v[12:15],a[108:111],a[212:215],v[12:15]
ds_read_b128 a[212:215],v246 offset:768
v_add_f32 v32,v230,v228
M v[16:19],a[108:111],a[216:219],v[16:19]
ds_read_b128 a[216:219],v246 offset:1024
v_fmac_f32 v230,4.0,v228
M v[20:23],a[108:111],a[220:223],v[20:23]
ds_read_b128 a[220:223],v246 offset:1280
v_fma_f32 v228,2.0,v128,v234
M v[24:27],a[108:111],a[192:195],v[24:27]
ds_read_b128 a[192:195],v246 offset:1536
v_fma_f32 v128,s40,v128,v234
M v[28:31],a[108:111],a[196:199],v[28:31]
s_waitcnt vmcnt(19) lgkmcnt(6)
buffer_load_dwordx4 a[108:111],v247,s[20:23],s46 offen offset:0 sc1
M v[0:3],a[248:251],a[200:203],v[0:3]
s_waitcnt lgkmcnt(5)
ds_read_b128 a[196:199],v246 offset:1792
ds_read_b128 a[200:203],v246 offset:2048
M v[4:7],a[248:251],a[204:207],v[4:7]
s_waitcnt lgkmcnt(6)
v_accvgpr_read_b32 v234,a33
v_accvgpr_read_b32 v233,a129
M v[8:11],a[248:251],a[208:211],v[8:11]
s_waitcnt lgkmcnt(5)
v_add_f32 v232,v234,v233
v_sub_f32 v234,v234,v233
M v[12:15],a[248:251],a[212:215],v[12:15]
s_waitcnt lgkmcnt(4)
v_add_f32 v233,v33,v129
v_sub_f32 v129,v33,v129
M v[16:19],a[248:251],a[216:219],v[16:19]
s_waitcnt lgkmcnt(3)
v_add_f32 v33,v232,v233
v_fmac_f32 v232,4.0,v233
M v[20:23],a[248:251],a[220:223],v[20:23]
s_waitcnt lgkmcnt(2)
v_fma_f32 v233,2.0,v129,v234
v_fma_f32 v129,s40,v129,v234
M v[24:27],a[248:251],a[192:195],v[24:27]
s_waitcnt lgkmcnt(1)
v_cvt_pk_bf16_f32 v228,v228,v233
v_cvt_pk_bf16_f32 v230,v230,v232
M v[28:31],a[248:251],a[196:199],v[28:31]
s_waitcnt vmcnt(19)
buffer_load_dwordx4 a[248:251],v247,s[20:23],s46 offen offset:1024 sc1
M v[0:3],a[96:99],a[204:207],v[0:3]
s_add_u32 s34,s32,0
ds_read_b128 a[204:207],v245 offset:2304
v_accvgpr_read_b32 v234,a34
M v[4:7],a[96:99],a[208:211],v[4:7]
buffer_store_dwordx4 a[0:3],v248,s[24:27],s34 offen offset:384 nt
M v[8:11],a[96:99],a[212:215],v[8:11]
v_accvgpr_read_b32 v229,a130
v_add_f32 v231,v234,v229
M v[12:15],a[96:99],a[216:219],v[12:15]
v_sub_f32 v234,v234,v229
v_add_f32 v229,v34,v130
M v[16:19],a[96:99],a[220:223],v[16:19]
v_sub_f32 v130,v34,v130
v_add_f32 v34,v231,v229
M v[20:23],a[96:99],a[192:195],v[20:23]
v_fmac_f32 v231,4.0,v229
v_fma_f32 v229,2.0,v130,v234
M v[24:27],a[96:99],a[196:199],v[24:27]
s_waitcnt lgkmcnt(1)
v_fma_f32 v130,s40,v130,v234
v_accvgpr_read_b32 v234,a35
M v[28:31],a[96:99],a[200:203],v[28:31]
s_waitcnt vmcnt(20)
buffer_load_dwordx4 a[96:99],v247,s[20:23],s46 offen offset:2048 sc1
M v[0:3],a[252:255],a[208:211],v[0:3]
s_add_u32 s46,s78,46080
ds_read_b128 a[208:211],v245 offset:17408
v_accvgpr_read_b32 v233,a131
M v[4:7],a[252:255],a[212:215],v[4:7]
ds_read_b128 a[212:215],v246 offset:17664
v_add_f32 v232,v234,v233
M v[8:11],a[252:255],a[216:219],v[8:11]
buffer_load_dwordx4 a[128:131],v247,s[20:23],s46 offen offset:0 sc1
M v[12:15],a[252:255],a[220:223],v[12:15]
ds_read_b128 a[216:219],v246 offset:17920
ds_read_b128 a[220:223],v246 offset:18176
M v[16:19],a[252:255],a[192:195],v[16:19]
ds_read_b128 a[192:195],v246 offset:18432
v_sub_f32 v234,v234,v233
M v[20:23],a[252:255],a[196:199],v[20:23]
ds_read_b128 a[196:199],v246 offset:18688
v_add_f32 v233,v35,v131
M v[24:27],a[252:255],a[200:203],v[24:27]
s_waitcnt lgkmcnt(6)
ds_read_b128 a[200:203],v246 offset:18944
v_sub_f32 v131,v35,v131
M v[28:31],a[252:255],a[204:207],v[28:31]
s_waitcnt vmcnt(19) lgkmcnt(6)
ds_read_b128 a[204:207],v246 offset:19200
v_add_f32 v35,v232,v233
M v[0:3],a[224:227],a[208:211],v[0:3]
s_waitcnt lgkmcnt(6)
ds_read_b128 a[208:211],v246 offset:19456
v_fmac_f32 v232,4.0,v233
M v[4:7],a[224:227],a[212:215],v[4:7]
s_waitcnt lgkmcnt(6)
v_fma_f32 v233,2.0,v131,v234
v_fma_f32 v131,s40,v131,v234
M v[8:11],a[224:227],a[216:219],v[8:11]
s_waitcnt lgkmcnt(5)
buffer_load_dwordx4 a[252:255],v247,s[20:23],s46 offen offset:1024 sc1
M v[12:15],a[224:227],a[220:223],v[12:15]
s_waitcnt lgkmcnt(4)
v_cvt_pk_bf16_f32 v229,v229,v233
v_cvt_pk_bf16_f32 v231,v231,v232
M v[16:19],a[224:227],a[192:195],v[16:19]
s_waitcnt lgkmcnt(3)
ds_write2st64_b64 v249,v[228:229],v[230:231] offset0:34 offset1:38
M v[20:23],a[224:227],a[196:199],v[20:23]
s_waitcnt lgkmcnt(3)
s_add_u32 s34,s32,196608
buffer_store_dwordx4 a[4:7],v248,s[24:27],s34 offen offset:384 nt
M v[24:27],a[224:227],a[200:203],v[24:27]
s_waitcnt lgkmcnt(2)
v_accvgpr_read_b32 v234,a36
v_accvgpr_read_b32 v228,a132
M v[28:31],a[224:227],a[204:207],v[28:31]
s_waitcnt vmcnt(20)
v_add_f32 v230,v234,v228
v_sub_f32 v234,v234,v228
M v[0:3],a[112:115],a[212:215],v[0:3]
ds_read_b128 a[212:215],v245 offset:19712
v_add_f32 v228,v36,v132
M v[4:7],a[112:115],a[216:219],v[4:7]
v_sub_f32 v132,v36,v132
v_add_f32 v36,v230,v228
M v[8:11],a[112:115],a[220:223],v[8:11]
buffer_load_dwordx4 a[224:227],v247,s[20:23],s46 offen offset:2048 sc1
M v[12:15],a[112:115],a[192:195],v[12:15]
v_fmac_f32 v230,4.0,v228
v_fma_f32 v228,2.0,v132,v234
M v[16:19],a[112:115],a[196:199],v[16:19]
s_add_u32 s46,s79,46080
v_fma_f32 v132,s40,v132,v234
v_accvgpr_read_b32 v234,a37
M v[20:23],a[112:115],a[200:203],v[20:23]
v_accvgpr_read_b32 v233,a133
v_add_f32 v232,v234,v233
M v[24:27],a[112:115],a[204:207],v[24:27]
s_waitcnt lgkmcnt(2)
v_sub_f32 v234,v234,v233
v_add_f32 v233,v37,v133
M v[28:31],a[112:115],a[208:211],v[28:31]
s_waitcnt vmcnt(20)
v_sub_f32 v133,v37,v133
v_add_f32 v37,v232,v233
M v[0:3],v[216:219],a[216:219],v[0:3]
ds_read_b128 a[216:219],v245 offset:34816
v_fmac_f32 v232,4.0,v233
M v[4:7],v[216:219],a[220:223],v[4:7]
ds_read_b128 a[220:223],v246 offset:35072
v_fma_f32 v233,2.0,v133,v234
M v[8:11],v[216:219],a[192:195],v[8:11]
buffer_load_dwordx4 a[112:115],v247,s[20:23],s46 offen offset:0 sc1
M v[12:15],v[216:219],a[196:199],v[12:15]
ds_read_b128 a[192:195],v246 offset:35328
ds_read_b128 a[196:199],v246 offset:35584
M v[16:19],v[216:219],a[200:203],v[16:19]
ds_read_b128 a[200:203],v246 offset:35840
v_fma_f32 v133,s40,v133,v234
M v[20:23],v[216:219],a[204:207],v[20:23]
ds_read_b128 a[204:207],v246 offset:36096
v_cvt_pk_bf16_f32 v228,v228,v233
M v[24:27],v[216:219],a[208:211],v[24:27]
s_waitcnt lgkmcnt(6)
ds_read_b128 a[208:211],v246 offset:36352
v_cvt_pk_bf16_f32 v230,v230,v232
M v[28:31],v[216:219],a[212:215],v[28:31]
s_waitcnt vmcnt(20) lgkmcnt(6)
ds_read_b128 a[212:215],v246 offset:36608
v_accvgpr_read_b32 v234,a38
M v[0:3],v[220:223],a[216:219],v[0:3]
s_waitcnt lgkmcnt(6)
ds_read_b128 a[216:219],v246 offset:36864
v_accvgpr_read_b32 v229,a134
M v[4:7],v[220:223],a[220:223],v[4:7]
s_waitcnt lgkmcnt(6)
v_add_f32 v231,v234,v229
v_sub_f32 v234,v234,v229
M v[8:11],v[220:223],a[192:195],v[8:11]
s_waitcnt lgkmcnt(5)
buffer_load_dwordx4 v[216:219],v247,s[20:23],s46 offen offset:1024 sc1
M v[12:15],v[220:223],a[196:199],v[12:15]
s_waitcnt lgkmcnt(4)
s_add_u32 s34,s32,393216
v_add_f32 v229,v38,v134
v_sub_f32 v134,v38,v134
M v[16:19],v[220:223],a[200:203],v[16:19]
s_waitcnt lgkmcnt(3)
buffer_store_dwordx4 a[8:11],v248,s[24:27],s34 offen offset:384 nt
M v[20:23],v[220:223],a[204:207],v[20:23]
s_waitcnt lgkmcnt(2)
v_add_f32 v38,v231,v229
v_fmac_f32 v231,4.0,v229
M v[24:27],v[220:223],a[208:211],v[24:27]
s_waitcnt lgkmcnt(1)
v_fma_f32 v229,2.0,v134,v234
v_fma_f32 v134,s40,v134,v234
M v[28:31],v[220:223],a[212:215],v[28:31]
s_waitcnt vmcnt(21)
v_accvgpr_read_b32 v234,a39
v_accvgpr_read_b32 v233,a135
M v[0:3],a[100:103],a[220:223],v[0:3]
ds_read_b128 a[220:223],v245 offset:37120
v_add_f32 v232,v234,v233
M v[4:7],a[100:103],a[192:195],v[4:7]
v_sub_f32 v234,v234,v233
v_add_f32 v233,v39,v135
M v[8:11],a[100:103],a[196:199],v[8:11]
buffer_load_dwordx4 v[220:223],v247,s[20:23],s46 offen offset:2048 sc1
M v[12:15],a[100:103],a[200:203],v[12:15]
v_sub_f32 v135,v39,v135
v_add_f32 v39,v232,v233
M v[16:19],a[100:103],a[204:207],v[16:19]
s_add_u32 s46,s80,46080
v_fmac_f32 v232,4.0,v233
v_fma_f32 v233,2.0,v135,v234
M v[20:23],a[100:103],a[208:211],v[20:23]
v_fma_f32 v135,s40,v135,v234
v_cvt_pk_bf16_f32 v229,v229,v233
M v[24:27],a[100:103],a[212:215],v[24:27]
s_waitcnt lgkmcnt(1)
v_cvt_pk_bf16_f32 v231,v231,v232
M v[28:31],a[100:103],a[216:219],v[28:31]
s_waitcnt vmcnt(21)
ds_write2st64_b64 v249,v[228:229],v[230:231] offset0:42 offset1:46
M v[0:3],a[116:119],a[192:195],v[0:3]
ds_read_b128 a[192:195],v245 offset:52224
v_accvgpr_read_b32 v234,a40
M v[4:7],a[116:119],a[196:199],v[4:7]
ds_read_b128 a[196:199],v246 offset:52480
v_accvgpr_read_b32 v228,a136
M v[8:11],a[116:119],a[200:203],v[8:11]
buffer_load_dwordx4 a[132:135],v247,s[20:23],s46 offen offset:0 sc1
M v[12:15],a[116:119],a[204:207],v[12:15]
ds_read_b128 a[200:203],v246 offset:52736
ds_read_b128 a[204:207],v246 offset:52992
M v[16:19],a[116:119],a[208:211],v[16:19]
ds_read_b128 a[208:211],v246 offset:53248
v_add_f32 v230,v234,v228
M v[20:23],a[116:119],a[212:215],v[20:23]
ds_read_b128 a[212:215],v246 offset:53504
v_sub_f32 v234,v234,v228
M v[24:27],a[116:119],a[216:219],v[24:27]
s_waitcnt lgkmcnt(7)
ds_read_b128 a[216:219],v246 offset:53760
v_add_f32 v228,v40,v136
M v[28:31],a[116:119],a[220:223],v[28:31]
s_waitcnt vmcnt(21) lgkmcnt(6)
ds_read_b128 a[220:223],v246 offset:54016
v_sub_f32 v136,v40,v136
M v[0:3],v[224:227],a[192:195],v[0:3]
s_waitcnt lgkmcnt(6)
s_add_u32 s34,s32,589824
buffer_store_dwordx4 a[12:15],v248,s[24:27],s34 offen offset:384 nt
M v[4:7],v[224:227],a[196:199],v[4:7]
s_waitcnt lgkmcnt(5)
ds_read_b128 a[192:195],v246 offset:54272
v_add_f32 v40,v230,v228
M v[8:11],v[224:227],a[200:203],v[8:11]
s_waitcnt lgkmcnt(5)
buffer_load_dwordx4 a[100:103],v247,s[20:23],s46 offen offset:1024 sc1
M v[12:15],v[224:227],a[204:207],v[12:15]
s_waitcnt lgkmcnt(4)
v_fmac_f32 v230,4.0,v228
v_fma_f32 v228,2.0,v136,v234
M v[16:19],v[224:227],a[208:211],v[16:19]
s_waitcnt lgkmcnt(3)
v_fma_f32 v136,s40,v136,v234
v_accvgpr_read_b32 v234,a41
M v[20:23],v[224:227],a[212:215],v[20:23]
s_waitcnt lgkmcnt(2)
v_accvgpr_read_b32 v233,a137
v_add_f32 v232,v234,v233
M v[24:27],v[224:227],a[216:219],v[24:27]
s_waitcnt lgkmcnt(1)
v_sub_f32 v234,v234,v233
v_add_f32 v233,v41,v137
M v[28:31],v[224:227],a[220:223],v[28:31]
s_waitcnt vmcnt(22)
v_sub_f32 v137,v41,v137
v_add_f32 v41,v232,v233
M v[0:3],a[228:231],a[196:199],v[0:3]
ds_read_b128 a[196:199],v245 offset:54528
v_fmac_f32 v232,4.0,v233
M v[4:7],a[228:231],a[200:203],v[4:7]
v_fma_f32 v233,2.0,v137,v234
v_fma_f32 v137,s40,v137,v234
M v[8:11],a[228:231],a[204:207],v[8:11]
buffer_load_dwordx4 a[116:119],v247,s[20:23],s46 offen offset:2048 sc1
M v[12:15],a[228:231],a[208:211],v[12:15]
v_cvt_pk_bf16_f32 v228,v228,v233
v_cvt_pk_bf16_f32 v230,v230,v232
M v[16:19],a[228:231],a[212:215],v[16:19]
s_add_u32 s46,s81,46080
v_accvgpr_read_b32 v234,a42
v_accvgpr_read_b32 v229,a138
M v[20:23],a[228:231],a[216:219],v[20:23]
v_add_u32 v245,0xfffece00,v245
v_add_u32 v246,0xfffece00,v246
M v[24:27],a[228:231],a[220:223],v[24:27]
s_waitcnt lgkmcnt(1)
v_add_f32 v231,v234,v229
v_sub_f32 v234,v234,v229
M v[28:31],a[228:231],a[192:195],v[28:31]
s_waitcnt vmcnt(22)
v_add_f32 v229,v42,v138
v_sub_f32 v138,v42,v138
M v[0:3],a[232:235],a[200:203],v[0:3]
ds_read_b128 a[200:203],v245 offset:60928
v_add_f32 v42,v231,v229
M v[4:7],a[232:235],a[204:207],v[4:7]
ds_read_b128 a[204:207],v246 offset:61184
v_fmac_f32 v231,4.0,v229
M v[8:11],a[232:235],a[208:211],v[8:11]
buffer_load_dwordx4 v[224:227],v247,s[20:23],s46 offen offset:0 sc1
M v[12:15],a[232:235],a[212:215],v[12:15]
ds_read_b128 a[208:211],v246 offset:61440
ds_read_b128 a[212:215],v246 offset:61696
M v[16:19],a[232:235],a[216:219],v[16:19]
ds_read_b128 a[216:219],v246 offset:61952
v_fma_f32 v229,2.0,v138,v234
M v[20:23],a[232:235],a[220:223],v[20:23]
ds_read_b128 a[220:223],v246 offset:62208
v_fma_f32 v138,s40,v138,v234
M v[24:27],a[232:235],a[192:195],v[24:27]
s_waitcnt lgkmcnt(6)
s_add_u32 s34,s32,786432
buffer_store_dwordx4 a[16:19],v248,s[24:27],s34 offen offset:384 nt
M v[28:31],a[232:235],a[196:199],v[28:31]
s_waitcnt vmcnt(23) lgkmcnt(5)
ds_read_b128 a[192:195],v246 offset:62464
ds_read_b128 a[196:199],v246 offset:62720
M v[0:3],a[236:239],a[200:203],v[0:3]
s_waitcnt lgkmcnt(6)
ds_read_b128 a[200:203],v246 offset:62976
v_accvgpr_read_b32 v234,a43
M v[4:7],a[236:239],a[204:207],v[4:7]
s_waitcnt lgkmcnt(6)
v_accvgpr_read_b32 v233,a139
v_add_f32 v232,v234,v233
M v[8:11],a[236:239],a[208:211],v[8:11]
s_waitcnt lgkmcnt(5)
buffer_load_dwordx4 a[228:231],v247,s[20:23],s46 offen offset:1024 sc1
M v[12:15],a[236:239],a[212:215],v[12:15]
s_waitcnt lgkmcnt(4)
v_sub_f32 v234,v234,v233
v_add_f32 v233,v43,v139
M v[16:19],a[236:239],a[216:219],v[16:19]
s_waitcnt lgkmcnt(3)
v_sub_f32 v139,v43,v139
v_add_f32 v43,v232,v233
M v[20:23],a[236:239],a[220:223],v[20:23]
s_waitcnt lgkmcnt(2)
v_fmac_f32 v232,4.0,v233
v_fma_f32 v233,2.0,v139,v234
M v[24:27],a[236:239],a[192:195],v[24:27]
s_waitcnt lgkmcnt(1)
v_fma_f32 v139,s40,v139,v234
v_cvt_pk_bf16_f32 v229,v229,v233
M v[28:31],a[236:239],a[196:199],v[28:31]
s_waitcnt vmcnt(23)
v_cvt_pk_bf16_f32 v231,v231,v232
M v[0:3],a[104:107],a[204:207],v[0:3]
ds_read_b128 a[204:207],v245 offset:63232
ds_write2st64_b64 v249,v[228:229],v[230:231] offset0:51 offset1:55
M v[4:7],a[104:107],a[208:211],v[4:7]
v_accvgpr_read_b32 v204,a44
v_accvgpr_read_b32 v208,a140
M v[8:11],a[104:107],a[212:215],v[8:11]
buffer_load_dwordx4 a[232:235],v247,s[20:23],s46 offen offset:2048 sc1
M v[12:15],a[104:107],a[216:219],v[12:15]
v_accvgpr_read_b32 v205,a45
v_accvgpr_read_b32 v209,a141
M v[16:19],a[104:107],a[220:223],v[16:19]
s_add_u32 s47,s76,3072
v_accvgpr_read_b32 v206,a46
v_accvgpr_read_b32 v210,a142
v_accvgpr_read_b32 v207,a47
v_accvgpr_read_b32 v211,a143
v_pk_add_f32 v[212:213],v[204:205],v[208:209]
v_pk_add_f32 v[214:215],v[206:207],v[210:211]
v_pk_add_f32 v[204:205],v[204:205],v[208:209] neg_lo:[0,1] neg_hi:[0,1]
v_pk_add_f32 v[206:207],v[206:207],v[210:211] neg_lo:[0,1] neg_hi:[0,1]
v_pk_add_f32 v[208:209],v[44:45],v[140:141]
v_pk_add_f32 v[210:211],v[46:47],v[142:143]
v_pk_add_f32 v[140:141],v[44:45],v[140:141] neg_lo:[0,1] neg_hi:[0,1]
v_pk_add_f32 v[142:143],v[46:47],v[142:143] neg_lo:[0,1] neg_hi:[0,1]
v_pk_add_f32 v[44:45],v[212:213],v[208:209]
v_pk_add_f32 v[46:47],v[214:215],v[210:211]
v_pk_fma_f32 v[212:213],v[208:209],4.0,v[212:213] op_sel_hi:[1,0,1]
v_pk_fma_f32 v[214:215],v[210:211],4.0,v[214:215] op_sel_hi:[1,0,1]
v_pk_fma_f32 v[208:209],v[140:141],2.0,v[204:205] op_sel_hi:[1,0,1]
v_pk_fma_f32 v[210:211],v[142:143],2.0,v[206:207] op_sel_hi:[1,0,1]
v_pk_fma_f32 v[140:141],v[140:141],s[40:41],v[204:205] op_sel_hi:[1,0,1]
v_pk_fma_f32 v[142:143],v[142:143],s[40:41],v[206:207] op_sel_hi:[1,0,1]
M v[20:23],a[104:107],a[192:195],v[20:23]
v_cvt_pk_bf16_f32 v208,v208,v209
v_cvt_pk_bf16_f32 v209,v210,v211
M v[24:27],a[104:107],a[196:199],v[24:27]
s_waitcnt lgkmcnt(2)
v_cvt_pk_bf16_f32 v212,v212,v213
v_cvt_pk_bf16_f32 v213,v214,v215
M v[28:31],a[104:107],a[200:203],v[28:31]
s_waitcnt vmcnt(23)
ds_write2st64_b64 v249,v[208:209],v[212:213] offset0:59 offset1:63
M v[0:3],a[120:123],a[208:211],v[0:3]
ds_read_b128 a[208:211],v245 offset:0
M v[4:7],a[120:123],a[212:215],v[4:7]
ds_read_b128 a[212:215],v246 offset:256
M v[8:11],a[120:123],a[216:219],v[8:11]
buffer_load_dwordx4 a[136:139],v247,s[20:23],s47 offen offset:0 sc1
M v[12:15],a[120:123],a[220:223],v[12:15]
s_add_u32 s34,s32,983040
ds_read_b128 a[216:219],v246 offset:512
ds_read_b128 a[220:223],v246 offset:768
M v[16:19],a[120:123],a[192:195],v[16:19]
buffer_store_dwordx4 a[20:23],v248,s[24:27],s34 offen offset:384 nt
M v[20:23],a[120:123],a[196:199],v[20:23]
ds_read_b128 a[192:195],v246 offset:1024
ds_read_b128 a[196:199],v246 offset:1280
M v[24:27],a[120:123],a[200:203],v[24:27]
s_waitcnt lgkmcnt(8)
ds_read_b128 a[200:203],v246 offset:1536
v_cvt_pk_bf16_f32 v0,v0,v1
M v[28:31],a[120:123],a[204:207],v[28:31]
s_waitcnt vmcnt(24) lgkmcnt(6)
ds_read_b128 a[204:207],v246 offset:1792
v_cvt_pk_bf16_f32 v1,v2,v3
M v[96:99],a[124:127],a[208:211],v[96:99]
s_waitcnt lgkmcnt(6)
ds_read_b128 a[208:211],v246 offset:2048
v_cvt_pk_bf16_f32 v4,v4,v5
M v[100:103],a[124:127],a[212:215],v[100:103]
s_waitcnt lgkmcnt(6)
v_cvt_pk_bf16_f32 v5,v6,v7
M v[104:107],a[124:127],a[216:219],v[104:107]
s_waitcnt lgkmcnt(5)
s_barrier
ds_read_b128 a[32:35],v247 offset:17408
M v[108:111],a[124:127],a[220:223],v[108:111]
s_waitcnt lgkmcnt(5)
ds_read_b128 a[36:39],v247 offset:21504
ds_read_b128 a[40:43],v247 offset:26112
M v[112:115],a[124:127],a[192:195],v[112:115]
s_waitcnt lgkmcnt(6)
ds_read_b128 a[44:47],v247 offset:30208
buffer_load_dwordx4 a[236:239],v247,s[20:23],s47 offen offset:1024 sc1
M v[116:119],a[124:127],a[196:199],v[116:119]
s_waitcnt lgkmcnt(6)
ds_write2st64_b64 v249,v[0:1],v[4:5] offset0:119 offset1:123
M v[120:123],a[124:127],a[200:203],v[120:123]
s_waitcnt lgkmcnt(6)
global_load_dword v251,v252,s[82:83]
M v[124:127],a[124:127],a[204:207],v[124:127]
s_waitcnt vmcnt(25)
v_cvt_pk_bf16_f32 v8,v8,v9
v_cvt_pk_bf16_f32 v9,v10,v11
M v[96:99],a[240:243],a[212:215],v[96:99]
ds_read_b128 a[212:215],v245 offset:2304
v_cvt_pk_bf16_f32 v12,v12,v13
M v[100:103],a[240:243],a[216:219],v[100:103]
v_cvt_pk_bf16_f32 v13,v14,v15
M v[104:107],a[240:243],a[220:223],v[104:107]
buffer_load_dwordx4 a[140:143],v247,s[20:23],s47 offen offset:2048 sc1
M v[108:111],a[240:243],a[192:195],v[108:111]
ds_write2st64_b64 v249,v[8:9],v[12:13] offset0:127 offset1:131
M v[112:115],a[240:243],a[196:199],v[112:115]
s_add_u32 s47,s77,3072
v_cvt_pk_bf16_f32 v16,v16,v17
v_cvt_pk_bf16_f32 v17,v18,v19
M v[116:119],a[240:243],a[200:203],v[116:119]
v_add_u32 v245,0x15400,v245
v_add_u32 v246,0x15400,v246
M v[120:123],a[240:243],a[204:207],v[120:123]
s_waitcnt lgkmcnt(7)
v_cvt_pk_bf16_f32 v20,v20,v21
v_cvt_pk_bf16_f32 v21,v22,v23
M v[124:127],a[240:243],a[208:211],v[124:127]
s_waitcnt vmcnt(25)
ds_write2st64_b64 v249,v[16:17],v[20:21] offset0:68 offset1:72
M v[96:99],a[244:247],a[216:219],v[96:99]
ds_read_b128 a[216:219],v245 offset:0
v_cvt_pk_bf16_f32 v24,v24,v25
M v[100:103],a[244:247],a[220:223],v[100:103]
s_add_u32 s34,s32,1179648
buffer_store_dwordx4 a[24:27],v248,s[24:27],s34 offen offset:384 nt
M v[104:107],a[244:247],a[192:195],v[104:107]
buffer_load_dwordx4 a[104:107],v247,s[20:23],s47 offen offset:0 sc1
M v[108:111],a[244:247],a[196:199],v[108:111]
ds_read_b128 a[220:223],v246 offset:256
ds_read_b128 a[192:195],v246 offset:512
M v[112:115],a[244:247],a[200:203],v[112:115]
ds_read_b128 a[196:199],v246 offset:768
ds_read_b128 a[200:203],v246 offset:1024
M v[116:119],a[244:247],a[204:207],v[116:119]
ds_read_b128 a[204:207],v246 offset:1280
v_cvt_pk_bf16_f32 v25,v26,v27
M v[120:123],a[244:247],a[208:211],v[120:123]
s_waitcnt lgkmcnt(8)
ds_read_b128 a[208:211],v246 offset:1536
v_cvt_pk_bf16_f32 v28,v28,v29
M v[124:127],a[244:247],a[212:215],v[124:127]
s_waitcnt vmcnt(26) lgkmcnt(6)
ds_read_b128 a[212:215],v246 offset:1792
v_cvt_pk_bf16_f32 v29,v30,v31
M v[96:99],a[108:111],a[216:219],v[96:99]
s_waitcnt lgkmcnt(6)
ds_read_b128 a[216:219],v246 offset:2048
ds_write2st64_b64 v249,v[24:25],v[28:29] offset0:76 offset1:80
M v[100:103],a[108:111],a[220:223],v[100:103]
s_waitcnt lgkmcnt(7)
v_accvgpr_read_b32 v234,a48
v_accvgpr_read_b32 v228,a144
M v[104:107],a[108:111],a[192:195],v[104:107]
s_waitcnt lgkmcnt(6)
buffer_load_dwordx4 a[120:123],v247,s[20:23],s47 offen offset:1024 sc1
M v[108:111],a[108:111],a[196:199],v[108:111]
s_waitcnt lgkmcnt(5)
v_add_f32 v230,v234,v228
v_sub_f32 v234,v234,v228
M v[112:115],a[108:111],a[200:203],v[112:115]
s_waitcnt lgkmcnt(4)
v_add_f32 v228,v48,v144
v_sub_f32 v144,v48,v144
M v[116:119],a[108:111],a[204:207],v[116:119]
s_waitcnt lgkmcnt(3)
v_add_f32 v48,v230,v228
v_fmac_f32 v230,4.0,v228
M v[120:123],a[108:111],a[208:211],v[120:123]
s_waitcnt lgkmcnt(2)
v_fma_f32 v228,2.0,v144,v234
v_fma_f32 v144,s40,v144,v234
M v[124:127],a[108:111],a[212:215],v[124:127]
s_waitcnt vmcnt(26)
v_accvgpr_read_b32 v234,a49
v_accvgpr_read_b32 v233,a145
M v[96:99],a[248:251],a[220:223],v[96:99]
ds_read_b128 a[220:223],v245 offset:2304
v_add_f32 v232,v234,v233
M v[100:103],a[248:251],a[192:195],v[100:103]
v_sub_f32 v234,v234,v233
v_add_f32 v233,v49,v145
M v[104:107],a[248:251],a[196:199],v[104:107]
buffer_load_dwordx4 a[124:127],v247,s[20:23],s47 offen offset:2048 sc1
M v[108:111],a[248:251],a[200:203],v[108:111]
v_sub_f32 v145,v49,v145
v_add_f32 v49,v232,v233
M v[112:115],a[248:251],a[204:207],v[112:115]
s_add_u32 s47,s78,3072
v_fmac_f32 v232,4.0,v233
v_fma_f32 v233,2.0,v145,v234
M v[116:119],a[248:251],a[208:211],v[116:119]
v_fma_f32 v145,s40,v145,v234
v_cvt_pk_bf16_f32 v228,v228,v233
M v[120:123],a[248:251],a[212:215],v[120:123]
s_waitcnt lgkmcnt(2)
s_add_u32 s34,s32,1376256
buffer_store_dwordx4 a[28:31],v248,s[24:27],s34 offen offset:384 nt
M v[124:127],a[248:251],a[216:219],v[124:127]
s_waitcnt vmcnt(26)
v_cvt_pk_bf16_f32 v230,v230,v232
v_accvgpr_read_b32 v234,a50
M v[96:99],a[96:99],a[192:195],v[96:99]
ds_read_b128 a[192:195],v245 offset:17408
v_accvgpr_read_b32 v229,a146
M v[100:103],a[96:99],a[196:199],v[100:103]
ds_read_b128 a[196:199],v246 offset:17664
v_add_f32 v231,v234,v229
M v[104:107],a[96:99],a[200:203],v[104:107]
buffer_load_dwordx4 a[240:243],v247,s[20:23],s47 offen offset:0 sc1
M v[108:111],a[96:99],a[204:207],v[108:111]
ds_read_b128 a[200:203],v246 offset:17920
ds_read_b128 a[204:207],v246 offset:18176
M v[112:115],a[96:99],a[208:211],v[112:115]
ds_read_b128 a[208:211],v246 offset:18432
v_sub_f32 v234,v234,v229
M v[116:119],a[96:99],a[212:215],v[116:119]
ds_read_b128 a[212:215],v246 offset:18688
v_add_f32 v229,v50,v146
M v[120:123],a[96:99],a[216:219],v[120:123]
s_waitcnt lgkmcnt(6)
ds_read_b128 a[216:219],v246 offset:18944
v_sub_f32 v146,v50,v146
M v[124:127],a[96:99],a[220:223],v[124:127]
s_waitcnt vmcnt(26) lgkmcnt(6)
ds_read_b128 a[220:223],v246 offset:19200
v_add_f32 v50,v231,v229
M v[96:99],a[128:131],a[192:195],v[96:99]
s_waitcnt lgkmcnt(6)
ds_read_b128 a[192:195],v246 offset:19456
v_fmac_f32 v231,4.0,v229
M v[100:103],a[128:131],a[196:199],v[100:103]
s_waitcnt lgkmcnt(6)
v_fma_f32 v229,2.0,v146,v234
v_fma_f32 v146,s40,v146,v234
M v[104:107],a[128:131],a[200:203],v[104:107]
s_waitcnt lgkmcnt(5)
buffer_load_dwordx4 a[244:247],v247,s[20:23],s47 offen offset:1024 sc1
M v[108:111],a[128:131],a[204:207],v[108:111]
s_waitcnt lgkmcnt(4)
v_accvgpr_read_b32 v234,a51
v_accvgpr_read_b32 v233,a147
M v[112:115],a[128:131],a[208:211],v[112:115]
s_waitcnt lgkmcnt(3)
v_add_f32 v232,v234,v233
v_sub_f32 v234,v234,v233
M v[116:119],a[128:131],a[212:215],v[116:119]
s_waitcnt lgkmcnt(2)
v_add_f32 v233,v51,v147
v_sub_f32 v147,v51,v147
M v[120:123],a[128:131],a[216:219],v[120:123]
s_waitcnt lgkmcnt(1)
v_add_f32 v51,v232,v233
v_fmac_f32 v232,4.0,v233
M v[124:127],a[128:131],a[220:223],v[124:127]
s_waitcnt vmcnt(26)
v_fma_f32 v233,2.0,v147,v234
v_fma_f32 v147,s40,v147,v234
M v[96:99],a[252:255],a[196:199],v[96:99]
ds_read_b128 a[196:199],v245 offset:19712
v_cvt_pk_bf16_f32 v229,v229,v233
M v[100:103],a[252:255],a[200:203],v[100:103]
v_cvt_pk_bf16_f32 v231,v231,v232
M v[104:107],a[252:255],a[204:207],v[104:107]
buffer_load_dwordx4 a[108:111],v247,s[20:23],s47 offen offset:2048 sc1
M v[108:111],a[252:255],a[208:211],v[108:111]
ds_write2st64_b64 v249,v[228:229],v[230:231] offset0:85 offset1:89
M v[112:115],a[252:255],a[212:215],v[112:115]
s_add_u32 s47,s79,3072
s_add_u32 s34,s32,0
v_accvgpr_read_b32 v234,a52
M v[116:119],a[252:255],a[216:219],v[116:119]
buffer_store_dwordx4 a[32:35],v248,s[24:27],s34 offen offset:512 nt
M v[120:123],a[252:255],a[220:223],v[120:123]
s_waitcnt lgkmcnt(2)
v_accvgpr_read_b32 v228,a148
v_add_f32 v230,v234,v228
M v[124:127],a[252:255],a[192:195],v[124:127]
s_waitcnt vmcnt(26)
v_sub_f32 v234,v234,v228
v_add_f32 v228,v52,v148
M v[96:99],a[224:227],a[200:203],v[96:99]
ds_read_b128 a[200:203],v245 offset:34816
v_sub_f32 v148,v52,v148
M v[100:103],a[224:227],a[204:207],v[100:103]
ds_read_b128 a[204:207],v246 offset:35072
v_add_f32 v52,v230,v228
M v[104:107],a[224:227],a[208:211],v[104:107]
buffer_load_dwordx4 a[248:251],v247,s[20:23],s47 offen offset:0 sc1
M v[108:111],a[224:227],a[212:215],v[108:111]
ds_read_b128 a[208:211],v246 offset:35328
ds_read_b128 a[212:215],v246 offset:35584
M v[112:115],a[224:227],a[216:219],v[112:115]
ds_read_b128 a[216:219],v246 offset:35840
v_fmac_f32 v230,4.0,v228
M v[116:119],a[224:227],a[220:223],v[116:119]
ds_read_b128 a[220:223],v246 offset:36096
v_fma_f32 v228,2.0,v148,v234
M v[120:123],a[224:227],a[192:195],v[120:123]
s_waitcnt lgkmcnt(7)
ds_read_b128 a[192:195],v246 offset:36352
v_fma_f32 v148,s40,v148,v234
M v[124:127],a[224:227],a[196:199],v[124:127]
s_waitcnt vmcnt(26) lgkmcnt(6)
ds_read_b128 a[196:199],v246 offset:36608
v_accvgpr_read_b32 v234,a53
M v[96:99],a[112:115],a[200:203],v[96:99]
s_waitcnt lgkmcnt(6)
ds_read_b128 a[200:203],v246 offset:36864
v_accvgpr_read_b32 v233,a149
M v[100:103],a[112:115],a[204:207],v[100:103]
s_waitcnt lgkmcnt(6)
v_add_f32 v232,v234,v233
v_sub_f32 v234,v234,v233
M v[104:107],a[112:115],a[208:211],v[104:107]
s_waitcnt lgkmcnt(5)
buffer_load_dwordx4 a[96:99],v247,s[20:23],s47 offen offset:1024 sc1
M v[108:111],a[112:115],a[212:215],v[108:111]
s_waitcnt lgkmcnt(4)
v_add_f32 v233,v53,v149
v_sub_f32 v149,v53,v149
M v[112:115],a[112:115],a[216:219],v[112:115]
s_waitcnt lgkmcnt(3)
v_add_f32 v53,v232,v233
v_fmac_f32 v232,4.0,v233
M v[116:119],a[112:115],a[220:223],v[116:119]
s_waitcnt lgkmcnt(2)
v_fma_f32 v233,2.0,v149,v234
v_fma_f32 v149,s40,v149,v234
M v[120:123],a[112:115],a[192:195],v[120:123]
s_waitcnt lgkmcnt(1)
v_cvt_pk_bf16_f32 v228,v228,v233
v_cvt_pk_bf16_f32 v230,v230,v232
M v[124:127],a[112:115],a[196:199],v[124:127]
s_waitcnt vmcnt(26)
v_accvgpr_read_b32 v234,a54
v_accvgpr_read_b32 v229,a150
M v[96:99],v[216:219],a[204:207],v[96:99]
ds_read_b128 a[204:207],v245 offset:37120
v_add_f32 v231,v234,v229
M v[100:103],v[216:219],a[208:211],v[100:103]
s_add_u32 s34,s32,196608
buffer_store_dwordx4 a[36:39],v248,s[24:27],s34 offen offset:512 nt
M v[104:107],v[216:219],a[212:215],v[104:107]
buffer_load_dwordx4 a[144:147],v247,s[20:23],s47 offen offset:2048 sc1
M v[108:111],v[216:219],a[216:219],v[108:111]
v_sub_f32 v234,v234,v229
v_add_f32 v229,v54,v150
M v[112:115],v[216:219],a[220:223],v[112:115]
s_add_u32 s47,s80,3072
v_sub_f32 v150,v54,v150
v_add_f32 v54,v231,v229
M v[116:119],v[216:219],a[192:195],v[116:119]
v_fmac_f32 v231,4.0,v229
v_fma_f32 v229,2.0,v150,v234
M v[120:123],v[216:219],a[196:199],v[120:123]
s_waitcnt lgkmcnt(1)
v_fma_f32 v150,s40,v150,v234
v_accvgpr_read_b32 v234,a55
M v[124:127],v[216:219],a[200:203],v[124:127]
s_waitcnt vmcnt(26)
v_accvgpr_read_b32 v233,a151
v_add_f32 v232,v234,v233
M v[96:99],v[220:223],a[208:211],v[96:99]
ds_read_b128 a[208:211],v245 offset:52224
v_sub_f32 v234,v234,v233
M v[100:103],v[220:223],a[212:215],v[100:103]
ds_read_b128 a[212:215],v246 offset:52480
v_add_f32 v233,v55,v151
M v[104:107],v[220:223],a[216:219],v[104:107]
buffer_load_dwordx4 a[128:131],v247,s[20:23],s47 offen offset:0 sc1
M v[108:111],v[220:223],a[220:223],v[108:111]
ds_read_b128 a[216:219],v246 offset:52736
ds_read_b128 a[220:223],v246 offset:52992
M v[112:115],v[220:223],a[192:195],v[112:115]
ds_read_b128 a[192:195],v246 offset:53248
v_sub_f32 v151,v55,v151
M v[116:119],v[220:223],a[196:199],v[116:119]
ds_read_b128 a[196:199],v246 offset:53504
v_add_f32 v55,v232,v233
M v[120:123],v[220:223],a[200:203],v[120:123]
s_waitcnt lgkmcnt(6)
ds_read_b128 a[200:203],v246 offset:53760
v_fmac_f32 v232,4.0,v233
M v[124:127],v[220:223],a[204:207],v[124:127]
s_waitcnt vmcnt(26) lgkmcnt(6)
ds_read_b128 a[204:207],v246 offset:54016
v_fma_f32 v233,2.0,v151,v234
M v[96:99],a[132:135],a[208:211],v[96:99]
s_waitcnt lgkmcnt(6)
ds_read_b128 a[208:211],v246 offset:54272
v_fma_f32 v151,s40,v151,v234
M v[100:103],a[132:135],a[212:215],v[100:103]
s_waitcnt lgkmcnt(6)
v_cvt_pk_bf16_f32 v229,v229,v233
v_cvt_pk_bf16_f32 v231,v231,v232
M v[104:107],a[132:135],a[216:219],v[104:107]
s_waitcnt lgkmcnt(5)
buffer_load_dwordx4 a[252:255],v247,s[20:23],s47 offen offset:1024 sc1
M v[108:111],a[132:135],a[220:223],v[108:111]
s_waitcnt lgkmcnt(4)
ds_write2st64_b64 v249,v[228:229],v[230:231] offset0:93 offset1:97
M v[112:115],a[132:135],a[192:195],v[112:115]
s_waitcnt lgkmcnt(4)
v_accvgpr_read_b32 v234,a56
v_accvgpr_read_b32 v228,a152
M v[116:119],a[132:135],a[196:199],v[116:119]
s_waitcnt lgkmcnt(3)
v_add_f32 v230,v234,v228
v_sub_f32 v234,v234,v228
M v[120:123],a[132:135],a[200:203],v[120:123]
s_waitcnt lgkmcnt(2)
v_add_f32 v228,v56,v152
v_sub_f32 v152,v56,v152
M v[124:127],a[132:135],a[204:207],v[124:127]
s_waitcnt vmcnt(25)
s_add_u32 s34,s32,393216
buffer_store_dwordx4 a[40:43],v248,s[24:27],s34 offen offset:512 nt
M v[96:99],a[100:103],a[212:215],v[96:99]
s_waitcnt lgkmcnt(0)
s_barrier
ds_read_b128 v[0:3],v247 offset:60928
M v[100:103],a[100:103],a[216:219],v[100:103]
ds_read_b128 v[8:11],v247 offset:65024
ds_read_b128 v[16:19],v247 offset:34816
M v[104:107],a[100:103],a[220:223],v[104:107]
ds_read_b128 v[24:27],v247 offset:38912
ds_read_b128 a[48:51],v247 offset:43520
M v[108:111],a[100:103],a[192:195],v[108:111]
ds_read_b128 a[52:55],v247 offset:47616
ds_read_b128 a[212:215],v245 offset:54528
M v[112:115],a[100:103],a[196:199],v[112:115]
buffer_load_dwordx4 a[224:227],v247,s[20:23],s47 offen offset:2048 sc1
M v[116:119],a[100:103],a[200:203],v[116:119]
s_add_u32 s47,s81,3072
v_add_u32 v245,0xffffbc00,v245
v_add_u32 v246,0xffffbc00,v246
M v[120:123],a[100:103],a[204:207],v[120:123]
v_add_f32 v56,v230,v228
v_fmac_f32 v230,4.0,v228
M v[124:127],a[100:103],a[208:211],v[124:127]
s_waitcnt vmcnt(26)
v_fma_f32 v228,2.0,v152,v234
v_fma_f32 v152,s40,v152,v234
M v[96:99],a[116:119],a[216:219],v[96:99]
ds_read_b128 a[216:219],v245 offset:0
v_accvgpr_read_b32 v234,a57
M v[100:103],a[116:119],a[220:223],v[100:103]
ds_read_b128 a[220:223],v246 offset:256
v_accvgpr_read_b32 v233,a153
M v[104:107],a[116:119],a[192:195],v[104:107]
buffer_load_dwordx4 a[112:115],v247,s[20:23],s47 offen offset:0 sc1
M v[108:111],a[116:119],a[196:199],v[108:111]
ds_read_b128 a[192:195],v246 offset:512
ds_read_b128 a[196:199],v246 offset:768
M v[112:115],a[116:119],a[200:203],v[112:115]
ds_read_b128 a[200:203],v246 offset:1024
v_add_f32 v232,v234,v233
M v[116:119],a[116:119],a[204:207],v[116:119]
ds_read_b128 a[204:207],v246 offset:1280
v_sub_f32 v234,v234,v233
M v[120:123],a[116:119],a[208:211],v[120:123]
s_waitcnt lgkmcnt(6)
ds_read_b128 a[208:211],v246 offset:1536
v_add_f32 v233,v57,v153
M v[124:127],a[116:119],a[212:215],v[124:127]
s_waitcnt vmcnt(26) lgkmcnt(6)
ds_read_b128 a[212:215],v246 offset:1792
v_sub_f32 v153,v57,v153
M v[96:99],v[224:227],a[216:219],v[96:99]
s_waitcnt lgkmcnt(6)
ds_read_b128 a[216:219],v246 offset:2048
v_add_f32 v57,v232,v233
M v[100:103],v[224:227],a[220:223],v[100:103]
s_waitcnt lgkmcnt(6)
v_fmac_f32 v232,4.0,v233
v_fma_f32 v233,2.0,v153,v234
M v[104:107],v[224:227],a[192:195],v[104:107]
s_waitcnt lgkmcnt(5)
buffer_load_dwordx4 v[216:219],v247,s[20:23],s47 offen offset:1024 sc1
M v[108:111],v[224:227],a[196:199],v[108:111]
s_waitcnt lgkmcnt(4)
v_fma_f32 v153,s40,v153,v234
v_cvt_pk_bf16_f32 v228,v228,v233
M v[112:115],v[224:227],a[200:203],v[112:115]
s_waitcnt lgkmcnt(3)
s_add_u32 s34,s32,589824
buffer_store_dwordx4 a[44:47],v248,s[24:27],s34 offen offset:512 nt
M v[116:119],v[224:227],a[204:207],v[116:119]
s_waitcnt lgkmcnt(2)
v_cvt_pk_bf16_f32 v230,v230,v232
v_accvgpr_read_b32 v234,a58
M v[120:123],v[224:227],a[208:211],v[120:123]
s_waitcnt lgkmcnt(1)
v_accvgpr_read_b32 v229,a154
v_add_f32 v231,v234,v229
M v[124:127],v[224:227],a[212:215],v[124:127]
s_waitcnt vmcnt(26)
v_sub_f32 v234,v234,v229
v_add_f32 v229,v58,v154
M v[96:99],a[228:231],a[220:223],v[96:99]
ds_read_b128 a[220:223],v245 offset:2304
v_sub_f32 v154,v58,v154
M v[100:103],a[228:231],a[192:195],v[100:103]
v_add_f32 v58,v231,v229
v_fmac_f32 v231,4.0,v229
M v[104:107],a[228:231],a[196:199],v[104:107]
buffer_load_dwordx4 a[148:151],v247,s[20:23],s47 offen offset:2048 sc1
M v[108:111],a[228:231],a[200:203],v[108:111]
v_fma_f32 v229,2.0,v154,v234
v_fma_f32 v154,s40,v154,v234
M v[112:115],a[228:231],a[204:207],v[112:115]
s_add_u32 s47,s76,49152
v_accvgpr_read_b32 v234,a59
v_accvgpr_read_b32 v233,a155
M v[116:119],a[228:231],a[208:211],v[116:119]
v_add_u32 v245,0xfffece00,v245
v_add_u32 v246,0xfffece00,v246
M v[120:123],a[228:231],a[212:215],v[120:123]
s_waitcnt lgkmcnt(1)
v_add_f32 v232,v234,v233
v_sub_f32 v234,v234,v233
M v[124:127],a[228:231],a[216:219],v[124:127]
s_waitcnt vmcnt(26)
v_add_f32 v233,v59,v155
v_sub_f32 v155,v59,v155
M v[96:99],a[232:235],a[192:195],v[96:99]
ds_read_b128 a[192:195],v245 offset:0
v_add_f32 v59,v232,v233
M v[100:103],a[232:235],a[196:199],v[100:103]
ds_read_b128 a[196:199],v246 offset:256
v_fmac_f32 v232,4.0,v233
M v[104:107],a[232:235],a[200:203],v[104:107]
buffer_load_dwordx4 v[220:223],v247,s[20:23],s47 offen offset:0 sc1
M v[108:111],a[232:235],a[204:207],v[108:111]
ds_read_b128 a[200:203],v246 offset:512
ds_read_b128 a[204:207],v246 offset:768
M v[112:115],a[232:235],a[208:211],v[112:115]
ds_read_b128 a[208:211],v246 offset:1024
v_fma_f32 v233,2.0,v155,v234
M v[116:119],a[232:235],a[212:215],v[116:119]
ds_read_b128 a[212:215],v246 offset:1280
v_fma_f32 v155,s40,v155,v234
M v[120:123],a[232:235],a[216:219],v[120:123]
s_waitcnt lgkmcnt(6)
ds_read_b128 a[216:219],v246 offset:1536
v_cvt_pk_bf16_f32 v229,v229,v233
M v[124:127],a[232:235],a[220:223],v[124:127]
s_waitcnt vmcnt(26) lgkmcnt(6)
ds_read_b128 a[220:223],v246 offset:1792
v_cvt_pk_bf16_f32 v231,v231,v232
M v[32:35],a[136:139],a[192:195],v[32:35]
s_waitcnt lgkmcnt(6)
ds_write2st64_b64 v249,v[228:229],v[230:231] offset0:34 offset1:38
M v[36:39],a[136:139],a[196:199],v[36:39]
s_waitcnt lgkmcnt(6)
ds_read_b128 a[192:195],v246 offset:2048
v_accvgpr_read_b32 v204,a60
M v[40:43],a[136:139],a[200:203],v[40:43]
s_waitcnt lgkmcnt(6)
s_add_u32 s34,s33,0
buffer_load_dwordx4 a[132:135],v247,s[20:23],s47 offen offset:1024 sc1
M v[44:47],a[136:139],a[204:207],v[44:47]
s_waitcnt lgkmcnt(5)
v_accvgpr_read_b32 v208,a156
v_accvgpr_read_b32 v205,a61
M v[48:51],a[136:139],a[208:211],v[48:51]
s_waitcnt lgkmcnt(4)
buffer_store_dwordx4 v[0:3],v248,s[24:27],s34 offen offset:0 nt
v_accvgpr_read_b32 v209,a157
v_accvgpr_read_b32 v206,a62
v_accvgpr_read_b32 v210,a158
v_accvgpr_read_b32 v207,a63
v_accvgpr_read_b32 v211,a159
v_pk_add_f32 v[212:213],v[204:205],v[208:209]
v_pk_add_f32 v[214:215],v[206:207],v[210:211]
v_pk_add_f32 v[204:205],v[204:205],v[208:209] neg_lo:[0,1] neg_hi:[0,1]
v_pk_add_f32 v[206:207],v[206:207],v[210:211] neg_lo:[0,1] neg_hi:[0,1]
v_pk_add_f32 v[208:209],v[60:61],v[156:157]
v_pk_add_f32 v[210:211],v[62:63],v[158:159]
v_pk_add_f32 v[156:157],v[60:61],v[156:157] neg_lo:[0,1] neg_hi:[0,1]
v_pk_add_f32 v[158:159],v[62:63],v[158:159] neg_lo:[0,1] neg_hi:[0,1]
v_pk_add_f32 v[60:61],v[212:213],v[208:209]
v_pk_add_f32 v[62:63],v[214:215],v[210:211]
v_pk_fma_f32 v[212:213],v[208:209],4.0,v[212:213] op_sel_hi:[1,0,1]
v_pk_fma_f32 v[214:215],v[210:211],4.0,v[214:215] op_sel_hi:[1,0,1]
v_pk_fma_f32 v[208:209],v[156:157],2.0,v[204:205] op_sel_hi:[1,0,1]
v_pk_fma_f32 v[210:211],v[158:159],2.0,v[206:207] op_sel_hi:[1,0,1]
v_pk_fma_f32 v[156:157],v[156:157],s[40:41],v[204:205] op_sel_hi:[1,0,1]
v_pk_fma_f32 v[158:159],v[158:159],s[40:41],v[206:207] op_sel_hi:[1,0,1]
M v[52:55],a[136:139],a[212:215],v[52:55]
s_waitcnt lgkmcnt(3)
v_cvt_pk_bf16_f32 v208,v208,v209
v_cvt_pk_bf16_f32 v209,v210,v211
M v[56:59],a[136:139],a[216:219],v[56:59]
s_waitcnt lgkmcnt(2)
v_cvt_pk_bf16_f32 v212,v212,v213
v_cvt_pk_bf16_f32 v213,v214,v215
M v[60:63],a[136:139],a[220:223],v[60:63]
s_waitcnt vmcnt(26)
ds_write2st64_b64 v249,v[208:209],v[212:213] offset0:42 offset1:46
M v[32:35],a[236:239],a[196:199],v[32:35]
ds_read_b128 a[196:199],v245 offset:2304
v_cvt_pk_bf16_f32 v96,v96,v97
M v[36:39],a[236:239],a[200:203],v[36:39]
v_cvt_pk_bf16_f32 v97,v98,v99
v_cvt_pk_bf16_f32 v100,v100,v101
M v[40:43],a[236:239],a[204:207],v[40:43]
buffer_load_dwordx4 a[100:103],v247,s[20:23],s47 offen offset:2048 sc1
M v[44:47],a[236:239],a[208:211],v[44:47]
v_cvt_pk_bf16_f32 v101,v102,v103
M v[48:51],a[236:239],a[212:215],v[48:51]
s_add_u32 s47,s77,49152
ds_write2st64_b64 v249,v[96:97],v[100:101] offset0:51 offset1:55
M v[52:55],a[236:239],a[216:219],v[52:55]
v_add_u32 v245,0x15400,v245
v_add_u32 v246,0x15400,v246
M v[56:59],a[236:239],a[220:223],v[56:59]
s_waitcnt lgkmcnt(3)
v_cvt_pk_bf16_f32 v104,v104,v105
v_cvt_pk_bf16_f32 v105,v106,v107
M v[60:63],a[236:239],a[192:195],v[60:63]
s_waitcnt vmcnt(25)
v_cvt_pk_bf16_f32 v108,v108,v109
v_cvt_pk_bf16_f32 v109,v110,v111
M v[32:35],a[140:143],a[200:203],v[32:35]
ds_read_b128 a[200:203],v245 offset:0
ds_write2st64_b64 v249,v[104:105],v[108:109] offset0:59 offset1:63
M v[36:39],a[140:143],a[204:207],v[36:39]
ds_read_b128 a[204:207],v246 offset:256
v_cvt_pk_bf16_f32 v112,v112,v113
M v[40:43],a[140:143],a[208:211],v[40:43]
buffer_load_dwordx4 a[116:119],v247,s[20:23],s47 offen offset:0 sc1
M v[44:47],a[140:143],a[212:215],v[44:47]
ds_read_b128 a[208:211],v246 offset:512
ds_read_b128 a[212:215],v246 offset:768
M v[48:51],a[140:143],a[216:219],v[48:51]
ds_read_b128 a[216:219],v246 offset:1024
v_cvt_pk_bf16_f32 v113,v114,v115
M v[52:55],a[140:143],a[220:223],v[52:55]
ds_read_b128 a[220:223],v246 offset:1280
v_cvt_pk_bf16_f32 v116,v116,v117
M v[56:59],a[140:143],a[192:195],v[56:59]
s_waitcnt lgkmcnt(8)
ds_read_b128 a[192:195],v246 offset:1536
v_cvt_pk_bf16_f32 v117,v118,v119
M v[60:63],a[140:143],a[196:199],v[60:63]
s_waitcnt vmcnt(24) lgkmcnt(7)
s_add_u32 s34,s33,393216
buffer_store_dwordx4 v[8:11],v248,s[24:27],s34 offen offset:0 nt
M v[32:35],a[104:107],a[200:203],v[32:35]
s_waitcnt lgkmcnt(5)
ds_read_b128 a[196:199],v246 offset:1792
ds_read_b128 a[200:203],v246 offset:2048
M v[36:39],a[104:107],a[204:207],v[36:39]
s_waitcnt lgkmcnt(6)
ds_write2st64_b64 v249,v[112:113],v[116:117] offset0:102 offset1:106
M v[40:43],a[104:107],a[208:211],v[40:43]
s_waitcnt lgkmcnt(6)
buffer_load_dwordx4 v[224:227],v247,s[20:23],s47 offen offset:1024 sc1
M v[44:47],a[104:107],a[212:215],v[44:47]
s_waitcnt lgkmcnt(5)
v_cvt_pk_bf16_f32 v120,v120,v121
v_cvt_pk_bf16_f32 v121,v122,v123
M v[48:51],a[104:107],a[216:219],v[48:51]
s_waitcnt lgkmcnt(4)
v_cvt_pk_bf16_f32 v124,v124,v125
v_cvt_pk_bf16_f32 v125,v126,v127
M v[52:55],a[104:107],a[220:223],v[52:55]
s_waitcnt lgkmcnt(3)
ds_write2st64_b64 v249,v[120:121],v[124:125] offset0:110 offset1:114
M v[56:59],a[104:107],a[192:195],v[56:59]
s_waitcnt lgkmcnt(3)
v_accvgpr_read_b32 v234,a64
v_accvgpr_read_b32 v228,a160
M v[60:63],a[104:107],a[196:199],v[60:63]
s_waitcnt vmcnt(25)
v_add_f32 v230,v234,v228
v_sub_f32 v234,v234,v228
M v[32:35],a[120:123],a[204:207],v[32:35]
ds_read_b128 a[204:207],v245 offset:2304
v_add_f32 v228,v64,v160
M v[36:39],a[120:123],a[208:211],v[36:39]
v_sub_f32 v160,v64,v160
M v[40:43],a[120:123],a[212:215],v[40:43]
s_waitcnt lgkmcnt(1)
s_barrier
ds_read_b128 a[56:59],v247 offset:17408
M v[44:47],a[120:123],a[216:219],v[44:47]
ds_read_b128 a[60:63],v247 offset:21504
ds_read_b128 v[96:99],v247 offset:26112
M v[48:51],a[120:123],a[220:223],v[48:51]
ds_read_b128 v[104:107],v247 offset:30208
ds_read_b128 v[112:115],v247 offset:52224
M v[52:55],a[120:123],a[192:195],v[52:55]
ds_read_b128 v[120:123],v247 offset:56320
v_add_f32 v64,v230,v228
M v[56:59],a[120:123],a[196:199],v[56:59]
buffer_load_dwordx4 a[152:155],v247,s[20:23],s47 offen offset:2048 sc1
M v[60:63],a[120:123],a[200:203],v[60:63]
s_waitcnt vmcnt(25)
s_add_u32 s47,s78,49152
v_fmac_f32 v230,4.0,v228
v_fma_f32 v228,2.0,v160,v234
M v[32:35],a[124:127],a[208:211],v[32:35]
ds_read_b128 a[208:211],v245 offset:17408
v_fma_f32 v160,s40,v160,v234
M v[36:39],a[124:127],a[212:215],v[36:39]
ds_read_b128 a[212:215],v246 offset:17664
v_accvgpr_read_b32 v234,a65
M v[40:43],a[124:127],a[216:219],v[40:43]
buffer_load_dwordx4 a[228:231],v247,s[20:23],s47 offen offset:0 sc1
M v[44:47],a[124:127],a[220:223],v[44:47]
ds_read_b128 a[216:219],v246 offset:17920
ds_read_b128 a[220:223],v246 offset:18176
M v[48:51],a[124:127],a[192:195],v[48:51]
ds_read_b128 a[192:195],v246 offset:18432
v_accvgpr_read_b32 v233,a161
M v[52:55],a[124:127],a[196:199],v[52:55]
s_add_u32 s34,s33,786432
buffer_store_dwordx4 v[16:19],v248,s[24:27],s34 offen offset:0 nt
M v[56:59],a[124:127],a[200:203],v[56:59]
s_waitcnt lgkmcnt(11)
ds_read_b128 a[196:199],v246 offset:18688
ds_read_b128 a[200:203],v246 offset:18944
M v[60:63],a[124:127],a[204:207],v[60:63]
s_waitcnt vmcnt(25) lgkmcnt(6)
ds_read_b128 a[204:207],v246 offset:19200
v_add_f32 v232,v234,v233
M v[32:35],a[240:243],a[208:211],v[32:35]
s_waitcnt lgkmcnt(6)
ds_read_b128 a[208:211],v246 offset:19456
v_sub_f32 v234,v234,v233
M v[36:39],a[240:243],a[212:215],v[36:39]
s_waitcnt lgkmcnt(6)
v_add_f32 v233,v65,v161
v_sub_f32 v161,v65,v161
M v[40:43],a[240:243],a[216:219],v[40:43]
s_waitcnt lgkmcnt(5)
buffer_load_dwordx4 a[232:235],v247,s[20:23],s47 offen offset:1024 sc1
M v[44:47],a[240:243],a[220:223],v[44:47]
s_waitcnt lgkmcnt(4)
v_add_f32 v65,v232,v233
v_fmac_f32 v232,4.0,v233
M v[48:51],a[240:243],a[192:195],v[48:51]
s_waitcnt lgkmcnt(3)
v_fma_f32 v233,2.0,v161,v234
v_fma_f32 v161,s40,v161,v234
M v[52:55],a[240:243],a[196:199],v[52:55]
s_waitcnt lgkmcnt(2)
v_cvt_pk_bf16_f32 v228,v228,v233
v_cvt_pk_bf16_f32 v230,v230,v232
M v[56:59],a[240:243],a[200:203],v[56:59]
s_waitcnt lgkmcnt(1)
v_accvgpr_read_b32 v234,a66
v_accvgpr_read_b32 v229,a162
M v[60:63],a[240:243],a[204:207],v[60:63]
s_waitcnt vmcnt(25)
v_add_f32 v231,v234,v229
v_sub_f32 v234,v234,v229
M v[32:35],a[244:247],a[212:215],v[32:35]
ds_read_b128 a[212:215],v245 offset:19712
v_add_f32 v229,v66,v162
M v[36:39],a[244:247],a[216:219],v[36:39]
v_sub_f32 v162,v66,v162
v_add_f32 v66,v231,v229
M v[40:43],a[244:247],a[220:223],v[40:43]
buffer_load_dwordx4 a[156:159],v247,s[20:23],s47 offen offset:2048 sc1
M v[44:47],a[244:247],a[192:195],v[44:47]
v_fmac_f32 v231,4.0,v229
v_fma_f32 v229,2.0,v162,v234
M v[48:51],a[244:247],a[196:199],v[48:51]
s_add_u32 s47,s79,49152
v_fma_f32 v162,s40,v162,v234
v_accvgpr_read_b32 v234,a67
M v[52:55],a[244:247],a[200:203],v[52:55]
v_accvgpr_read_b32 v233,a163
v_add_f32 v232,v234,v233
M v[56:59],a[244:247],a[204:207],v[56:59]
s_waitcnt lgkmcnt(1)
v_sub_f32 v234,v234,v233
v_add_f32 v233,v67,v163
M v[60:63],a[244:247],a[208:211],v[60:63]
s_waitcnt vmcnt(25)
v_sub_f32 v163,v67,v163
v_add_f32 v67,v232,v233
M v[32:35],a[108:111],a[216:219],v[32:35]
ds_read_b128 a[216:219],v245 offset:34816
v_fmac_f32 v232,4.0,v233
M v[36:39],a[108:111],a[220:223],v[36:39]
ds_read_b128 a[220:223],v246 offset:35072
v_fma_f32 v233,2.0,v163,v234
M v[40:43],a[108:111],a[192:195],v[40:43]
s_add_u32 s34,s33,1179648
buffer_load_dwordx4 a[136:139],v247,s[20:23],s47 offen offset:0 sc1
M v[44:47],a[108:111],a[196:199],v[44:47]
ds_read_b128 a[192:195],v246 offset:35328
ds_read_b128 a[196:199],v246 offset:35584
M v[48:51],a[108:111],a[200:203],v[48:51]
buffer_store_dwordx4 v[24:27],v248,s[24:27],s34 offen offset:0 nt
M v[52:55],a[108:111],a[204:207],v[52:55]
ds_read_b128 a[200:203],v246 offset:35840
ds_read_b128 a[204:207],v246 offset:36096
M v[56:59],a[108:111],a[208:211],v[56:59]
s_waitcnt lgkmcnt(6)
ds_read_b128 a[208:211],v246 offset:36352
v_fma_f32 v163,s40,v163,v234
M v[60:63],a[108:111],a[212:215],v[60:63]
s_waitcnt vmcnt(25) lgkmcnt(6)
ds_read_b128 a[212:215],v246 offset:36608
v_cvt_pk_bf16_f32 v229,v229,v233
M v[32:35],a[248:251],a[216:219],v[32:35]
s_waitcnt lgkmcnt(6)
ds_read_b128 a[216:219],v246 offset:36864
v_cvt_pk_bf16_f32 v231,v231,v232
M v[36:39],a[248:251],a[220:223],v[36:39]
s_waitcnt lgkmcnt(6)
ds_write2st64_b64 v249,v[228:229],v[230:231] offset0:119 offset1:123
M v[40:43],a[248:251],a[192:195],v[40:43]
s_waitcnt lgkmcnt(6)
buffer_load_dwordx4 a[236:239],v247,s[20:23],s47 offen offset:1024 sc1
M v[44:47],a[248:251],a[196:199],v[44:47]
s_waitcnt lgkmcnt(5)
v_accvgpr_read_b32 v234,a68
v_accvgpr_read_b32 v228,a164
M v[48:51],a[248:251],a[200:203],v[48:51]
s_waitcnt lgkmcnt(4)
v_add_f32 v230,v234,v228
v_sub_f32 v234,v234,v228
M v[52:55],a[248:251],a[204:207],v[52:55]
s_waitcnt lgkmcnt(3)
v_add_f32 v228,v68,v164
v_sub_f32 v164,v68,v164
M v[56:59],a[248:251],a[208:211],v[56:59]
s_waitcnt lgkmcnt(2)
v_add_f32 v68,v230,v228
v_fmac_f32 v230,4.0,v228
M v[60:63],a[248:251],a[212:215],v[60:63]
s_waitcnt vmcnt(25)
v_fma_f32 v228,2.0,v164,v234
v_fma_f32 v164,s40,v164,v234
M v[32:35],a[96:99],a[220:223],v[32:35]
ds_read_b128 a[220:223],v245 offset:37120
v_accvgpr_read_b32 v234,a69
M v[36:39],a[96:99],a[192:195],v[36:39]
v_accvgpr_read_b32 v233,a165
v_add_f32 v232,v234,v233
M v[40:43],a[96:99],a[196:199],v[40:43]
buffer_load_dwordx4 a[140:143],v247,s[20:23],s47 offen offset:2048 sc1
M v[44:47],a[96:99],a[200:203],v[44:47]
v_sub_f32 v234,v234,v233
v_add_f32 v233,v69,v165
M v[48:51],a[96:99],a[204:207],v[48:51]
s_add_u32 s47,s80,49152
v_sub_f32 v165,v69,v165
v_add_f32 v69,v232,v233
M v[52:55],a[96:99],a[208:211],v[52:55]
v_fmac_f32 v232,4.0,v233
v_fma_f32 v233,2.0,v165,v234
M v[56:59],a[96:99],a[212:215],v[56:59]
s_waitcnt lgkmcnt(2)
v_fma_f32 v165,s40,v165,v234
v_cvt_pk_bf16_f32 v228,v228,v233
M v[60:63],a[96:99],a[216:219],v[60:63]
s_waitcnt vmcnt(24)
v_cvt_pk_bf16_f32 v230,v230,v232
v_accvgpr_read_b32 v234,a70
M v[32:35],a[144:147],a[192:195],v[32:35]
s_add_u32 s34,s32,786432
buffer_store_dwordx4 a[48:51],v248,s[24:27],s34 offen offset:512 nt
M v[36:39],a[144:147],a[196:199],v[36:39]
ds_read_b128 a[192:195],v245 offset:52224
ds_read_b128 a[196:199],v246 offset:52480
M v[40:43],a[144:147],a[200:203],v[40:43]
buffer_load_dwordx4 a[104:107],v247,s[20:23],s47 offen offset:0 sc1
M v[44:47],a[144:147],a[204:207],v[44:47]
ds_read_b128 a[200:203],v246 offset:52736
ds_read_b128 a[204:207],v246 offset:52992
M v[48:51],a[144:147],a[208:211],v[48:51]
ds_read_b128 a[208:211],v246 offset:53248
v_accvgpr_read_b32 v229,a166
M v[52:55],a[144:147],a[212:215],v[52:55]
ds_read_b128 a[212:215],v246 offset:53504
v_add_f32 v231,v234,v229
M v[56:59],a[144:147],a[216:219],v[56:59]
s_waitcnt lgkmcnt(6)
ds_read_b128 a[216:219],v246 offset:53760
v_sub_f32 v234,v234,v229
M v[60:63],a[144:147],a[220:223],v[60:63]
s_waitcnt vmcnt(25) lgkmcnt(6)
ds_read_b128 a[220:223],v246 offset:54016
v_add_f32 v229,v70,v166
M v[32:35],a[128:131],a[192:195],v[32:35]
s_waitcnt lgkmcnt(6)
ds_read_b128 a[192:195],v246 offset:54272
v_sub_f32 v166,v70,v166
M v[36:39],a[128:131],a[196:199],v[36:39]
s_waitcnt lgkmcnt(6)
v_add_f32 v70,v231,v229
v_fmac_f32 v231,4.0,v229
M v[40:43],a[128:131],a[200:203],v[40:43]
s_waitcnt lgkmcnt(5)
buffer_load_dwordx4 a[120:123],v247,s[20:23],s47 offen offset:1024 sc1
M v[44:47],a[128:131],a[204:207],v[44:47]
s_waitcnt lgkmcnt(4)
v_fma_f32 v229,2.0,v166,v234
v_fma_f32 v166,s40,v166,v234
M v[48:51],a[128:131],a[208:211],v[48:51]
s_waitcnt lgkmcnt(3)
v_accvgpr_read_b32 v234,a71
v_accvgpr_read_b32 v233,a167
M v[52:55],a[128:131],a[212:215],v[52:55]
s_waitcnt lgkmcnt(2)
v_add_f32 v232,v234,v233
v_sub_f32 v234,v234,v233
M v[56:59],a[128:131],a[216:219],v[56:59]
s_waitcnt lgkmcnt(1)
v_add_f32 v233,v71,v167
v_sub_f32 v167,v71,v167
M v[60:63],a[128:131],a[220:223],v[60:63]
s_waitcnt vmcnt(25)
v_add_f32 v71,v232,v233
v_fmac_f32 v232,4.0,v233
M v[32:35],a[252:255],a[196:199],v[32:35]
ds_read_b128 a[196:199],v245 offset:54528
v_fma_f32 v233,2.0,v167,v234
M v[36:39],a[252:255],a[200:203],v[36:39]
v_fma_f32 v167,s40,v167,v234
v_cvt_pk_bf16_f32 v229,v229,v233
M v[40:43],a[252:255],a[204:207],v[40:43]
buffer_load_dwordx4 a[124:127],v247,s[20:23],s47 offen offset:2048 sc1
M v[44:47],a[252:255],a[208:211],v[44:47]
v_cvt_pk_bf16_f32 v231,v231,v232
v_add_u32 v4,69632,v247
M v[48:51],a[252:255],a[212:215],v[48:51]
s_add_u32 s47,s81,49152
ds_write2st64_b64 v249,v[228:229],v[230:231] offset0:127 offset1:131
M v[52:55],a[252:255],a[216:219],v[52:55]
s_add_u32 s34,s32,983040
buffer_store_dwordx4 a[52:55],v248,s[24:27],s34 offen offset:512 nt
M v[56:59],a[252:255],a[220:223],v[56:59]
s_waitcnt lgkmcnt(2)
v_add_u32 v245,0xfffece00,v245
v_add_u32 v246,0xfffece00,v246
M v[60:63],a[252:255],a[192:195],v[60:63]
s_waitcnt vmcnt(25)
v_accvgpr_read_b32 v234,a72
v_accvgpr_read_b32 v228,a168
M v[32:35],a[224:227],a[200:203],v[32:35]
ds_read_b128 a[200:203],v245 offset:60928
v_add_f32 v230,v234,v228
M v[36:39],a[224:227],a[204:207],v[36:39]
ds_read_b128 a[204:207],v246 offset:61184
v_sub_f32 v234,v234,v228
M v[40:43],a[224:227],a[208:211],v[40:43]
buffer_load_dwordx4 a[240:243],v247,s[20:23],s47 offen offset:0 sc1
M v[44:47],a[224:227],a[212:215],v[44:47]
ds_read_b128 a[208:211],v246 offset:61440
ds_read_b128 a[212:215],v246 offset:61696
M v[48:51],a[224:227],a[216:219],v[48:51]
ds_read_b128 a[216:219],v246 offset:61952
v_add_f32 v228,v72,v168
M v[52:55],a[224:227],a[220:223],v[52:55]
ds_read_b128 a[220:223],v246 offset:62208
v_sub_f32 v168,v72,v168
M v[56:59],a[224:227],a[192:195],v[56:59]
s_waitcnt lgkmcnt(7)
ds_read_b128 a[192:195],v246 offset:62464
v_add_f32 v72,v230,v228
M v[60:63],a[224:227],a[196:199],v[60:63]
s_waitcnt vmcnt(25) lgkmcnt(6)
ds_read_b128 a[196:199],v246 offset:62720
v_fmac_f32 v230,4.0,v228
M v[32:35],a[112:115],a[200:203],v[32:35]
s_waitcnt lgkmcnt(6)
ds_read_b128 a[200:203],v246 offset:62976
v_fma_f32 v228,2.0,v168,v234
M v[36:39],a[112:115],a[204:207],v[36:39]
s_waitcnt lgkmcnt(6)
v_fma_f32 v168,s40,v168,v234
v_accvgpr_read_b32 v234,a73
M v[40:43],a[112:115],a[208:211],v[40:43]
s_waitcnt lgkmcnt(5)
buffer_load_dwordx4 a[160:163],v247,s[20:23],s47 offen offset:1024 sc1
M v[44:47],a[112:115],a[212:215],v[44:47]
s_waitcnt lgkmcnt(4)
v_accvgpr_read_b32 v233,a169
v_add_f32 v232,v234,v233
M v[48:51],a[112:115],a[216:219],v[48:51]
s_waitcnt lgkmcnt(3)
v_sub_f32 v234,v234,v233
v_add_f32 v233,v73,v169
M v[52:55],a[112:115],a[220:223],v[52:55]
s_waitcnt lgkmcnt(2)
v_sub_f32 v169,v73,v169
v_add_f32 v73,v232,v233
M v[56:59],a[112:115],a[192:195],v[56:59]
s_waitcnt lgkmcnt(1)
v_fmac_f32 v232,4.0,v233
v_fma_f32 v233,2.0,v169,v234
M v[60:63],a[112:115],a[196:199],v[60:63]
s_waitcnt vmcnt(25)
v_fma_f32 v169,s40,v169,v234
v_cvt_pk_bf16_f32 v228,v228,v233
M v[32:35],v[216:219],a[204:207],v[32:35]
ds_read_b128 a[204:207],v245 offset:63232
v_cvt_pk_bf16_f32 v230,v230,v232
M v[36:39],v[216:219],a[208:211],v[36:39]
v_accvgpr_read_b32 v234,a74
v_accvgpr_read_b32 v229,a170
M v[40:43],v[216:219],a[212:215],v[40:43]
buffer_load_dwordx4 a[244:247],v247,s[20:23],s47 offen offset:2048 sc1
M v[44:47],v[216:219],a[216:219],v[44:47]
s_add_u32 s34,s32,1179648
v_add_f32 v231,v234,v229
v_sub_f32 v234,v234,v229
M v[48:51],v[216:219],a[220:223],v[48:51]
s_add_u32 s48,s76,6144
buffer_store_dwordx4 a[56:59],v248,s[24:27],s34 offen offset:512 nt
M v[52:55],v[216:219],a[192:195],v[52:55]
v_add_f32 v229,v74,v170
v_sub_f32 v170,v74,v170
M v[56:59],v[216:219],a[196:199],v[56:59]
s_waitcnt lgkmcnt(1)
v_add_f32 v74,v231,v229
v_fmac_f32 v231,4.0,v229
M v[60:63],v[216:219],a[200:203],v[60:63]
s_waitcnt vmcnt(25)
v_fma_f32 v229,2.0,v170,v234
v_fma_f32 v170,s40,v170,v234
M v[32:35],a[148:151],a[208:211],v[32:35]
ds_read_b128 a[208:211],v245 offset:0
v_accvgpr_read_b32 v234,a75
M v[36:39],a[148:151],a[212:215],v[36:39]
ds_read_b128 a[212:215],v246 offset:256
v_accvgpr_read_b32 v233,a171
M v[40:43],a[148:151],a[216:219],v[40:43]
buffer_load_dwordx4 a[108:111],v247,s[20:23],s48 offen offset:0 sc1
M v[44:47],a[148:151],a[220:223],v[44:47]
ds_read_b128 a[216:219],v246 offset:512
ds_read_b128 a[220:223],v246 offset:768
M v[48:51],a[148:151],a[192:195],v[48:51]
ds_read_b128 a[192:195],v246 offset:1024
v_add_f32 v232,v234,v233
M v[52:55],a[148:151],a[196:199],v[52:55]
ds_read_b128 a[196:199],v246 offset:1280
v_sub_f32 v234,v234,v233
M v[56:59],a[148:151],a[200:203],v[56:59]
s_waitcnt lgkmcnt(6)
ds_read_b128 a[200:203],v246 offset:1536
v_add_f32 v233,v75,v171
M v[60:63],a[148:151],a[204:207],v[60:63]
s_waitcnt vmcnt(25) lgkmcnt(6)
ds_read_b128 a[204:207],v246 offset:1792
v_sub_f32 v171,v75,v171
M v[128:131],v[220:223],a[208:211],v[128:131]
s_waitcnt lgkmcnt(6)
ds_read_b128 a[208:211],v246 offset:2048
v_add_f32 v75,v232,v233
M v[132:135],v[220:223],a[212:215],v[132:135]
s_waitcnt lgkmcnt(6)
v_fmac_f32 v232,4.0,v233
v_fma_f32 v233,2.0,v171,v234
M v[136:139],v[220:223],a[216:219],v[136:139]
s_waitcnt lgkmcnt(5)
buffer_load_dwordx4 a[248:251],v247,s[20:23],s48 offen offset:1024 sc1
M v[140:143],v[220:223],a[220:223],v[140:143]
s_waitcnt lgkmcnt(4)
v_fma_f32 v171,s40,v171,v234
v_cvt_pk_bf16_f32 v229,v229,v233
M v[144:147],v[220:223],a[192:195],v[144:147]
s_waitcnt lgkmcnt(3)
global_load_dword v251,v252,s[82:83]
M v[148:151],v[220:223],a[196:199],v[148:151]
s_waitcnt lgkmcnt(2)
v_cvt_pk_bf16_f32 v231,v231,v232
M v[152:155],v[220:223],a[200:203],v[152:155]
s_waitcnt lgkmcnt(1)
ds_write2st64_b64 v249,v[228:229],v[230:231] offset0:68 offset1:72
M v[156:159],v[220:223],a[204:207],v[156:159]
s_waitcnt vmcnt(26)
v_accvgpr_read_b32 v204,a76
v_accvgpr_read_b32 v208,a172
M v[128:131],a[132:135],a[212:215],v[128:131]
s_add_u32 s34,s32,1376256
buffer_store_dwordx4 a[60:63],v248,s[24:27],s34 offen offset:512 nt
M v[132:135],a[132:135],a[216:219],v[132:135]
ds_read_b128 a[212:215],v245 offset:2304
v_accvgpr_read_b32 v205,a77
M v[136:139],a[132:135],a[220:223],v[136:139]
buffer_load_dwordx4 a[96:99],v247,s[20:23],s48 offen offset:2048 sc1
M v[140:143],a[132:135],a[192:195],v[140:143]
v_accvgpr_read_b32 v209,a173
v_accvgpr_read_b32 v206,a78
M v[144:147],a[132:135],a[196:199],v[144:147]
s_add_u32 s48,s77,6144
v_accvgpr_read_b32 v210,a174
v_accvgpr_read_b32 v207,a79
v_accvgpr_read_b32 v211,a175
v_pk_add_f32 v[212:213],v[204:205],v[208:209]
v_pk_add_f32 v[214:215],v[206:207],v[210:211]
v_pk_add_f32 v[204:205],v[204:205],v[208:209] neg_lo:[0,1] neg_hi:[0,1]
v_pk_add_f32 v[206:207],v[206:207],v[210:211] neg_lo:[0,1] neg_hi:[0,1]
v_pk_add_f32 v[208:209],v[76:77],v[172:173]
v_pk_add_f32 v[210:211],v[78:79],v[174:175]
v_pk_add_f32 v[172:173],v[76:77],v[172:173] neg_lo:[0,1] neg_hi:[0,1]
v_pk_add_f32 v[174:175],v[78:79],v[174:175] neg_lo:[0,1] neg_hi:[0,1]
v_pk_add_f32 v[76:77],v[212:213],v[208:209]
v_pk_add_f32 v[78:79],v[214:215],v[210:211]
v_pk_fma_f32 v[212:213],v[208:209],4.0,v[212:213] op_sel_hi:[1,0,1]
v_pk_fma_f32 v[214:215],v[210:211],4.0,v[214:215] op_sel_hi:[1,0,1]
v_pk_fma_f32 v[208:209],v[172:173],2.0,v[204:205] op_sel_hi:[1,0,1]
v_pk_fma_f32 v[210:211],v[174:175],2.0,v[206:207] op_sel_hi:[1,0,1]
v_pk_fma_f32 v[172:173],v[172:173],s[40:41],v[204:205] op_sel_hi:[1,0,1]
v_pk_fma_f32 v[174:175],v[174:175],s[40:41],v[206:207] op_sel_hi:[1,0,1]
M v[148:151],a[132:135],a[200:203],v[148:151]
v_add_u32 v245,0x15400,v245
v_add_u32 v246,0x15400,v246
M v[152:155],a[132:135],a[204:207],v[152:155]
s_waitcnt lgkmcnt(2)
v_cvt_pk_bf16_f32 v208,v208,v209
v_cvt_pk_bf16_f32 v209,v210,v211
M v[156:159],a[132:135],a[208:211],v[156:159]
s_waitcnt vmcnt(26)
v_cvt_pk_bf16_f32 v212,v212,v213
v_cvt_pk_bf16_f32 v213,v214,v215
M v[128:131],a[100:103],a[216:219],v[128:131]
ds_read_b128 a[216:219],v245 offset:0
ds_write2st64_b64 v249,v[208:209],v[212:213] offset0:76 offset1:80
M v[132:135],a[100:103],a[220:223],v[132:135]
ds_read_b128 a[220:223],v246 offset:256
v_cvt_pk_bf16_f32 v32,v32,v33
M v[136:139],a[100:103],a[192:195],v[136:139]
buffer_load_dwordx4 a[144:147],v247,s[20:23],s48 offen offset:0 sc1
M v[140:143],a[100:103],a[196:199],v[140:143]
ds_read_b128 a[192:195],v246 offset:512
ds_read_b128 a[196:199],v246 offset:768
M v[144:147],a[100:103],a[200:203],v[144:147]
ds_read_b128 a[200:203],v246 offset:1024
v_cvt_pk_bf16_f32 v33,v34,v35
M v[148:151],a[100:103],a[204:207],v[148:151]
ds_read_b128 a[204:207],v246 offset:1280
v_cvt_pk_bf16_f32 v36,v36,v37
M v[152:155],a[100:103],a[208:211],v[152:155]
s_waitcnt lgkmcnt(7)
ds_read_b128 a[208:211],v246 offset:1536
v_cvt_pk_bf16_f32 v37,v38,v39
M v[156:159],a[100:103],a[212:215],v[156:159]
s_waitcnt vmcnt(26) lgkmcnt(6)
s_barrier
ds_read_b128 a[64:67],v247 offset:60928
M v[128:131],a[116:119],a[216:219],v[128:131]
s_waitcnt lgkmcnt(6)
ds_read_b128 a[68:71],v247 offset:65024
ds_read_b128 a[72:75],v247 offset:34816
M v[132:135],a[116:119],a[220:223],v[132:135]
s_waitcnt lgkmcnt(7)
ds_read_b128 a[76:79],v247 offset:38912
ds_read_b128 a[212:215],v246 offset:1792
M v[136:139],a[116:119],a[192:195],v[136:139]
s_waitcnt lgkmcnt(8)
buffer_load_dwordx4 a[164:167],v247,s[20:23],s48 offen offset:1024 sc1
M v[140:143],a[116:119],a[196:199],v[140:143]
s_waitcnt lgkmcnt(7)
ds_read_b128 a[216:219],v246 offset:2048
ds_write2st64_b64 v249,v[32:33],v[36:37] offset0:34 offset1:38
M v[144:147],a[116:119],a[200:203],v[144:147]
s_waitcnt lgkmcnt(8)
v_cvt_pk_bf16_f32 v40,v40,v41
v_cvt_pk_bf16_f32 v41,v42,v43
M v[148:151],a[116:119],a[204:207],v[148:151]
s_waitcnt lgkmcnt(7)
v_cvt_pk_bf16_f32 v44,v44,v45
v_cvt_pk_bf16_f32 v45,v46,v47
M v[152:155],a[116:119],a[208:211],v[152:155]
s_waitcnt lgkmcnt(2)
s_add_u32 s34,s33,0
buffer_store_dwordx4 v[96:99],v248,s[24:27],s34 offen offset:1152 nt
M v[156:159],a[116:119],a[212:215],v[156:159]
s_waitcnt vmcnt(26)
ds_write2st64_b64 v249,v[40:41],v[44:45] offset0:42 offset1:46
M v[128:131],v[224:227],a[220:223],v[128:131]
ds_read_b128 a[220:223],v245 offset:2304
v_cvt_pk_bf16_f32 v48,v48,v49
M v[132:135],v[224:227],a[192:195],v[132:135]
v_cvt_pk_bf16_f32 v49,v50,v51
v_cvt_pk_bf16_f32 v52,v52,v53
M v[136:139],v[224:227],a[196:199],v[136:139]
buffer_load_dwordx4 a[128:131],v247,s[20:23],s48 offen offset:2048 sc1
M v[140:143],v[224:227],a[200:203],v[140:143]
v_cvt_pk_bf16_f32 v53,v54,v55
M v[144:147],v[224:227],a[204:207],v[144:147]
s_add_u32 s48,s78,6144
ds_write2st64_b64 v249,v[48:49],v[52:53] offset0:51 offset1:55
M v[148:151],v[224:227],a[208:211],v[148:151]
v_cvt_pk_bf16_f32 v56,v56,v57
v_cvt_pk_bf16_f32 v57,v58,v59
M v[152:155],v[224:227],a[212:215],v[152:155]
s_waitcnt lgkmcnt(4)
v_cvt_pk_bf16_f32 v60,v60,v61
v_cvt_pk_bf16_f32 v61,v62,v63
M v[156:159],v[224:227],a[216:219],v[156:159]
s_waitcnt vmcnt(26)
ds_write2st64_b64 v249,v[56:57],v[60:61] offset0:59 offset1:63
M v[128:131],a[152:155],a[192:195],v[128:131]
ds_read_b128 a[192:195],v245 offset:17408
v_accvgpr_read_b32 v234,a80
M v[132:135],a[152:155],a[196:199],v[132:135]
ds_read_b128 a[196:199],v246 offset:17664
v_accvgpr_read_b32 v228,a176
M v[136:139],a[152:155],a[200:203],v[136:139]
buffer_load_dwordx4 a[252:255],v247,s[20:23],s48 offen offset:0 sc1
M v[140:143],a[152:155],a[204:207],v[140:143]
ds_read_b128 a[200:203],v246 offset:17920
ds_read_b128 a[204:207],v246 offset:18176
M v[144:147],a[152:155],a[208:211],v[144:147]
ds_read_b128 a[208:211],v246 offset:18432
v_add_f32 v230,v234,v228
M v[148:151],a[152:155],a[212:215],v[148:151]
ds_read_b128 a[212:215],v246 offset:18688
v_sub_f32 v234,v234,v228
M v[152:155],a[152:155],a[216:219],v[152:155]
s_waitcnt lgkmcnt(8)
ds_read_b128 a[216:219],v246 offset:18944
v_add_f32 v228,v80,v176
M v[156:159],a[152:155],a[220:223],v[156:159]
s_waitcnt vmcnt(26) lgkmcnt(6)
ds_read_b128 a[220:223],v246 offset:19200
v_sub_f32 v176,v80,v176
M v[128:131],a[228:231],a[192:195],v[128:131]
s_waitcnt lgkmcnt(6)
ds_read_b128 a[192:195],v246 offset:19456
v_add_f32 v80,v230,v228
M v[132:135],a[228:231],a[196:199],v[132:135]
s_waitcnt lgkmcnt(6)
v_fmac_f32 v230,4.0,v228
v_fma_f32 v228,2.0,v176,v234
M v[136:139],a[228:231],a[200:203],v[136:139]
s_waitcnt lgkmcnt(5)
buffer_load_dwordx4 a[224:227],v247,s[20:23],s48 offen offset:1024 sc1
M v[140:143],a[228:231],a[204:207],v[140:143]
s_waitcnt lgkmcnt(4)
s_add_u32 s34,s33,393216
v_fma_f32 v176,s40,v176,v234
v_accvgpr_read_b32 v234,a81
M v[144:147],a[228:231],a[208:211],v[144:147]
s_waitcnt lgkmcnt(3)
buffer_store_dwordx4 v[104:107],v248,s[24:27],s34 offen offset:1152 nt
M v[148:151],a[228:231],a[212:215],v[148:151]
s_waitcnt lgkmcnt(2)
v_accvgpr_read_b32 v233,a177
v_add_f32 v232,v234,v233
M v[152:155],a[228:231],a[216:219],v[152:155]
s_waitcnt lgkmcnt(1)
v_sub_f32 v234,v234,v233
v_add_f32 v233,v81,v177
M v[156:159],a[228:231],a[220:223],v[156:159]
s_waitcnt vmcnt(26)
v_sub_f32 v177,v81,v177
v_add_f32 v81,v232,v233
M v[128:131],a[232:235],a[196:199],v[128:131]
ds_read_b128 a[196:199],v245 offset:19712
v_fmac_f32 v232,4.0,v233
M v[132:135],a[232:235],a[200:203],v[132:135]
v_fma_f32 v233,2.0,v177,v234
v_fma_f32 v177,s40,v177,v234
M v[136:139],a[232:235],a[204:207],v[136:139]
buffer_load_dwordx4 a[112:115],v247,s[20:23],s48 offen offset:2048 sc1
M v[140:143],a[232:235],a[208:211],v[140:143]
v_cvt_pk_bf16_f32 v228,v228,v233
v_cvt_pk_bf16_f32 v230,v230,v232
M v[144:147],a[232:235],a[212:215],v[144:147]
s_add_u32 s48,s79,6144
v_accvgpr_read_b32 v234,a82
v_accvgpr_read_b32 v229,a178
M v[148:151],a[232:235],a[216:219],v[148:151]
v_add_f32 v231,v234,v229
v_sub_f32 v234,v234,v229
M v[152:155],a[232:235],a[220:223],v[152:155]
s_waitcnt lgkmcnt(1)
v_add_f32 v229,v82,v178
v_sub_f32 v178,v82,v178
M v[156:159],a[232:235],a[192:195],v[156:159]
s_waitcnt vmcnt(26)
v_add_f32 v82,v231,v229
v_fmac_f32 v231,4.0,v229
M v[128:131],a[156:159],a[200:203],v[128:131]
ds_read_b128 a[200:203],v245 offset:34816
v_fma_f32 v229,2.0,v178,v234
M v[132:135],a[156:159],a[204:207],v[132:135]
ds_read_b128 a[204:207],v246 offset:35072
v_fma_f32 v178,s40,v178,v234
M v[136:139],a[156:159],a[208:211],v[136:139]
buffer_load_dwordx4 v[216:219],v247,s[20:23],s48 offen offset:0 sc1
M v[140:143],a[156:159],a[212:215],v[140:143]
ds_read_b128 a[208:211],v246 offset:35328
ds_read_b128 a[212:215],v246 offset:35584
M v[144:147],a[156:159],a[216:219],v[144:147]
ds_read_b128 a[216:219],v246 offset:35840
v_accvgpr_read_b32 v234,a83
M v[148:151],a[156:159],a[220:223],v[148:151]
ds_read_b128 a[220:223],v246 offset:36096
v_accvgpr_read_b32 v233,a179
M v[152:155],a[156:159],a[192:195],v[152:155]
s_waitcnt lgkmcnt(6)
ds_read_b128 a[192:195],v246 offset:36352
v_add_f32 v232,v234,v233
M v[156:159],a[156:159],a[196:199],v[156:159]
s_waitcnt vmcnt(26) lgkmcnt(6)
ds_read_b128 a[196:199],v246 offset:36608
v_sub_f32 v234,v234,v233
M v[128:131],a[136:139],a[200:203],v[128:131]
s_waitcnt lgkmcnt(6)
ds_read_b128 a[200:203],v246 offset:36864
v_add_f32 v233,v83,v179
M v[132:135],a[136:139],a[204:207],v[132:135]
s_waitcnt lgkmcnt(6)
s_add_u32 s34,s33,786432
buffer_store_dwordx4 v[112:115],v248,s[24:27],s34 offen offset:1152 nt
M v[136:139],a[136:139],a[208:211],v[136:139]
s_waitcnt lgkmcnt(5)
buffer_load_dwordx4 a[168:171],v247,s[20:23],s48 offen offset:1024 sc1
M v[140:143],a[136:139],a[212:215],v[140:143]
s_waitcnt lgkmcnt(4)
v_sub_f32 v179,v83,v179
v_add_f32 v83,v232,v233
M v[144:147],a[136:139],a[216:219],v[144:147]
s_waitcnt lgkmcnt(3)
v_fmac_f32 v232,4.0,v233
v_fma_f32 v233,2.0,v179,v234
M v[148:151],a[136:139],a[220:223],v[148:151]
s_waitcnt lgkmcnt(2)
v_fma_f32 v179,s40,v179,v234
v_cvt_pk_bf16_f32 v229,v229,v233
M v[152:155],a[136:139],a[192:195],v[152:155]
s_waitcnt lgkmcnt(1)
v_cvt_pk_bf16_f32 v231,v231,v232
M v[156:159],a[136:139],a[196:199],v[156:159]
s_waitcnt vmcnt(26)
ds_write2st64_b64 v249,v[228:229],v[230:231] offset0:102 offset1:106
M v[128:131],a[236:239],a[204:207],v[128:131]
ds_read_b128 a[204:207],v245 offset:37120
v_accvgpr_read_b32 v234,a84
M v[132:135],a[236:239],a[208:211],v[132:135]
v_accvgpr_read_b32 v228,a180
v_add_f32 v230,v234,v228
M v[136:139],a[236:239],a[212:215],v[136:139]
buffer_load_dwordx4 a[148:151],v247,s[20:23],s48 offen offset:2048 sc1
M v[140:143],a[236:239],a[216:219],v[140:143]
v_sub_f32 v234,v234,v228
v_add_f32 v228,v84,v180
M v[144:147],a[236:239],a[220:223],v[144:147]
s_add_u32 s48,s80,6144
v_sub_f32 v180,v84,v180
v_add_f32 v84,v230,v228
M v[148:151],a[236:239],a[192:195],v[148:151]
v_fmac_f32 v230,4.0,v228
v_fma_f32 v228,2.0,v180,v234
M v[152:155],a[236:239],a[196:199],v[152:155]
s_waitcnt lgkmcnt(2)
v_fma_f32 v180,s40,v180,v234
v_accvgpr_read_b32 v234,a85
M v[156:159],a[236:239],a[200:203],v[156:159]
s_waitcnt vmcnt(26)
v_accvgpr_read_b32 v233,a181
v_add_f32 v232,v234,v233
M v[128:131],a[140:143],a[208:211],v[128:131]
ds_read_b128 a[208:211],v245 offset:52224
v_sub_f32 v234,v234,v233
M v[132:135],a[140:143],a[212:215],v[132:135]
ds_read_b128 a[212:215],v246 offset:52480
v_add_f32 v233,v85,v181
M v[136:139],a[140:143],a[216:219],v[136:139]
buffer_load_dwordx4 v[220:223],v247,s[20:23],s48 offen offset:0 sc1
M v[140:143],a[140:143],a[220:223],v[140:143]
ds_read_b128 a[216:219],v246 offset:52736
ds_read_b128 a[220:223],v246 offset:52992
M v[144:147],a[140:143],a[192:195],v[144:147]
ds_read_b128 a[192:195],v246 offset:53248
v_sub_f32 v181,v85,v181
M v[148:151],a[140:143],a[196:199],v[148:151]
ds_read_b128 a[196:199],v246 offset:53504
v_add_f32 v85,v232,v233
M v[152:155],a[140:143],a[200:203],v[152:155]
s_waitcnt lgkmcnt(6)
s_add_u32 s34,s33,1179648
buffer_store_dwordx4 v[120:123],v248,s[24:27],s34 offen offset:1152 nt
M v[156:159],a[140:143],a[204:207],v[156:159]
s_waitcnt vmcnt(26) lgkmcnt(5)
ds_read_b128 a[200:203],v246 offset:53760
ds_read_b128 a[204:207],v246 offset:54016
M v[128:131],a[104:107],a[208:211],v[128:131]
s_waitcnt lgkmcnt(6)
ds_read_b128 a[208:211],v246 offset:54272
v_fmac_f32 v232,4.0,v233
M v[132:135],a[104:107],a[212:215],v[132:135]
s_waitcnt lgkmcnt(6)
v_fma_f32 v233,2.0,v181,v234
v_fma_f32 v181,s40,v181,v234
M v[136:139],a[104:107],a[216:219],v[136:139]
s_waitcnt lgkmcnt(5)
buffer_load_dwordx4 a[172:175],v247,s[20:23],s48 offen offset:1024 sc1
M v[140:143],a[104:107],a[220:223],v[140:143]
s_waitcnt lgkmcnt(4)
v_cvt_pk_bf16_f32 v228,v228,v233
v_cvt_pk_bf16_f32 v230,v230,v232
M v[144:147],a[104:107],a[192:195],v[144:147]
s_waitcnt lgkmcnt(3)
v_accvgpr_read_b32 v234,a86
v_accvgpr_read_b32 v229,a182
M v[148:151],a[104:107],a[196:199],v[148:151]
s_waitcnt lgkmcnt(2)
v_add_f32 v231,v234,v229
v_sub_f32 v234,v234,v229
M v[152:155],a[104:107],a[200:203],v[152:155]
s_waitcnt lgkmcnt(1)
v_add_f32 v229,v86,v182
v_sub_f32 v182,v86,v182
M v[156:159],a[104:107],a[204:207],v[156:159]
s_waitcnt vmcnt(26)
v_add_f32 v86,v231,v229
v_fmac_f32 v231,4.0,v229
M v[128:131],a[120:123],a[212:215],v[128:131]
ds_read_b128 a[212:215],v245 offset:54528
v_fma_f32 v229,2.0,v182,v234
M v[132:135],a[120:123],a[216:219],v[132:135]
v_fma_f32 v182,s40,v182,v234
v_accvgpr_read_b32 v234,a87
M v[136:139],a[120:123],a[220:223],v[136:139]
buffer_load_dwordx4 a[132:135],v247,s[20:23],s48 offen offset:2048 sc1
M v[140:143],a[120:123],a[192:195],v[140:143]
v_accvgpr_read_b32 v233,a183
v_add_f32 v232,v234,v233
M v[144:147],a[120:123],a[196:199],v[144:147]
s_add_u32 s48,s81,6144
v_sub_f32 v234,v234,v233
v_add_f32 v233,v87,v183
M v[148:151],a[120:123],a[200:203],v[148:151]
v_add_u32 v245,0xffffbc00,v245
v_add_u32 v246,0xffffbc00,v246
M v[152:155],a[120:123],a[204:207],v[152:155]
s_waitcnt lgkmcnt(1)
v_sub_f32 v183,v87,v183
v_add_f32 v87,v232,v233
M v[156:159],a[120:123],a[208:211],v[156:159]
s_waitcnt vmcnt(26)
v_fmac_f32 v232,4.0,v233
v_fma_f32 v233,2.0,v183,v234
M v[128:131],a[124:127],a[216:219],v[128:131]
ds_read_b128 a[216:219],v245 offset:0
v_fma_f32 v183,s40,v183,v234
M v[132:135],a[124:127],a[220:223],v[132:135]
ds_read_b128 a[220:223],v246 offset:256
v_cvt_pk_bf16_f32 v229,v229,v233
M v[136:139],a[124:127],a[192:195],v[136:139]
buffer_load_dwordx4 a[100:103],v247,s[20:23],s48 offen offset:0 sc1
M v[140:143],a[124:127],a[196:199],v[140:143]
ds_read_b128 a[192:195],v246 offset:512
ds_read_b128 a[196:199],v246 offset:768
M v[144:147],a[124:127],a[200:203],v[144:147]
s_add_u32 s34,s32,0
buffer_store_dwordx4 a[64:67],v248,s[24:27],s34 offen offset:640 nt
M v[148:151],a[124:127],a[204:207],v[148:151]
ds_read_b128 a[200:203],v246 offset:1024
ds_read_b128 a[204:207],v246 offset:1280
M v[152:155],a[124:127],a[208:211],v[152:155]
s_waitcnt lgkmcnt(6)
ds_read_b128 a[208:211],v246 offset:1536
v_cvt_pk_bf16_f32 v231,v231,v232
M v[156:159],a[124:127],a[212:215],v[156:159]
s_waitcnt vmcnt(26) lgkmcnt(6)
ds_read_b128 a[212:215],v246 offset:1792
ds_write2st64_b64 v249,v[228:229],v[230:231] offset0:110 offset1:114
M v[128:131],a[240:243],a[216:219],v[128:131]
s_waitcnt lgkmcnt(7)
ds_read_b128 a[216:219],v246 offset:2048
v_accvgpr_read_b32 v234,a88
M v[132:135],a[240:243],a[220:223],v[132:135]
s_waitcnt lgkmcnt(7)
v_accvgpr_read_b32 v228,a184
v_add_f32 v230,v234,v228
M v[136:139],a[240:243],a[192:195],v[136:139]
s_waitcnt lgkmcnt(6)
buffer_load_dwordx4 a[116:119],v247,s[20:23],s48 offen offset:1024 sc1
M v[140:143],a[240:243],a[196:199],v[140:143]
s_waitcnt lgkmcnt(5)
v_sub_f32 v234,v234,v228
v_add_f32 v228,v88,v184
M v[144:147],a[240:243],a[200:203],v[144:147]
s_waitcnt lgkmcnt(4)
v_sub_f32 v184,v88,v184
M v[148:151],a[240:243],a[204:207],v[148:151]
s_waitcnt lgkmcnt(1)
s_barrier
ds_read_b128 v[32:35],v247 offset:17408
M v[152:155],a[240:243],a[208:211],v[152:155]
ds_read_b128 v[40:43],v247 offset:21504
ds_read_b128 v[48:51],v247 offset:26112
M v[156:159],a[240:243],a[212:215],v[156:159]
s_waitcnt vmcnt(26)
ds_read_b128 v[56:59],v247 offset:30208
ds_read_b128 a[80:83],v247 offset:52224
M v[128:131],a[160:163],a[220:223],v[128:131]
ds_read_b128 a[84:87],v247 offset:56320
ds_read_b128 a[220:223],v245 offset:2304
M v[132:135],a[160:163],a[192:195],v[132:135]
v_add_f32 v88,v230,v228
v_fmac_f32 v230,4.0,v228
M v[136:139],a[160:163],a[196:199],v[136:139]
buffer_load_dwordx4 v[224:227],v247,s[20:23],s48 offen offset:2048 sc1
M v[140:143],a[160:163],a[200:203],v[140:143]
v_fma_f32 v228,2.0,v184,v234
v_fma_f32 v184,s40,v184,v234
M v[144:147],a[160:163],a[204:207],v[144:147]
s_add_u32 s48,s76,52224
v_accvgpr_read_b32 v234,a89
v_accvgpr_read_b32 v233,a185
M v[148:151],a[160:163],a[208:211],v[148:151]
v_add_u32 v245,0xfffece00,v245
v_add_u32 v246,0xfffece00,v246
M v[152:155],a[160:163],a[212:215],v[152:155]
s_waitcnt lgkmcnt(7)
v_add_f32 v232,v234,v233
v_sub_f32 v234,v234,v233
M v[156:159],a[160:163],a[216:219],v[156:159]
s_waitcnt vmcnt(26)
v_add_f32 v233,v89,v185
v_sub_f32 v185,v89,v185
M v[128:131],a[244:247],a[192:195],v[128:131]
ds_read_b128 a[192:195],v245 offset:0
v_add_f32 v89,v232,v233
M v[132:135],a[244:247],a[196:199],v[132:135]
s_add_u32 s34,s32,196608
buffer_store_dwordx4 a[68:71],v248,s[24:27],s34 offen offset:640 nt
M v[136:139],a[244:247],a[200:203],v[136:139]
buffer_load_dwordx4 a[152:155],v247,s[20:23],s48 offen offset:0 sc1
M v[140:143],a[244:247],a[204:207],v[140:143]
ds_read_b128 a[196:199],v246 offset:256
ds_read_b128 a[200:203],v246 offset:512
v_fmac_f32 v232,4.0,v233
v_fma_f32 v233,2.0,v185,v234
v_fma_f32 v185,s40,v185,v234
v_cvt_pk_bf16_f32 v228,v228,v233
M v[144:147],a[244:247],a[208:211],v[144:147]
ds_read_b128 a[204:207],v246 offset:768
ds_read_b128 a[208:211],v246 offset:1024
v_cvt_pk_bf16_f32 v230,v230,v232
v_accvgpr_read_b32 v234,a90
v_accvgpr_read_b32 v229,a186
v_add_f32 v231,v234,v229
M v[148:151],a[244:247],a[212:215],v[148:151]
ds_read_b128 a[212:215],v246 offset:1280
v_sub_f32 v234,v234,v229
v_add_f32 v229,v90,v186
v_sub_f32 v186,v90,v186
v_add_f32 v90,v231,v229
M v[152:155],a[244:247],a[216:219],v[152:155]
s_waitcnt lgkmcnt(6)
ds_read_b128 a[216:219],v246 offset:1536
v_fmac_f32 v231,4.0,v229
v_fma_f32 v229,2.0,v186,v234
v_fma_f32 v186,s40,v186,v234
v_accvgpr_read_b32 v234,a91
M v[156:159],a[244:247],a[220:223],v[156:159]
s_waitcnt vmcnt(26) lgkmcnt(6)
ds_read_b128 a[220:223],v246 offset:1792
v_accvgpr_read_b32 v233,a187
v_add_f32 v232,v234,v233
v_sub_f32 v234,v234,v233
v_add_f32 v233,v91,v187
M v[64:67],a[108:111],a[192:195],v[64:67]
s_waitcnt lgkmcnt(6)
ds_read_b128 a[192:195],v246 offset:2048
v_sub_f32 v187,v91,v187
v_add_f32 v91,v232,v233
v_fmac_f32 v232,4.0,v233
v_fma_f32 v233,2.0,v187,v234
M v[68:71],a[108:111],a[196:199],v[68:71]
s_waitcnt lgkmcnt(6)
v_fma_f32 v187,s40,v187,v234
v_cvt_pk_bf16_f32 v229,v229,v233
v_cvt_pk_bf16_f32 v231,v231,v232
M v[72:75],a[108:111],a[200:203],v[72:75]
s_waitcnt lgkmcnt(5)
ds_write2st64_b64 v249,v[228:229],v[230:231] offset0:119 offset1:123
M v[76:79],a[108:111],a[204:207],v[76:79]
s_waitcnt lgkmcnt(5)
buffer_load_dwordx4 a[228:231],v247,s[20:23],s48 offen offset:1024 sc1
v_accvgpr_read_b32 v204,a92
v_accvgpr_read_b32 v208,a188
M v[80:83],a[108:111],a[208:211],v[80:83]
s_waitcnt lgkmcnt(4)
v_accvgpr_read_b32 v205,a93
v_accvgpr_read_b32 v209,a189
v_accvgpr_read_b32 v206,a94
v_accvgpr_read_b32 v210,a190
v_accvgpr_read_b32 v207,a95
v_accvgpr_read_b32 v211,a191
v_pk_add_f32 v[212:213],v[204:205],v[208:209]
v_pk_add_f32 v[214:215],v[206:207],v[210:211]
v_pk_add_f32 v[204:205],v[204:205],v[208:209] neg_lo:[0,1] neg_hi:[0,1]
v_pk_add_f32 v[206:207],v[206:207],v[210:211] neg_lo:[0,1] neg_hi:[0,1]
v_pk_add_f32 v[208:209],v[92:93],v[188:189]
v_pk_add_f32 v[210:211],v[94:95],v[190:191]
v_pk_add_f32 v[188:189],v[92:93],v[188:189] neg_lo:[0,1] neg_hi:[0,1]
v_pk_add_f32 v[190:191],v[94:95],v[190:191] neg_lo:[0,1] neg_hi:[0,1]
v_pk_add_f32 v[92:93],v[212:213],v[208:209]
v_pk_add_f32 v[94:95],v[214:215],v[210:211]
v_pk_fma_f32 v[212:213],v[208:209],4.0,v[212:213] op_sel_hi:[1,0,1]
v_pk_fma_f32 v[214:215],v[210:211],4.0,v[214:215] op_sel_hi:[1,0,1]
v_pk_fma_f32 v[208:209],v[188:189],2.0,v[204:205] op_sel_hi:[1,0,1]
v_pk_fma_f32 v[210:211],v[190:191],2.0,v[206:207] op_sel_hi:[1,0,1]
v_pk_fma_f32 v[188:189],v[188:189],s[40:41],v[204:205] op_sel_hi:[1,0,1]
v_pk_fma_f32 v[190:191],v[190:191],s[40:41],v[206:207] op_sel_hi:[1,0,1]
M v[84:87],a[108:111],a[212:215],v[84:87]
s_waitcnt lgkmcnt(3)
v_cvt_pk_bf16_f32 v208,v208,v209
v_cvt_pk_bf16_f32 v209,v210,v211
M v[88:91],a[108:111],a[216:219],v[88:91]
s_waitcnt lgkmcnt(2)
v_cvt_pk_bf16_f32 v212,v212,v213
v_cvt_pk_bf16_f32 v213,v214,v215
M v[92:95],a[108:111],a[220:223],v[92:95]
s_waitcnt vmcnt(26)
ds_write2st64_b64 v249,v[208:209],v[212:213] offset0:127 offset1:131
M v[64:67],a[248:251],a[196:199],v[64:67]
s_add_u32 s28,s64,6684672
buffer_load_dwordx2 v[204:205],v241,s[12:15],s28 offen offset:0
M v[68:71],a[248:251],a[200:203],v[68:71]
ds_read_b128 a[196:199],v245 offset:2304
v_cvt_pk_bf16_f32 v128,v128,v129
M v[72:75],a[248:251],a[204:207],v[72:75]
buffer_load_dwordx2 v[214:215],v241,s[16:19],s28 offen offset:1536
M v[76:79],a[248:251],a[208:211],v[76:79]
v_cvt_pk_bf16_f32 v129,v130,v131
v_cvt_pk_bf16_f32 v132,v132,v133
M v[80:83],a[248:251],a[212:215],v[80:83]
v_cvt_pk_bf16_f32 v133,v134,v135
M v[84:87],a[248:251],a[216:219],v[84:87]
ds_write2st64_b64 v249,v[128:129],v[132:133] offset0:68 offset1:72
M v[88:91],a[248:251],a[220:223],v[88:91]
s_waitcnt lgkmcnt(4)
buffer_load_dwordx2 v[206:207],v241,s[8:11],s28 offen offset:0
M v[92:95],a[248:251],a[192:195],v[92:95]
s_waitcnt vmcnt(26)
s_add_u32 s34,s32,393216
v_add_u32 v245,0x15400,v245
v_add_u32 v246,0x15400,v246
M v[64:67],a[96:99],a[200:203],v[64:67]
ds_read_b128 a[200:203],v245 offset:0
v_cvt_pk_bf16_f32 v136,v136,v137
M v[68:71],a[96:99],a[204:207],v[68:71]
ds_read_b128 a[204:207],v246 offset:256
v_cvt_pk_bf16_f32 v137,v138,v139
M v[72:75],a[96:99],a[208:211],v[72:75]
buffer_load_dwordx2 v[208:209],v241,s[8:11],s28 offen offset:384
M v[76:79],a[96:99],a[212:215],v[76:79]
ds_read_b128 a[208:211],v246 offset:512
ds_read_b128 a[212:215],v246 offset:768
M v[80:83],a[96:99],a[216:219],v[80:83]
ds_read_b128 a[216:219],v246 offset:1024
v_cvt_pk_bf16_f32 v140,v140,v141
M v[84:87],a[96:99],a[220:223],v[84:87]
ds_read_b128 a[220:223],v246 offset:1280
v_cvt_pk_bf16_f32 v141,v142,v143
M v[88:91],a[96:99],a[192:195],v[88:91]
s_waitcnt lgkmcnt(7)
buffer_load_dwordx2 v[210:211],v241,s[8:11],s28 offen offset:768
M v[92:95],a[96:99],a[196:199],v[92:95]
s_waitcnt vmcnt(27) lgkmcnt(5)
ds_read_b128 a[192:195],v246 offset:1536
ds_read_b128 a[196:199],v246 offset:1792
M v[64:67],a[144:147],a[200:203],v[64:67]
s_waitcnt lgkmcnt(6)
ds_read_b128 a[200:203],v246 offset:2048
ds_write2st64_b64 v249,v[136:137],v[140:141] offset0:76 offset1:80
M v[68:71],a[144:147],a[204:207],v[68:71]
s_waitcnt lgkmcnt(7)
buffer_load_dwordx2 v[212:213],v241,s[8:11],s28 offen offset:1152
M v[72:75],a[144:147],a[208:211],v[72:75]
s_waitcnt lgkmcnt(6)
v_cvt_pk_bf16_f32 v144,v144,v145
v_cvt_pk_bf16_f32 v145,v146,v147
M v[76:79],a[144:147],a[212:215],v[76:79]
s_waitcnt lgkmcnt(5)
v_cvt_pk_bf16_f32 v148,v148,v149
v_cvt_pk_bf16_f32 v149,v150,v151
M v[80:83],a[144:147],a[216:219],v[80:83]
s_waitcnt lgkmcnt(4)
ds_write2st64_b64 v249,v[144:145],v[148:149] offset0:85 offset1:89
M v[84:87],a[144:147],a[220:223],v[84:87]
s_waitcnt lgkmcnt(4)
buffer_load_dwordx4 a[232:235],v247,s[20:23],s48 offen offset:2048 sc1
M v[88:91],a[144:147],a[192:195],v[88:91]
s_waitcnt lgkmcnt(3)
s_add_u32 s48,s77,52224
v_cvt_pk_bf16_f32 v152,v152,v153
v_cvt_pk_bf16_f32 v153,v154,v155
M v[92:95],a[144:147],a[196:199],v[92:95]
s_waitcnt vmcnt(28)
v_cvt_pk_bf16_f32 v156,v156,v157
v_cvt_pk_bf16_f32 v157,v158,v159
M v[64:67],a[164:167],a[204:207],v[64:67]
buffer_store_dwordx4 a[72:75],v248,s[24:27],s34 offen offset:640 nt
M v[68:71],a[164:167],a[208:211],v[68:71]
ds_read_b128 a[204:207],v245 offset:2304
ds_write2st64_b64 v249,v[152:153],v[156:157] offset0:93 offset1:97
M v[72:75],a[164:167],a[212:215],v[72:75]
buffer_load_dwordx4 a[176:179],v247,s[20:23],s48 offen offset:0 sc1
M v[76:79],a[164:167],a[216:219],v[76:79]
M v[80:83],a[164:167],a[220:223],v[80:83]
s_add_u32 s34,s32,589824
M v[84:87],a[164:167],a[192:195],v[84:87]
s_waitcnt lgkmcnt(0)
s_barrier
ds_read_b128 a[88:91],v247 offset:60928
M v[88:91],a[164:167],a[196:199],v[88:91]
ds_read_b128 a[92:95],v247 offset:65024
ds_read_b128 v[128:131],v247 offset:34816
M v[92:95],a[164:167],a[200:203],v[92:95]
s_waitcnt vmcnt(28)
ds_read_b128 v[136:139],v247 offset:38912
ds_read_b128 v[144:147],v247 offset:43520
M v[64:67],a[128:131],a[208:211],v[64:67]
ds_read_b128 v[152:155],v247 offset:47616
buffer_load_dwordx4 a[156:159],v247,s[20:23],s48 offen offset:1024 sc1
M v[68:71],a[128:131],a[212:215],v[68:71]
ds_read_b128 a[208:211],v245 offset:17408
ds_read_b128 a[212:215],v246 offset:17664
M v[72:75],a[128:131],a[216:219],v[72:75]
buffer_load_dwordx4 a[136:139],v247,s[20:23],s48 offen offset:2048 sc1
M v[76:79],a[128:131],a[220:223],v[76:79]
s_add_u32 s48,s78,52224
ds_read_b128 a[216:219],v246 offset:17920
ds_read_b128 a[220:223],v246 offset:18176
M v[80:83],a[128:131],a[192:195],v[80:83]
s_waitcnt lgkmcnt(4)
s_barrier
ds_read_b128 a[192:195],v246 offset:18432
M v[84:87],a[128:131],a[196:199],v[84:87]
ds_read_b128 a[196:199],v246 offset:18688
ds_write2st64_b64 v243,v[192:193],v[202:203] offset0:102 offset1:119
M v[88:91],a[128:131],a[200:203],v[88:91]
s_add_u32 s28,s64,7077888
buffer_load_dwordx2 v[192:193],v241,s[12:15],s28 offen offset:0
M v[92:95],a[128:131],a[204:207],v[92:95]
s_waitcnt vmcnt(30) lgkmcnt(6)
ds_read_b128 a[200:203],v246 offset:18944
ds_read_b128 a[204:207],v246 offset:19200
M v[64:67],a[252:255],a[208:211],v[64:67]
s_waitcnt lgkmcnt(7)
ds_read_b128 a[208:211],v246 offset:19456
ds_write2st64_b64 v243,v[194:195],v[196:197] offset0:34 offset1:51
M v[68:71],a[252:255],a[212:215],v[68:71]
s_waitcnt lgkmcnt(8)
buffer_load_dwordx2 v[202:203],v241,s[16:19],s28 offen offset:1536
M v[72:75],a[252:255],a[216:219],v[72:75]
s_waitcnt lgkmcnt(7)
ds_write2st64_b64 v243,v[198:199],v[200:201] offset0:68 offset1:85
M v[76:79],a[252:255],a[220:223],v[76:79]
s_waitcnt lgkmcnt(7)
buffer_load_dwordx2 v[194:195],v241,s[8:11],s28 offen offset:0
M v[80:83],a[252:255],a[192:195],v[80:83]
s_waitcnt lgkmcnt(6)
v_fmac_f32 v235,s43,v237
v_fmac_f32 v240,4.0,v236
M v[84:87],a[252:255],a[196:199],v[84:87]
s_waitcnt lgkmcnt(4)
v_fma_f32 v228,-4.0,v237,v239
v_fmac_f32 v235,s45,v239
M v[88:91],a[252:255],a[200:203],v[88:91]
s_waitcnt lgkmcnt(3)
v_fmac_f32 v240,s41,v238
v_sub_f32 v239,v239,v237
M v[92:95],a[252:255],a[204:207],v[92:95]
s_waitcnt vmcnt(31)
buffer_load_dwordx2 v[196:197],v241,s[8:11],s28 offen offset:384
M v[64:67],a[224:227],a[212:215],v[64:67]
ds_read_b128 a[212:215],v245 offset:19712
v_fma_f32 v237,-4.0,v236,v238
M v[68:71],a[224:227],a[216:219],v[68:71]
v_sub_f32 v238,v238,v236
v_add_f32 v236,v228,v237
M v[72:75],a[224:227],a[220:223],v[72:75]
v_sub_f32 v228,v228,v237
v_fma_f32 v237,2.0,v238,v239
M v[76:79],a[224:227],a[192:195],v[76:79]
buffer_load_dwordx2 v[198:199],v241,s[8:11],s28 offen offset:768
M v[80:83],a[224:227],a[196:199],v[80:83]
v_fmac_f32 v239,-2.0,v238
v_cvt_pk_bf16_f32 v229,v235,v240
M v[84:87],a[224:227],a[200:203],v[84:87]
v_cvt_pk_bf16_f32 v230,v236,v228
v_cvt_pk_bf16_f32 v231,v237,v239
M v[88:91],a[224:227],a[204:207],v[88:91]
s_waitcnt lgkmcnt(3)
ds_write_b16 v244,v229 offset:52224
M v[92:95],a[224:227],a[208:211],v[92:95]
s_waitcnt vmcnt(31)
buffer_load_dwordx2 v[200:201],v241,s[8:11],s28 offen offset:1152
M v[64:67],a[112:115],a[216:219],v[64:67]
ds_read_b128 a[216:219],v245 offset:34816
ds_write_b16_d16_hi v244,v229 offset:60928
M v[68:71],a[112:115],a[220:223],v[68:71]
ds_read_b128 a[220:223],v246 offset:35072
ds_write_b16 v244,v230 offset:17408
M v[72:75],a[112:115],a[192:195],v[72:75]
ds_read_b128 a[192:195],v246 offset:35328
ds_write_b16_d16_hi v244,v230 offset:26112
M v[76:79],a[112:115],a[196:199],v[76:79]
buffer_load_short_d16_hi v235,v242,s[12:15],s71 offen offset:0
M v[80:83],a[112:115],a[200:203],v[80:83]
ds_read_b128 a[196:199],v246 offset:35584
ds_read_b128 a[200:203],v246 offset:35840
M v[84:87],a[112:115],a[204:207],v[84:87]
buffer_load_short_d16_hi v236,v242,s[8:11],s71 offen offset:0
M v[88:91],a[112:115],a[208:211],v[88:91]
s_waitcnt lgkmcnt(9)
ds_read_b128 a[204:207],v246 offset:36096
ds_read_b128 a[208:211],v246 offset:36352
M v[92:95],a[112:115],a[212:215],v[92:95]
s_waitcnt vmcnt(33) lgkmcnt(9)
buffer_load_short_d16_hi v237,v242,s[8:11],s71 offen offset:384
M v[64:67],v[216:219],a[216:219],v[64:67]
s_waitcnt lgkmcnt(7)
ds_read_b128 a[212:215],v246 offset:36608
ds_read_b128 a[216:219],v246 offset:36864
M v[68:71],v[216:219],a[220:223],v[68:71]
s_waitcnt lgkmcnt(7)
buffer_load_short_d16_hi v238,v242,s[8:11],s71 offen offset:768
M v[72:75],v[216:219],a[192:195],v[72:75]
s_waitcnt lgkmcnt(5)
ds_write_b16 v244,v231 offset:34816
M v[76:79],v[216:219],a[196:199],v[76:79]
s_waitcnt lgkmcnt(5)
buffer_load_short_d16_hi v239,v242,s[8:11],s71 offen offset:1152
M v[80:83],v[216:219],a[200:203],v[80:83]
s_waitcnt lgkmcnt(4)
ds_write_b16_d16_hi v244,v231 offset:43520
M v[84:87],v[216:219],a[204:207],v[84:87]
s_waitcnt lgkmcnt(4)
buffer_load_short_d16_hi v240,v242,s[16:19],s71 offen offset:1536
M v[88:91],v[216:219],a[208:211],v[88:91]
s_waitcnt vmcnt(19) lgkmcnt(3)
v_lshlrev_b32 v230,16,v208
v_lshlrev_b32 v228,16,v204
M v[92:95],v[216:219],a[212:215],v[92:95]
buffer_store_dwordx4 a[76:79],v248,s[24:27],s34 offen offset:640 nt
M v[64:67],a[168:171],a[220:223],v[64:67]
s_nop 0
s_add_u32 s34,s33,0
ds_read_b128 a[220:223],v245 offset:37120
v_lshlrev_b32 v229,16,v206
M v[68:71],a[168:171],a[192:195],v[68:71]
s_waitcnt vmcnt(18)
v_lshlrev_b32 v233,16,v214
v_lshlrev_b32 v232,16,v212
M v[72:75],a[168:171],a[196:199],v[72:75]
buffer_load_dwordx4 a[236:239],v247,s[20:23],s48 offen offset:0 sc1
M v[76:79],a[168:171],a[200:203],v[76:79]
v_lshlrev_b32 v231,16,v210
v_fmac_f32 v228,s43,v230
M v[80:83],a[168:171],a[204:207],v[80:83]
v_fmac_f32 v233,4.0,v229
v_fma_f32 v234,-4.0,v230,v232
M v[84:87],a[168:171],a[208:211],v[84:87]
v_fmac_f32 v228,s45,v232
v_fmac_f32 v233,s41,v231
M v[88:91],a[168:171],a[212:215],v[88:91]
s_waitcnt lgkmcnt(3)
buffer_load_dwordx4 a[140:143],v247,s[20:23],s48 offen offset:1024 sc1
M v[92:95],a[168:171],a[216:219],v[92:95]
v_sub_f32 v232,v232,v230
v_fma_f32 v230,-4.0,v229,v231
M v[64:67],a[148:151],a[192:195],v[64:67]
ds_read_b128 a[192:195],v245 offset:52224
v_sub_f32 v231,v231,v229
M v[68:71],a[148:151],a[196:199],v[68:71]
ds_read_b128 a[196:199],v246 offset:52480
v_add_f32 v229,v234,v230
M v[72:75],a[148:151],a[200:203],v[72:75]
buffer_load_dwordx4 a[104:107],v247,s[20:23],s48 offen offset:2048 sc1
M v[76:79],a[148:151],a[204:207],v[76:79]
s_add_u32 s48,s79,52224
ds_read_b128 a[200:203],v246 offset:52736
ds_read_b128 a[204:207],v246 offset:52992
M v[80:83],a[148:151],a[208:211],v[80:83]
ds_read_b128 a[208:211],v246 offset:53248
v_sub_f32 v234,v234,v230
M v[84:87],a[148:151],a[212:215],v[84:87]
ds_read_b128 a[212:215],v246 offset:53504
v_fma_f32 v230,2.0,v231,v232
M v[88:91],a[148:151],a[216:219],v[88:91]
s_waitcnt lgkmcnt(6)
buffer_store_dwordx4 v[32:35],v248,s[24:27],s34 offen offset:128 nt
M v[92:95],a[148:151],a[220:223],v[92:95]
s_waitcnt lgkmcnt(5)
s_add_u32 s34,s33,393216
ds_read_b128 a[216:219],v246 offset:53760
ds_read_b128 a[220:223],v246 offset:54016
M v[64:67],v[220:223],a[192:195],v[64:67]
s_waitcnt lgkmcnt(6)
ds_read_b128 a[192:195],v246 offset:54272
v_fmac_f32 v232,-2.0,v231
M v[68:71],v[220:223],a[196:199],v[68:71]
s_waitcnt lgkmcnt(6)
buffer_load_dwordx4 a[180:183],v247,s[20:23],s48 offen offset:0 sc1
M v[72:75],v[220:223],a[200:203],v[72:75]
s_waitcnt lgkmcnt(5)
v_and_b32 v208,s42,v208
v_and_b32 v204,s42,v204
M v[76:79],v[220:223],a[204:207],v[76:79]
s_waitcnt lgkmcnt(4)
v_and_b32 v206,s42,v206
v_and_b32 v214,s42,v214
M v[80:83],v[220:223],a[208:211],v[80:83]
s_waitcnt lgkmcnt(3)
v_and_b32 v212,s42,v212
v_and_b32 v210,s42,v210
M v[84:87],v[220:223],a[212:215],v[84:87]
s_waitcnt lgkmcnt(2)
buffer_load_dwordx4 a[120:123],v247,s[20:23],s48 offen offset:1024 sc1
M v[88:91],v[220:223],a[216:219],v[88:91]
s_waitcnt lgkmcnt(1)
v_fmac_f32 v204,s43,v208
v_fmac_f32 v214,4.0,v206
M v[92:95],v[220:223],a[220:223],v[92:95]
v_fma_f32 v231,-4.0,v208,v212
v_fmac_f32 v204,s45,v212
M v[64:67],a[172:175],a[196:199],v[64:67]
ds_read_b128 a[196:199],v245 offset:54528
v_fmac_f32 v214,s41,v210
M v[68:71],a[172:175],a[200:203],v[68:71]
buffer_store_dwordx4 v[40:43],v248,s[24:27],s34 offen offset:128 nt
M v[72:75],a[172:175],a[204:207],v[72:75]
s_nop 0
s_add_u32 s34,s33,786432
v_sub_f32 v212,v212,v208
v_fma_f32 v208,-4.0,v206,v210
M v[76:79],a[172:175],a[208:211],v[76:79]
v_sub_f32 v210,v210,v206
v_add_f32 v206,v231,v208
M v[80:83],a[172:175],a[212:215],v[80:83]
buffer_load_dwordx4 a[124:127],v247,s[20:23],s48 offen offset:2048 sc1
M v[84:87],a[172:175],a[216:219],v[84:87]
s_add_u32 s48,s80,52224
v_add_u32 v245,0xfffece00,v245
v_add_u32 v246,0xfffece00,v246
M v[88:91],a[172:175],a[220:223],v[88:91]
s_waitcnt lgkmcnt(1)
v_sub_f32 v231,v231,v208
v_fma_f32 v208,2.0,v210,v212
M v[92:95],a[172:175],a[192:195],v[92:95]
v_fmac_f32 v212,-2.0,v210
v_cvt_pk_bf16_f32 v204,v228,v204
M v[64:67],a[132:135],a[200:203],v[64:67]
buffer_load_dwordx4 a[240:243],v247,s[20:23],s48 offen offset:0 sc1
M v[68:71],a[132:135],a[204:207],v[68:71]
ds_read_b128 a[200:203],v245 offset:60928
ds_read_b128 a[204:207],v246 offset:61184
M v[72:75],a[132:135],a[208:211],v[72:75]
ds_read_b128 a[208:211],v246 offset:61440
v_cvt_pk_bf16_f32 v214,v233,v214
M v[76:79],a[132:135],a[212:215],v[76:79]
ds_read_b128 a[212:215],v246 offset:61696
v_cvt_pk_bf16_f32 v206,v229,v206
M v[80:83],a[132:135],a[216:219],v[80:83]
buffer_load_dwordx4 a[160:163],v247,s[20:23],s48 offen offset:1024 sc1
M v[84:87],a[132:135],a[220:223],v[84:87]
ds_read_b128 a[216:219],v246 offset:61952
ds_read_b128 a[220:223],v246 offset:62208
M v[88:91],a[132:135],a[192:195],v[88:91]
s_waitcnt lgkmcnt(6)
ds_read_b128 a[192:195],v246 offset:62464
v_cvt_pk_bf16_f32 v210,v230,v208
M v[92:95],a[132:135],a[196:199],v[92:95]
s_waitcnt lgkmcnt(6)
ds_read_b128 a[196:199],v246 offset:62720
v_cvt_pk_bf16_f32 v208,v234,v231
M v[64:67],a[100:103],a[200:203],v[64:67]
s_waitcnt lgkmcnt(6)
buffer_store_dwordx4 v[48:51],v248,s[24:27],s34 offen offset:128 nt
M v[68:71],a[100:103],a[204:207],v[68:71]
s_waitcnt lgkmcnt(5)
ds_read_b128 a[200:203],v246 offset:62976
v_cvt_pk_bf16_f32 v212,v232,v212
M v[72:75],a[100:103],a[208:211],v[72:75]
s_waitcnt lgkmcnt(5)
s_add_u32 s34,s33,1179648
v_lshlrev_b32 v230,16,v209
v_lshlrev_b32 v228,16,v205
M v[76:79],a[100:103],a[212:215],v[76:79]
s_waitcnt lgkmcnt(4)
buffer_load_dwordx4 a[244:247],v247,s[20:23],s48 offen offset:2048 sc1
M v[80:83],a[100:103],a[216:219],v[80:83]
s_waitcnt lgkmcnt(3)
s_add_u32 s48,s81,52224
v_lshlrev_b32 v229,16,v207
v_lshlrev_b32 v233,16,v215
M v[84:87],a[100:103],a[220:223],v[84:87]
s_waitcnt lgkmcnt(2)
v_lshlrev_b32 v232,16,v213
v_lshlrev_b32 v231,16,v211
M v[88:91],a[100:103],a[192:195],v[88:91]
s_waitcnt lgkmcnt(1)
v_fmac_f32 v228,s43,v230
v_fmac_f32 v233,4.0,v229
M v[92:95],a[100:103],a[196:199],v[92:95]
buffer_load_dwordx4 a[184:187],v247,s[20:23],s48 offen offset:0 sc1
M v[64:67],a[116:119],a[204:207],v[64:67]
ds_read_b128 a[204:207],v245 offset:63232
v_fma_f32 v234,-4.0,v230,v232
M v[68:71],a[116:119],a[208:211],v[68:71]
v_fmac_f32 v228,s45,v232
v_fmac_f32 v233,s41,v231
M v[72:75],a[116:119],a[212:215],v[72:75]
v_sub_f32 v232,v232,v230
v_fma_f32 v230,-4.0,v229,v231
M v[76:79],a[116:119],a[216:219],v[76:79]
buffer_load_dwordx4 a[188:191],v247,s[20:23],s48 offen offset:1024 sc1
M v[80:83],a[116:119],a[220:223],v[80:83]
v_sub_f32 v231,v231,v229
v_add_f32 v229,v234,v230
M v[84:87],a[116:119],a[192:195],v[84:87]
v_sub_f32 v234,v234,v230
v_fma_f32 v230,2.0,v231,v232
M v[88:91],a[116:119],a[196:199],v[88:91]
s_waitcnt lgkmcnt(1)
v_fmac_f32 v232,-2.0,v231
v_and_b32 v209,s42,v209
M v[92:95],a[116:119],a[200:203],v[92:95]
buffer_store_dwordx4 v[56:59],v248,s[24:27],s34 offen offset:128 nt
M v[64:67],v[224:227],a[208:211],v[64:67]
ds_read_b128 a[208:211],v245 offset:0
v_and_b32 v205,s42,v205
M v[68:71],v[224:227],a[212:215],v[68:71]
ds_read_b128 a[212:215],v246 offset:256
v_and_b32 v207,s42,v207
M v[72:75],v[224:227],a[216:219],v[72:75]
buffer_load_dwordx4 a[108:111],v247,s[20:23],s48 offen offset:2048 sc1
M v[76:79],v[224:227],a[220:223],v[76:79]
s_add_u32 s46,s76,9216
ds_read_b128 a[216:219],v246 offset:512
ds_read_b128 a[220:223],v246 offset:768
M v[80:83],v[224:227],a[192:195],v[80:83]
ds_read_b128 a[192:195],v246 offset:1024
v_and_b32 v215,s42,v215
M v[84:87],v[224:227],a[196:199],v[84:87]
ds_read_b128 a[196:199],v246 offset:1280
v_and_b32 v213,s42,v213
M v[88:91],v[224:227],a[200:203],v[88:91]
s_waitcnt lgkmcnt(6)
buffer_load_dwordx4 a[248:251],v247,s[20:23],s46 offen offset:0 sc1
M v[92:95],v[224:227],a[204:207],v[92:95]
s_waitcnt lgkmcnt(5)
s_add_u32 s47,s76,12288
ds_read_b128 a[200:203],v246 offset:1536
ds_read_b128 a[204:207],v246 offset:1792
M v[160:163],a[152:155],a[208:211],v[160:163]
s_waitcnt lgkmcnt(6)
s_add_u32 s34,s32,786432
ds_read_b128 a[208:211],v246 offset:2048
v_and_b32 v211,s42,v211
M v[164:167],a[152:155],a[212:215],v[164:167]
s_waitcnt lgkmcnt(6)
v_fmac_f32 v205,s43,v209
v_fmac_f32 v215,4.0,v207
M v[168:171],a[152:155],a[216:219],v[168:171]
s_waitcnt lgkmcnt(5)
buffer_store_dwordx4 a[80:83],v248,s[24:27],s34 offen offset:640 nt
M v[172:175],a[152:155],a[220:223],v[172:175]
s_waitcnt lgkmcnt(4)
v_fma_f32 v231,-4.0,v209,v213
v_fmac_f32 v205,s45,v213
M v[176:179],a[152:155],a[192:195],v[176:179]
s_waitcnt lgkmcnt(3)
v_fmac_f32 v215,s41,v211
v_sub_f32 v213,v213,v209
M v[180:183],a[152:155],a[196:199],v[180:183]
s_waitcnt lgkmcnt(2)
buffer_load_dwordx4 a[96:99],v247,s[20:23],s47 offen offset:0 sc1
M v[184:187],a[152:155],a[200:203],v[184:187]
s_waitcnt lgkmcnt(1)
s_add_u32 s48,s76,15360
v_fma_f32 v209,-4.0,v207,v211
v_sub_f32 v211,v211,v207
M v[188:191],a[152:155],a[204:207],v[188:191]
v_add_f32 v207,v231,v209
v_sub_f32 v231,v231,v209
M v[160:163],a[228:231],a[212:215],v[160:163]
ds_read_b128 a[212:215],v245 offset:2304
v_fma_f32 v209,2.0,v211,v213
M v[164:167],a[228:231],a[216:219],v[164:167]
global_load_dword v251,v252,s[82:83]
v_fmac_f32 v213,-2.0,v211
M v[168:171],a[228:231],a[220:223],v[168:171]
buffer_load_dwordx4 a[144:147],v247,s[20:23],s48 offen offset:0 sc1
v_cvt_pk_bf16_f32 v205,v228,v205
M v[172:175],a[228:231],a[192:195],v[172:175]
v_cvt_pk_bf16_f32 v215,v233,v215
v_cvt_pk_bf16_f32 v207,v229,v207
M v[176:179],a[228:231],a[196:199],v[176:179]
v_cvt_pk_bf16_f32 v211,v230,v209
v_cvt_pk_bf16_f32 v209,v234,v231
v_cvt_pk_bf16_f32 v213,v232,v213
M v[180:183],a[228:231],a[200:203],v[180:183]
ds_write2st64_b64 v243,v[204:205],v[214:215] offset0:103 offset1:120
M v[184:187],a[228:231],a[204:207],v[184:187]
s_waitcnt lgkmcnt(2)
s_add_u32 s28,s64,7471104
buffer_load_dwordx2 v[204:205],v241,s[12:15],s28 offen offset:0
M v[188:191],a[228:231],a[208:211],v[188:191]
s_waitcnt vmcnt(39)
ds_write2st64_b64 v243,v[206:207],v[208:209] offset0:35 offset1:52
M v[160:163],a[232:235],a[216:219],v[160:163]
buffer_load_dwordx2 v[214:215],v241,s[16:19],s28 offen offset:1536
M v[164:167],a[232:235],a[220:223],v[164:167]
ds_write2st64_b64 v243,v[210:211],v[212:213] offset0:69 offset1:86
v_add_u32 v245,0x15400,v245
v_add_u32 v246,0x15400,v246
M v[168:171],a[232:235],a[192:195],v[168:171]
ds_read_b128 a[216:219],v245 offset:0
ds_read_b128 a[220:223],v246 offset:256
M v[172:175],a[232:235],a[196:199],v[172:175]
buffer_load_dwordx2 v[206:207],v241,s[8:11],s28 offen offset:0
M v[176:179],a[232:235],a[200:203],v[176:179]
ds_read_b128 a[192:195],v246 offset:512
ds_read_b128 a[196:199],v246 offset:768
M v[180:183],a[232:235],a[204:207],v[180:183]
s_add_u32 s34,s32,983040
ds_read_b128 a[200:203],v246 offset:1024
ds_read_b128 a[204:207],v246 offset:1280
M v[184:187],a[232:235],a[208:211],v[184:187]
s_waitcnt vmcnt(33) lgkmcnt(9)
ds_read_b128 a[208:211],v246 offset:1536
v_lshlrev_b32 v230,16,v196
M v[188:191],a[232:235],a[212:215],v[188:191]
s_waitcnt lgkmcnt(6)
buffer_load_dwordx2 v[208:209],v241,s[8:11],s28 offen offset:384
M v[160:163],a[176:179],a[216:219],v[160:163]
s_waitcnt lgkmcnt(5)
ds_read_b128 a[212:215],v246 offset:1792
ds_read_b128 a[216:219],v246 offset:2048
M v[164:167],a[176:179],a[220:223],v[164:167]
s_waitcnt lgkmcnt(6)
v_lshlrev_b32 v228,16,v192
v_lshlrev_b32 v229,16,v194
M v[168:171],a[176:179],a[192:195],v[168:171]
s_waitcnt vmcnt(32) lgkmcnt(5)
v_lshlrev_b32 v233,16,v202
v_lshlrev_b32 v232,16,v200
M v[172:175],a[176:179],a[196:199],v[172:175]
s_waitcnt lgkmcnt(4)
buffer_load_dwordx2 v[210:211],v241,s[8:11],s28 offen offset:768
v_lshlrev_b32 v231,16,v198
M v[176:179],a[176:179],a[200:203],v[176:179]
s_waitcnt lgkmcnt(3)
v_fmac_f32 v228,s43,v230
v_fmac_f32 v233,4.0,v229
v_fma_f32 v234,-4.0,v230,v232
M v[180:183],a[176:179],a[204:207],v[180:183]
s_waitcnt lgkmcnt(2)
v_fmac_f32 v228,s45,v232
v_fmac_f32 v233,s41,v231
v_sub_f32 v232,v232,v230
M v[184:187],a[176:179],a[208:211],v[184:187]
s_waitcnt lgkmcnt(1)
buffer_load_dwordx2 v[212:213],v241,s[8:11],s28 offen offset:1152
v_fma_f32 v230,-4.0,v229,v231
M v[188:191],a[176:179],a[212:215],v[188:191]
v_sub_f32 v231,v231,v229
v_add_f32 v229,v234,v230
M v[160:163],a[156:159],a[220:223],v[160:163]
ds_read_b128 a[220:223],v245 offset:2304
v_sub_f32 v234,v234,v230
v_fma_f32 v230,2.0,v231,v232
M v[164:167],a[156:159],a[192:195],v[164:167]
v_fmac_f32 v232,-2.0,v231
v_and_b32 v196,s42,v196
v_and_b32 v192,s42,v192
M v[168:171],a[156:159],a[196:199],v[168:171]
buffer_load_dwordx4 a[164:167],v247,s[20:23],s46 offen offset:1024 sc1
v_and_b32 v194,s42,v194
M v[172:175],a[156:159],a[200:203],v[172:175]
v_and_b32 v202,s42,v202
v_and_b32 v200,s42,v200
v_and_b32 v198,s42,v198
M v[176:179],a[156:159],a[204:207],v[176:179]
v_fmac_f32 v192,s43,v196
v_fmac_f32 v202,4.0,v194
M v[180:183],a[156:159],a[208:211],v[180:183]
buffer_store_dwordx4 a[84:87],v248,s[24:27],s34 offen offset:640 nt
M v[184:187],a[156:159],a[212:215],v[184:187]
s_waitcnt lgkmcnt(1)
v_fma_f32 v231,-4.0,v196,v200
v_fmac_f32 v192,s45,v200
M v[188:191],a[156:159],a[216:219],v[188:191]
v_fmac_f32 v202,s41,v198
v_sub_f32 v200,v200,v196
M v[160:163],a[136:139],a[192:195],v[160:163]
buffer_load_dwordx4 a[128:131],v247,s[20:23],s47 offen offset:1024 sc1
M v[164:167],a[136:139],a[196:199],v[164:167]
ds_read_b128 a[192:195],v245 offset:17408
ds_read_b128 a[196:199],v246 offset:17664
M v[168:171],a[136:139],a[200:203],v[168:171]
ds_read_b128 a[200:203],v246 offset:17920
v_fma_f32 v196,-4.0,v194,v198
v_sub_f32 v198,v198,v194
M v[172:175],a[136:139],a[204:207],v[172:175]
s_add_u32 s34,s32,1179648
ds_read_b128 a[204:207],v246 offset:18176
v_add_f32 v194,v231,v196
v_sub_f32 v231,v231,v196
M v[176:179],a[136:139],a[208:211],v[176:179]
buffer_load_dwordx4 a[252:255],v247,s[20:23],s48 offen offset:1024 sc1
ds_read_b128 a[208:211],v246 offset:18432
M v[180:183],a[136:139],a[212:215],v[180:183]
ds_read_b128 a[212:215],v246 offset:18688
v_fma_f32 v196,2.0,v198,v200
v_fmac_f32 v200,-2.0,v198
M v[184:187],a[136:139],a[216:219],v[184:187]
s_waitcnt lgkmcnt(6)
ds_read_b128 a[216:219],v246 offset:18944
v_cvt_pk_bf16_f32 v192,v228,v192
M v[188:191],a[136:139],a[220:223],v[188:191]
s_waitcnt vmcnt(30) lgkmcnt(6)
buffer_load_dwordx4 a[224:227],v247,s[20:23],s46 offen offset:2048 sc1
ds_read_b128 a[220:223],v246 offset:19200
M v[160:163],a[236:239],a[192:195],v[160:163]
s_waitcnt lgkmcnt(6)
ds_read_b128 a[192:195],v246 offset:19456
v_cvt_pk_bf16_f32 v202,v233,v202
v_cvt_pk_bf16_f32 v194,v229,v194
M v[164:167],a[236:239],a[196:199],v[164:167]
s_waitcnt lgkmcnt(6)
v_cvt_pk_bf16_f32 v198,v230,v196
v_cvt_pk_bf16_f32 v196,v234,v231
v_cvt_pk_bf16_f32 v200,v232,v200
M v[168:171],a[236:239],a[200:203],v[168:171]
s_waitcnt lgkmcnt(5)
buffer_store_dwordx4 a[88:91],v248,s[24:27],s34 offen offset:640 nt
M v[172:175],a[236:239],a[204:207],v[172:175]
s_waitcnt lgkmcnt(4)
v_lshlrev_b32 v230,16,v197
v_lshlrev_b32 v228,16,v193
M v[176:179],a[236:239],a[208:211],v[176:179]
s_waitcnt lgkmcnt(3)
v_lshlrev_b32 v229,16,v195
v_lshlrev_b32 v233,16,v203
M v[180:183],a[236:239],a[212:215],v[180:183]
s_waitcnt lgkmcnt(2)
buffer_load_dwordx4 a[112:115],v247,s[20:23],s47 offen offset:2048 sc1
M v[184:187],a[236:239],a[216:219],v[184:187]
s_waitcnt lgkmcnt(1)
v_lshlrev_b32 v232,16,v201
v_lshlrev_b32 v231,16,v199
M v[188:191],a[236:239],a[220:223],v[188:191]
s_waitcnt vmcnt(32)
v_fmac_f32 v228,s43,v230
v_fmac_f32 v233,4.0,v229
v_fma_f32 v234,-4.0,v230,v232
M v[160:163],a[140:143],a[196:199],v[160:163]
ds_read_b128 a[196:199],v245 offset:19712
v_fmac_f32 v228,s45,v232
v_fmac_f32 v233,s41,v231
M v[164:167],a[140:143],a[200:203],v[164:167]
v_sub_f32 v232,v232,v230
v_fma_f32 v230,-4.0,v229,v231
M v[168:171],a[140:143],a[204:207],v[168:171]
buffer_load_dwordx4 v[216:219],v247,s[20:23],s48 offen offset:2048 sc1
v_sub_f32 v231,v231,v229
M v[172:175],a[140:143],a[208:211],v[172:175]
v_add_f32 v229,v234,v230
v_sub_f32 v234,v234,v230
v_fma_f32 v230,2.0,v231,v232
M v[176:179],a[140:143],a[212:215],v[176:179]
s_add_u32 s46,s76,18432
v_fmac_f32 v232,-2.0,v231
v_and_b32 v197,s42,v197
v_and_b32 v193,s42,v193
M v[180:183],a[140:143],a[216:219],v[180:183]
v_and_b32 v195,s42,v195
v_and_b32 v203,s42,v203
v_and_b32 v201,s42,v201
M v[184:187],a[140:143],a[220:223],v[184:187]
s_waitcnt lgkmcnt(1)
v_and_b32 v199,s42,v199
v_fmac_f32 v193,s43,v197
M v[188:191],a[140:143],a[192:195],v[188:191]
s_waitcnt vmcnt(32)
v_fmac_f32 v203,4.0,v195
v_fma_f32 v231,-4.0,v197,v201
v_fmac_f32 v193,s45,v201
M v[160:163],a[104:107],a[200:203],v[160:163]
s_add_u32 s34,s32,1376256
buffer_store_dwordx4 a[92:95],v248,s[24:27],s34 offen offset:640 nt
M v[164:167],a[104:107],a[204:207],v[164:167]
ds_read_b128 a[200:203],v245 offset:34816
ds_read_b128 a[204:207],v246 offset:35072
M v[168:171],a[104:107],a[208:211],v[168:171]
buffer_load_dwordx4 a[168:171],v247,s[20:23],s46 offen offset:0 sc1
M v[172:175],a[104:107],a[212:215],v[172:175]
ds_read_b128 a[208:211],v246 offset:35328
ds_read_b128 a[212:215],v246 offset:35584
M v[176:179],a[104:107],a[216:219],v[176:179]
s_add_u32 s47,s76,21504
ds_read_b128 a[216:219],v246 offset:35840
v_fmac_f32 v203,s41,v199
M v[180:183],a[104:107],a[220:223],v[180:183]
ds_read_b128 a[220:223],v246 offset:36096
v_sub_f32 v201,v201,v197
v_fma_f32 v197,-4.0,v195,v199
M v[184:187],a[104:107],a[192:195],v[184:187]
s_waitcnt lgkmcnt(6)
ds_read_b128 a[192:195],v246 offset:36352
v_sub_f32 v199,v199,v195
v_add_f32 v195,v231,v197
M v[188:191],a[104:107],a[196:199],v[188:191]
s_waitcnt vmcnt(32) lgkmcnt(6)
ds_read_b128 a[196:199],v246 offset:36608
v_sub_f32 v231,v231,v197
v_fma_f32 v197,2.0,v199,v201
M v[160:163],a[180:183],a[200:203],v[160:163]
s_waitcnt lgkmcnt(6)
ds_read_b128 a[200:203],v246 offset:36864
v_fmac_f32 v201,-2.0,v199
M v[164:167],a[180:183],a[204:207],v[164:167]
s_waitcnt lgkmcnt(6)
v_cvt_pk_bf16_f32 v193,v228,v193
v_cvt_pk_bf16_f32 v203,v233,v203
v_cvt_pk_bf16_f32 v195,v229,v195
M v[168:171],a[180:183],a[208:211],v[168:171]
s_waitcnt lgkmcnt(5)
buffer_load_dwordx4 v[220:223],v247,s[20:23],s47 offen offset:0 sc1
v_cvt_pk_bf16_f32 v199,v230,v197
M v[172:175],a[180:183],a[212:215],v[172:175]
s_waitcnt lgkmcnt(4)
v_cvt_pk_bf16_f32 v197,v234,v231
v_cvt_pk_bf16_f32 v201,v232,v201
M v[176:179],a[180:183],a[216:219],v[176:179]
s_waitcnt lgkmcnt(3)
s_add_u32 s48,s76,24576
ds_write2st64_b64 v243,v[192:193],v[202:203] offset0:104 offset1:121
M v[180:183],a[180:183],a[220:223],v[180:183]
s_waitcnt lgkmcnt(3)
s_add_u32 s28,s65,6291456
buffer_load_dwordx2 v[192:193],v241,s[12:15],s28 offen offset:0
M v[184:187],a[180:183],a[192:195],v[184:187]
s_waitcnt lgkmcnt(2)
ds_write2st64_b64 v243,v[194:195],v[196:197] offset0:36 offset1:53
M v[188:191],a[180:183],a[196:199],v[188:191]
s_waitcnt vmcnt(33)
buffer_load_dwordx2 v[202:203],v241,s[16:19],s28 offen offset:1536
M v[160:163],a[120:123],a[204:207],v[160:163]
ds_read_b128 a[204:207],v245 offset:37120
ds_write2st64_b64 v243,v[198:199],v[200:201] offset0:70 offset1:87
M v[164:167],a[120:123],a[208:211],v[164:167]
s_barrier
v_cvt_pk_bf16_f32 v64,v64,v65
M v[168:171],a[120:123],a[212:215],v[168:171]
buffer_load_dwordx2 v[194:195],v241,s[8:11],s28 offen offset:0
M v[172:175],a[120:123],a[216:219],v[172:175]
v_cvt_pk_bf16_f32 v65,v66,v67
v_cvt_pk_bf16_f32 v68,v68,v69
M v[176:179],a[120:123],a[220:223],v[176:179]
v_cvt_pk_bf16_f32 v69,v70,v71
M v[180:183],a[120:123],a[192:195],v[180:183]
ds_write2st64_b64 v249,v[64:65],v[68:69] offset0:136 offset1:140
M v[184:187],a[120:123],a[196:199],v[184:187]
s_waitcnt lgkmcnt(5)
s_add_u32 s34,s33,0
buffer_load_dwordx2 v[196:197],v241,s[8:11],s28 offen offset:384
M v[188:191],a[120:123],a[200:203],v[188:191]
s_waitcnt vmcnt(34)
v_cvt_pk_bf16_f32 v72,v72,v73
v_cvt_pk_bf16_f32 v73,v74,v75
M v[160:163],a[124:127],a[208:211],v[160:163]
ds_read_b128 a[208:211],v245 offset:52224
v_cvt_pk_bf16_f32 v76,v76,v77
M v[164:167],a[124:127],a[212:215],v[164:167]
buffer_load_dwordx2 v[198:199],v241,s[8:11],s28 offen offset:768
M v[168:171],a[124:127],a[216:219],v[168:171]
ds_read_b128 a[212:215],v246 offset:52480
ds_read_b128 a[216:219],v246 offset:52736
M v[172:175],a[124:127],a[220:223],v[172:175]
ds_read_b128 a[220:223],v246 offset:52992
v_cvt_pk_bf16_f32 v77,v78,v79
M v[176:179],a[124:127],a[192:195],v[176:179]
ds_read_b128 a[192:195],v246 offset:53248
ds_write2st64_b64 v249,v[72:73],v[76:77] offset0:144 offset1:148
M v[180:183],a[124:127],a[196:199],v[180:183]
buffer_load_dwordx2 v[200:201],v241,s[8:11],s28 offen offset:1152
M v[184:187],a[124:127],a[200:203],v[184:187]
s_waitcnt lgkmcnt(8)
ds_read_b128 a[196:199],v246 offset:53504
ds_read_b128 a[200:203],v246 offset:53760
M v[188:191],a[124:127],a[204:207],v[188:191]
s_waitcnt vmcnt(35) lgkmcnt(7)
ds_read_b128 a[204:207],v246 offset:54016
v_cvt_pk_bf16_f32 v80,v80,v81
M v[160:163],a[240:243],a[208:211],v[160:163]
s_waitcnt lgkmcnt(7)
buffer_load_dwordx4 v[224:227],v247,s[20:23],s48 offen offset:0 sc1
ds_read_b128 a[208:211],v246 offset:54272
M v[164:167],a[240:243],a[212:215],v[164:167]
s_waitcnt lgkmcnt(7)
v_cvt_pk_bf16_f32 v81,v82,v83
v_cvt_pk_bf16_f32 v84,v84,v85
M v[168:171],a[240:243],a[216:219],v[168:171]
s_waitcnt lgkmcnt(6)
v_cvt_pk_bf16_f32 v85,v86,v87
M v[172:175],a[240:243],a[220:223],v[172:175]
s_waitcnt lgkmcnt(5)
ds_write2st64_b64 v249,v[80:81],v[84:85] offset0:170 offset1:174
M v[176:179],a[240:243],a[192:195],v[176:179]
s_waitcnt lgkmcnt(4)
buffer_store_dwordx4 v[128:131],v248,s[24:27],s34 offen offset:1280 nt
M v[180:183],a[240:243],a[196:199],v[180:183]
s_waitcnt lgkmcnt(3)
v_cvt_pk_bf16_f32 v88,v88,v89
v_cvt_pk_bf16_f32 v89,v90,v91
M v[184:187],a[240:243],a[200:203],v[184:187]
s_waitcnt lgkmcnt(2)
buffer_load_dwordx4 a[228:231],v247,s[20:23],s46 offen offset:1024 sc1
M v[188:191],a[240:243],a[204:207],v[188:191]
s_waitcnt vmcnt(37)
v_cvt_pk_bf16_f32 v92,v92,v93
v_cvt_pk_bf16_f32 v93,v94,v95
M v[160:163],a[160:163],a[212:215],v[160:163]
ds_write2st64_b64 v249,v[88:89],v[92:93] offset0:178 offset1:182
M v[164:167],a[160:163],a[216:219],v[164:167]
buffer_load_dwordx4 a[232:235],v247,s[20:23],s47 offen offset:1024 sc1
M v[168:171],a[160:163],a[220:223],v[168:171]
s_waitcnt vmcnt(23)
ds_read_b128 a[212:215],v245 offset:54528
v_lshlrev_b32 v230,16,v208
v_lshlrev_b32 v228,16,v204
v_lshlrev_b32 v229,16,v206
M v[172:175],a[160:163],a[192:195],v[172:175]
s_waitcnt vmcnt(21)
s_add_u32 s34,s33,393216
v_lshlrev_b32 v233,16,v214
v_lshlrev_b32 v232,16,v212
v_lshlrev_b32 v231,16,v210
M v[176:179],a[160:163],a[196:199],v[176:179]
s_waitcnt lgkmcnt(1)
s_barrier
ds_read_b128 v[64:67],v4 offset:0
v_fmac_f32 v228,s43,v230
v_fmac_f32 v233,4.0,v229
v_fma_f32 v234,-4.0,v230,v232
M v[180:183],a[160:163],a[200:203],v[180:183]
ds_read_b128 v[72:75],v4 offset:4096
ds_read_b128 v[80:83],v4 offset:17408
v_fmac_f32 v228,s45,v232
v_fmac_f32 v233,s41,v231
v_sub_f32 v232,v232,v230
v_fma_f32 v230,-4.0,v229,v231
M v[184:187],a[160:163],a[204:207],v[184:187]
ds_read_b128 v[88:91],v4 offset:21504
v_add_u32 v245,0xfffece00,v245
v_sub_f32 v231,v231,v229
v_add_f32 v229,v234,v230
v_sub_f32 v234,v234,v230
v_fma_f32 v230,2.0,v231,v232
M v[188:191],a[160:163],a[208:211],v[188:191]
buffer_load_dwordx4 a[236:239],v247,s[20:23],s48 offen offset:1024 sc1
v_fmac_f32 v232,-2.0,v231
v_and_b32 v208,s42,v208
v_and_b32 v204,s42,v204
v_and_b32 v206,s42,v206
M v[160:163],a[244:247],a[216:219],v[160:163]
buffer_store_dwordx4 v[136:139],v248,s[24:27],s34 offen offset:1280 nt
v_and_b32 v214,s42,v214
v_and_b32 v212,s42,v212
v_and_b32 v210,s42,v210
v_fmac_f32 v204,s43,v208
M v[164:167],a[244:247],a[220:223],v[164:167]
v_add_u32 v246,0xfffece00,v246
v_fmac_f32 v214,4.0,v206
v_fma_f32 v231,-4.0,v208,v212
v_fmac_f32 v204,s45,v212
v_fmac_f32 v214,s41,v210
M v[168:171],a[244:247],a[192:195],v[168:171]
ds_read_b128 a[216:219],v245 offset:60928
ds_read_b128 a[220:223],v246 offset:61184
v_sub_f32 v212,v212,v208
v_fma_f32 v208,-4.0,v206,v210
v_sub_f32 v210,v210,v206
v_add_f32 v206,v231,v208
M v[172:175],a[244:247],a[196:199],v[172:175]
buffer_load_dwordx4 a[240:243],v247,s[20:23],s46 offen offset:2048 sc1
v_sub_f32 v231,v231,v208
v_fma_f32 v208,2.0,v210,v212
v_fmac_f32 v212,-2.0,v210
v_cvt_pk_bf16_f32 v204,v228,v204
M v[176:179],a[244:247],a[200:203],v[176:179]
ds_read_b128 a[192:195],v246 offset:61440
ds_read_b128 a[196:199],v246 offset:61696
v_cvt_pk_bf16_f32 v214,v233,v214
v_cvt_pk_bf16_f32 v206,v229,v206
v_cvt_pk_bf16_f32 v210,v230,v208
v_cvt_pk_bf16_f32 v208,v234,v231
M v[180:183],a[244:247],a[204:207],v[180:183]
ds_read_b128 a[200:203],v246 offset:61952
ds_read_b128 a[204:207],v246 offset:62208
v_cvt_pk_bf16_f32 v212,v232,v212
v_lshlrev_b32 v230,16,v209
v_lshlrev_b32 v228,16,v205
v_lshlrev_b32 v229,16,v207
M v[184:187],a[244:247],a[208:211],v[184:187]
s_waitcnt lgkmcnt(10)
ds_read_b128 a[208:211],v246 offset:62464
v_lshlrev_b32 v233,16,v215
v_lshlrev_b32 v232,16,v213
v_lshlrev_b32 v231,16,v211
v_fmac_f32 v228,s43,v230
M v[188:191],a[244:247],a[212:215],v[188:191]
s_waitcnt lgkmcnt(6)
ds_read_b128 a[212:215],v246 offset:62720
v_fmac_f32 v233,4.0,v229
v_fma_f32 v234,-4.0,v230,v232
v_fmac_f32 v228,s45,v232
v_fmac_f32 v233,s41,v231
M v[160:163],a[184:187],a[216:219],v[160:163]
s_waitcnt lgkmcnt(6)
ds_read_b128 a[216:219],v246 offset:62976
v_sub_f32 v232,v232,v230
v_fma_f32 v230,-4.0,v229,v231
v_sub_f32 v231,v231,v229
v_add_f32 v229,v234,v230
M v[164:167],a[184:187],a[220:223],v[164:167]
s_waitcnt lgkmcnt(6)
v_sub_f32 v234,v234,v230
v_fma_f32 v230,2.0,v231,v232
v_fmac_f32 v232,-2.0,v231
v_and_b32 v209,s42,v209
M v[168:171],a[184:187],a[192:195],v[168:171]
s_waitcnt lgkmcnt(5)
buffer_load_dwordx4 a[244:247],v247,s[20:23],s47 offen offset:2048 sc1
v_and_b32 v205,s42,v205
v_and_b32 v207,s42,v207
v_and_b32 v215,s42,v215
v_and_b32 v213,s42,v213
M v[172:175],a[184:187],a[196:199],v[172:175]
s_waitcnt lgkmcnt(4)
v_and_b32 v211,s42,v211
v_fmac_f32 v205,s43,v209
v_fmac_f32 v215,4.0,v207
v_fma_f32 v231,-4.0,v209,v213
M v[176:179],a[184:187],a[200:203],v[176:179]
s_waitcnt lgkmcnt(3)
v_fmac_f32 v205,s45,v213
v_fmac_f32 v215,s41,v211
v_sub_f32 v213,v213,v209
v_fma_f32 v209,-4.0,v207,v211
M v[180:183],a[184:187],a[204:207],v[180:183]
s_waitcnt lgkmcnt(2)
v_sub_f32 v211,v211,v207
v_add_f32 v207,v231,v209
v_sub_f32 v231,v231,v209
v_fma_f32 v209,2.0,v211,v213
M v[184:187],a[184:187],a[208:211],v[184:187]
s_waitcnt lgkmcnt(1)
v_fmac_f32 v213,-2.0,v211
v_cvt_pk_bf16_f32 v205,v228,v205
v_cvt_pk_bf16_f32 v215,v233,v215
v_cvt_pk_bf16_f32 v207,v229,v207
M v[188:191],a[184:187],a[212:215],v[188:191]
v_cvt_pk_bf16_f32 v211,v230,v209
v_cvt_pk_bf16_f32 v209,v234,v231
v_cvt_pk_bf16_f32 v213,v232,v213
M v[160:163],a[188:191],a[220:223],v[160:163]
ds_write2st64_b64 v243,v[204:205],v[214:215] offset0:105 offset1:122
M v[164:167],a[188:191],a[192:195],v[164:167]
s_add_u32 s28,s65,6684672
buffer_load_dwordx2 v[204:205],v241,s[12:15],s28 offen offset:0
ds_write2st64_b64 v243,v[206:207],v[208:209] offset0:37 offset1:54
M v[168:171],a[188:191],a[196:199],v[168:171]
s_add_u32 s34,s33,786432
buffer_load_dwordx2 v[214:215],v241,s[16:19],s28 offen offset:1536
M v[172:175],a[188:191],a[200:203],v[172:175]
ds_write2st64_b64 v243,v[210:211],v[212:213] offset0:71 offset1:88
M v[176:179],a[188:191],a[204:207],v[176:179]
ds_read_b128 a[220:223],v245 offset:63232
M v[180:183],a[188:191],a[208:211],v[180:183]
buffer_load_dwordx2 v[206:207],v241,s[8:11],s28 offen offset:0
M v[184:187],a[188:191],a[212:215],v[184:187]
s_waitcnt lgkmcnt(0)
s_barrier
M v[188:191],a[188:191],a[216:219],v[188:191]
M v[160:163],a[108:111],a[192:195],v[160:163]
ds_read_b128 a[192:195],v245 offset:0
M v[164:167],a[108:111],a[196:199],v[164:167]
buffer_load_dwordx2 v[208:209],v241,s[8:11],s28 offen offset:384
M v[168:171],a[108:111],a[200:203],v[168:171]
ds_read_b128 a[196:199],v246 offset:256
ds_read_b128 a[200:203],v246 offset:512
M v[172:175],a[108:111],a[204:207],v[172:175]
ds_read_b128 a[204:207],v246 offset:768
v_cvt_pk_bf16_f32 v160,v160,v161
M v[176:179],a[108:111],a[208:211],v[176:179]
ds_read_b128 a[208:211],v246 offset:1024
v_cvt_pk_bf16_f32 v161,v162,v163
M v[180:183],a[108:111],a[212:215],v[180:183]
buffer_load_dwordx2 v[210:211],v241,s[8:11],s28 offen offset:768
M v[184:187],a[108:111],a[216:219],v[184:187]
ds_read_b128 a[212:215],v246 offset:1280
ds_read_b128 a[216:219],v246 offset:1536
M v[188:191],a[108:111],a[220:223],v[188:191]
s_waitcnt lgkmcnt(6)
ds_read_b128 a[220:223],v246 offset:1792
v_cvt_pk_bf16_f32 v164,v164,v165
M a[0:3],a[248:251],a[192:195],0
s_waitcnt lgkmcnt(6)
v_cvt_pk_bf16_f32 v165,v166,v167
M a[4:7],a[248:251],a[196:199],0
s_waitcnt lgkmcnt(5)
buffer_load_dwordx2 v[212:213],v241,s[8:11],s28 offen offset:1152
M a[8:11],a[248:251],a[200:203],0
s_waitcnt lgkmcnt(4)
ds_write2st64_b64 v249,v[160:161],v[164:165] offset0:204 offset1:208
M a[12:15],a[248:251],a[204:207],0
s_waitcnt lgkmcnt(4)
v_cvt_pk_bf16_f32 v168,v168,v169
v_cvt_pk_bf16_f32 v169,v170,v171
M a[16:19],a[248:251],a[208:211],0
s_waitcnt lgkmcnt(3)
v_cvt_pk_bf16_f32 v172,v172,v173
v_cvt_pk_bf16_f32 v173,v174,v175
M a[20:23],a[248:251],a[212:215],0
s_waitcnt lgkmcnt(2)
buffer_store_dwordx4 v[144:147],v248,s[24:27],s34 offen offset:1280 nt
M a[24:27],a[248:251],a[216:219],0
s_waitcnt lgkmcnt(1)
s_add_u32 s34,s33,1179648
ds_write2st64_b64 v249,v[168:169],v[172:173] offset0:212 offset1:216
M a[28:31],a[248:251],a[220:223],0
buffer_store_dwordx4 v[152:155],v248,s[24:27],s34 offen offset:1280 nt
M a[32:35],a[96:99],a[192:195],0
v_cvt_pk_bf16_f32 v176,v176,v177
v_cvt_pk_bf16_f32 v177,v178,v179
M a[36:39],a[96:99],a[196:199],0
v_cvt_pk_bf16_f32 v180,v180,v181
v_cvt_pk_bf16_f32 v181,v182,v183
M a[40:43],a[96:99],a[200:203],0
buffer_load_dwordx4 a[248:251],v247,s[20:23],s48 offen offset:2048 sc1
M a[44:47],a[96:99],a[204:207],0
ds_write2st64_b64 v249,v[176:177],v[180:181] offset0:238 offset1:242
M a[48:51],a[96:99],a[208:211],0
v_cvt_pk_bf16_f32 v184,v184,v185
v_cvt_pk_bf16_f32 v185,v186,v187
M a[52:55],a[96:99],a[212:215],0
v_cvt_pk_bf16_f32 v188,v188,v189
v_cvt_pk_bf16_f32 v189,v190,v191
M a[56:59],a[96:99],a[216:219],0
ds_write2st64_b64 v249,v[184:185],v[188:189] offset0:246 offset1:250
M a[60:63],a[96:99],a[220:223],0
s_waitcnt vmcnt(19)
v_lshlrev_b32 v230,16,v196
v_lshlrev_b32 v228,16,v192
M a[64:67],a[144:147],a[192:195],0
ds_read_b128 a[192:195],v246 offset:2048
v_lshlrev_b32 v229,16,v194
M a[68:71],a[144:147],a[196:199],0
s_waitcnt vmcnt(17)
v_lshlrev_b32 v233,16,v202
v_lshlrev_b32 v232,16,v200
M a[72:75],a[144:147],a[200:203],0
v_lshlrev_b32 v231,16,v198
M a[76:79],a[144:147],a[204:207],0
s_waitcnt lgkmcnt(1)
s_barrier
ds_read_b128 v[160:163],v4 offset:34816
M a[80:83],a[144:147],a[208:211],0
ds_read_b128 v[168:171],v4 offset:38912
ds_read_b128 v[176:179],v4 offset:52224
M a[84:87],a[144:147],a[212:215],0
ds_read_b128 v[184:187],v4 offset:56320
v_fmac_f32 v228,s43,v230
M a[88:91],a[144:147],a[216:219],0
v_fmac_f32 v233,4.0,v229
v_fma_f32 v234,-4.0,v230,v232
M a[92:95],a[144:147],a[220:223],0
v_fmac_f32 v228,s45,v232
v_fmac_f32 v233,s41,v231
M a[0:3],a[164:167],a[196:199],a[0:3]
v_sub_f32 v232,v232,v230
v_fma_f32 v230,-4.0,v229,v231
M a[4:7],a[164:167],a[200:203],a[4:7]
v_sub_f32 v231,v231,v229
v_add_f32 v229,v234,v230
M a[8:11],a[164:167],a[204:207],a[8:11]
v_sub_f32 v234,v234,v230
v_fma_f32 v230,2.0,v231,v232
M a[12:15],a[164:167],a[208:211],a[12:15]
v_fmac_f32 v232,-2.0,v231
v_and_b32 v196,s42,v196
M a[16:19],a[164:167],a[212:215],a[16:19]
s_add_u32 s34,s33,0
buffer_store_dwordx4 v[64:67],v248,s[24:27],s34 offen offset:256 nt
M a[20:23],a[164:167],a[216:219],a[20:23]
v_and_b32 v192,s42,v192
v_and_b32 v194,s42,v194
M a[24:27],a[164:167],a[220:223],a[24:27]
s_waitcnt lgkmcnt(4)
v_and_b32 v202,s42,v202
v_and_b32 v200,s42,v200
M a[28:31],a[164:167],a[192:195],a[28:31]
v_and_b32 v198,s42,v198
v_fmac_f32 v192,s43,v196
M a[32:35],a[128:131],a[196:199],a[32:35]
v_fmac_f32 v202,4.0,v194
v_fma_f32 v231,-4.0,v196,v200
M a[36:39],a[128:131],a[200:203],a[36:39]
v_fmac_f32 v192,s45,v200
v_fmac_f32 v202,s41,v198
M a[40:43],a[128:131],a[204:207],a[40:43]
v_sub_f32 v200,v200,v196
v_fma_f32 v196,-4.0,v194,v198
M a[44:47],a[128:131],a[208:211],a[44:47]
v_sub_f32 v198,v198,v194
v_add_f32 v194,v231,v196
M a[48:51],a[128:131],a[212:215],a[48:51]
v_sub_f32 v231,v231,v196
v_fma_f32 v196,2.0,v198,v200
M a[52:55],a[128:131],a[216:219],a[52:55]
v_fmac_f32 v200,-2.0,v198
v_cvt_pk_bf16_f32 v192,v228,v192
M a[56:59],a[128:131],a[220:223],a[56:59]
v_cvt_pk_bf16_f32 v202,v233,v202
v_cvt_pk_bf16_f32 v194,v229,v194
M a[60:63],a[128:131],a[192:195],a[60:63]
v_cvt_pk_bf16_f32 v198,v230,v196
v_cvt_pk_bf16_f32 v196,v234,v231
M a[64:67],a[252:255],a[196:199],a[64:67]
ds_read_b128 a[196:199],v245 offset:2304
v_cvt_pk_bf16_f32 v200,v232,v200
M a[68:71],a[252:255],a[200:203],a[68:71]
s_add_u32 s46,s76,27648
v_lshlrev_b32 v230,16,v197
v_lshlrev_b32 v228,16,v193
M a[72:75],a[252:255],a[204:207],a[72:75]
v_lshlrev_b32 v229,16,v195
v_lshlrev_b32 v233,16,v203
M a[76:79],a[252:255],a[208:211],a[76:79]
v_lshlrev_b32 v232,16,v201
v_lshlrev_b32 v231,16,v199
M a[80:83],a[252:255],a[212:215],a[80:83]
v_fmac_f32 v228,s43,v230
v_fmac_f32 v233,4.0,v229
M a[84:87],a[252:255],a[216:219],a[84:87]
v_fma_f32 v234,-4.0,v230,v232
v_fmac_f32 v228,s45,v232
M a[88:91],a[252:255],a[220:223],a[88:91]
v_fmac_f32 v233,s41,v231
v_sub_f32 v232,v232,v230
M a[92:95],a[252:255],a[192:195],a[92:95]
buffer_load_dwordx4 a[252:255],v247,s[20:23],s46 offen offset:0 sc1
M a[0:3],a[224:227],a[200:203],a[0:3]
v_fma_f32 v230,-4.0,v229,v231
v_sub_f32 v231,v231,v229
M a[4:7],a[224:227],a[204:207],a[4:7]
s_add_u32 s47,s76,30720
s_add_u32 s34,s33,393216
v_add_f32 v229,v234,v230
M a[8:11],a[224:227],a[208:211],a[8:11]
buffer_store_dwordx4 v[72:75],v248,s[24:27],s34 offen offset:256 nt
M a[12:15],a[224:227],a[212:215],a[12:15]
v_sub_f32 v234,v234,v230
v_fma_f32 v230,2.0,v231,v232
M a[16:19],a[224:227],a[216:219],a[16:19]
v_fmac_f32 v232,-2.0,v231
v_and_b32 v197,s42,v197
M a[20:23],a[224:227],a[220:223],a[20:23]
v_and_b32 v193,s42,v193
v_and_b32 v195,s42,v195
M a[24:27],a[224:227],a[192:195],a[24:27]
s_waitcnt lgkmcnt(0)
v_and_b32 v203,s42,v203
v_and_b32 v201,s42,v201
M a[28:31],a[224:227],a[196:199],a[28:31]
buffer_load_dwordx4 a[224:227],v247,s[20:23],s47 offen offset:0 sc1
M a[32:35],a[112:115],a[200:203],a[32:35]
v_and_b32 v199,s42,v199
v_fmac_f32 v193,s43,v197
M a[36:39],a[112:115],a[204:207],a[36:39]
v_fmac_f32 v203,4.0,v195
v_fma_f32 v231,-4.0,v197,v201
M a[40:43],a[112:115],a[208:211],a[40:43]
v_fmac_f32 v193,s45,v201
v_fmac_f32 v203,s41,v199
M a[44:47],a[112:115],a[212:215],a[44:47]
v_sub_f32 v201,v201,v197
v_fma_f32 v197,-4.0,v195,v199
M a[48:51],a[112:115],a[216:219],a[48:51]
v_sub_f32 v199,v199,v195
v_add_f32 v195,v231,v197
M a[52:55],a[112:115],a[220:223],a[52:55]
v_sub_f32 v231,v231,v197
v_fma_f32 v197,2.0,v199,v201
M a[56:59],a[112:115],a[192:195],a[56:59]
v_fmac_f32 v201,-2.0,v199
v_cvt_pk_bf16_f32 v193,v228,v193
M a[60:63],a[112:115],a[196:199],a[60:63]
v_cvt_pk_bf16_f32 v203,v233,v203
v_cvt_pk_bf16_f32 v195,v229,v195
M a[64:67],v[216:219],a[200:203],a[64:67]
ds_read_b128 a[200:203],v245 offset:8704
v_cvt_pk_bf16_f32 v199,v230,v197
M a[68:71],v[216:219],a[204:207],a[68:71]
s_add_u32 s48,s76,33792
ds_read_b128 a[204:207],v246 offset:8960
v_cvt_pk_bf16_f32 v197,v234,v231
M a[72:75],v[216:219],a[208:211],a[72:75]
ds_read_b128 a[208:211],v246 offset:9216
v_cvt_pk_bf16_f32 v201,v232,v201
M a[76:79],v[216:219],a[212:215],a[76:79]
ds_read_b128 a[212:215],v246 offset:9472
ds_write2st64_b64 v243,v[192:193],v[202:203] offset0:170 offset1:187
M a[80:83],v[216:219],a[216:219],a[80:83]
s_add_u32 s28,s65,7077888
buffer_load_dwordx2 v[192:193],v241,s[12:15],s28 offen offset:0
M a[84:87],v[216:219],a[220:223],a[84:87]
ds_read_b128 a[216:219],v246 offset:9728
ds_read_b128 a[220:223],v246 offset:9984
M a[88:91],v[216:219],a[192:195],a[88:91]
buffer_load_dwordx2 v[202:203],v241,s[16:19],s28 offen offset:1536
M a[92:95],v[216:219],a[196:199],a[92:95]
s_waitcnt lgkmcnt(6)
s_add_u32 s34,s33,786432
ds_read_b128 a[192:195],v246 offset:10240
ds_read_b128 a[196:199],v246 offset:10496
M a[96:99],a[168:171],a[200:203],0
s_waitcnt lgkmcnt(7)
ds_write2st64_b64 v243,v[194:195],v[196:197] offset0:0 offset1:17
M a[100:103],a[168:171],a[204:207],0
s_waitcnt lgkmcnt(7)
ds_write2st64_b64 v243,v[198:199],v[200:201] offset0:136 offset1:153
M a[104:107],a[168:171],a[208:211],0
s_waitcnt lgkmcnt(7)
buffer_load_dwordx2 v[194:195],v241,s[8:11],s28 offen offset:0
M a[108:111],a[168:171],a[212:215],0
s_waitcnt vmcnt(12) lgkmcnt(5)
v_lshlrev_b32 v230,16,v208
v_lshlrev_b32 v228,16,v204
M a[112:115],a[168:171],a[216:219],0
s_waitcnt lgkmcnt(4)
v_lshlrev_b32 v229,16,v206
v_lshlrev_b32 v233,16,v214
M a[116:119],a[168:171],a[220:223],0
s_waitcnt lgkmcnt(3)
buffer_load_dwordx2 v[196:197],v241,s[8:11],s28 offen offset:384
M a[120:123],a[168:171],a[192:195],0
s_waitcnt vmcnt(11) lgkmcnt(2)
v_lshlrev_b32 v232,16,v212
v_lshlrev_b32 v231,16,v210
M a[124:127],a[168:171],a[196:199],0
v_fmac_f32 v228,s43,v230
v_fmac_f32 v233,4.0,v229
M a[128:131],v[220:223],a[200:203],0
v_fma_f32 v234,-4.0,v230,v232
v_fmac_f32 v228,s45,v232
M a[132:135],v[220:223],a[204:207],0
buffer_load_dwordx2 v[198:199],v241,s[8:11],s28 offen offset:768
M a[136:139],v[220:223],a[208:211],0
v_fmac_f32 v233,s41,v231
v_sub_f32 v232,v232,v230
M a[140:143],v[220:223],a[212:215],0
v_fma_f32 v230,-4.0,v229,v231
v_sub_f32 v231,v231,v229
M a[144:147],v[220:223],a[216:219],0
v_add_f32 v229,v234,v230
v_sub_f32 v234,v234,v230
M a[148:151],v[220:223],a[220:223],0
buffer_load_dwordx2 v[200:201],v241,s[8:11],s28 offen offset:1152
M a[152:155],v[220:223],a[192:195],0
v_fma_f32 v230,2.0,v231,v232
v_fmac_f32 v232,-2.0,v231
M a[156:159],v[220:223],a[196:199],0
v_and_b32 v208,s42,v208
v_and_b32 v204,s42,v204
M a[160:163],v[224:227],a[200:203],0
ds_read_b128 a[200:203],v246 offset:10752
v_and_b32 v206,s42,v206
M a[164:167],v[224:227],a[204:207],0
buffer_load_dwordx4 v[216:219],v247,s[20:23],s48 offen offset:0 sc1
M a[168:171],v[224:227],a[208:211],0
v_and_b32 v214,s42,v214
v_and_b32 v212,s42,v212
M a[172:175],v[224:227],a[212:215],0
v_and_b32 v210,s42,v210
v_fmac_f32 v204,s43,v208
M a[176:179],v[224:227],a[216:219],0
v_fmac_f32 v214,4.0,v206
v_fma_f32 v231,-4.0,v208,v212
M a[180:183],v[224:227],a[220:223],0
buffer_store_dwordx4 v[80:83],v248,s[24:27],s34 offen offset:256 nt
M a[184:187],v[224:227],a[192:195],0
s_nop 0
s_add_u32 s34,s33,1179648
v_fmac_f32 v204,s45,v212
v_fmac_f32 v214,s41,v210
M a[188:191],v[224:227],a[196:199],0
v_sub_f32 v212,v212,v208
v_fma_f32 v208,-4.0,v206,v210
M a[96:99],a[228:231],a[204:207],a[96:99]
buffer_load_dwordx4 v[220:223],v247,s[20:23],s46 offen offset:1024 sc1
M a[100:103],a[228:231],a[208:211],a[100:103]
v_sub_f32 v210,v210,v206
v_add_f32 v206,v231,v208
M a[104:107],a[228:231],a[212:215],a[104:107]
v_sub_f32 v231,v231,v208
v_fma_f32 v208,2.0,v210,v212
M a[108:111],a[228:231],a[216:219],a[108:111]
v_fmac_f32 v212,-2.0,v210
v_cvt_pk_bf16_f32 v204,v228,v204
M a[112:115],a[228:231],a[220:223],a[112:115]
buffer_store_dwordx4 v[88:91],v248,s[24:27],s34 offen offset:256 nt
M a[116:119],a[228:231],a[192:195],a[116:119]
v_cvt_pk_bf16_f32 v214,v233,v214
v_cvt_pk_bf16_f32 v206,v229,v206
M a[120:123],a[228:231],a[196:199],a[120:123]
s_waitcnt lgkmcnt(0)
v_cvt_pk_bf16_f32 v210,v230,v208
v_cvt_pk_bf16_f32 v208,v234,v231
M a[124:127],a[228:231],a[200:203],a[124:127]
buffer_load_dwordx4 v[224:227],v247,s[20:23],s47 offen offset:1024 sc1
M a[128:131],a[232:235],a[204:207],a[128:131]
v_cvt_pk_bf16_f32 v212,v232,v212
v_lshlrev_b32 v230,16,v209
M a[132:135],a[232:235],a[208:211],a[132:135]
v_lshlrev_b32 v228,16,v205
v_lshlrev_b32 v229,16,v207
M a[136:139],a[232:235],a[212:215],a[136:139]
v_lshlrev_b32 v233,16,v215
v_lshlrev_b32 v232,16,v213
M a[140:143],a[232:235],a[216:219],a[140:143]
buffer_load_dwordx4 a[228:231],v247,s[20:23],s48 offen offset:1024 sc1
M a[144:147],a[232:235],a[220:223],a[144:147]
v_lshlrev_b32 v231,16,v211
v_fmac_f32 v228,s43,v230
M a[148:151],a[232:235],a[192:195],a[148:151]
v_fmac_f32 v233,4.0,v229
v_fma_f32 v234,-4.0,v230,v232
M a[152:155],a[232:235],a[196:199],a[152:155]
v_fmac_f32 v228,s45,v232
v_fmac_f32 v233,s41,v231
M a[156:159],a[232:235],a[200:203],a[156:159]
buffer_load_dwordx4 a[232:235],v247,s[20:23],s46 offen offset:2048 sc1
M a[160:163],a[236:239],a[204:207],a[160:163]
ds_read_b128 a[204:207],v245 offset:11008
v_sub_f32 v232,v232,v230
M a[164:167],a[236:239],a[208:211],a[164:167]
v_fma_f32 v230,-4.0,v229,v231
v_sub_f32 v231,v231,v229
M a[168:171],a[236:239],a[212:215],a[168:171]
s_add_u32 s34,s33,0
v_add_f32 v229,v234,v230
v_sub_f32 v234,v234,v230
M a[172:175],a[236:239],a[216:219],a[172:175]
buffer_store_dwordx4 v[160:163],v248,s[24:27],s34 offen offset:1408 nt
M a[176:179],a[236:239],a[220:223],a[176:179]
v_fma_f32 v230,2.0,v231,v232
v_fmac_f32 v232,-2.0,v231
M a[180:183],a[236:239],a[192:195],a[180:183]
v_and_b32 v209,s42,v209
v_and_b32 v205,s42,v205
M a[184:187],a[236:239],a[196:199],a[184:187]
v_and_b32 v207,s42,v207
v_and_b32 v215,s42,v215
M a[188:191],a[236:239],a[200:203],a[188:191]
buffer_load_dwordx4 a[236:239],v247,s[20:23],s47 offen offset:2048 sc1
M a[96:99],a[240:243],a[208:211],a[96:99]
v_and_b32 v213,s42,v213
v_and_b32 v211,s42,v211
M a[100:103],a[240:243],a[212:215],a[100:103]
v_fmac_f32 v205,s43,v209
v_fmac_f32 v215,4.0,v207
M a[104:107],a[240:243],a[216:219],a[104:107]
v_fma_f32 v231,-4.0,v209,v213
v_fmac_f32 v205,s45,v213
M a[108:111],a[240:243],a[220:223],a[108:111]
v_fmac_f32 v215,s41,v211
v_sub_f32 v213,v213,v209
M a[112:115],a[240:243],a[192:195],a[112:115]
v_fma_f32 v209,-4.0,v207,v211
v_sub_f32 v211,v211,v207
M a[116:119],a[240:243],a[196:199],a[116:119]
v_add_f32 v207,v231,v209
v_sub_f32 v231,v231,v209
M a[120:123],a[240:243],a[200:203],a[120:123]
s_waitcnt lgkmcnt(0)
v_fma_f32 v209,2.0,v211,v213
v_fmac_f32 v213,-2.0,v211
M a[124:127],a[240:243],a[204:207],a[124:127]
buffer_load_dwordx4 a[240:243],v247,s[20:23],s48 offen offset:2048 sc1
M a[128:131],a[244:247],a[208:211],a[128:131]
v_cvt_pk_bf16_f32 v205,v228,v205
v_cvt_pk_bf16_f32 v215,v233,v215
M a[132:135],a[244:247],a[212:215],a[132:135]
s_add_u32 s46,s76,36864
v_cvt_pk_bf16_f32 v207,v229,v207
v_cvt_pk_bf16_f32 v211,v230,v209
M a[136:139],a[244:247],a[216:219],a[136:139]
v_cvt_pk_bf16_f32 v209,v234,v231
v_cvt_pk_bf16_f32 v213,v232,v213
M a[140:143],a[244:247],a[220:223],a[140:143]
ds_write2st64_b64 v243,v[204:205],v[214:215] offset0:171 offset1:188
M a[144:147],a[244:247],a[192:195],a[144:147]
s_add_u32 s28,s65,7471104
buffer_load_dwordx2 v[204:205],v241,s[12:15],s28 offen offset:0
M a[148:151],a[244:247],a[196:199],a[148:151]
ds_write2st64_b64 v243,v[206:207],v[208:209] offset0:1 offset1:18
M a[152:155],a[244:247],a[200:203],a[152:155]
buffer_load_dwordx2 v[214:215],v241,s[16:19],s28 offen offset:1536
M a[156:159],a[244:247],a[204:207],a[156:159]
s_waitcnt vmcnt(22)
s_add_u32 s34,s33,393216
ds_write2st64_b64 v243,v[210:211],v[212:213] offset0:137 offset1:154
M a[160:163],a[248:251],a[208:211],a[160:163]
ds_read_b128 a[208:211],v245 offset:17408
v_fmac_f32 v235,s43,v237
M a[164:167],a[248:251],a[212:215],a[164:167]
buffer_load_dwordx2 v[206:207],v241,s[8:11],s28 offen offset:0
M a[168:171],a[248:251],a[216:219],a[168:171]
ds_read_b128 a[212:215],v246 offset:17664
ds_read_b128 a[216:219],v246 offset:17920
M a[172:175],a[248:251],a[220:223],a[172:175]
ds_read_b128 a[220:223],v246 offset:18176
v_fmac_f32 v240,4.0,v236
M a[176:179],a[248:251],a[192:195],a[176:179]
ds_read_b128 a[192:195],v246 offset:18432
v_fma_f32 v228,-4.0,v237,v239
M a[180:183],a[248:251],a[196:199],a[180:183]
buffer_load_dwordx2 v[208:209],v241,s[8:11],s28 offen offset:384
M a[184:187],a[248:251],a[200:203],a[184:187]
ds_read_b128 a[196:199],v246 offset:18688
ds_read_b128 a[200:203],v246 offset:18944
M a[188:191],a[248:251],a[204:207],a[188:191]
s_waitcnt vmcnt(22) lgkmcnt(6)
ds_read_b128 a[204:207],v246 offset:19200
v_fmac_f32 v235,s45,v239
M v[0:3],a[252:255],a[208:211],0
s_waitcnt lgkmcnt(6)
v_fmac_f32 v240,s41,v238
v_sub_f32 v239,v239,v237
M v[4:7],a[252:255],a[212:215],0
s_waitcnt lgkmcnt(5)
buffer_load_dwordx2 v[210:211],v241,s[8:11],s28 offen offset:768
M v[8:11],a[252:255],a[216:219],0
s_waitcnt lgkmcnt(4)
v_fma_f32 v237,-4.0,v236,v238
v_sub_f32 v238,v238,v236
M v[12:15],a[252:255],a[220:223],0
s_waitcnt lgkmcnt(3)
v_add_f32 v236,v228,v237
v_sub_f32 v228,v228,v237
M v[16:19],a[252:255],a[192:195],0
s_waitcnt lgkmcnt(2)
v_fma_f32 v237,2.0,v238,v239
v_fmac_f32 v239,-2.0,v238
M v[20:23],a[252:255],a[196:199],0
s_waitcnt lgkmcnt(1)
buffer_load_dwordx2 v[212:213],v241,s[8:11],s28 offen offset:1152
M v[24:27],a[252:255],a[200:203],0
s_waitcnt lgkmcnt(0)
v_cvt_pk_bf16_f32 v229,v235,v240
v_cvt_pk_bf16_f32 v230,v236,v228
M v[28:31],a[252:255],a[204:207],0
s_waitcnt vmcnt(22)
v_cvt_pk_bf16_f32 v231,v237,v239
v_add_u32 v228,87040,v244
M v[32:35],a[224:227],a[208:211],0
ds_write_b16 v228,v229 offset:0
M v[36:39],a[224:227],a[212:215],0
buffer_load_short_d16_hi v235,v242,s[12:15],s72 offen offset:0
M v[40:43],a[224:227],a[216:219],0
ds_write_b16_d16_hi v228,v229 offset:8704
M v[44:47],a[224:227],a[220:223],0
buffer_load_short_d16_hi v236,v242,s[8:11],s72 offen offset:0
M v[48:51],a[224:227],a[192:195],0
ds_write_b16 v244,v230 offset:0
M v[52:55],a[224:227],a[196:199],0
buffer_load_short_d16_hi v237,v242,s[8:11],s72 offen offset:384
M v[56:59],a[224:227],a[200:203],0
ds_write_b16_d16_hi v244,v230 offset:8704
M v[60:63],a[224:227],a[204:207],0
s_waitcnt vmcnt(18)
buffer_load_short_d16_hi v238,v242,s[8:11],s72 offen offset:768
M v[64:67],v[216:219],a[208:211],0
ds_read_b128 a[208:211],v246 offset:19456
v_add_u32 v228,69632,v244
M v[68:71],v[216:219],a[212:215],0
buffer_load_short_d16_hi v239,v242,s[8:11],s72 offen offset:1152
M v[72:75],v[216:219],a[216:219],0
ds_write_b16 v228,v231 offset:0
M v[76:79],v[216:219],a[220:223],0
buffer_load_short_d16_hi v240,v242,s[16:19],s72 offen offset:1536
M v[80:83],v[216:219],a[192:195],0
ds_write_b16_d16_hi v228,v231 offset:8704
M v[84:87],v[216:219],a[196:199],0
buffer_load_dwordx4 a[244:247],v247,s[20:23],s46 offen offset:0 sc1
M v[88:91],v[216:219],a[200:203],0
s_add_u32 s47,s76,39936
v_lshlrev_b32 v230,16,v196
v_lshlrev_b32 v228,16,v192
M v[92:95],v[216:219],a[204:207],0
s_waitcnt vmcnt(20)
v_lshlrev_b32 v229,16,v194
v_lshlrev_b32 v233,16,v202
M v[0:3],v[220:223],a[212:215],v[0:3]
v_lshlrev_b32 v232,16,v200
v_lshlrev_b32 v231,16,v198
M v[4:7],v[220:223],a[216:219],v[4:7]
buffer_store_dwordx4 v[168:171],v248,s[24:27],s34 offen offset:1408 nt
M v[8:11],v[220:223],a[220:223],v[8:11]
s_nop 0
s_add_u32 s34,s33,786432
v_fmac_f32 v228,s43,v230
v_fmac_f32 v233,4.0,v229
M v[12:15],v[220:223],a[192:195],v[12:15]
v_fma_f32 v234,-4.0,v230,v232
v_fmac_f32 v228,s45,v232
M v[16:19],v[220:223],a[196:199],v[16:19]
buffer_load_dwordx4 a[248:251],v247,s[20:23],s47 offen offset:0 sc1
M v[20:23],v[220:223],a[200:203],v[20:23]
s_add_u32 s48,s76,43008
v_fmac_f32 v233,s41,v231
v_sub_f32 v232,v232,v230
M v[24:27],v[220:223],a[204:207],v[24:27]
s_waitcnt lgkmcnt(2)
v_fma_f32 v230,-4.0,v229,v231
v_sub_f32 v231,v231,v229
M v[28:31],v[220:223],a[208:211],v[28:31]
s_waitcnt vmcnt(20)
v_add_f32 v229,v234,v230
v_sub_f32 v234,v234,v230
M v[32:35],v[224:227],a[212:215],v[32:35]
global_load_dword v251,v252,s[82:83]
M v[36:39],v[224:227],a[216:219],v[36:39]
v_fma_f32 v230,2.0,v231,v232
v_fmac_f32 v232,-2.0,v231
M v[40:43],v[224:227],a[220:223],v[40:43]
buffer_load_dwordx4 a[252:255],v247,s[20:23],s48 offen offset:0 sc1
M v[44:47],v[224:227],a[192:195],v[44:47]
v_and_b32 v196,s42,v196
v_and_b32 v192,s42,v192
M v[48:51],v[224:227],a[196:199],v[48:51]
v_and_b32 v194,s42,v194
v_and_b32 v202,s42,v202
M v[52:55],v[224:227],a[200:203],v[52:55]
v_and_b32 v200,s42,v200
v_and_b32 v198,s42,v198
M v[56:59],v[224:227],a[204:207],v[56:59]
buffer_store_dwordx4 v[176:179],v248,s[24:27],s34 offen offset:1408 nt
M v[60:63],v[224:227],a[208:211],v[60:63]
s_waitcnt vmcnt(22)
s_add_u32 s34,s33,1179648
v_fmac_f32 v192,s43,v196
v_fmac_f32 v202,4.0,v194
M v[64:67],a[228:231],a[212:215],v[64:67]
ds_read_b128 a[212:215],v245 offset:19712
v_fma_f32 v231,-4.0,v196,v200
M v[68:71],a[228:231],a[216:219],v[68:71]
buffer_load_dwordx4 a[224:227],v247,s[20:23],s46 offen offset:1024 sc1
M v[72:75],a[228:231],a[220:223],v[72:75]
v_fmac_f32 v192,s45,v200
v_fmac_f32 v202,s41,v198
M v[76:79],a[228:231],a[192:195],v[76:79]
v_sub_f32 v200,v200,v196
v_fma_f32 v196,-4.0,v194,v198
M v[80:83],a[228:231],a[196:199],v[80:83]
v_sub_f32 v198,v198,v194
v_add_f32 v194,v231,v196
M v[84:87],a[228:231],a[200:203],v[84:87]
buffer_load_dwordx4 v[216:219],v247,s[20:23],s47 offen offset:1024 sc1
M v[88:91],a[228:231],a[204:207],v[88:91]
v_sub_f32 v231,v231,v196
v_fma_f32 v196,2.0,v198,v200
M v[92:95],a[228:231],a[208:211],v[92:95]
s_waitcnt vmcnt(23)
v_fmac_f32 v200,-2.0,v198
v_cvt_pk_bf16_f32 v192,v228,v192
M v[0:3],a[232:235],a[216:219],v[0:3]
v_cvt_pk_bf16_f32 v202,v233,v202
v_cvt_pk_bf16_f32 v194,v229,v194
M v[4:7],a[232:235],a[220:223],v[4:7]
buffer_load_dwordx4 v[220:223],v247,s[20:23],s48 offen offset:1024 sc1
M v[8:11],a[232:235],a[192:195],v[8:11]
v_cvt_pk_bf16_f32 v198,v230,v196
v_cvt_pk_bf16_f32 v196,v234,v231
M v[12:15],a[232:235],a[196:199],v[12:15]
v_cvt_pk_bf16_f32 v200,v232,v200
v_lshlrev_b32 v230,16,v197
M v[16:19],a[232:235],a[200:203],v[16:19]
v_lshlrev_b32 v228,16,v193
v_lshlrev_b32 v229,16,v195
M v[20:23],a[232:235],a[204:207],v[20:23]
buffer_store_dwordx4 v[184:187],v248,s[24:27],s34 offen offset:1408 nt
M v[24:27],a[232:235],a[208:211],v[24:27]
s_waitcnt lgkmcnt(0)
v_lshlrev_b32 v233,16,v203
v_lshlrev_b32 v232,16,v201
M v[28:31],a[232:235],a[212:215],v[28:31]
s_waitcnt vmcnt(23)
v_lshlrev_b32 v231,16,v199
v_fmac_f32 v228,s43,v230
M v[32:35],a[236:239],a[216:219],v[32:35]
buffer_load_dwordx4 v[224:227],v247,s[20:23],s46 offen offset:2048 sc1
M v[36:39],a[236:239],a[220:223],v[36:39]
v_fmac_f32 v233,4.0,v229
v_fma_f32 v234,-4.0,v230,v232
M v[40:43],a[236:239],a[192:195],v[40:43]
v_fmac_f32 v228,s45,v232
v_fmac_f32 v233,s41,v231
M v[44:47],a[236:239],a[196:199],v[44:47]
v_sub_f32 v232,v232,v230
v_fma_f32 v230,-4.0,v229,v231
M v[48:51],a[236:239],a[200:203],v[48:51]
buffer_load_dwordx4 a[228:231],v247,s[20:23],s47 offen offset:2048 sc1
M v[52:55],a[236:239],a[204:207],v[52:55]
v_sub_f32 v231,v231,v229
v_add_f32 v229,v234,v230
M v[56:59],a[236:239],a[208:211],v[56:59]
v_sub_f32 v234,v234,v230
v_fma_f32 v230,2.0,v231,v232
M v[60:63],a[236:239],a[212:215],v[60:63]
s_waitcnt vmcnt(24)
v_fmac_f32 v232,-2.0,v231
v_and_b32 v197,s42,v197
M v[64:67],a[240:243],a[216:219],v[64:67]
buffer_load_dwordx4 a[232:235],v247,s[20:23],s48 offen offset:2048 sc1
M v[68:71],a[240:243],a[220:223],v[68:71]
s_add_u32 s46,s77,9216
ds_read_b128 a[216:219],v245 offset:26112
ds_read_b128 a[220:223],v246 offset:26368
M v[72:75],a[240:243],a[192:195],v[72:75]
ds_read_b128 a[192:195],v246 offset:26624
v_and_b32 v193,s42,v193
M v[76:79],a[240:243],a[196:199],v[76:79]
ds_read_b128 a[196:199],v246 offset:26880
v_and_b32 v195,s42,v195
M v[80:83],a[240:243],a[200:203],v[80:83]
buffer_load_dwordx4 a[236:239],v247,s[20:23],s46 offen offset:0 sc1
M v[84:87],a[240:243],a[204:207],v[84:87]
s_add_u32 s47,s77,12288
ds_read_b128 a[200:203],v246 offset:27136
ds_read_b128 a[204:207],v246 offset:27392
M v[88:91],a[240:243],a[208:211],v[88:91]
ds_read_b128 a[208:211],v246 offset:27648
v_and_b32 v203,s42,v203
M v[92:95],a[240:243],a[212:215],v[92:95]
s_waitcnt vmcnt(13) lgkmcnt(6)
ds_read_b128 a[212:215],v246 offset:27904
v_and_b32 v201,s42,v201
M v[96:99],a[244:247],a[216:219],0
s_waitcnt lgkmcnt(6)
buffer_load_dwordx4 a[240:243],v247,s[20:23],s47 offen offset:0 sc1
M v[100:103],a[244:247],a[220:223],0
s_waitcnt lgkmcnt(5)
s_add_u32 s48,s77,15360
v_and_b32 v199,s42,v199
v_fmac_f32 v193,s43,v197
M v[104:107],a[244:247],a[192:195],0
s_waitcnt lgkmcnt(4)
v_fmac_f32 v203,4.0,v195
v_fma_f32 v231,-4.0,v197,v201
M v[108:111],a[244:247],a[196:199],0
s_waitcnt lgkmcnt(3)
v_fmac_f32 v193,s45,v201
v_fmac_f32 v203,s41,v199
M v[112:115],a[244:247],a[200:203],0
s_waitcnt lgkmcnt(2)
v_sub_f32 v201,v201,v197
v_fma_f32 v197,-4.0,v195,v199
M v[116:119],a[244:247],a[204:207],0
s_waitcnt lgkmcnt(1)
v_sub_f32 v199,v199,v195
v_add_f32 v195,v231,v197
M v[120:123],a[244:247],a[208:211],0
s_waitcnt lgkmcnt(0)
v_sub_f32 v231,v231,v197
v_fma_f32 v197,2.0,v199,v201
M v[124:127],a[244:247],a[212:215],0
s_waitcnt vmcnt(12)
buffer_load_dwordx4 a[244:247],v247,s[20:23],s48 offen offset:0 sc1
M v[128:131],a[248:251],a[216:219],0
v_fmac_f32 v201,-2.0,v199
v_cvt_pk_bf16_f32 v193,v228,v193
M v[132:135],a[248:251],a[220:223],0
v_cvt_pk_bf16_f32 v203,v233,v203
v_cvt_pk_bf16_f32 v195,v229,v195
M v[136:139],a[248:251],a[192:195],0
v_cvt_pk_bf16_f32 v199,v230,v197
v_cvt_pk_bf16_f32 v197,v234,v231
M v[140:143],a[248:251],a[196:199],0
v_cvt_pk_bf16_f32 v201,v232,v201
M v[144:147],a[248:251],a[200:203],0
ds_write2st64_b64 v243,v[192:193],v[202:203] offset0:172 offset1:189
M v[148:151],a[248:251],a[204:207],0
s_add_u32 s28,s66,6291456
buffer_load_dwordx2 v[192:193],v241,s[12:15],s28 offen offset:0
M v[152:155],a[248:251],a[208:211],0
ds_write2st64_b64 v243,v[194:195],v[196:197] offset0:2 offset1:19
M v[156:159],a[248:251],a[212:215],0
s_waitcnt vmcnt(12)
buffer_load_dwordx2 v[202:203],v241,s[16:19],s28 offen offset:1536
M v[160:163],a[252:255],a[216:219],0
ds_read_b128 a[216:219],v246 offset:28160
ds_write2st64_b64 v243,v[198:199],v[200:201] offset0:138 offset1:155
M v[164:167],a[252:255],a[220:223],0
v_lshlrev_b32 v230,16,v208
v_lshlrev_b32 v228,16,v204
M v[168:171],a[252:255],a[192:195],0
buffer_load_dwordx2 v[194:195],v241,s[8:11],s28 offen offset:0
M v[172:175],a[252:255],a[196:199],0
v_lshlrev_b32 v229,16,v206
v_lshlrev_b32 v233,16,v214
M v[176:179],a[252:255],a[200:203],0
v_lshlrev_b32 v232,16,v212
v_lshlrev_b32 v231,16,v210
M v[180:183],a[252:255],a[204:207],0
v_fmac_f32 v228,s43,v230
v_fmac_f32 v233,4.0,v229
M v[184:187],a[252:255],a[208:211],0
buffer_load_dwordx2 v[196:197],v241,s[8:11],s28 offen offset:384
M v[188:191],a[252:255],a[212:215],0
s_waitcnt vmcnt(13)
v_fma_f32 v234,-4.0,v230,v232
v_fmac_f32 v228,s45,v232
M v[96:99],a[224:227],a[220:223],v[96:99]
v_fmac_f32 v233,s41,v231
v_sub_f32 v232,v232,v230
M v[100:103],a[224:227],a[192:195],v[100:103]
v_fma_f32 v230,-4.0,v229,v231
v_sub_f32 v231,v231,v229
M v[104:107],a[224:227],a[196:199],v[104:107]
buffer_load_dwordx2 v[198:199],v241,s[8:11],s28 offen offset:768
M v[108:111],a[224:227],a[200:203],v[108:111]
v_add_f32 v229,v234,v230
v_sub_f32 v234,v234,v230
M v[112:115],a[224:227],a[204:207],v[112:115]
v_fma_f32 v230,2.0,v231,v232
v_fmac_f32 v232,-2.0,v231
M v[116:119],a[224:227],a[208:211],v[116:119]
v_and_b32 v208,s42,v208
v_and_b32 v204,s42,v204
M v[120:123],a[224:227],a[212:215],v[120:123]
s_waitcnt lgkmcnt(1)
buffer_load_dwordx2 v[200:201],v241,s[8:11],s28 offen offset:1152
M v[124:127],a[224:227],a[216:219],v[124:127]
s_waitcnt vmcnt(14)
v_and_b32 v206,s42,v206
v_and_b32 v214,s42,v214
M v[128:131],v[216:219],a[220:223],v[128:131]
v_and_b32 v212,s42,v212
v_and_b32 v210,s42,v210
M v[132:135],v[216:219],a[192:195],v[132:135]
v_fmac_f32 v204,s43,v208
v_fmac_f32 v214,4.0,v206
M v[136:139],v[216:219],a[196:199],v[136:139]
buffer_load_dwordx4 a[248:251],v247,s[20:23],s46 offen offset:1024 sc1
M v[140:143],v[216:219],a[200:203],v[140:143]
v_fma_f32 v231,-4.0,v208,v212
v_fmac_f32 v204,s45,v212
M v[144:147],v[216:219],a[204:207],v[144:147]
v_fmac_f32 v214,s41,v210
v_sub_f32 v212,v212,v208
M v[148:151],v[216:219],a[208:211],v[148:151]
v_fma_f32 v208,-4.0,v206,v210
v_sub_f32 v210,v210,v206
M v[152:155],v[216:219],a[212:215],v[152:155]
buffer_load_dwordx4 a[252:255],v247,s[20:23],s47 offen offset:1024 sc1
M v[156:159],v[216:219],a[216:219],v[156:159]
s_waitcnt vmcnt(15)
v_add_f32 v206,v231,v208
v_sub_f32 v231,v231,v208
M v[160:163],v[220:223],a[220:223],v[160:163]
ds_read_b128 a[220:223],v245 offset:28416
v_fma_f32 v208,2.0,v210,v212
M v[164:167],v[220:223],a[192:195],v[164:167]
v_fmac_f32 v212,-2.0,v210
v_cvt_pk_bf16_f32 v204,v228,v204
M v[168:171],v[220:223],a[196:199],v[168:171]
buffer_load_dwordx4 a[224:227],v247,s[20:23],s48 offen offset:1024 sc1
M v[172:175],v[220:223],a[200:203],v[172:175]
v_cvt_pk_bf16_f32 v214,v233,v214
v_cvt_pk_bf16_f32 v206,v229,v206
M v[176:179],v[220:223],a[204:207],v[176:179]
v_cvt_pk_bf16_f32 v210,v230,v208
v_cvt_pk_bf16_f32 v208,v234,v231
M v[180:183],v[220:223],a[208:211],v[180:183]
v_cvt_pk_bf16_f32 v212,v232,v212
v_lshlrev_b32 v230,16,v209
v_lshlrev_b32 v228,16,v205
v_lshlrev_b32 v229,16,v207
M v[184:187],v[220:223],a[212:215],v[184:187]
buffer_load_dwordx4 v[216:219],v247,s[20:23],s46 offen offset:2048 sc1
v_lshlrev_b32 v233,16,v215
v_lshlrev_b32 v232,16,v213
v_lshlrev_b32 v231,16,v211
v_fmac_f32 v228,s43,v230
M v[188:191],v[220:223],a[216:219],v[188:191]
s_waitcnt vmcnt(15)
v_fmac_f32 v233,4.0,v229
v_fma_f32 v234,-4.0,v230,v232
v_fmac_f32 v228,s45,v232
v_fmac_f32 v233,s41,v231
M v[96:99],v[224:227],a[192:195],v[96:99]
buffer_load_dwordx4 v[220:223],v247,s[20:23],s47 offen offset:2048 sc1
v_sub_f32 v232,v232,v230
v_fma_f32 v230,-4.0,v229,v231
v_sub_f32 v231,v231,v229
v_add_f32 v229,v234,v230
M v[100:103],v[224:227],a[196:199],v[100:103]
v_sub_f32 v234,v234,v230
v_fma_f32 v230,2.0,v231,v232
v_fmac_f32 v232,-2.0,v231
v_and_b32 v209,s42,v209
M v[104:107],v[224:227],a[200:203],v[104:107]
v_and_b32 v205,s42,v205
v_and_b32 v207,s42,v207
v_and_b32 v215,s42,v215
v_and_b32 v213,s42,v213
M v[108:111],v[224:227],a[204:207],v[108:111]
v_and_b32 v211,s42,v211
v_fmac_f32 v205,s43,v209
v_fmac_f32 v215,4.0,v207
v_fma_f32 v231,-4.0,v209,v213
M v[112:115],v[224:227],a[208:211],v[112:115]
v_fmac_f32 v205,s45,v213
v_fmac_f32 v215,s41,v211
v_sub_f32 v213,v213,v209
v_fma_f32 v209,-4.0,v207,v211
M v[116:119],v[224:227],a[212:215],v[116:119]
v_sub_f32 v211,v211,v207
v_add_f32 v207,v231,v209
v_sub_f32 v231,v231,v209
v_fma_f32 v209,2.0,v211,v213
M v[120:123],v[224:227],a[216:219],v[120:123]
s_waitcnt lgkmcnt(0)
v_fmac_f32 v213,-2.0,v211
v_cvt_pk_bf16_f32 v205,v228,v205
v_cvt_pk_bf16_f32 v215,v233,v215
v_cvt_pk_bf16_f32 v207,v229,v207
M v[124:127],v[224:227],a[220:223],v[124:127]
s_waitcnt vmcnt(15)
buffer_load_dwordx4 v[224:227],v247,s[20:23],s48 offen offset:2048 sc1
v_cvt_pk_bf16_f32 v211,v230,v209
v_cvt_pk_bf16_f32 v209,v234,v231
v_cvt_pk_bf16_f32 v213,v232,v213
M v[128:131],a[228:231],a[192:195],v[128:131]
ds_write2st64_b64 v243,v[204:205],v[214:215] offset0:173 offset1:190
M v[132:135],a[228:231],a[196:199],v[132:135]
s_add_u32 s28,s66,6684672
buffer_load_dwordx2 v[204:205],v241,s[12:15],s28 offen offset:0
ds_write2st64_b64 v243,v[206:207],v[208:209] offset0:3 offset1:20
M v[136:139],a[228:231],a[200:203],v[136:139]
s_add_u32 s46,s77,18432
ds_write2st64_b64 v243,v[210:211],v[212:213] offset0:139 offset1:156
M v[140:143],a[228:231],a[204:207],v[140:143]
buffer_load_dwordx2 v[214:215],v241,s[16:19],s28 offen offset:1536
M v[144:147],a[228:231],a[208:211],v[144:147]
s_waitcnt vmcnt(10)
v_lshlrev_b32 v230,16,v196
v_lshlrev_b32 v228,16,v192
M v[148:151],a[228:231],a[212:215],v[148:151]
v_add_u32 v245,0xffffbc00,v245
v_add_u32 v246,0xffffbc00,v246
M v[152:155],a[228:231],a[216:219],v[152:155]
s_waitcnt lgkmcnt(0)
s_barrier
v_lshlrev_b32 v229,16,v194
M v[156:159],a[228:231],a[220:223],v[156:159]
buffer_load_dwordx2 v[206:207],v241,s[8:11],s28 offen offset:0
M v[160:163],a[232:235],a[192:195],v[160:163]
ds_read_b128 a[192:195],v245 offset:0
v_lshlrev_b32 v233,16,v202
M v[164:167],a[232:235],a[196:199],v[164:167]
s_waitcnt vmcnt(9)
ds_read_b128 a[196:199],v246 offset:256
v_lshlrev_b32 v232,16,v200
M v[168:171],a[232:235],a[200:203],v[168:171]
buffer_load_dwordx2 v[208:209],v241,s[8:11],s28 offen offset:384
M v[172:175],a[232:235],a[204:207],v[172:175]
ds_read_b128 a[200:203],v246 offset:512
ds_read_b128 a[204:207],v246 offset:768
M v[176:179],a[232:235],a[208:211],v[176:179]
ds_read_b128 a[208:211],v246 offset:1024
v_lshlrev_b32 v231,16,v198
M v[180:183],a[232:235],a[212:215],v[180:183]
ds_read_b128 a[212:215],v246 offset:1280
v_fmac_f32 v228,s43,v230
M v[184:187],a[232:235],a[216:219],v[184:187]
buffer_load_dwordx2 v[210:211],v241,s[8:11],s28 offen offset:768
M v[188:191],a[232:235],a[220:223],v[188:191]
s_waitcnt lgkmcnt(5)
ds_read_b128 a[216:219],v246 offset:1536
ds_read_b128 a[220:223],v246 offset:1792
M a[0:3],a[236:239],a[192:195],a[0:3]
s_waitcnt lgkmcnt(6)
v_fmac_f32 v233,4.0,v229
v_fma_f32 v234,-4.0,v230,v232
M a[4:7],a[236:239],a[196:199],a[4:7]
s_waitcnt lgkmcnt(5)
v_fmac_f32 v228,s45,v232
v_fmac_f32 v233,s41,v231
M a[8:11],a[236:239],a[200:203],a[8:11]
s_waitcnt lgkmcnt(4)
buffer_load_dwordx2 v[212:213],v241,s[8:11],s28 offen offset:1152
M a[12:15],a[236:239],a[204:207],a[12:15]
s_waitcnt lgkmcnt(3)
v_sub_f32 v232,v232,v230
v_fma_f32 v230,-4.0,v229,v231
M a[16:19],a[236:239],a[208:211],a[16:19]
s_waitcnt lgkmcnt(2)
v_sub_f32 v231,v231,v229
v_add_f32 v229,v234,v230
M a[20:23],a[236:239],a[212:215],a[20:23]
s_waitcnt lgkmcnt(1)
v_sub_f32 v234,v234,v230
v_fma_f32 v230,2.0,v231,v232
M a[24:27],a[236:239],a[216:219],a[24:27]
s_waitcnt lgkmcnt(0)
buffer_load_dwordx4 a[228:231],v247,s[20:23],s46 offen offset:0 sc1
M a[28:31],a[236:239],a[220:223],a[28:31]
s_add_u32 s47,s77,21504
v_fmac_f32 v232,-2.0,v231
v_and_b32 v196,s42,v196
M a[32:35],a[240:243],a[192:195],a[32:35]
v_and_b32 v192,s42,v192
v_and_b32 v194,s42,v194
M a[36:39],a[240:243],a[196:199],a[36:39]
v_and_b32 v202,s42,v202
v_and_b32 v200,s42,v200
M a[40:43],a[240:243],a[200:203],a[40:43]
buffer_load_dwordx4 a[232:235],v247,s[20:23],s47 offen offset:0 sc1
M a[44:47],a[240:243],a[204:207],a[44:47]
s_add_u32 s48,s77,24576
v_and_b32 v198,s42,v198
v_fmac_f32 v192,s43,v196
M a[48:51],a[240:243],a[208:211],a[48:51]
v_fmac_f32 v202,4.0,v194
v_fma_f32 v231,-4.0,v196,v200
M a[52:55],a[240:243],a[212:215],a[52:55]
v_fmac_f32 v192,s45,v200
v_fmac_f32 v202,s41,v198
M a[56:59],a[240:243],a[216:219],a[56:59]
buffer_load_dwordx4 a[236:239],v247,s[20:23],s48 offen offset:0 sc1
M a[60:63],a[240:243],a[220:223],a[60:63]
v_sub_f32 v200,v200,v196
v_fma_f32 v196,-4.0,v194,v198
M a[64:67],a[244:247],a[192:195],a[64:67]
ds_read_b128 a[192:195],v246 offset:2048
v_sub_f32 v198,v198,v194
M a[68:71],a[244:247],a[196:199],a[68:71]
v_add_f32 v194,v231,v196
v_sub_f32 v231,v231,v196
M a[72:75],a[244:247],a[200:203],a[72:75]
buffer_load_dwordx4 a[240:243],v247,s[20:23],s46 offen offset:1024 sc1
M a[76:79],a[244:247],a[204:207],a[76:79]
v_fma_f32 v196,2.0,v198,v200
v_fmac_f32 v200,-2.0,v198
M a[80:83],a[244:247],a[208:211],a[80:83]
v_cvt_pk_bf16_f32 v192,v228,v192
v_cvt_pk_bf16_f32 v202,v233,v202
M a[84:87],a[244:247],a[212:215],a[84:87]
v_cvt_pk_bf16_f32 v194,v229,v194
v_cvt_pk_bf16_f32 v198,v230,v196
M a[88:91],a[244:247],a[216:219],a[88:91]
v_cvt_pk_bf16_f32 v196,v234,v231
v_cvt_pk_bf16_f32 v200,v232,v200
M a[92:95],a[244:247],a[220:223],a[92:95]
s_waitcnt vmcnt(15)
buffer_load_dwordx4 a[244:247],v247,s[20:23],s47 offen offset:1024 sc1
M a[0:3],a[248:251],a[196:199],a[0:3]
v_lshlrev_b32 v230,16,v197
v_lshlrev_b32 v228,16,v193
M a[4:7],a[248:251],a[200:203],a[4:7]
v_lshlrev_b32 v229,16,v195
v_lshlrev_b32 v233,16,v203
M a[8:11],a[248:251],a[204:207],a[8:11]
v_lshlrev_b32 v232,16,v201
v_lshlrev_b32 v231,16,v199
M a[12:15],a[248:251],a[208:211],a[12:15]
v_fmac_f32 v228,s43,v230
v_fmac_f32 v233,4.0,v229
M a[16:19],a[248:251],a[212:215],a[16:19]
v_fma_f32 v234,-4.0,v230,v232
v_fmac_f32 v228,s45,v232
M a[20:23],a[248:251],a[216:219],a[20:23]
v_fmac_f32 v233,s41,v231
v_sub_f32 v232,v232,v230
M a[24:27],a[248:251],a[220:223],a[24:27]
s_waitcnt lgkmcnt(0)
v_fma_f32 v230,-4.0,v229,v231
v_sub_f32 v231,v231,v229
M a[28:31],a[248:251],a[192:195],a[28:31]
s_waitcnt vmcnt(15)
buffer_load_dwordx4 a[248:251],v247,s[20:23],s48 offen offset:1024 sc1
M a[32:35],a[252:255],a[196:199],a[32:35]
v_add_f32 v229,v234,v230
v_sub_f32 v234,v234,v230
M a[36:39],a[252:255],a[200:203],a[36:39]
v_fma_f32 v230,2.0,v231,v232
v_fmac_f32 v232,-2.0,v231
M a[40:43],a[252:255],a[204:207],a[40:43]
v_and_b32 v197,s42,v197
v_and_b32 v193,s42,v193
M a[44:47],a[252:255],a[208:211],a[44:47]
v_and_b32 v195,s42,v195
v_and_b32 v203,s42,v203
M a[48:51],a[252:255],a[212:215],a[48:51]
v_and_b32 v201,s42,v201
v_and_b32 v199,s42,v199
M a[52:55],a[252:255],a[216:219],a[52:55]
v_fmac_f32 v193,s43,v197
v_fmac_f32 v203,4.0,v195
M a[56:59],a[252:255],a[220:223],a[56:59]
v_fma_f32 v231,-4.0,v197,v201
v_fmac_f32 v193,s45,v201
M a[60:63],a[252:255],a[192:195],a[60:63]
s_waitcnt vmcnt(15)
buffer_load_dwordx4 a[252:255],v247,s[20:23],s46 offen offset:2048 sc1
M a[64:67],a[224:227],a[196:199],a[64:67]
ds_read_b128 a[196:199],v245 offset:2304
v_fmac_f32 v203,s41,v199
M a[68:71],a[224:227],a[200:203],a[68:71]
v_sub_f32 v201,v201,v197
v_fma_f32 v197,-4.0,v195,v199
M a[72:75],a[224:227],a[204:207],a[72:75]
v_sub_f32 v199,v199,v195
v_add_f32 v195,v231,v197
M a[76:79],a[224:227],a[208:211],a[76:79]
v_sub_f32 v231,v231,v197
v_fma_f32 v197,2.0,v199,v201
M a[80:83],a[224:227],a[212:215],a[80:83]
v_fmac_f32 v201,-2.0,v199
v_cvt_pk_bf16_f32 v193,v228,v193
M a[84:87],a[224:227],a[216:219],a[84:87]
v_cvt_pk_bf16_f32 v203,v233,v203
v_cvt_pk_bf16_f32 v195,v229,v195
M a[88:91],a[224:227],a[220:223],a[88:91]
v_cvt_pk_bf16_f32 v199,v230,v197
v_cvt_pk_bf16_f32 v197,v234,v231
M a[92:95],a[224:227],a[192:195],a[92:95]
s_waitcnt vmcnt(15)
buffer_load_dwordx4 a[224:227],v247,s[20:23],s47 offen offset:2048 sc1
M a[0:3],v[216:219],a[200:203],a[0:3]
v_cvt_pk_bf16_f32 v201,v232,v201
M a[4:7],v[216:219],a[204:207],a[4:7]
ds_write2st64_b64 v243,v[192:193],v[202:203] offset0:204 offset1:221
M a[8:11],v[216:219],a[208:211],a[8:11]
s_add_u32 s28,s66,7077888
buffer_load_dwordx2 v[192:193],v241,s[12:15],s28 offen offset:0
M a[12:15],v[216:219],a[212:215],a[12:15]
ds_write2st64_b64 v243,v[194:195],v[196:197] offset0:34 offset1:51
M a[16:19],v[216:219],a[216:219],a[16:19]
buffer_load_dwordx2 v[202:203],v241,s[16:19],s28 offen offset:1536
M a[20:23],v[216:219],a[220:223],a[20:23]
ds_write2st64_b64 v243,v[198:199],v[200:201] offset0:68 offset1:85
M a[24:27],v[216:219],a[192:195],a[24:27]
s_waitcnt vmcnt(12) lgkmcnt(3)
v_lshlrev_b32 v230,16,v208
v_lshlrev_b32 v228,16,v204
M a[28:31],v[216:219],a[196:199],a[28:31]
buffer_load_dwordx2 v[194:195],v241,s[8:11],s28 offen offset:0
M a[32:35],v[220:223],a[200:203],a[32:35]
v_lshlrev_b32 v229,16,v206
v_lshlrev_b32 v233,16,v214
M a[36:39],v[220:223],a[204:207],a[36:39]
s_waitcnt vmcnt(11)
v_lshlrev_b32 v232,16,v212
v_lshlrev_b32 v231,16,v210
M a[40:43],v[220:223],a[208:211],a[40:43]
v_fmac_f32 v228,s43,v230
v_fmac_f32 v233,4.0,v229
M a[44:47],v[220:223],a[212:215],a[44:47]
buffer_load_dwordx2 v[196:197],v241,s[8:11],s28 offen offset:384
M a[48:51],v[220:223],a[216:219],a[48:51]
v_fma_f32 v234,-4.0,v230,v232
v_fmac_f32 v228,s45,v232
M a[52:55],v[220:223],a[220:223],a[52:55]
v_fmac_f32 v233,s41,v231
v_sub_f32 v232,v232,v230
M a[56:59],v[220:223],a[192:195],a[56:59]
v_fma_f32 v230,-4.0,v229,v231
v_sub_f32 v231,v231,v229
M a[60:63],v[220:223],a[196:199],a[60:63]
buffer_load_dwordx2 v[198:199],v241,s[8:11],s28 offen offset:768
M a[64:67],v[224:227],a[200:203],a[64:67]
ds_read_b128 a[200:203],v245 offset:8704
v_add_f32 v229,v234,v230
M a[68:71],v[224:227],a[204:207],a[68:71]
ds_read_b128 a[204:207],v246 offset:8960
v_sub_f32 v234,v234,v230
M a[72:75],v[224:227],a[208:211],a[72:75]
ds_read_b128 a[208:211],v246 offset:9216
v_fma_f32 v230,2.0,v231,v232
M a[76:79],v[224:227],a[212:215],a[76:79]
buffer_load_dwordx2 v[200:201],v241,s[8:11],s28 offen offset:1152
M a[80:83],v[224:227],a[216:219],a[80:83]
ds_read_b128 a[212:215],v246 offset:9472
ds_read_b128 a[216:219],v246 offset:9728
M a[84:87],v[224:227],a[220:223],a[84:87]
ds_read_b128 a[220:223],v246 offset:9984
v_fmac_f32 v232,-2.0,v231
M a[88:91],v[224:227],a[192:195],a[88:91]
ds_read_b128 a[192:195],v246 offset:10240
v_and_b32 v208,s42,v208
M a[92:95],v[224:227],a[196:199],a[92:95]
s_waitcnt vmcnt(13) lgkmcnt(6)
buffer_load_dwordx4 v[216:219],v247,s[20:23],s48 offen offset:2048 sc1
M a[96:99],a[228:231],a[200:203],a[96:99]
s_waitcnt lgkmcnt(5)
s_add_u32 s46,s77,27648
ds_read_b128 a[196:199],v246 offset:10496
v_and_b32 v204,s42,v204
M a[100:103],a[228:231],a[204:207],a[100:103]
s_waitcnt lgkmcnt(5)
v_and_b32 v206,s42,v206
v_and_b32 v214,s42,v214
M a[104:107],a[228:231],a[208:211],a[104:107]
s_waitcnt lgkmcnt(4)
v_and_b32 v212,s42,v212
v_and_b32 v210,s42,v210
M a[108:111],a[228:231],a[212:215],a[108:111]
s_waitcnt lgkmcnt(3)
buffer_load_dwordx4 v[220:223],v247,s[20:23],s46 offen offset:0 sc1
M a[112:115],a[228:231],a[216:219],a[112:115]
s_waitcnt lgkmcnt(2)
s_add_u32 s47,s77,30720
v_fmac_f32 v204,s43,v208
v_fmac_f32 v214,4.0,v206
M a[116:119],a[228:231],a[220:223],a[116:119]
s_waitcnt lgkmcnt(1)
v_fma_f32 v231,-4.0,v208,v212
v_fmac_f32 v204,s45,v212
M a[120:123],a[228:231],a[192:195],a[120:123]
s_waitcnt lgkmcnt(0)
v_fmac_f32 v214,s41,v210
v_sub_f32 v212,v212,v208
M a[124:127],a[228:231],a[196:199],a[124:127]
s_waitcnt vmcnt(14)
buffer_load_dwordx4 v[224:227],v247,s[20:23],s47 offen offset:0 sc1
M a[128:131],a[232:235],a[200:203],a[128:131]
s_add_u32 s48,s77,33792
v_fma_f32 v208,-4.0,v206,v210
v_sub_f32 v210,v210,v206
M a[132:135],a[232:235],a[204:207],a[132:135]
v_add_f32 v206,v231,v208
v_sub_f32 v231,v231,v208
M a[136:139],a[232:235],a[208:211],a[136:139]
v_fma_f32 v208,2.0,v210,v212
v_fmac_f32 v212,-2.0,v210
M a[140:143],a[232:235],a[212:215],a[140:143]
buffer_load_dwordx4 a[228:231],v247,s[20:23],s48 offen offset:0 sc1
M a[144:147],a[232:235],a[216:219],a[144:147]
v_cvt_pk_bf16_f32 v204,v228,v204
v_cvt_pk_bf16_f32 v214,v233,v214
M a[148:151],a[232:235],a[220:223],a[148:151]
v_cvt_pk_bf16_f32 v206,v229,v206
v_cvt_pk_bf16_f32 v210,v230,v208
M a[152:155],a[232:235],a[192:195],a[152:155]
v_cvt_pk_bf16_f32 v208,v234,v231
v_cvt_pk_bf16_f32 v212,v232,v212
M a[156:159],a[232:235],a[196:199],a[156:159]
s_waitcnt vmcnt(15)
buffer_load_dwordx4 a[232:235],v247,s[20:23],s46 offen offset:1024 sc1
M a[160:163],a[236:239],a[200:203],a[160:163]
ds_read_b128 a[200:203],v246 offset:10752
v_lshlrev_b32 v230,16,v209
M a[164:167],a[236:239],a[204:207],a[164:167]
v_lshlrev_b32 v228,16,v205
v_lshlrev_b32 v229,16,v207
M a[168:171],a[236:239],a[208:211],a[168:171]
v_lshlrev_b32 v233,16,v215
v_lshlrev_b32 v232,16,v213
M a[172:175],a[236:239],a[212:215],a[172:175]
v_lshlrev_b32 v231,16,v211
v_fmac_f32 v228,s43,v230
M a[176:179],a[236:239],a[216:219],a[176:179]
v_fmac_f32 v233,4.0,v229
v_fma_f32 v234,-4.0,v230,v232
M a[180:183],a[236:239],a[220:223],a[180:183]
v_fmac_f32 v228,s45,v232
v_fmac_f32 v233,s41,v231
M a[184:187],a[236:239],a[192:195],a[184:187]
v_sub_f32 v232,v232,v230
v_fma_f32 v230,-4.0,v229,v231
M a[188:191],a[236:239],a[196:199],a[188:191]
s_waitcnt vmcnt(15)
buffer_load_dwordx4 a[236:239],v247,s[20:23],s47 offen offset:1024 sc1
M a[96:99],a[240:243],a[204:207],a[96:99]
v_sub_f32 v231,v231,v229
v_add_f32 v229,v234,v230
M a[100:103],a[240:243],a[208:211],a[100:103]
v_sub_f32 v234,v234,v230
v_fma_f32 v230,2.0,v231,v232
M a[104:107],a[240:243],a[212:215],a[104:107]
v_fmac_f32 v232,-2.0,v231
v_and_b32 v209,s42,v209
M a[108:111],a[240:243],a[216:219],a[108:111]
v_and_b32 v205,s42,v205
v_and_b32 v207,s42,v207
M a[112:115],a[240:243],a[220:223],a[112:115]
v_and_b32 v215,s42,v215
v_and_b32 v213,s42,v213
M a[116:119],a[240:243],a[192:195],a[116:119]
v_and_b32 v211,s42,v211
v_fmac_f32 v205,s43,v209
M a[120:123],a[240:243],a[196:199],a[120:123]
s_waitcnt lgkmcnt(0)
v_fmac_f32 v215,4.0,v207
v_fma_f32 v231,-4.0,v209,v213
M a[124:127],a[240:243],a[200:203],a[124:127]
s_waitcnt vmcnt(15)
buffer_load_dwordx4 a[240:243],v247,s[20:23],s48 offen offset:1024 sc1
M a[128:131],a[244:247],a[204:207],a[128:131]
v_fmac_f32 v205,s45,v213
v_fmac_f32 v215,s41,v211
M a[132:135],a[244:247],a[208:211],a[132:135]
v_sub_f32 v213,v213,v209
v_fma_f32 v209,-4.0,v207,v211
M a[136:139],a[244:247],a[212:215],a[136:139]
v_sub_f32 v211,v211,v207
v_add_f32 v207,v231,v209
M a[140:143],a[244:247],a[216:219],a[140:143]
v_sub_f32 v231,v231,v209
v_fma_f32 v209,2.0,v211,v213
M a[144:147],a[244:247],a[220:223],a[144:147]
v_fmac_f32 v213,-2.0,v211
v_cvt_pk_bf16_f32 v205,v228,v205
M a[148:151],a[244:247],a[192:195],a[148:151]
v_cvt_pk_bf16_f32 v215,v233,v215
v_cvt_pk_bf16_f32 v207,v229,v207
M a[152:155],a[244:247],a[196:199],a[152:155]
v_cvt_pk_bf16_f32 v211,v230,v209
v_cvt_pk_bf16_f32 v209,v234,v231
M a[156:159],a[244:247],a[200:203],a[156:159]
s_waitcnt vmcnt(15)
buffer_load_dwordx4 a[244:247],v247,s[20:23],s46 offen offset:2048 sc1
M a[160:163],a[248:251],a[204:207],a[160:163]
ds_read_b128 a[204:207],v245 offset:11008
v_cvt_pk_bf16_f32 v213,v232,v213
M a[164:167],a[248:251],a[208:211],a[164:167]
ds_write2st64_b64 v243,v[204:205],v[214:215] offset0:205 offset1:222
M a[168:171],a[248:251],a[212:215],a[168:171]
s_add_u32 s28,s66,7471104
buffer_load_dwordx2 v[204:205],v241,s[12:15],s28 offen offset:0
M a[172:175],a[248:251],a[216:219],a[172:175]
ds_write2st64_b64 v243,v[206:207],v[208:209] offset0:35 offset1:52
M a[176:179],a[248:251],a[220:223],a[176:179]
buffer_load_dwordx2 v[214:215],v241,s[16:19],s28 offen offset:1536
M a[180:183],a[248:251],a[192:195],a[180:183]
ds_write2st64_b64 v243,v[210:211],v[212:213] offset0:69 offset1:86
M a[184:187],a[248:251],a[196:199],a[184:187]
v_fmac_f32 v235,s43,v237
v_fmac_f32 v240,4.0,v236
M a[188:191],a[248:251],a[200:203],a[188:191]
s_waitcnt vmcnt(17)
buffer_load_dwordx2 v[206:207],v241,s[8:11],s28 offen offset:0
M a[96:99],a[252:255],a[208:211],a[96:99]
v_fma_f32 v228,-4.0,v237,v239
v_fmac_f32 v235,s45,v239
M a[100:103],a[252:255],a[212:215],a[100:103]
v_fmac_f32 v240,s41,v238
v_sub_f32 v239,v239,v237
M a[104:107],a[252:255],a[216:219],a[104:107]
v_fma_f32 v237,-4.0,v236,v238
v_sub_f32 v238,v238,v236
M a[108:111],a[252:255],a[220:223],a[108:111]
buffer_load_dwordx2 v[208:209],v241,s[8:11],s28 offen offset:384
M a[112:115],a[252:255],a[192:195],a[112:115]
v_add_f32 v236,v228,v237
v_sub_f32 v228,v228,v237
M a[116:119],a[252:255],a[196:199],a[116:119]
v_fma_f32 v237,2.0,v238,v239
v_fmac_f32 v239,-2.0,v238
M a[120:123],a[252:255],a[200:203],a[120:123]
s_waitcnt lgkmcnt(3)
v_cvt_pk_bf16_f32 v229,v235,v240
v_cvt_pk_bf16_f32 v230,v236,v228
M a[124:127],a[252:255],a[204:207],a[124:127]
s_waitcnt vmcnt(18)
buffer_load_dwordx2 v[210:211],v241,s[8:11],s28 offen offset:768
M a[128:131],a[224:227],a[208:211],a[128:131]
v_cvt_pk_bf16_f32 v231,v237,v239
v_add_u32 v228,104448,v244
M a[132:135],a[224:227],a[212:215],a[132:135]
ds_write_b16 v228,v229 offset:0
M a[136:139],a[224:227],a[216:219],a[136:139]
ds_write_b16_d16_hi v228,v229 offset:8704
M a[140:143],a[224:227],a[220:223],a[140:143]
buffer_load_dwordx2 v[212:213],v241,s[8:11],s28 offen offset:1152
M a[144:147],a[224:227],a[192:195],a[144:147]
ds_write_b16 v244,v230 offset:17408
M a[148:151],a[224:227],a[196:199],a[148:151]
ds_write_b16_d16_hi v244,v230 offset:26112
M a[152:155],a[224:227],a[200:203],a[152:155]
ds_write_b16 v244,v231 offset:34816
M a[156:159],a[224:227],a[204:207],a[156:159]
s_waitcnt vmcnt(13)
buffer_load_short_d16_hi v235,v242,s[12:15],s73 offen offset:0
M a[160:163],v[216:219],a[208:211],a[160:163]
ds_write_b16_d16_hi v244,v231 offset:43520
M a[164:167],v[216:219],a[212:215],a[164:167]
buffer_load_short_d16_hi v236,v242,s[8:11],s73 offen offset:0
v_add_u32 v245,0x4400,v245
v_add_u32 v246,0x4400,v246
M a[168:171],v[216:219],a[216:219],a[168:171]
ds_read_b128 a[208:211],v245 offset:52224
ds_read_b128 a[212:215],v246 offset:52480
M a[172:175],v[216:219],a[220:223],a[172:175]
buffer_load_short_d16_hi v237,v242,s[8:11],s73 offen offset:384
M a[176:179],v[216:219],a[192:195],a[176:179]
ds_read_b128 a[216:219],v246 offset:52736
ds_read_b128 a[220:223],v246 offset:52992
M a[180:183],v[216:219],a[196:199],a[180:183]
buffer_load_short_d16_hi v238,v242,s[8:11],s73 offen offset:768
M a[184:187],v[216:219],a[200:203],a[184:187]
ds_read_b128 a[192:195],v246 offset:53248
ds_read_b128 a[196:199],v246 offset:53504
M a[188:191],v[216:219],a[204:207],a[188:191]
s_waitcnt vmcnt(16) lgkmcnt(5)
buffer_load_short_d16_hi v239,v242,s[8:11],s73 offen offset:1152
M v[0:3],v[220:223],a[208:211],v[0:3]
s_waitcnt lgkmcnt(4)
ds_read_b128 a[200:203],v246 offset:53760
ds_read_b128 a[204:207],v246 offset:54016
M v[4:7],v[220:223],a[212:215],v[4:7]
s_waitcnt lgkmcnt(5)
buffer_load_short_d16_hi v240,v242,s[16:19],s73 offen offset:1536
M v[8:11],v[220:223],a[216:219],v[8:11]
s_waitcnt lgkmcnt(4)
v_lshlrev_b32 v230,16,v196
v_lshlrev_b32 v228,16,v192
M v[12:15],v[220:223],a[220:223],v[12:15]
s_waitcnt lgkmcnt(3)
buffer_load_dwordx4 a[248:251],v247,s[20:23],s47 offen offset:2048 sc1
M v[16:19],v[220:223],a[192:195],v[16:19]
s_waitcnt lgkmcnt(2)
v_lshlrev_b32 v229,16,v194
v_lshlrev_b32 v233,16,v202
M v[20:23],v[220:223],a[196:199],v[20:23]
s_waitcnt lgkmcnt(1)
v_lshlrev_b32 v232,16,v200
v_lshlrev_b32 v231,16,v198
M v[24:27],v[220:223],a[200:203],v[24:27]
s_waitcnt lgkmcnt(0)
v_fmac_f32 v228,s43,v230
v_fmac_f32 v233,4.0,v229
M v[28:31],v[220:223],a[204:207],v[28:31]
s_waitcnt vmcnt(18)
buffer_load_dwordx4 a[252:255],v247,s[20:23],s48 offen offset:2048 sc1
M v[32:35],v[224:227],a[208:211],v[32:35]
s_add_u32 s46,s77,36864
v_fma_f32 v234,-4.0,v230,v232
v_fmac_f32 v228,s45,v232
M v[36:39],v[224:227],a[212:215],v[36:39]
v_fmac_f32 v233,s41,v231
v_sub_f32 v232,v232,v230
M v[40:43],v[224:227],a[216:219],v[40:43]
v_fma_f32 v230,-4.0,v229,v231
v_sub_f32 v231,v231,v229
M v[44:47],v[224:227],a[220:223],v[44:47]
buffer_load_dwordx4 a[224:227],v247,s[20:23],s46 offen offset:0 sc1
M v[48:51],v[224:227],a[192:195],v[48:51]
s_add_u32 s47,s77,39936
v_add_f32 v229,v234,v230
v_sub_f32 v234,v234,v230
M v[52:55],v[224:227],a[196:199],v[52:55]
v_fma_f32 v230,2.0,v231,v232
v_fmac_f32 v232,-2.0,v231
M v[56:59],v[224:227],a[200:203],v[56:59]
v_and_b32 v196,s42,v196
v_and_b32 v192,s42,v192
M v[60:63],v[224:227],a[204:207],v[60:63]
s_waitcnt vmcnt(19)
buffer_load_dwordx4 v[216:219],v247,s[20:23],s47 offen offset:0 sc1
M v[64:67],a[228:231],a[208:211],v[64:67]
s_add_u32 s48,s77,43008
ds_read_b128 a[208:211],v246 offset:54272
v_and_b32 v194,s42,v194
M v[68:71],a[228:231],a[212:215],v[68:71]
v_and_b32 v202,s42,v202
v_and_b32 v200,s42,v200
M v[72:75],a[228:231],a[216:219],v[72:75]
v_and_b32 v198,s42,v198
v_fmac_f32 v192,s43,v196
M v[76:79],a[228:231],a[220:223],v[76:79]
global_load_dword v251,v252,s[82:83]
M v[80:83],a[228:231],a[192:195],v[80:83]
v_fmac_f32 v202,4.0,v194
v_fma_f32 v231,-4.0,v196,v200
M v[84:87],a[228:231],a[196:199],v[84:87]
buffer_load_dwordx4 v[220:223],v247,s[20:23],s48 offen offset:0 sc1
M v[88:91],a[228:231],a[200:203],v[88:91]
v_fmac_f32 v192,s45,v200
v_fmac_f32 v202,s41,v198
M v[92:95],a[228:231],a[204:207],v[92:95]
s_waitcnt vmcnt(21)
v_sub_f32 v200,v200,v196
v_fma_f32 v196,-4.0,v194,v198
M v[0:3],a[232:235],a[212:215],v[0:3]
v_sub_f32 v198,v198,v194
v_add_f32 v194,v231,v196
M v[4:7],a[232:235],a[216:219],v[4:7]
buffer_load_dwordx4 v[224:227],v247,s[20:23],s46 offen offset:1024 sc1
M v[8:11],a[232:235],a[220:223],v[8:11]
v_sub_f32 v231,v231,v196
v_fma_f32 v196,2.0,v198,v200
M v[12:15],a[232:235],a[192:195],v[12:15]
v_fmac_f32 v200,-2.0,v198
v_cvt_pk_bf16_f32 v192,v228,v192
M v[16:19],a[232:235],a[196:199],v[16:19]
v_cvt_pk_bf16_f32 v202,v233,v202
v_cvt_pk_bf16_f32 v194,v229,v194
M v[20:23],a[232:235],a[200:203],v[20:23]
buffer_load_dwordx4 a[228:231],v247,s[20:23],s47 offen offset:1024 sc1
M v[24:27],a[232:235],a[204:207],v[24:27]
s_waitcnt lgkmcnt(0)
v_cvt_pk_bf16_f32 v198,v230,v196
v_cvt_pk_bf16_f32 v196,v234,v231
M v[28:31],a[232:235],a[208:211],v[28:31]
s_waitcnt vmcnt(22)
v_cvt_pk_bf16_f32 v200,v232,v200
v_lshlrev_b32 v230,16,v197
M v[32:35],a[236:239],a[212:215],v[32:35]
v_lshlrev_b32 v228,16,v193
v_lshlrev_b32 v229,16,v195
M v[36:39],a[236:239],a[216:219],v[36:39]
buffer_load_dwordx4 a[232:235],v247,s[20:23],s48 offen offset:1024 sc1
M v[40:43],a[236:239],a[220:223],v[40:43]
v_lshlrev_b32 v233,16,v203
v_lshlrev_b32 v232,16,v201
M v[44:47],a[236:239],a[192:195],v[44:47]
v_lshlrev_b32 v231,16,v199
v_fmac_f32 v228,s43,v230
M v[48:51],a[236:239],a[196:199],v[48:51]
v_fmac_f32 v233,4.0,v229
v_fma_f32 v234,-4.0,v230,v232
M v[52:55],a[236:239],a[200:203],v[52:55]
v_fmac_f32 v228,s45,v232
v_fmac_f32 v233,s41,v231
M v[56:59],a[236:239],a[204:207],v[56:59]
v_sub_f32 v232,v232,v230
v_fma_f32 v230,-4.0,v229,v231
M v[60:63],a[236:239],a[208:211],v[60:63]
s_waitcnt vmcnt(22)
buffer_load_dwordx4 a[236:239],v247,s[20:23],s46 offen offset:2048 sc1
M v[64:67],a[240:243],a[212:215],v[64:67]
ds_read_b128 a[212:215],v245 offset:54528
v_sub_f32 v231,v231,v229
M v[68:71],a[240:243],a[216:219],v[68:71]
v_add_f32 v229,v234,v230
v_sub_f32 v234,v234,v230
M v[72:75],a[240:243],a[220:223],v[72:75]
v_fma_f32 v230,2.0,v231,v232
v_fmac_f32 v232,-2.0,v231
M v[76:79],a[240:243],a[192:195],v[76:79]
v_and_b32 v197,s42,v197
v_and_b32 v193,s42,v193
M v[80:83],a[240:243],a[196:199],v[80:83]
v_and_b32 v195,s42,v195
v_and_b32 v203,s42,v203
M v[84:87],a[240:243],a[200:203],v[84:87]
v_and_b32 v201,s42,v201
v_and_b32 v199,s42,v199
M v[88:91],a[240:243],a[204:207],v[88:91]
v_fmac_f32 v193,s43,v197
v_fmac_f32 v203,4.0,v195
M v[92:95],a[240:243],a[208:211],v[92:95]
s_waitcnt vmcnt(22)
buffer_load_dwordx4 a[240:243],v247,s[20:23],s47 offen offset:2048 sc1
M v[0:3],a[244:247],a[216:219],v[0:3]
v_fma_f32 v231,-4.0,v197,v201
v_fmac_f32 v193,s45,v201
M v[4:7],a[244:247],a[220:223],v[4:7]
v_fmac_f32 v203,s41,v199
v_sub_f32 v201,v201,v197
M v[8:11],a[244:247],a[192:195],v[8:11]
v_fma_f32 v197,-4.0,v195,v199
v_sub_f32 v199,v199,v195
M v[12:15],a[244:247],a[196:199],v[12:15]
v_add_f32 v195,v231,v197
v_sub_f32 v231,v231,v197
M v[16:19],a[244:247],a[200:203],v[16:19]
v_fma_f32 v197,2.0,v199,v201
v_fmac_f32 v201,-2.0,v199
M v[20:23],a[244:247],a[204:207],v[20:23]
v_cvt_pk_bf16_f32 v193,v228,v193
v_cvt_pk_bf16_f32 v203,v233,v203
M v[24:27],a[244:247],a[208:211],v[24:27]
s_waitcnt lgkmcnt(0)
v_cvt_pk_bf16_f32 v195,v229,v195
v_cvt_pk_bf16_f32 v199,v230,v197
M v[28:31],a[244:247],a[212:215],v[28:31]
s_waitcnt vmcnt(10)
buffer_load_dwordx4 a[244:247],v247,s[20:23],s48 offen offset:2048 sc1
M v[32:35],a[248:251],a[216:219],v[32:35]
v_cvt_pk_bf16_f32 v197,v234,v231
v_cvt_pk_bf16_f32 v201,v232,v201
M v[36:39],a[248:251],a[220:223],v[36:39]
s_add_u32 s46,s78,9216
ds_write2st64_b64 v243,v[192:193],v[202:203] offset0:206 offset1:223
M v[40:43],a[248:251],a[192:195],v[40:43]
s_add_u32 s28,s67,6291456
buffer_load_dwordx2 v[192:193],v241,s[12:15],s28 offen offset:0
M v[44:47],a[248:251],a[196:199],v[44:47]
ds_write2st64_b64 v243,v[194:195],v[196:197] offset0:36 offset1:53
M v[48:51],a[248:251],a[200:203],v[48:51]
buffer_load_dwordx2 v[202:203],v241,s[16:19],s28 offen offset:1536
M v[52:55],a[248:251],a[204:207],v[52:55]
ds_write2st64_b64 v243,v[198:199],v[200:201] offset0:70 offset1:87
M v[56:59],a[248:251],a[208:211],v[56:59]
v_lshlrev_b32 v230,16,v208
v_lshlrev_b32 v228,16,v204
M v[60:63],a[248:251],a[212:215],v[60:63]
s_waitcnt vmcnt(12)
buffer_load_dwordx2 v[194:195],v241,s[8:11],s28 offen offset:0
M v[64:67],a[252:255],a[216:219],v[64:67]
ds_read_b128 a[216:219],v245 offset:60928
v_lshlrev_b32 v229,16,v206
M v[68:71],a[252:255],a[220:223],v[68:71]
ds_read_b128 a[220:223],v246 offset:61184
v_lshlrev_b32 v233,16,v214
M v[72:75],a[252:255],a[192:195],v[72:75]
ds_read_b128 a[192:195],v246 offset:61440
v_lshlrev_b32 v232,16,v212
M v[76:79],a[252:255],a[196:199],v[76:79]
buffer_load_dwordx2 v[196:197],v241,s[8:11],s28 offen offset:384
M v[80:83],a[252:255],a[200:203],v[80:83]
ds_read_b128 a[196:199],v246 offset:61696
ds_read_b128 a[200:203],v246 offset:61952
M v[84:87],a[252:255],a[204:207],v[84:87]
ds_read_b128 a[204:207],v246 offset:62208
v_lshlrev_b32 v231,16,v210
M v[88:91],a[252:255],a[208:211],v[88:91]
ds_read_b128 a[208:211],v246 offset:62464
v_fmac_f32 v228,s43,v230
M v[92:95],a[252:255],a[212:215],v[92:95]
s_waitcnt vmcnt(13) lgkmcnt(6)
buffer_load_dwordx2 v[198:199],v241,s[8:11],s28 offen offset:768
M v[96:99],a[224:227],a[216:219],v[96:99]
s_waitcnt lgkmcnt(5)
ds_read_b128 a[212:215],v246 offset:62720
v_fmac_f32 v233,4.0,v229
M v[100:103],a[224:227],a[220:223],v[100:103]
s_waitcnt lgkmcnt(5)
v_fma_f32 v234,-4.0,v230,v232
v_fmac_f32 v228,s45,v232
M v[104:107],a[224:227],a[192:195],v[104:107]
s_waitcnt lgkmcnt(4)
v_fmac_f32 v233,s41,v231
v_sub_f32 v232,v232,v230
M v[108:111],a[224:227],a[196:199],v[108:111]
s_waitcnt lgkmcnt(3)
buffer_load_dwordx2 v[200:201],v241,s[8:11],s28 offen offset:1152
M v[112:115],a[224:227],a[200:203],v[112:115]
s_waitcnt lgkmcnt(2)
v_fma_f32 v230,-4.0,v229,v231
v_sub_f32 v231,v231,v229
M v[116:119],a[224:227],a[204:207],v[116:119]
s_waitcnt lgkmcnt(1)
v_add_f32 v229,v234,v230
v_sub_f32 v234,v234,v230
M v[120:123],a[224:227],a[208:211],v[120:123]
s_waitcnt lgkmcnt(0)
v_fma_f32 v230,2.0,v231,v232
v_fmac_f32 v232,-2.0,v231
M v[124:127],a[224:227],a[212:215],v[124:127]
s_waitcnt vmcnt(14)
buffer_load_dwordx4 a[248:251],v247,s[20:23],s46 offen offset:0 sc1
M v[128:131],v[216:219],a[216:219],v[128:131]
s_add_u32 s47,s78,12288
v_and_b32 v208,s42,v208
v_and_b32 v204,s42,v204
M v[132:135],v[216:219],a[220:223],v[132:135]
v_and_b32 v206,s42,v206
v_and_b32 v214,s42,v214
M v[136:139],v[216:219],a[192:195],v[136:139]
v_and_b32 v212,s42,v212
v_and_b32 v210,s42,v210
M v[140:143],v[216:219],a[196:199],v[140:143]
buffer_load_dwordx4 a[252:255],v247,s[20:23],s47 offen offset:0 sc1
M v[144:147],v[216:219],a[200:203],v[144:147]
s_add_u32 s48,s78,15360
v_fmac_f32 v204,s43,v208
v_fmac_f32 v214,4.0,v206
M v[148:151],v[216:219],a[204:207],v[148:151]
v_fma_f32 v231,-4.0,v208,v212
v_fmac_f32 v204,s45,v212
M v[152:155],v[216:219],a[208:211],v[152:155]
v_fmac_f32 v214,s41,v210
v_sub_f32 v212,v212,v208
M v[156:159],v[216:219],a[212:215],v[156:159]
s_waitcnt vmcnt(14)
buffer_load_dwordx4 a[224:227],v247,s[20:23],s48 offen offset:0 sc1
M v[160:163],v[220:223],a[216:219],v[160:163]
ds_read_b128 a[216:219],v246 offset:62976
v_fma_f32 v208,-4.0,v206,v210
M v[164:167],v[220:223],a[220:223],v[164:167]
v_sub_f32 v210,v210,v206
v_add_f32 v206,v231,v208
M v[168:171],v[220:223],a[192:195],v[168:171]
v_sub_f32 v231,v231,v208
v_fma_f32 v208,2.0,v210,v212
M v[172:175],v[220:223],a[196:199],v[172:175]
buffer_load_dwordx4 v[216:219],v247,s[20:23],s46 offen offset:1024 sc1
M v[176:179],v[220:223],a[200:203],v[176:179]
v_fmac_f32 v212,-2.0,v210
v_cvt_pk_bf16_f32 v204,v228,v204
M v[180:183],v[220:223],a[204:207],v[180:183]
v_cvt_pk_bf16_f32 v214,v233,v214
v_cvt_pk_bf16_f32 v206,v229,v206
M v[184:187],v[220:223],a[208:211],v[184:187]
v_cvt_pk_bf16_f32 v210,v230,v208
v_cvt_pk_bf16_f32 v208,v234,v231
M v[188:191],v[220:223],a[212:215],v[188:191]
s_waitcnt vmcnt(15)
buffer_load_dwordx4 v[220:223],v247,s[20:23],s47 offen offset:1024 sc1
M v[96:99],v[224:227],a[220:223],v[96:99]
v_cvt_pk_bf16_f32 v212,v232,v212
v_lshlrev_b32 v230,16,v209
M v[100:103],v[224:227],a[192:195],v[100:103]
v_lshlrev_b32 v228,16,v205
v_lshlrev_b32 v229,16,v207
M v[104:107],v[224:227],a[196:199],v[104:107]
v_lshlrev_b32 v233,16,v215
v_lshlrev_b32 v232,16,v213
M v[108:111],v[224:227],a[200:203],v[108:111]
v_lshlrev_b32 v231,16,v211
v_fmac_f32 v228,s43,v230
M v[112:115],v[224:227],a[204:207],v[112:115]
v_fmac_f32 v233,4.0,v229
v_fma_f32 v234,-4.0,v230,v232
M v[116:119],v[224:227],a[208:211],v[116:119]
v_fmac_f32 v228,s45,v232
v_fmac_f32 v233,s41,v231
M v[120:123],v[224:227],a[212:215],v[120:123]
s_waitcnt lgkmcnt(0)
v_sub_f32 v232,v232,v230
v_fma_f32 v230,-4.0,v229,v231
M v[124:127],v[224:227],a[216:219],v[124:127]
s_waitcnt vmcnt(15)
buffer_load_dwordx4 v[224:227],v247,s[20:23],s48 offen offset:1024 sc1
M v[128:131],a[228:231],a[220:223],v[128:131]
v_sub_f32 v231,v231,v229
v_add_f32 v229,v234,v230
M v[132:135],a[228:231],a[192:195],v[132:135]
v_sub_f32 v234,v234,v230
v_fma_f32 v230,2.0,v231,v232
M v[136:139],a[228:231],a[196:199],v[136:139]
v_fmac_f32 v232,-2.0,v231
v_and_b32 v209,s42,v209
M v[140:143],a[228:231],a[200:203],v[140:143]
v_and_b32 v205,s42,v205
v_and_b32 v207,s42,v207
M v[144:147],a[228:231],a[204:207],v[144:147]
v_and_b32 v215,s42,v215
v_and_b32 v213,s42,v213
M v[148:151],a[228:231],a[208:211],v[148:151]
v_and_b32 v211,s42,v211
v_fmac_f32 v205,s43,v209
M v[152:155],a[228:231],a[212:215],v[152:155]
v_fmac_f32 v215,4.0,v207
v_fma_f32 v231,-4.0,v209,v213
M v[156:159],a[228:231],a[216:219],v[156:159]
s_waitcnt vmcnt(15)
buffer_load_dwordx4 a[228:231],v247,s[20:23],s46 offen offset:2048 sc1
M v[160:163],a[232:235],a[220:223],v[160:163]
ds_read_b128 a[220:223],v245 offset:63232
v_fmac_f32 v205,s45,v213
M v[164:167],a[232:235],a[192:195],v[164:167]
v_fmac_f32 v215,s41,v211
v_sub_f32 v213,v213,v209
M v[168:171],a[232:235],a[196:199],v[168:171]
v_fma_f32 v209,-4.0,v207,v211
v_sub_f32 v211,v211,v207
M v[172:175],a[232:235],a[200:203],v[172:175]
v_add_f32 v207,v231,v209
v_sub_f32 v231,v231,v209
M v[176:179],a[232:235],a[204:207],v[176:179]
v_fma_f32 v209,2.0,v211,v213
v_fmac_f32 v213,-2.0,v211
M v[180:183],a[232:235],a[208:211],v[180:183]
v_cvt_pk_bf16_f32 v205,v228,v205
v_cvt_pk_bf16_f32 v215,v233,v215
M v[184:187],a[232:235],a[212:215],v[184:187]
v_cvt_pk_bf16_f32 v207,v229,v207
v_cvt_pk_bf16_f32 v211,v230,v209
M v[188:191],a[232:235],a[216:219],v[188:191]
s_waitcnt vmcnt(15)
buffer_load_dwordx4 a[232:235],v247,s[20:23],s47 offen offset:2048 sc1
M v[96:99],a[236:239],a[192:195],v[96:99]
v_cvt_pk_bf16_f32 v209,v234,v231
v_cvt_pk_bf16_f32 v213,v232,v213
M v[100:103],a[236:239],a[196:199],v[100:103]
ds_write2st64_b64 v243,v[204:205],v[214:215] offset0:207 offset1:224
M v[104:107],a[236:239],a[200:203],v[104:107]
s_add_u32 s28,s67,6684672
buffer_load_dwordx2 v[204:205],v241,s[12:15],s28 offen offset:0
M v[108:111],a[236:239],a[204:207],v[108:111]
ds_write2st64_b64 v243,v[206:207],v[208:209] offset0:37 offset1:54
M v[112:115],a[236:239],a[208:211],v[112:115]
buffer_load_dwordx2 v[214:215],v241,s[16:19],s28 offen offset:1536
M v[116:119],a[236:239],a[212:215],v[116:119]
ds_write2st64_b64 v243,v[210:211],v[212:213] offset0:71 offset1:88
M v[120:123],a[236:239],a[216:219],v[120:123]
s_waitcnt vmcnt(12) lgkmcnt(3)
v_lshlrev_b32 v230,16,v196
v_lshlrev_b32 v228,16,v192
M v[124:127],a[236:239],a[220:223],v[124:127]
buffer_load_dwordx2 v[206:207],v241,s[8:11],s28 offen offset:0
M v[128:131],a[240:243],a[192:195],v[128:131]
v_lshlrev_b32 v229,16,v194
v_lshlrev_b32 v233,16,v202
M v[132:135],a[240:243],a[196:199],v[132:135]
s_waitcnt vmcnt(11)
v_lshlrev_b32 v232,16,v200
v_lshlrev_b32 v231,16,v198
M v[136:139],a[240:243],a[200:203],v[136:139]
v_fmac_f32 v228,s43,v230
v_fmac_f32 v233,4.0,v229
M v[140:143],a[240:243],a[204:207],v[140:143]
buffer_load_dwordx2 v[208:209],v241,s[8:11],s28 offen offset:384
M v[144:147],a[240:243],a[208:211],v[144:147]
v_fma_f32 v234,-4.0,v230,v232
v_fmac_f32 v228,s45,v232
M v[148:151],a[240:243],a[212:215],v[148:151]
v_fmac_f32 v233,s41,v231
v_sub_f32 v232,v232,v230
M v[152:155],a[240:243],a[216:219],v[152:155]
s_waitcnt lgkmcnt(0)
s_barrier
v_fma_f32 v230,-4.0,v229,v231
M v[156:159],a[240:243],a[220:223],v[156:159]
buffer_load_dwordx2 v[210:211],v241,s[8:11],s28 offen offset:768
M v[160:163],a[244:247],a[192:195],v[160:163]
ds_read_b128 a[192:195],v245 offset:0
v_sub_f32 v231,v231,v229
M v[164:167],a[244:247],a[196:199],v[164:167]
ds_read_b128 a[196:199],v246 offset:256
v_add_f32 v229,v234,v230
M v[168:171],a[244:247],a[200:203],v[168:171]
ds_read_b128 a[200:203],v246 offset:512
v_sub_f32 v234,v234,v230
M v[172:175],a[244:247],a[204:207],v[172:175]
buffer_load_dwordx2 v[212:213],v241,s[8:11],s28 offen offset:1152
M v[176:179],a[244:247],a[208:211],v[176:179]
ds_read_b128 a[204:207],v246 offset:768
ds_read_b128 a[208:211],v246 offset:1024
M v[180:183],a[244:247],a[212:215],v[180:183]
ds_read_b128 a[212:215],v246 offset:1280
v_fma_f32 v230,2.0,v231,v232
M v[184:187],a[244:247],a[216:219],v[184:187]
ds_read_b128 a[216:219],v246 offset:1536
v_fmac_f32 v232,-2.0,v231
M v[188:191],a[244:247],a[220:223],v[188:191]
s_waitcnt vmcnt(13) lgkmcnt(6)
buffer_load_dwordx4 a[236:239],v247,s[20:23],s48 offen offset:2048 sc1
M a[0:3],a[248:251],a[192:195],a[0:3]
s_waitcnt lgkmcnt(5)
s_add_u32 s46,s78,18432
ds_read_b128 a[220:223],v246 offset:1792
v_and_b32 v196,s42,v196
M a[4:7],a[248:251],a[196:199],a[4:7]
s_waitcnt lgkmcnt(5)
v_and_b32 v192,s42,v192
v_and_b32 v194,s42,v194
M a[8:11],a[248:251],a[200:203],a[8:11]
s_waitcnt lgkmcnt(4)
v_and_b32 v202,s42,v202
v_and_b32 v200,s42,v200
M a[12:15],a[248:251],a[204:207],a[12:15]
s_waitcnt lgkmcnt(3)
buffer_load_dwordx4 a[240:243],v247,s[20:23],s46 offen offset:0 sc1
M a[16:19],a[248:251],a[208:211],a[16:19]
s_waitcnt lgkmcnt(2)
s_add_u32 s47,s78,21504
v_and_b32 v198,s42,v198
v_fmac_f32 v192,s43,v196
M a[20:23],a[248:251],a[212:215],a[20:23]
s_waitcnt lgkmcnt(1)
v_fmac_f32 v202,4.0,v194
v_fma_f32 v231,-4.0,v196,v200
M a[24:27],a[248:251],a[216:219],a[24:27]
s_waitcnt lgkmcnt(0)
v_fmac_f32 v192,s45,v200
v_fmac_f32 v202,s41,v198
M a[28:31],a[248:251],a[220:223],a[28:31]
s_waitcnt vmcnt(14)
buffer_load_dwordx4 a[244:247],v247,s[20:23],s47 offen offset:0 sc1
M a[32:35],a[252:255],a[192:195],a[32:35]
s_add_u32 s48,s78,24576
v_sub_f32 v200,v200,v196
v_fma_f32 v196,-4.0,v194,v198
M a[36:39],a[252:255],a[196:199],a[36:39]
v_sub_f32 v198,v198,v194
v_add_f32 v194,v231,v196
M a[40:43],a[252:255],a[200:203],a[40:43]
v_sub_f32 v231,v231,v196
v_fma_f32 v196,2.0,v198,v200
M a[44:47],a[252:255],a[204:207],a[44:47]
buffer_load_dwordx4 a[248:251],v247,s[20:23],s48 offen offset:0 sc1
M a[48:51],a[252:255],a[208:211],a[48:51]
v_fmac_f32 v200,-2.0,v198
v_cvt_pk_bf16_f32 v192,v228,v192
M a[52:55],a[252:255],a[212:215],a[52:55]
v_cvt_pk_bf16_f32 v202,v233,v202
v_cvt_pk_bf16_f32 v194,v229,v194
M a[56:59],a[252:255],a[216:219],a[56:59]
v_cvt_pk_bf16_f32 v198,v230,v196
v_cvt_pk_bf16_f32 v196,v234,v231
M a[60:63],a[252:255],a[220:223],a[60:63]
s_waitcnt vmcnt(15)
buffer_load_dwordx4 a[252:255],v247,s[20:23],s46 offen offset:1024 sc1
M a[64:67],a[224:227],a[192:195],a[64:67]
ds_read_b128 a[192:195],v246 offset:2048
v_cvt_pk_bf16_f32 v200,v232,v200
M a[68:71],a[224:227],a[196:199],a[68:71]
v_lshlrev_b32 v230,16,v197
v_lshlrev_b32 v228,16,v193
M a[72:75],a[224:227],a[200:203],a[72:75]
v_lshlrev_b32 v229,16,v195
v_lshlrev_b32 v233,16,v203
M a[76:79],a[224:227],a[204:207],a[76:79]
v_lshlrev_b32 v232,16,v201
v_lshlrev_b32 v231,16,v199
M a[80:83],a[224:227],a[208:211],a[80:83]
v_fmac_f32 v228,s43,v230
v_fmac_f32 v233,4.0,v229
M a[84:87],a[224:227],a[212:215],a[84:87]
v_fma_f32 v234,-4.0,v230,v232
v_fmac_f32 v228,s45,v232
M a[88:91],a[224:227],a[216:219],a[88:91]
v_fmac_f32 v233,s41,v231
v_sub_f32 v232,v232,v230
M a[92:95],a[224:227],a[220:223],a[92:95]
s_waitcnt vmcnt(15)
buffer_load_dwordx4 a[224:227],v247,s[20:23],s47 offen offset:1024 sc1
M a[0:3],v[216:219],a[196:199],a[0:3]
v_fma_f32 v230,-4.0,v229,v231
v_sub_f32 v231,v231,v229
M a[4:7],v[216:219],a[200:203],a[4:7]
v_add_f32 v229,v234,v230
v_sub_f32 v234,v234,v230
M a[8:11],v[216:219],a[204:207],a[8:11]
v_fma_f32 v230,2.0,v231,v232
v_fmac_f32 v232,-2.0,v231
M a[12:15],v[216:219],a[208:211],a[12:15]
v_and_b32 v197,s42,v197
v_and_b32 v193,s42,v193
M a[16:19],v[216:219],a[212:215],a[16:19]
v_and_b32 v195,s42,v195
v_and_b32 v203,s42,v203
M a[20:23],v[216:219],a[216:219],a[20:23]
v_and_b32 v201,s42,v201
v_and_b32 v199,s42,v199
M a[24:27],v[216:219],a[220:223],a[24:27]
s_waitcnt lgkmcnt(0)
v_fmac_f32 v193,s43,v197
v_fmac_f32 v203,4.0,v195
M a[28:31],v[216:219],a[192:195],a[28:31]
s_waitcnt vmcnt(15)
buffer_load_dwordx4 v[216:219],v247,s[20:23],s48 offen offset:1024 sc1
M a[32:35],v[220:223],a[196:199],a[32:35]
v_fma_f32 v231,-4.0,v197,v201
v_fmac_f32 v193,s45,v201
M a[36:39],v[220:223],a[200:203],a[36:39]
v_fmac_f32 v203,s41,v199
v_sub_f32 v201,v201,v197
M a[40:43],v[220:223],a[204:207],a[40:43]
v_fma_f32 v197,-4.0,v195,v199
v_sub_f32 v199,v199,v195
M a[44:47],v[220:223],a[208:211],a[44:47]
v_add_f32 v195,v231,v197
v_sub_f32 v231,v231,v197
M a[48:51],v[220:223],a[212:215],a[48:51]
v_fma_f32 v197,2.0,v199,v201
v_fmac_f32 v201,-2.0,v199
M a[52:55],v[220:223],a[216:219],a[52:55]
v_cvt_pk_bf16_f32 v193,v228,v193
v_cvt_pk_bf16_f32 v203,v233,v203
M a[56:59],v[220:223],a[220:223],a[56:59]
v_cvt_pk_bf16_f32 v195,v229,v195
v_cvt_pk_bf16_f32 v199,v230,v197
M a[60:63],v[220:223],a[192:195],a[60:63]
s_waitcnt vmcnt(15)
buffer_load_dwordx4 v[220:223],v247,s[20:23],s46 offen offset:2048 sc1
M a[64:67],v[224:227],a[196:199],a[64:67]
ds_read_b128 a[196:199],v245 offset:2304
v_cvt_pk_bf16_f32 v197,v234,v231
M a[68:71],v[224:227],a[200:203],a[68:71]
v_cvt_pk_bf16_f32 v201,v232,v201
M a[72:75],v[224:227],a[204:207],a[72:75]
ds_write2st64_b64 v243,v[192:193],v[202:203] offset0:238 offset1:255
M a[76:79],v[224:227],a[208:211],a[76:79]
s_add_u32 s28,s67,7077888
buffer_load_dwordx2 v[192:193],v241,s[12:15],s28 offen offset:0
M a[80:83],v[224:227],a[212:215],a[80:83]
ds_write2st64_b64 v243,v[194:195],v[196:197] offset0:0 offset1:17
M a[84:87],v[224:227],a[216:219],a[84:87]
buffer_load_dwordx2 v[202:203],v241,s[16:19],s28 offen offset:1536
M a[88:91],v[224:227],a[220:223],a[88:91]
ds_write2st64_b64 v243,v[198:199],v[200:201] offset0:136 offset1:153
M a[92:95],v[224:227],a[192:195],a[92:95]
s_waitcnt vmcnt(12)
v_lshlrev_b32 v230,16,v208
v_lshlrev_b32 v228,16,v204
M a[0:3],a[228:231],a[200:203],a[0:3]
buffer_load_dwordx2 v[194:195],v241,s[8:11],s28 offen offset:0
M a[4:7],a[228:231],a[204:207],a[4:7]
v_lshlrev_b32 v229,16,v206
v_lshlrev_b32 v233,16,v214
M a[8:11],a[228:231],a[208:211],a[8:11]
s_waitcnt vmcnt(11)
v_lshlrev_b32 v232,16,v212
v_lshlrev_b32 v231,16,v210
M a[12:15],a[228:231],a[212:215],a[12:15]
v_fmac_f32 v228,s43,v230
v_fmac_f32 v233,4.0,v229
M a[16:19],a[228:231],a[216:219],a[16:19]
buffer_load_dwordx2 v[196:197],v241,s[8:11],s28 offen offset:384
M a[20:23],a[228:231],a[220:223],a[20:23]
v_fma_f32 v234,-4.0,v230,v232
v_fmac_f32 v228,s45,v232
M a[24:27],a[228:231],a[192:195],a[24:27]
s_waitcnt lgkmcnt(3)
v_fmac_f32 v233,s41,v231
v_sub_f32 v232,v232,v230
M a[28:31],a[228:231],a[196:199],a[28:31]
v_fma_f32 v230,-4.0,v229,v231
v_sub_f32 v231,v231,v229
M a[32:35],a[232:235],a[200:203],a[32:35]
buffer_load_dwordx2 v[198:199],v241,s[8:11],s28 offen offset:768
M a[36:39],a[232:235],a[204:207],a[36:39]
v_add_f32 v229,v234,v230
v_sub_f32 v234,v234,v230
M a[40:43],a[232:235],a[208:211],a[40:43]
v_fma_f32 v230,2.0,v231,v232
v_fmac_f32 v232,-2.0,v231
M a[44:47],a[232:235],a[212:215],a[44:47]
v_and_b32 v208,s42,v208
v_and_b32 v204,s42,v204
M a[48:51],a[232:235],a[216:219],a[48:51]
buffer_load_dwordx2 v[200:201],v241,s[8:11],s28 offen offset:1152
M a[52:55],a[232:235],a[220:223],a[52:55]
v_and_b32 v206,s42,v206
v_and_b32 v214,s42,v214
M a[56:59],a[232:235],a[192:195],a[56:59]
v_and_b32 v212,s42,v212
v_and_b32 v210,s42,v210
M a[60:63],a[232:235],a[196:199],a[60:63]
s_waitcnt vmcnt(13)
v_fmac_f32 v204,s43,v208
v_fmac_f32 v214,4.0,v206
M a[64:67],a[236:239],a[200:203],a[64:67]
buffer_load_dwordx4 v[224:227],v247,s[20:23],s47 offen offset:2048 sc1
M a[68:71],a[236:239],a[204:207],a[68:71]
ds_read_b128 a[200:203],v245 offset:8704
ds_read_b128 a[204:207],v246 offset:8960
M a[72:75],a[236:239],a[208:211],a[72:75]
ds_read_b128 a[208:211],v246 offset:9216
v_fma_f32 v231,-4.0,v208,v212
M a[76:79],a[236:239],a[212:215],a[76:79]
ds_read_b128 a[212:215],v246 offset:9472
v_fmac_f32 v204,s45,v212
M a[80:83],a[236:239],a[216:219],a[80:83]
buffer_load_dwordx4 a[228:231],v247,s[20:23],s48 offen offset:2048 sc1
M a[84:87],a[236:239],a[220:223],a[84:87]
s_add_u32 s46,s78,27648
ds_read_b128 a[216:219],v246 offset:9728
ds_read_b128 a[220:223],v246 offset:9984
M a[88:91],a[236:239],a[192:195],a[88:91]
ds_read_b128 a[192:195],v246 offset:10240
v_fmac_f32 v214,s41,v210
M a[92:95],a[236:239],a[196:199],a[92:95]
s_waitcnt vmcnt(14) lgkmcnt(6)
ds_read_b128 a[196:199],v246 offset:10496
v_sub_f32 v212,v212,v208
M a[96:99],a[240:243],a[200:203],a[96:99]
s_waitcnt lgkmcnt(6)
buffer_load_dwordx4 a[232:235],v247,s[20:23],s46 offen offset:0 sc1
M a[100:103],a[240:243],a[204:207],a[100:103]
s_waitcnt lgkmcnt(5)
s_add_u32 s47,s78,30720
v_fma_f32 v208,-4.0,v206,v210
v_sub_f32 v210,v210,v206
M a[104:107],a[240:243],a[208:211],a[104:107]
s_waitcnt lgkmcnt(4)
v_add_f32 v206,v231,v208
v_sub_f32 v231,v231,v208
M a[108:111],a[240:243],a[212:215],a[108:111]
s_waitcnt lgkmcnt(3)
v_fma_f32 v208,2.0,v210,v212
v_fmac_f32 v212,-2.0,v210
M a[112:115],a[240:243],a[216:219],a[112:115]
s_waitcnt lgkmcnt(2)
buffer_load_dwordx4 a[236:239],v247,s[20:23],s47 offen offset:0 sc1
M a[116:119],a[240:243],a[220:223],a[116:119]
s_waitcnt lgkmcnt(1)
s_add_u32 s48,s78,33792
v_cvt_pk_bf16_f32 v204,v228,v204
v_cvt_pk_bf16_f32 v214,v233,v214
M a[120:123],a[240:243],a[192:195],a[120:123]
s_waitcnt lgkmcnt(0)
v_cvt_pk_bf16_f32 v206,v229,v206
v_cvt_pk_bf16_f32 v210,v230,v208
M a[124:127],a[240:243],a[196:199],a[124:127]
s_waitcnt vmcnt(15)
v_cvt_pk_bf16_f32 v208,v234,v231
v_cvt_pk_bf16_f32 v212,v232,v212
M a[128:131],a[244:247],a[200:203],a[128:131]
buffer_load_dwordx4 a[240:243],v247,s[20:23],s48 offen offset:0 sc1
M a[132:135],a[244:247],a[204:207],a[132:135]
v_lshlrev_b32 v230,16,v209
v_lshlrev_b32 v228,16,v205
M a[136:139],a[244:247],a[208:211],a[136:139]
v_lshlrev_b32 v229,16,v207
v_lshlrev_b32 v233,16,v215
M a[140:143],a[244:247],a[212:215],a[140:143]
v_lshlrev_b32 v232,16,v213
v_lshlrev_b32 v231,16,v211
M a[144:147],a[244:247],a[216:219],a[144:147]
v_fmac_f32 v228,s43,v230
v_fmac_f32 v233,4.0,v229
M a[148:151],a[244:247],a[220:223],a[148:151]
v_fma_f32 v234,-4.0,v230,v232
v_fmac_f32 v228,s45,v232
M a[152:155],a[244:247],a[192:195],a[152:155]
v_fmac_f32 v233,s41,v231
v_sub_f32 v232,v232,v230
M a[156:159],a[244:247],a[196:199],a[156:159]
s_waitcnt vmcnt(15)
buffer_load_dwordx4 a[244:247],v247,s[20:23],s46 offen offset:1024 sc1
M a[160:163],a[248:251],a[200:203],a[160:163]
ds_read_b128 a[200:203],v246 offset:10752
v_fma_f32 v230,-4.0,v229,v231
M a[164:167],a[248:251],a[204:207],a[164:167]
v_sub_f32 v231,v231,v229
v_add_f32 v229,v234,v230
M a[168:171],a[248:251],a[208:211],a[168:171]
v_sub_f32 v234,v234,v230
v_fma_f32 v230,2.0,v231,v232
M a[172:175],a[248:251],a[212:215],a[172:175]
v_fmac_f32 v232,-2.0,v231
v_and_b32 v209,s42,v209
M a[176:179],a[248:251],a[216:219],a[176:179]
v_and_b32 v205,s42,v205
v_and_b32 v207,s42,v207
M a[180:183],a[248:251],a[220:223],a[180:183]
v_and_b32 v215,s42,v215
v_and_b32 v213,s42,v213
M a[184:187],a[248:251],a[192:195],a[184:187]
v_and_b32 v211,s42,v211
v_fmac_f32 v205,s43,v209
M a[188:191],a[248:251],a[196:199],a[188:191]
s_waitcnt vmcnt(15)
buffer_load_dwordx4 a[248:251],v247,s[20:23],s47 offen offset:1024 sc1
M a[96:99],a[252:255],a[204:207],a[96:99]
v_fmac_f32 v215,4.0,v207
v_fma_f32 v231,-4.0,v209,v213
M a[100:103],a[252:255],a[208:211],a[100:103]
v_fmac_f32 v205,s45,v213
v_fmac_f32 v215,s41,v211
M a[104:107],a[252:255],a[212:215],a[104:107]
v_sub_f32 v213,v213,v209
v_fma_f32 v209,-4.0,v207,v211
M a[108:111],a[252:255],a[216:219],a[108:111]
v_sub_f32 v211,v211,v207
v_add_f32 v207,v231,v209
M a[112:115],a[252:255],a[220:223],a[112:115]
v_sub_f32 v231,v231,v209
v_fma_f32 v209,2.0,v211,v213
M a[116:119],a[252:255],a[192:195],a[116:119]
v_fmac_f32 v213,-2.0,v211
v_cvt_pk_bf16_f32 v205,v228,v205
M a[120:123],a[252:255],a[196:199],a[120:123]
s_waitcnt lgkmcnt(0)
v_cvt_pk_bf16_f32 v215,v233,v215
v_cvt_pk_bf16_f32 v207,v229,v207
M a[124:127],a[252:255],a[200:203],a[124:127]
s_waitcnt vmcnt(15)
buffer_load_dwordx4 a[252:255],v247,s[20:23],s48 offen offset:1024 sc1
M a[128:131],a[224:227],a[204:207],a[128:131]
v_cvt_pk_bf16_f32 v211,v230,v209
v_cvt_pk_bf16_f32 v209,v234,v231
M a[132:135],a[224:227],a[208:211],a[132:135]
v_cvt_pk_bf16_f32 v213,v232,v213
v_add_u32 v228,121856,v243
M a[136:139],a[224:227],a[212:215],a[136:139]
ds_write2st64_b64 v228,v[204:205],v[214:215] offset0:1 offset1:18
M a[140:143],a[224:227],a[216:219],a[140:143]
s_add_u32 s28,s67,7471104
buffer_load_dwordx2 v[204:205],v241,s[12:15],s28 offen offset:0
M a[144:147],a[224:227],a[220:223],a[144:147]
ds_write2st64_b64 v243,v[206:207],v[208:209] offset0:1 offset1:18
M a[148:151],a[224:227],a[192:195],a[148:151]
buffer_load_dwordx2 v[214:215],v241,s[16:19],s28 offen offset:1536
M a[152:155],a[224:227],a[196:199],a[152:155]
ds_write2st64_b64 v243,v[210:211],v[212:213] offset0:137 offset1:154
M a[156:159],a[224:227],a[200:203],a[156:159]
s_waitcnt vmcnt(17)
v_fmac_f32 v235,s43,v237
v_fmac_f32 v240,4.0,v236
M a[160:163],v[216:219],a[204:207],a[160:163]
buffer_load_dwordx2 v[206:207],v241,s[8:11],s28 offen offset:0
M a[164:167],v[216:219],a[208:211],a[164:167]
ds_read_b128 a[204:207],v245 offset:11008
v_fma_f32 v228,-4.0,v237,v239
M a[168:171],v[216:219],a[212:215],a[168:171]
v_fmac_f32 v235,s45,v239
v_fmac_f32 v240,s41,v238
M a[172:175],v[216:219],a[216:219],a[172:175]
v_sub_f32 v239,v239,v237
v_fma_f32 v237,-4.0,v236,v238
M a[176:179],v[216:219],a[220:223],a[176:179]
buffer_load_dwordx2 v[208:209],v241,s[8:11],s28 offen offset:384
M a[180:183],v[216:219],a[192:195],a[180:183]
v_sub_f32 v238,v238,v236
v_add_f32 v236,v228,v237
M a[184:187],v[216:219],a[196:199],a[184:187]
v_sub_f32 v228,v228,v237
v_fma_f32 v237,2.0,v238,v239
M a[188:191],v[216:219],a[200:203],a[188:191]
s_waitcnt vmcnt(18)
v_fmac_f32 v239,-2.0,v238
v_cvt_pk_bf16_f32 v229,v235,v240
M a[96:99],v[220:223],a[208:211],a[96:99]
buffer_load_dwordx2 v[210:211],v241,s[8:11],s28 offen offset:768
M a[100:103],v[220:223],a[212:215],a[100:103]
v_cvt_pk_bf16_f32 v230,v236,v228
v_cvt_pk_bf16_f32 v231,v237,v239
M a[104:107],v[220:223],a[216:219],a[104:107]
v_add_u32 v228,121856,v244
M a[108:111],v[220:223],a[220:223],a[108:111]
ds_write_b16 v228,v229 offset:0
M a[112:115],v[220:223],a[192:195],a[112:115]
buffer_load_dwordx2 v[212:213],v241,s[8:11],s28 offen offset:1152
M a[116:119],v[220:223],a[196:199],a[116:119]
ds_write_b16_d16_hi v228,v229 offset:8704
M a[120:123],v[220:223],a[200:203],a[120:123]
s_waitcnt lgkmcnt(2)
ds_write_b16 v244,v230 offset:0
M a[124:127],v[220:223],a[204:207],a[124:127]
s_waitcnt vmcnt(13)
ds_write_b16_d16_hi v244,v230 offset:8704
M a[128:131],v[224:227],a[208:211],a[128:131]
buffer_load_short_d16_hi v235,v242,s[12:15],s74 offen offset:0
M a[132:135],v[224:227],a[212:215],a[132:135]
v_add_u32 v228,69632,v244
M a[136:139],v[224:227],a[216:219],a[136:139]
buffer_load_short_d16_hi v236,v242,s[8:11],s74 offen offset:0
M a[140:143],v[224:227],a[220:223],a[140:143]
ds_write_b16 v228,v231 offset:0
M a[144:147],v[224:227],a[192:195],a[144:147]
buffer_load_short_d16_hi v237,v242,s[8:11],s74 offen offset:384
M a[148:151],v[224:227],a[196:199],a[148:151]
ds_write_b16_d16_hi v228,v231 offset:8704
M a[152:155],v[224:227],a[200:203],a[152:155]
buffer_load_short_d16_hi v238,v242,s[8:11],s74 offen offset:768
M a[156:159],v[224:227],a[204:207],a[156:159]
s_waitcnt vmcnt(16)
v_lshlrev_b32 v230,16,v196
v_lshlrev_b32 v228,16,v192
M a[160:163],a[228:231],a[208:211],a[160:163]
buffer_load_short_d16_hi v239,v242,s[8:11],s74 offen offset:1152
M a[164:167],a[228:231],a[212:215],a[164:167]
ds_read_b128 a[208:211],v245 offset:17408
ds_read_b128 a[212:215],v246 offset:17664
M a[168:171],a[228:231],a[216:219],a[168:171]
buffer_load_short_d16_hi v240,v242,s[16:19],s74 offen offset:1536
M a[172:175],a[228:231],a[220:223],a[172:175]
ds_read_b128 a[216:219],v246 offset:17920
ds_read_b128 a[220:223],v246 offset:18176
M a[176:179],a[228:231],a[192:195],a[176:179]
buffer_load_dwordx4 a[224:227],v247,s[20:23],s46 offen offset:2048 sc1
M a[180:183],a[228:231],a[196:199],a[180:183]
ds_read_b128 a[192:195],v246 offset:18432
ds_read_b128 a[196:199],v246 offset:18688
M a[184:187],a[228:231],a[200:203],a[184:187]
ds_read_b128 a[200:203],v246 offset:18944
v_lshlrev_b32 v229,16,v194
M a[188:191],a[228:231],a[204:207],a[188:191]
s_waitcnt vmcnt(18) lgkmcnt(6)
ds_read_b128 a[204:207],v246 offset:19200
v_lshlrev_b32 v233,16,v202
M v[0:3],a[232:235],a[208:211],v[0:3]
s_waitcnt lgkmcnt(6)
buffer_load_dwordx4 v[216:219],v247,s[20:23],s47 offen offset:2048 sc1
M v[4:7],a[232:235],a[212:215],v[4:7]
s_waitcnt lgkmcnt(5)
v_lshlrev_b32 v232,16,v200
v_lshlrev_b32 v231,16,v198
M v[8:11],a[232:235],a[216:219],v[8:11]
s_waitcnt lgkmcnt(4)
v_fmac_f32 v228,s43,v230
v_fmac_f32 v233,4.0,v229
M v[12:15],a[232:235],a[220:223],v[12:15]
s_waitcnt lgkmcnt(3)
v_fma_f32 v234,-4.0,v230,v232
v_fmac_f32 v228,s45,v232
M v[16:19],a[232:235],a[192:195],v[16:19]
s_waitcnt lgkmcnt(2)
buffer_load_dwordx4 v[220:223],v247,s[20:23],s48 offen offset:2048 sc1
M v[20:23],a[232:235],a[196:199],v[20:23]
s_waitcnt lgkmcnt(1)
s_add_u32 s46,s78,36864
v_fmac_f32 v233,s41,v231
v_sub_f32 v232,v232,v230
M v[24:27],a[232:235],a[200:203],v[24:27]
s_waitcnt lgkmcnt(0)
v_fma_f32 v230,-4.0,v229,v231
v_sub_f32 v231,v231,v229
M v[28:31],a[232:235],a[204:207],v[28:31]
s_waitcnt vmcnt(19)
v_add_f32 v229,v234,v230
v_sub_f32 v234,v234,v230
M v[32:35],a[236:239],a[208:211],v[32:35]
buffer_load_dwordx4 v[224:227],v247,s[20:23],s46 offen offset:0 sc1
M v[36:39],a[236:239],a[212:215],v[36:39]
s_add_u32 s47,s78,39936
v_fma_f32 v230,2.0,v231,v232
v_fmac_f32 v232,-2.0,v231
M v[40:43],a[236:239],a[216:219],v[40:43]
v_and_b32 v196,s42,v196
v_and_b32 v192,s42,v192
M v[44:47],a[236:239],a[220:223],v[44:47]
v_and_b32 v194,s42,v194
v_and_b32 v202,s42,v202
M v[48:51],a[236:239],a[192:195],v[48:51]
buffer_load_dwordx4 a[228:231],v247,s[20:23],s47 offen offset:0 sc1
M v[52:55],a[236:239],a[196:199],v[52:55]
s_add_u32 s48,s78,43008
v_and_b32 v200,s42,v200
v_and_b32 v198,s42,v198
M v[56:59],a[236:239],a[200:203],v[56:59]
v_fmac_f32 v192,s43,v196
v_fmac_f32 v202,4.0,v194
M v[60:63],a[236:239],a[204:207],v[60:63]
s_waitcnt vmcnt(20)
v_fma_f32 v231,-4.0,v196,v200
v_fmac_f32 v192,s45,v200
M v[64:67],a[240:243],a[208:211],v[64:67]
global_load_dword v251,v252,s[82:83]
M v[68:71],a[240:243],a[212:215],v[68:71]
ds_read_b128 a[208:211],v246 offset:19456
v_fmac_f32 v202,s41,v198
M v[72:75],a[240:243],a[216:219],v[72:75]
buffer_load_dwordx4 a[232:235],v247,s[20:23],s48 offen offset:0 sc1
M v[76:79],a[240:243],a[220:223],v[76:79]
v_sub_f32 v200,v200,v196
v_fma_f32 v196,-4.0,v194,v198
M v[80:83],a[240:243],a[192:195],v[80:83]
v_sub_f32 v198,v198,v194
v_add_f32 v194,v231,v196
M v[84:87],a[240:243],a[196:199],v[84:87]
v_sub_f32 v231,v231,v196
v_fma_f32 v196,2.0,v198,v200
M v[88:91],a[240:243],a[200:203],v[88:91]
buffer_load_dwordx4 a[236:239],v247,s[20:23],s46 offen offset:1024 sc1
M v[92:95],a[240:243],a[204:207],v[92:95]
s_waitcnt vmcnt(22)
v_fmac_f32 v200,-2.0,v198
v_cvt_pk_bf16_f32 v192,v228,v192
M v[0:3],a[244:247],a[212:215],v[0:3]
v_cvt_pk_bf16_f32 v202,v233,v202
v_cvt_pk_bf16_f32 v194,v229,v194
M v[4:7],a[244:247],a[216:219],v[4:7]
v_cvt_pk_bf16_f32 v198,v230,v196
v_cvt_pk_bf16_f32 v196,v234,v231
M v[8:11],a[244:247],a[220:223],v[8:11]
buffer_load_dwordx4 a[240:243],v247,s[20:23],s47 offen offset:1024 sc1
M v[12:15],a[244:247],a[192:195],v[12:15]
v_cvt_pk_bf16_f32 v200,v232,v200
v_lshlrev_b32 v230,16,v197
M v[16:19],a[244:247],a[196:199],v[16:19]
v_lshlrev_b32 v228,16,v193
v_lshlrev_b32 v229,16,v195
M v[20:23],a[244:247],a[200:203],v[20:23]
v_lshlrev_b32 v233,16,v203
v_lshlrev_b32 v232,16,v201
M v[24:27],a[244:247],a[204:207],v[24:27]
s_waitcnt lgkmcnt(0)
v_lshlrev_b32 v231,16,v199
v_fmac_f32 v228,s43,v230
M v[28:31],a[244:247],a[208:211],v[28:31]
s_waitcnt vmcnt(22)
buffer_load_dwordx4 a[244:247],v247,s[20:23],s48 offen offset:1024 sc1
M v[32:35],a[248:251],a[212:215],v[32:35]
v_fmac_f32 v233,4.0,v229
v_fma_f32 v234,-4.0,v230,v232
M v[36:39],a[248:251],a[216:219],v[36:39]
v_fmac_f32 v228,s45,v232
v_fmac_f32 v233,s41,v231
M v[40:43],a[248:251],a[220:223],v[40:43]
v_sub_f32 v232,v232,v230
v_fma_f32 v230,-4.0,v229,v231
M v[44:47],a[248:251],a[192:195],v[44:47]
v_sub_f32 v231,v231,v229
v_add_f32 v229,v234,v230
M v[48:51],a[248:251],a[196:199],v[48:51]
v_sub_f32 v234,v234,v230
v_fma_f32 v230,2.0,v231,v232
M v[52:55],a[248:251],a[200:203],v[52:55]
v_fmac_f32 v232,-2.0,v231
v_and_b32 v197,s42,v197
M v[56:59],a[248:251],a[204:207],v[56:59]
v_and_b32 v193,s42,v193
v_and_b32 v195,s42,v195
M v[60:63],a[248:251],a[208:211],v[60:63]
s_waitcnt vmcnt(22)
buffer_load_dwordx4 a[248:251],v247,s[20:23],s46 offen offset:2048 sc1
M v[64:67],a[252:255],a[212:215],v[64:67]
ds_read_b128 a[212:215],v245 offset:19712
v_and_b32 v203,s42,v203
M v[68:71],a[252:255],a[216:219],v[68:71]
v_and_b32 v201,s42,v201
v_and_b32 v199,s42,v199
M v[72:75],a[252:255],a[220:223],v[72:75]
v_fmac_f32 v193,s43,v197
v_fmac_f32 v203,4.0,v195
M v[76:79],a[252:255],a[192:195],v[76:79]
v_fma_f32 v231,-4.0,v197,v201
v_fmac_f32 v193,s45,v201
M v[80:83],a[252:255],a[196:199],v[80:83]
v_fmac_f32 v203,s41,v199
v_sub_f32 v201,v201,v197
M v[84:87],a[252:255],a[200:203],v[84:87]
v_fma_f32 v197,-4.0,v195,v199
v_sub_f32 v199,v199,v195
M v[88:91],a[252:255],a[204:207],v[88:91]
v_add_f32 v195,v231,v197
v_sub_f32 v231,v231,v197
M v[92:95],a[252:255],a[208:211],v[92:95]
s_waitcnt vmcnt(10)
buffer_load_dwordx4 a[252:255],v247,s[20:23],s47 offen offset:2048 sc1
M v[0:3],a[224:227],a[216:219],v[0:3]
v_fma_f32 v197,2.0,v199,v201
v_fmac_f32 v201,-2.0,v199
M v[4:7],a[224:227],a[220:223],v[4:7]
v_cvt_pk_bf16_f32 v193,v228,v193
v_cvt_pk_bf16_f32 v203,v233,v203
M v[8:11],a[224:227],a[192:195],v[8:11]
v_cvt_pk_bf16_f32 v195,v229,v195
v_cvt_pk_bf16_f32 v199,v230,v197
M v[12:15],a[224:227],a[196:199],v[12:15]
v_cvt_pk_bf16_f32 v197,v234,v231
v_cvt_pk_bf16_f32 v201,v232,v201
M v[16:19],a[224:227],a[200:203],v[16:19]
v_add_u32 v228,121856,v243
M v[20:23],a[224:227],a[204:207],v[20:23]
ds_write2st64_b64 v228,v[192:193],v[202:203] offset0:2 offset1:19
M v[24:27],a[224:227],a[208:211],v[24:27]
s_waitcnt lgkmcnt(1)
s_add_u32 s28,s68,6291456
buffer_load_dwordx2 v[192:193],v241,s[12:15],s28 offen offset:0
M v[28:31],a[224:227],a[212:215],v[28:31]
s_waitcnt vmcnt(11)
ds_write2st64_b64 v243,v[194:195],v[196:197] offset0:2 offset1:19
M v[32:35],v[216:219],a[216:219],v[32:35]
buffer_load_dwordx2 v[202:203],v241,s[16:19],s28 offen offset:1536
M v[36:39],v[216:219],a[220:223],v[36:39]
ds_write2st64_b64 v243,v[198:199],v[200:201] offset0:138 offset1:155
M v[40:43],v[216:219],a[192:195],v[40:43]
v_lshlrev_b32 v230,16,v208
v_lshlrev_b32 v228,16,v204
M v[44:47],v[216:219],a[196:199],v[44:47]
buffer_load_dwordx2 v[194:195],v241,s[8:11],s28 offen offset:0
M v[48:51],v[216:219],a[200:203],v[48:51]
v_lshlrev_b32 v229,16,v206
v_lshlrev_b32 v233,16,v214
M v[52:55],v[216:219],a[204:207],v[52:55]
v_lshlrev_b32 v232,16,v212
v_lshlrev_b32 v231,16,v210
M v[56:59],v[216:219],a[208:211],v[56:59]
v_fmac_f32 v228,s43,v230
v_fmac_f32 v233,4.0,v229
M v[60:63],v[216:219],a[212:215],v[60:63]
s_waitcnt vmcnt(12)
buffer_load_dwordx2 v[196:197],v241,s[8:11],s28 offen offset:384
M v[64:67],v[220:223],a[216:219],v[64:67]
ds_read_b128 a[216:219],v245 offset:26112
v_fma_f32 v234,-4.0,v230,v232
M v[68:71],v[220:223],a[220:223],v[68:71]
ds_read_b128 a[220:223],v246 offset:26368
v_fmac_f32 v228,s45,v232
M v[72:75],v[220:223],a[192:195],v[72:75]
ds_read_b128 a[192:195],v246 offset:26624
v_fmac_f32 v233,s41,v231
M v[76:79],v[220:223],a[196:199],v[76:79]
buffer_load_dwordx2 v[198:199],v241,s[8:11],s28 offen offset:768
M v[80:83],v[220:223],a[200:203],v[80:83]
ds_read_b128 a[196:199],v246 offset:26880
ds_read_b128 a[200:203],v246 offset:27136
M v[84:87],v[220:223],a[204:207],v[84:87]
ds_read_b128 a[204:207],v246 offset:27392
v_sub_f32 v232,v232,v230
M v[88:91],v[220:223],a[208:211],v[88:91]
ds_read_b128 a[208:211],v246 offset:27648
v_fma_f32 v230,-4.0,v229,v231
M v[92:95],v[220:223],a[212:215],v[92:95]
s_waitcnt vmcnt(13) lgkmcnt(6)
buffer_load_dwordx2 v[200:201],v241,s[8:11],s28 offen offset:1152
M v[96:99],v[224:227],a[216:219],v[96:99]
s_waitcnt lgkmcnt(5)
ds_read_b128 a[212:215],v246 offset:27904
v_sub_f32 v231,v231,v229
M v[100:103],v[224:227],a[220:223],v[100:103]
s_waitcnt lgkmcnt(5)
v_add_f32 v229,v234,v230
v_sub_f32 v234,v234,v230
M v[104:107],v[224:227],a[192:195],v[104:107]
s_waitcnt lgkmcnt(4)
v_fma_f32 v230,2.0,v231,v232
v_fmac_f32 v232,-2.0,v231
M v[108:111],v[224:227],a[196:199],v[108:111]
s_waitcnt lgkmcnt(3)
buffer_load_dwordx4 a[224:227],v247,s[20:23],s48 offen offset:2048 sc1
M v[112:115],v[224:227],a[200:203],v[112:115]
s_waitcnt lgkmcnt(2)
s_add_u32 s46,s79,9216
v_and_b32 v208,s42,v208
v_and_b32 v204,s42,v204
M v[116:119],v[224:227],a[204:207],v[116:119]
s_waitcnt lgkmcnt(1)
v_and_b32 v206,s42,v206
v_and_b32 v214,s42,v214
M v[120:123],v[224:227],a[208:211],v[120:123]
s_waitcnt lgkmcnt(0)
v_and_b32 v212,s42,v212
v_and_b32 v210,s42,v210
M v[124:127],v[224:227],a[212:215],v[124:127]
s_waitcnt vmcnt(14)
buffer_load_dwordx4 v[216:219],v247,s[20:23],s46 offen offset:0 sc1
M v[128:131],a[228:231],a[216:219],v[128:131]
s_add_u32 s47,s79,12288
v_fmac_f32 v204,s43,v208
v_fmac_f32 v214,4.0,v206
M v[132:135],a[228:231],a[220:223],v[132:135]
v_fma_f32 v231,-4.0,v208,v212
v_fmac_f32 v204,s45,v212
M v[136:139],a[228:231],a[192:195],v[136:139]
v_fmac_f32 v214,s41,v210
v_sub_f32 v212,v212,v208
M v[140:143],a[228:231],a[196:199],v[140:143]
buffer_load_dwordx4 v[220:223],v247,s[20:23],s47 offen offset:0 sc1
M v[144:147],a[228:231],a[200:203],v[144:147]
s_add_u32 s48,s79,15360
v_fma_f32 v208,-4.0,v206,v210
v_sub_f32 v210,v210,v206
M v[148:151],a[228:231],a[204:207],v[148:151]
v_add_f32 v206,v231,v208
v_sub_f32 v231,v231,v208
M v[152:155],a[228:231],a[208:211],v[152:155]
v_fma_f32 v208,2.0,v210,v212
v_fmac_f32 v212,-2.0,v210
M v[156:159],a[228:231],a[212:215],v[156:159]
s_waitcnt vmcnt(14)
buffer_load_dwordx4 v[224:227],v247,s[20:23],s48 offen offset:0 sc1
M v[160:163],a[232:235],a[216:219],v[160:163]
ds_read_b128 a[216:219],v246 offset:28160
v_cvt_pk_bf16_f32 v204,v228,v204
M v[164:167],a[232:235],a[220:223],v[164:167]
v_cvt_pk_bf16_f32 v214,v233,v214
v_cvt_pk_bf16_f32 v206,v229,v206
M v[168:171],a[232:235],a[192:195],v[168:171]
v_cvt_pk_bf16_f32 v210,v230,v208
v_cvt_pk_bf16_f32 v208,v234,v231
M v[172:175],a[232:235],a[196:199],v[172:175]
buffer_load_dwordx4 a[228:231],v247,s[20:23],s46 offen offset:1024 sc1
M v[176:179],a[232:235],a[200:203],v[176:179]
v_cvt_pk_bf16_f32 v212,v232,v212
v_lshlrev_b32 v230,16,v209
M v[180:183],a[232:235],a[204:207],v[180:183]
v_lshlrev_b32 v228,16,v205
v_lshlrev_b32 v229,16,v207
M v[184:187],a[232:235],a[208:211],v[184:187]
v_lshlrev_b32 v233,16,v215
v_lshlrev_b32 v232,16,v213
M v[188:191],a[232:235],a[212:215],v[188:191]
s_waitcnt vmcnt(15)
buffer_load_dwordx4 a[232:235],v247,s[20:23],s47 offen offset:1024 sc1
M v[96:99],a[236:239],a[220:223],v[96:99]
v_lshlrev_b32 v231,16,v211
v_fmac_f32 v228,s43,v230
M v[100:103],a[236:239],a[192:195],v[100:103]
v_fmac_f32 v233,4.0,v229
v_fma_f32 v234,-4.0,v230,v232
M v[104:107],a[236:239],a[196:199],v[104:107]
v_fmac_f32 v228,s45,v232
v_fmac_f32 v233,s41,v231
M v[108:111],a[236:239],a[200:203],v[108:111]
v_sub_f32 v232,v232,v230
v_fma_f32 v230,-4.0,v229,v231
M v[112:115],a[236:239],a[204:207],v[112:115]
v_sub_f32 v231,v231,v229
v_add_f32 v229,v234,v230
M v[116:119],a[236:239],a[208:211],v[116:119]
v_sub_f32 v234,v234,v230
v_fma_f32 v230,2.0,v231,v232
M v[120:123],a[236:239],a[212:215],v[120:123]
s_waitcnt lgkmcnt(0)
v_fmac_f32 v232,-2.0,v231
v_and_b32 v209,s42,v209
M v[124:127],a[236:239],a[216:219],v[124:127]
s_waitcnt vmcnt(15)
buffer_load_dwordx4 a[236:239],v247,s[20:23],s48 offen offset:1024 sc1
M v[128:131],a[240:243],a[220:223],v[128:131]
v_and_b32 v205,s42,v205
v_and_b32 v207,s42,v207
M v[132:135],a[240:243],a[192:195],v[132:135]
v_and_b32 v215,s42,v215
v_and_b32 v213,s42,v213
M v[136:139],a[240:243],a[196:199],v[136:139]
v_and_b32 v211,s42,v211
v_fmac_f32 v205,s43,v209
M v[140:143],a[240:243],a[200:203],v[140:143]
v_fmac_f32 v215,4.0,v207
v_fma_f32 v231,-4.0,v209,v213
M v[144:147],a[240:243],a[204:207],v[144:147]
v_fmac_f32 v205,s45,v213
v_fmac_f32 v215,s41,v211
M v[148:151],a[240:243],a[208:211],v[148:151]
v_sub_f32 v213,v213,v209
v_fma_f32 v209,-4.0,v207,v211
M v[152:155],a[240:243],a[212:215],v[152:155]
v_sub_f32 v211,v211,v207
v_add_f32 v207,v231,v209
M v[156:159],a[240:243],a[216:219],v[156:159]
s_waitcnt vmcnt(15)
buffer_load_dwordx4 a[240:243],v247,s[20:23],s46 offen offset:2048 sc1
M v[160:163],a[244:247],a[220:223],v[160:163]
ds_read_b128 a[220:223],v245 offset:28416
v_sub_f32 v231,v231,v209
M v[164:167],a[244:247],a[192:195],v[164:167]
v_fma_f32 v209,2.0,v211,v213
v_fmac_f32 v213,-2.0,v211
M v[168:171],a[244:247],a[196:199],v[168:171]
v_cvt_pk_bf16_f32 v205,v228,v205
v_cvt_pk_bf16_f32 v215,v233,v215
M v[172:175],a[244:247],a[200:203],v[172:175]
v_cvt_pk_bf16_f32 v207,v229,v207
v_cvt_pk_bf16_f32 v211,v230,v209
M v[176:179],a[244:247],a[204:207],v[176:179]
v_cvt_pk_bf16_f32 v209,v234,v231
v_cvt_pk_bf16_f32 v213,v232,v213
M v[180:183],a[244:247],a[208:211],v[180:183]
v_add_u32 v228,121856,v243
M v[184:187],a[244:247],a[212:215],v[184:187]
ds_write2st64_b64 v228,v[204:205],v[214:215] offset0:3 offset1:20
M v[188:191],a[244:247],a[216:219],v[188:191]
s_waitcnt vmcnt(15)
s_add_u32 s28,s68,6684672
buffer_load_dwordx2 v[204:205],v241,s[12:15],s28 offen offset:0
M v[96:99],a[248:251],a[192:195],v[96:99]
ds_write2st64_b64 v243,v[206:207],v[208:209] offset0:3 offset1:20
M v[100:103],a[248:251],a[196:199],v[100:103]
buffer_load_dwordx2 v[214:215],v241,s[16:19],s28 offen offset:1536
M v[104:107],a[248:251],a[200:203],v[104:107]
ds_write2st64_b64 v243,v[210:211],v[212:213] offset0:139 offset1:156
M v[108:111],a[248:251],a[204:207],v[108:111]
s_waitcnt vmcnt(12)
v_lshlrev_b32 v230,16,v196
v_lshlrev_b32 v228,16,v192
M v[112:115],a[248:251],a[208:211],v[112:115]
buffer_load_dwordx2 v[206:207],v241,s[8:11],s28 offen offset:0
M v[116:119],a[248:251],a[212:215],v[116:119]
v_lshlrev_b32 v229,16,v194
v_lshlrev_b32 v233,16,v202
M v[120:123],a[248:251],a[216:219],v[120:123]
s_waitcnt vmcnt(11) lgkmcnt(3)
v_lshlrev_b32 v232,16,v200
v_lshlrev_b32 v231,16,v198
M v[124:127],a[248:251],a[220:223],v[124:127]
v_fmac_f32 v228,s43,v230
v_fmac_f32 v233,4.0,v229
M v[128:131],a[252:255],a[192:195],v[128:131]
buffer_load_dwordx2 v[208:209],v241,s[8:11],s28 offen offset:384
M v[132:135],a[252:255],a[196:199],v[132:135]
v_fma_f32 v234,-4.0,v230,v232
v_fmac_f32 v228,s45,v232
M v[136:139],a[252:255],a[200:203],v[136:139]
v_fmac_f32 v233,s41,v231
v_sub_f32 v232,v232,v230
M v[140:143],a[252:255],a[204:207],v[140:143]
v_fma_f32 v230,-4.0,v229,v231
v_sub_f32 v231,v231,v229
M v[144:147],a[252:255],a[208:211],v[144:147]
buffer_load_dwordx2 v[210:211],v241,s[8:11],s28 offen offset:768
M v[148:151],a[252:255],a[212:215],v[148:151]
v_add_u32 v245,0xffffbc00,v245
v_add_u32 v246,0xffffbc00,v246
M v[152:155],a[252:255],a[216:219],v[152:155]
s_waitcnt lgkmcnt(0)
s_barrier
v_add_f32 v229,v234,v230
M v[156:159],a[252:255],a[220:223],v[156:159]
s_waitcnt vmcnt(12)
v_sub_f32 v234,v234,v230
v_fma_f32 v230,2.0,v231,v232
M v[160:163],a[224:227],a[192:195],v[160:163]
buffer_load_dwordx2 v[212:213],v241,s[8:11],s28 offen offset:1152
M v[164:167],a[224:227],a[196:199],v[164:167]
ds_read_b128 a[192:195],v245 offset:0
ds_read_b128 a[196:199],v246 offset:256
M v[168:171],a[224:227],a[200:203],v[168:171]
ds_read_b128 a[200:203],v246 offset:512
v_fmac_f32 v232,-2.0,v231
M v[172:175],a[224:227],a[204:207],v[172:175]
ds_read_b128 a[204:207],v246 offset:768
v_and_b32 v196,s42,v196
M v[176:179],a[224:227],a[208:211],v[176:179]
buffer_load_dwordx4 a[244:247],v247,s[20:23],s47 offen offset:2048 sc1
M v[180:183],a[224:227],a[212:215],v[180:183]
ds_read_b128 a[208:211],v246 offset:1024
ds_read_b128 a[212:215],v246 offset:1280
M v[184:187],a[224:227],a[216:219],v[184:187]
ds_read_b128 a[216:219],v246 offset:1536
v_and_b32 v192,s42,v192
M v[188:191],a[224:227],a[220:223],v[188:191]
s_waitcnt vmcnt(13) lgkmcnt(6)
ds_read_b128 a[220:223],v246 offset:1792
v_and_b32 v194,s42,v194
M a[0:3],v[216:219],a[192:195],a[0:3]
s_waitcnt lgkmcnt(6)
buffer_load_dwordx4 a[248:251],v247,s[20:23],s48 offen offset:2048 sc1
M a[4:7],v[216:219],a[196:199],a[4:7]
s_waitcnt lgkmcnt(5)
s_add_u32 s46,s79,18432
v_and_b32 v202,s42,v202
v_and_b32 v200,s42,v200
M a[8:11],v[216:219],a[200:203],a[8:11]
s_waitcnt lgkmcnt(4)
v_and_b32 v198,s42,v198
v_fmac_f32 v192,s43,v196
M a[12:15],v[216:219],a[204:207],a[12:15]
s_waitcnt lgkmcnt(3)
v_fmac_f32 v202,4.0,v194
v_fma_f32 v231,-4.0,v196,v200
M a[16:19],v[216:219],a[208:211],a[16:19]
s_waitcnt lgkmcnt(2)
buffer_load_dwordx4 a[252:255],v247,s[20:23],s46 offen offset:0 sc1
M a[20:23],v[216:219],a[212:215],a[20:23]
s_waitcnt lgkmcnt(1)
s_add_u32 s47,s79,21504
v_fmac_f32 v192,s45,v200
v_fmac_f32 v202,s41,v198
M a[24:27],v[216:219],a[216:219],a[24:27]
s_waitcnt lgkmcnt(0)
v_sub_f32 v200,v200,v196
v_fma_f32 v196,-4.0,v194,v198
M a[28:31],v[216:219],a[220:223],a[28:31]
s_waitcnt vmcnt(14)
v_sub_f32 v198,v198,v194
v_add_f32 v194,v231,v196
M a[32:35],v[220:223],a[192:195],a[32:35]
buffer_load_dwordx4 a[224:227],v247,s[20:23],s47 offen offset:0 sc1
M a[36:39],v[220:223],a[196:199],a[36:39]
s_add_u32 s48,s79,24576
v_sub_f32 v231,v231,v196
v_fma_f32 v196,2.0,v198,v200
M a[40:43],v[220:223],a[200:203],a[40:43]
v_fmac_f32 v200,-2.0,v198
v_cvt_pk_bf16_f32 v192,v228,v192
M a[44:47],v[220:223],a[204:207],a[44:47]
v_cvt_pk_bf16_f32 v202,v233,v202
v_cvt_pk_bf16_f32 v194,v229,v194
M a[48:51],v[220:223],a[208:211],a[48:51]
buffer_load_dwordx4 v[216:219],v247,s[20:23],s48 offen offset:0 sc1
M a[52:55],v[220:223],a[212:215],a[52:55]
v_cvt_pk_bf16_f32 v198,v230,v196
v_cvt_pk_bf16_f32 v196,v234,v231
M a[56:59],v[220:223],a[216:219],a[56:59]
v_cvt_pk_bf16_f32 v200,v232,v200
v_lshlrev_b32 v230,16,v197
M a[60:63],v[220:223],a[220:223],a[60:63]
s_waitcnt vmcnt(15)
v_lshlrev_b32 v228,16,v193
v_lshlrev_b32 v229,16,v195
M a[64:67],v[224:227],a[192:195],a[64:67]
buffer_load_dwordx4 v[220:223],v247,s[20:23],s46 offen offset:1024 sc1
M a[68:71],v[224:227],a[196:199],a[68:71]
ds_read_b128 a[192:195],v246 offset:2048
v_lshlrev_b32 v233,16,v203
M a[72:75],v[224:227],a[200:203],a[72:75]
v_lshlrev_b32 v232,16,v201
v_lshlrev_b32 v231,16,v199
M a[76:79],v[224:227],a[204:207],a[76:79]
v_fmac_f32 v228,s43,v230
v_fmac_f32 v233,4.0,v229
M a[80:83],v[224:227],a[208:211],a[80:83]
v_fma_f32 v234,-4.0,v230,v232
v_fmac_f32 v228,s45,v232
M a[84:87],v[224:227],a[212:215],a[84:87]
v_fmac_f32 v233,s41,v231
v_sub_f32 v232,v232,v230
M a[88:91],v[224:227],a[216:219],a[88:91]
v_fma_f32 v230,-4.0,v229,v231
v_sub_f32 v231,v231,v229
M a[92:95],v[224:227],a[220:223],a[92:95]
s_waitcnt vmcnt(15)
buffer_load_dwordx4 v[224:227],v247,s[20:23],s47 offen offset:1024 sc1
M a[0:3],a[228:231],a[196:199],a[0:3]
v_add_f32 v229,v234,v230
v_sub_f32 v234,v234,v230
M a[4:7],a[228:231],a[200:203],a[4:7]
v_fma_f32 v230,2.0,v231,v232
v_fmac_f32 v232,-2.0,v231
M a[8:11],a[228:231],a[204:207],a[8:11]
v_and_b32 v197,s42,v197
v_and_b32 v193,s42,v193
M a[12:15],a[228:231],a[208:211],a[12:15]
v_and_b32 v195,s42,v195
v_and_b32 v203,s42,v203
M a[16:19],a[228:231],a[212:215],a[16:19]
v_and_b32 v201,s42,v201
v_and_b32 v199,s42,v199
M a[20:23],a[228:231],a[216:219],a[20:23]
v_fmac_f32 v193,s43,v197
v_fmac_f32 v203,4.0,v195
M a[24:27],a[228:231],a[220:223],a[24:27]
s_waitcnt lgkmcnt(0)
v_fma_f32 v231,-4.0,v197,v201
v_fmac_f32 v193,s45,v201
M a[28:31],a[228:231],a[192:195],a[28:31]
s_waitcnt vmcnt(15)
buffer_load_dwordx4 a[228:231],v247,s[20:23],s48 offen offset:1024 sc1
M a[32:35],a[232:235],a[196:199],a[32:35]
v_fmac_f32 v203,s41,v199
v_sub_f32 v201,v201,v197
M a[36:39],a[232:235],a[200:203],a[36:39]
v_fma_f32 v197,-4.0,v195,v199
v_sub_f32 v199,v199,v195
M a[40:43],a[232:235],a[204:207],a[40:43]
v_add_f32 v195,v231,v197
v_sub_f32 v231,v231,v197
M a[44:47],a[232:235],a[208:211],a[44:47]
v_fma_f32 v197,2.0,v199,v201
v_fmac_f32 v201,-2.0,v199
M a[48:51],a[232:235],a[212:215],a[48:51]
v_cvt_pk_bf16_f32 v193,v228,v193
v_cvt_pk_bf16_f32 v203,v233,v203
M a[52:55],a[232:235],a[216:219],a[52:55]
v_cvt_pk_bf16_f32 v195,v229,v195
v_cvt_pk_bf16_f32 v199,v230,v197
M a[56:59],a[232:235],a[220:223],a[56:59]
v_cvt_pk_bf16_f32 v197,v234,v231
v_cvt_pk_bf16_f32 v201,v232,v201
M a[60:63],a[232:235],a[192:195],a[60:63]
s_waitcnt vmcnt(15)
buffer_load_dwordx4 a[232:235],v247,s[20:23],s46 offen offset:2048 sc1
M a[64:67],a[236:239],a[196:199],a[64:67]
ds_read_b128 a[196:199],v245 offset:2304
v_add_u32 v228,139264,v243
M a[68:71],a[236:239],a[200:203],a[68:71]
ds_write2st64_b64 v228,v[192:193],v[202:203] offset0:0 offset1:17
M a[72:75],a[236:239],a[204:207],a[72:75]
s_add_u32 s28,s68,7077888
buffer_load_dwordx2 v[192:193],v241,s[12:15],s28 offen offset:0
M a[76:79],a[236:239],a[208:211],a[76:79]
ds_write2st64_b64 v243,v[194:195],v[196:197] offset0:34 offset1:51
M a[80:83],a[236:239],a[212:215],a[80:83]
buffer_load_dwordx2 v[202:203],v241,s[16:19],s28 offen offset:1536
M a[84:87],a[236:239],a[216:219],a[84:87]
ds_write2st64_b64 v243,v[198:199],v[200:201] offset0:68 offset1:85
M a[88:91],a[236:239],a[220:223],a[88:91]
s_waitcnt vmcnt(13)
v_lshlrev_b32 v230,16,v208
v_lshlrev_b32 v228,16,v204
M a[92:95],a[236:239],a[192:195],a[92:95]
buffer_load_dwordx2 v[194:195],v241,s[8:11],s28 offen offset:0
M a[0:3],a[240:243],a[200:203],a[0:3]
v_lshlrev_b32 v229,16,v206
v_lshlrev_b32 v233,16,v214
M a[4:7],a[240:243],a[204:207],a[4:7]
s_waitcnt vmcnt(12)
v_lshlrev_b32 v232,16,v212
v_lshlrev_b32 v231,16,v210
M a[8:11],a[240:243],a[208:211],a[8:11]
v_fmac_f32 v228,s43,v230
v_fmac_f32 v233,4.0,v229
M a[12:15],a[240:243],a[212:215],a[12:15]
buffer_load_dwordx2 v[196:197],v241,s[8:11],s28 offen offset:384
M a[16:19],a[240:243],a[216:219],a[16:19]
v_fma_f32 v234,-4.0,v230,v232
v_fmac_f32 v228,s45,v232
M a[20:23],a[240:243],a[220:223],a[20:23]
v_fmac_f32 v233,s41,v231
v_sub_f32 v232,v232,v230
M a[24:27],a[240:243],a[192:195],a[24:27]
s_waitcnt lgkmcnt(3)
v_fma_f32 v230,-4.0,v229,v231
v_sub_f32 v231,v231,v229
M a[28:31],a[240:243],a[196:199],a[28:31]
s_waitcnt vmcnt(12)
buffer_load_dwordx2 v[198:199],v241,s[8:11],s28 offen offset:768
M a[32:35],a[244:247],a[200:203],a[32:35]
v_add_f32 v229,v234,v230
v_sub_f32 v234,v234,v230
M a[36:39],a[244:247],a[204:207],a[36:39]
v_fma_f32 v230,2.0,v231,v232
v_fmac_f32 v232,-2.0,v231
M a[40:43],a[244:247],a[208:211],a[40:43]
v_and_b32 v208,s42,v208
v_and_b32 v204,s42,v204
M a[44:47],a[244:247],a[212:215],a[44:47]
buffer_load_dwordx2 v[200:201],v241,s[8:11],s28 offen offset:1152
M a[48:51],a[244:247],a[216:219],a[48:51]
v_and_b32 v206,s42,v206
v_and_b32 v214,s42,v214
M a[52:55],a[244:247],a[220:223],a[52:55]
v_and_b32 v212,s42,v212
v_and_b32 v210,s42,v210
M a[56:59],a[244:247],a[192:195],a[56:59]
v_fmac_f32 v204,s43,v208
v_fmac_f32 v214,4.0,v206
M a[60:63],a[244:247],a[196:199],a[60:63]
s_waitcnt vmcnt(13)
buffer_load_dwordx4 a[236:239],v247,s[20:23],s47 offen offset:2048 sc1
M a[64:67],a[248:251],a[200:203],a[64:67]
ds_read_b128 a[200:203],v245 offset:8704
v_fma_f32 v231,-4.0,v208,v212
M a[68:71],a[248:251],a[204:207],a[68:71]
ds_read_b128 a[204:207],v246 offset:8960
v_fmac_f32 v204,s45,v212
M a[72:75],a[248:251],a[208:211],a[72:75]
ds_read_b128 a[208:211],v246 offset:9216
v_fmac_f32 v214,s41,v210
M a[76:79],a[248:251],a[212:215],a[76:79]
buffer_load_dwordx4 a[240:243],v247,s[20:23],s48 offen offset:2048 sc1
M a[80:83],a[248:251],a[216:219],a[80:83]
s_add_u32 s46,s79,27648
ds_read_b128 a[212:215],v246 offset:9472
ds_read_b128 a[216:219],v246 offset:9728
M a[84:87],a[248:251],a[220:223],a[84:87]
ds_read_b128 a[220:223],v246 offset:9984
v_sub_f32 v212,v212,v208
M a[88:91],a[248:251],a[192:195],a[88:91]
ds_read_b128 a[192:195],v246 offset:10240
v_fma_f32 v208,-4.0,v206,v210
M a[92:95],a[248:251],a[196:199],a[92:95]
s_waitcnt vmcnt(14) lgkmcnt(6)
buffer_load_dwordx4 a[244:247],v247,s[20:23],s46 offen offset:0 sc1
M a[96:99],a[252:255],a[200:203],a[96:99]
s_waitcnt lgkmcnt(5)
s_add_u32 s47,s79,30720
ds_read_b128 a[196:199],v246 offset:10496
v_sub_f32 v210,v210,v206
M a[100:103],a[252:255],a[204:207],a[100:103]
s_waitcnt lgkmcnt(5)
v_add_f32 v206,v231,v208
v_sub_f32 v231,v231,v208
M a[104:107],a[252:255],a[208:211],a[104:107]
s_waitcnt lgkmcnt(4)
v_fma_f32 v208,2.0,v210,v212
v_fmac_f32 v212,-2.0,v210
M a[108:111],a[252:255],a[212:215],a[108:111]
s_waitcnt lgkmcnt(3)
buffer_load_dwordx4 a[248:251],v247,s[20:23],s47 offen offset:0 sc1
M a[112:115],a[252:255],a[216:219],a[112:115]
s_waitcnt lgkmcnt(2)
s_add_u32 s48,s79,33792
v_cvt_pk_bf16_f32 v204,v228,v204
v_cvt_pk_bf16_f32 v214,v233,v214
M a[116:119],a[252:255],a[220:223],a[116:119]
s_waitcnt lgkmcnt(1)
v_cvt_pk_bf16_f32 v206,v229,v206
v_cvt_pk_bf16_f32 v210,v230,v208
M a[120:123],a[252:255],a[192:195],a[120:123]
s_waitcnt lgkmcnt(0)
v_cvt_pk_bf16_f32 v208,v234,v231
v_cvt_pk_bf16_f32 v212,v232,v212
M a[124:127],a[252:255],a[196:199],a[124:127]
s_waitcnt vmcnt(15)
buffer_load_dwordx4 a[252:255],v247,s[20:23],s48 offen offset:0 sc1
M a[128:131],a[224:227],a[200:203],a[128:131]
v_lshlrev_b32 v230,16,v209
v_lshlrev_b32 v228,16,v205
M a[132:135],a[224:227],a[204:207],a[132:135]
v_lshlrev_b32 v229,16,v207
v_lshlrev_b32 v233,16,v215
M a[136:139],a[224:227],a[208:211],a[136:139]
v_lshlrev_b32 v232,16,v213
v_lshlrev_b32 v231,16,v211
M a[140:143],a[224:227],a[212:215],a[140:143]
v_fmac_f32 v228,s43,v230
v_fmac_f32 v233,4.0,v229
M a[144:147],a[224:227],a[216:219],a[144:147]
v_fma_f32 v234,-4.0,v230,v232
v_fmac_f32 v228,s45,v232
M a[148:151],a[224:227],a[220:223],a[148:151]
v_fmac_f32 v233,s41,v231
v_sub_f32 v232,v232,v230
M a[152:155],a[224:227],a[192:195],a[152:155]
v_fma_f32 v230,-4.0,v229,v231
v_sub_f32 v231,v231,v229
M a[156:159],a[224:227],a[196:199],a[156:159]
s_waitcnt vmcnt(15)
buffer_load_dwordx4 a[224:227],v247,s[20:23],s46 offen offset:1024 sc1
M a[160:163],v[216:219],a[200:203],a[160:163]
ds_read_b128 a[200:203],v246 offset:10752
v_add_f32 v229,v234,v230
M a[164:167],v[216:219],a[204:207],a[164:167]
v_sub_f32 v234,v234,v230
v_fma_f32 v230,2.0,v231,v232
M a[168:171],v[216:219],a[208:211],a[168:171]
v_fmac_f32 v232,-2.0,v231
v_and_b32 v209,s42,v209
M a[172:175],v[216:219],a[212:215],a[172:175]
v_and_b32 v205,s42,v205
v_and_b32 v207,s42,v207
M a[176:179],v[216:219],a[216:219],a[176:179]
v_and_b32 v215,s42,v215
v_and_b32 v213,s42,v213
M a[180:183],v[216:219],a[220:223],a[180:183]
v_and_b32 v211,s42,v211
v_fmac_f32 v205,s43,v209
M a[184:187],v[216:219],a[192:195],a[184:187]
v_fmac_f32 v215,4.0,v207
v_fma_f32 v231,-4.0,v209,v213
M a[188:191],v[216:219],a[196:199],a[188:191]
s_waitcnt vmcnt(15)
buffer_load_dwordx4 v[216:219],v247,s[20:23],s47 offen offset:1024 sc1
M a[96:99],v[220:223],a[204:207],a[96:99]
v_fmac_f32 v205,s45,v213
v_fmac_f32 v215,s41,v211
M a[100:103],v[220:223],a[208:211],a[100:103]
v_sub_f32 v213,v213,v209
v_fma_f32 v209,-4.0,v207,v211
M a[104:107],v[220:223],a[212:215],a[104:107]
v_sub_f32 v211,v211,v207
v_add_f32 v207,v231,v209
M a[108:111],v[220:223],a[216:219],a[108:111]
v_sub_f32 v231,v231,v209
v_fma_f32 v209,2.0,v211,v213
M a[112:115],v[220:223],a[220:223],a[112:115]
v_fmac_f32 v213,-2.0,v211
v_cvt_pk_bf16_f32 v205,v228,v205
M a[116:119],v[220:223],a[192:195],a[116:119]
v_cvt_pk_bf16_f32 v215,v233,v215
v_cvt_pk_bf16_f32 v207,v229,v207
M a[120:123],v[220:223],a[196:199],a[120:123]
s_waitcnt lgkmcnt(0)
v_cvt_pk_bf16_f32 v211,v230,v209
v_cvt_pk_bf16_f32 v209,v234,v231
M a[124:127],v[220:223],a[200:203],a[124:127]
s_waitcnt vmcnt(15)
buffer_load_dwordx4 v[220:223],v247,s[20:23],s48 offen offset:1024 sc1
M a[128:131],v[224:227],a[204:207],a[128:131]
v_cvt_pk_bf16_f32 v213,v232,v213
v_add_u32 v228,139264,v243
M a[132:135],v[224:227],a[208:211],a[132:135]
ds_write2st64_b64 v228,v[204:205],v[214:215] offset0:1 offset1:18
M a[136:139],v[224:227],a[212:215],a[136:139]
s_add_u32 s28,s68,7471104
buffer_load_dwordx2 v[204:205],v241,s[12:15],s28 offen offset:0
M a[140:143],v[224:227],a[216:219],a[140:143]
ds_write2st64_b64 v243,v[206:207],v[208:209] offset0:35 offset1:52
M a[144:147],v[224:227],a[220:223],a[144:147]
buffer_load_dwordx2 v[214:215],v241,s[16:19],s28 offen offset:1536
M a[148:151],v[224:227],a[192:195],a[148:151]
ds_write2st64_b64 v243,v[210:211],v[212:213] offset0:69 offset1:86
M a[152:155],v[224:227],a[196:199],a[152:155]
v_fmac_f32 v235,s43,v237
v_fmac_f32 v240,4.0,v236
M a[156:159],v[224:227],a[200:203],a[156:159]
s_waitcnt vmcnt(17)
buffer_load_dwordx2 v[206:207],v241,s[8:11],s28 offen offset:0
M a[160:163],a[228:231],a[204:207],a[160:163]
ds_read_b128 a[204:207],v245 offset:11008
v_fma_f32 v228,-4.0,v237,v239
M a[164:167],a[228:231],a[208:211],a[164:167]
v_fmac_f32 v235,s45,v239
v_fmac_f32 v240,s41,v238
M a[168:171],a[228:231],a[212:215],a[168:171]
v_sub_f32 v239,v239,v237
v_fma_f32 v237,-4.0,v236,v238
M a[172:175],a[228:231],a[216:219],a[172:175]
buffer_load_dwordx2 v[208:209],v241,s[8:11],s28 offen offset:384
M a[176:179],a[228:231],a[220:223],a[176:179]
v_sub_f32 v238,v238,v236
v_add_f32 v236,v228,v237
M a[180:183],a[228:231],a[192:195],a[180:183]
v_sub_f32 v228,v228,v237
v_fma_f32 v237,2.0,v238,v239
M a[184:187],a[228:231],a[196:199],a[184:187]
v_fmac_f32 v239,-2.0,v238
v_cvt_pk_bf16_f32 v229,v235,v240
M a[188:191],a[228:231],a[200:203],a[188:191]
s_waitcnt vmcnt(18)
buffer_load_dwordx2 v[210:211],v241,s[8:11],s28 offen offset:768
M a[96:99],a[232:235],a[208:211],a[96:99]
v_cvt_pk_bf16_f32 v230,v236,v228
v_cvt_pk_bf16_f32 v231,v237,v239
M a[100:103],a[232:235],a[212:215],a[100:103]
v_add_u32 v228,139264,v244
M a[104:107],a[232:235],a[216:219],a[104:107]
ds_write_b16 v228,v229 offset:0
M a[108:111],a[232:235],a[220:223],a[108:111]
buffer_load_dwordx2 v[212:213],v241,s[8:11],s28 offen offset:1152
M a[112:115],a[232:235],a[192:195],a[112:115]
ds_write_b16_d16_hi v228,v229 offset:8704
M a[116:119],a[232:235],a[196:199],a[116:119]
ds_write_b16 v244,v230 offset:17408
M a[120:123],a[232:235],a[200:203],a[120:123]
s_waitcnt lgkmcnt(3)
ds_write_b16_d16_hi v244,v230 offset:26112
M a[124:127],a[232:235],a[204:207],a[124:127]
s_waitcnt vmcnt(13)
buffer_load_short_d16_hi v235,v242,s[12:15],s75 offen offset:0
M a[128:131],a[236:239],a[208:211],a[128:131]
ds_write_b16 v244,v231 offset:34816
M a[132:135],a[236:239],a[212:215],a[132:135]
buffer_load_short_d16_hi v236,v242,s[8:11],s75 offen offset:0
M a[136:139],a[236:239],a[216:219],a[136:139]
ds_write_b16_d16_hi v244,v231 offset:43520
M a[140:143],a[236:239],a[220:223],a[140:143]
buffer_load_short_d16_hi v237,v242,s[8:11],s75 offen offset:384
M a[144:147],a[236:239],a[192:195],a[144:147]
v_lshlrev_b32 v230,16,v196
v_lshlrev_b32 v228,16,v192
M a[148:151],a[236:239],a[196:199],a[148:151]
buffer_load_short_d16_hi v238,v242,s[8:11],s75 offen offset:768
M a[152:155],a[236:239],a[200:203],a[152:155]
v_add_u32 v245,0x4400,v245
v_add_u32 v246,0x4400,v246
M a[156:159],a[236:239],a[204:207],a[156:159]
s_waitcnt vmcnt(16)
buffer_load_short_d16_hi v239,v242,s[8:11],s75 offen offset:1152
M a[160:163],a[240:243],a[208:211],a[160:163]
ds_read_b128 a[208:211],v245 offset:52224
v_lshlrev_b32 v229,16,v194
M a[164:167],a[240:243],a[212:215],a[164:167]
buffer_load_short_d16_hi v240,v242,s[16:19],s75 offen offset:1536
M a[168:171],a[240:243],a[216:219],a[168:171]
ds_read_b128 a[212:215],v246 offset:52480
ds_read_b128 a[216:219],v246 offset:52736
M a[172:175],a[240:243],a[220:223],a[172:175]
buffer_load_dwordx4 v[224:227],v247,s[20:23],s46 offen offset:2048 sc1
M a[176:179],a[240:243],a[192:195],a[176:179]
ds_read_b128 a[220:223],v246 offset:52992
ds_read_b128 a[192:195],v246 offset:53248
M a[180:183],a[240:243],a[196:199],a[180:183]
ds_read_b128 a[196:199],v246 offset:53504
v_lshlrev_b32 v233,16,v202
M a[184:187],a[240:243],a[200:203],a[184:187]
ds_read_b128 a[200:203],v246 offset:53760
v_lshlrev_b32 v232,16,v200
M a[188:191],a[240:243],a[204:207],a[188:191]
s_waitcnt vmcnt(18) lgkmcnt(6)
buffer_load_dwordx4 a[228:231],v247,s[20:23],s47 offen offset:2048 sc1
M v[0:3],a[244:247],a[208:211],v[0:3]
s_waitcnt lgkmcnt(5)
ds_read_b128 a[204:207],v246 offset:54016
v_lshlrev_b32 v231,16,v198
M v[4:7],a[244:247],a[212:215],v[4:7]
s_waitcnt lgkmcnt(5)
v_fmac_f32 v228,s43,v230
v_fmac_f32 v233,4.0,v229
M v[8:11],a[244:247],a[216:219],v[8:11]
s_waitcnt lgkmcnt(4)
v_fma_f32 v234,-4.0,v230,v232
v_fmac_f32 v228,s45,v232
M v[12:15],a[244:247],a[220:223],v[12:15]
s_waitcnt lgkmcnt(3)
buffer_load_dwordx4 a[232:235],v247,s[20:23],s48 offen offset:2048 sc1
M v[16:19],a[244:247],a[192:195],v[16:19]
s_waitcnt lgkmcnt(2)
s_add_u32 s46,s79,36864
v_fmac_f32 v233,s41,v231
v_sub_f32 v232,v232,v230
M v[20:23],a[244:247],a[196:199],v[20:23]
s_waitcnt lgkmcnt(1)
v_fma_f32 v230,-4.0,v229,v231
v_sub_f32 v231,v231,v229
M v[24:27],a[244:247],a[200:203],v[24:27]
s_waitcnt lgkmcnt(0)
v_add_f32 v229,v234,v230
v_sub_f32 v234,v234,v230
M v[28:31],a[244:247],a[204:207],v[28:31]
s_waitcnt vmcnt(19)
buffer_load_dwordx4 a[236:239],v247,s[20:23],s46 offen offset:0 sc1
M v[32:35],a[248:251],a[208:211],v[32:35]
s_add_u32 s47,s79,39936
v_fma_f32 v230,2.0,v231,v232
v_fmac_f32 v232,-2.0,v231
M v[36:39],a[248:251],a[212:215],v[36:39]
v_and_b32 v196,s42,v196
v_and_b32 v192,s42,v192
M v[40:43],a[248:251],a[216:219],v[40:43]
v_and_b32 v194,s42,v194
v_and_b32 v202,s42,v202
M v[44:47],a[248:251],a[220:223],v[44:47]
buffer_load_dwordx4 a[240:243],v247,s[20:23],s47 offen offset:0 sc1
M v[48:51],a[248:251],a[192:195],v[48:51]
s_add_u32 s48,s79,43008
v_and_b32 v200,s42,v200
v_and_b32 v198,s42,v198
M v[52:55],a[248:251],a[196:199],v[52:55]
v_fmac_f32 v192,s43,v196
v_fmac_f32 v202,4.0,v194
M v[56:59],a[248:251],a[200:203],v[56:59]
v_fma_f32 v231,-4.0,v196,v200
v_fmac_f32 v192,s45,v200
M v[60:63],a[248:251],a[204:207],v[60:63]
s_waitcnt vmcnt(20)
global_load_dword v251,v252,s[82:83]
M v[64:67],a[252:255],a[208:211],v[64:67]
ds_read_b128 a[208:211],v246 offset:54272
v_fmac_f32 v202,s41,v198
M v[68:71],a[252:255],a[212:215],v[68:71]
buffer_load_dwordx4 a[244:247],v247,s[20:23],s48 offen offset:0 sc1
M v[72:75],a[252:255],a[216:219],v[72:75]
v_sub_f32 v200,v200,v196
v_fma_f32 v196,-4.0,v194,v198
M v[76:79],a[252:255],a[220:223],v[76:79]
v_sub_f32 v198,v198,v194
v_add_f32 v194,v231,v196
M v[80:83],a[252:255],a[192:195],v[80:83]
v_sub_f32 v231,v231,v196
v_fma_f32 v196,2.0,v198,v200
M v[84:87],a[252:255],a[196:199],v[84:87]
buffer_load_dwordx4 a[248:251],v247,s[20:23],s46 offen offset:1024 sc1
M v[88:91],a[252:255],a[200:203],v[88:91]
v_fmac_f32 v200,-2.0,v198
v_cvt_pk_bf16_f32 v192,v228,v192
M v[92:95],a[252:255],a[204:207],v[92:95]
s_waitcnt vmcnt(22)
v_cvt_pk_bf16_f32 v202,v233,v202
v_cvt_pk_bf16_f32 v194,v229,v194
M v[0:3],a[224:227],a[212:215],v[0:3]
v_cvt_pk_bf16_f32 v198,v230,v196
v_cvt_pk_bf16_f32 v196,v234,v231
M v[4:7],a[224:227],a[216:219],v[4:7]
buffer_load_dwordx4 a[252:255],v247,s[20:23],s47 offen offset:1024 sc1
M v[8:11],a[224:227],a[220:223],v[8:11]
v_cvt_pk_bf16_f32 v200,v232,v200
v_lshlrev_b32 v230,16,v197
M v[12:15],a[224:227],a[192:195],v[12:15]
v_lshlrev_b32 v228,16,v193
v_lshlrev_b32 v229,16,v195
M v[16:19],a[224:227],a[196:199],v[16:19]
v_lshlrev_b32 v233,16,v203
v_lshlrev_b32 v232,16,v201
M v[20:23],a[224:227],a[200:203],v[20:23]
v_lshlrev_b32 v231,16,v199
v_fmac_f32 v228,s43,v230
M v[24:27],a[224:227],a[204:207],v[24:27]
s_waitcnt lgkmcnt(0)
v_fmac_f32 v233,4.0,v229
v_fma_f32 v234,-4.0,v230,v232
M v[28:31],a[224:227],a[208:211],v[28:31]
s_waitcnt vmcnt(22)
buffer_load_dwordx4 a[224:227],v247,s[20:23],s48 offen offset:1024 sc1
M v[32:35],v[216:219],a[212:215],v[32:35]
v_fmac_f32 v228,s45,v232
v_fmac_f32 v233,s41,v231
M v[36:39],v[216:219],a[216:219],v[36:39]
v_sub_f32 v232,v232,v230
v_fma_f32 v230,-4.0,v229,v231
M v[40:43],v[216:219],a[220:223],v[40:43]
v_sub_f32 v231,v231,v229
v_add_f32 v229,v234,v230
M v[44:47],v[216:219],a[192:195],v[44:47]
v_sub_f32 v234,v234,v230
v_fma_f32 v230,2.0,v231,v232
M v[48:51],v[216:219],a[196:199],v[48:51]
v_fmac_f32 v232,-2.0,v231
v_and_b32 v197,s42,v197
M v[52:55],v[216:219],a[200:203],v[52:55]
v_and_b32 v193,s42,v193
v_and_b32 v195,s42,v195
M v[56:59],v[216:219],a[204:207],v[56:59]
v_and_b32 v203,s42,v203
v_and_b32 v201,s42,v201
M v[60:63],v[216:219],a[208:211],v[60:63]
s_waitcnt vmcnt(22)
buffer_load_dwordx4 v[216:219],v247,s[20:23],s46 offen offset:2048 sc1
M v[64:67],v[220:223],a[212:215],v[64:67]
ds_read_b128 a[212:215],v245 offset:54528
v_and_b32 v199,s42,v199
M v[68:71],v[220:223],a[216:219],v[68:71]
v_fmac_f32 v193,s43,v197
v_fmac_f32 v203,4.0,v195
M v[72:75],v[220:223],a[220:223],v[72:75]
v_fma_f32 v231,-4.0,v197,v201
v_fmac_f32 v193,s45,v201
M v[76:79],v[220:223],a[192:195],v[76:79]
v_fmac_f32 v203,s41,v199
v_sub_f32 v201,v201,v197
M v[80:83],v[220:223],a[196:199],v[80:83]
v_fma_f32 v197,-4.0,v195,v199
v_sub_f32 v199,v199,v195
M v[84:87],v[220:223],a[200:203],v[84:87]
v_add_f32 v195,v231,v197
v_sub_f32 v231,v231,v197
M v[88:91],v[220:223],a[204:207],v[88:91]
v_fma_f32 v197,2.0,v199,v201
v_fmac_f32 v201,-2.0,v199
M v[92:95],v[220:223],a[208:211],v[92:95]
s_waitcnt vmcnt(10)
buffer_load_dwordx4 v[220:223],v247,s[20:23],s47 offen offset:2048 sc1
M v[0:3],v[224:227],a[216:219],v[0:3]
v_cvt_pk_bf16_f32 v193,v228,v193
v_cvt_pk_bf16_f32 v203,v233,v203
M v[4:7],v[224:227],a[220:223],v[4:7]
v_cvt_pk_bf16_f32 v195,v229,v195
v_cvt_pk_bf16_f32 v199,v230,v197
M v[8:11],v[224:227],a[192:195],v[8:11]
v_cvt_pk_bf16_f32 v197,v234,v231
v_cvt_pk_bf16_f32 v201,v232,v201
M v[12:15],v[224:227],a[196:199],v[12:15]
v_add_u32 v228,139264,v243
M v[16:19],v[224:227],a[200:203],v[16:19]
ds_write2st64_b64 v228,v[192:193],v[202:203] offset0:2 offset1:19
M v[20:23],v[224:227],a[204:207],v[20:23]
s_add_u32 s28,s69,6291456
buffer_load_dwordx2 v[192:193],v241,s[12:15],s28 offen offset:0
M v[24:27],v[224:227],a[208:211],v[24:27]
s_waitcnt lgkmcnt(1)
ds_write2st64_b64 v243,v[194:195],v[196:197] offset0:36 offset1:53
M v[28:31],v[224:227],a[212:215],v[28:31]
s_waitcnt vmcnt(11)
buffer_load_dwordx2 v[202:203],v241,s[16:19],s28 offen offset:1536
M v[32:35],a[228:231],a[216:219],v[32:35]
ds_write2st64_b64 v243,v[198:199],v[200:201] offset0:70 offset1:87
M v[36:39],a[228:231],a[220:223],v[36:39]
v_lshlrev_b32 v230,16,v208
v_lshlrev_b32 v228,16,v204
M v[40:43],a[228:231],a[192:195],v[40:43]
buffer_load_dwordx2 v[194:195],v241,s[8:11],s28 offen offset:0
M v[44:47],a[228:231],a[196:199],v[44:47]
v_lshlrev_b32 v229,16,v206
v_lshlrev_b32 v233,16,v214
M v[48:51],a[228:231],a[200:203],v[48:51]
v_lshlrev_b32 v232,16,v212
v_lshlrev_b32 v231,16,v210
M v[52:55],a[228:231],a[204:207],v[52:55]
v_fmac_f32 v228,s43,v230
v_fmac_f32 v233,4.0,v229
M v[56:59],a[228:231],a[208:211],v[56:59]
buffer_load_dwordx2 v[196:197],v241,s[8:11],s28 offen offset:384
M v[60:63],a[228:231],a[212:215],v[60:63]
s_waitcnt vmcnt(13)
v_fma_f32 v234,-4.0,v230,v232
v_fmac_f32 v228,s45,v232
M v[64:67],a[232:235],a[216:219],v[64:67]
ds_read_b128 a[216:219],v245 offset:60928
v_fmac_f32 v233,s41,v231
M v[68:71],a[232:235],a[220:223],v[68:71]
ds_read_b128 a[220:223],v246 offset:61184
v_sub_f32 v232,v232,v230
M v[72:75],a[232:235],a[192:195],v[72:75]
buffer_load_dwordx2 v[198:199],v241,s[8:11],s28 offen offset:768
M v[76:79],a[232:235],a[196:199],v[76:79]
ds_read_b128 a[192:195],v246 offset:61440
ds_read_b128 a[196:199],v246 offset:61696
M v[80:83],a[232:235],a[200:203],v[80:83]
ds_read_b128 a[200:203],v246 offset:61952
v_fma_f32 v230,-4.0,v229,v231
M v[84:87],a[232:235],a[204:207],v[84:87]
ds_read_b128 a[204:207],v246 offset:62208
v_sub_f32 v231,v231,v229
M v[88:91],a[232:235],a[208:211],v[88:91]
buffer_load_dwordx2 v[200:201],v241,s[8:11],s28 offen offset:1152
M v[92:95],a[232:235],a[212:215],v[92:95]
s_waitcnt vmcnt(14) lgkmcnt(5)
ds_read_b128 a[208:211],v246 offset:62464
ds_read_b128 a[212:215],v246 offset:62720
M v[96:99],a[236:239],a[216:219],v[96:99]
s_waitcnt lgkmcnt(6)
v_add_f32 v229,v234,v230
v_sub_f32 v234,v234,v230
M v[100:103],a[236:239],a[220:223],v[100:103]
s_waitcnt lgkmcnt(5)
v_fma_f32 v230,2.0,v231,v232
v_fmac_f32 v232,-2.0,v231
M v[104:107],a[236:239],a[192:195],v[104:107]
s_waitcnt lgkmcnt(4)
buffer_load_dwordx4 v[224:227],v247,s[20:23],s48 offen offset:2048 sc1
M v[108:111],a[236:239],a[196:199],v[108:111]
s_waitcnt lgkmcnt(3)
s_add_u32 s46,s80,9216
v_and_b32 v208,s42,v208
v_and_b32 v204,s42,v204
M v[112:115],a[236:239],a[200:203],v[112:115]
s_waitcnt lgkmcnt(2)
v_and_b32 v206,s42,v206
v_and_b32 v214,s42,v214
M v[116:119],a[236:239],a[204:207],v[116:119]
s_waitcnt lgkmcnt(1)
v_and_b32 v212,s42,v212
v_and_b32 v210,s42,v210
M v[120:123],a[236:239],a[208:211],v[120:123]
s_waitcnt lgkmcnt(0)
buffer_load_dwordx4 a[228:231],v247,s[20:23],s46 offen offset:0 sc1
M v[124:127],a[236:239],a[212:215],v[124:127]
s_waitcnt vmcnt(15)
s_add_u32 s47,s80,12288
v_fmac_f32 v204,s43,v208
v_fmac_f32 v214,4.0,v206
M v[128:131],a[240:243],a[216:219],v[128:131]
v_fma_f32 v231,-4.0,v208,v212
v_fmac_f32 v204,s45,v212
M v[132:135],a[240:243],a[220:223],v[132:135]
v_fmac_f32 v214,s41,v210
v_sub_f32 v212,v212,v208
M v[136:139],a[240:243],a[192:195],v[136:139]
buffer_load_dwordx4 a[232:235],v247,s[20:23],s47 offen offset:0 sc1
M v[140:143],a[240:243],a[196:199],v[140:143]
s_add_u32 s48,s80,15360
v_fma_f32 v208,-4.0,v206,v210
v_sub_f32 v210,v210,v206
M v[144:147],a[240:243],a[200:203],v[144:147]
v_add_f32 v206,v231,v208
v_sub_f32 v231,v231,v208
M v[148:151],a[240:243],a[204:207],v[148:151]
v_fma_f32 v208,2.0,v210,v212
v_fmac_f32 v212,-2.0,v210
M v[152:155],a[240:243],a[208:211],v[152:155]
buffer_load_dwordx4 a[236:239],v247,s[20:23],s48 offen offset:0 sc1
M v[156:159],a[240:243],a[212:215],v[156:159]
s_waitcnt vmcnt(15)
v_cvt_pk_bf16_f32 v204,v228,v204
v_cvt_pk_bf16_f32 v214,v233,v214
M v[160:163],a[244:247],a[216:219],v[160:163]
ds_read_b128 a[216:219],v246 offset:62976
v_cvt_pk_bf16_f32 v206,v229,v206
M v[164:167],a[244:247],a[220:223],v[164:167]
v_cvt_pk_bf16_f32 v210,v230,v208
v_cvt_pk_bf16_f32 v208,v234,v231
M v[168:171],a[244:247],a[192:195],v[168:171]
buffer_load_dwordx4 a[240:243],v247,s[20:23],s46 offen offset:1024 sc1
M v[172:175],a[244:247],a[196:199],v[172:175]
v_cvt_pk_bf16_f32 v212,v232,v212
v_lshlrev_b32 v230,16,v209
M v[176:179],a[244:247],a[200:203],v[176:179]
v_lshlrev_b32 v228,16,v205
v_lshlrev_b32 v229,16,v207
M v[180:183],a[244:247],a[204:207],v[180:183]
v_lshlrev_b32 v233,16,v215
v_lshlrev_b32 v232,16,v213
M v[184:187],a[244:247],a[208:211],v[184:187]
v_lshlrev_b32 v231,16,v211
v_fmac_f32 v228,s43,v230
M v[188:191],a[244:247],a[212:215],v[188:191]
s_waitcnt vmcnt(15)
buffer_load_dwordx4 a[244:247],v247,s[20:23],s47 offen offset:1024 sc1
M v[96:99],a[248:251],a[220:223],v[96:99]
v_fmac_f32 v233,4.0,v229
v_fma_f32 v234,-4.0,v230,v232
M v[100:103],a[248:251],a[192:195],v[100:103]
v_fmac_f32 v228,s45,v232
v_fmac_f32 v233,s41,v231
M v[104:107],a[248:251],a[196:199],v[104:107]
v_sub_f32 v232,v232,v230
v_fma_f32 v230,-4.0,v229,v231
M v[108:111],a[248:251],a[200:203],v[108:111]
v_sub_f32 v231,v231,v229
v_add_f32 v229,v234,v230
M v[112:115],a[248:251],a[204:207],v[112:115]
v_sub_f32 v234,v234,v230
v_fma_f32 v230,2.0,v231,v232
M v[116:119],a[248:251],a[208:211],v[116:119]
v_fmac_f32 v232,-2.0,v231
v_and_b32 v209,s42,v209
M v[120:123],a[248:251],a[212:215],v[120:123]
s_waitcnt lgkmcnt(0)
v_and_b32 v205,s42,v205
v_and_b32 v207,s42,v207
M v[124:127],a[248:251],a[216:219],v[124:127]
s_waitcnt vmcnt(15)
buffer_load_dwordx4 a[248:251],v247,s[20:23],s48 offen offset:1024 sc1
M v[128:131],a[252:255],a[220:223],v[128:131]
v_and_b32 v215,s42,v215
v_and_b32 v213,s42,v213
M v[132:135],a[252:255],a[192:195],v[132:135]
v_and_b32 v211,s42,v211
v_fmac_f32 v205,s43,v209
M v[136:139],a[252:255],a[196:199],v[136:139]
v_fmac_f32 v215,4.0,v207
v_fma_f32 v231,-4.0,v209,v213
M v[140:143],a[252:255],a[200:203],v[140:143]
v_fmac_f32 v205,s45,v213
v_fmac_f32 v215,s41,v211
M v[144:147],a[252:255],a[204:207],v[144:147]
v_sub_f32 v213,v213,v209
v_fma_f32 v209,-4.0,v207,v211
M v[148:151],a[252:255],a[208:211],v[148:151]
v_sub_f32 v211,v211,v207
v_add_f32 v207,v231,v209
M v[152:155],a[252:255],a[212:215],v[152:155]
v_sub_f32 v231,v231,v209
v_fma_f32 v209,2.0,v211,v213
M v[156:159],a[252:255],a[216:219],v[156:159]
s_waitcnt vmcnt(15)
buffer_load_dwordx4 a[252:255],v247,s[20:23],s46 offen offset:2048 sc1
M v[160:163],a[224:227],a[220:223],v[160:163]
ds_read_b128 a[220:223],v245 offset:63232
v_fmac_f32 v213,-2.0,v211
M v[164:167],a[224:227],a[192:195],v[164:167]
v_cvt_pk_bf16_f32 v205,v228,v205
v_cvt_pk_bf16_f32 v215,v233,v215
M v[168:171],a[224:227],a[196:199],v[168:171]
v_cvt_pk_bf16_f32 v207,v229,v207
v_cvt_pk_bf16_f32 v211,v230,v209
M v[172:175],a[224:227],a[200:203],v[172:175]
v_cvt_pk_bf16_f32 v209,v234,v231
v_cvt_pk_bf16_f32 v213,v232,v213
M v[176:179],a[224:227],a[204:207],v[176:179]
v_add_u32 v228,139264,v243
M v[180:183],a[224:227],a[208:211],v[180:183]
ds_write2st64_b64 v228,v[204:205],v[214:215] offset0:3 offset1:20
M v[184:187],a[224:227],a[212:215],v[184:187]
s_add_u32 s28,s69,6684672
buffer_load_dwordx2 v[204:205],v241,s[12:15],s28 offen offset:0
M v[188:191],a[224:227],a[216:219],v[188:191]
s_waitcnt vmcnt(16)
ds_write2st64_b64 v243,v[206:207],v[208:209] offset0:37 offset1:54
M v[96:99],v[216:219],a[192:195],v[96:99]
buffer_load_dwordx2 v[214:215],v241,s[16:19],s28 offen offset:1536
M v[100:103],v[216:219],a[196:199],v[100:103]
ds_write2st64_b64 v243,v[210:211],v[212:213] offset0:71 offset1:88
M v[104:107],v[216:219],a[200:203],v[104:107]
s_waitcnt vmcnt(12)
v_lshlrev_b32 v230,16,v196
v_lshlrev_b32 v228,16,v192
M v[108:111],v[216:219],a[204:207],v[108:111]
buffer_load_dwordx2 v[206:207],v241,s[8:11],s28 offen offset:0
M v[112:115],v[216:219],a[208:211],v[112:115]
v_lshlrev_b32 v229,16,v194
v_lshlrev_b32 v233,16,v202
M v[116:119],v[216:219],a[212:215],v[116:119]
s_waitcnt vmcnt(11)
v_lshlrev_b32 v232,16,v200
v_lshlrev_b32 v231,16,v198
M v[120:123],v[216:219],a[216:219],v[120:123]
s_waitcnt lgkmcnt(3)
v_fmac_f32 v228,s43,v230
v_fmac_f32 v233,4.0,v229
M v[124:127],v[216:219],a[220:223],v[124:127]
buffer_load_dwordx2 v[208:209],v241,s[8:11],s28 offen offset:384
M v[128:131],v[220:223],a[192:195],v[128:131]
v_fma_f32 v234,-4.0,v230,v232
v_fmac_f32 v228,s45,v232
M v[132:135],v[220:223],a[196:199],v[132:135]
v_fmac_f32 v233,s41,v231
v_sub_f32 v232,v232,v230
M v[136:139],v[220:223],a[200:203],v[136:139]
v_fma_f32 v230,-4.0,v229,v231
v_sub_f32 v231,v231,v229
M v[140:143],v[220:223],a[204:207],v[140:143]
buffer_load_dwordx2 v[210:211],v241,s[8:11],s28 offen offset:768
M v[144:147],v[220:223],a[208:211],v[144:147]
v_add_f32 v229,v234,v230
v_sub_f32 v234,v234,v230
M v[148:151],v[220:223],a[212:215],v[148:151]
v_fma_f32 v230,2.0,v231,v232
v_fmac_f32 v232,-2.0,v231
M v[152:155],v[220:223],a[216:219],v[152:155]
s_waitcnt lgkmcnt(0)
s_barrier
v_and_b32 v196,s42,v196
M v[156:159],v[220:223],a[220:223],v[156:159]
s_waitcnt vmcnt(12)
buffer_load_dwordx2 v[212:213],v241,s[8:11],s28 offen offset:1152
M v[160:163],v[224:227],a[192:195],v[160:163]
ds_read_b128 a[192:195],v245 offset:0
v_and_b32 v192,s42,v192
M v[164:167],v[224:227],a[196:199],v[164:167]
ds_read_b128 a[196:199],v246 offset:256
v_and_b32 v194,s42,v194
M v[168:171],v[224:227],a[200:203],v[168:171]
ds_read_b128 a[200:203],v246 offset:512
v_and_b32 v202,s42,v202
M v[172:175],v[224:227],a[204:207],v[172:175]
buffer_load_dwordx4 a[224:227],v247,s[20:23],s47 offen offset:2048 sc1
M v[176:179],v[224:227],a[208:211],v[176:179]
ds_read_b128 a[204:207],v246 offset:768
ds_read_b128 a[208:211],v246 offset:1024
M v[180:183],v[224:227],a[212:215],v[180:183]
ds_read_b128 a[212:215],v246 offset:1280
v_and_b32 v200,s42,v200
M v[184:187],v[224:227],a[216:219],v[184:187]
ds_read_b128 a[216:219],v246 offset:1536
v_and_b32 v198,s42,v198
M v[188:191],v[224:227],a[220:223],v[188:191]
s_waitcnt vmcnt(13) lgkmcnt(6)
buffer_load_dwordx4 v[216:219],v247,s[20:23],s48 offen offset:2048 sc1
M a[0:3],a[228:231],a[192:195],a[0:3]
s_waitcnt lgkmcnt(5)
s_add_u32 s46,s80,18432
ds_read_b128 a[220:223],v246 offset:1792
v_fmac_f32 v192,s43,v196
M a[4:7],a[228:231],a[196:199],a[4:7]
s_waitcnt lgkmcnt(5)
v_fmac_f32 v202,4.0,v194
v_fma_f32 v231,-4.0,v196,v200
M a[8:11],a[228:231],a[200:203],a[8:11]
s_waitcnt lgkmcnt(4)
v_fmac_f32 v192,s45,v200
v_fmac_f32 v202,s41,v198
M a[12:15],a[228:231],a[204:207],a[12:15]
s_waitcnt lgkmcnt(3)
buffer_load_dwordx4 v[220:223],v247,s[20:23],s46 offen offset:0 sc1
M a[16:19],a[228:231],a[208:211],a[16:19]
s_waitcnt lgkmcnt(2)
s_add_u32 s47,s80,21504
v_sub_f32 v200,v200,v196
v_fma_f32 v196,-4.0,v194,v198
M a[20:23],a[228:231],a[212:215],a[20:23]
s_waitcnt lgkmcnt(1)
v_sub_f32 v198,v198,v194
v_add_f32 v194,v231,v196
M a[24:27],a[228:231],a[216:219],a[24:27]
s_waitcnt lgkmcnt(0)
v_sub_f32 v231,v231,v196
v_fma_f32 v196,2.0,v198,v200
M a[28:31],a[228:231],a[220:223],a[28:31]
s_waitcnt vmcnt(14)
buffer_load_dwordx4 v[224:227],v247,s[20:23],s47 offen offset:0 sc1
M a[32:35],a[232:235],a[192:195],a[32:35]
s_add_u32 s48,s80,24576
v_fmac_f32 v200,-2.0,v198
v_cvt_pk_bf16_f32 v192,v228,v192
M a[36:39],a[232:235],a[196:199],a[36:39]
v_cvt_pk_bf16_f32 v202,v233,v202
v_cvt_pk_bf16_f32 v194,v229,v194
M a[40:43],a[232:235],a[200:203],a[40:43]
v_cvt_pk_bf16_f32 v198,v230,v196
v_cvt_pk_bf16_f32 v196,v234,v231
M a[44:47],a[232:235],a[204:207],a[44:47]
buffer_load_dwordx4 a[228:231],v247,s[20:23],s48 offen offset:0 sc1
M a[48:51],a[232:235],a[208:211],a[48:51]
v_cvt_pk_bf16_f32 v254,v232,v200
v_lshlrev_b32 v230,16,v197
M a[52:55],a[232:235],a[212:215],a[52:55]
v_lshlrev_b32 v228,16,v193
v_lshlrev_b32 v229,16,v195
M a[56:59],a[232:235],a[216:219],a[56:59]
v_lshlrev_b32 v233,16,v203
v_lshlrev_b32 v232,16,v201
M a[60:63],a[232:235],a[220:223],a[60:63]
s_waitcnt vmcnt(15)
buffer_load_dwordx4 a[232:235],v247,s[20:23],s46 offen offset:1024 sc1
M a[64:67],a[236:239],a[192:195],a[64:67]
ds_read_b128 a[192:195],v246 offset:2048
v_lshlrev_b32 v231,16,v199
M a[68:71],a[236:239],a[196:199],a[68:71]
v_fmac_f32 v228,s43,v230
v_fmac_f32 v233,4.0,v229
M a[72:75],a[236:239],a[200:203],a[72:75]
v_fma_f32 v234,-4.0,v230,v232
v_fmac_f32 v228,s45,v232
M a[76:79],a[236:239],a[204:207],a[76:79]
v_fmac_f32 v233,s41,v231
v_sub_f32 v232,v232,v230
M a[80:83],a[236:239],a[208:211],a[80:83]
v_fma_f32 v230,-4.0,v229,v231
v_sub_f32 v231,v231,v229
M a[84:87],a[236:239],a[212:215],a[84:87]
v_add_f32 v229,v234,v230
v_sub_f32 v234,v234,v230
M a[88:91],a[236:239],a[216:219],a[88:91]
v_fma_f32 v230,2.0,v231,v232
v_fmac_f32 v232,-2.0,v231
M a[92:95],a[236:239],a[220:223],a[92:95]
s_waitcnt vmcnt(15)
buffer_load_dwordx4 a[236:239],v247,s[20:23],s47 offen offset:1024 sc1
M a[0:3],a[240:243],a[196:199],a[0:3]
v_and_b32 v197,s42,v197
v_and_b32 v193,s42,v193
M a[4:7],a[240:243],a[200:203],a[4:7]
v_and_b32 v195,s42,v195
v_and_b32 v203,s42,v203
M a[8:11],a[240:243],a[204:207],a[8:11]
v_and_b32 v201,s42,v201
v_and_b32 v199,s42,v199
M a[12:15],a[240:243],a[208:211],a[12:15]
v_fmac_f32 v193,s43,v197
v_fmac_f32 v203,4.0,v195
M a[16:19],a[240:243],a[212:215],a[16:19]
v_fma_f32 v231,-4.0,v197,v201
v_fmac_f32 v193,s45,v201
M a[20:23],a[240:243],a[216:219],a[20:23]
v_fmac_f32 v203,s41,v199
v_sub_f32 v201,v201,v197
M a[24:27],a[240:243],a[220:223],a[24:27]
s_waitcnt lgkmcnt(0)
v_fma_f32 v197,-4.0,v195,v199
v_sub_f32 v199,v199,v195
M a[28:31],a[240:243],a[192:195],a[28:31]
s_waitcnt vmcnt(15)
buffer_load_dwordx4 a[240:243],v247,s[20:23],s48 offen offset:1024 sc1
M a[32:35],a[244:247],a[196:199],a[32:35]
v_add_f32 v195,v231,v197
v_sub_f32 v231,v231,v197
M a[36:39],a[244:247],a[200:203],a[36:39]
v_fma_f32 v197,2.0,v199,v201
v_fmac_f32 v201,-2.0,v199
M a[40:43],a[244:247],a[204:207],a[40:43]
v_cvt_pk_bf16_f32 v193,v228,v193
v_cvt_pk_bf16_f32 v203,v233,v203
M a[44:47],a[244:247],a[208:211],a[44:47]
v_cvt_pk_bf16_f32 v195,v229,v195
v_cvt_pk_bf16_f32 v199,v230,v197
M a[48:51],a[244:247],a[212:215],a[48:51]
v_cvt_pk_bf16_f32 v197,v234,v231
v_cvt_pk_bf16_f32 v255,v232,v201
M a[52:55],a[244:247],a[216:219],a[52:55]
ds_write2st64_b64 v243,v[192:193],v[202:203] offset0:136 offset1:153
M a[56:59],a[244:247],a[220:223],a[56:59]
s_add_u32 s28,s69,7077888
buffer_load_dwordx2 v[192:193],v241,s[12:15],s28 offen offset:0
M a[60:63],a[244:247],a[192:195],a[60:63]
s_waitcnt vmcnt(16)
ds_write2st64_b64 v243,v[194:195],v[196:197] offset0:0 offset1:17
M a[64:67],a[248:251],a[196:199],a[64:67]
buffer_load_dwordx2 v[202:203],v241,s[16:19],s28 offen offset:1536
M a[68:71],a[248:251],a[200:203],a[68:71]
ds_read_b128 a[196:199],v245 offset:2304
M a[72:75],a[248:251],a[204:207],a[72:75]
M a[76:79],a[248:251],a[208:211],a[76:79]
M a[80:83],a[248:251],a[212:215],a[80:83]
buffer_load_dwordx2 v[194:195],v241,s[8:11],s28 offen offset:0
M a[84:87],a[248:251],a[216:219],a[84:87]
M a[88:91],a[248:251],a[220:223],a[88:91]
M a[92:95],a[248:251],a[192:195],a[92:95]
s_waitcnt vmcnt(17)
M a[0:3],a[252:255],a[200:203],a[0:3]
buffer_load_dwordx2 v[196:197],v241,s[8:11],s28 offen offset:384
M a[4:7],a[252:255],a[204:207],a[4:7]
M a[8:11],a[252:255],a[208:211],a[8:11]
M a[12:15],a[252:255],a[212:215],a[12:15]
M a[16:19],a[252:255],a[216:219],a[16:19]
buffer_load_dwordx4 a[244:247],v247,s[20:23],s46 offen offset:2048 sc1
M a[20:23],a[252:255],a[220:223],a[20:23]
M a[24:27],a[252:255],a[192:195],a[24:27]
s_waitcnt lgkmcnt(0)
M a[28:31],a[252:255],a[196:199],a[28:31]
s_waitcnt vmcnt(12)
M a[32:35],a[224:227],a[200:203],a[32:35]
buffer_load_dwordx4 a[248:251],v247,s[20:23],s47 offen offset:2048 sc1
M a[36:39],a[224:227],a[204:207],a[36:39]
s_barrier
ds_write_b64 v243,v[198:199] offset:17408
M a[40:43],a[224:227],a[208:211],a[40:43]
v_lshlrev_b32 v230,16,v208
v_lshlrev_b32 v228,16,v204
M a[44:47],a[224:227],a[212:215],a[44:47]
buffer_load_dwordx2 v[198:199],v241,s[8:11],s28 offen offset:768
M a[48:51],a[224:227],a[216:219],a[48:51]
v_lshlrev_b32 v229,16,v206
v_lshlrev_b32 v233,16,v214
M a[52:55],a[224:227],a[220:223],a[52:55]
v_lshlrev_b32 v232,16,v212
v_lshlrev_b32 v231,16,v210
M a[56:59],a[224:227],a[192:195],a[56:59]
v_fmac_f32 v228,s43,v230
v_fmac_f32 v233,4.0,v229
M a[60:63],a[224:227],a[196:199],a[60:63]
s_waitcnt vmcnt(13)
buffer_load_dwordx2 v[200:201],v241,s[8:11],s28 offen offset:1152
M a[64:67],v[216:219],a[200:203],a[64:67]
ds_read_b128 a[200:203],v245 offset:8704
v_fma_f32 v234,-4.0,v230,v232
M a[68:71],v[216:219],a[204:207],a[68:71]
ds_read_b128 a[204:207],v246 offset:8960
v_fmac_f32 v228,s45,v232
M a[72:75],v[216:219],a[208:211],a[72:75]
ds_read_b128 a[208:211],v246 offset:9216
v_fmac_f32 v233,s41,v231
M a[76:79],v[216:219],a[212:215],a[76:79]
buffer_load_dwordx4 a[252:255],v247,s[20:23],s48 offen offset:2048 sc1
M a[80:83],v[216:219],a[216:219],a[80:83]
s_add_u32 s46,s80,27648
ds_read_b128 a[212:215],v246 offset:9472
ds_read_b128 a[216:219],v246 offset:9728
M a[84:87],v[216:219],a[220:223],a[84:87]
ds_read_b128 a[220:223],v246 offset:9984
v_sub_f32 v232,v232,v230
M a[88:91],v[216:219],a[192:195],a[88:91]
ds_read_b128 a[192:195],v246 offset:10240
v_fma_f32 v230,-4.0,v229,v231
M a[92:95],v[216:219],a[196:199],a[92:95]
s_waitcnt vmcnt(14) lgkmcnt(6)
buffer_load_dwordx4 a[224:227],v247,s[20:23],s46 offen offset:0 sc1
M a[96:99],v[220:223],a[200:203],a[96:99]
s_waitcnt lgkmcnt(5)
s_add_u32 s47,s80,30720
ds_read_b128 a[196:199],v246 offset:10496
v_sub_f32 v231,v231,v229
M a[100:103],v[220:223],a[204:207],a[100:103]
s_waitcnt lgkmcnt(5)
v_add_f32 v229,v234,v230
v_sub_f32 v234,v234,v230
M a[104:107],v[220:223],a[208:211],a[104:107]
s_waitcnt lgkmcnt(4)
v_fma_f32 v230,2.0,v231,v232
v_fmac_f32 v232,-2.0,v231
M a[108:111],v[220:223],a[212:215],a[108:111]
s_waitcnt lgkmcnt(3)
buffer_load_dwordx4 v[216:219],v247,s[20:23],s47 offen offset:0 sc1
M a[112:115],v[220:223],a[216:219],a[112:115]
s_waitcnt lgkmcnt(2)
s_add_u32 s48,s80,33792
v_and_b32 v208,s42,v208
v_and_b32 v204,s42,v204
M a[116:119],v[220:223],a[220:223],a[116:119]
s_waitcnt lgkmcnt(1)
v_and_b32 v206,s42,v206
v_and_b32 v214,s42,v214
M a[120:123],v[220:223],a[192:195],a[120:123]
s_waitcnt lgkmcnt(0)
v_and_b32 v212,s42,v212
v_and_b32 v210,s42,v210
M a[124:127],v[220:223],a[196:199],a[124:127]
s_waitcnt vmcnt(15)
buffer_load_dwordx4 v[220:223],v247,s[20:23],s48 offen offset:0 sc1
M a[128:131],v[224:227],a[200:203],a[128:131]
v_fmac_f32 v204,s43,v208
v_fmac_f32 v214,4.0,v206
M a[132:135],v[224:227],a[204:207],a[132:135]
v_fma_f32 v231,-4.0,v208,v212
v_fmac_f32 v204,s45,v212
M a[136:139],v[224:227],a[208:211],a[136:139]
v_fmac_f32 v214,s41,v210
v_sub_f32 v212,v212,v208
M a[140:143],v[224:227],a[212:215],a[140:143]
v_fma_f32 v208,-4.0,v206,v210
v_sub_f32 v210,v210,v206
M a[144:147],v[224:227],a[216:219],a[144:147]
v_add_f32 v206,v231,v208
v_sub_f32 v231,v231,v208
M a[148:151],v[224:227],a[220:223],a[148:151]
v_fma_f32 v208,2.0,v210,v212
v_fmac_f32 v212,-2.0,v210
M a[152:155],v[224:227],a[192:195],a[152:155]
v_cvt_pk_bf16_f32 v204,v228,v204
v_cvt_pk_bf16_f32 v214,v233,v214
M a[156:159],v[224:227],a[196:199],a[156:159]
s_waitcnt vmcnt(15)
buffer_load_dwordx4 v[224:227],v247,s[20:23],s46 offen offset:1024 sc1
M a[160:163],a[228:231],a[200:203],a[160:163]
ds_read_b128 a[200:203],v246 offset:10752
v_cvt_pk_bf16_f32 v206,v229,v206
M a[164:167],a[228:231],a[204:207],a[164:167]
v_cvt_pk_bf16_f32 v210,v230,v208
v_cvt_pk_bf16_f32 v208,v234,v231
M a[168:171],a[228:231],a[208:211],a[168:171]
v_cvt_pk_bf16_f32 v212,v232,v212
v_lshlrev_b32 v230,16,v209
M a[172:175],a[228:231],a[212:215],a[172:175]
v_lshlrev_b32 v228,16,v205
v_lshlrev_b32 v229,16,v207
M a[176:179],a[228:231],a[216:219],a[176:179]
v_lshlrev_b32 v233,16,v215
v_lshlrev_b32 v232,16,v213
M a[180:183],a[228:231],a[220:223],a[180:183]
v_lshlrev_b32 v231,16,v211
v_fmac_f32 v228,s43,v230
M a[184:187],a[228:231],a[192:195],a[184:187]
v_fmac_f32 v233,4.0,v229
v_fma_f32 v234,-4.0,v230,v232
M a[188:191],a[228:231],a[196:199],a[188:191]
s_waitcnt vmcnt(15)
buffer_load_dwordx4 a[228:231],v247,s[20:23],s47 offen offset:1024 sc1
M a[96:99],a[232:235],a[204:207],a[96:99]
v_fmac_f32 v228,s45,v232
v_fmac_f32 v233,s41,v231
M a[100:103],a[232:235],a[208:211],a[100:103]
v_sub_f32 v232,v232,v230
v_fma_f32 v230,-4.0,v229,v231
M a[104:107],a[232:235],a[212:215],a[104:107]
v_sub_f32 v231,v231,v229
v_add_f32 v229,v234,v230
M a[108:111],a[232:235],a[216:219],a[108:111]
v_sub_f32 v234,v234,v230
v_fma_f32 v230,2.0,v231,v232
M a[112:115],a[232:235],a[220:223],a[112:115]
v_fmac_f32 v232,-2.0,v231
v_and_b32 v209,s42,v209
M a[116:119],a[232:235],a[192:195],a[116:119]
v_and_b32 v205,s42,v205
v_and_b32 v207,s42,v207
M a[120:123],a[232:235],a[196:199],a[120:123]
s_waitcnt lgkmcnt(0)
v_and_b32 v215,s42,v215
v_and_b32 v213,s42,v213
M a[124:127],a[232:235],a[200:203],a[124:127]
s_waitcnt vmcnt(15)
buffer_load_dwordx4 a[232:235],v247,s[20:23],s48 offen offset:1024 sc1
M a[128:131],a[236:239],a[204:207],a[128:131]
v_and_b32 v211,s42,v211
v_fmac_f32 v205,s43,v209
M a[132:135],a[236:239],a[208:211],a[132:135]
v_fmac_f32 v215,4.0,v207
v_fma_f32 v231,-4.0,v209,v213
M a[136:139],a[236:239],a[212:215],a[136:139]
v_fmac_f32 v205,s45,v213
v_fmac_f32 v215,s41,v211
M a[140:143],a[236:239],a[216:219],a[140:143]
v_sub_f32 v213,v213,v209
v_fma_f32 v209,-4.0,v207,v211
M a[144:147],a[236:239],a[220:223],a[144:147]
v_sub_f32 v211,v211,v207
v_add_f32 v207,v231,v209
M a[148:151],a[236:239],a[192:195],a[148:151]
v_sub_f32 v231,v231,v209
v_fma_f32 v209,2.0,v211,v213
M a[152:155],a[236:239],a[196:199],a[152:155]
v_fmac_f32 v213,-2.0,v211
v_cvt_pk_bf16_f32 v205,v228,v205
M a[156:159],a[236:239],a[200:203],a[156:159]
s_waitcnt vmcnt(15)
buffer_load_dwordx4 a[236:239],v247,s[20:23],s46 offen offset:2048 sc1
M a[160:163],a[240:243],a[204:207],a[160:163]
ds_read_b128 a[204:207],v245 offset:11008
v_cvt_pk_bf16_f32 v215,v233,v215
M a[164:167],a[240:243],a[208:211],a[164:167]
v_cvt_pk_bf16_f32 v207,v229,v207
v_cvt_pk_bf16_f32 v211,v230,v209
M a[168:171],a[240:243],a[212:215],a[168:171]
v_cvt_pk_bf16_f32 v209,v234,v231
v_cvt_pk_bf16_f32 v213,v232,v213
M a[172:175],a[240:243],a[216:219],a[172:175]
ds_write2st64_b64 v243,v[204:205],v[214:215] offset0:137 offset1:154
M a[176:179],a[240:243],a[220:223],a[176:179]
s_add_u32 s28,s69,7471104
buffer_load_dwordx2 v[204:205],v241,s[12:15],s28 offen offset:0
M a[180:183],a[240:243],a[192:195],a[180:183]
ds_write2st64_b64 v243,v[206:207],v[208:209] offset0:1 offset1:18
M a[184:187],a[240:243],a[196:199],a[184:187]
buffer_load_dwordx2 v[214:215],v241,s[16:19],s28 offen offset:1536
M a[188:191],a[240:243],a[200:203],a[188:191]
s_waitcnt vmcnt(13)
M a[96:99],a[244:247],a[208:211],a[96:99]
M a[100:103],a[244:247],a[212:215],a[100:103]
M a[104:107],a[244:247],a[216:219],a[104:107]
buffer_load_dwordx2 v[206:207],v241,s[8:11],s28 offen offset:0
M a[108:111],a[244:247],a[220:223],a[108:111]
M a[112:115],a[244:247],a[192:195],a[112:115]
M a[116:119],a[244:247],a[196:199],a[116:119]
M a[120:123],a[244:247],a[200:203],a[120:123]
s_waitcnt lgkmcnt(2)
buffer_load_dwordx2 v[208:209],v241,s[8:11],s28 offen offset:384
M a[124:127],a[244:247],a[204:207],a[124:127]
s_waitcnt vmcnt(14)
M a[128:131],a[248:251],a[208:211],a[128:131]
M a[132:135],a[248:251],a[212:215],a[132:135]
s_waitcnt lgkmcnt(0)
s_barrier
ds_write_b64 v243,v[254:255] offset:26112
M a[136:139],a[248:251],a[216:219],a[136:139]
buffer_load_dwordx4 a[240:243],v247,s[20:23],s47 offen offset:2048 sc1
M a[140:143],a[248:251],a[220:223],a[140:143]
ds_write2st64_b64 v243,v[210:211],v[212:213] offset0:35 offset1:52
M a[144:147],a[248:251],a[192:195],a[144:147]
buffer_load_dwordx2 v[210:211],v241,s[8:11],s28 offen offset:768
M a[148:151],a[248:251],a[196:199],a[148:151]
v_fmac_f32 v235,s43,v237
v_fmac_f32 v240,4.0,v236
M a[152:155],a[248:251],a[200:203],a[152:155]
v_fma_f32 v228,-4.0,v237,v239
v_fmac_f32 v235,s45,v239
M a[156:159],a[248:251],a[204:207],a[156:159]
s_waitcnt vmcnt(13)
v_fmac_f32 v240,s41,v238
v_sub_f32 v239,v239,v237
M a[160:163],a[252:255],a[208:211],a[160:163]
buffer_load_dwordx2 v[212:213],v241,s[8:11],s28 offen offset:1152
M a[164:167],a[252:255],a[212:215],a[164:167]
ds_read_b128 a[208:211],v245 offset:17408
ds_read_b128 a[212:215],v246 offset:17664
M a[168:171],a[252:255],a[216:219],a[168:171]
ds_read_b128 a[216:219],v246 offset:17920
v_fma_f32 v237,-4.0,v236,v238
M a[172:175],a[252:255],a[220:223],a[172:175]
ds_read_b128 a[220:223],v246 offset:18176
v_sub_f32 v238,v238,v236
M a[176:179],a[252:255],a[192:195],a[176:179]
buffer_load_dwordx4 a[244:247],v247,s[20:23],s48 offen offset:2048 sc1
M a[180:183],a[252:255],a[196:199],a[180:183]
s_add_u32 s46,s80,36864
ds_read_b128 a[192:195],v246 offset:18432
ds_read_b128 a[196:199],v246 offset:18688
M a[184:187],a[252:255],a[200:203],a[184:187]
ds_read_b128 a[200:203],v246 offset:18944
v_add_f32 v236,v228,v237
M a[188:191],a[252:255],a[204:207],a[188:191]
s_waitcnt vmcnt(14) lgkmcnt(6)
ds_read_b128 a[204:207],v246 offset:19200
v_sub_f32 v228,v228,v237
M v[0:3],a[224:227],a[208:211],v[0:3]
s_waitcnt lgkmcnt(6)
buffer_load_dwordx4 a[248:251],v247,s[20:23],s46 offen offset:0 sc1
M v[4:7],a[224:227],a[212:215],v[4:7]
s_waitcnt lgkmcnt(5)
s_add_u32 s47,s80,39936
v_fma_f32 v237,2.0,v238,v239
v_fmac_f32 v239,-2.0,v238
M v[8:11],a[224:227],a[216:219],v[8:11]
s_waitcnt lgkmcnt(4)
v_cvt_pk_bf16_f32 v229,v235,v240
v_cvt_pk_bf16_f32 v230,v236,v228
M v[12:15],a[224:227],a[220:223],v[12:15]
s_waitcnt lgkmcnt(3)
v_cvt_pk_bf16_f32 v231,v237,v239
v_add_u32 v228,69632,v244
M v[16:19],a[224:227],a[192:195],v[16:19]
s_waitcnt lgkmcnt(2)
buffer_load_dwordx4 a[252:255],v247,s[20:23],s47 offen offset:0 sc1
M v[20:23],a[224:227],a[196:199],v[20:23]
s_waitcnt lgkmcnt(1)
s_add_u32 s48,s80,43008
ds_write_b16 v228,v229 offset:0
M v[24:27],a[224:227],a[200:203],v[24:27]
s_waitcnt lgkmcnt(1)
ds_write_b16_d16_hi v228,v229 offset:8704
M v[28:31],a[224:227],a[204:207],v[28:31]
s_waitcnt vmcnt(15)
ds_write_b16 v244,v230 offset:0
M v[32:35],v[216:219],a[208:211],v[32:35]
global_load_dword v251,v252,s[82:83]
M v[36:39],v[216:219],a[212:215],v[36:39]
ds_write_b16_d16_hi v244,v230 offset:8704
M v[40:43],v[216:219],a[216:219],v[40:43]
buffer_load_dwordx4 a[224:227],v247,s[20:23],s48 offen offset:0 sc1
M v[44:47],v[216:219],a[220:223],v[44:47]
ds_write_b16 v244,v231 offset:17408
M v[48:51],v[216:219],a[192:195],v[48:51]
ds_write_b16_d16_hi v244,v231 offset:26112
M v[52:55],v[216:219],a[196:199],v[52:55]
v_lshlrev_b32 v230,16,v196
v_lshlrev_b32 v228,16,v192
M v[56:59],v[216:219],a[200:203],v[56:59]
v_lshlrev_b32 v229,16,v194
v_lshlrev_b32 v233,16,v202
M v[60:63],v[216:219],a[204:207],v[60:63]
s_waitcnt vmcnt(16)
buffer_load_dwordx4 v[216:219],v247,s[20:23],s46 offen offset:1024 sc1
M v[64:67],v[220:223],a[208:211],v[64:67]
ds_read_b128 a[208:211],v246 offset:19456
v_lshlrev_b32 v232,16,v200
M v[68:71],v[220:223],a[212:215],v[68:71]
v_lshlrev_b32 v231,16,v198
v_fmac_f32 v228,s43,v230
M v[72:75],v[220:223],a[216:219],v[72:75]
v_fmac_f32 v233,4.0,v229
v_fma_f32 v234,-4.0,v230,v232
M v[76:79],v[220:223],a[220:223],v[76:79]
v_fmac_f32 v228,s45,v232
v_fmac_f32 v233,s41,v231
M v[80:83],v[220:223],a[192:195],v[80:83]
v_sub_f32 v232,v232,v230
v_fma_f32 v230,-4.0,v229,v231
M v[84:87],v[220:223],a[196:199],v[84:87]
v_sub_f32 v231,v231,v229
v_add_f32 v229,v234,v230
M v[88:91],v[220:223],a[200:203],v[88:91]
v_sub_f32 v234,v234,v230
v_fma_f32 v230,2.0,v231,v232
M v[92:95],v[220:223],a[204:207],v[92:95]
s_waitcnt vmcnt(16)
buffer_load_dwordx4 v[220:223],v247,s[20:23],s47 offen offset:1024 sc1
M v[0:3],v[224:227],a[212:215],v[0:3]
v_fmac_f32 v232,-2.0,v231
v_and_b32 v196,s42,v196
M v[4:7],v[224:227],a[216:219],v[4:7]
v_and_b32 v192,s42,v192
v_and_b32 v194,s42,v194
M v[8:11],v[224:227],a[220:223],v[8:11]
v_and_b32 v202,s42,v202
v_and_b32 v200,s42,v200
M v[12:15],v[224:227],a[192:195],v[12:15]
v_and_b32 v198,s42,v198
v_fmac_f32 v192,s43,v196
M v[16:19],v[224:227],a[196:199],v[16:19]
v_fmac_f32 v202,4.0,v194
v_fma_f32 v231,-4.0,v196,v200
M v[20:23],v[224:227],a[200:203],v[20:23]
v_fmac_f32 v192,s45,v200
v_fmac_f32 v202,s41,v198
M v[24:27],v[224:227],a[204:207],v[24:27]
s_waitcnt lgkmcnt(0)
v_sub_f32 v200,v200,v196
v_fma_f32 v196,-4.0,v194,v198
M v[28:31],v[224:227],a[208:211],v[28:31]
s_waitcnt vmcnt(16)
buffer_load_dwordx4 v[224:227],v247,s[20:23],s48 offen offset:1024 sc1
M v[32:35],a[228:231],a[212:215],v[32:35]
v_sub_f32 v198,v198,v194
v_add_f32 v194,v231,v196
M v[36:39],a[228:231],a[216:219],v[36:39]
v_sub_f32 v231,v231,v196
v_fma_f32 v196,2.0,v198,v200
M v[40:43],a[228:231],a[220:223],v[40:43]
v_fmac_f32 v200,-2.0,v198
v_cvt_pk_bf16_f32 v192,v228,v192
M v[44:47],a[228:231],a[192:195],v[44:47]
v_cvt_pk_bf16_f32 v202,v233,v202
v_cvt_pk_bf16_f32 v194,v229,v194
M v[48:51],a[228:231],a[196:199],v[48:51]
v_cvt_pk_bf16_f32 v198,v230,v196
v_cvt_pk_bf16_f32 v196,v234,v231
M v[52:55],a[228:231],a[200:203],v[52:55]
v_cvt_pk_bf16_f32 v200,v232,v200
v_lshlrev_b32 v230,16,v197
M v[56:59],a[228:231],a[204:207],v[56:59]
v_lshlrev_b32 v228,16,v193
v_lshlrev_b32 v229,16,v195
M v[60:63],a[228:231],a[208:211],v[60:63]
s_waitcnt vmcnt(16)
buffer_load_dwordx4 a[228:231],v247,s[20:23],s46 offen offset:2048 sc1
M v[64:67],a[232:235],a[212:215],v[64:67]
ds_read_b128 a[212:215],v245 offset:19712
v_lshlrev_b32 v233,16,v203
M v[68:71],a[232:235],a[216:219],v[68:71]
v_lshlrev_b32 v232,16,v201
v_lshlrev_b32 v231,16,v199
M v[72:75],a[232:235],a[220:223],v[72:75]
v_fmac_f32 v228,s43,v230
v_fmac_f32 v233,4.0,v229
M v[76:79],a[232:235],a[192:195],v[76:79]
v_fma_f32 v234,-4.0,v230,v232
v_fmac_f32 v228,s45,v232
M v[80:83],a[232:235],a[196:199],v[80:83]
v_fmac_f32 v233,s41,v231
v_sub_f32 v232,v232,v230
M v[84:87],a[232:235],a[200:203],v[84:87]
v_fma_f32 v230,-4.0,v229,v231
v_sub_f32 v231,v231,v229
M v[88:91],a[232:235],a[204:207],v[88:91]
v_add_f32 v229,v234,v230
v_sub_f32 v234,v234,v230
M v[92:95],a[232:235],a[208:211],v[92:95]
s_waitcnt vmcnt(16)
buffer_load_dwordx4 a[232:235],v247,s[20:23],s47 offen offset:2048 sc1
M v[0:3],a[236:239],a[216:219],v[0:3]
v_fma_f32 v230,2.0,v231,v232
v_fmac_f32 v232,-2.0,v231
M v[4:7],a[236:239],a[220:223],v[4:7]
v_and_b32 v197,s42,v197
v_and_b32 v193,s42,v193
M v[8:11],a[236:239],a[192:195],v[8:11]
v_and_b32 v195,s42,v195
v_and_b32 v203,s42,v203
M v[12:15],a[236:239],a[196:199],v[12:15]
v_and_b32 v201,s42,v201
v_and_b32 v199,s42,v199
M v[16:19],a[236:239],a[200:203],v[16:19]
v_fmac_f32 v193,s43,v197
v_fmac_f32 v203,4.0,v195
M v[20:23],a[236:239],a[204:207],v[20:23]
v_fma_f32 v231,-4.0,v197,v201
v_fmac_f32 v193,s45,v201
M v[24:27],a[236:239],a[208:211],v[24:27]
s_waitcnt lgkmcnt(0)
v_fmac_f32 v203,s41,v199
v_sub_f32 v201,v201,v197
M v[28:31],a[236:239],a[212:215],v[28:31]
s_waitcnt vmcnt(12)
buffer_load_dwordx4 a[236:239],v247,s[20:23],s48 offen offset:2048 sc1
M v[32:35],a[240:243],a[216:219],v[32:35]
v_fma_f32 v197,-4.0,v195,v199
v_sub_f32 v199,v199,v195
M v[36:39],a[240:243],a[220:223],v[36:39]
s_add_u32 s46,s81,9216
v_add_f32 v195,v231,v197
v_sub_f32 v231,v231,v197
M v[40:43],a[240:243],a[192:195],v[40:43]
v_fma_f32 v197,2.0,v199,v201
v_fmac_f32 v201,-2.0,v199
M v[44:47],a[240:243],a[196:199],v[44:47]
v_cvt_pk_bf16_f32 v193,v228,v193
v_cvt_pk_bf16_f32 v203,v233,v203
M v[48:51],a[240:243],a[200:203],v[48:51]
v_cvt_pk_bf16_f32 v195,v229,v195
v_cvt_pk_bf16_f32 v199,v230,v197
M v[52:55],a[240:243],a[204:207],v[52:55]
v_cvt_pk_bf16_f32 v197,v234,v231
v_cvt_pk_bf16_f32 v201,v232,v201
M v[56:59],a[240:243],a[208:211],v[56:59]
ds_write2st64_b64 v243,v[192:193],v[202:203] offset0:138 offset1:155
M v[60:63],a[240:243],a[212:215],v[60:63]
s_waitcnt vmcnt(10)
buffer_load_dwordx4 a[240:243],v247,s[20:23],s46 offen offset:0 sc1
M v[64:67],a[244:247],a[216:219],v[64:67]
ds_read_b128 a[216:219],v245 offset:26112
ds_write2st64_b64 v243,v[194:195],v[196:197] offset0:2 offset1:19
M v[68:71],a[244:247],a[220:223],v[68:71]
ds_read_b128 a[220:223],v246 offset:26368
ds_write2st64_b64 v243,v[198:199],v[200:201] offset0:36 offset1:53
M v[72:75],a[244:247],a[192:195],v[72:75]
ds_read_b128 a[192:195],v246 offset:26624
v_lshlrev_b32 v230,16,v208
M v[76:79],a[244:247],a[196:199],v[76:79]
ds_read_b128 a[196:199],v246 offset:26880
v_lshlrev_b32 v228,16,v204
M v[80:83],a[244:247],a[200:203],v[80:83]
ds_read_b128 a[200:203],v246 offset:27136
v_lshlrev_b32 v229,16,v206
M v[84:87],a[244:247],a[204:207],v[84:87]
ds_read_b128 a[204:207],v246 offset:27392
v_lshlrev_b32 v233,16,v214
M v[88:91],a[244:247],a[208:211],v[88:91]
ds_read_b128 a[208:211],v246 offset:27648
v_lshlrev_b32 v232,16,v212
M v[92:95],a[244:247],a[212:215],v[92:95]
s_waitcnt vmcnt(10) lgkmcnt(8)
buffer_load_dwordx4 a[244:247],v247,s[20:23],s46 offen offset:1024 sc1
M v[96:99],a[248:251],a[216:219],v[96:99]
s_waitcnt lgkmcnt(6)
ds_read_b128 a[212:215],v246 offset:27904
v_lshlrev_b32 v231,16,v210
M v[100:103],a[248:251],a[220:223],v[100:103]
s_waitcnt lgkmcnt(5)
v_fmac_f32 v228,s43,v230
v_fmac_f32 v233,4.0,v229
M v[104:107],a[248:251],a[192:195],v[104:107]
s_waitcnt lgkmcnt(4)
v_fma_f32 v234,-4.0,v230,v232
v_fmac_f32 v228,s45,v232
M v[108:111],a[248:251],a[196:199],v[108:111]
s_waitcnt lgkmcnt(3)
v_fmac_f32 v233,s41,v231
v_sub_f32 v232,v232,v230
M v[112:115],a[248:251],a[200:203],v[112:115]
s_waitcnt lgkmcnt(2)
v_fma_f32 v230,-4.0,v229,v231
v_sub_f32 v231,v231,v229
M v[116:119],a[248:251],a[204:207],v[116:119]
s_waitcnt lgkmcnt(1)
v_add_f32 v229,v234,v230
v_sub_f32 v234,v234,v230
M v[120:123],a[248:251],a[208:211],v[120:123]
s_waitcnt lgkmcnt(0)
v_fma_f32 v230,2.0,v231,v232
v_fmac_f32 v232,-2.0,v231
M v[124:127],a[248:251],a[212:215],v[124:127]
s_waitcnt vmcnt(10)
buffer_load_dwordx4 a[248:251],v247,s[20:23],s46 offen offset:2048 sc1
M v[128:131],a[252:255],a[216:219],v[128:131]
v_and_b32 v208,s42,v208
v_and_b32 v204,s42,v204
M v[132:135],a[252:255],a[220:223],v[132:135]
s_add_u32 s46,s81,18432
v_and_b32 v206,s42,v206
v_and_b32 v214,s42,v214
M v[136:139],a[252:255],a[192:195],v[136:139]
v_and_b32 v212,s42,v212
v_and_b32 v210,s42,v210
M v[140:143],a[252:255],a[196:199],v[140:143]
v_fmac_f32 v204,s43,v208
v_fmac_f32 v214,4.0,v206
M v[144:147],a[252:255],a[200:203],v[144:147]
v_fma_f32 v231,-4.0,v208,v212
v_fmac_f32 v204,s45,v212
M v[148:151],a[252:255],a[204:207],v[148:151]
v_fmac_f32 v214,s41,v210
v_sub_f32 v212,v212,v208
M v[152:155],a[252:255],a[208:211],v[152:155]
v_fma_f32 v208,-4.0,v206,v210
v_sub_f32 v210,v210,v206
M v[156:159],a[252:255],a[212:215],v[156:159]
s_waitcnt vmcnt(9)
buffer_load_dwordx4 a[252:255],v247,s[20:23],s46 offen offset:0 sc1
M v[160:163],a[224:227],a[216:219],v[160:163]
ds_read_b128 a[216:219],v246 offset:28160
v_add_f32 v206,v231,v208
M v[164:167],a[224:227],a[220:223],v[164:167]
v_sub_f32 v231,v231,v208
v_fma_f32 v208,2.0,v210,v212
M v[168:171],a[224:227],a[192:195],v[168:171]
v_fmac_f32 v212,-2.0,v210
v_cvt_pk_bf16_f32 v204,v228,v204
M v[172:175],a[224:227],a[196:199],v[172:175]
v_cvt_pk_bf16_f32 v214,v233,v214
v_cvt_pk_bf16_f32 v206,v229,v206
M v[176:179],a[224:227],a[200:203],v[176:179]
v_cvt_pk_bf16_f32 v210,v230,v208
v_cvt_pk_bf16_f32 v208,v234,v231
M v[180:183],a[224:227],a[204:207],v[180:183]
v_cvt_pk_bf16_f32 v212,v232,v212
v_lshlrev_b32 v230,16,v209
M v[184:187],a[224:227],a[208:211],v[184:187]
v_lshlrev_b32 v228,16,v205
v_lshlrev_b32 v229,16,v207
M v[188:191],a[224:227],a[212:215],v[188:191]
s_waitcnt vmcnt(9)
buffer_load_dwordx4 a[224:227],v247,s[20:23],s46 offen offset:1024 sc1
M v[96:99],v[216:219],a[220:223],v[96:99]
v_lshlrev_b32 v233,16,v215
v_lshlrev_b32 v232,16,v213
M v[100:103],v[216:219],a[192:195],v[100:103]
v_lshlrev_b32 v231,16,v211
v_fmac_f32 v228,s43,v230
M v[104:107],v[216:219],a[196:199],v[104:107]
v_fmac_f32 v233,4.0,v229
v_fma_f32 v234,-4.0,v230,v232
M v[108:111],v[216:219],a[200:203],v[108:111]
v_fmac_f32 v228,s45,v232
v_fmac_f32 v233,s41,v231
M v[112:115],v[216:219],a[204:207],v[112:115]
v_sub_f32 v232,v232,v230
v_fma_f32 v230,-4.0,v229,v231
M v[116:119],v[216:219],a[208:211],v[116:119]
v_sub_f32 v231,v231,v229
v_add_f32 v229,v234,v230
M v[120:123],v[216:219],a[212:215],v[120:123]
s_waitcnt lgkmcnt(0)
v_sub_f32 v234,v234,v230
v_fma_f32 v230,2.0,v231,v232
M v[124:127],v[216:219],a[216:219],v[124:127]
s_waitcnt vmcnt(9)
buffer_load_dwordx4 v[216:219],v247,s[20:23],s46 offen offset:2048 sc1
M v[128:131],v[220:223],a[220:223],v[128:131]
v_fmac_f32 v232,-2.0,v231
v_and_b32 v209,s42,v209
M v[132:135],v[220:223],a[192:195],v[132:135]
s_add_u32 s46,s81,27648
v_and_b32 v205,s42,v205
v_and_b32 v207,s42,v207
M v[136:139],v[220:223],a[196:199],v[136:139]
v_and_b32 v215,s42,v215
v_and_b32 v213,s42,v213
M v[140:143],v[220:223],a[200:203],v[140:143]
v_and_b32 v211,s42,v211
v_fmac_f32 v205,s43,v209
M v[144:147],v[220:223],a[204:207],v[144:147]
v_fmac_f32 v215,4.0,v207
v_fma_f32 v231,-4.0,v209,v213
M v[148:151],v[220:223],a[208:211],v[148:151]
v_fmac_f32 v205,s45,v213
v_fmac_f32 v215,s41,v211
M v[152:155],v[220:223],a[212:215],v[152:155]
v_sub_f32 v213,v213,v209
v_fma_f32 v209,-4.0,v207,v211
M v[156:159],v[220:223],a[216:219],v[156:159]
s_waitcnt vmcnt(9)
buffer_load_dwordx4 v[220:223],v247,s[20:23],s46 offen offset:0 sc1
M v[160:163],v[224:227],a[220:223],v[160:163]
ds_read_b128 a[220:223],v245 offset:28416
v_sub_f32 v211,v211,v207
M v[164:167],v[224:227],a[192:195],v[164:167]
v_add_f32 v207,v231,v209
v_sub_f32 v231,v231,v209
M v[168:171],v[224:227],a[196:199],v[168:171]
v_fma_f32 v209,2.0,v211,v213
v_fmac_f32 v213,-2.0,v211
M v[172:175],v[224:227],a[200:203],v[172:175]
v_cvt_pk_bf16_f32 v205,v228,v205
v_cvt_pk_bf16_f32 v215,v233,v215
M v[176:179],v[224:227],a[204:207],v[176:179]
v_cvt_pk_bf16_f32 v207,v229,v207
v_cvt_pk_bf16_f32 v211,v230,v209
M v[180:183],v[224:227],a[208:211],v[180:183]
v_cvt_pk_bf16_f32 v209,v234,v231
v_cvt_pk_bf16_f32 v213,v232,v213
M v[184:187],v[224:227],a[212:215],v[184:187]
ds_write2st64_b64 v243,v[204:205],v[214:215] offset0:139 offset1:156
M v[188:191],v[224:227],a[216:219],v[188:191]
s_waitcnt vmcnt(9)
buffer_load_dwordx4 v[224:227],v247,s[20:23],s46 offen offset:1024 sc1
M v[96:99],a[228:231],a[192:195],v[96:99]
ds_write2st64_b64 v243,v[206:207],v[208:209] offset0:3 offset1:20
M v[100:103],a[228:231],a[196:199],v[100:103]
ds_write2st64_b64 v243,v[210:211],v[212:213] offset0:37 offset1:54
M v[104:107],a[228:231],a[200:203],v[104:107]
M v[108:111],a[228:231],a[204:207],v[108:111]
M v[112:115],a[228:231],a[208:211],v[112:115]
M v[116:119],a[228:231],a[212:215],v[116:119]
M v[120:123],a[228:231],a[216:219],v[120:123]
s_waitcnt lgkmcnt(3)
M v[124:127],a[228:231],a[220:223],v[124:127]
s_waitcnt vmcnt(9)
buffer_load_dwordx4 a[228:231],v247,s[20:23],s46 offen offset:2048 sc1
M v[128:131],a[232:235],a[192:195],v[128:131]
M v[132:135],a[232:235],a[196:199],v[132:135]
s_add_u32 s46,s81,36864
M v[136:139],a[232:235],a[200:203],v[136:139]
M v[140:143],a[232:235],a[204:207],v[140:143]
M v[144:147],a[232:235],a[208:211],v[144:147]
M v[148:151],a[232:235],a[212:215],v[148:151]
v_add_u32 v245,0xffffbc00,v245
v_add_u32 v246,0xffffbc00,v246
M v[152:155],a[232:235],a[216:219],v[152:155]
s_waitcnt lgkmcnt(0)
s_barrier
M v[156:159],a[232:235],a[220:223],v[156:159]
s_waitcnt vmcnt(9)
buffer_load_dwordx4 a[232:235],v247,s[20:23],s46 offen offset:0 sc1
M v[160:163],a[236:239],a[192:195],v[160:163]
ds_read_b128 a[192:195],v245 offset:0
M v[164:167],a[236:239],a[196:199],v[164:167]
ds_read_b128 a[196:199],v246 offset:256
M v[168:171],a[236:239],a[200:203],v[168:171]
ds_read_b128 a[200:203],v246 offset:512
M v[172:175],a[236:239],a[204:207],v[172:175]
ds_read_b128 a[204:207],v246 offset:768
M v[176:179],a[236:239],a[208:211],v[176:179]
ds_read_b128 a[208:211],v246 offset:1024
M v[180:183],a[236:239],a[212:215],v[180:183]
ds_read_b128 a[212:215],v246 offset:1280
M v[184:187],a[236:239],a[216:219],v[184:187]
ds_read_b128 a[216:219],v246 offset:1536
M v[188:191],a[236:239],a[220:223],v[188:191]
s_waitcnt vmcnt(9) lgkmcnt(6)
buffer_load_dwordx4 a[236:239],v247,s[20:23],s46 offen offset:1024 sc1
M a[0:3],a[240:243],a[192:195],a[0:3]
s_waitcnt lgkmcnt(5)
ds_read_b128 a[220:223],v246 offset:1792
ds_read_b128 a[192:195],v246 offset:2048
M a[4:7],a[240:243],a[196:199],a[4:7]
s_waitcnt lgkmcnt(6)
M a[8:11],a[240:243],a[200:203],a[8:11]
s_waitcnt lgkmcnt(5)
M a[12:15],a[240:243],a[204:207],a[12:15]
s_waitcnt lgkmcnt(4)
M a[16:19],a[240:243],a[208:211],a[16:19]
s_waitcnt lgkmcnt(3)
M a[20:23],a[240:243],a[212:215],a[20:23]
s_waitcnt lgkmcnt(2)
M a[24:27],a[240:243],a[216:219],a[24:27]
s_waitcnt lgkmcnt(1)
M a[28:31],a[240:243],a[220:223],a[28:31]
s_waitcnt vmcnt(9)
buffer_load_dwordx4 a[240:243],v247,s[20:23],s46 offen offset:2048 sc1
M a[0:3],a[244:247],a[196:199],a[0:3]
ds_read_b128 a[196:199],v245 offset:2304
M a[4:7],a[244:247],a[200:203],a[4:7]
s_add_u32 s47,s81,12288
M a[8:11],a[244:247],a[204:207],a[8:11]
M a[12:15],a[244:247],a[208:211],a[12:15]
M a[16:19],a[244:247],a[212:215],a[16:19]
M a[20:23],a[244:247],a[216:219],a[20:23]
M a[24:27],a[244:247],a[220:223],a[24:27]
s_waitcnt lgkmcnt(1)
M a[28:31],a[244:247],a[192:195],a[28:31]
s_waitcnt vmcnt(9)
buffer_load_dwordx4 a[244:247],v247,s[20:23],s47 offen offset:0 sc1
M a[0:3],a[248:251],a[200:203],a[0:3]
ds_read_b128 a[200:203],v245 offset:8704
M a[4:7],a[248:251],a[204:207],a[4:7]
s_add_u32 s48,s81,15360
ds_read_b128 a[204:207],v246 offset:8960
M a[8:11],a[248:251],a[208:211],a[8:11]
ds_read_b128 a[208:211],v246 offset:9216
M a[12:15],a[248:251],a[212:215],a[12:15]
ds_read_b128 a[212:215],v246 offset:9472
M a[16:19],a[248:251],a[216:219],a[16:19]
ds_read_b128 a[216:219],v246 offset:9728
M a[20:23],a[248:251],a[220:223],a[20:23]
ds_read_b128 a[220:223],v246 offset:9984
M a[24:27],a[248:251],a[192:195],a[24:27]
s_waitcnt lgkmcnt(6)
ds_read_b128 a[192:195],v246 offset:10240
M a[28:31],a[248:251],a[196:199],a[28:31]
s_waitcnt vmcnt(9) lgkmcnt(6)
buffer_load_dwordx4 a[248:251],v247,s[20:23],s48 offen offset:0 sc1
M a[96:99],a[252:255],a[200:203],a[96:99]
s_waitcnt lgkmcnt(5)
ds_read_b128 a[196:199],v246 offset:10496
ds_read_b128 a[200:203],v246 offset:10752
M a[100:103],a[252:255],a[204:207],a[100:103]
s_waitcnt lgkmcnt(6)
M a[104:107],a[252:255],a[208:211],a[104:107]
s_waitcnt lgkmcnt(5)
M a[108:111],a[252:255],a[212:215],a[108:111]
s_waitcnt lgkmcnt(4)
M a[112:115],a[252:255],a[216:219],a[112:115]
s_waitcnt lgkmcnt(3)
M a[116:119],a[252:255],a[220:223],a[116:119]
s_waitcnt lgkmcnt(2)
M a[120:123],a[252:255],a[192:195],a[120:123]
s_waitcnt lgkmcnt(1)
M a[124:127],a[252:255],a[196:199],a[124:127]
s_waitcnt vmcnt(9)
buffer_load_dwordx4 a[252:255],v247,s[20:23],s47 offen offset:1024 sc1
M a[96:99],a[224:227],a[204:207],a[96:99]
ds_read_b128 a[204:207],v245 offset:11008
M a[100:103],a[224:227],a[208:211],a[100:103]
M a[104:107],a[224:227],a[212:215],a[104:107]
M a[108:111],a[224:227],a[216:219],a[108:111]
M a[112:115],a[224:227],a[220:223],a[112:115]
M a[116:119],a[224:227],a[192:195],a[116:119]
M a[120:123],a[224:227],a[196:199],a[120:123]
s_waitcnt lgkmcnt(1)
M a[124:127],a[224:227],a[200:203],a[124:127]
s_waitcnt vmcnt(9)
buffer_load_dwordx4 a[224:227],v247,s[20:23],s48 offen offset:1024 sc1
M a[96:99],v[216:219],a[208:211],a[96:99]
ds_read_b128 a[208:211],v245 offset:17408
M a[100:103],v[216:219],a[212:215],a[100:103]
ds_read_b128 a[212:215],v246 offset:17664
M a[104:107],v[216:219],a[216:219],a[104:107]
ds_read_b128 a[216:219],v246 offset:17920
M a[108:111],v[216:219],a[220:223],a[108:111]
ds_read_b128 a[220:223],v246 offset:18176
M a[112:115],v[216:219],a[192:195],a[112:115]
ds_read_b128 a[192:195],v246 offset:18432
M a[116:119],v[216:219],a[196:199],a[116:119]
ds_read_b128 a[196:199],v246 offset:18688
M a[120:123],v[216:219],a[200:203],a[120:123]
s_waitcnt lgkmcnt(6)
ds_read_b128 a[200:203],v246 offset:18944
M a[124:127],v[216:219],a[204:207],a[124:127]
s_waitcnt vmcnt(9) lgkmcnt(6)
buffer_load_dwordx4 v[216:219],v247,s[20:23],s47 offen offset:2048 sc1
M v[0:3],v[220:223],a[208:211],v[0:3]
s_waitcnt lgkmcnt(5)
ds_read_b128 a[204:207],v246 offset:19200
ds_read_b128 a[208:211],v246 offset:19456
M v[4:7],v[220:223],a[212:215],v[4:7]
s_waitcnt lgkmcnt(6)
M v[8:11],v[220:223],a[216:219],v[8:11]
s_waitcnt lgkmcnt(5)
M v[12:15],v[220:223],a[220:223],v[12:15]
s_waitcnt lgkmcnt(4)
M v[16:19],v[220:223],a[192:195],v[16:19]
s_waitcnt lgkmcnt(3)
M v[20:23],v[220:223],a[196:199],v[20:23]
s_waitcnt lgkmcnt(2)
M v[24:27],v[220:223],a[200:203],v[24:27]
s_waitcnt lgkmcnt(1)
M v[28:31],v[220:223],a[204:207],v[28:31]
s_waitcnt vmcnt(9)
buffer_load_dwordx4 v[220:223],v247,s[20:23],s48 offen offset:2048 sc1
M v[0:3],v[224:227],a[212:215],v[0:3]
ds_read_b128 a[212:215],v245 offset:19712
M v[4:7],v[224:227],a[216:219],v[4:7]
s_add_u32 s47,s81,21504
M v[8:11],v[224:227],a[220:223],v[8:11]
M v[12:15],v[224:227],a[192:195],v[12:15]
M v[16:19],v[224:227],a[196:199],v[16:19]
M v[20:23],v[224:227],a[200:203],v[20:23]
M v[24:27],v[224:227],a[204:207],v[24:27]
s_waitcnt lgkmcnt(1)
M v[28:31],v[224:227],a[208:211],v[28:31]
s_waitcnt vmcnt(9)
buffer_load_dwordx4 v[224:227],v247,s[20:23],s47 offen offset:0 sc1
M v[0:3],a[228:231],a[216:219],v[0:3]
ds_read_b128 a[216:219],v245 offset:26112
M v[4:7],a[228:231],a[220:223],v[4:7]
s_add_u32 s48,s81,24576
ds_read_b128 a[220:223],v246 offset:26368
M v[8:11],a[228:231],a[192:195],v[8:11]
ds_read_b128 a[192:195],v246 offset:26624
M v[12:15],a[228:231],a[196:199],v[12:15]
ds_read_b128 a[196:199],v246 offset:26880
M v[16:19],a[228:231],a[200:203],v[16:19]
ds_read_b128 a[200:203],v246 offset:27136
M v[20:23],a[228:231],a[204:207],v[20:23]
ds_read_b128 a[204:207],v246 offset:27392
M v[24:27],a[228:231],a[208:211],v[24:27]
s_waitcnt lgkmcnt(6)
ds_read_b128 a[208:211],v246 offset:27648
M v[28:31],a[228:231],a[212:215],v[28:31]
s_waitcnt vmcnt(9) lgkmcnt(6)
buffer_load_dwordx4 a[228:231],v247,s[20:23],s48 offen offset:0 sc1
M v[96:99],a[232:235],a[216:219],v[96:99]
s_waitcnt lgkmcnt(5)
ds_read_b128 a[212:215],v246 offset:27904
ds_read_b128 a[216:219],v246 offset:28160
M v[100:103],a[232:235],a[220:223],v[100:103]
s_waitcnt lgkmcnt(6)
M v[104:107],a[232:235],a[192:195],v[104:107]
s_waitcnt lgkmcnt(5)
M v[108:111],a[232:235],a[196:199],v[108:111]
s_waitcnt lgkmcnt(4)
M v[112:115],a[232:235],a[200:203],v[112:115]
s_waitcnt lgkmcnt(3)
M v[116:119],a[232:235],a[204:207],v[116:119]
s_waitcnt lgkmcnt(2)
M v[120:123],a[232:235],a[208:211],v[120:123]
s_waitcnt lgkmcnt(1)
M v[124:127],a[232:235],a[212:215],v[124:127]
s_waitcnt vmcnt(9)
buffer_load_dwordx4 a[232:235],v247,s[20:23],s47 offen offset:1024 sc1
M v[96:99],a[236:239],a[220:223],v[96:99]
ds_read_b128 a[220:223],v245 offset:28416
M v[100:103],a[236:239],a[192:195],v[100:103]
M v[104:107],a[236:239],a[196:199],v[104:107]
M v[108:111],a[236:239],a[200:203],v[108:111]
M v[112:115],a[236:239],a[204:207],v[112:115]
M v[116:119],a[236:239],a[208:211],v[116:119]
M v[120:123],a[236:239],a[212:215],v[120:123]
s_waitcnt lgkmcnt(1)
M v[124:127],a[236:239],a[216:219],v[124:127]
s_waitcnt vmcnt(9)
buffer_load_dwordx4 a[236:239],v247,s[20:23],s48 offen offset:1024 sc1
M v[96:99],a[240:243],a[192:195],v[96:99]
ds_read_b128 a[192:195],v245 offset:0
M v[100:103],a[240:243],a[196:199],v[100:103]
ds_read_b128 a[196:199],v246 offset:256
M v[104:107],a[240:243],a[200:203],v[104:107]
ds_read_b128 a[200:203],v246 offset:512
M v[108:111],a[240:243],a[204:207],v[108:111]
ds_read_b128 a[204:207],v246 offset:768
v_accvgpr_read_b32 v234,a0
M v[112:115],a[240:243],a[208:211],v[112:115]
ds_read_b128 a[208:211],v246 offset:1024
v_accvgpr_read_b32 v228,a96
M v[116:119],a[240:243],a[212:215],v[116:119]
ds_read_b128 a[212:215],v246 offset:1280
v_add_f32 v230,v234,v228
M v[120:123],a[240:243],a[216:219],v[120:123]
s_waitcnt lgkmcnt(6)
ds_read_b128 a[216:219],v246 offset:1536
v_sub_f32 v234,v234,v228
M v[124:127],a[240:243],a[220:223],v[124:127]
s_waitcnt vmcnt(9) lgkmcnt(6)
buffer_load_dwordx4 a[240:243],v247,s[20:23],s47 offen offset:2048 sc1
M a[32:35],a[244:247],a[192:195],a[32:35]
s_waitcnt lgkmcnt(5)
ds_read_b128 a[220:223],v246 offset:1792
v_add_f32 v228,v0,v96
M a[36:39],a[244:247],a[196:199],a[36:39]
s_waitcnt lgkmcnt(5)
v_sub_f32 v96,v0,v96
v_add_f32 v0,v230,v228
M a[40:43],a[244:247],a[200:203],a[40:43]
s_waitcnt lgkmcnt(4)
v_fmac_f32 v230,4.0,v228
v_fma_f32 v228,2.0,v96,v234
M a[44:47],a[244:247],a[204:207],a[44:47]
s_waitcnt lgkmcnt(3)
v_fma_f32 v96,s40,v96,v234
v_accvgpr_read_b32 v234,a1
M a[48:51],a[244:247],a[208:211],a[48:51]
s_waitcnt lgkmcnt(2)
v_accvgpr_read_b32 v233,a97
v_add_f32 v232,v234,v233
M a[52:55],a[244:247],a[212:215],a[52:55]
s_waitcnt lgkmcnt(1)
v_sub_f32 v234,v234,v233
v_add_f32 v233,v1,v97
M a[56:59],a[244:247],a[216:219],a[56:59]
s_waitcnt lgkmcnt(0)
v_sub_f32 v97,v1,v97
v_add_f32 v1,v232,v233
M a[60:63],a[244:247],a[220:223],a[60:63]
s_waitcnt vmcnt(9)
buffer_load_dwordx4 a[244:247],v247,s[20:23],s48 offen offset:2048 sc1
M a[64:67],a[248:251],a[192:195],a[64:67]
ds_read_b128 a[192:195],v246 offset:2048
v_fmac_f32 v232,4.0,v233
M a[68:71],a[248:251],a[196:199],a[68:71]
s_add_u32 s47,s81,30720
v_fma_f32 v233,2.0,v97,v234
v_fma_f32 v97,s40,v97,v234
M a[72:75],a[248:251],a[200:203],a[72:75]
v_cvt_pk_bf16_f32 v228,v228,v233
v_cvt_pk_bf16_f32 v230,v230,v232
M a[76:79],a[248:251],a[204:207],a[76:79]
v_accvgpr_read_b32 v234,a2
v_accvgpr_read_b32 v229,a98
M a[80:83],a[248:251],a[208:211],a[80:83]
v_add_f32 v231,v234,v229
v_sub_f32 v234,v234,v229
M a[84:87],a[248:251],a[212:215],a[84:87]
v_add_f32 v229,v2,v98
v_sub_f32 v98,v2,v98
M a[88:91],a[248:251],a[216:219],a[88:91]
v_add_f32 v2,v231,v229
v_fmac_f32 v231,4.0,v229
M a[92:95],a[248:251],a[220:223],a[92:95]
s_waitcnt vmcnt(9)
buffer_load_dwordx4 a[248:251],v247,s[20:23],s47 offen offset:0 sc1
M a[32:35],a[252:255],a[196:199],a[32:35]
s_add_u32 s48,s81,33792
v_fma_f32 v229,2.0,v98,v234
v_fma_f32 v98,s40,v98,v234
M a[36:39],a[252:255],a[200:203],a[36:39]
v_accvgpr_read_b32 v234,a3
v_accvgpr_read_b32 v233,a99
M a[40:43],a[252:255],a[204:207],a[40:43]
buffer_load_dwordx4 a[96:99],v247,s[20:23],s48 offen offset:0 sc1
M a[44:47],a[252:255],a[208:211],a[44:47]
v_add_f32 v232,v234,v233
v_sub_f32 v234,v234,v233
M a[48:51],a[252:255],a[212:215],a[48:51]
v_add_f32 v233,v3,v99
v_sub_f32 v99,v3,v99
M a[52:55],a[252:255],a[216:219],a[52:55]
v_add_f32 v3,v232,v233
v_fmac_f32 v232,4.0,v233
M a[56:59],a[252:255],a[220:223],a[56:59]
s_waitcnt lgkmcnt(0)
v_fma_f32 v233,2.0,v99,v234
v_fma_f32 v99,s40,v99,v234
M a[60:63],a[252:255],a[192:195],a[60:63]
s_waitcnt vmcnt(10)
buffer_load_dwordx4 a[252:255],v247,s[20:23],s47 offen offset:1024 sc1
M a[64:67],a[224:227],a[196:199],a[64:67]
ds_read_b128 a[196:199],v245 offset:2304
v_cvt_pk_bf16_f32 v229,v229,v233
M a[68:71],a[224:227],a[200:203],a[68:71]
v_cvt_pk_bf16_f32 v231,v231,v232
M a[72:75],a[224:227],a[204:207],a[72:75]
ds_write2st64_b64 v249,v[228:229],v[230:231] offset0:68 offset1:72
M a[76:79],a[224:227],a[208:211],a[76:79]
v_accvgpr_read_b32 v234,a4
v_accvgpr_read_b32 v228,a100
M a[80:83],a[224:227],a[212:215],a[80:83]
v_add_f32 v230,v234,v228
v_sub_f32 v234,v234,v228
M a[84:87],a[224:227],a[216:219],a[84:87]
v_add_f32 v228,v4,v100
v_sub_f32 v100,v4,v100
M a[88:91],a[224:227],a[220:223],a[88:91]
v_add_f32 v4,v230,v228
v_fmac_f32 v230,4.0,v228
M a[92:95],a[224:227],a[192:195],a[92:95]
s_waitcnt vmcnt(10)
buffer_load_dwordx4 a[224:227],v247,s[20:23],s48 offen offset:1024 sc1
M a[32:35],v[216:219],a[200:203],a[32:35]
v_fma_f32 v228,2.0,v100,v234
v_fma_f32 v100,s40,v100,v234
M a[36:39],v[216:219],a[204:207],a[36:39]
v_accvgpr_read_b32 v234,a5
v_accvgpr_read_b32 v233,a101
M a[40:43],v[216:219],a[208:211],a[40:43]
v_add_f32 v232,v234,v233
v_sub_f32 v234,v234,v233
M a[44:47],v[216:219],a[212:215],a[44:47]
v_add_f32 v233,v5,v101
v_sub_f32 v101,v5,v101
M a[48:51],v[216:219],a[216:219],a[48:51]
v_add_f32 v5,v232,v233
v_fmac_f32 v232,4.0,v233
M a[52:55],v[216:219],a[220:223],a[52:55]
v_fma_f32 v233,2.0,v101,v234
v_fma_f32 v101,s40,v101,v234
M a[56:59],v[216:219],a[192:195],a[56:59]
s_waitcnt lgkmcnt(1)
v_cvt_pk_bf16_f32 v228,v228,v233
v_cvt_pk_bf16_f32 v230,v230,v232
M a[60:63],v[216:219],a[196:199],a[60:63]
s_waitcnt vmcnt(10)
buffer_load_dwordx4 v[216:219],v247,s[20:23],s47 offen offset:2048 sc1
M a[64:67],v[220:223],a[200:203],a[64:67]
ds_read_b128 a[200:203],v245 offset:8704
v_accvgpr_read_b32 v234,a6
M a[68:71],v[220:223],a[204:207],a[68:71]
ds_read_b128 a[204:207],v246 offset:8960
v_accvgpr_read_b32 v229,a102
M a[72:75],v[220:223],a[208:211],a[72:75]
ds_read_b128 a[208:211],v246 offset:9216
v_add_f32 v231,v234,v229
M a[76:79],v[220:223],a[212:215],a[76:79]
ds_read_b128 a[212:215],v246 offset:9472
v_sub_f32 v234,v234,v229
M a[80:83],v[220:223],a[216:219],a[80:83]
ds_read_b128 a[216:219],v246 offset:9728
v_add_f32 v229,v6,v102
M a[84:87],v[220:223],a[220:223],a[84:87]
ds_read_b128 a[220:223],v246 offset:9984
v_sub_f32 v102,v6,v102
M a[88:91],v[220:223],a[192:195],a[88:91]
ds_read_b128 a[192:195],v246 offset:10240
v_add_f32 v6,v231,v229
M a[92:95],v[220:223],a[196:199],a[92:95]
s_waitcnt vmcnt(10) lgkmcnt(6)
buffer_load_dwordx4 v[220:223],v247,s[20:23],s48 offen offset:2048 sc1
M a[128:131],v[224:227],a[200:203],a[128:131]
s_waitcnt lgkmcnt(5)
s_add_u32 s47,s81,39936
ds_read_b128 a[196:199],v246 offset:10496
v_fmac_f32 v231,4.0,v229
M a[132:135],v[224:227],a[204:207],a[132:135]
s_waitcnt lgkmcnt(5)
v_fma_f32 v229,2.0,v102,v234
v_fma_f32 v102,s40,v102,v234
M a[136:139],v[224:227],a[208:211],a[136:139]
s_waitcnt lgkmcnt(4)
v_accvgpr_read_b32 v234,a7
v_accvgpr_read_b32 v233,a103
M a[140:143],v[224:227],a[212:215],a[140:143]
s_waitcnt lgkmcnt(3)
buffer_load_dwordx4 a[100:103],v247,s[20:23],s47 offen offset:0 sc1
M a[144:147],v[224:227],a[216:219],a[144:147]
s_waitcnt lgkmcnt(2)
s_add_u32 s48,s81,43008
v_add_f32 v232,v234,v233
v_sub_f32 v234,v234,v233
M a[148:151],v[224:227],a[220:223],a[148:151]
s_waitcnt lgkmcnt(1)
global_load_dword v251,v252,s[82:83]
M a[152:155],v[224:227],a[192:195],a[152:155]
s_waitcnt lgkmcnt(0)
v_add_f32 v233,v7,v103
v_sub_f32 v103,v7,v103
M a[156:159],v[224:227],a[196:199],a[156:159]
s_waitcnt vmcnt(12)
buffer_load_dwordx4 v[224:227],v247,s[20:23],s48 offen offset:0 sc1
M a[160:163],a[228:231],a[200:203],a[160:163]
ds_read_b128 a[200:203],v246 offset:10752
v_add_f32 v7,v232,v233
M a[164:167],a[228:231],a[204:207],a[164:167]
v_fmac_f32 v232,4.0,v233
v_fma_f32 v233,2.0,v103,v234
M a[168:171],a[228:231],a[208:211],a[168:171]
v_fma_f32 v103,s40,v103,v234
v_cvt_pk_bf16_f32 v229,v229,v233
M a[172:175],a[228:231],a[212:215],a[172:175]
v_cvt_pk_bf16_f32 v231,v231,v232
M a[176:179],a[228:231],a[216:219],a[176:179]
ds_write2st64_b64 v249,v[228:229],v[230:231] offset0:76 offset1:80
M a[180:183],a[228:231],a[220:223],a[180:183]
v_accvgpr_read_b32 v234,a8
v_accvgpr_read_b32 v228,a104
M a[184:187],a[228:231],a[192:195],a[184:187]
v_add_f32 v230,v234,v228
v_sub_f32 v234,v234,v228
M a[188:191],a[228:231],a[196:199],a[188:191]
s_waitcnt vmcnt(12)
buffer_load_dwordx4 a[228:231],v247,s[20:23],s47 offen offset:1024 sc1
M a[128:131],a[232:235],a[204:207],a[128:131]
v_add_f32 v228,v8,v104
v_sub_f32 v104,v8,v104
M a[132:135],a[232:235],a[208:211],a[132:135]
s_waitcnt lgkmcnt(0)
s_barrier
ds_read_b128 a[0:3],v247 offset:34816
M a[136:139],a[232:235],a[212:215],a[136:139]
ds_read_b128 a[4:7],v247 offset:38912
v_add_f32 v8,v230,v228
M a[140:143],a[232:235],a[216:219],a[140:143]
v_fmac_f32 v230,4.0,v228
v_fma_f32 v228,2.0,v104,v234
M a[144:147],a[232:235],a[220:223],a[144:147]
v_fma_f32 v104,s40,v104,v234
v_accvgpr_read_b32 v234,a9
M a[148:151],a[232:235],a[192:195],a[148:151]
v_accvgpr_read_b32 v233,a105
v_add_f32 v232,v234,v233
M a[152:155],a[232:235],a[196:199],a[152:155]
s_waitcnt lgkmcnt(1)
s_add_u32 s34,s32,6291456
buffer_store_dwordx4 a[0:3],v248,s[24:27],s34 offen offset:384 nt
M a[156:159],a[232:235],a[200:203],a[156:159]
s_waitcnt vmcnt(13)
buffer_load_dwordx4 a[232:235],v247,s[20:23],s48 offen offset:1024 sc1
M a[160:163],a[236:239],a[204:207],a[160:163]
ds_read_b128 a[204:207],v245 offset:11008
v_sub_f32 v234,v234,v233
M a[164:167],a[236:239],a[208:211],a[164:167]
v_add_f32 v233,v9,v105
v_sub_f32 v105,v9,v105
M a[168:171],a[236:239],a[212:215],a[168:171]
v_add_f32 v9,v232,v233
v_fmac_f32 v232,4.0,v233
M a[172:175],a[236:239],a[216:219],a[172:175]
v_fma_f32 v233,2.0,v105,v234
v_fma_f32 v105,s40,v105,v234
M a[176:179],a[236:239],a[220:223],a[176:179]
s_waitcnt lgkmcnt(1)
s_add_u32 s34,s32,6488064
buffer_store_dwordx4 a[4:7],v248,s[24:27],s34 offen offset:384 nt
M a[180:183],a[236:239],a[192:195],a[180:183]
v_cvt_pk_bf16_f32 v228,v228,v233
v_cvt_pk_bf16_f32 v230,v230,v232
M a[184:187],a[236:239],a[196:199],a[184:187]
v_accvgpr_read_b32 v234,a10
v_accvgpr_read_b32 v229,a106
M a[188:191],a[236:239],a[200:203],a[188:191]
s_waitcnt vmcnt(14)
buffer_load_dwordx4 a[236:239],v247,s[20:23],s47 offen offset:2048 sc1
M a[128:131],a[240:243],a[208:211],a[128:131]
v_add_f32 v231,v234,v229
v_sub_f32 v234,v234,v229
M a[132:135],a[240:243],a[212:215],a[132:135]
v_add_f32 v229,v10,v106
v_sub_f32 v106,v10,v106
M a[136:139],a[240:243],a[216:219],a[136:139]
v_add_f32 v10,v231,v229
v_fmac_f32 v231,4.0,v229
M a[140:143],a[240:243],a[220:223],a[140:143]
v_fma_f32 v229,2.0,v106,v234
v_fma_f32 v106,s40,v106,v234
M a[144:147],a[240:243],a[192:195],a[144:147]
v_accvgpr_read_b32 v234,a11
v_accvgpr_read_b32 v233,a107
M a[148:151],a[240:243],a[196:199],a[148:151]
buffer_load_dwordx4 a[104:107],v247,s[20:23],s48 offen offset:2048 sc1
M a[152:155],a[240:243],a[200:203],a[152:155]
s_waitcnt lgkmcnt(0)
s_add_u32 s46,s76,0
v_add_f32 v232,v234,v233
v_sub_f32 v234,v234,v233
M a[156:159],a[240:243],a[204:207],a[156:159]
s_waitcnt vmcnt(15)
buffer_load_dwordx4 a[240:243],v247,s[20:23],s46 offen offset:0 sc1
M a[160:163],a[244:247],a[208:211],a[160:163]
ds_read_b128 a[208:211],v245 offset:17408
v_add_f32 v233,v11,v107
M a[164:167],a[244:247],a[212:215],a[164:167]
ds_read_b128 a[212:215],v246 offset:17664
v_sub_f32 v107,v11,v107
M a[168:171],a[244:247],a[216:219],a[168:171]
ds_read_b128 a[216:219],v246 offset:17920
v_add_f32 v11,v232,v233
M a[172:175],a[244:247],a[220:223],a[172:175]
ds_read_b128 a[220:223],v246 offset:18176
v_fmac_f32 v232,4.0,v233
M a[176:179],a[244:247],a[192:195],a[176:179]
ds_read_b128 a[192:195],v246 offset:18432
v_fma_f32 v233,2.0,v107,v234
M a[180:183],a[244:247],a[196:199],a[180:183]
ds_read_b128 a[196:199],v246 offset:18688
v_fma_f32 v107,s40,v107,v234
M a[184:187],a[244:247],a[200:203],a[184:187]
ds_read_b128 a[200:203],v246 offset:18944
v_cvt_pk_bf16_f32 v229,v229,v233
M a[188:191],a[244:247],a[204:207],a[188:191]
s_waitcnt vmcnt(15) lgkmcnt(6)
buffer_load_dwordx4 a[244:247],v247,s[20:23],s46 offen offset:1024 sc1
M v[32:35],a[248:251],a[208:211],v[32:35]
s_waitcnt lgkmcnt(5)
ds_read_b128 a[204:207],v246 offset:19200
v_cvt_pk_bf16_f32 v231,v231,v232
M v[36:39],a[248:251],a[212:215],v[36:39]
s_waitcnt lgkmcnt(5)
ds_write2st64_b64 v249,v[228:229],v[230:231] offset0:85 offset1:89
M v[40:43],a[248:251],a[216:219],v[40:43]
s_waitcnt lgkmcnt(5)
v_accvgpr_read_b32 v204,a12
v_accvgpr_read_b32 v208,a108
M v[44:47],a[248:251],a[220:223],v[44:47]
s_waitcnt lgkmcnt(4)
v_accvgpr_read_b32 v205,a13
v_accvgpr_read_b32 v209,a109
M v[48:51],a[248:251],a[192:195],v[48:51]
s_waitcnt lgkmcnt(3)
v_accvgpr_read_b32 v206,a14
v_accvgpr_read_b32 v210,a110
v_accvgpr_read_b32 v207,a15
v_accvgpr_read_b32 v211,a111
v_pk_add_f32 v[212:213],v[204:205],v[208:209]
v_pk_add_f32 v[214:215],v[206:207],v[210:211]
v_pk_add_f32 v[204:205],v[204:205],v[208:209] neg_lo:[0,1] neg_hi:[0,1]
v_pk_add_f32 v[206:207],v[206:207],v[210:211] neg_lo:[0,1] neg_hi:[0,1]
v_pk_add_f32 v[208:209],v[12:13],v[108:109]
v_pk_add_f32 v[210:211],v[14:15],v[110:111]
v_pk_add_f32 v[108:109],v[12:13],v[108:109] neg_lo:[0,1] neg_hi:[0,1]
v_pk_add_f32 v[110:111],v[14:15],v[110:111] neg_lo:[0,1] neg_hi:[0,1]
v_pk_add_f32 v[12:13],v[212:213],v[208:209]
v_pk_add_f32 v[14:15],v[214:215],v[210:211]
v_pk_fma_f32 v[212:213],v[208:209],4.0,v[212:213] op_sel_hi:[1,0,1]
v_pk_fma_f32 v[214:215],v[210:211],4.0,v[214:215] op_sel_hi:[1,0,1]
v_pk_fma_f32 v[208:209],v[108:109],2.0,v[204:205] op_sel_hi:[1,0,1]
v_pk_fma_f32 v[210:211],v[110:111],2.0,v[206:207] op_sel_hi:[1,0,1]
v_pk_fma_f32 v[108:109],v[108:109],s[40:41],v[204:205] op_sel_hi:[1,0,1]
v_pk_fma_f32 v[110:111],v[110:111],s[40:41],v[206:207] op_sel_hi:[1,0,1]
M v[52:55],a[248:251],a[196:199],v[52:55]
s_waitcnt lgkmcnt(2)
buffer_load_dwordx4 a[108:111],v247,s[20:23],s46 offen offset:2048 sc1
M v[56:59],a[248:251],a[200:203],v[56:59]
s_waitcnt lgkmcnt(1)
s_add_u32 s46,s77,0
v_cvt_pk_bf16_f32 v208,v208,v209
v_cvt_pk_bf16_f32 v209,v210,v211
M v[60:63],a[248:251],a[204:207],v[60:63]
s_waitcnt vmcnt(16)
buffer_load_dwordx4 a[248:251],v247,s[20:23],s46 offen offset:0 sc1
M v[64:67],a[96:99],a[208:211],v[64:67]
ds_read_b128 a[208:211],v246 offset:19456
v_cvt_pk_bf16_f32 v212,v212,v213
M v[68:71],a[96:99],a[212:215],v[68:71]
v_cvt_pk_bf16_f32 v213,v214,v215
M v[72:75],a[96:99],a[216:219],v[72:75]
ds_write2st64_b64 v249,v[208:209],v[212:213] offset0:93 offset1:97
M v[76:79],a[96:99],a[220:223],v[76:79]
v_accvgpr_read_b32 v234,a16
v_accvgpr_read_b32 v228,a112
M v[80:83],a[96:99],a[192:195],v[80:83]
v_add_f32 v230,v234,v228
v_sub_f32 v234,v234,v228
M v[84:87],a[96:99],a[196:199],v[84:87]
v_add_f32 v228,v16,v112
v_sub_f32 v112,v16,v112
M v[88:91],a[96:99],a[200:203],v[88:91]
s_waitcnt lgkmcnt(0)
s_barrier
ds_read_b128 a[8:11],v247 offset:43520
M v[92:95],a[96:99],a[204:207],v[92:95]
s_waitcnt vmcnt(16)
ds_read_b128 a[12:15],v247 offset:47616
v_add_f32 v16,v230,v228
M v[32:35],a[252:255],a[212:215],v[32:35]
buffer_load_dwordx4 a[96:99],v247,s[20:23],s46 offen offset:1024 sc1
M v[36:39],a[252:255],a[216:219],v[36:39]
v_fmac_f32 v230,4.0,v228
v_fma_f32 v228,2.0,v112,v234
M v[40:43],a[252:255],a[220:223],v[40:43]
v_fma_f32 v112,s40,v112,v234
v_accvgpr_read_b32 v234,a17
M v[44:47],a[252:255],a[192:195],v[44:47]
s_waitcnt lgkmcnt(1)
s_add_u32 s34,s32,6684672
buffer_store_dwordx4 a[8:11],v248,s[24:27],s34 offen offset:384 nt
M v[48:51],a[252:255],a[196:199],v[48:51]
v_accvgpr_read_b32 v233,a113
v_add_f32 v232,v234,v233
M v[52:55],a[252:255],a[200:203],v[52:55]
v_sub_f32 v234,v234,v233
v_add_f32 v233,v17,v113
M v[56:59],a[252:255],a[204:207],v[56:59]
v_sub_f32 v113,v17,v113
v_add_f32 v17,v232,v233
M v[60:63],a[252:255],a[208:211],v[60:63]
s_waitcnt vmcnt(17)
buffer_load_dwordx4 a[252:255],v247,s[20:23],s46 offen offset:2048 sc1
M v[64:67],a[224:227],a[212:215],v[64:67]
s_add_u32 s34,s32,6881280
ds_read_b128 a[212:215],v245 offset:19712
v_fmac_f32 v232,4.0,v233
M v[68:71],a[224:227],a[216:219],v[68:71]
s_waitcnt lgkmcnt(1)
s_add_u32 s46,s78,0
buffer_store_dwordx4 a[12:15],v248,s[24:27],s34 offen offset:384 nt
M v[72:75],a[224:227],a[220:223],v[72:75]
v_fma_f32 v233,2.0,v113,v234
v_fma_f32 v113,s40,v113,v234
M v[76:79],a[224:227],a[192:195],v[76:79]
v_cvt_pk_bf16_f32 v228,v228,v233
v_cvt_pk_bf16_f32 v230,v230,v232
M v[80:83],a[224:227],a[196:199],v[80:83]
v_accvgpr_read_b32 v234,a18
v_accvgpr_read_b32 v229,a114
M v[84:87],a[224:227],a[200:203],v[84:87]
v_add_f32 v231,v234,v229
v_sub_f32 v234,v234,v229
M v[88:91],a[224:227],a[204:207],v[88:91]
v_add_f32 v229,v18,v114
v_sub_f32 v114,v18,v114
M v[92:95],a[224:227],a[208:211],v[92:95]
s_waitcnt vmcnt(18)
buffer_load_dwordx4 a[224:227],v247,s[20:23],s46 offen offset:0 sc1
M v[32:35],v[216:219],a[216:219],v[32:35]
v_add_f32 v18,v231,v229
v_fmac_f32 v231,4.0,v229
M v[36:39],v[216:219],a[220:223],v[36:39]
v_fma_f32 v229,2.0,v114,v234
v_fma_f32 v114,s40,v114,v234
M v[40:43],v[216:219],a[192:195],v[40:43]
v_accvgpr_read_b32 v234,a19
v_accvgpr_read_b32 v233,a115
M v[44:47],v[216:219],a[196:199],v[44:47]
buffer_load_dwordx4 a[112:115],v247,s[20:23],s46 offen offset:1024 sc1
M v[48:51],v[216:219],a[200:203],v[48:51]
v_add_f32 v232,v234,v233
v_sub_f32 v234,v234,v233
M v[52:55],v[216:219],a[204:207],v[52:55]
v_add_f32 v233,v19,v115
v_sub_f32 v115,v19,v115
M v[56:59],v[216:219],a[208:211],v[56:59]
s_waitcnt lgkmcnt(0)
v_add_f32 v19,v232,v233
v_fmac_f32 v232,4.0,v233
M v[60:63],v[216:219],a[212:215],v[60:63]
s_waitcnt vmcnt(19)
buffer_load_dwordx4 v[216:219],v247,s[20:23],s46 offen offset:2048 sc1
M v[64:67],v[220:223],a[216:219],v[64:67]
ds_read_b128 a[216:219],v245 offset:26112
v_fma_f32 v233,2.0,v115,v234
M v[68:71],v[220:223],a[220:223],v[68:71]
s_add_u32 s46,s79,0
ds_read_b128 a[220:223],v246 offset:26368
v_fma_f32 v115,s40,v115,v234
M v[72:75],v[220:223],a[192:195],v[72:75]
ds_read_b128 a[192:195],v246 offset:26624
v_cvt_pk_bf16_f32 v229,v229,v233
M v[76:79],v[220:223],a[196:199],v[76:79]
ds_read_b128 a[196:199],v246 offset:26880
v_cvt_pk_bf16_f32 v231,v231,v232
M v[80:83],v[220:223],a[200:203],v[80:83]
ds_read_b128 a[200:203],v246 offset:27136
ds_write2st64_b64 v249,v[228:229],v[230:231] offset0:68 offset1:72
M v[84:87],v[220:223],a[204:207],v[84:87]
ds_read_b128 a[204:207],v246 offset:27392
v_accvgpr_read_b32 v234,a20
M v[88:91],v[220:223],a[208:211],v[88:91]
ds_read_b128 a[208:211],v246 offset:27648
v_accvgpr_read_b32 v228,a116
M v[92:95],v[220:223],a[212:215],v[92:95]
s_waitcnt vmcnt(19) lgkmcnt(7)
buffer_load_dwordx4 v[220:223],v247,s[20:23],s46 offen offset:0 sc1
M v[128:131],a[100:103],a[216:219],v[128:131]
s_waitcnt lgkmcnt(6)
ds_read_b128 a[212:215],v246 offset:27904
v_add_f32 v230,v234,v228
M v[132:135],a[100:103],a[220:223],v[132:135]
s_waitcnt lgkmcnt(6)
v_sub_f32 v234,v234,v228
v_add_f32 v228,v20,v116
M v[136:139],a[100:103],a[192:195],v[136:139]
s_waitcnt lgkmcnt(5)
v_sub_f32 v116,v20,v116
v_add_f32 v20,v230,v228
M v[140:143],a[100:103],a[196:199],v[140:143]
s_waitcnt lgkmcnt(4)
v_fmac_f32 v230,4.0,v228
v_fma_f32 v228,2.0,v116,v234
M v[144:147],a[100:103],a[200:203],v[144:147]
s_waitcnt lgkmcnt(2)
v_fma_f32 v116,s40,v116,v234
v_accvgpr_read_b32 v234,a21
M v[148:151],a[100:103],a[204:207],v[148:151]
s_waitcnt lgkmcnt(1)
v_accvgpr_read_b32 v233,a117
v_add_f32 v232,v234,v233
M v[152:155],a[100:103],a[208:211],v[152:155]
s_waitcnt lgkmcnt(0)
v_sub_f32 v234,v234,v233
v_add_f32 v233,v21,v117
M v[156:159],a[100:103],a[212:215],v[156:159]
s_waitcnt vmcnt(18)
buffer_load_dwordx4 a[100:103],v247,s[20:23],s46 offen offset:1024 sc1
M v[160:163],v[224:227],a[216:219],v[160:163]
ds_read_b128 a[216:219],v246 offset:28160
v_sub_f32 v117,v21,v117
M v[164:167],v[224:227],a[220:223],v[164:167]
v_add_f32 v21,v232,v233
v_fmac_f32 v232,4.0,v233
M v[168:171],v[224:227],a[192:195],v[168:171]
v_fma_f32 v233,2.0,v117,v234
v_fma_f32 v117,s40,v117,v234
M v[172:175],v[224:227],a[196:199],v[172:175]
v_cvt_pk_bf16_f32 v228,v228,v233
v_cvt_pk_bf16_f32 v230,v230,v232
M v[176:179],v[224:227],a[200:203],v[176:179]
v_accvgpr_read_b32 v234,a22
v_accvgpr_read_b32 v229,a118
M v[180:183],v[224:227],a[204:207],v[180:183]
v_add_f32 v231,v234,v229
v_sub_f32 v234,v234,v229
M v[184:187],v[224:227],a[208:211],v[184:187]
v_add_f32 v229,v22,v118
v_sub_f32 v118,v22,v118
M v[188:191],v[224:227],a[212:215],v[188:191]
s_waitcnt vmcnt(18)
buffer_load_dwordx4 v[224:227],v247,s[20:23],s46 offen offset:2048 sc1
M v[128:131],a[228:231],a[220:223],v[128:131]
s_add_u32 s46,s80,0
v_add_f32 v22,v231,v229
v_fmac_f32 v231,4.0,v229
M v[132:135],a[228:231],a[192:195],v[132:135]
v_fma_f32 v229,2.0,v118,v234
v_fma_f32 v118,s40,v118,v234
M v[136:139],a[228:231],a[196:199],v[136:139]
v_accvgpr_read_b32 v234,a23
v_accvgpr_read_b32 v233,a119
M v[140:143],a[228:231],a[200:203],v[140:143]
buffer_load_dwordx4 a[116:119],v247,s[20:23],s46 offen offset:0 sc1
M v[144:147],a[228:231],a[204:207],v[144:147]
v_add_f32 v232,v234,v233
v_sub_f32 v234,v234,v233
M v[148:151],a[228:231],a[208:211],v[148:151]
v_add_f32 v233,v23,v119
v_sub_f32 v119,v23,v119
M v[152:155],a[228:231],a[212:215],v[152:155]
s_waitcnt lgkmcnt(0)
v_add_f32 v23,v232,v233
v_fmac_f32 v232,4.0,v233
M v[156:159],a[228:231],a[216:219],v[156:159]
s_waitcnt vmcnt(18)
buffer_load_dwordx4 a[228:231],v247,s[20:23],s46 offen offset:1024 sc1
M v[160:163],a[232:235],a[220:223],v[160:163]
ds_read_b128 a[220:223],v245 offset:28416
v_fma_f32 v233,2.0,v119,v234
M v[164:167],a[232:235],a[192:195],v[164:167]
v_fma_f32 v119,s40,v119,v234
v_cvt_pk_bf16_f32 v229,v229,v233
M v[168:171],a[232:235],a[196:199],v[168:171]
v_cvt_pk_bf16_f32 v231,v231,v232
M v[172:175],a[232:235],a[200:203],v[172:175]
ds_write2st64_b64 v249,v[228:229],v[230:231] offset0:76 offset1:80
M v[176:179],a[232:235],a[204:207],v[176:179]
v_accvgpr_read_b32 v234,a24
v_accvgpr_read_b32 v228,a120
M v[180:183],a[232:235],a[208:211],v[180:183]
v_add_f32 v230,v234,v228
v_sub_f32 v234,v234,v228
M v[184:187],a[232:235],a[212:215],v[184:187]
v_add_f32 v228,v24,v120
v_sub_f32 v120,v24,v120
M v[188:191],a[232:235],a[216:219],v[188:191]
s_waitcnt vmcnt(17) lgkmcnt(0)
s_barrier
ds_read_b128 a[16:19],v247 offset:34816
M v[128:131],a[236:239],a[192:195],v[128:131]
ds_read_b128 a[20:23],v247 offset:38912
v_add_f32 v24,v230,v228
M v[132:135],a[236:239],a[196:199],v[132:135]
buffer_load_dwordx4 a[232:235],v247,s[20:23],s46 offen offset:2048 sc1
M v[136:139],a[236:239],a[200:203],v[136:139]
s_add_u32 s46,s81,0
v_fmac_f32 v230,4.0,v228
v_fma_f32 v228,2.0,v120,v234
M v[140:143],a[236:239],a[204:207],v[140:143]
v_fma_f32 v120,s40,v120,v234
v_accvgpr_read_b32 v234,a25
M v[144:147],a[236:239],a[208:211],v[144:147]
s_waitcnt lgkmcnt(1)
s_add_u32 s34,s32,7077888
buffer_store_dwordx4 a[16:19],v248,s[24:27],s34 offen offset:384 nt
M v[148:151],a[236:239],a[212:215],v[148:151]
s_nop 0
s_add_u32 s34,s32,7274496
v_accvgpr_read_b32 v233,a121
v_add_f32 v232,v234,v233
M v[152:155],a[236:239],a[216:219],v[152:155]
s_waitcnt lgkmcnt(0)
buffer_store_dwordx4 a[20:23],v248,s[24:27],s34 offen offset:384 nt
M v[156:159],a[236:239],a[220:223],v[156:159]
s_waitcnt vmcnt(19)
v_sub_f32 v234,v234,v233
v_add_f32 v233,v25,v121
M v[160:163],a[104:107],a[192:195],v[160:163]
ds_read_b128 a[192:195],v245 offset:52224
v_sub_f32 v121,v25,v121
M v[164:167],a[104:107],a[196:199],v[164:167]
buffer_load_dwordx4 a[236:239],v247,s[20:23],s46 offen offset:0 sc1
M v[168:171],a[104:107],a[200:203],v[168:171]
s_waitcnt lgkmcnt(0)
s_barrier
ds_read_b128 a[196:199],v246 offset:52480
v_add_f32 v25,v232,v233
M v[172:175],a[104:107],a[204:207],v[172:175]
ds_read_b128 a[200:203],v246 offset:52736
ds_read_b128 a[204:207],v246 offset:52992
v_fmac_f32 v232,4.0,v233
v_fma_f32 v233,2.0,v121,v234
v_fma_f32 v121,s40,v121,v234
v_cvt_pk_bf16_f32 v228,v228,v233
M v[176:179],a[104:107],a[208:211],v[176:179]
ds_read_b128 a[208:211],v246 offset:53248
v_cvt_pk_bf16_f32 v230,v230,v232
v_accvgpr_read_b32 v234,a26
v_accvgpr_read_b32 v229,a122
v_add_f32 v231,v234,v229
M v[180:183],a[104:107],a[212:215],v[180:183]
ds_read_b128 a[212:215],v246 offset:53504
v_sub_f32 v234,v234,v229
v_add_f32 v229,v26,v122
v_sub_f32 v122,v26,v122
v_add_f32 v26,v231,v229
M v[184:187],a[104:107],a[216:219],v[184:187]
ds_read_b128 a[216:219],v246 offset:53760
v_fmac_f32 v231,4.0,v229
v_fma_f32 v229,2.0,v122,v234
v_fma_f32 v122,s40,v122,v234
v_accvgpr_read_b32 v234,a27
M v[188:191],a[104:107],a[220:223],v[188:191]
s_waitcnt vmcnt(19)
buffer_load_dwordx4 a[104:107],v247,s[20:23],s46 offen offset:1024 sc1
v_accvgpr_read_b32 v233,a123
v_add_f32 v232,v234,v233
v_sub_f32 v234,v234,v233
v_add_f32 v233,v27,v123
M v[0:3],a[240:243],a[192:195],v[0:3]
s_waitcnt lgkmcnt(5)
buffer_load_dwordx4 a[120:123],v247,s[20:23],s46 offen offset:2048 sc1
v_sub_f32 v123,v27,v123
v_add_f32 v27,v232,v233
v_fmac_f32 v232,4.0,v233
v_fma_f32 v233,2.0,v123,v234
M v[4:7],a[240:243],a[196:199],v[4:7]
s_waitcnt lgkmcnt(4)
s_add_u32 s46,s76,46080
ds_read_b128 a[220:223],v246 offset:54016
ds_read_b128 a[192:195],v246 offset:54272
v_fma_f32 v123,s40,v123,v234
v_cvt_pk_bf16_f32 v229,v229,v233
v_cvt_pk_bf16_f32 v231,v231,v232
M v[8:11],a[240:243],a[200:203],v[8:11]
s_waitcnt lgkmcnt(5)
ds_write2st64_b64 v249,v[228:229],v[230:231] offset0:85 offset1:89
M v[12:15],a[240:243],a[204:207],v[12:15]
s_waitcnt lgkmcnt(5)
v_accvgpr_read_b32 v204,a28
v_accvgpr_read_b32 v208,a124
M v[16:19],a[240:243],a[208:211],v[16:19]
s_waitcnt lgkmcnt(4)
v_accvgpr_read_b32 v205,a29
v_accvgpr_read_b32 v209,a125
v_accvgpr_read_b32 v206,a30
v_accvgpr_read_b32 v210,a126
v_accvgpr_read_b32 v207,a31
v_accvgpr_read_b32 v211,a127
v_pk_add_f32 v[212:213],v[204:205],v[208:209]
v_pk_add_f32 v[214:215],v[206:207],v[210:211]
v_pk_add_f32 v[204:205],v[204:205],v[208:209] neg_lo:[0,1] neg_hi:[0,1]
v_pk_add_f32 v[206:207],v[206:207],v[210:211] neg_lo:[0,1] neg_hi:[0,1]
v_pk_add_f32 v[208:209],v[28:29],v[124:125]
v_pk_add_f32 v[210:211],v[30:31],v[126:127]
v_pk_add_f32 v[124:125],v[28:29],v[124:125] neg_lo:[0,1] neg_hi:[0,1]
v_pk_add_f32 v[126:127],v[30:31],v[126:127] neg_lo:[0,1] neg_hi:[0,1]
v_pk_add_f32 v[28:29],v[212:213],v[208:209]
v_pk_add_f32 v[30:31],v[214:215],v[210:211]
v_pk_fma_f32 v[212:213],v[208:209],4.0,v[212:213] op_sel_hi:[1,0,1]
v_pk_fma_f32 v[214:215],v[210:211],4.0,v[214:215] op_sel_hi:[1,0,1]
v_pk_fma_f32 v[208:209],v[124:125],2.0,v[204:205] op_sel_hi:[1,0,1]
v_pk_fma_f32 v[210:211],v[126:127],2.0,v[206:207] op_sel_hi:[1,0,1]
v_pk_fma_f32 v[124:125],v[124:125],s[40:41],v[204:205] op_sel_hi:[1,0,1]
v_pk_fma_f32 v[126:127],v[126:127],s[40:41],v[206:207] op_sel_hi:[1,0,1]
M v[20:23],a[240:243],a[212:215],v[20:23]
s_waitcnt lgkmcnt(3)
buffer_load_dwordx4 a[124:127],v247,s[20:23],s46 offen offset:0 sc1
M v[24:27],a[240:243],a[216:219],v[24:27]
s_waitcnt lgkmcnt(2)
v_cvt_pk_bf16_f32 v208,v208,v209
v_cvt_pk_bf16_f32 v209,v210,v211
M v[28:31],a[240:243],a[220:223],v[28:31]
s_waitcnt vmcnt(21)
buffer_load_dwordx4 a[240:243],v247,s[20:23],s46 offen offset:1024 sc1
M v[0:3],a[244:247],a[196:199],v[0:3]
ds_read_b128 a[196:199],v245 offset:54528
v_cvt_pk_bf16_f32 v212,v212,v213
M v[4:7],a[244:247],a[200:203],v[4:7]
v_cvt_pk_bf16_f32 v213,v214,v215
M v[8:11],a[244:247],a[204:207],v[8:11]
ds_write2st64_b64 v249,v[208:209],v[212:213] offset0:93 offset1:97
M v[12:15],a[244:247],a[208:211],v[12:15]
v_accvgpr_read_b32 v234,a32
v_accvgpr_read_b32 v228,a128
M v[16:19],a[244:247],a[212:215],v[16:19]
v_add_f32 v230,v234,v228
v_sub_f32 v234,v234,v228
M v[20:23],a[244:247],a[216:219],v[20:23]
v_add_u32 v245,0x15400,v245
v_add_u32 v246,0x15400,v246
M v[24:27],a[244:247],a[220:223],v[24:27]
s_waitcnt lgkmcnt(3)
v_add_f32 v228,v32,v128
v_sub_f32 v128,v32,v128
M v[28:31],a[244:247],a[192:195],v[28:31]
s_waitcnt vmcnt(21) lgkmcnt(0)
s_barrier
ds_read_b128 a[24:27],v247 offset:43520
M v[0:3],a[108:111],a[200:203],v[0:3]
ds_read_b128 a[28:31],v247 offset:47616
ds_read_b128 a[200:203],v245 offset:0
M v[4:7],a[108:111],a[204:207],v[4:7]
buffer_load_dwordx4 a[244:247],v247,s[20:23],s46 offen offset:2048 sc1
M v[8:11],a[108:111],a[208:211],v[8:11]
s_add_u32 s46,s77,46080
ds_read_b128 a[204:207],v246 offset:256
ds_read_b128 a[208:211],v246 offset:512
M v[12:15],a[108:111],a[212:215],v[12:15]
ds_read_b128 a[212:215],v246 offset:768
v_add_f32 v32,v230,v228
M v[16:19],a[108:111],a[216:219],v[16:19]
s_waitcnt lgkmcnt(5)
s_add_u32 s34,s32,7471104
buffer_store_dwordx4 a[24:27],v248,s[24:27],s34 offen offset:384 nt
M v[20:23],a[108:111],a[220:223],v[20:23]
s_nop 0
s_add_u32 s34,s32,7667712
ds_read_b128 a[216:219],v246 offset:1024
ds_read_b128 a[220:223],v246 offset:1280
M v[24:27],a[108:111],a[192:195],v[24:27]
s_waitcnt lgkmcnt(6)
buffer_store_dwordx4 a[28:31],v248,s[24:27],s34 offen offset:384 nt
M v[28:31],a[108:111],a[196:199],v[28:31]
s_waitcnt vmcnt(23) lgkmcnt(5)
ds_read_b128 a[192:195],v246 offset:1536
ds_read_b128 a[196:199],v246 offset:1792
M v[0:3],a[248:251],a[200:203],v[0:3]
s_waitcnt lgkmcnt(6)
ds_read_b128 a[200:203],v246 offset:2048
v_fmac_f32 v230,4.0,v228
M v[4:7],a[248:251],a[204:207],v[4:7]
s_waitcnt lgkmcnt(6)
buffer_load_dwordx4 a[108:111],v247,s[20:23],s46 offen offset:0 sc1
M v[8:11],a[248:251],a[208:211],v[8:11]
s_waitcnt lgkmcnt(5)
v_fma_f32 v228,2.0,v128,v234
v_fma_f32 v128,s40,v128,v234
M v[12:15],a[248:251],a[212:215],v[12:15]
s_waitcnt lgkmcnt(4)
v_accvgpr_read_b32 v234,a33
v_accvgpr_read_b32 v233,a129
M v[16:19],a[248:251],a[216:219],v[16:19]
s_waitcnt lgkmcnt(3)
v_add_f32 v232,v234,v233
v_sub_f32 v234,v234,v233
M v[20:23],a[248:251],a[220:223],v[20:23]
s_waitcnt lgkmcnt(2)
v_add_f32 v233,v33,v129
v_sub_f32 v129,v33,v129
M v[24:27],a[248:251],a[192:195],v[24:27]
s_waitcnt lgkmcnt(1)
v_add_f32 v33,v232,v233
v_fmac_f32 v232,4.0,v233
M v[28:31],a[248:251],a[196:199],v[28:31]
s_waitcnt vmcnt(23)
buffer_load_dwordx4 a[248:251],v247,s[20:23],s46 offen offset:1024 sc1
M v[0:3],a[96:99],a[204:207],v[0:3]
ds_read_b128 a[204:207],v245 offset:2304
v_fma_f32 v233,2.0,v129,v234
M v[4:7],a[96:99],a[208:211],v[4:7]
v_fma_f32 v129,s40,v129,v234
v_cvt_pk_bf16_f32 v228,v228,v233
M v[8:11],a[96:99],a[212:215],v[8:11]
v_cvt_pk_bf16_f32 v230,v230,v232
v_accvgpr_read_b32 v234,a34
M v[12:15],a[96:99],a[216:219],v[12:15]
v_accvgpr_read_b32 v229,a130
v_add_f32 v231,v234,v229
M v[16:19],a[96:99],a[220:223],v[16:19]
v_sub_f32 v234,v234,v229
v_add_f32 v229,v34,v130
M v[20:23],a[96:99],a[192:195],v[20:23]
v_sub_f32 v130,v34,v130
v_add_f32 v34,v231,v229
M v[24:27],a[96:99],a[196:199],v[24:27]
s_waitcnt lgkmcnt(1)
v_fmac_f32 v231,4.0,v229
v_fma_f32 v229,2.0,v130,v234
M v[28:31],a[96:99],a[200:203],v[28:31]
s_waitcnt vmcnt(22)
buffer_load_dwordx4 a[96:99],v247,s[20:23],s46 offen offset:2048 sc1
M v[0:3],a[252:255],a[208:211],v[0:3]
s_add_u32 s46,s78,46080
ds_read_b128 a[208:211],v245 offset:17408
v_fma_f32 v130,s40,v130,v234
M v[4:7],a[252:255],a[212:215],v[4:7]
ds_read_b128 a[212:215],v246 offset:17664
v_accvgpr_read_b32 v234,a35
M v[8:11],a[252:255],a[216:219],v[8:11]
ds_read_b128 a[216:219],v246 offset:17920
v_accvgpr_read_b32 v233,a131
M v[12:15],a[252:255],a[220:223],v[12:15]
buffer_load_dwordx4 a[128:131],v247,s[20:23],s46 offen offset:0 sc1
M v[16:19],a[252:255],a[192:195],v[16:19]
ds_read_b128 a[220:223],v246 offset:18176
ds_read_b128 a[192:195],v246 offset:18432
M v[20:23],a[252:255],a[196:199],v[20:23]
ds_read_b128 a[196:199],v246 offset:18688
v_add_f32 v232,v234,v233
M v[24:27],a[252:255],a[200:203],v[24:27]
s_waitcnt lgkmcnt(6)
ds_read_b128 a[200:203],v246 offset:18944
v_sub_f32 v234,v234,v233
M v[28:31],a[252:255],a[204:207],v[28:31]
s_waitcnt vmcnt(22) lgkmcnt(6)
ds_read_b128 a[204:207],v246 offset:19200
v_add_f32 v233,v35,v131
M v[0:3],a[224:227],a[208:211],v[0:3]
s_waitcnt lgkmcnt(6)
ds_read_b128 a[208:211],v246 offset:19456
v_sub_f32 v131,v35,v131
M v[4:7],a[224:227],a[212:215],v[4:7]
s_waitcnt lgkmcnt(6)
v_add_f32 v35,v232,v233
v_fmac_f32 v232,4.0,v233
M v[8:11],a[224:227],a[216:219],v[8:11]
s_waitcnt lgkmcnt(5)
buffer_load_dwordx4 a[252:255],v247,s[20:23],s46 offen offset:1024 sc1
M v[12:15],a[224:227],a[220:223],v[12:15]
s_waitcnt lgkmcnt(4)
v_fma_f32 v233,2.0,v131,v234
v_fma_f32 v131,s40,v131,v234
M v[16:19],a[224:227],a[192:195],v[16:19]
s_waitcnt lgkmcnt(3)
v_cvt_pk_bf16_f32 v229,v229,v233
v_cvt_pk_bf16_f32 v231,v231,v232
M v[20:23],a[224:227],a[196:199],v[20:23]
s_waitcnt lgkmcnt(2)
ds_write2st64_b64 v249,v[228:229],v[230:231] offset0:34 offset1:38
M v[24:27],a[224:227],a[200:203],v[24:27]
s_waitcnt lgkmcnt(2)
v_accvgpr_read_b32 v234,a36
v_accvgpr_read_b32 v228,a132
M v[28:31],a[224:227],a[204:207],v[28:31]
s_waitcnt vmcnt(22)
v_add_f32 v230,v234,v228
v_sub_f32 v234,v234,v228
M v[0:3],a[112:115],a[212:215],v[0:3]
ds_read_b128 a[212:215],v245 offset:19712
v_add_f32 v228,v36,v132
M v[4:7],a[112:115],a[216:219],v[4:7]
v_sub_f32 v132,v36,v132
v_add_f32 v36,v230,v228
M v[8:11],a[112:115],a[220:223],v[8:11]
buffer_load_dwordx4 a[224:227],v247,s[20:23],s46 offen offset:2048 sc1
M v[12:15],a[112:115],a[192:195],v[12:15]
v_fmac_f32 v230,4.0,v228
v_fma_f32 v228,2.0,v132,v234
M v[16:19],a[112:115],a[196:199],v[16:19]
s_add_u32 s46,s79,46080
v_fma_f32 v132,s40,v132,v234
v_accvgpr_read_b32 v234,a37
M v[20:23],a[112:115],a[200:203],v[20:23]
v_accvgpr_read_b32 v233,a133
v_add_f32 v232,v234,v233
M v[24:27],a[112:115],a[204:207],v[24:27]
s_waitcnt lgkmcnt(2)
v_sub_f32 v234,v234,v233
v_add_f32 v233,v37,v133
M v[28:31],a[112:115],a[208:211],v[28:31]
s_waitcnt vmcnt(22)
v_sub_f32 v133,v37,v133
v_add_f32 v37,v232,v233
M v[0:3],v[216:219],a[216:219],v[0:3]
ds_read_b128 a[216:219],v245 offset:34816
v_fmac_f32 v232,4.0,v233
M v[4:7],v[216:219],a[220:223],v[4:7]
ds_read_b128 a[220:223],v246 offset:35072
v_fma_f32 v233,2.0,v133,v234
M v[8:11],v[216:219],a[192:195],v[8:11]
buffer_load_dwordx4 a[112:115],v247,s[20:23],s46 offen offset:0 sc1
M v[12:15],v[216:219],a[196:199],v[12:15]
ds_read_b128 a[192:195],v246 offset:35328
ds_read_b128 a[196:199],v246 offset:35584
M v[16:19],v[216:219],a[200:203],v[16:19]
ds_read_b128 a[200:203],v246 offset:35840
v_fma_f32 v133,s40,v133,v234
M v[20:23],v[216:219],a[204:207],v[20:23]
ds_read_b128 a[204:207],v246 offset:36096
v_cvt_pk_bf16_f32 v228,v228,v233
M v[24:27],v[216:219],a[208:211],v[24:27]
s_waitcnt lgkmcnt(6)
ds_read_b128 a[208:211],v246 offset:36352
v_cvt_pk_bf16_f32 v230,v230,v232
M v[28:31],v[216:219],a[212:215],v[28:31]
s_waitcnt vmcnt(22) lgkmcnt(6)
ds_read_b128 a[212:215],v246 offset:36608
v_accvgpr_read_b32 v234,a38
M v[0:3],v[220:223],a[216:219],v[0:3]
s_waitcnt lgkmcnt(6)
ds_read_b128 a[216:219],v246 offset:36864
v_accvgpr_read_b32 v229,a134
M v[4:7],v[220:223],a[220:223],v[4:7]
s_waitcnt lgkmcnt(6)
v_add_f32 v231,v234,v229
v_sub_f32 v234,v234,v229
M v[8:11],v[220:223],a[192:195],v[8:11]
s_waitcnt lgkmcnt(5)
buffer_load_dwordx4 v[216:219],v247,s[20:23],s46 offen offset:1024 sc1
M v[12:15],v[220:223],a[196:199],v[12:15]
s_waitcnt lgkmcnt(4)
v_add_f32 v229,v38,v134
v_sub_f32 v134,v38,v134
M v[16:19],v[220:223],a[200:203],v[16:19]
s_waitcnt lgkmcnt(3)
v_add_f32 v38,v231,v229
v_fmac_f32 v231,4.0,v229
M v[20:23],v[220:223],a[204:207],v[20:23]
s_waitcnt lgkmcnt(2)
v_fma_f32 v229,2.0,v134,v234
v_fma_f32 v134,s40,v134,v234
M v[24:27],v[220:223],a[208:211],v[24:27]
s_waitcnt lgkmcnt(1)
v_accvgpr_read_b32 v234,a39
v_accvgpr_read_b32 v233,a135
M v[28:31],v[220:223],a[212:215],v[28:31]
s_waitcnt vmcnt(22)
v_add_f32 v232,v234,v233
v_sub_f32 v234,v234,v233
M v[0:3],a[100:103],a[220:223],v[0:3]
ds_read_b128 a[220:223],v245 offset:37120
v_add_f32 v233,v39,v135
M v[4:7],a[100:103],a[192:195],v[4:7]
v_sub_f32 v135,v39,v135
v_add_f32 v39,v232,v233
M v[8:11],a[100:103],a[196:199],v[8:11]
buffer_load_dwordx4 v[220:223],v247,s[20:23],s46 offen offset:2048 sc1
M v[12:15],a[100:103],a[200:203],v[12:15]
v_fmac_f32 v232,4.0,v233
v_fma_f32 v233,2.0,v135,v234
M v[16:19],a[100:103],a[204:207],v[16:19]
s_add_u32 s46,s80,46080
v_fma_f32 v135,s40,v135,v234
v_cvt_pk_bf16_f32 v229,v229,v233
M v[20:23],a[100:103],a[208:211],v[20:23]
v_cvt_pk_bf16_f32 v231,v231,v232
M v[24:27],a[100:103],a[212:215],v[24:27]
s_waitcnt lgkmcnt(1)
ds_write2st64_b64 v249,v[228:229],v[230:231] offset0:42 offset1:46
M v[28:31],a[100:103],a[216:219],v[28:31]
s_waitcnt vmcnt(22)
v_accvgpr_read_b32 v234,a40
v_accvgpr_read_b32 v228,a136
M v[0:3],v[224:227],a[192:195],v[0:3]
ds_read_b128 a[192:195],v245 offset:52224
v_add_f32 v230,v234,v228
M v[4:7],v[224:227],a[196:199],v[4:7]
ds_read_b128 a[196:199],v246 offset:52480
v_sub_f32 v234,v234,v228
M v[8:11],v[224:227],a[200:203],v[8:11]
buffer_load_dwordx4 a[132:135],v247,s[20:23],s46 offen offset:0 sc1
M v[12:15],v[224:227],a[204:207],v[12:15]
ds_read_b128 a[200:203],v246 offset:52736
ds_read_b128 a[204:207],v246 offset:52992
M v[16:19],v[224:227],a[208:211],v[16:19]
ds_read_b128 a[208:211],v246 offset:53248
v_add_f32 v228,v40,v136
M v[20:23],v[224:227],a[212:215],v[20:23]
ds_read_b128 a[212:215],v246 offset:53504
v_sub_f32 v136,v40,v136
M v[24:27],v[224:227],a[216:219],v[24:27]
s_waitcnt lgkmcnt(7)
ds_read_b128 a[216:219],v246 offset:53760
v_add_f32 v40,v230,v228
M v[28:31],v[224:227],a[220:223],v[28:31]
s_waitcnt vmcnt(22) lgkmcnt(6)
ds_read_b128 a[220:223],v246 offset:54016
v_fmac_f32 v230,4.0,v228
M v[0:3],a[116:119],a[192:195],v[0:3]
s_waitcnt lgkmcnt(6)
ds_read_b128 a[192:195],v246 offset:54272
v_fma_f32 v228,2.0,v136,v234
M v[4:7],a[116:119],a[196:199],v[4:7]
s_waitcnt lgkmcnt(6)
v_fma_f32 v136,s40,v136,v234
v_accvgpr_read_b32 v234,a41
M v[8:11],a[116:119],a[200:203],v[8:11]
s_waitcnt lgkmcnt(5)
buffer_load_dwordx4 a[100:103],v247,s[20:23],s46 offen offset:1024 sc1
M v[12:15],a[116:119],a[204:207],v[12:15]
s_waitcnt lgkmcnt(4)
v_accvgpr_read_b32 v233,a137
v_add_f32 v232,v234,v233
M v[16:19],a[116:119],a[208:211],v[16:19]
s_waitcnt lgkmcnt(3)
v_sub_f32 v234,v234,v233
v_add_f32 v233,v41,v137
M v[20:23],a[116:119],a[212:215],v[20:23]
s_waitcnt lgkmcnt(2)
v_sub_f32 v137,v41,v137
v_add_f32 v41,v232,v233
M v[24:27],a[116:119],a[216:219],v[24:27]
s_waitcnt lgkmcnt(1)
v_fmac_f32 v232,4.0,v233
v_fma_f32 v233,2.0,v137,v234
M v[28:31],a[116:119],a[220:223],v[28:31]
s_waitcnt vmcnt(22)
v_fma_f32 v137,s40,v137,v234
v_cvt_pk_bf16_f32 v228,v228,v233
M v[0:3],a[228:231],a[196:199],v[0:3]
ds_read_b128 a[196:199],v245 offset:54528
v_cvt_pk_bf16_f32 v230,v230,v232
M v[4:7],a[228:231],a[200:203],v[4:7]
v_accvgpr_read_b32 v234,a42
v_accvgpr_read_b32 v229,a138
M v[8:11],a[228:231],a[204:207],v[8:11]
buffer_load_dwordx4 v[224:227],v247,s[20:23],s46 offen offset:2048 sc1
M v[12:15],a[228:231],a[208:211],v[12:15]
v_add_f32 v231,v234,v229
v_sub_f32 v234,v234,v229
M v[16:19],a[228:231],a[212:215],v[16:19]
s_add_u32 s46,s81,46080
v_add_f32 v229,v42,v138
v_sub_f32 v138,v42,v138
M v[20:23],a[228:231],a[216:219],v[20:23]
v_add_u32 v245,0xffff9a00,v245
v_add_u32 v246,0xffff9a00,v246
M v[24:27],a[228:231],a[220:223],v[24:27]
s_waitcnt lgkmcnt(1)
v_add_f32 v42,v231,v229
v_fmac_f32 v231,4.0,v229
M v[28:31],a[228:231],a[192:195],v[28:31]
s_waitcnt vmcnt(22)
v_fma_f32 v229,2.0,v138,v234
v_fma_f32 v138,s40,v138,v234
M v[0:3],a[232:235],a[200:203],v[0:3]
ds_read_b128 a[200:203],v245 offset:8704
v_accvgpr_read_b32 v234,a43
M v[4:7],a[232:235],a[204:207],v[4:7]
ds_read_b128 a[204:207],v246 offset:8960
v_accvgpr_read_b32 v233,a139
M v[8:11],a[232:235],a[208:211],v[8:11]
buffer_load_dwordx4 a[116:119],v247,s[20:23],s46 offen offset:0 sc1
M v[12:15],a[232:235],a[212:215],v[12:15]
ds_read_b128 a[208:211],v246 offset:9216
ds_read_b128 a[212:215],v246 offset:9472
M v[16:19],a[232:235],a[216:219],v[16:19]
ds_read_b128 a[216:219],v246 offset:9728
v_add_f32 v232,v234,v233
M v[20:23],a[232:235],a[220:223],v[20:23]
ds_read_b128 a[220:223],v246 offset:9984
v_sub_f32 v234,v234,v233
M v[24:27],a[232:235],a[192:195],v[24:27]
s_waitcnt lgkmcnt(6)
ds_read_b128 a[192:195],v246 offset:10240
v_add_f32 v233,v43,v139
M v[28:31],a[232:235],a[196:199],v[28:31]
s_waitcnt vmcnt(20) lgkmcnt(6)
ds_read_b128 a[196:199],v246 offset:10496
v_sub_f32 v139,v43,v139
M v[0:3],a[236:239],a[200:203],v[0:3]
s_waitcnt lgkmcnt(6)
ds_read_b128 a[200:203],v246 offset:10752
v_add_f32 v43,v232,v233
M v[4:7],a[236:239],a[204:207],v[4:7]
s_waitcnt lgkmcnt(6)
v_fmac_f32 v232,4.0,v233
v_fma_f32 v233,2.0,v139,v234
M v[8:11],a[236:239],a[208:211],v[8:11]
s_waitcnt lgkmcnt(5)
buffer_load_dwordx4 a[228:231],v247,s[20:23],s46 offen offset:1024 sc1
M v[12:15],a[236:239],a[212:215],v[12:15]
s_waitcnt lgkmcnt(4)
v_fma_f32 v139,s40,v139,v234
v_cvt_pk_bf16_f32 v229,v229,v233
M v[16:19],a[236:239],a[216:219],v[16:19]
s_waitcnt lgkmcnt(3)
v_cvt_pk_bf16_f32 v231,v231,v232
M v[20:23],a[236:239],a[220:223],v[20:23]
s_waitcnt lgkmcnt(2)
ds_write2st64_b64 v249,v[228:229],v[230:231] offset0:51 offset1:55
M v[24:27],a[236:239],a[192:195],v[24:27]
s_waitcnt lgkmcnt(2)
v_accvgpr_read_b32 v204,a44
v_accvgpr_read_b32 v208,a140
M v[28:31],a[236:239],a[196:199],v[28:31]
s_waitcnt vmcnt(20)
v_accvgpr_read_b32 v205,a45
v_accvgpr_read_b32 v209,a141
M v[0:3],a[104:107],a[204:207],v[0:3]
ds_read_b128 a[204:207],v245 offset:11008
v_accvgpr_read_b32 v206,a46
M v[4:7],a[104:107],a[208:211],v[4:7]
v_accvgpr_read_b32 v210,a142
v_accvgpr_read_b32 v207,a47
v_accvgpr_read_b32 v211,a143
v_pk_add_f32 v[212:213],v[204:205],v[208:209]
v_pk_add_f32 v[214:215],v[206:207],v[210:211]
v_pk_add_f32 v[204:205],v[204:205],v[208:209] neg_lo:[0,1] neg_hi:[0,1]
v_pk_add_f32 v[206:207],v[206:207],v[210:211] neg_lo:[0,1] neg_hi:[0,1]
v_pk_add_f32 v[208:209],v[44:45],v[140:141]
v_pk_add_f32 v[210:211],v[46:47],v[142:143]
v_pk_add_f32 v[140:141],v[44:45],v[140:141] neg_lo:[0,1] neg_hi:[0,1]
v_pk_add_f32 v[142:143],v[46:47],v[142:143] neg_lo:[0,1] neg_hi:[0,1]
v_pk_add_f32 v[44:45],v[212:213],v[208:209]
v_pk_add_f32 v[46:47],v[214:215],v[210:211]
v_pk_fma_f32 v[212:213],v[208:209],4.0,v[212:213] op_sel_hi:[1,0,1]
v_pk_fma_f32 v[214:215],v[210:211],4.0,v[214:215] op_sel_hi:[1,0,1]
v_pk_fma_f32 v[208:209],v[140:141],2.0,v[204:205] op_sel_hi:[1,0,1]
v_pk_fma_f32 v[210:211],v[142:143],2.0,v[206:207] op_sel_hi:[1,0,1]
v_pk_fma_f32 v[140:141],v[140:141],s[40:41],v[204:205] op_sel_hi:[1,0,1]
v_pk_fma_f32 v[142:143],v[142:143],s[40:41],v[206:207] op_sel_hi:[1,0,1]
M v[8:11],a[104:107],a[212:215],v[8:11]
buffer_load_dwordx4 a[136:139],v247,s[20:23],s46 offen offset:2048 sc1
M v[12:15],a[104:107],a[216:219],v[12:15]
v_cvt_pk_bf16_f32 v208,v208,v209
v_cvt_pk_bf16_f32 v209,v210,v211
M v[16:19],a[104:107],a[220:223],v[16:19]
s_add_u32 s47,s76,3072
v_cvt_pk_bf16_f32 v212,v212,v213
v_cvt_pk_bf16_f32 v213,v214,v215
M v[20:23],a[104:107],a[192:195],v[20:23]
ds_write2st64_b64 v249,v[208:209],v[212:213] offset0:59 offset1:63
M v[24:27],a[104:107],a[196:199],v[24:27]
s_waitcnt lgkmcnt(3)
M v[28:31],a[104:107],a[200:203],v[28:31]
s_waitcnt vmcnt(20)
M v[0:3],a[120:123],a[208:211],v[0:3]
ds_read_b128 a[208:211],v245 offset:0
M v[4:7],a[120:123],a[212:215],v[4:7]
ds_read_b128 a[212:215],v246 offset:256
M v[8:11],a[120:123],a[216:219],v[8:11]
buffer_load_dwordx4 a[232:235],v247,s[20:23],s47 offen offset:0 sc1
M v[12:15],a[120:123],a[220:223],v[12:15]
ds_read_b128 a[216:219],v246 offset:512
ds_read_b128 a[220:223],v246 offset:768
M v[16:19],a[120:123],a[192:195],v[16:19]
ds_read_b128 a[192:195],v246 offset:1024
v_cvt_pk_bf16_f32 v0,v0,v1
M v[20:23],a[120:123],a[196:199],v[20:23]
ds_read_b128 a[196:199],v246 offset:1280
v_cvt_pk_bf16_f32 v1,v2,v3
M v[24:27],a[120:123],a[200:203],v[24:27]
s_waitcnt lgkmcnt(7)
ds_read_b128 a[200:203],v246 offset:1536
v_cvt_pk_bf16_f32 v4,v4,v5
M v[28:31],a[120:123],a[204:207],v[28:31]
s_waitcnt vmcnt(20) lgkmcnt(6)
ds_read_b128 a[204:207],v246 offset:1792
v_cvt_pk_bf16_f32 v5,v6,v7
M v[96:99],a[124:127],a[208:211],v[96:99]
s_waitcnt lgkmcnt(6)
s_barrier
ds_read_b128 a[32:35],v247 offset:17408
M v[100:103],a[124:127],a[212:215],v[100:103]
s_waitcnt lgkmcnt(6)
ds_read_b128 a[36:39],v247 offset:21504
ds_read_b128 a[40:43],v247 offset:26112
M v[104:107],a[124:127],a[216:219],v[104:107]
s_waitcnt lgkmcnt(7)
ds_read_b128 a[44:47],v247 offset:30208
buffer_load_dwordx4 a[236:239],v247,s[20:23],s47 offen offset:1024 sc1
M v[108:111],a[124:127],a[220:223],v[108:111]
s_waitcnt lgkmcnt(7)
ds_read_b128 a[208:211],v246 offset:2048
ds_write2st64_b64 v249,v[0:1],v[4:5] offset0:17 offset1:21
M v[112:115],a[124:127],a[192:195],v[112:115]
s_waitcnt lgkmcnt(8)
global_load_dword v251,v252,s[82:83]
M v[116:119],a[124:127],a[196:199],v[116:119]
s_waitcnt lgkmcnt(5)
s_add_u32 s34,s32,6291456
buffer_store_dwordx4 a[32:35],v248,s[24:27],s34 offen offset:512 nt
M v[120:123],a[124:127],a[200:203],v[120:123]
s_nop 0
s_add_u32 s34,s32,6488064
v_cvt_pk_bf16_f32 v8,v8,v9
v_cvt_pk_bf16_f32 v9,v10,v11
M v[124:127],a[124:127],a[204:207],v[124:127]
s_waitcnt vmcnt(22)
v_cvt_pk_bf16_f32 v12,v12,v13
v_cvt_pk_bf16_f32 v13,v14,v15
M v[96:99],a[240:243],a[212:215],v[96:99]
s_waitcnt lgkmcnt(4)
buffer_store_dwordx4 a[36:39],v248,s[24:27],s34 offen offset:512 nt
M v[100:103],a[240:243],a[216:219],v[100:103]
s_nop 0
s_add_u32 s34,s32,6684672
ds_read_b128 a[212:215],v245 offset:2304
ds_write2st64_b64 v249,v[8:9],v[12:13] offset0:25 offset1:29
M v[104:107],a[240:243],a[220:223],v[104:107]
s_waitcnt lgkmcnt(5)
buffer_store_dwordx4 a[40:43],v248,s[24:27],s34 offen offset:512 nt
M v[108:111],a[240:243],a[192:195],v[108:111]
s_nop 0
s_add_u32 s34,s32,6881280
v_cvt_pk_bf16_f32 v16,v16,v17
v_cvt_pk_bf16_f32 v17,v18,v19
M v[112:115],a[240:243],a[196:199],v[112:115]
v_cvt_pk_bf16_f32 v20,v20,v21
v_cvt_pk_bf16_f32 v21,v22,v23
M v[116:119],a[240:243],a[200:203],v[116:119]
s_waitcnt lgkmcnt(4)
buffer_store_dwordx4 a[44:47],v248,s[24:27],s34 offen offset:512 nt
M v[120:123],a[240:243],a[204:207],v[120:123]
s_waitcnt lgkmcnt(3)
ds_write2st64_b64 v249,v[16:17],v[20:21] offset0:68 offset1:72
M v[124:127],a[240:243],a[208:211],v[124:127]
s_waitcnt vmcnt(24)
buffer_load_dwordx4 a[140:143],v247,s[20:23],s47 offen offset:2048 sc1
M v[96:99],a[244:247],a[216:219],v[96:99]
s_add_u32 s47,s77,3072
ds_read_b128 a[216:219],v245 offset:34816
v_cvt_pk_bf16_f32 v24,v24,v25
M v[100:103],a[244:247],a[220:223],v[100:103]
ds_read_b128 a[220:223],v246 offset:35072
v_cvt_pk_bf16_f32 v25,v26,v27
M v[104:107],a[244:247],a[192:195],v[104:107]
ds_read_b128 a[192:195],v246 offset:35328
v_cvt_pk_bf16_f32 v28,v28,v29
M v[108:111],a[244:247],a[196:199],v[108:111]
buffer_load_dwordx4 a[104:107],v247,s[20:23],s47 offen offset:0 sc1
M v[112:115],a[244:247],a[200:203],v[112:115]
ds_read_b128 a[196:199],v246 offset:35584
ds_read_b128 a[200:203],v246 offset:35840
M v[116:119],a[244:247],a[204:207],v[116:119]
ds_read_b128 a[204:207],v246 offset:36096
v_cvt_pk_bf16_f32 v29,v30,v31
M v[120:123],a[244:247],a[208:211],v[120:123]
s_waitcnt lgkmcnt(8)
ds_read_b128 a[208:211],v246 offset:36352
ds_write2st64_b64 v249,v[24:25],v[28:29] offset0:76 offset1:80
M v[124:127],a[244:247],a[212:215],v[124:127]
s_waitcnt vmcnt(23) lgkmcnt(7)
ds_read_b128 a[212:215],v246 offset:36608
v_accvgpr_read_b32 v234,a48
M v[96:99],a[108:111],a[216:219],v[96:99]
s_waitcnt lgkmcnt(7)
ds_read_b128 a[216:219],v246 offset:36864
v_accvgpr_read_b32 v228,a144
M v[100:103],a[108:111],a[220:223],v[100:103]
s_waitcnt lgkmcnt(7)
v_add_f32 v230,v234,v228
v_sub_f32 v234,v234,v228
M v[104:107],a[108:111],a[192:195],v[104:107]
s_waitcnt lgkmcnt(6)
buffer_load_dwordx4 a[120:123],v247,s[20:23],s47 offen offset:1024 sc1
M v[108:111],a[108:111],a[196:199],v[108:111]
s_waitcnt lgkmcnt(5)
v_add_f32 v228,v48,v144
v_sub_f32 v144,v48,v144
M v[112:115],a[108:111],a[200:203],v[112:115]
s_waitcnt lgkmcnt(4)
v_add_f32 v48,v230,v228
v_fmac_f32 v230,4.0,v228
M v[116:119],a[108:111],a[204:207],v[116:119]
s_waitcnt lgkmcnt(3)
v_fma_f32 v228,2.0,v144,v234
v_fma_f32 v144,s40,v144,v234
M v[120:123],a[108:111],a[208:211],v[120:123]
s_waitcnt lgkmcnt(1)
v_accvgpr_read_b32 v234,a49
v_accvgpr_read_b32 v233,a145
M v[124:127],a[108:111],a[212:215],v[124:127]
s_waitcnt vmcnt(23)
v_add_f32 v232,v234,v233
v_sub_f32 v234,v234,v233
M v[96:99],a[248:251],a[220:223],v[96:99]
ds_read_b128 a[220:223],v245 offset:37120
v_add_f32 v233,v49,v145
M v[100:103],a[248:251],a[192:195],v[100:103]
v_sub_f32 v145,v49,v145
v_add_f32 v49,v232,v233
M v[104:107],a[248:251],a[196:199],v[104:107]
buffer_load_dwordx4 a[124:127],v247,s[20:23],s47 offen offset:2048 sc1
M v[108:111],a[248:251],a[200:203],v[108:111]
v_fmac_f32 v232,4.0,v233
v_fma_f32 v233,2.0,v145,v234
M v[112:115],a[248:251],a[204:207],v[112:115]
s_add_u32 s47,s78,3072
v_fma_f32 v145,s40,v145,v234
v_cvt_pk_bf16_f32 v228,v228,v233
M v[116:119],a[248:251],a[208:211],v[116:119]
v_cvt_pk_bf16_f32 v230,v230,v232
v_accvgpr_read_b32 v234,a50
M v[120:123],a[248:251],a[212:215],v[120:123]
s_waitcnt lgkmcnt(1)
v_accvgpr_read_b32 v229,a146
v_add_f32 v231,v234,v229
M v[124:127],a[248:251],a[216:219],v[124:127]
s_waitcnt vmcnt(23)
v_sub_f32 v234,v234,v229
v_add_f32 v229,v50,v146
M v[96:99],a[96:99],a[192:195],v[96:99]
ds_read_b128 a[192:195],v245 offset:52224
v_sub_f32 v146,v50,v146
M v[100:103],a[96:99],a[196:199],v[100:103]
ds_read_b128 a[196:199],v246 offset:52480
v_add_f32 v50,v231,v229
M v[104:107],a[96:99],a[200:203],v[104:107]
buffer_load_dwordx4 a[240:243],v247,s[20:23],s47 offen offset:0 sc1
M v[108:111],a[96:99],a[204:207],v[108:111]
ds_read_b128 a[200:203],v246 offset:52736
ds_read_b128 a[204:207],v246 offset:52992
M v[112:115],a[96:99],a[208:211],v[112:115]
ds_read_b128 a[208:211],v246 offset:53248
v_fmac_f32 v231,4.0,v229
M v[116:119],a[96:99],a[212:215],v[116:119]
ds_read_b128 a[212:215],v246 offset:53504
v_fma_f32 v229,2.0,v146,v234
M v[120:123],a[96:99],a[216:219],v[120:123]
s_waitcnt lgkmcnt(6)
ds_read_b128 a[216:219],v246 offset:53760
v_fma_f32 v146,s40,v146,v234
M v[124:127],a[96:99],a[220:223],v[124:127]
s_waitcnt vmcnt(23) lgkmcnt(6)
ds_read_b128 a[220:223],v246 offset:54016
v_accvgpr_read_b32 v234,a51
M v[96:99],a[128:131],a[192:195],v[96:99]
s_waitcnt lgkmcnt(6)
ds_read_b128 a[192:195],v246 offset:54272
v_accvgpr_read_b32 v233,a147
M v[100:103],a[128:131],a[196:199],v[100:103]
s_waitcnt lgkmcnt(6)
v_add_f32 v232,v234,v233
v_sub_f32 v234,v234,v233
M v[104:107],a[128:131],a[200:203],v[104:107]
s_waitcnt lgkmcnt(5)
buffer_load_dwordx4 a[244:247],v247,s[20:23],s47 offen offset:1024 sc1
M v[108:111],a[128:131],a[204:207],v[108:111]
s_waitcnt lgkmcnt(4)
v_add_f32 v233,v51,v147
v_sub_f32 v147,v51,v147
M v[112:115],a[128:131],a[208:211],v[112:115]
s_waitcnt lgkmcnt(3)
v_add_f32 v51,v232,v233
v_fmac_f32 v232,4.0,v233
M v[116:119],a[128:131],a[212:215],v[116:119]
s_waitcnt lgkmcnt(2)
v_fma_f32 v233,2.0,v147,v234
v_fma_f32 v147,s40,v147,v234
M v[120:123],a[128:131],a[216:219],v[120:123]
s_waitcnt lgkmcnt(1)
v_cvt_pk_bf16_f32 v229,v229,v233
v_cvt_pk_bf16_f32 v231,v231,v232
M v[124:127],a[128:131],a[220:223],v[124:127]
s_waitcnt vmcnt(23)
ds_write2st64_b64 v249,v[228:229],v[230:231] offset0:85 offset1:89
M v[96:99],a[252:255],a[196:199],v[96:99]
ds_read_b128 a[196:199],v245 offset:54528
v_accvgpr_read_b32 v234,a52
M v[100:103],a[252:255],a[200:203],v[100:103]
v_accvgpr_read_b32 v228,a148
v_add_f32 v230,v234,v228
M v[104:107],a[252:255],a[204:207],v[104:107]
buffer_load_dwordx4 a[108:111],v247,s[20:23],s47 offen offset:2048 sc1
M v[108:111],a[252:255],a[208:211],v[108:111]
v_sub_f32 v234,v234,v228
v_add_f32 v228,v52,v148
M v[112:115],a[252:255],a[212:215],v[112:115]
s_add_u32 s47,s79,3072
v_sub_f32 v148,v52,v148
v_add_f32 v52,v230,v228
M v[116:119],a[252:255],a[216:219],v[116:119]
v_add_u32 v245,0x11000,v245
v_add_u32 v246,0x11000,v246
M v[120:123],a[252:255],a[220:223],v[120:123]
s_waitcnt lgkmcnt(2)
v_fmac_f32 v230,4.0,v228
v_fma_f32 v228,2.0,v148,v234
M v[124:127],a[252:255],a[192:195],v[124:127]
s_waitcnt vmcnt(23)
v_fma_f32 v148,s40,v148,v234
v_accvgpr_read_b32 v234,a53
M v[96:99],a[224:227],a[200:203],v[96:99]
ds_read_b128 a[200:203],v245 offset:0
v_accvgpr_read_b32 v233,a149
M v[100:103],a[224:227],a[204:207],v[100:103]
ds_read_b128 a[204:207],v246 offset:256
v_add_f32 v232,v234,v233
M v[104:107],a[224:227],a[208:211],v[104:107]
buffer_load_dwordx4 a[248:251],v247,s[20:23],s47 offen offset:0 sc1
M v[108:111],a[224:227],a[212:215],v[108:111]
ds_read_b128 a[208:211],v246 offset:512
ds_read_b128 a[212:215],v246 offset:768
M v[112:115],a[224:227],a[216:219],v[112:115]
ds_read_b128 a[216:219],v246 offset:1024
v_sub_f32 v234,v234,v233
M v[116:119],a[224:227],a[220:223],v[116:119]
ds_read_b128 a[220:223],v246 offset:1280
v_add_f32 v233,v53,v149
M v[120:123],a[224:227],a[192:195],v[120:123]
s_waitcnt lgkmcnt(6)
ds_read_b128 a[192:195],v246 offset:1536
v_sub_f32 v149,v53,v149
M v[124:127],a[224:227],a[196:199],v[124:127]
s_waitcnt vmcnt(23) lgkmcnt(6)
ds_read_b128 a[196:199],v246 offset:1792
v_add_f32 v53,v232,v233
M v[96:99],a[112:115],a[200:203],v[96:99]
s_waitcnt lgkmcnt(6)
ds_read_b128 a[200:203],v246 offset:2048
v_fmac_f32 v232,4.0,v233
M v[100:103],a[112:115],a[204:207],v[100:103]
s_waitcnt lgkmcnt(6)
v_fma_f32 v233,2.0,v149,v234
v_fma_f32 v149,s40,v149,v234
M v[104:107],a[112:115],a[208:211],v[104:107]
s_waitcnt lgkmcnt(5)
buffer_load_dwordx4 a[96:99],v247,s[20:23],s47 offen offset:1024 sc1
M v[108:111],a[112:115],a[212:215],v[108:111]
s_waitcnt lgkmcnt(4)
v_cvt_pk_bf16_f32 v228,v228,v233
v_cvt_pk_bf16_f32 v230,v230,v232
M v[112:115],a[112:115],a[216:219],v[112:115]
s_waitcnt lgkmcnt(3)
v_accvgpr_read_b32 v234,a54
v_accvgpr_read_b32 v229,a150
M v[116:119],a[112:115],a[220:223],v[116:119]
s_waitcnt lgkmcnt(2)
v_add_f32 v231,v234,v229
v_sub_f32 v234,v234,v229
M v[120:123],a[112:115],a[192:195],v[120:123]
s_waitcnt lgkmcnt(1)
v_add_f32 v229,v54,v150
v_sub_f32 v150,v54,v150
M v[124:127],a[112:115],a[196:199],v[124:127]
s_waitcnt vmcnt(23)
v_add_f32 v54,v231,v229
v_fmac_f32 v231,4.0,v229
M v[96:99],v[216:219],a[204:207],v[96:99]
ds_read_b128 a[204:207],v245 offset:2304
v_fma_f32 v229,2.0,v150,v234
M v[100:103],v[216:219],a[208:211],v[100:103]
v_fma_f32 v150,s40,v150,v234
v_accvgpr_read_b32 v234,a55
M v[104:107],v[216:219],a[212:215],v[104:107]
buffer_load_dwordx4 a[144:147],v247,s[20:23],s47 offen offset:2048 sc1
M v[108:111],v[216:219],a[216:219],v[108:111]
v_accvgpr_read_b32 v233,a151
v_add_f32 v232,v234,v233
M v[112:115],v[216:219],a[220:223],v[112:115]
s_add_u32 s47,s80,3072
v_sub_f32 v234,v234,v233
v_add_f32 v233,v55,v151
M v[116:119],v[216:219],a[192:195],v[116:119]
v_sub_f32 v151,v55,v151
v_add_f32 v55,v232,v233
M v[120:123],v[216:219],a[196:199],v[120:123]
s_waitcnt lgkmcnt(1)
v_fmac_f32 v232,4.0,v233
v_fma_f32 v233,2.0,v151,v234
M v[124:127],v[216:219],a[200:203],v[124:127]
s_waitcnt vmcnt(23)
v_fma_f32 v151,s40,v151,v234
v_cvt_pk_bf16_f32 v229,v229,v233
M v[96:99],v[220:223],a[208:211],v[96:99]
ds_read_b128 a[208:211],v245 offset:17408
v_cvt_pk_bf16_f32 v231,v231,v232
M v[100:103],v[220:223],a[212:215],v[100:103]
ds_read_b128 a[212:215],v246 offset:17664
ds_write2st64_b64 v249,v[228:229],v[230:231] offset0:93 offset1:97
M v[104:107],v[220:223],a[216:219],v[104:107]
buffer_load_dwordx4 a[128:131],v247,s[20:23],s47 offen offset:0 sc1
M v[108:111],v[220:223],a[220:223],v[108:111]
ds_read_b128 a[216:219],v246 offset:17920
ds_read_b128 a[220:223],v246 offset:18176
M v[112:115],v[220:223],a[192:195],v[112:115]
ds_read_b128 a[192:195],v246 offset:18432
v_accvgpr_read_b32 v234,a56
M v[116:119],v[220:223],a[196:199],v[116:119]
ds_read_b128 a[196:199],v246 offset:18688
v_accvgpr_read_b32 v228,a152
M v[120:123],v[220:223],a[200:203],v[120:123]
s_waitcnt lgkmcnt(7)
ds_read_b128 a[200:203],v246 offset:18944
v_add_f32 v230,v234,v228
M v[124:127],v[220:223],a[204:207],v[124:127]
s_waitcnt vmcnt(23) lgkmcnt(7)
ds_read_b128 a[204:207],v246 offset:19200
v_sub_f32 v234,v234,v228
M v[96:99],a[132:135],a[208:211],v[96:99]
s_waitcnt lgkmcnt(7)
ds_read_b128 a[208:211],v246 offset:19456
v_add_f32 v228,v56,v152
M v[100:103],a[132:135],a[212:215],v[100:103]
s_waitcnt lgkmcnt(6)
v_sub_f32 v152,v56,v152
M v[104:107],a[132:135],a[216:219],v[104:107]
s_waitcnt lgkmcnt(5)
s_barrier
ds_read_b128 v[0:3],v247 offset:8704
M v[108:111],a[132:135],a[220:223],v[108:111]
s_waitcnt lgkmcnt(5)
ds_read_b128 v[8:11],v247 offset:12800
ds_read_b128 v[16:19],v247 offset:34816
M v[112:115],a[132:135],a[192:195],v[112:115]
s_waitcnt lgkmcnt(6)
ds_read_b128 v[24:27],v247 offset:38912
ds_read_b128 a[48:51],v247 offset:43520
M v[116:119],a[132:135],a[196:199],v[116:119]
s_waitcnt lgkmcnt(7)
ds_read_b128 a[52:55],v247 offset:47616
v_add_f32 v56,v230,v228
M v[120:123],a[132:135],a[200:203],v[120:123]
s_waitcnt lgkmcnt(7)
buffer_load_dwordx4 a[252:255],v247,s[20:23],s47 offen offset:1024 sc1
M v[124:127],a[132:135],a[204:207],v[124:127]
s_waitcnt vmcnt(23)
s_add_u32 s34,s33,6291456
v_fmac_f32 v230,4.0,v228
v_fma_f32 v228,2.0,v152,v234
M v[96:99],a[100:103],a[212:215],v[96:99]
s_waitcnt lgkmcnt(5)
buffer_store_dwordx4 v[0:3],v248,s[24:27],s34 offen offset:0 nt
M v[100:103],a[100:103],a[216:219],v[100:103]
s_nop 0
s_add_u32 s34,s33,6684672
ds_read_b128 a[212:215],v245 offset:19712
v_fma_f32 v152,s40,v152,v234
M v[104:107],a[100:103],a[220:223],v[104:107]
v_accvgpr_read_b32 v234,a57
v_accvgpr_read_b32 v233,a153
M v[108:111],a[100:103],a[192:195],v[108:111]
s_waitcnt lgkmcnt(5)
buffer_store_dwordx4 v[8:11],v248,s[24:27],s34 offen offset:0 nt
M v[112:115],a[100:103],a[196:199],v[112:115]
s_nop 0
s_add_u32 s34,s33,7077888
v_add_f32 v232,v234,v233
v_sub_f32 v234,v234,v233
M v[116:119],a[100:103],a[200:203],v[116:119]
v_add_u32 v245,0xfffece00,v245
v_add_u32 v246,0xfffece00,v246
M v[120:123],a[100:103],a[204:207],v[120:123]
s_waitcnt lgkmcnt(4)
buffer_store_dwordx4 v[16:19],v248,s[24:27],s34 offen offset:0 nt
M v[124:127],a[100:103],a[208:211],v[124:127]
s_waitcnt vmcnt(25)
s_add_u32 s34,s33,7471104
v_add_f32 v233,v57,v153
v_sub_f32 v153,v57,v153
M v[96:99],v[224:227],a[216:219],v[96:99]
ds_read_b128 a[216:219],v245 offset:26112
v_add_f32 v57,v232,v233
M v[100:103],v[224:227],a[220:223],v[100:103]
s_waitcnt lgkmcnt(4)
buffer_store_dwordx4 v[24:27],v248,s[24:27],s34 offen offset:0 nt
M v[104:107],v[224:227],a[192:195],v[104:107]
s_nop 0
s_add_u32 s34,s32,7077888
ds_read_b128 a[220:223],v246 offset:26368
ds_read_b128 a[192:195],v246 offset:26624
M v[108:111],v[224:227],a[196:199],v[108:111]
ds_read_b128 a[196:199],v246 offset:26880
v_fmac_f32 v232,4.0,v233
M v[112:115],v[224:227],a[200:203],v[112:115]
s_waitcnt lgkmcnt(6)
buffer_store_dwordx4 a[48:51],v248,s[24:27],s34 offen offset:512 nt
M v[116:119],v[224:227],a[204:207],v[116:119]
s_nop 0
s_add_u32 s34,s32,7274496
ds_read_b128 a[200:203],v246 offset:27136
ds_read_b128 a[204:207],v246 offset:27392
M v[120:123],v[224:227],a[208:211],v[120:123]
s_waitcnt lgkmcnt(6)
ds_read_b128 a[208:211],v246 offset:27648
v_fma_f32 v233,2.0,v153,v234
M v[124:127],v[224:227],a[212:215],v[124:127]
s_waitcnt vmcnt(26) lgkmcnt(6)
buffer_store_dwordx4 a[52:55],v248,s[24:27],s34 offen offset:512 nt
M v[96:99],a[116:119],a[216:219],v[96:99]
s_waitcnt lgkmcnt(5)
ds_read_b128 a[212:215],v246 offset:27904
ds_read_b128 a[216:219],v246 offset:28160
M v[100:103],a[116:119],a[220:223],v[100:103]
s_waitcnt lgkmcnt(6)
v_fma_f32 v153,s40,v153,v234
v_cvt_pk_bf16_f32 v228,v228,v233
M v[104:107],a[116:119],a[192:195],v[104:107]
s_waitcnt lgkmcnt(5)
buffer_load_dwordx4 a[224:227],v247,s[20:23],s47 offen offset:2048 sc1
M v[108:111],a[116:119],a[196:199],v[108:111]
s_waitcnt lgkmcnt(4)
s_add_u32 s47,s81,3072
v_cvt_pk_bf16_f32 v230,v230,v232
v_accvgpr_read_b32 v234,a58
M v[112:115],a[116:119],a[200:203],v[112:115]
s_waitcnt lgkmcnt(3)
v_accvgpr_read_b32 v229,a154
v_add_f32 v231,v234,v229
M v[116:119],a[116:119],a[204:207],v[116:119]
s_waitcnt lgkmcnt(2)
v_sub_f32 v234,v234,v229
v_add_f32 v229,v58,v154
M v[120:123],a[116:119],a[208:211],v[120:123]
s_waitcnt lgkmcnt(1)
buffer_load_dwordx4 a[112:115],v247,s[20:23],s47 offen offset:0 sc1
M v[124:127],a[116:119],a[212:215],v[124:127]
s_waitcnt vmcnt(28)
v_sub_f32 v154,v58,v154
v_add_f32 v58,v231,v229
M v[96:99],a[228:231],a[220:223],v[96:99]
ds_read_b128 a[220:223],v245 offset:28416
v_fmac_f32 v231,4.0,v229
M v[100:103],a[228:231],a[192:195],v[100:103]
v_fma_f32 v229,2.0,v154,v234
v_fma_f32 v154,s40,v154,v234
M v[104:107],a[228:231],a[196:199],v[104:107]
buffer_load_dwordx4 a[148:151],v247,s[20:23],s47 offen offset:1024 sc1
M v[108:111],a[228:231],a[200:203],v[108:111]
v_accvgpr_read_b32 v234,a59
v_accvgpr_read_b32 v233,a155
M v[112:115],a[228:231],a[204:207],v[112:115]
v_add_f32 v232,v234,v233
v_sub_f32 v234,v234,v233
M v[116:119],a[228:231],a[208:211],v[116:119]
v_add_f32 v233,v59,v155
v_sub_f32 v155,v59,v155
M v[120:123],a[228:231],a[212:215],v[120:123]
s_waitcnt lgkmcnt(1)
buffer_load_dwordx4 v[216:219],v247,s[20:23],s47 offen offset:2048 sc1
M v[124:127],a[228:231],a[216:219],v[124:127]
s_waitcnt vmcnt(29)
s_add_u32 s47,s76,49152
v_add_f32 v59,v232,v233
v_fmac_f32 v232,4.0,v233
M v[96:99],a[136:139],a[192:195],v[96:99]
ds_read_b128 a[192:195],v245 offset:0
v_fma_f32 v233,2.0,v155,v234
M v[100:103],a[136:139],a[196:199],v[100:103]
ds_read_b128 a[196:199],v246 offset:256
v_fma_f32 v155,s40,v155,v234
M v[104:107],a[136:139],a[200:203],v[104:107]
buffer_load_dwordx4 v[220:223],v247,s[20:23],s47 offen offset:0 sc1
M v[108:111],a[136:139],a[204:207],v[108:111]
ds_read_b128 a[200:203],v246 offset:512
ds_read_b128 a[204:207],v246 offset:768
M v[112:115],a[136:139],a[208:211],v[112:115]
ds_read_b128 a[208:211],v246 offset:1024
v_cvt_pk_bf16_f32 v229,v229,v233
M v[116:119],a[136:139],a[212:215],v[116:119]
ds_read_b128 a[212:215],v246 offset:1280
v_cvt_pk_bf16_f32 v231,v231,v232
M v[120:123],a[136:139],a[216:219],v[120:123]
s_waitcnt lgkmcnt(6)
ds_read_b128 a[216:219],v246 offset:1536
ds_write2st64_b64 v249,v[228:229],v[230:231] offset0:34 offset1:38
M v[124:127],a[136:139],a[220:223],v[124:127]
s_waitcnt vmcnt(29) lgkmcnt(7)
ds_read_b128 a[220:223],v246 offset:1792
v_accvgpr_read_b32 v204,a60
M v[32:35],a[232:235],a[192:195],v[32:35]
s_waitcnt lgkmcnt(7)
ds_read_b128 a[192:195],v246 offset:2048
v_accvgpr_read_b32 v208,a156
M v[36:39],a[232:235],a[196:199],v[36:39]
s_waitcnt lgkmcnt(7)
v_accvgpr_read_b32 v205,a61
v_accvgpr_read_b32 v209,a157
M v[40:43],a[232:235],a[200:203],v[40:43]
s_waitcnt lgkmcnt(6)
buffer_load_dwordx4 a[132:135],v247,s[20:23],s47 offen offset:1024 sc1
M v[44:47],a[232:235],a[204:207],v[44:47]
s_waitcnt lgkmcnt(5)
v_accvgpr_read_b32 v206,a62
v_accvgpr_read_b32 v210,a158
v_accvgpr_read_b32 v207,a63
v_accvgpr_read_b32 v211,a159
v_pk_add_f32 v[212:213],v[204:205],v[208:209]
v_pk_add_f32 v[214:215],v[206:207],v[210:211]
v_pk_add_f32 v[204:205],v[204:205],v[208:209] neg_lo:[0,1] neg_hi:[0,1]
v_pk_add_f32 v[206:207],v[206:207],v[210:211] neg_lo:[0,1] neg_hi:[0,1]
v_pk_add_f32 v[208:209],v[60:61],v[156:157]
v_pk_add_f32 v[210:211],v[62:63],v[158:159]
v_pk_add_f32 v[156:157],v[60:61],v[156:157] neg_lo:[0,1] neg_hi:[0,1]
v_pk_add_f32 v[158:159],v[62:63],v[158:159] neg_lo:[0,1] neg_hi:[0,1]
v_pk_add_f32 v[60:61],v[212:213],v[208:209]
v_pk_add_f32 v[62:63],v[214:215],v[210:211]
v_pk_fma_f32 v[212:213],v[208:209],4.0,v[212:213] op_sel_hi:[1,0,1]
v_pk_fma_f32 v[214:215],v[210:211],4.0,v[214:215] op_sel_hi:[1,0,1]
v_pk_fma_f32 v[208:209],v[156:157],2.0,v[204:205] op_sel_hi:[1,0,1]
v_pk_fma_f32 v[210:211],v[158:159],2.0,v[206:207] op_sel_hi:[1,0,1]
v_pk_fma_f32 v[156:157],v[156:157],s[40:41],v[204:205] op_sel_hi:[1,0,1]
v_pk_fma_f32 v[158:159],v[158:159],s[40:41],v[206:207] op_sel_hi:[1,0,1]
M v[48:51],a[232:235],a[208:211],v[48:51]
s_waitcnt lgkmcnt(4)
v_cvt_pk_bf16_f32 v208,v208,v209
v_cvt_pk_bf16_f32 v209,v210,v211
M v[52:55],a[232:235],a[212:215],v[52:55]
s_waitcnt lgkmcnt(3)
v_cvt_pk_bf16_f32 v212,v212,v213
v_cvt_pk_bf16_f32 v213,v214,v215
M v[56:59],a[232:235],a[216:219],v[56:59]
s_waitcnt lgkmcnt(1)
ds_write2st64_b64 v249,v[208:209],v[212:213] offset0:42 offset1:46
M v[60:63],a[232:235],a[220:223],v[60:63]
s_waitcnt vmcnt(29)
v_cvt_pk_bf16_f32 v96,v96,v97
v_cvt_pk_bf16_f32 v97,v98,v99
M v[32:35],a[236:239],a[196:199],v[32:35]
ds_read_b128 a[196:199],v245 offset:2304
v_cvt_pk_bf16_f32 v100,v100,v101
M v[36:39],a[236:239],a[200:203],v[36:39]
v_cvt_pk_bf16_f32 v101,v102,v103
M v[40:43],a[236:239],a[204:207],v[40:43]
buffer_load_dwordx4 a[100:103],v247,s[20:23],s47 offen offset:2048 sc1
M v[44:47],a[236:239],a[208:211],v[44:47]
ds_write2st64_b64 v249,v[96:97],v[100:101] offset0:51 offset1:55
M v[48:51],a[236:239],a[212:215],v[48:51]
s_add_u32 s47,s77,49152
v_cvt_pk_bf16_f32 v104,v104,v105
v_cvt_pk_bf16_f32 v105,v106,v107
M v[52:55],a[236:239],a[216:219],v[52:55]
v_cvt_pk_bf16_f32 v108,v108,v109
v_cvt_pk_bf16_f32 v109,v110,v111
M v[56:59],a[236:239],a[220:223],v[56:59]
s_waitcnt lgkmcnt(3)
ds_write2st64_b64 v249,v[104:105],v[108:109] offset0:59 offset1:63
M v[60:63],a[236:239],a[192:195],v[60:63]
s_waitcnt vmcnt(24)
v_cvt_pk_bf16_f32 v112,v112,v113
v_cvt_pk_bf16_f32 v113,v114,v115
M v[32:35],a[140:143],a[200:203],v[32:35]
ds_read_b128 a[200:203],v245 offset:34816
v_cvt_pk_bf16_f32 v116,v116,v117
M v[36:39],a[140:143],a[204:207],v[36:39]
ds_read_b128 a[204:207],v246 offset:35072
v_cvt_pk_bf16_f32 v117,v118,v119
M v[40:43],a[140:143],a[208:211],v[40:43]
buffer_load_dwordx4 v[224:227],v247,s[20:23],s47 offen offset:0 sc1
M v[44:47],a[140:143],a[212:215],v[44:47]
ds_read_b128 a[208:211],v246 offset:35328
ds_read_b128 a[212:215],v246 offset:35584
M v[48:51],a[140:143],a[216:219],v[48:51]
ds_read_b128 a[216:219],v246 offset:35840
ds_write2st64_b64 v249,v[112:113],v[116:117] offset0:0 offset1:4
M v[52:55],a[140:143],a[220:223],v[52:55]
ds_read_b128 a[220:223],v246 offset:36096
v_cvt_pk_bf16_f32 v120,v120,v121
M v[56:59],a[140:143],a[192:195],v[56:59]
s_waitcnt lgkmcnt(9)
ds_read_b128 a[192:195],v246 offset:36352
v_cvt_pk_bf16_f32 v121,v122,v123
M v[60:63],a[140:143],a[196:199],v[60:63]
s_waitcnt vmcnt(24) lgkmcnt(7)
ds_read_b128 a[196:199],v246 offset:36608
v_cvt_pk_bf16_f32 v124,v124,v125
M v[32:35],a[104:107],a[200:203],v[32:35]
s_waitcnt lgkmcnt(7)
ds_read_b128 a[200:203],v246 offset:36864
v_cvt_pk_bf16_f32 v125,v126,v127
M v[36:39],a[104:107],a[204:207],v[36:39]
s_waitcnt lgkmcnt(7)
ds_write2st64_b64 v249,v[120:121],v[124:125] offset0:8 offset1:12
M v[40:43],a[104:107],a[208:211],v[40:43]
s_waitcnt lgkmcnt(7)
buffer_load_dwordx4 a[116:119],v247,s[20:23],s47 offen offset:1024 sc1
M v[44:47],a[104:107],a[212:215],v[44:47]
s_waitcnt lgkmcnt(6)
v_accvgpr_read_b32 v234,a64
v_accvgpr_read_b32 v228,a160
M v[48:51],a[104:107],a[216:219],v[48:51]
s_waitcnt lgkmcnt(4)
v_add_f32 v230,v234,v228
v_sub_f32 v234,v234,v228
M v[52:55],a[104:107],a[220:223],v[52:55]
s_waitcnt lgkmcnt(3)
v_add_f32 v228,v64,v160
v_sub_f32 v160,v64,v160
M v[56:59],a[104:107],a[192:195],v[56:59]
s_waitcnt lgkmcnt(0)
s_barrier
ds_read_b128 a[56:59],v247 offset:17408
M v[60:63],a[104:107],a[196:199],v[60:63]
s_waitcnt vmcnt(24)
ds_read_b128 a[60:63],v247 offset:21504
ds_read_b128 v[96:99],v247 offset:26112
M v[32:35],a[120:123],a[204:207],v[32:35]
ds_read_b128 v[104:107],v247 offset:30208
ds_read_b128 v[112:115],v247 offset:0
M v[36:39],a[120:123],a[208:211],v[36:39]
ds_read_b128 v[120:123],v247 offset:4096
ds_read_b128 a[204:207],v245 offset:37120
M v[40:43],a[120:123],a[212:215],v[40:43]
buffer_load_dwordx4 a[152:155],v247,s[20:23],s47 offen offset:2048 sc1
M v[44:47],a[120:123],a[216:219],v[44:47]
s_add_u32 s34,s32,7471104
v_add_f32 v64,v230,v228
v_fmac_f32 v230,4.0,v228
M v[48:51],a[120:123],a[220:223],v[48:51]
s_waitcnt lgkmcnt(6)
s_add_u32 s47,s78,49152
buffer_store_dwordx4 a[56:59],v248,s[24:27],s34 offen offset:512 nt
M v[52:55],a[120:123],a[192:195],v[52:55]
s_nop 0
s_add_u32 s34,s32,7667712
v_fma_f32 v228,2.0,v160,v234
v_fma_f32 v160,s40,v160,v234
M v[56:59],a[120:123],a[196:199],v[56:59]
v_accvgpr_read_b32 v234,a65
v_accvgpr_read_b32 v233,a161
M v[60:63],a[120:123],a[200:203],v[60:63]
s_waitcnt vmcnt(25) lgkmcnt(5)
buffer_store_dwordx4 a[60:63],v248,s[24:27],s34 offen offset:512 nt
M v[32:35],a[124:127],a[208:211],v[32:35]
s_nop 0
s_add_u32 s34,s33,6291456
ds_read_b128 a[208:211],v245 offset:52224
v_add_f32 v232,v234,v233
M v[36:39],a[124:127],a[212:215],v[36:39]
ds_read_b128 a[212:215],v246 offset:52480
v_sub_f32 v234,v234,v233
M v[40:43],a[124:127],a[216:219],v[40:43]
s_waitcnt lgkmcnt(6)
buffer_store_dwordx4 v[96:99],v248,s[24:27],s34 offen offset:1152 nt
M v[44:47],a[124:127],a[220:223],v[44:47]
s_nop 0
s_add_u32 s34,s33,6684672
ds_read_b128 a[216:219],v246 offset:52736
ds_read_b128 a[220:223],v246 offset:52992
M v[48:51],a[124:127],a[192:195],v[48:51]
ds_read_b128 a[192:195],v246 offset:53248
v_add_f32 v233,v65,v161
M v[52:55],a[124:127],a[196:199],v[52:55]
s_waitcnt lgkmcnt(8)
buffer_store_dwordx4 v[104:107],v248,s[24:27],s34 offen offset:1152 nt
M v[56:59],a[124:127],a[200:203],v[56:59]
s_waitcnt lgkmcnt(5)
ds_read_b128 a[196:199],v246 offset:53504
ds_read_b128 a[200:203],v246 offset:53760
M v[60:63],a[124:127],a[204:207],v[60:63]
s_waitcnt vmcnt(27) lgkmcnt(6)
ds_read_b128 a[204:207],v246 offset:54016
v_sub_f32 v161,v65,v161
M v[32:35],a[240:243],a[208:211],v[32:35]
s_waitcnt lgkmcnt(6)
buffer_load_dwordx4 a[228:231],v247,s[20:23],s47 offen offset:0 sc1
M v[36:39],a[240:243],a[212:215],v[36:39]
s_waitcnt lgkmcnt(5)
ds_read_b128 a[208:211],v246 offset:54272
v_add_f32 v65,v232,v233
M v[40:43],a[240:243],a[216:219],v[40:43]
s_waitcnt lgkmcnt(5)
v_fmac_f32 v232,4.0,v233
v_fma_f32 v233,2.0,v161,v234
M v[44:47],a[240:243],a[220:223],v[44:47]
s_waitcnt lgkmcnt(4)
v_fma_f32 v161,s40,v161,v234
v_cvt_pk_bf16_f32 v228,v228,v233
M v[48:51],a[240:243],a[192:195],v[48:51]
s_waitcnt lgkmcnt(3)
buffer_load_dwordx4 a[136:139],v247,s[20:23],s47 offen offset:1024 sc1
M v[52:55],a[240:243],a[196:199],v[52:55]
s_waitcnt lgkmcnt(2)
v_cvt_pk_bf16_f32 v230,v230,v232
v_accvgpr_read_b32 v234,a66
M v[56:59],a[240:243],a[200:203],v[56:59]
s_waitcnt lgkmcnt(1)
v_accvgpr_read_b32 v229,a162
v_add_f32 v231,v234,v229
M v[60:63],a[240:243],a[204:207],v[60:63]
s_waitcnt vmcnt(28)
v_sub_f32 v234,v234,v229
v_add_f32 v229,v66,v162
M v[32:35],a[244:247],a[212:215],v[32:35]
ds_read_b128 a[212:215],v245 offset:54528
v_sub_f32 v162,v66,v162
M v[36:39],a[244:247],a[216:219],v[36:39]
v_add_f32 v66,v231,v229
v_fmac_f32 v231,4.0,v229
M v[40:43],a[244:247],a[220:223],v[40:43]
buffer_load_dwordx4 a[156:159],v247,s[20:23],s47 offen offset:2048 sc1
M v[44:47],a[244:247],a[192:195],v[44:47]
v_fma_f32 v229,2.0,v162,v234
v_fma_f32 v162,s40,v162,v234
M v[48:51],a[244:247],a[196:199],v[48:51]
s_add_u32 s47,s79,49152
s_add_u32 s34,s33,7077888
v_accvgpr_read_b32 v234,a67
M v[52:55],a[244:247],a[200:203],v[52:55]
buffer_store_dwordx4 v[112:115],v248,s[24:27],s34 offen offset:1152 nt
M v[56:59],a[244:247],a[204:207],v[56:59]
s_waitcnt lgkmcnt(1)
v_add_u32 v245,0x11000,v245
v_add_u32 v246,0x11000,v246
M v[60:63],a[244:247],a[208:211],v[60:63]
s_waitcnt vmcnt(29)
v_accvgpr_read_b32 v233,a163
v_add_f32 v232,v234,v233
M v[32:35],a[108:111],a[216:219],v[32:35]
ds_read_b128 a[216:219],v245 offset:0
v_sub_f32 v234,v234,v233
M v[36:39],a[108:111],a[220:223],v[36:39]
ds_read_b128 a[220:223],v246 offset:256
v_add_f32 v233,v67,v163
M v[40:43],a[108:111],a[192:195],v[40:43]
buffer_load_dwordx4 a[232:235],v247,s[20:23],s47 offen offset:0 sc1
M v[44:47],a[108:111],a[196:199],v[44:47]
ds_read_b128 a[192:195],v246 offset:512
ds_read_b128 a[196:199],v246 offset:768
M v[48:51],a[108:111],a[200:203],v[48:51]
ds_read_b128 a[200:203],v246 offset:1024
v_sub_f32 v163,v67,v163
M v[52:55],a[108:111],a[204:207],v[52:55]
ds_read_b128 a[204:207],v246 offset:1280
v_add_f32 v67,v232,v233
M v[56:59],a[108:111],a[208:211],v[56:59]
s_waitcnt lgkmcnt(6)
ds_read_b128 a[208:211],v246 offset:1536
v_fmac_f32 v232,4.0,v233
M v[60:63],a[108:111],a[212:215],v[60:63]
s_waitcnt vmcnt(29) lgkmcnt(6)
ds_read_b128 a[212:215],v246 offset:1792
v_fma_f32 v233,2.0,v163,v234
M v[32:35],a[248:251],a[216:219],v[32:35]
s_waitcnt lgkmcnt(6)
ds_read_b128 a[216:219],v246 offset:2048
v_fma_f32 v163,s40,v163,v234
M v[36:39],a[248:251],a[220:223],v[36:39]
s_waitcnt lgkmcnt(6)
v_cvt_pk_bf16_f32 v229,v229,v233
v_cvt_pk_bf16_f32 v231,v231,v232
M v[40:43],a[248:251],a[192:195],v[40:43]
s_waitcnt lgkmcnt(5)
buffer_load_dwordx4 a[236:239],v247,s[20:23],s47 offen offset:1024 sc1
M v[44:47],a[248:251],a[196:199],v[44:47]
s_waitcnt lgkmcnt(4)
ds_write2st64_b64 v249,v[228:229],v[230:231] offset0:17 offset1:21
M v[48:51],a[248:251],a[200:203],v[48:51]
s_waitcnt lgkmcnt(4)
v_accvgpr_read_b32 v234,a68
v_accvgpr_read_b32 v228,a164
M v[52:55],a[248:251],a[204:207],v[52:55]
s_waitcnt lgkmcnt(3)
v_add_f32 v230,v234,v228
v_sub_f32 v234,v234,v228
M v[56:59],a[248:251],a[208:211],v[56:59]
s_waitcnt lgkmcnt(2)
v_add_f32 v228,v68,v164
v_sub_f32 v164,v68,v164
M v[60:63],a[248:251],a[212:215],v[60:63]
s_waitcnt vmcnt(29)
v_add_f32 v68,v230,v228
v_fmac_f32 v230,4.0,v228
M v[32:35],a[96:99],a[220:223],v[32:35]
ds_read_b128 a[220:223],v245 offset:2304
v_fma_f32 v228,2.0,v164,v234
M v[36:39],a[96:99],a[192:195],v[36:39]
v_fma_f32 v164,s40,v164,v234
v_accvgpr_read_b32 v234,a69
M v[40:43],a[96:99],a[196:199],v[40:43]
s_add_u32 s34,s33,7471104
buffer_load_dwordx4 a[140:143],v247,s[20:23],s47 offen offset:2048 sc1
M v[44:47],a[96:99],a[200:203],v[44:47]
v_accvgpr_read_b32 v233,a165
v_add_f32 v232,v234,v233
M v[48:51],a[96:99],a[204:207],v[48:51]
s_add_u32 s47,s80,49152
buffer_store_dwordx4 v[120:123],v248,s[24:27],s34 offen offset:1152 nt
M v[52:55],a[96:99],a[208:211],v[52:55]
v_sub_f32 v234,v234,v233
v_add_f32 v233,v69,v165
M v[56:59],a[96:99],a[212:215],v[56:59]
s_waitcnt lgkmcnt(2)
v_sub_f32 v165,v69,v165
v_add_f32 v69,v232,v233
M v[60:63],a[96:99],a[216:219],v[60:63]
s_waitcnt vmcnt(30)
v_fmac_f32 v232,4.0,v233
v_fma_f32 v233,2.0,v165,v234
M v[32:35],a[144:147],a[192:195],v[32:35]
ds_read_b128 a[192:195],v245 offset:17408
v_fma_f32 v165,s40,v165,v234
M v[36:39],a[144:147],a[196:199],v[36:39]
ds_read_b128 a[196:199],v246 offset:17664
v_cvt_pk_bf16_f32 v228,v228,v233
M v[40:43],a[144:147],a[200:203],v[40:43]
buffer_load_dwordx4 a[104:107],v247,s[20:23],s47 offen offset:0 sc1
M v[44:47],a[144:147],a[204:207],v[44:47]
ds_read_b128 a[200:203],v246 offset:17920
ds_read_b128 a[204:207],v246 offset:18176
M v[48:51],a[144:147],a[208:211],v[48:51]
ds_read_b128 a[208:211],v246 offset:18432
v_cvt_pk_bf16_f32 v230,v230,v232
M v[52:55],a[144:147],a[212:215],v[52:55]
ds_read_b128 a[212:215],v246 offset:18688
v_accvgpr_read_b32 v234,a70
M v[56:59],a[144:147],a[216:219],v[56:59]
s_waitcnt lgkmcnt(6)
ds_read_b128 a[216:219],v246 offset:18944
v_accvgpr_read_b32 v229,a166
M v[60:63],a[144:147],a[220:223],v[60:63]
s_waitcnt vmcnt(30) lgkmcnt(6)
ds_read_b128 a[220:223],v246 offset:19200
v_add_f32 v231,v234,v229
M v[32:35],a[128:131],a[192:195],v[32:35]
s_waitcnt lgkmcnt(6)
ds_read_b128 a[192:195],v246 offset:19456
v_sub_f32 v234,v234,v229
M v[36:39],a[128:131],a[196:199],v[36:39]
s_waitcnt lgkmcnt(6)
v_add_f32 v229,v70,v166
v_sub_f32 v166,v70,v166
M v[40:43],a[128:131],a[200:203],v[40:43]
s_waitcnt lgkmcnt(5)
buffer_load_dwordx4 a[120:123],v247,s[20:23],s47 offen offset:1024 sc1
M v[44:47],a[128:131],a[204:207],v[44:47]
s_waitcnt lgkmcnt(4)
v_add_f32 v70,v231,v229
v_fmac_f32 v231,4.0,v229
M v[48:51],a[128:131],a[208:211],v[48:51]
s_waitcnt lgkmcnt(3)
v_fma_f32 v229,2.0,v166,v234
v_fma_f32 v166,s40,v166,v234
M v[52:55],a[128:131],a[212:215],v[52:55]
s_waitcnt lgkmcnt(2)
v_accvgpr_read_b32 v234,a71
v_accvgpr_read_b32 v233,a167
M v[56:59],a[128:131],a[216:219],v[56:59]
s_waitcnt lgkmcnt(1)
v_add_f32 v232,v234,v233
v_sub_f32 v234,v234,v233
M v[60:63],a[128:131],a[220:223],v[60:63]
s_waitcnt vmcnt(30)
v_add_f32 v233,v71,v167
v_sub_f32 v167,v71,v167
M v[32:35],a[252:255],a[196:199],v[32:35]
ds_read_b128 a[196:199],v245 offset:19712
v_add_f32 v71,v232,v233
M v[36:39],a[252:255],a[200:203],v[36:39]
v_fmac_f32 v232,4.0,v233
v_fma_f32 v233,2.0,v167,v234
M v[40:43],a[252:255],a[204:207],v[40:43]
buffer_load_dwordx4 a[124:127],v247,s[20:23],s47 offen offset:2048 sc1
M v[44:47],a[252:255],a[208:211],v[44:47]
v_fma_f32 v167,s40,v167,v234
v_cvt_pk_bf16_f32 v229,v229,v233
M v[48:51],a[252:255],a[212:215],v[48:51]
s_add_u32 s47,s81,49152
v_cvt_pk_bf16_f32 v231,v231,v232
M v[52:55],a[252:255],a[216:219],v[52:55]
ds_write2st64_b64 v249,v[228:229],v[230:231] offset0:25 offset1:29
M v[56:59],a[252:255],a[220:223],v[56:59]
s_waitcnt lgkmcnt(2)
v_add_u32 v245,0xffff1200,v245
v_add_u32 v246,0xffff1200,v246
M v[60:63],a[252:255],a[192:195],v[60:63]
s_waitcnt vmcnt(24)
v_accvgpr_read_b32 v234,a72
v_accvgpr_read_b32 v228,a168
M v[32:35],a[224:227],a[200:203],v[32:35]
ds_read_b128 a[200:203],v245 offset:8704
v_add_f32 v230,v234,v228
M v[36:39],a[224:227],a[204:207],v[36:39]
ds_read_b128 a[204:207],v246 offset:8960
v_sub_f32 v234,v234,v228
M v[40:43],a[224:227],a[208:211],v[40:43]
buffer_load_dwordx4 a[240:243],v247,s[20:23],s47 offen offset:0 sc1
M v[44:47],a[224:227],a[212:215],v[44:47]
ds_read_b128 a[208:211],v246 offset:9216
ds_read_b128 a[212:215],v246 offset:9472
M v[48:51],a[224:227],a[216:219],v[48:51]
ds_read_b128 a[216:219],v246 offset:9728
v_add_f32 v228,v72,v168
M v[52:55],a[224:227],a[220:223],v[52:55]
ds_read_b128 a[220:223],v246 offset:9984
v_sub_f32 v168,v72,v168
M v[56:59],a[224:227],a[192:195],v[56:59]
s_waitcnt lgkmcnt(7)
ds_read_b128 a[192:195],v246 offset:10240
v_add_f32 v72,v230,v228
M v[60:63],a[224:227],a[196:199],v[60:63]
s_waitcnt vmcnt(24) lgkmcnt(6)
ds_read_b128 a[196:199],v246 offset:10496
v_fmac_f32 v230,4.0,v228
M v[32:35],a[112:115],a[200:203],v[32:35]
s_waitcnt lgkmcnt(6)
ds_read_b128 a[200:203],v246 offset:10752
v_fma_f32 v228,2.0,v168,v234
M v[36:39],a[112:115],a[204:207],v[36:39]
s_waitcnt lgkmcnt(6)
v_fma_f32 v168,s40,v168,v234
v_accvgpr_read_b32 v234,a73
M v[40:43],a[112:115],a[208:211],v[40:43]
s_waitcnt lgkmcnt(5)
buffer_load_dwordx4 a[244:247],v247,s[20:23],s47 offen offset:1024 sc1
M v[44:47],a[112:115],a[212:215],v[44:47]
s_waitcnt lgkmcnt(4)
v_accvgpr_read_b32 v233,a169
v_add_f32 v232,v234,v233
M v[48:51],a[112:115],a[216:219],v[48:51]
s_waitcnt lgkmcnt(3)
v_sub_f32 v234,v234,v233
v_add_f32 v233,v73,v169
M v[52:55],a[112:115],a[220:223],v[52:55]
s_waitcnt lgkmcnt(2)
v_sub_f32 v169,v73,v169
v_add_f32 v73,v232,v233
M v[56:59],a[112:115],a[192:195],v[56:59]
s_waitcnt lgkmcnt(1)
v_fmac_f32 v232,4.0,v233
v_fma_f32 v233,2.0,v169,v234
M v[60:63],a[112:115],a[196:199],v[60:63]
s_waitcnt vmcnt(24)
v_fma_f32 v169,s40,v169,v234
v_cvt_pk_bf16_f32 v228,v228,v233
M v[32:35],a[148:151],a[204:207],v[32:35]
ds_read_b128 a[204:207],v245 offset:11008
v_cvt_pk_bf16_f32 v230,v230,v232
M v[36:39],a[148:151],a[208:211],v[36:39]
v_accvgpr_read_b32 v234,a74
v_accvgpr_read_b32 v229,a170
M v[40:43],a[148:151],a[212:215],v[40:43]
buffer_load_dwordx4 a[160:163],v247,s[20:23],s47 offen offset:2048 sc1
M v[44:47],a[148:151],a[216:219],v[44:47]
v_add_f32 v231,v234,v229
v_sub_f32 v234,v234,v229
M v[48:51],a[148:151],a[220:223],v[48:51]
s_add_u32 s48,s76,6144
v_add_f32 v229,v74,v170
v_sub_f32 v170,v74,v170
M v[52:55],a[148:151],a[192:195],v[52:55]
v_add_f32 v74,v231,v229
v_fmac_f32 v231,4.0,v229
M v[56:59],a[148:151],a[196:199],v[56:59]
s_waitcnt lgkmcnt(1)
v_fma_f32 v229,2.0,v170,v234
v_fma_f32 v170,s40,v170,v234
M v[60:63],a[148:151],a[200:203],v[60:63]
s_waitcnt vmcnt(24)
v_accvgpr_read_b32 v234,a75
v_accvgpr_read_b32 v233,a171
M v[32:35],v[216:219],a[208:211],v[32:35]
ds_read_b128 a[208:211],v245 offset:0
v_add_f32 v232,v234,v233
M v[36:39],v[216:219],a[212:215],v[36:39]
ds_read_b128 a[212:215],v246 offset:256
v_sub_f32 v234,v234,v233
M v[40:43],v[216:219],a[216:219],v[40:43]
buffer_load_dwordx4 a[108:111],v247,s[20:23],s48 offen offset:0 sc1
M v[44:47],v[216:219],a[220:223],v[44:47]
ds_read_b128 a[216:219],v246 offset:512
ds_read_b128 a[220:223],v246 offset:768
M v[48:51],v[216:219],a[192:195],v[48:51]
ds_read_b128 a[192:195],v246 offset:1024
v_add_f32 v233,v75,v171
M v[52:55],v[216:219],a[196:199],v[52:55]
ds_read_b128 a[196:199],v246 offset:1280
v_sub_f32 v171,v75,v171
M v[56:59],v[216:219],a[200:203],v[56:59]
s_waitcnt lgkmcnt(6)
ds_read_b128 a[200:203],v246 offset:1536
v_add_f32 v75,v232,v233
M v[60:63],v[216:219],a[204:207],v[60:63]
s_waitcnt vmcnt(24) lgkmcnt(6)
ds_read_b128 a[204:207],v246 offset:1792
v_fmac_f32 v232,4.0,v233
M v[128:131],v[220:223],a[208:211],v[128:131]
s_waitcnt lgkmcnt(6)
ds_read_b128 a[208:211],v246 offset:2048
v_fma_f32 v233,2.0,v171,v234
M v[132:135],v[220:223],a[212:215],v[132:135]
s_waitcnt lgkmcnt(6)
v_fma_f32 v171,s40,v171,v234
v_cvt_pk_bf16_f32 v229,v229,v233
M v[136:139],v[220:223],a[216:219],v[136:139]
s_waitcnt lgkmcnt(5)
buffer_load_dwordx4 a[248:251],v247,s[20:23],s48 offen offset:1024 sc1
M v[140:143],v[220:223],a[220:223],v[140:143]
s_waitcnt lgkmcnt(4)
v_cvt_pk_bf16_f32 v231,v231,v232
M v[144:147],v[220:223],a[192:195],v[144:147]
s_waitcnt lgkmcnt(3)
global_load_dword v251,v252,s[82:83]
M v[148:151],v[220:223],a[196:199],v[148:151]
s_waitcnt lgkmcnt(2)
ds_write2st64_b64 v249,v[228:229],v[230:231] offset0:68 offset1:72
M v[152:155],v[220:223],a[200:203],v[152:155]
s_waitcnt lgkmcnt(2)
v_accvgpr_read_b32 v204,a76
v_accvgpr_read_b32 v208,a172
M v[156:159],v[220:223],a[204:207],v[156:159]
s_waitcnt vmcnt(25)
v_accvgpr_read_b32 v205,a77
v_accvgpr_read_b32 v209,a173
M v[128:131],a[132:135],a[212:215],v[128:131]
ds_read_b128 a[212:215],v245 offset:2304
v_accvgpr_read_b32 v206,a78
M v[132:135],a[132:135],a[216:219],v[132:135]
v_accvgpr_read_b32 v210,a174
v_accvgpr_read_b32 v207,a79
v_accvgpr_read_b32 v211,a175
v_pk_add_f32 v[212:213],v[204:205],v[208:209]
v_pk_add_f32 v[214:215],v[206:207],v[210:211]
v_pk_add_f32 v[204:205],v[204:205],v[208:209] neg_lo:[0,1] neg_hi:[0,1]
v_pk_add_f32 v[206:207],v[206:207],v[210:211] neg_lo:[0,1] neg_hi:[0,1]
v_pk_add_f32 v[208:209],v[76:77],v[172:173]
v_pk_add_f32 v[210:211],v[78:79],v[174:175]
v_pk_add_f32 v[172:173],v[76:77],v[172:173] neg_lo:[0,1] neg_hi:[0,1]
v_pk_add_f32 v[174:175],v[78:79],v[174:175] neg_lo:[0,1] neg_hi:[0,1]
v_pk_add_f32 v[76:77],v[212:213],v[208:209]
v_pk_add_f32 v[78:79],v[214:215],v[210:211]
v_pk_fma_f32 v[212:213],v[208:209],4.0,v[212:213] op_sel_hi:[1,0,1]
v_pk_fma_f32 v[214:215],v[210:211],4.0,v[214:215] op_sel_hi:[1,0,1]
v_pk_fma_f32 v[208:209],v[172:173],2.0,v[204:205] op_sel_hi:[1,0,1]
v_pk_fma_f32 v[210:211],v[174:175],2.0,v[206:207] op_sel_hi:[1,0,1]
v_pk_fma_f32 v[172:173],v[172:173],s[40:41],v[204:205] op_sel_hi:[1,0,1]
v_pk_fma_f32 v[174:175],v[174:175],s[40:41],v[206:207] op_sel_hi:[1,0,1]
M v[136:139],a[132:135],a[220:223],v[136:139]
buffer_load_dwordx4 a[96:99],v247,s[20:23],s48 offen offset:2048 sc1
M v[140:143],a[132:135],a[192:195],v[140:143]
v_cvt_pk_bf16_f32 v208,v208,v209
v_cvt_pk_bf16_f32 v209,v210,v211
M v[144:147],a[132:135],a[196:199],v[144:147]
s_add_u32 s48,s77,6144
v_cvt_pk_bf16_f32 v212,v212,v213
v_cvt_pk_bf16_f32 v213,v214,v215
M v[148:151],a[132:135],a[200:203],v[148:151]
ds_write2st64_b64 v249,v[208:209],v[212:213] offset0:76 offset1:80
M v[152:155],a[132:135],a[204:207],v[152:155]
s_waitcnt lgkmcnt(3)
v_cvt_pk_bf16_f32 v32,v32,v33
v_cvt_pk_bf16_f32 v33,v34,v35
M v[156:159],a[132:135],a[208:211],v[156:159]
s_waitcnt vmcnt(25)
v_cvt_pk_bf16_f32 v36,v36,v37
v_cvt_pk_bf16_f32 v37,v38,v39
M v[128:131],a[100:103],a[216:219],v[128:131]
s_waitcnt lgkmcnt(0)
s_barrier
ds_read_b128 a[64:67],v247 offset:8704
M v[132:135],a[100:103],a[220:223],v[132:135]
ds_read_b128 a[68:71],v247 offset:12800
ds_read_b128 a[72:75],v247 offset:34816
M v[136:139],a[100:103],a[192:195],v[136:139]
ds_read_b128 a[76:79],v247 offset:38912
ds_read_b128 a[216:219],v245 offset:34816
M v[140:143],a[100:103],a[196:199],v[140:143]
buffer_load_dwordx4 a[144:147],v247,s[20:23],s48 offen offset:0 sc1
M v[144:147],a[100:103],a[200:203],v[144:147]
ds_read_b128 a[220:223],v246 offset:35072
ds_read_b128 a[192:195],v246 offset:35328
M v[148:151],a[100:103],a[204:207],v[148:151]
s_waitcnt lgkmcnt(6)
s_add_u32 s34,s32,6291456
buffer_store_dwordx4 a[64:67],v248,s[24:27],s34 offen offset:640 nt
M v[152:155],a[100:103],a[208:211],v[152:155]
s_nop 0
s_add_u32 s34,s32,6488064
ds_read_b128 a[196:199],v246 offset:35584
ds_read_b128 a[200:203],v246 offset:35840
M v[156:159],a[100:103],a[212:215],v[156:159]
s_waitcnt vmcnt(26) lgkmcnt(4)
ds_read_b128 a[204:207],v246 offset:36096
ds_read_b128 a[208:211],v246 offset:36352
M v[128:131],v[224:227],a[216:219],v[128:131]
s_waitcnt lgkmcnt(5)
buffer_store_dwordx4 a[68:71],v248,s[24:27],s34 offen offset:640 nt
M v[132:135],v[224:227],a[220:223],v[132:135]
s_waitcnt lgkmcnt(4)
s_add_u32 s34,s32,6684672
ds_read_b128 a[212:215],v246 offset:36608
ds_read_b128 a[216:219],v246 offset:36864
M v[136:139],v[224:227],a[192:195],v[136:139]
s_waitcnt lgkmcnt(5)
ds_write2st64_b64 v249,v[32:33],v[36:37] offset0:34 offset1:38
M v[140:143],v[224:227],a[196:199],v[140:143]
s_waitcnt lgkmcnt(5)
buffer_store_dwordx4 a[72:75],v248,s[24:27],s34 offen offset:640 nt
M v[144:147],v[224:227],a[200:203],v[144:147]
s_waitcnt lgkmcnt(4)
s_add_u32 s34,s32,6881280
v_cvt_pk_bf16_f32 v40,v40,v41
v_cvt_pk_bf16_f32 v41,v42,v43
M v[148:151],v[224:227],a[204:207],v[148:151]
s_waitcnt lgkmcnt(3)
v_cvt_pk_bf16_f32 v44,v44,v45
v_cvt_pk_bf16_f32 v45,v46,v47
M v[152:155],v[224:227],a[208:211],v[152:155]
s_waitcnt lgkmcnt(2)
buffer_load_dwordx4 a[164:167],v247,s[20:23],s48 offen offset:1024 sc1
M v[156:159],v[224:227],a[212:215],v[156:159]
s_waitcnt vmcnt(28)
ds_write2st64_b64 v249,v[40:41],v[44:45] offset0:42 offset1:46
M v[128:131],a[116:119],a[220:223],v[128:131]
ds_read_b128 a[220:223],v245 offset:37120
v_cvt_pk_bf16_f32 v48,v48,v49
M v[132:135],a[116:119],a[192:195],v[132:135]
buffer_store_dwordx4 a[76:79],v248,s[24:27],s34 offen offset:640 nt
M v[136:139],a[116:119],a[196:199],v[136:139]
v_cvt_pk_bf16_f32 v49,v50,v51
v_cvt_pk_bf16_f32 v52,v52,v53
M v[140:143],a[116:119],a[200:203],v[140:143]
v_cvt_pk_bf16_f32 v53,v54,v55
M v[144:147],a[116:119],a[204:207],v[144:147]
buffer_load_dwordx4 a[128:131],v247,s[20:23],s48 offen offset:2048 sc1
M v[148:151],a[116:119],a[208:211],v[148:151]
s_add_u32 s48,s78,6144
ds_write2st64_b64 v249,v[48:49],v[52:53] offset0:51 offset1:55
M v[152:155],a[116:119],a[212:215],v[152:155]
s_waitcnt lgkmcnt(4)
v_cvt_pk_bf16_f32 v56,v56,v57
v_cvt_pk_bf16_f32 v57,v58,v59
M v[156:159],a[116:119],a[216:219],v[156:159]
s_waitcnt vmcnt(29)
v_cvt_pk_bf16_f32 v60,v60,v61
v_cvt_pk_bf16_f32 v61,v62,v63
M v[128:131],a[152:155],a[192:195],v[128:131]
ds_read_b128 a[192:195],v245 offset:52224
ds_write2st64_b64 v249,v[56:57],v[60:61] offset0:59 offset1:63
M v[132:135],a[152:155],a[196:199],v[132:135]
ds_read_b128 a[196:199],v246 offset:52480
v_accvgpr_read_b32 v234,a80
M v[136:139],a[152:155],a[200:203],v[136:139]
buffer_load_dwordx4 a[252:255],v247,s[20:23],s48 offen offset:0 sc1
M v[140:143],a[152:155],a[204:207],v[140:143]
ds_read_b128 a[200:203],v246 offset:52736
ds_read_b128 a[204:207],v246 offset:52992
M v[144:147],a[152:155],a[208:211],v[144:147]
ds_read_b128 a[208:211],v246 offset:53248
v_accvgpr_read_b32 v228,a176
M v[148:151],a[152:155],a[212:215],v[148:151]
ds_read_b128 a[212:215],v246 offset:53504
v_add_f32 v230,v234,v228
M v[152:155],a[152:155],a[216:219],v[152:155]
s_waitcnt lgkmcnt(8)
ds_read_b128 a[216:219],v246 offset:53760
v_sub_f32 v234,v234,v228
M v[156:159],a[152:155],a[220:223],v[156:159]
s_waitcnt vmcnt(25) lgkmcnt(7)
ds_read_b128 a[220:223],v246 offset:54016
v_add_f32 v228,v80,v176
M v[128:131],a[228:231],a[192:195],v[128:131]
s_waitcnt lgkmcnt(6)
ds_read_b128 a[192:195],v246 offset:54272
v_sub_f32 v176,v80,v176
M v[132:135],a[228:231],a[196:199],v[132:135]
s_waitcnt lgkmcnt(6)
v_add_f32 v80,v230,v228
v_fmac_f32 v230,4.0,v228
M v[136:139],a[228:231],a[200:203],v[136:139]
s_waitcnt lgkmcnt(5)
buffer_load_dwordx4 a[224:227],v247,s[20:23],s48 offen offset:1024 sc1
M v[140:143],a[228:231],a[204:207],v[140:143]
s_waitcnt lgkmcnt(4)
v_fma_f32 v228,2.0,v176,v234
v_fma_f32 v176,s40,v176,v234
M v[144:147],a[228:231],a[208:211],v[144:147]
s_waitcnt lgkmcnt(3)
v_accvgpr_read_b32 v234,a81
v_accvgpr_read_b32 v233,a177
M v[148:151],a[228:231],a[212:215],v[148:151]
s_waitcnt lgkmcnt(2)
v_add_f32 v232,v234,v233
v_sub_f32 v234,v234,v233
M v[152:155],a[228:231],a[216:219],v[152:155]
s_waitcnt lgkmcnt(1)
v_add_f32 v233,v81,v177
v_sub_f32 v177,v81,v177
M v[156:159],a[228:231],a[220:223],v[156:159]
s_waitcnt vmcnt(25)
v_add_f32 v81,v232,v233
v_fmac_f32 v232,4.0,v233
M v[128:131],a[136:139],a[196:199],v[128:131]
ds_read_b128 a[196:199],v245 offset:54528
v_fma_f32 v233,2.0,v177,v234
M v[132:135],a[136:139],a[200:203],v[132:135]
v_fma_f32 v177,s40,v177,v234
v_cvt_pk_bf16_f32 v228,v228,v233
M v[136:139],a[136:139],a[204:207],v[136:139]
buffer_load_dwordx4 a[112:115],v247,s[20:23],s48 offen offset:2048 sc1
M v[140:143],a[136:139],a[208:211],v[140:143]
v_cvt_pk_bf16_f32 v230,v230,v232
v_accvgpr_read_b32 v234,a82
M v[144:147],a[136:139],a[212:215],v[144:147]
s_add_u32 s48,s79,6144
v_accvgpr_read_b32 v229,a178
v_add_f32 v231,v234,v229
M v[148:151],a[136:139],a[216:219],v[148:151]
v_add_u32 v245,0x11000,v245
v_add_u32 v246,0x11000,v246
M v[152:155],a[136:139],a[220:223],v[152:155]
s_waitcnt lgkmcnt(1)
v_sub_f32 v234,v234,v229
v_add_f32 v229,v82,v178
M v[156:159],a[136:139],a[192:195],v[156:159]
s_waitcnt vmcnt(25)
v_sub_f32 v178,v82,v178
v_add_f32 v82,v231,v229
M v[128:131],a[156:159],a[200:203],v[128:131]
ds_read_b128 a[200:203],v245 offset:0
v_fmac_f32 v231,4.0,v229
M v[132:135],a[156:159],a[204:207],v[132:135]
ds_read_b128 a[204:207],v246 offset:256
v_fma_f32 v229,2.0,v178,v234
M v[136:139],a[156:159],a[208:211],v[136:139]
buffer_load_dwordx4 a[148:151],v247,s[20:23],s48 offen offset:0 sc1
M v[140:143],a[156:159],a[212:215],v[140:143]
ds_read_b128 a[208:211],v246 offset:512
ds_read_b128 a[212:215],v246 offset:768
M v[144:147],a[156:159],a[216:219],v[144:147]
ds_read_b128 a[216:219],v246 offset:1024
v_fma_f32 v178,s40,v178,v234
M v[148:151],a[156:159],a[220:223],v[148:151]
ds_read_b128 a[220:223],v246 offset:1280
v_accvgpr_read_b32 v234,a83
M v[152:155],a[156:159],a[192:195],v[152:155]
s_waitcnt lgkmcnt(6)
ds_read_b128 a[192:195],v246 offset:1536
v_accvgpr_read_b32 v233,a179
M v[156:159],a[156:159],a[196:199],v[156:159]
s_waitcnt vmcnt(24) lgkmcnt(6)
ds_read_b128 a[196:199],v246 offset:1792
v_add_f32 v232,v234,v233
M v[128:131],a[232:235],a[200:203],v[128:131]
s_waitcnt lgkmcnt(6)
ds_read_b128 a[200:203],v246 offset:2048
v_sub_f32 v234,v234,v233
M v[132:135],a[232:235],a[204:207],v[132:135]
s_waitcnt lgkmcnt(6)
v_add_f32 v233,v83,v179
v_sub_f32 v179,v83,v179
M v[136:139],a[232:235],a[208:211],v[136:139]
s_waitcnt lgkmcnt(5)
buffer_load_dwordx4 a[168:171],v247,s[20:23],s48 offen offset:1024 sc1
M v[140:143],a[232:235],a[212:215],v[140:143]
s_waitcnt lgkmcnt(4)
v_add_f32 v83,v232,v233
v_fmac_f32 v232,4.0,v233
M v[144:147],a[232:235],a[216:219],v[144:147]
s_waitcnt lgkmcnt(3)
v_fma_f32 v233,2.0,v179,v234
v_fma_f32 v179,s40,v179,v234
M v[148:151],a[232:235],a[220:223],v[148:151]
s_waitcnt lgkmcnt(2)
v_cvt_pk_bf16_f32 v229,v229,v233
v_cvt_pk_bf16_f32 v231,v231,v232
M v[152:155],a[232:235],a[192:195],v[152:155]
s_waitcnt lgkmcnt(1)
ds_write2st64_b64 v249,v[228:229],v[230:231] offset0:0 offset1:4
M v[156:159],a[232:235],a[196:199],v[156:159]
s_waitcnt vmcnt(24)
v_accvgpr_read_b32 v234,a84
v_accvgpr_read_b32 v228,a180
M v[128:131],a[236:239],a[204:207],v[128:131]
ds_read_b128 a[204:207],v245 offset:2304
v_add_f32 v230,v234,v228
M v[132:135],a[236:239],a[208:211],v[132:135]
v_sub_f32 v234,v234,v228
v_add_f32 v228,v84,v180
M v[136:139],a[236:239],a[212:215],v[136:139]
buffer_load_dwordx4 v[216:219],v247,s[20:23],s48 offen offset:2048 sc1
M v[140:143],a[236:239],a[216:219],v[140:143]
v_sub_f32 v180,v84,v180
v_add_f32 v84,v230,v228
M v[144:147],a[236:239],a[220:223],v[144:147]
s_add_u32 s48,s80,6144
v_fmac_f32 v230,4.0,v228
v_fma_f32 v228,2.0,v180,v234
M v[148:151],a[236:239],a[192:195],v[148:151]
v_fma_f32 v180,s40,v180,v234
v_accvgpr_read_b32 v234,a85
M v[152:155],a[236:239],a[196:199],v[152:155]
s_waitcnt lgkmcnt(2)
v_accvgpr_read_b32 v233,a181
v_add_f32 v232,v234,v233
M v[156:159],a[236:239],a[200:203],v[156:159]
s_waitcnt vmcnt(24)
v_sub_f32 v234,v234,v233
v_add_f32 v233,v85,v181
M v[128:131],a[140:143],a[208:211],v[128:131]
ds_read_b128 a[208:211],v245 offset:17408
v_sub_f32 v181,v85,v181
M v[132:135],a[140:143],a[212:215],v[132:135]
ds_read_b128 a[212:215],v246 offset:17664
v_add_f32 v85,v232,v233
M v[136:139],a[140:143],a[216:219],v[136:139]
buffer_load_dwordx4 v[220:223],v247,s[20:23],s48 offen offset:0 sc1
M v[140:143],a[140:143],a[220:223],v[140:143]
ds_read_b128 a[216:219],v246 offset:17920
ds_read_b128 a[220:223],v246 offset:18176
M v[144:147],a[140:143],a[192:195],v[144:147]
ds_read_b128 a[192:195],v246 offset:18432
v_fmac_f32 v232,4.0,v233
M v[148:151],a[140:143],a[196:199],v[148:151]
ds_read_b128 a[196:199],v246 offset:18688
v_fma_f32 v233,2.0,v181,v234
M v[152:155],a[140:143],a[200:203],v[152:155]
s_waitcnt lgkmcnt(6)
ds_read_b128 a[200:203],v246 offset:18944
v_fma_f32 v181,s40,v181,v234
M v[156:159],a[140:143],a[204:207],v[156:159]
s_waitcnt vmcnt(23) lgkmcnt(6)
ds_read_b128 a[204:207],v246 offset:19200
v_cvt_pk_bf16_f32 v228,v228,v233
M v[128:131],a[104:107],a[208:211],v[128:131]
s_waitcnt lgkmcnt(6)
ds_read_b128 a[208:211],v246 offset:19456
v_cvt_pk_bf16_f32 v230,v230,v232
M v[132:135],a[104:107],a[212:215],v[132:135]
s_waitcnt lgkmcnt(6)
v_accvgpr_read_b32 v234,a86
v_accvgpr_read_b32 v229,a182
M v[136:139],a[104:107],a[216:219],v[136:139]
s_waitcnt lgkmcnt(5)
buffer_load_dwordx4 a[172:175],v247,s[20:23],s48 offen offset:1024 sc1
M v[140:143],a[104:107],a[220:223],v[140:143]
s_waitcnt lgkmcnt(4)
v_add_f32 v231,v234,v229
v_sub_f32 v234,v234,v229
M v[144:147],a[104:107],a[192:195],v[144:147]
s_waitcnt lgkmcnt(3)
v_add_f32 v229,v86,v182
v_sub_f32 v182,v86,v182
M v[148:151],a[104:107],a[196:199],v[148:151]
s_waitcnt lgkmcnt(2)
v_add_f32 v86,v231,v229
v_fmac_f32 v231,4.0,v229
M v[152:155],a[104:107],a[200:203],v[152:155]
s_waitcnt lgkmcnt(1)
v_fma_f32 v229,2.0,v182,v234
v_fma_f32 v182,s40,v182,v234
M v[156:159],a[104:107],a[204:207],v[156:159]
s_waitcnt vmcnt(23)
v_accvgpr_read_b32 v234,a87
v_accvgpr_read_b32 v233,a183
M v[128:131],a[120:123],a[212:215],v[128:131]
ds_read_b128 a[212:215],v245 offset:19712
v_add_f32 v232,v234,v233
M v[132:135],a[120:123],a[216:219],v[132:135]
v_sub_f32 v234,v234,v233
v_add_f32 v233,v87,v183
M v[136:139],a[120:123],a[220:223],v[136:139]
buffer_load_dwordx4 a[132:135],v247,s[20:23],s48 offen offset:2048 sc1
M v[140:143],a[120:123],a[192:195],v[140:143]
v_sub_f32 v183,v87,v183
v_add_f32 v87,v232,v233
M v[144:147],a[120:123],a[196:199],v[144:147]
s_add_u32 s48,s81,6144
v_fmac_f32 v232,4.0,v233
v_fma_f32 v233,2.0,v183,v234
M v[148:151],a[120:123],a[200:203],v[148:151]
v_add_u32 v245,0xfffece00,v245
v_add_u32 v246,0xfffece00,v246
M v[152:155],a[120:123],a[204:207],v[152:155]
s_waitcnt lgkmcnt(1)
v_fma_f32 v183,s40,v183,v234
v_cvt_pk_bf16_f32 v229,v229,v233
M v[156:159],a[120:123],a[208:211],v[156:159]
s_waitcnt vmcnt(23)
v_cvt_pk_bf16_f32 v231,v231,v232
M v[128:131],a[124:127],a[216:219],v[128:131]
ds_read_b128 a[216:219],v245 offset:26112
ds_write2st64_b64 v249,v[228:229],v[230:231] offset0:8 offset1:12
M v[132:135],a[124:127],a[220:223],v[132:135]
ds_read_b128 a[220:223],v246 offset:26368
v_accvgpr_read_b32 v234,a88
M v[136:139],a[124:127],a[192:195],v[136:139]
buffer_load_dwordx4 a[100:103],v247,s[20:23],s48 offen offset:0 sc1
M v[140:143],a[124:127],a[196:199],v[140:143]
ds_read_b128 a[192:195],v246 offset:26624
ds_read_b128 a[196:199],v246 offset:26880
M v[144:147],a[124:127],a[200:203],v[144:147]
ds_read_b128 a[200:203],v246 offset:27136
v_accvgpr_read_b32 v228,a184
M v[148:151],a[124:127],a[204:207],v[148:151]
ds_read_b128 a[204:207],v246 offset:27392
v_add_f32 v230,v234,v228
M v[152:155],a[124:127],a[208:211],v[152:155]
s_waitcnt lgkmcnt(7)
ds_read_b128 a[208:211],v246 offset:27648
v_sub_f32 v234,v234,v228
M v[156:159],a[124:127],a[212:215],v[156:159]
s_waitcnt vmcnt(23) lgkmcnt(7)
ds_read_b128 a[212:215],v246 offset:27904
v_add_f32 v228,v88,v184
M v[128:131],a[240:243],a[216:219],v[128:131]
s_waitcnt lgkmcnt(6)
ds_read_b128 a[216:219],v246 offset:28160
v_sub_f32 v184,v88,v184
M v[132:135],a[240:243],a[220:223],v[132:135]
s_waitcnt lgkmcnt(6)
s_barrier
ds_read_b128 v[32:35],v247 offset:17408
M v[136:139],a[240:243],a[192:195],v[136:139]
s_waitcnt lgkmcnt(6)
ds_read_b128 v[40:43],v247 offset:21504
ds_read_b128 v[48:51],v247 offset:26112
M v[140:143],a[240:243],a[196:199],v[140:143]
s_waitcnt lgkmcnt(7)
ds_read_b128 v[56:59],v247 offset:30208
ds_read_b128 a[80:83],v247 offset:0
M v[144:147],a[240:243],a[200:203],v[144:147]
s_waitcnt lgkmcnt(8)
ds_read_b128 a[84:87],v247 offset:4096
v_add_f32 v88,v230,v228
M v[148:151],a[240:243],a[204:207],v[148:151]
s_waitcnt lgkmcnt(8)
buffer_load_dwordx4 v[224:227],v247,s[20:23],s48 offen offset:1024 sc1
M v[152:155],a[240:243],a[208:211],v[152:155]
s_waitcnt lgkmcnt(7)
s_add_u32 s34,s33,6291456
v_fmac_f32 v230,4.0,v228
v_fma_f32 v228,2.0,v184,v234
M v[156:159],a[240:243],a[212:215],v[156:159]
s_waitcnt vmcnt(23) lgkmcnt(5)
buffer_store_dwordx4 v[32:35],v248,s[24:27],s34 offen offset:128 nt
M v[128:131],a[244:247],a[220:223],v[128:131]
s_nop 0
s_add_u32 s34,s33,6684672
ds_read_b128 a[220:223],v245 offset:28416
v_fma_f32 v184,s40,v184,v234
M v[132:135],a[244:247],a[192:195],v[132:135]
v_accvgpr_read_b32 v234,a89
v_accvgpr_read_b32 v233,a185
M v[136:139],a[244:247],a[196:199],v[136:139]
s_waitcnt lgkmcnt(5)
buffer_store_dwordx4 v[40:43],v248,s[24:27],s34 offen offset:128 nt
M v[140:143],a[244:247],a[200:203],v[140:143]
s_nop 0
s_add_u32 s34,s33,7077888
v_add_f32 v232,v234,v233
v_sub_f32 v234,v234,v233
M v[144:147],a[244:247],a[204:207],v[144:147]
v_add_f32 v233,v89,v185
v_sub_f32 v185,v89,v185
M v[148:151],a[244:247],a[208:211],v[148:151]
s_waitcnt lgkmcnt(4)
buffer_store_dwordx4 v[48:51],v248,s[24:27],s34 offen offset:128 nt
M v[152:155],a[244:247],a[212:215],v[152:155]
s_nop 0
s_add_u32 s34,s33,7471104
v_add_f32 v89,v232,v233
v_fmac_f32 v232,4.0,v233
M v[156:159],a[244:247],a[216:219],v[156:159]
s_waitcnt vmcnt(25)
v_fma_f32 v233,2.0,v185,v234
v_fma_f32 v185,s40,v185,v234
M v[128:131],a[160:163],a[192:195],v[128:131]
s_waitcnt lgkmcnt(3)
buffer_store_dwordx4 v[56:59],v248,s[24:27],s34 offen offset:128 nt
M v[132:135],a[160:163],a[196:199],v[132:135]
s_nop 0
s_add_u32 s34,s32,7077888
ds_read_b128 a[192:195],v245 offset:0
ds_read_b128 a[196:199],v246 offset:256
M v[136:139],a[160:163],a[200:203],v[136:139]
ds_read_b128 a[200:203],v246 offset:512
v_cvt_pk_bf16_f32 v228,v228,v233
M v[140:143],a[160:163],a[204:207],v[140:143]
buffer_load_dwordx4 a[116:119],v247,s[20:23],s48 offen offset:2048 sc1
M v[144:147],a[160:163],a[208:211],v[144:147]
s_add_u32 s48,s76,52224
ds_read_b128 a[204:207],v246 offset:768
ds_read_b128 a[208:211],v246 offset:1024
v_cvt_pk_bf16_f32 v230,v230,v232
v_accvgpr_read_b32 v234,a90
v_accvgpr_read_b32 v229,a186
v_add_f32 v231,v234,v229
M v[148:151],a[160:163],a[212:215],v[148:151]
ds_read_b128 a[212:215],v246 offset:1280
v_sub_f32 v234,v234,v229
v_add_f32 v229,v90,v186
v_sub_f32 v186,v90,v186
v_add_f32 v90,v231,v229
M v[152:155],a[160:163],a[216:219],v[152:155]
s_waitcnt lgkmcnt(6)
buffer_store_dwordx4 a[80:83],v248,s[24:27],s34 offen offset:640 nt
v_fmac_f32 v231,4.0,v229
v_fma_f32 v229,2.0,v186,v234
v_fma_f32 v186,s40,v186,v234
v_accvgpr_read_b32 v234,a91
M v[156:159],a[160:163],a[220:223],v[156:159]
s_waitcnt vmcnt(27) lgkmcnt(5)
ds_read_b128 a[216:219],v246 offset:1536
ds_read_b128 a[220:223],v246 offset:1792
v_accvgpr_read_b32 v233,a187
v_add_f32 v232,v234,v233
v_sub_f32 v234,v234,v233
v_add_f32 v233,v91,v187
M v[64:67],a[108:111],a[192:195],v[64:67]
s_waitcnt lgkmcnt(6)
buffer_load_dwordx4 a[152:155],v247,s[20:23],s48 offen offset:0 sc1
v_sub_f32 v187,v91,v187
v_add_f32 v91,v232,v233
v_fmac_f32 v232,4.0,v233
v_fma_f32 v233,2.0,v187,v234
M v[68:71],a[108:111],a[196:199],v[68:71]
s_waitcnt lgkmcnt(5)
ds_read_b128 a[192:195],v246 offset:2048
v_fma_f32 v187,s40,v187,v234
v_cvt_pk_bf16_f32 v229,v229,v233
v_cvt_pk_bf16_f32 v231,v231,v232
M v[72:75],a[108:111],a[200:203],v[72:75]
s_waitcnt lgkmcnt(5)
ds_write2st64_b64 v249,v[228:229],v[230:231] offset0:17 offset1:21
M v[76:79],a[108:111],a[204:207],v[76:79]
s_waitcnt lgkmcnt(5)
buffer_load_dwordx4 a[228:231],v247,s[20:23],s48 offen offset:1024 sc1
v_accvgpr_read_b32 v204,a92
v_accvgpr_read_b32 v208,a188
M v[80:83],a[108:111],a[208:211],v[80:83]
s_waitcnt lgkmcnt(4)
v_accvgpr_read_b32 v205,a93
v_accvgpr_read_b32 v209,a189
v_accvgpr_read_b32 v206,a94
v_accvgpr_read_b32 v210,a190
v_accvgpr_read_b32 v207,a95
v_accvgpr_read_b32 v211,a191
v_pk_add_f32 v[212:213],v[204:205],v[208:209]
v_pk_add_f32 v[214:215],v[206:207],v[210:211]
v_pk_add_f32 v[204:205],v[204:205],v[208:209] neg_lo:[0,1] neg_hi:[0,1]
v_pk_add_f32 v[206:207],v[206:207],v[210:211] neg_lo:[0,1] neg_hi:[0,1]
v_pk_add_f32 v[208:209],v[92:93],v[188:189]
v_pk_add_f32 v[210:211],v[94:95],v[190:191]
v_pk_add_f32 v[188:189],v[92:93],v[188:189] neg_lo:[0,1] neg_hi:[0,1]
v_pk_add_f32 v[190:191],v[94:95],v[190:191] neg_lo:[0,1] neg_hi:[0,1]
v_pk_add_f32 v[92:93],v[212:213],v[208:209]
v_pk_add_f32 v[94:95],v[214:215],v[210:211]
v_pk_fma_f32 v[212:213],v[208:209],4.0,v[212:213] op_sel_hi:[1,0,1]
v_pk_fma_f32 v[214:215],v[210:211],4.0,v[214:215] op_sel_hi:[1,0,1]
v_pk_fma_f32 v[208:209],v[188:189],2.0,v[204:205] op_sel_hi:[1,0,1]
v_pk_fma_f32 v[210:211],v[190:191],2.0,v[206:207] op_sel_hi:[1,0,1]
v_pk_fma_f32 v[188:189],v[188:189],s[40:41],v[204:205] op_sel_hi:[1,0,1]
v_pk_fma_f32 v[190:191],v[190:191],s[40:41],v[206:207] op_sel_hi:[1,0,1]
M v[84:87],a[108:111],a[212:215],v[84:87]
s_waitcnt lgkmcnt(3)
v_cvt_pk_bf16_f32 v208,v208,v209
v_cvt_pk_bf16_f32 v209,v210,v211
M v[88:91],a[108:111],a[216:219],v[88:91]
s_waitcnt lgkmcnt(2)
v_cvt_pk_bf16_f32 v212,v212,v213
v_cvt_pk_bf16_f32 v213,v214,v215
M v[92:95],a[108:111],a[220:223],v[92:95]
s_waitcnt vmcnt(28)
ds_write2st64_b64 v249,v[208:209],v[212:213] offset0:25 offset1:29
M v[64:67],a[248:251],a[196:199],v[64:67]
ds_read_b128 a[196:199],v245 offset:2304
v_cvt_pk_bf16_f32 v128,v128,v129
M v[68:71],a[248:251],a[200:203],v[68:71]
v_cvt_pk_bf16_f32 v129,v130,v131
v_cvt_pk_bf16_f32 v132,v132,v133
M v[72:75],a[248:251],a[204:207],v[72:75]
buffer_load_dwordx4 a[136:139],v247,s[20:23],s48 offen offset:2048 sc1
M v[76:79],a[248:251],a[208:211],v[76:79]
v_cvt_pk_bf16_f32 v133,v134,v135
M v[80:83],a[248:251],a[212:215],v[80:83]
s_add_u32 s48,s77,52224
ds_write2st64_b64 v249,v[128:129],v[132:133] offset0:68 offset1:72
M v[84:87],a[248:251],a[216:219],v[84:87]
v_cvt_pk_bf16_f32 v136,v136,v137
v_cvt_pk_bf16_f32 v137,v138,v139
M v[88:91],a[248:251],a[220:223],v[88:91]
s_waitcnt lgkmcnt(4)
v_cvt_pk_bf16_f32 v140,v140,v141
v_cvt_pk_bf16_f32 v141,v142,v143
M v[92:95],a[248:251],a[192:195],v[92:95]
s_waitcnt vmcnt(27)
s_add_u32 s34,s32,7274496
buffer_store_dwordx4 a[84:87],v248,s[24:27],s34 offen offset:640 nt
M v[64:67],a[96:99],a[200:203],v[64:67]
ds_read_b128 a[200:203],v245 offset:34816
ds_write2st64_b64 v249,v[136:137],v[140:141] offset0:76 offset1:80
M v[68:71],a[96:99],a[204:207],v[68:71]
ds_read_b128 a[204:207],v246 offset:35072
v_cvt_pk_bf16_f32 v144,v144,v145
M v[72:75],a[96:99],a[208:211],v[72:75]
buffer_load_dwordx4 a[156:159],v247,s[20:23],s48 offen offset:0 sc1
M v[76:79],a[96:99],a[212:215],v[76:79]
ds_read_b128 a[208:211],v246 offset:35328
ds_read_b128 a[212:215],v246 offset:35584
M v[80:83],a[96:99],a[216:219],v[80:83]
ds_read_b128 a[216:219],v246 offset:35840
v_cvt_pk_bf16_f32 v145,v146,v147
M v[84:87],a[96:99],a[220:223],v[84:87]
ds_read_b128 a[220:223],v246 offset:36096
v_cvt_pk_bf16_f32 v148,v148,v149
M v[88:91],a[96:99],a[192:195],v[88:91]
s_waitcnt lgkmcnt(8)
ds_read_b128 a[192:195],v246 offset:36352
v_cvt_pk_bf16_f32 v149,v150,v151
M v[92:95],a[96:99],a[196:199],v[92:95]
s_waitcnt vmcnt(28) lgkmcnt(7)
ds_read_b128 a[196:199],v246 offset:36608
ds_write2st64_b64 v249,v[144:145],v[148:149] offset0:85 offset1:89
M v[64:67],a[144:147],a[200:203],v[64:67]
s_waitcnt lgkmcnt(7)
ds_read_b128 a[200:203],v246 offset:36864
v_cvt_pk_bf16_f32 v152,v152,v153
M v[68:71],a[144:147],a[204:207],v[68:71]
s_waitcnt lgkmcnt(7)
v_cvt_pk_bf16_f32 v153,v154,v155
v_cvt_pk_bf16_f32 v156,v156,v157
M v[72:75],a[144:147],a[208:211],v[72:75]
s_waitcnt lgkmcnt(6)
buffer_load_dwordx4 a[176:179],v247,s[20:23],s48 offen offset:1024 sc1
M v[76:79],a[144:147],a[212:215],v[76:79]
s_waitcnt lgkmcnt(5)
v_cvt_pk_bf16_f32 v157,v158,v159
M v[80:83],a[144:147],a[216:219],v[80:83]
s_waitcnt lgkmcnt(4)
ds_write2st64_b64 v249,v[152:153],v[156:157] offset0:93 offset1:97
M v[84:87],a[144:147],a[220:223],v[84:87]
s_waitcnt lgkmcnt(4)
M v[88:91],a[144:147],a[192:195],v[88:91]
s_waitcnt lgkmcnt(3)
M v[92:95],a[144:147],a[196:199],v[92:95]
s_waitcnt vmcnt(25) lgkmcnt(0)
s_barrier
ds_read_b128 a[88:91],v247 offset:8704
M v[64:67],a[164:167],a[204:207],v[64:67]
ds_read_b128 a[92:95],v247 offset:12800
ds_read_b128 v[128:131],v247 offset:34816
M v[68:71],a[164:167],a[208:211],v[68:71]
ds_read_b128 v[136:139],v247 offset:38912
ds_read_b128 v[144:147],v247 offset:43520
M v[72:75],a[164:167],a[212:215],v[72:75]
ds_read_b128 v[152:155],v247 offset:47616
buffer_load_dwordx4 a[232:235],v247,s[20:23],s48 offen offset:2048 sc1
M v[76:79],a[164:167],a[216:219],v[76:79]
ds_read_b128 a[204:207],v245 offset:37120
M v[80:83],a[164:167],a[220:223],v[80:83]
s_add_u32 s48,s78,52224
M v[84:87],a[164:167],a[192:195],v[84:87]
s_waitcnt lgkmcnt(6)
s_add_u32 s34,s32,7471104
buffer_store_dwordx4 a[88:91],v248,s[24:27],s34 offen offset:640 nt
M v[88:91],a[164:167],a[196:199],v[88:91]
M v[92:95],a[164:167],a[200:203],v[92:95]
s_waitcnt vmcnt(25)
M v[64:67],a[128:131],a[208:211],v[64:67]
ds_read_b128 a[208:211],v245 offset:52224
M v[68:71],a[128:131],a[212:215],v[68:71]
ds_read_b128 a[212:215],v246 offset:52480
M v[72:75],a[128:131],a[216:219],v[72:75]
buffer_load_dwordx4 a[236:239],v247,s[20:23],s48 offen offset:0 sc1
M v[76:79],a[128:131],a[220:223],v[76:79]
ds_read_b128 a[216:219],v246 offset:52736
ds_read_b128 a[220:223],v246 offset:52992
M v[80:83],a[128:131],a[192:195],v[80:83]
ds_read_b128 a[192:195],v246 offset:53248
M v[84:87],a[128:131],a[196:199],v[84:87]
ds_read_b128 a[196:199],v246 offset:53504
M v[88:91],a[128:131],a[200:203],v[88:91]
s_waitcnt lgkmcnt(6)
ds_read_b128 a[200:203],v246 offset:53760
M v[92:95],a[128:131],a[204:207],v[92:95]
s_waitcnt vmcnt(25) lgkmcnt(6)
ds_read_b128 a[204:207],v246 offset:54016
M v[64:67],a[252:255],a[208:211],v[64:67]
s_waitcnt lgkmcnt(6)
ds_read_b128 a[208:211],v246 offset:54272
M v[68:71],a[252:255],a[212:215],v[68:71]
s_waitcnt lgkmcnt(6)
M v[72:75],a[252:255],a[216:219],v[72:75]
s_waitcnt lgkmcnt(5)
buffer_load_dwordx4 a[140:143],v247,s[20:23],s48 offen offset:1024 sc1
M v[76:79],a[252:255],a[220:223],v[76:79]
s_waitcnt lgkmcnt(4)
M v[80:83],a[252:255],a[192:195],v[80:83]
s_waitcnt lgkmcnt(3)
M v[84:87],a[252:255],a[196:199],v[84:87]
s_waitcnt lgkmcnt(2)
M v[88:91],a[252:255],a[200:203],v[88:91]
s_waitcnt lgkmcnt(1)
M v[92:95],a[252:255],a[204:207],v[92:95]
s_waitcnt vmcnt(25)
M v[64:67],a[224:227],a[212:215],v[64:67]
ds_read_b128 a[212:215],v245 offset:54528
M v[68:71],a[224:227],a[216:219],v[68:71]
M v[72:75],a[224:227],a[220:223],v[72:75]
buffer_load_dwordx4 a[104:107],v247,s[20:23],s48 offen offset:2048 sc1
M v[76:79],a[224:227],a[192:195],v[76:79]
s_add_u32 s34,s32,7667712
M v[80:83],a[224:227],a[196:199],v[80:83]
s_add_u32 s48,s79,52224
buffer_store_dwordx4 a[92:95],v248,s[24:27],s34 offen offset:640 nt
M v[84:87],a[224:227],a[200:203],v[84:87]
v_add_u32 v245,0x11000,v245
v_add_u32 v246,0x11000,v246
M v[88:91],a[224:227],a[204:207],v[88:91]
s_waitcnt lgkmcnt(1)
M v[92:95],a[224:227],a[208:211],v[92:95]
s_waitcnt vmcnt(26)
M v[64:67],a[112:115],a[216:219],v[64:67]
ds_read_b128 a[216:219],v245 offset:0
M v[68:71],a[112:115],a[220:223],v[68:71]
ds_read_b128 a[220:223],v246 offset:256
M v[72:75],a[112:115],a[192:195],v[72:75]
buffer_load_dwordx4 a[180:183],v247,s[20:23],s48 offen offset:0 sc1
M v[76:79],a[112:115],a[196:199],v[76:79]
ds_read_b128 a[192:195],v246 offset:512
ds_read_b128 a[196:199],v246 offset:768
M v[80:83],a[112:115],a[200:203],v[80:83]
ds_read_b128 a[200:203],v246 offset:1024
M v[84:87],a[112:115],a[204:207],v[84:87]
ds_read_b128 a[204:207],v246 offset:1280
M v[88:91],a[112:115],a[208:211],v[88:91]
s_waitcnt lgkmcnt(6)
ds_read_b128 a[208:211],v246 offset:1536
M v[92:95],a[112:115],a[212:215],v[92:95]
s_waitcnt vmcnt(26) lgkmcnt(6)
ds_read_b128 a[212:215],v246 offset:1792
M v[64:67],a[148:151],a[216:219],v[64:67]
s_waitcnt lgkmcnt(6)
ds_read_b128 a[216:219],v246 offset:2048
M v[68:71],a[148:151],a[220:223],v[68:71]
s_waitcnt lgkmcnt(6)
M v[72:75],a[148:151],a[192:195],v[72:75]
s_waitcnt lgkmcnt(5)
buffer_load_dwordx4 a[120:123],v247,s[20:23],s48 offen offset:1024 sc1
M v[76:79],a[148:151],a[196:199],v[76:79]
s_waitcnt lgkmcnt(4)
M v[80:83],a[148:151],a[200:203],v[80:83]
s_waitcnt lgkmcnt(3)
M v[84:87],a[148:151],a[204:207],v[84:87]
s_waitcnt lgkmcnt(2)
M v[88:91],a[148:151],a[208:211],v[88:91]
s_waitcnt lgkmcnt(1)
M v[92:95],a[148:151],a[212:215],v[92:95]
s_waitcnt vmcnt(26)
M v[64:67],a[168:171],a[220:223],v[64:67]
ds_read_b128 a[220:223],v245 offset:2304
M v[68:71],a[168:171],a[192:195],v[68:71]
s_add_u32 s34,s33,6291456
buffer_store_dwordx4 v[128:131],v248,s[24:27],s34 offen offset:1280 nt
M v[72:75],a[168:171],a[196:199],v[72:75]
buffer_load_dwordx4 a[124:127],v247,s[20:23],s48 offen offset:2048 sc1
M v[76:79],a[168:171],a[200:203],v[76:79]
M v[80:83],a[168:171],a[204:207],v[80:83]
s_add_u32 s48,s80,52224
M v[84:87],a[168:171],a[208:211],v[84:87]
M v[88:91],a[168:171],a[212:215],v[88:91]
s_waitcnt lgkmcnt(1)
M v[92:95],a[168:171],a[216:219],v[92:95]
s_waitcnt vmcnt(27)
M v[64:67],v[216:219],a[192:195],v[64:67]
ds_read_b128 a[192:195],v245 offset:17408
M v[68:71],v[216:219],a[196:199],v[68:71]
ds_read_b128 a[196:199],v246 offset:17664
M v[72:75],v[216:219],a[200:203],v[72:75]
buffer_load_dwordx4 a[240:243],v247,s[20:23],s48 offen offset:0 sc1
M v[76:79],v[216:219],a[204:207],v[76:79]
ds_read_b128 a[200:203],v246 offset:17920
ds_read_b128 a[204:207],v246 offset:18176
M v[80:83],v[216:219],a[208:211],v[80:83]
ds_read_b128 a[208:211],v246 offset:18432
M v[84:87],v[216:219],a[212:215],v[84:87]
ds_read_b128 a[212:215],v246 offset:18688
M v[88:91],v[216:219],a[216:219],v[88:91]
s_waitcnt lgkmcnt(6)
ds_read_b128 a[216:219],v246 offset:18944
M v[92:95],v[216:219],a[220:223],v[92:95]
s_waitcnt vmcnt(27) lgkmcnt(6)
ds_read_b128 a[220:223],v246 offset:19200
M v[64:67],v[220:223],a[192:195],v[64:67]
s_waitcnt lgkmcnt(6)
ds_read_b128 a[192:195],v246 offset:19456
M v[68:71],v[220:223],a[196:199],v[68:71]
s_waitcnt lgkmcnt(6)
M v[72:75],v[220:223],a[200:203],v[72:75]
s_waitcnt lgkmcnt(5)
buffer_load_dwordx4 a[244:247],v247,s[20:23],s48 offen offset:1024 sc1
M v[76:79],v[220:223],a[204:207],v[76:79]
s_waitcnt lgkmcnt(4)
M v[80:83],v[220:223],a[208:211],v[80:83]
s_waitcnt lgkmcnt(3)
M v[84:87],v[220:223],a[212:215],v[84:87]
s_waitcnt lgkmcnt(2)
M v[88:91],v[220:223],a[216:219],v[88:91]
s_waitcnt lgkmcnt(1)
M v[92:95],v[220:223],a[220:223],v[92:95]
s_waitcnt vmcnt(27)
s_add_u32 s34,s33,6684672
buffer_store_dwordx4 v[136:139],v248,s[24:27],s34 offen offset:1280 nt
M v[64:67],a[172:175],a[196:199],v[64:67]
ds_read_b128 a[196:199],v245 offset:19712
M v[68:71],a[172:175],a[200:203],v[68:71]
M v[72:75],a[172:175],a[204:207],v[72:75]
buffer_load_dwordx4 a[160:163],v247,s[20:23],s48 offen offset:2048 sc1
M v[76:79],a[172:175],a[208:211],v[76:79]
M v[80:83],a[172:175],a[212:215],v[80:83]
s_add_u32 s48,s81,52224
M v[84:87],a[172:175],a[216:219],v[84:87]
v_add_u32 v245,0xffff1200,v245
v_add_u32 v246,0xffff1200,v246
M v[88:91],a[172:175],a[220:223],v[88:91]
s_waitcnt lgkmcnt(1)
M v[92:95],a[172:175],a[192:195],v[92:95]
s_waitcnt vmcnt(28)
M v[64:67],a[132:135],a[200:203],v[64:67]
ds_read_b128 a[200:203],v245 offset:8704
M v[68:71],a[132:135],a[204:207],v[68:71]
ds_read_b128 a[204:207],v246 offset:8960
M v[72:75],a[132:135],a[208:211],v[72:75]
buffer_load_dwordx4 a[184:187],v247,s[20:23],s48 offen offset:0 sc1
M v[76:79],a[132:135],a[212:215],v[76:79]
ds_read_b128 a[208:211],v246 offset:9216
ds_read_b128 a[212:215],v246 offset:9472
M v[80:83],a[132:135],a[216:219],v[80:83]
ds_read_b128 a[216:219],v246 offset:9728
M v[84:87],a[132:135],a[220:223],v[84:87]
ds_read_b128 a[220:223],v246 offset:9984
M v[88:91],a[132:135],a[192:195],v[88:91]
s_waitcnt lgkmcnt(6)
ds_read_b128 a[192:195],v246 offset:10240
M v[92:95],a[132:135],a[196:199],v[92:95]
s_waitcnt vmcnt(28) lgkmcnt(6)
ds_read_b128 a[196:199],v246 offset:10496
M v[64:67],a[100:103],a[200:203],v[64:67]
s_waitcnt lgkmcnt(6)
ds_read_b128 a[200:203],v246 offset:10752
M v[68:71],a[100:103],a[204:207],v[68:71]
s_waitcnt lgkmcnt(6)
M v[72:75],a[100:103],a[208:211],v[72:75]
s_waitcnt lgkmcnt(5)
buffer_load_dwordx4 a[188:191],v247,s[20:23],s48 offen offset:1024 sc1
M v[76:79],a[100:103],a[212:215],v[76:79]
s_waitcnt lgkmcnt(4)
M v[80:83],a[100:103],a[216:219],v[80:83]
s_waitcnt lgkmcnt(3)
M v[84:87],a[100:103],a[220:223],v[84:87]
s_waitcnt lgkmcnt(2)
s_add_u32 s34,s33,7077888
buffer_store_dwordx4 v[144:147],v248,s[24:27],s34 offen offset:1280 nt
M v[88:91],a[100:103],a[192:195],v[88:91]
s_waitcnt lgkmcnt(1)
M v[92:95],a[100:103],a[196:199],v[92:95]
s_waitcnt vmcnt(29)
M v[64:67],v[224:227],a[204:207],v[64:67]
ds_read_b128 a[204:207],v245 offset:11008
M v[68:71],v[224:227],a[208:211],v[68:71]
M v[72:75],v[224:227],a[212:215],v[72:75]
buffer_load_dwordx4 a[108:111],v247,s[20:23],s48 offen offset:2048 sc1
M v[76:79],v[224:227],a[216:219],v[76:79]
M v[80:83],v[224:227],a[220:223],v[80:83]
M v[84:87],v[224:227],a[192:195],v[84:87]
M v[88:91],v[224:227],a[196:199],v[88:91]
s_waitcnt lgkmcnt(1)
M v[92:95],v[224:227],a[200:203],v[92:95]
s_waitcnt vmcnt(25)
M v[64:67],a[116:119],a[208:211],v[64:67]
ds_read_b128 a[208:211],v245 offset:0
M v[68:71],a[116:119],a[212:215],v[68:71]
ds_read_b128 a[212:215],v246 offset:256
M v[72:75],a[116:119],a[216:219],v[72:75]
ds_read_b128 a[216:219],v246 offset:512
M v[76:79],a[116:119],a[220:223],v[76:79]
ds_read_b128 a[220:223],v246 offset:768
s_nop 0
v_cvt_pk_bf16_f32 v64,v64,v65
M v[80:83],a[116:119],a[192:195],v[80:83]
ds_read_b128 a[192:195],v246 offset:1024
v_cvt_pk_bf16_f32 v65,v66,v67
M v[84:87],a[116:119],a[196:199],v[84:87]
ds_read_b128 a[196:199],v246 offset:1280
v_cvt_pk_bf16_f32 v68,v68,v69
M v[88:91],a[116:119],a[200:203],v[88:91]
s_waitcnt lgkmcnt(6)
ds_read_b128 a[200:203],v246 offset:1536
v_cvt_pk_bf16_f32 v69,v70,v71
M v[92:95],a[116:119],a[204:207],v[92:95]
s_waitcnt vmcnt(23) lgkmcnt(6)
ds_read_b128 a[204:207],v246 offset:1792
ds_write2st64_b64 v249,v[64:65],v[68:69] offset0:34 offset1:38
M v[160:163],a[152:155],a[208:211],v[160:163]
s_waitcnt lgkmcnt(7)
ds_read_b128 a[208:211],v246 offset:2048
v_cvt_pk_bf16_f32 v72,v72,v73
M v[164:167],a[152:155],a[212:215],v[164:167]
s_waitcnt lgkmcnt(7)
v_cvt_pk_bf16_f32 v73,v74,v75
v_cvt_pk_bf16_f32 v76,v76,v77
M v[168:171],a[152:155],a[216:219],v[168:171]
s_waitcnt lgkmcnt(6)
v_cvt_pk_bf16_f32 v77,v78,v79
M v[172:175],a[152:155],a[220:223],v[172:175]
s_waitcnt lgkmcnt(5)
s_add_u32 s34,s33,7471104
buffer_store_dwordx4 v[152:155],v248,s[24:27],s34 offen offset:1280 nt
M v[176:179],a[152:155],a[192:195],v[176:179]
s_waitcnt lgkmcnt(4)
ds_write2st64_b64 v249,v[72:73],v[76:77] offset0:42 offset1:46
M v[180:183],a[152:155],a[196:199],v[180:183]
s_waitcnt lgkmcnt(4)
v_cvt_pk_bf16_f32 v80,v80,v81
v_cvt_pk_bf16_f32 v81,v82,v83
M v[184:187],a[152:155],a[200:203],v[184:187]
s_waitcnt lgkmcnt(3)
v_cvt_pk_bf16_f32 v84,v84,v85
v_cvt_pk_bf16_f32 v85,v86,v87
M v[188:191],a[152:155],a[204:207],v[188:191]
s_waitcnt vmcnt(23)
ds_write2st64_b64 v249,v[80:81],v[84:85] offset0:51 offset1:55
M v[160:163],a[228:231],a[212:215],v[160:163]
ds_read_b128 a[212:215],v245 offset:2304
v_cvt_pk_bf16_f32 v88,v88,v89
M v[164:167],a[228:231],a[216:219],v[164:167]
v_cvt_pk_bf16_f32 v89,v90,v91
v_cvt_pk_bf16_f32 v92,v92,v93
M v[168:171],a[228:231],a[220:223],v[168:171]
v_cvt_pk_bf16_f32 v93,v94,v95
M v[172:175],a[228:231],a[192:195],v[172:175]
ds_write2st64_b64 v249,v[88:89],v[92:93] offset0:59 offset1:63
M v[176:179],a[228:231],a[196:199],v[176:179]
M v[180:183],a[228:231],a[200:203],v[180:183]
M v[184:187],a[228:231],a[204:207],v[184:187]
s_waitcnt lgkmcnt(0)
s_barrier
ds_read_b128 v[64:67],v247 offset:17408
M v[188:191],a[228:231],a[208:211],v[188:191]
s_waitcnt vmcnt(22)
ds_read_b128 v[72:75],v247 offset:21504
ds_read_b128 v[80:83],v247 offset:26112
M v[160:163],a[136:139],a[216:219],v[160:163]
ds_read_b128 v[88:91],v247 offset:30208
ds_read_b128 a[216:219],v245 offset:34816
M v[164:167],a[136:139],a[220:223],v[164:167]
ds_read_b128 a[220:223],v246 offset:35072
M v[168:171],a[136:139],a[192:195],v[168:171]
ds_read_b128 a[192:195],v246 offset:35328
M v[172:175],a[136:139],a[196:199],v[172:175]
ds_read_b128 a[196:199],v246 offset:35584
M v[176:179],a[136:139],a[200:203],v[176:179]
ds_read_b128 a[200:203],v246 offset:35840
M v[180:183],a[136:139],a[204:207],v[180:183]
ds_read_b128 a[204:207],v246 offset:36096
M v[184:187],a[136:139],a[208:211],v[184:187]
ds_read_b128 a[208:211],v246 offset:36352
M v[188:191],a[136:139],a[212:215],v[188:191]
s_waitcnt vmcnt(20) lgkmcnt(6)
ds_read_b128 a[212:215],v246 offset:36608
M v[160:163],a[156:159],a[216:219],v[160:163]
s_waitcnt lgkmcnt(6)
ds_read_b128 a[216:219],v246 offset:36864
M v[164:167],a[156:159],a[220:223],v[164:167]
s_waitcnt lgkmcnt(6)
s_add_u32 s34,s33,6291456
buffer_store_dwordx4 v[64:67],v248,s[24:27],s34 offen offset:256 nt
M v[168:171],a[156:159],a[192:195],v[168:171]
s_waitcnt lgkmcnt(5)
M v[172:175],a[156:159],a[196:199],v[172:175]
s_waitcnt lgkmcnt(4)
M v[176:179],a[156:159],a[200:203],v[176:179]
s_waitcnt lgkmcnt(3)
M v[180:183],a[156:159],a[204:207],v[180:183]
s_waitcnt lgkmcnt(2)
M v[184:187],a[156:159],a[208:211],v[184:187]
s_waitcnt lgkmcnt(1)
M v[188:191],a[156:159],a[212:215],v[188:191]
s_waitcnt vmcnt(20)
M v[160:163],a[176:179],a[220:223],v[160:163]
ds_read_b128 a[220:223],v245 offset:37120
M v[164:167],a[176:179],a[192:195],v[164:167]
M v[168:171],a[176:179],a[196:199],v[168:171]
M v[172:175],a[176:179],a[200:203],v[172:175]
M v[176:179],a[176:179],a[204:207],v[176:179]
M v[180:183],a[176:179],a[208:211],v[180:183]
M v[184:187],a[176:179],a[212:215],v[184:187]
s_waitcnt lgkmcnt(1)
M v[188:191],a[176:179],a[216:219],v[188:191]
s_waitcnt vmcnt(19)
M v[160:163],a[232:235],a[192:195],v[160:163]
ds_read_b128 a[192:195],v245 offset:52224
M v[164:167],a[232:235],a[196:199],v[164:167]
ds_read_b128 a[196:199],v246 offset:52480
M v[168:171],a[232:235],a[200:203],v[168:171]
ds_read_b128 a[200:203],v246 offset:52736
M v[172:175],a[232:235],a[204:207],v[172:175]
ds_read_b128 a[204:207],v246 offset:52992
M v[176:179],a[232:235],a[208:211],v[176:179]
ds_read_b128 a[208:211],v246 offset:53248
M v[180:183],a[232:235],a[212:215],v[180:183]
ds_read_b128 a[212:215],v246 offset:53504
M v[184:187],a[232:235],a[216:219],v[184:187]
s_waitcnt lgkmcnt(6)
ds_read_b128 a[216:219],v246 offset:53760
M v[188:191],a[232:235],a[220:223],v[188:191]
s_waitcnt vmcnt(17) lgkmcnt(6)
s_add_u32 s34,s33,6684672
buffer_store_dwordx4 v[72:75],v248,s[24:27],s34 offen offset:256 nt
M v[160:163],a[236:239],a[192:195],v[160:163]
s_waitcnt lgkmcnt(5)
ds_read_b128 a[220:223],v246 offset:54016
ds_read_b128 a[192:195],v246 offset:54272
M v[164:167],a[236:239],a[196:199],v[164:167]
s_waitcnt lgkmcnt(6)
M v[168:171],a[236:239],a[200:203],v[168:171]
s_waitcnt lgkmcnt(5)
M v[172:175],a[236:239],a[204:207],v[172:175]
s_waitcnt lgkmcnt(4)
M v[176:179],a[236:239],a[208:211],v[176:179]
s_waitcnt lgkmcnt(3)
M v[180:183],a[236:239],a[212:215],v[180:183]
s_waitcnt lgkmcnt(2)
M v[184:187],a[236:239],a[216:219],v[184:187]
s_waitcnt lgkmcnt(1)
M v[188:191],a[236:239],a[220:223],v[188:191]
s_waitcnt vmcnt(17)
M v[160:163],a[140:143],a[196:199],v[160:163]
ds_read_b128 a[196:199],v245 offset:54528
M v[164:167],a[140:143],a[200:203],v[164:167]
M v[168:171],a[140:143],a[204:207],v[168:171]
M v[172:175],a[140:143],a[208:211],v[172:175]
M v[176:179],a[140:143],a[212:215],v[176:179]
M v[180:183],a[140:143],a[216:219],v[180:183]
v_add_u32 v245,0x11000,v245
v_add_u32 v246,0x11000,v246
M v[184:187],a[140:143],a[220:223],v[184:187]
s_waitcnt lgkmcnt(1)
M v[188:191],a[140:143],a[192:195],v[188:191]
s_waitcnt vmcnt(16)
M v[160:163],a[104:107],a[200:203],v[160:163]
ds_read_b128 a[200:203],v245 offset:0
M v[164:167],a[104:107],a[204:207],v[164:167]
ds_read_b128 a[204:207],v246 offset:256
M v[168:171],a[104:107],a[208:211],v[168:171]
ds_read_b128 a[208:211],v246 offset:512
M v[172:175],a[104:107],a[212:215],v[172:175]
ds_read_b128 a[212:215],v246 offset:768
M v[176:179],a[104:107],a[216:219],v[176:179]
ds_read_b128 a[216:219],v246 offset:1024
M v[180:183],a[104:107],a[220:223],v[180:183]
s_add_u32 s34,s33,7077888
buffer_store_dwordx4 v[80:83],v248,s[24:27],s34 offen offset:256 nt
M v[184:187],a[104:107],a[192:195],v[184:187]
s_waitcnt lgkmcnt(5)
ds_read_b128 a[220:223],v246 offset:1280
ds_read_b128 a[192:195],v246 offset:1536
M v[188:191],a[104:107],a[196:199],v[188:191]
s_waitcnt vmcnt(15) lgkmcnt(6)
ds_read_b128 a[196:199],v246 offset:1792
M v[160:163],a[180:183],a[200:203],v[160:163]
s_waitcnt lgkmcnt(6)
ds_read_b128 a[200:203],v246 offset:2048
M v[164:167],a[180:183],a[204:207],v[164:167]
s_waitcnt lgkmcnt(6)
M v[168:171],a[180:183],a[208:211],v[168:171]
s_waitcnt lgkmcnt(5)
M v[172:175],a[180:183],a[212:215],v[172:175]
s_waitcnt lgkmcnt(4)
M v[176:179],a[180:183],a[216:219],v[176:179]
s_waitcnt lgkmcnt(3)
M v[180:183],a[180:183],a[220:223],v[180:183]
s_waitcnt lgkmcnt(2)
M v[184:187],a[180:183],a[192:195],v[184:187]
s_waitcnt lgkmcnt(1)
M v[188:191],a[180:183],a[196:199],v[188:191]
s_waitcnt vmcnt(14)
M v[160:163],a[120:123],a[204:207],v[160:163]
ds_read_b128 a[204:207],v245 offset:2304
M v[164:167],a[120:123],a[208:211],v[164:167]
M v[168:171],a[120:123],a[212:215],v[168:171]
M v[172:175],a[120:123],a[216:219],v[172:175]
M v[176:179],a[120:123],a[220:223],v[176:179]
M v[180:183],a[120:123],a[192:195],v[180:183]
M v[184:187],a[120:123],a[196:199],v[184:187]
s_waitcnt lgkmcnt(1)
M v[188:191],a[120:123],a[200:203],v[188:191]
s_waitcnt vmcnt(12)
M v[160:163],a[124:127],a[208:211],v[160:163]
ds_read_b128 a[208:211],v245 offset:17408
M v[164:167],a[124:127],a[212:215],v[164:167]
ds_read_b128 a[212:215],v246 offset:17664
M v[168:171],a[124:127],a[216:219],v[168:171]
ds_read_b128 a[216:219],v246 offset:17920
M v[172:175],a[124:127],a[220:223],v[172:175]
s_add_u32 s34,s33,7471104
buffer_store_dwordx4 v[88:91],v248,s[24:27],s34 offen offset:256 nt
M v[176:179],a[124:127],a[192:195],v[176:179]
ds_read_b128 a[220:223],v246 offset:18176
ds_read_b128 a[192:195],v246 offset:18432
M v[180:183],a[124:127],a[196:199],v[180:183]
ds_read_b128 a[196:199],v246 offset:18688
M v[184:187],a[124:127],a[200:203],v[184:187]
s_waitcnt lgkmcnt(6)
ds_read_b128 a[200:203],v246 offset:18944
M v[188:191],a[124:127],a[204:207],v[188:191]
s_waitcnt vmcnt(12) lgkmcnt(6)
ds_read_b128 a[204:207],v246 offset:19200
M v[160:163],a[240:243],a[208:211],v[160:163]
s_waitcnt lgkmcnt(6)
ds_read_b128 a[208:211],v246 offset:19456
M v[164:167],a[240:243],a[212:215],v[164:167]
s_waitcnt lgkmcnt(6)
M v[168:171],a[240:243],a[216:219],v[168:171]
s_waitcnt lgkmcnt(5)
M v[172:175],a[240:243],a[220:223],v[172:175]
s_waitcnt lgkmcnt(4)
M v[176:179],a[240:243],a[192:195],v[176:179]
s_waitcnt lgkmcnt(3)
M v[180:183],a[240:243],a[196:199],v[180:183]
s_waitcnt lgkmcnt(2)
M v[184:187],a[240:243],a[200:203],v[184:187]
s_waitcnt lgkmcnt(1)
M v[188:191],a[240:243],a[204:207],v[188:191]
s_waitcnt vmcnt(11)
M v[160:163],a[244:247],a[212:215],v[160:163]
ds_read_b128 a[212:215],v245 offset:19712
M v[164:167],a[244:247],a[216:219],v[164:167]
M v[168:171],a[244:247],a[220:223],v[168:171]
M v[172:175],a[244:247],a[192:195],v[172:175]
M v[176:179],a[244:247],a[196:199],v[176:179]
M v[180:183],a[244:247],a[200:203],v[180:183]
v_add_u32 v245,0xffff3400,v245
v_add_u32 v246,0xffff3400,v246
M v[184:187],a[244:247],a[204:207],v[184:187]
s_waitcnt lgkmcnt(1)
M v[188:191],a[244:247],a[208:211],v[188:191]
s_waitcnt vmcnt(9)
M v[160:163],a[160:163],a[216:219],v[160:163]
ds_read_b128 a[216:219],v245 offset:0
M v[164:167],a[160:163],a[220:223],v[164:167]
ds_read_b128 a[220:223],v246 offset:256
M v[168:171],a[160:163],a[192:195],v[168:171]
ds_read_b128 a[192:195],v246 offset:512
M v[172:175],a[160:163],a[196:199],v[172:175]
ds_read_b128 a[196:199],v246 offset:768
M v[176:179],a[160:163],a[200:203],v[176:179]
ds_read_b128 a[200:203],v246 offset:1024
M v[180:183],a[160:163],a[204:207],v[180:183]
ds_read_b128 a[204:207],v246 offset:1280
M v[184:187],a[160:163],a[208:211],v[184:187]
s_waitcnt lgkmcnt(6)
ds_read_b128 a[208:211],v246 offset:1536
M v[188:191],a[160:163],a[212:215],v[188:191]
s_waitcnt vmcnt(8) lgkmcnt(6)
ds_read_b128 a[212:215],v246 offset:1792
M v[160:163],a[184:187],a[216:219],v[160:163]
s_waitcnt lgkmcnt(6)
ds_read_b128 a[216:219],v246 offset:2048
M v[164:167],a[184:187],a[220:223],v[164:167]
s_waitcnt lgkmcnt(6)
M v[168:171],a[184:187],a[192:195],v[168:171]
s_waitcnt lgkmcnt(5)
M v[172:175],a[184:187],a[196:199],v[172:175]
s_waitcnt lgkmcnt(4)
M v[176:179],a[184:187],a[200:203],v[176:179]
s_waitcnt lgkmcnt(3)
M v[180:183],a[184:187],a[204:207],v[180:183]
s_waitcnt lgkmcnt(2)
M v[184:187],a[184:187],a[208:211],v[184:187]
s_waitcnt lgkmcnt(1)
M v[188:191],a[184:187],a[212:215],v[188:191]
s_waitcnt vmcnt(7)
M v[160:163],a[188:191],a[220:223],v[160:163]
ds_read_b128 a[220:223],v245 offset:2304
M v[164:167],a[188:191],a[192:195],v[164:167]
M v[168:171],a[188:191],a[196:199],v[168:171]
M v[172:175],a[188:191],a[200:203],v[172:175]
M v[176:179],a[188:191],a[204:207],v[176:179]
M v[180:183],a[188:191],a[208:211],v[180:183]
M v[184:187],a[188:191],a[212:215],v[184:187]
s_waitcnt lgkmcnt(1)
M v[188:191],a[188:191],a[216:219],v[188:191]
s_waitcnt vmcnt(5)
M v[160:163],a[108:111],a[192:195],v[160:163]
M v[164:167],a[108:111],a[196:199],v[164:167]
M v[168:171],a[108:111],a[200:203],v[168:171]
M v[172:175],a[108:111],a[204:207],v[172:175]
s_nop 4
v_cvt_pk_bf16_f32 v160,v160,v161
v_cvt_pk_bf16_f32 v161,v162,v163
M v[176:179],a[108:111],a[208:211],v[176:179]
v_cvt_pk_bf16_f32 v164,v164,v165
v_cvt_pk_bf16_f32 v165,v166,v167
M v[180:183],a[108:111],a[212:215],v[180:183]
ds_write2st64_b64 v249,v[160:161],v[164:165] offset0:17 offset1:21
M v[184:187],a[108:111],a[216:219],v[184:187]
s_waitcnt lgkmcnt(1)
v_cvt_pk_bf16_f32 v168,v168,v169
v_cvt_pk_bf16_f32 v169,v170,v171
M v[188:191],a[108:111],a[220:223],v[188:191]
v_cvt_pk_bf16_f32 v172,v172,v173
v_cvt_pk_bf16_f32 v173,v174,v175
ds_write2st64_b64 v249,v[168:169],v[172:173] offset0:25 offset1:29
v_cvt_pk_bf16_f32 v176,v176,v177
v_cvt_pk_bf16_f32 v177,v178,v179
v_cvt_pk_bf16_f32 v180,v180,v181
v_cvt_pk_bf16_f32 v181,v182,v183
ds_write2st64_b64 v249,v[176:177],v[180:181] offset0:68 offset1:72
v_cvt_pk_bf16_f32 v184,v184,v185
v_cvt_pk_bf16_f32 v185,v186,v187
v_cvt_pk_bf16_f32 v188,v188,v189
v_cvt_pk_bf16_f32 v189,v190,v191
ds_write2st64_b64 v249,v[184:185],v[188:189] offset0:76 offset1:80
s_waitcnt lgkmcnt(0)
s_barrier
ds_read_b128 v[160:163],v247 offset:8704
ds_read_b128 v[168:171],v247 offset:12800
ds_read_b128 v[176:179],v247 offset:34816
ds_read_b128 v[184:187],v247 offset:38912
s_add_u32 s34,s33,6291456
s_waitcnt lgkmcnt(3)
buffer_store_dwordx4 v[160:163],v248,s[24:27],s34 offen offset:1408 nt
s_nop 1
s_add_u32 s34,s33,6684672
s_waitcnt lgkmcnt(2)
buffer_store_dwordx4 v[168:171],v248,s[24:27],s34 offen offset:1408 nt
s_nop 1
s_add_u32 s34,s33,7077888
s_waitcnt lgkmcnt(1)
buffer_store_dwordx4 v[176:179],v248,s[24:27],s34 offen offset:1408 nt
s_nop 1
s_add_u32 s34,s33,7471104
s_waitcnt lgkmcnt(0)
buffer_store_dwordx4 v[184:187],v248,s[24:27],s34 offen offset:1408 nt
s_endpgm
L_code_end:
L_fallback:
s_mov_b32 s84,0
L_itemF:
s_and_b32 s85,s84,3
s_lshr_b32 s86,s84,2
s_mul_hi_u32 s87,s86,0x55555556
s_mul_i32 s88,s87,3
s_sub_u32 s86,s86,s88
s_mul_hi_u32 s88,s87,0x2aaaaaab
s_mul_i32 s89,s88,6
s_sub_u32 s87,s87,s89
s_mul_i32 s89,s86,221184
s_mul_i32 s90,s87,12288
s_add_u32 s89,s89,s90
s_mul_i32 s90,s85,3072
s_add_u32 s89,s89,s90
s_lshl_b32 s90,s88,7
s_add_u32 s89,s89,s90
s_add_u32 s90,s89,73728
s_add_u32 s91,s90,73728
v_lshlrev_b32 v149,1,v64
buffer_load_short_d16_hi v68,v149,s[36:39],s89 offen offset:0
buffer_load_short_d16_hi v69,v149,s[36:39],s89 offen offset:384
buffer_load_short_d16_hi v70,v149,s[36:39],s89 offen offset:768
buffer_load_short_d16_hi v71,v149,s[36:39],s89 offen offset:1152
buffer_load_short_d16_hi v72,v149,s[36:39],s89 offen offset:1536
buffer_load_short_d16_hi v73,v149,s[36:39],s89 offen offset:1920
buffer_load_short_d16_hi v74,v149,s[36:39],s89 offen offset:2304
buffer_load_short_d16_hi v75,v149,s[36:39],s89 offen offset:2688
buffer_load_short_d16_hi v76,v149,s[36:39],s90 offen offset:0
buffer_load_short_d16_hi v77,v149,s[36:39],s90 offen offset:384
buffer_load_short_d16_hi v78,v149,s[36:39],s90 offen offset:768
buffer_load_short_d16_hi v79,v149,s[36:39],s90 offen offset:1152
buffer_load_short_d16_hi v80,v149,s[36:39],s90 offen offset:1536
buffer_load_short_d16_hi v81,v149,s[36:39],s90 offen offset:1920
buffer_load_short_d16_hi v82,v149,s[36:39],s90 offen offset:2304
buffer_load_short_d16_hi v83,v149,s[36:39],s90 offen offset:2688
buffer_load_short_d16_hi v84,v149,s[36:39],s91 offen offset:0
buffer_load_short_d16_hi v85,v149,s[36:39],s91 offen offset:384
buffer_load_short_d16_hi v86,v149,s[36:39],s91 offen offset:768
buffer_load_short_d16_hi v87,v149,s[36:39],s91 offen offset:1152
buffer_load_short_d16_hi v88,v149,s[36:39],s91 offen offset:1536
buffer_load_short_d16_hi v89,v149,s[36:39],s91 offen offset:1920
buffer_load_short_d16_hi v90,v149,s[36:39],s91 offen offset:2304
buffer_load_short_d16_hi v91,v149,s[36:39],s91 offen offset:2688
v_lshrrev_b32 v150,4,v64
v_mul_u32_u24 v150,331776,v150
v_and_b32 v148,15,v64
v_lshl_add_u32 v150,v148,4,v150
s_mul_i32 s87,s87,55296
s_mul_i32 s88,s88,3072
s_add_u32 s87,s87,s88
s_lshl_b32 s86,s86,10
s_add_u32 s87,s87,s86
s_lshl_b32 s85,s85,8
s_add_u32 s87,s87,s85
s_mov_b32 s85,0xbe2aaaab
s_mov_b32 s86,0x3d2aaaab
s_mov_b32 s88,0x3e2aaaab
s_mov_b32 s92,0x3daaaaab
s_waitcnt vmcnt(0)
v_add_f32 v148,v68,v84
v_add_f32 v92,v148,v76
v_sub_f32 v100,v148,v76
v_mul_f32 v92,s85,v92
v_mul_f32 v100,s85,v100
v_mul_f32 v148,s86,v68
v_fmac_f32 v148,s88,v84
v_fma_f32 v108,s92,v76,v148
v_fma_f32 v116,-s92,v76,v148
v_add_f32 v148,v69,v85
v_add_f32 v93,v148,v77
v_sub_f32 v101,v148,v77
v_mul_f32 v93,s85,v93
v_mul_f32 v101,s85,v101
v_mul_f32 v148,s86,v69
v_fmac_f32 v148,s88,v85
v_fma_f32 v109,s92,v77,v148
v_fma_f32 v117,-s92,v77,v148
v_add_f32 v148,v70,v86
v_add_f32 v94,v148,v78
v_sub_f32 v102,v148,v78
v_mul_f32 v94,s85,v94
v_mul_f32 v102,s85,v102
v_mul_f32 v148,s86,v70
v_fmac_f32 v148,s88,v86
v_fma_f32 v110,s92,v78,v148
v_fma_f32 v118,-s92,v78,v148
v_add_f32 v148,v71,v87
v_add_f32 v95,v148,v79
v_sub_f32 v103,v148,v79
v_mul_f32 v95,s85,v95
v_mul_f32 v103,s85,v103
v_mul_f32 v148,s86,v71
v_fmac_f32 v148,s88,v87
v_fma_f32 v111,s92,v79,v148
v_fma_f32 v119,-s92,v79,v148
v_add_f32 v148,v72,v88
v_add_f32 v96,v148,v80
v_sub_f32 v104,v148,v80
v_mul_f32 v96,s85,v96
v_mul_f32 v104,s85,v104
v_mul_f32 v148,s86,v72
v_fmac_f32 v148,s88,v88
v_fma_f32 v112,s92,v80,v148
v_fma_f32 v120,-s92,v80,v148
v_add_f32 v148,v73,v89
v_add_f32 v97,v148,v81
v_sub_f32 v105,v148,v81
v_mul_f32 v97,s85,v97
v_mul_f32 v105,s85,v105
v_mul_f32 v148,s86,v73
v_fmac_f32 v148,s88,v89
v_fma_f32 v113,s92,v81,v148
v_fma_f32 v121,-s92,v81,v148
v_add_f32 v148,v74,v90
v_add_f32 v98,v148,v82
v_sub_f32 v106,v148,v82
v_mul_f32 v98,s85,v98
v_mul_f32 v106,s85,v106
v_mul_f32 v148,s86,v74
v_fmac_f32 v148,s88,v90
v_fma_f32 v114,s92,v82,v148
v_fma_f32 v122,-s92,v82,v148
v_add_f32 v148,v75,v91
v_add_f32 v99,v148,v83
v_sub_f32 v107,v148,v83
v_mul_f32 v99,s85,v99
v_mul_f32 v107,s85,v107
v_mul_f32 v148,s86,v75
v_fmac_f32 v148,s88,v91
v_fma_f32 v115,s92,v83,v148
v_fma_f32 v123,-s92,v83,v148
v_cvt_pk_bf16_f32 v124,v68,v69
v_cvt_pk_bf16_f32 v125,v70,v71
v_cvt_pk_bf16_f32 v126,v72,v73
v_cvt_pk_bf16_f32 v127,v74,v75
s_add_u32 s89,s87,0
buffer_store_dwordx4 v[124:127],v150,s[20:23],s89 offen sc1
v_cvt_pk_bf16_f32 v144,v84,v85
v_cvt_pk_bf16_f32 v145,v86,v87
v_cvt_pk_bf16_f32 v146,v88,v89
v_cvt_pk_bf16_f32 v147,v90,v91
s_add_u32 s89,s87,46080
buffer_store_dwordx4 v[144:147],v150,s[20:23],s89 offen sc1
v_cvt_pk_bf16_f32 v128,v92,v93
v_cvt_pk_bf16_f32 v129,v94,v95
v_cvt_pk_bf16_f32 v130,v96,v97
v_cvt_pk_bf16_f32 v131,v98,v99
s_add_u32 s89,s87,9216
buffer_store_dwordx4 v[128:131],v150,s[20:23],s89 offen sc1
v_cvt_pk_bf16_f32 v132,v100,v101
v_cvt_pk_bf16_f32 v133,v102,v103
v_cvt_pk_bf16_f32 v134,v104,v105
v_cvt_pk_bf16_f32 v135,v106,v107
s_add_u32 s89,s87,18432
buffer_store_dwordx4 v[132:135],v150,s[20:23],s89 offen sc1
v_cvt_pk_bf16_f32 v136,v108,v109
v_cvt_pk_bf16_f32 v137,v110,v111
v_cvt_pk_bf16_f32 v138,v112,v113
v_cvt_pk_bf16_f32 v139,v114,v115
s_add_u32 s89,s87,27648
buffer_store_dwordx4 v[136:139],v150,s[20:23],s89 offen sc1
v_cvt_pk_bf16_f32 v140,v116,v117
v_cvt_pk_bf16_f32 v141,v118,v119
v_cvt_pk_bf16_f32 v142,v120,v121
v_cvt_pk_bf16_f32 v143,v122,v123
s_add_u32 s89,s87,36864
buffer_store_dwordx4 v[140:143],v150,s[20:23],s89 offen sc1
s_waitcnt vmcnt(0)
s_add_u32 s84,s84,1
s_cmp_lt_u32 s84,216
s_cbranch_scc1 L_itemF
s_branch L_uready
.section .rodata,"a"
.p2align 6
.amdhsa_kernel standalone__winograd__vision_kernel
  .amdhsa_next_free_vgpr 512
  .amdhsa_next_free_sgpr 96
  .amdhsa_accum_offset 256
  .amdhsa_group_segment_fixed_size 0
  .amdhsa_kernarg_size 40
  .amdhsa_user_sgpr_count 2
  .amdhsa_user_sgpr_kernarg_segment_ptr 1
  .amdhsa_system_sgpr_workgroup_id_x 1
  .amdhsa_float_denorm_mode_32 3
.end_amdhsa_kernel
```

```asm
; @launch grid=(256,1,1) block=(256,1,1) lds=156672
.amdgcn_target "amdgcn-amd-amdhsa--gfx950"
.macro M d,a,b,c
v_mfma_f32_16x16x32_bf16 \d,\a,\b,\c
.endm
.text
.globl standalone__winograd__vision_kernel
.p2align 8
.type standalone__winograd__vision_kernel,@function
standalone__winograd__vision_kernel:
s_cmp_ge_u32 s2,256
s_cbranch_scc0 L_go
s_endpgm
L_go:
s_load_dwordx4 s[4:7],s[0:1],0
s_load_dwordx4 s[24:27],s[0:1],16
s_load_dwordx2 s[52:53],s[0:1],32
v_lshrrev_b32 v60,6,v0
v_and_b32 v64,63,v0
v_readfirstlane_b32 s50,v60
v_lshrrev_b32 v60,4,v64
v_bfe_u32 v61,v64,3,1
v_lshl_add_u32 v61,v60,3,v61
v_and_b32 v62,7,v64
v_mul_u32_u24 v241,196608,v61
v_lshl_add_u32 v241,v62,3,v241
v_lshlrev_b32 v247,4,v0
s_and_b32 s54,s2,7
s_lshr_b32 s55,s2,3
s_lshl_b32 s49,s54,6
s_lshl_b32 s55,s55,4
s_lshl_b32 s56,s50,2
s_add_u32 s56,s56,s55
s_mul_i32 s31,s56,384
s_mul_i32 s57,s49,196608
s_add_u32 s30,s57,s31
s_mul_i32 s44,s50,330752
s_mov_b32 s58,0
s_add_u32 s59,s58,0
s_mul_i32 s60,s59,55296
s_lshl_b32 s59,s59,6
s_add_u32 s64,s30,s59
s_add_u32 s70,s31,s59
s_add_u32 s76,s44,s60
s_add_u32 s59,s58,1
s_mul_i32 s60,s59,55296
s_lshl_b32 s59,s59,6
s_add_u32 s65,s30,s59
s_add_u32 s71,s31,s59
s_add_u32 s77,s44,s60
s_add_u32 s59,s58,2
s_mul_i32 s60,s59,55296
s_lshl_b32 s59,s59,6
s_add_u32 s66,s30,s59
s_add_u32 s72,s31,s59
s_add_u32 s78,s44,s60
s_add_u32 s59,s58,3
s_mul_i32 s60,s59,55296
s_lshl_b32 s59,s59,6
s_add_u32 s67,s30,s59
s_add_u32 s73,s31,s59
s_add_u32 s79,s44,s60
s_add_u32 s59,s58,4
s_mul_i32 s60,s59,55296
s_lshl_b32 s59,s59,6
s_add_u32 s68,s30,s59
s_add_u32 s74,s31,s59
s_add_u32 s80,s44,s60
s_add_u32 s59,s58,5
s_cmp_eq_u32 s59,6
s_cselect_b32 s59,0,s59
s_mul_i32 s60,s59,55296
s_lshl_b32 s59,s59,6
s_add_u32 s69,s30,s59
s_add_u32 s75,s31,s59
s_add_u32 s81,s44,s60
s_waitcnt lgkmcnt(0)
s_mov_b32 s20,s52
s_and_b32 s21,s53,0xffff
s_mov_b32 s22,1327104
s_mov_b32 s23,0x20000
s_mov_b32 s36,s6
s_and_b32 s37,s7,0xffff
s_mov_b32 s38,663552
s_mov_b32 s39,0x20000
s_mov_b32 s60,s26
s_and_b32 s61,s27,0xffff
s_mov_b32 s62,0
s_mov_b32 s63,0x20000
s_mov_b32 s52,s26
s_mov_b32 s53,s27
v_mov_b32 v66,1
s_cmp_lt_u32 s2,54
s_cbranch_scc0 L_noitem
s_lshl_b32 s84,s2,2
s_add_u32 s84,s84,s50
s_mov_b32 s62,256
L_itemP:
s_and_b32 s85,s84,3
s_lshr_b32 s86,s84,2
s_mul_hi_u32 s87,s86,0x55555556
s_mul_i32 s88,s87,3
s_sub_u32 s86,s86,s88
s_mul_hi_u32 s88,s87,0x2aaaaaab
s_mul_i32 s89,s88,6
s_sub_u32 s87,s87,s89
s_mul_i32 s89,s86,221184
s_mul_i32 s90,s87,12288
s_add_u32 s89,s89,s90
s_mul_i32 s90,s85,3072
s_add_u32 s89,s89,s90
s_lshl_b32 s90,s88,7
s_add_u32 s89,s89,s90
s_add_u32 s90,s89,73728
s_add_u32 s91,s90,73728
v_lshlrev_b32 v149,1,v64
buffer_load_short_d16_hi v68,v149,s[36:39],s89 offen offset:0
buffer_load_short_d16_hi v69,v149,s[36:39],s89 offen offset:384
buffer_load_short_d16_hi v70,v149,s[36:39],s89 offen offset:768
buffer_load_short_d16_hi v71,v149,s[36:39],s89 offen offset:1152
buffer_load_short_d16_hi v72,v149,s[36:39],s89 offen offset:1536
buffer_load_short_d16_hi v73,v149,s[36:39],s89 offen offset:1920
buffer_load_short_d16_hi v74,v149,s[36:39],s89 offen offset:2304
buffer_load_short_d16_hi v75,v149,s[36:39],s89 offen offset:2688
buffer_load_short_d16_hi v76,v149,s[36:39],s90 offen offset:0
buffer_load_short_d16_hi v77,v149,s[36:39],s90 offen offset:384
buffer_load_short_d16_hi v78,v149,s[36:39],s90 offen offset:768
buffer_load_short_d16_hi v79,v149,s[36:39],s90 offen offset:1152
buffer_load_short_d16_hi v80,v149,s[36:39],s90 offen offset:1536
buffer_load_short_d16_hi v81,v149,s[36:39],s90 offen offset:1920
buffer_load_short_d16_hi v82,v149,s[36:39],s90 offen offset:2304
buffer_load_short_d16_hi v83,v149,s[36:39],s90 offen offset:2688
buffer_load_short_d16_hi v84,v149,s[36:39],s91 offen offset:0
buffer_load_short_d16_hi v85,v149,s[36:39],s91 offen offset:384
buffer_load_short_d16_hi v86,v149,s[36:39],s91 offen offset:768
buffer_load_short_d16_hi v87,v149,s[36:39],s91 offen offset:1152
buffer_load_short_d16_hi v88,v149,s[36:39],s91 offen offset:1536
buffer_load_short_d16_hi v89,v149,s[36:39],s91 offen offset:1920
buffer_load_short_d16_hi v90,v149,s[36:39],s91 offen offset:2304
buffer_load_short_d16_hi v91,v149,s[36:39],s91 offen offset:2688
v_lshrrev_b32 v150,4,v64
v_mul_u32_u24 v150,331776,v150
v_and_b32 v148,15,v64
v_lshl_add_u32 v150,v148,4,v150
s_mul_i32 s87,s87,55296
s_mul_i32 s88,s88,3072
s_add_u32 s87,s87,s88
s_lshl_b32 s86,s86,10
s_add_u32 s87,s87,s86
s_lshl_b32 s85,s85,8
s_add_u32 s87,s87,s85
s_mov_b32 s85,0xbe2aaaab
s_mov_b32 s86,0x3d2aaaab
s_mov_b32 s88,0x3e2aaaab
s_mov_b32 s92,0x3daaaaab
s_waitcnt vmcnt(0)
v_add_f32 v148,v68,v84
v_add_f32 v92,v148,v76
v_sub_f32 v100,v148,v76
v_mul_f32 v92,s85,v92
v_mul_f32 v100,s85,v100
v_mul_f32 v148,s86,v68
v_fmac_f32 v148,s88,v84
v_fma_f32 v108,s92,v76,v148
v_fma_f32 v116,-s92,v76,v148
v_add_f32 v148,v69,v85
v_add_f32 v93,v148,v77
v_sub_f32 v101,v148,v77
v_mul_f32 v93,s85,v93
v_mul_f32 v101,s85,v101
v_mul_f32 v148,s86,v69
v_fmac_f32 v148,s88,v85
v_fma_f32 v109,s92,v77,v148
v_fma_f32 v117,-s92,v77,v148
v_add_f32 v148,v70,v86
v_add_f32 v94,v148,v78
v_sub_f32 v102,v148,v78
v_mul_f32 v94,s85,v94
v_mul_f32 v102,s85,v102
v_mul_f32 v148,s86,v70
v_fmac_f32 v148,s88,v86
v_fma_f32 v110,s92,v78,v148
v_fma_f32 v118,-s92,v78,v148
v_add_f32 v148,v71,v87
v_add_f32 v95,v148,v79
v_sub_f32 v103,v148,v79
v_mul_f32 v95,s85,v95
v_mul_f32 v103,s85,v103
v_mul_f32 v148,s86,v71
v_fmac_f32 v148,s88,v87
v_fma_f32 v111,s92,v79,v148
v_fma_f32 v119,-s92,v79,v148
v_add_f32 v148,v72,v88
v_add_f32 v96,v148,v80
v_sub_f32 v104,v148,v80
v_mul_f32 v96,s85,v96
v_mul_f32 v104,s85,v104
v_mul_f32 v148,s86,v72
v_fmac_f32 v148,s88,v88
v_fma_f32 v112,s92,v80,v148
v_fma_f32 v120,-s92,v80,v148
v_add_f32 v148,v73,v89
v_add_f32 v97,v148,v81
v_sub_f32 v105,v148,v81
v_mul_f32 v97,s85,v97
v_mul_f32 v105,s85,v105
v_mul_f32 v148,s86,v73
v_fmac_f32 v148,s88,v89
v_fma_f32 v113,s92,v81,v148
v_fma_f32 v121,-s92,v81,v148
v_add_f32 v148,v74,v90
v_add_f32 v98,v148,v82
v_sub_f32 v106,v148,v82
v_mul_f32 v98,s85,v98
v_mul_f32 v106,s85,v106
v_mul_f32 v148,s86,v74
v_fmac_f32 v148,s88,v90
v_fma_f32 v114,s92,v82,v148
v_fma_f32 v122,-s92,v82,v148
v_add_f32 v148,v75,v91
v_add_f32 v99,v148,v83
v_sub_f32 v107,v148,v83
v_mul_f32 v99,s85,v99
v_mul_f32 v107,s85,v107
v_mul_f32 v148,s86,v75
v_fmac_f32 v148,s88,v91
v_fma_f32 v115,s92,v83,v148
v_fma_f32 v123,-s92,v83,v148
v_cvt_pk_bf16_f32 v124,v68,v69
v_cvt_pk_bf16_f32 v125,v70,v71
v_cvt_pk_bf16_f32 v126,v72,v73
v_cvt_pk_bf16_f32 v127,v74,v75
s_add_u32 s89,s87,0
buffer_store_dwordx4 v[124:127],v150,s[20:23],s89 offen sc1
v_cvt_pk_bf16_f32 v144,v84,v85
v_cvt_pk_bf16_f32 v145,v86,v87
v_cvt_pk_bf16_f32 v146,v88,v89
v_cvt_pk_bf16_f32 v147,v90,v91
s_add_u32 s89,s87,46080
buffer_store_dwordx4 v[144:147],v150,s[20:23],s89 offen sc1
v_cvt_pk_bf16_f32 v128,v92,v93
v_cvt_pk_bf16_f32 v129,v94,v95
v_cvt_pk_bf16_f32 v130,v96,v97
v_cvt_pk_bf16_f32 v131,v98,v99
s_add_u32 s89,s87,9216
buffer_store_dwordx4 v[128:131],v150,s[20:23],s89 offen sc1
v_cvt_pk_bf16_f32 v132,v100,v101
v_cvt_pk_bf16_f32 v133,v102,v103
v_cvt_pk_bf16_f32 v134,v104,v105
v_cvt_pk_bf16_f32 v135,v106,v107
s_add_u32 s89,s87,18432
buffer_store_dwordx4 v[132:135],v150,s[20:23],s89 offen sc1
v_cvt_pk_bf16_f32 v136,v108,v109
v_cvt_pk_bf16_f32 v137,v110,v111
v_cvt_pk_bf16_f32 v138,v112,v113
v_cvt_pk_bf16_f32 v139,v114,v115
s_add_u32 s89,s87,27648
buffer_store_dwordx4 v[136:139],v150,s[20:23],s89 offen sc1
v_cvt_pk_bf16_f32 v140,v116,v117
v_cvt_pk_bf16_f32 v141,v118,v119
v_cvt_pk_bf16_f32 v142,v120,v121
v_cvt_pk_bf16_f32 v143,v122,v123
s_add_u32 s89,s87,36864
buffer_store_dwordx4 v[140:143],v150,s[20:23],s89 offen sc1
L_noitem:
s_and_b32 s94,s50,1
s_waitcnt vmcnt(0)
s_lshl_b32 s85,s94,6
s_lshl_b32 s84,s94,2
s_mov_b64 exec,1
buffer_atomic_add v66,off,s[60:63],s85 sc0 sc1
s_mov_b64 exec,-1
s_and_b32 s5,s5,0xffff
s_sub_u32 s8,s4,196608
s_subb_u32 s9,s5,0
s_mov_b32 s10,100859904
s_mov_b32 s11,0x20000
s_sub_u32 s12,s4,196992
s_subb_u32 s13,s5,0
s_cmp_eq_u32 s56,0
s_cselect_b32 s14,0,100860288
s_mov_b32 s15,0x20000
s_mov_b32 s16,s8
s_mov_b32 s17,s9
s_cmp_eq_u32 s56,508
s_cselect_b32 s18,0,100859904
s_mov_b32 s19,0x20000
s_cmp_eq_u32 s49,0
s_cselect_b32 s58,8,0
v_cmp_gt_u32 vcc,s58,v64
v_lshrrev_b32 v63,5,v64
v_add_u32 v63,32,v63
v_mul_u32_u24 v242,196608,v63
v_bfrev_b32 v63,1
v_cndmask_b32 v250,v241,v63,vcc
v_bfe_u32 v63,v247,3,6
v_add_u32 v242,v242,v63
s_add_u32 s28,s64,0
buffer_load_dwordx2 v[0:1],v250,s[12:15],s28 offen offset:0
buffer_load_dwordx2 v[10:11],v250,s[16:19],s28 offen offset:1536
buffer_load_dwordx2 v[2:3],v250,s[8:11],s28 offen offset:0
buffer_load_dwordx2 v[4:5],v250,s[8:11],s28 offen offset:384
buffer_load_dwordx2 v[6:7],v250,s[8:11],s28 offen offset:768
buffer_load_dwordx2 v[8:9],v250,s[8:11],s28 offen offset:1152
s_mov_b64 exec,1
s_waitcnt vmcnt(6)
v_cmp_eq_u32 vcc,107,v66
v_mov_b32 v65,1
s_nop 2
s_and_b64 exec,exec,vcc
s_cselect_b32 s62,s62,0
s_mov_b64 exec,1
buffer_store_dword v65,off,s[60:63],s84 offset:128 sc1
s_mov_b64 exec,-1
s_add_u32 s28,s64,393216
buffer_load_dwordx2 v[12:13],v241,s[12:15],s28 offen offset:0
buffer_load_dwordx2 v[22:23],v241,s[16:19],s28 offen offset:1536
buffer_load_dwordx2 v[14:15],v241,s[8:11],s28 offen offset:0
buffer_load_dwordx2 v[16:17],v241,s[8:11],s28 offen offset:384
buffer_load_dwordx2 v[18:19],v241,s[8:11],s28 offen offset:768
buffer_load_dwordx2 v[20:21],v241,s[8:11],s28 offen offset:1152
s_add_u32 s28,s64,786432
buffer_load_dwordx2 v[24:25],v241,s[12:15],s28 offen offset:0
buffer_load_dwordx2 v[34:35],v241,s[16:19],s28 offen offset:1536
buffer_load_dwordx2 v[26:27],v241,s[8:11],s28 offen offset:0
buffer_load_dwordx2 v[28:29],v241,s[8:11],s28 offen offset:384
buffer_load_dwordx2 v[30:31],v241,s[8:11],s28 offen offset:768
buffer_load_dwordx2 v[32:33],v241,s[8:11],s28 offen offset:1152
s_add_u32 s28,s64,1179648
buffer_load_dwordx2 v[36:37],v241,s[12:15],s28 offen offset:0
buffer_load_dwordx2 v[46:47],v241,s[16:19],s28 offen offset:1536
buffer_load_dwordx2 v[38:39],v241,s[8:11],s28 offen offset:0
buffer_load_dwordx2 v[40:41],v241,s[8:11],s28 offen offset:384
buffer_load_dwordx2 v[42:43],v241,s[8:11],s28 offen offset:768
buffer_load_dwordx2 v[44:45],v241,s[8:11],s28 offen offset:1152
s_add_u32 s29,s64,0
buffer_load_short_d16_hi v48,v242,s[12:15],s29 offen offset:0
buffer_load_short_d16_hi v49,v242,s[8:11],s29 offen offset:0
buffer_load_short_d16_hi v50,v242,s[8:11],s29 offen offset:384
buffer_load_short_d16_hi v51,v242,s[8:11],s29 offen offset:768
buffer_load_short_d16_hi v52,v242,s[8:11],s29 offen offset:1152
buffer_load_short_d16_hi v53,v242,s[16:19],s29 offen offset:1536
s_getpc_b64 s[82:83]
L_pc:
s_lshr_b32 s84,s2,3
s_lshl_b32 s84,s84,2
s_add_u32 s84,s84,s50
s_lshl_b32 s84,s84,10
v_and_b32 v65,7,v64
v_lshl_add_u32 v65,v65,7,s84
v_min_u32 v65,L_code_end-L_pc-4,v65
global_load_dword v67,v65,s[82:83]
v_mov_b32 v252,v65
s_and_b32 s25,s25,0xffff
s_mov_b32 s26,100663296
s_mov_b32 s27,0x20000
s_mov_b32 s41,0xc0a00000
s_mov_b32 s40,0x41000000
s_mov_b32 s42,0xffff0000
s_mov_b32 s43,0xbfa00000
s_mov_b32 s45,0x3e800000
s_mul_i32 s58,s55,384
s_add_u32 s58,s57,s58
s_lshr_b32 s59,s50,1
s_mul_i32 s32,s59,384
s_mul_i32 s33,s59,196608
s_add_u32 s32,s32,s58
s_add_u32 s33,s33,s58
s_lshl_b32 s59,s50,7
s_lshr_b32 s58,s50,1
s_lshl_b32 s58,s58,5
s_mov_b32 s56,768
v_lshlrev_b32 v243,11,v60
v_xor_b32 v63,v60,v61
v_and_b32 v63,1,v63
v_lshl_add_u32 v243,v63,6,v243
v_lshlrev_b32 v63,3,v62
v_xor_b32 v63,s58,v63
v_add3_u32 v243,v243,v63,s59
v_lshrrev_b32 v60,5,v64
v_lshlrev_b32 v60,6,v60
v_bfe_u32 v61,v247,3,6
v_xor_b32 v61,s58,v61
v_add3_u32 v244,v60,v61,s59
v_add_u32 v244,8192,v244
v_bfe_u32 v60,v64,2,2
v_and_b32 v61,3,v64
v_lshrrev_b32 v62,4,v64
v_lshlrev_b32 v245,11,v60
v_lshl_add_u32 v245,v61,7,v245
v_and_b32 v63,1,v60
v_lshl_add_u32 v245,v63,6,v245
v_and_b32 v63,2,v61
v_xor_b32 v63,v63,v62
v_lshl_add_u32 v245,v63,4,v245
v_xor_b32 v246,64,v245
v_lshrrev_b32 v60,1,v62
v_lshl_add_u32 v60,s50,1,v60
v_and_b32 v61,7,v64
v_xor_b32 v60,v60,v61
v_and_b32 v63,15,v64
v_lshlrev_b32 v249,7,v63
v_lshl_add_u32 v249,v60,4,v249
v_and_b32 v63,1,v62
v_lshl_add_u32 v249,v63,3,v249
v_bfe_u32 v60,v247,7,4
v_lshrrev_b32 v62,2,v60
v_mul_u32_u24 v248,1572864,v62
v_and_b32 v62,3,v60
v_mul_u32_u24 v62,1536,v62
v_and_b32 v60,7,v60
v_xor_b32 v60,v60,v61
v_lshl_add_u32 v60,v60,4,v62
v_add_u32 v248,v248,v60
s_waitcnt vmcnt(28)
v_lshlrev_b32 v230,16,v4
v_lshlrev_b32 v228,16,v0
v_lshlrev_b32 v229,16,v2
v_lshlrev_b32 v233,16,v10
s_waitcnt vmcnt(26)
v_lshlrev_b32 v232,16,v8
v_lshlrev_b32 v231,16,v6
v_fmac_f32 v228,s43,v230
v_fmac_f32 v233,4.0,v229
v_fma_f32 v234,-4.0,v230,v232
v_fmac_f32 v228,s45,v232
v_fmac_f32 v233,s41,v231
v_sub_f32 v232,v232,v230
v_fma_f32 v230,-4.0,v229,v231
v_sub_f32 v231,v231,v229
v_add_f32 v229,v234,v230
v_sub_f32 v234,v234,v230
v_fma_f32 v230,2.0,v231,v232
v_fmac_f32 v232,-2.0,v231
v_and_b32 v4,s42,v4
v_and_b32 v0,s42,v0
v_and_b32 v2,s42,v2
v_and_b32 v10,s42,v10
v_and_b32 v8,s42,v8
v_and_b32 v6,s42,v6
v_fmac_f32 v0,s43,v4
v_fmac_f32 v10,4.0,v2
v_fma_f32 v231,-4.0,v4,v8
v_fmac_f32 v0,s45,v8
v_fmac_f32 v10,s41,v6
v_sub_f32 v8,v8,v4
v_fma_f32 v4,-4.0,v2,v6
v_sub_f32 v6,v6,v2
v_add_f32 v2,v231,v4
v_sub_f32 v231,v231,v4
v_fma_f32 v4,2.0,v6,v8
v_fmac_f32 v8,-2.0,v6
v_cvt_pk_bf16_f32 v0,v228,v0
v_cvt_pk_bf16_f32 v10,v233,v10
v_cvt_pk_bf16_f32 v2,v229,v2
v_cvt_pk_bf16_f32 v6,v230,v4
v_cvt_pk_bf16_f32 v4,v234,v231
v_cvt_pk_bf16_f32 v8,v232,v8
v_lshlrev_b32 v230,16,v5
v_lshlrev_b32 v228,16,v1
v_lshlrev_b32 v229,16,v3
v_lshlrev_b32 v233,16,v11
v_lshlrev_b32 v232,16,v9
v_lshlrev_b32 v231,16,v7
v_fmac_f32 v228,s43,v230
v_fmac_f32 v233,4.0,v229
v_fma_f32 v234,-4.0,v230,v232
v_fmac_f32 v228,s45,v232
v_fmac_f32 v233,s41,v231
v_sub_f32 v232,v232,v230
v_fma_f32 v230,-4.0,v229,v231
v_sub_f32 v231,v231,v229
v_add_f32 v229,v234,v230
v_sub_f32 v234,v234,v230
v_fma_f32 v230,2.0,v231,v232
v_fmac_f32 v232,-2.0,v231
v_and_b32 v5,s42,v5
v_and_b32 v1,s42,v1
v_and_b32 v3,s42,v3
v_and_b32 v11,s42,v11
v_and_b32 v9,s42,v9
v_and_b32 v7,s42,v7
v_fmac_f32 v1,s43,v5
v_fmac_f32 v11,4.0,v3
v_fma_f32 v231,-4.0,v5,v9
v_fmac_f32 v1,s45,v9
v_fmac_f32 v11,s41,v7
v_sub_f32 v9,v9,v5
v_fma_f32 v5,-4.0,v3,v7
v_sub_f32 v7,v7,v3
v_add_f32 v3,v231,v5
v_sub_f32 v231,v231,v5
v_fma_f32 v5,2.0,v7,v9
v_fmac_f32 v9,-2.0,v7
v_cvt_pk_bf16_f32 v1,v228,v1
v_cvt_pk_bf16_f32 v11,v233,v11
v_cvt_pk_bf16_f32 v3,v229,v3
v_cvt_pk_bf16_f32 v7,v230,v5
v_cvt_pk_bf16_f32 v5,v234,v231
v_cvt_pk_bf16_f32 v9,v232,v9
ds_write2st64_b64 v243,v[0:1],v[10:11] offset0:0 offset1:17
ds_write2st64_b64 v243,v[2:3],v[4:5] offset0:34 offset1:51
ds_write2st64_b64 v243,v[6:7],v[8:9] offset0:68 offset1:85
s_waitcnt vmcnt(21)
v_lshlrev_b32 v230,16,v16
v_lshlrev_b32 v228,16,v12
v_lshlrev_b32 v229,16,v14
v_lshlrev_b32 v233,16,v22
s_waitcnt vmcnt(19)
v_lshlrev_b32 v232,16,v20
v_lshlrev_b32 v231,16,v18
v_fmac_f32 v228,s43,v230
v_fmac_f32 v233,4.0,v229
v_fma_f32 v234,-4.0,v230,v232
v_fmac_f32 v228,s45,v232
v_fmac_f32 v233,s41,v231
v_sub_f32 v232,v232,v230
v_fma_f32 v230,-4.0,v229,v231
v_sub_f32 v231,v231,v229
v_add_f32 v229,v234,v230
v_sub_f32 v234,v234,v230
v_fma_f32 v230,2.0,v231,v232
v_fmac_f32 v232,-2.0,v231
v_and_b32 v16,s42,v16
v_and_b32 v12,s42,v12
v_and_b32 v14,s42,v14
v_and_b32 v22,s42,v22
v_and_b32 v20,s42,v20
v_and_b32 v18,s42,v18
v_fmac_f32 v12,s43,v16
v_fmac_f32 v22,4.0,v14
v_fma_f32 v231,-4.0,v16,v20
v_fmac_f32 v12,s45,v20
v_fmac_f32 v22,s41,v18
v_sub_f32 v20,v20,v16
v_fma_f32 v16,-4.0,v14,v18
v_sub_f32 v18,v18,v14
v_add_f32 v14,v231,v16
v_sub_f32 v231,v231,v16
v_fma_f32 v16,2.0,v18,v20
v_fmac_f32 v20,-2.0,v18
v_cvt_pk_bf16_f32 v12,v228,v12
v_cvt_pk_bf16_f32 v22,v233,v22
v_cvt_pk_bf16_f32 v14,v229,v14
v_cvt_pk_bf16_f32 v18,v230,v16
v_cvt_pk_bf16_f32 v16,v234,v231
v_cvt_pk_bf16_f32 v20,v232,v20
v_lshlrev_b32 v230,16,v17
v_lshlrev_b32 v228,16,v13
v_lshlrev_b32 v229,16,v15
v_lshlrev_b32 v233,16,v23
v_lshlrev_b32 v232,16,v21
v_lshlrev_b32 v231,16,v19
v_fmac_f32 v228,s43,v230
v_fmac_f32 v233,4.0,v229
v_fma_f32 v234,-4.0,v230,v232
v_fmac_f32 v228,s45,v232
v_fmac_f32 v233,s41,v231
v_sub_f32 v232,v232,v230
v_fma_f32 v230,-4.0,v229,v231
v_sub_f32 v231,v231,v229
v_add_f32 v229,v234,v230
v_sub_f32 v234,v234,v230
v_fma_f32 v230,2.0,v231,v232
v_fmac_f32 v232,-2.0,v231
v_and_b32 v17,s42,v17
v_and_b32 v13,s42,v13
v_and_b32 v15,s42,v15
v_and_b32 v23,s42,v23
v_and_b32 v21,s42,v21
v_and_b32 v19,s42,v19
v_fmac_f32 v13,s43,v17
v_fmac_f32 v23,4.0,v15
v_fma_f32 v231,-4.0,v17,v21
v_fmac_f32 v13,s45,v21
v_fmac_f32 v23,s41,v19
v_sub_f32 v21,v21,v17
v_fma_f32 v17,-4.0,v15,v19
v_sub_f32 v19,v19,v15
v_add_f32 v15,v231,v17
v_sub_f32 v231,v231,v17
v_fma_f32 v17,2.0,v19,v21
v_fmac_f32 v21,-2.0,v19
v_cvt_pk_bf16_f32 v13,v228,v13
v_cvt_pk_bf16_f32 v23,v233,v23
v_cvt_pk_bf16_f32 v15,v229,v15
v_cvt_pk_bf16_f32 v19,v230,v17
v_cvt_pk_bf16_f32 v17,v234,v231
v_cvt_pk_bf16_f32 v21,v232,v21
ds_write2st64_b64 v243,v[12:13],v[22:23] offset0:1 offset1:18
ds_write2st64_b64 v243,v[14:15],v[16:17] offset0:35 offset1:52
ds_write2st64_b64 v243,v[18:19],v[20:21] offset0:69 offset1:86
s_add_u32 s28,s65,0
buffer_load_dwordx2 v[192:193],v250,s[12:15],s28 offen offset:0
buffer_load_dwordx2 v[202:203],v250,s[16:19],s28 offen offset:1536
buffer_load_dwordx2 v[194:195],v250,s[8:11],s28 offen offset:0
buffer_load_dwordx2 v[196:197],v250,s[8:11],s28 offen offset:384
buffer_load_dwordx2 v[198:199],v250,s[8:11],s28 offen offset:768
buffer_load_dwordx2 v[200:201],v250,s[8:11],s28 offen offset:1152
s_add_u32 s28,s65,393216
buffer_load_dwordx2 v[204:205],v241,s[12:15],s28 offen offset:0
buffer_load_dwordx2 v[214:215],v241,s[16:19],s28 offen offset:1536
buffer_load_dwordx2 v[206:207],v241,s[8:11],s28 offen offset:0
buffer_load_dwordx2 v[208:209],v241,s[8:11],s28 offen offset:384
buffer_load_dwordx2 v[210:211],v241,s[8:11],s28 offen offset:768
buffer_load_dwordx2 v[212:213],v241,s[8:11],s28 offen offset:1152
s_add_u32 s29,s65,0
buffer_load_short_d16_hi v235,v242,s[12:15],s29 offen offset:0
buffer_load_short_d16_hi v236,v242,s[8:11],s29 offen offset:0
buffer_load_short_d16_hi v237,v242,s[8:11],s29 offen offset:384
buffer_load_short_d16_hi v238,v242,s[8:11],s29 offen offset:768
buffer_load_short_d16_hi v239,v242,s[8:11],s29 offen offset:1152
buffer_load_short_d16_hi v240,v242,s[16:19],s29 offen offset:1536
s_waitcnt vmcnt(33)
v_lshlrev_b32 v230,16,v28
v_lshlrev_b32 v228,16,v24
v_lshlrev_b32 v229,16,v26
v_lshlrev_b32 v233,16,v34
s_waitcnt vmcnt(31)
v_lshlrev_b32 v232,16,v32
v_lshlrev_b32 v231,16,v30
v_fmac_f32 v228,s43,v230
v_fmac_f32 v233,4.0,v229
v_fma_f32 v234,-4.0,v230,v232
v_fmac_f32 v228,s45,v232
v_fmac_f32 v233,s41,v231
v_sub_f32 v232,v232,v230
v_fma_f32 v230,-4.0,v229,v231
v_sub_f32 v231,v231,v229
v_add_f32 v229,v234,v230
v_sub_f32 v234,v234,v230
v_fma_f32 v230,2.0,v231,v232
v_fmac_f32 v232,-2.0,v231
v_and_b32 v28,s42,v28
v_and_b32 v24,s42,v24
v_and_b32 v26,s42,v26
v_and_b32 v34,s42,v34
v_and_b32 v32,s42,v32
v_and_b32 v30,s42,v30
v_fmac_f32 v24,s43,v28
v_fmac_f32 v34,4.0,v26
v_fma_f32 v231,-4.0,v28,v32
v_fmac_f32 v24,s45,v32
v_fmac_f32 v34,s41,v30
v_sub_f32 v32,v32,v28
v_fma_f32 v28,-4.0,v26,v30
v_sub_f32 v30,v30,v26
v_add_f32 v26,v231,v28
v_sub_f32 v231,v231,v28
v_fma_f32 v28,2.0,v30,v32
v_fmac_f32 v32,-2.0,v30
v_cvt_pk_bf16_f32 v24,v228,v24
v_cvt_pk_bf16_f32 v34,v233,v34
v_cvt_pk_bf16_f32 v26,v229,v26
v_cvt_pk_bf16_f32 v30,v230,v28
v_cvt_pk_bf16_f32 v28,v234,v231
v_cvt_pk_bf16_f32 v32,v232,v32
v_lshlrev_b32 v230,16,v29
v_lshlrev_b32 v228,16,v25
v_lshlrev_b32 v229,16,v27
v_lshlrev_b32 v233,16,v35
v_lshlrev_b32 v232,16,v33
v_lshlrev_b32 v231,16,v31
v_fmac_f32 v228,s43,v230
v_fmac_f32 v233,4.0,v229
v_fma_f32 v234,-4.0,v230,v232
v_fmac_f32 v228,s45,v232
v_fmac_f32 v233,s41,v231
v_sub_f32 v232,v232,v230
v_fma_f32 v230,-4.0,v229,v231
v_sub_f32 v231,v231,v229
v_add_f32 v229,v234,v230
v_sub_f32 v234,v234,v230
v_fma_f32 v230,2.0,v231,v232
v_fmac_f32 v232,-2.0,v231
v_and_b32 v29,s42,v29
v_and_b32 v25,s42,v25
v_and_b32 v27,s42,v27
v_and_b32 v35,s42,v35
v_and_b32 v33,s42,v33
v_and_b32 v31,s42,v31
v_fmac_f32 v25,s43,v29
v_fmac_f32 v35,4.0,v27
v_fma_f32 v231,-4.0,v29,v33
v_fmac_f32 v25,s45,v33
v_fmac_f32 v35,s41,v31
v_sub_f32 v33,v33,v29
v_fma_f32 v29,-4.0,v27,v31
v_sub_f32 v31,v31,v27
v_add_f32 v27,v231,v29
v_sub_f32 v231,v231,v29
v_fma_f32 v29,2.0,v31,v33
v_fmac_f32 v33,-2.0,v31
v_cvt_pk_bf16_f32 v25,v228,v25
v_cvt_pk_bf16_f32 v35,v233,v35
v_cvt_pk_bf16_f32 v27,v229,v27
v_cvt_pk_bf16_f32 v31,v230,v29
v_cvt_pk_bf16_f32 v29,v234,v231
v_cvt_pk_bf16_f32 v33,v232,v33
ds_write2st64_b64 v243,v[24:25],v[34:35] offset0:2 offset1:19
ds_write2st64_b64 v243,v[26:27],v[28:29] offset0:36 offset1:53
ds_write2st64_b64 v243,v[30:31],v[32:33] offset0:70 offset1:87
s_waitcnt vmcnt(27)
v_lshlrev_b32 v230,16,v40
v_lshlrev_b32 v228,16,v36
v_lshlrev_b32 v229,16,v38
v_lshlrev_b32 v233,16,v46
s_waitcnt vmcnt(25)
v_lshlrev_b32 v232,16,v44
v_lshlrev_b32 v231,16,v42
v_fmac_f32 v228,s43,v230
v_fmac_f32 v233,4.0,v229
v_fma_f32 v234,-4.0,v230,v232
v_fmac_f32 v228,s45,v232
v_fmac_f32 v233,s41,v231
v_sub_f32 v232,v232,v230
v_fma_f32 v230,-4.0,v229,v231
v_sub_f32 v231,v231,v229
v_add_f32 v229,v234,v230
v_sub_f32 v234,v234,v230
v_fma_f32 v230,2.0,v231,v232
v_fmac_f32 v232,-2.0,v231
v_and_b32 v40,s42,v40
v_and_b32 v36,s42,v36
v_and_b32 v38,s42,v38
v_and_b32 v46,s42,v46
v_and_b32 v44,s42,v44
v_and_b32 v42,s42,v42
v_fmac_f32 v36,s43,v40
v_fmac_f32 v46,4.0,v38
v_fma_f32 v231,-4.0,v40,v44
v_fmac_f32 v36,s45,v44
v_fmac_f32 v46,s41,v42
v_sub_f32 v44,v44,v40
v_fma_f32 v40,-4.0,v38,v42
v_sub_f32 v42,v42,v38
v_add_f32 v38,v231,v40
v_sub_f32 v231,v231,v40
v_fma_f32 v40,2.0,v42,v44
v_fmac_f32 v44,-2.0,v42
v_cvt_pk_bf16_f32 v36,v228,v36
v_cvt_pk_bf16_f32 v46,v233,v46
v_cvt_pk_bf16_f32 v38,v229,v38
v_cvt_pk_bf16_f32 v42,v230,v40
v_cvt_pk_bf16_f32 v40,v234,v231
v_cvt_pk_bf16_f32 v44,v232,v44
v_lshlrev_b32 v230,16,v41
v_lshlrev_b32 v228,16,v37
v_lshlrev_b32 v229,16,v39
v_lshlrev_b32 v233,16,v47
v_lshlrev_b32 v232,16,v45
v_lshlrev_b32 v231,16,v43
v_fmac_f32 v228,s43,v230
v_fmac_f32 v233,4.0,v229
v_fma_f32 v234,-4.0,v230,v232
v_fmac_f32 v228,s45,v232
v_fmac_f32 v233,s41,v231
v_sub_f32 v232,v232,v230
v_fma_f32 v230,-4.0,v229,v231
v_sub_f32 v231,v231,v229
v_add_f32 v229,v234,v230
v_sub_f32 v234,v234,v230
v_fma_f32 v230,2.0,v231,v232
v_fmac_f32 v232,-2.0,v231
v_and_b32 v41,s42,v41
v_and_b32 v37,s42,v37
v_and_b32 v39,s42,v39
v_and_b32 v47,s42,v47
v_and_b32 v45,s42,v45
v_and_b32 v43,s42,v43
v_fmac_f32 v37,s43,v41
v_fmac_f32 v47,4.0,v39
v_fma_f32 v231,-4.0,v41,v45
v_fmac_f32 v37,s45,v45
v_fmac_f32 v47,s41,v43
v_sub_f32 v45,v45,v41
v_fma_f32 v41,-4.0,v39,v43
v_sub_f32 v43,v43,v39
v_add_f32 v39,v231,v41
v_sub_f32 v231,v231,v41
v_fma_f32 v41,2.0,v43,v45
v_fmac_f32 v45,-2.0,v43
v_cvt_pk_bf16_f32 v37,v228,v37
v_cvt_pk_bf16_f32 v47,v233,v47
v_cvt_pk_bf16_f32 v39,v229,v39
v_cvt_pk_bf16_f32 v43,v230,v41
v_cvt_pk_bf16_f32 v41,v234,v231
v_cvt_pk_bf16_f32 v45,v232,v45
ds_write2st64_b64 v243,v[36:37],v[46:47] offset0:3 offset1:20
ds_write2st64_b64 v243,v[38:39],v[40:41] offset0:37 offset1:54
ds_write2st64_b64 v243,v[42:43],v[44:45] offset0:71 offset1:88
s_waitcnt vmcnt(22)
v_fmac_f32 v48,s43,v50
s_waitcnt vmcnt(19)
v_fmac_f32 v53,4.0,v49
v_fma_f32 v228,-4.0,v50,v52
v_fmac_f32 v48,s45,v52
v_fmac_f32 v53,s41,v51
v_sub_f32 v52,v52,v50
v_fma_f32 v50,-4.0,v49,v51
v_sub_f32 v51,v51,v49
v_add_f32 v49,v228,v50
v_sub_f32 v228,v228,v50
v_fma_f32 v50,2.0,v51,v52
v_fmac_f32 v52,-2.0,v51
v_cvt_pk_bf16_f32 v229,v48,v53
v_cvt_pk_bf16_f32 v230,v49,v228
v_cvt_pk_bf16_f32 v231,v50,v52
ds_write_b16 v244,v229 offset:0
ds_write_b16_d16_hi v244,v229 offset:8704
ds_write_b16 v244,v230 offset:17408
ds_write_b16_d16_hi v244,v230 offset:26112
ds_write_b16 v244,v231 offset:34816
ds_write_b16_d16_hi v244,v231 offset:43520
s_waitcnt lgkmcnt(0)
s_barrier
ds_read_b128 a[192:195],v245 offset:17408
ds_read_b128 a[196:199],v246 offset:17408
ds_read_b128 a[200:203],v245 offset:17920
ds_read_b128 a[204:207],v246 offset:17920
ds_read_b128 a[208:211],v245 offset:18432
ds_read_b128 a[212:215],v246 offset:18432
ds_read_b128 a[216:219],v245 offset:18944
ds_read_b128 a[220:223],v246 offset:18944
v_and_b32 v65,1,v64
v_lshlrev_b32 v65,2,v65
s_mov_b32 s84,0
L_poll:
global_load_dword v66,v65,s[52:53] offset:128 sc1
s_add_u32 s84,s84,1
s_waitcnt vmcnt(0)
v_cmp_eq_u32 vcc,0,v66
s_cmp_gt_u32 s84,0x4000
s_cbranch_scc1 L_fallback
s_cbranch_vccnz L_poll
L_uready:
s_add_u32 s46,s76,9216
buffer_load_dwordx4 a[224:227],v247,s[20:23],s46 offen offset:0 sc1
s_add_u32 s47,s76,12288
buffer_load_dwordx4 a[228:231],v247,s[20:23],s47 offen offset:0 sc1
s_add_u32 s48,s76,15360
buffer_load_dwordx4 a[232:235],v247,s[20:23],s48 offen offset:0 sc1
buffer_load_dwordx4 a[236:239],v247,s[20:23],s46 offen offset:1024 sc1
s_waitcnt vmcnt(3) lgkmcnt(7)
M a[0:3],a[224:227],a[192:195],0
s_waitcnt lgkmcnt(6)
buffer_load_dwordx4 a[240:243],v247,s[20:23],s47 offen offset:1024 sc1
M a[4:7],a[224:227],a[196:199],0
s_waitcnt lgkmcnt(5)
v_lshlrev_b32 v230,16,v196
v_lshlrev_b32 v228,16,v192
M a[8:11],a[224:227],a[200:203],0
s_waitcnt lgkmcnt(4)
buffer_load_dwordx4 a[244:247],v247,s[20:23],s48 offen offset:1024 sc1
M a[12:15],a[224:227],a[204:207],0
s_waitcnt lgkmcnt(3)
v_lshlrev_b32 v229,16,v194
v_lshlrev_b32 v233,16,v202
M a[16:19],a[224:227],a[208:211],0
s_waitcnt lgkmcnt(2)
v_lshlrev_b32 v232,16,v200
v_lshlrev_b32 v231,16,v198
M a[20:23],a[224:227],a[212:215],0
s_waitcnt lgkmcnt(1)
v_fmac_f32 v228,s43,v230
v_fmac_f32 v233,4.0,v229
M a[24:27],a[224:227],a[216:219],0
s_waitcnt lgkmcnt(0)
buffer_load_dwordx4 a[248:251],v247,s[20:23],s46 offen offset:2048 sc1
v_fma_f32 v234,-4.0,v230,v232
M a[28:31],a[224:227],a[220:223],0
s_waitcnt vmcnt(5)
v_fmac_f32 v228,s45,v232
v_fmac_f32 v233,s41,v231
M a[32:35],a[228:231],a[192:195],0
v_sub_f32 v232,v232,v230
v_fma_f32 v230,-4.0,v229,v231
M a[36:39],a[228:231],a[196:199],0
v_sub_f32 v231,v231,v229
v_add_f32 v229,v234,v230
M a[40:43],a[228:231],a[200:203],0
buffer_load_dwordx4 a[252:255],v247,s[20:23],s47 offen offset:2048 sc1
M a[44:47],a[228:231],a[204:207],0
v_sub_f32 v234,v234,v230
v_fma_f32 v230,2.0,v231,v232
M a[48:51],a[228:231],a[208:211],0
v_fmac_f32 v232,-2.0,v231
v_and_b32 v196,s42,v196
M a[52:55],a[228:231],a[212:215],0
v_and_b32 v192,s42,v192
v_and_b32 v194,s42,v194
v_and_b32 v202,s42,v202
M a[56:59],a[228:231],a[216:219],0
buffer_load_dwordx4 a[224:227],v247,s[20:23],s48 offen offset:2048 sc1
M a[60:63],a[228:231],a[220:223],0
s_waitcnt vmcnt(6)
s_add_u32 s46,s76,18432
v_and_b32 v200,s42,v200
v_and_b32 v198,s42,v198
M a[64:67],a[232:235],a[192:195],0
ds_read_b128 a[192:195],v246 offset:19456
v_fmac_f32 v192,s43,v196
M a[68:71],a[232:235],a[196:199],0
v_fmac_f32 v202,4.0,v194
v_fma_f32 v231,-4.0,v196,v200
M a[72:75],a[232:235],a[200:203],0
buffer_load_dwordx4 v[216:219],v247,s[20:23],s46 offen offset:0 sc1
M a[76:79],a[232:235],a[204:207],0
s_add_u32 s47,s76,21504
v_fmac_f32 v192,s45,v200
v_fmac_f32 v202,s41,v198
M a[80:83],a[232:235],a[208:211],0
v_sub_f32 v200,v200,v196
v_fma_f32 v196,-4.0,v194,v198
v_sub_f32 v198,v198,v194
M a[84:87],a[232:235],a[212:215],0
v_add_f32 v194,v231,v196
v_sub_f32 v231,v231,v196
M a[88:91],a[232:235],a[216:219],0
buffer_load_dwordx4 v[220:223],v247,s[20:23],s47 offen offset:0 sc1
M a[92:95],a[232:235],a[220:223],0
s_waitcnt vmcnt(7)
s_add_u32 s48,s76,24576
v_fma_f32 v196,2.0,v198,v200
v_fmac_f32 v200,-2.0,v198
M a[0:3],a[236:239],a[196:199],a[0:3]
v_cvt_pk_bf16_f32 v192,v228,v192
v_cvt_pk_bf16_f32 v202,v233,v202
M a[4:7],a[236:239],a[200:203],a[4:7]
v_cvt_pk_bf16_f32 v194,v229,v194
v_cvt_pk_bf16_f32 v198,v230,v196
M a[8:11],a[236:239],a[204:207],a[8:11]
buffer_load_dwordx4 v[224:227],v247,s[20:23],s48 offen offset:0 sc1
M a[12:15],a[236:239],a[208:211],a[12:15]
v_cvt_pk_bf16_f32 v196,v234,v231
v_cvt_pk_bf16_f32 v200,v232,v200
v_lshlrev_b32 v230,16,v197
M a[16:19],a[236:239],a[212:215],a[16:19]
v_lshlrev_b32 v228,16,v193
v_lshlrev_b32 v229,16,v195
M a[20:23],a[236:239],a[216:219],a[20:23]
buffer_load_dwordx4 a[228:231],v247,s[20:23],s46 offen offset:1024 sc1
M a[24:27],a[236:239],a[220:223],a[24:27]
s_waitcnt lgkmcnt(0)
v_lshlrev_b32 v233,16,v203
v_lshlrev_b32 v232,16,v201
M a[28:31],a[236:239],a[192:195],a[28:31]
s_waitcnt vmcnt(8)
v_lshlrev_b32 v231,16,v199
v_fmac_f32 v228,s43,v230
M a[32:35],a[240:243],a[196:199],a[32:35]
v_fmac_f32 v233,4.0,v229
v_fma_f32 v234,-4.0,v230,v232
M a[36:39],a[240:243],a[200:203],a[36:39]
buffer_load_dwordx4 a[232:235],v247,s[20:23],s47 offen offset:1024 sc1
M a[40:43],a[240:243],a[204:207],a[40:43]
v_fmac_f32 v228,s45,v232
v_fmac_f32 v233,s41,v231
v_sub_f32 v232,v232,v230
M a[44:47],a[240:243],a[208:211],a[44:47]
v_fma_f32 v230,-4.0,v229,v231
v_sub_f32 v231,v231,v229
M a[48:51],a[240:243],a[212:215],a[48:51]
v_add_f32 v229,v234,v230
v_sub_f32 v234,v234,v230
M a[52:55],a[240:243],a[216:219],a[52:55]
buffer_load_dwordx4 a[236:239],v247,s[20:23],s48 offen offset:1024 sc1
M a[56:59],a[240:243],a[220:223],a[56:59]
v_fma_f32 v230,2.0,v231,v232
v_fmac_f32 v232,-2.0,v231
M a[60:63],a[240:243],a[192:195],a[60:63]
s_waitcnt vmcnt(9)
v_and_b32 v197,s42,v197
v_and_b32 v193,s42,v193
M a[64:67],a[244:247],a[196:199],a[64:67]
ds_read_b128 a[196:199],v245 offset:19456
v_and_b32 v195,s42,v195
M a[68:71],a[244:247],a[200:203],a[68:71]
buffer_load_dwordx4 a[240:243],v247,s[20:23],s46 offen offset:2048 sc1
v_and_b32 v203,s42,v203
M a[72:75],a[244:247],a[204:207],a[72:75]
v_and_b32 v201,s42,v201
v_and_b32 v199,s42,v199
M a[76:79],a[244:247],a[208:211],a[76:79]
v_fmac_f32 v193,s43,v197
v_fmac_f32 v203,4.0,v195
M a[80:83],a[244:247],a[212:215],a[80:83]
v_fma_f32 v231,-4.0,v197,v201
v_fmac_f32 v193,s45,v201
M a[84:87],a[244:247],a[216:219],a[84:87]
v_fmac_f32 v203,s41,v199
v_sub_f32 v201,v201,v197
M a[88:91],a[244:247],a[220:223],a[88:91]
v_fma_f32 v197,-4.0,v195,v199
v_sub_f32 v199,v199,v195
M a[92:95],a[244:247],a[192:195],a[92:95]
s_waitcnt vmcnt(9)
buffer_load_dwordx4 a[244:247],v247,s[20:23],s47 offen offset:2048 sc1
M a[0:3],a[248:251],a[200:203],a[0:3]
v_add_f32 v195,v231,v197
v_sub_f32 v231,v231,v197
v_fma_f32 v197,2.0,v199,v201
M a[4:7],a[248:251],a[204:207],a[4:7]
v_fmac_f32 v201,-2.0,v199
v_cvt_pk_bf16_f32 v193,v228,v193
M a[8:11],a[248:251],a[208:211],a[8:11]
v_cvt_pk_bf16_f32 v203,v233,v203
v_cvt_pk_bf16_f32 v195,v229,v195
M a[12:15],a[248:251],a[212:215],a[12:15]
v_cvt_pk_bf16_f32 v199,v230,v197
v_cvt_pk_bf16_f32 v197,v234,v231
M a[16:19],a[248:251],a[216:219],a[16:19]
v_cvt_pk_bf16_f32 v201,v232,v201
M a[20:23],a[248:251],a[220:223],a[20:23]
ds_write2st64_b64 v243,v[192:193],v[202:203] offset0:170 offset1:187
M a[24:27],a[248:251],a[192:195],a[24:27]
s_waitcnt lgkmcnt(1)
s_add_u32 s28,s65,786432
buffer_load_dwordx2 v[192:193],v241,s[12:15],s28 offen offset:0
M a[28:31],a[248:251],a[196:199],a[28:31]
s_waitcnt vmcnt(10)
ds_write2st64_b64 v243,v[194:195],v[196:197] offset0:102 offset1:119
M a[32:35],a[252:255],a[200:203],a[32:35]
buffer_load_dwordx2 v[202:203],v241,s[16:19],s28 offen offset:1536
M a[36:39],a[252:255],a[204:207],a[36:39]
ds_write2st64_b64 v243,v[198:199],v[200:201] offset0:136 offset1:153
M a[40:43],a[252:255],a[208:211],a[40:43]
v_lshlrev_b32 v230,16,v208
v_lshlrev_b32 v228,16,v204
M a[44:47],a[252:255],a[212:215],a[44:47]
buffer_load_dwordx2 v[194:195],v241,s[8:11],s28 offen offset:0
M a[48:51],a[252:255],a[216:219],a[48:51]
v_lshlrev_b32 v229,16,v206
v_lshlrev_b32 v233,16,v214
M a[52:55],a[252:255],a[220:223],a[52:55]
v_lshlrev_b32 v232,16,v212
v_lshlrev_b32 v231,16,v210
M a[56:59],a[252:255],a[192:195],a[56:59]
v_fmac_f32 v228,s43,v230
v_fmac_f32 v233,4.0,v229
M a[60:63],a[252:255],a[196:199],a[60:63]
s_waitcnt vmcnt(11)
buffer_load_dwordx2 v[196:197],v241,s[8:11],s28 offen offset:384
M a[64:67],a[224:227],a[200:203],a[64:67]
ds_read_b128 a[200:203],v245 offset:26112
v_fma_f32 v234,-4.0,v230,v232
M a[68:71],a[224:227],a[204:207],a[68:71]
ds_read_b128 a[204:207],v246 offset:26112
v_fmac_f32 v228,s45,v232
M a[72:75],a[224:227],a[208:211],a[72:75]
ds_read_b128 a[208:211],v245 offset:26624
v_fmac_f32 v233,s41,v231
M a[76:79],a[224:227],a[212:215],a[76:79]
buffer_load_dwordx2 v[198:199],v241,s[8:11],s28 offen offset:768
M a[80:83],a[224:227],a[216:219],a[80:83]
ds_read_b128 a[212:215],v246 offset:26624
ds_read_b128 a[216:219],v245 offset:27136
M a[84:87],a[224:227],a[220:223],a[84:87]
ds_read_b128 a[220:223],v246 offset:27136
v_sub_f32 v232,v232,v230
M a[88:91],a[224:227],a[192:195],a[88:91]
ds_read_b128 a[192:195],v245 offset:27648
v_fma_f32 v230,-4.0,v229,v231
M a[92:95],a[224:227],a[196:199],a[92:95]
s_waitcnt vmcnt(12) lgkmcnt(6)
buffer_load_dwordx2 v[200:201],v241,s[8:11],s28 offen offset:1152
M a[96:99],v[216:219],a[200:203],0
s_waitcnt lgkmcnt(5)
ds_read_b128 a[196:199],v246 offset:27648
v_sub_f32 v231,v231,v229
M a[100:103],v[216:219],a[204:207],0
s_waitcnt lgkmcnt(5)
v_add_f32 v229,v234,v230
v_sub_f32 v234,v234,v230
M a[104:107],v[216:219],a[208:211],0
s_waitcnt lgkmcnt(4)
v_fma_f32 v230,2.0,v231,v232
v_fmac_f32 v232,-2.0,v231
M a[108:111],v[216:219],a[212:215],0
s_waitcnt lgkmcnt(3)
buffer_load_dwordx4 a[248:251],v247,s[20:23],s48 offen offset:2048 sc1
M a[112:115],v[216:219],a[216:219],0
s_waitcnt lgkmcnt(2)
s_add_u32 s46,s76,27648
v_and_b32 v208,s42,v208
v_and_b32 v204,s42,v204
M a[116:119],v[216:219],a[220:223],0
s_waitcnt lgkmcnt(1)
v_and_b32 v206,s42,v206
v_and_b32 v214,s42,v214
M a[120:123],v[216:219],a[192:195],0
s_waitcnt lgkmcnt(0)
v_and_b32 v212,s42,v212
v_and_b32 v210,s42,v210
M a[124:127],v[216:219],a[196:199],0
s_waitcnt vmcnt(13)
buffer_load_dwordx4 a[252:255],v247,s[20:23],s46 offen offset:0 sc1
M a[128:131],v[220:223],a[200:203],0
s_add_u32 s47,s76,30720
v_fmac_f32 v204,s43,v208
v_fmac_f32 v214,4.0,v206
M a[132:135],v[220:223],a[204:207],0
v_fma_f32 v231,-4.0,v208,v212
v_fmac_f32 v204,s45,v212
M a[136:139],v[220:223],a[208:211],0
v_fmac_f32 v214,s41,v210
v_sub_f32 v212,v212,v208
M a[140:143],v[220:223],a[212:215],0
buffer_load_dwordx4 a[224:227],v247,s[20:23],s47 offen offset:0 sc1
M a[144:147],v[220:223],a[216:219],0
s_add_u32 s48,s76,33792
v_fma_f32 v208,-4.0,v206,v210
v_sub_f32 v210,v210,v206
M a[148:151],v[220:223],a[220:223],0
v_add_f32 v206,v231,v208
v_sub_f32 v231,v231,v208
M a[152:155],v[220:223],a[192:195],0
v_fma_f32 v208,2.0,v210,v212
v_fmac_f32 v212,-2.0,v210
M a[156:159],v[220:223],a[196:199],0
s_waitcnt vmcnt(14)
buffer_load_dwordx4 v[216:219],v247,s[20:23],s48 offen offset:0 sc1
M a[160:163],v[224:227],a[200:203],0
ds_read_b128 a[200:203],v246 offset:28160
v_cvt_pk_bf16_f32 v204,v228,v204
M a[164:167],v[224:227],a[204:207],0
v_cvt_pk_bf16_f32 v214,v233,v214
v_cvt_pk_bf16_f32 v206,v229,v206
M a[168:171],v[224:227],a[208:211],0
v_cvt_pk_bf16_f32 v210,v230,v208
v_cvt_pk_bf16_f32 v208,v234,v231
M a[172:175],v[224:227],a[212:215],0
buffer_load_dwordx4 v[220:223],v247,s[20:23],s46 offen offset:1024 sc1
M a[176:179],v[224:227],a[216:219],0
v_cvt_pk_bf16_f32 v212,v232,v212
v_lshlrev_b32 v230,16,v209
M a[180:183],v[224:227],a[220:223],0
v_lshlrev_b32 v228,16,v205
v_lshlrev_b32 v229,16,v207
M a[184:187],v[224:227],a[192:195],0
v_lshlrev_b32 v233,16,v215
v_lshlrev_b32 v232,16,v213
M a[188:191],v[224:227],a[196:199],0
s_waitcnt vmcnt(15)
buffer_load_dwordx4 v[224:227],v247,s[20:23],s47 offen offset:1024 sc1
M a[96:99],a[228:231],a[204:207],a[96:99]
v_lshlrev_b32 v231,16,v211
v_fmac_f32 v228,s43,v230
M a[100:103],a[228:231],a[208:211],a[100:103]
v_fmac_f32 v233,4.0,v229
v_fma_f32 v234,-4.0,v230,v232
M a[104:107],a[228:231],a[212:215],a[104:107]
v_fmac_f32 v228,s45,v232
v_fmac_f32 v233,s41,v231
M a[108:111],a[228:231],a[216:219],a[108:111]
v_sub_f32 v232,v232,v230
v_fma_f32 v230,-4.0,v229,v231
M a[112:115],a[228:231],a[220:223],a[112:115]
v_sub_f32 v231,v231,v229
v_add_f32 v229,v234,v230
M a[116:119],a[228:231],a[192:195],a[116:119]
v_sub_f32 v234,v234,v230
v_fma_f32 v230,2.0,v231,v232
M a[120:123],a[228:231],a[196:199],a[120:123]
s_waitcnt lgkmcnt(0)
v_fmac_f32 v232,-2.0,v231
v_and_b32 v209,s42,v209
M a[124:127],a[228:231],a[200:203],a[124:127]
s_waitcnt vmcnt(15)
buffer_load_dwordx4 a[228:231],v247,s[20:23],s48 offen offset:1024 sc1
M a[128:131],a[232:235],a[204:207],a[128:131]
v_and_b32 v205,s42,v205
v_and_b32 v207,s42,v207
M a[132:135],a[232:235],a[208:211],a[132:135]
v_and_b32 v215,s42,v215
v_and_b32 v213,s42,v213
M a[136:139],a[232:235],a[212:215],a[136:139]
v_and_b32 v211,s42,v211
v_fmac_f32 v205,s43,v209
M a[140:143],a[232:235],a[216:219],a[140:143]
v_fmac_f32 v215,4.0,v207
v_fma_f32 v231,-4.0,v209,v213
M a[144:147],a[232:235],a[220:223],a[144:147]
v_fmac_f32 v205,s45,v213
v_fmac_f32 v215,s41,v211
M a[148:151],a[232:235],a[192:195],a[148:151]
v_sub_f32 v213,v213,v209
v_fma_f32 v209,-4.0,v207,v211
M a[152:155],a[232:235],a[196:199],a[152:155]
v_sub_f32 v211,v211,v207
v_add_f32 v207,v231,v209
M a[156:159],a[232:235],a[200:203],a[156:159]
s_waitcnt vmcnt(15)
buffer_load_dwordx4 a[232:235],v247,s[20:23],s46 offen offset:2048 sc1
M a[160:163],a[236:239],a[204:207],a[160:163]
ds_read_b128 a[204:207],v245 offset:28160
v_sub_f32 v231,v231,v209
M a[164:167],a[236:239],a[208:211],a[164:167]
v_fma_f32 v209,2.0,v211,v213
v_fmac_f32 v213,-2.0,v211
M a[168:171],a[236:239],a[212:215],a[168:171]
v_cvt_pk_bf16_f32 v205,v228,v205
v_cvt_pk_bf16_f32 v215,v233,v215
M a[172:175],a[236:239],a[216:219],a[172:175]
v_cvt_pk_bf16_f32 v207,v229,v207
v_cvt_pk_bf16_f32 v211,v230,v209
M a[176:179],a[236:239],a[220:223],a[176:179]
v_cvt_pk_bf16_f32 v209,v234,v231
v_cvt_pk_bf16_f32 v213,v232,v213
M a[180:183],a[236:239],a[192:195],a[180:183]
ds_write2st64_b64 v243,v[204:205],v[214:215] offset0:171 offset1:188
M a[184:187],a[236:239],a[196:199],a[184:187]
s_add_u32 s28,s65,1179648
buffer_load_dwordx2 v[204:205],v241,s[12:15],s28 offen offset:0
M a[188:191],a[236:239],a[200:203],a[188:191]
s_waitcnt vmcnt(16)
ds_write2st64_b64 v243,v[206:207],v[208:209] offset0:103 offset1:120
M a[96:99],a[240:243],a[208:211],a[96:99]
buffer_load_dwordx2 v[214:215],v241,s[16:19],s28 offen offset:1536
M a[100:103],a[240:243],a[212:215],a[100:103]
ds_write2st64_b64 v243,v[210:211],v[212:213] offset0:137 offset1:154
M a[104:107],a[240:243],a[216:219],a[104:107]
v_fmac_f32 v235,s43,v237
v_fmac_f32 v240,4.0,v236
M a[108:111],a[240:243],a[220:223],a[108:111]
buffer_load_dwordx2 v[206:207],v241,s[8:11],s28 offen offset:0
M a[112:115],a[240:243],a[192:195],a[112:115]
v_fma_f32 v228,-4.0,v237,v239
v_fmac_f32 v235,s45,v239
M a[116:119],a[240:243],a[196:199],a[116:119]
v_fmac_f32 v240,s41,v238
v_sub_f32 v239,v239,v237
M a[120:123],a[240:243],a[200:203],a[120:123]
s_waitcnt lgkmcnt(3)
v_fma_f32 v237,-4.0,v236,v238
v_sub_f32 v238,v238,v236
M a[124:127],a[240:243],a[204:207],a[124:127]
s_waitcnt vmcnt(17)
buffer_load_dwordx2 v[208:209],v241,s[8:11],s28 offen offset:384
M a[128:131],a[244:247],a[208:211],a[128:131]
v_add_f32 v236,v228,v237
v_sub_f32 v228,v228,v237
M a[132:135],a[244:247],a[212:215],a[132:135]
v_fma_f32 v237,2.0,v238,v239
v_fmac_f32 v239,-2.0,v238
M a[136:139],a[244:247],a[216:219],a[136:139]
v_cvt_pk_bf16_f32 v229,v235,v240
v_cvt_pk_bf16_f32 v230,v236,v228
M a[140:143],a[244:247],a[220:223],a[140:143]
buffer_load_dwordx2 v[210:211],v241,s[8:11],s28 offen offset:768
M a[144:147],a[244:247],a[192:195],a[144:147]
v_cvt_pk_bf16_f32 v231,v237,v239
v_add_u32 v228,87040,v244
M a[148:151],a[244:247],a[196:199],a[148:151]
ds_write_b16 v228,v229 offset:0
M a[152:155],a[244:247],a[200:203],a[152:155]
ds_write_b16_d16_hi v228,v229 offset:8704
M a[156:159],a[244:247],a[204:207],a[156:159]
s_waitcnt vmcnt(12)
buffer_load_dwordx2 v[212:213],v241,s[8:11],s28 offen offset:1152
M a[160:163],a[248:251],a[208:211],a[160:163]
s_add_u32 s29,s66,0
ds_read_b128 a[208:211],v245 offset:34816
ds_write_b16 v244,v230 offset:52224
M a[164:167],a[248:251],a[212:215],a[164:167]
ds_read_b128 a[212:215],v246 offset:34816
ds_write_b16_d16_hi v244,v230 offset:60928
M a[168:171],a[248:251],a[216:219],a[168:171]
buffer_load_short_d16_hi v235,v242,s[12:15],s29 offen offset:0
M a[172:175],a[248:251],a[220:223],a[172:175]
ds_read_b128 a[216:219],v245 offset:35328
ds_read_b128 a[220:223],v246 offset:35328
M a[176:179],a[248:251],a[192:195],a[176:179]
buffer_load_short_d16_hi v236,v242,s[8:11],s29 offen offset:0
M a[180:183],a[248:251],a[196:199],a[180:183]
ds_read_b128 a[192:195],v245 offset:35840
ds_read_b128 a[196:199],v246 offset:35840
M a[184:187],a[248:251],a[200:203],a[184:187]
buffer_load_short_d16_hi v237,v242,s[8:11],s29 offen offset:384
M a[188:191],a[248:251],a[204:207],a[188:191]
s_waitcnt vmcnt(15) lgkmcnt(7)
ds_read_b128 a[200:203],v245 offset:36352
ds_read_b128 a[204:207],v246 offset:36352
M v[0:3],a[252:255],a[208:211],0
s_waitcnt lgkmcnt(7)
buffer_load_short_d16_hi v238,v242,s[8:11],s29 offen offset:768
M v[4:7],a[252:255],a[212:215],0
s_waitcnt lgkmcnt(5)
v_add_u32 v228,69632,v244
M v[8:11],a[252:255],a[216:219],0
s_waitcnt lgkmcnt(4)
buffer_load_short_d16_hi v239,v242,s[8:11],s29 offen offset:1152
M v[12:15],a[252:255],a[220:223],0
s_waitcnt lgkmcnt(3)
ds_write_b16 v228,v231 offset:0
M v[16:19],a[252:255],a[192:195],0
s_waitcnt lgkmcnt(3)
buffer_load_short_d16_hi v240,v242,s[16:19],s29 offen offset:1536
M v[20:23],a[252:255],a[196:199],0
s_waitcnt lgkmcnt(2)
ds_write_b16_d16_hi v228,v231 offset:8704
M v[24:27],a[252:255],a[200:203],0
s_waitcnt lgkmcnt(2)
buffer_load_dwordx4 a[236:239],v247,s[20:23],s47 offen offset:2048 sc1
M v[28:31],a[252:255],a[204:207],0
s_waitcnt vmcnt(18)
v_lshlrev_b32 v230,16,v196
v_lshlrev_b32 v228,16,v192
M v[32:35],a[224:227],a[208:211],0
v_lshlrev_b32 v229,16,v194
v_lshlrev_b32 v233,16,v202
M v[36:39],a[224:227],a[212:215],0
v_lshlrev_b32 v232,16,v200
v_lshlrev_b32 v231,16,v198
M v[40:43],a[224:227],a[216:219],0
buffer_load_dwordx4 a[240:243],v247,s[20:23],s48 offen offset:2048 sc1
M v[44:47],a[224:227],a[220:223],0
s_add_u32 s46,s76,36864
v_fmac_f32 v228,s43,v230
v_fmac_f32 v233,4.0,v229
M v[48:51],a[224:227],a[192:195],0
v_fma_f32 v234,-4.0,v230,v232
v_fmac_f32 v228,s45,v232
M v[52:55],a[224:227],a[196:199],0
v_fmac_f32 v233,s41,v231
v_sub_f32 v232,v232,v230
M v[56:59],a[224:227],a[200:203],0
buffer_load_dwordx4 a[244:247],v247,s[20:23],s46 offen offset:0 sc1
M v[60:63],a[224:227],a[204:207],0
s_waitcnt vmcnt(19)
s_add_u32 s47,s76,39936
v_fma_f32 v230,-4.0,v229,v231
v_sub_f32 v231,v231,v229
M v[64:67],v[216:219],a[208:211],0
ds_read_b128 a[208:211],v246 offset:36864
v_add_f32 v229,v234,v230
M v[68:71],v[216:219],a[212:215],0
v_sub_f32 v234,v234,v230
v_fma_f32 v230,2.0,v231,v232
M v[72:75],v[216:219],a[216:219],0
buffer_load_dwordx4 a[248:251],v247,s[20:23],s47 offen offset:0 sc1
M v[76:79],v[216:219],a[220:223],0
s_add_u32 s48,s76,43008
v_fmac_f32 v232,-2.0,v231
v_and_b32 v196,s42,v196
M v[80:83],v[216:219],a[192:195],0
v_and_b32 v192,s42,v192
v_and_b32 v194,s42,v194
M v[84:87],v[216:219],a[196:199],0
v_and_b32 v202,s42,v202
v_and_b32 v200,s42,v200
M v[88:91],v[216:219],a[200:203],0
global_load_dword v251,v252,s[82:83]
M v[92:95],v[216:219],a[204:207],0
s_waitcnt vmcnt(20)
v_and_b32 v198,s42,v198
v_fmac_f32 v192,s43,v196
M v[0:3],v[220:223],a[212:215],v[0:3]
buffer_load_dwordx4 a[252:255],v247,s[20:23],s48 offen offset:0 sc1
M v[4:7],v[220:223],a[216:219],v[4:7]
v_fmac_f32 v202,4.0,v194
v_fma_f32 v231,-4.0,v196,v200
M v[8:11],v[220:223],a[220:223],v[8:11]
v_fmac_f32 v192,s45,v200
v_fmac_f32 v202,s41,v198
M v[12:15],v[220:223],a[192:195],v[12:15]
v_sub_f32 v200,v200,v196
v_fma_f32 v196,-4.0,v194,v198
M v[16:19],v[220:223],a[196:199],v[16:19]
buffer_load_dwordx4 a[224:227],v247,s[20:23],s46 offen offset:1024 sc1
M v[20:23],v[220:223],a[200:203],v[20:23]
v_sub_f32 v198,v198,v194
v_add_f32 v194,v231,v196
M v[24:27],v[220:223],a[204:207],v[24:27]
s_waitcnt lgkmcnt(0)
v_sub_f32 v231,v231,v196
v_fma_f32 v196,2.0,v198,v200
M v[28:31],v[220:223],a[208:211],v[28:31]
s_waitcnt vmcnt(21)
v_fmac_f32 v200,-2.0,v198
v_cvt_pk_bf16_f32 v192,v228,v192
M v[32:35],v[224:227],a[212:215],v[32:35]
buffer_load_dwordx4 v[216:219],v247,s[20:23],s47 offen offset:1024 sc1
M v[36:39],v[224:227],a[216:219],v[36:39]
v_cvt_pk_bf16_f32 v202,v233,v202
v_cvt_pk_bf16_f32 v194,v229,v194
M v[40:43],v[224:227],a[220:223],v[40:43]
v_cvt_pk_bf16_f32 v198,v230,v196
v_cvt_pk_bf16_f32 v196,v234,v231
M v[44:47],v[224:227],a[192:195],v[44:47]
v_cvt_pk_bf16_f32 v200,v232,v200
v_lshlrev_b32 v230,16,v197
M v[48:51],v[224:227],a[196:199],v[48:51]
buffer_load_dwordx4 v[220:223],v247,s[20:23],s48 offen offset:1024 sc1
M v[52:55],v[224:227],a[200:203],v[52:55]
v_lshlrev_b32 v228,16,v193
v_lshlrev_b32 v229,16,v195
M v[56:59],v[224:227],a[204:207],v[56:59]
v_lshlrev_b32 v233,16,v203
v_lshlrev_b32 v232,16,v201
M v[60:63],v[224:227],a[208:211],v[60:63]
s_waitcnt vmcnt(22)
v_lshlrev_b32 v231,16,v199
v_fmac_f32 v228,s43,v230
M v[64:67],a[228:231],a[212:215],v[64:67]
buffer_load_dwordx4 v[224:227],v247,s[20:23],s46 offen offset:2048 sc1
M v[68:71],a[228:231],a[216:219],v[68:71]
ds_read_b128 a[212:215],v245 offset:36864
v_fmac_f32 v233,4.0,v229
M v[72:75],a[228:231],a[220:223],v[72:75]
v_fma_f32 v234,-4.0,v230,v232
v_fmac_f32 v228,s45,v232
M v[76:79],a[228:231],a[192:195],v[76:79]
v_fmac_f32 v233,s41,v231
v_sub_f32 v232,v232,v230
M v[80:83],a[228:231],a[196:199],v[80:83]
v_fma_f32 v230,-4.0,v229,v231
v_sub_f32 v231,v231,v229
M v[84:87],a[228:231],a[200:203],v[84:87]
v_add_f32 v229,v234,v230
v_sub_f32 v234,v234,v230
M v[88:91],a[228:231],a[204:207],v[88:91]
v_fma_f32 v230,2.0,v231,v232
v_fmac_f32 v232,-2.0,v231
M v[92:95],a[228:231],a[208:211],v[92:95]
s_waitcnt vmcnt(22)
buffer_load_dwordx4 a[228:231],v247,s[20:23],s47 offen offset:2048 sc1
M v[0:3],a[232:235],a[216:219],v[0:3]
v_and_b32 v197,s42,v197
v_and_b32 v193,s42,v193
M v[4:7],a[232:235],a[220:223],v[4:7]
v_and_b32 v195,s42,v195
v_and_b32 v203,s42,v203
v_and_b32 v201,s42,v201
M v[8:11],a[232:235],a[192:195],v[8:11]
v_and_b32 v199,s42,v199
v_fmac_f32 v193,s43,v197
M v[12:15],a[232:235],a[196:199],v[12:15]
v_fmac_f32 v203,4.0,v195
v_fma_f32 v231,-4.0,v197,v201
M v[16:19],a[232:235],a[200:203],v[16:19]
v_fmac_f32 v193,s45,v201
v_fmac_f32 v203,s41,v199
M v[20:23],a[232:235],a[204:207],v[20:23]
v_sub_f32 v201,v201,v197
v_fma_f32 v197,-4.0,v195,v199
M v[24:27],a[232:235],a[208:211],v[24:27]
s_waitcnt lgkmcnt(0)
v_sub_f32 v199,v199,v195
v_add_f32 v195,v231,v197
M v[28:31],a[232:235],a[212:215],v[28:31]
s_waitcnt vmcnt(10)
buffer_load_dwordx4 a[232:235],v247,s[20:23],s48 offen offset:2048 sc1
M v[32:35],a[236:239],a[216:219],v[32:35]
v_sub_f32 v231,v231,v197
v_fma_f32 v197,2.0,v199,v201
v_fmac_f32 v201,-2.0,v199
M v[36:39],a[236:239],a[220:223],v[36:39]
s_add_u32 s46,s77,9216
v_cvt_pk_bf16_f32 v193,v228,v193
v_cvt_pk_bf16_f32 v203,v233,v203
M v[40:43],a[236:239],a[192:195],v[40:43]
v_cvt_pk_bf16_f32 v195,v229,v195
v_cvt_pk_bf16_f32 v199,v230,v197
M v[44:47],a[236:239],a[196:199],v[44:47]
v_cvt_pk_bf16_f32 v197,v234,v231
v_cvt_pk_bf16_f32 v201,v232,v201
M v[48:51],a[236:239],a[200:203],v[48:51]
ds_write2st64_b64 v243,v[192:193],v[202:203] offset0:172 offset1:189
M v[52:55],a[236:239],a[204:207],v[52:55]
s_add_u32 s28,s66,0
buffer_load_dwordx2 v[192:193],v250,s[12:15],s28 offen offset:0
M v[56:59],a[236:239],a[208:211],v[56:59]
ds_write2st64_b64 v243,v[194:195],v[196:197] offset0:104 offset1:121
M v[60:63],a[236:239],a[212:215],v[60:63]
s_waitcnt vmcnt(11)
buffer_load_dwordx2 v[202:203],v250,s[16:19],s28 offen offset:1536
M v[64:67],a[240:243],a[216:219],v[64:67]
ds_read_b128 a[216:219],v245 offset:43520
ds_write2st64_b64 v243,v[198:199],v[200:201] offset0:138 offset1:155
M v[68:71],a[240:243],a[220:223],v[68:71]
ds_read_b128 a[220:223],v246 offset:43520
v_lshlrev_b32 v230,16,v208
M v[72:75],a[240:243],a[192:195],v[72:75]
buffer_load_dwordx2 v[194:195],v250,s[8:11],s28 offen offset:0
M v[76:79],a[240:243],a[196:199],v[76:79]
ds_read_b128 a[192:195],v245 offset:44032
ds_read_b128 a[196:199],v246 offset:44032
M v[80:83],a[240:243],a[200:203],v[80:83]
ds_read_b128 a[200:203],v245 offset:44544
v_lshlrev_b32 v228,16,v204
M v[84:87],a[240:243],a[204:207],v[84:87]
ds_read_b128 a[204:207],v246 offset:44544
v_lshlrev_b32 v229,16,v206
M v[88:91],a[240:243],a[208:211],v[88:91]
buffer_load_dwordx2 v[196:197],v250,s[8:11],s28 offen offset:384
M v[92:95],a[240:243],a[212:215],v[92:95]
s_waitcnt vmcnt(13) lgkmcnt(6)
ds_read_b128 a[208:211],v245 offset:45056
ds_read_b128 a[212:215],v246 offset:45056
M v[96:99],a[244:247],a[216:219],0
s_waitcnt lgkmcnt(6)
v_lshlrev_b32 v233,16,v214
v_lshlrev_b32 v232,16,v212
M v[100:103],a[244:247],a[220:223],0
s_waitcnt lgkmcnt(5)
v_lshlrev_b32 v231,16,v210
v_fmac_f32 v228,s43,v230
M v[104:107],a[244:247],a[192:195],0
s_waitcnt lgkmcnt(4)
buffer_load_dwordx2 v[198:199],v250,s[8:11],s28 offen offset:768
M v[108:111],a[244:247],a[196:199],0
s_waitcnt lgkmcnt(3)
v_fmac_f32 v233,4.0,v229
v_fma_f32 v234,-4.0,v230,v232
M v[112:115],a[244:247],a[200:203],0
s_waitcnt lgkmcnt(2)
v_fmac_f32 v228,s45,v232
v_fmac_f32 v233,s41,v231
M v[116:119],a[244:247],a[204:207],0
s_waitcnt lgkmcnt(1)
v_sub_f32 v232,v232,v230
v_fma_f32 v230,-4.0,v229,v231
M v[120:123],a[244:247],a[208:211],0
s_waitcnt lgkmcnt(0)
buffer_load_dwordx2 v[200:201],v250,s[8:11],s28 offen offset:1152
M v[124:127],a[244:247],a[212:215],0
s_waitcnt vmcnt(14)
v_sub_f32 v231,v231,v229
v_add_f32 v229,v234,v230
M v[128:131],a[248:251],a[216:219],0
v_sub_f32 v234,v234,v230
v_fma_f32 v230,2.0,v231,v232
M v[132:135],a[248:251],a[220:223],0
v_fmac_f32 v232,-2.0,v231
v_and_b32 v208,s42,v208
M v[136:139],a[248:251],a[192:195],0
buffer_load_dwordx4 a[236:239],v247,s[20:23],s46 offen offset:0 sc1
M v[140:143],a[248:251],a[196:199],0
s_add_u32 s47,s77,12288
v_and_b32 v204,s42,v204
v_and_b32 v206,s42,v206
M v[144:147],a[248:251],a[200:203],0
v_and_b32 v214,s42,v214
v_and_b32 v212,s42,v212
M v[148:151],a[248:251],a[204:207],0
v_and_b32 v210,s42,v210
v_fmac_f32 v204,s43,v208
M v[152:155],a[248:251],a[208:211],0
buffer_load_dwordx4 a[240:243],v247,s[20:23],s47 offen offset:0 sc1
M v[156:159],a[248:251],a[212:215],0
s_waitcnt vmcnt(14)
s_add_u32 s48,s77,15360
v_fmac_f32 v214,4.0,v206
v_fma_f32 v231,-4.0,v208,v212
M v[160:163],a[252:255],a[216:219],0
ds_read_b128 a[216:219],v246 offset:45568
v_fmac_f32 v204,s45,v212
M v[164:167],a[252:255],a[220:223],0
v_fmac_f32 v214,s41,v210
v_sub_f32 v212,v212,v208
M v[168:171],a[252:255],a[192:195],0
buffer_load_dwordx4 a[244:247],v247,s[20:23],s48 offen offset:0 sc1
M v[172:175],a[252:255],a[196:199],0
v_fma_f32 v208,-4.0,v206,v210
v_sub_f32 v210,v210,v206
M v[176:179],a[252:255],a[200:203],0
v_add_f32 v206,v231,v208
v_sub_f32 v231,v231,v208
M v[180:183],a[252:255],a[204:207],0
v_fma_f32 v208,2.0,v210,v212
v_fmac_f32 v212,-2.0,v210
M v[184:187],a[252:255],a[208:211],0
buffer_load_dwordx4 a[248:251],v247,s[20:23],s46 offen offset:1024 sc1
M v[188:191],a[252:255],a[212:215],0
s_waitcnt vmcnt(15)
v_cvt_pk_bf16_f32 v204,v228,v204
v_cvt_pk_bf16_f32 v214,v233,v214
M v[96:99],a[224:227],a[220:223],v[96:99]
v_cvt_pk_bf16_f32 v206,v229,v206
v_cvt_pk_bf16_f32 v210,v230,v208
M v[100:103],a[224:227],a[192:195],v[100:103]
v_cvt_pk_bf16_f32 v208,v234,v231
v_cvt_pk_bf16_f32 v212,v232,v212
M v[104:107],a[224:227],a[196:199],v[104:107]
buffer_load_dwordx4 a[252:255],v247,s[20:23],s47 offen offset:1024 sc1
M v[108:111],a[224:227],a[200:203],v[108:111]
v_lshlrev_b32 v230,16,v209
v_lshlrev_b32 v228,16,v205
M v[112:115],a[224:227],a[204:207],v[112:115]
v_lshlrev_b32 v229,16,v207
v_lshlrev_b32 v233,16,v215
M v[116:119],a[224:227],a[208:211],v[116:119]
v_lshlrev_b32 v232,16,v213
v_lshlrev_b32 v231,16,v211
M v[120:123],a[224:227],a[212:215],v[120:123]
s_waitcnt lgkmcnt(0)
v_fmac_f32 v228,s43,v230
v_fmac_f32 v233,4.0,v229
M v[124:127],a[224:227],a[216:219],v[124:127]
s_waitcnt vmcnt(15)
buffer_load_dwordx4 a[224:227],v247,s[20:23],s48 offen offset:1024 sc1
M v[128:131],v[216:219],a[220:223],v[128:131]
v_fma_f32 v234,-4.0,v230,v232
v_fmac_f32 v228,s45,v232
M v[132:135],v[216:219],a[192:195],v[132:135]
v_fmac_f32 v233,s41,v231
v_sub_f32 v232,v232,v230
M v[136:139],v[216:219],a[196:199],v[136:139]
v_fma_f32 v230,-4.0,v229,v231
v_sub_f32 v231,v231,v229
M v[140:143],v[216:219],a[200:203],v[140:143]
v_add_f32 v229,v234,v230
v_sub_f32 v234,v234,v230
M v[144:147],v[216:219],a[204:207],v[144:147]
v_fma_f32 v230,2.0,v231,v232
v_fmac_f32 v232,-2.0,v231
M v[148:151],v[216:219],a[208:211],v[148:151]
v_and_b32 v209,s42,v209
v_and_b32 v205,s42,v205
M v[152:155],v[216:219],a[212:215],v[152:155]
v_and_b32 v207,s42,v207
v_and_b32 v215,s42,v215
M v[156:159],v[216:219],a[216:219],v[156:159]
s_waitcnt vmcnt(15)
buffer_load_dwordx4 v[216:219],v247,s[20:23],s46 offen offset:2048 sc1
M v[160:163],v[220:223],a[220:223],v[160:163]
ds_read_b128 a[220:223],v245 offset:45568
v_and_b32 v213,s42,v213
M v[164:167],v[220:223],a[192:195],v[164:167]
v_and_b32 v211,s42,v211
v_fmac_f32 v205,s43,v209
M v[168:171],v[220:223],a[196:199],v[168:171]
v_fmac_f32 v215,4.0,v207
v_fma_f32 v231,-4.0,v209,v213
M v[172:175],v[220:223],a[200:203],v[172:175]
v_fmac_f32 v205,s45,v213
v_fmac_f32 v215,s41,v211
M v[176:179],v[220:223],a[204:207],v[176:179]
v_sub_f32 v213,v213,v209
v_fma_f32 v209,-4.0,v207,v211
M v[180:183],v[220:223],a[208:211],v[180:183]
v_sub_f32 v211,v211,v207
v_add_f32 v207,v231,v209
M v[184:187],v[220:223],a[212:215],v[184:187]
v_sub_f32 v231,v231,v209
v_fma_f32 v209,2.0,v211,v213
M v[188:191],v[220:223],a[216:219],v[188:191]
s_waitcnt vmcnt(15)
buffer_load_dwordx4 v[220:223],v247,s[20:23],s47 offen offset:2048 sc1
M v[96:99],v[224:227],a[192:195],v[96:99]
v_fmac_f32 v213,-2.0,v211
v_cvt_pk_bf16_f32 v205,v228,v205
M v[100:103],v[224:227],a[196:199],v[100:103]
v_cvt_pk_bf16_f32 v215,v233,v215
v_cvt_pk_bf16_f32 v207,v229,v207
M v[104:107],v[224:227],a[200:203],v[104:107]
v_cvt_pk_bf16_f32 v211,v230,v209
v_cvt_pk_bf16_f32 v209,v234,v231
M v[108:111],v[224:227],a[204:207],v[108:111]
v_cvt_pk_bf16_f32 v213,v232,v213
M v[112:115],v[224:227],a[208:211],v[112:115]
ds_write2st64_b64 v243,v[204:205],v[214:215] offset0:173 offset1:190
M v[116:119],v[224:227],a[212:215],v[116:119]
s_add_u32 s28,s66,393216
buffer_load_dwordx2 v[204:205],v241,s[12:15],s28 offen offset:0
M v[120:123],v[224:227],a[216:219],v[120:123]
s_waitcnt lgkmcnt(1)
ds_write2st64_b64 v243,v[206:207],v[208:209] offset0:105 offset1:122
M v[124:127],v[224:227],a[220:223],v[124:127]
s_waitcnt vmcnt(16)
buffer_load_dwordx2 v[214:215],v241,s[16:19],s28 offen offset:1536
M v[128:131],a[228:231],a[192:195],v[128:131]
ds_write2st64_b64 v243,v[210:211],v[212:213] offset0:139 offset1:156
M v[132:135],a[228:231],a[196:199],v[132:135]
s_waitcnt vmcnt(12)
v_lshlrev_b32 v230,16,v196
v_lshlrev_b32 v228,16,v192
M v[136:139],a[228:231],a[200:203],v[136:139]
buffer_load_dwordx2 v[206:207],v241,s[8:11],s28 offen offset:0
M v[140:143],a[228:231],a[204:207],v[140:143]
v_lshlrev_b32 v229,16,v194
v_lshlrev_b32 v233,16,v202
M v[144:147],a[228:231],a[208:211],v[144:147]
s_waitcnt vmcnt(11)
v_lshlrev_b32 v232,16,v200
v_lshlrev_b32 v231,16,v198
M v[148:151],a[228:231],a[212:215],v[148:151]
v_fmac_f32 v228,s43,v230
v_fmac_f32 v233,4.0,v229
M v[152:155],a[228:231],a[216:219],v[152:155]
s_waitcnt lgkmcnt(0)
s_barrier
v_fma_f32 v234,-4.0,v230,v232
M v[156:159],a[228:231],a[220:223],v[156:159]
buffer_load_dwordx2 v[208:209],v241,s[8:11],s28 offen offset:384
M v[160:163],a[232:235],a[192:195],v[160:163]
ds_read_b128 a[192:195],v245 offset:52224
v_fmac_f32 v228,s45,v232
M v[164:167],a[232:235],a[196:199],v[164:167]
ds_read_b128 a[196:199],v246 offset:52224
v_fmac_f32 v233,s41,v231
M v[168:171],a[232:235],a[200:203],v[168:171]
buffer_load_dwordx2 v[210:211],v241,s[8:11],s28 offen offset:768
M v[172:175],a[232:235],a[204:207],v[172:175]
ds_read_b128 a[200:203],v245 offset:52736
ds_read_b128 a[204:207],v246 offset:52736
M v[176:179],a[232:235],a[208:211],v[176:179]
ds_read_b128 a[208:211],v245 offset:53248
v_sub_f32 v232,v232,v230
M v[180:183],a[232:235],a[212:215],v[180:183]
ds_read_b128 a[212:215],v246 offset:53248
v_fma_f32 v230,-4.0,v229,v231
M v[184:187],a[232:235],a[216:219],v[184:187]
buffer_load_dwordx2 v[212:213],v241,s[8:11],s28 offen offset:1152
M v[188:191],a[232:235],a[220:223],v[188:191]
s_waitcnt vmcnt(13) lgkmcnt(5)
ds_read_b128 a[216:219],v245 offset:53760
ds_read_b128 a[220:223],v246 offset:53760
M a[0:3],a[236:239],a[192:195],a[0:3]
s_waitcnt lgkmcnt(6)
v_sub_f32 v231,v231,v229
v_add_f32 v229,v234,v230
M a[4:7],a[236:239],a[196:199],a[4:7]
s_waitcnt lgkmcnt(5)
v_sub_f32 v234,v234,v230
v_fma_f32 v230,2.0,v231,v232
M a[8:11],a[236:239],a[200:203],a[8:11]
s_waitcnt lgkmcnt(4)
buffer_load_dwordx4 v[224:227],v247,s[20:23],s48 offen offset:2048 sc1
M a[12:15],a[236:239],a[204:207],a[12:15]
s_waitcnt lgkmcnt(3)
s_add_u32 s46,s77,18432
v_fmac_f32 v232,-2.0,v231
v_and_b32 v196,s42,v196
M a[16:19],a[236:239],a[208:211],a[16:19]
s_waitcnt lgkmcnt(2)
v_and_b32 v192,s42,v192
v_and_b32 v194,s42,v194
M a[20:23],a[236:239],a[212:215],a[20:23]
s_waitcnt lgkmcnt(1)
v_and_b32 v202,s42,v202
v_and_b32 v200,s42,v200
M a[24:27],a[236:239],a[216:219],a[24:27]
s_waitcnt lgkmcnt(0)
buffer_load_dwordx4 a[228:231],v247,s[20:23],s46 offen offset:0 sc1
M a[28:31],a[236:239],a[220:223],a[28:31]
s_waitcnt vmcnt(14)
s_add_u32 s47,s77,21504
v_and_b32 v198,s42,v198
v_fmac_f32 v192,s43,v196
M a[32:35],a[240:243],a[192:195],a[32:35]
v_fmac_f32 v202,4.0,v194
v_fma_f32 v231,-4.0,v196,v200
M a[36:39],a[240:243],a[196:199],a[36:39]
v_fmac_f32 v192,s45,v200
v_fmac_f32 v202,s41,v198
M a[40:43],a[240:243],a[200:203],a[40:43]
buffer_load_dwordx4 a[232:235],v247,s[20:23],s47 offen offset:0 sc1
M a[44:47],a[240:243],a[204:207],a[44:47]
s_add_u32 s48,s77,24576
v_sub_f32 v200,v200,v196
v_fma_f32 v196,-4.0,v194,v198
M a[48:51],a[240:243],a[208:211],a[48:51]
v_sub_f32 v198,v198,v194
v_add_f32 v194,v231,v196
M a[52:55],a[240:243],a[212:215],a[52:55]
v_sub_f32 v231,v231,v196
v_fma_f32 v196,2.0,v198,v200
M a[56:59],a[240:243],a[216:219],a[56:59]
buffer_load_dwordx4 a[236:239],v247,s[20:23],s48 offen offset:0 sc1
M a[60:63],a[240:243],a[220:223],a[60:63]
s_waitcnt vmcnt(15)
v_fmac_f32 v200,-2.0,v198
v_cvt_pk_bf16_f32 v192,v228,v192
M a[64:67],a[244:247],a[192:195],a[64:67]
ds_read_b128 a[192:195],v246 offset:54272
v_cvt_pk_bf16_f32 v202,v233,v202
M a[68:71],a[244:247],a[196:199],a[68:71]
v_cvt_pk_bf16_f32 v194,v229,v194
v_cvt_pk_bf16_f32 v198,v230,v196
M a[72:75],a[244:247],a[200:203],a[72:75]
buffer_load_dwordx4 a[240:243],v247,s[20:23],s46 offen offset:1024 sc1
M a[76:79],a[244:247],a[204:207],a[76:79]
v_cvt_pk_bf16_f32 v196,v234,v231
v_cvt_pk_bf16_f32 v200,v232,v200
M a[80:83],a[244:247],a[208:211],a[80:83]
v_lshlrev_b32 v230,16,v197
v_lshlrev_b32 v228,16,v193
M a[84:87],a[244:247],a[212:215],a[84:87]
v_lshlrev_b32 v229,16,v195
v_lshlrev_b32 v233,16,v203
M a[88:91],a[244:247],a[216:219],a[88:91]
v_lshlrev_b32 v232,16,v201
v_lshlrev_b32 v231,16,v199
M a[92:95],a[244:247],a[220:223],a[92:95]
s_waitcnt vmcnt(15)
buffer_load_dwordx4 a[244:247],v247,s[20:23],s47 offen offset:1024 sc1
M a[0:3],a[248:251],a[196:199],a[0:3]
v_fmac_f32 v228,s43,v230
v_fmac_f32 v233,4.0,v229
M a[4:7],a[248:251],a[200:203],a[4:7]
v_fma_f32 v234,-4.0,v230,v232
v_fmac_f32 v228,s45,v232
M a[8:11],a[248:251],a[204:207],a[8:11]
v_fmac_f32 v233,s41,v231
v_sub_f32 v232,v232,v230
M a[12:15],a[248:251],a[208:211],a[12:15]
v_fma_f32 v230,-4.0,v229,v231
v_sub_f32 v231,v231,v229
M a[16:19],a[248:251],a[212:215],a[16:19]
v_add_f32 v229,v234,v230
v_sub_f32 v234,v234,v230
M a[20:23],a[248:251],a[216:219],a[20:23]
v_fma_f32 v230,2.0,v231,v232
v_fmac_f32 v232,-2.0,v231
M a[24:27],a[248:251],a[220:223],a[24:27]
s_waitcnt lgkmcnt(0)
v_and_b32 v197,s42,v197
v_and_b32 v193,s42,v193
M a[28:31],a[248:251],a[192:195],a[28:31]
s_waitcnt vmcnt(15)
buffer_load_dwordx4 a[248:251],v247,s[20:23],s48 offen offset:1024 sc1
M a[32:35],a[252:255],a[196:199],a[32:35]
v_and_b32 v195,s42,v195
v_and_b32 v203,s42,v203
M a[36:39],a[252:255],a[200:203],a[36:39]
v_and_b32 v201,s42,v201
v_and_b32 v199,s42,v199
M a[40:43],a[252:255],a[204:207],a[40:43]
v_fmac_f32 v193,s43,v197
v_fmac_f32 v203,4.0,v195
M a[44:47],a[252:255],a[208:211],a[44:47]
v_fma_f32 v231,-4.0,v197,v201
v_fmac_f32 v193,s45,v201
M a[48:51],a[252:255],a[212:215],a[48:51]
v_fmac_f32 v203,s41,v199
v_sub_f32 v201,v201,v197
M a[52:55],a[252:255],a[216:219],a[52:55]
v_fma_f32 v197,-4.0,v195,v199
v_sub_f32 v199,v199,v195
M a[56:59],a[252:255],a[220:223],a[56:59]
v_add_f32 v195,v231,v197
v_sub_f32 v231,v231,v197
M a[60:63],a[252:255],a[192:195],a[60:63]
s_waitcnt vmcnt(15)
buffer_load_dwordx4 a[252:255],v247,s[20:23],s46 offen offset:2048 sc1
M a[64:67],a[224:227],a[196:199],a[64:67]
ds_read_b128 a[196:199],v245 offset:54272
v_fma_f32 v197,2.0,v199,v201
M a[68:71],a[224:227],a[200:203],a[68:71]
v_fmac_f32 v201,-2.0,v199
v_cvt_pk_bf16_f32 v193,v228,v193
M a[72:75],a[224:227],a[204:207],a[72:75]
v_cvt_pk_bf16_f32 v203,v233,v203
v_cvt_pk_bf16_f32 v195,v229,v195
M a[76:79],a[224:227],a[208:211],a[76:79]
v_cvt_pk_bf16_f32 v199,v230,v197
v_cvt_pk_bf16_f32 v197,v234,v231
M a[80:83],a[224:227],a[212:215],a[80:83]
v_cvt_pk_bf16_f32 v201,v232,v201
M a[84:87],a[224:227],a[216:219],a[84:87]
ds_write2st64_b64 v243,v[192:193],v[202:203] offset0:204 offset1:221
M a[88:91],a[224:227],a[220:223],a[88:91]
s_add_u32 s28,s66,786432
buffer_load_dwordx2 v[192:193],v241,s[12:15],s28 offen offset:0
M a[92:95],a[224:227],a[192:195],a[92:95]
s_waitcnt vmcnt(16)
ds_write2st64_b64 v243,v[194:195],v[196:197] offset0:34 offset1:51
M a[0:3],v[216:219],a[200:203],a[0:3]
buffer_load_dwordx2 v[202:203],v241,s[16:19],s28 offen offset:1536
M a[4:7],v[216:219],a[204:207],a[4:7]
ds_write2st64_b64 v243,v[198:199],v[200:201] offset0:68 offset1:85
M a[8:11],v[216:219],a[208:211],a[8:11]
s_waitcnt vmcnt(12)
v_lshlrev_b32 v230,16,v208
v_lshlrev_b32 v228,16,v204
M a[12:15],v[216:219],a[212:215],a[12:15]
buffer_load_dwordx2 v[194:195],v241,s[8:11],s28 offen offset:0
M a[16:19],v[216:219],a[216:219],a[16:19]
v_lshlrev_b32 v229,16,v206
v_lshlrev_b32 v233,16,v214
M a[20:23],v[216:219],a[220:223],a[20:23]
s_waitcnt vmcnt(11)
v_lshlrev_b32 v232,16,v212
v_lshlrev_b32 v231,16,v210
M a[24:27],v[216:219],a[192:195],a[24:27]
s_waitcnt lgkmcnt(3)
v_fmac_f32 v228,s43,v230
v_fmac_f32 v233,4.0,v229
M a[28:31],v[216:219],a[196:199],a[28:31]
buffer_load_dwordx2 v[196:197],v241,s[8:11],s28 offen offset:384
M a[32:35],v[220:223],a[200:203],a[32:35]
v_fma_f32 v234,-4.0,v230,v232
v_fmac_f32 v228,s45,v232
M a[36:39],v[220:223],a[204:207],a[36:39]
v_fmac_f32 v233,s41,v231
v_sub_f32 v232,v232,v230
M a[40:43],v[220:223],a[208:211],a[40:43]
v_fma_f32 v230,-4.0,v229,v231
v_sub_f32 v231,v231,v229
M a[44:47],v[220:223],a[212:215],a[44:47]
buffer_load_dwordx2 v[198:199],v241,s[8:11],s28 offen offset:768
M a[48:51],v[220:223],a[216:219],a[48:51]
v_add_f32 v229,v234,v230
v_sub_f32 v234,v234,v230
M a[52:55],v[220:223],a[220:223],a[52:55]
v_fma_f32 v230,2.0,v231,v232
v_fmac_f32 v232,-2.0,v231
M a[56:59],v[220:223],a[192:195],a[56:59]
v_and_b32 v208,s42,v208
v_and_b32 v204,s42,v204
M a[60:63],v[220:223],a[196:199],a[60:63]
s_waitcnt vmcnt(12)
buffer_load_dwordx2 v[200:201],v241,s[8:11],s28 offen offset:1152
M a[64:67],v[224:227],a[200:203],a[64:67]
ds_read_b128 a[200:203],v245 offset:60928
v_and_b32 v206,s42,v206
M a[68:71],v[224:227],a[204:207],a[68:71]
ds_read_b128 a[204:207],v246 offset:60928
v_and_b32 v214,s42,v214
M a[72:75],v[224:227],a[208:211],a[72:75]
ds_read_b128 a[208:211],v245 offset:61440
v_and_b32 v212,s42,v212
M a[76:79],v[224:227],a[212:215],a[76:79]
buffer_load_dwordx4 a[224:227],v247,s[20:23],s47 offen offset:2048 sc1
M a[80:83],v[224:227],a[216:219],a[80:83]
ds_read_b128 a[212:215],v246 offset:61440
ds_read_b128 a[216:219],v245 offset:61952
M a[84:87],v[224:227],a[220:223],a[84:87]
ds_read_b128 a[220:223],v246 offset:61952
v_and_b32 v210,s42,v210
M a[88:91],v[224:227],a[192:195],a[88:91]
ds_read_b128 a[192:195],v245 offset:62464
v_fmac_f32 v204,s43,v208
M a[92:95],v[224:227],a[196:199],a[92:95]
s_waitcnt vmcnt(13) lgkmcnt(6)
buffer_load_dwordx4 v[216:219],v247,s[20:23],s48 offen offset:2048 sc1
M a[96:99],a[228:231],a[200:203],a[96:99]
s_waitcnt lgkmcnt(5)
s_add_u32 s46,s77,27648
ds_read_b128 a[196:199],v246 offset:62464
v_fmac_f32 v214,4.0,v206
M a[100:103],a[228:231],a[204:207],a[100:103]
s_waitcnt lgkmcnt(5)
v_fma_f32 v231,-4.0,v208,v212
v_fmac_f32 v204,s45,v212
M a[104:107],a[228:231],a[208:211],a[104:107]
s_waitcnt lgkmcnt(4)
v_fmac_f32 v214,s41,v210
v_sub_f32 v212,v212,v208
M a[108:111],a[228:231],a[212:215],a[108:111]
s_waitcnt lgkmcnt(3)
buffer_load_dwordx4 v[220:223],v247,s[20:23],s46 offen offset:0 sc1
M a[112:115],a[228:231],a[216:219],a[112:115]
s_waitcnt lgkmcnt(2)
s_add_u32 s47,s77,30720
v_fma_f32 v208,-4.0,v206,v210
v_sub_f32 v210,v210,v206
M a[116:119],a[228:231],a[220:223],a[116:119]
s_waitcnt lgkmcnt(1)
v_add_f32 v206,v231,v208
v_sub_f32 v231,v231,v208
M a[120:123],a[228:231],a[192:195],a[120:123]
s_waitcnt lgkmcnt(0)
v_fma_f32 v208,2.0,v210,v212
v_fmac_f32 v212,-2.0,v210
M a[124:127],a[228:231],a[196:199],a[124:127]
s_waitcnt vmcnt(14)
buffer_load_dwordx4 v[224:227],v247,s[20:23],s47 offen offset:0 sc1
M a[128:131],a[232:235],a[200:203],a[128:131]
s_add_u32 s48,s77,33792
v_cvt_pk_bf16_f32 v204,v228,v204
v_cvt_pk_bf16_f32 v214,v233,v214
M a[132:135],a[232:235],a[204:207],a[132:135]
v_cvt_pk_bf16_f32 v206,v229,v206
v_cvt_pk_bf16_f32 v210,v230,v208
M a[136:139],a[232:235],a[208:211],a[136:139]
v_cvt_pk_bf16_f32 v208,v234,v231
v_cvt_pk_bf16_f32 v212,v232,v212
M a[140:143],a[232:235],a[212:215],a[140:143]
buffer_load_dwordx4 a[228:231],v247,s[20:23],s48 offen offset:0 sc1
M a[144:147],a[232:235],a[216:219],a[144:147]
v_lshlrev_b32 v230,16,v209
v_lshlrev_b32 v228,16,v205
M a[148:151],a[232:235],a[220:223],a[148:151]
v_lshlrev_b32 v229,16,v207
v_lshlrev_b32 v233,16,v215
M a[152:155],a[232:235],a[192:195],a[152:155]
v_lshlrev_b32 v232,16,v213
v_lshlrev_b32 v231,16,v211
M a[156:159],a[232:235],a[196:199],a[156:159]
s_waitcnt vmcnt(15)
buffer_load_dwordx4 a[232:235],v247,s[20:23],s46 offen offset:1024 sc1
M a[160:163],a[236:239],a[200:203],a[160:163]
ds_read_b128 a[200:203],v246 offset:62976
v_fmac_f32 v228,s43,v230
M a[164:167],a[236:239],a[204:207],a[164:167]
v_fmac_f32 v233,4.0,v229
v_fma_f32 v234,-4.0,v230,v232
M a[168:171],a[236:239],a[208:211],a[168:171]
v_fmac_f32 v228,s45,v232
v_fmac_f32 v233,s41,v231
M a[172:175],a[236:239],a[212:215],a[172:175]
v_sub_f32 v232,v232,v230
v_fma_f32 v230,-4.0,v229,v231
M a[176:179],a[236:239],a[216:219],a[176:179]
v_sub_f32 v231,v231,v229
v_add_f32 v229,v234,v230
M a[180:183],a[236:239],a[220:223],a[180:183]
v_sub_f32 v234,v234,v230
v_fma_f32 v230,2.0,v231,v232
M a[184:187],a[236:239],a[192:195],a[184:187]
v_fmac_f32 v232,-2.0,v231
v_and_b32 v209,s42,v209
M a[188:191],a[236:239],a[196:199],a[188:191]
s_waitcnt vmcnt(15)
buffer_load_dwordx4 a[236:239],v247,s[20:23],s47 offen offset:1024 sc1
M a[96:99],a[240:243],a[204:207],a[96:99]
v_and_b32 v205,s42,v205
v_and_b32 v207,s42,v207
M a[100:103],a[240:243],a[208:211],a[100:103]
v_and_b32 v215,s42,v215
v_and_b32 v213,s42,v213
M a[104:107],a[240:243],a[212:215],a[104:107]
v_and_b32 v211,s42,v211
v_fmac_f32 v205,s43,v209
M a[108:111],a[240:243],a[216:219],a[108:111]
v_fmac_f32 v215,4.0,v207
v_fma_f32 v231,-4.0,v209,v213
M a[112:115],a[240:243],a[220:223],a[112:115]
v_fmac_f32 v205,s45,v213
v_fmac_f32 v215,s41,v211
M a[116:119],a[240:243],a[192:195],a[116:119]
v_sub_f32 v213,v213,v209
v_fma_f32 v209,-4.0,v207,v211
M a[120:123],a[240:243],a[196:199],a[120:123]
s_waitcnt lgkmcnt(0)
v_sub_f32 v211,v211,v207
v_add_f32 v207,v231,v209
M a[124:127],a[240:243],a[200:203],a[124:127]
s_waitcnt vmcnt(15)
buffer_load_dwordx4 a[240:243],v247,s[20:23],s48 offen offset:1024 sc1
M a[128:131],a[244:247],a[204:207],a[128:131]
v_sub_f32 v231,v231,v209
v_fma_f32 v209,2.0,v211,v213
M a[132:135],a[244:247],a[208:211],a[132:135]
v_fmac_f32 v213,-2.0,v211
v_cvt_pk_bf16_f32 v205,v228,v205
M a[136:139],a[244:247],a[212:215],a[136:139]
v_cvt_pk_bf16_f32 v215,v233,v215
v_cvt_pk_bf16_f32 v207,v229,v207
M a[140:143],a[244:247],a[216:219],a[140:143]
v_cvt_pk_bf16_f32 v211,v230,v209
v_cvt_pk_bf16_f32 v209,v234,v231
M a[144:147],a[244:247],a[220:223],a[144:147]
v_cvt_pk_bf16_f32 v213,v232,v213
M a[148:151],a[244:247],a[192:195],a[148:151]
ds_write2st64_b64 v243,v[204:205],v[214:215] offset0:205 offset1:222
M a[152:155],a[244:247],a[196:199],a[152:155]
s_add_u32 s28,s66,1179648
buffer_load_dwordx2 v[204:205],v241,s[12:15],s28 offen offset:0
M a[156:159],a[244:247],a[200:203],a[156:159]
s_waitcnt vmcnt(16)
ds_write2st64_b64 v243,v[206:207],v[208:209] offset0:35 offset1:52
M a[160:163],a[248:251],a[204:207],a[160:163]
buffer_load_dwordx2 v[214:215],v241,s[16:19],s28 offen offset:1536
M a[164:167],a[248:251],a[208:211],a[164:167]
ds_read_b128 a[204:207],v245 offset:62976
ds_write2st64_b64 v243,v[210:211],v[212:213] offset0:69 offset1:86
M a[168:171],a[248:251],a[212:215],a[168:171]
v_fmac_f32 v235,s43,v237
v_fmac_f32 v240,4.0,v236
M a[172:175],a[248:251],a[216:219],a[172:175]
buffer_load_dwordx2 v[206:207],v241,s[8:11],s28 offen offset:0
M a[176:179],a[248:251],a[220:223],a[176:179]
v_fma_f32 v228,-4.0,v237,v239
v_fmac_f32 v235,s45,v239
M a[180:183],a[248:251],a[192:195],a[180:183]
v_fmac_f32 v240,s41,v238
v_sub_f32 v239,v239,v237
M a[184:187],a[248:251],a[196:199],a[184:187]
v_fma_f32 v237,-4.0,v236,v238
v_sub_f32 v238,v238,v236
M a[188:191],a[248:251],a[200:203],a[188:191]
s_waitcnt vmcnt(17)
buffer_load_dwordx2 v[208:209],v241,s[8:11],s28 offen offset:384
M a[96:99],a[252:255],a[208:211],a[96:99]
v_add_f32 v236,v228,v237
v_sub_f32 v228,v228,v237
M a[100:103],a[252:255],a[212:215],a[100:103]
v_fma_f32 v237,2.0,v238,v239
v_fmac_f32 v239,-2.0,v238
M a[104:107],a[252:255],a[216:219],a[104:107]
v_cvt_pk_bf16_f32 v229,v235,v240
v_cvt_pk_bf16_f32 v230,v236,v228
M a[108:111],a[252:255],a[220:223],a[108:111]
buffer_load_dwordx2 v[210:211],v241,s[8:11],s28 offen offset:768
M a[112:115],a[252:255],a[192:195],a[112:115]
v_cvt_pk_bf16_f32 v231,v237,v239
v_add_u32 v228,104448,v244
M a[116:119],a[252:255],a[196:199],a[116:119]
ds_write_b16 v228,v229 offset:0
M a[120:123],a[252:255],a[200:203],a[120:123]
s_waitcnt lgkmcnt(2)
ds_write_b16_d16_hi v228,v229 offset:8704
M a[124:127],a[252:255],a[204:207],a[124:127]
s_waitcnt vmcnt(12)
buffer_load_dwordx2 v[212:213],v241,s[8:11],s28 offen offset:1152
M a[128:131],a[224:227],a[208:211],a[128:131]
s_add_u32 s29,s67,0
ds_write_b16 v244,v230 offset:17408
M a[132:135],a[224:227],a[212:215],a[132:135]
ds_write_b16_d16_hi v244,v230 offset:26112
M a[136:139],a[224:227],a[216:219],a[136:139]
ds_write_b16 v244,v231 offset:34816
M a[140:143],a[224:227],a[220:223],a[140:143]
buffer_load_short_d16_hi v235,v242,s[12:15],s29 offen offset:0
M a[144:147],a[224:227],a[192:195],a[144:147]
ds_write_b16_d16_hi v244,v231 offset:43520
M a[148:151],a[224:227],a[196:199],a[148:151]
buffer_load_short_d16_hi v236,v242,s[8:11],s29 offen offset:0
M a[152:155],a[224:227],a[200:203],a[152:155]
v_add_u32 v245,0x4400,v245
v_add_u32 v246,0x4400,v246
M a[156:159],a[224:227],a[204:207],a[156:159]
s_waitcnt vmcnt(14)
buffer_load_short_d16_hi v237,v242,s[8:11],s29 offen offset:384
M a[160:163],v[216:219],a[208:211],a[160:163]
ds_read_b128 a[208:211],v245 offset:52224
v_lshlrev_b32 v230,16,v196
M a[164:167],v[216:219],a[212:215],a[164:167]
buffer_load_short_d16_hi v238,v242,s[8:11],s29 offen offset:768
M a[168:171],v[216:219],a[216:219],a[168:171]
ds_read_b128 a[212:215],v246 offset:52224
ds_read_b128 a[216:219],v245 offset:52736
M a[172:175],v[216:219],a[220:223],a[172:175]
buffer_load_short_d16_hi v239,v242,s[8:11],s29 offen offset:1152
M a[176:179],v[216:219],a[192:195],a[176:179]
ds_read_b128 a[220:223],v246 offset:52736
ds_read_b128 a[192:195],v245 offset:53248
M a[180:183],v[216:219],a[196:199],a[180:183]
buffer_load_short_d16_hi v240,v242,s[16:19],s29 offen offset:1536
M a[184:187],v[216:219],a[200:203],a[184:187]
ds_read_b128 a[196:199],v246 offset:53248
ds_read_b128 a[200:203],v245 offset:53760
M a[188:191],v[216:219],a[204:207],a[188:191]
s_waitcnt vmcnt(17) lgkmcnt(6)
buffer_load_dwordx4 a[244:247],v247,s[20:23],s46 offen offset:2048 sc1
M v[0:3],v[220:223],a[208:211],v[0:3]
s_waitcnt lgkmcnt(5)
ds_read_b128 a[204:207],v246 offset:53760
v_lshlrev_b32 v228,16,v192
M v[4:7],v[220:223],a[212:215],v[4:7]
s_waitcnt lgkmcnt(5)
v_lshlrev_b32 v229,16,v194
v_lshlrev_b32 v233,16,v202
M v[8:11],v[220:223],a[216:219],v[8:11]
s_waitcnt lgkmcnt(4)
v_lshlrev_b32 v232,16,v200
v_lshlrev_b32 v231,16,v198
M v[12:15],v[220:223],a[220:223],v[12:15]
s_waitcnt lgkmcnt(3)
buffer_load_dwordx4 a[248:251],v247,s[20:23],s47 offen offset:2048 sc1
M v[16:19],v[220:223],a[192:195],v[16:19]
s_waitcnt lgkmcnt(2)
v_fmac_f32 v228,s43,v230
v_fmac_f32 v233,4.0,v229
M v[20:23],v[220:223],a[196:199],v[20:23]
s_waitcnt lgkmcnt(1)
v_fma_f32 v234,-4.0,v230,v232
v_fmac_f32 v228,s45,v232
M v[24:27],v[220:223],a[200:203],v[24:27]
s_waitcnt lgkmcnt(0)
v_fmac_f32 v233,s41,v231
v_sub_f32 v232,v232,v230
M v[28:31],v[220:223],a[204:207],v[28:31]
s_waitcnt vmcnt(18)
buffer_load_dwordx4 a[252:255],v247,s[20:23],s48 offen offset:2048 sc1
M v[32:35],v[224:227],a[208:211],v[32:35]
s_add_u32 s46,s77,36864
v_fma_f32 v230,-4.0,v229,v231
v_sub_f32 v231,v231,v229
M v[36:39],v[224:227],a[212:215],v[36:39]
v_add_f32 v229,v234,v230
v_sub_f32 v234,v234,v230
M v[40:43],v[224:227],a[216:219],v[40:43]
v_fma_f32 v230,2.0,v231,v232
v_fmac_f32 v232,-2.0,v231
M v[44:47],v[224:227],a[220:223],v[44:47]
buffer_load_dwordx4 a[224:227],v247,s[20:23],s46 offen offset:0 sc1
M v[48:51],v[224:227],a[192:195],v[48:51]
s_add_u32 s47,s77,39936
v_and_b32 v196,s42,v196
v_and_b32 v192,s42,v192
M v[52:55],v[224:227],a[196:199],v[52:55]
v_and_b32 v194,s42,v194
v_and_b32 v202,s42,v202
M v[56:59],v[224:227],a[200:203],v[56:59]
v_and_b32 v200,s42,v200
v_and_b32 v198,s42,v198
M v[60:63],v[224:227],a[204:207],v[60:63]
s_waitcnt vmcnt(19)
buffer_load_dwordx4 v[216:219],v247,s[20:23],s47 offen offset:0 sc1
M v[64:67],a[228:231],a[208:211],v[64:67]
s_add_u32 s48,s77,43008
ds_read_b128 a[208:211],v246 offset:54272
v_fmac_f32 v192,s43,v196
M v[68:71],a[228:231],a[212:215],v[68:71]
v_fmac_f32 v202,4.0,v194
v_fma_f32 v231,-4.0,v196,v200
M v[72:75],a[228:231],a[216:219],v[72:75]
v_fmac_f32 v192,s45,v200
v_fmac_f32 v202,s41,v198
M v[76:79],a[228:231],a[220:223],v[76:79]
global_load_dword v251,v252,s[82:83]
M v[80:83],a[228:231],a[192:195],v[80:83]
v_sub_f32 v200,v200,v196
v_fma_f32 v196,-4.0,v194,v198
M v[84:87],a[228:231],a[196:199],v[84:87]
buffer_load_dwordx4 v[220:223],v247,s[20:23],s48 offen offset:0 sc1
M v[88:91],a[228:231],a[200:203],v[88:91]
v_sub_f32 v198,v198,v194
v_add_f32 v194,v231,v196
M v[92:95],a[228:231],a[204:207],v[92:95]
s_waitcnt vmcnt(21)
v_sub_f32 v231,v231,v196
v_fma_f32 v196,2.0,v198,v200
M v[0:3],a[232:235],a[212:215],v[0:3]
v_fmac_f32 v200,-2.0,v198
v_cvt_pk_bf16_f32 v192,v228,v192
M v[4:7],a[232:235],a[216:219],v[4:7]
buffer_load_dwordx4 v[224:227],v247,s[20:23],s46 offen offset:1024 sc1
M v[8:11],a[232:235],a[220:223],v[8:11]
v_cvt_pk_bf16_f32 v202,v233,v202
v_cvt_pk_bf16_f32 v194,v229,v194
M v[12:15],a[232:235],a[192:195],v[12:15]
v_cvt_pk_bf16_f32 v198,v230,v196
v_cvt_pk_bf16_f32 v196,v234,v231
M v[16:19],a[232:235],a[196:199],v[16:19]
v_cvt_pk_bf16_f32 v200,v232,v200
v_lshlrev_b32 v230,16,v197
M v[20:23],a[232:235],a[200:203],v[20:23]
buffer_load_dwordx4 a[228:231],v247,s[20:23],s47 offen offset:1024 sc1
M v[24:27],a[232:235],a[204:207],v[24:27]
s_waitcnt lgkmcnt(0)
v_lshlrev_b32 v228,16,v193
v_lshlrev_b32 v229,16,v195
M v[28:31],a[232:235],a[208:211],v[28:31]
s_waitcnt vmcnt(22)
v_lshlrev_b32 v233,16,v203
v_lshlrev_b32 v232,16,v201
M v[32:35],a[236:239],a[212:215],v[32:35]
v_lshlrev_b32 v231,16,v199
v_fmac_f32 v228,s43,v230
M v[36:39],a[236:239],a[216:219],v[36:39]
buffer_load_dwordx4 a[232:235],v247,s[20:23],s48 offen offset:1024 sc1
M v[40:43],a[236:239],a[220:223],v[40:43]
v_fmac_f32 v233,4.0,v229
v_fma_f32 v234,-4.0,v230,v232
M v[44:47],a[236:239],a[192:195],v[44:47]
v_fmac_f32 v228,s45,v232
v_fmac_f32 v233,s41,v231
M v[48:51],a[236:239],a[196:199],v[48:51]
v_sub_f32 v232,v232,v230
v_fma_f32 v230,-4.0,v229,v231
M v[52:55],a[236:239],a[200:203],v[52:55]
v_sub_f32 v231,v231,v229
v_add_f32 v229,v234,v230
M v[56:59],a[236:239],a[204:207],v[56:59]
v_sub_f32 v234,v234,v230
v_fma_f32 v230,2.0,v231,v232
M v[60:63],a[236:239],a[208:211],v[60:63]
s_waitcnt vmcnt(22)
buffer_load_dwordx4 a[236:239],v247,s[20:23],s46 offen offset:2048 sc1
M v[64:67],a[240:243],a[212:215],v[64:67]
ds_read_b128 a[212:215],v245 offset:54272
v_fmac_f32 v232,-2.0,v231
M v[68:71],a[240:243],a[216:219],v[68:71]
v_and_b32 v197,s42,v197
v_and_b32 v193,s42,v193
M v[72:75],a[240:243],a[220:223],v[72:75]
v_and_b32 v195,s42,v195
v_and_b32 v203,s42,v203
M v[76:79],a[240:243],a[192:195],v[76:79]
v_and_b32 v201,s42,v201
v_and_b32 v199,s42,v199
M v[80:83],a[240:243],a[196:199],v[80:83]
v_fmac_f32 v193,s43,v197
v_fmac_f32 v203,4.0,v195
M v[84:87],a[240:243],a[200:203],v[84:87]
v_fma_f32 v231,-4.0,v197,v201
v_fmac_f32 v193,s45,v201
M v[88:91],a[240:243],a[204:207],v[88:91]
v_fmac_f32 v203,s41,v199
v_sub_f32 v201,v201,v197
M v[92:95],a[240:243],a[208:211],v[92:95]
s_waitcnt vmcnt(10)
buffer_load_dwordx4 a[240:243],v247,s[20:23],s47 offen offset:2048 sc1
M v[0:3],a[244:247],a[216:219],v[0:3]
v_fma_f32 v197,-4.0,v195,v199
v_sub_f32 v199,v199,v195
M v[4:7],a[244:247],a[220:223],v[4:7]
v_add_f32 v195,v231,v197
v_sub_f32 v231,v231,v197
M v[8:11],a[244:247],a[192:195],v[8:11]
v_fma_f32 v197,2.0,v199,v201
v_fmac_f32 v201,-2.0,v199
M v[12:15],a[244:247],a[196:199],v[12:15]
v_cvt_pk_bf16_f32 v193,v228,v193
v_cvt_pk_bf16_f32 v203,v233,v203
M v[16:19],a[244:247],a[200:203],v[16:19]
v_cvt_pk_bf16_f32 v195,v229,v195
v_cvt_pk_bf16_f32 v199,v230,v197
M v[20:23],a[244:247],a[204:207],v[20:23]
v_cvt_pk_bf16_f32 v197,v234,v231
v_cvt_pk_bf16_f32 v201,v232,v201
M v[24:27],a[244:247],a[208:211],v[24:27]
s_waitcnt lgkmcnt(0)
ds_write2st64_b64 v243,v[192:193],v[202:203] offset0:206 offset1:223
M v[28:31],a[244:247],a[212:215],v[28:31]
s_waitcnt vmcnt(10)
s_add_u32 s28,s67,0
buffer_load_dwordx2 v[192:193],v250,s[12:15],s28 offen offset:0
M v[32:35],a[248:251],a[216:219],v[32:35]
ds_write2st64_b64 v243,v[194:195],v[196:197] offset0:36 offset1:53
M v[36:39],a[248:251],a[220:223],v[36:39]
buffer_load_dwordx2 v[202:203],v250,s[16:19],s28 offen offset:1536
M v[40:43],a[248:251],a[192:195],v[40:43]
ds_write2st64_b64 v243,v[198:199],v[200:201] offset0:70 offset1:87
M v[44:47],a[248:251],a[196:199],v[44:47]
v_lshlrev_b32 v230,16,v208
v_lshlrev_b32 v228,16,v204
M v[48:51],a[248:251],a[200:203],v[48:51]
buffer_load_dwordx2 v[194:195],v250,s[8:11],s28 offen offset:0
M v[52:55],a[248:251],a[204:207],v[52:55]
v_lshlrev_b32 v229,16,v206
v_lshlrev_b32 v233,16,v214
M v[56:59],a[248:251],a[208:211],v[56:59]
v_lshlrev_b32 v232,16,v212
v_lshlrev_b32 v231,16,v210
M v[60:63],a[248:251],a[212:215],v[60:63]
s_waitcnt vmcnt(12)
v_fmac_f32 v228,s43,v230
v_fmac_f32 v233,4.0,v229
M v[64:67],a[252:255],a[216:219],v[64:67]
buffer_load_dwordx2 v[196:197],v250,s[8:11],s28 offen offset:384
M v[68:71],a[252:255],a[220:223],v[68:71]
ds_read_b128 a[216:219],v245 offset:60928
ds_read_b128 a[220:223],v246 offset:60928
M v[72:75],a[252:255],a[192:195],v[72:75]
ds_read_b128 a[192:195],v245 offset:61440
v_fma_f32 v234,-4.0,v230,v232
M v[76:79],a[252:255],a[196:199],v[76:79]
ds_read_b128 a[196:199],v246 offset:61440
v_fmac_f32 v228,s45,v232
M v[80:83],a[252:255],a[200:203],v[80:83]
buffer_load_dwordx2 v[198:199],v250,s[8:11],s28 offen offset:768
M v[84:87],a[252:255],a[204:207],v[84:87]
ds_read_b128 a[200:203],v245 offset:61952
ds_read_b128 a[204:207],v246 offset:61952
M v[88:91],a[252:255],a[208:211],v[88:91]
ds_read_b128 a[208:211],v245 offset:62464
v_fmac_f32 v233,s41,v231
M v[92:95],a[252:255],a[212:215],v[92:95]
s_waitcnt vmcnt(13) lgkmcnt(6)
ds_read_b128 a[212:215],v246 offset:62464
v_sub_f32 v232,v232,v230
M v[96:99],a[224:227],a[216:219],v[96:99]
s_waitcnt lgkmcnt(6)
buffer_load_dwordx2 v[200:201],v250,s[8:11],s28 offen offset:1152
M v[100:103],a[224:227],a[220:223],v[100:103]
s_waitcnt lgkmcnt(5)
v_fma_f32 v230,-4.0,v229,v231
v_sub_f32 v231,v231,v229
M v[104:107],a[224:227],a[192:195],v[104:107]
s_waitcnt lgkmcnt(4)
v_add_f32 v229,v234,v230
v_sub_f32 v234,v234,v230
M v[108:111],a[224:227],a[196:199],v[108:111]
s_waitcnt lgkmcnt(3)
v_fma_f32 v230,2.0,v231,v232
v_fmac_f32 v232,-2.0,v231
M v[112:115],a[224:227],a[200:203],v[112:115]
s_waitcnt lgkmcnt(2)
buffer_load_dwordx4 a[244:247],v247,s[20:23],s48 offen offset:2048 sc1
M v[116:119],a[224:227],a[204:207],v[116:119]
s_waitcnt lgkmcnt(1)
s_add_u32 s46,s78,9216
v_and_b32 v208,s42,v208
v_and_b32 v204,s42,v204
M v[120:123],a[224:227],a[208:211],v[120:123]
s_waitcnt lgkmcnt(0)
v_and_b32 v206,s42,v206
v_and_b32 v214,s42,v214
M v[124:127],a[224:227],a[212:215],v[124:127]
s_waitcnt vmcnt(14)
v_and_b32 v212,s42,v212
v_and_b32 v210,s42,v210
M v[128:131],v[216:219],a[216:219],v[128:131]
buffer_load_dwordx4 a[248:251],v247,s[20:23],s46 offen offset:0 sc1
M v[132:135],v[216:219],a[220:223],v[132:135]
s_add_u32 s47,s78,12288
v_fmac_f32 v204,s43,v208
v_fmac_f32 v214,4.0,v206
M v[136:139],v[216:219],a[192:195],v[136:139]
v_fma_f32 v231,-4.0,v208,v212
v_fmac_f32 v204,s45,v212
M v[140:143],v[216:219],a[196:199],v[140:143]
v_fmac_f32 v214,s41,v210
v_sub_f32 v212,v212,v208
M v[144:147],v[216:219],a[200:203],v[144:147]
buffer_load_dwordx4 a[252:255],v247,s[20:23],s47 offen offset:0 sc1
M v[148:151],v[216:219],a[204:207],v[148:151]
s_add_u32 s48,s78,15360
v_fma_f32 v208,-4.0,v206,v210
v_sub_f32 v210,v210,v206
M v[152:155],v[216:219],a[208:211],v[152:155]
v_add_f32 v206,v231,v208
v_sub_f32 v231,v231,v208
M v[156:159],v[216:219],a[212:215],v[156:159]
s_waitcnt vmcnt(14)
v_fma_f32 v208,2.0,v210,v212
v_fmac_f32 v212,-2.0,v210
M v[160:163],v[220:223],a[216:219],v[160:163]
buffer_load_dwordx4 a[224:227],v247,s[20:23],s48 offen offset:0 sc1
M v[164:167],v[220:223],a[220:223],v[164:167]
ds_read_b128 a[216:219],v246 offset:62976
v_cvt_pk_bf16_f32 v204,v228,v204
M v[168:171],v[220:223],a[192:195],v[168:171]
v_cvt_pk_bf16_f32 v214,v233,v214
v_cvt_pk_bf16_f32 v206,v229,v206
M v[172:175],v[220:223],a[196:199],v[172:175]
v_cvt_pk_bf16_f32 v210,v230,v208
v_cvt_pk_bf16_f32 v208,v234,v231
M v[176:179],v[220:223],a[200:203],v[176:179]
buffer_load_dwordx4 v[216:219],v247,s[20:23],s46 offen offset:1024 sc1
M v[180:183],v[220:223],a[204:207],v[180:183]
v_cvt_pk_bf16_f32 v212,v232,v212
v_lshlrev_b32 v230,16,v209
M v[184:187],v[220:223],a[208:211],v[184:187]
v_lshlrev_b32 v228,16,v205
v_lshlrev_b32 v229,16,v207
M v[188:191],v[220:223],a[212:215],v[188:191]
s_waitcnt vmcnt(15)
v_lshlrev_b32 v233,16,v215
v_lshlrev_b32 v232,16,v213
M v[96:99],v[224:227],a[220:223],v[96:99]
buffer_load_dwordx4 v[220:223],v247,s[20:23],s47 offen offset:1024 sc1
M v[100:103],v[224:227],a[192:195],v[100:103]
v_lshlrev_b32 v231,16,v211
v_fmac_f32 v228,s43,v230
M v[104:107],v[224:227],a[196:199],v[104:107]
v_fmac_f32 v233,4.0,v229
v_fma_f32 v234,-4.0,v230,v232
M v[108:111],v[224:227],a[200:203],v[108:111]
v_fmac_f32 v228,s45,v232
v_fmac_f32 v233,s41,v231
M v[112:115],v[224:227],a[204:207],v[112:115]
v_sub_f32 v232,v232,v230
v_fma_f32 v230,-4.0,v229,v231
M v[116:119],v[224:227],a[208:211],v[116:119]
v_sub_f32 v231,v231,v229
v_add_f32 v229,v234,v230
M v[120:123],v[224:227],a[212:215],v[120:123]
s_waitcnt lgkmcnt(0)
v_sub_f32 v234,v234,v230
v_fma_f32 v230,2.0,v231,v232
M v[124:127],v[224:227],a[216:219],v[124:127]
s_waitcnt vmcnt(15)
buffer_load_dwordx4 v[224:227],v247,s[20:23],s48 offen offset:1024 sc1
M v[128:131],a[228:231],a[220:223],v[128:131]
v_fmac_f32 v232,-2.0,v231
v_and_b32 v209,s42,v209
M v[132:135],a[228:231],a[192:195],v[132:135]
v_and_b32 v205,s42,v205
v_and_b32 v207,s42,v207
M v[136:139],a[228:231],a[196:199],v[136:139]
v_and_b32 v215,s42,v215
v_and_b32 v213,s42,v213
M v[140:143],a[228:231],a[200:203],v[140:143]
v_and_b32 v211,s42,v211
v_fmac_f32 v205,s43,v209
M v[144:147],a[228:231],a[204:207],v[144:147]
v_fmac_f32 v215,4.0,v207
v_fma_f32 v231,-4.0,v209,v213
M v[148:151],a[228:231],a[208:211],v[148:151]
v_fmac_f32 v205,s45,v213
v_fmac_f32 v215,s41,v211
M v[152:155],a[228:231],a[212:215],v[152:155]
v_sub_f32 v213,v213,v209
v_fma_f32 v209,-4.0,v207,v211
M v[156:159],a[228:231],a[216:219],v[156:159]
s_waitcnt vmcnt(15)
buffer_load_dwordx4 a[228:231],v247,s[20:23],s46 offen offset:2048 sc1
M v[160:163],a[232:235],a[220:223],v[160:163]
ds_read_b128 a[220:223],v245 offset:62976
v_sub_f32 v211,v211,v207
M v[164:167],a[232:235],a[192:195],v[164:167]
v_add_f32 v207,v231,v209
v_sub_f32 v231,v231,v209
M v[168:171],a[232:235],a[196:199],v[168:171]
v_fma_f32 v209,2.0,v211,v213
v_fmac_f32 v213,-2.0,v211
M v[172:175],a[232:235],a[200:203],v[172:175]
v_cvt_pk_bf16_f32 v205,v228,v205
v_cvt_pk_bf16_f32 v215,v233,v215
M v[176:179],a[232:235],a[204:207],v[176:179]
v_cvt_pk_bf16_f32 v207,v229,v207
v_cvt_pk_bf16_f32 v211,v230,v209
M v[180:183],a[232:235],a[208:211],v[180:183]
v_cvt_pk_bf16_f32 v209,v234,v231
v_cvt_pk_bf16_f32 v213,v232,v213
M v[184:187],a[232:235],a[212:215],v[184:187]
ds_write2st64_b64 v243,v[204:205],v[214:215] offset0:207 offset1:224
M v[188:191],a[232:235],a[216:219],v[188:191]
s_waitcnt vmcnt(15)
s_add_u32 s28,s67,393216
buffer_load_dwordx2 v[204:205],v241,s[12:15],s28 offen offset:0
M v[96:99],a[236:239],a[192:195],v[96:99]
ds_write2st64_b64 v243,v[206:207],v[208:209] offset0:37 offset1:54
M v[100:103],a[236:239],a[196:199],v[100:103]
buffer_load_dwordx2 v[214:215],v241,s[16:19],s28 offen offset:1536
M v[104:107],a[236:239],a[200:203],v[104:107]
ds_write2st64_b64 v243,v[210:211],v[212:213] offset0:71 offset1:88
M v[108:111],a[236:239],a[204:207],v[108:111]
s_waitcnt vmcnt(12)
v_lshlrev_b32 v230,16,v196
v_lshlrev_b32 v228,16,v192
M v[112:115],a[236:239],a[208:211],v[112:115]
buffer_load_dwordx2 v[206:207],v241,s[8:11],s28 offen offset:0
M v[116:119],a[236:239],a[212:215],v[116:119]
v_lshlrev_b32 v229,16,v194
v_lshlrev_b32 v233,16,v202
M v[120:123],a[236:239],a[216:219],v[120:123]
s_waitcnt vmcnt(11) lgkmcnt(3)
v_lshlrev_b32 v232,16,v200
v_lshlrev_b32 v231,16,v198
M v[124:127],a[236:239],a[220:223],v[124:127]
v_fmac_f32 v228,s43,v230
v_fmac_f32 v233,4.0,v229
M v[128:131],a[240:243],a[192:195],v[128:131]
buffer_load_dwordx2 v[208:209],v241,s[8:11],s28 offen offset:384
M v[132:135],a[240:243],a[196:199],v[132:135]
v_fma_f32 v234,-4.0,v230,v232
v_fmac_f32 v228,s45,v232
M v[136:139],a[240:243],a[200:203],v[136:139]
v_fmac_f32 v233,s41,v231
v_sub_f32 v232,v232,v230
M v[140:143],a[240:243],a[204:207],v[140:143]
v_fma_f32 v230,-4.0,v229,v231
v_sub_f32 v231,v231,v229
M v[144:147],a[240:243],a[208:211],v[144:147]
buffer_load_dwordx2 v[210:211],v241,s[8:11],s28 offen offset:768
M v[148:151],a[240:243],a[212:215],v[148:151]
v_add_f32 v229,v234,v230
v_sub_f32 v234,v234,v230
M v[152:155],a[240:243],a[216:219],v[152:155]
s_waitcnt lgkmcnt(0)
s_barrier
v_fma_f32 v230,2.0,v231,v232
M v[156:159],a[240:243],a[220:223],v[156:159]
s_waitcnt vmcnt(12)
v_fmac_f32 v232,-2.0,v231
v_and_b32 v196,s42,v196
M v[160:163],a[244:247],a[192:195],v[160:163]
buffer_load_dwordx2 v[212:213],v241,s[8:11],s28 offen offset:1152
M v[164:167],a[244:247],a[196:199],v[164:167]
ds_read_b128 a[192:195],v245 offset:0
ds_read_b128 a[196:199],v246 offset:0
M v[168:171],a[244:247],a[200:203],v[168:171]
ds_read_b128 a[200:203],v245 offset:512
v_and_b32 v192,s42,v192
M v[172:175],a[244:247],a[204:207],v[172:175]
ds_read_b128 a[204:207],v246 offset:512
v_and_b32 v194,s42,v194
M v[176:179],a[244:247],a[208:211],v[176:179]
buffer_load_dwordx4 a[232:235],v247,s[20:23],s47 offen offset:2048 sc1
M v[180:183],a[244:247],a[212:215],v[180:183]
ds_read_b128 a[208:211],v245 offset:1024
ds_read_b128 a[212:215],v246 offset:1024
M v[184:187],a[244:247],a[216:219],v[184:187]
ds_read_b128 a[216:219],v245 offset:1536
v_and_b32 v202,s42,v202
M v[188:191],a[244:247],a[220:223],v[188:191]
s_waitcnt vmcnt(13) lgkmcnt(6)
ds_read_b128 a[220:223],v246 offset:1536
v_and_b32 v200,s42,v200
M a[0:3],a[248:251],a[192:195],a[0:3]
s_waitcnt lgkmcnt(6)
buffer_load_dwordx4 a[236:239],v247,s[20:23],s48 offen offset:2048 sc1
M a[4:7],a[248:251],a[196:199],a[4:7]
s_waitcnt lgkmcnt(5)
s_add_u32 s46,s78,18432
v_and_b32 v198,s42,v198
v_fmac_f32 v192,s43,v196
M a[8:11],a[248:251],a[200:203],a[8:11]
s_waitcnt lgkmcnt(4)
v_fmac_f32 v202,4.0,v194
v_fma_f32 v231,-4.0,v196,v200
M a[12:15],a[248:251],a[204:207],a[12:15]
s_waitcnt lgkmcnt(3)
v_fmac_f32 v192,s45,v200
v_fmac_f32 v202,s41,v198
M a[16:19],a[248:251],a[208:211],a[16:19]
s_waitcnt lgkmcnt(2)
buffer_load_dwordx4 a[240:243],v247,s[20:23],s46 offen offset:0 sc1
M a[20:23],a[248:251],a[212:215],a[20:23]
s_waitcnt lgkmcnt(1)
s_add_u32 s47,s78,21504
v_sub_f32 v200,v200,v196
v_fma_f32 v196,-4.0,v194,v198
M a[24:27],a[248:251],a[216:219],a[24:27]
s_waitcnt lgkmcnt(0)
v_sub_f32 v198,v198,v194
v_add_f32 v194,v231,v196
M a[28:31],a[248:251],a[220:223],a[28:31]
s_waitcnt vmcnt(14)
v_sub_f32 v231,v231,v196
v_fma_f32 v196,2.0,v198,v200
M a[32:35],a[252:255],a[192:195],a[32:35]
buffer_load_dwordx4 a[244:247],v247,s[20:23],s47 offen offset:0 sc1
M a[36:39],a[252:255],a[196:199],a[36:39]
s_add_u32 s48,s78,24576
v_fmac_f32 v200,-2.0,v198
v_cvt_pk_bf16_f32 v192,v228,v192
M a[40:43],a[252:255],a[200:203],a[40:43]
v_cvt_pk_bf16_f32 v202,v233,v202
v_cvt_pk_bf16_f32 v194,v229,v194
M a[44:47],a[252:255],a[204:207],a[44:47]
v_cvt_pk_bf16_f32 v198,v230,v196
v_cvt_pk_bf16_f32 v196,v234,v231
M a[48:51],a[252:255],a[208:211],a[48:51]
buffer_load_dwordx4 a[248:251],v247,s[20:23],s48 offen offset:0 sc1
M a[52:55],a[252:255],a[212:215],a[52:55]
v_cvt_pk_bf16_f32 v200,v232,v200
v_lshlrev_b32 v230,16,v197
M a[56:59],a[252:255],a[216:219],a[56:59]
v_lshlrev_b32 v228,16,v193
v_lshlrev_b32 v229,16,v195
M a[60:63],a[252:255],a[220:223],a[60:63]
s_waitcnt vmcnt(15)
v_lshlrev_b32 v233,16,v203
v_lshlrev_b32 v232,16,v201
M a[64:67],a[224:227],a[192:195],a[64:67]
buffer_load_dwordx4 a[252:255],v247,s[20:23],s46 offen offset:1024 sc1
M a[68:71],a[224:227],a[196:199],a[68:71]
ds_read_b128 a[192:195],v246 offset:2048
v_lshlrev_b32 v231,16,v199
M a[72:75],a[224:227],a[200:203],a[72:75]
v_fmac_f32 v228,s43,v230
v_fmac_f32 v233,4.0,v229
M a[76:79],a[224:227],a[204:207],a[76:79]
v_fma_f32 v234,-4.0,v230,v232
v_fmac_f32 v228,s45,v232
M a[80:83],a[224:227],a[208:211],a[80:83]
v_fmac_f32 v233,s41,v231
v_sub_f32 v232,v232,v230
M a[84:87],a[224:227],a[212:215],a[84:87]
v_fma_f32 v230,-4.0,v229,v231
v_sub_f32 v231,v231,v229
M a[88:91],a[224:227],a[216:219],a[88:91]
v_add_f32 v229,v234,v230
v_sub_f32 v234,v234,v230
M a[92:95],a[224:227],a[220:223],a[92:95]
s_waitcnt vmcnt(15)
buffer_load_dwordx4 a[224:227],v247,s[20:23],s47 offen offset:1024 sc1
M a[0:3],v[216:219],a[196:199],a[0:3]
v_fma_f32 v230,2.0,v231,v232
v_fmac_f32 v232,-2.0,v231
M a[4:7],v[216:219],a[200:203],a[4:7]
v_and_b32 v197,s42,v197
v_and_b32 v193,s42,v193
M a[8:11],v[216:219],a[204:207],a[8:11]
v_and_b32 v195,s42,v195
v_and_b32 v203,s42,v203
M a[12:15],v[216:219],a[208:211],a[12:15]
v_and_b32 v201,s42,v201
v_and_b32 v199,s42,v199
M a[16:19],v[216:219],a[212:215],a[16:19]
v_fmac_f32 v193,s43,v197
v_fmac_f32 v203,4.0,v195
M a[20:23],v[216:219],a[216:219],a[20:23]
v_fma_f32 v231,-4.0,v197,v201
v_fmac_f32 v193,s45,v201
M a[24:27],v[216:219],a[220:223],a[24:27]
s_waitcnt lgkmcnt(0)
v_fmac_f32 v203,s41,v199
v_sub_f32 v201,v201,v197
M a[28:31],v[216:219],a[192:195],a[28:31]
s_waitcnt vmcnt(15)
buffer_load_dwordx4 v[216:219],v247,s[20:23],s48 offen offset:1024 sc1
M a[32:35],v[220:223],a[196:199],a[32:35]
v_fma_f32 v197,-4.0,v195,v199
v_sub_f32 v199,v199,v195
M a[36:39],v[220:223],a[200:203],a[36:39]
v_add_f32 v195,v231,v197
v_sub_f32 v231,v231,v197
M a[40:43],v[220:223],a[204:207],a[40:43]
v_fma_f32 v197,2.0,v199,v201
v_fmac_f32 v201,-2.0,v199
M a[44:47],v[220:223],a[208:211],a[44:47]
v_cvt_pk_bf16_f32 v193,v228,v193
v_cvt_pk_bf16_f32 v203,v233,v203
M a[48:51],v[220:223],a[212:215],a[48:51]
v_cvt_pk_bf16_f32 v195,v229,v195
v_cvt_pk_bf16_f32 v199,v230,v197
M a[52:55],v[220:223],a[216:219],a[52:55]
v_cvt_pk_bf16_f32 v197,v234,v231
v_cvt_pk_bf16_f32 v201,v232,v201
M a[56:59],v[220:223],a[220:223],a[56:59]
ds_write2st64_b64 v243,v[192:193],v[202:203] offset0:238 offset1:255
M a[60:63],v[220:223],a[192:195],a[60:63]
s_waitcnt vmcnt(15)
s_add_u32 s28,s67,786432
buffer_load_dwordx2 v[192:193],v241,s[12:15],s28 offen offset:0
M a[64:67],v[224:227],a[196:199],a[64:67]
ds_read_b128 a[196:199],v245 offset:2048
ds_write2st64_b64 v243,v[194:195],v[196:197] offset0:102 offset1:119
M a[68:71],v[224:227],a[200:203],a[68:71]
buffer_load_dwordx2 v[202:203],v241,s[16:19],s28 offen offset:1536
M a[72:75],v[224:227],a[204:207],a[72:75]
ds_write2st64_b64 v243,v[198:199],v[200:201] offset0:136 offset1:153
M a[76:79],v[224:227],a[208:211],a[76:79]
s_waitcnt vmcnt(12)
v_lshlrev_b32 v230,16,v208
v_lshlrev_b32 v228,16,v204
M a[80:83],v[224:227],a[212:215],a[80:83]
buffer_load_dwordx2 v[194:195],v241,s[8:11],s28 offen offset:0
M a[84:87],v[224:227],a[216:219],a[84:87]
v_lshlrev_b32 v229,16,v206
v_lshlrev_b32 v233,16,v214
M a[88:91],v[224:227],a[220:223],a[88:91]
s_waitcnt vmcnt(11)
v_lshlrev_b32 v232,16,v212
v_lshlrev_b32 v231,16,v210
M a[92:95],v[224:227],a[192:195],a[92:95]
v_fmac_f32 v228,s43,v230
v_fmac_f32 v233,4.0,v229
M a[0:3],a[228:231],a[200:203],a[0:3]
buffer_load_dwordx2 v[196:197],v241,s[8:11],s28 offen offset:384
M a[4:7],a[228:231],a[204:207],a[4:7]
v_fma_f32 v234,-4.0,v230,v232
v_fmac_f32 v228,s45,v232
M a[8:11],a[228:231],a[208:211],a[8:11]
v_fmac_f32 v233,s41,v231
v_sub_f32 v232,v232,v230
M a[12:15],a[228:231],a[212:215],a[12:15]
v_fma_f32 v230,-4.0,v229,v231
v_sub_f32 v231,v231,v229
M a[16:19],a[228:231],a[216:219],a[16:19]
buffer_load_dwordx2 v[198:199],v241,s[8:11],s28 offen offset:768
M a[20:23],a[228:231],a[220:223],a[20:23]
v_add_f32 v229,v234,v230
v_sub_f32 v234,v234,v230
M a[24:27],a[228:231],a[192:195],a[24:27]
s_waitcnt lgkmcnt(2)
v_fma_f32 v230,2.0,v231,v232
v_fmac_f32 v232,-2.0,v231
M a[28:31],a[228:231],a[196:199],a[28:31]
s_waitcnt vmcnt(12)
v_and_b32 v208,s42,v208
v_and_b32 v204,s42,v204
M a[32:35],a[232:235],a[200:203],a[32:35]
buffer_load_dwordx2 v[200:201],v241,s[8:11],s28 offen offset:1152
M a[36:39],a[232:235],a[204:207],a[36:39]
v_and_b32 v206,s42,v206
v_and_b32 v214,s42,v214
M a[40:43],a[232:235],a[208:211],a[40:43]
v_and_b32 v212,s42,v212
v_and_b32 v210,s42,v210
M a[44:47],a[232:235],a[212:215],a[44:47]
v_fmac_f32 v204,s43,v208
v_fmac_f32 v214,4.0,v206
M a[48:51],a[232:235],a[216:219],a[48:51]
buffer_load_dwordx4 v[220:223],v247,s[20:23],s46 offen offset:2048 sc1
M a[52:55],a[232:235],a[220:223],a[52:55]
v_fma_f32 v231,-4.0,v208,v212
v_fmac_f32 v204,s45,v212
M a[56:59],a[232:235],a[192:195],a[56:59]
v_fmac_f32 v214,s41,v210
v_sub_f32 v212,v212,v208
M a[60:63],a[232:235],a[196:199],a[60:63]
s_waitcnt vmcnt(13)
v_fma_f32 v208,-4.0,v206,v210
v_sub_f32 v210,v210,v206
M a[64:67],a[236:239],a[200:203],a[64:67]
buffer_load_dwordx4 v[224:227],v247,s[20:23],s47 offen offset:2048 sc1
M a[68:71],a[236:239],a[204:207],a[68:71]
ds_read_b128 a[200:203],v245 offset:8704
ds_read_b128 a[204:207],v246 offset:8704
M a[72:75],a[236:239],a[208:211],a[72:75]
ds_read_b128 a[208:211],v245 offset:9216
v_add_f32 v206,v231,v208
M a[76:79],a[236:239],a[212:215],a[76:79]
ds_read_b128 a[212:215],v246 offset:9216
v_sub_f32 v231,v231,v208
M a[80:83],a[236:239],a[216:219],a[80:83]
buffer_load_dwordx4 a[228:231],v247,s[20:23],s48 offen offset:2048 sc1
M a[84:87],a[236:239],a[220:223],a[84:87]
s_add_u32 s46,s78,27648
ds_read_b128 a[216:219],v245 offset:9728
ds_read_b128 a[220:223],v246 offset:9728
M a[88:91],a[236:239],a[192:195],a[88:91]
ds_read_b128 a[192:195],v245 offset:10240
v_fma_f32 v208,2.0,v210,v212
M a[92:95],a[236:239],a[196:199],a[92:95]
s_waitcnt vmcnt(14) lgkmcnt(6)
ds_read_b128 a[196:199],v246 offset:10240
v_fmac_f32 v212,-2.0,v210
M a[96:99],a[240:243],a[200:203],a[96:99]
s_waitcnt lgkmcnt(6)
buffer_load_dwordx4 a[232:235],v247,s[20:23],s46 offen offset:0 sc1
M a[100:103],a[240:243],a[204:207],a[100:103]
s_waitcnt lgkmcnt(5)
s_add_u32 s47,s78,30720
v_cvt_pk_bf16_f32 v204,v228,v204
v_cvt_pk_bf16_f32 v214,v233,v214
M a[104:107],a[240:243],a[208:211],a[104:107]
s_waitcnt lgkmcnt(4)
v_cvt_pk_bf16_f32 v206,v229,v206
v_cvt_pk_bf16_f32 v210,v230,v208
M a[108:111],a[240:243],a[212:215],a[108:111]
s_waitcnt lgkmcnt(3)
v_cvt_pk_bf16_f32 v208,v234,v231
v_cvt_pk_bf16_f32 v212,v232,v212
M a[112:115],a[240:243],a[216:219],a[112:115]
s_waitcnt lgkmcnt(2)
buffer_load_dwordx4 a[236:239],v247,s[20:23],s47 offen offset:0 sc1
M a[116:119],a[240:243],a[220:223],a[116:119]
s_waitcnt lgkmcnt(1)
s_add_u32 s48,s78,33792
v_lshlrev_b32 v230,16,v209
v_lshlrev_b32 v228,16,v205
M a[120:123],a[240:243],a[192:195],a[120:123]
s_waitcnt lgkmcnt(0)
v_lshlrev_b32 v229,16,v207
v_lshlrev_b32 v233,16,v215
M a[124:127],a[240:243],a[196:199],a[124:127]
s_waitcnt vmcnt(15)
v_lshlrev_b32 v232,16,v213
v_lshlrev_b32 v231,16,v211
M a[128:131],a[244:247],a[200:203],a[128:131]
buffer_load_dwordx4 a[240:243],v247,s[20:23],s48 offen offset:0 sc1
M a[132:135],a[244:247],a[204:207],a[132:135]
v_fmac_f32 v228,s43,v230
v_fmac_f32 v233,4.0,v229
M a[136:139],a[244:247],a[208:211],a[136:139]
v_fma_f32 v234,-4.0,v230,v232
v_fmac_f32 v228,s45,v232
M a[140:143],a[244:247],a[212:215],a[140:143]
v_fmac_f32 v233,s41,v231
v_sub_f32 v232,v232,v230
M a[144:147],a[244:247],a[216:219],a[144:147]
v_fma_f32 v230,-4.0,v229,v231
v_sub_f32 v231,v231,v229
M a[148:151],a[244:247],a[220:223],a[148:151]
v_add_f32 v229,v234,v230
v_sub_f32 v234,v234,v230
M a[152:155],a[244:247],a[192:195],a[152:155]
v_fma_f32 v230,2.0,v231,v232
v_fmac_f32 v232,-2.0,v231
M a[156:159],a[244:247],a[196:199],a[156:159]
s_waitcnt vmcnt(15)
buffer_load_dwordx4 a[244:247],v247,s[20:23],s46 offen offset:1024 sc1
M a[160:163],a[248:251],a[200:203],a[160:163]
ds_read_b128 a[200:203],v246 offset:10752
v_and_b32 v209,s42,v209
M a[164:167],a[248:251],a[204:207],a[164:167]
v_and_b32 v205,s42,v205
v_and_b32 v207,s42,v207
M a[168:171],a[248:251],a[208:211],a[168:171]
v_and_b32 v215,s42,v215
v_and_b32 v213,s42,v213
M a[172:175],a[248:251],a[212:215],a[172:175]
v_and_b32 v211,s42,v211
v_fmac_f32 v205,s43,v209
M a[176:179],a[248:251],a[216:219],a[176:179]
v_fmac_f32 v215,4.0,v207
v_fma_f32 v231,-4.0,v209,v213
M a[180:183],a[248:251],a[220:223],a[180:183]
v_fmac_f32 v205,s45,v213
v_fmac_f32 v215,s41,v211
M a[184:187],a[248:251],a[192:195],a[184:187]
v_sub_f32 v213,v213,v209
v_fma_f32 v209,-4.0,v207,v211
M a[188:191],a[248:251],a[196:199],a[188:191]
s_waitcnt vmcnt(15)
buffer_load_dwordx4 a[248:251],v247,s[20:23],s47 offen offset:1024 sc1
M a[96:99],a[252:255],a[204:207],a[96:99]
v_sub_f32 v211,v211,v207
v_add_f32 v207,v231,v209
M a[100:103],a[252:255],a[208:211],a[100:103]
v_sub_f32 v231,v231,v209
v_fma_f32 v209,2.0,v211,v213
M a[104:107],a[252:255],a[212:215],a[104:107]
v_fmac_f32 v213,-2.0,v211
v_cvt_pk_bf16_f32 v205,v228,v205
M a[108:111],a[252:255],a[216:219],a[108:111]
v_cvt_pk_bf16_f32 v215,v233,v215
v_cvt_pk_bf16_f32 v207,v229,v207
M a[112:115],a[252:255],a[220:223],a[112:115]
v_cvt_pk_bf16_f32 v211,v230,v209
v_cvt_pk_bf16_f32 v209,v234,v231
M a[116:119],a[252:255],a[192:195],a[116:119]
v_cvt_pk_bf16_f32 v213,v232,v213
v_add_u32 v228,121856,v243
M a[120:123],a[252:255],a[196:199],a[120:123]
s_waitcnt lgkmcnt(0)
ds_write2st64_b64 v228,v[204:205],v[214:215] offset0:1 offset1:18
M a[124:127],a[252:255],a[200:203],a[124:127]
s_waitcnt vmcnt(15)
s_add_u32 s28,s67,1179648
buffer_load_dwordx2 v[204:205],v241,s[12:15],s28 offen offset:0
M a[128:131],a[224:227],a[204:207],a[128:131]
ds_write2st64_b64 v243,v[206:207],v[208:209] offset0:103 offset1:120
M a[132:135],a[224:227],a[208:211],a[132:135]
buffer_load_dwordx2 v[214:215],v241,s[16:19],s28 offen offset:1536
M a[136:139],a[224:227],a[212:215],a[136:139]
ds_write2st64_b64 v243,v[210:211],v[212:213] offset0:137 offset1:154
M a[140:143],a[224:227],a[216:219],a[140:143]
v_fmac_f32 v235,s43,v237
v_fmac_f32 v240,4.0,v236
M a[144:147],a[224:227],a[220:223],a[144:147]
buffer_load_dwordx2 v[206:207],v241,s[8:11],s28 offen offset:0
M a[148:151],a[224:227],a[192:195],a[148:151]
v_fma_f32 v228,-4.0,v237,v239
v_fmac_f32 v235,s45,v239
M a[152:155],a[224:227],a[196:199],a[152:155]
v_fmac_f32 v240,s41,v238
v_sub_f32 v239,v239,v237
M a[156:159],a[224:227],a[200:203],a[156:159]
s_waitcnt vmcnt(17)
v_fma_f32 v237,-4.0,v236,v238
v_sub_f32 v238,v238,v236
M a[160:163],v[216:219],a[204:207],a[160:163]
buffer_load_dwordx2 v[208:209],v241,s[8:11],s28 offen offset:384
M a[164:167],v[216:219],a[208:211],a[164:167]
ds_read_b128 a[204:207],v245 offset:10752
v_add_f32 v236,v228,v237
M a[168:171],v[216:219],a[212:215],a[168:171]
v_sub_f32 v228,v228,v237
v_fma_f32 v237,2.0,v238,v239
M a[172:175],v[216:219],a[216:219],a[172:175]
v_fmac_f32 v239,-2.0,v238
v_cvt_pk_bf16_f32 v229,v235,v240
M a[176:179],v[216:219],a[220:223],a[176:179]
buffer_load_dwordx2 v[210:211],v241,s[8:11],s28 offen offset:768
M a[180:183],v[216:219],a[192:195],a[180:183]
v_cvt_pk_bf16_f32 v230,v236,v228
v_cvt_pk_bf16_f32 v231,v237,v239
M a[184:187],v[216:219],a[196:199],a[184:187]
v_add_u32 v228,121856,v244
M a[188:191],v[216:219],a[200:203],a[188:191]
s_waitcnt vmcnt(12)
ds_write_b16 v228,v229 offset:0
M a[96:99],v[220:223],a[208:211],a[96:99]
buffer_load_dwordx2 v[212:213],v241,s[8:11],s28 offen offset:1152
M a[100:103],v[220:223],a[212:215],a[100:103]
s_add_u32 s29,s68,0
ds_write_b16_d16_hi v228,v229 offset:8704
M a[104:107],v[220:223],a[216:219],a[104:107]
ds_write_b16 v244,v230 offset:52224
M a[108:111],v[220:223],a[220:223],a[108:111]
ds_write_b16_d16_hi v244,v230 offset:60928
M a[112:115],v[220:223],a[192:195],a[112:115]
buffer_load_short_d16_hi v235,v242,s[12:15],s29 offen offset:0
M a[116:119],v[220:223],a[196:199],a[116:119]
v_add_u32 v228,69632,v244
M a[120:123],v[220:223],a[200:203],a[120:123]
s_waitcnt lgkmcnt(4)
buffer_load_short_d16_hi v236,v242,s[8:11],s29 offen offset:0
M a[124:127],v[220:223],a[204:207],a[124:127]
s_waitcnt vmcnt(14)
ds_write_b16 v228,v231 offset:0
M a[128:131],v[224:227],a[208:211],a[128:131]
buffer_load_short_d16_hi v237,v242,s[8:11],s29 offen offset:384
M a[132:135],v[224:227],a[212:215],a[132:135]
ds_write_b16_d16_hi v228,v231 offset:8704
M a[136:139],v[224:227],a[216:219],a[136:139]
buffer_load_short_d16_hi v238,v242,s[8:11],s29 offen offset:768
M a[140:143],v[224:227],a[220:223],a[140:143]
v_lshlrev_b32 v230,16,v196
v_lshlrev_b32 v228,16,v192
M a[144:147],v[224:227],a[192:195],a[144:147]
buffer_load_short_d16_hi v239,v242,s[8:11],s29 offen offset:1152
M a[148:151],v[224:227],a[196:199],a[148:151]
v_lshlrev_b32 v229,16,v194
v_lshlrev_b32 v233,16,v202
M a[152:155],v[224:227],a[200:203],a[152:155]
buffer_load_short_d16_hi v240,v242,s[16:19],s29 offen offset:1536
M a[156:159],v[224:227],a[204:207],a[156:159]
s_waitcnt vmcnt(17)
v_lshlrev_b32 v232,16,v200
v_lshlrev_b32 v231,16,v198
M a[160:163],a[228:231],a[208:211],a[160:163]
buffer_load_dwordx4 a[252:255],v247,s[20:23],s48 offen offset:1024 sc1
M a[164:167],a[228:231],a[212:215],a[164:167]
ds_read_b128 a[208:211],v245 offset:17408
ds_read_b128 a[212:215],v246 offset:17408
M a[168:171],a[228:231],a[216:219],a[168:171]
ds_read_b128 a[216:219],v245 offset:17920
v_fmac_f32 v228,s43,v230
M a[172:175],a[228:231],a[220:223],a[172:175]
ds_read_b128 a[220:223],v246 offset:17920
v_fmac_f32 v233,4.0,v229
M a[176:179],a[228:231],a[192:195],a[176:179]
buffer_load_dwordx4 a[224:227],v247,s[20:23],s46 offen offset:2048 sc1
M a[180:183],a[228:231],a[196:199],a[180:183]
ds_read_b128 a[192:195],v245 offset:18432
ds_read_b128 a[196:199],v246 offset:18432
M a[184:187],a[228:231],a[200:203],a[184:187]
ds_read_b128 a[200:203],v245 offset:18944
v_fma_f32 v234,-4.0,v230,v232
M a[188:191],a[228:231],a[204:207],a[188:191]
s_waitcnt vmcnt(18) lgkmcnt(6)
ds_read_b128 a[204:207],v246 offset:18944
v_fmac_f32 v228,s45,v232
M v[0:3],a[232:235],a[208:211],v[0:3]
s_waitcnt lgkmcnt(6)
buffer_load_dwordx4 v[216:219],v247,s[20:23],s47 offen offset:2048 sc1
M v[4:7],a[232:235],a[212:215],v[4:7]
s_waitcnt lgkmcnt(5)
v_fmac_f32 v233,s41,v231
v_sub_f32 v232,v232,v230
M v[8:11],a[232:235],a[216:219],v[8:11]
s_waitcnt lgkmcnt(4)
v_fma_f32 v230,-4.0,v229,v231
v_sub_f32 v231,v231,v229
M v[12:15],a[232:235],a[220:223],v[12:15]
s_waitcnt lgkmcnt(3)
v_add_f32 v229,v234,v230
v_sub_f32 v234,v234,v230
M v[16:19],a[232:235],a[192:195],v[16:19]
s_waitcnt lgkmcnt(2)
buffer_load_dwordx4 v[220:223],v247,s[20:23],s48 offen offset:2048 sc1
M v[20:23],a[232:235],a[196:199],v[20:23]
s_waitcnt lgkmcnt(1)
s_add_u32 s46,s78,36864
v_fma_f32 v230,2.0,v231,v232
v_fmac_f32 v232,-2.0,v231
M v[24:27],a[232:235],a[200:203],v[24:27]
s_waitcnt lgkmcnt(0)
v_and_b32 v196,s42,v196
v_and_b32 v192,s42,v192
M v[28:31],a[232:235],a[204:207],v[28:31]
s_waitcnt vmcnt(19)
v_and_b32 v194,s42,v194
v_and_b32 v202,s42,v202
M v[32:35],a[236:239],a[208:211],v[32:35]
buffer_load_dwordx4 v[224:227],v247,s[20:23],s46 offen offset:0 sc1
M v[36:39],a[236:239],a[212:215],v[36:39]
s_add_u32 s47,s78,39936
v_and_b32 v200,s42,v200
v_and_b32 v198,s42,v198
M v[40:43],a[236:239],a[216:219],v[40:43]
v_fmac_f32 v192,s43,v196
v_fmac_f32 v202,4.0,v194
M v[44:47],a[236:239],a[220:223],v[44:47]
v_fma_f32 v231,-4.0,v196,v200
v_fmac_f32 v192,s45,v200
M v[48:51],a[236:239],a[192:195],v[48:51]
buffer_load_dwordx4 a[228:231],v247,s[20:23],s47 offen offset:0 sc1
M v[52:55],a[236:239],a[196:199],v[52:55]
s_add_u32 s48,s78,43008
v_fmac_f32 v202,s41,v198
v_sub_f32 v200,v200,v196
M v[56:59],a[236:239],a[200:203],v[56:59]
v_fma_f32 v196,-4.0,v194,v198
v_sub_f32 v198,v198,v194
M v[60:63],a[236:239],a[204:207],v[60:63]
s_waitcnt vmcnt(20)
v_add_f32 v194,v231,v196
v_sub_f32 v231,v231,v196
M v[64:67],a[240:243],a[208:211],v[64:67]
global_load_dword v251,v252,s[82:83]
M v[68:71],a[240:243],a[212:215],v[68:71]
ds_read_b128 a[208:211],v246 offset:19456
v_fma_f32 v196,2.0,v198,v200
M v[72:75],a[240:243],a[216:219],v[72:75]
buffer_load_dwordx4 a[232:235],v247,s[20:23],s48 offen offset:0 sc1
M v[76:79],a[240:243],a[220:223],v[76:79]
v_fmac_f32 v200,-2.0,v198
v_cvt_pk_bf16_f32 v192,v228,v192
M v[80:83],a[240:243],a[192:195],v[80:83]
v_cvt_pk_bf16_f32 v202,v233,v202
v_cvt_pk_bf16_f32 v194,v229,v194
M v[84:87],a[240:243],a[196:199],v[84:87]
v_cvt_pk_bf16_f32 v198,v230,v196
v_cvt_pk_bf16_f32 v196,v234,v231
M v[88:91],a[240:243],a[200:203],v[88:91]
buffer_load_dwordx4 a[236:239],v247,s[20:23],s46 offen offset:1024 sc1
M v[92:95],a[240:243],a[204:207],v[92:95]
s_waitcnt vmcnt(22)
v_cvt_pk_bf16_f32 v200,v232,v200
v_lshlrev_b32 v230,16,v197
M v[0:3],a[244:247],a[212:215],v[0:3]
v_lshlrev_b32 v228,16,v193
v_lshlrev_b32 v229,16,v195
M v[4:7],a[244:247],a[216:219],v[4:7]
v_lshlrev_b32 v233,16,v203
v_lshlrev_b32 v232,16,v201
M v[8:11],a[244:247],a[220:223],v[8:11]
buffer_load_dwordx4 a[240:243],v247,s[20:23],s47 offen offset:1024 sc1
M v[12:15],a[244:247],a[192:195],v[12:15]
v_lshlrev_b32 v231,16,v199
v_fmac_f32 v228,s43,v230
M v[16:19],a[244:247],a[196:199],v[16:19]
v_fmac_f32 v233,4.0,v229
v_fma_f32 v234,-4.0,v230,v232
M v[20:23],a[244:247],a[200:203],v[20:23]
v_fmac_f32 v228,s45,v232
v_fmac_f32 v233,s41,v231
M v[24:27],a[244:247],a[204:207],v[24:27]
s_waitcnt lgkmcnt(0)
v_sub_f32 v232,v232,v230
v_fma_f32 v230,-4.0,v229,v231
M v[28:31],a[244:247],a[208:211],v[28:31]
s_waitcnt vmcnt(22)
buffer_load_dwordx4 a[244:247],v247,s[20:23],s48 offen offset:1024 sc1
M v[32:35],a[248:251],a[212:215],v[32:35]
v_sub_f32 v231,v231,v229
v_add_f32 v229,v234,v230
M v[36:39],a[248:251],a[216:219],v[36:39]
v_sub_f32 v234,v234,v230
v_fma_f32 v230,2.0,v231,v232
M v[40:43],a[248:251],a[220:223],v[40:43]
v_fmac_f32 v232,-2.0,v231
v_and_b32 v197,s42,v197
M v[44:47],a[248:251],a[192:195],v[44:47]
v_and_b32 v193,s42,v193
v_and_b32 v195,s42,v195
M v[48:51],a[248:251],a[196:199],v[48:51]
v_and_b32 v203,s42,v203
v_and_b32 v201,s42,v201
M v[52:55],a[248:251],a[200:203],v[52:55]
v_and_b32 v199,s42,v199
v_fmac_f32 v193,s43,v197
M v[56:59],a[248:251],a[204:207],v[56:59]
v_fmac_f32 v203,4.0,v195
v_fma_f32 v231,-4.0,v197,v201
M v[60:63],a[248:251],a[208:211],v[60:63]
s_waitcnt vmcnt(10)
buffer_load_dwordx4 a[248:251],v247,s[20:23],s46 offen offset:2048 sc1
M v[64:67],a[252:255],a[212:215],v[64:67]
ds_read_b128 a[212:215],v245 offset:19456
v_fmac_f32 v193,s45,v201
M v[68:71],a[252:255],a[216:219],v[68:71]
v_fmac_f32 v203,s41,v199
v_sub_f32 v201,v201,v197
M v[72:75],a[252:255],a[220:223],v[72:75]
v_fma_f32 v197,-4.0,v195,v199
v_sub_f32 v199,v199,v195
M v[76:79],a[252:255],a[192:195],v[76:79]
v_add_f32 v195,v231,v197
v_sub_f32 v231,v231,v197
M v[80:83],a[252:255],a[196:199],v[80:83]
v_fma_f32 v197,2.0,v199,v201
v_fmac_f32 v201,-2.0,v199
M v[84:87],a[252:255],a[200:203],v[84:87]
v_cvt_pk_bf16_f32 v193,v228,v193
v_cvt_pk_bf16_f32 v203,v233,v203
M v[88:91],a[252:255],a[204:207],v[88:91]
v_cvt_pk_bf16_f32 v195,v229,v195
v_cvt_pk_bf16_f32 v199,v230,v197
M v[92:95],a[252:255],a[208:211],v[92:95]
s_waitcnt vmcnt(10)
buffer_load_dwordx4 a[252:255],v247,s[20:23],s47 offen offset:2048 sc1
M v[0:3],a[224:227],a[216:219],v[0:3]
v_cvt_pk_bf16_f32 v197,v234,v231
v_cvt_pk_bf16_f32 v201,v232,v201
M v[4:7],a[224:227],a[220:223],v[4:7]
v_add_u32 v228,121856,v243
M v[8:11],a[224:227],a[192:195],v[8:11]
ds_write2st64_b64 v228,v[192:193],v[202:203] offset0:2 offset1:19
M v[12:15],a[224:227],a[196:199],v[12:15]
s_add_u32 s28,s68,0
buffer_load_dwordx2 v[192:193],v250,s[12:15],s28 offen offset:0
M v[16:19],a[224:227],a[200:203],v[16:19]
ds_write2st64_b64 v243,v[194:195],v[196:197] offset0:104 offset1:121
M v[20:23],a[224:227],a[204:207],v[20:23]
buffer_load_dwordx2 v[202:203],v250,s[16:19],s28 offen offset:1536
M v[24:27],a[224:227],a[208:211],v[24:27]
s_waitcnt lgkmcnt(2)
ds_write2st64_b64 v243,v[198:199],v[200:201] offset0:138 offset1:155
M v[28:31],a[224:227],a[212:215],v[28:31]
s_waitcnt vmcnt(12)
v_lshlrev_b32 v230,16,v208
v_lshlrev_b32 v228,16,v204
M v[32:35],v[216:219],a[216:219],v[32:35]
buffer_load_dwordx2 v[194:195],v250,s[8:11],s28 offen offset:0
M v[36:39],v[216:219],a[220:223],v[36:39]
v_lshlrev_b32 v229,16,v206
v_lshlrev_b32 v233,16,v214
M v[40:43],v[216:219],a[192:195],v[40:43]
v_lshlrev_b32 v232,16,v212
v_lshlrev_b32 v231,16,v210
M v[44:47],v[216:219],a[196:199],v[44:47]
v_fmac_f32 v228,s43,v230
v_fmac_f32 v233,4.0,v229
M v[48:51],v[216:219],a[200:203],v[48:51]
buffer_load_dwordx2 v[196:197],v250,s[8:11],s28 offen offset:384
M v[52:55],v[216:219],a[204:207],v[52:55]
v_fma_f32 v234,-4.0,v230,v232
v_fmac_f32 v228,s45,v232
M v[56:59],v[216:219],a[208:211],v[56:59]
v_fmac_f32 v233,s41,v231
v_sub_f32 v232,v232,v230
M v[60:63],v[216:219],a[212:215],v[60:63]
s_waitcnt vmcnt(13)
v_fma_f32 v230,-4.0,v229,v231
v_sub_f32 v231,v231,v229
M v[64:67],v[220:223],a[216:219],v[64:67]
buffer_load_dwordx2 v[198:199],v250,s[8:11],s28 offen offset:768
M v[68:71],v[220:223],a[220:223],v[68:71]
ds_read_b128 a[216:219],v245 offset:26112
ds_read_b128 a[220:223],v246 offset:26112
M v[72:75],v[220:223],a[192:195],v[72:75]
ds_read_b128 a[192:195],v245 offset:26624
v_add_f32 v229,v234,v230
M v[76:79],v[220:223],a[196:199],v[76:79]
ds_read_b128 a[196:199],v246 offset:26624
v_sub_f32 v234,v234,v230
M v[80:83],v[220:223],a[200:203],v[80:83]
buffer_load_dwordx2 v[200:201],v250,s[8:11],s28 offen offset:1152
M v[84:87],v[220:223],a[204:207],v[84:87]
ds_read_b128 a[200:203],v245 offset:27136
ds_read_b128 a[204:207],v246 offset:27136
M v[88:91],v[220:223],a[208:211],v[88:91]
ds_read_b128 a[208:211],v245 offset:27648
v_fma_f32 v230,2.0,v231,v232
M v[92:95],v[220:223],a[212:215],v[92:95]
s_waitcnt vmcnt(14) lgkmcnt(6)
ds_read_b128 a[212:215],v246 offset:27648
v_fmac_f32 v232,-2.0,v231
M v[96:99],v[224:227],a[216:219],v[96:99]
s_waitcnt lgkmcnt(6)
buffer_load_dwordx4 a[224:227],v247,s[20:23],s48 offen offset:2048 sc1
M v[100:103],v[224:227],a[220:223],v[100:103]
s_waitcnt lgkmcnt(5)
s_add_u32 s46,s79,9216
v_and_b32 v208,s42,v208
v_and_b32 v204,s42,v204
M v[104:107],v[224:227],a[192:195],v[104:107]
s_waitcnt lgkmcnt(4)
v_and_b32 v206,s42,v206
v_and_b32 v214,s42,v214
M v[108:111],v[224:227],a[196:199],v[108:111]
s_waitcnt lgkmcnt(3)
v_and_b32 v212,s42,v212
v_and_b32 v210,s42,v210
M v[112:115],v[224:227],a[200:203],v[112:115]
s_waitcnt lgkmcnt(2)
buffer_load_dwordx4 v[216:219],v247,s[20:23],s46 offen offset:0 sc1
M v[116:119],v[224:227],a[204:207],v[116:119]
s_waitcnt lgkmcnt(1)
s_add_u32 s47,s79,12288
v_fmac_f32 v204,s43,v208
v_fmac_f32 v214,4.0,v206
M v[120:123],v[224:227],a[208:211],v[120:123]
s_waitcnt lgkmcnt(0)
v_fma_f32 v231,-4.0,v208,v212
v_fmac_f32 v204,s45,v212
M v[124:127],v[224:227],a[212:215],v[124:127]
s_waitcnt vmcnt(15)
v_fmac_f32 v214,s41,v210
v_sub_f32 v212,v212,v208
M v[128:131],a[228:231],a[216:219],v[128:131]
buffer_load_dwordx4 v[220:223],v247,s[20:23],s47 offen offset:0 sc1
M v[132:135],a[228:231],a[220:223],v[132:135]
s_add_u32 s48,s79,15360
v_fma_f32 v208,-4.0,v206,v210
v_sub_f32 v210,v210,v206
M v[136:139],a[228:231],a[192:195],v[136:139]
v_add_f32 v206,v231,v208
v_sub_f32 v231,v231,v208
M v[140:143],a[228:231],a[196:199],v[140:143]
v_fma_f32 v208,2.0,v210,v212
v_fmac_f32 v212,-2.0,v210
M v[144:147],a[228:231],a[200:203],v[144:147]
buffer_load_dwordx4 v[224:227],v247,s[20:23],s48 offen offset:0 sc1
M v[148:151],a[228:231],a[204:207],v[148:151]
v_cvt_pk_bf16_f32 v204,v228,v204
v_cvt_pk_bf16_f32 v214,v233,v214
M v[152:155],a[228:231],a[208:211],v[152:155]
v_cvt_pk_bf16_f32 v206,v229,v206
v_cvt_pk_bf16_f32 v210,v230,v208
M v[156:159],a[228:231],a[212:215],v[156:159]
s_waitcnt vmcnt(15)
v_cvt_pk_bf16_f32 v208,v234,v231
v_cvt_pk_bf16_f32 v212,v232,v212
M v[160:163],a[232:235],a[216:219],v[160:163]
buffer_load_dwordx4 a[228:231],v247,s[20:23],s46 offen offset:1024 sc1
M v[164:167],a[232:235],a[220:223],v[164:167]
ds_read_b128 a[216:219],v246 offset:28160
v_lshlrev_b32 v230,16,v209
M v[168:171],a[232:235],a[192:195],v[168:171]
v_lshlrev_b32 v228,16,v205
v_lshlrev_b32 v229,16,v207
M v[172:175],a[232:235],a[196:199],v[172:175]
v_lshlrev_b32 v233,16,v215
v_lshlrev_b32 v232,16,v213
M v[176:179],a[232:235],a[200:203],v[176:179]
v_lshlrev_b32 v231,16,v211
v_fmac_f32 v228,s43,v230
M v[180:183],a[232:235],a[204:207],v[180:183]
v_fmac_f32 v233,4.0,v229
v_fma_f32 v234,-4.0,v230,v232
M v[184:187],a[232:235],a[208:211],v[184:187]
v_fmac_f32 v228,s45,v232
v_fmac_f32 v233,s41,v231
M v[188:191],a[232:235],a[212:215],v[188:191]
s_waitcnt vmcnt(15)
buffer_load_dwordx4 a[232:235],v247,s[20:23],s47 offen offset:1024 sc1
M v[96:99],a[236:239],a[220:223],v[96:99]
v_sub_f32 v232,v232,v230
v_fma_f32 v230,-4.0,v229,v231
M v[100:103],a[236:239],a[192:195],v[100:103]
v_sub_f32 v231,v231,v229
v_add_f32 v229,v234,v230
M v[104:107],a[236:239],a[196:199],v[104:107]
v_sub_f32 v234,v234,v230
v_fma_f32 v230,2.0,v231,v232
M v[108:111],a[236:239],a[200:203],v[108:111]
v_fmac_f32 v232,-2.0,v231
v_and_b32 v209,s42,v209
M v[112:115],a[236:239],a[204:207],v[112:115]
v_and_b32 v205,s42,v205
v_and_b32 v207,s42,v207
M v[116:119],a[236:239],a[208:211],v[116:119]
v_and_b32 v215,s42,v215
v_and_b32 v213,s42,v213
M v[120:123],a[236:239],a[212:215],v[120:123]
s_waitcnt lgkmcnt(0)
v_and_b32 v211,s42,v211
v_fmac_f32 v205,s43,v209
M v[124:127],a[236:239],a[216:219],v[124:127]
s_waitcnt vmcnt(15)
buffer_load_dwordx4 a[236:239],v247,s[20:23],s48 offen offset:1024 sc1
M v[128:131],a[240:243],a[220:223],v[128:131]
v_fmac_f32 v215,4.0,v207
v_fma_f32 v231,-4.0,v209,v213
M v[132:135],a[240:243],a[192:195],v[132:135]
v_fmac_f32 v205,s45,v213
v_fmac_f32 v215,s41,v211
M v[136:139],a[240:243],a[196:199],v[136:139]
v_sub_f32 v213,v213,v209
v_fma_f32 v209,-4.0,v207,v211
M v[140:143],a[240:243],a[200:203],v[140:143]
v_sub_f32 v211,v211,v207
v_add_f32 v207,v231,v209
M v[144:147],a[240:243],a[204:207],v[144:147]
v_sub_f32 v231,v231,v209
v_fma_f32 v209,2.0,v211,v213
M v[148:151],a[240:243],a[208:211],v[148:151]
v_fmac_f32 v213,-2.0,v211
v_cvt_pk_bf16_f32 v205,v228,v205
M v[152:155],a[240:243],a[212:215],v[152:155]
v_cvt_pk_bf16_f32 v215,v233,v215
v_cvt_pk_bf16_f32 v207,v229,v207
M v[156:159],a[240:243],a[216:219],v[156:159]
s_waitcnt vmcnt(15)
buffer_load_dwordx4 a[240:243],v247,s[20:23],s46 offen offset:2048 sc1
M v[160:163],a[244:247],a[220:223],v[160:163]
ds_read_b128 a[220:223],v245 offset:28160
v_cvt_pk_bf16_f32 v211,v230,v209
M v[164:167],a[244:247],a[192:195],v[164:167]
v_cvt_pk_bf16_f32 v209,v234,v231
v_cvt_pk_bf16_f32 v213,v232,v213
M v[168:171],a[244:247],a[196:199],v[168:171]
v_add_u32 v228,121856,v243
M v[172:175],a[244:247],a[200:203],v[172:175]
ds_write2st64_b64 v228,v[204:205],v[214:215] offset0:3 offset1:20
M v[176:179],a[244:247],a[204:207],v[176:179]
s_add_u32 s28,s68,393216
buffer_load_dwordx2 v[204:205],v241,s[12:15],s28 offen offset:0
M v[180:183],a[244:247],a[208:211],v[180:183]
ds_write2st64_b64 v243,v[206:207],v[208:209] offset0:105 offset1:122
M v[184:187],a[244:247],a[212:215],v[184:187]
buffer_load_dwordx2 v[214:215],v241,s[16:19],s28 offen offset:1536
M v[188:191],a[244:247],a[216:219],v[188:191]
s_waitcnt vmcnt(17)
ds_write2st64_b64 v243,v[210:211],v[212:213] offset0:139 offset1:156
M v[96:99],a[248:251],a[192:195],v[96:99]
s_waitcnt vmcnt(12)
v_lshlrev_b32 v230,16,v196
v_lshlrev_b32 v228,16,v192
M v[100:103],a[248:251],a[196:199],v[100:103]
buffer_load_dwordx2 v[206:207],v241,s[8:11],s28 offen offset:0
M v[104:107],a[248:251],a[200:203],v[104:107]
v_lshlrev_b32 v229,16,v194
v_lshlrev_b32 v233,16,v202
M v[108:111],a[248:251],a[204:207],v[108:111]
s_waitcnt vmcnt(11)
v_lshlrev_b32 v232,16,v200
v_lshlrev_b32 v231,16,v198
M v[112:115],a[248:251],a[208:211],v[112:115]
v_fmac_f32 v228,s43,v230
v_fmac_f32 v233,4.0,v229
M v[116:119],a[248:251],a[212:215],v[116:119]
buffer_load_dwordx2 v[208:209],v241,s[8:11],s28 offen offset:384
M v[120:123],a[248:251],a[216:219],v[120:123]
s_waitcnt lgkmcnt(3)
v_fma_f32 v234,-4.0,v230,v232
v_fmac_f32 v228,s45,v232
M v[124:127],a[248:251],a[220:223],v[124:127]
v_fmac_f32 v233,s41,v231
v_sub_f32 v232,v232,v230
M v[128:131],a[252:255],a[192:195],v[128:131]
v_fma_f32 v230,-4.0,v229,v231
v_sub_f32 v231,v231,v229
M v[132:135],a[252:255],a[196:199],v[132:135]
buffer_load_dwordx2 v[210:211],v241,s[8:11],s28 offen offset:768
M v[136:139],a[252:255],a[200:203],v[136:139]
v_add_f32 v229,v234,v230
v_sub_f32 v234,v234,v230
M v[140:143],a[252:255],a[204:207],v[140:143]
v_fma_f32 v230,2.0,v231,v232
v_fmac_f32 v232,-2.0,v231
M v[144:147],a[252:255],a[208:211],v[144:147]
v_and_b32 v196,s42,v196
v_and_b32 v192,s42,v192
M v[148:151],a[252:255],a[212:215],v[148:151]
buffer_load_dwordx2 v[212:213],v241,s[8:11],s28 offen offset:1152
M v[152:155],a[252:255],a[216:219],v[152:155]
s_waitcnt lgkmcnt(0)
s_barrier
v_and_b32 v194,s42,v194
M v[156:159],a[252:255],a[220:223],v[156:159]
s_waitcnt vmcnt(13)
v_and_b32 v202,s42,v202
v_and_b32 v200,s42,v200
M v[160:163],a[224:227],a[192:195],v[160:163]
ds_read_b128 a[192:195],v245 offset:34816
v_and_b32 v198,s42,v198
M v[164:167],a[224:227],a[196:199],v[164:167]
buffer_load_dwordx4 a[244:247],v247,s[20:23],s47 offen offset:2048 sc1
M v[168:171],a[224:227],a[200:203],v[168:171]
ds_read_b128 a[196:199],v246 offset:34816
ds_read_b128 a[200:203],v245 offset:35328
M v[172:175],a[224:227],a[204:207],v[172:175]
ds_read_b128 a[204:207],v246 offset:35328
v_fmac_f32 v192,s43,v196
M v[176:179],a[224:227],a[208:211],v[176:179]
ds_read_b128 a[208:211],v245 offset:35840
v_fmac_f32 v202,4.0,v194
M v[180:183],a[224:227],a[212:215],v[180:183]
buffer_load_dwordx4 a[248:251],v247,s[20:23],s48 offen offset:2048 sc1
M v[184:187],a[224:227],a[216:219],v[184:187]
s_add_u32 s46,s79,18432
ds_read_b128 a[212:215],v246 offset:35840
ds_read_b128 a[216:219],v245 offset:36352
M v[188:191],a[224:227],a[220:223],v[188:191]
s_waitcnt vmcnt(14) lgkmcnt(6)
ds_read_b128 a[220:223],v246 offset:36352
v_fma_f32 v231,-4.0,v196,v200
M a[0:3],v[216:219],a[192:195],a[0:3]
s_waitcnt lgkmcnt(6)
v_fmac_f32 v192,s45,v200
v_fmac_f32 v202,s41,v198
M a[4:7],v[216:219],a[196:199],a[4:7]
s_waitcnt lgkmcnt(5)
buffer_load_dwordx4 a[252:255],v247,s[20:23],s46 offen offset:0 sc1
M a[8:11],v[216:219],a[200:203],a[8:11]
s_waitcnt lgkmcnt(4)
s_add_u32 s47,s79,21504
v_sub_f32 v200,v200,v196
v_fma_f32 v196,-4.0,v194,v198
M a[12:15],v[216:219],a[204:207],a[12:15]
s_waitcnt lgkmcnt(3)
v_sub_f32 v198,v198,v194
v_add_f32 v194,v231,v196
M a[16:19],v[216:219],a[208:211],a[16:19]
s_waitcnt lgkmcnt(2)
v_sub_f32 v231,v231,v196
v_fma_f32 v196,2.0,v198,v200
M a[20:23],v[216:219],a[212:215],a[20:23]
s_waitcnt lgkmcnt(1)
buffer_load_dwordx4 a[224:227],v247,s[20:23],s47 offen offset:0 sc1
M a[24:27],v[216:219],a[216:219],a[24:27]
s_waitcnt lgkmcnt(0)
s_add_u32 s48,s79,24576
v_fmac_f32 v200,-2.0,v198
v_cvt_pk_bf16_f32 v192,v228,v192
M a[28:31],v[216:219],a[220:223],a[28:31]
s_waitcnt vmcnt(15)
v_cvt_pk_bf16_f32 v202,v233,v202
v_cvt_pk_bf16_f32 v194,v229,v194
M a[32:35],v[220:223],a[192:195],a[32:35]
v_cvt_pk_bf16_f32 v198,v230,v196
v_cvt_pk_bf16_f32 v196,v234,v231
M a[36:39],v[220:223],a[196:199],a[36:39]
buffer_load_dwordx4 v[216:219],v247,s[20:23],s48 offen offset:0 sc1
M a[40:43],v[220:223],a[200:203],a[40:43]
v_cvt_pk_bf16_f32 v200,v232,v200
v_lshlrev_b32 v230,16,v197
M a[44:47],v[220:223],a[204:207],a[44:47]
v_lshlrev_b32 v228,16,v193
v_lshlrev_b32 v229,16,v195
M a[48:51],v[220:223],a[208:211],a[48:51]
v_lshlrev_b32 v233,16,v203
v_lshlrev_b32 v232,16,v201
M a[52:55],v[220:223],a[212:215],a[52:55]
v_lshlrev_b32 v231,16,v199
v_fmac_f32 v228,s43,v230
M a[56:59],v[220:223],a[216:219],a[56:59]
v_fmac_f32 v233,4.0,v229
v_fma_f32 v234,-4.0,v230,v232
M a[60:63],v[220:223],a[220:223],a[60:63]
s_waitcnt vmcnt(15)
buffer_load_dwordx4 v[220:223],v247,s[20:23],s46 offen offset:1024 sc1
M a[64:67],v[224:227],a[192:195],a[64:67]
ds_read_b128 a[192:195],v246 offset:36864
v_fmac_f32 v228,s45,v232
M a[68:71],v[224:227],a[196:199],a[68:71]
v_fmac_f32 v233,s41,v231
v_sub_f32 v232,v232,v230
M a[72:75],v[224:227],a[200:203],a[72:75]
v_fma_f32 v230,-4.0,v229,v231
v_sub_f32 v231,v231,v229
M a[76:79],v[224:227],a[204:207],a[76:79]
v_add_f32 v229,v234,v230
v_sub_f32 v234,v234,v230
M a[80:83],v[224:227],a[208:211],a[80:83]
v_fma_f32 v230,2.0,v231,v232
v_fmac_f32 v232,-2.0,v231
M a[84:87],v[224:227],a[212:215],a[84:87]
v_and_b32 v197,s42,v197
v_and_b32 v193,s42,v193
M a[88:91],v[224:227],a[216:219],a[88:91]
v_and_b32 v195,s42,v195
v_and_b32 v203,s42,v203
M a[92:95],v[224:227],a[220:223],a[92:95]
s_waitcnt vmcnt(15)
buffer_load_dwordx4 v[224:227],v247,s[20:23],s47 offen offset:1024 sc1
M a[0:3],a[228:231],a[196:199],a[0:3]
v_and_b32 v201,s42,v201
v_and_b32 v199,s42,v199
M a[4:7],a[228:231],a[200:203],a[4:7]
v_fmac_f32 v193,s43,v197
v_fmac_f32 v203,4.0,v195
M a[8:11],a[228:231],a[204:207],a[8:11]
v_fma_f32 v231,-4.0,v197,v201
v_fmac_f32 v193,s45,v201
M a[12:15],a[228:231],a[208:211],a[12:15]
v_fmac_f32 v203,s41,v199
v_sub_f32 v201,v201,v197
M a[16:19],a[228:231],a[212:215],a[16:19]
v_fma_f32 v197,-4.0,v195,v199
v_sub_f32 v199,v199,v195
M a[20:23],a[228:231],a[216:219],a[20:23]
v_add_f32 v195,v231,v197
v_sub_f32 v231,v231,v197
M a[24:27],a[228:231],a[220:223],a[24:27]
s_waitcnt lgkmcnt(0)
v_fma_f32 v197,2.0,v199,v201
v_fmac_f32 v201,-2.0,v199
M a[28:31],a[228:231],a[192:195],a[28:31]
s_waitcnt vmcnt(15)
buffer_load_dwordx4 a[228:231],v247,s[20:23],s48 offen offset:1024 sc1
M a[32:35],a[232:235],a[196:199],a[32:35]
v_cvt_pk_bf16_f32 v193,v228,v193
v_cvt_pk_bf16_f32 v203,v233,v203
M a[36:39],a[232:235],a[200:203],a[36:39]
v_cvt_pk_bf16_f32 v195,v229,v195
v_cvt_pk_bf16_f32 v199,v230,v197
M a[40:43],a[232:235],a[204:207],a[40:43]
v_cvt_pk_bf16_f32 v197,v234,v231
v_cvt_pk_bf16_f32 v201,v232,v201
M a[44:47],a[232:235],a[208:211],a[44:47]
v_add_u32 v228,139264,v243
M a[48:51],a[232:235],a[212:215],a[48:51]
ds_write2st64_b64 v228,v[192:193],v[202:203] offset0:0 offset1:17
M a[52:55],a[232:235],a[216:219],a[52:55]
s_add_u32 s28,s68,786432
buffer_load_dwordx2 v[192:193],v241,s[12:15],s28 offen offset:0
M a[56:59],a[232:235],a[220:223],a[56:59]
ds_write2st64_b64 v243,v[194:195],v[196:197] offset0:34 offset1:51
M a[60:63],a[232:235],a[192:195],a[60:63]
s_waitcnt vmcnt(16)
buffer_load_dwordx2 v[202:203],v241,s[16:19],s28 offen offset:1536
M a[64:67],a[236:239],a[196:199],a[64:67]
ds_read_b128 a[196:199],v245 offset:36864
ds_write2st64_b64 v243,v[198:199],v[200:201] offset0:68 offset1:85
M a[68:71],a[236:239],a[200:203],a[68:71]
s_waitcnt vmcnt(12)
v_lshlrev_b32 v230,16,v208
v_lshlrev_b32 v228,16,v204
M a[72:75],a[236:239],a[204:207],a[72:75]
buffer_load_dwordx2 v[194:195],v241,s[8:11],s28 offen offset:0
M a[76:79],a[236:239],a[208:211],a[76:79]
v_lshlrev_b32 v229,16,v206
v_lshlrev_b32 v233,16,v214
M a[80:83],a[236:239],a[212:215],a[80:83]
s_waitcnt vmcnt(11)
v_lshlrev_b32 v232,16,v212
v_lshlrev_b32 v231,16,v210
M a[84:87],a[236:239],a[216:219],a[84:87]
v_fmac_f32 v228,s43,v230
v_fmac_f32 v233,4.0,v229
M a[88:91],a[236:239],a[220:223],a[88:91]
buffer_load_dwordx2 v[196:197],v241,s[8:11],s28 offen offset:384
M a[92:95],a[236:239],a[192:195],a[92:95]
v_fma_f32 v234,-4.0,v230,v232
v_fmac_f32 v228,s45,v232
M a[0:3],a[240:243],a[200:203],a[0:3]
v_fmac_f32 v233,s41,v231
v_sub_f32 v232,v232,v230
M a[4:7],a[240:243],a[204:207],a[4:7]
v_fma_f32 v230,-4.0,v229,v231
v_sub_f32 v231,v231,v229
M a[8:11],a[240:243],a[208:211],a[8:11]
buffer_load_dwordx2 v[198:199],v241,s[8:11],s28 offen offset:768
M a[12:15],a[240:243],a[212:215],a[12:15]
v_add_f32 v229,v234,v230
v_sub_f32 v234,v234,v230
M a[16:19],a[240:243],a[216:219],a[16:19]
v_fma_f32 v230,2.0,v231,v232
v_fmac_f32 v232,-2.0,v231
M a[20:23],a[240:243],a[220:223],a[20:23]
v_and_b32 v208,s42,v208
v_and_b32 v204,s42,v204
M a[24:27],a[240:243],a[192:195],a[24:27]
s_waitcnt lgkmcnt(1)
buffer_load_dwordx2 v[200:201],v241,s[8:11],s28 offen offset:1152
M a[28:31],a[240:243],a[196:199],a[28:31]
s_waitcnt vmcnt(13)
v_and_b32 v206,s42,v206
v_and_b32 v214,s42,v214
M a[32:35],a[244:247],a[200:203],a[32:35]
v_and_b32 v212,s42,v212
v_and_b32 v210,s42,v210
M a[36:39],a[244:247],a[204:207],a[36:39]
v_fmac_f32 v204,s43,v208
v_fmac_f32 v214,4.0,v206
M a[40:43],a[244:247],a[208:211],a[40:43]
buffer_load_dwordx4 a[232:235],v247,s[20:23],s46 offen offset:2048 sc1
M a[44:47],a[244:247],a[212:215],a[44:47]
v_fma_f32 v231,-4.0,v208,v212
v_fmac_f32 v204,s45,v212
M a[48:51],a[244:247],a[216:219],a[48:51]
v_fmac_f32 v214,s41,v210
v_sub_f32 v212,v212,v208
M a[52:55],a[244:247],a[220:223],a[52:55]
v_fma_f32 v208,-4.0,v206,v210
v_sub_f32 v210,v210,v206
M a[56:59],a[244:247],a[192:195],a[56:59]
buffer_load_dwordx4 a[236:239],v247,s[20:23],s47 offen offset:2048 sc1
M a[60:63],a[244:247],a[196:199],a[60:63]
s_waitcnt vmcnt(14)
v_add_f32 v206,v231,v208
v_sub_f32 v231,v231,v208
M a[64:67],a[248:251],a[200:203],a[64:67]
ds_read_b128 a[200:203],v245 offset:43520
v_fma_f32 v208,2.0,v210,v212
M a[68:71],a[248:251],a[204:207],a[68:71]
ds_read_b128 a[204:207],v246 offset:43520
v_fmac_f32 v212,-2.0,v210
M a[72:75],a[248:251],a[208:211],a[72:75]
buffer_load_dwordx4 a[240:243],v247,s[20:23],s48 offen offset:2048 sc1
M a[76:79],a[248:251],a[212:215],a[76:79]
s_add_u32 s46,s79,27648
ds_read_b128 a[208:211],v245 offset:44032
ds_read_b128 a[212:215],v246 offset:44032
M a[80:83],a[248:251],a[216:219],a[80:83]
ds_read_b128 a[216:219],v245 offset:44544
v_cvt_pk_bf16_f32 v204,v228,v204
M a[84:87],a[248:251],a[220:223],a[84:87]
ds_read_b128 a[220:223],v246 offset:44544
v_cvt_pk_bf16_f32 v214,v233,v214
M a[88:91],a[248:251],a[192:195],a[88:91]
buffer_load_dwordx4 a[244:247],v247,s[20:23],s46 offen offset:0 sc1
M a[92:95],a[248:251],a[196:199],a[92:95]
s_waitcnt vmcnt(15) lgkmcnt(5)
s_add_u32 s47,s79,30720
ds_read_b128 a[192:195],v245 offset:45056
ds_read_b128 a[196:199],v246 offset:45056
M a[96:99],a[252:255],a[200:203],a[96:99]
s_waitcnt lgkmcnt(6)
v_cvt_pk_bf16_f32 v206,v229,v206
v_cvt_pk_bf16_f32 v210,v230,v208
M a[100:103],a[252:255],a[204:207],a[100:103]
s_waitcnt lgkmcnt(5)
v_cvt_pk_bf16_f32 v208,v234,v231
v_cvt_pk_bf16_f32 v212,v232,v212
M a[104:107],a[252:255],a[208:211],a[104:107]
s_waitcnt lgkmcnt(4)
buffer_load_dwordx4 a[248:251],v247,s[20:23],s47 offen offset:0 sc1
M a[108:111],a[252:255],a[212:215],a[108:111]
s_waitcnt lgkmcnt(3)
s_add_u32 s48,s79,33792
v_lshlrev_b32 v230,16,v209
v_lshlrev_b32 v228,16,v205
M a[112:115],a[252:255],a[216:219],a[112:115]
s_waitcnt lgkmcnt(2)
v_lshlrev_b32 v229,16,v207
v_lshlrev_b32 v233,16,v215
M a[116:119],a[252:255],a[220:223],a[116:119]
s_waitcnt lgkmcnt(1)
v_lshlrev_b32 v232,16,v213
v_lshlrev_b32 v231,16,v211
M a[120:123],a[252:255],a[192:195],a[120:123]
s_waitcnt lgkmcnt(0)
v_fmac_f32 v228,s43,v230
v_fmac_f32 v233,4.0,v229
M a[124:127],a[252:255],a[196:199],a[124:127]
s_waitcnt vmcnt(15)
buffer_load_dwordx4 a[252:255],v247,s[20:23],s48 offen offset:0 sc1
M a[128:131],a[224:227],a[200:203],a[128:131]
v_fma_f32 v234,-4.0,v230,v232
v_fmac_f32 v228,s45,v232
M a[132:135],a[224:227],a[204:207],a[132:135]
v_fmac_f32 v233,s41,v231
v_sub_f32 v232,v232,v230
M a[136:139],a[224:227],a[208:211],a[136:139]
v_fma_f32 v230,-4.0,v229,v231
v_sub_f32 v231,v231,v229
M a[140:143],a[224:227],a[212:215],a[140:143]
v_add_f32 v229,v234,v230
v_sub_f32 v234,v234,v230
M a[144:147],a[224:227],a[216:219],a[144:147]
v_fma_f32 v230,2.0,v231,v232
v_fmac_f32 v232,-2.0,v231
M a[148:151],a[224:227],a[220:223],a[148:151]
v_and_b32 v209,s42,v209
v_and_b32 v205,s42,v205
M a[152:155],a[224:227],a[192:195],a[152:155]
v_and_b32 v207,s42,v207
v_and_b32 v215,s42,v215
M a[156:159],a[224:227],a[196:199],a[156:159]
s_waitcnt vmcnt(15)
buffer_load_dwordx4 a[224:227],v247,s[20:23],s46 offen offset:1024 sc1
M a[160:163],v[216:219],a[200:203],a[160:163]
ds_read_b128 a[200:203],v246 offset:45568
v_and_b32 v213,s42,v213
M a[164:167],v[216:219],a[204:207],a[164:167]
v_and_b32 v211,s42,v211
v_fmac_f32 v205,s43,v209
M a[168:171],v[216:219],a[208:211],a[168:171]
v_fmac_f32 v215,4.0,v207
v_fma_f32 v231,-4.0,v209,v213
M a[172:175],v[216:219],a[212:215],a[172:175]
v_fmac_f32 v205,s45,v213
v_fmac_f32 v215,s41,v211
M a[176:179],v[216:219],a[216:219],a[176:179]
v_sub_f32 v213,v213,v209
v_fma_f32 v209,-4.0,v207,v211
M a[180:183],v[216:219],a[220:223],a[180:183]
v_sub_f32 v211,v211,v207
v_add_f32 v207,v231,v209
M a[184:187],v[216:219],a[192:195],a[184:187]
v_sub_f32 v231,v231,v209
v_fma_f32 v209,2.0,v211,v213
M a[188:191],v[216:219],a[196:199],a[188:191]
s_waitcnt vmcnt(15)
buffer_load_dwordx4 v[216:219],v247,s[20:23],s47 offen offset:1024 sc1
M a[96:99],v[220:223],a[204:207],a[96:99]
v_fmac_f32 v213,-2.0,v211
v_cvt_pk_bf16_f32 v205,v228,v205
M a[100:103],v[220:223],a[208:211],a[100:103]
v_cvt_pk_bf16_f32 v215,v233,v215
v_cvt_pk_bf16_f32 v207,v229,v207
M a[104:107],v[220:223],a[212:215],a[104:107]
v_cvt_pk_bf16_f32 v211,v230,v209
v_cvt_pk_bf16_f32 v209,v234,v231
M a[108:111],v[220:223],a[216:219],a[108:111]
v_cvt_pk_bf16_f32 v213,v232,v213
v_add_u32 v228,139264,v243
M a[112:115],v[220:223],a[220:223],a[112:115]
ds_write2st64_b64 v228,v[204:205],v[214:215] offset0:1 offset1:18
M a[116:119],v[220:223],a[192:195],a[116:119]
s_add_u32 s28,s68,1179648
buffer_load_dwordx2 v[204:205],v241,s[12:15],s28 offen offset:0
M a[120:123],v[220:223],a[196:199],a[120:123]
s_waitcnt lgkmcnt(1)
ds_write2st64_b64 v243,v[206:207],v[208:209] offset0:35 offset1:52
M a[124:127],v[220:223],a[200:203],a[124:127]
s_waitcnt vmcnt(16)
buffer_load_dwordx2 v[214:215],v241,s[16:19],s28 offen offset:1536
M a[128:131],v[224:227],a[204:207],a[128:131]
ds_write2st64_b64 v243,v[210:211],v[212:213] offset0:69 offset1:86
M a[132:135],v[224:227],a[208:211],a[132:135]
v_fmac_f32 v235,s43,v237
v_fmac_f32 v240,4.0,v236
M a[136:139],v[224:227],a[212:215],a[136:139]
buffer_load_dwordx2 v[206:207],v241,s[8:11],s28 offen offset:0
M a[140:143],v[224:227],a[216:219],a[140:143]
v_fma_f32 v228,-4.0,v237,v239
v_fmac_f32 v235,s45,v239
M a[144:147],v[224:227],a[220:223],a[144:147]
v_fmac_f32 v240,s41,v238
v_sub_f32 v239,v239,v237
M a[148:151],v[224:227],a[192:195],a[148:151]
v_fma_f32 v237,-4.0,v236,v238
v_sub_f32 v238,v238,v236
M a[152:155],v[224:227],a[196:199],a[152:155]
buffer_load_dwordx2 v[208:209],v241,s[8:11],s28 offen offset:384
M a[156:159],v[224:227],a[200:203],a[156:159]
s_waitcnt vmcnt(18)
v_add_f32 v236,v228,v237
v_sub_f32 v228,v228,v237
M a[160:163],a[228:231],a[204:207],a[160:163]
ds_read_b128 a[204:207],v245 offset:45568
v_fma_f32 v237,2.0,v238,v239
M a[164:167],a[228:231],a[208:211],a[164:167]
v_fmac_f32 v239,-2.0,v238
v_cvt_pk_bf16_f32 v229,v235,v240
M a[168:171],a[228:231],a[212:215],a[168:171]
buffer_load_dwordx2 v[210:211],v241,s[8:11],s28 offen offset:768
M a[172:175],a[228:231],a[216:219],a[172:175]
v_cvt_pk_bf16_f32 v230,v236,v228
v_cvt_pk_bf16_f32 v231,v237,v239
M a[176:179],a[228:231],a[220:223],a[176:179]
v_add_u32 v228,139264,v244
M a[180:183],a[228:231],a[192:195],a[180:183]
ds_write_b16 v228,v229 offset:0
M a[184:187],a[228:231],a[196:199],a[184:187]
buffer_load_dwordx2 v[212:213],v241,s[8:11],s28 offen offset:1152
M a[188:191],a[228:231],a[200:203],a[188:191]
s_waitcnt vmcnt(13)
s_add_u32 s29,s69,0
ds_write_b16_d16_hi v228,v229 offset:8704
M a[96:99],a[232:235],a[208:211],a[96:99]
ds_write_b16 v244,v230 offset:17408
M a[100:103],a[232:235],a[212:215],a[100:103]
ds_write_b16_d16_hi v244,v230 offset:26112
M a[104:107],a[232:235],a[216:219],a[104:107]
buffer_load_short_d16_hi v235,v242,s[12:15],s29 offen offset:0
M a[108:111],a[232:235],a[220:223],a[108:111]
ds_write_b16 v244,v231 offset:34816
M a[112:115],a[232:235],a[192:195],a[112:115]
buffer_load_short_d16_hi v236,v242,s[8:11],s29 offen offset:0
M a[116:119],a[232:235],a[196:199],a[116:119]
ds_write_b16_d16_hi v244,v231 offset:43520
M a[120:123],a[232:235],a[200:203],a[120:123]
s_waitcnt lgkmcnt(6)
buffer_load_short_d16_hi v237,v242,s[8:11],s29 offen offset:384
M a[124:127],a[232:235],a[204:207],a[124:127]
s_waitcnt vmcnt(15)
v_lshlrev_b32 v230,16,v196
v_lshlrev_b32 v228,16,v192
M a[128:131],a[236:239],a[208:211],a[128:131]
buffer_load_short_d16_hi v238,v242,s[8:11],s29 offen offset:768
M a[132:135],a[236:239],a[212:215],a[132:135]
v_lshlrev_b32 v229,16,v194
v_lshlrev_b32 v233,16,v202
M a[136:139],a[236:239],a[216:219],a[136:139]
buffer_load_short_d16_hi v239,v242,s[8:11],s29 offen offset:1152
M a[140:143],a[236:239],a[220:223],a[140:143]
v_lshlrev_b32 v232,16,v200
v_lshlrev_b32 v231,16,v198
M a[144:147],a[236:239],a[192:195],a[144:147]
buffer_load_short_d16_hi v240,v242,s[16:19],s29 offen offset:1536
M a[148:151],a[236:239],a[196:199],a[148:151]
v_fmac_f32 v228,s43,v230
v_fmac_f32 v233,4.0,v229
M a[152:155],a[236:239],a[200:203],a[152:155]
buffer_load_dwordx4 v[220:223],v247,s[20:23],s48 offen offset:1024 sc1
M a[156:159],a[236:239],a[204:207],a[156:159]
s_waitcnt vmcnt(18)
v_fma_f32 v234,-4.0,v230,v232
v_fmac_f32 v228,s45,v232
M a[160:163],a[240:243],a[208:211],a[160:163]
ds_read_b128 a[208:211],v245 offset:52224
v_fmac_f32 v233,s41,v231
M a[164:167],a[240:243],a[212:215],a[164:167]
ds_read_b128 a[212:215],v246 offset:52224
v_sub_f32 v232,v232,v230
M a[168:171],a[240:243],a[216:219],a[168:171]
buffer_load_dwordx4 v[224:227],v247,s[20:23],s46 offen offset:2048 sc1
M a[172:175],a[240:243],a[220:223],a[172:175]
ds_read_b128 a[216:219],v245 offset:52736
ds_read_b128 a[220:223],v246 offset:52736
M a[176:179],a[240:243],a[192:195],a[176:179]
ds_read_b128 a[192:195],v245 offset:53248
v_fma_f32 v230,-4.0,v229,v231
M a[180:183],a[240:243],a[196:199],a[180:183]
ds_read_b128 a[196:199],v246 offset:53248
v_sub_f32 v231,v231,v229
M a[184:187],a[240:243],a[200:203],a[184:187]
buffer_load_dwordx4 a[228:231],v247,s[20:23],s47 offen offset:2048 sc1
M a[188:191],a[240:243],a[204:207],a[188:191]
s_waitcnt vmcnt(19) lgkmcnt(5)
ds_read_b128 a[200:203],v245 offset:53760
ds_read_b128 a[204:207],v246 offset:53760
M v[0:3],a[244:247],a[208:211],v[0:3]
s_waitcnt lgkmcnt(6)
v_add_f32 v229,v234,v230
v_sub_f32 v234,v234,v230
M v[4:7],a[244:247],a[212:215],v[4:7]
s_waitcnt lgkmcnt(5)
v_fma_f32 v230,2.0,v231,v232
v_fmac_f32 v232,-2.0,v231
M v[8:11],a[244:247],a[216:219],v[8:11]
s_waitcnt lgkmcnt(4)
buffer_load_dwordx4 a[232:235],v247,s[20:23],s48 offen offset:2048 sc1
M v[12:15],a[244:247],a[220:223],v[12:15]
s_waitcnt lgkmcnt(3)
s_add_u32 s46,s79,36864
v_and_b32 v196,s42,v196
v_and_b32 v192,s42,v192
M v[16:19],a[244:247],a[192:195],v[16:19]
s_waitcnt lgkmcnt(2)
v_and_b32 v194,s42,v194
v_and_b32 v202,s42,v202
M v[20:23],a[244:247],a[196:199],v[20:23]
s_waitcnt lgkmcnt(1)
v_and_b32 v200,s42,v200
v_and_b32 v198,s42,v198
M v[24:27],a[244:247],a[200:203],v[24:27]
s_waitcnt lgkmcnt(0)
buffer_load_dwordx4 a[236:239],v247,s[20:23],s46 offen offset:0 sc1
M v[28:31],a[244:247],a[204:207],v[28:31]
s_waitcnt vmcnt(20)
s_add_u32 s47,s79,39936
v_fmac_f32 v192,s43,v196
v_fmac_f32 v202,4.0,v194
M v[32:35],a[248:251],a[208:211],v[32:35]
v_fma_f32 v231,-4.0,v196,v200
v_fmac_f32 v192,s45,v200
M v[36:39],a[248:251],a[212:215],v[36:39]
v_fmac_f32 v202,s41,v198
v_sub_f32 v200,v200,v196
M v[40:43],a[248:251],a[216:219],v[40:43]
buffer_load_dwordx4 a[240:243],v247,s[20:23],s47 offen offset:0 sc1
M v[44:47],a[248:251],a[220:223],v[44:47]
s_add_u32 s48,s79,43008
v_fma_f32 v196,-4.0,v194,v198
v_sub_f32 v198,v198,v194
M v[48:51],a[248:251],a[192:195],v[48:51]
v_add_f32 v194,v231,v196
v_sub_f32 v231,v231,v196
M v[52:55],a[248:251],a[196:199],v[52:55]
v_fma_f32 v196,2.0,v198,v200
v_fmac_f32 v200,-2.0,v198
M v[56:59],a[248:251],a[200:203],v[56:59]
global_load_dword v251,v252,s[82:83]
M v[60:63],a[248:251],a[204:207],v[60:63]
s_waitcnt vmcnt(21)
v_cvt_pk_bf16_f32 v192,v228,v192
v_cvt_pk_bf16_f32 v202,v233,v202
M v[64:67],a[252:255],a[208:211],v[64:67]
buffer_load_dwordx4 a[244:247],v247,s[20:23],s48 offen offset:0 sc1
M v[68:71],a[252:255],a[212:215],v[68:71]
ds_read_b128 a[208:211],v246 offset:54272
v_cvt_pk_bf16_f32 v194,v229,v194
M v[72:75],a[252:255],a[216:219],v[72:75]
v_cvt_pk_bf16_f32 v198,v230,v196
v_cvt_pk_bf16_f32 v196,v234,v231
M v[76:79],a[252:255],a[220:223],v[76:79]
v_cvt_pk_bf16_f32 v200,v232,v200
v_lshlrev_b32 v230,16,v197
M v[80:83],a[252:255],a[192:195],v[80:83]
buffer_load_dwordx4 a[248:251],v247,s[20:23],s46 offen offset:1024 sc1
M v[84:87],a[252:255],a[196:199],v[84:87]
v_lshlrev_b32 v228,16,v193
v_lshlrev_b32 v229,16,v195
M v[88:91],a[252:255],a[200:203],v[88:91]
v_lshlrev_b32 v233,16,v203
v_lshlrev_b32 v232,16,v201
M v[92:95],a[252:255],a[204:207],v[92:95]
s_waitcnt vmcnt(22)
v_lshlrev_b32 v231,16,v199
v_fmac_f32 v228,s43,v230
M v[0:3],a[224:227],a[212:215],v[0:3]
buffer_load_dwordx4 a[252:255],v247,s[20:23],s47 offen offset:1024 sc1
M v[4:7],a[224:227],a[216:219],v[4:7]
v_fmac_f32 v233,4.0,v229
v_fma_f32 v234,-4.0,v230,v232
M v[8:11],a[224:227],a[220:223],v[8:11]
v_fmac_f32 v228,s45,v232
v_fmac_f32 v233,s41,v231
M v[12:15],a[224:227],a[192:195],v[12:15]
v_sub_f32 v232,v232,v230
v_fma_f32 v230,-4.0,v229,v231
M v[16:19],a[224:227],a[196:199],v[16:19]
v_sub_f32 v231,v231,v229
v_add_f32 v229,v234,v230
M v[20:23],a[224:227],a[200:203],v[20:23]
v_sub_f32 v234,v234,v230
v_fma_f32 v230,2.0,v231,v232
M v[24:27],a[224:227],a[204:207],v[24:27]
s_waitcnt lgkmcnt(0)
v_fmac_f32 v232,-2.0,v231
v_and_b32 v197,s42,v197
M v[28:31],a[224:227],a[208:211],v[28:31]
s_waitcnt vmcnt(22)
buffer_load_dwordx4 a[224:227],v247,s[20:23],s48 offen offset:1024 sc1
M v[32:35],v[216:219],a[212:215],v[32:35]
v_and_b32 v193,s42,v193
v_and_b32 v195,s42,v195
M v[36:39],v[216:219],a[216:219],v[36:39]
v_and_b32 v203,s42,v203
v_and_b32 v201,s42,v201
M v[40:43],v[216:219],a[220:223],v[40:43]
v_and_b32 v199,s42,v199
v_fmac_f32 v193,s43,v197
M v[44:47],v[216:219],a[192:195],v[44:47]
v_fmac_f32 v203,4.0,v195
v_fma_f32 v231,-4.0,v197,v201
M v[48:51],v[216:219],a[196:199],v[48:51]
v_fmac_f32 v193,s45,v201
v_fmac_f32 v203,s41,v199
M v[52:55],v[216:219],a[200:203],v[52:55]
v_sub_f32 v201,v201,v197
v_fma_f32 v197,-4.0,v195,v199
M v[56:59],v[216:219],a[204:207],v[56:59]
v_sub_f32 v199,v199,v195
v_add_f32 v195,v231,v197
M v[60:63],v[216:219],a[208:211],v[60:63]
s_waitcnt vmcnt(10)
buffer_load_dwordx4 v[216:219],v247,s[20:23],s46 offen offset:2048 sc1
M v[64:67],v[220:223],a[212:215],v[64:67]
ds_read_b128 a[212:215],v245 offset:54272
v_sub_f32 v231,v231,v197
M v[68:71],v[220:223],a[216:219],v[68:71]
v_fma_f32 v197,2.0,v199,v201
v_fmac_f32 v201,-2.0,v199
M v[72:75],v[220:223],a[220:223],v[72:75]
v_cvt_pk_bf16_f32 v193,v228,v193
v_cvt_pk_bf16_f32 v203,v233,v203
M v[76:79],v[220:223],a[192:195],v[76:79]
v_cvt_pk_bf16_f32 v195,v229,v195
v_cvt_pk_bf16_f32 v199,v230,v197
M v[80:83],v[220:223],a[196:199],v[80:83]
v_cvt_pk_bf16_f32 v197,v234,v231
v_cvt_pk_bf16_f32 v201,v232,v201
M v[84:87],v[220:223],a[200:203],v[84:87]
v_add_u32 v228,139264,v243
M v[88:91],v[220:223],a[204:207],v[88:91]
ds_write2st64_b64 v228,v[192:193],v[202:203] offset0:2 offset1:19
M v[92:95],v[220:223],a[208:211],v[92:95]
s_waitcnt vmcnt(10)
s_add_u32 s28,s69,0
buffer_load_dwordx2 v[192:193],v250,s[12:15],s28 offen offset:0
M v[0:3],v[224:227],a[216:219],v[0:3]
ds_write2st64_b64 v243,v[194:195],v[196:197] offset0:36 offset1:53
M v[4:7],v[224:227],a[220:223],v[4:7]
buffer_load_dwordx2 v[202:203],v250,s[16:19],s28 offen offset:1536
M v[8:11],v[224:227],a[192:195],v[8:11]
ds_write2st64_b64 v243,v[198:199],v[200:201] offset0:70 offset1:87
M v[12:15],v[224:227],a[196:199],v[12:15]
v_lshlrev_b32 v230,16,v208
v_lshlrev_b32 v228,16,v204
M v[16:19],v[224:227],a[200:203],v[16:19]
buffer_load_dwordx2 v[194:195],v250,s[8:11],s28 offen offset:0
M v[20:23],v[224:227],a[204:207],v[20:23]
v_lshlrev_b32 v229,16,v206
v_lshlrev_b32 v233,16,v214
M v[24:27],v[224:227],a[208:211],v[24:27]
s_waitcnt lgkmcnt(3)
v_lshlrev_b32 v232,16,v212
v_lshlrev_b32 v231,16,v210
M v[28:31],v[224:227],a[212:215],v[28:31]
s_waitcnt vmcnt(12)
v_fmac_f32 v228,s43,v230
v_fmac_f32 v233,4.0,v229
M v[32:35],a[228:231],a[216:219],v[32:35]
buffer_load_dwordx2 v[196:197],v250,s[8:11],s28 offen offset:384
M v[36:39],a[228:231],a[220:223],v[36:39]
v_fma_f32 v234,-4.0,v230,v232
v_fmac_f32 v228,s45,v232
M v[40:43],a[228:231],a[192:195],v[40:43]
v_fmac_f32 v233,s41,v231
v_sub_f32 v232,v232,v230
M v[44:47],a[228:231],a[196:199],v[44:47]
v_fma_f32 v230,-4.0,v229,v231
v_sub_f32 v231,v231,v229
M v[48:51],a[228:231],a[200:203],v[48:51]
buffer_load_dwordx2 v[198:199],v250,s[8:11],s28 offen offset:768
M v[52:55],a[228:231],a[204:207],v[52:55]
v_add_f32 v229,v234,v230
v_sub_f32 v234,v234,v230
M v[56:59],a[228:231],a[208:211],v[56:59]
v_fma_f32 v230,2.0,v231,v232
v_fmac_f32 v232,-2.0,v231
M v[60:63],a[228:231],a[212:215],v[60:63]
s_waitcnt vmcnt(13)
v_and_b32 v208,s42,v208
v_and_b32 v204,s42,v204
M v[64:67],a[232:235],a[216:219],v[64:67]
buffer_load_dwordx2 v[200:201],v250,s[8:11],s28 offen offset:1152
M v[68:71],a[232:235],a[220:223],v[68:71]
ds_read_b128 a[216:219],v245 offset:60928
ds_read_b128 a[220:223],v246 offset:60928
M v[72:75],a[232:235],a[192:195],v[72:75]
ds_read_b128 a[192:195],v245 offset:61440
v_and_b32 v206,s42,v206
M v[76:79],a[232:235],a[196:199],v[76:79]
ds_read_b128 a[196:199],v246 offset:61440
v_and_b32 v214,s42,v214
M v[80:83],a[232:235],a[200:203],v[80:83]
buffer_load_dwordx4 v[220:223],v247,s[20:23],s47 offen offset:2048 sc1
M v[84:87],a[232:235],a[204:207],v[84:87]
ds_read_b128 a[200:203],v245 offset:61952
ds_read_b128 a[204:207],v246 offset:61952
M v[88:91],a[232:235],a[208:211],v[88:91]
ds_read_b128 a[208:211],v245 offset:62464
v_and_b32 v212,s42,v212
M v[92:95],a[232:235],a[212:215],v[92:95]
s_waitcnt vmcnt(14) lgkmcnt(6)
ds_read_b128 a[212:215],v246 offset:62464
v_and_b32 v210,s42,v210
M v[96:99],a[236:239],a[216:219],v[96:99]
s_waitcnt lgkmcnt(6)
buffer_load_dwordx4 v[224:227],v247,s[20:23],s48 offen offset:2048 sc1
M v[100:103],a[236:239],a[220:223],v[100:103]
s_waitcnt lgkmcnt(5)
s_add_u32 s46,s80,9216
v_fmac_f32 v204,s43,v208
v_fmac_f32 v214,4.0,v206
M v[104:107],a[236:239],a[192:195],v[104:107]
s_waitcnt lgkmcnt(4)
v_fma_f32 v231,-4.0,v208,v212
v_fmac_f32 v204,s45,v212
M v[108:111],a[236:239],a[196:199],v[108:111]
s_waitcnt lgkmcnt(3)
v_fmac_f32 v214,s41,v210
v_sub_f32 v212,v212,v208
M v[112:115],a[236:239],a[200:203],v[112:115]
s_waitcnt lgkmcnt(2)
buffer_load_dwordx4 a[228:231],v247,s[20:23],s46 offen offset:0 sc1
M v[116:119],a[236:239],a[204:207],v[116:119]
s_waitcnt lgkmcnt(1)
s_add_u32 s47,s80,12288
v_fma_f32 v208,-4.0,v206,v210
v_sub_f32 v210,v210,v206
M v[120:123],a[236:239],a[208:211],v[120:123]
s_waitcnt lgkmcnt(0)
v_add_f32 v206,v231,v208
v_sub_f32 v231,v231,v208
M v[124:127],a[236:239],a[212:215],v[124:127]
s_waitcnt vmcnt(15)
v_fma_f32 v208,2.0,v210,v212
v_fmac_f32 v212,-2.0,v210
M v[128:131],a[240:243],a[216:219],v[128:131]
buffer_load_dwordx4 a[232:235],v247,s[20:23],s47 offen offset:0 sc1
M v[132:135],a[240:243],a[220:223],v[132:135]
s_add_u32 s48,s80,15360
v_cvt_pk_bf16_f32 v204,v228,v204
v_cvt_pk_bf16_f32 v214,v233,v214
M v[136:139],a[240:243],a[192:195],v[136:139]
v_cvt_pk_bf16_f32 v206,v229,v206
v_cvt_pk_bf16_f32 v210,v230,v208
M v[140:143],a[240:243],a[196:199],v[140:143]
v_cvt_pk_bf16_f32 v208,v234,v231
v_cvt_pk_bf16_f32 v212,v232,v212
M v[144:147],a[240:243],a[200:203],v[144:147]
buffer_load_dwordx4 a[236:239],v247,s[20:23],s48 offen offset:0 sc1
M v[148:151],a[240:243],a[204:207],v[148:151]
v_lshlrev_b32 v230,16,v209
v_lshlrev_b32 v228,16,v205
M v[152:155],a[240:243],a[208:211],v[152:155]
v_lshlrev_b32 v229,16,v207
v_lshlrev_b32 v233,16,v215
M v[156:159],a[240:243],a[212:215],v[156:159]
s_waitcnt vmcnt(15)
v_lshlrev_b32 v232,16,v213
v_lshlrev_b32 v231,16,v211
M v[160:163],a[244:247],a[216:219],v[160:163]
buffer_load_dwordx4 a[240:243],v247,s[20:23],s46 offen offset:1024 sc1
M v[164:167],a[244:247],a[220:223],v[164:167]
ds_read_b128 a[216:219],v246 offset:62976
v_fmac_f32 v228,s43,v230
M v[168:171],a[244:247],a[192:195],v[168:171]
v_fmac_f32 v233,4.0,v229
v_fma_f32 v234,-4.0,v230,v232
M v[172:175],a[244:247],a[196:199],v[172:175]
v_fmac_f32 v228,s45,v232
v_fmac_f32 v233,s41,v231
M v[176:179],a[244:247],a[200:203],v[176:179]
v_sub_f32 v232,v232,v230
v_fma_f32 v230,-4.0,v229,v231
M v[180:183],a[244:247],a[204:207],v[180:183]
v_sub_f32 v231,v231,v229
v_add_f32 v229,v234,v230
M v[184:187],a[244:247],a[208:211],v[184:187]
v_sub_f32 v234,v234,v230
v_fma_f32 v230,2.0,v231,v232
M v[188:191],a[244:247],a[212:215],v[188:191]
s_waitcnt vmcnt(15)
buffer_load_dwordx4 a[244:247],v247,s[20:23],s47 offen offset:1024 sc1
M v[96:99],a[248:251],a[220:223],v[96:99]
v_fmac_f32 v232,-2.0,v231
v_and_b32 v209,s42,v209
M v[100:103],a[248:251],a[192:195],v[100:103]
v_and_b32 v205,s42,v205
v_and_b32 v207,s42,v207
M v[104:107],a[248:251],a[196:199],v[104:107]
v_and_b32 v215,s42,v215
v_and_b32 v213,s42,v213
M v[108:111],a[248:251],a[200:203],v[108:111]
v_and_b32 v211,s42,v211
v_fmac_f32 v205,s43,v209
M v[112:115],a[248:251],a[204:207],v[112:115]
v_fmac_f32 v215,4.0,v207
v_fma_f32 v231,-4.0,v209,v213
M v[116:119],a[248:251],a[208:211],v[116:119]
v_fmac_f32 v205,s45,v213
v_fmac_f32 v215,s41,v211
M v[120:123],a[248:251],a[212:215],v[120:123]
s_waitcnt lgkmcnt(0)
v_sub_f32 v213,v213,v209
v_fma_f32 v209,-4.0,v207,v211
M v[124:127],a[248:251],a[216:219],v[124:127]
s_waitcnt vmcnt(15)
buffer_load_dwordx4 a[248:251],v247,s[20:23],s48 offen offset:1024 sc1
M v[128:131],a[252:255],a[220:223],v[128:131]
v_sub_f32 v211,v211,v207
v_add_f32 v207,v231,v209
M v[132:135],a[252:255],a[192:195],v[132:135]
v_sub_f32 v231,v231,v209
v_fma_f32 v209,2.0,v211,v213
M v[136:139],a[252:255],a[196:199],v[136:139]
v_fmac_f32 v213,-2.0,v211
v_cvt_pk_bf16_f32 v205,v228,v205
M v[140:143],a[252:255],a[200:203],v[140:143]
v_cvt_pk_bf16_f32 v215,v233,v215
v_cvt_pk_bf16_f32 v207,v229,v207
M v[144:147],a[252:255],a[204:207],v[144:147]
v_cvt_pk_bf16_f32 v211,v230,v209
v_cvt_pk_bf16_f32 v209,v234,v231
M v[148:151],a[252:255],a[208:211],v[148:151]
v_cvt_pk_bf16_f32 v213,v232,v213
v_add_u32 v228,139264,v243
M v[152:155],a[252:255],a[212:215],v[152:155]
ds_write2st64_b64 v228,v[204:205],v[214:215] offset0:3 offset1:20
M v[156:159],a[252:255],a[216:219],v[156:159]
s_waitcnt vmcnt(15)
s_add_u32 s28,s69,393216
buffer_load_dwordx2 v[204:205],v241,s[12:15],s28 offen offset:0
M v[160:163],a[224:227],a[220:223],v[160:163]
ds_read_b128 a[220:223],v245 offset:62976
ds_write2st64_b64 v243,v[206:207],v[208:209] offset0:37 offset1:54
M v[164:167],a[224:227],a[192:195],v[164:167]
buffer_load_dwordx2 v[214:215],v241,s[16:19],s28 offen offset:1536
M v[168:171],a[224:227],a[196:199],v[168:171]
ds_write2st64_b64 v243,v[210:211],v[212:213] offset0:71 offset1:88
M v[172:175],a[224:227],a[200:203],v[172:175]
s_waitcnt vmcnt(12)
v_lshlrev_b32 v230,16,v196
v_lshlrev_b32 v228,16,v192
M v[176:179],a[224:227],a[204:207],v[176:179]
buffer_load_dwordx2 v[206:207],v241,s[8:11],s28 offen offset:0
M v[180:183],a[224:227],a[208:211],v[180:183]
v_lshlrev_b32 v229,16,v194
v_lshlrev_b32 v233,16,v202
M v[184:187],a[224:227],a[212:215],v[184:187]
s_waitcnt vmcnt(11)
v_lshlrev_b32 v232,16,v200
v_lshlrev_b32 v231,16,v198
M v[188:191],a[224:227],a[216:219],v[188:191]
v_fmac_f32 v228,s43,v230
v_fmac_f32 v233,4.0,v229
M v[96:99],v[216:219],a[192:195],v[96:99]
buffer_load_dwordx2 v[208:209],v241,s[8:11],s28 offen offset:384
M v[100:103],v[216:219],a[196:199],v[100:103]
v_fma_f32 v234,-4.0,v230,v232
v_fmac_f32 v228,s45,v232
M v[104:107],v[216:219],a[200:203],v[104:107]
v_fmac_f32 v233,s41,v231
v_sub_f32 v232,v232,v230
M v[108:111],v[216:219],a[204:207],v[108:111]
v_fma_f32 v230,-4.0,v229,v231
v_sub_f32 v231,v231,v229
M v[112:115],v[216:219],a[208:211],v[112:115]
buffer_load_dwordx2 v[210:211],v241,s[8:11],s28 offen offset:768
M v[116:119],v[216:219],a[212:215],v[116:119]
v_add_f32 v229,v234,v230
v_sub_f32 v234,v234,v230
M v[120:123],v[216:219],a[216:219],v[120:123]
s_waitcnt lgkmcnt(2)
v_fma_f32 v230,2.0,v231,v232
v_fmac_f32 v232,-2.0,v231
M v[124:127],v[216:219],a[220:223],v[124:127]
s_waitcnt vmcnt(12)
v_and_b32 v196,s42,v196
v_and_b32 v192,s42,v192
M v[128:131],v[220:223],a[192:195],v[128:131]
buffer_load_dwordx2 v[212:213],v241,s[8:11],s28 offen offset:1152
M v[132:135],v[220:223],a[196:199],v[132:135]
v_and_b32 v194,s42,v194
v_and_b32 v202,s42,v202
M v[136:139],v[220:223],a[200:203],v[136:139]
v_and_b32 v200,s42,v200
v_and_b32 v198,s42,v198
M v[140:143],v[220:223],a[204:207],v[140:143]
v_fmac_f32 v192,s43,v196
v_fmac_f32 v202,4.0,v194
M v[144:147],v[220:223],a[208:211],v[144:147]
buffer_load_dwordx4 a[252:255],v247,s[20:23],s46 offen offset:2048 sc1
M v[148:151],v[220:223],a[212:215],v[148:151]
v_fma_f32 v231,-4.0,v196,v200
v_fmac_f32 v192,s45,v200
M v[152:155],v[220:223],a[216:219],v[152:155]
s_waitcnt lgkmcnt(0)
s_barrier
v_fmac_f32 v202,s41,v198
M v[156:159],v[220:223],a[220:223],v[156:159]
s_waitcnt vmcnt(13)
v_sub_f32 v200,v200,v196
v_fma_f32 v196,-4.0,v194,v198
M v[160:163],v[224:227],a[192:195],v[160:163]
buffer_load_dwordx4 a[224:227],v247,s[20:23],s47 offen offset:2048 sc1
M v[164:167],v[224:227],a[196:199],v[164:167]
ds_read_b128 a[192:195],v245 offset:0
ds_read_b128 a[196:199],v246 offset:0
M v[168:171],v[224:227],a[200:203],v[168:171]
ds_read_b128 a[200:203],v245 offset:512
v_sub_f32 v198,v198,v194
M v[172:175],v[224:227],a[204:207],v[172:175]
ds_read_b128 a[204:207],v246 offset:512
v_add_f32 v194,v231,v196
M v[176:179],v[224:227],a[208:211],v[176:179]
buffer_load_dwordx4 v[216:219],v247,s[20:23],s48 offen offset:2048 sc1
M v[180:183],v[224:227],a[212:215],v[180:183]
s_add_u32 s46,s80,18432
ds_read_b128 a[208:211],v245 offset:1024
ds_read_b128 a[212:215],v246 offset:1024
M v[184:187],v[224:227],a[216:219],v[184:187]
ds_read_b128 a[216:219],v245 offset:1536
v_sub_f32 v231,v231,v196
M v[188:191],v[224:227],a[220:223],v[188:191]
s_waitcnt vmcnt(14) lgkmcnt(6)
ds_read_b128 a[220:223],v246 offset:1536
v_fma_f32 v196,2.0,v198,v200
M a[0:3],a[228:231],a[192:195],a[0:3]
s_waitcnt lgkmcnt(6)
buffer_load_dwordx4 v[220:223],v247,s[20:23],s46 offen offset:0 sc1
M a[4:7],a[228:231],a[196:199],a[4:7]
s_waitcnt lgkmcnt(5)
s_add_u32 s47,s80,21504
v_fmac_f32 v200,-2.0,v198
v_cvt_pk_bf16_f32 v192,v228,v192
M a[8:11],a[228:231],a[200:203],a[8:11]
s_waitcnt lgkmcnt(4)
v_cvt_pk_bf16_f32 v202,v233,v202
v_cvt_pk_bf16_f32 v194,v229,v194
M a[12:15],a[228:231],a[204:207],a[12:15]
s_waitcnt lgkmcnt(3)
v_cvt_pk_bf16_f32 v198,v230,v196
v_cvt_pk_bf16_f32 v196,v234,v231
M a[16:19],a[228:231],a[208:211],a[16:19]
s_waitcnt lgkmcnt(2)
buffer_load_dwordx4 v[224:227],v247,s[20:23],s47 offen offset:0 sc1
M a[20:23],a[228:231],a[212:215],a[20:23]
s_waitcnt lgkmcnt(1)
s_add_u32 s48,s80,24576
v_cvt_pk_bf16_f32 v254,v232,v200
v_lshlrev_b32 v230,16,v197
M a[24:27],a[228:231],a[216:219],a[24:27]
s_waitcnt lgkmcnt(0)
v_lshlrev_b32 v228,16,v193
v_lshlrev_b32 v229,16,v195
M a[28:31],a[228:231],a[220:223],a[28:31]
s_waitcnt vmcnt(15)
v_lshlrev_b32 v233,16,v203
v_lshlrev_b32 v232,16,v201
M a[32:35],a[232:235],a[192:195],a[32:35]
buffer_load_dwordx4 a[228:231],v247,s[20:23],s48 offen offset:0 sc1
M a[36:39],a[232:235],a[196:199],a[36:39]
v_lshlrev_b32 v231,16,v199
v_fmac_f32 v228,s43,v230
M a[40:43],a[232:235],a[200:203],a[40:43]
v_fmac_f32 v233,4.0,v229
v_fma_f32 v234,-4.0,v230,v232
M a[44:47],a[232:235],a[204:207],a[44:47]
v_fmac_f32 v228,s45,v232
v_fmac_f32 v233,s41,v231
M a[48:51],a[232:235],a[208:211],a[48:51]
v_sub_f32 v232,v232,v230
v_fma_f32 v230,-4.0,v229,v231
M a[52:55],a[232:235],a[212:215],a[52:55]
v_sub_f32 v231,v231,v229
v_add_f32 v229,v234,v230
M a[56:59],a[232:235],a[216:219],a[56:59]
v_sub_f32 v234,v234,v230
v_fma_f32 v230,2.0,v231,v232
M a[60:63],a[232:235],a[220:223],a[60:63]
s_waitcnt vmcnt(15)
buffer_load_dwordx4 a[232:235],v247,s[20:23],s46 offen offset:1024 sc1
M a[64:67],a[236:239],a[192:195],a[64:67]
ds_read_b128 a[192:195],v246 offset:2048
v_fmac_f32 v232,-2.0,v231
M a[68:71],a[236:239],a[196:199],a[68:71]
v_and_b32 v197,s42,v197
v_and_b32 v193,s42,v193
M a[72:75],a[236:239],a[200:203],a[72:75]
v_and_b32 v195,s42,v195
v_and_b32 v203,s42,v203
M a[76:79],a[236:239],a[204:207],a[76:79]
v_and_b32 v201,s42,v201
v_and_b32 v199,s42,v199
M a[80:83],a[236:239],a[208:211],a[80:83]
v_fmac_f32 v193,s43,v197
v_fmac_f32 v203,4.0,v195
M a[84:87],a[236:239],a[212:215],a[84:87]
v_fma_f32 v231,-4.0,v197,v201
v_fmac_f32 v193,s45,v201
M a[88:91],a[236:239],a[216:219],a[88:91]
v_fmac_f32 v203,s41,v199
v_sub_f32 v201,v201,v197
M a[92:95],a[236:239],a[220:223],a[92:95]
s_waitcnt vmcnt(15)
buffer_load_dwordx4 a[236:239],v247,s[20:23],s47 offen offset:1024 sc1
M a[0:3],a[240:243],a[196:199],a[0:3]
v_fma_f32 v197,-4.0,v195,v199
v_sub_f32 v199,v199,v195
M a[4:7],a[240:243],a[200:203],a[4:7]
v_add_f32 v195,v231,v197
v_sub_f32 v231,v231,v197
M a[8:11],a[240:243],a[204:207],a[8:11]
v_fma_f32 v197,2.0,v199,v201
v_fmac_f32 v201,-2.0,v199
M a[12:15],a[240:243],a[208:211],a[12:15]
v_cvt_pk_bf16_f32 v193,v228,v193
v_cvt_pk_bf16_f32 v203,v233,v203
M a[16:19],a[240:243],a[212:215],a[16:19]
v_cvt_pk_bf16_f32 v195,v229,v195
v_cvt_pk_bf16_f32 v199,v230,v197
M a[20:23],a[240:243],a[216:219],a[20:23]
v_cvt_pk_bf16_f32 v197,v234,v231
v_cvt_pk_bf16_f32 v255,v232,v201
M a[24:27],a[240:243],a[220:223],a[24:27]
s_waitcnt lgkmcnt(0)
ds_write2st64_b64 v243,v[192:193],v[202:203] offset0:136 offset1:153
M a[28:31],a[240:243],a[192:195],a[28:31]
s_waitcnt vmcnt(15)
s_add_u32 s28,s69,786432
buffer_load_dwordx2 v[192:193],v241,s[12:15],s28 offen offset:0
M a[32:35],a[244:247],a[196:199],a[32:35]
ds_write2st64_b64 v243,v[194:195],v[196:197] offset0:102 offset1:119
M a[36:39],a[244:247],a[200:203],a[36:39]
buffer_load_dwordx2 v[202:203],v241,s[16:19],s28 offen offset:1536
M a[40:43],a[244:247],a[204:207],a[40:43]
M a[44:47],a[244:247],a[208:211],a[44:47]
M a[48:51],a[244:247],a[212:215],a[48:51]
M a[52:55],a[244:247],a[216:219],a[52:55]
buffer_load_dwordx2 v[194:195],v241,s[8:11],s28 offen offset:0
M a[56:59],a[244:247],a[220:223],a[56:59]
M a[60:63],a[244:247],a[192:195],a[60:63]
s_waitcnt vmcnt(17)
M a[64:67],a[248:251],a[196:199],a[64:67]
ds_read_b128 a[196:199],v245 offset:2048
M a[68:71],a[248:251],a[200:203],a[68:71]
buffer_load_dwordx2 v[196:197],v241,s[8:11],s28 offen offset:384
M a[72:75],a[248:251],a[204:207],a[72:75]
M a[76:79],a[248:251],a[208:211],a[76:79]
M a[80:83],a[248:251],a[212:215],a[80:83]
M a[84:87],a[248:251],a[216:219],a[84:87]
buffer_load_dwordx4 a[240:243],v247,s[20:23],s48 offen offset:1024 sc1
M a[88:91],a[248:251],a[220:223],a[88:91]
M a[92:95],a[248:251],a[192:195],a[92:95]
s_waitcnt vmcnt(12)
M a[0:3],a[252:255],a[200:203],a[0:3]
M a[4:7],a[252:255],a[204:207],a[4:7]
buffer_load_dwordx4 a[244:247],v247,s[20:23],s46 offen offset:2048 sc1
M a[8:11],a[252:255],a[208:211],a[8:11]
M a[12:15],a[252:255],a[212:215],a[12:15]
M a[16:19],a[252:255],a[216:219],a[16:19]
M a[20:23],a[252:255],a[220:223],a[20:23]
buffer_load_dwordx4 a[248:251],v247,s[20:23],s47 offen offset:2048 sc1
M a[24:27],a[252:255],a[192:195],a[24:27]
s_waitcnt lgkmcnt(0)
M a[28:31],a[252:255],a[196:199],a[28:31]
s_waitcnt vmcnt(13)
M a[32:35],a[224:227],a[200:203],a[32:35]
M a[36:39],a[224:227],a[204:207],a[36:39]
s_barrier
buffer_load_dwordx4 a[252:255],v247,s[20:23],s48 offen offset:2048 sc1
M a[40:43],a[224:227],a[208:211],a[40:43]
s_add_u32 s46,s80,27648
ds_write_b64 v243,v[198:199] offset:17408
M a[44:47],a[224:227],a[212:215],a[44:47]
v_lshlrev_b32 v230,16,v208
v_lshlrev_b32 v228,16,v204
M a[48:51],a[224:227],a[216:219],a[48:51]
buffer_load_dwordx2 v[198:199],v241,s[8:11],s28 offen offset:768
M a[52:55],a[224:227],a[220:223],a[52:55]
v_lshlrev_b32 v229,16,v206
v_lshlrev_b32 v233,16,v214
M a[56:59],a[224:227],a[192:195],a[56:59]
v_lshlrev_b32 v232,16,v212
v_lshlrev_b32 v231,16,v210
M a[60:63],a[224:227],a[196:199],a[60:63]
s_waitcnt vmcnt(14)
v_fmac_f32 v228,s43,v230
v_fmac_f32 v233,4.0,v229
M a[64:67],v[216:219],a[200:203],a[64:67]
buffer_load_dwordx2 v[200:201],v241,s[8:11],s28 offen offset:1152
M a[68:71],v[216:219],a[204:207],a[68:71]
ds_read_b128 a[200:203],v245 offset:8704
ds_read_b128 a[204:207],v246 offset:8704
M a[72:75],v[216:219],a[208:211],a[72:75]
ds_read_b128 a[208:211],v245 offset:9216
v_fma_f32 v234,-4.0,v230,v232
M a[76:79],v[216:219],a[212:215],a[76:79]
ds_read_b128 a[212:215],v246 offset:9216
v_fmac_f32 v228,s45,v232
M a[80:83],v[216:219],a[216:219],a[80:83]
buffer_load_dwordx4 a[224:227],v247,s[20:23],s46 offen offset:0 sc1
M a[84:87],v[216:219],a[220:223],a[84:87]
s_add_u32 s47,s80,30720
ds_read_b128 a[216:219],v245 offset:9728
ds_read_b128 a[220:223],v246 offset:9728
M a[88:91],v[216:219],a[192:195],a[88:91]
ds_read_b128 a[192:195],v245 offset:10240
v_fmac_f32 v233,s41,v231
M a[92:95],v[216:219],a[196:199],a[92:95]
s_waitcnt vmcnt(15) lgkmcnt(6)
ds_read_b128 a[196:199],v246 offset:10240
v_sub_f32 v232,v232,v230
M a[96:99],v[220:223],a[200:203],a[96:99]
s_waitcnt lgkmcnt(6)
buffer_load_dwordx4 v[216:219],v247,s[20:23],s47 offen offset:0 sc1
M a[100:103],v[220:223],a[204:207],a[100:103]
s_waitcnt lgkmcnt(5)
s_add_u32 s48,s80,33792
v_fma_f32 v230,-4.0,v229,v231
v_sub_f32 v231,v231,v229
M a[104:107],v[220:223],a[208:211],a[104:107]
s_waitcnt lgkmcnt(4)
v_add_f32 v229,v234,v230
v_sub_f32 v234,v234,v230
M a[108:111],v[220:223],a[212:215],a[108:111]
s_waitcnt lgkmcnt(3)
v_fma_f32 v230,2.0,v231,v232
v_fmac_f32 v232,-2.0,v231
M a[112:115],v[220:223],a[216:219],a[112:115]
s_waitcnt lgkmcnt(2)
v_and_b32 v208,s42,v208
v_and_b32 v204,s42,v204
M a[116:119],v[220:223],a[220:223],a[116:119]
s_waitcnt lgkmcnt(1)
v_and_b32 v206,s42,v206
v_and_b32 v214,s42,v214
M a[120:123],v[220:223],a[192:195],a[120:123]
s_waitcnt lgkmcnt(0)
v_and_b32 v212,s42,v212
v_and_b32 v210,s42,v210
M a[124:127],v[220:223],a[196:199],a[124:127]
s_waitcnt vmcnt(15)
buffer_load_dwordx4 v[220:223],v247,s[20:23],s48 offen offset:0 sc1
M a[128:131],v[224:227],a[200:203],a[128:131]
v_fmac_f32 v204,s43,v208
v_fmac_f32 v214,4.0,v206
M a[132:135],v[224:227],a[204:207],a[132:135]
v_fma_f32 v231,-4.0,v208,v212
v_fmac_f32 v204,s45,v212
M a[136:139],v[224:227],a[208:211],a[136:139]
v_fmac_f32 v214,s41,v210
v_sub_f32 v212,v212,v208
M a[140:143],v[224:227],a[212:215],a[140:143]
v_fma_f32 v208,-4.0,v206,v210
v_sub_f32 v210,v210,v206
M a[144:147],v[224:227],a[216:219],a[144:147]
v_add_f32 v206,v231,v208
v_sub_f32 v231,v231,v208
M a[148:151],v[224:227],a[220:223],a[148:151]
v_fma_f32 v208,2.0,v210,v212
v_fmac_f32 v212,-2.0,v210
M a[152:155],v[224:227],a[192:195],a[152:155]
v_cvt_pk_bf16_f32 v204,v228,v204
v_cvt_pk_bf16_f32 v214,v233,v214
M a[156:159],v[224:227],a[196:199],a[156:159]
s_waitcnt vmcnt(15)
buffer_load_dwordx4 v[224:227],v247,s[20:23],s46 offen offset:1024 sc1
M a[160:163],a[228:231],a[200:203],a[160:163]
ds_read_b128 a[200:203],v246 offset:10752
v_cvt_pk_bf16_f32 v206,v229,v206
M a[164:167],a[228:231],a[204:207],a[164:167]
v_cvt_pk_bf16_f32 v210,v230,v208
v_cvt_pk_bf16_f32 v208,v234,v231
M a[168:171],a[228:231],a[208:211],a[168:171]
v_cvt_pk_bf16_f32 v212,v232,v212
v_lshlrev_b32 v230,16,v209
M a[172:175],a[228:231],a[212:215],a[172:175]
v_lshlrev_b32 v228,16,v205
v_lshlrev_b32 v229,16,v207
M a[176:179],a[228:231],a[216:219],a[176:179]
v_lshlrev_b32 v233,16,v215
v_lshlrev_b32 v232,16,v213
M a[180:183],a[228:231],a[220:223],a[180:183]
v_lshlrev_b32 v231,16,v211
v_fmac_f32 v228,s43,v230
M a[184:187],a[228:231],a[192:195],a[184:187]
v_fmac_f32 v233,4.0,v229
v_fma_f32 v234,-4.0,v230,v232
M a[188:191],a[228:231],a[196:199],a[188:191]
s_waitcnt vmcnt(15)
buffer_load_dwordx4 a[228:231],v247,s[20:23],s47 offen offset:1024 sc1
M a[96:99],a[232:235],a[204:207],a[96:99]
v_fmac_f32 v228,s45,v232
v_fmac_f32 v233,s41,v231
M a[100:103],a[232:235],a[208:211],a[100:103]
v_sub_f32 v232,v232,v230
v_fma_f32 v230,-4.0,v229,v231
M a[104:107],a[232:235],a[212:215],a[104:107]
v_sub_f32 v231,v231,v229
v_add_f32 v229,v234,v230
M a[108:111],a[232:235],a[216:219],a[108:111]
v_sub_f32 v234,v234,v230
v_fma_f32 v230,2.0,v231,v232
M a[112:115],a[232:235],a[220:223],a[112:115]
v_fmac_f32 v232,-2.0,v231
v_and_b32 v209,s42,v209
M a[116:119],a[232:235],a[192:195],a[116:119]
v_and_b32 v205,s42,v205
v_and_b32 v207,s42,v207
M a[120:123],a[232:235],a[196:199],a[120:123]
s_waitcnt lgkmcnt(0)
v_and_b32 v215,s42,v215
v_and_b32 v213,s42,v213
M a[124:127],a[232:235],a[200:203],a[124:127]
s_waitcnt vmcnt(15)
buffer_load_dwordx4 a[232:235],v247,s[20:23],s48 offen offset:1024 sc1
M a[128:131],a[236:239],a[204:207],a[128:131]
v_and_b32 v211,s42,v211
v_fmac_f32 v205,s43,v209
M a[132:135],a[236:239],a[208:211],a[132:135]
v_fmac_f32 v215,4.0,v207
v_fma_f32 v231,-4.0,v209,v213
M a[136:139],a[236:239],a[212:215],a[136:139]
v_fmac_f32 v205,s45,v213
v_fmac_f32 v215,s41,v211
M a[140:143],a[236:239],a[216:219],a[140:143]
v_sub_f32 v213,v213,v209
v_fma_f32 v209,-4.0,v207,v211
M a[144:147],a[236:239],a[220:223],a[144:147]
v_sub_f32 v211,v211,v207
v_add_f32 v207,v231,v209
M a[148:151],a[236:239],a[192:195],a[148:151]
v_sub_f32 v231,v231,v209
v_fma_f32 v209,2.0,v211,v213
M a[152:155],a[236:239],a[196:199],a[152:155]
v_fmac_f32 v213,-2.0,v211
v_cvt_pk_bf16_f32 v205,v228,v205
M a[156:159],a[236:239],a[200:203],a[156:159]
s_waitcnt vmcnt(11)
buffer_load_dwordx4 a[236:239],v247,s[20:23],s46 offen offset:2048 sc1
M a[160:163],a[240:243],a[204:207],a[160:163]
ds_read_b128 a[204:207],v245 offset:10752
v_cvt_pk_bf16_f32 v215,v233,v215
M a[164:167],a[240:243],a[208:211],a[164:167]
v_cvt_pk_bf16_f32 v207,v229,v207
v_cvt_pk_bf16_f32 v211,v230,v209
M a[168:171],a[240:243],a[212:215],a[168:171]
v_cvt_pk_bf16_f32 v209,v234,v231
v_cvt_pk_bf16_f32 v213,v232,v213
M a[172:175],a[240:243],a[216:219],a[172:175]
ds_write2st64_b64 v243,v[204:205],v[214:215] offset0:137 offset1:154
M a[176:179],a[240:243],a[220:223],a[176:179]
s_add_u32 s28,s69,1179648
buffer_load_dwordx2 v[204:205],v241,s[12:15],s28 offen offset:0
M a[180:183],a[240:243],a[192:195],a[180:183]
ds_write2st64_b64 v243,v[206:207],v[208:209] offset0:103 offset1:120
M a[184:187],a[240:243],a[196:199],a[184:187]
buffer_load_dwordx2 v[214:215],v241,s[16:19],s28 offen offset:1536
M a[188:191],a[240:243],a[200:203],a[188:191]
s_waitcnt vmcnt(13)
M a[96:99],a[244:247],a[208:211],a[96:99]
M a[100:103],a[244:247],a[212:215],a[100:103]
M a[104:107],a[244:247],a[216:219],a[104:107]
buffer_load_dwordx2 v[206:207],v241,s[8:11],s28 offen offset:0
M a[108:111],a[244:247],a[220:223],a[108:111]
M a[112:115],a[244:247],a[192:195],a[112:115]
M a[116:119],a[244:247],a[196:199],a[116:119]
M a[120:123],a[244:247],a[200:203],a[120:123]
s_waitcnt lgkmcnt(2)
buffer_load_dwordx2 v[208:209],v241,s[8:11],s28 offen offset:384
M a[124:127],a[244:247],a[204:207],a[124:127]
s_waitcnt vmcnt(14)
M a[128:131],a[248:251],a[208:211],a[128:131]
M a[132:135],a[248:251],a[212:215],a[132:135]
s_waitcnt lgkmcnt(0)
s_barrier
ds_write_b64 v243,v[254:255] offset:26112
M a[136:139],a[248:251],a[216:219],a[136:139]
buffer_load_dwordx4 a[240:243],v247,s[20:23],s47 offen offset:2048 sc1
M a[140:143],a[248:251],a[220:223],a[140:143]
ds_write2st64_b64 v243,v[210:211],v[212:213] offset0:35 offset1:52
M a[144:147],a[248:251],a[192:195],a[144:147]
buffer_load_dwordx2 v[210:211],v241,s[8:11],s28 offen offset:768
M a[148:151],a[248:251],a[196:199],a[148:151]
v_fmac_f32 v235,s43,v237
v_fmac_f32 v240,4.0,v236
M a[152:155],a[248:251],a[200:203],a[152:155]
v_fma_f32 v228,-4.0,v237,v239
v_fmac_f32 v235,s45,v239
M a[156:159],a[248:251],a[204:207],a[156:159]
s_waitcnt vmcnt(15)
v_fmac_f32 v240,s41,v238
v_sub_f32 v239,v239,v237
M a[160:163],a[252:255],a[208:211],a[160:163]
buffer_load_dwordx2 v[212:213],v241,s[8:11],s28 offen offset:1152
M a[164:167],a[252:255],a[212:215],a[164:167]
ds_read_b128 a[208:211],v245 offset:17408
ds_read_b128 a[212:215],v246 offset:17408
M a[168:171],a[252:255],a[216:219],a[168:171]
ds_read_b128 a[216:219],v245 offset:17920
v_fma_f32 v237,-4.0,v236,v238
M a[172:175],a[252:255],a[220:223],a[172:175]
ds_read_b128 a[220:223],v246 offset:17920
v_sub_f32 v238,v238,v236
M a[176:179],a[252:255],a[192:195],a[176:179]
buffer_load_dwordx4 a[244:247],v247,s[20:23],s48 offen offset:2048 sc1
M a[180:183],a[252:255],a[196:199],a[180:183]
s_add_u32 s46,s80,36864
ds_read_b128 a[192:195],v245 offset:18432
ds_read_b128 a[196:199],v246 offset:18432
M a[184:187],a[252:255],a[200:203],a[184:187]
ds_read_b128 a[200:203],v245 offset:18944
v_add_f32 v236,v228,v237
M a[188:191],a[252:255],a[204:207],a[188:191]
s_waitcnt vmcnt(14) lgkmcnt(6)
ds_read_b128 a[204:207],v246 offset:18944
v_sub_f32 v228,v228,v237
M v[0:3],a[224:227],a[208:211],v[0:3]
s_waitcnt lgkmcnt(6)
buffer_load_dwordx4 a[248:251],v247,s[20:23],s46 offen offset:0 sc1
M v[4:7],a[224:227],a[212:215],v[4:7]
s_waitcnt lgkmcnt(5)
s_add_u32 s47,s80,39936
v_fma_f32 v237,2.0,v238,v239
v_fmac_f32 v239,-2.0,v238
M v[8:11],a[224:227],a[216:219],v[8:11]
s_waitcnt lgkmcnt(4)
v_cvt_pk_bf16_f32 v229,v235,v240
v_cvt_pk_bf16_f32 v230,v236,v228
M v[12:15],a[224:227],a[220:223],v[12:15]
s_waitcnt lgkmcnt(3)
v_cvt_pk_bf16_f32 v231,v237,v239
v_add_u32 v228,69632,v244
M v[16:19],a[224:227],a[192:195],v[16:19]
s_waitcnt lgkmcnt(2)
s_add_u32 s29,s64,6291456
buffer_load_short_d16_hi v235,v242,s[12:15],s29 offen offset:0
M v[20:23],a[224:227],a[196:199],v[20:23]
s_waitcnt lgkmcnt(1)
ds_write_b16 v228,v229 offset:0
M v[24:27],a[224:227],a[200:203],v[24:27]
s_waitcnt lgkmcnt(1)
buffer_load_short_d16_hi v236,v242,s[8:11],s29 offen offset:0
M v[28:31],a[224:227],a[204:207],v[28:31]
s_waitcnt vmcnt(16)
ds_write_b16_d16_hi v228,v229 offset:8704
M v[32:35],v[216:219],a[208:211],v[32:35]
buffer_load_short_d16_hi v237,v242,s[8:11],s29 offen offset:384
M v[36:39],v[216:219],a[212:215],v[36:39]
ds_write_b16 v244,v230 offset:52224
M v[40:43],v[216:219],a[216:219],v[40:43]
buffer_load_short_d16_hi v238,v242,s[8:11],s29 offen offset:768
M v[44:47],v[216:219],a[220:223],v[44:47]
ds_write_b16_d16_hi v244,v230 offset:60928
M v[48:51],v[216:219],a[192:195],v[48:51]
buffer_load_short_d16_hi v239,v242,s[8:11],s29 offen offset:1152
M v[52:55],v[216:219],a[196:199],v[52:55]
ds_write_b16 v244,v231 offset:17408
M v[56:59],v[216:219],a[200:203],v[56:59]
buffer_load_short_d16_hi v240,v242,s[16:19],s29 offen offset:1536
M v[60:63],v[216:219],a[204:207],v[60:63]
s_waitcnt vmcnt(19)
ds_write_b16_d16_hi v244,v231 offset:26112
M v[64:67],v[220:223],a[208:211],v[64:67]
buffer_load_dwordx4 a[252:255],v247,s[20:23],s47 offen offset:0 sc1
M v[68:71],v[220:223],a[212:215],v[68:71]
s_add_u32 s48,s80,43008
ds_read_b128 a[208:211],v246 offset:19456
v_lshlrev_b32 v230,16,v196
M v[72:75],v[220:223],a[216:219],v[72:75]
v_lshlrev_b32 v228,16,v192
v_lshlrev_b32 v229,16,v194
M v[76:79],v[220:223],a[220:223],v[76:79]
v_lshlrev_b32 v233,16,v202
v_lshlrev_b32 v232,16,v200
M v[80:83],v[220:223],a[192:195],v[80:83]
global_load_dword v251,v252,s[82:83]
M v[84:87],v[220:223],a[196:199],v[84:87]
v_lshlrev_b32 v231,16,v198
v_fmac_f32 v228,s43,v230
M v[88:91],v[220:223],a[200:203],v[88:91]
buffer_load_dwordx4 a[224:227],v247,s[20:23],s48 offen offset:0 sc1
M v[92:95],v[220:223],a[204:207],v[92:95]
s_waitcnt vmcnt(21)
v_fmac_f32 v233,4.0,v229
v_fma_f32 v234,-4.0,v230,v232
M v[0:3],v[224:227],a[212:215],v[0:3]
v_fmac_f32 v228,s45,v232
v_fmac_f32 v233,s41,v231
M v[4:7],v[224:227],a[216:219],v[4:7]
v_sub_f32 v232,v232,v230
v_fma_f32 v230,-4.0,v229,v231
M v[8:11],v[224:227],a[220:223],v[8:11]
buffer_load_dwordx4 v[216:219],v247,s[20:23],s46 offen offset:1024 sc1
M v[12:15],v[224:227],a[192:195],v[12:15]
v_sub_f32 v231,v231,v229
v_add_f32 v229,v234,v230
M v[16:19],v[224:227],a[196:199],v[16:19]
v_sub_f32 v234,v234,v230
v_fma_f32 v230,2.0,v231,v232
M v[20:23],v[224:227],a[200:203],v[20:23]
v_fmac_f32 v232,-2.0,v231
v_and_b32 v196,s42,v196
M v[24:27],v[224:227],a[204:207],v[24:27]
s_waitcnt lgkmcnt(0)
buffer_load_dwordx4 v[220:223],v247,s[20:23],s47 offen offset:1024 sc1
M v[28:31],v[224:227],a[208:211],v[28:31]
s_waitcnt vmcnt(22)
v_and_b32 v192,s42,v192
v_and_b32 v194,s42,v194
M v[32:35],a[228:231],a[212:215],v[32:35]
v_and_b32 v202,s42,v202
v_and_b32 v200,s42,v200
M v[36:39],a[228:231],a[216:219],v[36:39]
v_and_b32 v198,s42,v198
v_fmac_f32 v192,s43,v196
M v[40:43],a[228:231],a[220:223],v[40:43]
buffer_load_dwordx4 v[224:227],v247,s[20:23],s48 offen offset:1024 sc1
M v[44:47],a[228:231],a[192:195],v[44:47]
v_fmac_f32 v202,4.0,v194
v_fma_f32 v231,-4.0,v196,v200
M v[48:51],a[228:231],a[196:199],v[48:51]
v_fmac_f32 v192,s45,v200
v_fmac_f32 v202,s41,v198
M v[52:55],a[228:231],a[200:203],v[52:55]
v_sub_f32 v200,v200,v196
v_fma_f32 v196,-4.0,v194,v198
M v[56:59],a[228:231],a[204:207],v[56:59]
v_sub_f32 v198,v198,v194
v_add_f32 v194,v231,v196
M v[60:63],a[228:231],a[208:211],v[60:63]
s_waitcnt vmcnt(22)
buffer_load_dwordx4 a[228:231],v247,s[20:23],s46 offen offset:2048 sc1
M v[64:67],a[232:235],a[212:215],v[64:67]
ds_read_b128 a[212:215],v245 offset:19456
v_sub_f32 v231,v231,v196
M v[68:71],a[232:235],a[216:219],v[68:71]
v_fma_f32 v196,2.0,v198,v200
v_fmac_f32 v200,-2.0,v198
M v[72:75],a[232:235],a[220:223],v[72:75]
v_cvt_pk_bf16_f32 v192,v228,v192
v_cvt_pk_bf16_f32 v202,v233,v202
M v[76:79],a[232:235],a[192:195],v[76:79]
v_cvt_pk_bf16_f32 v194,v229,v194
v_cvt_pk_bf16_f32 v198,v230,v196
M v[80:83],a[232:235],a[196:199],v[80:83]
v_cvt_pk_bf16_f32 v196,v234,v231
v_cvt_pk_bf16_f32 v200,v232,v200
M v[84:87],a[232:235],a[200:203],v[84:87]
v_lshlrev_b32 v230,16,v197
v_lshlrev_b32 v228,16,v193
M v[88:91],a[232:235],a[204:207],v[88:91]
v_lshlrev_b32 v229,16,v195
v_lshlrev_b32 v233,16,v203
M v[92:95],a[232:235],a[208:211],v[92:95]
s_waitcnt vmcnt(22)
buffer_load_dwordx4 a[232:235],v247,s[20:23],s47 offen offset:2048 sc1
M v[0:3],a[236:239],a[216:219],v[0:3]
v_lshlrev_b32 v232,16,v201
v_lshlrev_b32 v231,16,v199
M v[4:7],a[236:239],a[220:223],v[4:7]
v_fmac_f32 v228,s43,v230
v_fmac_f32 v233,4.0,v229
M v[8:11],a[236:239],a[192:195],v[8:11]
v_fma_f32 v234,-4.0,v230,v232
v_fmac_f32 v228,s45,v232
M v[12:15],a[236:239],a[196:199],v[12:15]
v_fmac_f32 v233,s41,v231
v_sub_f32 v232,v232,v230
M v[16:19],a[236:239],a[200:203],v[16:19]
v_fma_f32 v230,-4.0,v229,v231
v_sub_f32 v231,v231,v229
M v[20:23],a[236:239],a[204:207],v[20:23]
v_add_f32 v229,v234,v230
v_sub_f32 v234,v234,v230
M v[24:27],a[236:239],a[208:211],v[24:27]
s_waitcnt lgkmcnt(0)
v_fma_f32 v230,2.0,v231,v232
v_fmac_f32 v232,-2.0,v231
M v[28:31],a[236:239],a[212:215],v[28:31]
s_waitcnt vmcnt(18)
buffer_load_dwordx4 a[236:239],v247,s[20:23],s48 offen offset:2048 sc1
M v[32:35],a[240:243],a[216:219],v[32:35]
v_and_b32 v197,s42,v197
v_and_b32 v193,s42,v193
M v[36:39],a[240:243],a[220:223],v[36:39]
s_add_u32 s46,s81,9216
v_and_b32 v195,s42,v195
v_and_b32 v203,s42,v203
M v[40:43],a[240:243],a[192:195],v[40:43]
v_and_b32 v201,s42,v201
v_and_b32 v199,s42,v199
M v[44:47],a[240:243],a[196:199],v[44:47]
v_fmac_f32 v193,s43,v197
v_fmac_f32 v203,4.0,v195
M v[48:51],a[240:243],a[200:203],v[48:51]
v_fma_f32 v231,-4.0,v197,v201
v_fmac_f32 v193,s45,v201
M v[52:55],a[240:243],a[204:207],v[52:55]
v_fmac_f32 v203,s41,v199
v_sub_f32 v201,v201,v197
M v[56:59],a[240:243],a[208:211],v[56:59]
v_fma_f32 v197,-4.0,v195,v199
v_sub_f32 v199,v199,v195
M v[60:63],a[240:243],a[212:215],v[60:63]
s_waitcnt vmcnt(16)
buffer_load_dwordx4 a[240:243],v247,s[20:23],s46 offen offset:0 sc1
M v[64:67],a[244:247],a[216:219],v[64:67]
ds_read_b128 a[216:219],v245 offset:26112
v_add_f32 v195,v231,v197
M v[68:71],a[244:247],a[220:223],v[68:71]
ds_read_b128 a[220:223],v246 offset:26112
v_sub_f32 v231,v231,v197
M v[72:75],a[244:247],a[192:195],v[72:75]
ds_read_b128 a[192:195],v245 offset:26624
v_fma_f32 v197,2.0,v199,v201
M v[76:79],a[244:247],a[196:199],v[76:79]
ds_read_b128 a[196:199],v246 offset:26624
v_fmac_f32 v201,-2.0,v199
M v[80:83],a[244:247],a[200:203],v[80:83]
ds_read_b128 a[200:203],v245 offset:27136
v_cvt_pk_bf16_f32 v193,v228,v193
M v[84:87],a[244:247],a[204:207],v[84:87]
ds_read_b128 a[204:207],v246 offset:27136
v_cvt_pk_bf16_f32 v203,v233,v203
M v[88:91],a[244:247],a[208:211],v[88:91]
ds_read_b128 a[208:211],v245 offset:27648
v_cvt_pk_bf16_f32 v195,v229,v195
M v[92:95],a[244:247],a[212:215],v[92:95]
s_waitcnt vmcnt(16) lgkmcnt(6)
buffer_load_dwordx4 a[244:247],v247,s[20:23],s46 offen offset:1024 sc1
M v[96:99],a[248:251],a[216:219],v[96:99]
s_waitcnt lgkmcnt(5)
ds_read_b128 a[212:215],v246 offset:27648
v_cvt_pk_bf16_f32 v199,v230,v197
M v[100:103],a[248:251],a[220:223],v[100:103]
s_waitcnt lgkmcnt(5)
v_cvt_pk_bf16_f32 v197,v234,v231
v_cvt_pk_bf16_f32 v201,v232,v201
M v[104:107],a[248:251],a[192:195],v[104:107]
s_waitcnt lgkmcnt(4)
ds_write2st64_b64 v243,v[192:193],v[202:203] offset0:138 offset1:155
M v[108:111],a[248:251],a[196:199],v[108:111]
s_waitcnt lgkmcnt(4)
s_add_u32 s28,s64,6291456
buffer_load_dwordx2 v[192:193],v241,s[12:15],s28 offen offset:0
M v[112:115],a[248:251],a[200:203],v[112:115]
s_waitcnt lgkmcnt(3)
ds_write2st64_b64 v243,v[194:195],v[196:197] offset0:104 offset1:121
M v[116:119],a[248:251],a[204:207],v[116:119]
s_waitcnt lgkmcnt(3)
buffer_load_dwordx2 v[202:203],v241,s[16:19],s28 offen offset:1536
M v[120:123],a[248:251],a[208:211],v[120:123]
s_waitcnt lgkmcnt(2)
ds_write2st64_b64 v243,v[198:199],v[200:201] offset0:36 offset1:53
M v[124:127],a[248:251],a[212:215],v[124:127]
s_waitcnt vmcnt(12)
v_lshlrev_b32 v230,16,v208
v_lshlrev_b32 v228,16,v204
M v[128:131],a[252:255],a[216:219],v[128:131]
buffer_load_dwordx2 v[194:195],v241,s[8:11],s28 offen offset:0
M v[132:135],a[252:255],a[220:223],v[132:135]
v_lshlrev_b32 v229,16,v206
v_lshlrev_b32 v233,16,v214
M v[136:139],a[252:255],a[192:195],v[136:139]
v_lshlrev_b32 v232,16,v212
v_lshlrev_b32 v231,16,v210
M v[140:143],a[252:255],a[196:199],v[140:143]
v_fmac_f32 v228,s43,v230
v_fmac_f32 v233,4.0,v229
M v[144:147],a[252:255],a[200:203],v[144:147]
buffer_load_dwordx2 v[196:197],v241,s[8:11],s28 offen offset:384
M v[148:151],a[252:255],a[204:207],v[148:151]
v_fma_f32 v234,-4.0,v230,v232
v_fmac_f32 v228,s45,v232
M v[152:155],a[252:255],a[208:211],v[152:155]
v_fmac_f32 v233,s41,v231
v_sub_f32 v232,v232,v230
M v[156:159],a[252:255],a[212:215],v[156:159]
s_waitcnt vmcnt(12)
v_fma_f32 v230,-4.0,v229,v231
v_sub_f32 v231,v231,v229
M v[160:163],a[224:227],a[216:219],v[160:163]
buffer_load_dwordx2 v[198:199],v241,s[8:11],s28 offen offset:768
M v[164:167],a[224:227],a[220:223],v[164:167]
ds_read_b128 a[216:219],v246 offset:28160
v_add_f32 v229,v234,v230
M v[168:171],a[224:227],a[192:195],v[168:171]
v_sub_f32 v234,v234,v230
v_fma_f32 v230,2.0,v231,v232
M v[172:175],a[224:227],a[196:199],v[172:175]
v_fmac_f32 v232,-2.0,v231
v_and_b32 v208,s42,v208
M v[176:179],a[224:227],a[200:203],v[176:179]
buffer_load_dwordx2 v[200:201],v241,s[8:11],s28 offen offset:1152
M v[180:183],a[224:227],a[204:207],v[180:183]
v_and_b32 v204,s42,v204
v_and_b32 v206,s42,v206
M v[184:187],a[224:227],a[208:211],v[184:187]
v_and_b32 v214,s42,v214
v_and_b32 v212,s42,v212
M v[188:191],a[224:227],a[212:215],v[188:191]
s_waitcnt vmcnt(13)
v_and_b32 v210,s42,v210
v_fmac_f32 v204,s43,v208
M v[96:99],v[216:219],a[220:223],v[96:99]
buffer_load_dwordx4 a[248:251],v247,s[20:23],s46 offen offset:2048 sc1
M v[100:103],v[216:219],a[192:195],v[100:103]
s_add_u32 s46,s81,18432
v_fmac_f32 v214,4.0,v206
v_fma_f32 v231,-4.0,v208,v212
M v[104:107],v[216:219],a[196:199],v[104:107]
v_fmac_f32 v204,s45,v212
v_fmac_f32 v214,s41,v210
M v[108:111],v[216:219],a[200:203],v[108:111]
v_sub_f32 v212,v212,v208
v_fma_f32 v208,-4.0,v206,v210
M v[112:115],v[216:219],a[204:207],v[112:115]
buffer_load_dwordx4 a[252:255],v247,s[20:23],s46 offen offset:0 sc1
M v[116:119],v[216:219],a[208:211],v[116:119]
v_sub_f32 v210,v210,v206
v_add_f32 v206,v231,v208
M v[120:123],v[216:219],a[212:215],v[120:123]
s_waitcnt lgkmcnt(0)
v_sub_f32 v231,v231,v208
v_fma_f32 v208,2.0,v210,v212
M v[124:127],v[216:219],a[216:219],v[124:127]
s_waitcnt vmcnt(14)
v_fmac_f32 v212,-2.0,v210
v_cvt_pk_bf16_f32 v204,v228,v204
M v[128:131],v[220:223],a[220:223],v[128:131]
buffer_load_dwordx4 a[224:227],v247,s[20:23],s46 offen offset:1024 sc1
M v[132:135],v[220:223],a[192:195],v[132:135]
v_cvt_pk_bf16_f32 v214,v233,v214
v_cvt_pk_bf16_f32 v206,v229,v206
M v[136:139],v[220:223],a[196:199],v[136:139]
v_cvt_pk_bf16_f32 v210,v230,v208
v_cvt_pk_bf16_f32 v208,v234,v231
M v[140:143],v[220:223],a[200:203],v[140:143]
v_cvt_pk_bf16_f32 v212,v232,v212
v_lshlrev_b32 v230,16,v209
M v[144:147],v[220:223],a[204:207],v[144:147]
buffer_load_dwordx4 v[216:219],v247,s[20:23],s46 offen offset:2048 sc1
M v[148:151],v[220:223],a[208:211],v[148:151]
s_add_u32 s46,s81,27648
v_lshlrev_b32 v228,16,v205
v_lshlrev_b32 v229,16,v207
M v[152:155],v[220:223],a[212:215],v[152:155]
v_lshlrev_b32 v233,16,v215
v_lshlrev_b32 v232,16,v213
M v[156:159],v[220:223],a[216:219],v[156:159]
s_waitcnt vmcnt(15)
v_lshlrev_b32 v231,16,v211
v_fmac_f32 v228,s43,v230
M v[160:163],v[224:227],a[220:223],v[160:163]
buffer_load_dwordx4 v[220:223],v247,s[20:23],s46 offen offset:0 sc1
M v[164:167],v[224:227],a[192:195],v[164:167]
ds_read_b128 a[220:223],v245 offset:28160
v_fmac_f32 v233,4.0,v229
M v[168:171],v[224:227],a[196:199],v[168:171]
v_fma_f32 v234,-4.0,v230,v232
v_fmac_f32 v228,s45,v232
M v[172:175],v[224:227],a[200:203],v[172:175]
v_fmac_f32 v233,s41,v231
v_sub_f32 v232,v232,v230
M v[176:179],v[224:227],a[204:207],v[176:179]
v_fma_f32 v230,-4.0,v229,v231
v_sub_f32 v231,v231,v229
M v[180:183],v[224:227],a[208:211],v[180:183]
v_add_f32 v229,v234,v230
v_sub_f32 v234,v234,v230
M v[184:187],v[224:227],a[212:215],v[184:187]
v_fma_f32 v230,2.0,v231,v232
v_fmac_f32 v232,-2.0,v231
M v[188:191],v[224:227],a[216:219],v[188:191]
s_waitcnt vmcnt(15)
buffer_load_dwordx4 v[224:227],v247,s[20:23],s46 offen offset:1024 sc1
M v[96:99],a[228:231],a[192:195],v[96:99]
v_and_b32 v209,s42,v209
v_and_b32 v205,s42,v205
M v[100:103],a[228:231],a[196:199],v[100:103]
v_and_b32 v207,s42,v207
v_and_b32 v215,s42,v215
M v[104:107],a[228:231],a[200:203],v[104:107]
v_and_b32 v213,s42,v213
v_and_b32 v211,s42,v211
M v[108:111],a[228:231],a[204:207],v[108:111]
v_fmac_f32 v205,s43,v209
v_fmac_f32 v215,4.0,v207
v_fma_f32 v231,-4.0,v209,v213
M v[112:115],a[228:231],a[208:211],v[112:115]
v_fmac_f32 v205,s45,v213
v_fmac_f32 v215,s41,v211
v_sub_f32 v213,v213,v209
v_fma_f32 v209,-4.0,v207,v211
M v[116:119],a[228:231],a[212:215],v[116:119]
v_sub_f32 v211,v211,v207
v_add_f32 v207,v231,v209
v_sub_f32 v231,v231,v209
v_fma_f32 v209,2.0,v211,v213
M v[120:123],a[228:231],a[216:219],v[120:123]
s_waitcnt lgkmcnt(0)
v_fmac_f32 v213,-2.0,v211
v_cvt_pk_bf16_f32 v205,v228,v205
v_cvt_pk_bf16_f32 v215,v233,v215
v_cvt_pk_bf16_f32 v207,v229,v207
M v[124:127],a[228:231],a[220:223],v[124:127]
s_waitcnt vmcnt(15)
buffer_load_dwordx4 a[228:231],v247,s[20:23],s46 offen offset:2048 sc1
v_cvt_pk_bf16_f32 v211,v230,v209
v_cvt_pk_bf16_f32 v209,v234,v231
v_cvt_pk_bf16_f32 v213,v232,v213
M v[128:131],a[232:235],a[192:195],v[128:131]
ds_write2st64_b64 v243,v[204:205],v[214:215] offset0:139 offset1:156
M v[132:135],a[232:235],a[196:199],v[132:135]
s_add_u32 s46,s81,36864
ds_write2st64_b64 v243,v[206:207],v[208:209] offset0:105 offset1:122
M v[136:139],a[232:235],a[200:203],v[136:139]
ds_write2st64_b64 v243,v[210:211],v[212:213] offset0:37 offset1:54
M v[140:143],a[232:235],a[204:207],v[140:143]
s_waitcnt vmcnt(9)
v_lshlrev_b32 v230,16,v196
v_lshlrev_b32 v228,16,v192
M v[144:147],a[232:235],a[208:211],v[144:147]
v_lshlrev_b32 v229,16,v194
v_lshlrev_b32 v233,16,v202
M v[148:151],a[232:235],a[212:215],v[148:151]
s_waitcnt vmcnt(7)
v_lshlrev_b32 v232,16,v200
v_lshlrev_b32 v231,16,v198
M v[152:155],a[232:235],a[216:219],v[152:155]
s_waitcnt lgkmcnt(0)
s_barrier
v_fmac_f32 v228,s43,v230
M v[156:159],a[232:235],a[220:223],v[156:159]
buffer_load_dwordx4 a[232:235],v247,s[20:23],s46 offen offset:0 sc1
M v[160:163],a[236:239],a[192:195],v[160:163]
ds_read_b128 a[192:195],v245 offset:34816
v_fmac_f32 v233,4.0,v229
M v[164:167],a[236:239],a[196:199],v[164:167]
ds_read_b128 a[196:199],v246 offset:34816
v_fma_f32 v234,-4.0,v230,v232
M v[168:171],a[236:239],a[200:203],v[168:171]
ds_read_b128 a[200:203],v245 offset:35328
v_fmac_f32 v228,s45,v232
M v[172:175],a[236:239],a[204:207],v[172:175]
ds_read_b128 a[204:207],v246 offset:35328
v_fmac_f32 v233,s41,v231
M v[176:179],a[236:239],a[208:211],v[176:179]
ds_read_b128 a[208:211],v245 offset:35840
v_sub_f32 v232,v232,v230
M v[180:183],a[236:239],a[212:215],v[180:183]
ds_read_b128 a[212:215],v246 offset:35840
v_fma_f32 v230,-4.0,v229,v231
M v[184:187],a[236:239],a[216:219],v[184:187]
ds_read_b128 a[216:219],v245 offset:36352
v_sub_f32 v231,v231,v229
M v[188:191],a[236:239],a[220:223],v[188:191]
s_waitcnt lgkmcnt(6)
buffer_load_dwordx4 a[236:239],v247,s[20:23],s46 offen offset:1024 sc1
M a[0:3],a[240:243],a[192:195],a[0:3]
s_waitcnt lgkmcnt(5)
ds_read_b128 a[220:223],v246 offset:36352
ds_read_b128 a[192:195],v246 offset:36864
M a[4:7],a[240:243],a[196:199],a[4:7]
s_waitcnt lgkmcnt(6)
v_add_f32 v229,v234,v230
v_sub_f32 v234,v234,v230
M a[8:11],a[240:243],a[200:203],a[8:11]
s_waitcnt lgkmcnt(5)
v_fma_f32 v230,2.0,v231,v232
v_fmac_f32 v232,-2.0,v231
M a[12:15],a[240:243],a[204:207],a[12:15]
s_waitcnt lgkmcnt(4)
v_and_b32 v196,s42,v196
v_and_b32 v192,s42,v192
M a[16:19],a[240:243],a[208:211],a[16:19]
s_waitcnt lgkmcnt(3)
v_and_b32 v194,s42,v194
v_and_b32 v202,s42,v202
M a[20:23],a[240:243],a[212:215],a[20:23]
s_waitcnt lgkmcnt(2)
v_and_b32 v200,s42,v200
v_and_b32 v198,s42,v198
M a[24:27],a[240:243],a[216:219],a[24:27]
s_waitcnt lgkmcnt(1)
v_fmac_f32 v192,s43,v196
v_fmac_f32 v202,4.0,v194
M a[28:31],a[240:243],a[220:223],a[28:31]
buffer_load_dwordx4 a[240:243],v247,s[20:23],s46 offen offset:2048 sc1
M a[0:3],a[244:247],a[196:199],a[0:3]
ds_read_b128 a[196:199],v245 offset:36864
v_fma_f32 v231,-4.0,v196,v200
M a[4:7],a[244:247],a[200:203],a[4:7]
s_add_u32 s47,s81,12288
v_fmac_f32 v192,s45,v200
v_fmac_f32 v202,s41,v198
M a[8:11],a[244:247],a[204:207],a[8:11]
v_sub_f32 v200,v200,v196
v_fma_f32 v196,-4.0,v194,v198
M a[12:15],a[244:247],a[208:211],a[12:15]
v_sub_f32 v198,v198,v194
v_add_f32 v194,v231,v196
M a[16:19],a[244:247],a[212:215],a[16:19]
v_sub_f32 v231,v231,v196
v_fma_f32 v196,2.0,v198,v200
M a[20:23],a[244:247],a[216:219],a[20:23]
v_fmac_f32 v200,-2.0,v198
v_cvt_pk_bf16_f32 v192,v228,v192
M a[24:27],a[244:247],a[220:223],a[24:27]
s_waitcnt lgkmcnt(1)
v_cvt_pk_bf16_f32 v202,v233,v202
v_cvt_pk_bf16_f32 v194,v229,v194
M a[28:31],a[244:247],a[192:195],a[28:31]
s_waitcnt vmcnt(9)
buffer_load_dwordx4 a[244:247],v247,s[20:23],s47 offen offset:0 sc1
M a[0:3],a[248:251],a[200:203],a[0:3]
ds_read_b128 a[200:203],v245 offset:43520
v_cvt_pk_bf16_f32 v198,v230,v196
M a[4:7],a[248:251],a[204:207],a[4:7]
s_add_u32 s48,s81,15360
ds_read_b128 a[204:207],v246 offset:43520
v_cvt_pk_bf16_f32 v196,v234,v231
M a[8:11],a[248:251],a[208:211],a[8:11]
ds_read_b128 a[208:211],v245 offset:44032
v_cvt_pk_bf16_f32 v200,v232,v200
M a[12:15],a[248:251],a[212:215],a[12:15]
ds_read_b128 a[212:215],v246 offset:44032
v_lshlrev_b32 v230,16,v197
M a[16:19],a[248:251],a[216:219],a[16:19]
ds_read_b128 a[216:219],v245 offset:44544
v_bfe_u32 v251,v241,5,1
M a[20:23],a[248:251],a[220:223],a[20:23]
ds_read_b128 a[220:223],v246 offset:44544
v_and_b32 v250,0xffffffc0,v241
M a[24:27],a[248:251],a[192:195],a[24:27]
s_waitcnt lgkmcnt(6)
ds_read_b128 a[192:195],v245 offset:45056
v_mad_u32_u24 v250,v251,s56,v250
M a[28:31],a[248:251],a[196:199],a[28:31]
s_waitcnt vmcnt(9) lgkmcnt(6)
buffer_load_dwordx4 a[248:251],v247,s[20:23],s48 offen offset:0 sc1
M a[96:99],a[252:255],a[200:203],a[96:99]
s_waitcnt lgkmcnt(5)
ds_read_b128 a[196:199],v246 offset:45056
ds_read_b128 a[200:203],v246 offset:45568
M a[100:103],a[252:255],a[204:207],a[100:103]
s_waitcnt lgkmcnt(6)
v_lshlrev_b32 v228,16,v193
v_lshlrev_b32 v229,16,v195
M a[104:107],a[252:255],a[208:211],a[104:107]
s_waitcnt lgkmcnt(5)
v_lshlrev_b32 v233,16,v203
v_lshlrev_b32 v232,16,v201
M a[108:111],a[252:255],a[212:215],a[108:111]
s_waitcnt lgkmcnt(4)
v_lshlrev_b32 v231,16,v199
v_fmac_f32 v228,s43,v230
M a[112:115],a[252:255],a[216:219],a[112:115]
s_waitcnt lgkmcnt(3)
v_fmac_f32 v233,4.0,v229
v_fma_f32 v234,-4.0,v230,v232
M a[116:119],a[252:255],a[220:223],a[116:119]
s_waitcnt lgkmcnt(2)
v_fmac_f32 v228,s45,v232
v_fmac_f32 v233,s41,v231
M a[120:123],a[252:255],a[192:195],a[120:123]
s_waitcnt lgkmcnt(1)
v_sub_f32 v232,v232,v230
v_fma_f32 v230,-4.0,v229,v231
M a[124:127],a[252:255],a[196:199],a[124:127]
s_waitcnt vmcnt(9)
buffer_load_dwordx4 a[252:255],v247,s[20:23],s47 offen offset:1024 sc1
M a[96:99],a[224:227],a[204:207],a[96:99]
ds_read_b128 a[204:207],v245 offset:45568
v_sub_f32 v231,v231,v229
M a[100:103],a[224:227],a[208:211],a[100:103]
v_add_f32 v229,v234,v230
v_sub_f32 v234,v234,v230
M a[104:107],a[224:227],a[212:215],a[104:107]
v_fma_f32 v230,2.0,v231,v232
v_fmac_f32 v232,-2.0,v231
M a[108:111],a[224:227],a[216:219],a[108:111]
v_and_b32 v197,s42,v197
v_and_b32 v193,s42,v193
M a[112:115],a[224:227],a[220:223],a[112:115]
v_and_b32 v195,s42,v195
v_and_b32 v203,s42,v203
M a[116:119],a[224:227],a[192:195],a[116:119]
v_and_b32 v201,s42,v201
v_and_b32 v199,s42,v199
M a[120:123],a[224:227],a[196:199],a[120:123]
s_waitcnt lgkmcnt(1)
v_fmac_f32 v193,s43,v197
v_fmac_f32 v203,4.0,v195
M a[124:127],a[224:227],a[200:203],a[124:127]
s_waitcnt vmcnt(9)
buffer_load_dwordx4 a[224:227],v247,s[20:23],s48 offen offset:1024 sc1
M a[96:99],v[216:219],a[208:211],a[96:99]
s_add_u32 s35,s64,6684672
ds_read_b128 a[208:211],v245 offset:0
v_fma_f32 v231,-4.0,v197,v201
M a[100:103],v[216:219],a[212:215],a[100:103]
buffer_load_dword v251,v250,s[8:11],s35 offen offset:0
M a[104:107],v[216:219],a[216:219],a[104:107]
ds_read_b128 a[212:215],v246 offset:0
ds_read_b128 a[216:219],v245 offset:512
M a[108:111],v[216:219],a[220:223],a[108:111]
ds_read_b128 a[220:223],v246 offset:512
v_fmac_f32 v193,s45,v201
M a[112:115],v[216:219],a[192:195],a[112:115]
s_add_u32 s35,s64,6684672
ds_read_b128 a[192:195],v245 offset:1024
v_fmac_f32 v203,s41,v199
M a[116:119],v[216:219],a[196:199],a[116:119]
buffer_load_dword v251,v250,s[8:11],s35 offen offset:384
M a[120:123],v[216:219],a[200:203],a[120:123]
s_waitcnt lgkmcnt(5)
ds_read_b128 a[196:199],v246 offset:1024
ds_read_b128 a[200:203],v245 offset:1536
M a[124:127],v[216:219],a[204:207],a[124:127]
s_waitcnt vmcnt(11) lgkmcnt(6)
ds_read_b128 a[204:207],v246 offset:1536
v_sub_f32 v201,v201,v197
M v[0:3],v[220:223],a[208:211],v[0:3]
s_waitcnt lgkmcnt(6)
ds_read_b128 a[208:211],v246 offset:2048
v_fma_f32 v197,-4.0,v195,v199
M v[4:7],v[220:223],a[212:215],v[4:7]
s_waitcnt lgkmcnt(6)
v_sub_f32 v199,v199,v195
v_add_f32 v195,v231,v197
M v[8:11],v[220:223],a[216:219],v[8:11]
s_waitcnt lgkmcnt(5)
v_sub_f32 v231,v231,v197
v_fma_f32 v197,2.0,v199,v201
M v[12:15],v[220:223],a[220:223],v[12:15]
s_waitcnt lgkmcnt(4)
v_fmac_f32 v201,-2.0,v199
v_cvt_pk_bf16_f32 v193,v228,v193
M v[16:19],v[220:223],a[192:195],v[16:19]
s_waitcnt lgkmcnt(3)
v_cvt_pk_bf16_f32 v203,v233,v203
v_cvt_pk_bf16_f32 v195,v229,v195
M v[20:23],v[220:223],a[196:199],v[20:23]
s_waitcnt lgkmcnt(2)
v_cvt_pk_bf16_f32 v199,v230,v197
v_cvt_pk_bf16_f32 v197,v234,v231
M v[24:27],v[220:223],a[200:203],v[24:27]
s_waitcnt lgkmcnt(1)
v_cvt_pk_bf16_f32 v201,v232,v201
M v[28:31],v[220:223],a[204:207],v[28:31]
s_waitcnt vmcnt(10)
M v[0:3],v[224:227],a[212:215],v[0:3]
ds_read_b128 a[212:215],v245 offset:2048
M v[4:7],v[224:227],a[216:219],v[4:7]
M v[8:11],v[224:227],a[220:223],v[8:11]
M v[12:15],v[224:227],a[192:195],v[12:15]
M v[16:19],v[224:227],a[196:199],v[16:19]
M v[20:23],v[224:227],a[200:203],v[20:23]
M v[24:27],v[224:227],a[204:207],v[24:27]
s_waitcnt lgkmcnt(1)
M v[28:31],v[224:227],a[208:211],v[28:31]
s_waitcnt vmcnt(9)
M v[0:3],a[228:231],a[216:219],v[0:3]
ds_read_b128 a[216:219],v245 offset:8704
M v[4:7],a[228:231],a[220:223],v[4:7]
ds_read_b128 a[220:223],v246 offset:8704
M v[8:11],a[228:231],a[192:195],v[8:11]
ds_read_b128 a[192:195],v245 offset:9216
M v[12:15],a[228:231],a[196:199],v[12:15]
ds_read_b128 a[196:199],v246 offset:9216
M v[16:19],a[228:231],a[200:203],v[16:19]
buffer_load_dwordx4 v[216:219],v247,s[20:23],s47 offen offset:2048 sc1
M v[20:23],a[228:231],a[204:207],v[20:23]
ds_read_b128 a[200:203],v245 offset:9728
ds_read_b128 a[204:207],v246 offset:9728
M v[24:27],a[228:231],a[208:211],v[24:27]
s_waitcnt lgkmcnt(6)
ds_read_b128 a[208:211],v245 offset:10240
M v[28:31],a[228:231],a[212:215],v[28:31]
s_waitcnt vmcnt(9) lgkmcnt(6)
ds_read_b128 a[212:215],v246 offset:10240
M v[96:99],a[232:235],a[216:219],v[96:99]
s_waitcnt lgkmcnt(6)
ds_read_b128 a[216:219],v246 offset:10752
M v[100:103],a[232:235],a[220:223],v[100:103]
s_waitcnt lgkmcnt(6)
M v[104:107],a[232:235],a[192:195],v[104:107]
s_waitcnt lgkmcnt(5)
M v[108:111],a[232:235],a[196:199],v[108:111]
s_waitcnt lgkmcnt(4)
buffer_load_dwordx4 v[220:223],v247,s[20:23],s48 offen offset:2048 sc1
M v[112:115],a[232:235],a[200:203],v[112:115]
s_waitcnt lgkmcnt(3)
s_add_u32 s47,s81,21504
M v[116:119],a[232:235],a[204:207],v[116:119]
s_waitcnt lgkmcnt(2)
buffer_load_dwordx4 v[224:227],v247,s[20:23],s47 offen offset:0 sc1
M v[120:123],a[232:235],a[208:211],v[120:123]
s_waitcnt lgkmcnt(1)
s_add_u32 s48,s81,24576
M v[124:127],a[232:235],a[212:215],v[124:127]
s_waitcnt vmcnt(10)
M v[96:99],a[236:239],a[220:223],v[96:99]
ds_read_b128 a[220:223],v245 offset:10752
M v[100:103],a[236:239],a[192:195],v[100:103]
buffer_load_dwordx4 a[228:231],v247,s[20:23],s48 offen offset:0 sc1
M v[104:107],a[236:239],a[196:199],v[104:107]
M v[108:111],a[236:239],a[200:203],v[108:111]
M v[112:115],a[236:239],a[204:207],v[112:115]
M v[116:119],a[236:239],a[208:211],v[116:119]
buffer_load_dwordx4 a[232:235],v247,s[20:23],s47 offen offset:1024 sc1
M v[120:123],a[236:239],a[212:215],v[120:123]
s_waitcnt lgkmcnt(1)
M v[124:127],a[236:239],a[216:219],v[124:127]
s_waitcnt vmcnt(11)
M v[96:99],a[240:243],a[192:195],v[96:99]
ds_read_b128 a[192:195],v245 offset:34816
M v[100:103],a[240:243],a[196:199],v[100:103]
buffer_load_dwordx4 a[236:239],v247,s[20:23],s48 offen offset:1024 sc1
M v[104:107],a[240:243],a[200:203],v[104:107]
ds_read_b128 a[196:199],v246 offset:34816
ds_read_b128 a[200:203],v245 offset:35328
M v[108:111],a[240:243],a[204:207],v[108:111]
ds_read_b128 a[204:207],v246 offset:35328
v_accvgpr_read_b32 v234,a0
M v[112:115],a[240:243],a[208:211],v[112:115]
ds_read_b128 a[208:211],v245 offset:35840
v_accvgpr_read_b32 v228,a96
M v[116:119],a[240:243],a[212:215],v[116:119]
ds_read_b128 a[212:215],v246 offset:35840
v_add_f32 v230,v234,v228
M v[120:123],a[240:243],a[216:219],v[120:123]
s_waitcnt lgkmcnt(6)
ds_read_b128 a[216:219],v245 offset:36352
v_sub_f32 v234,v234,v228
M v[124:127],a[240:243],a[220:223],v[124:127]
s_waitcnt vmcnt(11) lgkmcnt(6)
buffer_load_dwordx4 a[240:243],v247,s[20:23],s47 offen offset:2048 sc1
M a[32:35],a[244:247],a[192:195],a[32:35]
s_waitcnt lgkmcnt(5)
ds_read_b128 a[220:223],v246 offset:36352
v_add_f32 v228,v0,v96
M a[36:39],a[244:247],a[196:199],a[36:39]
s_waitcnt lgkmcnt(5)
v_sub_f32 v96,v0,v96
v_add_f32 v0,v230,v228
M a[40:43],a[244:247],a[200:203],a[40:43]
s_waitcnt lgkmcnt(4)
v_fmac_f32 v230,4.0,v228
v_fma_f32 v228,2.0,v96,v234
M a[44:47],a[244:247],a[204:207],a[44:47]
s_waitcnt lgkmcnt(3)
v_fma_f32 v96,s40,v96,v234
v_accvgpr_read_b32 v234,a1
M a[48:51],a[244:247],a[208:211],a[48:51]
s_waitcnt lgkmcnt(2)
v_accvgpr_read_b32 v233,a97
v_add_f32 v232,v234,v233
M a[52:55],a[244:247],a[212:215],a[52:55]
s_waitcnt lgkmcnt(1)
v_sub_f32 v234,v234,v233
v_add_f32 v233,v1,v97
M a[56:59],a[244:247],a[216:219],a[56:59]
s_waitcnt lgkmcnt(0)
v_sub_f32 v97,v1,v97
v_add_f32 v1,v232,v233
M a[60:63],a[244:247],a[220:223],a[60:63]
s_waitcnt vmcnt(11)
buffer_load_dwordx4 a[244:247],v247,s[20:23],s48 offen offset:2048 sc1
M a[64:67],a[248:251],a[192:195],a[64:67]
ds_read_b128 a[192:195],v246 offset:36864
v_fmac_f32 v232,4.0,v233
M a[68:71],a[248:251],a[196:199],a[68:71]
s_add_u32 s47,s81,30720
v_fma_f32 v233,2.0,v97,v234
v_fma_f32 v97,s40,v97,v234
M a[72:75],a[248:251],a[200:203],a[72:75]
v_cvt_pk_bf16_f32 v228,v228,v233
v_cvt_pk_bf16_f32 v230,v230,v232
M a[76:79],a[248:251],a[204:207],a[76:79]
v_accvgpr_read_b32 v234,a2
v_accvgpr_read_b32 v229,a98
M a[80:83],a[248:251],a[208:211],a[80:83]
v_add_f32 v231,v234,v229
v_sub_f32 v234,v234,v229
M a[84:87],a[248:251],a[212:215],a[84:87]
v_add_f32 v229,v2,v98
v_sub_f32 v98,v2,v98
M a[88:91],a[248:251],a[216:219],a[88:91]
v_add_f32 v2,v231,v229
v_fmac_f32 v231,4.0,v229
M a[92:95],a[248:251],a[220:223],a[92:95]
s_waitcnt vmcnt(11)
buffer_load_dwordx4 a[248:251],v247,s[20:23],s47 offen offset:0 sc1
M a[32:35],a[252:255],a[196:199],a[32:35]
s_add_u32 s48,s81,33792
v_fma_f32 v229,2.0,v98,v234
v_fma_f32 v98,s40,v98,v234
M a[36:39],a[252:255],a[200:203],a[36:39]
v_accvgpr_read_b32 v234,a3
v_accvgpr_read_b32 v233,a99
M a[40:43],a[252:255],a[204:207],a[40:43]
buffer_load_dwordx4 a[96:99],v247,s[20:23],s48 offen offset:0 sc1
M a[44:47],a[252:255],a[208:211],a[44:47]
v_add_f32 v232,v234,v233
v_sub_f32 v234,v234,v233
M a[48:51],a[252:255],a[212:215],a[48:51]
v_add_f32 v233,v3,v99
v_sub_f32 v99,v3,v99
M a[52:55],a[252:255],a[216:219],a[52:55]
v_add_f32 v3,v232,v233
v_fmac_f32 v232,4.0,v233
M a[56:59],a[252:255],a[220:223],a[56:59]
s_waitcnt lgkmcnt(0)
v_fma_f32 v233,2.0,v99,v234
v_fma_f32 v99,s40,v99,v234
M a[60:63],a[252:255],a[192:195],a[60:63]
s_waitcnt vmcnt(12)
buffer_load_dwordx4 a[252:255],v247,s[20:23],s47 offen offset:1024 sc1
M a[64:67],a[224:227],a[196:199],a[64:67]
ds_read_b128 a[196:199],v245 offset:36864
v_cvt_pk_bf16_f32 v229,v229,v233
M a[68:71],a[224:227],a[200:203],a[68:71]
v_cvt_pk_bf16_f32 v231,v231,v232
M a[72:75],a[224:227],a[204:207],a[72:75]
ds_write2st64_b64 v249,v[228:229],v[230:231] offset0:68 offset1:72
M a[76:79],a[224:227],a[208:211],a[76:79]
v_accvgpr_read_b32 v234,a4
v_accvgpr_read_b32 v228,a100
M a[80:83],a[224:227],a[212:215],a[80:83]
v_add_f32 v230,v234,v228
v_sub_f32 v234,v234,v228
M a[84:87],a[224:227],a[216:219],a[84:87]
v_add_f32 v228,v4,v100
v_sub_f32 v100,v4,v100
M a[88:91],a[224:227],a[220:223],a[88:91]
v_add_f32 v4,v230,v228
v_fmac_f32 v230,4.0,v228
M a[92:95],a[224:227],a[192:195],a[92:95]
s_waitcnt vmcnt(10)
buffer_load_dwordx4 a[224:227],v247,s[20:23],s48 offen offset:1024 sc1
M a[32:35],v[216:219],a[200:203],a[32:35]
v_fma_f32 v228,2.0,v100,v234
v_fma_f32 v100,s40,v100,v234
M a[36:39],v[216:219],a[204:207],a[36:39]
v_accvgpr_read_b32 v234,a5
v_accvgpr_read_b32 v233,a101
M a[40:43],v[216:219],a[208:211],a[40:43]
s_add_u32 s35,s64,7077888
buffer_load_dword v251,v250,s[8:11],s35 offen offset:0
M a[44:47],v[216:219],a[212:215],a[44:47]
v_add_f32 v232,v234,v233
v_sub_f32 v234,v234,v233
M a[48:51],v[216:219],a[216:219],a[48:51]
v_add_f32 v233,v5,v101
v_sub_f32 v101,v5,v101
M a[52:55],v[216:219],a[220:223],a[52:55]
v_add_f32 v5,v232,v233
v_fmac_f32 v232,4.0,v233
M a[56:59],v[216:219],a[192:195],a[56:59]
s_waitcnt lgkmcnt(1)
s_add_u32 s35,s64,7077888
buffer_load_dword v251,v250,s[8:11],s35 offen offset:384
M a[60:63],v[216:219],a[196:199],a[60:63]
s_waitcnt vmcnt(12)
v_fma_f32 v233,2.0,v101,v234
v_fma_f32 v101,s40,v101,v234
M a[64:67],v[220:223],a[200:203],a[64:67]
ds_read_b128 a[200:203],v245 offset:43520
v_cvt_pk_bf16_f32 v228,v228,v233
M a[68:71],v[220:223],a[204:207],a[68:71]
ds_read_b128 a[204:207],v246 offset:43520
v_cvt_pk_bf16_f32 v230,v230,v232
M a[72:75],v[220:223],a[208:211],a[72:75]
ds_read_b128 a[208:211],v245 offset:44032
v_accvgpr_read_b32 v234,a6
M a[76:79],v[220:223],a[212:215],a[76:79]
ds_read_b128 a[212:215],v246 offset:44032
v_accvgpr_read_b32 v229,a102
M a[80:83],v[220:223],a[216:219],a[80:83]
ds_read_b128 a[216:219],v245 offset:44544
v_add_f32 v231,v234,v229
M a[84:87],v[220:223],a[220:223],a[84:87]
ds_read_b128 a[220:223],v246 offset:44544
v_sub_f32 v234,v234,v229
M a[88:91],v[220:223],a[192:195],a[88:91]
ds_read_b128 a[192:195],v245 offset:45056
v_add_f32 v229,v6,v102
M a[92:95],v[220:223],a[196:199],a[92:95]
s_waitcnt vmcnt(11) lgkmcnt(6)
ds_read_b128 a[196:199],v246 offset:45056
v_sub_f32 v102,v6,v102
M a[128:131],v[224:227],a[200:203],a[128:131]
s_waitcnt lgkmcnt(6)
v_add_f32 v6,v231,v229
v_fmac_f32 v231,4.0,v229
M a[132:135],v[224:227],a[204:207],a[132:135]
s_waitcnt lgkmcnt(5)
v_fma_f32 v229,2.0,v102,v234
v_fma_f32 v102,s40,v102,v234
M a[136:139],v[224:227],a[208:211],a[136:139]
s_waitcnt lgkmcnt(4)
v_accvgpr_read_b32 v234,a7
v_accvgpr_read_b32 v233,a103
M a[140:143],v[224:227],a[212:215],a[140:143]
s_waitcnt lgkmcnt(3)
v_add_f32 v232,v234,v233
v_sub_f32 v234,v234,v233
M a[144:147],v[224:227],a[216:219],a[144:147]
s_waitcnt lgkmcnt(2)
global_load_dword v251,v252,s[82:83]
M a[148:151],v[224:227],a[220:223],a[148:151]
s_waitcnt lgkmcnt(1)
v_add_f32 v233,v7,v103
v_sub_f32 v103,v7,v103
M a[152:155],v[224:227],a[192:195],a[152:155]
s_waitcnt lgkmcnt(0)
v_add_f32 v7,v232,v233
v_fmac_f32 v232,4.0,v233
M a[156:159],v[224:227],a[196:199],a[156:159]
s_waitcnt vmcnt(11)
v_fma_f32 v233,2.0,v103,v234
v_fma_f32 v103,s40,v103,v234
M a[160:163],a[228:231],a[200:203],a[160:163]
ds_read_b128 a[200:203],v246 offset:45568
v_cvt_pk_bf16_f32 v229,v229,v233
M a[164:167],a[228:231],a[204:207],a[164:167]
v_cvt_pk_bf16_f32 v231,v231,v232
M a[168:171],a[228:231],a[208:211],a[168:171]
ds_write2st64_b64 v249,v[228:229],v[230:231] offset0:76 offset1:80
M a[172:175],a[228:231],a[212:215],a[172:175]
v_accvgpr_read_b32 v234,a8
v_accvgpr_read_b32 v228,a104
M a[176:179],a[228:231],a[216:219],a[176:179]
v_add_f32 v230,v234,v228
v_sub_f32 v234,v234,v228
M a[180:183],a[228:231],a[220:223],a[180:183]
v_add_f32 v228,v8,v104
v_sub_f32 v104,v8,v104
M a[184:187],a[228:231],a[192:195],a[184:187]
s_waitcnt lgkmcnt(0)
s_barrier
ds_read_b128 a[0:3],v247 offset:34816
M a[188:191],a[228:231],a[196:199],a[188:191]
s_waitcnt vmcnt(10)
ds_read_b128 a[4:7],v247 offset:38912
v_add_f32 v8,v230,v228
M a[128:131],a[232:235],a[204:207],a[128:131]
v_fmac_f32 v230,4.0,v228
v_fma_f32 v228,2.0,v104,v234
M a[132:135],a[232:235],a[208:211],a[132:135]
v_fma_f32 v104,s40,v104,v234
v_accvgpr_read_b32 v234,a9
M a[136:139],a[232:235],a[212:215],a[136:139]
v_accvgpr_read_b32 v233,a105
v_add_f32 v232,v234,v233
M a[140:143],a[232:235],a[216:219],a[140:143]
v_sub_f32 v234,v234,v233
v_add_f32 v233,v9,v105
M a[144:147],a[232:235],a[220:223],a[144:147]
buffer_load_dwordx4 v[216:219],v247,s[20:23],s47 offen offset:2048 sc1
M a[148:151],a[232:235],a[192:195],a[148:151]
v_sub_f32 v105,v9,v105
v_add_f32 v9,v232,v233
M a[152:155],a[232:235],a[196:199],a[152:155]
buffer_load_dwordx4 v[220:223],v247,s[20:23],s48 offen offset:2048 sc1
M a[156:159],a[232:235],a[200:203],a[156:159]
s_waitcnt vmcnt(11)
s_add_u32 s47,s81,39936
v_fmac_f32 v232,4.0,v233
v_fma_f32 v233,2.0,v105,v234
M a[160:163],a[236:239],a[204:207],a[160:163]
ds_read_b128 a[204:207],v245 offset:45568
v_fma_f32 v105,s40,v105,v234
M a[164:167],a[236:239],a[208:211],a[164:167]
v_cvt_pk_bf16_f32 v228,v228,v233
v_cvt_pk_bf16_f32 v230,v230,v232
M a[168:171],a[236:239],a[212:215],a[168:171]
buffer_load_dwordx4 a[100:103],v247,s[20:23],s47 offen offset:0 sc1
M a[172:175],a[236:239],a[216:219],a[172:175]
s_add_u32 s48,s81,43008
v_accvgpr_read_b32 v234,a10
v_accvgpr_read_b32 v229,a106
M a[176:179],a[236:239],a[220:223],a[176:179]
v_add_f32 v231,v234,v229
v_sub_f32 v234,v234,v229
M a[180:183],a[236:239],a[192:195],a[180:183]
v_add_f32 v229,v10,v106
v_sub_f32 v106,v10,v106
M a[184:187],a[236:239],a[196:199],a[184:187]
buffer_load_dwordx4 v[224:227],v247,s[20:23],s48 offen offset:0 sc1
M a[188:191],a[236:239],a[200:203],a[188:191]
s_waitcnt vmcnt(12)
v_add_f32 v10,v231,v229
v_fmac_f32 v231,4.0,v229
M a[128:131],a[240:243],a[208:211],a[128:131]
v_fma_f32 v229,2.0,v106,v234
v_fma_f32 v106,s40,v106,v234
M a[132:135],a[240:243],a[212:215],a[132:135]
v_accvgpr_read_b32 v234,a11
v_accvgpr_read_b32 v233,a107
M a[136:139],a[240:243],a[216:219],a[136:139]
buffer_load_dwordx4 a[228:231],v247,s[20:23],s47 offen offset:1024 sc1
M a[140:143],a[240:243],a[220:223],a[140:143]
v_add_f32 v232,v234,v233
v_sub_f32 v234,v234,v233
M a[144:147],a[240:243],a[192:195],a[144:147]
v_add_f32 v233,v11,v107
v_sub_f32 v107,v11,v107
M a[148:151],a[240:243],a[196:199],a[148:151]
v_add_f32 v11,v232,v233
v_fmac_f32 v232,4.0,v233
M a[152:155],a[240:243],a[200:203],a[152:155]
s_waitcnt lgkmcnt(0)
buffer_load_dwordx4 a[232:235],v247,s[20:23],s48 offen offset:1024 sc1
M a[156:159],a[240:243],a[204:207],a[156:159]
s_waitcnt vmcnt(13)
v_fma_f32 v233,2.0,v107,v234
v_fma_f32 v107,s40,v107,v234
M a[160:163],a[244:247],a[208:211],a[160:163]
ds_read_b128 a[208:211],v245 offset:0
v_cvt_pk_bf16_f32 v229,v229,v233
M a[164:167],a[244:247],a[212:215],a[164:167]
ds_read_b128 a[212:215],v246 offset:0
v_cvt_pk_bf16_f32 v231,v231,v232
M a[168:171],a[244:247],a[216:219],a[168:171]
buffer_load_dwordx4 a[236:239],v247,s[20:23],s47 offen offset:2048 sc1
M a[172:175],a[244:247],a[220:223],a[172:175]
ds_read_b128 a[216:219],v245 offset:512
ds_read_b128 a[220:223],v246 offset:512
M a[176:179],a[244:247],a[192:195],a[176:179]
ds_read_b128 a[192:195],v245 offset:1024
ds_write2st64_b64 v249,v[228:229],v[230:231] offset0:85 offset1:89
M a[180:183],a[244:247],a[196:199],a[180:183]
buffer_load_dwordx4 a[104:107],v247,s[20:23],s48 offen offset:2048 sc1
M a[184:187],a[244:247],a[200:203],a[184:187]
s_add_u32 s46,s76,0
ds_read_b128 a[196:199],v246 offset:1024
ds_read_b128 a[200:203],v245 offset:1536
M a[188:191],a[244:247],a[204:207],a[188:191]
s_waitcnt vmcnt(14) lgkmcnt(7)
ds_read_b128 a[204:207],v246 offset:1536
v_accvgpr_read_b32 v204,a12
M v[32:35],a[248:251],a[208:211],v[32:35]
s_waitcnt lgkmcnt(7)
v_accvgpr_read_b32 v208,a108
v_accvgpr_read_b32 v205,a13
M v[36:39],a[248:251],a[212:215],v[36:39]
s_waitcnt lgkmcnt(6)
buffer_load_dwordx4 a[240:243],v247,s[20:23],s46 offen offset:0 sc1
M v[40:43],a[248:251],a[216:219],v[40:43]
s_waitcnt lgkmcnt(5)
v_accvgpr_read_b32 v209,a109
v_accvgpr_read_b32 v206,a14
M v[44:47],a[248:251],a[220:223],v[44:47]
s_waitcnt lgkmcnt(4)
v_accvgpr_read_b32 v210,a110
v_accvgpr_read_b32 v207,a15
v_accvgpr_read_b32 v211,a111
v_pk_add_f32 v[212:213],v[204:205],v[208:209]
v_pk_add_f32 v[214:215],v[206:207],v[210:211]
v_pk_add_f32 v[204:205],v[204:205],v[208:209] neg_lo:[0,1] neg_hi:[0,1]
v_pk_add_f32 v[206:207],v[206:207],v[210:211] neg_lo:[0,1] neg_hi:[0,1]
v_pk_add_f32 v[208:209],v[12:13],v[108:109]
v_pk_add_f32 v[210:211],v[14:15],v[110:111]
v_pk_add_f32 v[108:109],v[12:13],v[108:109] neg_lo:[0,1] neg_hi:[0,1]
v_pk_add_f32 v[110:111],v[14:15],v[110:111] neg_lo:[0,1] neg_hi:[0,1]
v_pk_add_f32 v[12:13],v[212:213],v[208:209]
v_pk_add_f32 v[14:15],v[214:215],v[210:211]
v_pk_fma_f32 v[212:213],v[208:209],4.0,v[212:213] op_sel_hi:[1,0,1]
v_pk_fma_f32 v[214:215],v[210:211],4.0,v[214:215] op_sel_hi:[1,0,1]
v_pk_fma_f32 v[208:209],v[108:109],2.0,v[204:205] op_sel_hi:[1,0,1]
v_pk_fma_f32 v[210:211],v[110:111],2.0,v[206:207] op_sel_hi:[1,0,1]
v_pk_fma_f32 v[108:109],v[108:109],s[40:41],v[204:205] op_sel_hi:[1,0,1]
v_pk_fma_f32 v[110:111],v[110:111],s[40:41],v[206:207] op_sel_hi:[1,0,1]
M v[48:51],a[248:251],a[192:195],v[48:51]
s_waitcnt lgkmcnt(2)
buffer_load_dwordx4 a[244:247],v247,s[20:23],s46 offen offset:1024 sc1
M v[52:55],a[248:251],a[196:199],v[52:55]
s_waitcnt lgkmcnt(1)
v_cvt_pk_bf16_f32 v208,v208,v209
v_cvt_pk_bf16_f32 v209,v210,v211
M v[56:59],a[248:251],a[200:203],v[56:59]
s_waitcnt lgkmcnt(0)
buffer_load_dwordx4 a[108:111],v247,s[20:23],s46 offen offset:2048 sc1
M v[60:63],a[248:251],a[204:207],v[60:63]
s_waitcnt vmcnt(16)
s_add_u32 s46,s77,0
v_cvt_pk_bf16_f32 v212,v212,v213
v_cvt_pk_bf16_f32 v213,v214,v215
M v[64:67],a[96:99],a[208:211],v[64:67]
ds_read_b128 a[208:211],v246 offset:2048
ds_write2st64_b64 v249,v[208:209],v[212:213] offset0:93 offset1:97
M v[68:71],a[96:99],a[212:215],v[68:71]
buffer_load_dwordx4 a[248:251],v247,s[20:23],s46 offen offset:0 sc1
M v[72:75],a[96:99],a[216:219],v[72:75]
v_accvgpr_read_b32 v234,a16
v_accvgpr_read_b32 v228,a112
M v[76:79],a[96:99],a[220:223],v[76:79]
v_add_f32 v230,v234,v228
v_sub_f32 v234,v234,v228
M v[80:83],a[96:99],a[192:195],v[80:83]
v_add_f32 v228,v16,v112
v_sub_f32 v112,v16,v112
M v[84:87],a[96:99],a[196:199],v[84:87]
s_waitcnt lgkmcnt(0)
s_barrier
ds_read_b128 a[8:11],v247 offset:43520
M v[88:91],a[96:99],a[200:203],v[88:91]
ds_read_b128 a[12:15],v247 offset:47616
v_add_f32 v16,v230,v228
M v[92:95],a[96:99],a[204:207],v[92:95]
s_waitcnt vmcnt(16)
buffer_load_dwordx4 a[96:99],v247,s[20:23],s46 offen offset:1024 sc1
M v[32:35],a[252:255],a[212:215],v[32:35]
v_fmac_f32 v230,4.0,v228
v_fma_f32 v228,2.0,v112,v234
M v[36:39],a[252:255],a[216:219],v[36:39]
v_fma_f32 v112,s40,v112,v234
v_accvgpr_read_b32 v234,a17
M v[40:43],a[252:255],a[220:223],v[40:43]
v_accvgpr_read_b32 v233,a113
v_add_f32 v232,v234,v233
M v[44:47],a[252:255],a[192:195],v[44:47]
v_sub_f32 v234,v234,v233
v_add_f32 v233,v17,v113
M v[48:51],a[252:255],a[196:199],v[48:51]
v_sub_f32 v113,v17,v113
v_add_f32 v17,v232,v233
M v[52:55],a[252:255],a[200:203],v[52:55]
v_fmac_f32 v232,4.0,v233
v_fma_f32 v233,2.0,v113,v234
M v[56:59],a[252:255],a[204:207],v[56:59]
v_fma_f32 v113,s40,v113,v234
v_cvt_pk_bf16_f32 v228,v228,v233
M v[60:63],a[252:255],a[208:211],v[60:63]
s_waitcnt vmcnt(16)
buffer_load_dwordx4 a[252:255],v247,s[20:23],s46 offen offset:2048 sc1
M v[64:67],a[224:227],a[212:215],v[64:67]
ds_read_b128 a[212:215],v245 offset:2048
v_cvt_pk_bf16_f32 v230,v230,v232
M v[68:71],a[224:227],a[216:219],v[68:71]
v_accvgpr_read_b32 v234,a18
v_accvgpr_read_b32 v229,a114
M v[72:75],a[224:227],a[220:223],v[72:75]
v_add_f32 v231,v234,v229
v_sub_f32 v234,v234,v229
M v[76:79],a[224:227],a[192:195],v[76:79]
v_add_f32 v229,v18,v114
v_sub_f32 v114,v18,v114
M v[80:83],a[224:227],a[196:199],v[80:83]
s_add_u32 s35,s64,7471104
buffer_load_dword v251,v250,s[8:11],s35 offen offset:0
M v[84:87],a[224:227],a[200:203],v[84:87]
v_add_f32 v18,v231,v229
v_fmac_f32 v231,4.0,v229
M v[88:91],a[224:227],a[204:207],v[88:91]
v_fma_f32 v229,2.0,v114,v234
v_fma_f32 v114,s40,v114,v234
M v[92:95],a[224:227],a[208:211],v[92:95]
s_waitcnt vmcnt(14)
v_accvgpr_read_b32 v234,a19
v_accvgpr_read_b32 v233,a115
M v[32:35],v[216:219],a[216:219],v[32:35]
s_add_u32 s35,s64,7471104
buffer_load_dword v251,v250,s[8:11],s35 offen offset:384
M v[36:39],v[216:219],a[220:223],v[36:39]
v_add_f32 v232,v234,v233
v_sub_f32 v234,v234,v233
M v[40:43],v[216:219],a[192:195],v[40:43]
v_add_f32 v233,v19,v115
v_sub_f32 v115,v19,v115
M v[44:47],v[216:219],a[196:199],v[44:47]
v_add_f32 v19,v232,v233
v_fmac_f32 v232,4.0,v233
M v[48:51],v[216:219],a[200:203],v[48:51]
v_fma_f32 v233,2.0,v115,v234
v_fma_f32 v115,s40,v115,v234
M v[52:55],v[216:219],a[204:207],v[52:55]
v_cvt_pk_bf16_f32 v229,v229,v233
v_cvt_pk_bf16_f32 v231,v231,v232
M v[56:59],v[216:219],a[208:211],v[56:59]
s_waitcnt lgkmcnt(0)
ds_write2st64_b64 v249,v[228:229],v[230:231] offset0:68 offset1:72
M v[60:63],v[216:219],a[212:215],v[60:63]
s_waitcnt vmcnt(14)
v_accvgpr_read_b32 v234,a20
v_accvgpr_read_b32 v228,a116
M v[64:67],v[220:223],a[216:219],v[64:67]
ds_read_b128 a[216:219],v245 offset:8704
v_add_f32 v230,v234,v228
M v[68:71],v[220:223],a[220:223],v[68:71]
ds_read_b128 a[220:223],v246 offset:8704
v_sub_f32 v234,v234,v228
M v[72:75],v[220:223],a[192:195],v[72:75]
ds_read_b128 a[192:195],v245 offset:9216
v_add_f32 v228,v20,v116
M v[76:79],v[220:223],a[196:199],v[76:79]
ds_read_b128 a[196:199],v246 offset:9216
v_sub_f32 v116,v20,v116
M v[80:83],v[220:223],a[200:203],v[80:83]
ds_read_b128 a[200:203],v245 offset:9728
v_add_f32 v20,v230,v228
M v[84:87],v[220:223],a[204:207],v[84:87]
ds_read_b128 a[204:207],v246 offset:9728
v_fmac_f32 v230,4.0,v228
M v[88:91],v[220:223],a[208:211],v[88:91]
ds_read_b128 a[208:211],v245 offset:10240
v_fma_f32 v228,2.0,v116,v234
M v[92:95],v[220:223],a[212:215],v[92:95]
s_waitcnt vmcnt(13) lgkmcnt(6)
ds_read_b128 a[212:215],v246 offset:10240
v_fma_f32 v116,s40,v116,v234
M v[128:131],a[100:103],a[216:219],v[128:131]
s_waitcnt lgkmcnt(6)
v_accvgpr_read_b32 v234,a21
v_accvgpr_read_b32 v233,a117
M v[132:135],a[100:103],a[220:223],v[132:135]
s_waitcnt lgkmcnt(5)
v_add_f32 v232,v234,v233
v_sub_f32 v234,v234,v233
M v[136:139],a[100:103],a[192:195],v[136:139]
s_waitcnt lgkmcnt(4)
v_add_f32 v233,v21,v117
v_sub_f32 v117,v21,v117
M v[140:143],a[100:103],a[196:199],v[140:143]
s_waitcnt lgkmcnt(3)
v_add_f32 v21,v232,v233
v_fmac_f32 v232,4.0,v233
M v[144:147],a[100:103],a[200:203],v[144:147]
s_waitcnt lgkmcnt(2)
v_fma_f32 v233,2.0,v117,v234
v_fma_f32 v117,s40,v117,v234
M v[148:151],a[100:103],a[204:207],v[148:151]
s_waitcnt lgkmcnt(1)
v_cvt_pk_bf16_f32 v228,v228,v233
v_cvt_pk_bf16_f32 v230,v230,v232
M v[152:155],a[100:103],a[208:211],v[152:155]
s_waitcnt lgkmcnt(0)
v_accvgpr_read_b32 v234,a22
v_accvgpr_read_b32 v229,a118
M v[156:159],a[100:103],a[212:215],v[156:159]
s_waitcnt vmcnt(12)
v_add_f32 v231,v234,v229
v_sub_f32 v234,v234,v229
M v[160:163],v[224:227],a[216:219],v[160:163]
ds_read_b128 a[216:219],v246 offset:10752
v_add_f32 v229,v22,v118
M v[164:167],v[224:227],a[220:223],v[164:167]
s_add_u32 s46,s78,0
v_sub_f32 v118,v22,v118
v_add_f32 v22,v231,v229
M v[168:171],v[224:227],a[192:195],v[168:171]
v_fmac_f32 v231,4.0,v229
v_fma_f32 v229,2.0,v118,v234
M v[172:175],v[224:227],a[196:199],v[172:175]
v_fma_f32 v118,s40,v118,v234
v_accvgpr_read_b32 v234,a23
M v[176:179],v[224:227],a[200:203],v[176:179]
v_accvgpr_read_b32 v233,a119
v_add_f32 v232,v234,v233
M v[180:183],v[224:227],a[204:207],v[180:183]
v_sub_f32 v234,v234,v233
v_add_f32 v233,v23,v119
M v[184:187],v[224:227],a[208:211],v[184:187]
v_sub_f32 v119,v23,v119
v_add_f32 v23,v232,v233
M v[188:191],v[224:227],a[212:215],v[188:191]
s_waitcnt vmcnt(11)
buffer_load_dwordx4 a[224:227],v247,s[20:23],s46 offen offset:0 sc1
M v[128:131],a[228:231],a[220:223],v[128:131]
v_fmac_f32 v232,4.0,v233
v_fma_f32 v233,2.0,v119,v234
M v[132:135],a[228:231],a[192:195],v[132:135]
buffer_load_dwordx4 a[112:115],v247,s[20:23],s46 offen offset:1024 sc1
M v[136:139],a[228:231],a[196:199],v[136:139]
v_fma_f32 v119,s40,v119,v234
v_cvt_pk_bf16_f32 v229,v229,v233
M v[140:143],a[228:231],a[200:203],v[140:143]
v_cvt_pk_bf16_f32 v231,v231,v232
M v[144:147],a[228:231],a[204:207],v[144:147]
ds_write2st64_b64 v249,v[228:229],v[230:231] offset0:76 offset1:80
M v[148:151],a[228:231],a[208:211],v[148:151]
buffer_load_dwordx4 v[216:219],v247,s[20:23],s46 offen offset:2048 sc1
M v[152:155],a[228:231],a[212:215],v[152:155]
s_waitcnt lgkmcnt(1)
s_add_u32 s46,s79,0
v_accvgpr_read_b32 v234,a24
v_accvgpr_read_b32 v228,a120
M v[156:159],a[228:231],a[216:219],v[156:159]
s_waitcnt vmcnt(13)
v_add_f32 v230,v234,v228
v_sub_f32 v234,v234,v228
M v[160:163],a[232:235],a[220:223],v[160:163]
ds_read_b128 a[220:223],v245 offset:10752
v_add_f32 v228,v24,v120
M v[164:167],a[232:235],a[192:195],v[164:167]
buffer_load_dwordx4 v[220:223],v247,s[20:23],s46 offen offset:0 sc1
M v[168:171],a[232:235],a[196:199],v[168:171]
v_sub_f32 v120,v24,v120
M v[172:175],a[232:235],a[200:203],v[172:175]
s_waitcnt lgkmcnt(1)
s_barrier
ds_read_b128 a[16:19],v247 offset:34816
M v[176:179],a[232:235],a[204:207],v[176:179]
ds_read_b128 a[20:23],v247 offset:38912
v_add_f32 v24,v230,v228
M v[180:183],a[232:235],a[208:211],v[180:183]
buffer_load_dwordx4 a[100:103],v247,s[20:23],s46 offen offset:1024 sc1
M v[184:187],a[232:235],a[212:215],v[184:187]
v_fmac_f32 v230,4.0,v228
v_fma_f32 v228,2.0,v120,v234
M v[188:191],a[232:235],a[216:219],v[188:191]
s_waitcnt vmcnt(14)
v_fma_f32 v120,s40,v120,v234
v_accvgpr_read_b32 v234,a25
M v[128:131],a[236:239],a[192:195],v[128:131]
v_accvgpr_read_b32 v233,a121
v_add_f32 v232,v234,v233
M v[132:135],a[236:239],a[196:199],v[132:135]
buffer_load_dwordx4 a[116:119],v247,s[20:23],s46 offen offset:2048 sc1
M v[136:139],a[236:239],a[200:203],v[136:139]
s_add_u32 s46,s80,0
v_sub_f32 v234,v234,v233
v_add_f32 v233,v25,v121
M v[140:143],a[236:239],a[204:207],v[140:143]
v_sub_f32 v121,v25,v121
v_add_f32 v25,v232,v233
M v[144:147],a[236:239],a[208:211],v[144:147]
v_fmac_f32 v232,4.0,v233
v_fma_f32 v233,2.0,v121,v234
M v[148:151],a[236:239],a[212:215],v[148:151]
buffer_load_dwordx4 v[224:227],v247,s[20:23],s46 offen offset:0 sc1
M v[152:155],a[236:239],a[216:219],v[152:155]
s_waitcnt lgkmcnt(2)
v_add_u32 v245,0xffffbc00,v245
v_add_u32 v246,0xffffbc00,v246
M v[156:159],a[236:239],a[220:223],v[156:159]
s_waitcnt vmcnt(15)
v_fma_f32 v121,s40,v121,v234
v_cvt_pk_bf16_f32 v228,v228,v233
M v[160:163],a[104:107],a[192:195],v[160:163]
ds_read_b128 a[192:195],v245 offset:0
v_cvt_pk_bf16_f32 v230,v230,v232
M v[164:167],a[104:107],a[196:199],v[164:167]
buffer_load_dwordx4 a[228:231],v247,s[20:23],s46 offen offset:1024 sc1
M v[168:171],a[104:107],a[200:203],v[168:171]
s_waitcnt lgkmcnt(0)
s_barrier
ds_read_b128 a[196:199],v246 offset:0
M v[172:175],a[104:107],a[204:207],v[172:175]
ds_read_b128 a[200:203],v245 offset:512
ds_read_b128 a[204:207],v246 offset:512
M v[176:179],a[104:107],a[208:211],v[176:179]
ds_read_b128 a[208:211],v245 offset:1024
v_accvgpr_read_b32 v234,a26
v_accvgpr_read_b32 v229,a122
v_add_f32 v231,v234,v229
M v[180:183],a[104:107],a[212:215],v[180:183]
buffer_load_dwordx4 a[232:235],v247,s[20:23],s46 offen offset:2048 sc1
v_sub_f32 v234,v234,v229
v_add_f32 v229,v26,v122
v_sub_f32 v122,v26,v122
v_add_f32 v26,v231,v229
M v[184:187],a[104:107],a[216:219],v[184:187]
s_add_u32 s46,s81,0
ds_read_b128 a[212:215],v246 offset:1024
ds_read_b128 a[216:219],v245 offset:1536
v_fmac_f32 v231,4.0,v229
v_fma_f32 v229,2.0,v122,v234
v_fma_f32 v122,s40,v122,v234
v_accvgpr_read_b32 v234,a27
M v[188:191],a[104:107],a[220:223],v[188:191]
s_waitcnt vmcnt(16)
buffer_load_dwordx4 a[236:239],v247,s[20:23],s46 offen offset:0 sc1
v_accvgpr_read_b32 v233,a123
v_add_f32 v232,v234,v233
v_sub_f32 v234,v234,v233
v_add_f32 v233,v27,v123
M v[0:3],a[240:243],a[192:195],v[0:3]
s_waitcnt lgkmcnt(5)
ds_read_b128 a[220:223],v246 offset:1536
ds_read_b128 a[192:195],v246 offset:2048
v_sub_f32 v123,v27,v123
v_add_f32 v27,v232,v233
v_fmac_f32 v232,4.0,v233
v_fma_f32 v233,2.0,v123,v234
M v[4:7],a[240:243],a[196:199],v[4:7]
s_waitcnt lgkmcnt(6)
buffer_load_dwordx4 a[104:107],v247,s[20:23],s46 offen offset:1024 sc1
v_fma_f32 v123,s40,v123,v234
v_cvt_pk_bf16_f32 v229,v229,v233
v_cvt_pk_bf16_f32 v231,v231,v232
M v[8:11],a[240:243],a[200:203],v[8:11]
s_waitcnt lgkmcnt(5)
ds_write2st64_b64 v249,v[228:229],v[230:231] offset0:85 offset1:89
M v[12:15],a[240:243],a[204:207],v[12:15]
s_waitcnt lgkmcnt(5)
buffer_load_dwordx4 a[120:123],v247,s[20:23],s46 offen offset:2048 sc1
v_accvgpr_read_b32 v204,a28
v_accvgpr_read_b32 v208,a124
M v[16:19],a[240:243],a[208:211],v[16:19]
s_waitcnt lgkmcnt(4)
s_add_u32 s46,s76,46080
v_accvgpr_read_b32 v205,a29
v_accvgpr_read_b32 v209,a125
v_accvgpr_read_b32 v206,a30
v_accvgpr_read_b32 v210,a126
v_accvgpr_read_b32 v207,a31
v_accvgpr_read_b32 v211,a127
v_pk_add_f32 v[212:213],v[204:205],v[208:209]
v_pk_add_f32 v[214:215],v[206:207],v[210:211]
v_pk_add_f32 v[204:205],v[204:205],v[208:209] neg_lo:[0,1] neg_hi:[0,1]
v_pk_add_f32 v[206:207],v[206:207],v[210:211] neg_lo:[0,1] neg_hi:[0,1]
v_pk_add_f32 v[208:209],v[28:29],v[124:125]
v_pk_add_f32 v[210:211],v[30:31],v[126:127]
v_pk_add_f32 v[124:125],v[28:29],v[124:125] neg_lo:[0,1] neg_hi:[0,1]
v_pk_add_f32 v[126:127],v[30:31],v[126:127] neg_lo:[0,1] neg_hi:[0,1]
v_pk_add_f32 v[28:29],v[212:213],v[208:209]
v_pk_add_f32 v[30:31],v[214:215],v[210:211]
v_pk_fma_f32 v[212:213],v[208:209],4.0,v[212:213] op_sel_hi:[1,0,1]
v_pk_fma_f32 v[214:215],v[210:211],4.0,v[214:215] op_sel_hi:[1,0,1]
v_pk_fma_f32 v[208:209],v[124:125],2.0,v[204:205] op_sel_hi:[1,0,1]
v_pk_fma_f32 v[210:211],v[126:127],2.0,v[206:207] op_sel_hi:[1,0,1]
v_pk_fma_f32 v[124:125],v[124:125],s[40:41],v[204:205] op_sel_hi:[1,0,1]
v_pk_fma_f32 v[126:127],v[126:127],s[40:41],v[206:207] op_sel_hi:[1,0,1]
M v[20:23],a[240:243],a[212:215],v[20:23]
s_waitcnt lgkmcnt(3)
buffer_load_dwordx4 a[124:127],v247,s[20:23],s46 offen offset:0 sc1
M v[24:27],a[240:243],a[216:219],v[24:27]
s_waitcnt lgkmcnt(2)
s_add_u32 s47,s76,49152
v_cvt_pk_bf16_f32 v208,v208,v209
v_cvt_pk_bf16_f32 v209,v210,v211
M v[28:31],a[240:243],a[220:223],v[28:31]
s_waitcnt vmcnt(19)
buffer_load_dwordx4 a[240:243],v247,s[20:23],s47 offen offset:0 sc1
M v[0:3],a[244:247],a[196:199],v[0:3]
ds_read_b128 a[196:199],v245 offset:2048
v_cvt_pk_bf16_f32 v212,v212,v213
M v[4:7],a[244:247],a[200:203],v[4:7]
v_cvt_pk_bf16_f32 v213,v214,v215
M v[8:11],a[244:247],a[204:207],v[8:11]
ds_write2st64_b64 v249,v[208:209],v[212:213] offset0:93 offset1:97
M v[12:15],a[244:247],a[208:211],v[12:15]
v_accvgpr_read_b32 v234,a32
v_accvgpr_read_b32 v228,a128
M v[16:19],a[244:247],a[212:215],v[16:19]
v_add_f32 v230,v234,v228
v_sub_f32 v234,v234,v228
M v[20:23],a[244:247],a[216:219],v[20:23]
v_add_u32 v245,0x15400,v245
v_add_u32 v246,0x15400,v246
M v[24:27],a[244:247],a[220:223],v[24:27]
s_waitcnt lgkmcnt(3)
v_add_f32 v228,v32,v128
v_sub_f32 v128,v32,v128
M v[28:31],a[244:247],a[192:195],v[28:31]
s_waitcnt vmcnt(19) lgkmcnt(0)
s_barrier
ds_read_b128 a[24:27],v247 offset:43520
M v[0:3],a[108:111],a[200:203],v[0:3]
ds_read_b128 a[28:31],v247 offset:47616
ds_read_b128 a[200:203],v245 offset:0
M v[4:7],a[108:111],a[204:207],v[4:7]
buffer_load_dwordx4 a[244:247],v247,s[20:23],s46 offen offset:1024 sc1
M v[8:11],a[108:111],a[208:211],v[8:11]
ds_read_b128 a[204:207],v246 offset:0
ds_read_b128 a[208:211],v245 offset:512
M v[12:15],a[108:111],a[212:215],v[12:15]
ds_read_b128 a[212:215],v246 offset:512
v_add_f32 v32,v230,v228
M v[16:19],a[108:111],a[216:219],v[16:19]
ds_read_b128 a[216:219],v245 offset:1024
v_fmac_f32 v230,4.0,v228
M v[20:23],a[108:111],a[220:223],v[20:23]
ds_read_b128 a[220:223],v246 offset:1024
v_fma_f32 v228,2.0,v128,v234
M v[24:27],a[108:111],a[192:195],v[24:27]
ds_read_b128 a[192:195],v245 offset:1536
v_fma_f32 v128,s40,v128,v234
M v[28:31],a[108:111],a[196:199],v[28:31]
s_waitcnt vmcnt(19) lgkmcnt(6)
buffer_load_dwordx4 a[108:111],v247,s[20:23],s47 offen offset:1024 sc1
M v[0:3],a[248:251],a[200:203],v[0:3]
s_waitcnt lgkmcnt(5)
ds_read_b128 a[196:199],v246 offset:1536
ds_read_b128 a[200:203],v246 offset:2048
M v[4:7],a[248:251],a[204:207],v[4:7]
s_waitcnt lgkmcnt(6)
v_accvgpr_read_b32 v234,a33
v_accvgpr_read_b32 v233,a129
M v[8:11],a[248:251],a[208:211],v[8:11]
s_waitcnt lgkmcnt(5)
v_add_f32 v232,v234,v233
v_sub_f32 v234,v234,v233
M v[12:15],a[248:251],a[212:215],v[12:15]
s_waitcnt lgkmcnt(4)
v_add_f32 v233,v33,v129
v_sub_f32 v129,v33,v129
M v[16:19],a[248:251],a[216:219],v[16:19]
s_waitcnt lgkmcnt(3)
v_add_f32 v33,v232,v233
v_fmac_f32 v232,4.0,v233
M v[20:23],a[248:251],a[220:223],v[20:23]
s_waitcnt lgkmcnt(2)
v_fma_f32 v233,2.0,v129,v234
v_fma_f32 v129,s40,v129,v234
M v[24:27],a[248:251],a[192:195],v[24:27]
s_waitcnt lgkmcnt(1)
v_cvt_pk_bf16_f32 v228,v228,v233
v_cvt_pk_bf16_f32 v230,v230,v232
M v[28:31],a[248:251],a[196:199],v[28:31]
s_waitcnt vmcnt(19)
buffer_load_dwordx4 a[248:251],v247,s[20:23],s46 offen offset:2048 sc1
M v[0:3],a[96:99],a[204:207],v[0:3]
s_add_u32 s34,s32,0
ds_read_b128 a[204:207],v245 offset:2048
v_accvgpr_read_b32 v234,a34
M v[4:7],a[96:99],a[208:211],v[4:7]
buffer_store_dwordx4 a[0:3],v248,s[24:27],s34 offen offset:384 nt
M v[8:11],a[96:99],a[212:215],v[8:11]
v_accvgpr_read_b32 v229,a130
v_add_f32 v231,v234,v229
M v[12:15],a[96:99],a[216:219],v[12:15]
v_sub_f32 v234,v234,v229
v_add_f32 v229,v34,v130
M v[16:19],a[96:99],a[220:223],v[16:19]
v_sub_f32 v130,v34,v130
v_add_f32 v34,v231,v229
M v[20:23],a[96:99],a[192:195],v[20:23]
v_fmac_f32 v231,4.0,v229
v_fma_f32 v229,2.0,v130,v234
M v[24:27],a[96:99],a[196:199],v[24:27]
s_waitcnt lgkmcnt(1)
v_fma_f32 v130,s40,v130,v234
v_accvgpr_read_b32 v234,a35
M v[28:31],a[96:99],a[200:203],v[28:31]
s_waitcnt vmcnt(20)
buffer_load_dwordx4 a[96:99],v247,s[20:23],s47 offen offset:2048 sc1
M v[0:3],a[252:255],a[208:211],v[0:3]
s_add_u32 s46,s77,46080
ds_read_b128 a[208:211],v245 offset:17408
v_accvgpr_read_b32 v233,a131
M v[4:7],a[252:255],a[212:215],v[4:7]
ds_read_b128 a[212:215],v246 offset:17408
v_add_f32 v232,v234,v233
M v[8:11],a[252:255],a[216:219],v[8:11]
buffer_load_dwordx4 a[128:131],v247,s[20:23],s46 offen offset:0 sc1
M v[12:15],a[252:255],a[220:223],v[12:15]
ds_read_b128 a[216:219],v245 offset:17920
ds_read_b128 a[220:223],v246 offset:17920
M v[16:19],a[252:255],a[192:195],v[16:19]
s_add_u32 s47,s77,49152
ds_read_b128 a[192:195],v245 offset:18432
v_sub_f32 v234,v234,v233
M v[20:23],a[252:255],a[196:199],v[20:23]
ds_read_b128 a[196:199],v246 offset:18432
v_add_f32 v233,v35,v131
M v[24:27],a[252:255],a[200:203],v[24:27]
s_waitcnt lgkmcnt(6)
ds_read_b128 a[200:203],v245 offset:18944
v_sub_f32 v131,v35,v131
M v[28:31],a[252:255],a[204:207],v[28:31]
s_waitcnt vmcnt(19) lgkmcnt(6)
ds_read_b128 a[204:207],v246 offset:18944
v_add_f32 v35,v232,v233
M v[0:3],a[224:227],a[208:211],v[0:3]
s_waitcnt lgkmcnt(6)
ds_read_b128 a[208:211],v246 offset:19456
v_fmac_f32 v232,4.0,v233
M v[4:7],a[224:227],a[212:215],v[4:7]
s_waitcnt lgkmcnt(6)
v_fma_f32 v233,2.0,v131,v234
v_fma_f32 v131,s40,v131,v234
M v[8:11],a[224:227],a[216:219],v[8:11]
s_waitcnt lgkmcnt(5)
s_add_u32 s34,s32,196608
buffer_load_dwordx4 a[252:255],v247,s[20:23],s47 offen offset:0 sc1
M v[12:15],a[224:227],a[220:223],v[12:15]
s_waitcnt lgkmcnt(4)
v_cvt_pk_bf16_f32 v229,v229,v233
v_cvt_pk_bf16_f32 v231,v231,v232
M v[16:19],a[224:227],a[192:195],v[16:19]
s_waitcnt lgkmcnt(3)
buffer_store_dwordx4 a[4:7],v248,s[24:27],s34 offen offset:384 nt
M v[20:23],a[224:227],a[196:199],v[20:23]
s_waitcnt lgkmcnt(2)
ds_write2st64_b64 v249,v[228:229],v[230:231] offset0:34 offset1:38
M v[24:27],a[224:227],a[200:203],v[24:27]
s_waitcnt lgkmcnt(2)
v_accvgpr_read_b32 v204,a36
v_accvgpr_read_b32 v208,a132
M v[28:31],a[224:227],a[204:207],v[28:31]
s_waitcnt vmcnt(20)
v_accvgpr_read_b32 v205,a37
v_accvgpr_read_b32 v209,a133
M v[0:3],a[112:115],a[212:215],v[0:3]
ds_read_b128 a[212:215],v245 offset:19456
v_accvgpr_read_b32 v206,a38
M v[4:7],a[112:115],a[216:219],v[4:7]
v_accvgpr_read_b32 v210,a134
v_accvgpr_read_b32 v207,a39
v_accvgpr_read_b32 v211,a135
v_pk_add_f32 v[212:213],v[204:205],v[208:209]
v_pk_add_f32 v[214:215],v[206:207],v[210:211]
v_pk_add_f32 v[204:205],v[204:205],v[208:209] neg_lo:[0,1] neg_hi:[0,1]
v_pk_add_f32 v[206:207],v[206:207],v[210:211] neg_lo:[0,1] neg_hi:[0,1]
v_pk_add_f32 v[208:209],v[36:37],v[132:133]
v_pk_add_f32 v[210:211],v[38:39],v[134:135]
v_pk_add_f32 v[132:133],v[36:37],v[132:133] neg_lo:[0,1] neg_hi:[0,1]
v_pk_add_f32 v[134:135],v[38:39],v[134:135] neg_lo:[0,1] neg_hi:[0,1]
v_pk_add_f32 v[36:37],v[212:213],v[208:209]
v_pk_add_f32 v[38:39],v[214:215],v[210:211]
v_pk_fma_f32 v[212:213],v[208:209],4.0,v[212:213] op_sel_hi:[1,0,1]
v_pk_fma_f32 v[214:215],v[210:211],4.0,v[214:215] op_sel_hi:[1,0,1]
v_pk_fma_f32 v[208:209],v[132:133],2.0,v[204:205] op_sel_hi:[1,0,1]
v_pk_fma_f32 v[210:211],v[134:135],2.0,v[206:207] op_sel_hi:[1,0,1]
v_pk_fma_f32 v[132:133],v[132:133],s[40:41],v[204:205] op_sel_hi:[1,0,1]
v_pk_fma_f32 v[134:135],v[134:135],s[40:41],v[206:207] op_sel_hi:[1,0,1]
M v[8:11],a[112:115],a[220:223],v[8:11]
buffer_load_dwordx4 a[224:227],v247,s[20:23],s46 offen offset:1024 sc1
M v[12:15],a[112:115],a[192:195],v[12:15]
v_cvt_pk_bf16_f32 v208,v208,v209
v_cvt_pk_bf16_f32 v209,v210,v211
M v[16:19],a[112:115],a[196:199],v[16:19]
v_cvt_pk_bf16_f32 v212,v212,v213
v_cvt_pk_bf16_f32 v213,v214,v215
M v[20:23],a[112:115],a[200:203],v[20:23]
ds_write2st64_b64 v249,v[208:209],v[212:213] offset0:42 offset1:46
M v[24:27],a[112:115],a[204:207],v[24:27]
s_waitcnt lgkmcnt(3)
v_accvgpr_read_b32 v204,a40
v_accvgpr_read_b32 v208,a136
M v[28:31],a[112:115],a[208:211],v[28:31]
s_waitcnt vmcnt(20)
v_accvgpr_read_b32 v205,a41
v_accvgpr_read_b32 v209,a137
M v[0:3],v[216:219],a[216:219],v[0:3]
ds_read_b128 a[216:219],v245 offset:34816
v_accvgpr_read_b32 v206,a42
M v[4:7],v[216:219],a[220:223],v[4:7]
ds_read_b128 a[220:223],v246 offset:34816
v_accvgpr_read_b32 v210,a138
v_accvgpr_read_b32 v207,a43
v_accvgpr_read_b32 v211,a139
v_pk_add_f32 v[212:213],v[204:205],v[208:209]
v_pk_add_f32 v[214:215],v[206:207],v[210:211]
v_pk_add_f32 v[204:205],v[204:205],v[208:209] neg_lo:[0,1] neg_hi:[0,1]
v_pk_add_f32 v[206:207],v[206:207],v[210:211] neg_lo:[0,1] neg_hi:[0,1]
v_pk_add_f32 v[208:209],v[40:41],v[136:137]
v_pk_add_f32 v[210:211],v[42:43],v[138:139]
v_pk_add_f32 v[136:137],v[40:41],v[136:137] neg_lo:[0,1] neg_hi:[0,1]
v_pk_add_f32 v[138:139],v[42:43],v[138:139] neg_lo:[0,1] neg_hi:[0,1]
v_pk_add_f32 v[40:41],v[212:213],v[208:209]
v_pk_add_f32 v[42:43],v[214:215],v[210:211]
v_pk_fma_f32 v[212:213],v[208:209],4.0,v[212:213] op_sel_hi:[1,0,1]
v_pk_fma_f32 v[214:215],v[210:211],4.0,v[214:215] op_sel_hi:[1,0,1]
v_pk_fma_f32 v[208:209],v[136:137],2.0,v[204:205] op_sel_hi:[1,0,1]
v_pk_fma_f32 v[210:211],v[138:139],2.0,v[206:207] op_sel_hi:[1,0,1]
v_pk_fma_f32 v[136:137],v[136:137],s[40:41],v[204:205] op_sel_hi:[1,0,1]
v_pk_fma_f32 v[138:139],v[138:139],s[40:41],v[206:207] op_sel_hi:[1,0,1]
M v[8:11],v[216:219],a[192:195],v[8:11]
buffer_load_dwordx4 a[132:135],v247,s[20:23],s47 offen offset:1024 sc1
M v[12:15],v[216:219],a[196:199],v[12:15]
ds_read_b128 a[192:195],v245 offset:35328
ds_read_b128 a[196:199],v246 offset:35328
M v[16:19],v[216:219],a[200:203],v[16:19]
s_add_u32 s34,s32,393216
buffer_store_dwordx4 a[8:11],v248,s[24:27],s34 offen offset:384 nt
M v[20:23],v[216:219],a[204:207],v[20:23]
ds_read_b128 a[200:203],v245 offset:35840
ds_read_b128 a[204:207],v246 offset:35840
M v[24:27],v[216:219],a[208:211],v[24:27]
s_waitcnt lgkmcnt(7)
ds_read_b128 a[208:211],v245 offset:36352
v_cvt_pk_bf16_f32 v208,v208,v209
M v[28:31],v[216:219],a[212:215],v[28:31]
s_waitcnt vmcnt(21) lgkmcnt(6)
ds_read_b128 a[212:215],v246 offset:36352
v_cvt_pk_bf16_f32 v209,v210,v211
M v[0:3],v[220:223],a[216:219],v[0:3]
s_waitcnt lgkmcnt(6)
ds_read_b128 a[216:219],v246 offset:36864
v_cvt_pk_bf16_f32 v212,v212,v213
M v[4:7],v[220:223],a[220:223],v[4:7]
s_waitcnt lgkmcnt(6)
v_cvt_pk_bf16_f32 v213,v214,v215
M v[8:11],v[220:223],a[192:195],v[8:11]
s_waitcnt lgkmcnt(5)
buffer_load_dwordx4 a[112:115],v247,s[20:23],s46 offen offset:2048 sc1
M v[12:15],v[220:223],a[196:199],v[12:15]
s_waitcnt lgkmcnt(4)
ds_write2st64_b64 v249,v[208:209],v[212:213] offset0:51 offset1:55
M v[16:19],v[220:223],a[200:203],v[16:19]
s_waitcnt lgkmcnt(4)
v_accvgpr_read_b32 v204,a44
v_accvgpr_read_b32 v208,a140
M v[20:23],v[220:223],a[204:207],v[20:23]
s_waitcnt lgkmcnt(3)
v_accvgpr_read_b32 v205,a45
v_accvgpr_read_b32 v209,a141
M v[24:27],v[220:223],a[208:211],v[24:27]
s_waitcnt lgkmcnt(2)
v_accvgpr_read_b32 v206,a46
v_accvgpr_read_b32 v210,a142
v_accvgpr_read_b32 v207,a47
v_accvgpr_read_b32 v211,a143
v_pk_add_f32 v[212:213],v[204:205],v[208:209]
v_pk_add_f32 v[214:215],v[206:207],v[210:211]
v_pk_add_f32 v[204:205],v[204:205],v[208:209] neg_lo:[0,1] neg_hi:[0,1]
v_pk_add_f32 v[206:207],v[206:207],v[210:211] neg_lo:[0,1] neg_hi:[0,1]
v_pk_add_f32 v[208:209],v[44:45],v[140:141]
v_pk_add_f32 v[210:211],v[46:47],v[142:143]
v_pk_add_f32 v[140:141],v[44:45],v[140:141] neg_lo:[0,1] neg_hi:[0,1]
v_pk_add_f32 v[142:143],v[46:47],v[142:143] neg_lo:[0,1] neg_hi:[0,1]
v_pk_add_f32 v[44:45],v[212:213],v[208:209]
v_pk_add_f32 v[46:47],v[214:215],v[210:211]
v_pk_fma_f32 v[212:213],v[208:209],4.0,v[212:213] op_sel_hi:[1,0,1]
v_pk_fma_f32 v[214:215],v[210:211],4.0,v[214:215] op_sel_hi:[1,0,1]
v_pk_fma_f32 v[208:209],v[140:141],2.0,v[204:205] op_sel_hi:[1,0,1]
v_pk_fma_f32 v[210:211],v[142:143],2.0,v[206:207] op_sel_hi:[1,0,1]
v_pk_fma_f32 v[140:141],v[140:141],s[40:41],v[204:205] op_sel_hi:[1,0,1]
v_pk_fma_f32 v[142:143],v[142:143],s[40:41],v[206:207] op_sel_hi:[1,0,1]
M v[28:31],v[220:223],a[212:215],v[28:31]
s_waitcnt vmcnt(21)
v_cvt_pk_bf16_f32 v208,v208,v209
v_cvt_pk_bf16_f32 v209,v210,v211
M v[0:3],a[100:103],a[220:223],v[0:3]
ds_read_b128 a[220:223],v245 offset:36864
v_cvt_pk_bf16_f32 v212,v212,v213
M v[4:7],a[100:103],a[192:195],v[4:7]
v_cvt_pk_bf16_f32 v213,v214,v215
M v[8:11],a[100:103],a[196:199],v[8:11]
buffer_load_dwordx4 a[136:139],v247,s[20:23],s47 offen offset:2048 sc1
M v[12:15],a[100:103],a[200:203],v[12:15]
ds_write2st64_b64 v249,v[208:209],v[212:213] offset0:59 offset1:63
M v[16:19],a[100:103],a[204:207],v[16:19]
s_add_u32 s46,s78,46080
v_accvgpr_read_b32 v234,a48
v_accvgpr_read_b32 v228,a144
M v[20:23],a[100:103],a[208:211],v[20:23]
v_add_f32 v230,v234,v228
v_sub_f32 v234,v234,v228
M v[24:27],a[100:103],a[212:215],v[24:27]
s_waitcnt lgkmcnt(3)
s_add_u32 s34,s32,589824
buffer_store_dwordx4 a[12:15],v248,s[24:27],s34 offen offset:384 nt
M v[28:31],a[100:103],a[216:219],v[28:31]
s_waitcnt vmcnt(22)
v_add_f32 v228,v48,v144
v_sub_f32 v144,v48,v144
M v[0:3],a[116:119],a[192:195],v[0:3]
s_waitcnt lgkmcnt(0)
s_barrier
ds_read_b128 a[32:35],v247 offset:17408
M v[4:7],a[116:119],a[196:199],v[4:7]
ds_read_b128 a[36:39],v247 offset:21504
ds_read_b128 a[40:43],v247 offset:26112
M v[8:11],a[116:119],a[200:203],v[8:11]
ds_read_b128 a[44:47],v247 offset:30208
ds_read_b128 a[192:195],v245 offset:52224
M v[12:15],a[116:119],a[204:207],v[12:15]
buffer_load_dwordx4 v[216:219],v247,s[20:23],s46 offen offset:0 sc1
M v[16:19],a[116:119],a[208:211],v[16:19]
s_add_u32 s47,s78,49152
ds_read_b128 a[196:199],v246 offset:52224
ds_read_b128 a[200:203],v245 offset:52736
M v[20:23],a[116:119],a[212:215],v[20:23]
ds_read_b128 a[204:207],v246 offset:52736
ds_read_b128 a[208:211],v245 offset:53248
M v[24:27],a[116:119],a[216:219],v[24:27]
ds_read_b128 a[212:215],v246 offset:53248
ds_read_b128 a[216:219],v245 offset:53760
M v[28:31],a[116:119],a[220:223],v[28:31]
s_waitcnt vmcnt(22) lgkmcnt(6)
ds_read_b128 a[220:223],v246 offset:53760
v_add_f32 v48,v230,v228
M v[0:3],v[224:227],a[192:195],v[0:3]
s_waitcnt lgkmcnt(6)
ds_read_b128 a[192:195],v246 offset:54272
v_fmac_f32 v230,4.0,v228
M v[4:7],v[224:227],a[196:199],v[4:7]
s_waitcnt lgkmcnt(6)
v_fma_f32 v228,2.0,v144,v234
v_fma_f32 v144,s40,v144,v234
M v[8:11],v[224:227],a[200:203],v[8:11]
s_waitcnt lgkmcnt(5)
buffer_load_dwordx4 v[220:223],v247,s[20:23],s47 offen offset:0 sc1
M v[12:15],v[224:227],a[204:207],v[12:15]
s_waitcnt lgkmcnt(4)
v_accvgpr_read_b32 v234,a49
v_accvgpr_read_b32 v233,a145
M v[16:19],v[224:227],a[208:211],v[16:19]
s_waitcnt lgkmcnt(3)
v_add_f32 v232,v234,v233
v_sub_f32 v234,v234,v233
M v[20:23],v[224:227],a[212:215],v[20:23]
s_waitcnt lgkmcnt(2)
v_add_f32 v233,v49,v145
v_sub_f32 v145,v49,v145
M v[24:27],v[224:227],a[216:219],v[24:27]
s_waitcnt lgkmcnt(1)
v_add_f32 v49,v232,v233
v_fmac_f32 v232,4.0,v233
M v[28:31],v[224:227],a[220:223],v[28:31]
s_waitcnt vmcnt(22)
v_fma_f32 v233,2.0,v145,v234
v_fma_f32 v145,s40,v145,v234
M v[0:3],a[228:231],a[196:199],v[0:3]
s_add_u32 s34,s32,786432
buffer_store_dwordx4 a[16:19],v248,s[24:27],s34 offen offset:384 nt
M v[4:7],a[228:231],a[200:203],v[4:7]
ds_read_b128 a[196:199],v245 offset:54272
v_cvt_pk_bf16_f32 v228,v228,v233
M v[8:11],a[228:231],a[204:207],v[8:11]
buffer_load_dwordx4 a[140:143],v247,s[20:23],s46 offen offset:1024 sc1
M v[12:15],a[228:231],a[208:211],v[12:15]
v_cvt_pk_bf16_f32 v230,v230,v232
v_accvgpr_read_b32 v234,a50
M v[16:19],a[228:231],a[212:215],v[16:19]
v_accvgpr_read_b32 v229,a146
v_add_f32 v231,v234,v229
M v[20:23],a[228:231],a[216:219],v[20:23]
v_add_u32 v245,0xfffece00,v245
v_add_u32 v246,0xfffece00,v246
M v[24:27],a[228:231],a[220:223],v[24:27]
s_waitcnt lgkmcnt(1)
v_sub_f32 v234,v234,v229
v_add_f32 v229,v50,v146
M v[28:31],a[228:231],a[192:195],v[28:31]
s_waitcnt vmcnt(23)
v_sub_f32 v146,v50,v146
v_add_f32 v50,v231,v229
M v[0:3],a[232:235],a[200:203],v[0:3]
ds_read_b128 a[200:203],v245 offset:60928
v_fmac_f32 v231,4.0,v229
M v[4:7],a[232:235],a[204:207],v[4:7]
ds_read_b128 a[204:207],v246 offset:60928
v_fma_f32 v229,2.0,v146,v234
M v[8:11],a[232:235],a[208:211],v[8:11]
buffer_load_dwordx4 a[100:103],v247,s[20:23],s47 offen offset:1024 sc1
M v[12:15],a[232:235],a[212:215],v[12:15]
ds_read_b128 a[208:211],v245 offset:61440
ds_read_b128 a[212:215],v246 offset:61440
M v[16:19],a[232:235],a[216:219],v[16:19]
ds_read_b128 a[216:219],v245 offset:61952
v_fma_f32 v146,s40,v146,v234
M v[20:23],a[232:235],a[220:223],v[20:23]
ds_read_b128 a[220:223],v246 offset:61952
v_accvgpr_read_b32 v234,a51
M v[24:27],a[232:235],a[192:195],v[24:27]
s_waitcnt lgkmcnt(6)
ds_read_b128 a[192:195],v245 offset:62464
v_accvgpr_read_b32 v233,a147
M v[28:31],a[232:235],a[196:199],v[28:31]
s_waitcnt vmcnt(23) lgkmcnt(6)
ds_read_b128 a[196:199],v246 offset:62464
v_add_f32 v232,v234,v233
M v[0:3],a[236:239],a[200:203],v[0:3]
s_waitcnt lgkmcnt(6)
ds_read_b128 a[200:203],v246 offset:62976
v_sub_f32 v234,v234,v233
M v[4:7],a[236:239],a[204:207],v[4:7]
s_waitcnt lgkmcnt(6)
v_add_f32 v233,v51,v147
v_sub_f32 v147,v51,v147
M v[8:11],a[236:239],a[208:211],v[8:11]
s_waitcnt lgkmcnt(5)
s_add_u32 s34,s32,983040
buffer_load_dwordx4 a[116:119],v247,s[20:23],s46 offen offset:2048 sc1
M v[12:15],a[236:239],a[212:215],v[12:15]
s_waitcnt lgkmcnt(4)
v_add_f32 v51,v232,v233
v_fmac_f32 v232,4.0,v233
M v[16:19],a[236:239],a[216:219],v[16:19]
s_waitcnt lgkmcnt(3)
buffer_store_dwordx4 a[20:23],v248,s[24:27],s34 offen offset:384 nt
M v[20:23],a[236:239],a[220:223],v[20:23]
s_waitcnt lgkmcnt(2)
v_fma_f32 v233,2.0,v147,v234
v_fma_f32 v147,s40,v147,v234
M v[24:27],a[236:239],a[192:195],v[24:27]
s_waitcnt lgkmcnt(1)
v_cvt_pk_bf16_f32 v229,v229,v233
v_cvt_pk_bf16_f32 v231,v231,v232
M v[28:31],a[236:239],a[196:199],v[28:31]
s_waitcnt vmcnt(24)
ds_write2st64_b64 v249,v[228:229],v[230:231] offset0:119 offset1:123
M v[0:3],a[104:107],a[204:207],v[0:3]
ds_read_b128 a[204:207],v245 offset:62976
v_accvgpr_read_b32 v204,a52
M v[4:7],a[104:107],a[208:211],v[4:7]
v_accvgpr_read_b32 v208,a148
v_accvgpr_read_b32 v205,a53
M v[8:11],a[104:107],a[212:215],v[8:11]
buffer_load_dwordx4 v[224:227],v247,s[20:23],s47 offen offset:2048 sc1
M v[12:15],a[104:107],a[216:219],v[12:15]
v_accvgpr_read_b32 v209,a149
v_accvgpr_read_b32 v206,a54
M v[16:19],a[104:107],a[220:223],v[16:19]
s_add_u32 s46,s79,46080
v_accvgpr_read_b32 v210,a150
v_accvgpr_read_b32 v207,a55
v_accvgpr_read_b32 v211,a151
v_pk_add_f32 v[212:213],v[204:205],v[208:209]
v_pk_add_f32 v[214:215],v[206:207],v[210:211]
v_pk_add_f32 v[204:205],v[204:205],v[208:209] neg_lo:[0,1] neg_hi:[0,1]
v_pk_add_f32 v[206:207],v[206:207],v[210:211] neg_lo:[0,1] neg_hi:[0,1]
v_pk_add_f32 v[208:209],v[52:53],v[148:149]
v_pk_add_f32 v[210:211],v[54:55],v[150:151]
v_pk_add_f32 v[148:149],v[52:53],v[148:149] neg_lo:[0,1] neg_hi:[0,1]
v_pk_add_f32 v[150:151],v[54:55],v[150:151] neg_lo:[0,1] neg_hi:[0,1]
v_pk_add_f32 v[52:53],v[212:213],v[208:209]
v_pk_add_f32 v[54:55],v[214:215],v[210:211]
v_pk_fma_f32 v[212:213],v[208:209],4.0,v[212:213] op_sel_hi:[1,0,1]
v_pk_fma_f32 v[214:215],v[210:211],4.0,v[214:215] op_sel_hi:[1,0,1]
v_pk_fma_f32 v[208:209],v[148:149],2.0,v[204:205] op_sel_hi:[1,0,1]
v_pk_fma_f32 v[210:211],v[150:151],2.0,v[206:207] op_sel_hi:[1,0,1]
v_pk_fma_f32 v[148:149],v[148:149],s[40:41],v[204:205] op_sel_hi:[1,0,1]
v_pk_fma_f32 v[150:151],v[150:151],s[40:41],v[206:207] op_sel_hi:[1,0,1]
M v[20:23],a[104:107],a[192:195],v[20:23]
v_cvt_pk_bf16_f32 v208,v208,v209
v_cvt_pk_bf16_f32 v209,v210,v211
M v[24:27],a[104:107],a[196:199],v[24:27]
s_waitcnt lgkmcnt(2)
v_cvt_pk_bf16_f32 v212,v212,v213
v_cvt_pk_bf16_f32 v213,v214,v215
M v[28:31],a[104:107],a[200:203],v[28:31]
s_waitcnt vmcnt(24)
ds_write2st64_b64 v249,v[208:209],v[212:213] offset0:127 offset1:131
M v[0:3],a[120:123],a[208:211],v[0:3]
ds_read_b128 a[208:211],v245 offset:0
v_accvgpr_read_b32 v204,a56
M v[4:7],a[120:123],a[212:215],v[4:7]
ds_read_b128 a[212:215],v246 offset:0
v_accvgpr_read_b32 v208,a152
M v[8:11],a[120:123],a[216:219],v[8:11]
buffer_load_dwordx4 a[228:231],v247,s[20:23],s46 offen offset:0 sc1
M v[12:15],a[120:123],a[220:223],v[12:15]
ds_read_b128 a[216:219],v245 offset:512
ds_read_b128 a[220:223],v246 offset:512
M v[16:19],a[120:123],a[192:195],v[16:19]
s_add_u32 s47,s79,49152
ds_read_b128 a[192:195],v245 offset:1024
s_add_u32 s34,s32,1179648
M v[20:23],a[120:123],a[196:199],v[20:23]
buffer_store_dwordx4 a[24:27],v248,s[24:27],s34 offen offset:384 nt
M v[24:27],a[120:123],a[200:203],v[24:27]
s_waitcnt lgkmcnt(6)
ds_read_b128 a[196:199],v246 offset:1024
ds_read_b128 a[200:203],v245 offset:1536
M v[28:31],a[120:123],a[204:207],v[28:31]
s_waitcnt vmcnt(25) lgkmcnt(6)
ds_read_b128 a[204:207],v246 offset:1536
v_accvgpr_read_b32 v205,a57
M v[96:99],a[124:127],a[208:211],v[96:99]
s_waitcnt lgkmcnt(6)
v_accvgpr_read_b32 v209,a153
v_accvgpr_read_b32 v206,a58
M v[100:103],a[124:127],a[212:215],v[100:103]
s_waitcnt lgkmcnt(5)
v_accvgpr_read_b32 v210,a154
v_accvgpr_read_b32 v207,a59
v_accvgpr_read_b32 v211,a155
v_pk_add_f32 v[212:213],v[204:205],v[208:209]
v_pk_add_f32 v[214:215],v[206:207],v[210:211]
v_pk_add_f32 v[204:205],v[204:205],v[208:209] neg_lo:[0,1] neg_hi:[0,1]
v_pk_add_f32 v[206:207],v[206:207],v[210:211] neg_lo:[0,1] neg_hi:[0,1]
v_pk_add_f32 v[208:209],v[56:57],v[152:153]
v_pk_add_f32 v[210:211],v[58:59],v[154:155]
v_pk_add_f32 v[152:153],v[56:57],v[152:153] neg_lo:[0,1] neg_hi:[0,1]
v_pk_add_f32 v[154:155],v[58:59],v[154:155] neg_lo:[0,1] neg_hi:[0,1]
v_pk_add_f32 v[56:57],v[212:213],v[208:209]
v_pk_add_f32 v[58:59],v[214:215],v[210:211]
v_pk_fma_f32 v[212:213],v[208:209],4.0,v[212:213] op_sel_hi:[1,0,1]
v_pk_fma_f32 v[214:215],v[210:211],4.0,v[214:215] op_sel_hi:[1,0,1]
v_pk_fma_f32 v[208:209],v[152:153],2.0,v[204:205] op_sel_hi:[1,0,1]
v_pk_fma_f32 v[210:211],v[154:155],2.0,v[206:207] op_sel_hi:[1,0,1]
v_pk_fma_f32 v[152:153],v[152:153],s[40:41],v[204:205] op_sel_hi:[1,0,1]
v_pk_fma_f32 v[154:155],v[154:155],s[40:41],v[206:207] op_sel_hi:[1,0,1]
M v[104:107],a[124:127],a[216:219],v[104:107]
s_waitcnt lgkmcnt(4)
buffer_load_dwordx4 a[232:235],v247,s[20:23],s47 offen offset:0 sc1
M v[108:111],a[124:127],a[220:223],v[108:111]
s_waitcnt lgkmcnt(3)
v_cvt_pk_bf16_f32 v208,v208,v209
v_cvt_pk_bf16_f32 v209,v210,v211
M v[112:115],a[124:127],a[192:195],v[112:115]
s_waitcnt lgkmcnt(2)
global_load_dword v251,v252,s[82:83]
M v[116:119],a[124:127],a[196:199],v[116:119]
s_waitcnt lgkmcnt(1)
v_cvt_pk_bf16_f32 v212,v212,v213
v_cvt_pk_bf16_f32 v213,v214,v215
M v[120:123],a[124:127],a[200:203],v[120:123]
s_waitcnt lgkmcnt(0)
ds_write2st64_b64 v249,v[208:209],v[212:213] offset0:68 offset1:72
M v[124:127],a[124:127],a[204:207],v[124:127]
s_waitcnt vmcnt(26)
v_accvgpr_read_b32 v204,a60
v_accvgpr_read_b32 v208,a156
M v[128:131],a[240:243],a[208:211],v[128:131]
ds_read_b128 a[208:211],v246 offset:2048
v_accvgpr_read_b32 v205,a61
M v[132:135],a[240:243],a[212:215],v[132:135]
v_accvgpr_read_b32 v209,a157
v_accvgpr_read_b32 v206,a62
M v[136:139],a[240:243],a[216:219],v[136:139]
buffer_load_dwordx4 a[144:147],v247,s[20:23],s46 offen offset:1024 sc1
M v[140:143],a[240:243],a[220:223],v[140:143]
v_accvgpr_read_b32 v210,a158
v_accvgpr_read_b32 v207,a63
v_accvgpr_read_b32 v211,a159
v_pk_add_f32 v[212:213],v[204:205],v[208:209]
v_pk_add_f32 v[214:215],v[206:207],v[210:211]
v_pk_add_f32 v[204:205],v[204:205],v[208:209] neg_lo:[0,1] neg_hi:[0,1]
v_pk_add_f32 v[206:207],v[206:207],v[210:211] neg_lo:[0,1] neg_hi:[0,1]
v_pk_add_f32 v[208:209],v[60:61],v[156:157]
v_pk_add_f32 v[210:211],v[62:63],v[158:159]
v_pk_add_f32 v[156:157],v[60:61],v[156:157] neg_lo:[0,1] neg_hi:[0,1]
v_pk_add_f32 v[158:159],v[62:63],v[158:159] neg_lo:[0,1] neg_hi:[0,1]
v_pk_add_f32 v[60:61],v[212:213],v[208:209]
v_pk_add_f32 v[62:63],v[214:215],v[210:211]
v_pk_fma_f32 v[212:213],v[208:209],4.0,v[212:213] op_sel_hi:[1,0,1]
v_pk_fma_f32 v[214:215],v[210:211],4.0,v[214:215] op_sel_hi:[1,0,1]
v_pk_fma_f32 v[208:209],v[156:157],2.0,v[204:205] op_sel_hi:[1,0,1]
v_pk_fma_f32 v[210:211],v[158:159],2.0,v[206:207] op_sel_hi:[1,0,1]
v_pk_fma_f32 v[156:157],v[156:157],s[40:41],v[204:205] op_sel_hi:[1,0,1]
v_pk_fma_f32 v[158:159],v[158:159],s[40:41],v[206:207] op_sel_hi:[1,0,1]
M v[144:147],a[240:243],a[192:195],v[144:147]
v_cvt_pk_bf16_f32 v208,v208,v209
v_cvt_pk_bf16_f32 v209,v210,v211
M v[148:151],a[240:243],a[196:199],v[148:151]
v_cvt_pk_bf16_f32 v212,v212,v213
v_cvt_pk_bf16_f32 v213,v214,v215
M v[152:155],a[240:243],a[200:203],v[152:155]
s_add_u32 s34,s32,1376256
buffer_store_dwordx4 a[28:31],v248,s[24:27],s34 offen offset:384 nt
M v[156:159],a[240:243],a[204:207],v[156:159]
s_waitcnt vmcnt(27)
ds_write2st64_b64 v249,v[208:209],v[212:213] offset0:76 offset1:80
M v[96:99],a[244:247],a[212:215],v[96:99]
s_add_u32 s28,s64,6684672
buffer_load_dwordx2 v[204:205],v241,s[12:15],s28 offen offset:0
M v[100:103],a[244:247],a[216:219],v[100:103]
v_cvt_pk_bf16_f32 v0,v0,v1
v_cvt_pk_bf16_f32 v1,v2,v3
M v[104:107],a[244:247],a[220:223],v[104:107]
v_cvt_pk_bf16_f32 v4,v4,v5
v_cvt_pk_bf16_f32 v5,v6,v7
M v[108:111],a[244:247],a[192:195],v[108:111]
s_waitcnt lgkmcnt(0)
s_barrier
buffer_load_dwordx2 v[214:215],v241,s[16:19],s28 offen offset:1536
M v[112:115],a[244:247],a[196:199],v[112:115]
ds_read_b128 a[48:51],v247 offset:60928
ds_read_b128 a[52:55],v247 offset:65024
M v[116:119],a[244:247],a[200:203],v[116:119]
ds_read_b128 a[56:59],v247 offset:34816
ds_read_b128 a[60:63],v247 offset:38912
M v[120:123],a[244:247],a[204:207],v[120:123]
buffer_load_dwordx2 v[206:207],v241,s[8:11],s28 offen offset:0
M v[124:127],a[244:247],a[208:211],v[124:127]
s_waitcnt vmcnt(29)
ds_write2st64_b64 v249,v[0:1],v[4:5] offset0:34 offset1:38
M v[128:131],a[108:111],a[212:215],v[128:131]
ds_read_b128 a[212:215],v245 offset:2048
v_cvt_pk_bf16_f32 v8,v8,v9
M v[132:135],a[108:111],a[216:219],v[132:135]
v_cvt_pk_bf16_f32 v9,v10,v11
v_cvt_pk_bf16_f32 v12,v12,v13
M v[136:139],a[108:111],a[220:223],v[136:139]
buffer_load_dwordx2 v[208:209],v241,s[8:11],s28 offen offset:384
M v[140:143],a[108:111],a[192:195],v[140:143]
v_cvt_pk_bf16_f32 v13,v14,v15
M v[144:147],a[108:111],a[196:199],v[144:147]
ds_write2st64_b64 v249,v[8:9],v[12:13] offset0:42 offset1:46
M v[148:151],a[108:111],a[200:203],v[148:151]
buffer_load_dwordx2 v[210:211],v241,s[8:11],s28 offen offset:768
M v[152:155],a[108:111],a[204:207],v[152:155]
v_cvt_pk_bf16_f32 v16,v16,v17
v_cvt_pk_bf16_f32 v17,v18,v19
M v[156:159],a[108:111],a[208:211],v[156:159]
s_waitcnt vmcnt(30)
v_cvt_pk_bf16_f32 v20,v20,v21
v_cvt_pk_bf16_f32 v21,v22,v23
M v[96:99],a[248:251],a[216:219],v[96:99]
s_add_u32 s34,s32,0
ds_write2st64_b64 v249,v[16:17],v[20:21] offset0:51 offset1:55
M v[100:103],a[248:251],a[220:223],v[100:103]
buffer_load_dwordx2 v[212:213],v241,s[8:11],s28 offen offset:1152
M v[104:107],a[248:251],a[192:195],v[104:107]
v_cvt_pk_bf16_f32 v24,v24,v25
v_cvt_pk_bf16_f32 v25,v26,v27
M v[108:111],a[248:251],a[196:199],v[108:111]
v_cvt_pk_bf16_f32 v28,v28,v29
v_cvt_pk_bf16_f32 v29,v30,v31
M v[112:115],a[248:251],a[200:203],v[112:115]
buffer_load_dwordx4 a[236:239],v247,s[20:23],s47 offen offset:1024 sc1
M v[116:119],a[248:251],a[204:207],v[116:119]
ds_write2st64_b64 v249,v[24:25],v[28:29] offset0:59 offset1:63
M v[120:123],a[248:251],a[208:211],v[120:123]
s_waitcnt lgkmcnt(3)
v_add_u32 v245,0x15400,v245
v_add_u32 v246,0x15400,v246
M v[124:127],a[248:251],a[212:215],v[124:127]
s_waitcnt vmcnt(30)
buffer_load_dwordx4 a[148:151],v247,s[20:23],s46 offen offset:2048 sc1
M v[128:131],a[96:99],a[216:219],v[128:131]
ds_read_b128 a[216:219],v245 offset:0
v_accvgpr_read_b32 v234,a64
M v[132:135],a[96:99],a[220:223],v[132:135]
ds_read_b128 a[220:223],v246 offset:0
v_accvgpr_read_b32 v228,a160
M v[136:139],a[96:99],a[192:195],v[136:139]
ds_read_b128 a[192:195],v245 offset:512
v_add_f32 v230,v234,v228
M v[140:143],a[96:99],a[196:199],v[140:143]
buffer_store_dwordx4 a[32:35],v248,s[24:27],s34 offen offset:512 nt
M v[144:147],a[96:99],a[200:203],v[144:147]
ds_read_b128 a[196:199],v246 offset:512
ds_read_b128 a[200:203],v245 offset:1024
M v[148:151],a[96:99],a[204:207],v[148:151]
ds_read_b128 a[204:207],v246 offset:1024
v_sub_f32 v234,v234,v228
M v[152:155],a[96:99],a[208:211],v[152:155]
buffer_load_dwordx4 a[104:107],v247,s[20:23],s47 offen offset:2048 sc1
M v[156:159],a[96:99],a[212:215],v[156:159]
s_waitcnt vmcnt(32) lgkmcnt(5)
s_add_u32 s46,s80,46080
ds_read_b128 a[208:211],v245 offset:1536
ds_read_b128 a[212:215],v246 offset:1536
M v[96:99],a[128:131],a[216:219],v[96:99]
s_waitcnt lgkmcnt(6)
v_add_f32 v228,v64,v160
v_sub_f32 v160,v64,v160
M v[100:103],a[128:131],a[220:223],v[100:103]
s_waitcnt lgkmcnt(5)
v_add_f32 v64,v230,v228
v_fmac_f32 v230,4.0,v228
M v[104:107],a[128:131],a[192:195],v[104:107]
s_waitcnt lgkmcnt(4)
s_add_u32 s34,s32,196608
buffer_load_dwordx4 a[120:123],v247,s[20:23],s46 offen offset:0 sc1
M v[108:111],a[128:131],a[196:199],v[108:111]
s_waitcnt lgkmcnt(3)
s_add_u32 s47,s80,49152
v_fma_f32 v228,2.0,v160,v234
v_fma_f32 v160,s40,v160,v234
M v[112:115],a[128:131],a[200:203],v[112:115]
s_waitcnt lgkmcnt(2)
v_accvgpr_read_b32 v234,a65
v_accvgpr_read_b32 v233,a161
M v[116:119],a[128:131],a[204:207],v[116:119]
s_waitcnt lgkmcnt(1)
v_add_f32 v232,v234,v233
v_sub_f32 v234,v234,v233
M v[120:123],a[128:131],a[208:211],v[120:123]
s_waitcnt lgkmcnt(0)
buffer_load_dwordx4 a[152:155],v247,s[20:23],s47 offen offset:0 sc1
M v[124:127],a[128:131],a[212:215],v[124:127]
s_waitcnt vmcnt(33)
v_add_f32 v233,v65,v161
v_sub_f32 v161,v65,v161
M v[128:131],a[252:255],a[216:219],v[128:131]
ds_read_b128 a[216:219],v246 offset:2048
v_add_f32 v65,v232,v233
M v[132:135],a[252:255],a[220:223],v[132:135]
v_fmac_f32 v232,4.0,v233
v_fma_f32 v233,2.0,v161,v234
M v[136:139],a[252:255],a[192:195],v[136:139]
buffer_store_dwordx4 a[36:39],v248,s[24:27],s34 offen offset:512 nt
M v[140:143],a[252:255],a[196:199],v[140:143]
v_fma_f32 v161,s40,v161,v234
v_cvt_pk_bf16_f32 v228,v228,v233
M v[144:147],a[252:255],a[200:203],v[144:147]
v_cvt_pk_bf16_f32 v230,v230,v232
v_accvgpr_read_b32 v234,a66
M v[148:151],a[252:255],a[204:207],v[148:151]
buffer_load_dwordx4 a[124:127],v247,s[20:23],s46 offen offset:1024 sc1
M v[152:155],a[252:255],a[208:211],v[152:155]
v_accvgpr_read_b32 v229,a162
v_add_f32 v231,v234,v229
M v[156:159],a[252:255],a[212:215],v[156:159]
s_waitcnt vmcnt(33)
v_sub_f32 v234,v234,v229
v_add_f32 v229,v66,v162
M v[96:99],a[224:227],a[220:223],v[96:99]
v_sub_f32 v162,v66,v162
v_add_f32 v66,v231,v229
M v[100:103],a[224:227],a[192:195],v[100:103]
v_fmac_f32 v231,4.0,v229
v_fma_f32 v229,2.0,v162,v234
M v[104:107],a[224:227],a[196:199],v[104:107]
buffer_load_dwordx4 a[156:159],v247,s[20:23],s47 offen offset:1024 sc1
M v[108:111],a[224:227],a[200:203],v[108:111]
v_fma_f32 v162,s40,v162,v234
v_accvgpr_read_b32 v234,a67
M v[112:115],a[224:227],a[204:207],v[112:115]
s_add_u32 s34,s32,393216
v_accvgpr_read_b32 v233,a163
v_add_f32 v232,v234,v233
M v[116:119],a[224:227],a[208:211],v[116:119]
buffer_store_dwordx4 a[40:43],v248,s[24:27],s34 offen offset:512 nt
M v[120:123],a[224:227],a[212:215],v[120:123]
s_waitcnt lgkmcnt(0)
v_sub_f32 v234,v234,v233
v_add_f32 v233,v67,v163
M v[124:127],a[224:227],a[216:219],v[124:127]
s_waitcnt vmcnt(34)
v_sub_f32 v163,v67,v163
v_add_f32 v67,v232,v233
M v[128:131],a[132:135],a[220:223],v[128:131]
ds_read_b128 a[220:223],v245 offset:2048
v_fmac_f32 v232,4.0,v233
M v[132:135],a[132:135],a[192:195],v[132:135]
v_fma_f32 v233,2.0,v163,v234
v_fma_f32 v163,s40,v163,v234
M v[136:139],a[132:135],a[196:199],v[136:139]
buffer_load_dwordx4 a[240:243],v247,s[20:23],s46 offen offset:2048 sc1
M v[140:143],a[132:135],a[200:203],v[140:143]
v_cvt_pk_bf16_f32 v229,v229,v233
v_cvt_pk_bf16_f32 v231,v231,v232
M v[144:147],a[132:135],a[204:207],v[144:147]
ds_write2st64_b64 v249,v[228:229],v[230:231] offset0:102 offset1:106
M v[148:151],a[132:135],a[208:211],v[148:151]
v_accvgpr_read_b32 v234,a68
v_accvgpr_read_b32 v228,a164
M v[152:155],a[132:135],a[212:215],v[152:155]
v_add_f32 v230,v234,v228
v_sub_f32 v234,v234,v228
M v[156:159],a[132:135],a[216:219],v[156:159]
s_waitcnt vmcnt(33)
v_add_f32 v228,v68,v164
v_sub_f32 v164,v68,v164
M v[96:99],a[112:115],a[192:195],v[96:99]
v_add_f32 v68,v230,v228
v_fmac_f32 v230,4.0,v228
M v[100:103],a[112:115],a[196:199],v[100:103]
v_fma_f32 v228,2.0,v164,v234
v_fma_f32 v164,s40,v164,v234
M v[104:107],a[112:115],a[200:203],v[104:107]
buffer_load_dwordx4 a[244:247],v247,s[20:23],s47 offen offset:2048 sc1
M v[108:111],a[112:115],a[204:207],v[108:111]
v_accvgpr_read_b32 v234,a69
v_accvgpr_read_b32 v233,a165
M v[112:115],a[112:115],a[208:211],v[112:115]
s_add_u32 s46,s81,46080
v_add_f32 v232,v234,v233
v_sub_f32 v234,v234,v233
M v[116:119],a[112:115],a[212:215],v[116:119]
v_add_f32 v233,v69,v165
v_sub_f32 v165,v69,v165
M v[120:123],a[112:115],a[216:219],v[120:123]
s_waitcnt lgkmcnt(1)
s_add_u32 s34,s32,589824
buffer_store_dwordx4 a[44:47],v248,s[24:27],s34 offen offset:512 nt
M v[124:127],a[112:115],a[220:223],v[124:127]
s_waitcnt vmcnt(34)
v_add_f32 v69,v232,v233
v_fmac_f32 v232,4.0,v233
M v[128:131],a[136:139],a[192:195],v[128:131]
ds_read_b128 a[192:195],v245 offset:17408
v_fma_f32 v233,2.0,v165,v234
M v[132:135],a[136:139],a[196:199],v[132:135]
ds_read_b128 a[196:199],v246 offset:17408
v_fma_f32 v165,s40,v165,v234
M v[136:139],a[136:139],a[200:203],v[136:139]
buffer_load_dwordx4 a[108:111],v247,s[20:23],s46 offen offset:0 sc1
M v[140:143],a[136:139],a[204:207],v[140:143]
ds_read_b128 a[200:203],v245 offset:17920
ds_read_b128 a[204:207],v246 offset:17920
M v[144:147],a[136:139],a[208:211],v[144:147]
s_add_u32 s47,s81,49152
ds_read_b128 a[208:211],v245 offset:18432
v_cvt_pk_bf16_f32 v228,v228,v233
M v[148:151],a[136:139],a[212:215],v[148:151]
ds_read_b128 a[212:215],v246 offset:18432
v_cvt_pk_bf16_f32 v230,v230,v232
M v[152:155],a[136:139],a[216:219],v[152:155]
ds_read_b128 a[216:219],v245 offset:18944
v_accvgpr_read_b32 v234,a70
M v[156:159],a[136:139],a[220:223],v[156:159]
s_waitcnt vmcnt(33) lgkmcnt(6)
ds_read_b128 a[220:223],v246 offset:18944
v_accvgpr_read_b32 v229,a166
M v[96:99],v[216:219],a[192:195],v[96:99]
s_waitcnt lgkmcnt(6)
v_add_f32 v231,v234,v229
v_sub_f32 v234,v234,v229
M v[100:103],v[216:219],a[196:199],v[100:103]
s_waitcnt lgkmcnt(5)
v_add_f32 v229,v70,v166
v_sub_f32 v166,v70,v166
v_add_f32 v70,v231,v229
M v[104:107],v[216:219],a[200:203],v[104:107]
s_waitcnt lgkmcnt(4)
buffer_load_dwordx4 a[248:251],v247,s[20:23],s47 offen offset:0 sc1
v_fmac_f32 v231,4.0,v229
M v[108:111],v[216:219],a[204:207],v[108:111]
s_waitcnt lgkmcnt(3)
v_fma_f32 v229,2.0,v166,v234
v_fma_f32 v166,s40,v166,v234
v_accvgpr_read_b32 v234,a71
M v[112:115],v[216:219],a[208:211],v[112:115]
s_waitcnt lgkmcnt(2)
v_accvgpr_read_b32 v233,a167
v_add_f32 v232,v234,v233
v_sub_f32 v234,v234,v233
M v[116:119],v[216:219],a[212:215],v[116:119]
s_waitcnt lgkmcnt(1)
v_add_f32 v233,v71,v167
v_sub_f32 v167,v71,v167
v_add_f32 v71,v232,v233
M v[120:123],v[216:219],a[216:219],v[120:123]
s_waitcnt lgkmcnt(0)
v_fmac_f32 v232,4.0,v233
v_fma_f32 v233,2.0,v167,v234
v_fma_f32 v167,s40,v167,v234
M v[124:127],v[216:219],a[220:223],v[124:127]
s_waitcnt vmcnt(33)
v_cvt_pk_bf16_f32 v229,v229,v233
v_cvt_pk_bf16_f32 v231,v231,v232
M v[128:131],v[220:223],a[192:195],v[128:131]
s_add_u32 s34,s32,786432
buffer_store_dwordx4 a[48:51],v248,s[24:27],s34 offen offset:512 nt
M v[132:135],v[220:223],a[196:199],v[132:135]
ds_read_b128 a[192:195],v246 offset:19456
ds_write2st64_b64 v249,v[228:229],v[230:231] offset0:110 offset1:114
M v[136:139],v[220:223],a[200:203],v[136:139]
buffer_load_dwordx4 a[96:99],v247,s[20:23],s46 offen offset:1024 sc1
M v[140:143],v[220:223],a[204:207],v[140:143]
v_accvgpr_read_b32 v234,a72
v_accvgpr_read_b32 v228,a168
M v[144:147],v[220:223],a[208:211],v[144:147]
v_add_f32 v230,v234,v228
v_sub_f32 v234,v234,v228
M v[148:151],v[220:223],a[212:215],v[148:151]
v_add_f32 v228,v72,v168
v_sub_f32 v168,v72,v168
M v[152:155],v[220:223],a[216:219],v[152:155]
s_waitcnt lgkmcnt(0)
s_barrier
ds_read_b128 v[0:3],v247 offset:17408
M v[156:159],v[220:223],a[220:223],v[156:159]
s_waitcnt vmcnt(33)
ds_read_b128 v[8:11],v247 offset:21504
ds_read_b128 v[16:19],v247 offset:26112
M v[96:99],a[140:143],a[196:199],v[96:99]
ds_read_b128 v[24:27],v247 offset:30208
ds_read_b128 a[64:67],v247 offset:52224
M v[100:103],a[140:143],a[200:203],v[100:103]
ds_read_b128 a[68:71],v247 offset:56320
v_add_f32 v72,v230,v228
v_fmac_f32 v230,4.0,v228
M v[104:107],a[140:143],a[204:207],v[104:107]
buffer_load_dwordx4 a[128:131],v247,s[20:23],s47 offen offset:1024 sc1
v_fma_f32 v228,2.0,v168,v234
M v[108:111],a[140:143],a[208:211],v[108:111]
v_fma_f32 v168,s40,v168,v234
v_accvgpr_read_b32 v234,a73
v_accvgpr_read_b32 v233,a169
M v[112:115],a[140:143],a[212:215],v[112:115]
v_add_f32 v232,v234,v233
v_sub_f32 v234,v234,v233
M v[116:119],a[140:143],a[216:219],v[116:119]
v_add_f32 v233,v73,v169
v_sub_f32 v169,v73,v169
v_add_f32 v73,v232,v233
M v[120:123],a[140:143],a[220:223],v[120:123]
v_fmac_f32 v232,4.0,v233
v_fma_f32 v233,2.0,v169,v234
v_fma_f32 v169,s40,v169,v234
M v[124:127],a[140:143],a[192:195],v[124:127]
s_waitcnt vmcnt(33)
v_cvt_pk_bf16_f32 v228,v228,v233
v_cvt_pk_bf16_f32 v230,v230,v232
v_accvgpr_read_b32 v234,a74
M v[128:131],a[100:103],a[196:199],v[128:131]
ds_read_b128 a[196:199],v245 offset:19456
v_accvgpr_read_b32 v229,a170
v_add_f32 v231,v234,v229
M v[132:135],a[100:103],a[200:203],v[132:135]
v_sub_f32 v234,v234,v229
v_add_f32 v229,v74,v170
v_sub_f32 v170,v74,v170
M v[136:139],a[100:103],a[204:207],v[136:139]
s_add_u32 s34,s32,983040
buffer_load_dwordx4 a[252:255],v247,s[20:23],s46 offen offset:2048 sc1
M v[140:143],a[100:103],a[208:211],v[140:143]
v_add_f32 v74,v231,v229
v_fmac_f32 v231,4.0,v229
v_fma_f32 v229,2.0,v170,v234
M v[144:147],a[100:103],a[212:215],v[144:147]
buffer_store_dwordx4 a[52:55],v248,s[24:27],s34 offen offset:512 nt
M v[148:151],a[100:103],a[216:219],v[148:151]
v_fma_f32 v170,s40,v170,v234
v_accvgpr_read_b32 v234,a75
M v[152:155],a[100:103],a[220:223],v[152:155]
v_accvgpr_read_b32 v233,a171
v_add_f32 v232,v234,v233
M v[156:159],a[100:103],a[192:195],v[156:159]
s_waitcnt vmcnt(34)
v_sub_f32 v234,v234,v233
v_add_f32 v233,v75,v171
M v[96:99],a[116:119],a[200:203],v[96:99]
v_sub_f32 v171,v75,v171
v_add_f32 v75,v232,v233
v_fmac_f32 v232,4.0,v233
M v[100:103],a[116:119],a[204:207],v[100:103]
v_fma_f32 v233,2.0,v171,v234
v_fma_f32 v171,s40,v171,v234
M v[104:107],a[116:119],a[208:211],v[104:107]
buffer_load_dwordx4 a[160:163],v247,s[20:23],s47 offen offset:2048 sc1
v_cvt_pk_bf16_f32 v229,v229,v233
M v[108:111],a[116:119],a[212:215],v[108:111]
v_cvt_pk_bf16_f32 v231,v231,v232
M v[112:115],a[116:119],a[216:219],v[112:115]
s_add_u32 s47,s76,3072
ds_write2st64_b64 v249,v[228:229],v[230:231] offset0:119 offset1:123
M v[116:119],a[116:119],a[220:223],v[116:119]
v_accvgpr_read_b32 v234,a76
v_accvgpr_read_b32 v228,a172
M v[120:123],a[116:119],a[192:195],v[120:123]
s_waitcnt lgkmcnt(1)
v_add_f32 v230,v234,v228
v_sub_f32 v234,v234,v228
v_add_f32 v228,v76,v172
M v[124:127],a[116:119],a[196:199],v[124:127]
s_waitcnt vmcnt(33)
v_sub_f32 v172,v76,v172
v_add_f32 v76,v230,v228
v_fmac_f32 v230,4.0,v228
M v[128:131],v[224:227],a[200:203],v[128:131]
ds_read_b128 a[200:203],v245 offset:34816
v_fma_f32 v228,2.0,v172,v234
M v[132:135],v[224:227],a[204:207],v[132:135]
ds_read_b128 a[204:207],v246 offset:34816
v_fma_f32 v172,s40,v172,v234
v_accvgpr_read_b32 v234,a77
M v[136:139],v[224:227],a[208:211],v[136:139]
buffer_load_dwordx4 a[224:227],v247,s[20:23],s47 offen offset:0 sc1
ds_read_b128 a[208:211],v245 offset:35328
M v[140:143],v[224:227],a[212:215],v[140:143]
ds_read_b128 a[212:215],v246 offset:35328
v_accvgpr_read_b32 v233,a173
v_add_f32 v232,v234,v233
M v[144:147],v[224:227],a[216:219],v[144:147]
s_add_u32 s48,s76,6144
ds_read_b128 a[216:219],v245 offset:35840
s_add_u32 s34,s32,1179648
v_sub_f32 v234,v234,v233
M v[148:151],v[224:227],a[220:223],v[148:151]
buffer_store_dwordx4 a[56:59],v248,s[24:27],s34 offen offset:512 nt
M v[152:155],v[224:227],a[192:195],v[152:155]
ds_read_b128 a[220:223],v246 offset:35840
ds_read_b128 a[192:195],v245 offset:36352
M v[156:159],v[224:227],a[196:199],v[156:159]
s_waitcnt vmcnt(34) lgkmcnt(6)
ds_read_b128 a[196:199],v246 offset:36352
v_add_f32 v233,v77,v173
M v[96:99],a[228:231],a[200:203],v[96:99]
s_waitcnt lgkmcnt(6)
v_sub_f32 v173,v77,v173
v_add_f32 v77,v232,v233
M v[100:103],a[228:231],a[204:207],v[100:103]
s_waitcnt lgkmcnt(5)
v_fmac_f32 v232,4.0,v233
v_fma_f32 v233,2.0,v173,v234
M v[104:107],a[228:231],a[208:211],v[104:107]
s_waitcnt lgkmcnt(4)
buffer_load_dwordx4 a[132:135],v247,s[20:23],s48 offen offset:0 sc1
M v[108:111],a[228:231],a[212:215],v[108:111]
s_waitcnt lgkmcnt(3)
v_fma_f32 v173,s40,v173,v234
v_cvt_pk_bf16_f32 v228,v228,v233
M v[112:115],a[228:231],a[216:219],v[112:115]
s_waitcnt lgkmcnt(2)
v_cvt_pk_bf16_f32 v230,v230,v232
v_accvgpr_read_b32 v234,a78
v_accvgpr_read_b32 v229,a174
M v[116:119],a[228:231],a[220:223],v[116:119]
s_waitcnt lgkmcnt(1)
v_add_f32 v231,v234,v229
v_sub_f32 v234,v234,v229
M v[120:123],a[228:231],a[192:195],v[120:123]
s_waitcnt lgkmcnt(0)
v_add_f32 v229,v78,v174
v_sub_f32 v174,v78,v174
M v[124:127],a[228:231],a[196:199],v[124:127]
s_waitcnt vmcnt(33)
v_add_f32 v78,v231,v229
v_fmac_f32 v231,4.0,v229
v_fma_f32 v229,2.0,v174,v234
M v[128:131],a[232:235],a[200:203],v[128:131]
ds_read_b128 a[200:203],v246 offset:36864
v_fma_f32 v174,s40,v174,v234
M v[132:135],a[232:235],a[204:207],v[132:135]
v_accvgpr_read_b32 v234,a79
v_accvgpr_read_b32 v233,a175
v_add_f32 v232,v234,v233
M v[136:139],a[232:235],a[208:211],v[136:139]
buffer_load_dwordx4 a[112:115],v247,s[20:23],s47 offen offset:1024 sc1
M v[140:143],a[232:235],a[212:215],v[140:143]
v_sub_f32 v234,v234,v233
v_add_f32 v233,v79,v175
v_sub_f32 v175,v79,v175
M v[144:147],a[232:235],a[216:219],v[144:147]
v_add_f32 v79,v232,v233
v_fmac_f32 v232,4.0,v233
M v[148:151],a[232:235],a[220:223],v[148:151]
v_fma_f32 v233,2.0,v175,v234
v_fma_f32 v175,s40,v175,v234
v_cvt_pk_bf16_f32 v229,v229,v233
M v[152:155],a[232:235],a[192:195],v[152:155]
s_add_u32 s34,s32,1376256
buffer_store_dwordx4 a[60:63],v248,s[24:27],s34 offen offset:512 nt
M v[156:159],a[232:235],a[196:199],v[156:159]
s_waitcnt vmcnt(33)
v_cvt_pk_bf16_f32 v231,v231,v232
M v[96:99],a[144:147],a[204:207],v[96:99]
ds_write2st64_b64 v249,v[228:229],v[230:231] offset0:127 offset1:131
M v[100:103],a[144:147],a[208:211],v[100:103]
v_accvgpr_read_b32 v234,a80
v_accvgpr_read_b32 v228,a176
M v[104:107],a[144:147],a[212:215],v[104:107]
buffer_load_dwordx4 a[136:139],v247,s[20:23],s48 offen offset:1024 sc1
M v[108:111],a[144:147],a[216:219],v[108:111]
v_add_f32 v230,v234,v228
v_sub_f32 v234,v234,v228
M v[112:115],a[144:147],a[220:223],v[112:115]
v_add_f32 v228,v80,v176
v_sub_f32 v176,v80,v176
M v[116:119],a[144:147],a[192:195],v[116:119]
v_add_f32 v80,v230,v228
v_fmac_f32 v230,4.0,v228
M v[120:123],a[144:147],a[196:199],v[120:123]
s_waitcnt lgkmcnt(1)
v_fma_f32 v228,2.0,v176,v234
v_fma_f32 v176,s40,v176,v234
M v[124:127],a[144:147],a[200:203],v[124:127]
s_waitcnt vmcnt(26)
v_accvgpr_read_b32 v234,a81
v_accvgpr_read_b32 v233,a177
M v[128:131],a[236:239],a[204:207],v[128:131]
ds_read_b128 a[204:207],v245 offset:36864
v_add_f32 v232,v234,v233
M v[132:135],a[236:239],a[208:211],v[132:135]
v_sub_f32 v234,v234,v233
v_add_f32 v233,v81,v177
M v[136:139],a[236:239],a[212:215],v[136:139]
buffer_load_dwordx4 a[164:167],v247,s[20:23],s47 offen offset:2048 sc1
M v[140:143],a[236:239],a[216:219],v[140:143]
v_sub_f32 v177,v81,v177
v_add_f32 v81,v232,v233
M v[144:147],a[236:239],a[220:223],v[144:147]
v_fmac_f32 v232,4.0,v233
v_fma_f32 v233,2.0,v177,v234
M v[148:151],a[236:239],a[192:195],v[148:151]
v_fma_f32 v177,s40,v177,v234
v_cvt_pk_bf16_f32 v228,v228,v233
M v[152:155],a[236:239],a[196:199],v[152:155]
v_cvt_pk_bf16_f32 v230,v230,v232
v_accvgpr_read_b32 v234,a82
M v[156:159],a[236:239],a[200:203],v[156:159]
s_waitcnt vmcnt(26)
v_accvgpr_read_b32 v229,a178
v_add_f32 v231,v234,v229
v_sub_f32 v234,v234,v229
M v[96:99],a[148:151],a[208:211],v[96:99]
s_add_u32 s34,s33,0
buffer_store_dwordx4 v[0:3],v248,s[24:27],s34 offen offset:0 nt
M v[100:103],a[148:151],a[212:215],v[100:103]
v_add_f32 v229,v82,v178
v_sub_f32 v178,v82,v178
M v[104:107],a[148:151],a[216:219],v[104:107]
buffer_load_dwordx4 v[216:219],v247,s[20:23],s48 offen offset:2048 sc1
M v[108:111],a[148:151],a[220:223],v[108:111]
v_add_f32 v82,v231,v229
v_fmac_f32 v231,4.0,v229
M v[112:115],a[148:151],a[192:195],v[112:115]
s_add_u32 s47,s77,3072
v_fma_f32 v229,2.0,v178,v234
v_fma_f32 v178,s40,v178,v234
M v[116:119],a[148:151],a[196:199],v[116:119]
v_accvgpr_read_b32 v234,a83
v_accvgpr_read_b32 v233,a179
M v[120:123],a[148:151],a[200:203],v[120:123]
s_waitcnt lgkmcnt(0)
v_add_f32 v232,v234,v233
v_sub_f32 v234,v234,v233
M v[124:127],a[148:151],a[204:207],v[124:127]
s_waitcnt vmcnt(26)
v_add_f32 v233,v83,v179
v_sub_f32 v179,v83,v179
M v[128:131],a[104:107],a[208:211],v[128:131]
ds_read_b128 a[208:211],v245 offset:52224
v_add_f32 v83,v232,v233
M v[132:135],a[104:107],a[212:215],v[132:135]
ds_read_b128 a[212:215],v246 offset:52224
v_fmac_f32 v232,4.0,v233
M v[136:139],a[104:107],a[216:219],v[136:139]
buffer_load_dwordx4 v[220:223],v247,s[20:23],s47 offen offset:0 sc1
ds_read_b128 a[216:219],v245 offset:52736
M v[140:143],a[104:107],a[220:223],v[140:143]
ds_read_b128 a[220:223],v246 offset:52736
v_fma_f32 v233,2.0,v179,v234
M v[144:147],a[104:107],a[192:195],v[144:147]
s_add_u32 s48,s77,6144
ds_read_b128 a[192:195],v245 offset:53248
v_fma_f32 v179,s40,v179,v234
M v[148:151],a[104:107],a[196:199],v[148:151]
ds_read_b128 a[196:199],v246 offset:53248
v_cvt_pk_bf16_f32 v229,v229,v233
v_cvt_pk_bf16_f32 v231,v231,v232
M v[152:155],a[104:107],a[200:203],v[152:155]
ds_read_b128 a[200:203],v245 offset:53760
ds_write2st64_b64 v249,v[228:229],v[230:231] offset0:68 offset1:72
M v[156:159],a[104:107],a[204:207],v[156:159]
s_waitcnt vmcnt(26) lgkmcnt(7)
ds_read_b128 a[204:207],v246 offset:53760
v_accvgpr_read_b32 v234,a84
M v[96:99],a[120:123],a[208:211],v[96:99]
s_waitcnt lgkmcnt(7)
v_accvgpr_read_b32 v228,a180
v_add_f32 v230,v234,v228
M v[100:103],a[120:123],a[212:215],v[100:103]
s_waitcnt lgkmcnt(6)
v_sub_f32 v234,v234,v228
v_add_f32 v228,v84,v180
M v[104:107],a[120:123],a[216:219],v[104:107]
s_waitcnt lgkmcnt(5)
s_add_u32 s34,s33,393216
buffer_load_dwordx4 a[140:143],v247,s[20:23],s48 offen offset:0 sc1
M v[108:111],a[120:123],a[220:223],v[108:111]
s_waitcnt lgkmcnt(4)
v_sub_f32 v180,v84,v180
v_add_f32 v84,v230,v228
M v[112:115],a[120:123],a[192:195],v[112:115]
s_waitcnt lgkmcnt(3)
buffer_store_dwordx4 v[8:11],v248,s[24:27],s34 offen offset:0 nt
M v[116:119],a[120:123],a[196:199],v[116:119]
s_waitcnt lgkmcnt(2)
v_fmac_f32 v230,4.0,v228
v_fma_f32 v228,2.0,v180,v234
M v[120:123],a[120:123],a[200:203],v[120:123]
s_waitcnt lgkmcnt(0)
v_fma_f32 v180,s40,v180,v234
v_accvgpr_read_b32 v234,a85
M v[124:127],a[120:123],a[204:207],v[124:127]
s_waitcnt vmcnt(27)
v_accvgpr_read_b32 v233,a181
v_add_f32 v232,v234,v233
M v[128:131],a[152:155],a[208:211],v[128:131]
ds_read_b128 a[208:211],v246 offset:54272
v_sub_f32 v234,v234,v233
M v[132:135],a[152:155],a[212:215],v[132:135]
v_add_f32 v233,v85,v181
v_sub_f32 v181,v85,v181
M v[136:139],a[152:155],a[216:219],v[136:139]
buffer_load_dwordx4 a[100:103],v247,s[20:23],s47 offen offset:1024 sc1
M v[140:143],a[152:155],a[220:223],v[140:143]
v_add_f32 v85,v232,v233
v_fmac_f32 v232,4.0,v233
M v[144:147],a[152:155],a[192:195],v[144:147]
v_fma_f32 v233,2.0,v181,v234
v_fma_f32 v181,s40,v181,v234
M v[148:151],a[152:155],a[196:199],v[148:151]
v_cvt_pk_bf16_f32 v228,v228,v233
v_cvt_pk_bf16_f32 v230,v230,v232
M v[152:155],a[152:155],a[200:203],v[152:155]
v_accvgpr_read_b32 v234,a86
v_accvgpr_read_b32 v229,a182
M v[156:159],a[152:155],a[204:207],v[156:159]
s_waitcnt vmcnt(26)
v_add_f32 v231,v234,v229
v_sub_f32 v234,v234,v229
M v[96:99],a[124:127],a[212:215],v[96:99]
v_add_f32 v229,v86,v182
v_sub_f32 v182,v86,v182
M v[100:103],a[124:127],a[216:219],v[100:103]
v_add_f32 v86,v231,v229
v_fmac_f32 v231,4.0,v229
v_fma_f32 v229,2.0,v182,v234
M v[104:107],a[124:127],a[220:223],v[104:107]
buffer_load_dwordx4 a[168:171],v247,s[20:23],s48 offen offset:1024 sc1
M v[108:111],a[124:127],a[192:195],v[108:111]
v_fma_f32 v182,s40,v182,v234
v_accvgpr_read_b32 v234,a87
v_accvgpr_read_b32 v233,a183
M v[112:115],a[124:127],a[196:199],v[112:115]
s_add_u32 s34,s33,786432
buffer_store_dwordx4 v[16:19],v248,s[24:27],s34 offen offset:0 nt
M v[116:119],a[124:127],a[200:203],v[116:119]
v_add_f32 v232,v234,v233
v_sub_f32 v234,v234,v233
M v[120:123],a[124:127],a[204:207],v[120:123]
s_waitcnt lgkmcnt(0)
v_add_f32 v233,v87,v183
v_sub_f32 v183,v87,v183
M v[124:127],a[124:127],a[208:211],v[124:127]
s_waitcnt vmcnt(27)
v_add_f32 v87,v232,v233
v_fmac_f32 v232,4.0,v233
M v[128:131],a[156:159],a[212:215],v[128:131]
ds_read_b128 a[212:215],v245 offset:54272
v_fma_f32 v233,2.0,v183,v234
M v[132:135],a[156:159],a[216:219],v[132:135]
v_fma_f32 v183,s40,v183,v234
v_cvt_pk_bf16_f32 v229,v229,v233
M v[136:139],a[156:159],a[220:223],v[136:139]
buffer_load_dwordx4 a[116:119],v247,s[20:23],s47 offen offset:2048 sc1
M v[140:143],a[156:159],a[192:195],v[140:143]
v_cvt_pk_bf16_f32 v231,v231,v232
M v[144:147],a[156:159],a[196:199],v[144:147]
ds_write2st64_b64 v249,v[228:229],v[230:231] offset0:76 offset1:80
M v[148:151],a[156:159],a[200:203],v[148:151]
v_accvgpr_read_b32 v234,a88
v_accvgpr_read_b32 v228,a184
M v[152:155],a[156:159],a[204:207],v[152:155]
v_add_f32 v230,v234,v228
v_sub_f32 v234,v234,v228
M v[156:159],a[156:159],a[208:211],v[156:159]
s_waitcnt vmcnt(26)
v_add_f32 v228,v88,v184
v_sub_f32 v184,v88,v184
M v[96:99],a[240:243],a[216:219],v[96:99]
v_add_f32 v88,v230,v228
v_fmac_f32 v230,4.0,v228
M v[100:103],a[240:243],a[220:223],v[100:103]
v_fma_f32 v228,2.0,v184,v234
v_fma_f32 v184,s40,v184,v234
M v[104:107],a[240:243],a[192:195],v[104:107]
buffer_load_dwordx4 v[224:227],v247,s[20:23],s48 offen offset:2048 sc1
M v[108:111],a[240:243],a[196:199],v[108:111]
v_accvgpr_read_b32 v234,a89
v_accvgpr_read_b32 v233,a185
M v[112:115],a[240:243],a[200:203],v[112:115]
s_add_u32 s47,s78,3072
v_add_f32 v232,v234,v233
v_sub_f32 v234,v234,v233
M v[116:119],a[240:243],a[204:207],v[116:119]
v_add_u32 v245,0xffffbc00,v245
v_add_u32 v246,0xffffbc00,v246
v_add_f32 v233,v89,v185
M v[120:123],a[240:243],a[208:211],v[120:123]
s_waitcnt lgkmcnt(1)
s_add_u32 s34,s33,1179648
buffer_store_dwordx4 v[24:27],v248,s[24:27],s34 offen offset:0 nt
M v[124:127],a[240:243],a[212:215],v[124:127]
s_waitcnt vmcnt(27)
v_sub_f32 v185,v89,v185
v_add_f32 v89,v232,v233
M v[128:131],a[244:247],a[216:219],v[128:131]
ds_read_b128 a[216:219],v245 offset:0
v_fmac_f32 v232,4.0,v233
M v[132:135],a[244:247],a[220:223],v[132:135]
ds_read_b128 a[220:223],v246 offset:0
v_fma_f32 v233,2.0,v185,v234
M v[136:139],a[244:247],a[192:195],v[136:139]
buffer_load_dwordx4 a[228:231],v247,s[20:23],s47 offen offset:0 sc1
M v[140:143],a[244:247],a[196:199],v[140:143]
ds_read_b128 a[192:195],v245 offset:512
ds_read_b128 a[196:199],v246 offset:512
M v[144:147],a[244:247],a[200:203],v[144:147]
s_add_u32 s48,s78,6144
ds_read_b128 a[200:203],v245 offset:1024
v_fma_f32 v185,s40,v185,v234
M v[148:151],a[244:247],a[204:207],v[148:151]
ds_read_b128 a[204:207],v246 offset:1024
v_cvt_pk_bf16_f32 v228,v228,v233
M v[152:155],a[244:247],a[208:211],v[152:155]
ds_read_b128 a[208:211],v245 offset:1536
v_cvt_pk_bf16_f32 v230,v230,v232
M v[156:159],a[244:247],a[212:215],v[156:159]
s_waitcnt vmcnt(26) lgkmcnt(6)
ds_read_b128 a[212:215],v246 offset:1536
v_accvgpr_read_b32 v234,a90
M v[96:99],a[108:111],a[216:219],v[96:99]
s_waitcnt lgkmcnt(6)
v_accvgpr_read_b32 v229,a186
v_add_f32 v231,v234,v229
v_sub_f32 v234,v234,v229
M v[100:103],a[108:111],a[220:223],v[100:103]
s_waitcnt lgkmcnt(5)
v_add_f32 v229,v90,v186
v_sub_f32 v186,v90,v186
M v[104:107],a[108:111],a[192:195],v[104:107]
s_waitcnt lgkmcnt(4)
buffer_load_dwordx4 a[172:175],v247,s[20:23],s48 offen offset:0 sc1
v_add_f32 v90,v231,v229
M v[108:111],a[108:111],a[196:199],v[108:111]
s_waitcnt lgkmcnt(3)
v_fmac_f32 v231,4.0,v229
v_fma_f32 v229,2.0,v186,v234
M v[112:115],a[108:111],a[200:203],v[112:115]
s_waitcnt lgkmcnt(2)
v_fma_f32 v186,s40,v186,v234
v_accvgpr_read_b32 v234,a91
M v[116:119],a[108:111],a[204:207],v[116:119]
s_waitcnt lgkmcnt(1)
v_accvgpr_read_b32 v233,a187
v_add_f32 v232,v234,v233
v_sub_f32 v234,v234,v233
M v[120:123],a[108:111],a[208:211],v[120:123]
s_waitcnt lgkmcnt(0)
v_add_f32 v233,v91,v187
v_sub_f32 v187,v91,v187
M v[124:127],a[108:111],a[212:215],v[124:127]
s_waitcnt vmcnt(26)
v_add_f32 v91,v232,v233
v_fmac_f32 v232,4.0,v233
v_fma_f32 v233,2.0,v187,v234
M v[128:131],a[248:251],a[216:219],v[128:131]
s_add_u32 s34,s32,0
buffer_store_dwordx4 a[64:67],v248,s[24:27],s34 offen offset:640 nt
M v[132:135],a[248:251],a[220:223],v[132:135]
ds_read_b128 a[216:219],v246 offset:2048
v_fma_f32 v187,s40,v187,v234
M v[136:139],a[248:251],a[192:195],v[136:139]
buffer_load_dwordx4 a[232:235],v247,s[20:23],s47 offen offset:1024 sc1
M v[140:143],a[248:251],a[196:199],v[140:143]
v_cvt_pk_bf16_f32 v229,v229,v233
v_cvt_pk_bf16_f32 v231,v231,v232
M v[144:147],a[248:251],a[200:203],v[144:147]
ds_write2st64_b64 v249,v[228:229],v[230:231] offset0:85 offset1:89
M v[148:151],a[248:251],a[204:207],v[148:151]
v_accvgpr_read_b32 v234,a92
v_accvgpr_read_b32 v228,a188
M v[152:155],a[248:251],a[208:211],v[152:155]
v_add_f32 v230,v234,v228
v_sub_f32 v234,v234,v228
M v[156:159],a[248:251],a[212:215],v[156:159]
s_waitcnt vmcnt(26)
v_add_f32 v228,v92,v188
v_sub_f32 v188,v92,v188
M v[96:99],a[96:99],a[220:223],v[96:99]
v_add_f32 v92,v230,v228
v_fmac_f32 v230,4.0,v228
M v[100:103],a[96:99],a[192:195],v[100:103]
v_fma_f32 v228,2.0,v188,v234
v_fma_f32 v188,s40,v188,v234
M v[104:107],a[96:99],a[196:199],v[104:107]
buffer_load_dwordx4 a[144:147],v247,s[20:23],s48 offen offset:1024 sc1
M v[108:111],a[96:99],a[200:203],v[108:111]
v_accvgpr_read_b32 v234,a93
v_accvgpr_read_b32 v233,a189
M v[112:115],a[96:99],a[204:207],v[112:115]
v_add_f32 v232,v234,v233
v_sub_f32 v234,v234,v233
M v[116:119],a[96:99],a[208:211],v[116:119]
v_add_f32 v233,v93,v189
v_sub_f32 v189,v93,v189
M v[120:123],a[96:99],a[212:215],v[120:123]
s_waitcnt lgkmcnt(1)
v_add_f32 v93,v232,v233
v_fmac_f32 v232,4.0,v233
M v[124:127],a[96:99],a[216:219],v[124:127]
s_waitcnt vmcnt(26)
v_fma_f32 v233,2.0,v189,v234
v_fma_f32 v189,s40,v189,v234
M v[128:131],a[128:131],a[220:223],v[128:131]
ds_read_b128 a[220:223],v245 offset:2048
v_cvt_pk_bf16_f32 v228,v228,v233
M v[132:135],a[128:131],a[192:195],v[132:135]
v_cvt_pk_bf16_f32 v230,v230,v232
v_accvgpr_read_b32 v234,a94
v_accvgpr_read_b32 v229,a190
M v[136:139],a[128:131],a[196:199],v[136:139]
s_add_u32 s34,s32,196608
buffer_load_dwordx4 a[236:239],v247,s[20:23],s47 offen offset:2048 sc1
M v[140:143],a[128:131],a[200:203],v[140:143]
v_add_f32 v231,v234,v229
v_sub_f32 v234,v234,v229
v_add_f32 v229,v94,v190
M v[144:147],a[128:131],a[204:207],v[144:147]
buffer_store_dwordx4 a[68:71],v248,s[24:27],s34 offen offset:640 nt
M v[148:151],a[128:131],a[208:211],v[148:151]
v_sub_f32 v190,v94,v190
v_add_f32 v94,v231,v229
M v[152:155],a[128:131],a[212:215],v[152:155]
v_fmac_f32 v231,4.0,v229
v_fma_f32 v229,2.0,v190,v234
M v[156:159],a[128:131],a[216:219],v[156:159]
s_waitcnt vmcnt(27)
v_fma_f32 v190,s40,v190,v234
v_accvgpr_read_b32 v234,a95
M v[96:99],a[252:255],a[192:195],v[96:99]
v_accvgpr_read_b32 v233,a191
v_add_f32 v232,v234,v233
M v[100:103],a[252:255],a[196:199],v[100:103]
v_sub_f32 v234,v234,v233
v_add_f32 v233,v95,v191
M v[104:107],a[252:255],a[200:203],v[104:107]
buffer_load_dwordx4 a[176:179],v247,s[20:23],s48 offen offset:2048 sc1
M v[108:111],a[252:255],a[204:207],v[108:111]
v_sub_f32 v191,v95,v191
v_add_f32 v95,v232,v233
M v[112:115],a[252:255],a[208:211],v[112:115]
s_add_u32 s47,s79,3072
v_fmac_f32 v232,4.0,v233
v_fma_f32 v233,2.0,v191,v234
M v[116:119],a[252:255],a[212:215],v[116:119]
v_add_u32 v245,0xfffece00,v245
v_add_u32 v246,0xfffece00,v246
M v[120:123],a[252:255],a[216:219],v[120:123]
s_waitcnt lgkmcnt(0)
v_fma_f32 v191,s40,v191,v234
v_cvt_pk_bf16_f32 v229,v229,v233
v_cvt_pk_bf16_f32 v231,v231,v232
M v[124:127],a[252:255],a[220:223],v[124:127]
s_waitcnt vmcnt(26)
ds_write2st64_b64 v249,v[228:229],v[230:231] offset0:93 offset1:97
M v[128:131],a[160:163],a[192:195],v[128:131]
ds_read_b128 a[192:195],v245 offset:0
v_cvt_pk_bf16_f32 v96,v96,v97
M v[132:135],a[160:163],a[196:199],v[132:135]
ds_read_b128 a[196:199],v246 offset:0
v_cvt_pk_bf16_f32 v97,v98,v99
M v[136:139],a[160:163],a[200:203],v[136:139]
buffer_load_dwordx4 a[148:151],v247,s[20:23],s47 offen offset:0 sc1
M v[140:143],a[160:163],a[204:207],v[140:143]
ds_read_b128 a[200:203],v245 offset:512
ds_read_b128 a[204:207],v246 offset:512
M v[144:147],a[160:163],a[208:211],v[144:147]
s_add_u32 s48,s79,6144
ds_read_b128 a[208:211],v245 offset:1024
v_cvt_pk_bf16_f32 v100,v100,v101
M v[148:151],a[160:163],a[212:215],v[148:151]
ds_read_b128 a[212:215],v246 offset:1024
v_cvt_pk_bf16_f32 v101,v102,v103
M v[152:155],a[160:163],a[216:219],v[152:155]
s_waitcnt lgkmcnt(6)
s_barrier
ds_read_b128 a[72:75],v247 offset:60928
M v[156:159],a[160:163],a[220:223],v[156:159]
s_waitcnt vmcnt(26) lgkmcnt(6)
ds_read_b128 a[76:79],v247 offset:65024
ds_read_b128 a[80:83],v247 offset:34816
ds_read_b128 a[84:87],v247 offset:38912
M v[32:35],a[224:227],a[192:195],v[32:35]
s_waitcnt lgkmcnt(8)
ds_read_b128 a[88:91],v247 offset:43520
ds_read_b128 a[92:95],v247 offset:47616
M v[36:39],a[224:227],a[196:199],v[36:39]
s_waitcnt lgkmcnt(9)
ds_read_b128 a[216:219],v245 offset:1536
ds_read_b128 a[220:223],v246 offset:1536
v_add_u32 v4,69632,v247
M v[40:43],a[224:227],a[200:203],v[40:43]
s_waitcnt lgkmcnt(10)
buffer_load_dwordx4 a[104:107],v247,s[20:23],s48 offen offset:0 sc1
M v[44:47],a[224:227],a[204:207],v[44:47]
s_waitcnt lgkmcnt(9)
s_add_u32 s34,s32,393216
ds_write2st64_b64 v249,v[96:97],v[100:101] offset0:34 offset1:38
M v[48:51],a[224:227],a[208:211],v[48:51]
s_waitcnt lgkmcnt(8)
buffer_store_dwordx4 a[72:75],v248,s[24:27],s34 offen offset:640 nt
M v[52:55],a[224:227],a[212:215],v[52:55]
s_waitcnt lgkmcnt(2)
v_cvt_pk_bf16_f32 v104,v104,v105
v_cvt_pk_bf16_f32 v105,v106,v107
M v[56:59],a[224:227],a[216:219],v[56:59]
s_waitcnt lgkmcnt(1)
v_cvt_pk_bf16_f32 v108,v108,v109
v_cvt_pk_bf16_f32 v109,v110,v111
M v[60:63],a[224:227],a[220:223],v[60:63]
s_waitcnt vmcnt(26)
global_load_dword v251,v252,s[82:83]
M v[64:67],a[132:135],a[192:195],v[64:67]
ds_read_b128 a[192:195],v246 offset:2048
ds_write2st64_b64 v249,v[104:105],v[108:109] offset0:42 offset1:46
M v[68:71],a[132:135],a[196:199],v[68:71]
v_cvt_pk_bf16_f32 v112,v112,v113
v_cvt_pk_bf16_f32 v113,v114,v115
M v[72:75],a[132:135],a[200:203],v[72:75]
buffer_load_dwordx4 a[120:123],v247,s[20:23],s47 offen offset:1024 sc1
M v[76:79],a[132:135],a[204:207],v[76:79]
v_cvt_pk_bf16_f32 v116,v116,v117
v_cvt_pk_bf16_f32 v117,v118,v119
M v[80:83],a[132:135],a[208:211],v[80:83]
ds_write2st64_b64 v249,v[112:113],v[116:117] offset0:51 offset1:55
M v[84:87],a[132:135],a[212:215],v[84:87]
v_cvt_pk_bf16_f32 v120,v120,v121
v_cvt_pk_bf16_f32 v121,v122,v123
M v[88:91],a[132:135],a[216:219],v[88:91]
s_add_u32 s34,s32,589824
buffer_store_dwordx4 a[76:79],v248,s[24:27],s34 offen offset:640 nt
M v[92:95],a[132:135],a[220:223],v[92:95]
s_waitcnt vmcnt(28)
v_cvt_pk_bf16_f32 v124,v124,v125
v_cvt_pk_bf16_f32 v125,v126,v127
M v[32:35],a[112:115],a[196:199],v[32:35]
ds_write2st64_b64 v249,v[120:121],v[124:125] offset0:59 offset1:63
M v[36:39],a[112:115],a[200:203],v[36:39]
v_cvt_pk_bf16_f32 v128,v128,v129
v_cvt_pk_bf16_f32 v129,v130,v131
M v[40:43],a[112:115],a[204:207],v[40:43]
buffer_load_dwordx4 a[152:155],v247,s[20:23],s48 offen offset:1024 sc1
M v[44:47],a[112:115],a[208:211],v[44:47]
v_cvt_pk_bf16_f32 v132,v132,v133
v_cvt_pk_bf16_f32 v133,v134,v135
M v[48:51],a[112:115],a[212:215],v[48:51]
s_waitcnt lgkmcnt(0)
s_barrier
ds_read_b128 v[96:99],v247 offset:17408
M v[52:55],a[112:115],a[216:219],v[52:55]
ds_read_b128 v[104:107],v247 offset:21504
ds_read_b128 v[112:115],v247 offset:26112
M v[56:59],a[112:115],a[220:223],v[56:59]
ds_read_b128 v[120:123],v247 offset:30208
ds_write2st64_b64 v249,v[128:129],v[132:133] offset0:119 offset1:123
M v[60:63],a[112:115],a[192:195],v[60:63]
s_waitcnt vmcnt(27)
v_cvt_pk_bf16_f32 v136,v136,v137
v_cvt_pk_bf16_f32 v137,v138,v139
M v[64:67],a[136:139],a[196:199],v[64:67]
ds_read_b128 a[196:199],v245 offset:2048
v_cvt_pk_bf16_f32 v140,v140,v141
M v[68:71],a[136:139],a[200:203],v[68:71]
v_cvt_pk_bf16_f32 v141,v142,v143
M v[72:75],a[136:139],a[204:207],v[72:75]
buffer_load_dwordx4 a[180:183],v247,s[20:23],s47 offen offset:2048 sc1
M v[76:79],a[136:139],a[208:211],v[76:79]
ds_write2st64_b64 v249,v[136:137],v[140:141] offset0:127 offset1:131
M v[80:83],a[136:139],a[212:215],v[80:83]
v_cvt_pk_bf16_f32 v144,v144,v145
v_cvt_pk_bf16_f32 v145,v146,v147
M v[84:87],a[136:139],a[216:219],v[84:87]
v_cvt_pk_bf16_f32 v148,v148,v149
v_cvt_pk_bf16_f32 v149,v150,v151
M v[88:91],a[136:139],a[220:223],v[88:91]
ds_write2st64_b64 v249,v[144:145],v[148:149] offset0:68 offset1:72
M v[92:95],a[136:139],a[192:195],v[92:95]
s_waitcnt vmcnt(27)
v_cvt_pk_bf16_f32 v152,v152,v153
v_cvt_pk_bf16_f32 v153,v154,v155
M v[32:35],a[164:167],a[200:203],v[32:35]
s_add_u32 s34,s32,786432
buffer_store_dwordx4 a[80:83],v248,s[24:27],s34 offen offset:640 nt
M v[36:39],a[164:167],a[204:207],v[36:39]
v_cvt_pk_bf16_f32 v156,v156,v157
v_cvt_pk_bf16_f32 v157,v158,v159
M v[40:43],a[164:167],a[208:211],v[40:43]
buffer_load_dwordx4 a[124:127],v247,s[20:23],s48 offen offset:2048 sc1
M v[44:47],a[164:167],a[212:215],v[44:47]
ds_write2st64_b64 v249,v[152:153],v[156:157] offset0:76 offset1:80
M v[48:51],a[164:167],a[216:219],v[48:51]
s_add_u32 s47,s80,3072
v_lshlrev_b32 v230,16,v208
v_lshlrev_b32 v228,16,v204
M v[52:55],a[164:167],a[220:223],v[52:55]
v_add_u32 v245,0x15400,v245
v_add_u32 v246,0x15400,v246
M v[56:59],a[164:167],a[192:195],v[56:59]
s_waitcnt lgkmcnt(3)
v_lshlrev_b32 v229,16,v206
v_lshlrev_b32 v233,16,v214
M v[60:63],a[164:167],a[196:199],v[60:63]
s_waitcnt vmcnt(27)
v_lshlrev_b32 v232,16,v212
v_lshlrev_b32 v231,16,v210
M v[64:67],v[216:219],a[200:203],v[64:67]
s_waitcnt lgkmcnt(0)
s_barrier
ds_read_b128 v[128:131],v247 offset:60928
M v[68:71],v[216:219],a[204:207],v[68:71]
ds_read_b128 v[136:139],v247 offset:65024
ds_read_b128 v[144:147],v247 offset:34816
M v[72:75],v[216:219],a[208:211],v[72:75]
ds_read_b128 v[152:155],v247 offset:38912
ds_read_b128 a[200:203],v245 offset:0
M v[76:79],v[216:219],a[212:215],v[76:79]
buffer_load_dwordx4 a[156:159],v247,s[20:23],s47 offen offset:0 sc1
M v[80:83],v[216:219],a[216:219],v[80:83]
s_add_u32 s48,s80,6144
ds_read_b128 a[204:207],v246 offset:0
ds_read_b128 a[208:211],v245 offset:512
M v[84:87],v[216:219],a[220:223],v[84:87]
ds_read_b128 a[212:215],v246 offset:512
ds_read_b128 a[216:219],v245 offset:1024
M v[88:91],v[216:219],a[192:195],v[88:91]
ds_read_b128 a[220:223],v246 offset:1024
ds_read_b128 a[192:195],v245 offset:1536
M v[92:95],v[216:219],a[196:199],v[92:95]
s_waitcnt vmcnt(27) lgkmcnt(6)
ds_read_b128 a[196:199],v246 offset:1536
v_fmac_f32 v228,s43,v230
M v[32:35],v[220:223],a[200:203],v[32:35]
s_waitcnt lgkmcnt(6)
v_fmac_f32 v233,4.0,v229
v_fma_f32 v234,-4.0,v230,v232
M v[36:39],v[220:223],a[204:207],v[36:39]
s_waitcnt lgkmcnt(5)
v_fmac_f32 v228,s45,v232
v_fmac_f32 v233,s41,v231
M v[40:43],v[220:223],a[208:211],v[40:43]
s_waitcnt lgkmcnt(4)
s_add_u32 s34,s32,983040
buffer_load_dwordx4 a[240:243],v247,s[20:23],s48 offen offset:0 sc1
M v[44:47],v[220:223],a[212:215],v[44:47]
s_waitcnt lgkmcnt(3)
v_sub_f32 v232,v232,v230
v_fma_f32 v230,-4.0,v229,v231
M v[48:51],v[220:223],a[216:219],v[48:51]
s_waitcnt lgkmcnt(2)
buffer_store_dwordx4 a[84:87],v248,s[24:27],s34 offen offset:640 nt
M v[52:55],v[220:223],a[220:223],v[52:55]
s_waitcnt lgkmcnt(1)
v_sub_f32 v231,v231,v229
v_add_f32 v229,v234,v230
M v[56:59],v[220:223],a[192:195],v[56:59]
s_waitcnt lgkmcnt(0)
v_sub_f32 v234,v234,v230
v_fma_f32 v230,2.0,v231,v232
M v[60:63],v[220:223],a[196:199],v[60:63]
s_waitcnt vmcnt(28)
v_fmac_f32 v232,-2.0,v231
v_and_b32 v208,s42,v208
M v[64:67],a[140:143],a[200:203],v[64:67]
ds_read_b128 a[200:203],v246 offset:2048
v_and_b32 v204,s42,v204
M v[68:71],a[140:143],a[204:207],v[68:71]
v_and_b32 v206,s42,v206
v_and_b32 v214,s42,v214
M v[72:75],a[140:143],a[208:211],v[72:75]
buffer_load_dwordx4 a[244:247],v247,s[20:23],s47 offen offset:1024 sc1
M v[76:79],a[140:143],a[212:215],v[76:79]
v_and_b32 v212,s42,v212
v_and_b32 v210,s42,v210
M v[80:83],a[140:143],a[216:219],v[80:83]
v_fmac_f32 v204,s43,v208
v_fmac_f32 v214,4.0,v206
M v[84:87],a[140:143],a[220:223],v[84:87]
v_fma_f32 v231,-4.0,v208,v212
v_fmac_f32 v204,s45,v212
M v[88:91],a[140:143],a[192:195],v[88:91]
v_fmac_f32 v214,s41,v210
v_sub_f32 v212,v212,v208
M v[92:95],a[140:143],a[196:199],v[92:95]
s_waitcnt vmcnt(27)
v_fma_f32 v208,-4.0,v206,v210
v_sub_f32 v210,v210,v206
M v[32:35],a[100:103],a[204:207],v[32:35]
v_add_f32 v206,v231,v208
v_sub_f32 v231,v231,v208
M v[36:39],a[100:103],a[208:211],v[36:39]
v_fma_f32 v208,2.0,v210,v212
v_fmac_f32 v212,-2.0,v210
M v[40:43],a[100:103],a[212:215],v[40:43]
buffer_load_dwordx4 a[184:187],v247,s[20:23],s48 offen offset:1024 sc1
M v[44:47],a[100:103],a[216:219],v[44:47]
v_cvt_pk_bf16_f32 v204,v228,v204
v_cvt_pk_bf16_f32 v214,v233,v214
M v[48:51],a[100:103],a[220:223],v[48:51]
s_add_u32 s34,s32,1179648
buffer_store_dwordx4 a[88:91],v248,s[24:27],s34 offen offset:640 nt
M v[52:55],a[100:103],a[192:195],v[52:55]
v_cvt_pk_bf16_f32 v206,v229,v206
v_cvt_pk_bf16_f32 v210,v230,v208
M v[56:59],a[100:103],a[196:199],v[56:59]
s_waitcnt lgkmcnt(0)
v_cvt_pk_bf16_f32 v208,v234,v231
v_cvt_pk_bf16_f32 v212,v232,v212
M v[60:63],a[100:103],a[200:203],v[60:63]
s_waitcnt vmcnt(28)
v_lshlrev_b32 v230,16,v209
v_lshlrev_b32 v228,16,v205
M v[64:67],a[168:171],a[204:207],v[64:67]
ds_read_b128 a[204:207],v245 offset:2048
v_lshlrev_b32 v229,16,v207
M v[68:71],a[168:171],a[208:211],v[68:71]
v_lshlrev_b32 v233,16,v215
v_lshlrev_b32 v232,16,v213
M v[72:75],a[168:171],a[212:215],v[72:75]
buffer_load_dwordx4 a[108:111],v247,s[20:23],s47 offen offset:2048 sc1
M v[76:79],a[168:171],a[216:219],v[76:79]
v_lshlrev_b32 v231,16,v211
v_fmac_f32 v228,s43,v230
M v[80:83],a[168:171],a[220:223],v[80:83]
v_fmac_f32 v233,4.0,v229
v_fma_f32 v234,-4.0,v230,v232
M v[84:87],a[168:171],a[192:195],v[84:87]
v_fmac_f32 v228,s45,v232
v_fmac_f32 v233,s41,v231
M v[88:91],a[168:171],a[196:199],v[88:91]
v_sub_f32 v232,v232,v230
v_fma_f32 v230,-4.0,v229,v231
M v[92:95],a[168:171],a[200:203],v[92:95]
s_waitcnt vmcnt(27)
v_sub_f32 v231,v231,v229
v_add_f32 v229,v234,v230
M v[32:35],a[116:119],a[208:211],v[32:35]
v_sub_f32 v234,v234,v230
v_fma_f32 v230,2.0,v231,v232
M v[36:39],a[116:119],a[212:215],v[36:39]
v_fmac_f32 v232,-2.0,v231
v_and_b32 v209,s42,v209
M v[40:43],a[116:119],a[216:219],v[40:43]
buffer_load_dwordx4 a[248:251],v247,s[20:23],s48 offen offset:2048 sc1
M v[44:47],a[116:119],a[220:223],v[44:47]
v_and_b32 v205,s42,v205
v_and_b32 v207,s42,v207
M v[48:51],a[116:119],a[192:195],v[48:51]
s_add_u32 s47,s81,3072
v_and_b32 v215,s42,v215
v_and_b32 v213,s42,v213
M v[52:55],a[116:119],a[196:199],v[52:55]
v_and_b32 v211,s42,v211
v_fmac_f32 v205,s43,v209
M v[56:59],a[116:119],a[200:203],v[56:59]
s_waitcnt lgkmcnt(0)
s_add_u32 s34,s32,1376256
buffer_store_dwordx4 a[92:95],v248,s[24:27],s34 offen offset:640 nt
M v[60:63],a[116:119],a[204:207],v[60:63]
s_waitcnt vmcnt(28)
v_fmac_f32 v215,4.0,v207
v_fma_f32 v231,-4.0,v209,v213
M v[64:67],v[224:227],a[208:211],v[64:67]
ds_read_b128 a[208:211],v245 offset:17408
v_fmac_f32 v205,s45,v213
M v[68:71],v[224:227],a[212:215],v[68:71]
ds_read_b128 a[212:215],v246 offset:17408
v_fmac_f32 v215,s41,v211
M v[72:75],v[224:227],a[216:219],v[72:75]
buffer_load_dwordx4 a[96:99],v247,s[20:23],s47 offen offset:0 sc1
M v[76:79],v[224:227],a[220:223],v[76:79]
ds_read_b128 a[216:219],v245 offset:17920
ds_read_b128 a[220:223],v246 offset:17920
M v[80:83],v[224:227],a[192:195],v[80:83]
s_add_u32 s48,s81,6144
ds_read_b128 a[192:195],v245 offset:18432
v_sub_f32 v213,v213,v209
M v[84:87],v[224:227],a[196:199],v[84:87]
ds_read_b128 a[196:199],v246 offset:18432
v_fma_f32 v209,-4.0,v207,v211
M v[88:91],v[224:227],a[200:203],v[88:91]
ds_read_b128 a[200:203],v245 offset:18944
v_sub_f32 v211,v211,v207
M v[92:95],v[224:227],a[204:207],v[92:95]
s_waitcnt vmcnt(27) lgkmcnt(6)
ds_read_b128 a[204:207],v246 offset:18944
v_add_f32 v207,v231,v209
M v[32:35],a[228:231],a[208:211],v[32:35]
s_waitcnt lgkmcnt(6)
v_sub_f32 v231,v231,v209
v_fma_f32 v209,2.0,v211,v213
M v[36:39],a[228:231],a[212:215],v[36:39]
s_waitcnt lgkmcnt(5)
v_fmac_f32 v213,-2.0,v211
v_cvt_pk_bf16_f32 v205,v228,v205
M v[40:43],a[228:231],a[216:219],v[40:43]
s_waitcnt lgkmcnt(4)
buffer_load_dwordx4 a[128:131],v247,s[20:23],s48 offen offset:0 sc1
M v[44:47],a[228:231],a[220:223],v[44:47]
s_waitcnt lgkmcnt(3)
v_cvt_pk_bf16_f32 v215,v233,v215
v_cvt_pk_bf16_f32 v207,v229,v207
M v[48:51],a[228:231],a[192:195],v[48:51]
s_waitcnt lgkmcnt(2)
v_cvt_pk_bf16_f32 v211,v230,v209
v_cvt_pk_bf16_f32 v209,v234,v231
M v[52:55],a[228:231],a[196:199],v[52:55]
s_waitcnt lgkmcnt(1)
v_cvt_pk_bf16_f32 v213,v232,v213
M v[56:59],a[228:231],a[200:203],v[56:59]
s_waitcnt lgkmcnt(0)
s_barrier
ds_write2st64_b64 v243,v[192:193],v[202:203] offset0:102 offset1:119
M v[60:63],a[228:231],a[204:207],v[60:63]
s_waitcnt vmcnt(27)
s_add_u32 s28,s64,7077888
buffer_load_dwordx2 v[192:193],v241,s[12:15],s28 offen offset:0
M v[64:67],a[172:175],a[208:211],v[64:67]
s_add_u32 s34,s33,0
ds_read_b128 a[208:211],v246 offset:19456
ds_write2st64_b64 v243,v[194:195],v[196:197] offset0:34 offset1:51
M v[68:71],a[172:175],a[212:215],v[68:71]
buffer_load_dwordx2 v[202:203],v241,s[16:19],s28 offen offset:1536
M v[72:75],a[172:175],a[216:219],v[72:75]
ds_write2st64_b64 v243,v[198:199],v[200:201] offset0:68 offset1:85
M v[76:79],a[172:175],a[220:223],v[76:79]
ds_write2st64_b64 v243,v[204:205],v[214:215] offset0:103 offset1:120
M v[80:83],a[172:175],a[192:195],v[80:83]
buffer_load_dwordx2 v[194:195],v241,s[8:11],s28 offen offset:0
M v[84:87],a[172:175],a[196:199],v[84:87]
ds_write2st64_b64 v243,v[206:207],v[208:209] offset0:35 offset1:52
M v[88:91],a[172:175],a[200:203],v[88:91]
buffer_load_dwordx2 v[196:197],v241,s[8:11],s28 offen offset:384
M v[92:95],a[172:175],a[204:207],v[92:95]
s_waitcnt vmcnt(29)
ds_write2st64_b64 v243,v[210:211],v[212:213] offset0:69 offset1:86
M v[32:35],a[232:235],a[212:215],v[32:35]
v_fmac_f32 v235,s43,v237
v_fmac_f32 v240,4.0,v236
M v[36:39],a[232:235],a[216:219],v[36:39]
buffer_load_dwordx2 v[198:199],v241,s[8:11],s28 offen offset:768
M v[40:43],a[232:235],a[220:223],v[40:43]
v_fma_f32 v228,-4.0,v237,v239
v_fmac_f32 v235,s45,v239
M v[44:47],a[232:235],a[192:195],v[44:47]
v_fmac_f32 v240,s41,v238
v_sub_f32 v239,v239,v237
M v[48:51],a[232:235],a[196:199],v[48:51]
v_fma_f32 v237,-4.0,v236,v238
v_sub_f32 v238,v238,v236
M v[52:55],a[232:235],a[200:203],v[52:55]
buffer_load_dwordx2 v[200:201],v241,s[8:11],s28 offen offset:1152
M v[56:59],a[232:235],a[204:207],v[56:59]
s_waitcnt lgkmcnt(5)
s_add_u32 s28,s64,7471104
v_add_f32 v236,v228,v237
v_sub_f32 v228,v228,v237
M v[60:63],a[232:235],a[208:211],v[60:63]
s_waitcnt vmcnt(30)
v_fma_f32 v237,2.0,v238,v239
v_fmac_f32 v239,-2.0,v238
M v[64:67],a[144:147],a[212:215],v[64:67]
ds_read_b128 a[212:215],v245 offset:19456
v_cvt_pk_bf16_f32 v229,v235,v240
M v[68:71],a[144:147],a[216:219],v[68:71]
buffer_load_dwordx2 v[204:205],v241,s[12:15],s28 offen offset:0
M v[72:75],a[144:147],a[220:223],v[72:75]
v_cvt_pk_bf16_f32 v230,v236,v228
v_cvt_pk_bf16_f32 v231,v237,v239
M v[76:79],a[144:147],a[192:195],v[76:79]
ds_write_b16 v244,v229 offset:52224
M v[80:83],a[144:147],a[196:199],v[80:83]
ds_write_b16_d16_hi v244,v229 offset:60928
M v[84:87],a[144:147],a[200:203],v[84:87]
buffer_load_dwordx2 v[214:215],v241,s[16:19],s28 offen offset:1536
M v[88:91],a[144:147],a[204:207],v[88:91]
ds_write_b16 v244,v230 offset:17408
M v[92:95],a[144:147],a[208:211],v[92:95]
s_waitcnt vmcnt(31)
ds_write_b16_d16_hi v244,v230 offset:26112
M v[32:35],a[236:239],a[216:219],v[32:35]
ds_write_b16 v244,v231 offset:34816
M v[36:39],a[236:239],a[220:223],v[36:39]
buffer_load_dwordx2 v[206:207],v241,s[8:11],s28 offen offset:0
M v[40:43],a[236:239],a[192:195],v[40:43]
ds_write_b16_d16_hi v244,v231 offset:43520
M v[44:47],a[236:239],a[196:199],v[44:47]
M v[48:51],a[236:239],a[200:203],v[48:51]
M v[52:55],a[236:239],a[204:207],v[52:55]
buffer_load_dwordx2 v[208:209],v241,s[8:11],s28 offen offset:384
M v[56:59],a[236:239],a[208:211],v[56:59]
s_waitcnt lgkmcnt(6)
M v[60:63],a[236:239],a[212:215],v[60:63]
s_waitcnt vmcnt(31)
M v[64:67],a[176:179],a[216:219],v[64:67]
ds_read_b128 a[216:219],v245 offset:34816
M v[68:71],a[176:179],a[220:223],v[68:71]
buffer_load_dwordx2 v[210:211],v241,s[8:11],s28 offen offset:768
M v[72:75],a[176:179],a[192:195],v[72:75]
ds_read_b128 a[220:223],v246 offset:34816
ds_read_b128 a[192:195],v245 offset:35328
M v[76:79],a[176:179],a[196:199],v[76:79]
ds_read_b128 a[196:199],v246 offset:35328
M v[80:83],a[176:179],a[200:203],v[80:83]
ds_read_b128 a[200:203],v245 offset:35840
M v[84:87],a[176:179],a[204:207],v[84:87]
buffer_load_dwordx2 v[212:213],v241,s[8:11],s28 offen offset:1152
M v[88:91],a[176:179],a[208:211],v[88:91]
s_add_u32 s29,s65,6291456
ds_read_b128 a[204:207],v246 offset:35840
ds_read_b128 a[208:211],v245 offset:36352
M v[92:95],a[176:179],a[212:215],v[92:95]
s_waitcnt vmcnt(32) lgkmcnt(6)
ds_read_b128 a[212:215],v246 offset:36352
M v[32:35],a[148:151],a[216:219],v[32:35]
s_waitcnt lgkmcnt(6)
M v[36:39],a[148:151],a[220:223],v[36:39]
s_waitcnt lgkmcnt(5)
buffer_load_short_d16_hi v235,v242,s[12:15],s29 offen offset:0
M v[40:43],a[148:151],a[192:195],v[40:43]
s_waitcnt lgkmcnt(4)
M v[44:47],a[148:151],a[196:199],v[44:47]
s_waitcnt lgkmcnt(3)
buffer_load_short_d16_hi v236,v242,s[8:11],s29 offen offset:0
M v[48:51],a[148:151],a[200:203],v[48:51]
s_waitcnt vmcnt(10) lgkmcnt(2)
v_lshlrev_b32 v230,16,v196
v_lshlrev_b32 v228,16,v192
M v[52:55],a[148:151],a[204:207],v[52:55]
s_waitcnt lgkmcnt(1)
buffer_load_short_d16_hi v237,v242,s[8:11],s29 offen offset:384
M v[56:59],a[148:151],a[208:211],v[56:59]
s_waitcnt lgkmcnt(0)
v_lshlrev_b32 v229,16,v194
v_lshlrev_b32 v233,16,v202
M v[60:63],a[148:151],a[212:215],v[60:63]
buffer_load_short_d16_hi v238,v242,s[8:11],s29 offen offset:768
M v[64:67],a[104:107],a[216:219],v[64:67]
s_waitcnt vmcnt(10)
ds_read_b128 a[216:219],v246 offset:36864
v_lshlrev_b32 v232,16,v200
M v[68:71],a[104:107],a[220:223],v[68:71]
buffer_load_short_d16_hi v239,v242,s[8:11],s29 offen offset:1152
M v[72:75],a[104:107],a[192:195],v[72:75]
v_lshlrev_b32 v231,16,v198
v_fmac_f32 v228,s43,v230
M v[76:79],a[104:107],a[196:199],v[76:79]
buffer_load_short_d16_hi v240,v242,s[16:19],s29 offen offset:1536
M v[80:83],a[104:107],a[200:203],v[80:83]
v_fmac_f32 v233,4.0,v229
v_fma_f32 v234,-4.0,v230,v232
M v[84:87],a[104:107],a[204:207],v[84:87]
buffer_store_dwordx4 v[96:99],v248,s[24:27],s34 offen offset:1152 nt
M v[88:91],a[104:107],a[208:211],v[88:91]
s_add_u32 s34,s33,393216
v_fmac_f32 v228,s45,v232
v_fmac_f32 v233,s41,v231
M v[92:95],a[104:107],a[212:215],v[92:95]
v_sub_f32 v232,v232,v230
v_fma_f32 v230,-4.0,v229,v231
M v[32:35],a[120:123],a[220:223],v[32:35]
buffer_load_dwordx4 a[188:191],v247,s[20:23],s47 offen offset:1024 sc1
M v[36:39],a[120:123],a[192:195],v[36:39]
v_sub_f32 v231,v231,v229
v_add_f32 v229,v234,v230
M v[40:43],a[120:123],a[196:199],v[40:43]
v_sub_f32 v234,v234,v230
v_fma_f32 v230,2.0,v231,v232
M v[44:47],a[120:123],a[200:203],v[44:47]
v_fmac_f32 v232,-2.0,v231
v_and_b32 v196,s42,v196
M v[48:51],a[120:123],a[204:207],v[48:51]
buffer_load_dwordx4 a[252:255],v247,s[20:23],s48 offen offset:1024 sc1
M v[52:55],a[120:123],a[208:211],v[52:55]
v_and_b32 v192,s42,v192
v_and_b32 v194,s42,v194
M v[56:59],a[120:123],a[212:215],v[56:59]
s_waitcnt lgkmcnt(0)
v_and_b32 v202,s42,v202
v_and_b32 v200,s42,v200
M v[60:63],a[120:123],a[216:219],v[60:63]
v_and_b32 v198,s42,v198
v_fmac_f32 v192,s43,v196
M v[64:67],a[152:155],a[220:223],v[64:67]
buffer_load_dwordx4 a[160:163],v247,s[20:23],s47 offen offset:2048 sc1
M v[68:71],a[152:155],a[192:195],v[68:71]
ds_read_b128 a[220:223],v245 offset:36864
v_fmac_f32 v202,4.0,v194
M v[72:75],a[152:155],a[196:199],v[72:75]
v_fma_f32 v231,-4.0,v196,v200
v_fmac_f32 v192,s45,v200
M v[76:79],a[152:155],a[200:203],v[76:79]
v_fmac_f32 v202,s41,v198
v_sub_f32 v200,v200,v196
M v[80:83],a[152:155],a[204:207],v[80:83]
buffer_store_dwordx4 v[104:107],v248,s[24:27],s34 offen offset:1152 nt
M v[84:87],a[152:155],a[208:211],v[84:87]
s_add_u32 s34,s33,786432
v_fma_f32 v196,-4.0,v194,v198
v_sub_f32 v198,v198,v194
M v[88:91],a[152:155],a[212:215],v[88:91]
v_add_f32 v194,v231,v196
v_sub_f32 v231,v231,v196
M v[92:95],a[152:155],a[216:219],v[92:95]
buffer_load_dwordx4 a[224:227],v247,s[20:23],s48 offen offset:2048 sc1
M v[32:35],a[180:183],a[192:195],v[32:35]
s_add_u32 s48,s76,52224
v_fma_f32 v196,2.0,v198,v200
v_fmac_f32 v200,-2.0,v198
M v[36:39],a[180:183],a[196:199],v[36:39]
v_cvt_pk_bf16_f32 v192,v228,v192
v_cvt_pk_bf16_f32 v202,v233,v202
M v[40:43],a[180:183],a[200:203],v[40:43]
v_cvt_pk_bf16_f32 v194,v229,v194
v_cvt_pk_bf16_f32 v198,v230,v196
M v[44:47],a[180:183],a[204:207],v[44:47]
buffer_load_dwordx4 a[132:135],v247,s[20:23],s48 offen offset:0 sc1
M v[48:51],a[180:183],a[208:211],v[48:51]
v_cvt_pk_bf16_f32 v196,v234,v231
v_cvt_pk_bf16_f32 v200,v232,v200
M v[52:55],a[180:183],a[212:215],v[52:55]
v_lshlrev_b32 v230,16,v197
v_lshlrev_b32 v228,16,v193
M v[56:59],a[180:183],a[216:219],v[56:59]
s_waitcnt lgkmcnt(0)
v_lshlrev_b32 v229,16,v195
v_lshlrev_b32 v233,16,v203
M v[60:63],a[180:183],a[220:223],v[60:63]
buffer_store_dwordx4 v[112:115],v248,s[24:27],s34 offen offset:1152 nt
M v[64:67],a[124:127],a[192:195],v[64:67]
s_add_u32 s34,s33,1179648
ds_read_b128 a[192:195],v245 offset:52224
v_lshlrev_b32 v232,16,v201
M v[68:71],a[124:127],a[196:199],v[68:71]
ds_read_b128 a[196:199],v246 offset:52224
v_lshlrev_b32 v231,16,v199
M v[72:75],a[124:127],a[200:203],v[72:75]
buffer_load_dwordx4 a[112:115],v247,s[20:23],s48 offen offset:1024 sc1
M v[76:79],a[124:127],a[204:207],v[76:79]
ds_read_b128 a[200:203],v245 offset:52736
ds_read_b128 a[204:207],v246 offset:52736
M v[80:83],a[124:127],a[208:211],v[80:83]
ds_read_b128 a[208:211],v245 offset:53248
v_fmac_f32 v228,s43,v230
M v[84:87],a[124:127],a[212:215],v[84:87]
ds_read_b128 a[212:215],v246 offset:53248
v_fmac_f32 v233,4.0,v229
M v[88:91],a[124:127],a[216:219],v[88:91]
buffer_load_dwordx4 a[136:139],v247,s[20:23],s48 offen offset:2048 sc1
M v[92:95],a[124:127],a[220:223],v[92:95]
s_waitcnt lgkmcnt(5)
s_add_u32 s48,s77,52224
ds_read_b128 a[216:219],v245 offset:53760
ds_read_b128 a[220:223],v246 offset:53760
M v[32:35],a[156:159],a[192:195],v[32:35]
s_waitcnt lgkmcnt(6)
v_fma_f32 v234,-4.0,v230,v232
v_fmac_f32 v228,s45,v232
M v[36:39],a[156:159],a[196:199],v[36:39]
s_waitcnt lgkmcnt(5)
v_fmac_f32 v233,s41,v231
v_sub_f32 v232,v232,v230
M v[40:43],a[156:159],a[200:203],v[40:43]
s_waitcnt lgkmcnt(4)
buffer_store_dwordx4 v[120:123],v248,s[24:27],s34 offen offset:1152 nt
M v[44:47],a[156:159],a[204:207],v[44:47]
s_waitcnt lgkmcnt(3)
s_add_u32 s34,s33,0
v_fma_f32 v230,-4.0,v229,v231
v_sub_f32 v231,v231,v229
M v[48:51],a[156:159],a[208:211],v[48:51]
s_waitcnt lgkmcnt(2)
v_add_f32 v229,v234,v230
v_sub_f32 v234,v234,v230
M v[52:55],a[156:159],a[212:215],v[52:55]
s_waitcnt lgkmcnt(1)
buffer_load_dwordx4 a[164:167],v247,s[20:23],s48 offen offset:0 sc1
M v[56:59],a[156:159],a[216:219],v[56:59]
s_waitcnt lgkmcnt(0)
v_fma_f32 v230,2.0,v231,v232
v_fmac_f32 v232,-2.0,v231
M v[60:63],a[156:159],a[220:223],v[60:63]
v_and_b32 v197,s42,v197
v_and_b32 v193,s42,v193
M v[64:67],a[240:243],a[192:195],v[64:67]
ds_read_b128 a[192:195],v246 offset:54272
v_and_b32 v195,s42,v195
M v[68:71],a[240:243],a[196:199],v[68:71]
buffer_load_dwordx4 v[216:219],v247,s[20:23],s48 offen offset:1024 sc1
M v[72:75],a[240:243],a[200:203],v[72:75]
v_and_b32 v203,s42,v203
v_and_b32 v201,s42,v201
M v[76:79],a[240:243],a[204:207],v[76:79]
v_and_b32 v199,s42,v199
v_fmac_f32 v193,s43,v197
M v[80:83],a[240:243],a[208:211],v[80:83]
v_fmac_f32 v203,4.0,v195
v_fma_f32 v231,-4.0,v197,v201
M v[84:87],a[240:243],a[212:215],v[84:87]
buffer_store_dwordx4 v[128:131],v248,s[24:27],s34 offen offset:1280 nt
M v[88:91],a[240:243],a[216:219],v[88:91]
s_add_u32 s34,s33,393216
v_fmac_f32 v193,s45,v201
v_fmac_f32 v203,s41,v199
M v[92:95],a[240:243],a[220:223],v[92:95]
v_sub_f32 v201,v201,v197
v_fma_f32 v197,-4.0,v195,v199
M v[32:35],a[244:247],a[196:199],v[32:35]
buffer_load_dwordx4 v[220:223],v247,s[20:23],s48 offen offset:2048 sc1
M v[36:39],a[244:247],a[200:203],v[36:39]
s_add_u32 s48,s78,52224
v_sub_f32 v199,v199,v195
v_add_f32 v195,v231,v197
M v[40:43],a[244:247],a[204:207],v[40:43]
v_sub_f32 v231,v231,v197
v_fma_f32 v197,2.0,v199,v201
M v[44:47],a[244:247],a[208:211],v[44:47]
v_fmac_f32 v201,-2.0,v199
v_cvt_pk_bf16_f32 v193,v228,v193
M v[48:51],a[244:247],a[212:215],v[48:51]
buffer_load_dwordx4 a[140:143],v247,s[20:23],s48 offen offset:0 sc1
M v[52:55],a[244:247],a[216:219],v[52:55]
v_cvt_pk_bf16_f32 v203,v233,v203
v_cvt_pk_bf16_f32 v195,v229,v195
M v[56:59],a[244:247],a[220:223],v[56:59]
s_waitcnt lgkmcnt(0)
v_cvt_pk_bf16_f32 v199,v230,v197
v_cvt_pk_bf16_f32 v197,v234,v231
M v[60:63],a[244:247],a[192:195],v[60:63]
v_cvt_pk_bf16_f32 v201,v232,v201
M v[64:67],a[184:187],a[196:199],v[64:67]
buffer_load_dwordx4 a[100:103],v247,s[20:23],s48 offen offset:1024 sc1
M v[68:71],a[184:187],a[200:203],v[68:71]
ds_read_b128 a[196:199],v245 offset:54272
ds_write2st64_b64 v243,v[192:193],v[202:203] offset0:104 offset1:121
M v[72:75],a[184:187],a[204:207],v[72:75]
s_add_u32 s28,s65,6291456
ds_write2st64_b64 v243,v[194:195],v[196:197] offset0:36 offset1:53
M v[76:79],a[184:187],a[208:211],v[76:79]
buffer_load_dwordx2 v[192:193],v241,s[12:15],s28 offen offset:0
M v[80:83],a[184:187],a[212:215],v[80:83]
ds_write2st64_b64 v243,v[198:199],v[200:201] offset0:70 offset1:87
M v[84:87],a[184:187],a[216:219],v[84:87]
s_waitcnt vmcnt(26)
v_lshlrev_b32 v230,16,v208
v_lshlrev_b32 v228,16,v204
M v[88:91],a[184:187],a[220:223],v[88:91]
buffer_load_dwordx2 v[202:203],v241,s[16:19],s28 offen offset:1536
M v[92:95],a[184:187],a[192:195],v[92:95]
v_lshlrev_b32 v229,16,v206
v_lshlrev_b32 v233,16,v214
M v[32:35],a[108:111],a[200:203],v[32:35]
s_waitcnt vmcnt(25)
v_lshlrev_b32 v232,16,v212
v_lshlrev_b32 v231,16,v210
M v[36:39],a[108:111],a[204:207],v[36:39]
v_fmac_f32 v228,s43,v230
v_fmac_f32 v233,4.0,v229
M v[40:43],a[108:111],a[208:211],v[40:43]
buffer_load_dwordx2 v[194:195],v241,s[8:11],s28 offen offset:0
M v[44:47],a[108:111],a[212:215],v[44:47]
v_fma_f32 v234,-4.0,v230,v232
v_fmac_f32 v228,s45,v232
M v[48:51],a[108:111],a[216:219],v[48:51]
v_fmac_f32 v233,s41,v231
v_sub_f32 v232,v232,v230
M v[52:55],a[108:111],a[220:223],v[52:55]
v_add_u32 v245,0xfffece00,v245
v_add_u32 v246,0xfffece00,v246
M v[56:59],a[108:111],a[192:195],v[56:59]
s_waitcnt lgkmcnt(3)
buffer_load_dwordx2 v[196:197],v241,s[8:11],s28 offen offset:384
M v[60:63],a[108:111],a[196:199],v[60:63]
v_fma_f32 v230,-4.0,v229,v231
v_sub_f32 v231,v231,v229
M v[64:67],a[248:251],a[200:203],v[64:67]
ds_read_b128 a[200:203],v245 offset:60928
v_add_f32 v229,v234,v230
M v[68:71],a[248:251],a[204:207],v[68:71]
ds_read_b128 a[204:207],v246 offset:60928
v_sub_f32 v234,v234,v230
M v[72:75],a[248:251],a[208:211],v[72:75]
buffer_load_dwordx2 v[198:199],v241,s[8:11],s28 offen offset:768
M v[76:79],a[248:251],a[212:215],v[76:79]
ds_read_b128 a[208:211],v245 offset:61440
ds_read_b128 a[212:215],v246 offset:61440
M v[80:83],a[248:251],a[216:219],v[80:83]
ds_read_b128 a[216:219],v245 offset:61952
v_fma_f32 v230,2.0,v231,v232
M v[84:87],a[248:251],a[220:223],v[84:87]
ds_read_b128 a[220:223],v246 offset:61952
v_fmac_f32 v232,-2.0,v231
M v[88:91],a[248:251],a[192:195],v[88:91]
buffer_load_dwordx2 v[200:201],v241,s[8:11],s28 offen offset:1152
M v[92:95],a[248:251],a[196:199],v[92:95]
s_waitcnt lgkmcnt(5)
ds_read_b128 a[192:195],v245 offset:62464
ds_read_b128 a[196:199],v246 offset:62464
M v[32:35],a[96:99],a[200:203],v[32:35]
s_waitcnt lgkmcnt(6)
v_and_b32 v208,s42,v208
v_and_b32 v204,s42,v204
M v[36:39],a[96:99],a[204:207],v[36:39]
s_waitcnt lgkmcnt(5)
v_and_b32 v206,s42,v206
v_and_b32 v214,s42,v214
M v[40:43],a[96:99],a[208:211],v[40:43]
s_waitcnt lgkmcnt(4)
buffer_store_dwordx4 v[136:139],v248,s[24:27],s34 offen offset:1280 nt
M v[44:47],a[96:99],a[212:215],v[44:47]
s_waitcnt lgkmcnt(3)
s_add_u32 s34,s33,786432
v_and_b32 v212,s42,v212
v_and_b32 v210,s42,v210
M v[48:51],a[96:99],a[216:219],v[48:51]
s_waitcnt lgkmcnt(2)
v_fmac_f32 v204,s43,v208
v_fmac_f32 v214,4.0,v206
M v[52:55],a[96:99],a[220:223],v[52:55]
s_waitcnt lgkmcnt(1)
buffer_load_dwordx4 a[168:171],v247,s[20:23],s48 offen offset:2048 sc1
M v[56:59],a[96:99],a[192:195],v[56:59]
s_waitcnt lgkmcnt(0)
s_add_u32 s48,s79,52224
v_fma_f32 v231,-4.0,v208,v212
v_fmac_f32 v204,s45,v212
M v[60:63],a[96:99],a[196:199],v[60:63]
v_fmac_f32 v214,s41,v210
v_sub_f32 v212,v212,v208
M v[64:67],a[128:131],a[200:203],v[64:67]
ds_read_b128 a[200:203],v246 offset:62976
v_fma_f32 v208,-4.0,v206,v210
M v[68:71],a[128:131],a[204:207],v[68:71]
buffer_load_dwordx4 a[116:119],v247,s[20:23],s48 offen offset:0 sc1
M v[72:75],a[128:131],a[208:211],v[72:75]
v_sub_f32 v210,v210,v206
v_add_f32 v206,v231,v208
M v[76:79],a[128:131],a[212:215],v[76:79]
v_sub_f32 v231,v231,v208
v_fma_f32 v208,2.0,v210,v212
M v[80:83],a[128:131],a[216:219],v[80:83]
v_fmac_f32 v212,-2.0,v210
v_cvt_pk_bf16_f32 v204,v228,v204
M v[84:87],a[128:131],a[220:223],v[84:87]
buffer_store_dwordx4 v[144:147],v248,s[24:27],s34 offen offset:1280 nt
M v[88:91],a[128:131],a[192:195],v[88:91]
s_add_u32 s34,s33,1179648
v_cvt_pk_bf16_f32 v214,v233,v214
v_cvt_pk_bf16_f32 v206,v229,v206
M v[92:95],a[128:131],a[196:199],v[92:95]
s_waitcnt vmcnt(25)
v_cvt_pk_bf16_f32 v210,v230,v208
v_cvt_pk_bf16_f32 v208,v234,v231
M v[32:35],a[188:191],a[204:207],v[32:35]
buffer_load_dwordx4 v[224:227],v247,s[20:23],s48 offen offset:1024 sc1
M v[36:39],a[188:191],a[208:211],v[36:39]
v_cvt_pk_bf16_f32 v212,v232,v212
v_lshlrev_b32 v230,16,v209
M v[40:43],a[188:191],a[212:215],v[40:43]
v_lshlrev_b32 v228,16,v205
v_lshlrev_b32 v229,16,v207
M v[44:47],a[188:191],a[216:219],v[44:47]
v_lshlrev_b32 v233,16,v215
v_lshlrev_b32 v232,16,v213
M v[48:51],a[188:191],a[220:223],v[48:51]
buffer_load_dwordx4 a[228:231],v247,s[20:23],s48 offen offset:2048 sc1
M v[52:55],a[188:191],a[192:195],v[52:55]
s_add_u32 s48,s80,52224
v_lshlrev_b32 v231,16,v211
v_fmac_f32 v228,s43,v230
M v[56:59],a[188:191],a[196:199],v[56:59]
s_waitcnt lgkmcnt(0)
v_fmac_f32 v233,4.0,v229
v_fma_f32 v234,-4.0,v230,v232
M v[60:63],a[188:191],a[200:203],v[60:63]
s_waitcnt vmcnt(26)
v_fmac_f32 v228,s45,v232
v_fmac_f32 v233,s41,v231
M v[64:67],a[252:255],a[204:207],v[64:67]
buffer_store_dwordx4 v[152:155],v248,s[24:27],s34 offen offset:1280 nt
M v[68:71],a[252:255],a[208:211],v[68:71]
ds_read_b128 a[204:207],v245 offset:62976
v_sub_f32 v232,v232,v230
M v[72:75],a[252:255],a[212:215],v[72:75]
v_fma_f32 v230,-4.0,v229,v231
v_sub_f32 v231,v231,v229
M v[76:79],a[252:255],a[216:219],v[76:79]
buffer_load_dwordx4 a[172:175],v247,s[20:23],s48 offen offset:0 sc1
M v[80:83],a[252:255],a[220:223],v[80:83]
v_add_f32 v229,v234,v230
v_sub_f32 v234,v234,v230
M v[84:87],a[252:255],a[192:195],v[84:87]
v_fma_f32 v230,2.0,v231,v232
v_fmac_f32 v232,-2.0,v231
M v[88:91],a[252:255],a[196:199],v[88:91]
v_and_b32 v209,s42,v209
v_and_b32 v205,s42,v205
M v[92:95],a[252:255],a[200:203],v[92:95]
s_waitcnt vmcnt(27)
buffer_load_dwordx4 a[232:235],v247,s[20:23],s48 offen offset:1024 sc1
M v[32:35],a[160:163],a[208:211],v[32:35]
v_and_b32 v207,s42,v207
v_and_b32 v215,s42,v215
M v[36:39],a[160:163],a[212:215],v[36:39]
v_and_b32 v213,s42,v213
v_and_b32 v211,s42,v211
M v[40:43],a[160:163],a[216:219],v[40:43]
v_fmac_f32 v205,s43,v209
v_fmac_f32 v215,4.0,v207
M v[44:47],a[160:163],a[220:223],v[44:47]
buffer_load_dwordx4 a[144:147],v247,s[20:23],s48 offen offset:2048 sc1
M v[48:51],a[160:163],a[192:195],v[48:51]
s_add_u32 s48,s81,52224
v_fma_f32 v231,-4.0,v209,v213
v_fmac_f32 v205,s45,v213
M v[52:55],a[160:163],a[196:199],v[52:55]
v_fmac_f32 v215,s41,v211
v_sub_f32 v213,v213,v209
M v[56:59],a[160:163],a[200:203],v[56:59]
s_waitcnt lgkmcnt(0)
v_fma_f32 v209,-4.0,v207,v211
v_sub_f32 v211,v211,v207
M v[60:63],a[160:163],a[204:207],v[60:63]
s_waitcnt vmcnt(27)
buffer_load_dwordx4 a[236:239],v247,s[20:23],s48 offen offset:0 sc1
M v[64:67],a[224:227],a[208:211],v[64:67]
ds_read_b128 a[208:211],v245 offset:0
v_add_f32 v207,v231,v209
M v[68:71],a[224:227],a[212:215],v[68:71]
ds_read_b128 a[212:215],v246 offset:0
v_sub_f32 v231,v231,v209
M v[72:75],a[224:227],a[216:219],v[72:75]
ds_read_b128 a[216:219],v245 offset:512
v_fma_f32 v209,2.0,v211,v213
M v[76:79],a[224:227],a[220:223],v[76:79]
buffer_load_dwordx4 a[176:179],v247,s[20:23],s48 offen offset:1024 sc1
M v[80:83],a[224:227],a[192:195],v[80:83]
ds_read_b128 a[220:223],v246 offset:512
ds_read_b128 a[192:195],v245 offset:1024
M v[84:87],a[224:227],a[196:199],v[84:87]
ds_read_b128 a[196:199],v246 offset:1024
v_fmac_f32 v213,-2.0,v211
M v[88:91],a[224:227],a[200:203],v[88:91]
ds_read_b128 a[200:203],v245 offset:1536
v_cvt_pk_bf16_f32 v205,v228,v205
M v[92:95],a[224:227],a[204:207],v[92:95]
s_waitcnt vmcnt(28) lgkmcnt(6)
buffer_load_dwordx4 a[148:151],v247,s[20:23],s48 offen offset:2048 sc1
M v[160:163],a[132:135],a[208:211],v[160:163]
s_waitcnt lgkmcnt(5)
s_add_u32 s46,s76,9216
ds_read_b128 a[204:207],v246 offset:1536
ds_read_b128 a[208:211],v246 offset:2048
M v[164:167],a[132:135],a[212:215],v[164:167]
s_waitcnt lgkmcnt(6)
v_cvt_pk_bf16_f32 v215,v233,v215
v_cvt_pk_bf16_f32 v207,v229,v207
M v[168:171],a[132:135],a[216:219],v[168:171]
s_waitcnt lgkmcnt(5)
v_cvt_pk_bf16_f32 v211,v230,v209
v_cvt_pk_bf16_f32 v209,v234,v231
M v[172:175],a[132:135],a[220:223],v[172:175]
s_waitcnt lgkmcnt(4)
buffer_load_dwordx4 a[104:107],v247,s[20:23],s46 offen offset:0 sc1
M v[176:179],a[132:135],a[192:195],v[176:179]
s_waitcnt lgkmcnt(3)
s_add_u32 s47,s76,12288
v_cvt_pk_bf16_f32 v213,v232,v213
M v[180:183],a[132:135],a[196:199],v[180:183]
s_waitcnt lgkmcnt(2)
ds_write2st64_b64 v243,v[204:205],v[214:215] offset0:105 offset1:122
M v[184:187],a[132:135],a[200:203],v[184:187]
s_waitcnt lgkmcnt(2)
s_add_u32 s28,s65,6684672
buffer_load_dwordx2 v[204:205],v241,s[12:15],s28 offen offset:0
M v[188:191],a[132:135],a[204:207],v[188:191]
s_waitcnt vmcnt(29)
ds_write2st64_b64 v243,v[206:207],v[208:209] offset0:37 offset1:54
M v[160:163],a[112:115],a[212:215],v[160:163]
ds_read_b128 a[212:215],v245 offset:2048
ds_write2st64_b64 v243,v[210:211],v[212:213] offset0:71 offset1:88
M v[164:167],a[112:115],a[216:219],v[164:167]
s_barrier
v_cvt_pk_bf16_f32 v32,v32,v33
M v[168:171],a[112:115],a[220:223],v[168:171]
buffer_load_dwordx2 v[214:215],v241,s[16:19],s28 offen offset:1536
M v[172:175],a[112:115],a[192:195],v[172:175]
v_cvt_pk_bf16_f32 v33,v34,v35
v_cvt_pk_bf16_f32 v36,v36,v37
M v[176:179],a[112:115],a[196:199],v[176:179]
buffer_load_dwordx2 v[206:207],v241,s[8:11],s28 offen offset:0
M v[180:183],a[112:115],a[200:203],v[180:183]
v_add_u32 v245,0x15400,v245
v_add_u32 v246,0x15400,v246
M v[184:187],a[112:115],a[204:207],v[184:187]
s_waitcnt lgkmcnt(4)
v_cvt_pk_bf16_f32 v37,v38,v39
M v[188:191],a[112:115],a[208:211],v[188:191]
s_waitcnt vmcnt(30)
ds_write2st64_b64 v249,v[32:33],v[36:37] offset0:0 offset1:4
M v[160:163],a[136:139],a[216:219],v[160:163]
buffer_load_dwordx2 v[208:209],v241,s[8:11],s28 offen offset:384
M v[164:167],a[136:139],a[220:223],v[164:167]
ds_read_b128 a[216:219],v245 offset:0
ds_read_b128 a[220:223],v246 offset:0
M v[168:171],a[136:139],a[192:195],v[168:171]
ds_read_b128 a[192:195],v245 offset:512
v_cvt_pk_bf16_f32 v40,v40,v41
M v[172:175],a[136:139],a[196:199],v[172:175]
ds_read_b128 a[196:199],v246 offset:512
v_cvt_pk_bf16_f32 v41,v42,v43
M v[176:179],a[136:139],a[200:203],v[176:179]
buffer_load_dwordx2 v[210:211],v241,s[8:11],s28 offen offset:768
M v[180:183],a[136:139],a[204:207],v[180:183]
ds_read_b128 a[200:203],v245 offset:1024
ds_read_b128 a[204:207],v246 offset:1024
M v[184:187],a[136:139],a[208:211],v[184:187]
s_waitcnt lgkmcnt(8)
ds_read_b128 a[208:211],v245 offset:1536
v_cvt_pk_bf16_f32 v44,v44,v45
M v[188:191],a[136:139],a[212:215],v[188:191]
s_waitcnt vmcnt(30) lgkmcnt(6)
ds_read_b128 a[212:215],v246 offset:1536
v_cvt_pk_bf16_f32 v45,v46,v47
M v[160:163],a[164:167],a[216:219],v[160:163]
s_waitcnt lgkmcnt(6)
buffer_load_dwordx2 v[212:213],v241,s[8:11],s28 offen offset:1152
M v[164:167],a[164:167],a[220:223],v[164:167]
s_waitcnt lgkmcnt(5)
ds_read_b128 a[216:219],v246 offset:2048
ds_write2st64_b64 v249,v[40:41],v[44:45] offset0:8 offset1:12
M v[168:171],a[164:167],a[192:195],v[168:171]
s_waitcnt lgkmcnt(6)
v_cvt_pk_bf16_f32 v48,v48,v49
v_cvt_pk_bf16_f32 v49,v50,v51
M v[172:175],a[164:167],a[196:199],v[172:175]
s_waitcnt lgkmcnt(5)
buffer_load_dwordx4 a[120:123],v247,s[20:23],s47 offen offset:0 sc1
M v[176:179],a[164:167],a[200:203],v[176:179]
s_waitcnt lgkmcnt(4)
s_add_u32 s48,s76,15360
v_cvt_pk_bf16_f32 v52,v52,v53
v_cvt_pk_bf16_f32 v53,v54,v55
M v[180:183],a[164:167],a[204:207],v[180:183]
s_waitcnt lgkmcnt(3)
ds_write2st64_b64 v249,v[48:49],v[52:53] offset0:136 offset1:140
M v[184:187],a[164:167],a[208:211],v[184:187]
s_waitcnt lgkmcnt(3)
global_load_dword v251,v252,s[82:83]
M v[188:191],a[164:167],a[212:215],v[188:191]
s_waitcnt vmcnt(32)
v_cvt_pk_bf16_f32 v56,v56,v57
v_cvt_pk_bf16_f32 v57,v58,v59
M v[160:163],v[216:219],a[220:223],v[160:163]
buffer_load_dwordx4 a[152:155],v247,s[20:23],s48 offen offset:0 sc1
M v[164:167],v[216:219],a[192:195],v[164:167]
ds_read_b128 a[220:223],v245 offset:2048
v_cvt_pk_bf16_f32 v60,v60,v61
M v[168:171],v[216:219],a[196:199],v[168:171]
v_cvt_pk_bf16_f32 v61,v62,v63
M v[172:175],v[216:219],a[200:203],v[172:175]
ds_write2st64_b64 v249,v[56:57],v[60:61] offset0:144 offset1:148
M v[176:179],v[216:219],a[204:207],v[176:179]
buffer_load_dwordx4 a[180:183],v247,s[20:23],s46 offen offset:1024 sc1
M v[180:183],v[216:219],a[208:211],v[180:183]
v_cvt_pk_bf16_f32 v64,v64,v65
v_cvt_pk_bf16_f32 v65,v66,v67
M v[184:187],v[216:219],a[212:215],v[184:187]
s_waitcnt lgkmcnt(4)
v_cvt_pk_bf16_f32 v68,v68,v69
v_cvt_pk_bf16_f32 v69,v70,v71
M v[188:191],v[216:219],a[216:219],v[188:191]
s_waitcnt vmcnt(32)
buffer_load_dwordx4 a[124:127],v247,s[20:23],s47 offen offset:1024 sc1
M v[160:163],v[220:223],a[192:195],v[160:163]
ds_read_b128 a[192:195],v245 offset:17408
ds_write2st64_b64 v249,v[64:65],v[68:69] offset0:170 offset1:174
M v[164:167],v[220:223],a[196:199],v[164:167]
ds_read_b128 a[196:199],v246 offset:17408
v_cvt_pk_bf16_f32 v72,v72,v73
M v[168:171],v[220:223],a[200:203],v[168:171]
buffer_load_dwordx4 a[156:159],v247,s[20:23],s48 offen offset:1024 sc1
M v[172:175],v[220:223],a[204:207],v[172:175]
ds_read_b128 a[200:203],v245 offset:17920
ds_read_b128 a[204:207],v246 offset:17920
M v[176:179],v[220:223],a[208:211],v[176:179]
ds_read_b128 a[208:211],v245 offset:18432
v_cvt_pk_bf16_f32 v73,v74,v75
M v[180:183],v[220:223],a[212:215],v[180:183]
ds_read_b128 a[212:215],v246 offset:18432
v_cvt_pk_bf16_f32 v76,v76,v77
M v[184:187],v[220:223],a[216:219],v[184:187]
s_waitcnt lgkmcnt(8)
buffer_load_dwordx4 a[240:243],v247,s[20:23],s46 offen offset:2048 sc1
M v[188:191],v[220:223],a[220:223],v[188:191]
s_waitcnt vmcnt(34) lgkmcnt(6)
ds_read_b128 a[216:219],v245 offset:18944
ds_read_b128 a[220:223],v246 offset:18944
M v[160:163],a[140:143],a[192:195],v[160:163]
s_waitcnt lgkmcnt(6)
ds_read_b128 a[192:195],v246 offset:19456
v_cvt_pk_bf16_f32 v77,v78,v79
M v[164:167],a[140:143],a[196:199],v[164:167]
s_waitcnt lgkmcnt(6)
ds_write2st64_b64 v249,v[72:73],v[76:77] offset0:178 offset1:182
M v[168:171],a[140:143],a[200:203],v[168:171]
s_waitcnt lgkmcnt(6)
buffer_load_dwordx4 a[244:247],v247,s[20:23],s47 offen offset:2048 sc1
M v[172:175],a[140:143],a[204:207],v[172:175]
s_waitcnt lgkmcnt(5)
v_cvt_pk_bf16_f32 v80,v80,v81
v_cvt_pk_bf16_f32 v81,v82,v83
M v[176:179],a[140:143],a[208:211],v[176:179]
s_waitcnt lgkmcnt(4)
v_cvt_pk_bf16_f32 v84,v84,v85
v_cvt_pk_bf16_f32 v85,v86,v87
M v[180:183],a[140:143],a[212:215],v[180:183]
s_waitcnt lgkmcnt(3)
ds_write2st64_b64 v249,v[80:81],v[84:85] offset0:204 offset1:208
M v[184:187],a[140:143],a[216:219],v[184:187]
s_waitcnt lgkmcnt(3)
v_cvt_pk_bf16_f32 v88,v88,v89
v_cvt_pk_bf16_f32 v89,v90,v91
M v[188:191],a[140:143],a[220:223],v[188:191]
s_waitcnt vmcnt(34)
v_cvt_pk_bf16_f32 v92,v92,v93
v_cvt_pk_bf16_f32 v93,v94,v95
M v[160:163],a[100:103],a[196:199],v[160:163]
ds_read_b128 a[196:199],v245 offset:19456
ds_write2st64_b64 v249,v[88:89],v[92:93] offset0:212 offset1:216
M v[164:167],a[100:103],a[200:203],v[164:167]
M v[168:171],a[100:103],a[204:207],v[168:171]
buffer_load_dwordx4 a[184:187],v247,s[20:23],s48 offen offset:2048 sc1
M v[172:175],a[100:103],a[208:211],v[172:175]
s_waitcnt lgkmcnt(0)
s_barrier
ds_read_b128 v[32:35],v247 offset:0
M v[176:179],a[100:103],a[212:215],v[176:179]
s_add_u32 s46,s76,18432
ds_read_b128 v[40:43],v247 offset:4096
ds_read_b128 v[48:51],v4 offset:0
M v[180:183],a[100:103],a[216:219],v[180:183]
ds_read_b128 v[56:59],v4 offset:4096
ds_read_b128 v[64:67],v4 offset:17408
M v[184:187],a[100:103],a[220:223],v[184:187]
ds_read_b128 v[72:75],v4 offset:21504
ds_read_b128 v[80:83],v4 offset:34816
M v[188:191],a[100:103],a[192:195],v[188:191]
s_waitcnt vmcnt(27)
ds_read_b128 v[88:91],v4 offset:38912
M v[160:163],a[168:171],a[200:203],v[160:163]
s_waitcnt lgkmcnt(7)
s_add_u32 s34,s33,0
buffer_store_dwordx4 v[32:35],v248,s[24:27],s34 offen offset:128 nt
M v[164:167],a[168:171],a[204:207],v[164:167]
s_waitcnt lgkmcnt(6)
s_add_u32 s34,s33,393216
buffer_store_dwordx4 v[40:43],v248,s[24:27],s34 offen offset:128 nt
M v[168:171],a[168:171],a[208:211],v[168:171]
s_add_u32 s34,s33,786432
ds_read_b128 a[200:203],v245 offset:34816
ds_read_b128 a[204:207],v246 offset:34816
M v[172:175],a[168:171],a[212:215],v[172:175]
ds_read_b128 a[208:211],v245 offset:35328
ds_read_b128 a[212:215],v246 offset:35328
M v[176:179],a[168:171],a[216:219],v[176:179]
s_waitcnt lgkmcnt(9)
buffer_store_dwordx4 v[48:51],v248,s[24:27],s34 offen offset:128 nt
M v[180:183],a[168:171],a[220:223],v[180:183]
s_add_u32 s34,s33,1179648
ds_read_b128 a[216:219],v245 offset:35840
ds_read_b128 a[220:223],v246 offset:35840
M v[184:187],a[168:171],a[192:195],v[184:187]
ds_read_b128 a[192:195],v245 offset:36352
M v[188:191],a[168:171],a[196:199],v[188:191]
s_waitcnt vmcnt(29) lgkmcnt(6)
buffer_store_dwordx4 v[56:59],v248,s[24:27],s34 offen offset:128 nt
M v[160:163],a[116:119],a[200:203],v[160:163]
s_waitcnt lgkmcnt(5)
s_add_u32 s34,s33,0
ds_read_b128 a[196:199],v246 offset:36352
ds_read_b128 a[200:203],v246 offset:36864
M v[164:167],a[116:119],a[204:207],v[164:167]
s_waitcnt lgkmcnt(6)
M v[168:171],a[116:119],a[208:211],v[168:171]
s_waitcnt lgkmcnt(5)
buffer_store_dwordx4 v[64:67],v248,s[24:27],s34 offen offset:256 nt
M v[172:175],a[116:119],a[212:215],v[172:175]
s_waitcnt lgkmcnt(4)
s_add_u32 s34,s33,393216
M v[176:179],a[116:119],a[216:219],v[176:179]
s_waitcnt lgkmcnt(3)
M v[180:183],a[116:119],a[220:223],v[180:183]
s_waitcnt lgkmcnt(2)
buffer_store_dwordx4 v[72:75],v248,s[24:27],s34 offen offset:256 nt
M v[184:187],a[116:119],a[192:195],v[184:187]
s_waitcnt lgkmcnt(1)
s_add_u32 s34,s33,786432
M v[188:191],a[116:119],a[196:199],v[188:191]
s_waitcnt vmcnt(30)
M v[160:163],v[224:227],a[204:207],v[160:163]
buffer_load_dwordx4 a[248:251],v247,s[20:23],s46 offen offset:0 sc1
M v[164:167],v[224:227],a[208:211],v[164:167]
s_add_u32 s47,s76,21504
ds_read_b128 a[204:207],v245 offset:36864
M v[168:171],v[224:227],a[212:215],v[168:171]
M v[172:175],v[224:227],a[216:219],v[172:175]
M v[176:179],v[224:227],a[220:223],v[176:179]
buffer_store_dwordx4 v[80:83],v248,s[24:27],s34 offen offset:256 nt
M v[180:183],v[224:227],a[192:195],v[180:183]
M v[184:187],v[224:227],a[196:199],v[184:187]
s_waitcnt lgkmcnt(1)
s_add_u32 s34,s33,1179648
M v[188:191],v[224:227],a[200:203],v[188:191]
s_waitcnt vmcnt(31)
buffer_load_dwordx4 a[188:191],v247,s[20:23],s47 offen offset:0 sc1
M v[160:163],a[228:231],a[208:211],v[160:163]
s_add_u32 s48,s76,24576
ds_read_b128 a[208:211],v245 offset:52224
M v[164:167],a[228:231],a[212:215],v[164:167]
ds_read_b128 a[212:215],v246 offset:52224
M v[168:171],a[228:231],a[216:219],v[168:171]
ds_read_b128 a[216:219],v245 offset:52736
M v[172:175],a[228:231],a[220:223],v[172:175]
buffer_load_dwordx4 a[252:255],v247,s[20:23],s48 offen offset:0 sc1
M v[176:179],a[228:231],a[192:195],v[176:179]
ds_read_b128 a[220:223],v246 offset:52736
ds_read_b128 a[192:195],v245 offset:53248
M v[180:183],a[228:231],a[196:199],v[180:183]
ds_read_b128 a[196:199],v246 offset:53248
M v[184:187],a[228:231],a[200:203],v[184:187]
s_waitcnt lgkmcnt(6)
ds_read_b128 a[200:203],v245 offset:53760
M v[188:191],a[228:231],a[204:207],v[188:191]
s_waitcnt vmcnt(31) lgkmcnt(6)
buffer_store_dwordx4 v[88:91],v248,s[24:27],s34 offen offset:256 nt
M v[160:163],a[172:175],a[208:211],v[160:163]
s_waitcnt lgkmcnt(5)
ds_read_b128 a[204:207],v246 offset:53760
ds_read_b128 a[208:211],v246 offset:54272
M v[164:167],a[172:175],a[212:215],v[164:167]
s_waitcnt lgkmcnt(6)
M v[168:171],a[172:175],a[216:219],v[168:171]
s_waitcnt lgkmcnt(5)
buffer_load_dwordx4 a[224:227],v247,s[20:23],s46 offen offset:1024 sc1
M v[172:175],a[172:175],a[220:223],v[172:175]
s_waitcnt lgkmcnt(4)
M v[176:179],a[172:175],a[192:195],v[176:179]
s_waitcnt lgkmcnt(3)
M v[180:183],a[172:175],a[196:199],v[180:183]
s_waitcnt lgkmcnt(2)
M v[184:187],a[172:175],a[200:203],v[184:187]
s_waitcnt lgkmcnt(1)
buffer_load_dwordx4 v[216:219],v247,s[20:23],s47 offen offset:1024 sc1
M v[188:191],a[172:175],a[204:207],v[188:191]
s_waitcnt vmcnt(33)
M v[160:163],a[232:235],a[212:215],v[160:163]
ds_read_b128 a[212:215],v245 offset:54272
M v[164:167],a[232:235],a[216:219],v[164:167]
M v[168:171],a[232:235],a[220:223],v[168:171]
buffer_load_dwordx4 v[220:223],v247,s[20:23],s48 offen offset:1024 sc1
M v[172:175],a[232:235],a[192:195],v[172:175]
M v[176:179],a[232:235],a[196:199],v[176:179]
M v[180:183],a[232:235],a[200:203],v[180:183]
v_add_u32 v245,0xfffece00,v245
v_add_u32 v246,0xfffece00,v246
M v[184:187],a[232:235],a[204:207],v[184:187]
s_waitcnt lgkmcnt(1)
M v[188:191],a[232:235],a[208:211],v[188:191]
s_waitcnt vmcnt(33)
M v[160:163],a[144:147],a[216:219],v[160:163]
ds_read_b128 a[216:219],v245 offset:60928
M v[164:167],a[144:147],a[220:223],v[164:167]
ds_read_b128 a[220:223],v246 offset:60928
M v[168:171],a[144:147],a[192:195],v[168:171]
buffer_load_dwordx4 v[224:227],v247,s[20:23],s46 offen offset:2048 sc1
M v[172:175],a[144:147],a[196:199],v[172:175]
ds_read_b128 a[192:195],v245 offset:61440
ds_read_b128 a[196:199],v246 offset:61440
M v[176:179],a[144:147],a[200:203],v[176:179]
ds_read_b128 a[200:203],v245 offset:61952
M v[180:183],a[144:147],a[204:207],v[180:183]
ds_read_b128 a[204:207],v246 offset:61952
M v[184:187],a[144:147],a[208:211],v[184:187]
s_waitcnt lgkmcnt(6)
ds_read_b128 a[208:211],v245 offset:62464
M v[188:191],a[144:147],a[212:215],v[188:191]
s_waitcnt vmcnt(33) lgkmcnt(6)
ds_read_b128 a[212:215],v246 offset:62464
M v[160:163],a[236:239],a[216:219],v[160:163]
s_waitcnt lgkmcnt(6)
ds_read_b128 a[216:219],v246 offset:62976
M v[164:167],a[236:239],a[220:223],v[164:167]
s_waitcnt lgkmcnt(6)
M v[168:171],a[236:239],a[192:195],v[168:171]
s_waitcnt lgkmcnt(5)
buffer_load_dwordx4 a[228:231],v247,s[20:23],s47 offen offset:2048 sc1
M v[172:175],a[236:239],a[196:199],v[172:175]
s_waitcnt lgkmcnt(4)
M v[176:179],a[236:239],a[200:203],v[176:179]
s_waitcnt lgkmcnt(3)
M v[180:183],a[236:239],a[204:207],v[180:183]
s_waitcnt lgkmcnt(2)
M v[184:187],a[236:239],a[208:211],v[184:187]
s_waitcnt lgkmcnt(1)
M v[188:191],a[236:239],a[212:215],v[188:191]
s_waitcnt vmcnt(33)
M v[160:163],a[176:179],a[220:223],v[160:163]
ds_read_b128 a[220:223],v245 offset:62976
M v[164:167],a[176:179],a[192:195],v[164:167]
M v[168:171],a[176:179],a[196:199],v[168:171]
buffer_load_dwordx4 a[232:235],v247,s[20:23],s48 offen offset:2048 sc1
M v[172:175],a[176:179],a[200:203],v[172:175]
M v[176:179],a[176:179],a[204:207],v[176:179]
s_add_u32 s46,s76,27648
M v[180:183],a[176:179],a[208:211],v[180:183]
M v[184:187],a[176:179],a[212:215],v[184:187]
s_waitcnt lgkmcnt(0)
s_barrier
M v[188:191],a[176:179],a[216:219],v[188:191]
s_waitcnt vmcnt(33)
M v[160:163],a[148:151],a[192:195],v[160:163]
ds_read_b128 a[192:195],v245 offset:0
M v[164:167],a[148:151],a[196:199],v[164:167]
ds_read_b128 a[196:199],v246 offset:0
M v[168:171],a[148:151],a[200:203],v[168:171]
buffer_load_dwordx4 a[236:239],v247,s[20:23],s46 offen offset:0 sc1
M v[172:175],a[148:151],a[204:207],v[172:175]
ds_read_b128 a[200:203],v245 offset:512
ds_read_b128 a[204:207],v246 offset:512
M v[176:179],a[148:151],a[208:211],v[176:179]
ds_read_b128 a[208:211],v245 offset:1024
v_cvt_pk_bf16_f32 v160,v160,v161
M v[180:183],a[148:151],a[212:215],v[180:183]
ds_read_b128 a[212:215],v246 offset:1024
v_cvt_pk_bf16_f32 v161,v162,v163
M v[184:187],a[148:151],a[216:219],v[184:187]
ds_read_b128 a[216:219],v245 offset:1536
v_cvt_pk_bf16_f32 v164,v164,v165
M v[188:191],a[148:151],a[220:223],v[188:191]
s_waitcnt vmcnt(33) lgkmcnt(6)
ds_read_b128 a[220:223],v246 offset:1536
v_cvt_pk_bf16_f32 v165,v166,v167
M a[0:3],a[104:107],a[192:195],0
s_waitcnt lgkmcnt(6)
ds_write2st64_b64 v249,v[160:161],v[164:165] offset0:221 offset1:225
M a[4:7],a[104:107],a[196:199],0
s_waitcnt lgkmcnt(6)
v_cvt_pk_bf16_f32 v168,v168,v169
v_cvt_pk_bf16_f32 v169,v170,v171
M a[8:11],a[104:107],a[200:203],0
s_waitcnt lgkmcnt(5)
v_cvt_pk_bf16_f32 v172,v172,v173
v_cvt_pk_bf16_f32 v173,v174,v175
M a[12:15],a[104:107],a[204:207],0
s_waitcnt lgkmcnt(4)
ds_write2st64_b64 v249,v[168:169],v[172:173] offset0:229 offset1:233
M a[16:19],a[104:107],a[208:211],0
s_waitcnt lgkmcnt(4)
v_cvt_pk_bf16_f32 v176,v176,v177
v_cvt_pk_bf16_f32 v177,v178,v179
M a[20:23],a[104:107],a[212:215],0
s_waitcnt lgkmcnt(3)
v_cvt_pk_bf16_f32 v180,v180,v181
v_cvt_pk_bf16_f32 v181,v182,v183
M a[24:27],a[104:107],a[216:219],0
s_waitcnt lgkmcnt(2)
ds_write2st64_b64 v249,v[176:177],v[180:181] offset0:238 offset1:242
M a[28:31],a[104:107],a[220:223],0
s_waitcnt vmcnt(26)
v_cvt_pk_bf16_f32 v184,v184,v185
v_cvt_pk_bf16_f32 v185,v186,v187
M a[32:35],a[120:123],a[192:195],0
v_cvt_pk_bf16_f32 v188,v188,v189
v_cvt_pk_bf16_f32 v189,v190,v191
M a[36:39],a[120:123],a[196:199],0
ds_write2st64_b64 v249,v[184:185],v[188:189] offset0:246 offset1:250
M a[40:43],a[120:123],a[200:203],0
v_lshlrev_b32 v230,16,v196
v_lshlrev_b32 v228,16,v192
M a[44:47],a[120:123],a[204:207],0
v_lshlrev_b32 v229,16,v194
v_lshlrev_b32 v233,16,v202
M a[48:51],a[120:123],a[208:211],0
v_lshlrev_b32 v232,16,v200
v_lshlrev_b32 v231,16,v198
M a[52:55],a[120:123],a[212:215],0
s_waitcnt lgkmcnt(0)
s_barrier
ds_read_b128 v[160:163],v4 offset:43520
M a[56:59],a[120:123],a[216:219],0
ds_read_b128 v[168:171],v4 offset:47616
ds_read_b128 v[176:179],v4 offset:52224
M a[60:63],a[120:123],a[220:223],0
s_waitcnt vmcnt(24)
ds_read_b128 v[184:187],v4 offset:56320
v_fmac_f32 v228,s43,v230
M a[64:67],a[152:155],a[192:195],0
ds_read_b128 a[192:195],v246 offset:2048
v_fmac_f32 v233,4.0,v229
M a[68:71],a[152:155],a[196:199],0
v_fma_f32 v234,-4.0,v230,v232
v_fmac_f32 v228,s45,v232
M a[72:75],a[152:155],a[200:203],0
s_waitcnt lgkmcnt(4)
s_add_u32 s34,s33,0
buffer_store_dwordx4 v[160:163],v248,s[24:27],s34 offen offset:1408 nt
M a[76:79],a[152:155],a[204:207],0
s_waitcnt lgkmcnt(3)
s_add_u32 s34,s33,393216
buffer_store_dwordx4 v[168:171],v248,s[24:27],s34 offen offset:1408 nt
M a[80:83],a[152:155],a[208:211],0
s_add_u32 s34,s33,786432
v_fmac_f32 v233,s41,v231
v_sub_f32 v232,v232,v230
M a[84:87],a[152:155],a[212:215],0
v_fma_f32 v230,-4.0,v229,v231
v_sub_f32 v231,v231,v229
M a[88:91],a[152:155],a[216:219],0
s_waitcnt lgkmcnt(2)
buffer_store_dwordx4 v[176:179],v248,s[24:27],s34 offen offset:1408 nt
M a[92:95],a[152:155],a[220:223],0
s_waitcnt vmcnt(26)
s_add_u32 s34,s33,1179648
v_add_f32 v229,v234,v230
v_sub_f32 v234,v234,v230
M a[0:3],a[180:183],a[196:199],a[0:3]
v_fma_f32 v230,2.0,v231,v232
v_fmac_f32 v232,-2.0,v231
M a[4:7],a[180:183],a[200:203],a[4:7]
s_waitcnt lgkmcnt(1)
buffer_store_dwordx4 v[184:187],v248,s[24:27],s34 offen offset:1408 nt
M a[8:11],a[180:183],a[204:207],a[8:11]
v_and_b32 v196,s42,v196
v_and_b32 v192,s42,v192
M a[12:15],a[180:183],a[208:211],a[12:15]
v_and_b32 v194,s42,v194
v_and_b32 v202,s42,v202
M a[16:19],a[180:183],a[212:215],a[16:19]
v_and_b32 v200,s42,v200
v_and_b32 v198,s42,v198
M a[20:23],a[180:183],a[216:219],a[20:23]
v_fmac_f32 v192,s43,v196
v_fmac_f32 v202,4.0,v194
M a[24:27],a[180:183],a[220:223],a[24:27]
s_waitcnt lgkmcnt(0)
v_fma_f32 v231,-4.0,v196,v200
v_fmac_f32 v192,s45,v200
M a[28:31],a[180:183],a[192:195],a[28:31]
s_waitcnt vmcnt(26)
v_fmac_f32 v202,s41,v198
v_sub_f32 v200,v200,v196
M a[32:35],a[124:127],a[196:199],a[32:35]
v_fma_f32 v196,-4.0,v194,v198
v_sub_f32 v198,v198,v194
M a[36:39],a[124:127],a[200:203],a[36:39]
v_add_f32 v194,v231,v196
v_sub_f32 v231,v231,v196
M a[40:43],a[124:127],a[204:207],a[40:43]
v_fma_f32 v196,2.0,v198,v200
v_fmac_f32 v200,-2.0,v198
M a[44:47],a[124:127],a[208:211],a[44:47]
v_cvt_pk_bf16_f32 v192,v228,v192
v_cvt_pk_bf16_f32 v202,v233,v202
M a[48:51],a[124:127],a[212:215],a[48:51]
v_cvt_pk_bf16_f32 v194,v229,v194
v_cvt_pk_bf16_f32 v198,v230,v196
M a[52:55],a[124:127],a[216:219],a[52:55]
v_cvt_pk_bf16_f32 v196,v234,v231
v_cvt_pk_bf16_f32 v200,v232,v200
M a[56:59],a[124:127],a[220:223],a[56:59]
v_lshlrev_b32 v230,16,v197
v_lshlrev_b32 v228,16,v193
M a[60:63],a[124:127],a[192:195],a[60:63]
s_waitcnt vmcnt(25)
v_lshlrev_b32 v229,16,v195
v_lshlrev_b32 v233,16,v203
M a[64:67],a[156:159],a[196:199],a[64:67]
ds_read_b128 a[196:199],v245 offset:2048
v_lshlrev_b32 v232,16,v201
M a[68:71],a[156:159],a[200:203],a[68:71]
v_lshlrev_b32 v231,16,v199
v_fmac_f32 v228,s43,v230
M a[72:75],a[156:159],a[204:207],a[72:75]
v_fmac_f32 v233,4.0,v229
v_fma_f32 v234,-4.0,v230,v232
M a[76:79],a[156:159],a[208:211],a[76:79]
v_fmac_f32 v228,s45,v232
v_fmac_f32 v233,s41,v231
M a[80:83],a[156:159],a[212:215],a[80:83]
v_sub_f32 v232,v232,v230
v_fma_f32 v230,-4.0,v229,v231
M a[84:87],a[156:159],a[216:219],a[84:87]
v_sub_f32 v231,v231,v229
v_add_f32 v229,v234,v230
M a[88:91],a[156:159],a[220:223],a[88:91]
v_sub_f32 v234,v234,v230
v_fma_f32 v230,2.0,v231,v232
M a[92:95],a[156:159],a[192:195],a[92:95]
s_waitcnt vmcnt(24)
v_fmac_f32 v232,-2.0,v231
v_and_b32 v197,s42,v197
M a[0:3],a[240:243],a[200:203],a[0:3]
v_and_b32 v193,s42,v193
v_and_b32 v195,s42,v195
M a[4:7],a[240:243],a[204:207],a[4:7]
s_add_u32 s47,s76,30720
v_and_b32 v203,s42,v203
v_and_b32 v201,s42,v201
M a[8:11],a[240:243],a[208:211],a[8:11]
v_and_b32 v199,s42,v199
v_fmac_f32 v193,s43,v197
M a[12:15],a[240:243],a[212:215],a[12:15]
v_fmac_f32 v203,4.0,v195
v_fma_f32 v231,-4.0,v197,v201
M a[16:19],a[240:243],a[216:219],a[16:19]
v_fmac_f32 v193,s45,v201
v_fmac_f32 v203,s41,v199
M a[20:23],a[240:243],a[220:223],a[20:23]
v_sub_f32 v201,v201,v197
v_fma_f32 v197,-4.0,v195,v199
M a[24:27],a[240:243],a[192:195],a[24:27]
s_waitcnt lgkmcnt(0)
v_sub_f32 v199,v199,v195
v_add_f32 v195,v231,v197
M a[28:31],a[240:243],a[196:199],a[28:31]
s_waitcnt vmcnt(23)
buffer_load_dwordx4 a[240:243],v247,s[20:23],s47 offen offset:0 sc1
M a[32:35],a[244:247],a[200:203],a[32:35]
v_sub_f32 v231,v231,v197
v_fma_f32 v197,2.0,v199,v201
M a[36:39],a[244:247],a[204:207],a[36:39]
s_add_u32 s48,s76,33792
v_fmac_f32 v201,-2.0,v199
v_cvt_pk_bf16_f32 v193,v228,v193
M a[40:43],a[244:247],a[208:211],a[40:43]
v_cvt_pk_bf16_f32 v203,v233,v203
v_cvt_pk_bf16_f32 v195,v229,v195
M a[44:47],a[244:247],a[212:215],a[44:47]
v_cvt_pk_bf16_f32 v199,v230,v197
v_cvt_pk_bf16_f32 v197,v234,v231
M a[48:51],a[244:247],a[216:219],a[48:51]
v_cvt_pk_bf16_f32 v201,v232,v201
M a[52:55],a[244:247],a[220:223],a[52:55]
ds_write2st64_b64 v243,v[192:193],v[202:203] offset0:170 offset1:187
M a[56:59],a[244:247],a[192:195],a[56:59]
s_add_u32 s28,s65,7077888
buffer_load_dwordx2 v[192:193],v241,s[12:15],s28 offen offset:0
M a[60:63],a[244:247],a[196:199],a[60:63]
s_waitcnt vmcnt(24)
ds_write2st64_b64 v243,v[194:195],v[196:197] offset0:0 offset1:17
M a[64:67],a[184:187],a[200:203],a[64:67]
buffer_load_dwordx2 v[202:203],v241,s[16:19],s28 offen offset:1536
M a[68:71],a[184:187],a[204:207],a[68:71]
ds_read_b128 a[200:203],v245 offset:8704
ds_read_b128 a[204:207],v246 offset:8704
M a[72:75],a[184:187],a[208:211],a[72:75]
ds_read_b128 a[208:211],v245 offset:9216
ds_write2st64_b64 v243,v[198:199],v[200:201] offset0:136 offset1:153
M a[76:79],a[184:187],a[212:215],a[76:79]
buffer_load_dwordx2 v[194:195],v241,s[8:11],s28 offen offset:0
M a[80:83],a[184:187],a[216:219],a[80:83]
ds_read_b128 a[212:215],v246 offset:9216
ds_read_b128 a[216:219],v245 offset:9728
M a[84:87],a[184:187],a[220:223],a[84:87]
ds_read_b128 a[220:223],v246 offset:9728
v_lshlrev_b32 v230,16,v208
M a[88:91],a[184:187],a[192:195],a[88:91]
ds_read_b128 a[192:195],v245 offset:10240
v_lshlrev_b32 v228,16,v204
M a[92:95],a[184:187],a[196:199],a[92:95]
s_waitcnt vmcnt(19) lgkmcnt(7)
buffer_load_dwordx2 v[196:197],v241,s[8:11],s28 offen offset:384
M a[96:99],a[248:251],a[200:203],0
s_waitcnt lgkmcnt(6)
ds_read_b128 a[196:199],v246 offset:10240
v_lshlrev_b32 v229,16,v206
M a[100:103],a[248:251],a[204:207],0
s_waitcnt lgkmcnt(6)
v_lshlrev_b32 v233,16,v214
v_lshlrev_b32 v232,16,v212
M a[104:107],a[248:251],a[208:211],0
s_waitcnt lgkmcnt(4)
v_lshlrev_b32 v231,16,v210
v_fmac_f32 v228,s43,v230
M a[108:111],a[248:251],a[212:215],0
s_waitcnt lgkmcnt(3)
buffer_load_dwordx2 v[198:199],v241,s[8:11],s28 offen offset:768
M a[112:115],a[248:251],a[216:219],0
s_waitcnt lgkmcnt(2)
v_fmac_f32 v233,4.0,v229
v_fma_f32 v234,-4.0,v230,v232
M a[116:119],a[248:251],a[220:223],0
s_waitcnt lgkmcnt(1)
v_fmac_f32 v228,s45,v232
v_fmac_f32 v233,s41,v231
M a[120:123],a[248:251],a[192:195],0
s_waitcnt lgkmcnt(0)
v_sub_f32 v232,v232,v230
v_fma_f32 v230,-4.0,v229,v231
M a[124:127],a[248:251],a[196:199],0
s_waitcnt vmcnt(19)
buffer_load_dwordx2 v[200:201],v241,s[8:11],s28 offen offset:1152
M a[128:131],a[188:191],a[200:203],0
v_sub_f32 v231,v231,v229
v_add_f32 v229,v234,v230
M a[132:135],a[188:191],a[204:207],0
v_sub_f32 v234,v234,v230
v_fma_f32 v230,2.0,v231,v232
M a[136:139],a[188:191],a[208:211],0
v_fmac_f32 v232,-2.0,v231
v_and_b32 v208,s42,v208
M a[140:143],a[188:191],a[212:215],0
buffer_load_dwordx4 a[244:247],v247,s[20:23],s48 offen offset:0 sc1
M a[144:147],a[188:191],a[216:219],0
v_and_b32 v204,s42,v204
v_and_b32 v206,s42,v206
M a[148:151],a[188:191],a[220:223],0
v_and_b32 v214,s42,v214
v_and_b32 v212,s42,v212
M a[152:155],a[188:191],a[192:195],0
v_and_b32 v210,s42,v210
v_fmac_f32 v204,s43,v208
M a[156:159],a[188:191],a[196:199],0
s_waitcnt vmcnt(20)
buffer_load_dwordx4 a[248:251],v247,s[20:23],s46 offen offset:1024 sc1
M a[160:163],a[252:255],a[200:203],0
ds_read_b128 a[200:203],v246 offset:10752
v_fmac_f32 v214,4.0,v206
M a[164:167],a[252:255],a[204:207],0
v_fma_f32 v231,-4.0,v208,v212
v_fmac_f32 v204,s45,v212
M a[168:171],a[252:255],a[208:211],0
v_fmac_f32 v214,s41,v210
v_sub_f32 v212,v212,v208
M a[172:175],a[252:255],a[212:215],0
v_fma_f32 v208,-4.0,v206,v210
v_sub_f32 v210,v210,v206
M a[176:179],a[252:255],a[216:219],0
v_add_f32 v206,v231,v208
v_sub_f32 v231,v231,v208
M a[180:183],a[252:255],a[220:223],0
v_fma_f32 v208,2.0,v210,v212
v_fmac_f32 v212,-2.0,v210
M a[184:187],a[252:255],a[192:195],0
v_cvt_pk_bf16_f32 v204,v228,v204
v_cvt_pk_bf16_f32 v214,v233,v214
M a[188:191],a[252:255],a[196:199],0
s_waitcnt vmcnt(19)
buffer_load_dwordx4 a[252:255],v247,s[20:23],s47 offen offset:1024 sc1
M a[96:99],a[224:227],a[204:207],a[96:99]
v_cvt_pk_bf16_f32 v206,v229,v206
v_cvt_pk_bf16_f32 v210,v230,v208
M a[100:103],a[224:227],a[208:211],a[100:103]
v_cvt_pk_bf16_f32 v208,v234,v231
v_cvt_pk_bf16_f32 v212,v232,v212
M a[104:107],a[224:227],a[212:215],a[104:107]
v_lshlrev_b32 v230,16,v209
v_lshlrev_b32 v228,16,v205
M a[108:111],a[224:227],a[216:219],a[108:111]
v_lshlrev_b32 v229,16,v207
v_lshlrev_b32 v233,16,v215
M a[112:115],a[224:227],a[220:223],a[112:115]
v_lshlrev_b32 v232,16,v213
v_lshlrev_b32 v231,16,v211
M a[116:119],a[224:227],a[192:195],a[116:119]
v_fmac_f32 v228,s43,v230
v_fmac_f32 v233,4.0,v229
M a[120:123],a[224:227],a[196:199],a[120:123]
s_waitcnt lgkmcnt(0)
v_fma_f32 v234,-4.0,v230,v232
v_fmac_f32 v228,s45,v232
M a[124:127],a[224:227],a[200:203],a[124:127]
s_waitcnt vmcnt(19)
buffer_load_dwordx4 a[224:227],v247,s[20:23],s48 offen offset:1024 sc1
M a[128:131],v[216:219],a[204:207],a[128:131]
v_fmac_f32 v233,s41,v231
v_sub_f32 v232,v232,v230
M a[132:135],v[216:219],a[208:211],a[132:135]
v_fma_f32 v230,-4.0,v229,v231
v_sub_f32 v231,v231,v229
M a[136:139],v[216:219],a[212:215],a[136:139]
v_add_f32 v229,v234,v230
v_sub_f32 v234,v234,v230
M a[140:143],v[216:219],a[216:219],a[140:143]
v_fma_f32 v230,2.0,v231,v232
v_fmac_f32 v232,-2.0,v231
M a[144:147],v[216:219],a[220:223],a[144:147]
v_and_b32 v209,s42,v209
v_and_b32 v205,s42,v205
M a[148:151],v[216:219],a[192:195],a[148:151]
v_and_b32 v207,s42,v207
v_and_b32 v215,s42,v215
M a[152:155],v[216:219],a[196:199],a[152:155]
v_and_b32 v213,s42,v213
v_and_b32 v211,s42,v211
M a[156:159],v[216:219],a[200:203],a[156:159]
s_waitcnt vmcnt(19)
buffer_load_dwordx4 v[216:219],v247,s[20:23],s46 offen offset:2048 sc1
M a[160:163],v[220:223],a[204:207],a[160:163]
ds_read_b128 a[204:207],v245 offset:10752
v_fmac_f32 v205,s43,v209
M a[164:167],v[220:223],a[208:211],a[164:167]
v_fmac_f32 v215,4.0,v207
v_fma_f32 v231,-4.0,v209,v213
M a[168:171],v[220:223],a[212:215],a[168:171]
v_fmac_f32 v205,s45,v213
v_fmac_f32 v215,s41,v211
M a[172:175],v[220:223],a[216:219],a[172:175]
v_sub_f32 v213,v213,v209
v_fma_f32 v209,-4.0,v207,v211
M a[176:179],v[220:223],a[220:223],a[176:179]
v_sub_f32 v211,v211,v207
v_add_f32 v207,v231,v209
M a[180:183],v[220:223],a[192:195],a[180:183]
v_sub_f32 v231,v231,v209
v_fma_f32 v209,2.0,v211,v213
M a[184:187],v[220:223],a[196:199],a[184:187]
v_fmac_f32 v213,-2.0,v211
v_cvt_pk_bf16_f32 v205,v228,v205
M a[188:191],v[220:223],a[200:203],a[188:191]
s_waitcnt vmcnt(19)
buffer_load_dwordx4 v[220:223],v247,s[20:23],s47 offen offset:2048 sc1
M a[96:99],v[224:227],a[208:211],a[96:99]
v_cvt_pk_bf16_f32 v215,v233,v215
v_cvt_pk_bf16_f32 v207,v229,v207
M a[100:103],v[224:227],a[212:215],a[100:103]
v_cvt_pk_bf16_f32 v211,v230,v209
v_cvt_pk_bf16_f32 v209,v234,v231
M a[104:107],v[224:227],a[216:219],a[104:107]
v_cvt_pk_bf16_f32 v213,v232,v213
M a[108:111],v[224:227],a[220:223],a[108:111]
ds_write2st64_b64 v243,v[204:205],v[214:215] offset0:171 offset1:188
M a[112:115],v[224:227],a[192:195],a[112:115]
s_add_u32 s28,s65,7471104
buffer_load_dwordx2 v[204:205],v241,s[12:15],s28 offen offset:0
M a[116:119],v[224:227],a[196:199],a[116:119]
ds_write2st64_b64 v243,v[206:207],v[208:209] offset0:1 offset1:18
M a[120:123],v[224:227],a[200:203],a[120:123]
s_waitcnt lgkmcnt(2)
buffer_load_dwordx2 v[214:215],v241,s[16:19],s28 offen offset:1536
M a[124:127],v[224:227],a[204:207],a[124:127]
s_waitcnt vmcnt(21)
ds_write2st64_b64 v243,v[210:211],v[212:213] offset0:137 offset1:154
M a[128:131],a[228:231],a[208:211],a[128:131]
v_fmac_f32 v235,s43,v237
v_fmac_f32 v240,4.0,v236
M a[132:135],a[228:231],a[212:215],a[132:135]
buffer_load_dwordx2 v[206:207],v241,s[8:11],s28 offen offset:0
M a[136:139],a[228:231],a[216:219],a[136:139]
v_fma_f32 v228,-4.0,v237,v239
v_fmac_f32 v235,s45,v239
M a[140:143],a[228:231],a[220:223],a[140:143]
v_fmac_f32 v240,s41,v238
v_sub_f32 v239,v239,v237
M a[144:147],a[228:231],a[192:195],a[144:147]
v_fma_f32 v237,-4.0,v236,v238
v_sub_f32 v238,v238,v236
M a[148:151],a[228:231],a[196:199],a[148:151]
buffer_load_dwordx2 v[208:209],v241,s[8:11],s28 offen offset:384
M a[152:155],a[228:231],a[200:203],a[152:155]
v_add_f32 v236,v228,v237
v_sub_f32 v228,v228,v237
M a[156:159],a[228:231],a[204:207],a[156:159]
s_waitcnt vmcnt(22)
v_fma_f32 v237,2.0,v238,v239
v_fmac_f32 v239,-2.0,v238
M a[160:163],a[232:235],a[208:211],a[160:163]
ds_read_b128 a[208:211],v245 offset:17408
v_cvt_pk_bf16_f32 v229,v235,v240
M a[164:167],a[232:235],a[212:215],a[164:167]
buffer_load_dwordx2 v[210:211],v241,s[8:11],s28 offen offset:768
M a[168:171],a[232:235],a[216:219],a[168:171]
ds_read_b128 a[212:215],v246 offset:17408
ds_read_b128 a[216:219],v245 offset:17920
M a[172:175],a[232:235],a[220:223],a[172:175]
ds_read_b128 a[220:223],v246 offset:17920
v_cvt_pk_bf16_f32 v230,v236,v228
M a[176:179],a[232:235],a[192:195],a[176:179]
ds_read_b128 a[192:195],v245 offset:18432
v_cvt_pk_bf16_f32 v231,v237,v239
M a[180:183],a[232:235],a[196:199],a[180:183]
buffer_load_dwordx2 v[212:213],v241,s[8:11],s28 offen offset:1152
M a[184:187],a[232:235],a[200:203],a[184:187]
s_add_u32 s29,s66,6291456
ds_read_b128 a[196:199],v246 offset:18432
ds_read_b128 a[200:203],v245 offset:18944
M a[188:191],a[232:235],a[204:207],a[188:191]
s_waitcnt vmcnt(23) lgkmcnt(6)
ds_read_b128 a[204:207],v246 offset:18944
v_add_u32 v228,87040,v244
M v[0:3],a[236:239],a[208:211],0
s_waitcnt lgkmcnt(6)
ds_write_b16 v228,v229 offset:0
M v[4:7],a[236:239],a[212:215],0
s_waitcnt lgkmcnt(6)
buffer_load_short_d16_hi v235,v242,s[12:15],s29 offen offset:0
M v[8:11],a[236:239],a[216:219],0
s_waitcnt lgkmcnt(5)
ds_write_b16_d16_hi v228,v229 offset:8704
M v[12:15],a[236:239],a[220:223],0
s_waitcnt lgkmcnt(5)
buffer_load_short_d16_hi v236,v242,s[8:11],s29 offen offset:0
M v[16:19],a[236:239],a[192:195],0
s_waitcnt lgkmcnt(4)
ds_write_b16 v244,v230 offset:0
M v[20:23],a[236:239],a[196:199],0
s_waitcnt lgkmcnt(4)
buffer_load_short_d16_hi v237,v242,s[8:11],s29 offen offset:384
M v[24:27],a[236:239],a[200:203],0
s_waitcnt lgkmcnt(3)
ds_write_b16_d16_hi v244,v230 offset:8704
M v[28:31],a[236:239],a[204:207],0
s_waitcnt vmcnt(21)
buffer_load_short_d16_hi v238,v242,s[8:11],s29 offen offset:768
M v[32:35],a[240:243],a[208:211],0
v_add_u32 v228,69632,v244
M v[36:39],a[240:243],a[212:215],0
buffer_load_short_d16_hi v239,v242,s[8:11],s29 offen offset:1152
M v[40:43],a[240:243],a[216:219],0
ds_write_b16 v228,v231 offset:0
M v[44:47],a[240:243],a[220:223],0
buffer_load_short_d16_hi v240,v242,s[16:19],s29 offen offset:1536
M v[48:51],a[240:243],a[192:195],0
ds_write_b16_d16_hi v228,v231 offset:8704
M v[52:55],a[240:243],a[196:199],0
buffer_load_dwordx4 v[224:227],v247,s[20:23],s48 offen offset:2048 sc1
M v[56:59],a[240:243],a[200:203],0
s_waitcnt vmcnt(21)
s_add_u32 s46,s76,36864
v_lshlrev_b32 v230,16,v196
v_lshlrev_b32 v228,16,v192
M v[60:63],a[240:243],a[204:207],0
s_waitcnt vmcnt(18)
v_lshlrev_b32 v229,16,v194
v_lshlrev_b32 v233,16,v202
M v[64:67],a[244:247],a[208:211],0
ds_read_b128 a[208:211],v246 offset:19456
v_lshlrev_b32 v232,16,v200
M v[68:71],a[244:247],a[212:215],0
buffer_load_dwordx4 a[228:231],v247,s[20:23],s46 offen offset:0 sc1
M v[72:75],a[244:247],a[216:219],0
s_add_u32 s47,s76,39936
v_lshlrev_b32 v231,16,v198
v_fmac_f32 v228,s43,v230
M v[76:79],a[244:247],a[220:223],0
v_fmac_f32 v233,4.0,v229
v_fma_f32 v234,-4.0,v230,v232
M v[80:83],a[244:247],a[192:195],0
v_fmac_f32 v228,s45,v232
v_fmac_f32 v233,s41,v231
M v[84:87],a[244:247],a[196:199],0
buffer_load_dwordx4 a[232:235],v247,s[20:23],s47 offen offset:0 sc1
M v[88:91],a[244:247],a[200:203],0
s_add_u32 s48,s76,43008
v_sub_f32 v232,v232,v230
v_fma_f32 v230,-4.0,v229,v231
M v[92:95],a[244:247],a[204:207],0
s_waitcnt vmcnt(19)
v_sub_f32 v231,v231,v229
v_add_f32 v229,v234,v230
M v[0:3],a[248:251],a[212:215],v[0:3]
v_sub_f32 v234,v234,v230
v_fma_f32 v230,2.0,v231,v232
M v[4:7],a[248:251],a[216:219],v[4:7]
global_load_dword v251,v252,s[82:83]
M v[8:11],a[248:251],a[220:223],v[8:11]
v_fmac_f32 v232,-2.0,v231
v_and_b32 v196,s42,v196
M v[12:15],a[248:251],a[192:195],v[12:15]
buffer_load_dwordx4 a[236:239],v247,s[20:23],s48 offen offset:0 sc1
M v[16:19],a[248:251],a[196:199],v[16:19]
v_and_b32 v192,s42,v192
v_and_b32 v194,s42,v194
M v[20:23],a[248:251],a[200:203],v[20:23]
v_and_b32 v202,s42,v202
v_and_b32 v200,s42,v200
M v[24:27],a[248:251],a[204:207],v[24:27]
s_waitcnt lgkmcnt(0)
v_and_b32 v198,s42,v198
v_fmac_f32 v192,s43,v196
M v[28:31],a[248:251],a[208:211],v[28:31]
s_waitcnt vmcnt(20)
buffer_load_dwordx4 a[240:243],v247,s[20:23],s46 offen offset:1024 sc1
M v[32:35],a[252:255],a[212:215],v[32:35]
v_fmac_f32 v202,4.0,v194
v_fma_f32 v231,-4.0,v196,v200
M v[36:39],a[252:255],a[216:219],v[36:39]
v_fmac_f32 v192,s45,v200
v_fmac_f32 v202,s41,v198
M v[40:43],a[252:255],a[220:223],v[40:43]
v_sub_f32 v200,v200,v196
v_fma_f32 v196,-4.0,v194,v198
M v[44:47],a[252:255],a[192:195],v[44:47]
buffer_load_dwordx4 a[244:247],v247,s[20:23],s47 offen offset:1024 sc1
M v[48:51],a[252:255],a[196:199],v[48:51]
v_sub_f32 v198,v198,v194
v_add_f32 v194,v231,v196
M v[52:55],a[252:255],a[200:203],v[52:55]
v_sub_f32 v231,v231,v196
v_fma_f32 v196,2.0,v198,v200
M v[56:59],a[252:255],a[204:207],v[56:59]
v_fmac_f32 v200,-2.0,v198
v_cvt_pk_bf16_f32 v192,v228,v192
M v[60:63],a[252:255],a[208:211],v[60:63]
s_waitcnt vmcnt(21)
buffer_load_dwordx4 a[248:251],v247,s[20:23],s48 offen offset:1024 sc1
M v[64:67],a[224:227],a[212:215],v[64:67]
ds_read_b128 a[212:215],v245 offset:19456
v_cvt_pk_bf16_f32 v202,v233,v202
M v[68:71],a[224:227],a[216:219],v[68:71]
v_cvt_pk_bf16_f32 v194,v229,v194
v_cvt_pk_bf16_f32 v198,v230,v196
M v[72:75],a[224:227],a[220:223],v[72:75]
v_cvt_pk_bf16_f32 v196,v234,v231
v_cvt_pk_bf16_f32 v200,v232,v200
M v[76:79],a[224:227],a[192:195],v[76:79]
buffer_load_dwordx4 a[252:255],v247,s[20:23],s46 offen offset:2048 sc1
M v[80:83],a[224:227],a[196:199],v[80:83]
v_lshlrev_b32 v230,16,v197
v_lshlrev_b32 v228,16,v193
M v[84:87],a[224:227],a[200:203],v[84:87]
v_lshlrev_b32 v229,16,v195
v_lshlrev_b32 v233,16,v203
M v[88:91],a[224:227],a[204:207],v[88:91]
v_lshlrev_b32 v232,16,v201
v_lshlrev_b32 v231,16,v199
M v[92:95],a[224:227],a[208:211],v[92:95]
s_waitcnt vmcnt(22)
buffer_load_dwordx4 a[224:227],v247,s[20:23],s47 offen offset:2048 sc1
M v[0:3],v[216:219],a[216:219],v[0:3]
v_fmac_f32 v228,s43,v230
v_fmac_f32 v233,4.0,v229
M v[4:7],v[216:219],a[220:223],v[4:7]
v_fma_f32 v234,-4.0,v230,v232
v_fmac_f32 v228,s45,v232
M v[8:11],v[216:219],a[192:195],v[8:11]
v_fmac_f32 v233,s41,v231
v_sub_f32 v232,v232,v230
M v[12:15],v[216:219],a[196:199],v[12:15]
v_fma_f32 v230,-4.0,v229,v231
v_sub_f32 v231,v231,v229
M v[16:19],v[216:219],a[200:203],v[16:19]
v_add_f32 v229,v234,v230
v_sub_f32 v234,v234,v230
M v[20:23],v[216:219],a[204:207],v[20:23]
v_fma_f32 v230,2.0,v231,v232
v_fmac_f32 v232,-2.0,v231
M v[24:27],v[216:219],a[208:211],v[24:27]
s_waitcnt lgkmcnt(0)
v_and_b32 v197,s42,v197
v_and_b32 v193,s42,v193
M v[28:31],v[216:219],a[212:215],v[28:31]
s_waitcnt vmcnt(22)
buffer_load_dwordx4 v[216:219],v247,s[20:23],s48 offen offset:2048 sc1
M v[32:35],v[220:223],a[216:219],v[32:35]
v_and_b32 v195,s42,v195
v_and_b32 v203,s42,v203
M v[36:39],v[220:223],a[220:223],v[36:39]
s_add_u32 s46,s77,9216
v_and_b32 v201,s42,v201
v_and_b32 v199,s42,v199
M v[40:43],v[220:223],a[192:195],v[40:43]
v_fmac_f32 v193,s43,v197
v_fmac_f32 v203,4.0,v195
M v[44:47],v[220:223],a[196:199],v[44:47]
v_fma_f32 v231,-4.0,v197,v201
v_fmac_f32 v193,s45,v201
M v[48:51],v[220:223],a[200:203],v[48:51]
v_fmac_f32 v203,s41,v199
v_sub_f32 v201,v201,v197
M v[52:55],v[220:223],a[204:207],v[52:55]
v_fma_f32 v197,-4.0,v195,v199
v_sub_f32 v199,v199,v195
M v[56:59],v[220:223],a[208:211],v[56:59]
v_add_f32 v195,v231,v197
v_sub_f32 v231,v231,v197
M v[60:63],v[220:223],a[212:215],v[60:63]
s_waitcnt vmcnt(10)
buffer_load_dwordx4 v[220:223],v247,s[20:23],s46 offen offset:0 sc1
M v[64:67],v[224:227],a[216:219],v[64:67]
ds_read_b128 a[216:219],v245 offset:26112
v_fma_f32 v197,2.0,v199,v201
M v[68:71],v[224:227],a[220:223],v[68:71]
s_add_u32 s47,s77,12288
ds_read_b128 a[220:223],v246 offset:26112
v_fmac_f32 v201,-2.0,v199
M v[72:75],v[224:227],a[192:195],v[72:75]
ds_read_b128 a[192:195],v245 offset:26624
v_cvt_pk_bf16_f32 v193,v228,v193
M v[76:79],v[224:227],a[196:199],v[76:79]
ds_read_b128 a[196:199],v246 offset:26624
v_cvt_pk_bf16_f32 v203,v233,v203
M v[80:83],v[224:227],a[200:203],v[80:83]
ds_read_b128 a[200:203],v245 offset:27136
v_cvt_pk_bf16_f32 v195,v229,v195
M v[84:87],v[224:227],a[204:207],v[84:87]
ds_read_b128 a[204:207],v246 offset:27136
v_cvt_pk_bf16_f32 v199,v230,v197
M v[88:91],v[224:227],a[208:211],v[88:91]
ds_read_b128 a[208:211],v245 offset:27648
v_cvt_pk_bf16_f32 v197,v234,v231
M v[92:95],v[224:227],a[212:215],v[92:95]
s_waitcnt vmcnt(10) lgkmcnt(6)
buffer_load_dwordx4 v[224:227],v247,s[20:23],s47 offen offset:0 sc1
M v[96:99],a[228:231],a[216:219],0
s_waitcnt lgkmcnt(5)
ds_read_b128 a[212:215],v246 offset:27648
v_cvt_pk_bf16_f32 v201,v232,v201
M v[100:103],a[228:231],a[220:223],0
s_waitcnt lgkmcnt(5)
s_add_u32 s48,s77,15360
ds_write2st64_b64 v243,v[192:193],v[202:203] offset0:172 offset1:189
M v[104:107],a[228:231],a[192:195],0
s_waitcnt lgkmcnt(5)
s_add_u32 s28,s66,6291456
buffer_load_dwordx2 v[192:193],v241,s[12:15],s28 offen offset:0
M v[108:111],a[228:231],a[196:199],0
s_waitcnt lgkmcnt(4)
ds_write2st64_b64 v243,v[194:195],v[196:197] offset0:2 offset1:19
M v[112:115],a[228:231],a[200:203],0
s_waitcnt lgkmcnt(4)
buffer_load_dwordx2 v[202:203],v241,s[16:19],s28 offen offset:1536
M v[116:119],a[228:231],a[204:207],0
s_waitcnt lgkmcnt(3)
ds_write2st64_b64 v243,v[198:199],v[200:201] offset0:138 offset1:155
M v[120:123],a[228:231],a[208:211],0
s_waitcnt lgkmcnt(3)
v_lshlrev_b32 v230,16,v208
v_lshlrev_b32 v228,16,v204
M v[124:127],a[228:231],a[212:215],0
s_waitcnt vmcnt(12)
buffer_load_dwordx2 v[194:195],v241,s[8:11],s28 offen offset:0
M v[128:131],a[232:235],a[216:219],0
v_lshlrev_b32 v229,16,v206
v_lshlrev_b32 v233,16,v214
M v[132:135],a[232:235],a[220:223],0
v_lshlrev_b32 v232,16,v212
v_lshlrev_b32 v231,16,v210
M v[136:139],a[232:235],a[192:195],0
v_fmac_f32 v228,s43,v230
v_fmac_f32 v233,4.0,v229
M v[140:143],a[232:235],a[196:199],0
buffer_load_dwordx2 v[196:197],v241,s[8:11],s28 offen offset:384
M v[144:147],a[232:235],a[200:203],0
v_fma_f32 v234,-4.0,v230,v232
v_fmac_f32 v228,s45,v232
M v[148:151],a[232:235],a[204:207],0
v_fmac_f32 v233,s41,v231
v_sub_f32 v232,v232,v230
M v[152:155],a[232:235],a[208:211],0
v_fma_f32 v230,-4.0,v229,v231
v_sub_f32 v231,v231,v229
M v[156:159],a[232:235],a[212:215],0
s_waitcnt vmcnt(12)
buffer_load_dwordx2 v[198:199],v241,s[8:11],s28 offen offset:768
M v[160:163],a[236:239],a[216:219],0
ds_read_b128 a[216:219],v246 offset:28160
v_add_f32 v229,v234,v230
M v[164:167],a[236:239],a[220:223],0
v_sub_f32 v234,v234,v230
v_fma_f32 v230,2.0,v231,v232
M v[168:171],a[236:239],a[192:195],0
v_fmac_f32 v232,-2.0,v231
v_and_b32 v208,s42,v208
M v[172:175],a[236:239],a[196:199],0
buffer_load_dwordx2 v[200:201],v241,s[8:11],s28 offen offset:1152
M v[176:179],a[236:239],a[200:203],0
v_and_b32 v204,s42,v204
v_and_b32 v206,s42,v206
M v[180:183],a[236:239],a[204:207],0
v_and_b32 v214,s42,v214
v_and_b32 v212,s42,v212
M v[184:187],a[236:239],a[208:211],0
v_and_b32 v210,s42,v210
v_fmac_f32 v204,s43,v208
M v[188:191],a[236:239],a[212:215],0
s_waitcnt vmcnt(13)
buffer_load_dwordx4 a[228:231],v247,s[20:23],s48 offen offset:0 sc1
M v[96:99],a[240:243],a[220:223],v[96:99]
v_fmac_f32 v214,4.0,v206
v_fma_f32 v231,-4.0,v208,v212
M v[100:103],a[240:243],a[192:195],v[100:103]
v_fmac_f32 v204,s45,v212
v_fmac_f32 v214,s41,v210
M v[104:107],a[240:243],a[196:199],v[104:107]
v_sub_f32 v212,v212,v208
v_fma_f32 v208,-4.0,v206,v210
M v[108:111],a[240:243],a[200:203],v[108:111]
buffer_load_dwordx4 a[232:235],v247,s[20:23],s46 offen offset:1024 sc1
M v[112:115],a[240:243],a[204:207],v[112:115]
v_sub_f32 v210,v210,v206
v_add_f32 v206,v231,v208
M v[116:119],a[240:243],a[208:211],v[116:119]
v_sub_f32 v231,v231,v208
v_fma_f32 v208,2.0,v210,v212
M v[120:123],a[240:243],a[212:215],v[120:123]
s_waitcnt lgkmcnt(0)
v_fmac_f32 v212,-2.0,v210
v_cvt_pk_bf16_f32 v204,v228,v204
M v[124:127],a[240:243],a[216:219],v[124:127]
s_waitcnt vmcnt(14)
buffer_load_dwordx4 a[236:239],v247,s[20:23],s47 offen offset:1024 sc1
M v[128:131],a[244:247],a[220:223],v[128:131]
v_cvt_pk_bf16_f32 v214,v233,v214
v_cvt_pk_bf16_f32 v206,v229,v206
M v[132:135],a[244:247],a[192:195],v[132:135]
v_cvt_pk_bf16_f32 v210,v230,v208
v_cvt_pk_bf16_f32 v208,v234,v231
M v[136:139],a[244:247],a[196:199],v[136:139]
v_cvt_pk_bf16_f32 v212,v232,v212
v_lshlrev_b32 v230,16,v209
M v[140:143],a[244:247],a[200:203],v[140:143]
buffer_load_dwordx4 a[240:243],v247,s[20:23],s48 offen offset:1024 sc1
M v[144:147],a[244:247],a[204:207],v[144:147]
v_lshlrev_b32 v228,16,v205
v_lshlrev_b32 v229,16,v207
M v[148:151],a[244:247],a[208:211],v[148:151]
v_lshlrev_b32 v233,16,v215
v_lshlrev_b32 v232,16,v213
M v[152:155],a[244:247],a[212:215],v[152:155]
v_lshlrev_b32 v231,16,v211
v_fmac_f32 v228,s43,v230
M v[156:159],a[244:247],a[216:219],v[156:159]
s_waitcnt vmcnt(15)
buffer_load_dwordx4 a[244:247],v247,s[20:23],s46 offen offset:2048 sc1
M v[160:163],a[248:251],a[220:223],v[160:163]
ds_read_b128 a[220:223],v245 offset:28160
v_fmac_f32 v233,4.0,v229
M v[164:167],a[248:251],a[192:195],v[164:167]
v_fma_f32 v234,-4.0,v230,v232
v_fmac_f32 v228,s45,v232
M v[168:171],a[248:251],a[196:199],v[168:171]
v_fmac_f32 v233,s41,v231
v_sub_f32 v232,v232,v230
M v[172:175],a[248:251],a[200:203],v[172:175]
v_fma_f32 v230,-4.0,v229,v231
v_sub_f32 v231,v231,v229
M v[176:179],a[248:251],a[204:207],v[176:179]
v_add_f32 v229,v234,v230
v_sub_f32 v234,v234,v230
M v[180:183],a[248:251],a[208:211],v[180:183]
v_fma_f32 v230,2.0,v231,v232
v_fmac_f32 v232,-2.0,v231
M v[184:187],a[248:251],a[212:215],v[184:187]
v_and_b32 v209,s42,v209
v_and_b32 v205,s42,v205
M v[188:191],a[248:251],a[216:219],v[188:191]
s_waitcnt vmcnt(15)
buffer_load_dwordx4 a[248:251],v247,s[20:23],s47 offen offset:2048 sc1
M v[96:99],a[252:255],a[192:195],v[96:99]
v_and_b32 v207,s42,v207
v_and_b32 v215,s42,v215
M v[100:103],a[252:255],a[196:199],v[100:103]
v_and_b32 v213,s42,v213
v_and_b32 v211,s42,v211
M v[104:107],a[252:255],a[200:203],v[104:107]
v_fmac_f32 v205,s43,v209
v_fmac_f32 v215,4.0,v207
M v[108:111],a[252:255],a[204:207],v[108:111]
v_fma_f32 v231,-4.0,v209,v213
v_fmac_f32 v205,s45,v213
M v[112:115],a[252:255],a[208:211],v[112:115]
v_fmac_f32 v215,s41,v211
v_sub_f32 v213,v213,v209
v_fma_f32 v209,-4.0,v207,v211
M v[116:119],a[252:255],a[212:215],v[116:119]
v_sub_f32 v211,v211,v207
v_add_f32 v207,v231,v209
v_sub_f32 v231,v231,v209
v_fma_f32 v209,2.0,v211,v213
M v[120:123],a[252:255],a[216:219],v[120:123]
s_waitcnt lgkmcnt(0)
v_fmac_f32 v213,-2.0,v211
v_cvt_pk_bf16_f32 v205,v228,v205
v_cvt_pk_bf16_f32 v215,v233,v215
v_cvt_pk_bf16_f32 v207,v229,v207
M v[124:127],a[252:255],a[220:223],v[124:127]
s_waitcnt vmcnt(15)
buffer_load_dwordx4 a[252:255],v247,s[20:23],s48 offen offset:2048 sc1
v_cvt_pk_bf16_f32 v211,v230,v209
v_cvt_pk_bf16_f32 v209,v234,v231
v_cvt_pk_bf16_f32 v213,v232,v213
M v[128:131],a[224:227],a[192:195],v[128:131]
ds_write2st64_b64 v243,v[204:205],v[214:215] offset0:173 offset1:190
M v[132:135],a[224:227],a[196:199],v[132:135]
s_add_u32 s28,s66,6684672
buffer_load_dwordx2 v[204:205],v241,s[12:15],s28 offen offset:0
ds_write2st64_b64 v243,v[206:207],v[208:209] offset0:3 offset1:20
M v[136:139],a[224:227],a[200:203],v[136:139]
s_add_u32 s46,s77,18432
ds_write2st64_b64 v243,v[210:211],v[212:213] offset0:139 offset1:156
M v[140:143],a[224:227],a[204:207],v[140:143]
buffer_load_dwordx2 v[214:215],v241,s[16:19],s28 offen offset:1536
M v[144:147],a[224:227],a[208:211],v[144:147]
s_waitcnt vmcnt(11)
v_lshlrev_b32 v230,16,v196
v_lshlrev_b32 v228,16,v192
M v[148:151],a[224:227],a[212:215],v[148:151]
v_add_u32 v245,0xffffbc00,v245
v_add_u32 v246,0xffffbc00,v246
M v[152:155],a[224:227],a[216:219],v[152:155]
s_waitcnt lgkmcnt(0)
s_barrier
v_lshlrev_b32 v229,16,v194
M v[156:159],a[224:227],a[220:223],v[156:159]
buffer_load_dwordx2 v[206:207],v241,s[8:11],s28 offen offset:0
M v[160:163],v[216:219],a[192:195],v[160:163]
ds_read_b128 a[192:195],v245 offset:0
v_lshlrev_b32 v233,16,v202
M v[164:167],v[216:219],a[196:199],v[164:167]
s_waitcnt vmcnt(10)
ds_read_b128 a[196:199],v246 offset:0
v_lshlrev_b32 v232,16,v200
M v[168:171],v[216:219],a[200:203],v[168:171]
buffer_load_dwordx2 v[208:209],v241,s[8:11],s28 offen offset:384
M v[172:175],v[216:219],a[204:207],v[172:175]
ds_read_b128 a[200:203],v245 offset:512
ds_read_b128 a[204:207],v246 offset:512
M v[176:179],v[216:219],a[208:211],v[176:179]
ds_read_b128 a[208:211],v245 offset:1024
v_lshlrev_b32 v231,16,v198
M v[180:183],v[216:219],a[212:215],v[180:183]
ds_read_b128 a[212:215],v246 offset:1024
v_fmac_f32 v228,s43,v230
M v[184:187],v[216:219],a[216:219],v[184:187]
buffer_load_dwordx2 v[210:211],v241,s[8:11],s28 offen offset:768
M v[188:191],v[216:219],a[220:223],v[188:191]
s_waitcnt lgkmcnt(5)
ds_read_b128 a[216:219],v245 offset:1536
ds_read_b128 a[220:223],v246 offset:1536
M a[0:3],v[220:223],a[192:195],a[0:3]
s_waitcnt lgkmcnt(6)
v_fmac_f32 v233,4.0,v229
v_fma_f32 v234,-4.0,v230,v232
M a[4:7],v[220:223],a[196:199],a[4:7]
s_waitcnt lgkmcnt(5)
v_fmac_f32 v228,s45,v232
v_fmac_f32 v233,s41,v231
M a[8:11],v[220:223],a[200:203],a[8:11]
s_waitcnt lgkmcnt(4)
buffer_load_dwordx2 v[212:213],v241,s[8:11],s28 offen offset:1152
M a[12:15],v[220:223],a[204:207],a[12:15]
s_waitcnt lgkmcnt(3)
v_sub_f32 v232,v232,v230
v_fma_f32 v230,-4.0,v229,v231
M a[16:19],v[220:223],a[208:211],a[16:19]
s_waitcnt lgkmcnt(2)
v_sub_f32 v231,v231,v229
v_add_f32 v229,v234,v230
M a[20:23],v[220:223],a[212:215],a[20:23]
s_waitcnt lgkmcnt(1)
v_sub_f32 v234,v234,v230
v_fma_f32 v230,2.0,v231,v232
M a[24:27],v[220:223],a[216:219],a[24:27]
s_waitcnt lgkmcnt(0)
buffer_load_dwordx4 a[224:227],v247,s[20:23],s46 offen offset:0 sc1
M a[28:31],v[220:223],a[220:223],a[28:31]
s_add_u32 s47,s77,21504
v_fmac_f32 v232,-2.0,v231
v_and_b32 v196,s42,v196
M a[32:35],v[224:227],a[192:195],a[32:35]
v_and_b32 v192,s42,v192
v_and_b32 v194,s42,v194
M a[36:39],v[224:227],a[196:199],a[36:39]
v_and_b32 v202,s42,v202
v_and_b32 v200,s42,v200
M a[40:43],v[224:227],a[200:203],a[40:43]
buffer_load_dwordx4 v[216:219],v247,s[20:23],s47 offen offset:0 sc1
M a[44:47],v[224:227],a[204:207],a[44:47]
s_add_u32 s48,s77,24576
v_and_b32 v198,s42,v198
v_fmac_f32 v192,s43,v196
M a[48:51],v[224:227],a[208:211],a[48:51]
v_fmac_f32 v202,4.0,v194
v_fma_f32 v231,-4.0,v196,v200
M a[52:55],v[224:227],a[212:215],a[52:55]
v_fmac_f32 v192,s45,v200
v_fmac_f32 v202,s41,v198
M a[56:59],v[224:227],a[216:219],a[56:59]
buffer_load_dwordx4 v[220:223],v247,s[20:23],s48 offen offset:0 sc1
M a[60:63],v[224:227],a[220:223],a[60:63]
s_waitcnt vmcnt(15)
v_sub_f32 v200,v200,v196
v_fma_f32 v196,-4.0,v194,v198
M a[64:67],a[228:231],a[192:195],a[64:67]
ds_read_b128 a[192:195],v246 offset:2048
v_sub_f32 v198,v198,v194
M a[68:71],a[228:231],a[196:199],a[68:71]
v_add_f32 v194,v231,v196
v_sub_f32 v231,v231,v196
M a[72:75],a[228:231],a[200:203],a[72:75]
buffer_load_dwordx4 v[224:227],v247,s[20:23],s46 offen offset:1024 sc1
M a[76:79],a[228:231],a[204:207],a[76:79]
v_fma_f32 v196,2.0,v198,v200
v_fmac_f32 v200,-2.0,v198
M a[80:83],a[228:231],a[208:211],a[80:83]
v_cvt_pk_bf16_f32 v192,v228,v192
v_cvt_pk_bf16_f32 v202,v233,v202
M a[84:87],a[228:231],a[212:215],a[84:87]
v_cvt_pk_bf16_f32 v194,v229,v194
v_cvt_pk_bf16_f32 v198,v230,v196
M a[88:91],a[228:231],a[216:219],a[88:91]
v_cvt_pk_bf16_f32 v196,v234,v231
v_cvt_pk_bf16_f32 v200,v232,v200
M a[92:95],a[228:231],a[220:223],a[92:95]
s_waitcnt vmcnt(15)
buffer_load_dwordx4 a[228:231],v247,s[20:23],s47 offen offset:1024 sc1
M a[0:3],a[232:235],a[196:199],a[0:3]
v_lshlrev_b32 v230,16,v197
v_lshlrev_b32 v228,16,v193
M a[4:7],a[232:235],a[200:203],a[4:7]
v_lshlrev_b32 v229,16,v195
v_lshlrev_b32 v233,16,v203
M a[8:11],a[232:235],a[204:207],a[8:11]
v_lshlrev_b32 v232,16,v201
v_lshlrev_b32 v231,16,v199
M a[12:15],a[232:235],a[208:211],a[12:15]
v_fmac_f32 v228,s43,v230
v_fmac_f32 v233,4.0,v229
M a[16:19],a[232:235],a[212:215],a[16:19]
v_fma_f32 v234,-4.0,v230,v232
v_fmac_f32 v228,s45,v232
M a[20:23],a[232:235],a[216:219],a[20:23]
v_fmac_f32 v233,s41,v231
v_sub_f32 v232,v232,v230
M a[24:27],a[232:235],a[220:223],a[24:27]
s_waitcnt lgkmcnt(0)
v_fma_f32 v230,-4.0,v229,v231
v_sub_f32 v231,v231,v229
M a[28:31],a[232:235],a[192:195],a[28:31]
s_waitcnt vmcnt(15)
buffer_load_dwordx4 a[232:235],v247,s[20:23],s48 offen offset:1024 sc1
M a[32:35],a[236:239],a[196:199],a[32:35]
v_add_f32 v229,v234,v230
v_sub_f32 v234,v234,v230
M a[36:39],a[236:239],a[200:203],a[36:39]
v_fma_f32 v230,2.0,v231,v232
v_fmac_f32 v232,-2.0,v231
M a[40:43],a[236:239],a[204:207],a[40:43]
v_and_b32 v197,s42,v197
v_and_b32 v193,s42,v193
M a[44:47],a[236:239],a[208:211],a[44:47]
v_and_b32 v195,s42,v195
v_and_b32 v203,s42,v203
M a[48:51],a[236:239],a[212:215],a[48:51]
v_and_b32 v201,s42,v201
v_and_b32 v199,s42,v199
M a[52:55],a[236:239],a[216:219],a[52:55]
v_fmac_f32 v193,s43,v197
v_fmac_f32 v203,4.0,v195
M a[56:59],a[236:239],a[220:223],a[56:59]
v_fma_f32 v231,-4.0,v197,v201
v_fmac_f32 v193,s45,v201
M a[60:63],a[236:239],a[192:195],a[60:63]
s_waitcnt vmcnt(15)
buffer_load_dwordx4 a[236:239],v247,s[20:23],s46 offen offset:2048 sc1
M a[64:67],a[240:243],a[196:199],a[64:67]
ds_read_b128 a[196:199],v245 offset:2048
v_fmac_f32 v203,s41,v199
M a[68:71],a[240:243],a[200:203],a[68:71]
v_sub_f32 v201,v201,v197
v_fma_f32 v197,-4.0,v195,v199
M a[72:75],a[240:243],a[204:207],a[72:75]
v_sub_f32 v199,v199,v195
v_add_f32 v195,v231,v197
M a[76:79],a[240:243],a[208:211],a[76:79]
v_sub_f32 v231,v231,v197
v_fma_f32 v197,2.0,v199,v201
M a[80:83],a[240:243],a[212:215],a[80:83]
v_fmac_f32 v201,-2.0,v199
v_cvt_pk_bf16_f32 v193,v228,v193
M a[84:87],a[240:243],a[216:219],a[84:87]
v_cvt_pk_bf16_f32 v203,v233,v203
v_cvt_pk_bf16_f32 v195,v229,v195
M a[88:91],a[240:243],a[220:223],a[88:91]
v_cvt_pk_bf16_f32 v199,v230,v197
v_cvt_pk_bf16_f32 v197,v234,v231
M a[92:95],a[240:243],a[192:195],a[92:95]
s_waitcnt vmcnt(15)
buffer_load_dwordx4 a[240:243],v247,s[20:23],s47 offen offset:2048 sc1
M a[0:3],a[244:247],a[200:203],a[0:3]
v_cvt_pk_bf16_f32 v201,v232,v201
M a[4:7],a[244:247],a[204:207],a[4:7]
ds_write2st64_b64 v243,v[192:193],v[202:203] offset0:204 offset1:221
M a[8:11],a[244:247],a[208:211],a[8:11]
s_add_u32 s28,s66,7077888
buffer_load_dwordx2 v[192:193],v241,s[12:15],s28 offen offset:0
M a[12:15],a[244:247],a[212:215],a[12:15]
ds_write2st64_b64 v243,v[194:195],v[196:197] offset0:34 offset1:51
M a[16:19],a[244:247],a[216:219],a[16:19]
buffer_load_dwordx2 v[202:203],v241,s[16:19],s28 offen offset:1536
M a[20:23],a[244:247],a[220:223],a[20:23]
ds_write2st64_b64 v243,v[198:199],v[200:201] offset0:68 offset1:85
M a[24:27],a[244:247],a[192:195],a[24:27]
s_waitcnt vmcnt(12) lgkmcnt(3)
v_lshlrev_b32 v230,16,v208
v_lshlrev_b32 v228,16,v204
M a[28:31],a[244:247],a[196:199],a[28:31]
buffer_load_dwordx2 v[194:195],v241,s[8:11],s28 offen offset:0
M a[32:35],a[248:251],a[200:203],a[32:35]
v_lshlrev_b32 v229,16,v206
v_lshlrev_b32 v233,16,v214
M a[36:39],a[248:251],a[204:207],a[36:39]
s_waitcnt vmcnt(11)
v_lshlrev_b32 v232,16,v212
v_lshlrev_b32 v231,16,v210
M a[40:43],a[248:251],a[208:211],a[40:43]
v_fmac_f32 v228,s43,v230
v_fmac_f32 v233,4.0,v229
M a[44:47],a[248:251],a[212:215],a[44:47]
buffer_load_dwordx2 v[196:197],v241,s[8:11],s28 offen offset:384
M a[48:51],a[248:251],a[216:219],a[48:51]
v_fma_f32 v234,-4.0,v230,v232
v_fmac_f32 v228,s45,v232
M a[52:55],a[248:251],a[220:223],a[52:55]
v_fmac_f32 v233,s41,v231
v_sub_f32 v232,v232,v230
M a[56:59],a[248:251],a[192:195],a[56:59]
v_fma_f32 v230,-4.0,v229,v231
v_sub_f32 v231,v231,v229
M a[60:63],a[248:251],a[196:199],a[60:63]
buffer_load_dwordx2 v[198:199],v241,s[8:11],s28 offen offset:768
M a[64:67],a[252:255],a[200:203],a[64:67]
ds_read_b128 a[200:203],v245 offset:8704
v_add_f32 v229,v234,v230
M a[68:71],a[252:255],a[204:207],a[68:71]
ds_read_b128 a[204:207],v246 offset:8704
v_sub_f32 v234,v234,v230
M a[72:75],a[252:255],a[208:211],a[72:75]
ds_read_b128 a[208:211],v245 offset:9216
v_fma_f32 v230,2.0,v231,v232
M a[76:79],a[252:255],a[212:215],a[76:79]
buffer_load_dwordx2 v[200:201],v241,s[8:11],s28 offen offset:1152
M a[80:83],a[252:255],a[216:219],a[80:83]
ds_read_b128 a[212:215],v246 offset:9216
ds_read_b128 a[216:219],v245 offset:9728
M a[84:87],a[252:255],a[220:223],a[84:87]
ds_read_b128 a[220:223],v246 offset:9728
v_fmac_f32 v232,-2.0,v231
M a[88:91],a[252:255],a[192:195],a[88:91]
ds_read_b128 a[192:195],v245 offset:10240
v_and_b32 v208,s42,v208
M a[92:95],a[252:255],a[196:199],a[92:95]
s_waitcnt vmcnt(13) lgkmcnt(6)
buffer_load_dwordx4 a[244:247],v247,s[20:23],s48 offen offset:2048 sc1
M a[96:99],a[224:227],a[200:203],a[96:99]
s_waitcnt lgkmcnt(5)
s_add_u32 s46,s77,27648
ds_read_b128 a[196:199],v246 offset:10240
v_and_b32 v204,s42,v204
M a[100:103],a[224:227],a[204:207],a[100:103]
s_waitcnt lgkmcnt(5)
v_and_b32 v206,s42,v206
v_and_b32 v214,s42,v214
M a[104:107],a[224:227],a[208:211],a[104:107]
s_waitcnt lgkmcnt(4)
v_and_b32 v212,s42,v212
v_and_b32 v210,s42,v210
M a[108:111],a[224:227],a[212:215],a[108:111]
s_waitcnt lgkmcnt(3)
buffer_load_dwordx4 a[248:251],v247,s[20:23],s46 offen offset:0 sc1
M a[112:115],a[224:227],a[216:219],a[112:115]
s_waitcnt lgkmcnt(2)
s_add_u32 s47,s77,30720
v_fmac_f32 v204,s43,v208
v_fmac_f32 v214,4.0,v206
M a[116:119],a[224:227],a[220:223],a[116:119]
s_waitcnt lgkmcnt(1)
v_fma_f32 v231,-4.0,v208,v212
v_fmac_f32 v204,s45,v212
M a[120:123],a[224:227],a[192:195],a[120:123]
s_waitcnt lgkmcnt(0)
v_fmac_f32 v214,s41,v210
v_sub_f32 v212,v212,v208
M a[124:127],a[224:227],a[196:199],a[124:127]
s_waitcnt vmcnt(14)
buffer_load_dwordx4 a[252:255],v247,s[20:23],s47 offen offset:0 sc1
M a[128:131],v[216:219],a[200:203],a[128:131]
s_add_u32 s48,s77,33792
v_fma_f32 v208,-4.0,v206,v210
v_sub_f32 v210,v210,v206
M a[132:135],v[216:219],a[204:207],a[132:135]
v_add_f32 v206,v231,v208
v_sub_f32 v231,v231,v208
M a[136:139],v[216:219],a[208:211],a[136:139]
v_fma_f32 v208,2.0,v210,v212
v_fmac_f32 v212,-2.0,v210
M a[140:143],v[216:219],a[212:215],a[140:143]
buffer_load_dwordx4 a[224:227],v247,s[20:23],s48 offen offset:0 sc1
M a[144:147],v[216:219],a[216:219],a[144:147]
v_cvt_pk_bf16_f32 v204,v228,v204
v_cvt_pk_bf16_f32 v214,v233,v214
M a[148:151],v[216:219],a[220:223],a[148:151]
v_cvt_pk_bf16_f32 v206,v229,v206
v_cvt_pk_bf16_f32 v210,v230,v208
M a[152:155],v[216:219],a[192:195],a[152:155]
v_cvt_pk_bf16_f32 v208,v234,v231
v_cvt_pk_bf16_f32 v212,v232,v212
M a[156:159],v[216:219],a[196:199],a[156:159]
s_waitcnt vmcnt(15)
buffer_load_dwordx4 v[216:219],v247,s[20:23],s46 offen offset:1024 sc1
M a[160:163],v[220:223],a[200:203],a[160:163]
ds_read_b128 a[200:203],v246 offset:10752
v_lshlrev_b32 v230,16,v209
M a[164:167],v[220:223],a[204:207],a[164:167]
v_lshlrev_b32 v228,16,v205
v_lshlrev_b32 v229,16,v207
M a[168:171],v[220:223],a[208:211],a[168:171]
v_lshlrev_b32 v233,16,v215
v_lshlrev_b32 v232,16,v213
M a[172:175],v[220:223],a[212:215],a[172:175]
v_lshlrev_b32 v231,16,v211
v_fmac_f32 v228,s43,v230
M a[176:179],v[220:223],a[216:219],a[176:179]
v_fmac_f32 v233,4.0,v229
v_fma_f32 v234,-4.0,v230,v232
M a[180:183],v[220:223],a[220:223],a[180:183]
v_fmac_f32 v228,s45,v232
v_fmac_f32 v233,s41,v231
M a[184:187],v[220:223],a[192:195],a[184:187]
v_sub_f32 v232,v232,v230
v_fma_f32 v230,-4.0,v229,v231
M a[188:191],v[220:223],a[196:199],a[188:191]
s_waitcnt vmcnt(15)
buffer_load_dwordx4 v[220:223],v247,s[20:23],s47 offen offset:1024 sc1
M a[96:99],v[224:227],a[204:207],a[96:99]
v_sub_f32 v231,v231,v229
v_add_f32 v229,v234,v230
M a[100:103],v[224:227],a[208:211],a[100:103]
v_sub_f32 v234,v234,v230
v_fma_f32 v230,2.0,v231,v232
M a[104:107],v[224:227],a[212:215],a[104:107]
v_fmac_f32 v232,-2.0,v231
v_and_b32 v209,s42,v209
M a[108:111],v[224:227],a[216:219],a[108:111]
v_and_b32 v205,s42,v205
v_and_b32 v207,s42,v207
M a[112:115],v[224:227],a[220:223],a[112:115]
v_and_b32 v215,s42,v215
v_and_b32 v213,s42,v213
M a[116:119],v[224:227],a[192:195],a[116:119]
v_and_b32 v211,s42,v211
v_fmac_f32 v205,s43,v209
M a[120:123],v[224:227],a[196:199],a[120:123]
s_waitcnt lgkmcnt(0)
v_fmac_f32 v215,4.0,v207
v_fma_f32 v231,-4.0,v209,v213
M a[124:127],v[224:227],a[200:203],a[124:127]
s_waitcnt vmcnt(15)
buffer_load_dwordx4 v[224:227],v247,s[20:23],s48 offen offset:1024 sc1
M a[128:131],a[228:231],a[204:207],a[128:131]
v_fmac_f32 v205,s45,v213
v_fmac_f32 v215,s41,v211
M a[132:135],a[228:231],a[208:211],a[132:135]
v_sub_f32 v213,v213,v209
v_fma_f32 v209,-4.0,v207,v211
M a[136:139],a[228:231],a[212:215],a[136:139]
v_sub_f32 v211,v211,v207
v_add_f32 v207,v231,v209
M a[140:143],a[228:231],a[216:219],a[140:143]
v_sub_f32 v231,v231,v209
v_fma_f32 v209,2.0,v211,v213
M a[144:147],a[228:231],a[220:223],a[144:147]
v_fmac_f32 v213,-2.0,v211
v_cvt_pk_bf16_f32 v205,v228,v205
M a[148:151],a[228:231],a[192:195],a[148:151]
v_cvt_pk_bf16_f32 v215,v233,v215
v_cvt_pk_bf16_f32 v207,v229,v207
M a[152:155],a[228:231],a[196:199],a[152:155]
v_cvt_pk_bf16_f32 v211,v230,v209
v_cvt_pk_bf16_f32 v209,v234,v231
M a[156:159],a[228:231],a[200:203],a[156:159]
s_waitcnt vmcnt(15)
buffer_load_dwordx4 a[228:231],v247,s[20:23],s46 offen offset:2048 sc1
M a[160:163],a[232:235],a[204:207],a[160:163]
ds_read_b128 a[204:207],v245 offset:10752
v_cvt_pk_bf16_f32 v213,v232,v213
M a[164:167],a[232:235],a[208:211],a[164:167]
ds_write2st64_b64 v243,v[204:205],v[214:215] offset0:205 offset1:222
M a[168:171],a[232:235],a[212:215],a[168:171]
s_add_u32 s28,s66,7471104
buffer_load_dwordx2 v[204:205],v241,s[12:15],s28 offen offset:0
M a[172:175],a[232:235],a[216:219],a[172:175]
ds_write2st64_b64 v243,v[206:207],v[208:209] offset0:35 offset1:52
M a[176:179],a[232:235],a[220:223],a[176:179]
buffer_load_dwordx2 v[214:215],v241,s[16:19],s28 offen offset:1536
M a[180:183],a[232:235],a[192:195],a[180:183]
ds_write2st64_b64 v243,v[210:211],v[212:213] offset0:69 offset1:86
M a[184:187],a[232:235],a[196:199],a[184:187]
v_fmac_f32 v235,s43,v237
v_fmac_f32 v240,4.0,v236
M a[188:191],a[232:235],a[200:203],a[188:191]
s_waitcnt vmcnt(17)
buffer_load_dwordx2 v[206:207],v241,s[8:11],s28 offen offset:0
M a[96:99],a[236:239],a[208:211],a[96:99]
v_fma_f32 v228,-4.0,v237,v239
v_fmac_f32 v235,s45,v239
M a[100:103],a[236:239],a[212:215],a[100:103]
v_fmac_f32 v240,s41,v238
v_sub_f32 v239,v239,v237
M a[104:107],a[236:239],a[216:219],a[104:107]
v_fma_f32 v237,-4.0,v236,v238
v_sub_f32 v238,v238,v236
M a[108:111],a[236:239],a[220:223],a[108:111]
buffer_load_dwordx2 v[208:209],v241,s[8:11],s28 offen offset:384
M a[112:115],a[236:239],a[192:195],a[112:115]
v_add_f32 v236,v228,v237
v_sub_f32 v228,v228,v237
M a[116:119],a[236:239],a[196:199],a[116:119]
v_fma_f32 v237,2.0,v238,v239
v_fmac_f32 v239,-2.0,v238
M a[120:123],a[236:239],a[200:203],a[120:123]
s_waitcnt lgkmcnt(3)
v_cvt_pk_bf16_f32 v229,v235,v240
v_cvt_pk_bf16_f32 v230,v236,v228
M a[124:127],a[236:239],a[204:207],a[124:127]
s_waitcnt vmcnt(18)
buffer_load_dwordx2 v[210:211],v241,s[8:11],s28 offen offset:768
M a[128:131],a[240:243],a[208:211],a[128:131]
v_cvt_pk_bf16_f32 v231,v237,v239
v_add_u32 v228,104448,v244
M a[132:135],a[240:243],a[212:215],a[132:135]
ds_write_b16 v228,v229 offset:0
M a[136:139],a[240:243],a[216:219],a[136:139]
ds_write_b16_d16_hi v228,v229 offset:8704
M a[140:143],a[240:243],a[220:223],a[140:143]
buffer_load_dwordx2 v[212:213],v241,s[8:11],s28 offen offset:1152
M a[144:147],a[240:243],a[192:195],a[144:147]
s_add_u32 s29,s67,6291456
ds_write_b16 v244,v230 offset:17408
M a[148:151],a[240:243],a[196:199],a[148:151]
ds_write_b16_d16_hi v244,v230 offset:26112
M a[152:155],a[240:243],a[200:203],a[152:155]
ds_write_b16 v244,v231 offset:34816
M a[156:159],a[240:243],a[204:207],a[156:159]
s_waitcnt vmcnt(13)
buffer_load_short_d16_hi v235,v242,s[12:15],s29 offen offset:0
M a[160:163],a[244:247],a[208:211],a[160:163]
ds_write_b16_d16_hi v244,v231 offset:43520
M a[164:167],a[244:247],a[212:215],a[164:167]
buffer_load_short_d16_hi v236,v242,s[8:11],s29 offen offset:0
v_add_u32 v245,0x4400,v245
v_add_u32 v246,0x4400,v246
M a[168:171],a[244:247],a[216:219],a[168:171]
ds_read_b128 a[208:211],v245 offset:52224
ds_read_b128 a[212:215],v246 offset:52224
M a[172:175],a[244:247],a[220:223],a[172:175]
buffer_load_short_d16_hi v237,v242,s[8:11],s29 offen offset:384
M a[176:179],a[244:247],a[192:195],a[176:179]
ds_read_b128 a[216:219],v245 offset:52736
ds_read_b128 a[220:223],v246 offset:52736
M a[180:183],a[244:247],a[196:199],a[180:183]
buffer_load_short_d16_hi v238,v242,s[8:11],s29 offen offset:768
M a[184:187],a[244:247],a[200:203],a[184:187]
ds_read_b128 a[192:195],v245 offset:53248
ds_read_b128 a[196:199],v246 offset:53248
M a[188:191],a[244:247],a[204:207],a[188:191]
s_waitcnt vmcnt(16) lgkmcnt(5)
buffer_load_short_d16_hi v239,v242,s[8:11],s29 offen offset:1152
M v[0:3],a[248:251],a[208:211],v[0:3]
s_waitcnt lgkmcnt(4)
ds_read_b128 a[200:203],v245 offset:53760
ds_read_b128 a[204:207],v246 offset:53760
M v[4:7],a[248:251],a[212:215],v[4:7]
s_waitcnt lgkmcnt(5)
buffer_load_short_d16_hi v240,v242,s[16:19],s29 offen offset:1536
M v[8:11],a[248:251],a[216:219],v[8:11]
s_waitcnt lgkmcnt(4)
v_lshlrev_b32 v230,16,v196
v_lshlrev_b32 v228,16,v192
M v[12:15],a[248:251],a[220:223],v[12:15]
s_waitcnt lgkmcnt(3)
buffer_load_dwordx4 a[232:235],v247,s[20:23],s47 offen offset:2048 sc1
M v[16:19],a[248:251],a[192:195],v[16:19]
s_waitcnt lgkmcnt(2)
v_lshlrev_b32 v229,16,v194
v_lshlrev_b32 v233,16,v202
M v[20:23],a[248:251],a[196:199],v[20:23]
s_waitcnt lgkmcnt(1)
v_lshlrev_b32 v232,16,v200
v_lshlrev_b32 v231,16,v198
M v[24:27],a[248:251],a[200:203],v[24:27]
s_waitcnt lgkmcnt(0)
v_fmac_f32 v228,s43,v230
v_fmac_f32 v233,4.0,v229
M v[28:31],a[248:251],a[204:207],v[28:31]
s_waitcnt vmcnt(18)
buffer_load_dwordx4 a[236:239],v247,s[20:23],s48 offen offset:2048 sc1
M v[32:35],a[252:255],a[208:211],v[32:35]
s_add_u32 s46,s77,36864
v_fma_f32 v234,-4.0,v230,v232
v_fmac_f32 v228,s45,v232
M v[36:39],a[252:255],a[212:215],v[36:39]
v_fmac_f32 v233,s41,v231
v_sub_f32 v232,v232,v230
M v[40:43],a[252:255],a[216:219],v[40:43]
v_fma_f32 v230,-4.0,v229,v231
v_sub_f32 v231,v231,v229
M v[44:47],a[252:255],a[220:223],v[44:47]
buffer_load_dwordx4 a[240:243],v247,s[20:23],s46 offen offset:0 sc1
M v[48:51],a[252:255],a[192:195],v[48:51]
s_add_u32 s47,s77,39936
v_add_f32 v229,v234,v230
v_sub_f32 v234,v234,v230
M v[52:55],a[252:255],a[196:199],v[52:55]
v_fma_f32 v230,2.0,v231,v232
v_fmac_f32 v232,-2.0,v231
M v[56:59],a[252:255],a[200:203],v[56:59]
v_and_b32 v196,s42,v196
v_and_b32 v192,s42,v192
M v[60:63],a[252:255],a[204:207],v[60:63]
s_waitcnt vmcnt(19)
buffer_load_dwordx4 a[244:247],v247,s[20:23],s47 offen offset:0 sc1
M v[64:67],a[224:227],a[208:211],v[64:67]
s_add_u32 s48,s77,43008
ds_read_b128 a[208:211],v246 offset:54272
v_and_b32 v194,s42,v194
M v[68:71],a[224:227],a[212:215],v[68:71]
v_and_b32 v202,s42,v202
v_and_b32 v200,s42,v200
M v[72:75],a[224:227],a[216:219],v[72:75]
v_and_b32 v198,s42,v198
v_fmac_f32 v192,s43,v196
M v[76:79],a[224:227],a[220:223],v[76:79]
global_load_dword v251,v252,s[82:83]
M v[80:83],a[224:227],a[192:195],v[80:83]
v_fmac_f32 v202,4.0,v194
v_fma_f32 v231,-4.0,v196,v200
M v[84:87],a[224:227],a[196:199],v[84:87]
buffer_load_dwordx4 a[248:251],v247,s[20:23],s48 offen offset:0 sc1
M v[88:91],a[224:227],a[200:203],v[88:91]
v_fmac_f32 v192,s45,v200
v_fmac_f32 v202,s41,v198
M v[92:95],a[224:227],a[204:207],v[92:95]
s_waitcnt vmcnt(21)
v_sub_f32 v200,v200,v196
v_fma_f32 v196,-4.0,v194,v198
M v[0:3],v[216:219],a[212:215],v[0:3]
v_sub_f32 v198,v198,v194
v_add_f32 v194,v231,v196
M v[4:7],v[216:219],a[216:219],v[4:7]
buffer_load_dwordx4 a[252:255],v247,s[20:23],s46 offen offset:1024 sc1
M v[8:11],v[216:219],a[220:223],v[8:11]
v_sub_f32 v231,v231,v196
v_fma_f32 v196,2.0,v198,v200
M v[12:15],v[216:219],a[192:195],v[12:15]
v_fmac_f32 v200,-2.0,v198
v_cvt_pk_bf16_f32 v192,v228,v192
M v[16:19],v[216:219],a[196:199],v[16:19]
v_cvt_pk_bf16_f32 v202,v233,v202
v_cvt_pk_bf16_f32 v194,v229,v194
M v[20:23],v[216:219],a[200:203],v[20:23]
buffer_load_dwordx4 a[224:227],v247,s[20:23],s47 offen offset:1024 sc1
M v[24:27],v[216:219],a[204:207],v[24:27]
s_waitcnt lgkmcnt(0)
v_cvt_pk_bf16_f32 v198,v230,v196
v_cvt_pk_bf16_f32 v196,v234,v231
M v[28:31],v[216:219],a[208:211],v[28:31]
s_waitcnt vmcnt(22)
v_cvt_pk_bf16_f32 v200,v232,v200
v_lshlrev_b32 v230,16,v197
M v[32:35],v[220:223],a[212:215],v[32:35]
v_lshlrev_b32 v228,16,v193
v_lshlrev_b32 v229,16,v195
M v[36:39],v[220:223],a[216:219],v[36:39]
buffer_load_dwordx4 v[216:219],v247,s[20:23],s48 offen offset:1024 sc1
M v[40:43],v[220:223],a[220:223],v[40:43]
v_lshlrev_b32 v233,16,v203
v_lshlrev_b32 v232,16,v201
M v[44:47],v[220:223],a[192:195],v[44:47]
v_lshlrev_b32 v231,16,v199
v_fmac_f32 v228,s43,v230
M v[48:51],v[220:223],a[196:199],v[48:51]
v_fmac_f32 v233,4.0,v229
v_fma_f32 v234,-4.0,v230,v232
M v[52:55],v[220:223],a[200:203],v[52:55]
v_fmac_f32 v228,s45,v232
v_fmac_f32 v233,s41,v231
M v[56:59],v[220:223],a[204:207],v[56:59]
v_sub_f32 v232,v232,v230
v_fma_f32 v230,-4.0,v229,v231
M v[60:63],v[220:223],a[208:211],v[60:63]
s_waitcnt vmcnt(22)
buffer_load_dwordx4 v[220:223],v247,s[20:23],s46 offen offset:2048 sc1
M v[64:67],v[224:227],a[212:215],v[64:67]
ds_read_b128 a[212:215],v245 offset:54272
v_sub_f32 v231,v231,v229
M v[68:71],v[224:227],a[216:219],v[68:71]
v_add_f32 v229,v234,v230
v_sub_f32 v234,v234,v230
M v[72:75],v[224:227],a[220:223],v[72:75]
v_fma_f32 v230,2.0,v231,v232
v_fmac_f32 v232,-2.0,v231
M v[76:79],v[224:227],a[192:195],v[76:79]
v_and_b32 v197,s42,v197
v_and_b32 v193,s42,v193
M v[80:83],v[224:227],a[196:199],v[80:83]
v_and_b32 v195,s42,v195
v_and_b32 v203,s42,v203
M v[84:87],v[224:227],a[200:203],v[84:87]
v_and_b32 v201,s42,v201
v_and_b32 v199,s42,v199
M v[88:91],v[224:227],a[204:207],v[88:91]
v_fmac_f32 v193,s43,v197
v_fmac_f32 v203,4.0,v195
M v[92:95],v[224:227],a[208:211],v[92:95]
s_waitcnt vmcnt(22)
buffer_load_dwordx4 v[224:227],v247,s[20:23],s47 offen offset:2048 sc1
M v[0:3],a[228:231],a[216:219],v[0:3]
v_fma_f32 v231,-4.0,v197,v201
v_fmac_f32 v193,s45,v201
M v[4:7],a[228:231],a[220:223],v[4:7]
v_fmac_f32 v203,s41,v199
v_sub_f32 v201,v201,v197
M v[8:11],a[228:231],a[192:195],v[8:11]
v_fma_f32 v197,-4.0,v195,v199
v_sub_f32 v199,v199,v195
M v[12:15],a[228:231],a[196:199],v[12:15]
v_add_f32 v195,v231,v197
v_sub_f32 v231,v231,v197
M v[16:19],a[228:231],a[200:203],v[16:19]
v_fma_f32 v197,2.0,v199,v201
v_fmac_f32 v201,-2.0,v199
M v[20:23],a[228:231],a[204:207],v[20:23]
v_cvt_pk_bf16_f32 v193,v228,v193
v_cvt_pk_bf16_f32 v203,v233,v203
M v[24:27],a[228:231],a[208:211],v[24:27]
s_waitcnt lgkmcnt(0)
v_cvt_pk_bf16_f32 v195,v229,v195
v_cvt_pk_bf16_f32 v199,v230,v197
M v[28:31],a[228:231],a[212:215],v[28:31]
s_waitcnt vmcnt(10)
buffer_load_dwordx4 a[228:231],v247,s[20:23],s48 offen offset:2048 sc1
M v[32:35],a[232:235],a[216:219],v[32:35]
v_cvt_pk_bf16_f32 v197,v234,v231
v_cvt_pk_bf16_f32 v201,v232,v201
M v[36:39],a[232:235],a[220:223],v[36:39]
s_add_u32 s46,s78,9216
ds_write2st64_b64 v243,v[192:193],v[202:203] offset0:206 offset1:223
M v[40:43],a[232:235],a[192:195],v[40:43]
s_add_u32 s28,s67,6291456
buffer_load_dwordx2 v[192:193],v241,s[12:15],s28 offen offset:0
M v[44:47],a[232:235],a[196:199],v[44:47]
ds_write2st64_b64 v243,v[194:195],v[196:197] offset0:36 offset1:53
M v[48:51],a[232:235],a[200:203],v[48:51]
buffer_load_dwordx2 v[202:203],v241,s[16:19],s28 offen offset:1536
M v[52:55],a[232:235],a[204:207],v[52:55]
ds_write2st64_b64 v243,v[198:199],v[200:201] offset0:70 offset1:87
M v[56:59],a[232:235],a[208:211],v[56:59]
v_lshlrev_b32 v230,16,v208
v_lshlrev_b32 v228,16,v204
M v[60:63],a[232:235],a[212:215],v[60:63]
s_waitcnt vmcnt(12)
buffer_load_dwordx2 v[194:195],v241,s[8:11],s28 offen offset:0
M v[64:67],a[236:239],a[216:219],v[64:67]
ds_read_b128 a[216:219],v245 offset:60928
v_lshlrev_b32 v229,16,v206
M v[68:71],a[236:239],a[220:223],v[68:71]
ds_read_b128 a[220:223],v246 offset:60928
v_lshlrev_b32 v233,16,v214
M v[72:75],a[236:239],a[192:195],v[72:75]
ds_read_b128 a[192:195],v245 offset:61440
v_lshlrev_b32 v232,16,v212
M v[76:79],a[236:239],a[196:199],v[76:79]
buffer_load_dwordx2 v[196:197],v241,s[8:11],s28 offen offset:384
M v[80:83],a[236:239],a[200:203],v[80:83]
ds_read_b128 a[196:199],v246 offset:61440
ds_read_b128 a[200:203],v245 offset:61952
M v[84:87],a[236:239],a[204:207],v[84:87]
ds_read_b128 a[204:207],v246 offset:61952
v_lshlrev_b32 v231,16,v210
M v[88:91],a[236:239],a[208:211],v[88:91]
ds_read_b128 a[208:211],v245 offset:62464
v_fmac_f32 v228,s43,v230
M v[92:95],a[236:239],a[212:215],v[92:95]
s_waitcnt vmcnt(13) lgkmcnt(6)
buffer_load_dwordx2 v[198:199],v241,s[8:11],s28 offen offset:768
M v[96:99],a[240:243],a[216:219],v[96:99]
s_waitcnt lgkmcnt(5)
ds_read_b128 a[212:215],v246 offset:62464
v_fmac_f32 v233,4.0,v229
M v[100:103],a[240:243],a[220:223],v[100:103]
s_waitcnt lgkmcnt(5)
v_fma_f32 v234,-4.0,v230,v232
v_fmac_f32 v228,s45,v232
M v[104:107],a[240:243],a[192:195],v[104:107]
s_waitcnt lgkmcnt(4)
v_fmac_f32 v233,s41,v231
v_sub_f32 v232,v232,v230
M v[108:111],a[240:243],a[196:199],v[108:111]
s_waitcnt lgkmcnt(3)
buffer_load_dwordx2 v[200:201],v241,s[8:11],s28 offen offset:1152
M v[112:115],a[240:243],a[200:203],v[112:115]
s_waitcnt lgkmcnt(2)
v_fma_f32 v230,-4.0,v229,v231
v_sub_f32 v231,v231,v229
M v[116:119],a[240:243],a[204:207],v[116:119]
s_waitcnt lgkmcnt(1)
v_add_f32 v229,v234,v230
v_sub_f32 v234,v234,v230
M v[120:123],a[240:243],a[208:211],v[120:123]
s_waitcnt lgkmcnt(0)
v_fma_f32 v230,2.0,v231,v232
v_fmac_f32 v232,-2.0,v231
M v[124:127],a[240:243],a[212:215],v[124:127]
s_waitcnt vmcnt(14)
buffer_load_dwordx4 a[232:235],v247,s[20:23],s46 offen offset:0 sc1
M v[128:131],a[244:247],a[216:219],v[128:131]
s_add_u32 s47,s78,12288
v_and_b32 v208,s42,v208
v_and_b32 v204,s42,v204
M v[132:135],a[244:247],a[220:223],v[132:135]
v_and_b32 v206,s42,v206
v_and_b32 v214,s42,v214
M v[136:139],a[244:247],a[192:195],v[136:139]
v_and_b32 v212,s42,v212
v_and_b32 v210,s42,v210
M v[140:143],a[244:247],a[196:199],v[140:143]
buffer_load_dwordx4 a[236:239],v247,s[20:23],s47 offen offset:0 sc1
M v[144:147],a[244:247],a[200:203],v[144:147]
s_add_u32 s48,s78,15360
v_fmac_f32 v204,s43,v208
v_fmac_f32 v214,4.0,v206
M v[148:151],a[244:247],a[204:207],v[148:151]
v_fma_f32 v231,-4.0,v208,v212
v_fmac_f32 v204,s45,v212
M v[152:155],a[244:247],a[208:211],v[152:155]
v_fmac_f32 v214,s41,v210
v_sub_f32 v212,v212,v208
M v[156:159],a[244:247],a[212:215],v[156:159]
s_waitcnt vmcnt(14)
buffer_load_dwordx4 a[240:243],v247,s[20:23],s48 offen offset:0 sc1
M v[160:163],a[248:251],a[216:219],v[160:163]
ds_read_b128 a[216:219],v246 offset:62976
v_fma_f32 v208,-4.0,v206,v210
M v[164:167],a[248:251],a[220:223],v[164:167]
v_sub_f32 v210,v210,v206
v_add_f32 v206,v231,v208
M v[168:171],a[248:251],a[192:195],v[168:171]
v_sub_f32 v231,v231,v208
v_fma_f32 v208,2.0,v210,v212
M v[172:175],a[248:251],a[196:199],v[172:175]
buffer_load_dwordx4 a[244:247],v247,s[20:23],s46 offen offset:1024 sc1
M v[176:179],a[248:251],a[200:203],v[176:179]
v_fmac_f32 v212,-2.0,v210
v_cvt_pk_bf16_f32 v204,v228,v204
M v[180:183],a[248:251],a[204:207],v[180:183]
v_cvt_pk_bf16_f32 v214,v233,v214
v_cvt_pk_bf16_f32 v206,v229,v206
M v[184:187],a[248:251],a[208:211],v[184:187]
v_cvt_pk_bf16_f32 v210,v230,v208
v_cvt_pk_bf16_f32 v208,v234,v231
M v[188:191],a[248:251],a[212:215],v[188:191]
s_waitcnt vmcnt(15)
buffer_load_dwordx4 a[248:251],v247,s[20:23],s47 offen offset:1024 sc1
M v[96:99],a[252:255],a[220:223],v[96:99]
v_cvt_pk_bf16_f32 v212,v232,v212
v_lshlrev_b32 v230,16,v209
M v[100:103],a[252:255],a[192:195],v[100:103]
v_lshlrev_b32 v228,16,v205
v_lshlrev_b32 v229,16,v207
M v[104:107],a[252:255],a[196:199],v[104:107]
v_lshlrev_b32 v233,16,v215
v_lshlrev_b32 v232,16,v213
M v[108:111],a[252:255],a[200:203],v[108:111]
v_lshlrev_b32 v231,16,v211
v_fmac_f32 v228,s43,v230
M v[112:115],a[252:255],a[204:207],v[112:115]
v_fmac_f32 v233,4.0,v229
v_fma_f32 v234,-4.0,v230,v232
M v[116:119],a[252:255],a[208:211],v[116:119]
v_fmac_f32 v228,s45,v232
v_fmac_f32 v233,s41,v231
M v[120:123],a[252:255],a[212:215],v[120:123]
s_waitcnt lgkmcnt(0)
v_sub_f32 v232,v232,v230
v_fma_f32 v230,-4.0,v229,v231
M v[124:127],a[252:255],a[216:219],v[124:127]
s_waitcnt vmcnt(15)
buffer_load_dwordx4 a[252:255],v247,s[20:23],s48 offen offset:1024 sc1
M v[128:131],a[224:227],a[220:223],v[128:131]
v_sub_f32 v231,v231,v229
v_add_f32 v229,v234,v230
M v[132:135],a[224:227],a[192:195],v[132:135]
v_sub_f32 v234,v234,v230
v_fma_f32 v230,2.0,v231,v232
M v[136:139],a[224:227],a[196:199],v[136:139]
v_fmac_f32 v232,-2.0,v231
v_and_b32 v209,s42,v209
M v[140:143],a[224:227],a[200:203],v[140:143]
v_and_b32 v205,s42,v205
v_and_b32 v207,s42,v207
M v[144:147],a[224:227],a[204:207],v[144:147]
v_and_b32 v215,s42,v215
v_and_b32 v213,s42,v213
M v[148:151],a[224:227],a[208:211],v[148:151]
v_and_b32 v211,s42,v211
v_fmac_f32 v205,s43,v209
M v[152:155],a[224:227],a[212:215],v[152:155]
v_fmac_f32 v215,4.0,v207
v_fma_f32 v231,-4.0,v209,v213
M v[156:159],a[224:227],a[216:219],v[156:159]
s_waitcnt vmcnt(15)
buffer_load_dwordx4 a[224:227],v247,s[20:23],s46 offen offset:2048 sc1
M v[160:163],v[216:219],a[220:223],v[160:163]
ds_read_b128 a[220:223],v245 offset:62976
v_fmac_f32 v205,s45,v213
M v[164:167],v[216:219],a[192:195],v[164:167]
v_fmac_f32 v215,s41,v211
v_sub_f32 v213,v213,v209
M v[168:171],v[216:219],a[196:199],v[168:171]
v_fma_f32 v209,-4.0,v207,v211
v_sub_f32 v211,v211,v207
M v[172:175],v[216:219],a[200:203],v[172:175]
v_add_f32 v207,v231,v209
v_sub_f32 v231,v231,v209
M v[176:179],v[216:219],a[204:207],v[176:179]
v_fma_f32 v209,2.0,v211,v213
v_fmac_f32 v213,-2.0,v211
M v[180:183],v[216:219],a[208:211],v[180:183]
v_cvt_pk_bf16_f32 v205,v228,v205
v_cvt_pk_bf16_f32 v215,v233,v215
M v[184:187],v[216:219],a[212:215],v[184:187]
v_cvt_pk_bf16_f32 v207,v229,v207
v_cvt_pk_bf16_f32 v211,v230,v209
M v[188:191],v[216:219],a[216:219],v[188:191]
s_waitcnt vmcnt(15)
buffer_load_dwordx4 v[216:219],v247,s[20:23],s47 offen offset:2048 sc1
M v[96:99],v[220:223],a[192:195],v[96:99]
v_cvt_pk_bf16_f32 v209,v234,v231
v_cvt_pk_bf16_f32 v213,v232,v213
M v[100:103],v[220:223],a[196:199],v[100:103]
ds_write2st64_b64 v243,v[204:205],v[214:215] offset0:207 offset1:224
M v[104:107],v[220:223],a[200:203],v[104:107]
s_add_u32 s28,s67,6684672
buffer_load_dwordx2 v[204:205],v241,s[12:15],s28 offen offset:0
M v[108:111],v[220:223],a[204:207],v[108:111]
ds_write2st64_b64 v243,v[206:207],v[208:209] offset0:37 offset1:54
M v[112:115],v[220:223],a[208:211],v[112:115]
buffer_load_dwordx2 v[214:215],v241,s[16:19],s28 offen offset:1536
M v[116:119],v[220:223],a[212:215],v[116:119]
ds_write2st64_b64 v243,v[210:211],v[212:213] offset0:71 offset1:88
M v[120:123],v[220:223],a[216:219],v[120:123]
s_waitcnt vmcnt(12) lgkmcnt(3)
v_lshlrev_b32 v230,16,v196
v_lshlrev_b32 v228,16,v192
M v[124:127],v[220:223],a[220:223],v[124:127]
buffer_load_dwordx2 v[206:207],v241,s[8:11],s28 offen offset:0
M v[128:131],v[224:227],a[192:195],v[128:131]
v_lshlrev_b32 v229,16,v194
v_lshlrev_b32 v233,16,v202
M v[132:135],v[224:227],a[196:199],v[132:135]
s_waitcnt vmcnt(11)
v_lshlrev_b32 v232,16,v200
v_lshlrev_b32 v231,16,v198
M v[136:139],v[224:227],a[200:203],v[136:139]
v_fmac_f32 v228,s43,v230
v_fmac_f32 v233,4.0,v229
M v[140:143],v[224:227],a[204:207],v[140:143]
buffer_load_dwordx2 v[208:209],v241,s[8:11],s28 offen offset:384
M v[144:147],v[224:227],a[208:211],v[144:147]
v_fma_f32 v234,-4.0,v230,v232
v_fmac_f32 v228,s45,v232
M v[148:151],v[224:227],a[212:215],v[148:151]
v_fmac_f32 v233,s41,v231
v_sub_f32 v232,v232,v230
M v[152:155],v[224:227],a[216:219],v[152:155]
s_waitcnt lgkmcnt(0)
s_barrier
v_fma_f32 v230,-4.0,v229,v231
M v[156:159],v[224:227],a[220:223],v[156:159]
buffer_load_dwordx2 v[210:211],v241,s[8:11],s28 offen offset:768
M v[160:163],a[228:231],a[192:195],v[160:163]
ds_read_b128 a[192:195],v245 offset:0
v_sub_f32 v231,v231,v229
M v[164:167],a[228:231],a[196:199],v[164:167]
ds_read_b128 a[196:199],v246 offset:0
v_add_f32 v229,v234,v230
M v[168:171],a[228:231],a[200:203],v[168:171]
ds_read_b128 a[200:203],v245 offset:512
v_sub_f32 v234,v234,v230
M v[172:175],a[228:231],a[204:207],v[172:175]
buffer_load_dwordx2 v[212:213],v241,s[8:11],s28 offen offset:1152
M v[176:179],a[228:231],a[208:211],v[176:179]
ds_read_b128 a[204:207],v246 offset:512
ds_read_b128 a[208:211],v245 offset:1024
M v[180:183],a[228:231],a[212:215],v[180:183]
ds_read_b128 a[212:215],v246 offset:1024
v_fma_f32 v230,2.0,v231,v232
M v[184:187],a[228:231],a[216:219],v[184:187]
ds_read_b128 a[216:219],v245 offset:1536
v_fmac_f32 v232,-2.0,v231
M v[188:191],a[228:231],a[220:223],v[188:191]
s_waitcnt vmcnt(13) lgkmcnt(6)
buffer_load_dwordx4 v[220:223],v247,s[20:23],s48 offen offset:2048 sc1
M a[0:3],a[232:235],a[192:195],a[0:3]
s_waitcnt lgkmcnt(5)
s_add_u32 s46,s78,18432
ds_read_b128 a[220:223],v246 offset:1536
v_and_b32 v196,s42,v196
M a[4:7],a[232:235],a[196:199],a[4:7]
s_waitcnt lgkmcnt(5)
v_and_b32 v192,s42,v192
v_and_b32 v194,s42,v194
M a[8:11],a[232:235],a[200:203],a[8:11]
s_waitcnt lgkmcnt(4)
v_and_b32 v202,s42,v202
v_and_b32 v200,s42,v200
M a[12:15],a[232:235],a[204:207],a[12:15]
s_waitcnt lgkmcnt(3)
buffer_load_dwordx4 v[224:227],v247,s[20:23],s46 offen offset:0 sc1
M a[16:19],a[232:235],a[208:211],a[16:19]
s_waitcnt lgkmcnt(2)
s_add_u32 s47,s78,21504
v_and_b32 v198,s42,v198
v_fmac_f32 v192,s43,v196
M a[20:23],a[232:235],a[212:215],a[20:23]
s_waitcnt lgkmcnt(1)
v_fmac_f32 v202,4.0,v194
v_fma_f32 v231,-4.0,v196,v200
M a[24:27],a[232:235],a[216:219],a[24:27]
s_waitcnt lgkmcnt(0)
v_fmac_f32 v192,s45,v200
v_fmac_f32 v202,s41,v198
M a[28:31],a[232:235],a[220:223],a[28:31]
s_waitcnt vmcnt(14)
buffer_load_dwordx4 a[228:231],v247,s[20:23],s47 offen offset:0 sc1
M a[32:35],a[236:239],a[192:195],a[32:35]
s_add_u32 s48,s78,24576
v_sub_f32 v200,v200,v196
v_fma_f32 v196,-4.0,v194,v198
M a[36:39],a[236:239],a[196:199],a[36:39]
v_sub_f32 v198,v198,v194
v_add_f32 v194,v231,v196
M a[40:43],a[236:239],a[200:203],a[40:43]
v_sub_f32 v231,v231,v196
v_fma_f32 v196,2.0,v198,v200
M a[44:47],a[236:239],a[204:207],a[44:47]
buffer_load_dwordx4 a[232:235],v247,s[20:23],s48 offen offset:0 sc1
M a[48:51],a[236:239],a[208:211],a[48:51]
v_fmac_f32 v200,-2.0,v198
v_cvt_pk_bf16_f32 v192,v228,v192
M a[52:55],a[236:239],a[212:215],a[52:55]
v_cvt_pk_bf16_f32 v202,v233,v202
v_cvt_pk_bf16_f32 v194,v229,v194
M a[56:59],a[236:239],a[216:219],a[56:59]
v_cvt_pk_bf16_f32 v198,v230,v196
v_cvt_pk_bf16_f32 v196,v234,v231
M a[60:63],a[236:239],a[220:223],a[60:63]
s_waitcnt vmcnt(15)
buffer_load_dwordx4 a[236:239],v247,s[20:23],s46 offen offset:1024 sc1
M a[64:67],a[240:243],a[192:195],a[64:67]
ds_read_b128 a[192:195],v246 offset:2048
v_cvt_pk_bf16_f32 v200,v232,v200
M a[68:71],a[240:243],a[196:199],a[68:71]
v_lshlrev_b32 v230,16,v197
v_lshlrev_b32 v228,16,v193
M a[72:75],a[240:243],a[200:203],a[72:75]
v_lshlrev_b32 v229,16,v195
v_lshlrev_b32 v233,16,v203
M a[76:79],a[240:243],a[204:207],a[76:79]
v_lshlrev_b32 v232,16,v201
v_lshlrev_b32 v231,16,v199
M a[80:83],a[240:243],a[208:211],a[80:83]
v_fmac_f32 v228,s43,v230
v_fmac_f32 v233,4.0,v229
M a[84:87],a[240:243],a[212:215],a[84:87]
v_fma_f32 v234,-4.0,v230,v232
v_fmac_f32 v228,s45,v232
M a[88:91],a[240:243],a[216:219],a[88:91]
v_fmac_f32 v233,s41,v231
v_sub_f32 v232,v232,v230
M a[92:95],a[240:243],a[220:223],a[92:95]
s_waitcnt vmcnt(15)
buffer_load_dwordx4 a[240:243],v247,s[20:23],s47 offen offset:1024 sc1
M a[0:3],a[244:247],a[196:199],a[0:3]
v_fma_f32 v230,-4.0,v229,v231
v_sub_f32 v231,v231,v229
M a[4:7],a[244:247],a[200:203],a[4:7]
v_add_f32 v229,v234,v230
v_sub_f32 v234,v234,v230
M a[8:11],a[244:247],a[204:207],a[8:11]
v_fma_f32 v230,2.0,v231,v232
v_fmac_f32 v232,-2.0,v231
M a[12:15],a[244:247],a[208:211],a[12:15]
v_and_b32 v197,s42,v197
v_and_b32 v193,s42,v193
M a[16:19],a[244:247],a[212:215],a[16:19]
v_and_b32 v195,s42,v195
v_and_b32 v203,s42,v203
M a[20:23],a[244:247],a[216:219],a[20:23]
v_and_b32 v201,s42,v201
v_and_b32 v199,s42,v199
M a[24:27],a[244:247],a[220:223],a[24:27]
s_waitcnt lgkmcnt(0)
v_fmac_f32 v193,s43,v197
v_fmac_f32 v203,4.0,v195
M a[28:31],a[244:247],a[192:195],a[28:31]
s_waitcnt vmcnt(15)
buffer_load_dwordx4 a[244:247],v247,s[20:23],s48 offen offset:1024 sc1
M a[32:35],a[248:251],a[196:199],a[32:35]
v_fma_f32 v231,-4.0,v197,v201
v_fmac_f32 v193,s45,v201
M a[36:39],a[248:251],a[200:203],a[36:39]
v_fmac_f32 v203,s41,v199
v_sub_f32 v201,v201,v197
M a[40:43],a[248:251],a[204:207],a[40:43]
v_fma_f32 v197,-4.0,v195,v199
v_sub_f32 v199,v199,v195
M a[44:47],a[248:251],a[208:211],a[44:47]
v_add_f32 v195,v231,v197
v_sub_f32 v231,v231,v197
M a[48:51],a[248:251],a[212:215],a[48:51]
v_fma_f32 v197,2.0,v199,v201
v_fmac_f32 v201,-2.0,v199
M a[52:55],a[248:251],a[216:219],a[52:55]
v_cvt_pk_bf16_f32 v193,v228,v193
v_cvt_pk_bf16_f32 v203,v233,v203
M a[56:59],a[248:251],a[220:223],a[56:59]
v_cvt_pk_bf16_f32 v195,v229,v195
v_cvt_pk_bf16_f32 v199,v230,v197
M a[60:63],a[248:251],a[192:195],a[60:63]
s_waitcnt vmcnt(15)
buffer_load_dwordx4 a[248:251],v247,s[20:23],s46 offen offset:2048 sc1
M a[64:67],a[252:255],a[196:199],a[64:67]
ds_read_b128 a[196:199],v245 offset:2048
v_cvt_pk_bf16_f32 v197,v234,v231
M a[68:71],a[252:255],a[200:203],a[68:71]
v_cvt_pk_bf16_f32 v201,v232,v201
M a[72:75],a[252:255],a[204:207],a[72:75]
ds_write2st64_b64 v243,v[192:193],v[202:203] offset0:238 offset1:255
M a[76:79],a[252:255],a[208:211],a[76:79]
s_add_u32 s28,s67,7077888
buffer_load_dwordx2 v[192:193],v241,s[12:15],s28 offen offset:0
M a[80:83],a[252:255],a[212:215],a[80:83]
ds_write2st64_b64 v243,v[194:195],v[196:197] offset0:0 offset1:17
M a[84:87],a[252:255],a[216:219],a[84:87]
buffer_load_dwordx2 v[202:203],v241,s[16:19],s28 offen offset:1536
M a[88:91],a[252:255],a[220:223],a[88:91]
ds_write2st64_b64 v243,v[198:199],v[200:201] offset0:136 offset1:153
M a[92:95],a[252:255],a[192:195],a[92:95]
s_waitcnt vmcnt(12)
v_lshlrev_b32 v230,16,v208
v_lshlrev_b32 v228,16,v204
M a[0:3],a[224:227],a[200:203],a[0:3]
buffer_load_dwordx2 v[194:195],v241,s[8:11],s28 offen offset:0
M a[4:7],a[224:227],a[204:207],a[4:7]
v_lshlrev_b32 v229,16,v206
v_lshlrev_b32 v233,16,v214
M a[8:11],a[224:227],a[208:211],a[8:11]
s_waitcnt vmcnt(11)
v_lshlrev_b32 v232,16,v212
v_lshlrev_b32 v231,16,v210
M a[12:15],a[224:227],a[212:215],a[12:15]
v_fmac_f32 v228,s43,v230
v_fmac_f32 v233,4.0,v229
M a[16:19],a[224:227],a[216:219],a[16:19]
buffer_load_dwordx2 v[196:197],v241,s[8:11],s28 offen offset:384
M a[20:23],a[224:227],a[220:223],a[20:23]
v_fma_f32 v234,-4.0,v230,v232
v_fmac_f32 v228,s45,v232
M a[24:27],a[224:227],a[192:195],a[24:27]
s_waitcnt lgkmcnt(3)
v_fmac_f32 v233,s41,v231
v_sub_f32 v232,v232,v230
M a[28:31],a[224:227],a[196:199],a[28:31]
v_fma_f32 v230,-4.0,v229,v231
v_sub_f32 v231,v231,v229
M a[32:35],v[216:219],a[200:203],a[32:35]
buffer_load_dwordx2 v[198:199],v241,s[8:11],s28 offen offset:768
M a[36:39],v[216:219],a[204:207],a[36:39]
v_add_f32 v229,v234,v230
v_sub_f32 v234,v234,v230
M a[40:43],v[216:219],a[208:211],a[40:43]
v_fma_f32 v230,2.0,v231,v232
v_fmac_f32 v232,-2.0,v231
M a[44:47],v[216:219],a[212:215],a[44:47]
v_and_b32 v208,s42,v208
v_and_b32 v204,s42,v204
M a[48:51],v[216:219],a[216:219],a[48:51]
buffer_load_dwordx2 v[200:201],v241,s[8:11],s28 offen offset:1152
M a[52:55],v[216:219],a[220:223],a[52:55]
v_and_b32 v206,s42,v206
v_and_b32 v214,s42,v214
M a[56:59],v[216:219],a[192:195],a[56:59]
v_and_b32 v212,s42,v212
v_and_b32 v210,s42,v210
M a[60:63],v[216:219],a[196:199],a[60:63]
s_waitcnt vmcnt(13)
v_fmac_f32 v204,s43,v208
v_fmac_f32 v214,4.0,v206
M a[64:67],v[220:223],a[200:203],a[64:67]
buffer_load_dwordx4 a[252:255],v247,s[20:23],s47 offen offset:2048 sc1
M a[68:71],v[220:223],a[204:207],a[68:71]
ds_read_b128 a[200:203],v245 offset:8704
ds_read_b128 a[204:207],v246 offset:8704
M a[72:75],v[220:223],a[208:211],a[72:75]
ds_read_b128 a[208:211],v245 offset:9216
v_fma_f32 v231,-4.0,v208,v212
M a[76:79],v[220:223],a[212:215],a[76:79]
ds_read_b128 a[212:215],v246 offset:9216
v_fmac_f32 v204,s45,v212
M a[80:83],v[220:223],a[216:219],a[80:83]
buffer_load_dwordx4 a[224:227],v247,s[20:23],s48 offen offset:2048 sc1
M a[84:87],v[220:223],a[220:223],a[84:87]
s_add_u32 s46,s78,27648
ds_read_b128 a[216:219],v245 offset:9728
ds_read_b128 a[220:223],v246 offset:9728
M a[88:91],v[220:223],a[192:195],a[88:91]
ds_read_b128 a[192:195],v245 offset:10240
v_fmac_f32 v214,s41,v210
M a[92:95],v[220:223],a[196:199],a[92:95]
s_waitcnt vmcnt(14) lgkmcnt(6)
ds_read_b128 a[196:199],v246 offset:10240
v_sub_f32 v212,v212,v208
M a[96:99],v[224:227],a[200:203],a[96:99]
s_waitcnt lgkmcnt(6)
buffer_load_dwordx4 v[216:219],v247,s[20:23],s46 offen offset:0 sc1
M a[100:103],v[224:227],a[204:207],a[100:103]
s_waitcnt lgkmcnt(5)
s_add_u32 s47,s78,30720
v_fma_f32 v208,-4.0,v206,v210
v_sub_f32 v210,v210,v206
M a[104:107],v[224:227],a[208:211],a[104:107]
s_waitcnt lgkmcnt(4)
v_add_f32 v206,v231,v208
v_sub_f32 v231,v231,v208
M a[108:111],v[224:227],a[212:215],a[108:111]
s_waitcnt lgkmcnt(3)
v_fma_f32 v208,2.0,v210,v212
v_fmac_f32 v212,-2.0,v210
M a[112:115],v[224:227],a[216:219],a[112:115]
s_waitcnt lgkmcnt(2)
buffer_load_dwordx4 v[220:223],v247,s[20:23],s47 offen offset:0 sc1
M a[116:119],v[224:227],a[220:223],a[116:119]
s_waitcnt lgkmcnt(1)
s_add_u32 s48,s78,33792
v_cvt_pk_bf16_f32 v204,v228,v204
v_cvt_pk_bf16_f32 v214,v233,v214
M a[120:123],v[224:227],a[192:195],a[120:123]
s_waitcnt lgkmcnt(0)
v_cvt_pk_bf16_f32 v206,v229,v206
v_cvt_pk_bf16_f32 v210,v230,v208
M a[124:127],v[224:227],a[196:199],a[124:127]
s_waitcnt vmcnt(15)
v_cvt_pk_bf16_f32 v208,v234,v231
v_cvt_pk_bf16_f32 v212,v232,v212
M a[128:131],a[228:231],a[200:203],a[128:131]
buffer_load_dwordx4 v[224:227],v247,s[20:23],s48 offen offset:0 sc1
M a[132:135],a[228:231],a[204:207],a[132:135]
v_lshlrev_b32 v230,16,v209
v_lshlrev_b32 v228,16,v205
M a[136:139],a[228:231],a[208:211],a[136:139]
v_lshlrev_b32 v229,16,v207
v_lshlrev_b32 v233,16,v215
M a[140:143],a[228:231],a[212:215],a[140:143]
v_lshlrev_b32 v232,16,v213
v_lshlrev_b32 v231,16,v211
M a[144:147],a[228:231],a[216:219],a[144:147]
v_fmac_f32 v228,s43,v230
v_fmac_f32 v233,4.0,v229
M a[148:151],a[228:231],a[220:223],a[148:151]
v_fma_f32 v234,-4.0,v230,v232
v_fmac_f32 v228,s45,v232
M a[152:155],a[228:231],a[192:195],a[152:155]
v_fmac_f32 v233,s41,v231
v_sub_f32 v232,v232,v230
M a[156:159],a[228:231],a[196:199],a[156:159]
s_waitcnt vmcnt(15)
buffer_load_dwordx4 a[228:231],v247,s[20:23],s46 offen offset:1024 sc1
M a[160:163],a[232:235],a[200:203],a[160:163]
ds_read_b128 a[200:203],v246 offset:10752
v_fma_f32 v230,-4.0,v229,v231
M a[164:167],a[232:235],a[204:207],a[164:167]
v_sub_f32 v231,v231,v229
v_add_f32 v229,v234,v230
M a[168:171],a[232:235],a[208:211],a[168:171]
v_sub_f32 v234,v234,v230
v_fma_f32 v230,2.0,v231,v232
M a[172:175],a[232:235],a[212:215],a[172:175]
v_fmac_f32 v232,-2.0,v231
v_and_b32 v209,s42,v209
M a[176:179],a[232:235],a[216:219],a[176:179]
v_and_b32 v205,s42,v205
v_and_b32 v207,s42,v207
M a[180:183],a[232:235],a[220:223],a[180:183]
v_and_b32 v215,s42,v215
v_and_b32 v213,s42,v213
M a[184:187],a[232:235],a[192:195],a[184:187]
v_and_b32 v211,s42,v211
v_fmac_f32 v205,s43,v209
M a[188:191],a[232:235],a[196:199],a[188:191]
s_waitcnt vmcnt(15)
buffer_load_dwordx4 a[232:235],v247,s[20:23],s47 offen offset:1024 sc1
M a[96:99],a[236:239],a[204:207],a[96:99]
v_fmac_f32 v215,4.0,v207
v_fma_f32 v231,-4.0,v209,v213
M a[100:103],a[236:239],a[208:211],a[100:103]
v_fmac_f32 v205,s45,v213
v_fmac_f32 v215,s41,v211
M a[104:107],a[236:239],a[212:215],a[104:107]
v_sub_f32 v213,v213,v209
v_fma_f32 v209,-4.0,v207,v211
M a[108:111],a[236:239],a[216:219],a[108:111]
v_sub_f32 v211,v211,v207
v_add_f32 v207,v231,v209
M a[112:115],a[236:239],a[220:223],a[112:115]
v_sub_f32 v231,v231,v209
v_fma_f32 v209,2.0,v211,v213
M a[116:119],a[236:239],a[192:195],a[116:119]
v_fmac_f32 v213,-2.0,v211
v_cvt_pk_bf16_f32 v205,v228,v205
M a[120:123],a[236:239],a[196:199],a[120:123]
s_waitcnt lgkmcnt(0)
v_cvt_pk_bf16_f32 v215,v233,v215
v_cvt_pk_bf16_f32 v207,v229,v207
M a[124:127],a[236:239],a[200:203],a[124:127]
s_waitcnt vmcnt(15)
buffer_load_dwordx4 a[236:239],v247,s[20:23],s48 offen offset:1024 sc1
M a[128:131],a[240:243],a[204:207],a[128:131]
v_cvt_pk_bf16_f32 v211,v230,v209
v_cvt_pk_bf16_f32 v209,v234,v231
M a[132:135],a[240:243],a[208:211],a[132:135]
v_cvt_pk_bf16_f32 v213,v232,v213
v_add_u32 v228,121856,v243
M a[136:139],a[240:243],a[212:215],a[136:139]
ds_write2st64_b64 v228,v[204:205],v[214:215] offset0:1 offset1:18
M a[140:143],a[240:243],a[216:219],a[140:143]
s_add_u32 s28,s67,7471104
buffer_load_dwordx2 v[204:205],v241,s[12:15],s28 offen offset:0
M a[144:147],a[240:243],a[220:223],a[144:147]
ds_write2st64_b64 v243,v[206:207],v[208:209] offset0:1 offset1:18
M a[148:151],a[240:243],a[192:195],a[148:151]
buffer_load_dwordx2 v[214:215],v241,s[16:19],s28 offen offset:1536
M a[152:155],a[240:243],a[196:199],a[152:155]
ds_write2st64_b64 v243,v[210:211],v[212:213] offset0:137 offset1:154
M a[156:159],a[240:243],a[200:203],a[156:159]
s_waitcnt vmcnt(17)
v_fmac_f32 v235,s43,v237
v_fmac_f32 v240,4.0,v236
M a[160:163],a[244:247],a[204:207],a[160:163]
buffer_load_dwordx2 v[206:207],v241,s[8:11],s28 offen offset:0
M a[164:167],a[244:247],a[208:211],a[164:167]
ds_read_b128 a[204:207],v245 offset:10752
v_fma_f32 v228,-4.0,v237,v239
M a[168:171],a[244:247],a[212:215],a[168:171]
v_fmac_f32 v235,s45,v239
v_fmac_f32 v240,s41,v238
M a[172:175],a[244:247],a[216:219],a[172:175]
v_sub_f32 v239,v239,v237
v_fma_f32 v237,-4.0,v236,v238
M a[176:179],a[244:247],a[220:223],a[176:179]
buffer_load_dwordx2 v[208:209],v241,s[8:11],s28 offen offset:384
M a[180:183],a[244:247],a[192:195],a[180:183]
v_sub_f32 v238,v238,v236
v_add_f32 v236,v228,v237
M a[184:187],a[244:247],a[196:199],a[184:187]
v_sub_f32 v228,v228,v237
v_fma_f32 v237,2.0,v238,v239
M a[188:191],a[244:247],a[200:203],a[188:191]
s_waitcnt vmcnt(18)
v_fmac_f32 v239,-2.0,v238
v_cvt_pk_bf16_f32 v229,v235,v240
M a[96:99],a[248:251],a[208:211],a[96:99]
buffer_load_dwordx2 v[210:211],v241,s[8:11],s28 offen offset:768
M a[100:103],a[248:251],a[212:215],a[100:103]
v_cvt_pk_bf16_f32 v230,v236,v228
v_cvt_pk_bf16_f32 v231,v237,v239
M a[104:107],a[248:251],a[216:219],a[104:107]
v_add_u32 v228,121856,v244
M a[108:111],a[248:251],a[220:223],a[108:111]
ds_write_b16 v228,v229 offset:0
M a[112:115],a[248:251],a[192:195],a[112:115]
buffer_load_dwordx2 v[212:213],v241,s[8:11],s28 offen offset:1152
M a[116:119],a[248:251],a[196:199],a[116:119]
s_add_u32 s29,s68,6291456
ds_write_b16_d16_hi v228,v229 offset:8704
M a[120:123],a[248:251],a[200:203],a[120:123]
s_waitcnt lgkmcnt(2)
ds_write_b16 v244,v230 offset:0
M a[124:127],a[248:251],a[204:207],a[124:127]
s_waitcnt vmcnt(13)
ds_write_b16_d16_hi v244,v230 offset:8704
M a[128:131],a[252:255],a[208:211],a[128:131]
buffer_load_short_d16_hi v235,v242,s[12:15],s29 offen offset:0
M a[132:135],a[252:255],a[212:215],a[132:135]
v_add_u32 v228,69632,v244
M a[136:139],a[252:255],a[216:219],a[136:139]
buffer_load_short_d16_hi v236,v242,s[8:11],s29 offen offset:0
M a[140:143],a[252:255],a[220:223],a[140:143]
ds_write_b16 v228,v231 offset:0
M a[144:147],a[252:255],a[192:195],a[144:147]
buffer_load_short_d16_hi v237,v242,s[8:11],s29 offen offset:384
M a[148:151],a[252:255],a[196:199],a[148:151]
ds_write_b16_d16_hi v228,v231 offset:8704
M a[152:155],a[252:255],a[200:203],a[152:155]
buffer_load_short_d16_hi v238,v242,s[8:11],s29 offen offset:768
M a[156:159],a[252:255],a[204:207],a[156:159]
s_waitcnt vmcnt(16)
v_lshlrev_b32 v230,16,v196
v_lshlrev_b32 v228,16,v192
M a[160:163],a[224:227],a[208:211],a[160:163]
buffer_load_short_d16_hi v239,v242,s[8:11],s29 offen offset:1152
M a[164:167],a[224:227],a[212:215],a[164:167]
ds_read_b128 a[208:211],v245 offset:17408
ds_read_b128 a[212:215],v246 offset:17408
M a[168:171],a[224:227],a[216:219],a[168:171]
buffer_load_short_d16_hi v240,v242,s[16:19],s29 offen offset:1536
M a[172:175],a[224:227],a[220:223],a[172:175]
ds_read_b128 a[216:219],v245 offset:17920
ds_read_b128 a[220:223],v246 offset:17920
M a[176:179],a[224:227],a[192:195],a[176:179]
buffer_load_dwordx4 a[240:243],v247,s[20:23],s46 offen offset:2048 sc1
M a[180:183],a[224:227],a[196:199],a[180:183]
ds_read_b128 a[192:195],v245 offset:18432
ds_read_b128 a[196:199],v246 offset:18432
M a[184:187],a[224:227],a[200:203],a[184:187]
ds_read_b128 a[200:203],v245 offset:18944
v_lshlrev_b32 v229,16,v194
M a[188:191],a[224:227],a[204:207],a[188:191]
s_waitcnt vmcnt(18) lgkmcnt(6)
ds_read_b128 a[204:207],v246 offset:18944
v_lshlrev_b32 v233,16,v202
M v[0:3],v[216:219],a[208:211],v[0:3]
s_waitcnt lgkmcnt(6)
buffer_load_dwordx4 a[244:247],v247,s[20:23],s47 offen offset:2048 sc1
M v[4:7],v[216:219],a[212:215],v[4:7]
s_waitcnt lgkmcnt(5)
v_lshlrev_b32 v232,16,v200
v_lshlrev_b32 v231,16,v198
M v[8:11],v[216:219],a[216:219],v[8:11]
s_waitcnt lgkmcnt(4)
v_fmac_f32 v228,s43,v230
v_fmac_f32 v233,4.0,v229
M v[12:15],v[216:219],a[220:223],v[12:15]
s_waitcnt lgkmcnt(3)
v_fma_f32 v234,-4.0,v230,v232
v_fmac_f32 v228,s45,v232
M v[16:19],v[216:219],a[192:195],v[16:19]
s_waitcnt lgkmcnt(2)
buffer_load_dwordx4 a[248:251],v247,s[20:23],s48 offen offset:2048 sc1
M v[20:23],v[216:219],a[196:199],v[20:23]
s_waitcnt lgkmcnt(1)
s_add_u32 s46,s78,36864
v_fmac_f32 v233,s41,v231
v_sub_f32 v232,v232,v230
M v[24:27],v[216:219],a[200:203],v[24:27]
s_waitcnt lgkmcnt(0)
v_fma_f32 v230,-4.0,v229,v231
v_sub_f32 v231,v231,v229
M v[28:31],v[216:219],a[204:207],v[28:31]
s_waitcnt vmcnt(19)
v_add_f32 v229,v234,v230
v_sub_f32 v234,v234,v230
M v[32:35],v[220:223],a[208:211],v[32:35]
buffer_load_dwordx4 a[252:255],v247,s[20:23],s46 offen offset:0 sc1
M v[36:39],v[220:223],a[212:215],v[36:39]
s_add_u32 s47,s78,39936
v_fma_f32 v230,2.0,v231,v232
v_fmac_f32 v232,-2.0,v231
M v[40:43],v[220:223],a[216:219],v[40:43]
v_and_b32 v196,s42,v196
v_and_b32 v192,s42,v192
M v[44:47],v[220:223],a[220:223],v[44:47]
v_and_b32 v194,s42,v194
v_and_b32 v202,s42,v202
M v[48:51],v[220:223],a[192:195],v[48:51]
buffer_load_dwordx4 a[224:227],v247,s[20:23],s47 offen offset:0 sc1
M v[52:55],v[220:223],a[196:199],v[52:55]
s_add_u32 s48,s78,43008
v_and_b32 v200,s42,v200
v_and_b32 v198,s42,v198
M v[56:59],v[220:223],a[200:203],v[56:59]
v_fmac_f32 v192,s43,v196
v_fmac_f32 v202,4.0,v194
M v[60:63],v[220:223],a[204:207],v[60:63]
s_waitcnt vmcnt(20)
v_fma_f32 v231,-4.0,v196,v200
v_fmac_f32 v192,s45,v200
M v[64:67],v[224:227],a[208:211],v[64:67]
global_load_dword v251,v252,s[82:83]
M v[68:71],v[224:227],a[212:215],v[68:71]
ds_read_b128 a[208:211],v246 offset:19456
v_fmac_f32 v202,s41,v198
M v[72:75],v[224:227],a[216:219],v[72:75]
buffer_load_dwordx4 v[216:219],v247,s[20:23],s48 offen offset:0 sc1
M v[76:79],v[224:227],a[220:223],v[76:79]
v_sub_f32 v200,v200,v196
v_fma_f32 v196,-4.0,v194,v198
M v[80:83],v[224:227],a[192:195],v[80:83]
v_sub_f32 v198,v198,v194
v_add_f32 v194,v231,v196
M v[84:87],v[224:227],a[196:199],v[84:87]
v_sub_f32 v231,v231,v196
v_fma_f32 v196,2.0,v198,v200
M v[88:91],v[224:227],a[200:203],v[88:91]
buffer_load_dwordx4 v[220:223],v247,s[20:23],s46 offen offset:1024 sc1
M v[92:95],v[224:227],a[204:207],v[92:95]
s_waitcnt vmcnt(22)
v_fmac_f32 v200,-2.0,v198
v_cvt_pk_bf16_f32 v192,v228,v192
M v[0:3],a[228:231],a[212:215],v[0:3]
v_cvt_pk_bf16_f32 v202,v233,v202
v_cvt_pk_bf16_f32 v194,v229,v194
M v[4:7],a[228:231],a[216:219],v[4:7]
v_cvt_pk_bf16_f32 v198,v230,v196
v_cvt_pk_bf16_f32 v196,v234,v231
M v[8:11],a[228:231],a[220:223],v[8:11]
buffer_load_dwordx4 v[224:227],v247,s[20:23],s47 offen offset:1024 sc1
M v[12:15],a[228:231],a[192:195],v[12:15]
v_cvt_pk_bf16_f32 v200,v232,v200
v_lshlrev_b32 v230,16,v197
M v[16:19],a[228:231],a[196:199],v[16:19]
v_lshlrev_b32 v228,16,v193
v_lshlrev_b32 v229,16,v195
M v[20:23],a[228:231],a[200:203],v[20:23]
v_lshlrev_b32 v233,16,v203
v_lshlrev_b32 v232,16,v201
M v[24:27],a[228:231],a[204:207],v[24:27]
s_waitcnt lgkmcnt(0)
v_lshlrev_b32 v231,16,v199
v_fmac_f32 v228,s43,v230
M v[28:31],a[228:231],a[208:211],v[28:31]
s_waitcnt vmcnt(22)
buffer_load_dwordx4 a[228:231],v247,s[20:23],s48 offen offset:1024 sc1
M v[32:35],a[232:235],a[212:215],v[32:35]
v_fmac_f32 v233,4.0,v229
v_fma_f32 v234,-4.0,v230,v232
M v[36:39],a[232:235],a[216:219],v[36:39]
v_fmac_f32 v228,s45,v232
v_fmac_f32 v233,s41,v231
M v[40:43],a[232:235],a[220:223],v[40:43]
v_sub_f32 v232,v232,v230
v_fma_f32 v230,-4.0,v229,v231
M v[44:47],a[232:235],a[192:195],v[44:47]
v_sub_f32 v231,v231,v229
v_add_f32 v229,v234,v230
M v[48:51],a[232:235],a[196:199],v[48:51]
v_sub_f32 v234,v234,v230
v_fma_f32 v230,2.0,v231,v232
M v[52:55],a[232:235],a[200:203],v[52:55]
v_fmac_f32 v232,-2.0,v231
v_and_b32 v197,s42,v197
M v[56:59],a[232:235],a[204:207],v[56:59]
v_and_b32 v193,s42,v193
v_and_b32 v195,s42,v195
M v[60:63],a[232:235],a[208:211],v[60:63]
s_waitcnt vmcnt(22)
buffer_load_dwordx4 a[232:235],v247,s[20:23],s46 offen offset:2048 sc1
M v[64:67],a[236:239],a[212:215],v[64:67]
ds_read_b128 a[212:215],v245 offset:19456
v_and_b32 v203,s42,v203
M v[68:71],a[236:239],a[216:219],v[68:71]
v_and_b32 v201,s42,v201
v_and_b32 v199,s42,v199
M v[72:75],a[236:239],a[220:223],v[72:75]
v_fmac_f32 v193,s43,v197
v_fmac_f32 v203,4.0,v195
M v[76:79],a[236:239],a[192:195],v[76:79]
v_fma_f32 v231,-4.0,v197,v201
v_fmac_f32 v193,s45,v201
M v[80:83],a[236:239],a[196:199],v[80:83]
v_fmac_f32 v203,s41,v199
v_sub_f32 v201,v201,v197
M v[84:87],a[236:239],a[200:203],v[84:87]
v_fma_f32 v197,-4.0,v195,v199
v_sub_f32 v199,v199,v195
M v[88:91],a[236:239],a[204:207],v[88:91]
v_add_f32 v195,v231,v197
v_sub_f32 v231,v231,v197
M v[92:95],a[236:239],a[208:211],v[92:95]
s_waitcnt vmcnt(10)
buffer_load_dwordx4 a[236:239],v247,s[20:23],s47 offen offset:2048 sc1
M v[0:3],a[240:243],a[216:219],v[0:3]
v_fma_f32 v197,2.0,v199,v201
v_fmac_f32 v201,-2.0,v199
M v[4:7],a[240:243],a[220:223],v[4:7]
v_cvt_pk_bf16_f32 v193,v228,v193
v_cvt_pk_bf16_f32 v203,v233,v203
M v[8:11],a[240:243],a[192:195],v[8:11]
v_cvt_pk_bf16_f32 v195,v229,v195
v_cvt_pk_bf16_f32 v199,v230,v197
M v[12:15],a[240:243],a[196:199],v[12:15]
v_cvt_pk_bf16_f32 v197,v234,v231
v_cvt_pk_bf16_f32 v201,v232,v201
M v[16:19],a[240:243],a[200:203],v[16:19]
v_add_u32 v228,121856,v243
M v[20:23],a[240:243],a[204:207],v[20:23]
ds_write2st64_b64 v228,v[192:193],v[202:203] offset0:2 offset1:19
M v[24:27],a[240:243],a[208:211],v[24:27]
s_waitcnt lgkmcnt(1)
s_add_u32 s28,s68,6291456
buffer_load_dwordx2 v[192:193],v241,s[12:15],s28 offen offset:0
M v[28:31],a[240:243],a[212:215],v[28:31]
s_waitcnt vmcnt(11)
ds_write2st64_b64 v243,v[194:195],v[196:197] offset0:2 offset1:19
M v[32:35],a[244:247],a[216:219],v[32:35]
buffer_load_dwordx2 v[202:203],v241,s[16:19],s28 offen offset:1536
M v[36:39],a[244:247],a[220:223],v[36:39]
ds_write2st64_b64 v243,v[198:199],v[200:201] offset0:138 offset1:155
M v[40:43],a[244:247],a[192:195],v[40:43]
v_lshlrev_b32 v230,16,v208
v_lshlrev_b32 v228,16,v204
M v[44:47],a[244:247],a[196:199],v[44:47]
buffer_load_dwordx2 v[194:195],v241,s[8:11],s28 offen offset:0
M v[48:51],a[244:247],a[200:203],v[48:51]
v_lshlrev_b32 v229,16,v206
v_lshlrev_b32 v233,16,v214
M v[52:55],a[244:247],a[204:207],v[52:55]
v_lshlrev_b32 v232,16,v212
v_lshlrev_b32 v231,16,v210
M v[56:59],a[244:247],a[208:211],v[56:59]
v_fmac_f32 v228,s43,v230
v_fmac_f32 v233,4.0,v229
M v[60:63],a[244:247],a[212:215],v[60:63]
s_waitcnt vmcnt(12)
buffer_load_dwordx2 v[196:197],v241,s[8:11],s28 offen offset:384
M v[64:67],a[248:251],a[216:219],v[64:67]
ds_read_b128 a[216:219],v245 offset:26112
v_fma_f32 v234,-4.0,v230,v232
M v[68:71],a[248:251],a[220:223],v[68:71]
ds_read_b128 a[220:223],v246 offset:26112
v_fmac_f32 v228,s45,v232
M v[72:75],a[248:251],a[192:195],v[72:75]
ds_read_b128 a[192:195],v245 offset:26624
v_fmac_f32 v233,s41,v231
M v[76:79],a[248:251],a[196:199],v[76:79]
buffer_load_dwordx2 v[198:199],v241,s[8:11],s28 offen offset:768
M v[80:83],a[248:251],a[200:203],v[80:83]
ds_read_b128 a[196:199],v246 offset:26624
ds_read_b128 a[200:203],v245 offset:27136
M v[84:87],a[248:251],a[204:207],v[84:87]
ds_read_b128 a[204:207],v246 offset:27136
v_sub_f32 v232,v232,v230
M v[88:91],a[248:251],a[208:211],v[88:91]
ds_read_b128 a[208:211],v245 offset:27648
v_fma_f32 v230,-4.0,v229,v231
M v[92:95],a[248:251],a[212:215],v[92:95]
s_waitcnt vmcnt(13) lgkmcnt(6)
buffer_load_dwordx2 v[200:201],v241,s[8:11],s28 offen offset:1152
M v[96:99],a[252:255],a[216:219],v[96:99]
s_waitcnt lgkmcnt(5)
ds_read_b128 a[212:215],v246 offset:27648
v_sub_f32 v231,v231,v229
M v[100:103],a[252:255],a[220:223],v[100:103]
s_waitcnt lgkmcnt(5)
v_add_f32 v229,v234,v230
v_sub_f32 v234,v234,v230
M v[104:107],a[252:255],a[192:195],v[104:107]
s_waitcnt lgkmcnt(4)
v_fma_f32 v230,2.0,v231,v232
v_fmac_f32 v232,-2.0,v231
M v[108:111],a[252:255],a[196:199],v[108:111]
s_waitcnt lgkmcnt(3)
buffer_load_dwordx4 a[240:243],v247,s[20:23],s48 offen offset:2048 sc1
M v[112:115],a[252:255],a[200:203],v[112:115]
s_waitcnt lgkmcnt(2)
s_add_u32 s46,s79,9216
v_and_b32 v208,s42,v208
v_and_b32 v204,s42,v204
M v[116:119],a[252:255],a[204:207],v[116:119]
s_waitcnt lgkmcnt(1)
v_and_b32 v206,s42,v206
v_and_b32 v214,s42,v214
M v[120:123],a[252:255],a[208:211],v[120:123]
s_waitcnt lgkmcnt(0)
v_and_b32 v212,s42,v212
v_and_b32 v210,s42,v210
M v[124:127],a[252:255],a[212:215],v[124:127]
s_waitcnt vmcnt(14)
buffer_load_dwordx4 a[244:247],v247,s[20:23],s46 offen offset:0 sc1
M v[128:131],a[224:227],a[216:219],v[128:131]
s_add_u32 s47,s79,12288
v_fmac_f32 v204,s43,v208
v_fmac_f32 v214,4.0,v206
M v[132:135],a[224:227],a[220:223],v[132:135]
v_fma_f32 v231,-4.0,v208,v212
v_fmac_f32 v204,s45,v212
M v[136:139],a[224:227],a[192:195],v[136:139]
v_fmac_f32 v214,s41,v210
v_sub_f32 v212,v212,v208
M v[140:143],a[224:227],a[196:199],v[140:143]
buffer_load_dwordx4 a[248:251],v247,s[20:23],s47 offen offset:0 sc1
M v[144:147],a[224:227],a[200:203],v[144:147]
s_add_u32 s48,s79,15360
v_fma_f32 v208,-4.0,v206,v210
v_sub_f32 v210,v210,v206
M v[148:151],a[224:227],a[204:207],v[148:151]
v_add_f32 v206,v231,v208
v_sub_f32 v231,v231,v208
M v[152:155],a[224:227],a[208:211],v[152:155]
v_fma_f32 v208,2.0,v210,v212
v_fmac_f32 v212,-2.0,v210
M v[156:159],a[224:227],a[212:215],v[156:159]
s_waitcnt vmcnt(14)
buffer_load_dwordx4 a[252:255],v247,s[20:23],s48 offen offset:0 sc1
M v[160:163],v[216:219],a[216:219],v[160:163]
ds_read_b128 a[216:219],v246 offset:28160
v_cvt_pk_bf16_f32 v204,v228,v204
M v[164:167],v[216:219],a[220:223],v[164:167]
v_cvt_pk_bf16_f32 v214,v233,v214
v_cvt_pk_bf16_f32 v206,v229,v206
M v[168:171],v[216:219],a[192:195],v[168:171]
v_cvt_pk_bf16_f32 v210,v230,v208
v_cvt_pk_bf16_f32 v208,v234,v231
M v[172:175],v[216:219],a[196:199],v[172:175]
buffer_load_dwordx4 a[224:227],v247,s[20:23],s46 offen offset:1024 sc1
M v[176:179],v[216:219],a[200:203],v[176:179]
v_cvt_pk_bf16_f32 v212,v232,v212
v_lshlrev_b32 v230,16,v209
M v[180:183],v[216:219],a[204:207],v[180:183]
v_lshlrev_b32 v228,16,v205
v_lshlrev_b32 v229,16,v207
M v[184:187],v[216:219],a[208:211],v[184:187]
v_lshlrev_b32 v233,16,v215
v_lshlrev_b32 v232,16,v213
M v[188:191],v[216:219],a[212:215],v[188:191]
s_waitcnt vmcnt(15)
buffer_load_dwordx4 v[216:219],v247,s[20:23],s47 offen offset:1024 sc1
M v[96:99],v[220:223],a[220:223],v[96:99]
v_lshlrev_b32 v231,16,v211
v_fmac_f32 v228,s43,v230
M v[100:103],v[220:223],a[192:195],v[100:103]
v_fmac_f32 v233,4.0,v229
v_fma_f32 v234,-4.0,v230,v232
M v[104:107],v[220:223],a[196:199],v[104:107]
v_fmac_f32 v228,s45,v232
v_fmac_f32 v233,s41,v231
M v[108:111],v[220:223],a[200:203],v[108:111]
v_sub_f32 v232,v232,v230
v_fma_f32 v230,-4.0,v229,v231
M v[112:115],v[220:223],a[204:207],v[112:115]
v_sub_f32 v231,v231,v229
v_add_f32 v229,v234,v230
M v[116:119],v[220:223],a[208:211],v[116:119]
v_sub_f32 v234,v234,v230
v_fma_f32 v230,2.0,v231,v232
M v[120:123],v[220:223],a[212:215],v[120:123]
s_waitcnt lgkmcnt(0)
v_fmac_f32 v232,-2.0,v231
v_and_b32 v209,s42,v209
M v[124:127],v[220:223],a[216:219],v[124:127]
s_waitcnt vmcnt(15)
buffer_load_dwordx4 v[220:223],v247,s[20:23],s48 offen offset:1024 sc1
M v[128:131],v[224:227],a[220:223],v[128:131]
v_and_b32 v205,s42,v205
v_and_b32 v207,s42,v207
M v[132:135],v[224:227],a[192:195],v[132:135]
v_and_b32 v215,s42,v215
v_and_b32 v213,s42,v213
M v[136:139],v[224:227],a[196:199],v[136:139]
v_and_b32 v211,s42,v211
v_fmac_f32 v205,s43,v209
M v[140:143],v[224:227],a[200:203],v[140:143]
v_fmac_f32 v215,4.0,v207
v_fma_f32 v231,-4.0,v209,v213
M v[144:147],v[224:227],a[204:207],v[144:147]
v_fmac_f32 v205,s45,v213
v_fmac_f32 v215,s41,v211
M v[148:151],v[224:227],a[208:211],v[148:151]
v_sub_f32 v213,v213,v209
v_fma_f32 v209,-4.0,v207,v211
M v[152:155],v[224:227],a[212:215],v[152:155]
v_sub_f32 v211,v211,v207
v_add_f32 v207,v231,v209
M v[156:159],v[224:227],a[216:219],v[156:159]
s_waitcnt vmcnt(15)
buffer_load_dwordx4 v[224:227],v247,s[20:23],s46 offen offset:2048 sc1
M v[160:163],a[228:231],a[220:223],v[160:163]
ds_read_b128 a[220:223],v245 offset:28160
v_sub_f32 v231,v231,v209
M v[164:167],a[228:231],a[192:195],v[164:167]
v_fma_f32 v209,2.0,v211,v213
v_fmac_f32 v213,-2.0,v211
M v[168:171],a[228:231],a[196:199],v[168:171]
v_cvt_pk_bf16_f32 v205,v228,v205
v_cvt_pk_bf16_f32 v215,v233,v215
M v[172:175],a[228:231],a[200:203],v[172:175]
v_cvt_pk_bf16_f32 v207,v229,v207
v_cvt_pk_bf16_f32 v211,v230,v209
M v[176:179],a[228:231],a[204:207],v[176:179]
v_cvt_pk_bf16_f32 v209,v234,v231
v_cvt_pk_bf16_f32 v213,v232,v213
M v[180:183],a[228:231],a[208:211],v[180:183]
v_add_u32 v228,121856,v243
M v[184:187],a[228:231],a[212:215],v[184:187]
ds_write2st64_b64 v228,v[204:205],v[214:215] offset0:3 offset1:20
M v[188:191],a[228:231],a[216:219],v[188:191]
s_waitcnt vmcnt(15)
s_add_u32 s28,s68,6684672
buffer_load_dwordx2 v[204:205],v241,s[12:15],s28 offen offset:0
M v[96:99],a[232:235],a[192:195],v[96:99]
ds_write2st64_b64 v243,v[206:207],v[208:209] offset0:3 offset1:20
M v[100:103],a[232:235],a[196:199],v[100:103]
buffer_load_dwordx2 v[214:215],v241,s[16:19],s28 offen offset:1536
M v[104:107],a[232:235],a[200:203],v[104:107]
ds_write2st64_b64 v243,v[210:211],v[212:213] offset0:139 offset1:156
M v[108:111],a[232:235],a[204:207],v[108:111]
s_waitcnt vmcnt(12)
v_lshlrev_b32 v230,16,v196
v_lshlrev_b32 v228,16,v192
M v[112:115],a[232:235],a[208:211],v[112:115]
buffer_load_dwordx2 v[206:207],v241,s[8:11],s28 offen offset:0
M v[116:119],a[232:235],a[212:215],v[116:119]
v_lshlrev_b32 v229,16,v194
v_lshlrev_b32 v233,16,v202
M v[120:123],a[232:235],a[216:219],v[120:123]
s_waitcnt vmcnt(11) lgkmcnt(3)
v_lshlrev_b32 v232,16,v200
v_lshlrev_b32 v231,16,v198
M v[124:127],a[232:235],a[220:223],v[124:127]
v_fmac_f32 v228,s43,v230
v_fmac_f32 v233,4.0,v229
M v[128:131],a[236:239],a[192:195],v[128:131]
buffer_load_dwordx2 v[208:209],v241,s[8:11],s28 offen offset:384
M v[132:135],a[236:239],a[196:199],v[132:135]
v_fma_f32 v234,-4.0,v230,v232
v_fmac_f32 v228,s45,v232
M v[136:139],a[236:239],a[200:203],v[136:139]
v_fmac_f32 v233,s41,v231
v_sub_f32 v232,v232,v230
M v[140:143],a[236:239],a[204:207],v[140:143]
v_fma_f32 v230,-4.0,v229,v231
v_sub_f32 v231,v231,v229
M v[144:147],a[236:239],a[208:211],v[144:147]
buffer_load_dwordx2 v[210:211],v241,s[8:11],s28 offen offset:768
M v[148:151],a[236:239],a[212:215],v[148:151]
v_add_u32 v245,0xffffbc00,v245
v_add_u32 v246,0xffffbc00,v246
M v[152:155],a[236:239],a[216:219],v[152:155]
s_waitcnt lgkmcnt(0)
s_barrier
v_add_f32 v229,v234,v230
M v[156:159],a[236:239],a[220:223],v[156:159]
s_waitcnt vmcnt(12)
v_sub_f32 v234,v234,v230
v_fma_f32 v230,2.0,v231,v232
M v[160:163],a[240:243],a[192:195],v[160:163]
buffer_load_dwordx2 v[212:213],v241,s[8:11],s28 offen offset:1152
M v[164:167],a[240:243],a[196:199],v[164:167]
ds_read_b128 a[192:195],v245 offset:0
ds_read_b128 a[196:199],v246 offset:0
M v[168:171],a[240:243],a[200:203],v[168:171]
ds_read_b128 a[200:203],v245 offset:512
v_fmac_f32 v232,-2.0,v231
M v[172:175],a[240:243],a[204:207],v[172:175]
ds_read_b128 a[204:207],v246 offset:512
v_and_b32 v196,s42,v196
M v[176:179],a[240:243],a[208:211],v[176:179]
buffer_load_dwordx4 a[228:231],v247,s[20:23],s47 offen offset:2048 sc1
M v[180:183],a[240:243],a[212:215],v[180:183]
ds_read_b128 a[208:211],v245 offset:1024
ds_read_b128 a[212:215],v246 offset:1024
M v[184:187],a[240:243],a[216:219],v[184:187]
ds_read_b128 a[216:219],v245 offset:1536
v_and_b32 v192,s42,v192
M v[188:191],a[240:243],a[220:223],v[188:191]
s_waitcnt vmcnt(13) lgkmcnt(6)
ds_read_b128 a[220:223],v246 offset:1536
v_and_b32 v194,s42,v194
M a[0:3],a[244:247],a[192:195],a[0:3]
s_waitcnt lgkmcnt(6)
buffer_load_dwordx4 a[232:235],v247,s[20:23],s48 offen offset:2048 sc1
M a[4:7],a[244:247],a[196:199],a[4:7]
s_waitcnt lgkmcnt(5)
s_add_u32 s46,s79,18432
v_and_b32 v202,s42,v202
v_and_b32 v200,s42,v200
M a[8:11],a[244:247],a[200:203],a[8:11]
s_waitcnt lgkmcnt(4)
v_and_b32 v198,s42,v198
v_fmac_f32 v192,s43,v196
M a[12:15],a[244:247],a[204:207],a[12:15]
s_waitcnt lgkmcnt(3)
v_fmac_f32 v202,4.0,v194
v_fma_f32 v231,-4.0,v196,v200
M a[16:19],a[244:247],a[208:211],a[16:19]
s_waitcnt lgkmcnt(2)
buffer_load_dwordx4 a[236:239],v247,s[20:23],s46 offen offset:0 sc1
M a[20:23],a[244:247],a[212:215],a[20:23]
s_waitcnt lgkmcnt(1)
s_add_u32 s47,s79,21504
v_fmac_f32 v192,s45,v200
v_fmac_f32 v202,s41,v198
M a[24:27],a[244:247],a[216:219],a[24:27]
s_waitcnt lgkmcnt(0)
v_sub_f32 v200,v200,v196
v_fma_f32 v196,-4.0,v194,v198
M a[28:31],a[244:247],a[220:223],a[28:31]
s_waitcnt vmcnt(14)
v_sub_f32 v198,v198,v194
v_add_f32 v194,v231,v196
M a[32:35],a[248:251],a[192:195],a[32:35]
buffer_load_dwordx4 a[240:243],v247,s[20:23],s47 offen offset:0 sc1
M a[36:39],a[248:251],a[196:199],a[36:39]
s_add_u32 s48,s79,24576
v_sub_f32 v231,v231,v196
v_fma_f32 v196,2.0,v198,v200
M a[40:43],a[248:251],a[200:203],a[40:43]
v_fmac_f32 v200,-2.0,v198
v_cvt_pk_bf16_f32 v192,v228,v192
M a[44:47],a[248:251],a[204:207],a[44:47]
v_cvt_pk_bf16_f32 v202,v233,v202
v_cvt_pk_bf16_f32 v194,v229,v194
M a[48:51],a[248:251],a[208:211],a[48:51]
buffer_load_dwordx4 a[244:247],v247,s[20:23],s48 offen offset:0 sc1
M a[52:55],a[248:251],a[212:215],a[52:55]
v_cvt_pk_bf16_f32 v198,v230,v196
v_cvt_pk_bf16_f32 v196,v234,v231
M a[56:59],a[248:251],a[216:219],a[56:59]
v_cvt_pk_bf16_f32 v200,v232,v200
v_lshlrev_b32 v230,16,v197
M a[60:63],a[248:251],a[220:223],a[60:63]
s_waitcnt vmcnt(15)
v_lshlrev_b32 v228,16,v193
v_lshlrev_b32 v229,16,v195
M a[64:67],a[252:255],a[192:195],a[64:67]
buffer_load_dwordx4 a[248:251],v247,s[20:23],s46 offen offset:1024 sc1
M a[68:71],a[252:255],a[196:199],a[68:71]
ds_read_b128 a[192:195],v246 offset:2048
v_lshlrev_b32 v233,16,v203
M a[72:75],a[252:255],a[200:203],a[72:75]
v_lshlrev_b32 v232,16,v201
v_lshlrev_b32 v231,16,v199
M a[76:79],a[252:255],a[204:207],a[76:79]
v_fmac_f32 v228,s43,v230
v_fmac_f32 v233,4.0,v229
M a[80:83],a[252:255],a[208:211],a[80:83]
v_fma_f32 v234,-4.0,v230,v232
v_fmac_f32 v228,s45,v232
M a[84:87],a[252:255],a[212:215],a[84:87]
v_fmac_f32 v233,s41,v231
v_sub_f32 v232,v232,v230
M a[88:91],a[252:255],a[216:219],a[88:91]
v_fma_f32 v230,-4.0,v229,v231
v_sub_f32 v231,v231,v229
M a[92:95],a[252:255],a[220:223],a[92:95]
s_waitcnt vmcnt(15)
buffer_load_dwordx4 a[252:255],v247,s[20:23],s47 offen offset:1024 sc1
M a[0:3],a[224:227],a[196:199],a[0:3]
v_add_f32 v229,v234,v230
v_sub_f32 v234,v234,v230
M a[4:7],a[224:227],a[200:203],a[4:7]
v_fma_f32 v230,2.0,v231,v232
v_fmac_f32 v232,-2.0,v231
M a[8:11],a[224:227],a[204:207],a[8:11]
v_and_b32 v197,s42,v197
v_and_b32 v193,s42,v193
M a[12:15],a[224:227],a[208:211],a[12:15]
v_and_b32 v195,s42,v195
v_and_b32 v203,s42,v203
M a[16:19],a[224:227],a[212:215],a[16:19]
v_and_b32 v201,s42,v201
v_and_b32 v199,s42,v199
M a[20:23],a[224:227],a[216:219],a[20:23]
v_fmac_f32 v193,s43,v197
v_fmac_f32 v203,4.0,v195
M a[24:27],a[224:227],a[220:223],a[24:27]
s_waitcnt lgkmcnt(0)
v_fma_f32 v231,-4.0,v197,v201
v_fmac_f32 v193,s45,v201
M a[28:31],a[224:227],a[192:195],a[28:31]
s_waitcnt vmcnt(15)
buffer_load_dwordx4 a[224:227],v247,s[20:23],s48 offen offset:1024 sc1
M a[32:35],v[216:219],a[196:199],a[32:35]
v_fmac_f32 v203,s41,v199
v_sub_f32 v201,v201,v197
M a[36:39],v[216:219],a[200:203],a[36:39]
v_fma_f32 v197,-4.0,v195,v199
v_sub_f32 v199,v199,v195
M a[40:43],v[216:219],a[204:207],a[40:43]
v_add_f32 v195,v231,v197
v_sub_f32 v231,v231,v197
M a[44:47],v[216:219],a[208:211],a[44:47]
v_fma_f32 v197,2.0,v199,v201
v_fmac_f32 v201,-2.0,v199
M a[48:51],v[216:219],a[212:215],a[48:51]
v_cvt_pk_bf16_f32 v193,v228,v193
v_cvt_pk_bf16_f32 v203,v233,v203
M a[52:55],v[216:219],a[216:219],a[52:55]
v_cvt_pk_bf16_f32 v195,v229,v195
v_cvt_pk_bf16_f32 v199,v230,v197
M a[56:59],v[216:219],a[220:223],a[56:59]
v_cvt_pk_bf16_f32 v197,v234,v231
v_cvt_pk_bf16_f32 v201,v232,v201
M a[60:63],v[216:219],a[192:195],a[60:63]
s_waitcnt vmcnt(15)
buffer_load_dwordx4 v[216:219],v247,s[20:23],s46 offen offset:2048 sc1
M a[64:67],v[220:223],a[196:199],a[64:67]
ds_read_b128 a[196:199],v245 offset:2048
v_add_u32 v228,139264,v243
M a[68:71],v[220:223],a[200:203],a[68:71]
ds_write2st64_b64 v228,v[192:193],v[202:203] offset0:0 offset1:17
M a[72:75],v[220:223],a[204:207],a[72:75]
s_add_u32 s28,s68,7077888
buffer_load_dwordx2 v[192:193],v241,s[12:15],s28 offen offset:0
M a[76:79],v[220:223],a[208:211],a[76:79]
ds_write2st64_b64 v243,v[194:195],v[196:197] offset0:34 offset1:51
M a[80:83],v[220:223],a[212:215],a[80:83]
buffer_load_dwordx2 v[202:203],v241,s[16:19],s28 offen offset:1536
M a[84:87],v[220:223],a[216:219],a[84:87]
ds_write2st64_b64 v243,v[198:199],v[200:201] offset0:68 offset1:85
M a[88:91],v[220:223],a[220:223],a[88:91]
s_waitcnt vmcnt(13)
v_lshlrev_b32 v230,16,v208
v_lshlrev_b32 v228,16,v204
M a[92:95],v[220:223],a[192:195],a[92:95]
buffer_load_dwordx2 v[194:195],v241,s[8:11],s28 offen offset:0
M a[0:3],v[224:227],a[200:203],a[0:3]
v_lshlrev_b32 v229,16,v206
v_lshlrev_b32 v233,16,v214
M a[4:7],v[224:227],a[204:207],a[4:7]
s_waitcnt vmcnt(12)
v_lshlrev_b32 v232,16,v212
v_lshlrev_b32 v231,16,v210
M a[8:11],v[224:227],a[208:211],a[8:11]
v_fmac_f32 v228,s43,v230
v_fmac_f32 v233,4.0,v229
M a[12:15],v[224:227],a[212:215],a[12:15]
buffer_load_dwordx2 v[196:197],v241,s[8:11],s28 offen offset:384
M a[16:19],v[224:227],a[216:219],a[16:19]
v_fma_f32 v234,-4.0,v230,v232
v_fmac_f32 v228,s45,v232
M a[20:23],v[224:227],a[220:223],a[20:23]
v_fmac_f32 v233,s41,v231
v_sub_f32 v232,v232,v230
M a[24:27],v[224:227],a[192:195],a[24:27]
s_waitcnt lgkmcnt(3)
v_fma_f32 v230,-4.0,v229,v231
v_sub_f32 v231,v231,v229
M a[28:31],v[224:227],a[196:199],a[28:31]
s_waitcnt vmcnt(12)
buffer_load_dwordx2 v[198:199],v241,s[8:11],s28 offen offset:768
M a[32:35],a[228:231],a[200:203],a[32:35]
v_add_f32 v229,v234,v230
v_sub_f32 v234,v234,v230
M a[36:39],a[228:231],a[204:207],a[36:39]
v_fma_f32 v230,2.0,v231,v232
v_fmac_f32 v232,-2.0,v231
M a[40:43],a[228:231],a[208:211],a[40:43]
v_and_b32 v208,s42,v208
v_and_b32 v204,s42,v204
M a[44:47],a[228:231],a[212:215],a[44:47]
buffer_load_dwordx2 v[200:201],v241,s[8:11],s28 offen offset:1152
M a[48:51],a[228:231],a[216:219],a[48:51]
v_and_b32 v206,s42,v206
v_and_b32 v214,s42,v214
M a[52:55],a[228:231],a[220:223],a[52:55]
v_and_b32 v212,s42,v212
v_and_b32 v210,s42,v210
M a[56:59],a[228:231],a[192:195],a[56:59]
v_fmac_f32 v204,s43,v208
v_fmac_f32 v214,4.0,v206
M a[60:63],a[228:231],a[196:199],a[60:63]
s_waitcnt vmcnt(13)
buffer_load_dwordx4 v[220:223],v247,s[20:23],s47 offen offset:2048 sc1
M a[64:67],a[232:235],a[200:203],a[64:67]
ds_read_b128 a[200:203],v245 offset:8704
v_fma_f32 v231,-4.0,v208,v212
M a[68:71],a[232:235],a[204:207],a[68:71]
ds_read_b128 a[204:207],v246 offset:8704
v_fmac_f32 v204,s45,v212
M a[72:75],a[232:235],a[208:211],a[72:75]
ds_read_b128 a[208:211],v245 offset:9216
v_fmac_f32 v214,s41,v210
M a[76:79],a[232:235],a[212:215],a[76:79]
buffer_load_dwordx4 v[224:227],v247,s[20:23],s48 offen offset:2048 sc1
M a[80:83],a[232:235],a[216:219],a[80:83]
s_add_u32 s46,s79,27648
ds_read_b128 a[212:215],v246 offset:9216
ds_read_b128 a[216:219],v245 offset:9728
M a[84:87],a[232:235],a[220:223],a[84:87]
ds_read_b128 a[220:223],v246 offset:9728
v_sub_f32 v212,v212,v208
M a[88:91],a[232:235],a[192:195],a[88:91]
ds_read_b128 a[192:195],v245 offset:10240
v_fma_f32 v208,-4.0,v206,v210
M a[92:95],a[232:235],a[196:199],a[92:95]
s_waitcnt vmcnt(14) lgkmcnt(6)
buffer_load_dwordx4 a[228:231],v247,s[20:23],s46 offen offset:0 sc1
M a[96:99],a[236:239],a[200:203],a[96:99]
s_waitcnt lgkmcnt(5)
s_add_u32 s47,s79,30720
ds_read_b128 a[196:199],v246 offset:10240
v_sub_f32 v210,v210,v206
M a[100:103],a[236:239],a[204:207],a[100:103]
s_waitcnt lgkmcnt(5)
v_add_f32 v206,v231,v208
v_sub_f32 v231,v231,v208
M a[104:107],a[236:239],a[208:211],a[104:107]
s_waitcnt lgkmcnt(4)
v_fma_f32 v208,2.0,v210,v212
v_fmac_f32 v212,-2.0,v210
M a[108:111],a[236:239],a[212:215],a[108:111]
s_waitcnt lgkmcnt(3)
buffer_load_dwordx4 a[232:235],v247,s[20:23],s47 offen offset:0 sc1
M a[112:115],a[236:239],a[216:219],a[112:115]
s_waitcnt lgkmcnt(2)
s_add_u32 s48,s79,33792
v_cvt_pk_bf16_f32 v204,v228,v204
v_cvt_pk_bf16_f32 v214,v233,v214
M a[116:119],a[236:239],a[220:223],a[116:119]
s_waitcnt lgkmcnt(1)
v_cvt_pk_bf16_f32 v206,v229,v206
v_cvt_pk_bf16_f32 v210,v230,v208
M a[120:123],a[236:239],a[192:195],a[120:123]
s_waitcnt lgkmcnt(0)
v_cvt_pk_bf16_f32 v208,v234,v231
v_cvt_pk_bf16_f32 v212,v232,v212
M a[124:127],a[236:239],a[196:199],a[124:127]
s_waitcnt vmcnt(15)
buffer_load_dwordx4 a[236:239],v247,s[20:23],s48 offen offset:0 sc1
M a[128:131],a[240:243],a[200:203],a[128:131]
v_lshlrev_b32 v230,16,v209
v_lshlrev_b32 v228,16,v205
M a[132:135],a[240:243],a[204:207],a[132:135]
v_lshlrev_b32 v229,16,v207
v_lshlrev_b32 v233,16,v215
M a[136:139],a[240:243],a[208:211],a[136:139]
v_lshlrev_b32 v232,16,v213
v_lshlrev_b32 v231,16,v211
M a[140:143],a[240:243],a[212:215],a[140:143]
v_fmac_f32 v228,s43,v230
v_fmac_f32 v233,4.0,v229
M a[144:147],a[240:243],a[216:219],a[144:147]
v_fma_f32 v234,-4.0,v230,v232
v_fmac_f32 v228,s45,v232
M a[148:151],a[240:243],a[220:223],a[148:151]
v_fmac_f32 v233,s41,v231
v_sub_f32 v232,v232,v230
M a[152:155],a[240:243],a[192:195],a[152:155]
v_fma_f32 v230,-4.0,v229,v231
v_sub_f32 v231,v231,v229
M a[156:159],a[240:243],a[196:199],a[156:159]
s_waitcnt vmcnt(15)
buffer_load_dwordx4 a[240:243],v247,s[20:23],s46 offen offset:1024 sc1
M a[160:163],a[244:247],a[200:203],a[160:163]
ds_read_b128 a[200:203],v246 offset:10752
v_add_f32 v229,v234,v230
M a[164:167],a[244:247],a[204:207],a[164:167]
v_sub_f32 v234,v234,v230
v_fma_f32 v230,2.0,v231,v232
M a[168:171],a[244:247],a[208:211],a[168:171]
v_fmac_f32 v232,-2.0,v231
v_and_b32 v209,s42,v209
M a[172:175],a[244:247],a[212:215],a[172:175]
v_and_b32 v205,s42,v205
v_and_b32 v207,s42,v207
M a[176:179],a[244:247],a[216:219],a[176:179]
v_and_b32 v215,s42,v215
v_and_b32 v213,s42,v213
M a[180:183],a[244:247],a[220:223],a[180:183]
v_and_b32 v211,s42,v211
v_fmac_f32 v205,s43,v209
M a[184:187],a[244:247],a[192:195],a[184:187]
v_fmac_f32 v215,4.0,v207
v_fma_f32 v231,-4.0,v209,v213
M a[188:191],a[244:247],a[196:199],a[188:191]
s_waitcnt vmcnt(15)
buffer_load_dwordx4 a[244:247],v247,s[20:23],s47 offen offset:1024 sc1
M a[96:99],a[248:251],a[204:207],a[96:99]
v_fmac_f32 v205,s45,v213
v_fmac_f32 v215,s41,v211
M a[100:103],a[248:251],a[208:211],a[100:103]
v_sub_f32 v213,v213,v209
v_fma_f32 v209,-4.0,v207,v211
M a[104:107],a[248:251],a[212:215],a[104:107]
v_sub_f32 v211,v211,v207
v_add_f32 v207,v231,v209
M a[108:111],a[248:251],a[216:219],a[108:111]
v_sub_f32 v231,v231,v209
v_fma_f32 v209,2.0,v211,v213
M a[112:115],a[248:251],a[220:223],a[112:115]
v_fmac_f32 v213,-2.0,v211
v_cvt_pk_bf16_f32 v205,v228,v205
M a[116:119],a[248:251],a[192:195],a[116:119]
v_cvt_pk_bf16_f32 v215,v233,v215
v_cvt_pk_bf16_f32 v207,v229,v207
M a[120:123],a[248:251],a[196:199],a[120:123]
s_waitcnt lgkmcnt(0)
v_cvt_pk_bf16_f32 v211,v230,v209
v_cvt_pk_bf16_f32 v209,v234,v231
M a[124:127],a[248:251],a[200:203],a[124:127]
s_waitcnt vmcnt(15)
buffer_load_dwordx4 a[248:251],v247,s[20:23],s48 offen offset:1024 sc1
M a[128:131],a[252:255],a[204:207],a[128:131]
v_cvt_pk_bf16_f32 v213,v232,v213
v_add_u32 v228,139264,v243
M a[132:135],a[252:255],a[208:211],a[132:135]
ds_write2st64_b64 v228,v[204:205],v[214:215] offset0:1 offset1:18
M a[136:139],a[252:255],a[212:215],a[136:139]
s_add_u32 s28,s68,7471104
buffer_load_dwordx2 v[204:205],v241,s[12:15],s28 offen offset:0
M a[140:143],a[252:255],a[216:219],a[140:143]
ds_write2st64_b64 v243,v[206:207],v[208:209] offset0:35 offset1:52
M a[144:147],a[252:255],a[220:223],a[144:147]
buffer_load_dwordx2 v[214:215],v241,s[16:19],s28 offen offset:1536
M a[148:151],a[252:255],a[192:195],a[148:151]
ds_write2st64_b64 v243,v[210:211],v[212:213] offset0:69 offset1:86
M a[152:155],a[252:255],a[196:199],a[152:155]
v_fmac_f32 v235,s43,v237
v_fmac_f32 v240,4.0,v236
M a[156:159],a[252:255],a[200:203],a[156:159]
s_waitcnt vmcnt(17)
buffer_load_dwordx2 v[206:207],v241,s[8:11],s28 offen offset:0
M a[160:163],a[224:227],a[204:207],a[160:163]
ds_read_b128 a[204:207],v245 offset:10752
v_fma_f32 v228,-4.0,v237,v239
M a[164:167],a[224:227],a[208:211],a[164:167]
v_fmac_f32 v235,s45,v239
v_fmac_f32 v240,s41,v238
M a[168:171],a[224:227],a[212:215],a[168:171]
v_sub_f32 v239,v239,v237
v_fma_f32 v237,-4.0,v236,v238
M a[172:175],a[224:227],a[216:219],a[172:175]
buffer_load_dwordx2 v[208:209],v241,s[8:11],s28 offen offset:384
M a[176:179],a[224:227],a[220:223],a[176:179]
v_sub_f32 v238,v238,v236
v_add_f32 v236,v228,v237
M a[180:183],a[224:227],a[192:195],a[180:183]
v_sub_f32 v228,v228,v237
v_fma_f32 v237,2.0,v238,v239
M a[184:187],a[224:227],a[196:199],a[184:187]
v_fmac_f32 v239,-2.0,v238
v_cvt_pk_bf16_f32 v229,v235,v240
M a[188:191],a[224:227],a[200:203],a[188:191]
s_waitcnt vmcnt(18)
buffer_load_dwordx2 v[210:211],v241,s[8:11],s28 offen offset:768
M a[96:99],v[216:219],a[208:211],a[96:99]
v_cvt_pk_bf16_f32 v230,v236,v228
v_cvt_pk_bf16_f32 v231,v237,v239
M a[100:103],v[216:219],a[212:215],a[100:103]
v_add_u32 v228,139264,v244
M a[104:107],v[216:219],a[216:219],a[104:107]
ds_write_b16 v228,v229 offset:0
M a[108:111],v[216:219],a[220:223],a[108:111]
buffer_load_dwordx2 v[212:213],v241,s[8:11],s28 offen offset:1152
M a[112:115],v[216:219],a[192:195],a[112:115]
s_add_u32 s29,s69,6291456
ds_write_b16_d16_hi v228,v229 offset:8704
M a[116:119],v[216:219],a[196:199],a[116:119]
ds_write_b16 v244,v230 offset:17408
M a[120:123],v[216:219],a[200:203],a[120:123]
s_waitcnt lgkmcnt(3)
ds_write_b16_d16_hi v244,v230 offset:26112
M a[124:127],v[216:219],a[204:207],a[124:127]
s_waitcnt vmcnt(13)
buffer_load_short_d16_hi v235,v242,s[12:15],s29 offen offset:0
M a[128:131],v[220:223],a[208:211],a[128:131]
ds_write_b16 v244,v231 offset:34816
M a[132:135],v[220:223],a[212:215],a[132:135]
buffer_load_short_d16_hi v236,v242,s[8:11],s29 offen offset:0
M a[136:139],v[220:223],a[216:219],a[136:139]
ds_write_b16_d16_hi v244,v231 offset:43520
M a[140:143],v[220:223],a[220:223],a[140:143]
buffer_load_short_d16_hi v237,v242,s[8:11],s29 offen offset:384
M a[144:147],v[220:223],a[192:195],a[144:147]
v_lshlrev_b32 v230,16,v196
v_lshlrev_b32 v228,16,v192
M a[148:151],v[220:223],a[196:199],a[148:151]
buffer_load_short_d16_hi v238,v242,s[8:11],s29 offen offset:768
M a[152:155],v[220:223],a[200:203],a[152:155]
v_add_u32 v245,0x4400,v245
v_add_u32 v246,0x4400,v246
M a[156:159],v[220:223],a[204:207],a[156:159]
s_waitcnt vmcnt(16)
buffer_load_short_d16_hi v239,v242,s[8:11],s29 offen offset:1152
M a[160:163],v[224:227],a[208:211],a[160:163]
ds_read_b128 a[208:211],v245 offset:52224
v_lshlrev_b32 v229,16,v194
M a[164:167],v[224:227],a[212:215],a[164:167]
buffer_load_short_d16_hi v240,v242,s[16:19],s29 offen offset:1536
M a[168:171],v[224:227],a[216:219],a[168:171]
ds_read_b128 a[212:215],v246 offset:52224
ds_read_b128 a[216:219],v245 offset:52736
M a[172:175],v[224:227],a[220:223],a[172:175]
buffer_load_dwordx4 a[252:255],v247,s[20:23],s46 offen offset:2048 sc1
M a[176:179],v[224:227],a[192:195],a[176:179]
ds_read_b128 a[220:223],v246 offset:52736
ds_read_b128 a[192:195],v245 offset:53248
M a[180:183],v[224:227],a[196:199],a[180:183]
ds_read_b128 a[196:199],v246 offset:53248
v_lshlrev_b32 v233,16,v202
M a[184:187],v[224:227],a[200:203],a[184:187]
ds_read_b128 a[200:203],v245 offset:53760
v_lshlrev_b32 v232,16,v200
M a[188:191],v[224:227],a[204:207],a[188:191]
s_waitcnt vmcnt(18) lgkmcnt(6)
buffer_load_dwordx4 a[224:227],v247,s[20:23],s47 offen offset:2048 sc1
M v[0:3],a[228:231],a[208:211],v[0:3]
s_waitcnt lgkmcnt(5)
ds_read_b128 a[204:207],v246 offset:53760
v_lshlrev_b32 v231,16,v198
M v[4:7],a[228:231],a[212:215],v[4:7]
s_waitcnt lgkmcnt(5)
v_fmac_f32 v228,s43,v230
v_fmac_f32 v233,4.0,v229
M v[8:11],a[228:231],a[216:219],v[8:11]
s_waitcnt lgkmcnt(4)
v_fma_f32 v234,-4.0,v230,v232
v_fmac_f32 v228,s45,v232
M v[12:15],a[228:231],a[220:223],v[12:15]
s_waitcnt lgkmcnt(3)
buffer_load_dwordx4 v[216:219],v247,s[20:23],s48 offen offset:2048 sc1
M v[16:19],a[228:231],a[192:195],v[16:19]
s_waitcnt lgkmcnt(2)
s_add_u32 s46,s79,36864
v_fmac_f32 v233,s41,v231
v_sub_f32 v232,v232,v230
M v[20:23],a[228:231],a[196:199],v[20:23]
s_waitcnt lgkmcnt(1)
v_fma_f32 v230,-4.0,v229,v231
v_sub_f32 v231,v231,v229
M v[24:27],a[228:231],a[200:203],v[24:27]
s_waitcnt lgkmcnt(0)
v_add_f32 v229,v234,v230
v_sub_f32 v234,v234,v230
M v[28:31],a[228:231],a[204:207],v[28:31]
s_waitcnt vmcnt(19)
buffer_load_dwordx4 v[220:223],v247,s[20:23],s46 offen offset:0 sc1
M v[32:35],a[232:235],a[208:211],v[32:35]
s_add_u32 s47,s79,39936
v_fma_f32 v230,2.0,v231,v232
v_fmac_f32 v232,-2.0,v231
M v[36:39],a[232:235],a[212:215],v[36:39]
v_and_b32 v196,s42,v196
v_and_b32 v192,s42,v192
M v[40:43],a[232:235],a[216:219],v[40:43]
v_and_b32 v194,s42,v194
v_and_b32 v202,s42,v202
M v[44:47],a[232:235],a[220:223],v[44:47]
buffer_load_dwordx4 v[224:227],v247,s[20:23],s47 offen offset:0 sc1
M v[48:51],a[232:235],a[192:195],v[48:51]
s_add_u32 s48,s79,43008
v_and_b32 v200,s42,v200
v_and_b32 v198,s42,v198
M v[52:55],a[232:235],a[196:199],v[52:55]
v_fmac_f32 v192,s43,v196
v_fmac_f32 v202,4.0,v194
M v[56:59],a[232:235],a[200:203],v[56:59]
v_fma_f32 v231,-4.0,v196,v200
v_fmac_f32 v192,s45,v200
M v[60:63],a[232:235],a[204:207],v[60:63]
s_waitcnt vmcnt(20)
global_load_dword v251,v252,s[82:83]
M v[64:67],a[236:239],a[208:211],v[64:67]
ds_read_b128 a[208:211],v246 offset:54272
v_fmac_f32 v202,s41,v198
M v[68:71],a[236:239],a[212:215],v[68:71]
buffer_load_dwordx4 a[228:231],v247,s[20:23],s48 offen offset:0 sc1
M v[72:75],a[236:239],a[216:219],v[72:75]
v_sub_f32 v200,v200,v196
v_fma_f32 v196,-4.0,v194,v198
M v[76:79],a[236:239],a[220:223],v[76:79]
v_sub_f32 v198,v198,v194
v_add_f32 v194,v231,v196
M v[80:83],a[236:239],a[192:195],v[80:83]
v_sub_f32 v231,v231,v196
v_fma_f32 v196,2.0,v198,v200
M v[84:87],a[236:239],a[196:199],v[84:87]
buffer_load_dwordx4 a[232:235],v247,s[20:23],s46 offen offset:1024 sc1
M v[88:91],a[236:239],a[200:203],v[88:91]
v_fmac_f32 v200,-2.0,v198
v_cvt_pk_bf16_f32 v192,v228,v192
M v[92:95],a[236:239],a[204:207],v[92:95]
s_waitcnt vmcnt(22)
v_cvt_pk_bf16_f32 v202,v233,v202
v_cvt_pk_bf16_f32 v194,v229,v194
M v[0:3],a[240:243],a[212:215],v[0:3]
v_cvt_pk_bf16_f32 v198,v230,v196
v_cvt_pk_bf16_f32 v196,v234,v231
M v[4:7],a[240:243],a[216:219],v[4:7]
buffer_load_dwordx4 a[236:239],v247,s[20:23],s47 offen offset:1024 sc1
M v[8:11],a[240:243],a[220:223],v[8:11]
v_cvt_pk_bf16_f32 v200,v232,v200
v_lshlrev_b32 v230,16,v197
M v[12:15],a[240:243],a[192:195],v[12:15]
v_lshlrev_b32 v228,16,v193
v_lshlrev_b32 v229,16,v195
M v[16:19],a[240:243],a[196:199],v[16:19]
v_lshlrev_b32 v233,16,v203
v_lshlrev_b32 v232,16,v201
M v[20:23],a[240:243],a[200:203],v[20:23]
v_lshlrev_b32 v231,16,v199
v_fmac_f32 v228,s43,v230
M v[24:27],a[240:243],a[204:207],v[24:27]
s_waitcnt lgkmcnt(0)
v_fmac_f32 v233,4.0,v229
v_fma_f32 v234,-4.0,v230,v232
M v[28:31],a[240:243],a[208:211],v[28:31]
s_waitcnt vmcnt(22)
buffer_load_dwordx4 a[240:243],v247,s[20:23],s48 offen offset:1024 sc1
M v[32:35],a[244:247],a[212:215],v[32:35]
v_fmac_f32 v228,s45,v232
v_fmac_f32 v233,s41,v231
M v[36:39],a[244:247],a[216:219],v[36:39]
v_sub_f32 v232,v232,v230
v_fma_f32 v230,-4.0,v229,v231
M v[40:43],a[244:247],a[220:223],v[40:43]
v_sub_f32 v231,v231,v229
v_add_f32 v229,v234,v230
M v[44:47],a[244:247],a[192:195],v[44:47]
v_sub_f32 v234,v234,v230
v_fma_f32 v230,2.0,v231,v232
M v[48:51],a[244:247],a[196:199],v[48:51]
v_fmac_f32 v232,-2.0,v231
v_and_b32 v197,s42,v197
M v[52:55],a[244:247],a[200:203],v[52:55]
v_and_b32 v193,s42,v193
v_and_b32 v195,s42,v195
M v[56:59],a[244:247],a[204:207],v[56:59]
v_and_b32 v203,s42,v203
v_and_b32 v201,s42,v201
M v[60:63],a[244:247],a[208:211],v[60:63]
s_waitcnt vmcnt(22)
buffer_load_dwordx4 a[244:247],v247,s[20:23],s46 offen offset:2048 sc1
M v[64:67],a[248:251],a[212:215],v[64:67]
ds_read_b128 a[212:215],v245 offset:54272
v_and_b32 v199,s42,v199
M v[68:71],a[248:251],a[216:219],v[68:71]
v_fmac_f32 v193,s43,v197
v_fmac_f32 v203,4.0,v195
M v[72:75],a[248:251],a[220:223],v[72:75]
v_fma_f32 v231,-4.0,v197,v201
v_fmac_f32 v193,s45,v201
M v[76:79],a[248:251],a[192:195],v[76:79]
v_fmac_f32 v203,s41,v199
v_sub_f32 v201,v201,v197
M v[80:83],a[248:251],a[196:199],v[80:83]
v_fma_f32 v197,-4.0,v195,v199
v_sub_f32 v199,v199,v195
M v[84:87],a[248:251],a[200:203],v[84:87]
v_add_f32 v195,v231,v197
v_sub_f32 v231,v231,v197
M v[88:91],a[248:251],a[204:207],v[88:91]
v_fma_f32 v197,2.0,v199,v201
v_fmac_f32 v201,-2.0,v199
M v[92:95],a[248:251],a[208:211],v[92:95]
s_waitcnt vmcnt(10)
buffer_load_dwordx4 a[248:251],v247,s[20:23],s47 offen offset:2048 sc1
M v[0:3],a[252:255],a[216:219],v[0:3]
v_cvt_pk_bf16_f32 v193,v228,v193
v_cvt_pk_bf16_f32 v203,v233,v203
M v[4:7],a[252:255],a[220:223],v[4:7]
v_cvt_pk_bf16_f32 v195,v229,v195
v_cvt_pk_bf16_f32 v199,v230,v197
M v[8:11],a[252:255],a[192:195],v[8:11]
v_cvt_pk_bf16_f32 v197,v234,v231
v_cvt_pk_bf16_f32 v201,v232,v201
M v[12:15],a[252:255],a[196:199],v[12:15]
v_add_u32 v228,139264,v243
M v[16:19],a[252:255],a[200:203],v[16:19]
ds_write2st64_b64 v228,v[192:193],v[202:203] offset0:2 offset1:19
M v[20:23],a[252:255],a[204:207],v[20:23]
s_add_u32 s28,s69,6291456
buffer_load_dwordx2 v[192:193],v241,s[12:15],s28 offen offset:0
M v[24:27],a[252:255],a[208:211],v[24:27]
s_waitcnt lgkmcnt(1)
ds_write2st64_b64 v243,v[194:195],v[196:197] offset0:36 offset1:53
M v[28:31],a[252:255],a[212:215],v[28:31]
s_waitcnt vmcnt(11)
buffer_load_dwordx2 v[202:203],v241,s[16:19],s28 offen offset:1536
M v[32:35],a[224:227],a[216:219],v[32:35]
ds_write2st64_b64 v243,v[198:199],v[200:201] offset0:70 offset1:87
M v[36:39],a[224:227],a[220:223],v[36:39]
v_lshlrev_b32 v230,16,v208
v_lshlrev_b32 v228,16,v204
M v[40:43],a[224:227],a[192:195],v[40:43]
buffer_load_dwordx2 v[194:195],v241,s[8:11],s28 offen offset:0
M v[44:47],a[224:227],a[196:199],v[44:47]
v_lshlrev_b32 v229,16,v206
v_lshlrev_b32 v233,16,v214
M v[48:51],a[224:227],a[200:203],v[48:51]
v_lshlrev_b32 v232,16,v212
v_lshlrev_b32 v231,16,v210
M v[52:55],a[224:227],a[204:207],v[52:55]
v_fmac_f32 v228,s43,v230
v_fmac_f32 v233,4.0,v229
M v[56:59],a[224:227],a[208:211],v[56:59]
buffer_load_dwordx2 v[196:197],v241,s[8:11],s28 offen offset:384
M v[60:63],a[224:227],a[212:215],v[60:63]
s_waitcnt vmcnt(13)
v_fma_f32 v234,-4.0,v230,v232
v_fmac_f32 v228,s45,v232
M v[64:67],v[216:219],a[216:219],v[64:67]
ds_read_b128 a[216:219],v245 offset:60928
v_fmac_f32 v233,s41,v231
M v[68:71],v[216:219],a[220:223],v[68:71]
ds_read_b128 a[220:223],v246 offset:60928
v_sub_f32 v232,v232,v230
M v[72:75],v[216:219],a[192:195],v[72:75]
buffer_load_dwordx2 v[198:199],v241,s[8:11],s28 offen offset:768
M v[76:79],v[216:219],a[196:199],v[76:79]
ds_read_b128 a[192:195],v245 offset:61440
ds_read_b128 a[196:199],v246 offset:61440
M v[80:83],v[216:219],a[200:203],v[80:83]
ds_read_b128 a[200:203],v245 offset:61952
v_fma_f32 v230,-4.0,v229,v231
M v[84:87],v[216:219],a[204:207],v[84:87]
ds_read_b128 a[204:207],v246 offset:61952
v_sub_f32 v231,v231,v229
M v[88:91],v[216:219],a[208:211],v[88:91]
buffer_load_dwordx2 v[200:201],v241,s[8:11],s28 offen offset:1152
M v[92:95],v[216:219],a[212:215],v[92:95]
s_waitcnt vmcnt(14) lgkmcnt(5)
ds_read_b128 a[208:211],v245 offset:62464
ds_read_b128 a[212:215],v246 offset:62464
M v[96:99],v[220:223],a[216:219],v[96:99]
s_waitcnt lgkmcnt(6)
v_add_f32 v229,v234,v230
v_sub_f32 v234,v234,v230
M v[100:103],v[220:223],a[220:223],v[100:103]
s_waitcnt lgkmcnt(5)
v_fma_f32 v230,2.0,v231,v232
v_fmac_f32 v232,-2.0,v231
M v[104:107],v[220:223],a[192:195],v[104:107]
s_waitcnt lgkmcnt(4)
buffer_load_dwordx4 a[252:255],v247,s[20:23],s48 offen offset:2048 sc1
M v[108:111],v[220:223],a[196:199],v[108:111]
s_waitcnt lgkmcnt(3)
s_add_u32 s46,s80,9216
v_and_b32 v208,s42,v208
v_and_b32 v204,s42,v204
M v[112:115],v[220:223],a[200:203],v[112:115]
s_waitcnt lgkmcnt(2)
v_and_b32 v206,s42,v206
v_and_b32 v214,s42,v214
M v[116:119],v[220:223],a[204:207],v[116:119]
s_waitcnt lgkmcnt(1)
v_and_b32 v212,s42,v212
v_and_b32 v210,s42,v210
M v[120:123],v[220:223],a[208:211],v[120:123]
s_waitcnt lgkmcnt(0)
buffer_load_dwordx4 a[224:227],v247,s[20:23],s46 offen offset:0 sc1
M v[124:127],v[220:223],a[212:215],v[124:127]
s_waitcnt vmcnt(15)
s_add_u32 s47,s80,12288
v_fmac_f32 v204,s43,v208
v_fmac_f32 v214,4.0,v206
M v[128:131],v[224:227],a[216:219],v[128:131]
v_fma_f32 v231,-4.0,v208,v212
v_fmac_f32 v204,s45,v212
M v[132:135],v[224:227],a[220:223],v[132:135]
v_fmac_f32 v214,s41,v210
v_sub_f32 v212,v212,v208
M v[136:139],v[224:227],a[192:195],v[136:139]
buffer_load_dwordx4 v[216:219],v247,s[20:23],s47 offen offset:0 sc1
M v[140:143],v[224:227],a[196:199],v[140:143]
s_add_u32 s48,s80,15360
v_fma_f32 v208,-4.0,v206,v210
v_sub_f32 v210,v210,v206
M v[144:147],v[224:227],a[200:203],v[144:147]
v_add_f32 v206,v231,v208
v_sub_f32 v231,v231,v208
M v[148:151],v[224:227],a[204:207],v[148:151]
v_fma_f32 v208,2.0,v210,v212
v_fmac_f32 v212,-2.0,v210
M v[152:155],v[224:227],a[208:211],v[152:155]
buffer_load_dwordx4 v[220:223],v247,s[20:23],s48 offen offset:0 sc1
M v[156:159],v[224:227],a[212:215],v[156:159]
s_waitcnt vmcnt(15)
v_cvt_pk_bf16_f32 v204,v228,v204
v_cvt_pk_bf16_f32 v214,v233,v214
M v[160:163],a[228:231],a[216:219],v[160:163]
ds_read_b128 a[216:219],v246 offset:62976
v_cvt_pk_bf16_f32 v206,v229,v206
M v[164:167],a[228:231],a[220:223],v[164:167]
v_cvt_pk_bf16_f32 v210,v230,v208
v_cvt_pk_bf16_f32 v208,v234,v231
M v[168:171],a[228:231],a[192:195],v[168:171]
buffer_load_dwordx4 v[224:227],v247,s[20:23],s46 offen offset:1024 sc1
M v[172:175],a[228:231],a[196:199],v[172:175]
v_cvt_pk_bf16_f32 v212,v232,v212
v_lshlrev_b32 v230,16,v209
M v[176:179],a[228:231],a[200:203],v[176:179]
v_lshlrev_b32 v228,16,v205
v_lshlrev_b32 v229,16,v207
M v[180:183],a[228:231],a[204:207],v[180:183]
v_lshlrev_b32 v233,16,v215
v_lshlrev_b32 v232,16,v213
M v[184:187],a[228:231],a[208:211],v[184:187]
v_lshlrev_b32 v231,16,v211
v_fmac_f32 v228,s43,v230
M v[188:191],a[228:231],a[212:215],v[188:191]
s_waitcnt vmcnt(15)
buffer_load_dwordx4 a[228:231],v247,s[20:23],s47 offen offset:1024 sc1
M v[96:99],a[232:235],a[220:223],v[96:99]
v_fmac_f32 v233,4.0,v229
v_fma_f32 v234,-4.0,v230,v232
M v[100:103],a[232:235],a[192:195],v[100:103]
v_fmac_f32 v228,s45,v232
v_fmac_f32 v233,s41,v231
M v[104:107],a[232:235],a[196:199],v[104:107]
v_sub_f32 v232,v232,v230
v_fma_f32 v230,-4.0,v229,v231
M v[108:111],a[232:235],a[200:203],v[108:111]
v_sub_f32 v231,v231,v229
v_add_f32 v229,v234,v230
M v[112:115],a[232:235],a[204:207],v[112:115]
v_sub_f32 v234,v234,v230
v_fma_f32 v230,2.0,v231,v232
M v[116:119],a[232:235],a[208:211],v[116:119]
v_fmac_f32 v232,-2.0,v231
v_and_b32 v209,s42,v209
M v[120:123],a[232:235],a[212:215],v[120:123]
s_waitcnt lgkmcnt(0)
v_and_b32 v205,s42,v205
v_and_b32 v207,s42,v207
M v[124:127],a[232:235],a[216:219],v[124:127]
s_waitcnt vmcnt(15)
buffer_load_dwordx4 a[232:235],v247,s[20:23],s48 offen offset:1024 sc1
M v[128:131],a[236:239],a[220:223],v[128:131]
v_and_b32 v215,s42,v215
v_and_b32 v213,s42,v213
M v[132:135],a[236:239],a[192:195],v[132:135]
v_and_b32 v211,s42,v211
v_fmac_f32 v205,s43,v209
M v[136:139],a[236:239],a[196:199],v[136:139]
v_fmac_f32 v215,4.0,v207
v_fma_f32 v231,-4.0,v209,v213
M v[140:143],a[236:239],a[200:203],v[140:143]
v_fmac_f32 v205,s45,v213
v_fmac_f32 v215,s41,v211
M v[144:147],a[236:239],a[204:207],v[144:147]
v_sub_f32 v213,v213,v209
v_fma_f32 v209,-4.0,v207,v211
M v[148:151],a[236:239],a[208:211],v[148:151]
v_sub_f32 v211,v211,v207
v_add_f32 v207,v231,v209
M v[152:155],a[236:239],a[212:215],v[152:155]
v_sub_f32 v231,v231,v209
v_fma_f32 v209,2.0,v211,v213
M v[156:159],a[236:239],a[216:219],v[156:159]
s_waitcnt vmcnt(15)
buffer_load_dwordx4 a[236:239],v247,s[20:23],s46 offen offset:2048 sc1
M v[160:163],a[240:243],a[220:223],v[160:163]
ds_read_b128 a[220:223],v245 offset:62976
v_fmac_f32 v213,-2.0,v211
M v[164:167],a[240:243],a[192:195],v[164:167]
v_cvt_pk_bf16_f32 v205,v228,v205
v_cvt_pk_bf16_f32 v215,v233,v215
M v[168:171],a[240:243],a[196:199],v[168:171]
v_cvt_pk_bf16_f32 v207,v229,v207
v_cvt_pk_bf16_f32 v211,v230,v209
M v[172:175],a[240:243],a[200:203],v[172:175]
v_cvt_pk_bf16_f32 v209,v234,v231
v_cvt_pk_bf16_f32 v213,v232,v213
M v[176:179],a[240:243],a[204:207],v[176:179]
v_add_u32 v228,139264,v243
M v[180:183],a[240:243],a[208:211],v[180:183]
ds_write2st64_b64 v228,v[204:205],v[214:215] offset0:3 offset1:20
M v[184:187],a[240:243],a[212:215],v[184:187]
s_add_u32 s28,s69,6684672
buffer_load_dwordx2 v[204:205],v241,s[12:15],s28 offen offset:0
M v[188:191],a[240:243],a[216:219],v[188:191]
s_waitcnt vmcnt(16)
ds_write2st64_b64 v243,v[206:207],v[208:209] offset0:37 offset1:54
M v[96:99],a[244:247],a[192:195],v[96:99]
buffer_load_dwordx2 v[214:215],v241,s[16:19],s28 offen offset:1536
M v[100:103],a[244:247],a[196:199],v[100:103]
ds_write2st64_b64 v243,v[210:211],v[212:213] offset0:71 offset1:88
M v[104:107],a[244:247],a[200:203],v[104:107]
s_waitcnt vmcnt(12)
v_lshlrev_b32 v230,16,v196
v_lshlrev_b32 v228,16,v192
M v[108:111],a[244:247],a[204:207],v[108:111]
buffer_load_dwordx2 v[206:207],v241,s[8:11],s28 offen offset:0
M v[112:115],a[244:247],a[208:211],v[112:115]
v_lshlrev_b32 v229,16,v194
v_lshlrev_b32 v233,16,v202
M v[116:119],a[244:247],a[212:215],v[116:119]
s_waitcnt vmcnt(11)
v_lshlrev_b32 v232,16,v200
v_lshlrev_b32 v231,16,v198
M v[120:123],a[244:247],a[216:219],v[120:123]
s_waitcnt lgkmcnt(3)
v_fmac_f32 v228,s43,v230
v_fmac_f32 v233,4.0,v229
M v[124:127],a[244:247],a[220:223],v[124:127]
buffer_load_dwordx2 v[208:209],v241,s[8:11],s28 offen offset:384
M v[128:131],a[248:251],a[192:195],v[128:131]
v_fma_f32 v234,-4.0,v230,v232
v_fmac_f32 v228,s45,v232
M v[132:135],a[248:251],a[196:199],v[132:135]
v_fmac_f32 v233,s41,v231
v_sub_f32 v232,v232,v230
M v[136:139],a[248:251],a[200:203],v[136:139]
v_fma_f32 v230,-4.0,v229,v231
v_sub_f32 v231,v231,v229
M v[140:143],a[248:251],a[204:207],v[140:143]
buffer_load_dwordx2 v[210:211],v241,s[8:11],s28 offen offset:768
M v[144:147],a[248:251],a[208:211],v[144:147]
v_add_f32 v229,v234,v230
v_sub_f32 v234,v234,v230
M v[148:151],a[248:251],a[212:215],v[148:151]
v_fma_f32 v230,2.0,v231,v232
v_fmac_f32 v232,-2.0,v231
M v[152:155],a[248:251],a[216:219],v[152:155]
s_waitcnt lgkmcnt(0)
s_barrier
v_and_b32 v196,s42,v196
M v[156:159],a[248:251],a[220:223],v[156:159]
s_waitcnt vmcnt(12)
buffer_load_dwordx2 v[212:213],v241,s[8:11],s28 offen offset:1152
M v[160:163],a[252:255],a[192:195],v[160:163]
ds_read_b128 a[192:195],v245 offset:0
v_and_b32 v192,s42,v192
M v[164:167],a[252:255],a[196:199],v[164:167]
ds_read_b128 a[196:199],v246 offset:0
v_and_b32 v194,s42,v194
M v[168:171],a[252:255],a[200:203],v[168:171]
ds_read_b128 a[200:203],v245 offset:512
v_and_b32 v202,s42,v202
M v[172:175],a[252:255],a[204:207],v[172:175]
buffer_load_dwordx4 a[240:243],v247,s[20:23],s47 offen offset:2048 sc1
M v[176:179],a[252:255],a[208:211],v[176:179]
ds_read_b128 a[204:207],v246 offset:512
ds_read_b128 a[208:211],v245 offset:1024
M v[180:183],a[252:255],a[212:215],v[180:183]
ds_read_b128 a[212:215],v246 offset:1024
v_and_b32 v200,s42,v200
M v[184:187],a[252:255],a[216:219],v[184:187]
ds_read_b128 a[216:219],v245 offset:1536
v_and_b32 v198,s42,v198
M v[188:191],a[252:255],a[220:223],v[188:191]
s_waitcnt vmcnt(13) lgkmcnt(6)
buffer_load_dwordx4 a[244:247],v247,s[20:23],s48 offen offset:2048 sc1
M a[0:3],a[224:227],a[192:195],a[0:3]
s_waitcnt lgkmcnt(5)
s_add_u32 s46,s80,18432
ds_read_b128 a[220:223],v246 offset:1536
v_fmac_f32 v192,s43,v196
M a[4:7],a[224:227],a[196:199],a[4:7]
s_waitcnt lgkmcnt(5)
v_fmac_f32 v202,4.0,v194
v_fma_f32 v231,-4.0,v196,v200
M a[8:11],a[224:227],a[200:203],a[8:11]
s_waitcnt lgkmcnt(4)
v_fmac_f32 v192,s45,v200
v_fmac_f32 v202,s41,v198
M a[12:15],a[224:227],a[204:207],a[12:15]
s_waitcnt lgkmcnt(3)
buffer_load_dwordx4 a[248:251],v247,s[20:23],s46 offen offset:0 sc1
M a[16:19],a[224:227],a[208:211],a[16:19]
s_waitcnt lgkmcnt(2)
s_add_u32 s47,s80,21504
v_sub_f32 v200,v200,v196
v_fma_f32 v196,-4.0,v194,v198
M a[20:23],a[224:227],a[212:215],a[20:23]
s_waitcnt lgkmcnt(1)
v_sub_f32 v198,v198,v194
v_add_f32 v194,v231,v196
M a[24:27],a[224:227],a[216:219],a[24:27]
s_waitcnt lgkmcnt(0)
v_sub_f32 v231,v231,v196
v_fma_f32 v196,2.0,v198,v200
M a[28:31],a[224:227],a[220:223],a[28:31]
s_waitcnt vmcnt(14)
buffer_load_dwordx4 a[252:255],v247,s[20:23],s47 offen offset:0 sc1
M a[32:35],v[216:219],a[192:195],a[32:35]
s_add_u32 s48,s80,24576
v_fmac_f32 v200,-2.0,v198
v_cvt_pk_bf16_f32 v192,v228,v192
M a[36:39],v[216:219],a[196:199],a[36:39]
v_cvt_pk_bf16_f32 v202,v233,v202
v_cvt_pk_bf16_f32 v194,v229,v194
M a[40:43],v[216:219],a[200:203],a[40:43]
v_cvt_pk_bf16_f32 v198,v230,v196
v_cvt_pk_bf16_f32 v196,v234,v231
M a[44:47],v[216:219],a[204:207],a[44:47]
buffer_load_dwordx4 a[224:227],v247,s[20:23],s48 offen offset:0 sc1
M a[48:51],v[216:219],a[208:211],a[48:51]
v_cvt_pk_bf16_f32 v254,v232,v200
v_lshlrev_b32 v230,16,v197
M a[52:55],v[216:219],a[212:215],a[52:55]
v_lshlrev_b32 v228,16,v193
v_lshlrev_b32 v229,16,v195
M a[56:59],v[216:219],a[216:219],a[56:59]
v_lshlrev_b32 v233,16,v203
v_lshlrev_b32 v232,16,v201
M a[60:63],v[216:219],a[220:223],a[60:63]
s_waitcnt vmcnt(15)
buffer_load_dwordx4 v[216:219],v247,s[20:23],s46 offen offset:1024 sc1
M a[64:67],v[220:223],a[192:195],a[64:67]
ds_read_b128 a[192:195],v246 offset:2048
v_lshlrev_b32 v231,16,v199
M a[68:71],v[220:223],a[196:199],a[68:71]
v_fmac_f32 v228,s43,v230
v_fmac_f32 v233,4.0,v229
M a[72:75],v[220:223],a[200:203],a[72:75]
v_fma_f32 v234,-4.0,v230,v232
v_fmac_f32 v228,s45,v232
M a[76:79],v[220:223],a[204:207],a[76:79]
v_fmac_f32 v233,s41,v231
v_sub_f32 v232,v232,v230
M a[80:83],v[220:223],a[208:211],a[80:83]
v_fma_f32 v230,-4.0,v229,v231
v_sub_f32 v231,v231,v229
M a[84:87],v[220:223],a[212:215],a[84:87]
v_add_f32 v229,v234,v230
v_sub_f32 v234,v234,v230
M a[88:91],v[220:223],a[216:219],a[88:91]
v_fma_f32 v230,2.0,v231,v232
v_fmac_f32 v232,-2.0,v231
M a[92:95],v[220:223],a[220:223],a[92:95]
s_waitcnt vmcnt(15)
buffer_load_dwordx4 v[220:223],v247,s[20:23],s47 offen offset:1024 sc1
M a[0:3],v[224:227],a[196:199],a[0:3]
v_and_b32 v197,s42,v197
v_and_b32 v193,s42,v193
M a[4:7],v[224:227],a[200:203],a[4:7]
v_and_b32 v195,s42,v195
v_and_b32 v203,s42,v203
M a[8:11],v[224:227],a[204:207],a[8:11]
v_and_b32 v201,s42,v201
v_and_b32 v199,s42,v199
M a[12:15],v[224:227],a[208:211],a[12:15]
v_fmac_f32 v193,s43,v197
v_fmac_f32 v203,4.0,v195
M a[16:19],v[224:227],a[212:215],a[16:19]
v_fma_f32 v231,-4.0,v197,v201
v_fmac_f32 v193,s45,v201
M a[20:23],v[224:227],a[216:219],a[20:23]
v_fmac_f32 v203,s41,v199
v_sub_f32 v201,v201,v197
M a[24:27],v[224:227],a[220:223],a[24:27]
s_waitcnt lgkmcnt(0)
v_fma_f32 v197,-4.0,v195,v199
v_sub_f32 v199,v199,v195
M a[28:31],v[224:227],a[192:195],a[28:31]
s_waitcnt vmcnt(15)
buffer_load_dwordx4 v[224:227],v247,s[20:23],s48 offen offset:1024 sc1
M a[32:35],a[228:231],a[196:199],a[32:35]
v_add_f32 v195,v231,v197
v_sub_f32 v231,v231,v197
M a[36:39],a[228:231],a[200:203],a[36:39]
v_fma_f32 v197,2.0,v199,v201
v_fmac_f32 v201,-2.0,v199
M a[40:43],a[228:231],a[204:207],a[40:43]
v_cvt_pk_bf16_f32 v193,v228,v193
v_cvt_pk_bf16_f32 v203,v233,v203
M a[44:47],a[228:231],a[208:211],a[44:47]
v_cvt_pk_bf16_f32 v195,v229,v195
v_cvt_pk_bf16_f32 v199,v230,v197
M a[48:51],a[228:231],a[212:215],a[48:51]
v_cvt_pk_bf16_f32 v197,v234,v231
v_cvt_pk_bf16_f32 v255,v232,v201
M a[52:55],a[228:231],a[216:219],a[52:55]
ds_write2st64_b64 v243,v[192:193],v[202:203] offset0:136 offset1:153
M a[56:59],a[228:231],a[220:223],a[56:59]
s_add_u32 s28,s69,7077888
buffer_load_dwordx2 v[192:193],v241,s[12:15],s28 offen offset:0
M a[60:63],a[228:231],a[192:195],a[60:63]
s_waitcnt vmcnt(16)
ds_write2st64_b64 v243,v[194:195],v[196:197] offset0:0 offset1:17
M a[64:67],a[232:235],a[196:199],a[64:67]
buffer_load_dwordx2 v[202:203],v241,s[16:19],s28 offen offset:1536
M a[68:71],a[232:235],a[200:203],a[68:71]
ds_read_b128 a[196:199],v245 offset:2048
M a[72:75],a[232:235],a[204:207],a[72:75]
M a[76:79],a[232:235],a[208:211],a[76:79]
M a[80:83],a[232:235],a[212:215],a[80:83]
buffer_load_dwordx2 v[194:195],v241,s[8:11],s28 offen offset:0
M a[84:87],a[232:235],a[216:219],a[84:87]
M a[88:91],a[232:235],a[220:223],a[88:91]
M a[92:95],a[232:235],a[192:195],a[92:95]
s_waitcnt vmcnt(17)
M a[0:3],a[236:239],a[200:203],a[0:3]
buffer_load_dwordx2 v[196:197],v241,s[8:11],s28 offen offset:384
M a[4:7],a[236:239],a[204:207],a[4:7]
M a[8:11],a[236:239],a[208:211],a[8:11]
M a[12:15],a[236:239],a[212:215],a[12:15]
M a[16:19],a[236:239],a[216:219],a[16:19]
buffer_load_dwordx4 a[228:231],v247,s[20:23],s46 offen offset:2048 sc1
M a[20:23],a[236:239],a[220:223],a[20:23]
M a[24:27],a[236:239],a[192:195],a[24:27]
s_waitcnt lgkmcnt(0)
M a[28:31],a[236:239],a[196:199],a[28:31]
s_waitcnt vmcnt(12)
M a[32:35],a[240:243],a[200:203],a[32:35]
buffer_load_dwordx4 a[232:235],v247,s[20:23],s47 offen offset:2048 sc1
M a[36:39],a[240:243],a[204:207],a[36:39]
s_barrier
ds_write_b64 v243,v[198:199] offset:17408
M a[40:43],a[240:243],a[208:211],a[40:43]
v_lshlrev_b32 v230,16,v208
v_lshlrev_b32 v228,16,v204
M a[44:47],a[240:243],a[212:215],a[44:47]
buffer_load_dwordx2 v[198:199],v241,s[8:11],s28 offen offset:768
M a[48:51],a[240:243],a[216:219],a[48:51]
v_lshlrev_b32 v229,16,v206
v_lshlrev_b32 v233,16,v214
M a[52:55],a[240:243],a[220:223],a[52:55]
v_lshlrev_b32 v232,16,v212
v_lshlrev_b32 v231,16,v210
M a[56:59],a[240:243],a[192:195],a[56:59]
v_fmac_f32 v228,s43,v230
v_fmac_f32 v233,4.0,v229
M a[60:63],a[240:243],a[196:199],a[60:63]
s_waitcnt vmcnt(13)
buffer_load_dwordx2 v[200:201],v241,s[8:11],s28 offen offset:1152
M a[64:67],a[244:247],a[200:203],a[64:67]
ds_read_b128 a[200:203],v245 offset:8704
v_fma_f32 v234,-4.0,v230,v232
M a[68:71],a[244:247],a[204:207],a[68:71]
ds_read_b128 a[204:207],v246 offset:8704
v_fmac_f32 v228,s45,v232
M a[72:75],a[244:247],a[208:211],a[72:75]
ds_read_b128 a[208:211],v245 offset:9216
v_fmac_f32 v233,s41,v231
M a[76:79],a[244:247],a[212:215],a[76:79]
buffer_load_dwordx4 a[236:239],v247,s[20:23],s48 offen offset:2048 sc1
M a[80:83],a[244:247],a[216:219],a[80:83]
s_add_u32 s46,s80,27648
ds_read_b128 a[212:215],v246 offset:9216
ds_read_b128 a[216:219],v245 offset:9728
M a[84:87],a[244:247],a[220:223],a[84:87]
ds_read_b128 a[220:223],v246 offset:9728
v_sub_f32 v232,v232,v230
M a[88:91],a[244:247],a[192:195],a[88:91]
ds_read_b128 a[192:195],v245 offset:10240
v_fma_f32 v230,-4.0,v229,v231
M a[92:95],a[244:247],a[196:199],a[92:95]
s_waitcnt vmcnt(14) lgkmcnt(6)
buffer_load_dwordx4 a[240:243],v247,s[20:23],s46 offen offset:0 sc1
M a[96:99],a[248:251],a[200:203],a[96:99]
s_waitcnt lgkmcnt(5)
s_add_u32 s47,s80,30720
ds_read_b128 a[196:199],v246 offset:10240
v_sub_f32 v231,v231,v229
M a[100:103],a[248:251],a[204:207],a[100:103]
s_waitcnt lgkmcnt(5)
v_add_f32 v229,v234,v230
v_sub_f32 v234,v234,v230
M a[104:107],a[248:251],a[208:211],a[104:107]
s_waitcnt lgkmcnt(4)
v_fma_f32 v230,2.0,v231,v232
v_fmac_f32 v232,-2.0,v231
M a[108:111],a[248:251],a[212:215],a[108:111]
s_waitcnt lgkmcnt(3)
buffer_load_dwordx4 a[244:247],v247,s[20:23],s47 offen offset:0 sc1
M a[112:115],a[248:251],a[216:219],a[112:115]
s_waitcnt lgkmcnt(2)
s_add_u32 s48,s80,33792
v_and_b32 v208,s42,v208
v_and_b32 v204,s42,v204
M a[116:119],a[248:251],a[220:223],a[116:119]
s_waitcnt lgkmcnt(1)
v_and_b32 v206,s42,v206
v_and_b32 v214,s42,v214
M a[120:123],a[248:251],a[192:195],a[120:123]
s_waitcnt lgkmcnt(0)
v_and_b32 v212,s42,v212
v_and_b32 v210,s42,v210
M a[124:127],a[248:251],a[196:199],a[124:127]
s_waitcnt vmcnt(15)
buffer_load_dwordx4 a[248:251],v247,s[20:23],s48 offen offset:0 sc1
M a[128:131],a[252:255],a[200:203],a[128:131]
v_fmac_f32 v204,s43,v208
v_fmac_f32 v214,4.0,v206
M a[132:135],a[252:255],a[204:207],a[132:135]
v_fma_f32 v231,-4.0,v208,v212
v_fmac_f32 v204,s45,v212
M a[136:139],a[252:255],a[208:211],a[136:139]
v_fmac_f32 v214,s41,v210
v_sub_f32 v212,v212,v208
M a[140:143],a[252:255],a[212:215],a[140:143]
v_fma_f32 v208,-4.0,v206,v210
v_sub_f32 v210,v210,v206
M a[144:147],a[252:255],a[216:219],a[144:147]
v_add_f32 v206,v231,v208
v_sub_f32 v231,v231,v208
M a[148:151],a[252:255],a[220:223],a[148:151]
v_fma_f32 v208,2.0,v210,v212
v_fmac_f32 v212,-2.0,v210
M a[152:155],a[252:255],a[192:195],a[152:155]
v_cvt_pk_bf16_f32 v204,v228,v204
v_cvt_pk_bf16_f32 v214,v233,v214
M a[156:159],a[252:255],a[196:199],a[156:159]
s_waitcnt vmcnt(15)
buffer_load_dwordx4 a[252:255],v247,s[20:23],s46 offen offset:1024 sc1
M a[160:163],a[224:227],a[200:203],a[160:163]
ds_read_b128 a[200:203],v246 offset:10752
v_cvt_pk_bf16_f32 v206,v229,v206
M a[164:167],a[224:227],a[204:207],a[164:167]
v_cvt_pk_bf16_f32 v210,v230,v208
v_cvt_pk_bf16_f32 v208,v234,v231
M a[168:171],a[224:227],a[208:211],a[168:171]
v_cvt_pk_bf16_f32 v212,v232,v212
v_lshlrev_b32 v230,16,v209
M a[172:175],a[224:227],a[212:215],a[172:175]
v_lshlrev_b32 v228,16,v205
v_lshlrev_b32 v229,16,v207
M a[176:179],a[224:227],a[216:219],a[176:179]
v_lshlrev_b32 v233,16,v215
v_lshlrev_b32 v232,16,v213
M a[180:183],a[224:227],a[220:223],a[180:183]
v_lshlrev_b32 v231,16,v211
v_fmac_f32 v228,s43,v230
M a[184:187],a[224:227],a[192:195],a[184:187]
v_fmac_f32 v233,4.0,v229
v_fma_f32 v234,-4.0,v230,v232
M a[188:191],a[224:227],a[196:199],a[188:191]
s_waitcnt vmcnt(15)
buffer_load_dwordx4 a[224:227],v247,s[20:23],s47 offen offset:1024 sc1
M a[96:99],v[216:219],a[204:207],a[96:99]
v_fmac_f32 v228,s45,v232
v_fmac_f32 v233,s41,v231
M a[100:103],v[216:219],a[208:211],a[100:103]
v_sub_f32 v232,v232,v230
v_fma_f32 v230,-4.0,v229,v231
M a[104:107],v[216:219],a[212:215],a[104:107]
v_sub_f32 v231,v231,v229
v_add_f32 v229,v234,v230
M a[108:111],v[216:219],a[216:219],a[108:111]
v_sub_f32 v234,v234,v230
v_fma_f32 v230,2.0,v231,v232
M a[112:115],v[216:219],a[220:223],a[112:115]
v_fmac_f32 v232,-2.0,v231
v_and_b32 v209,s42,v209
M a[116:119],v[216:219],a[192:195],a[116:119]
v_and_b32 v205,s42,v205
v_and_b32 v207,s42,v207
M a[120:123],v[216:219],a[196:199],a[120:123]
s_waitcnt lgkmcnt(0)
v_and_b32 v215,s42,v215
v_and_b32 v213,s42,v213
M a[124:127],v[216:219],a[200:203],a[124:127]
s_waitcnt vmcnt(15)
buffer_load_dwordx4 v[216:219],v247,s[20:23],s48 offen offset:1024 sc1
M a[128:131],v[220:223],a[204:207],a[128:131]
v_and_b32 v211,s42,v211
v_fmac_f32 v205,s43,v209
M a[132:135],v[220:223],a[208:211],a[132:135]
v_fmac_f32 v215,4.0,v207
v_fma_f32 v231,-4.0,v209,v213
M a[136:139],v[220:223],a[212:215],a[136:139]
v_fmac_f32 v205,s45,v213
v_fmac_f32 v215,s41,v211
M a[140:143],v[220:223],a[216:219],a[140:143]
v_sub_f32 v213,v213,v209
v_fma_f32 v209,-4.0,v207,v211
M a[144:147],v[220:223],a[220:223],a[144:147]
v_sub_f32 v211,v211,v207
v_add_f32 v207,v231,v209
M a[148:151],v[220:223],a[192:195],a[148:151]
v_sub_f32 v231,v231,v209
v_fma_f32 v209,2.0,v211,v213
M a[152:155],v[220:223],a[196:199],a[152:155]
v_fmac_f32 v213,-2.0,v211
v_cvt_pk_bf16_f32 v205,v228,v205
M a[156:159],v[220:223],a[200:203],a[156:159]
s_waitcnt vmcnt(15)
buffer_load_dwordx4 v[220:223],v247,s[20:23],s46 offen offset:2048 sc1
M a[160:163],v[224:227],a[204:207],a[160:163]
ds_read_b128 a[204:207],v245 offset:10752
v_cvt_pk_bf16_f32 v215,v233,v215
M a[164:167],v[224:227],a[208:211],a[164:167]
v_cvt_pk_bf16_f32 v207,v229,v207
v_cvt_pk_bf16_f32 v211,v230,v209
M a[168:171],v[224:227],a[212:215],a[168:171]
v_cvt_pk_bf16_f32 v209,v234,v231
v_cvt_pk_bf16_f32 v213,v232,v213
M a[172:175],v[224:227],a[216:219],a[172:175]
ds_write2st64_b64 v243,v[204:205],v[214:215] offset0:137 offset1:154
M a[176:179],v[224:227],a[220:223],a[176:179]
s_add_u32 s28,s69,7471104
buffer_load_dwordx2 v[204:205],v241,s[12:15],s28 offen offset:0
M a[180:183],v[224:227],a[192:195],a[180:183]
ds_write2st64_b64 v243,v[206:207],v[208:209] offset0:1 offset1:18
M a[184:187],v[224:227],a[196:199],a[184:187]
buffer_load_dwordx2 v[214:215],v241,s[16:19],s28 offen offset:1536
M a[188:191],v[224:227],a[200:203],a[188:191]
s_waitcnt vmcnt(13)
M a[96:99],a[228:231],a[208:211],a[96:99]
M a[100:103],a[228:231],a[212:215],a[100:103]
M a[104:107],a[228:231],a[216:219],a[104:107]
buffer_load_dwordx2 v[206:207],v241,s[8:11],s28 offen offset:0
M a[108:111],a[228:231],a[220:223],a[108:111]
M a[112:115],a[228:231],a[192:195],a[112:115]
M a[116:119],a[228:231],a[196:199],a[116:119]
M a[120:123],a[228:231],a[200:203],a[120:123]
s_waitcnt lgkmcnt(2)
buffer_load_dwordx2 v[208:209],v241,s[8:11],s28 offen offset:384
M a[124:127],a[228:231],a[204:207],a[124:127]
s_waitcnt vmcnt(14)
M a[128:131],a[232:235],a[208:211],a[128:131]
M a[132:135],a[232:235],a[212:215],a[132:135]
s_waitcnt lgkmcnt(0)
s_barrier
ds_write_b64 v243,v[254:255] offset:26112
M a[136:139],a[232:235],a[216:219],a[136:139]
buffer_load_dwordx4 v[224:227],v247,s[20:23],s47 offen offset:2048 sc1
M a[140:143],a[232:235],a[220:223],a[140:143]
ds_write2st64_b64 v243,v[210:211],v[212:213] offset0:35 offset1:52
M a[144:147],a[232:235],a[192:195],a[144:147]
buffer_load_dwordx2 v[210:211],v241,s[8:11],s28 offen offset:768
M a[148:151],a[232:235],a[196:199],a[148:151]
v_fmac_f32 v235,s43,v237
v_fmac_f32 v240,4.0,v236
M a[152:155],a[232:235],a[200:203],a[152:155]
v_fma_f32 v228,-4.0,v237,v239
v_fmac_f32 v235,s45,v239
M a[156:159],a[232:235],a[204:207],a[156:159]
s_waitcnt vmcnt(13)
v_fmac_f32 v240,s41,v238
v_sub_f32 v239,v239,v237
M a[160:163],a[236:239],a[208:211],a[160:163]
buffer_load_dwordx2 v[212:213],v241,s[8:11],s28 offen offset:1152
M a[164:167],a[236:239],a[212:215],a[164:167]
ds_read_b128 a[208:211],v245 offset:17408
ds_read_b128 a[212:215],v246 offset:17408
M a[168:171],a[236:239],a[216:219],a[168:171]
ds_read_b128 a[216:219],v245 offset:17920
v_fma_f32 v237,-4.0,v236,v238
M a[172:175],a[236:239],a[220:223],a[172:175]
ds_read_b128 a[220:223],v246 offset:17920
v_sub_f32 v238,v238,v236
M a[176:179],a[236:239],a[192:195],a[176:179]
buffer_load_dwordx4 a[228:231],v247,s[20:23],s48 offen offset:2048 sc1
M a[180:183],a[236:239],a[196:199],a[180:183]
s_add_u32 s46,s80,36864
ds_read_b128 a[192:195],v245 offset:18432
ds_read_b128 a[196:199],v246 offset:18432
M a[184:187],a[236:239],a[200:203],a[184:187]
ds_read_b128 a[200:203],v245 offset:18944
v_add_f32 v236,v228,v237
M a[188:191],a[236:239],a[204:207],a[188:191]
s_waitcnt vmcnt(14) lgkmcnt(6)
ds_read_b128 a[204:207],v246 offset:18944
v_sub_f32 v228,v228,v237
M v[0:3],a[240:243],a[208:211],v[0:3]
s_waitcnt lgkmcnt(6)
buffer_load_dwordx4 a[232:235],v247,s[20:23],s46 offen offset:0 sc1
M v[4:7],a[240:243],a[212:215],v[4:7]
s_waitcnt lgkmcnt(5)
s_add_u32 s47,s80,39936
v_fma_f32 v237,2.0,v238,v239
v_fmac_f32 v239,-2.0,v238
M v[8:11],a[240:243],a[216:219],v[8:11]
s_waitcnt lgkmcnt(4)
v_cvt_pk_bf16_f32 v229,v235,v240
v_cvt_pk_bf16_f32 v230,v236,v228
M v[12:15],a[240:243],a[220:223],v[12:15]
s_waitcnt lgkmcnt(3)
v_cvt_pk_bf16_f32 v231,v237,v239
v_add_u32 v228,69632,v244
M v[16:19],a[240:243],a[192:195],v[16:19]
s_waitcnt lgkmcnt(2)
buffer_load_dwordx4 a[236:239],v247,s[20:23],s47 offen offset:0 sc1
M v[20:23],a[240:243],a[196:199],v[20:23]
s_waitcnt lgkmcnt(1)
s_add_u32 s48,s80,43008
ds_write_b16 v228,v229 offset:0
M v[24:27],a[240:243],a[200:203],v[24:27]
s_waitcnt lgkmcnt(1)
ds_write_b16_d16_hi v228,v229 offset:8704
M v[28:31],a[240:243],a[204:207],v[28:31]
s_waitcnt vmcnt(15)
ds_write_b16 v244,v230 offset:0
M v[32:35],a[244:247],a[208:211],v[32:35]
global_load_dword v251,v252,s[82:83]
M v[36:39],a[244:247],a[212:215],v[36:39]
ds_write_b16_d16_hi v244,v230 offset:8704
M v[40:43],a[244:247],a[216:219],v[40:43]
buffer_load_dwordx4 a[240:243],v247,s[20:23],s48 offen offset:0 sc1
M v[44:47],a[244:247],a[220:223],v[44:47]
ds_write_b16 v244,v231 offset:17408
M v[48:51],a[244:247],a[192:195],v[48:51]
ds_write_b16_d16_hi v244,v231 offset:26112
M v[52:55],a[244:247],a[196:199],v[52:55]
v_lshlrev_b32 v230,16,v196
v_lshlrev_b32 v228,16,v192
M v[56:59],a[244:247],a[200:203],v[56:59]
v_lshlrev_b32 v229,16,v194
v_lshlrev_b32 v233,16,v202
M v[60:63],a[244:247],a[204:207],v[60:63]
s_waitcnt vmcnt(16)
buffer_load_dwordx4 a[244:247],v247,s[20:23],s46 offen offset:1024 sc1
M v[64:67],a[248:251],a[208:211],v[64:67]
ds_read_b128 a[208:211],v246 offset:19456
v_lshlrev_b32 v232,16,v200
M v[68:71],a[248:251],a[212:215],v[68:71]
v_lshlrev_b32 v231,16,v198
v_fmac_f32 v228,s43,v230
M v[72:75],a[248:251],a[216:219],v[72:75]
v_fmac_f32 v233,4.0,v229
v_fma_f32 v234,-4.0,v230,v232
M v[76:79],a[248:251],a[220:223],v[76:79]
v_fmac_f32 v228,s45,v232
v_fmac_f32 v233,s41,v231
M v[80:83],a[248:251],a[192:195],v[80:83]
v_sub_f32 v232,v232,v230
v_fma_f32 v230,-4.0,v229,v231
M v[84:87],a[248:251],a[196:199],v[84:87]
v_sub_f32 v231,v231,v229
v_add_f32 v229,v234,v230
M v[88:91],a[248:251],a[200:203],v[88:91]
v_sub_f32 v234,v234,v230
v_fma_f32 v230,2.0,v231,v232
M v[92:95],a[248:251],a[204:207],v[92:95]
s_waitcnt vmcnt(16)
buffer_load_dwordx4 a[248:251],v247,s[20:23],s47 offen offset:1024 sc1
M v[0:3],a[252:255],a[212:215],v[0:3]
v_fmac_f32 v232,-2.0,v231
v_and_b32 v196,s42,v196
M v[4:7],a[252:255],a[216:219],v[4:7]
v_and_b32 v192,s42,v192
v_and_b32 v194,s42,v194
M v[8:11],a[252:255],a[220:223],v[8:11]
v_and_b32 v202,s42,v202
v_and_b32 v200,s42,v200
M v[12:15],a[252:255],a[192:195],v[12:15]
v_and_b32 v198,s42,v198
v_fmac_f32 v192,s43,v196
M v[16:19],a[252:255],a[196:199],v[16:19]
v_fmac_f32 v202,4.0,v194
v_fma_f32 v231,-4.0,v196,v200
M v[20:23],a[252:255],a[200:203],v[20:23]
v_fmac_f32 v192,s45,v200
v_fmac_f32 v202,s41,v198
M v[24:27],a[252:255],a[204:207],v[24:27]
s_waitcnt lgkmcnt(0)
v_sub_f32 v200,v200,v196
v_fma_f32 v196,-4.0,v194,v198
M v[28:31],a[252:255],a[208:211],v[28:31]
s_waitcnt vmcnt(16)
buffer_load_dwordx4 a[252:255],v247,s[20:23],s48 offen offset:1024 sc1
M v[32:35],a[224:227],a[212:215],v[32:35]
v_sub_f32 v198,v198,v194
v_add_f32 v194,v231,v196
M v[36:39],a[224:227],a[216:219],v[36:39]
v_sub_f32 v231,v231,v196
v_fma_f32 v196,2.0,v198,v200
M v[40:43],a[224:227],a[220:223],v[40:43]
v_fmac_f32 v200,-2.0,v198
v_cvt_pk_bf16_f32 v192,v228,v192
M v[44:47],a[224:227],a[192:195],v[44:47]
v_cvt_pk_bf16_f32 v202,v233,v202
v_cvt_pk_bf16_f32 v194,v229,v194
M v[48:51],a[224:227],a[196:199],v[48:51]
v_cvt_pk_bf16_f32 v198,v230,v196
v_cvt_pk_bf16_f32 v196,v234,v231
M v[52:55],a[224:227],a[200:203],v[52:55]
v_cvt_pk_bf16_f32 v200,v232,v200
v_lshlrev_b32 v230,16,v197
M v[56:59],a[224:227],a[204:207],v[56:59]
v_lshlrev_b32 v228,16,v193
v_lshlrev_b32 v229,16,v195
M v[60:63],a[224:227],a[208:211],v[60:63]
s_waitcnt vmcnt(16)
buffer_load_dwordx4 a[224:227],v247,s[20:23],s46 offen offset:2048 sc1
M v[64:67],v[216:219],a[212:215],v[64:67]
ds_read_b128 a[212:215],v245 offset:19456
v_lshlrev_b32 v233,16,v203
M v[68:71],v[216:219],a[216:219],v[68:71]
v_lshlrev_b32 v232,16,v201
v_lshlrev_b32 v231,16,v199
M v[72:75],v[216:219],a[220:223],v[72:75]
v_fmac_f32 v228,s43,v230
v_fmac_f32 v233,4.0,v229
M v[76:79],v[216:219],a[192:195],v[76:79]
v_fma_f32 v234,-4.0,v230,v232
v_fmac_f32 v228,s45,v232
M v[80:83],v[216:219],a[196:199],v[80:83]
v_fmac_f32 v233,s41,v231
v_sub_f32 v232,v232,v230
M v[84:87],v[216:219],a[200:203],v[84:87]
v_fma_f32 v230,-4.0,v229,v231
v_sub_f32 v231,v231,v229
M v[88:91],v[216:219],a[204:207],v[88:91]
v_add_f32 v229,v234,v230
v_sub_f32 v234,v234,v230
M v[92:95],v[216:219],a[208:211],v[92:95]
s_waitcnt vmcnt(16)
buffer_load_dwordx4 v[216:219],v247,s[20:23],s47 offen offset:2048 sc1
M v[0:3],v[220:223],a[216:219],v[0:3]
v_fma_f32 v230,2.0,v231,v232
v_fmac_f32 v232,-2.0,v231
M v[4:7],v[220:223],a[220:223],v[4:7]
v_and_b32 v197,s42,v197
v_and_b32 v193,s42,v193
M v[8:11],v[220:223],a[192:195],v[8:11]
v_and_b32 v195,s42,v195
v_and_b32 v203,s42,v203
M v[12:15],v[220:223],a[196:199],v[12:15]
v_and_b32 v201,s42,v201
v_and_b32 v199,s42,v199
M v[16:19],v[220:223],a[200:203],v[16:19]
v_fmac_f32 v193,s43,v197
v_fmac_f32 v203,4.0,v195
M v[20:23],v[220:223],a[204:207],v[20:23]
v_fma_f32 v231,-4.0,v197,v201
v_fmac_f32 v193,s45,v201
M v[24:27],v[220:223],a[208:211],v[24:27]
s_waitcnt lgkmcnt(0)
v_fmac_f32 v203,s41,v199
v_sub_f32 v201,v201,v197
M v[28:31],v[220:223],a[212:215],v[28:31]
s_waitcnt vmcnt(12)
buffer_load_dwordx4 v[220:223],v247,s[20:23],s48 offen offset:2048 sc1
M v[32:35],v[224:227],a[216:219],v[32:35]
v_fma_f32 v197,-4.0,v195,v199
v_sub_f32 v199,v199,v195
M v[36:39],v[224:227],a[220:223],v[36:39]
s_add_u32 s46,s81,9216
v_add_f32 v195,v231,v197
v_sub_f32 v231,v231,v197
M v[40:43],v[224:227],a[192:195],v[40:43]
v_fma_f32 v197,2.0,v199,v201
v_fmac_f32 v201,-2.0,v199
M v[44:47],v[224:227],a[196:199],v[44:47]
v_cvt_pk_bf16_f32 v193,v228,v193
v_cvt_pk_bf16_f32 v203,v233,v203
M v[48:51],v[224:227],a[200:203],v[48:51]
v_cvt_pk_bf16_f32 v195,v229,v195
v_cvt_pk_bf16_f32 v199,v230,v197
M v[52:55],v[224:227],a[204:207],v[52:55]
v_cvt_pk_bf16_f32 v197,v234,v231
v_cvt_pk_bf16_f32 v201,v232,v201
M v[56:59],v[224:227],a[208:211],v[56:59]
ds_write2st64_b64 v243,v[192:193],v[202:203] offset0:138 offset1:155
M v[60:63],v[224:227],a[212:215],v[60:63]
s_waitcnt vmcnt(10)
buffer_load_dwordx4 v[224:227],v247,s[20:23],s46 offen offset:0 sc1
M v[64:67],a[228:231],a[216:219],v[64:67]
ds_read_b128 a[216:219],v245 offset:26112
ds_write2st64_b64 v243,v[194:195],v[196:197] offset0:2 offset1:19
M v[68:71],a[228:231],a[220:223],v[68:71]
ds_read_b128 a[220:223],v246 offset:26112
ds_write2st64_b64 v243,v[198:199],v[200:201] offset0:36 offset1:53
M v[72:75],a[228:231],a[192:195],v[72:75]
ds_read_b128 a[192:195],v245 offset:26624
v_lshlrev_b32 v230,16,v208
M v[76:79],a[228:231],a[196:199],v[76:79]
ds_read_b128 a[196:199],v246 offset:26624
v_lshlrev_b32 v228,16,v204
M v[80:83],a[228:231],a[200:203],v[80:83]
ds_read_b128 a[200:203],v245 offset:27136
v_lshlrev_b32 v229,16,v206
M v[84:87],a[228:231],a[204:207],v[84:87]
ds_read_b128 a[204:207],v246 offset:27136
v_lshlrev_b32 v233,16,v214
M v[88:91],a[228:231],a[208:211],v[88:91]
ds_read_b128 a[208:211],v245 offset:27648
v_lshlrev_b32 v232,16,v212
M v[92:95],a[228:231],a[212:215],v[92:95]
s_waitcnt vmcnt(10) lgkmcnt(8)
buffer_load_dwordx4 a[228:231],v247,s[20:23],s46 offen offset:1024 sc1
M v[96:99],a[232:235],a[216:219],v[96:99]
s_waitcnt lgkmcnt(6)
ds_read_b128 a[212:215],v246 offset:27648
v_lshlrev_b32 v231,16,v210
M v[100:103],a[232:235],a[220:223],v[100:103]
s_waitcnt lgkmcnt(5)
v_fmac_f32 v228,s43,v230
v_fmac_f32 v233,4.0,v229
M v[104:107],a[232:235],a[192:195],v[104:107]
s_waitcnt lgkmcnt(4)
v_fma_f32 v234,-4.0,v230,v232
v_fmac_f32 v228,s45,v232
M v[108:111],a[232:235],a[196:199],v[108:111]
s_waitcnt lgkmcnt(3)
v_fmac_f32 v233,s41,v231
v_sub_f32 v232,v232,v230
M v[112:115],a[232:235],a[200:203],v[112:115]
s_waitcnt lgkmcnt(2)
v_fma_f32 v230,-4.0,v229,v231
v_sub_f32 v231,v231,v229
M v[116:119],a[232:235],a[204:207],v[116:119]
s_waitcnt lgkmcnt(1)
v_add_f32 v229,v234,v230
v_sub_f32 v234,v234,v230
M v[120:123],a[232:235],a[208:211],v[120:123]
s_waitcnt lgkmcnt(0)
v_fma_f32 v230,2.0,v231,v232
v_fmac_f32 v232,-2.0,v231
M v[124:127],a[232:235],a[212:215],v[124:127]
s_waitcnt vmcnt(10)
buffer_load_dwordx4 a[232:235],v247,s[20:23],s46 offen offset:2048 sc1
M v[128:131],a[236:239],a[216:219],v[128:131]
v_and_b32 v208,s42,v208
v_and_b32 v204,s42,v204
M v[132:135],a[236:239],a[220:223],v[132:135]
s_add_u32 s46,s81,18432
v_and_b32 v206,s42,v206
v_and_b32 v214,s42,v214
M v[136:139],a[236:239],a[192:195],v[136:139]
v_and_b32 v212,s42,v212
v_and_b32 v210,s42,v210
M v[140:143],a[236:239],a[196:199],v[140:143]
v_fmac_f32 v204,s43,v208
v_fmac_f32 v214,4.0,v206
M v[144:147],a[236:239],a[200:203],v[144:147]
v_fma_f32 v231,-4.0,v208,v212
v_fmac_f32 v204,s45,v212
M v[148:151],a[236:239],a[204:207],v[148:151]
v_fmac_f32 v214,s41,v210
v_sub_f32 v212,v212,v208
M v[152:155],a[236:239],a[208:211],v[152:155]
v_fma_f32 v208,-4.0,v206,v210
v_sub_f32 v210,v210,v206
M v[156:159],a[236:239],a[212:215],v[156:159]
s_waitcnt vmcnt(9)
buffer_load_dwordx4 a[236:239],v247,s[20:23],s46 offen offset:0 sc1
M v[160:163],a[240:243],a[216:219],v[160:163]
ds_read_b128 a[216:219],v246 offset:28160
v_add_f32 v206,v231,v208
M v[164:167],a[240:243],a[220:223],v[164:167]
v_sub_f32 v231,v231,v208
v_fma_f32 v208,2.0,v210,v212
M v[168:171],a[240:243],a[192:195],v[168:171]
v_fmac_f32 v212,-2.0,v210
v_cvt_pk_bf16_f32 v204,v228,v204
M v[172:175],a[240:243],a[196:199],v[172:175]
v_cvt_pk_bf16_f32 v214,v233,v214
v_cvt_pk_bf16_f32 v206,v229,v206
M v[176:179],a[240:243],a[200:203],v[176:179]
v_cvt_pk_bf16_f32 v210,v230,v208
v_cvt_pk_bf16_f32 v208,v234,v231
M v[180:183],a[240:243],a[204:207],v[180:183]
v_cvt_pk_bf16_f32 v212,v232,v212
v_lshlrev_b32 v230,16,v209
M v[184:187],a[240:243],a[208:211],v[184:187]
v_lshlrev_b32 v228,16,v205
v_lshlrev_b32 v229,16,v207
M v[188:191],a[240:243],a[212:215],v[188:191]
s_waitcnt vmcnt(9)
buffer_load_dwordx4 a[240:243],v247,s[20:23],s46 offen offset:1024 sc1
M v[96:99],a[244:247],a[220:223],v[96:99]
v_lshlrev_b32 v233,16,v215
v_lshlrev_b32 v232,16,v213
M v[100:103],a[244:247],a[192:195],v[100:103]
v_lshlrev_b32 v231,16,v211
v_fmac_f32 v228,s43,v230
M v[104:107],a[244:247],a[196:199],v[104:107]
v_fmac_f32 v233,4.0,v229
v_fma_f32 v234,-4.0,v230,v232
M v[108:111],a[244:247],a[200:203],v[108:111]
v_fmac_f32 v228,s45,v232
v_fmac_f32 v233,s41,v231
M v[112:115],a[244:247],a[204:207],v[112:115]
v_sub_f32 v232,v232,v230
v_fma_f32 v230,-4.0,v229,v231
M v[116:119],a[244:247],a[208:211],v[116:119]
v_sub_f32 v231,v231,v229
v_add_f32 v229,v234,v230
M v[120:123],a[244:247],a[212:215],v[120:123]
s_waitcnt lgkmcnt(0)
v_sub_f32 v234,v234,v230
v_fma_f32 v230,2.0,v231,v232
M v[124:127],a[244:247],a[216:219],v[124:127]
s_waitcnt vmcnt(9)
buffer_load_dwordx4 a[244:247],v247,s[20:23],s46 offen offset:2048 sc1
M v[128:131],a[248:251],a[220:223],v[128:131]
v_fmac_f32 v232,-2.0,v231
v_and_b32 v209,s42,v209
M v[132:135],a[248:251],a[192:195],v[132:135]
s_add_u32 s46,s81,27648
v_and_b32 v205,s42,v205
v_and_b32 v207,s42,v207
M v[136:139],a[248:251],a[196:199],v[136:139]
v_and_b32 v215,s42,v215
v_and_b32 v213,s42,v213
M v[140:143],a[248:251],a[200:203],v[140:143]
v_and_b32 v211,s42,v211
v_fmac_f32 v205,s43,v209
M v[144:147],a[248:251],a[204:207],v[144:147]
v_fmac_f32 v215,4.0,v207
v_fma_f32 v231,-4.0,v209,v213
M v[148:151],a[248:251],a[208:211],v[148:151]
v_fmac_f32 v205,s45,v213
v_fmac_f32 v215,s41,v211
M v[152:155],a[248:251],a[212:215],v[152:155]
v_sub_f32 v213,v213,v209
v_fma_f32 v209,-4.0,v207,v211
M v[156:159],a[248:251],a[216:219],v[156:159]
s_waitcnt vmcnt(9)
buffer_load_dwordx4 a[248:251],v247,s[20:23],s46 offen offset:0 sc1
M v[160:163],a[252:255],a[220:223],v[160:163]
ds_read_b128 a[220:223],v245 offset:28160
v_sub_f32 v211,v211,v207
M v[164:167],a[252:255],a[192:195],v[164:167]
v_add_f32 v207,v231,v209
v_sub_f32 v231,v231,v209
M v[168:171],a[252:255],a[196:199],v[168:171]
v_fma_f32 v209,2.0,v211,v213
v_fmac_f32 v213,-2.0,v211
M v[172:175],a[252:255],a[200:203],v[172:175]
v_cvt_pk_bf16_f32 v205,v228,v205
v_cvt_pk_bf16_f32 v215,v233,v215
M v[176:179],a[252:255],a[204:207],v[176:179]
v_cvt_pk_bf16_f32 v207,v229,v207
v_cvt_pk_bf16_f32 v211,v230,v209
M v[180:183],a[252:255],a[208:211],v[180:183]
v_cvt_pk_bf16_f32 v209,v234,v231
v_cvt_pk_bf16_f32 v213,v232,v213
M v[184:187],a[252:255],a[212:215],v[184:187]
ds_write2st64_b64 v243,v[204:205],v[214:215] offset0:139 offset1:156
M v[188:191],a[252:255],a[216:219],v[188:191]
s_waitcnt vmcnt(9)
buffer_load_dwordx4 a[252:255],v247,s[20:23],s46 offen offset:1024 sc1
M v[96:99],a[224:227],a[192:195],v[96:99]
ds_write2st64_b64 v243,v[206:207],v[208:209] offset0:3 offset1:20
M v[100:103],a[224:227],a[196:199],v[100:103]
ds_write2st64_b64 v243,v[210:211],v[212:213] offset0:37 offset1:54
M v[104:107],a[224:227],a[200:203],v[104:107]
M v[108:111],a[224:227],a[204:207],v[108:111]
M v[112:115],a[224:227],a[208:211],v[112:115]
M v[116:119],a[224:227],a[212:215],v[116:119]
M v[120:123],a[224:227],a[216:219],v[120:123]
s_waitcnt lgkmcnt(3)
M v[124:127],a[224:227],a[220:223],v[124:127]
s_waitcnt vmcnt(9)
buffer_load_dwordx4 a[224:227],v247,s[20:23],s46 offen offset:2048 sc1
M v[128:131],v[216:219],a[192:195],v[128:131]
M v[132:135],v[216:219],a[196:199],v[132:135]
s_add_u32 s46,s81,36864
M v[136:139],v[216:219],a[200:203],v[136:139]
M v[140:143],v[216:219],a[204:207],v[140:143]
M v[144:147],v[216:219],a[208:211],v[144:147]
M v[148:151],v[216:219],a[212:215],v[148:151]
v_add_u32 v245,0xffffbc00,v245
v_add_u32 v246,0xffffbc00,v246
M v[152:155],v[216:219],a[216:219],v[152:155]
s_waitcnt lgkmcnt(0)
s_barrier
M v[156:159],v[216:219],a[220:223],v[156:159]
s_waitcnt vmcnt(9)
buffer_load_dwordx4 v[216:219],v247,s[20:23],s46 offen offset:0 sc1
M v[160:163],v[220:223],a[192:195],v[160:163]
ds_read_b128 a[192:195],v245 offset:0
M v[164:167],v[220:223],a[196:199],v[164:167]
ds_read_b128 a[196:199],v246 offset:0
M v[168:171],v[220:223],a[200:203],v[168:171]
ds_read_b128 a[200:203],v245 offset:512
M v[172:175],v[220:223],a[204:207],v[172:175]
ds_read_b128 a[204:207],v246 offset:512
M v[176:179],v[220:223],a[208:211],v[176:179]
ds_read_b128 a[208:211],v245 offset:1024
M v[180:183],v[220:223],a[212:215],v[180:183]
ds_read_b128 a[212:215],v246 offset:1024
M v[184:187],v[220:223],a[216:219],v[184:187]
ds_read_b128 a[216:219],v245 offset:1536
M v[188:191],v[220:223],a[220:223],v[188:191]
s_waitcnt vmcnt(9) lgkmcnt(6)
buffer_load_dwordx4 v[220:223],v247,s[20:23],s46 offen offset:1024 sc1
M a[0:3],v[224:227],a[192:195],a[0:3]
s_waitcnt lgkmcnt(5)
ds_read_b128 a[220:223],v246 offset:1536
ds_read_b128 a[192:195],v246 offset:2048
M a[4:7],v[224:227],a[196:199],a[4:7]
s_waitcnt lgkmcnt(6)
M a[8:11],v[224:227],a[200:203],a[8:11]
s_waitcnt lgkmcnt(5)
M a[12:15],v[224:227],a[204:207],a[12:15]
s_waitcnt lgkmcnt(4)
M a[16:19],v[224:227],a[208:211],a[16:19]
s_waitcnt lgkmcnt(3)
M a[20:23],v[224:227],a[212:215],a[20:23]
s_waitcnt lgkmcnt(2)
M a[24:27],v[224:227],a[216:219],a[24:27]
s_waitcnt lgkmcnt(1)
M a[28:31],v[224:227],a[220:223],a[28:31]
s_waitcnt vmcnt(9)
buffer_load_dwordx4 v[224:227],v247,s[20:23],s46 offen offset:2048 sc1
M a[0:3],a[228:231],a[196:199],a[0:3]
ds_read_b128 a[196:199],v245 offset:2048
M a[4:7],a[228:231],a[200:203],a[4:7]
s_add_u32 s47,s81,12288
M a[8:11],a[228:231],a[204:207],a[8:11]
M a[12:15],a[228:231],a[208:211],a[12:15]
M a[16:19],a[228:231],a[212:215],a[16:19]
M a[20:23],a[228:231],a[216:219],a[20:23]
M a[24:27],a[228:231],a[220:223],a[24:27]
s_waitcnt lgkmcnt(1)
M a[28:31],a[228:231],a[192:195],a[28:31]
s_waitcnt vmcnt(9)
buffer_load_dwordx4 a[228:231],v247,s[20:23],s47 offen offset:0 sc1
M a[0:3],a[232:235],a[200:203],a[0:3]
ds_read_b128 a[200:203],v245 offset:8704
M a[4:7],a[232:235],a[204:207],a[4:7]
s_add_u32 s48,s81,15360
ds_read_b128 a[204:207],v246 offset:8704
M a[8:11],a[232:235],a[208:211],a[8:11]
ds_read_b128 a[208:211],v245 offset:9216
M a[12:15],a[232:235],a[212:215],a[12:15]
ds_read_b128 a[212:215],v246 offset:9216
M a[16:19],a[232:235],a[216:219],a[16:19]
ds_read_b128 a[216:219],v245 offset:9728
M a[20:23],a[232:235],a[220:223],a[20:23]
ds_read_b128 a[220:223],v246 offset:9728
M a[24:27],a[232:235],a[192:195],a[24:27]
s_waitcnt lgkmcnt(6)
ds_read_b128 a[192:195],v245 offset:10240
M a[28:31],a[232:235],a[196:199],a[28:31]
s_waitcnt vmcnt(9) lgkmcnt(6)
buffer_load_dwordx4 a[232:235],v247,s[20:23],s48 offen offset:0 sc1
M a[96:99],a[236:239],a[200:203],a[96:99]
s_waitcnt lgkmcnt(5)
ds_read_b128 a[196:199],v246 offset:10240
ds_read_b128 a[200:203],v246 offset:10752
M a[100:103],a[236:239],a[204:207],a[100:103]
s_waitcnt lgkmcnt(6)
M a[104:107],a[236:239],a[208:211],a[104:107]
s_waitcnt lgkmcnt(5)
M a[108:111],a[236:239],a[212:215],a[108:111]
s_waitcnt lgkmcnt(4)
M a[112:115],a[236:239],a[216:219],a[112:115]
s_waitcnt lgkmcnt(3)
M a[116:119],a[236:239],a[220:223],a[116:119]
s_waitcnt lgkmcnt(2)
M a[120:123],a[236:239],a[192:195],a[120:123]
s_waitcnt lgkmcnt(1)
M a[124:127],a[236:239],a[196:199],a[124:127]
s_waitcnt vmcnt(9)
buffer_load_dwordx4 a[236:239],v247,s[20:23],s47 offen offset:1024 sc1
M a[96:99],a[240:243],a[204:207],a[96:99]
ds_read_b128 a[204:207],v245 offset:10752
M a[100:103],a[240:243],a[208:211],a[100:103]
M a[104:107],a[240:243],a[212:215],a[104:107]
M a[108:111],a[240:243],a[216:219],a[108:111]
M a[112:115],a[240:243],a[220:223],a[112:115]
M a[116:119],a[240:243],a[192:195],a[116:119]
M a[120:123],a[240:243],a[196:199],a[120:123]
s_waitcnt lgkmcnt(1)
M a[124:127],a[240:243],a[200:203],a[124:127]
s_waitcnt vmcnt(9)
buffer_load_dwordx4 a[240:243],v247,s[20:23],s48 offen offset:1024 sc1
M a[96:99],a[244:247],a[208:211],a[96:99]
ds_read_b128 a[208:211],v245 offset:17408
M a[100:103],a[244:247],a[212:215],a[100:103]
ds_read_b128 a[212:215],v246 offset:17408
M a[104:107],a[244:247],a[216:219],a[104:107]
ds_read_b128 a[216:219],v245 offset:17920
M a[108:111],a[244:247],a[220:223],a[108:111]
ds_read_b128 a[220:223],v246 offset:17920
M a[112:115],a[244:247],a[192:195],a[112:115]
ds_read_b128 a[192:195],v245 offset:18432
M a[116:119],a[244:247],a[196:199],a[116:119]
ds_read_b128 a[196:199],v246 offset:18432
M a[120:123],a[244:247],a[200:203],a[120:123]
s_waitcnt lgkmcnt(6)
ds_read_b128 a[200:203],v245 offset:18944
M a[124:127],a[244:247],a[204:207],a[124:127]
s_waitcnt vmcnt(9) lgkmcnt(6)
buffer_load_dwordx4 a[244:247],v247,s[20:23],s47 offen offset:2048 sc1
M v[0:3],a[248:251],a[208:211],v[0:3]
s_waitcnt lgkmcnt(5)
ds_read_b128 a[204:207],v246 offset:18944
ds_read_b128 a[208:211],v246 offset:19456
M v[4:7],a[248:251],a[212:215],v[4:7]
s_waitcnt lgkmcnt(6)
M v[8:11],a[248:251],a[216:219],v[8:11]
s_waitcnt lgkmcnt(5)
M v[12:15],a[248:251],a[220:223],v[12:15]
s_waitcnt lgkmcnt(4)
M v[16:19],a[248:251],a[192:195],v[16:19]
s_waitcnt lgkmcnt(3)
M v[20:23],a[248:251],a[196:199],v[20:23]
s_waitcnt lgkmcnt(2)
M v[24:27],a[248:251],a[200:203],v[24:27]
s_waitcnt lgkmcnt(1)
M v[28:31],a[248:251],a[204:207],v[28:31]
s_waitcnt vmcnt(9)
buffer_load_dwordx4 a[248:251],v247,s[20:23],s48 offen offset:2048 sc1
M v[0:3],a[252:255],a[212:215],v[0:3]
ds_read_b128 a[212:215],v245 offset:19456
M v[4:7],a[252:255],a[216:219],v[4:7]
s_add_u32 s47,s81,21504
M v[8:11],a[252:255],a[220:223],v[8:11]
M v[12:15],a[252:255],a[192:195],v[12:15]
M v[16:19],a[252:255],a[196:199],v[16:19]
M v[20:23],a[252:255],a[200:203],v[20:23]
M v[24:27],a[252:255],a[204:207],v[24:27]
s_waitcnt lgkmcnt(1)
M v[28:31],a[252:255],a[208:211],v[28:31]
s_waitcnt vmcnt(9)
buffer_load_dwordx4 a[252:255],v247,s[20:23],s47 offen offset:0 sc1
M v[0:3],a[224:227],a[216:219],v[0:3]
ds_read_b128 a[216:219],v245 offset:26112
M v[4:7],a[224:227],a[220:223],v[4:7]
s_add_u32 s48,s81,24576
ds_read_b128 a[220:223],v246 offset:26112
M v[8:11],a[224:227],a[192:195],v[8:11]
ds_read_b128 a[192:195],v245 offset:26624
M v[12:15],a[224:227],a[196:199],v[12:15]
ds_read_b128 a[196:199],v246 offset:26624
M v[16:19],a[224:227],a[200:203],v[16:19]
ds_read_b128 a[200:203],v245 offset:27136
M v[20:23],a[224:227],a[204:207],v[20:23]
ds_read_b128 a[204:207],v246 offset:27136
M v[24:27],a[224:227],a[208:211],v[24:27]
s_waitcnt lgkmcnt(6)
ds_read_b128 a[208:211],v245 offset:27648
M v[28:31],a[224:227],a[212:215],v[28:31]
s_waitcnt vmcnt(9) lgkmcnt(6)
buffer_load_dwordx4 a[224:227],v247,s[20:23],s48 offen offset:0 sc1
M v[96:99],v[216:219],a[216:219],v[96:99]
s_waitcnt lgkmcnt(5)
ds_read_b128 a[212:215],v246 offset:27648
ds_read_b128 a[216:219],v246 offset:28160
M v[100:103],v[216:219],a[220:223],v[100:103]
s_waitcnt lgkmcnt(6)
M v[104:107],v[216:219],a[192:195],v[104:107]
s_waitcnt lgkmcnt(5)
M v[108:111],v[216:219],a[196:199],v[108:111]
s_waitcnt lgkmcnt(4)
M v[112:115],v[216:219],a[200:203],v[112:115]
s_waitcnt lgkmcnt(3)
M v[116:119],v[216:219],a[204:207],v[116:119]
s_waitcnt lgkmcnt(2)
M v[120:123],v[216:219],a[208:211],v[120:123]
s_waitcnt lgkmcnt(1)
M v[124:127],v[216:219],a[212:215],v[124:127]
s_waitcnt vmcnt(9)
buffer_load_dwordx4 v[216:219],v247,s[20:23],s47 offen offset:1024 sc1
M v[96:99],v[220:223],a[220:223],v[96:99]
ds_read_b128 a[220:223],v245 offset:28160
M v[100:103],v[220:223],a[192:195],v[100:103]
M v[104:107],v[220:223],a[196:199],v[104:107]
M v[108:111],v[220:223],a[200:203],v[108:111]
M v[112:115],v[220:223],a[204:207],v[112:115]
M v[116:119],v[220:223],a[208:211],v[116:119]
M v[120:123],v[220:223],a[212:215],v[120:123]
s_waitcnt lgkmcnt(1)
M v[124:127],v[220:223],a[216:219],v[124:127]
s_waitcnt vmcnt(9)
buffer_load_dwordx4 v[220:223],v247,s[20:23],s48 offen offset:1024 sc1
M v[96:99],v[224:227],a[192:195],v[96:99]
ds_read_b128 a[192:195],v245 offset:0
M v[100:103],v[224:227],a[196:199],v[100:103]
ds_read_b128 a[196:199],v246 offset:0
M v[104:107],v[224:227],a[200:203],v[104:107]
ds_read_b128 a[200:203],v245 offset:512
M v[108:111],v[224:227],a[204:207],v[108:111]
ds_read_b128 a[204:207],v246 offset:512
v_accvgpr_read_b32 v234,a0
M v[112:115],v[224:227],a[208:211],v[112:115]
ds_read_b128 a[208:211],v245 offset:1024
v_accvgpr_read_b32 v228,a96
M v[116:119],v[224:227],a[212:215],v[116:119]
ds_read_b128 a[212:215],v246 offset:1024
v_add_f32 v230,v234,v228
M v[120:123],v[224:227],a[216:219],v[120:123]
s_waitcnt lgkmcnt(6)
ds_read_b128 a[216:219],v245 offset:1536
v_sub_f32 v234,v234,v228
M v[124:127],v[224:227],a[220:223],v[124:127]
s_waitcnt vmcnt(9) lgkmcnt(6)
buffer_load_dwordx4 v[224:227],v247,s[20:23],s47 offen offset:2048 sc1
M a[32:35],a[228:231],a[192:195],a[32:35]
s_waitcnt lgkmcnt(5)
ds_read_b128 a[220:223],v246 offset:1536
v_add_f32 v228,v0,v96
M a[36:39],a[228:231],a[196:199],a[36:39]
s_waitcnt lgkmcnt(5)
v_sub_f32 v96,v0,v96
v_add_f32 v0,v230,v228
M a[40:43],a[228:231],a[200:203],a[40:43]
s_waitcnt lgkmcnt(4)
v_fmac_f32 v230,4.0,v228
v_fma_f32 v228,2.0,v96,v234
M a[44:47],a[228:231],a[204:207],a[44:47]
s_waitcnt lgkmcnt(3)
v_fma_f32 v96,s40,v96,v234
v_accvgpr_read_b32 v234,a1
M a[48:51],a[228:231],a[208:211],a[48:51]
s_waitcnt lgkmcnt(2)
v_accvgpr_read_b32 v233,a97
v_add_f32 v232,v234,v233
M a[52:55],a[228:231],a[212:215],a[52:55]
s_waitcnt lgkmcnt(1)
v_sub_f32 v234,v234,v233
v_add_f32 v233,v1,v97
M a[56:59],a[228:231],a[216:219],a[56:59]
s_waitcnt lgkmcnt(0)
v_sub_f32 v97,v1,v97
v_add_f32 v1,v232,v233
M a[60:63],a[228:231],a[220:223],a[60:63]
s_waitcnt vmcnt(9)
buffer_load_dwordx4 a[228:231],v247,s[20:23],s48 offen offset:2048 sc1
M a[64:67],a[232:235],a[192:195],a[64:67]
ds_read_b128 a[192:195],v246 offset:2048
v_fmac_f32 v232,4.0,v233
M a[68:71],a[232:235],a[196:199],a[68:71]
s_add_u32 s47,s81,30720
v_fma_f32 v233,2.0,v97,v234
v_fma_f32 v97,s40,v97,v234
M a[72:75],a[232:235],a[200:203],a[72:75]
v_cvt_pk_bf16_f32 v228,v228,v233
v_cvt_pk_bf16_f32 v230,v230,v232
M a[76:79],a[232:235],a[204:207],a[76:79]
v_accvgpr_read_b32 v234,a2
v_accvgpr_read_b32 v229,a98
M a[80:83],a[232:235],a[208:211],a[80:83]
v_add_f32 v231,v234,v229
v_sub_f32 v234,v234,v229
M a[84:87],a[232:235],a[212:215],a[84:87]
v_add_f32 v229,v2,v98
v_sub_f32 v98,v2,v98
M a[88:91],a[232:235],a[216:219],a[88:91]
v_add_f32 v2,v231,v229
v_fmac_f32 v231,4.0,v229
M a[92:95],a[232:235],a[220:223],a[92:95]
s_waitcnt vmcnt(9)
buffer_load_dwordx4 a[232:235],v247,s[20:23],s47 offen offset:0 sc1
M a[32:35],a[236:239],a[196:199],a[32:35]
s_add_u32 s48,s81,33792
v_fma_f32 v229,2.0,v98,v234
v_fma_f32 v98,s40,v98,v234
M a[36:39],a[236:239],a[200:203],a[36:39]
v_accvgpr_read_b32 v234,a3
v_accvgpr_read_b32 v233,a99
M a[40:43],a[236:239],a[204:207],a[40:43]
buffer_load_dwordx4 a[96:99],v247,s[20:23],s48 offen offset:0 sc1
M a[44:47],a[236:239],a[208:211],a[44:47]
v_add_f32 v232,v234,v233
v_sub_f32 v234,v234,v233
M a[48:51],a[236:239],a[212:215],a[48:51]
v_add_f32 v233,v3,v99
v_sub_f32 v99,v3,v99
M a[52:55],a[236:239],a[216:219],a[52:55]
v_add_f32 v3,v232,v233
v_fmac_f32 v232,4.0,v233
M a[56:59],a[236:239],a[220:223],a[56:59]
s_waitcnt lgkmcnt(0)
v_fma_f32 v233,2.0,v99,v234
v_fma_f32 v99,s40,v99,v234
M a[60:63],a[236:239],a[192:195],a[60:63]
s_waitcnt vmcnt(10)
buffer_load_dwordx4 a[236:239],v247,s[20:23],s47 offen offset:1024 sc1
M a[64:67],a[240:243],a[196:199],a[64:67]
ds_read_b128 a[196:199],v245 offset:2048
v_cvt_pk_bf16_f32 v229,v229,v233
M a[68:71],a[240:243],a[200:203],a[68:71]
v_cvt_pk_bf16_f32 v231,v231,v232
M a[72:75],a[240:243],a[204:207],a[72:75]
ds_write2st64_b64 v249,v[228:229],v[230:231] offset0:68 offset1:72
M a[76:79],a[240:243],a[208:211],a[76:79]
v_accvgpr_read_b32 v234,a4
v_accvgpr_read_b32 v228,a100
M a[80:83],a[240:243],a[212:215],a[80:83]
v_add_f32 v230,v234,v228
v_sub_f32 v234,v234,v228
M a[84:87],a[240:243],a[216:219],a[84:87]
v_add_f32 v228,v4,v100
v_sub_f32 v100,v4,v100
M a[88:91],a[240:243],a[220:223],a[88:91]
v_add_f32 v4,v230,v228
v_fmac_f32 v230,4.0,v228
M a[92:95],a[240:243],a[192:195],a[92:95]
s_waitcnt vmcnt(10)
buffer_load_dwordx4 a[240:243],v247,s[20:23],s48 offen offset:1024 sc1
M a[32:35],a[244:247],a[200:203],a[32:35]
v_fma_f32 v228,2.0,v100,v234
v_fma_f32 v100,s40,v100,v234
M a[36:39],a[244:247],a[204:207],a[36:39]
v_accvgpr_read_b32 v234,a5
v_accvgpr_read_b32 v233,a101
M a[40:43],a[244:247],a[208:211],a[40:43]
v_add_f32 v232,v234,v233
v_sub_f32 v234,v234,v233
M a[44:47],a[244:247],a[212:215],a[44:47]
v_add_f32 v233,v5,v101
v_sub_f32 v101,v5,v101
M a[48:51],a[244:247],a[216:219],a[48:51]
v_add_f32 v5,v232,v233
v_fmac_f32 v232,4.0,v233
M a[52:55],a[244:247],a[220:223],a[52:55]
v_fma_f32 v233,2.0,v101,v234
v_fma_f32 v101,s40,v101,v234
M a[56:59],a[244:247],a[192:195],a[56:59]
s_waitcnt lgkmcnt(1)
v_cvt_pk_bf16_f32 v228,v228,v233
v_cvt_pk_bf16_f32 v230,v230,v232
M a[60:63],a[244:247],a[196:199],a[60:63]
s_waitcnt vmcnt(10)
buffer_load_dwordx4 a[244:247],v247,s[20:23],s47 offen offset:2048 sc1
M a[64:67],a[248:251],a[200:203],a[64:67]
ds_read_b128 a[200:203],v245 offset:8704
v_accvgpr_read_b32 v234,a6
M a[68:71],a[248:251],a[204:207],a[68:71]
ds_read_b128 a[204:207],v246 offset:8704
v_accvgpr_read_b32 v229,a102
M a[72:75],a[248:251],a[208:211],a[72:75]
ds_read_b128 a[208:211],v245 offset:9216
v_add_f32 v231,v234,v229
M a[76:79],a[248:251],a[212:215],a[76:79]
ds_read_b128 a[212:215],v246 offset:9216
v_sub_f32 v234,v234,v229
M a[80:83],a[248:251],a[216:219],a[80:83]
ds_read_b128 a[216:219],v245 offset:9728
v_add_f32 v229,v6,v102
M a[84:87],a[248:251],a[220:223],a[84:87]
ds_read_b128 a[220:223],v246 offset:9728
v_sub_f32 v102,v6,v102
M a[88:91],a[248:251],a[192:195],a[88:91]
ds_read_b128 a[192:195],v245 offset:10240
v_add_f32 v6,v231,v229
M a[92:95],a[248:251],a[196:199],a[92:95]
s_waitcnt vmcnt(10) lgkmcnt(6)
buffer_load_dwordx4 a[248:251],v247,s[20:23],s48 offen offset:2048 sc1
M a[128:131],a[252:255],a[200:203],a[128:131]
s_waitcnt lgkmcnt(5)
s_add_u32 s47,s81,39936
ds_read_b128 a[196:199],v246 offset:10240
v_fmac_f32 v231,4.0,v229
M a[132:135],a[252:255],a[204:207],a[132:135]
s_waitcnt lgkmcnt(5)
v_fma_f32 v229,2.0,v102,v234
v_fma_f32 v102,s40,v102,v234
M a[136:139],a[252:255],a[208:211],a[136:139]
s_waitcnt lgkmcnt(4)
v_accvgpr_read_b32 v234,a7
v_accvgpr_read_b32 v233,a103
M a[140:143],a[252:255],a[212:215],a[140:143]
s_waitcnt lgkmcnt(3)
buffer_load_dwordx4 a[100:103],v247,s[20:23],s47 offen offset:0 sc1
M a[144:147],a[252:255],a[216:219],a[144:147]
s_waitcnt lgkmcnt(2)
s_add_u32 s48,s81,43008
v_add_f32 v232,v234,v233
v_sub_f32 v234,v234,v233
M a[148:151],a[252:255],a[220:223],a[148:151]
s_waitcnt lgkmcnt(1)
global_load_dword v251,v252,s[82:83]
M a[152:155],a[252:255],a[192:195],a[152:155]
s_waitcnt lgkmcnt(0)
v_add_f32 v233,v7,v103
v_sub_f32 v103,v7,v103
M a[156:159],a[252:255],a[196:199],a[156:159]
s_waitcnt vmcnt(12)
buffer_load_dwordx4 a[252:255],v247,s[20:23],s48 offen offset:0 sc1
M a[160:163],a[224:227],a[200:203],a[160:163]
ds_read_b128 a[200:203],v246 offset:10752
v_add_f32 v7,v232,v233
M a[164:167],a[224:227],a[204:207],a[164:167]
v_fmac_f32 v232,4.0,v233
v_fma_f32 v233,2.0,v103,v234
M a[168:171],a[224:227],a[208:211],a[168:171]
v_fma_f32 v103,s40,v103,v234
v_cvt_pk_bf16_f32 v229,v229,v233
M a[172:175],a[224:227],a[212:215],a[172:175]
v_cvt_pk_bf16_f32 v231,v231,v232
M a[176:179],a[224:227],a[216:219],a[176:179]
ds_write2st64_b64 v249,v[228:229],v[230:231] offset0:76 offset1:80
M a[180:183],a[224:227],a[220:223],a[180:183]
v_accvgpr_read_b32 v234,a8
v_accvgpr_read_b32 v228,a104
M a[184:187],a[224:227],a[192:195],a[184:187]
v_add_f32 v230,v234,v228
v_sub_f32 v234,v234,v228
M a[188:191],a[224:227],a[196:199],a[188:191]
s_waitcnt vmcnt(12)
buffer_load_dwordx4 a[224:227],v247,s[20:23],s47 offen offset:1024 sc1
M a[128:131],v[216:219],a[204:207],a[128:131]
v_add_f32 v228,v8,v104
v_sub_f32 v104,v8,v104
M a[132:135],v[216:219],a[208:211],a[132:135]
s_waitcnt lgkmcnt(0)
s_barrier
ds_read_b128 a[0:3],v247 offset:34816
M a[136:139],v[216:219],a[212:215],a[136:139]
ds_read_b128 a[4:7],v247 offset:38912
v_add_f32 v8,v230,v228
M a[140:143],v[216:219],a[216:219],a[140:143]
v_fmac_f32 v230,4.0,v228
v_fma_f32 v228,2.0,v104,v234
M a[144:147],v[216:219],a[220:223],a[144:147]
v_fma_f32 v104,s40,v104,v234
v_accvgpr_read_b32 v234,a9
M a[148:151],v[216:219],a[192:195],a[148:151]
v_accvgpr_read_b32 v233,a105
v_add_f32 v232,v234,v233
M a[152:155],v[216:219],a[196:199],a[152:155]
s_waitcnt lgkmcnt(1)
s_add_u32 s34,s32,6291456
buffer_store_dwordx4 a[0:3],v248,s[24:27],s34 offen offset:384 nt
M a[156:159],v[216:219],a[200:203],a[156:159]
s_waitcnt vmcnt(13)
buffer_load_dwordx4 v[216:219],v247,s[20:23],s48 offen offset:1024 sc1
M a[160:163],v[220:223],a[204:207],a[160:163]
ds_read_b128 a[204:207],v245 offset:10752
v_sub_f32 v234,v234,v233
M a[164:167],v[220:223],a[208:211],a[164:167]
v_add_f32 v233,v9,v105
v_sub_f32 v105,v9,v105
M a[168:171],v[220:223],a[212:215],a[168:171]
v_add_f32 v9,v232,v233
v_fmac_f32 v232,4.0,v233
M a[172:175],v[220:223],a[216:219],a[172:175]
v_fma_f32 v233,2.0,v105,v234
v_fma_f32 v105,s40,v105,v234
M a[176:179],v[220:223],a[220:223],a[176:179]
s_waitcnt lgkmcnt(1)
s_add_u32 s34,s32,6488064
buffer_store_dwordx4 a[4:7],v248,s[24:27],s34 offen offset:384 nt
M a[180:183],v[220:223],a[192:195],a[180:183]
v_cvt_pk_bf16_f32 v228,v228,v233
v_cvt_pk_bf16_f32 v230,v230,v232
M a[184:187],v[220:223],a[196:199],a[184:187]
v_accvgpr_read_b32 v234,a10
v_accvgpr_read_b32 v229,a106
M a[188:191],v[220:223],a[200:203],a[188:191]
s_waitcnt vmcnt(14)
buffer_load_dwordx4 v[220:223],v247,s[20:23],s47 offen offset:2048 sc1
M a[128:131],v[224:227],a[208:211],a[128:131]
v_add_f32 v231,v234,v229
v_sub_f32 v234,v234,v229
M a[132:135],v[224:227],a[212:215],a[132:135]
v_add_f32 v229,v10,v106
v_sub_f32 v106,v10,v106
M a[136:139],v[224:227],a[216:219],a[136:139]
v_add_f32 v10,v231,v229
v_fmac_f32 v231,4.0,v229
M a[140:143],v[224:227],a[220:223],a[140:143]
v_fma_f32 v229,2.0,v106,v234
v_fma_f32 v106,s40,v106,v234
M a[144:147],v[224:227],a[192:195],a[144:147]
v_accvgpr_read_b32 v234,a11
v_accvgpr_read_b32 v233,a107
M a[148:151],v[224:227],a[196:199],a[148:151]
buffer_load_dwordx4 a[104:107],v247,s[20:23],s48 offen offset:2048 sc1
M a[152:155],v[224:227],a[200:203],a[152:155]
s_waitcnt lgkmcnt(0)
s_add_u32 s46,s76,0
v_add_f32 v232,v234,v233
v_sub_f32 v234,v234,v233
M a[156:159],v[224:227],a[204:207],a[156:159]
s_waitcnt vmcnt(15)
buffer_load_dwordx4 v[224:227],v247,s[20:23],s46 offen offset:0 sc1
M a[160:163],a[228:231],a[208:211],a[160:163]
ds_read_b128 a[208:211],v245 offset:17408
v_add_f32 v233,v11,v107
M a[164:167],a[228:231],a[212:215],a[164:167]
ds_read_b128 a[212:215],v246 offset:17408
v_sub_f32 v107,v11,v107
M a[168:171],a[228:231],a[216:219],a[168:171]
ds_read_b128 a[216:219],v245 offset:17920
v_add_f32 v11,v232,v233
M a[172:175],a[228:231],a[220:223],a[172:175]
ds_read_b128 a[220:223],v246 offset:17920
v_fmac_f32 v232,4.0,v233
M a[176:179],a[228:231],a[192:195],a[176:179]
ds_read_b128 a[192:195],v245 offset:18432
v_fma_f32 v233,2.0,v107,v234
M a[180:183],a[228:231],a[196:199],a[180:183]
ds_read_b128 a[196:199],v246 offset:18432
v_fma_f32 v107,s40,v107,v234
M a[184:187],a[228:231],a[200:203],a[184:187]
ds_read_b128 a[200:203],v245 offset:18944
v_cvt_pk_bf16_f32 v229,v229,v233
M a[188:191],a[228:231],a[204:207],a[188:191]
s_waitcnt vmcnt(15) lgkmcnt(6)
buffer_load_dwordx4 a[228:231],v247,s[20:23],s46 offen offset:1024 sc1
M v[32:35],a[232:235],a[208:211],v[32:35]
s_waitcnt lgkmcnt(5)
ds_read_b128 a[204:207],v246 offset:18944
v_cvt_pk_bf16_f32 v231,v231,v232
M v[36:39],a[232:235],a[212:215],v[36:39]
s_waitcnt lgkmcnt(5)
ds_write2st64_b64 v249,v[228:229],v[230:231] offset0:85 offset1:89
M v[40:43],a[232:235],a[216:219],v[40:43]
s_waitcnt lgkmcnt(5)
v_accvgpr_read_b32 v204,a12
v_accvgpr_read_b32 v208,a108
M v[44:47],a[232:235],a[220:223],v[44:47]
s_waitcnt lgkmcnt(4)
v_accvgpr_read_b32 v205,a13
v_accvgpr_read_b32 v209,a109
M v[48:51],a[232:235],a[192:195],v[48:51]
s_waitcnt lgkmcnt(3)
v_accvgpr_read_b32 v206,a14
v_accvgpr_read_b32 v210,a110
v_accvgpr_read_b32 v207,a15
v_accvgpr_read_b32 v211,a111
v_pk_add_f32 v[212:213],v[204:205],v[208:209]
v_pk_add_f32 v[214:215],v[206:207],v[210:211]
v_pk_add_f32 v[204:205],v[204:205],v[208:209] neg_lo:[0,1] neg_hi:[0,1]
v_pk_add_f32 v[206:207],v[206:207],v[210:211] neg_lo:[0,1] neg_hi:[0,1]
v_pk_add_f32 v[208:209],v[12:13],v[108:109]
v_pk_add_f32 v[210:211],v[14:15],v[110:111]
v_pk_add_f32 v[108:109],v[12:13],v[108:109] neg_lo:[0,1] neg_hi:[0,1]
v_pk_add_f32 v[110:111],v[14:15],v[110:111] neg_lo:[0,1] neg_hi:[0,1]
v_pk_add_f32 v[12:13],v[212:213],v[208:209]
v_pk_add_f32 v[14:15],v[214:215],v[210:211]
v_pk_fma_f32 v[212:213],v[208:209],4.0,v[212:213] op_sel_hi:[1,0,1]
v_pk_fma_f32 v[214:215],v[210:211],4.0,v[214:215] op_sel_hi:[1,0,1]
v_pk_fma_f32 v[208:209],v[108:109],2.0,v[204:205] op_sel_hi:[1,0,1]
v_pk_fma_f32 v[210:211],v[110:111],2.0,v[206:207] op_sel_hi:[1,0,1]
v_pk_fma_f32 v[108:109],v[108:109],s[40:41],v[204:205] op_sel_hi:[1,0,1]
v_pk_fma_f32 v[110:111],v[110:111],s[40:41],v[206:207] op_sel_hi:[1,0,1]
M v[52:55],a[232:235],a[196:199],v[52:55]
s_waitcnt lgkmcnt(2)
buffer_load_dwordx4 a[108:111],v247,s[20:23],s46 offen offset:2048 sc1
M v[56:59],a[232:235],a[200:203],v[56:59]
s_waitcnt lgkmcnt(1)
s_add_u32 s46,s77,0
v_cvt_pk_bf16_f32 v208,v208,v209
v_cvt_pk_bf16_f32 v209,v210,v211
M v[60:63],a[232:235],a[204:207],v[60:63]
s_waitcnt vmcnt(16)
buffer_load_dwordx4 a[232:235],v247,s[20:23],s46 offen offset:0 sc1
M v[64:67],a[96:99],a[208:211],v[64:67]
ds_read_b128 a[208:211],v246 offset:19456
v_cvt_pk_bf16_f32 v212,v212,v213
M v[68:71],a[96:99],a[212:215],v[68:71]
v_cvt_pk_bf16_f32 v213,v214,v215
M v[72:75],a[96:99],a[216:219],v[72:75]
ds_write2st64_b64 v249,v[208:209],v[212:213] offset0:93 offset1:97
M v[76:79],a[96:99],a[220:223],v[76:79]
v_accvgpr_read_b32 v234,a16
v_accvgpr_read_b32 v228,a112
M v[80:83],a[96:99],a[192:195],v[80:83]
v_add_f32 v230,v234,v228
v_sub_f32 v234,v234,v228
M v[84:87],a[96:99],a[196:199],v[84:87]
v_add_f32 v228,v16,v112
v_sub_f32 v112,v16,v112
M v[88:91],a[96:99],a[200:203],v[88:91]
s_waitcnt lgkmcnt(0)
s_barrier
ds_read_b128 a[8:11],v247 offset:43520
M v[92:95],a[96:99],a[204:207],v[92:95]
s_waitcnt vmcnt(16)
ds_read_b128 a[12:15],v247 offset:47616
v_add_f32 v16,v230,v228
M v[32:35],a[236:239],a[212:215],v[32:35]
buffer_load_dwordx4 a[96:99],v247,s[20:23],s46 offen offset:1024 sc1
M v[36:39],a[236:239],a[216:219],v[36:39]
v_fmac_f32 v230,4.0,v228
v_fma_f32 v228,2.0,v112,v234
M v[40:43],a[236:239],a[220:223],v[40:43]
v_fma_f32 v112,s40,v112,v234
v_accvgpr_read_b32 v234,a17
M v[44:47],a[236:239],a[192:195],v[44:47]
s_waitcnt lgkmcnt(1)
s_add_u32 s34,s32,6684672
buffer_store_dwordx4 a[8:11],v248,s[24:27],s34 offen offset:384 nt
M v[48:51],a[236:239],a[196:199],v[48:51]
v_accvgpr_read_b32 v233,a113
v_add_f32 v232,v234,v233
M v[52:55],a[236:239],a[200:203],v[52:55]
v_sub_f32 v234,v234,v233
v_add_f32 v233,v17,v113
M v[56:59],a[236:239],a[204:207],v[56:59]
v_sub_f32 v113,v17,v113
v_add_f32 v17,v232,v233
M v[60:63],a[236:239],a[208:211],v[60:63]
s_waitcnt vmcnt(17)
buffer_load_dwordx4 a[236:239],v247,s[20:23],s46 offen offset:2048 sc1
M v[64:67],a[240:243],a[212:215],v[64:67]
s_add_u32 s34,s32,6881280
ds_read_b128 a[212:215],v245 offset:19456
v_fmac_f32 v232,4.0,v233
M v[68:71],a[240:243],a[216:219],v[68:71]
s_waitcnt lgkmcnt(1)
s_add_u32 s46,s78,0
buffer_store_dwordx4 a[12:15],v248,s[24:27],s34 offen offset:384 nt
M v[72:75],a[240:243],a[220:223],v[72:75]
v_fma_f32 v233,2.0,v113,v234
v_fma_f32 v113,s40,v113,v234
M v[76:79],a[240:243],a[192:195],v[76:79]
v_cvt_pk_bf16_f32 v228,v228,v233
v_cvt_pk_bf16_f32 v230,v230,v232
M v[80:83],a[240:243],a[196:199],v[80:83]
v_accvgpr_read_b32 v234,a18
v_accvgpr_read_b32 v229,a114
M v[84:87],a[240:243],a[200:203],v[84:87]
v_add_f32 v231,v234,v229
v_sub_f32 v234,v234,v229
M v[88:91],a[240:243],a[204:207],v[88:91]
v_add_f32 v229,v18,v114
v_sub_f32 v114,v18,v114
M v[92:95],a[240:243],a[208:211],v[92:95]
s_waitcnt vmcnt(18)
buffer_load_dwordx4 a[240:243],v247,s[20:23],s46 offen offset:0 sc1
M v[32:35],a[244:247],a[216:219],v[32:35]
v_add_f32 v18,v231,v229
v_fmac_f32 v231,4.0,v229
M v[36:39],a[244:247],a[220:223],v[36:39]
v_fma_f32 v229,2.0,v114,v234
v_fma_f32 v114,s40,v114,v234
M v[40:43],a[244:247],a[192:195],v[40:43]
v_accvgpr_read_b32 v234,a19
v_accvgpr_read_b32 v233,a115
M v[44:47],a[244:247],a[196:199],v[44:47]
buffer_load_dwordx4 a[112:115],v247,s[20:23],s46 offen offset:1024 sc1
M v[48:51],a[244:247],a[200:203],v[48:51]
v_add_f32 v232,v234,v233
v_sub_f32 v234,v234,v233
M v[52:55],a[244:247],a[204:207],v[52:55]
v_add_f32 v233,v19,v115
v_sub_f32 v115,v19,v115
M v[56:59],a[244:247],a[208:211],v[56:59]
s_waitcnt lgkmcnt(0)
v_add_f32 v19,v232,v233
v_fmac_f32 v232,4.0,v233
M v[60:63],a[244:247],a[212:215],v[60:63]
s_waitcnt vmcnt(19)
buffer_load_dwordx4 a[244:247],v247,s[20:23],s46 offen offset:2048 sc1
M v[64:67],a[248:251],a[216:219],v[64:67]
ds_read_b128 a[216:219],v245 offset:26112
v_fma_f32 v233,2.0,v115,v234
M v[68:71],a[248:251],a[220:223],v[68:71]
s_add_u32 s46,s79,0
ds_read_b128 a[220:223],v246 offset:26112
v_fma_f32 v115,s40,v115,v234
M v[72:75],a[248:251],a[192:195],v[72:75]
ds_read_b128 a[192:195],v245 offset:26624
v_cvt_pk_bf16_f32 v229,v229,v233
M v[76:79],a[248:251],a[196:199],v[76:79]
ds_read_b128 a[196:199],v246 offset:26624
v_cvt_pk_bf16_f32 v231,v231,v232
M v[80:83],a[248:251],a[200:203],v[80:83]
ds_read_b128 a[200:203],v245 offset:27136
ds_write2st64_b64 v249,v[228:229],v[230:231] offset0:68 offset1:72
M v[84:87],a[248:251],a[204:207],v[84:87]
ds_read_b128 a[204:207],v246 offset:27136
v_accvgpr_read_b32 v234,a20
M v[88:91],a[248:251],a[208:211],v[88:91]
ds_read_b128 a[208:211],v245 offset:27648
v_accvgpr_read_b32 v228,a116
M v[92:95],a[248:251],a[212:215],v[92:95]
s_waitcnt vmcnt(19) lgkmcnt(7)
buffer_load_dwordx4 a[248:251],v247,s[20:23],s46 offen offset:0 sc1
M v[128:131],a[100:103],a[216:219],v[128:131]
s_waitcnt lgkmcnt(6)
ds_read_b128 a[212:215],v246 offset:27648
v_add_f32 v230,v234,v228
M v[132:135],a[100:103],a[220:223],v[132:135]
s_waitcnt lgkmcnt(6)
v_sub_f32 v234,v234,v228
v_add_f32 v228,v20,v116
M v[136:139],a[100:103],a[192:195],v[136:139]
s_waitcnt lgkmcnt(5)
v_sub_f32 v116,v20,v116
v_add_f32 v20,v230,v228
M v[140:143],a[100:103],a[196:199],v[140:143]
s_waitcnt lgkmcnt(4)
v_fmac_f32 v230,4.0,v228
v_fma_f32 v228,2.0,v116,v234
M v[144:147],a[100:103],a[200:203],v[144:147]
s_waitcnt lgkmcnt(2)
v_fma_f32 v116,s40,v116,v234
v_accvgpr_read_b32 v234,a21
M v[148:151],a[100:103],a[204:207],v[148:151]
s_waitcnt lgkmcnt(1)
v_accvgpr_read_b32 v233,a117
v_add_f32 v232,v234,v233
M v[152:155],a[100:103],a[208:211],v[152:155]
s_waitcnt lgkmcnt(0)
v_sub_f32 v234,v234,v233
v_add_f32 v233,v21,v117
M v[156:159],a[100:103],a[212:215],v[156:159]
s_waitcnt vmcnt(18)
buffer_load_dwordx4 a[100:103],v247,s[20:23],s46 offen offset:1024 sc1
M v[160:163],a[252:255],a[216:219],v[160:163]
ds_read_b128 a[216:219],v246 offset:28160
v_sub_f32 v117,v21,v117
M v[164:167],a[252:255],a[220:223],v[164:167]
v_add_f32 v21,v232,v233
v_fmac_f32 v232,4.0,v233
M v[168:171],a[252:255],a[192:195],v[168:171]
v_fma_f32 v233,2.0,v117,v234
v_fma_f32 v117,s40,v117,v234
M v[172:175],a[252:255],a[196:199],v[172:175]
v_cvt_pk_bf16_f32 v228,v228,v233
v_cvt_pk_bf16_f32 v230,v230,v232
M v[176:179],a[252:255],a[200:203],v[176:179]
v_accvgpr_read_b32 v234,a22
v_accvgpr_read_b32 v229,a118
M v[180:183],a[252:255],a[204:207],v[180:183]
v_add_f32 v231,v234,v229
v_sub_f32 v234,v234,v229
M v[184:187],a[252:255],a[208:211],v[184:187]
v_add_f32 v229,v22,v118
v_sub_f32 v118,v22,v118
M v[188:191],a[252:255],a[212:215],v[188:191]
s_waitcnt vmcnt(18)
buffer_load_dwordx4 a[252:255],v247,s[20:23],s46 offen offset:2048 sc1
M v[128:131],a[224:227],a[220:223],v[128:131]
s_add_u32 s46,s80,0
v_add_f32 v22,v231,v229
v_fmac_f32 v231,4.0,v229
M v[132:135],a[224:227],a[192:195],v[132:135]
v_fma_f32 v229,2.0,v118,v234
v_fma_f32 v118,s40,v118,v234
M v[136:139],a[224:227],a[196:199],v[136:139]
v_accvgpr_read_b32 v234,a23
v_accvgpr_read_b32 v233,a119
M v[140:143],a[224:227],a[200:203],v[140:143]
buffer_load_dwordx4 a[116:119],v247,s[20:23],s46 offen offset:0 sc1
M v[144:147],a[224:227],a[204:207],v[144:147]
v_add_f32 v232,v234,v233
v_sub_f32 v234,v234,v233
M v[148:151],a[224:227],a[208:211],v[148:151]
v_add_f32 v233,v23,v119
v_sub_f32 v119,v23,v119
M v[152:155],a[224:227],a[212:215],v[152:155]
s_waitcnt lgkmcnt(0)
v_add_f32 v23,v232,v233
v_fmac_f32 v232,4.0,v233
M v[156:159],a[224:227],a[216:219],v[156:159]
s_waitcnt vmcnt(18)
buffer_load_dwordx4 a[224:227],v247,s[20:23],s46 offen offset:1024 sc1
M v[160:163],v[216:219],a[220:223],v[160:163]
ds_read_b128 a[220:223],v245 offset:28160
v_fma_f32 v233,2.0,v119,v234
M v[164:167],v[216:219],a[192:195],v[164:167]
v_fma_f32 v119,s40,v119,v234
v_cvt_pk_bf16_f32 v229,v229,v233
M v[168:171],v[216:219],a[196:199],v[168:171]
v_cvt_pk_bf16_f32 v231,v231,v232
M v[172:175],v[216:219],a[200:203],v[172:175]
ds_write2st64_b64 v249,v[228:229],v[230:231] offset0:76 offset1:80
M v[176:179],v[216:219],a[204:207],v[176:179]
v_accvgpr_read_b32 v234,a24
v_accvgpr_read_b32 v228,a120
M v[180:183],v[216:219],a[208:211],v[180:183]
v_add_f32 v230,v234,v228
v_sub_f32 v234,v234,v228
M v[184:187],v[216:219],a[212:215],v[184:187]
v_add_f32 v228,v24,v120
v_sub_f32 v120,v24,v120
M v[188:191],v[216:219],a[216:219],v[188:191]
s_waitcnt vmcnt(17) lgkmcnt(0)
s_barrier
ds_read_b128 a[16:19],v247 offset:34816
M v[128:131],v[220:223],a[192:195],v[128:131]
ds_read_b128 a[20:23],v247 offset:38912
v_add_f32 v24,v230,v228
M v[132:135],v[220:223],a[196:199],v[132:135]
buffer_load_dwordx4 v[216:219],v247,s[20:23],s46 offen offset:2048 sc1
M v[136:139],v[220:223],a[200:203],v[136:139]
s_add_u32 s46,s81,0
v_fmac_f32 v230,4.0,v228
v_fma_f32 v228,2.0,v120,v234
M v[140:143],v[220:223],a[204:207],v[140:143]
v_fma_f32 v120,s40,v120,v234
v_accvgpr_read_b32 v234,a25
M v[144:147],v[220:223],a[208:211],v[144:147]
s_waitcnt lgkmcnt(1)
s_add_u32 s34,s32,7077888
buffer_store_dwordx4 a[16:19],v248,s[24:27],s34 offen offset:384 nt
M v[148:151],v[220:223],a[212:215],v[148:151]
s_add_u32 s34,s32,7274496
v_accvgpr_read_b32 v233,a121
v_add_f32 v232,v234,v233
M v[152:155],v[220:223],a[216:219],v[152:155]
s_waitcnt lgkmcnt(0)
buffer_store_dwordx4 a[20:23],v248,s[24:27],s34 offen offset:384 nt
M v[156:159],v[220:223],a[220:223],v[156:159]
s_waitcnt vmcnt(19)
v_sub_f32 v234,v234,v233
v_add_f32 v233,v25,v121
M v[160:163],a[104:107],a[192:195],v[160:163]
ds_read_b128 a[192:195],v245 offset:52224
v_sub_f32 v121,v25,v121
M v[164:167],a[104:107],a[196:199],v[164:167]
buffer_load_dwordx4 v[220:223],v247,s[20:23],s46 offen offset:0 sc1
M v[168:171],a[104:107],a[200:203],v[168:171]
s_waitcnt lgkmcnt(0)
s_barrier
ds_read_b128 a[196:199],v246 offset:52224
v_add_f32 v25,v232,v233
M v[172:175],a[104:107],a[204:207],v[172:175]
ds_read_b128 a[200:203],v245 offset:52736
ds_read_b128 a[204:207],v246 offset:52736
v_fmac_f32 v232,4.0,v233
v_fma_f32 v233,2.0,v121,v234
v_fma_f32 v121,s40,v121,v234
v_cvt_pk_bf16_f32 v228,v228,v233
M v[176:179],a[104:107],a[208:211],v[176:179]
ds_read_b128 a[208:211],v245 offset:53248
v_cvt_pk_bf16_f32 v230,v230,v232
v_accvgpr_read_b32 v234,a26
v_accvgpr_read_b32 v229,a122
v_add_f32 v231,v234,v229
M v[180:183],a[104:107],a[212:215],v[180:183]
ds_read_b128 a[212:215],v246 offset:53248
v_sub_f32 v234,v234,v229
v_add_f32 v229,v26,v122
v_sub_f32 v122,v26,v122
v_add_f32 v26,v231,v229
M v[184:187],a[104:107],a[216:219],v[184:187]
ds_read_b128 a[216:219],v245 offset:53760
v_fmac_f32 v231,4.0,v229
v_fma_f32 v229,2.0,v122,v234
v_fma_f32 v122,s40,v122,v234
v_accvgpr_read_b32 v234,a27
M v[188:191],a[104:107],a[220:223],v[188:191]
s_waitcnt vmcnt(19)
buffer_load_dwordx4 a[104:107],v247,s[20:23],s46 offen offset:1024 sc1
v_accvgpr_read_b32 v233,a123
v_add_f32 v232,v234,v233
v_sub_f32 v234,v234,v233
v_add_f32 v233,v27,v123
M v[0:3],v[224:227],a[192:195],v[0:3]
s_waitcnt lgkmcnt(5)
buffer_load_dwordx4 a[120:123],v247,s[20:23],s46 offen offset:2048 sc1
v_sub_f32 v123,v27,v123
v_add_f32 v27,v232,v233
v_fmac_f32 v232,4.0,v233
v_fma_f32 v233,2.0,v123,v234
M v[4:7],v[224:227],a[196:199],v[4:7]
s_waitcnt lgkmcnt(4)
s_add_u32 s46,s76,46080
ds_read_b128 a[220:223],v246 offset:53760
ds_read_b128 a[192:195],v246 offset:54272
v_fma_f32 v123,s40,v123,v234
v_cvt_pk_bf16_f32 v229,v229,v233
v_cvt_pk_bf16_f32 v231,v231,v232
M v[8:11],v[224:227],a[200:203],v[8:11]
s_waitcnt lgkmcnt(5)
ds_write2st64_b64 v249,v[228:229],v[230:231] offset0:85 offset1:89
M v[12:15],v[224:227],a[204:207],v[12:15]
s_waitcnt lgkmcnt(5)
v_accvgpr_read_b32 v204,a28
v_accvgpr_read_b32 v208,a124
M v[16:19],v[224:227],a[208:211],v[16:19]
s_waitcnt lgkmcnt(4)
v_accvgpr_read_b32 v205,a29
v_accvgpr_read_b32 v209,a125
v_accvgpr_read_b32 v206,a30
v_accvgpr_read_b32 v210,a126
v_accvgpr_read_b32 v207,a31
v_accvgpr_read_b32 v211,a127
v_pk_add_f32 v[212:213],v[204:205],v[208:209]
v_pk_add_f32 v[214:215],v[206:207],v[210:211]
v_pk_add_f32 v[204:205],v[204:205],v[208:209] neg_lo:[0,1] neg_hi:[0,1]
v_pk_add_f32 v[206:207],v[206:207],v[210:211] neg_lo:[0,1] neg_hi:[0,1]
v_pk_add_f32 v[208:209],v[28:29],v[124:125]
v_pk_add_f32 v[210:211],v[30:31],v[126:127]
v_pk_add_f32 v[124:125],v[28:29],v[124:125] neg_lo:[0,1] neg_hi:[0,1]
v_pk_add_f32 v[126:127],v[30:31],v[126:127] neg_lo:[0,1] neg_hi:[0,1]
v_pk_add_f32 v[28:29],v[212:213],v[208:209]
v_pk_add_f32 v[30:31],v[214:215],v[210:211]
v_pk_fma_f32 v[212:213],v[208:209],4.0,v[212:213] op_sel_hi:[1,0,1]
v_pk_fma_f32 v[214:215],v[210:211],4.0,v[214:215] op_sel_hi:[1,0,1]
v_pk_fma_f32 v[208:209],v[124:125],2.0,v[204:205] op_sel_hi:[1,0,1]
v_pk_fma_f32 v[210:211],v[126:127],2.0,v[206:207] op_sel_hi:[1,0,1]
v_pk_fma_f32 v[124:125],v[124:125],s[40:41],v[204:205] op_sel_hi:[1,0,1]
v_pk_fma_f32 v[126:127],v[126:127],s[40:41],v[206:207] op_sel_hi:[1,0,1]
M v[20:23],v[224:227],a[212:215],v[20:23]
s_waitcnt lgkmcnt(3)
buffer_load_dwordx4 a[124:127],v247,s[20:23],s46 offen offset:0 sc1
M v[24:27],v[224:227],a[216:219],v[24:27]
s_waitcnt lgkmcnt(2)
s_add_u32 s47,s76,49152
v_cvt_pk_bf16_f32 v208,v208,v209
v_cvt_pk_bf16_f32 v209,v210,v211
M v[28:31],v[224:227],a[220:223],v[28:31]
s_waitcnt vmcnt(21)
buffer_load_dwordx4 v[224:227],v247,s[20:23],s47 offen offset:0 sc1
M v[0:3],a[228:231],a[196:199],v[0:3]
ds_read_b128 a[196:199],v245 offset:54272
v_cvt_pk_bf16_f32 v212,v212,v213
M v[4:7],a[228:231],a[200:203],v[4:7]
v_cvt_pk_bf16_f32 v213,v214,v215
M v[8:11],a[228:231],a[204:207],v[8:11]
ds_write2st64_b64 v249,v[208:209],v[212:213] offset0:93 offset1:97
M v[12:15],a[228:231],a[208:211],v[12:15]
v_accvgpr_read_b32 v234,a32
v_accvgpr_read_b32 v228,a128
M v[16:19],a[228:231],a[212:215],v[16:19]
v_add_f32 v230,v234,v228
v_sub_f32 v234,v234,v228
M v[20:23],a[228:231],a[216:219],v[20:23]
v_add_u32 v245,0x15400,v245
v_add_u32 v246,0x15400,v246
M v[24:27],a[228:231],a[220:223],v[24:27]
s_waitcnt lgkmcnt(3)
v_add_f32 v228,v32,v128
v_sub_f32 v128,v32,v128
M v[28:31],a[228:231],a[192:195],v[28:31]
s_waitcnt vmcnt(21) lgkmcnt(0)
s_barrier
ds_read_b128 a[24:27],v247 offset:43520
M v[0:3],a[108:111],a[200:203],v[0:3]
ds_read_b128 a[28:31],v247 offset:47616
ds_read_b128 a[200:203],v245 offset:0
M v[4:7],a[108:111],a[204:207],v[4:7]
buffer_load_dwordx4 a[228:231],v247,s[20:23],s46 offen offset:1024 sc1
M v[8:11],a[108:111],a[208:211],v[8:11]
ds_read_b128 a[204:207],v246 offset:0
ds_read_b128 a[208:211],v245 offset:512
M v[12:15],a[108:111],a[212:215],v[12:15]
ds_read_b128 a[212:215],v246 offset:512
v_add_f32 v32,v230,v228
M v[16:19],a[108:111],a[216:219],v[16:19]
s_waitcnt lgkmcnt(5)
s_add_u32 s34,s32,7471104
buffer_store_dwordx4 a[24:27],v248,s[24:27],s34 offen offset:384 nt
M v[20:23],a[108:111],a[220:223],v[20:23]
s_add_u32 s34,s32,7667712
ds_read_b128 a[216:219],v245 offset:1024
ds_read_b128 a[220:223],v246 offset:1024
M v[24:27],a[108:111],a[192:195],v[24:27]
s_waitcnt lgkmcnt(6)
buffer_store_dwordx4 a[28:31],v248,s[24:27],s34 offen offset:384 nt
M v[28:31],a[108:111],a[196:199],v[28:31]
s_waitcnt vmcnt(23) lgkmcnt(5)
ds_read_b128 a[192:195],v245 offset:1536
ds_read_b128 a[196:199],v246 offset:1536
M v[0:3],a[232:235],a[200:203],v[0:3]
s_waitcnt lgkmcnt(6)
ds_read_b128 a[200:203],v246 offset:2048
v_fmac_f32 v230,4.0,v228
M v[4:7],a[232:235],a[204:207],v[4:7]
s_waitcnt lgkmcnt(6)
buffer_load_dwordx4 a[108:111],v247,s[20:23],s47 offen offset:1024 sc1
M v[8:11],a[232:235],a[208:211],v[8:11]
s_waitcnt lgkmcnt(5)
v_fma_f32 v228,2.0,v128,v234
v_fma_f32 v128,s40,v128,v234
M v[12:15],a[232:235],a[212:215],v[12:15]
s_waitcnt lgkmcnt(4)
v_accvgpr_read_b32 v234,a33
v_accvgpr_read_b32 v233,a129
M v[16:19],a[232:235],a[216:219],v[16:19]
s_waitcnt lgkmcnt(3)
v_add_f32 v232,v234,v233
v_sub_f32 v234,v234,v233
M v[20:23],a[232:235],a[220:223],v[20:23]
s_waitcnt lgkmcnt(2)
v_add_f32 v233,v33,v129
v_sub_f32 v129,v33,v129
M v[24:27],a[232:235],a[192:195],v[24:27]
s_waitcnt lgkmcnt(1)
v_add_f32 v33,v232,v233
v_fmac_f32 v232,4.0,v233
M v[28:31],a[232:235],a[196:199],v[28:31]
s_waitcnt vmcnt(23)
buffer_load_dwordx4 a[232:235],v247,s[20:23],s46 offen offset:2048 sc1
M v[0:3],a[96:99],a[204:207],v[0:3]
ds_read_b128 a[204:207],v245 offset:2048
v_fma_f32 v233,2.0,v129,v234
M v[4:7],a[96:99],a[208:211],v[4:7]
v_fma_f32 v129,s40,v129,v234
v_cvt_pk_bf16_f32 v228,v228,v233
M v[8:11],a[96:99],a[212:215],v[8:11]
v_cvt_pk_bf16_f32 v230,v230,v232
v_accvgpr_read_b32 v234,a34
M v[12:15],a[96:99],a[216:219],v[12:15]
v_accvgpr_read_b32 v229,a130
v_add_f32 v231,v234,v229
M v[16:19],a[96:99],a[220:223],v[16:19]
v_sub_f32 v234,v234,v229
v_add_f32 v229,v34,v130
M v[20:23],a[96:99],a[192:195],v[20:23]
v_sub_f32 v130,v34,v130
v_add_f32 v34,v231,v229
M v[24:27],a[96:99],a[196:199],v[24:27]
s_waitcnt lgkmcnt(1)
v_fmac_f32 v231,4.0,v229
v_fma_f32 v229,2.0,v130,v234
M v[28:31],a[96:99],a[200:203],v[28:31]
s_waitcnt vmcnt(22)
buffer_load_dwordx4 a[96:99],v247,s[20:23],s47 offen offset:2048 sc1
M v[0:3],a[236:239],a[208:211],v[0:3]
s_add_u32 s46,s77,46080
ds_read_b128 a[208:211],v245 offset:17408
v_fma_f32 v130,s40,v130,v234
M v[4:7],a[236:239],a[212:215],v[4:7]
ds_read_b128 a[212:215],v246 offset:17408
v_accvgpr_read_b32 v234,a35
M v[8:11],a[236:239],a[216:219],v[8:11]
ds_read_b128 a[216:219],v245 offset:17920
v_accvgpr_read_b32 v233,a131
M v[12:15],a[236:239],a[220:223],v[12:15]
buffer_load_dwordx4 a[128:131],v247,s[20:23],s46 offen offset:0 sc1
M v[16:19],a[236:239],a[192:195],v[16:19]
s_add_u32 s47,s77,49152
ds_read_b128 a[220:223],v246 offset:17920
ds_read_b128 a[192:195],v245 offset:18432
M v[20:23],a[236:239],a[196:199],v[20:23]
ds_read_b128 a[196:199],v246 offset:18432
v_add_f32 v232,v234,v233
M v[24:27],a[236:239],a[200:203],v[24:27]
s_waitcnt lgkmcnt(6)
ds_read_b128 a[200:203],v245 offset:18944
v_sub_f32 v234,v234,v233
M v[28:31],a[236:239],a[204:207],v[28:31]
s_waitcnt vmcnt(22) lgkmcnt(6)
ds_read_b128 a[204:207],v246 offset:18944
v_add_f32 v233,v35,v131
M v[0:3],a[240:243],a[208:211],v[0:3]
s_waitcnt lgkmcnt(6)
ds_read_b128 a[208:211],v246 offset:19456
v_sub_f32 v131,v35,v131
M v[4:7],a[240:243],a[212:215],v[4:7]
s_waitcnt lgkmcnt(6)
v_add_f32 v35,v232,v233
v_fmac_f32 v232,4.0,v233
M v[8:11],a[240:243],a[216:219],v[8:11]
s_waitcnt lgkmcnt(5)
buffer_load_dwordx4 a[236:239],v247,s[20:23],s47 offen offset:0 sc1
M v[12:15],a[240:243],a[220:223],v[12:15]
s_waitcnt lgkmcnt(4)
v_fma_f32 v233,2.0,v131,v234
v_fma_f32 v131,s40,v131,v234
M v[16:19],a[240:243],a[192:195],v[16:19]
s_waitcnt lgkmcnt(3)
v_cvt_pk_bf16_f32 v229,v229,v233
v_cvt_pk_bf16_f32 v231,v231,v232
M v[20:23],a[240:243],a[196:199],v[20:23]
s_waitcnt lgkmcnt(2)
ds_write2st64_b64 v249,v[228:229],v[230:231] offset0:34 offset1:38
M v[24:27],a[240:243],a[200:203],v[24:27]
s_waitcnt lgkmcnt(2)
v_accvgpr_read_b32 v204,a36
v_accvgpr_read_b32 v208,a132
M v[28:31],a[240:243],a[204:207],v[28:31]
s_waitcnt vmcnt(22)
v_accvgpr_read_b32 v205,a37
v_accvgpr_read_b32 v209,a133
M v[0:3],a[112:115],a[212:215],v[0:3]
ds_read_b128 a[212:215],v245 offset:19456
v_accvgpr_read_b32 v206,a38
M v[4:7],a[112:115],a[216:219],v[4:7]
v_accvgpr_read_b32 v210,a134
v_accvgpr_read_b32 v207,a39
v_accvgpr_read_b32 v211,a135
v_pk_add_f32 v[212:213],v[204:205],v[208:209]
v_pk_add_f32 v[214:215],v[206:207],v[210:211]
v_pk_add_f32 v[204:205],v[204:205],v[208:209] neg_lo:[0,1] neg_hi:[0,1]
v_pk_add_f32 v[206:207],v[206:207],v[210:211] neg_lo:[0,1] neg_hi:[0,1]
v_pk_add_f32 v[208:209],v[36:37],v[132:133]
v_pk_add_f32 v[210:211],v[38:39],v[134:135]
v_pk_add_f32 v[132:133],v[36:37],v[132:133] neg_lo:[0,1] neg_hi:[0,1]
v_pk_add_f32 v[134:135],v[38:39],v[134:135] neg_lo:[0,1] neg_hi:[0,1]
v_pk_add_f32 v[36:37],v[212:213],v[208:209]
v_pk_add_f32 v[38:39],v[214:215],v[210:211]
v_pk_fma_f32 v[212:213],v[208:209],4.0,v[212:213] op_sel_hi:[1,0,1]
v_pk_fma_f32 v[214:215],v[210:211],4.0,v[214:215] op_sel_hi:[1,0,1]
v_pk_fma_f32 v[208:209],v[132:133],2.0,v[204:205] op_sel_hi:[1,0,1]
v_pk_fma_f32 v[210:211],v[134:135],2.0,v[206:207] op_sel_hi:[1,0,1]
v_pk_fma_f32 v[132:133],v[132:133],s[40:41],v[204:205] op_sel_hi:[1,0,1]
v_pk_fma_f32 v[134:135],v[134:135],s[40:41],v[206:207] op_sel_hi:[1,0,1]
M v[8:11],a[112:115],a[220:223],v[8:11]
buffer_load_dwordx4 a[240:243],v247,s[20:23],s46 offen offset:1024 sc1
M v[12:15],a[112:115],a[192:195],v[12:15]
v_cvt_pk_bf16_f32 v208,v208,v209
v_cvt_pk_bf16_f32 v209,v210,v211
M v[16:19],a[112:115],a[196:199],v[16:19]
v_cvt_pk_bf16_f32 v212,v212,v213
v_cvt_pk_bf16_f32 v213,v214,v215
M v[20:23],a[112:115],a[200:203],v[20:23]
ds_write2st64_b64 v249,v[208:209],v[212:213] offset0:42 offset1:46
M v[24:27],a[112:115],a[204:207],v[24:27]
s_waitcnt lgkmcnt(3)
v_accvgpr_read_b32 v204,a40
v_accvgpr_read_b32 v208,a136
M v[28:31],a[112:115],a[208:211],v[28:31]
s_waitcnt vmcnt(22)
v_accvgpr_read_b32 v205,a41
v_accvgpr_read_b32 v209,a137
M v[0:3],a[244:247],a[216:219],v[0:3]
ds_read_b128 a[216:219],v245 offset:34816
v_accvgpr_read_b32 v206,a42
M v[4:7],a[244:247],a[220:223],v[4:7]
ds_read_b128 a[220:223],v246 offset:34816
v_accvgpr_read_b32 v210,a138
v_accvgpr_read_b32 v207,a43
v_accvgpr_read_b32 v211,a139
v_pk_add_f32 v[212:213],v[204:205],v[208:209]
v_pk_add_f32 v[214:215],v[206:207],v[210:211]
v_pk_add_f32 v[204:205],v[204:205],v[208:209] neg_lo:[0,1] neg_hi:[0,1]
v_pk_add_f32 v[206:207],v[206:207],v[210:211] neg_lo:[0,1] neg_hi:[0,1]
v_pk_add_f32 v[208:209],v[40:41],v[136:137]
v_pk_add_f32 v[210:211],v[42:43],v[138:139]
v_pk_add_f32 v[136:137],v[40:41],v[136:137] neg_lo:[0,1] neg_hi:[0,1]
v_pk_add_f32 v[138:139],v[42:43],v[138:139] neg_lo:[0,1] neg_hi:[0,1]
v_pk_add_f32 v[40:41],v[212:213],v[208:209]
v_pk_add_f32 v[42:43],v[214:215],v[210:211]
v_pk_fma_f32 v[212:213],v[208:209],4.0,v[212:213] op_sel_hi:[1,0,1]
v_pk_fma_f32 v[214:215],v[210:211],4.0,v[214:215] op_sel_hi:[1,0,1]
v_pk_fma_f32 v[208:209],v[136:137],2.0,v[204:205] op_sel_hi:[1,0,1]
v_pk_fma_f32 v[210:211],v[138:139],2.0,v[206:207] op_sel_hi:[1,0,1]
v_pk_fma_f32 v[136:137],v[136:137],s[40:41],v[204:205] op_sel_hi:[1,0,1]
v_pk_fma_f32 v[138:139],v[138:139],s[40:41],v[206:207] op_sel_hi:[1,0,1]
M v[8:11],a[244:247],a[192:195],v[8:11]
buffer_load_dwordx4 a[132:135],v247,s[20:23],s47 offen offset:1024 sc1
M v[12:15],a[244:247],a[196:199],v[12:15]
ds_read_b128 a[192:195],v245 offset:35328
ds_read_b128 a[196:199],v246 offset:35328
M v[16:19],a[244:247],a[200:203],v[16:19]
ds_read_b128 a[200:203],v245 offset:35840
v_cvt_pk_bf16_f32 v208,v208,v209
M v[20:23],a[244:247],a[204:207],v[20:23]
ds_read_b128 a[204:207],v246 offset:35840
v_cvt_pk_bf16_f32 v209,v210,v211
M v[24:27],a[244:247],a[208:211],v[24:27]
s_waitcnt lgkmcnt(7)
ds_read_b128 a[208:211],v245 offset:36352
v_cvt_pk_bf16_f32 v212,v212,v213
M v[28:31],a[244:247],a[212:215],v[28:31]
s_waitcnt vmcnt(22) lgkmcnt(6)
ds_read_b128 a[212:215],v246 offset:36352
v_cvt_pk_bf16_f32 v213,v214,v215
M v[0:3],a[248:251],a[216:219],v[0:3]
s_waitcnt lgkmcnt(6)
ds_read_b128 a[216:219],v246 offset:36864
ds_write2st64_b64 v249,v[208:209],v[212:213] offset0:51 offset1:55
M v[4:7],a[248:251],a[220:223],v[4:7]
s_waitcnt lgkmcnt(7)
v_accvgpr_read_b32 v204,a44
v_accvgpr_read_b32 v208,a140
M v[8:11],a[248:251],a[192:195],v[8:11]
s_waitcnt lgkmcnt(6)
buffer_load_dwordx4 a[112:115],v247,s[20:23],s46 offen offset:2048 sc1
M v[12:15],a[248:251],a[196:199],v[12:15]
s_waitcnt lgkmcnt(5)
v_accvgpr_read_b32 v205,a45
v_accvgpr_read_b32 v209,a141
M v[16:19],a[248:251],a[200:203],v[16:19]
s_waitcnt lgkmcnt(4)
v_accvgpr_read_b32 v206,a46
v_accvgpr_read_b32 v210,a142
v_accvgpr_read_b32 v207,a47
v_accvgpr_read_b32 v211,a143
v_pk_add_f32 v[212:213],v[204:205],v[208:209]
v_pk_add_f32 v[214:215],v[206:207],v[210:211]
v_pk_add_f32 v[204:205],v[204:205],v[208:209] neg_lo:[0,1] neg_hi:[0,1]
v_pk_add_f32 v[206:207],v[206:207],v[210:211] neg_lo:[0,1] neg_hi:[0,1]
v_pk_add_f32 v[208:209],v[44:45],v[140:141]
v_pk_add_f32 v[210:211],v[46:47],v[142:143]
v_pk_add_f32 v[140:141],v[44:45],v[140:141] neg_lo:[0,1] neg_hi:[0,1]
v_pk_add_f32 v[142:143],v[46:47],v[142:143] neg_lo:[0,1] neg_hi:[0,1]
v_pk_add_f32 v[44:45],v[212:213],v[208:209]
v_pk_add_f32 v[46:47],v[214:215],v[210:211]
v_pk_fma_f32 v[212:213],v[208:209],4.0,v[212:213] op_sel_hi:[1,0,1]
v_pk_fma_f32 v[214:215],v[210:211],4.0,v[214:215] op_sel_hi:[1,0,1]
v_pk_fma_f32 v[208:209],v[140:141],2.0,v[204:205] op_sel_hi:[1,0,1]
v_pk_fma_f32 v[210:211],v[142:143],2.0,v[206:207] op_sel_hi:[1,0,1]
v_pk_fma_f32 v[140:141],v[140:141],s[40:41],v[204:205] op_sel_hi:[1,0,1]
v_pk_fma_f32 v[142:143],v[142:143],s[40:41],v[206:207] op_sel_hi:[1,0,1]
M v[20:23],a[248:251],a[204:207],v[20:23]
s_waitcnt lgkmcnt(3)
v_cvt_pk_bf16_f32 v208,v208,v209
v_cvt_pk_bf16_f32 v209,v210,v211
M v[24:27],a[248:251],a[208:211],v[24:27]
s_waitcnt lgkmcnt(2)
v_cvt_pk_bf16_f32 v212,v212,v213
v_cvt_pk_bf16_f32 v213,v214,v215
M v[28:31],a[248:251],a[212:215],v[28:31]
s_waitcnt vmcnt(22)
ds_write2st64_b64 v249,v[208:209],v[212:213] offset0:59 offset1:63
M v[0:3],a[100:103],a[220:223],v[0:3]
ds_read_b128 a[220:223],v245 offset:36864
v_accvgpr_read_b32 v234,a48
M v[4:7],a[100:103],a[192:195],v[4:7]
v_accvgpr_read_b32 v228,a144
v_add_f32 v230,v234,v228
M v[8:11],a[100:103],a[196:199],v[8:11]
buffer_load_dwordx4 a[136:139],v247,s[20:23],s47 offen offset:2048 sc1
M v[12:15],a[100:103],a[200:203],v[12:15]
v_sub_f32 v234,v234,v228
v_add_f32 v228,v48,v144
M v[16:19],a[100:103],a[204:207],v[16:19]
s_add_u32 s46,s78,46080
v_sub_f32 v144,v48,v144
M v[20:23],a[100:103],a[208:211],v[20:23]
s_waitcnt lgkmcnt(1)
s_barrier
ds_read_b128 a[32:35],v247 offset:17408
M v[24:27],a[100:103],a[212:215],v[24:27]
ds_read_b128 a[36:39],v247 offset:21504
ds_read_b128 a[40:43],v247 offset:26112
M v[28:31],a[100:103],a[216:219],v[28:31]
s_waitcnt vmcnt(22)
ds_read_b128 a[44:47],v247 offset:30208
v_add_f32 v48,v230,v228
M v[0:3],a[252:255],a[192:195],v[0:3]
ds_read_b128 a[192:195],v245 offset:52224
v_fmac_f32 v230,4.0,v228
M v[4:7],a[252:255],a[196:199],v[4:7]
ds_read_b128 a[196:199],v246 offset:52224
v_fma_f32 v228,2.0,v144,v234
M v[8:11],a[252:255],a[200:203],v[8:11]
s_waitcnt lgkmcnt(5)
s_add_u32 s34,s32,6291456
buffer_store_dwordx4 a[32:35],v248,s[24:27],s34 offen offset:512 nt
M v[12:15],a[252:255],a[204:207],v[12:15]
s_waitcnt lgkmcnt(4)
s_add_u32 s34,s32,6488064
buffer_store_dwordx4 a[36:39],v248,s[24:27],s34 offen offset:512 nt
M v[16:19],a[252:255],a[208:211],v[16:19]
s_add_u32 s34,s32,6684672
ds_read_b128 a[200:203],v245 offset:52736
ds_read_b128 a[204:207],v246 offset:52736
M v[20:23],a[252:255],a[212:215],v[20:23]
ds_read_b128 a[208:211],v245 offset:53248
ds_read_b128 a[212:215],v246 offset:53248
M v[24:27],a[252:255],a[216:219],v[24:27]
s_waitcnt lgkmcnt(7)
buffer_store_dwordx4 a[40:43],v248,s[24:27],s34 offen offset:512 nt
M v[28:31],a[252:255],a[220:223],v[28:31]
s_waitcnt vmcnt(24) lgkmcnt(5)
ds_read_b128 a[216:219],v245 offset:53760
ds_read_b128 a[220:223],v246 offset:53760
M v[0:3],a[116:119],a[192:195],v[0:3]
s_waitcnt lgkmcnt(6)
ds_read_b128 a[192:195],v246 offset:54272
v_fma_f32 v144,s40,v144,v234
M v[4:7],a[116:119],a[196:199],v[4:7]
s_waitcnt lgkmcnt(6)
buffer_load_dwordx4 a[244:247],v247,s[20:23],s46 offen offset:0 sc1
M v[8:11],a[116:119],a[200:203],v[8:11]
s_waitcnt lgkmcnt(5)
s_add_u32 s47,s78,49152
v_accvgpr_read_b32 v234,a49
v_accvgpr_read_b32 v233,a145
M v[12:15],a[116:119],a[204:207],v[12:15]
s_waitcnt lgkmcnt(4)
v_add_f32 v232,v234,v233
v_sub_f32 v234,v234,v233
M v[16:19],a[116:119],a[208:211],v[16:19]
s_waitcnt lgkmcnt(3)
v_add_f32 v233,v49,v145
v_sub_f32 v145,v49,v145
M v[20:23],a[116:119],a[212:215],v[20:23]
s_waitcnt lgkmcnt(2)
buffer_load_dwordx4 a[140:143],v247,s[20:23],s47 offen offset:0 sc1
M v[24:27],a[116:119],a[216:219],v[24:27]
s_waitcnt lgkmcnt(1)
v_add_f32 v49,v232,v233
v_fmac_f32 v232,4.0,v233
M v[28:31],a[116:119],a[220:223],v[28:31]
s_waitcnt vmcnt(25)
v_fma_f32 v233,2.0,v145,v234
v_fma_f32 v145,s40,v145,v234
M v[0:3],a[224:227],a[196:199],v[0:3]
ds_read_b128 a[196:199],v245 offset:54272
v_cvt_pk_bf16_f32 v228,v228,v233
M v[4:7],a[224:227],a[200:203],v[4:7]
s_add_u32 s34,s32,6881280
buffer_store_dwordx4 a[44:47],v248,s[24:27],s34 offen offset:512 nt
M v[8:11],a[224:227],a[204:207],v[8:11]
v_cvt_pk_bf16_f32 v230,v230,v232
v_accvgpr_read_b32 v234,a50
M v[12:15],a[224:227],a[208:211],v[12:15]
v_accvgpr_read_b32 v229,a146
v_add_f32 v231,v234,v229
M v[16:19],a[224:227],a[212:215],v[16:19]
buffer_load_dwordx4 a[248:251],v247,s[20:23],s46 offen offset:1024 sc1
M v[20:23],a[224:227],a[216:219],v[20:23]
v_add_u32 v245,0xffff9a00,v245
v_add_u32 v246,0xffff9a00,v246
M v[24:27],a[224:227],a[220:223],v[24:27]
s_waitcnt lgkmcnt(1)
v_sub_f32 v234,v234,v229
v_add_f32 v229,v50,v146
M v[28:31],a[224:227],a[192:195],v[28:31]
s_waitcnt vmcnt(26)
v_sub_f32 v146,v50,v146
v_add_f32 v50,v231,v229
M v[0:3],v[216:219],a[200:203],v[0:3]
ds_read_b128 a[200:203],v245 offset:8704
v_fmac_f32 v231,4.0,v229
M v[4:7],v[216:219],a[204:207],v[4:7]
ds_read_b128 a[204:207],v246 offset:8704
v_fma_f32 v229,2.0,v146,v234
M v[8:11],v[216:219],a[208:211],v[8:11]
buffer_load_dwordx4 a[100:103],v247,s[20:23],s47 offen offset:1024 sc1
M v[12:15],v[216:219],a[212:215],v[12:15]
ds_read_b128 a[208:211],v245 offset:9216
ds_read_b128 a[212:215],v246 offset:9216
M v[16:19],v[216:219],a[216:219],v[16:19]
ds_read_b128 a[216:219],v245 offset:9728
v_fma_f32 v146,s40,v146,v234
M v[20:23],v[216:219],a[220:223],v[20:23]
ds_read_b128 a[220:223],v246 offset:9728
v_accvgpr_read_b32 v234,a51
M v[24:27],v[216:219],a[192:195],v[24:27]
s_waitcnt lgkmcnt(6)
ds_read_b128 a[192:195],v245 offset:10240
v_accvgpr_read_b32 v233,a147
M v[28:31],v[216:219],a[196:199],v[28:31]
s_waitcnt vmcnt(24) lgkmcnt(6)
ds_read_b128 a[196:199],v246 offset:10240
v_add_f32 v232,v234,v233
M v[0:3],v[220:223],a[200:203],v[0:3]
s_waitcnt lgkmcnt(6)
ds_read_b128 a[200:203],v246 offset:10752
v_sub_f32 v234,v234,v233
M v[4:7],v[220:223],a[204:207],v[4:7]
s_waitcnt lgkmcnt(6)
v_add_f32 v233,v51,v147
v_sub_f32 v147,v51,v147
M v[8:11],v[220:223],a[208:211],v[8:11]
s_waitcnt lgkmcnt(5)
buffer_load_dwordx4 a[252:255],v247,s[20:23],s46 offen offset:2048 sc1
M v[12:15],v[220:223],a[212:215],v[12:15]
s_waitcnt lgkmcnt(4)
v_add_f32 v51,v232,v233
v_fmac_f32 v232,4.0,v233
M v[16:19],v[220:223],a[216:219],v[16:19]
s_waitcnt lgkmcnt(3)
v_fma_f32 v233,2.0,v147,v234
v_fma_f32 v147,s40,v147,v234
M v[20:23],v[220:223],a[220:223],v[20:23]
s_waitcnt lgkmcnt(2)
v_cvt_pk_bf16_f32 v229,v229,v233
v_cvt_pk_bf16_f32 v231,v231,v232
M v[24:27],v[220:223],a[192:195],v[24:27]
s_waitcnt lgkmcnt(1)
ds_write2st64_b64 v249,v[228:229],v[230:231] offset0:17 offset1:21
M v[28:31],v[220:223],a[196:199],v[28:31]
s_waitcnt vmcnt(24)
v_accvgpr_read_b32 v204,a52
v_accvgpr_read_b32 v208,a148
M v[0:3],a[104:107],a[204:207],v[0:3]
ds_read_b128 a[204:207],v245 offset:10752
v_accvgpr_read_b32 v205,a53
M v[4:7],a[104:107],a[208:211],v[4:7]
v_accvgpr_read_b32 v209,a149
v_accvgpr_read_b32 v206,a54
M v[8:11],a[104:107],a[212:215],v[8:11]
buffer_load_dwordx4 a[116:119],v247,s[20:23],s47 offen offset:2048 sc1
M v[12:15],a[104:107],a[216:219],v[12:15]
v_accvgpr_read_b32 v210,a150
v_accvgpr_read_b32 v207,a55
v_accvgpr_read_b32 v211,a151
v_pk_add_f32 v[212:213],v[204:205],v[208:209]
v_pk_add_f32 v[214:215],v[206:207],v[210:211]
v_pk_add_f32 v[204:205],v[204:205],v[208:209] neg_lo:[0,1] neg_hi:[0,1]
v_pk_add_f32 v[206:207],v[206:207],v[210:211] neg_lo:[0,1] neg_hi:[0,1]
v_pk_add_f32 v[208:209],v[52:53],v[148:149]
v_pk_add_f32 v[210:211],v[54:55],v[150:151]
v_pk_add_f32 v[148:149],v[52:53],v[148:149] neg_lo:[0,1] neg_hi:[0,1]
v_pk_add_f32 v[150:151],v[54:55],v[150:151] neg_lo:[0,1] neg_hi:[0,1]
v_pk_add_f32 v[52:53],v[212:213],v[208:209]
v_pk_add_f32 v[54:55],v[214:215],v[210:211]
v_pk_fma_f32 v[212:213],v[208:209],4.0,v[212:213] op_sel_hi:[1,0,1]
v_pk_fma_f32 v[214:215],v[210:211],4.0,v[214:215] op_sel_hi:[1,0,1]
v_pk_fma_f32 v[208:209],v[148:149],2.0,v[204:205] op_sel_hi:[1,0,1]
v_pk_fma_f32 v[210:211],v[150:151],2.0,v[206:207] op_sel_hi:[1,0,1]
v_pk_fma_f32 v[148:149],v[148:149],s[40:41],v[204:205] op_sel_hi:[1,0,1]
v_pk_fma_f32 v[150:151],v[150:151],s[40:41],v[206:207] op_sel_hi:[1,0,1]
M v[16:19],a[104:107],a[220:223],v[16:19]
s_add_u32 s46,s79,46080
v_cvt_pk_bf16_f32 v208,v208,v209
v_cvt_pk_bf16_f32 v209,v210,v211
M v[20:23],a[104:107],a[192:195],v[20:23]
v_cvt_pk_bf16_f32 v212,v212,v213
v_cvt_pk_bf16_f32 v213,v214,v215
M v[24:27],a[104:107],a[196:199],v[24:27]
s_waitcnt lgkmcnt(2)
ds_write2st64_b64 v249,v[208:209],v[212:213] offset0:25 offset1:29
M v[28:31],a[104:107],a[200:203],v[28:31]
s_waitcnt vmcnt(24)
v_accvgpr_read_b32 v204,a56
v_accvgpr_read_b32 v208,a152
M v[0:3],a[120:123],a[208:211],v[0:3]
ds_read_b128 a[208:211],v245 offset:0
v_accvgpr_read_b32 v205,a57
M v[4:7],a[120:123],a[212:215],v[4:7]
ds_read_b128 a[212:215],v246 offset:0
v_accvgpr_read_b32 v209,a153
M v[8:11],a[120:123],a[216:219],v[8:11]
buffer_load_dwordx4 a[224:227],v247,s[20:23],s46 offen offset:0 sc1
M v[12:15],a[120:123],a[220:223],v[12:15]
ds_read_b128 a[216:219],v245 offset:512
ds_read_b128 a[220:223],v246 offset:512
M v[16:19],a[120:123],a[192:195],v[16:19]
s_add_u32 s47,s79,49152
ds_read_b128 a[192:195],v245 offset:1024
v_accvgpr_read_b32 v206,a58
M v[20:23],a[120:123],a[196:199],v[20:23]
ds_read_b128 a[196:199],v246 offset:1024
v_accvgpr_read_b32 v210,a154
v_accvgpr_read_b32 v207,a59
v_accvgpr_read_b32 v211,a155
v_pk_add_f32 v[212:213],v[204:205],v[208:209]
v_pk_add_f32 v[214:215],v[206:207],v[210:211]
v_pk_add_f32 v[204:205],v[204:205],v[208:209] neg_lo:[0,1] neg_hi:[0,1]
v_pk_add_f32 v[206:207],v[206:207],v[210:211] neg_lo:[0,1] neg_hi:[0,1]
v_pk_add_f32 v[208:209],v[56:57],v[152:153]
v_pk_add_f32 v[210:211],v[58:59],v[154:155]
v_pk_add_f32 v[152:153],v[56:57],v[152:153] neg_lo:[0,1] neg_hi:[0,1]
v_pk_add_f32 v[154:155],v[58:59],v[154:155] neg_lo:[0,1] neg_hi:[0,1]
v_pk_add_f32 v[56:57],v[212:213],v[208:209]
v_pk_add_f32 v[58:59],v[214:215],v[210:211]
v_pk_fma_f32 v[212:213],v[208:209],4.0,v[212:213] op_sel_hi:[1,0,1]
v_pk_fma_f32 v[214:215],v[210:211],4.0,v[214:215] op_sel_hi:[1,0,1]
v_pk_fma_f32 v[208:209],v[152:153],2.0,v[204:205] op_sel_hi:[1,0,1]
v_pk_fma_f32 v[210:211],v[154:155],2.0,v[206:207] op_sel_hi:[1,0,1]
v_pk_fma_f32 v[152:153],v[152:153],s[40:41],v[204:205] op_sel_hi:[1,0,1]
v_pk_fma_f32 v[154:155],v[154:155],s[40:41],v[206:207] op_sel_hi:[1,0,1]
M v[24:27],a[120:123],a[200:203],v[24:27]
s_waitcnt lgkmcnt(7)
ds_read_b128 a[200:203],v245 offset:1536
v_cvt_pk_bf16_f32 v208,v208,v209
M v[28:31],a[120:123],a[204:207],v[28:31]
s_waitcnt vmcnt(24) lgkmcnt(6)
ds_read_b128 a[204:207],v246 offset:1536
v_cvt_pk_bf16_f32 v209,v210,v211
M v[96:99],a[124:127],a[208:211],v[96:99]
s_waitcnt lgkmcnt(6)
v_cvt_pk_bf16_f32 v212,v212,v213
v_cvt_pk_bf16_f32 v213,v214,v215
M v[100:103],a[124:127],a[212:215],v[100:103]
s_waitcnt lgkmcnt(5)
ds_write2st64_b64 v249,v[208:209],v[212:213] offset0:68 offset1:72
M v[104:107],a[124:127],a[216:219],v[104:107]
s_waitcnt lgkmcnt(5)
buffer_load_dwordx4 v[216:219],v247,s[20:23],s47 offen offset:0 sc1
M v[108:111],a[124:127],a[220:223],v[108:111]
s_waitcnt lgkmcnt(4)
v_accvgpr_read_b32 v204,a60
v_accvgpr_read_b32 v208,a156
M v[112:115],a[124:127],a[192:195],v[112:115]
s_waitcnt lgkmcnt(3)
global_load_dword v251,v252,s[82:83]
M v[116:119],a[124:127],a[196:199],v[116:119]
s_waitcnt lgkmcnt(2)
v_accvgpr_read_b32 v205,a61
v_accvgpr_read_b32 v209,a157
M v[120:123],a[124:127],a[200:203],v[120:123]
s_waitcnt lgkmcnt(1)
v_accvgpr_read_b32 v206,a62
v_accvgpr_read_b32 v210,a158
v_accvgpr_read_b32 v207,a63
v_accvgpr_read_b32 v211,a159
v_pk_add_f32 v[212:213],v[204:205],v[208:209]
v_pk_add_f32 v[214:215],v[206:207],v[210:211]
v_pk_add_f32 v[204:205],v[204:205],v[208:209] neg_lo:[0,1] neg_hi:[0,1]
v_pk_add_f32 v[206:207],v[206:207],v[210:211] neg_lo:[0,1] neg_hi:[0,1]
v_pk_add_f32 v[208:209],v[60:61],v[156:157]
v_pk_add_f32 v[210:211],v[62:63],v[158:159]
v_pk_add_f32 v[156:157],v[60:61],v[156:157] neg_lo:[0,1] neg_hi:[0,1]
v_pk_add_f32 v[158:159],v[62:63],v[158:159] neg_lo:[0,1] neg_hi:[0,1]
v_pk_add_f32 v[60:61],v[212:213],v[208:209]
v_pk_add_f32 v[62:63],v[214:215],v[210:211]
v_pk_fma_f32 v[212:213],v[208:209],4.0,v[212:213] op_sel_hi:[1,0,1]
v_pk_fma_f32 v[214:215],v[210:211],4.0,v[214:215] op_sel_hi:[1,0,1]
v_pk_fma_f32 v[208:209],v[156:157],2.0,v[204:205] op_sel_hi:[1,0,1]
v_pk_fma_f32 v[210:211],v[158:159],2.0,v[206:207] op_sel_hi:[1,0,1]
v_pk_fma_f32 v[156:157],v[156:157],s[40:41],v[204:205] op_sel_hi:[1,0,1]
v_pk_fma_f32 v[158:159],v[158:159],s[40:41],v[206:207] op_sel_hi:[1,0,1]
M v[124:127],a[124:127],a[204:207],v[124:127]
s_waitcnt vmcnt(25)
v_cvt_pk_bf16_f32 v208,v208,v209
v_cvt_pk_bf16_f32 v209,v210,v211
M v[128:131],v[224:227],a[208:211],v[128:131]
ds_read_b128 a[208:211],v246 offset:2048
v_cvt_pk_bf16_f32 v212,v212,v213
M v[132:135],v[224:227],a[212:215],v[132:135]
v_cvt_pk_bf16_f32 v213,v214,v215
M v[136:139],v[224:227],a[216:219],v[136:139]
buffer_load_dwordx4 a[144:147],v247,s[20:23],s46 offen offset:1024 sc1
M v[140:143],v[224:227],a[220:223],v[140:143]
ds_write2st64_b64 v249,v[208:209],v[212:213] offset0:76 offset1:80
M v[144:147],v[224:227],a[192:195],v[144:147]
v_cvt_pk_bf16_f32 v0,v0,v1
v_cvt_pk_bf16_f32 v1,v2,v3
M v[148:151],v[224:227],a[196:199],v[148:151]
v_cvt_pk_bf16_f32 v4,v4,v5
v_cvt_pk_bf16_f32 v5,v6,v7
M v[152:155],v[224:227],a[200:203],v[152:155]
s_waitcnt lgkmcnt(0)
s_barrier
ds_read_b128 a[48:51],v247 offset:8704
M v[156:159],v[224:227],a[204:207],v[156:159]
s_waitcnt vmcnt(25)
ds_read_b128 a[52:55],v247 offset:12800
ds_read_b128 a[56:59],v247 offset:34816
M v[96:99],a[228:231],a[212:215],v[96:99]
ds_read_b128 a[60:63],v247 offset:38912
ds_write2st64_b64 v249,v[0:1],v[4:5] offset0:34 offset1:38
M v[100:103],a[228:231],a[216:219],v[100:103]
v_cvt_pk_bf16_f32 v8,v8,v9
v_cvt_pk_bf16_f32 v9,v10,v11
M v[104:107],a[228:231],a[220:223],v[104:107]
buffer_load_dwordx4 v[220:223],v247,s[20:23],s47 offen offset:1024 sc1
M v[108:111],a[228:231],a[192:195],v[108:111]
s_add_u32 s34,s32,7077888
v_cvt_pk_bf16_f32 v12,v12,v13
v_cvt_pk_bf16_f32 v13,v14,v15
M v[112:115],a[228:231],a[196:199],v[112:115]
s_waitcnt lgkmcnt(4)
buffer_store_dwordx4 a[48:51],v248,s[24:27],s34 offen offset:512 nt
M v[116:119],a[228:231],a[200:203],v[116:119]
s_add_u32 s34,s32,7274496
ds_write2st64_b64 v249,v[8:9],v[12:13] offset0:42 offset1:46
M v[120:123],a[228:231],a[204:207],v[120:123]
v_cvt_pk_bf16_f32 v16,v16,v17
v_cvt_pk_bf16_f32 v17,v18,v19
M v[124:127],a[228:231],a[208:211],v[124:127]
s_waitcnt vmcnt(24) lgkmcnt(4)
buffer_store_dwordx4 a[52:55],v248,s[24:27],s34 offen offset:512 nt
M v[128:131],a[108:111],a[212:215],v[128:131]
ds_read_b128 a[212:215],v245 offset:2048
v_cvt_pk_bf16_f32 v20,v20,v21
M v[132:135],a[108:111],a[216:219],v[132:135]
v_cvt_pk_bf16_f32 v21,v22,v23
M v[136:139],a[108:111],a[220:223],v[136:139]
buffer_load_dwordx4 a[148:151],v247,s[20:23],s46 offen offset:2048 sc1
M v[140:143],a[108:111],a[192:195],v[140:143]
s_add_u32 s34,s32,7471104
ds_write2st64_b64 v249,v[16:17],v[20:21] offset0:51 offset1:55
M v[144:147],a[108:111],a[196:199],v[144:147]
v_cvt_pk_bf16_f32 v24,v24,v25
v_cvt_pk_bf16_f32 v25,v26,v27
M v[148:151],a[108:111],a[200:203],v[148:151]
s_waitcnt lgkmcnt(5)
buffer_store_dwordx4 a[56:59],v248,s[24:27],s34 offen offset:512 nt
M v[152:155],a[108:111],a[204:207],v[152:155]
v_cvt_pk_bf16_f32 v28,v28,v29
v_cvt_pk_bf16_f32 v29,v30,v31
M v[156:159],a[108:111],a[208:211],v[156:159]
s_waitcnt vmcnt(26)
ds_write2st64_b64 v249,v[24:25],v[28:29] offset0:59 offset1:63
M v[96:99],a[232:235],a[216:219],v[96:99]
v_accvgpr_read_b32 v234,a64
v_accvgpr_read_b32 v228,a160
M v[100:103],a[232:235],a[220:223],v[100:103]
v_add_f32 v230,v234,v228
v_sub_f32 v234,v234,v228
M v[104:107],a[232:235],a[192:195],v[104:107]
buffer_load_dwordx4 a[104:107],v247,s[20:23],s47 offen offset:2048 sc1
M v[108:111],a[232:235],a[196:199],v[108:111]
v_add_f32 v228,v64,v160
v_sub_f32 v160,v64,v160
M v[112:115],a[232:235],a[200:203],v[112:115]
s_add_u32 s46,s80,46080
v_add_f32 v64,v230,v228
v_fmac_f32 v230,4.0,v228
M v[116:119],a[232:235],a[204:207],v[116:119]
v_fma_f32 v228,2.0,v160,v234
v_fma_f32 v160,s40,v160,v234
M v[120:123],a[232:235],a[208:211],v[120:123]
s_waitcnt lgkmcnt(2)
v_accvgpr_read_b32 v234,a65
v_accvgpr_read_b32 v233,a161
M v[124:127],a[232:235],a[212:215],v[124:127]
s_waitcnt vmcnt(26)
v_add_f32 v232,v234,v233
v_sub_f32 v234,v234,v233
M v[128:131],a[96:99],a[216:219],v[128:131]
ds_read_b128 a[216:219],v245 offset:34816
v_add_f32 v233,v65,v161
M v[132:135],a[96:99],a[220:223],v[132:135]
ds_read_b128 a[220:223],v246 offset:34816
v_sub_f32 v161,v65,v161
M v[136:139],a[96:99],a[192:195],v[136:139]
buffer_load_dwordx4 a[152:155],v247,s[20:23],s46 offen offset:0 sc1
M v[140:143],a[96:99],a[196:199],v[140:143]
ds_read_b128 a[192:195],v245 offset:35328
ds_read_b128 a[196:199],v246 offset:35328
M v[144:147],a[96:99],a[200:203],v[144:147]
s_add_u32 s47,s80,49152
ds_read_b128 a[200:203],v245 offset:35840
v_add_f32 v65,v232,v233
M v[148:151],a[96:99],a[204:207],v[148:151]
ds_read_b128 a[204:207],v246 offset:35840
v_fmac_f32 v232,4.0,v233
M v[152:155],a[96:99],a[208:211],v[152:155]
ds_read_b128 a[208:211],v245 offset:36352
v_fma_f32 v233,2.0,v161,v234
M v[156:159],a[96:99],a[212:215],v[156:159]
s_waitcnt vmcnt(26) lgkmcnt(6)
ds_read_b128 a[212:215],v246 offset:36352
v_fma_f32 v161,s40,v161,v234
M v[96:99],a[128:131],a[216:219],v[96:99]
s_waitcnt lgkmcnt(6)
v_cvt_pk_bf16_f32 v228,v228,v233
v_cvt_pk_bf16_f32 v230,v230,v232
M v[100:103],a[128:131],a[220:223],v[100:103]
s_waitcnt lgkmcnt(5)
s_add_u32 s34,s32,7667712
buffer_store_dwordx4 a[60:63],v248,s[24:27],s34 offen offset:512 nt
M v[104:107],a[128:131],a[192:195],v[104:107]
s_waitcnt lgkmcnt(4)
buffer_load_dwordx4 a[120:123],v247,s[20:23],s47 offen offset:0 sc1
M v[108:111],a[128:131],a[196:199],v[108:111]
s_waitcnt lgkmcnt(3)
v_accvgpr_read_b32 v234,a66
v_accvgpr_read_b32 v229,a162
M v[112:115],a[128:131],a[200:203],v[112:115]
s_waitcnt lgkmcnt(2)
v_add_f32 v231,v234,v229
v_sub_f32 v234,v234,v229
M v[116:119],a[128:131],a[204:207],v[116:119]
s_waitcnt lgkmcnt(1)
v_add_f32 v229,v66,v162
v_sub_f32 v162,v66,v162
M v[120:123],a[128:131],a[208:211],v[120:123]
s_waitcnt lgkmcnt(0)
v_add_f32 v66,v231,v229
v_fmac_f32 v231,4.0,v229
M v[124:127],a[128:131],a[212:215],v[124:127]
s_waitcnt vmcnt(27)
v_fma_f32 v229,2.0,v162,v234
v_fma_f32 v162,s40,v162,v234
M v[128:131],a[236:239],a[216:219],v[128:131]
ds_read_b128 a[216:219],v246 offset:36864
v_accvgpr_read_b32 v234,a67
M v[132:135],a[236:239],a[220:223],v[132:135]
v_accvgpr_read_b32 v233,a163
v_add_f32 v232,v234,v233
M v[136:139],a[236:239],a[192:195],v[136:139]
buffer_load_dwordx4 a[124:127],v247,s[20:23],s46 offen offset:1024 sc1
M v[140:143],a[236:239],a[196:199],v[140:143]
v_sub_f32 v234,v234,v233
v_add_f32 v233,v67,v163
M v[144:147],a[236:239],a[200:203],v[144:147]
v_sub_f32 v163,v67,v163
v_add_f32 v67,v232,v233
M v[148:151],a[236:239],a[204:207],v[148:151]
v_fmac_f32 v232,4.0,v233
v_fma_f32 v233,2.0,v163,v234
M v[152:155],a[236:239],a[208:211],v[152:155]
v_fma_f32 v163,s40,v163,v234
v_cvt_pk_bf16_f32 v229,v229,v233
M v[156:159],a[236:239],a[212:215],v[156:159]
s_waitcnt vmcnt(27)
v_cvt_pk_bf16_f32 v231,v231,v232
M v[96:99],a[240:243],a[220:223],v[96:99]
ds_write2st64_b64 v249,v[228:229],v[230:231] offset0:0 offset1:4
M v[100:103],a[240:243],a[192:195],v[100:103]
v_accvgpr_read_b32 v234,a68
v_accvgpr_read_b32 v228,a164
M v[104:107],a[240:243],a[196:199],v[104:107]
buffer_load_dwordx4 a[156:159],v247,s[20:23],s47 offen offset:1024 sc1
M v[108:111],a[240:243],a[200:203],v[108:111]
v_add_f32 v230,v234,v228
v_sub_f32 v234,v234,v228
M v[112:115],a[240:243],a[204:207],v[112:115]
v_add_f32 v228,v68,v164
v_sub_f32 v164,v68,v164
M v[116:119],a[240:243],a[208:211],v[116:119]
v_add_f32 v68,v230,v228
v_fmac_f32 v230,4.0,v228
M v[120:123],a[240:243],a[212:215],v[120:123]
s_waitcnt lgkmcnt(1)
v_fma_f32 v228,2.0,v164,v234
v_fma_f32 v164,s40,v164,v234
M v[124:127],a[240:243],a[216:219],v[124:127]
s_waitcnt vmcnt(27)
v_accvgpr_read_b32 v234,a69
v_accvgpr_read_b32 v233,a165
M v[128:131],a[132:135],a[220:223],v[128:131]
ds_read_b128 a[220:223],v245 offset:36864
v_add_f32 v232,v234,v233
M v[132:135],a[132:135],a[192:195],v[132:135]
v_sub_f32 v234,v234,v233
v_add_f32 v233,v69,v165
M v[136:139],a[132:135],a[196:199],v[136:139]
buffer_load_dwordx4 v[224:227],v247,s[20:23],s46 offen offset:2048 sc1
M v[140:143],a[132:135],a[200:203],v[140:143]
v_sub_f32 v165,v69,v165
v_add_f32 v69,v232,v233
M v[144:147],a[132:135],a[204:207],v[144:147]
v_fmac_f32 v232,4.0,v233
v_fma_f32 v233,2.0,v165,v234
M v[148:151],a[132:135],a[208:211],v[148:151]
v_fma_f32 v165,s40,v165,v234
v_cvt_pk_bf16_f32 v228,v228,v233
M v[152:155],a[132:135],a[212:215],v[152:155]
v_cvt_pk_bf16_f32 v230,v230,v232
v_accvgpr_read_b32 v234,a70
M v[156:159],a[132:135],a[216:219],v[156:159]
s_waitcnt vmcnt(27)
v_accvgpr_read_b32 v229,a166
v_add_f32 v231,v234,v229
M v[96:99],a[112:115],a[192:195],v[96:99]
v_sub_f32 v234,v234,v229
v_add_f32 v229,v70,v166
M v[100:103],a[112:115],a[196:199],v[100:103]
v_sub_f32 v166,v70,v166
v_add_f32 v70,v231,v229
M v[104:107],a[112:115],a[200:203],v[104:107]
buffer_load_dwordx4 a[228:231],v247,s[20:23],s47 offen offset:2048 sc1
M v[108:111],a[112:115],a[204:207],v[108:111]
v_fmac_f32 v231,4.0,v229
v_fma_f32 v229,2.0,v166,v234
M v[112:115],a[112:115],a[208:211],v[112:115]
s_add_u32 s46,s81,46080
v_fma_f32 v166,s40,v166,v234
v_accvgpr_read_b32 v234,a71
M v[116:119],a[112:115],a[212:215],v[116:119]
v_accvgpr_read_b32 v233,a167
v_add_f32 v232,v234,v233
M v[120:123],a[112:115],a[216:219],v[120:123]
s_waitcnt lgkmcnt(0)
v_sub_f32 v234,v234,v233
v_add_f32 v233,v71,v167
M v[124:127],a[112:115],a[220:223],v[124:127]
s_waitcnt vmcnt(27)
v_sub_f32 v167,v71,v167
v_add_f32 v71,v232,v233
M v[128:131],a[136:139],a[192:195],v[128:131]
ds_read_b128 a[192:195],v245 offset:52224
v_fmac_f32 v232,4.0,v233
M v[132:135],a[136:139],a[196:199],v[132:135]
ds_read_b128 a[196:199],v246 offset:52224
v_fma_f32 v233,2.0,v167,v234
M v[136:139],a[136:139],a[200:203],v[136:139]
buffer_load_dwordx4 a[108:111],v247,s[20:23],s46 offen offset:0 sc1
M v[140:143],a[136:139],a[204:207],v[140:143]
ds_read_b128 a[200:203],v245 offset:52736
ds_read_b128 a[204:207],v246 offset:52736
M v[144:147],a[136:139],a[208:211],v[144:147]
s_add_u32 s47,s81,49152
ds_read_b128 a[208:211],v245 offset:53248
v_fma_f32 v167,s40,v167,v234
M v[148:151],a[136:139],a[212:215],v[148:151]
ds_read_b128 a[212:215],v246 offset:53248
v_cvt_pk_bf16_f32 v229,v229,v233
M v[152:155],a[136:139],a[216:219],v[152:155]
ds_read_b128 a[216:219],v245 offset:53760
v_cvt_pk_bf16_f32 v231,v231,v232
M v[156:159],a[136:139],a[220:223],v[156:159]
s_waitcnt vmcnt(24) lgkmcnt(6)
ds_read_b128 a[220:223],v246 offset:53760
ds_write2st64_b64 v249,v[228:229],v[230:231] offset0:8 offset1:12
M v[96:99],a[244:247],a[192:195],v[96:99]
s_waitcnt lgkmcnt(7)
v_accvgpr_read_b32 v234,a72
v_accvgpr_read_b32 v228,a168
M v[100:103],a[244:247],a[196:199],v[100:103]
s_waitcnt lgkmcnt(6)
v_add_f32 v230,v234,v228
v_sub_f32 v234,v234,v228
M v[104:107],a[244:247],a[200:203],v[104:107]
s_waitcnt lgkmcnt(5)
buffer_load_dwordx4 a[232:235],v247,s[20:23],s47 offen offset:0 sc1
M v[108:111],a[244:247],a[204:207],v[108:111]
s_waitcnt lgkmcnt(4)
v_add_f32 v228,v72,v168
v_sub_f32 v168,v72,v168
M v[112:115],a[244:247],a[208:211],v[112:115]
s_waitcnt lgkmcnt(0)
s_barrier
ds_read_b128 v[0:3],v247 offset:17408
M v[116:119],a[244:247],a[212:215],v[116:119]
ds_read_b128 v[8:11],v247 offset:21504
ds_read_b128 v[16:19],v247 offset:26112
M v[120:123],a[244:247],a[216:219],v[120:123]
ds_read_b128 v[24:27],v247 offset:30208
ds_read_b128 a[64:67],v247 offset:0
M v[124:127],a[244:247],a[220:223],v[124:127]
s_waitcnt vmcnt(24)
ds_read_b128 a[68:71],v247 offset:4096
v_add_f32 v72,v230,v228
M v[128:131],a[140:143],a[192:195],v[128:131]
ds_read_b128 a[192:195],v246 offset:54272
v_fmac_f32 v230,4.0,v228
M v[132:135],a[140:143],a[196:199],v[132:135]
s_waitcnt lgkmcnt(6)
s_add_u32 s34,s33,6291456
buffer_store_dwordx4 v[0:3],v248,s[24:27],s34 offen offset:0 nt
M v[136:139],a[140:143],a[200:203],v[136:139]
s_waitcnt lgkmcnt(5)
s_add_u32 s34,s33,6684672
buffer_store_dwordx4 v[8:11],v248,s[24:27],s34 offen offset:0 nt
M v[140:143],a[140:143],a[204:207],v[140:143]
v_fma_f32 v228,2.0,v168,v234
v_fma_f32 v168,s40,v168,v234
M v[144:147],a[140:143],a[208:211],v[144:147]
v_accvgpr_read_b32 v234,a73
v_accvgpr_read_b32 v233,a169
M v[148:151],a[140:143],a[212:215],v[148:151]
buffer_load_dwordx4 a[96:99],v247,s[20:23],s46 offen offset:1024 sc1
M v[152:155],a[140:143],a[216:219],v[152:155]
v_add_f32 v232,v234,v233
v_sub_f32 v234,v234,v233
M v[156:159],a[140:143],a[220:223],v[156:159]
s_waitcnt vmcnt(25)
v_add_f32 v233,v73,v169
v_sub_f32 v169,v73,v169
M v[96:99],a[248:251],a[196:199],v[96:99]
v_add_f32 v73,v232,v233
v_fmac_f32 v232,4.0,v233
M v[100:103],a[248:251],a[200:203],v[100:103]
v_fma_f32 v233,2.0,v169,v234
v_fma_f32 v169,s40,v169,v234
M v[104:107],a[248:251],a[204:207],v[104:107]
buffer_load_dwordx4 a[128:131],v247,s[20:23],s47 offen offset:1024 sc1
M v[108:111],a[248:251],a[208:211],v[108:111]
s_add_u32 s34,s33,7077888
v_cvt_pk_bf16_f32 v228,v228,v233
v_cvt_pk_bf16_f32 v230,v230,v232
M v[112:115],a[248:251],a[212:215],v[112:115]
v_accvgpr_read_b32 v234,a74
v_accvgpr_read_b32 v229,a170
M v[116:119],a[248:251],a[216:219],v[116:119]
s_waitcnt lgkmcnt(4)
buffer_store_dwordx4 v[16:19],v248,s[24:27],s34 offen offset:0 nt
M v[120:123],a[248:251],a[220:223],v[120:123]
s_waitcnt lgkmcnt(0)
v_add_f32 v231,v234,v229
v_sub_f32 v234,v234,v229
M v[124:127],a[248:251],a[192:195],v[124:127]
s_waitcnt vmcnt(26)
v_add_f32 v229,v74,v170
v_sub_f32 v170,v74,v170
M v[128:131],a[100:103],a[196:199],v[128:131]
ds_read_b128 a[196:199],v245 offset:54272
v_add_f32 v74,v231,v229
M v[132:135],a[100:103],a[200:203],v[132:135]
v_fmac_f32 v231,4.0,v229
v_fma_f32 v229,2.0,v170,v234
M v[136:139],a[100:103],a[204:207],v[136:139]
buffer_load_dwordx4 a[160:163],v247,s[20:23],s46 offen offset:2048 sc1
M v[140:143],a[100:103],a[208:211],v[140:143]
v_fma_f32 v170,s40,v170,v234
v_accvgpr_read_b32 v234,a75
M v[144:147],a[100:103],a[212:215],v[144:147]
v_accvgpr_read_b32 v233,a171
v_add_f32 v232,v234,v233
M v[148:151],a[100:103],a[216:219],v[148:151]
v_sub_f32 v234,v234,v233
v_add_f32 v233,v75,v171
M v[152:155],a[100:103],a[220:223],v[152:155]
v_sub_f32 v171,v75,v171
v_add_f32 v75,v232,v233
M v[156:159],a[100:103],a[192:195],v[156:159]
s_waitcnt vmcnt(26)
v_fmac_f32 v232,4.0,v233
v_fma_f32 v233,2.0,v171,v234
M v[96:99],a[252:255],a[200:203],v[96:99]
v_fma_f32 v171,s40,v171,v234
v_cvt_pk_bf16_f32 v229,v229,v233
M v[100:103],a[252:255],a[204:207],v[100:103]
v_cvt_pk_bf16_f32 v231,v231,v232
M v[104:107],a[252:255],a[208:211],v[104:107]
buffer_load_dwordx4 a[236:239],v247,s[20:23],s47 offen offset:2048 sc1
M v[108:111],a[252:255],a[212:215],v[108:111]
ds_write2st64_b64 v249,v[228:229],v[230:231] offset0:17 offset1:21
M v[112:115],a[252:255],a[216:219],v[112:115]
s_add_u32 s47,s76,3072
v_accvgpr_read_b32 v234,a76
v_accvgpr_read_b32 v228,a172
M v[116:119],a[252:255],a[220:223],v[116:119]
v_add_u32 v245,0x11000,v245
v_add_u32 v246,0x11000,v246
M v[120:123],a[252:255],a[192:195],v[120:123]
s_waitcnt lgkmcnt(1)
v_add_f32 v230,v234,v228
v_sub_f32 v234,v234,v228
M v[124:127],a[252:255],a[196:199],v[124:127]
s_waitcnt vmcnt(26)
v_add_f32 v228,v76,v172
v_sub_f32 v172,v76,v172
M v[128:131],a[116:119],a[200:203],v[128:131]
ds_read_b128 a[200:203],v245 offset:0
v_add_f32 v76,v230,v228
M v[132:135],a[116:119],a[204:207],v[132:135]
s_add_u32 s34,s33,7471104
buffer_store_dwordx4 v[24:27],v248,s[24:27],s34 offen offset:0 nt
M v[136:139],a[116:119],a[208:211],v[136:139]
buffer_load_dwordx4 a[240:243],v247,s[20:23],s47 offen offset:0 sc1
M v[140:143],a[116:119],a[212:215],v[140:143]
ds_read_b128 a[204:207],v246 offset:0
ds_read_b128 a[208:211],v245 offset:512
M v[144:147],a[116:119],a[216:219],v[144:147]
s_add_u32 s48,s76,6144
ds_read_b128 a[212:215],v246 offset:512
ds_read_b128 a[216:219],v245 offset:1024
M v[148:151],a[116:119],a[220:223],v[148:151]
ds_read_b128 a[220:223],v246 offset:1024
v_fmac_f32 v230,4.0,v228
M v[152:155],a[116:119],a[192:195],v[152:155]
ds_read_b128 a[192:195],v245 offset:1536
v_fma_f32 v228,2.0,v172,v234
M v[156:159],a[116:119],a[196:199],v[156:159]
s_waitcnt vmcnt(27) lgkmcnt(6)
ds_read_b128 a[196:199],v246 offset:1536
v_fma_f32 v172,s40,v172,v234
M v[96:99],a[224:227],a[200:203],v[96:99]
s_waitcnt lgkmcnt(6)
v_accvgpr_read_b32 v234,a77
v_accvgpr_read_b32 v233,a173
M v[100:103],a[224:227],a[204:207],v[100:103]
s_waitcnt lgkmcnt(5)
v_add_f32 v232,v234,v233
v_sub_f32 v234,v234,v233
M v[104:107],a[224:227],a[208:211],v[104:107]
s_waitcnt lgkmcnt(4)
buffer_load_dwordx4 a[132:135],v247,s[20:23],s48 offen offset:0 sc1
M v[108:111],a[224:227],a[212:215],v[108:111]
s_waitcnt lgkmcnt(3)
v_add_f32 v233,v77,v173
v_sub_f32 v173,v77,v173
M v[112:115],a[224:227],a[216:219],v[112:115]
s_waitcnt lgkmcnt(2)
v_add_f32 v77,v232,v233
v_fmac_f32 v232,4.0,v233
M v[116:119],a[224:227],a[220:223],v[116:119]
s_waitcnt lgkmcnt(1)
v_fma_f32 v233,2.0,v173,v234
v_fma_f32 v173,s40,v173,v234
M v[120:123],a[224:227],a[192:195],v[120:123]
s_waitcnt lgkmcnt(0)
v_cvt_pk_bf16_f32 v228,v228,v233
v_cvt_pk_bf16_f32 v230,v230,v232
M v[124:127],a[224:227],a[196:199],v[124:127]
s_waitcnt vmcnt(27)
v_accvgpr_read_b32 v234,a78
v_accvgpr_read_b32 v229,a174
M v[128:131],v[216:219],a[200:203],v[128:131]
ds_read_b128 a[200:203],v246 offset:2048
v_add_f32 v231,v234,v229
M v[132:135],v[216:219],a[204:207],v[132:135]
v_sub_f32 v234,v234,v229
v_add_f32 v229,v78,v174
M v[136:139],v[216:219],a[208:211],v[136:139]
buffer_load_dwordx4 a[164:167],v247,s[20:23],s47 offen offset:1024 sc1
M v[140:143],v[216:219],a[212:215],v[140:143]
v_sub_f32 v174,v78,v174
v_add_f32 v78,v231,v229
M v[144:147],v[216:219],a[216:219],v[144:147]
v_fmac_f32 v231,4.0,v229
v_fma_f32 v229,2.0,v174,v234
M v[148:151],v[216:219],a[220:223],v[148:151]
v_fma_f32 v174,s40,v174,v234
v_accvgpr_read_b32 v234,a79
M v[152:155],v[216:219],a[192:195],v[152:155]
v_accvgpr_read_b32 v233,a175
v_add_f32 v232,v234,v233
M v[156:159],v[216:219],a[196:199],v[156:159]
s_waitcnt vmcnt(26)
s_add_u32 s34,s32,6291456
buffer_store_dwordx4 a[64:67],v248,s[24:27],s34 offen offset:640 nt
M v[96:99],a[144:147],a[204:207],v[96:99]
v_sub_f32 v234,v234,v233
v_add_f32 v233,v79,v175
M v[100:103],a[144:147],a[208:211],v[100:103]
v_sub_f32 v175,v79,v175
v_add_f32 v79,v232,v233
M v[104:107],a[144:147],a[212:215],v[104:107]
buffer_load_dwordx4 a[112:115],v247,s[20:23],s48 offen offset:1024 sc1
M v[108:111],a[144:147],a[216:219],v[108:111]
v_fmac_f32 v232,4.0,v233
v_fma_f32 v233,2.0,v175,v234
M v[112:115],a[144:147],a[220:223],v[112:115]
v_fma_f32 v175,s40,v175,v234
v_cvt_pk_bf16_f32 v229,v229,v233
M v[116:119],a[144:147],a[192:195],v[116:119]
v_cvt_pk_bf16_f32 v231,v231,v232
M v[120:123],a[144:147],a[196:199],v[120:123]
s_waitcnt lgkmcnt(0)
ds_write2st64_b64 v249,v[228:229],v[230:231] offset0:25 offset1:29
M v[124:127],a[144:147],a[200:203],v[124:127]
s_waitcnt vmcnt(27)
v_accvgpr_read_b32 v234,a80
v_accvgpr_read_b32 v228,a176
M v[128:131],v[220:223],a[204:207],v[128:131]
ds_read_b128 a[204:207],v245 offset:2048
v_add_f32 v230,v234,v228
M v[132:135],v[220:223],a[208:211],v[132:135]
v_sub_f32 v234,v234,v228
v_add_f32 v228,v80,v176
M v[136:139],v[220:223],a[212:215],v[136:139]
buffer_load_dwordx4 a[136:139],v247,s[20:23],s47 offen offset:2048 sc1
M v[140:143],v[220:223],a[216:219],v[140:143]
v_sub_f32 v176,v80,v176
v_add_f32 v80,v230,v228
M v[144:147],v[220:223],a[220:223],v[144:147]
v_fmac_f32 v230,4.0,v228
v_fma_f32 v228,2.0,v176,v234
M v[148:151],v[220:223],a[192:195],v[148:151]
v_fma_f32 v176,s40,v176,v234
v_accvgpr_read_b32 v234,a81
M v[152:155],v[220:223],a[196:199],v[152:155]
v_accvgpr_read_b32 v233,a177
v_add_f32 v232,v234,v233
M v[156:159],v[220:223],a[200:203],v[156:159]
s_waitcnt vmcnt(25)
v_sub_f32 v234,v234,v233
v_add_f32 v233,v81,v177
M v[96:99],a[148:151],a[208:211],v[96:99]
v_sub_f32 v177,v81,v177
v_add_f32 v81,v232,v233
M v[100:103],a[148:151],a[212:215],v[100:103]
v_fmac_f32 v232,4.0,v233
v_fma_f32 v233,2.0,v177,v234
M v[104:107],a[148:151],a[216:219],v[104:107]
buffer_load_dwordx4 a[244:247],v247,s[20:23],s48 offen offset:2048 sc1
M v[108:111],a[148:151],a[220:223],v[108:111]
v_fma_f32 v177,s40,v177,v234
v_cvt_pk_bf16_f32 v228,v228,v233
M v[112:115],a[148:151],a[192:195],v[112:115]
s_add_u32 s47,s77,3072
v_cvt_pk_bf16_f32 v230,v230,v232
v_accvgpr_read_b32 v234,a82
M v[116:119],a[148:151],a[196:199],v[116:119]
s_add_u32 s34,s32,6488064
buffer_store_dwordx4 a[68:71],v248,s[24:27],s34 offen offset:640 nt
M v[120:123],a[148:151],a[200:203],v[120:123]
s_waitcnt lgkmcnt(0)
v_accvgpr_read_b32 v229,a178
v_add_f32 v231,v234,v229
M v[124:127],a[148:151],a[204:207],v[124:127]
s_waitcnt vmcnt(25)
v_sub_f32 v234,v234,v229
v_add_f32 v229,v82,v178
M v[128:131],a[104:107],a[208:211],v[128:131]
ds_read_b128 a[208:211],v245 offset:17408
v_sub_f32 v178,v82,v178
M v[132:135],a[104:107],a[212:215],v[132:135]
ds_read_b128 a[212:215],v246 offset:17408
v_add_f32 v82,v231,v229
M v[136:139],a[104:107],a[216:219],v[136:139]
buffer_load_dwordx4 a[140:143],v247,s[20:23],s47 offen offset:0 sc1
M v[140:143],a[104:107],a[220:223],v[140:143]
ds_read_b128 a[216:219],v245 offset:17920
ds_read_b128 a[220:223],v246 offset:17920
M v[144:147],a[104:107],a[192:195],v[144:147]
s_add_u32 s48,s77,6144
ds_read_b128 a[192:195],v245 offset:18432
v_fmac_f32 v231,4.0,v229
M v[148:151],a[104:107],a[196:199],v[148:151]
ds_read_b128 a[196:199],v246 offset:18432
v_fma_f32 v229,2.0,v178,v234
M v[152:155],a[104:107],a[200:203],v[152:155]
ds_read_b128 a[200:203],v245 offset:18944
v_fma_f32 v178,s40,v178,v234
M v[156:159],a[104:107],a[204:207],v[156:159]
s_waitcnt vmcnt(25) lgkmcnt(6)
ds_read_b128 a[204:207],v246 offset:18944
v_accvgpr_read_b32 v234,a83
M v[96:99],a[152:155],a[208:211],v[96:99]
s_waitcnt lgkmcnt(6)
v_accvgpr_read_b32 v233,a179
v_add_f32 v232,v234,v233
M v[100:103],a[152:155],a[212:215],v[100:103]
s_waitcnt lgkmcnt(5)
v_sub_f32 v234,v234,v233
v_add_f32 v233,v83,v179
M v[104:107],a[152:155],a[216:219],v[104:107]
s_waitcnt lgkmcnt(4)
buffer_load_dwordx4 a[248:251],v247,s[20:23],s48 offen offset:0 sc1
M v[108:111],a[152:155],a[220:223],v[108:111]
s_waitcnt lgkmcnt(3)
v_sub_f32 v179,v83,v179
v_add_f32 v83,v232,v233
M v[112:115],a[152:155],a[192:195],v[112:115]
s_waitcnt lgkmcnt(2)
v_fmac_f32 v232,4.0,v233
v_fma_f32 v233,2.0,v179,v234
M v[116:119],a[152:155],a[196:199],v[116:119]
s_waitcnt lgkmcnt(1)
v_fma_f32 v179,s40,v179,v234
v_cvt_pk_bf16_f32 v229,v229,v233
M v[120:123],a[152:155],a[200:203],v[120:123]
s_waitcnt lgkmcnt(0)
v_cvt_pk_bf16_f32 v231,v231,v232
M v[124:127],a[152:155],a[204:207],v[124:127]
s_waitcnt vmcnt(24)
ds_write2st64_b64 v249,v[228:229],v[230:231] offset0:68 offset1:72
M v[128:131],a[120:123],a[208:211],v[128:131]
ds_read_b128 a[208:211],v246 offset:19456
v_accvgpr_read_b32 v234,a84
M v[132:135],a[120:123],a[212:215],v[132:135]
v_accvgpr_read_b32 v228,a180
v_add_f32 v230,v234,v228
M v[136:139],a[120:123],a[216:219],v[136:139]
buffer_load_dwordx4 a[168:171],v247,s[20:23],s47 offen offset:1024 sc1
M v[140:143],a[120:123],a[220:223],v[140:143]
v_sub_f32 v234,v234,v228
v_add_f32 v228,v84,v180
M v[144:147],a[120:123],a[192:195],v[144:147]
v_sub_f32 v180,v84,v180
v_add_f32 v84,v230,v228
M v[148:151],a[120:123],a[196:199],v[148:151]
v_fmac_f32 v230,4.0,v228
v_fma_f32 v228,2.0,v180,v234
M v[152:155],a[120:123],a[200:203],v[152:155]
v_fma_f32 v180,s40,v180,v234
v_accvgpr_read_b32 v234,a85
M v[156:159],a[120:123],a[204:207],v[156:159]
s_waitcnt vmcnt(24)
v_accvgpr_read_b32 v233,a181
v_add_f32 v232,v234,v233
M v[96:99],a[124:127],a[212:215],v[96:99]
v_sub_f32 v234,v234,v233
v_add_f32 v233,v85,v181
M v[100:103],a[124:127],a[216:219],v[100:103]
v_sub_f32 v181,v85,v181
v_add_f32 v85,v232,v233
M v[104:107],a[124:127],a[220:223],v[104:107]
buffer_load_dwordx4 a[100:103],v247,s[20:23],s48 offen offset:1024 sc1
M v[108:111],a[124:127],a[192:195],v[108:111]
v_fmac_f32 v232,4.0,v233
v_fma_f32 v233,2.0,v181,v234
M v[112:115],a[124:127],a[196:199],v[112:115]
v_fma_f32 v181,s40,v181,v234
v_cvt_pk_bf16_f32 v228,v228,v233
M v[116:119],a[124:127],a[200:203],v[116:119]
v_cvt_pk_bf16_f32 v230,v230,v232
v_accvgpr_read_b32 v234,a86
M v[120:123],a[124:127],a[204:207],v[120:123]
s_waitcnt lgkmcnt(0)
v_accvgpr_read_b32 v229,a182
v_add_f32 v231,v234,v229
M v[124:127],a[124:127],a[208:211],v[124:127]
s_waitcnt vmcnt(24)
v_sub_f32 v234,v234,v229
v_add_f32 v229,v86,v182
M v[128:131],a[156:159],a[212:215],v[128:131]
ds_read_b128 a[212:215],v245 offset:19456
v_sub_f32 v182,v86,v182
M v[132:135],a[156:159],a[216:219],v[132:135]
v_add_f32 v86,v231,v229
v_fmac_f32 v231,4.0,v229
M v[136:139],a[156:159],a[220:223],v[136:139]
buffer_load_dwordx4 a[252:255],v247,s[20:23],s47 offen offset:2048 sc1
M v[140:143],a[156:159],a[192:195],v[140:143]
v_fma_f32 v229,2.0,v182,v234
v_fma_f32 v182,s40,v182,v234
M v[144:147],a[156:159],a[196:199],v[144:147]
v_accvgpr_read_b32 v234,a87
v_accvgpr_read_b32 v233,a183
M v[148:151],a[156:159],a[200:203],v[148:151]
v_add_f32 v232,v234,v233
v_sub_f32 v234,v234,v233
M v[152:155],a[156:159],a[204:207],v[152:155]
v_add_f32 v233,v87,v183
v_sub_f32 v183,v87,v183
M v[156:159],a[156:159],a[208:211],v[156:159]
s_waitcnt vmcnt(24)
v_add_f32 v87,v232,v233
v_fmac_f32 v232,4.0,v233
M v[96:99],v[224:227],a[216:219],v[96:99]
v_fma_f32 v233,2.0,v183,v234
v_fma_f32 v183,s40,v183,v234
M v[100:103],v[224:227],a[220:223],v[100:103]
v_cvt_pk_bf16_f32 v229,v229,v233
v_cvt_pk_bf16_f32 v231,v231,v232
M v[104:107],v[224:227],a[192:195],v[104:107]
buffer_load_dwordx4 a[116:119],v247,s[20:23],s48 offen offset:2048 sc1
M v[108:111],v[224:227],a[196:199],v[108:111]
ds_write2st64_b64 v249,v[228:229],v[230:231] offset0:76 offset1:80
M v[112:115],v[224:227],a[200:203],v[112:115]
s_add_u32 s47,s78,3072
v_accvgpr_read_b32 v234,a88
v_accvgpr_read_b32 v228,a184
M v[116:119],v[224:227],a[204:207],v[116:119]
v_add_u32 v245,0xfffece00,v245
v_add_u32 v246,0xfffece00,v246
M v[120:123],v[224:227],a[208:211],v[120:123]
s_waitcnt lgkmcnt(1)
v_add_f32 v230,v234,v228
v_sub_f32 v234,v234,v228
M v[124:127],v[224:227],a[212:215],v[124:127]
s_waitcnt vmcnt(24)
v_add_f32 v228,v88,v184
v_sub_f32 v184,v88,v184
M v[128:131],a[228:231],a[216:219],v[128:131]
ds_read_b128 a[216:219],v245 offset:26112
v_add_f32 v88,v230,v228
M v[132:135],a[228:231],a[220:223],v[132:135]
ds_read_b128 a[220:223],v246 offset:26112
v_fmac_f32 v230,4.0,v228
M v[136:139],a[228:231],a[192:195],v[136:139]
buffer_load_dwordx4 a[224:227],v247,s[20:23],s47 offen offset:0 sc1
M v[140:143],a[228:231],a[196:199],v[140:143]
ds_read_b128 a[192:195],v245 offset:26624
ds_read_b128 a[196:199],v246 offset:26624
M v[144:147],a[228:231],a[200:203],v[144:147]
s_add_u32 s48,s78,6144
ds_read_b128 a[200:203],v245 offset:27136
v_fma_f32 v228,2.0,v184,v234
M v[148:151],a[228:231],a[204:207],v[148:151]
ds_read_b128 a[204:207],v246 offset:27136
v_fma_f32 v184,s40,v184,v234
M v[152:155],a[228:231],a[208:211],v[152:155]
ds_read_b128 a[208:211],v245 offset:27648
v_accvgpr_read_b32 v234,a89
M v[156:159],a[228:231],a[212:215],v[156:159]
s_waitcnt vmcnt(24) lgkmcnt(6)
ds_read_b128 a[212:215],v246 offset:27648
v_accvgpr_read_b32 v233,a185
M v[96:99],a[108:111],a[216:219],v[96:99]
s_waitcnt lgkmcnt(6)
v_add_f32 v232,v234,v233
v_sub_f32 v234,v234,v233
M v[100:103],a[108:111],a[220:223],v[100:103]
s_waitcnt lgkmcnt(5)
v_add_f32 v233,v89,v185
v_sub_f32 v185,v89,v185
M v[104:107],a[108:111],a[192:195],v[104:107]
s_waitcnt lgkmcnt(4)
buffer_load_dwordx4 v[216:219],v247,s[20:23],s48 offen offset:0 sc1
M v[108:111],a[108:111],a[196:199],v[108:111]
s_waitcnt lgkmcnt(3)
v_add_f32 v89,v232,v233
v_fmac_f32 v232,4.0,v233
M v[112:115],a[108:111],a[200:203],v[112:115]
s_waitcnt lgkmcnt(2)
v_fma_f32 v233,2.0,v185,v234
v_fma_f32 v185,s40,v185,v234
M v[116:119],a[108:111],a[204:207],v[116:119]
s_waitcnt lgkmcnt(1)
v_cvt_pk_bf16_f32 v228,v228,v233
v_cvt_pk_bf16_f32 v230,v230,v232
M v[120:123],a[108:111],a[208:211],v[120:123]
s_waitcnt lgkmcnt(0)
v_accvgpr_read_b32 v234,a90
v_accvgpr_read_b32 v229,a186
M v[124:127],a[108:111],a[212:215],v[124:127]
s_waitcnt vmcnt(24)
v_add_f32 v231,v234,v229
v_sub_f32 v234,v234,v229
M v[128:131],a[232:235],a[216:219],v[128:131]
ds_read_b128 a[216:219],v246 offset:28160
v_add_f32 v229,v90,v186
M v[132:135],a[232:235],a[220:223],v[132:135]
v_sub_f32 v186,v90,v186
v_add_f32 v90,v231,v229
M v[136:139],a[232:235],a[192:195],v[136:139]
buffer_load_dwordx4 a[172:175],v247,s[20:23],s47 offen offset:1024 sc1
M v[140:143],a[232:235],a[196:199],v[140:143]
v_fmac_f32 v231,4.0,v229
v_fma_f32 v229,2.0,v186,v234
M v[144:147],a[232:235],a[200:203],v[144:147]
v_fma_f32 v186,s40,v186,v234
v_accvgpr_read_b32 v234,a91
M v[148:151],a[232:235],a[204:207],v[148:151]
v_accvgpr_read_b32 v233,a187
v_add_f32 v232,v234,v233
M v[152:155],a[232:235],a[208:211],v[152:155]
v_sub_f32 v234,v234,v233
v_add_f32 v233,v91,v187
M v[156:159],a[232:235],a[212:215],v[156:159]
s_waitcnt vmcnt(22)
v_sub_f32 v187,v91,v187
v_add_f32 v91,v232,v233
M v[96:99],a[96:99],a[220:223],v[96:99]
v_fmac_f32 v232,4.0,v233
v_fma_f32 v233,2.0,v187,v234
M v[100:103],a[96:99],a[192:195],v[100:103]
v_fma_f32 v187,s40,v187,v234
v_cvt_pk_bf16_f32 v229,v229,v233
M v[104:107],a[96:99],a[196:199],v[104:107]
buffer_load_dwordx4 a[144:147],v247,s[20:23],s48 offen offset:1024 sc1
M v[108:111],a[96:99],a[200:203],v[108:111]
v_cvt_pk_bf16_f32 v231,v231,v232
M v[112:115],a[96:99],a[204:207],v[112:115]
ds_write2st64_b64 v249,v[228:229],v[230:231] offset0:85 offset1:89
M v[116:119],a[96:99],a[208:211],v[116:119]
v_accvgpr_read_b32 v234,a92
v_accvgpr_read_b32 v228,a188
M v[120:123],a[96:99],a[212:215],v[120:123]
s_waitcnt lgkmcnt(1)
v_add_f32 v230,v234,v228
v_sub_f32 v234,v234,v228
M v[124:127],a[96:99],a[216:219],v[124:127]
s_waitcnt vmcnt(22)
v_add_f32 v228,v92,v188
v_sub_f32 v188,v92,v188
M v[128:131],a[128:131],a[220:223],v[128:131]
ds_read_b128 a[220:223],v245 offset:28160
v_add_f32 v92,v230,v228
M v[132:135],a[128:131],a[192:195],v[132:135]
v_fmac_f32 v230,4.0,v228
v_fma_f32 v228,2.0,v188,v234
M v[136:139],a[128:131],a[196:199],v[136:139]
buffer_load_dwordx4 v[220:223],v247,s[20:23],s47 offen offset:2048 sc1
M v[140:143],a[128:131],a[200:203],v[140:143]
v_fma_f32 v188,s40,v188,v234
v_accvgpr_read_b32 v234,a93
M v[144:147],a[128:131],a[204:207],v[144:147]
v_accvgpr_read_b32 v233,a189
v_add_f32 v232,v234,v233
M v[148:151],a[128:131],a[208:211],v[148:151]
v_sub_f32 v234,v234,v233
v_add_f32 v233,v93,v189
M v[152:155],a[128:131],a[212:215],v[152:155]
v_sub_f32 v189,v93,v189
v_add_f32 v93,v232,v233
M v[156:159],a[128:131],a[216:219],v[156:159]
s_waitcnt vmcnt(21)
v_fmac_f32 v232,4.0,v233
v_fma_f32 v233,2.0,v189,v234
M v[96:99],a[160:163],a[192:195],v[96:99]
v_fma_f32 v189,s40,v189,v234
v_cvt_pk_bf16_f32 v228,v228,v233
M v[100:103],a[160:163],a[196:199],v[100:103]
v_cvt_pk_bf16_f32 v230,v230,v232
v_accvgpr_read_b32 v234,a94
M v[104:107],a[160:163],a[200:203],v[104:107]
buffer_load_dwordx4 a[148:151],v247,s[20:23],s48 offen offset:2048 sc1
M v[108:111],a[160:163],a[204:207],v[108:111]
v_accvgpr_read_b32 v229,a190
v_add_f32 v231,v234,v229
M v[112:115],a[160:163],a[208:211],v[112:115]
s_add_u32 s47,s79,3072
v_sub_f32 v234,v234,v229
v_add_f32 v229,v94,v190
M v[116:119],a[160:163],a[212:215],v[116:119]
v_sub_f32 v190,v94,v190
v_add_f32 v94,v231,v229
M v[120:123],a[160:163],a[216:219],v[120:123]
s_waitcnt lgkmcnt(0)
v_fmac_f32 v231,4.0,v229
v_fma_f32 v229,2.0,v190,v234
M v[124:127],a[160:163],a[220:223],v[124:127]
s_waitcnt vmcnt(21)
v_fma_f32 v190,s40,v190,v234
v_accvgpr_read_b32 v234,a95
M v[128:131],a[236:239],a[192:195],v[128:131]
ds_read_b128 a[192:195],v245 offset:0
v_accvgpr_read_b32 v233,a191
M v[132:135],a[236:239],a[196:199],v[132:135]
ds_read_b128 a[196:199],v246 offset:0
v_add_f32 v232,v234,v233
M v[136:139],a[236:239],a[200:203],v[136:139]
buffer_load_dwordx4 a[104:107],v247,s[20:23],s47 offen offset:0 sc1
M v[140:143],a[236:239],a[204:207],v[140:143]
ds_read_b128 a[200:203],v245 offset:512
ds_read_b128 a[204:207],v246 offset:512
M v[144:147],a[236:239],a[208:211],v[144:147]
s_add_u32 s48,s79,6144
ds_read_b128 a[208:211],v245 offset:1024
v_sub_f32 v234,v234,v233
M v[148:151],a[236:239],a[212:215],v[148:151]
ds_read_b128 a[212:215],v246 offset:1024
v_add_f32 v233,v95,v191
M v[152:155],a[236:239],a[216:219],v[152:155]
ds_read_b128 a[216:219],v245 offset:1536
v_sub_f32 v191,v95,v191
M v[156:159],a[236:239],a[220:223],v[156:159]
s_waitcnt vmcnt(20) lgkmcnt(6)
ds_read_b128 a[220:223],v246 offset:1536
v_add_f32 v95,v232,v233
M v[32:35],a[240:243],a[192:195],v[32:35]
s_waitcnt lgkmcnt(6)
v_fmac_f32 v232,4.0,v233
v_fma_f32 v233,2.0,v191,v234
M v[36:39],a[240:243],a[196:199],v[36:39]
s_waitcnt lgkmcnt(5)
v_fma_f32 v191,s40,v191,v234
v_cvt_pk_bf16_f32 v229,v229,v233
M v[40:43],a[240:243],a[200:203],v[40:43]
s_waitcnt lgkmcnt(4)
buffer_load_dwordx4 a[176:179],v247,s[20:23],s48 offen offset:0 sc1
M v[44:47],a[240:243],a[204:207],v[44:47]
s_waitcnt lgkmcnt(3)
v_cvt_pk_bf16_f32 v231,v231,v232
M v[48:51],a[240:243],a[208:211],v[48:51]
s_waitcnt lgkmcnt(2)
global_load_dword v251,v252,s[82:83]
M v[52:55],a[240:243],a[212:215],v[52:55]
s_waitcnt lgkmcnt(1)
ds_write2st64_b64 v249,v[228:229],v[230:231] offset0:93 offset1:97
M v[56:59],a[240:243],a[216:219],v[56:59]
s_waitcnt lgkmcnt(1)
v_cvt_pk_bf16_f32 v96,v96,v97
v_cvt_pk_bf16_f32 v97,v98,v99
M v[60:63],a[240:243],a[220:223],v[60:63]
s_waitcnt vmcnt(21)
v_cvt_pk_bf16_f32 v100,v100,v101
v_cvt_pk_bf16_f32 v101,v102,v103
M v[64:67],a[132:135],a[192:195],v[64:67]
s_waitcnt lgkmcnt(0)
s_barrier
ds_read_b128 a[72:75],v247 offset:8704
M v[68:71],a[132:135],a[196:199],v[68:71]
ds_read_b128 a[76:79],v247 offset:12800
ds_read_b128 a[80:83],v247 offset:34816
M v[72:75],a[132:135],a[200:203],v[72:75]
ds_read_b128 a[84:87],v247 offset:38912
ds_read_b128 a[88:91],v247 offset:43520
M v[76:79],a[132:135],a[204:207],v[76:79]
ds_read_b128 a[92:95],v247 offset:47616
buffer_load_dwordx4 a[152:155],v247,s[20:23],s47 offen offset:1024 sc1
M v[80:83],a[132:135],a[208:211],v[80:83]
ds_read_b128 a[192:195],v246 offset:2048
ds_write2st64_b64 v249,v[96:97],v[100:101] offset0:34 offset1:38
M v[84:87],a[132:135],a[212:215],v[84:87]
s_waitcnt lgkmcnt(7)
s_add_u32 s34,s32,6684672
buffer_store_dwordx4 a[72:75],v248,s[24:27],s34 offen offset:640 nt
M v[88:91],a[132:135],a[216:219],v[88:91]
s_add_u32 s34,s32,6881280
v_cvt_pk_bf16_f32 v104,v104,v105
v_cvt_pk_bf16_f32 v105,v106,v107
M v[92:95],a[132:135],a[220:223],v[92:95]
s_waitcnt vmcnt(22) lgkmcnt(6)
buffer_store_dwordx4 a[76:79],v248,s[24:27],s34 offen offset:640 nt
M v[32:35],a[164:167],a[196:199],v[32:35]
s_add_u32 s34,s32,7077888
v_cvt_pk_bf16_f32 v108,v108,v109
v_cvt_pk_bf16_f32 v109,v110,v111
M v[36:39],a[164:167],a[200:203],v[36:39]
ds_write2st64_b64 v249,v[104:105],v[108:109] offset0:42 offset1:46
M v[40:43],a[164:167],a[204:207],v[40:43]
s_waitcnt lgkmcnt(6)
buffer_store_dwordx4 a[80:83],v248,s[24:27],s34 offen offset:640 nt
M v[44:47],a[164:167],a[208:211],v[44:47]
s_add_u32 s34,s32,7274496
v_cvt_pk_bf16_f32 v112,v112,v113
v_cvt_pk_bf16_f32 v113,v114,v115
M v[48:51],a[164:167],a[212:215],v[48:51]
s_waitcnt lgkmcnt(5)
buffer_store_dwordx4 a[84:87],v248,s[24:27],s34 offen offset:640 nt
M v[52:55],a[164:167],a[216:219],v[52:55]
s_add_u32 s34,s32,7471104
v_cvt_pk_bf16_f32 v116,v116,v117
v_cvt_pk_bf16_f32 v117,v118,v119
M v[56:59],a[164:167],a[220:223],v[56:59]
s_waitcnt lgkmcnt(2)
ds_write2st64_b64 v249,v[112:113],v[116:117] offset0:51 offset1:55
M v[60:63],a[164:167],a[192:195],v[60:63]
s_waitcnt vmcnt(23)
buffer_store_dwordx4 a[88:91],v248,s[24:27],s34 offen offset:640 nt
M v[64:67],a[112:115],a[196:199],v[64:67]
ds_read_b128 a[196:199],v245 offset:2048
v_cvt_pk_bf16_f32 v120,v120,v121
M v[68:71],a[112:115],a[200:203],v[68:71]
v_cvt_pk_bf16_f32 v121,v122,v123
v_cvt_pk_bf16_f32 v124,v124,v125
M v[72:75],a[112:115],a[204:207],v[72:75]
s_add_u32 s34,s32,7667712
buffer_load_dwordx4 a[120:123],v247,s[20:23],s48 offen offset:1024 sc1
M v[76:79],a[112:115],a[208:211],v[76:79]
v_cvt_pk_bf16_f32 v125,v126,v127
M v[80:83],a[112:115],a[212:215],v[80:83]
ds_write2st64_b64 v249,v[120:121],v[124:125] offset0:59 offset1:63
M v[84:87],a[112:115],a[216:219],v[84:87]
buffer_load_dwordx4 a[124:127],v247,s[20:23],s47 offen offset:2048 sc1
M v[88:91],a[112:115],a[220:223],v[88:91]
v_cvt_pk_bf16_f32 v128,v128,v129
v_cvt_pk_bf16_f32 v129,v130,v131
M v[92:95],a[112:115],a[192:195],v[92:95]
s_waitcnt vmcnt(25)
v_cvt_pk_bf16_f32 v132,v132,v133
v_cvt_pk_bf16_f32 v133,v134,v135
M v[32:35],a[136:139],a[200:203],v[32:35]
s_waitcnt lgkmcnt(0)
s_barrier
ds_read_b128 v[96:99],v247 offset:17408
M v[36:39],a[136:139],a[204:207],v[36:39]
ds_read_b128 v[104:107],v247 offset:21504
ds_read_b128 v[112:115],v247 offset:26112
M v[40:43],a[136:139],a[208:211],v[40:43]
ds_read_b128 v[120:123],v247 offset:30208
buffer_store_dwordx4 a[92:95],v248,s[24:27],s34 offen offset:640 nt
M v[44:47],a[136:139],a[212:215],v[44:47]
ds_write2st64_b64 v249,v[128:129],v[132:133] offset0:17 offset1:21
M v[48:51],a[136:139],a[216:219],v[48:51]
buffer_load_dwordx4 a[180:183],v247,s[20:23],s48 offen offset:2048 sc1
M v[52:55],a[136:139],a[220:223],v[52:55]
s_add_u32 s47,s80,3072
v_cvt_pk_bf16_f32 v136,v136,v137
v_cvt_pk_bf16_f32 v137,v138,v139
M v[56:59],a[136:139],a[192:195],v[56:59]
v_cvt_pk_bf16_f32 v140,v140,v141
v_cvt_pk_bf16_f32 v141,v142,v143
M v[60:63],a[136:139],a[196:199],v[60:63]
s_waitcnt vmcnt(26)
ds_write2st64_b64 v249,v[136:137],v[140:141] offset0:25 offset1:29
M v[64:67],a[244:247],a[200:203],v[64:67]
ds_read_b128 a[200:203],v245 offset:34816
v_cvt_pk_bf16_f32 v144,v144,v145
M v[68:71],a[244:247],a[204:207],v[68:71]
ds_read_b128 a[204:207],v246 offset:34816
v_cvt_pk_bf16_f32 v145,v146,v147
M v[72:75],a[244:247],a[208:211],v[72:75]
buffer_load_dwordx4 a[156:159],v247,s[20:23],s47 offen offset:0 sc1
M v[76:79],a[244:247],a[212:215],v[76:79]
ds_read_b128 a[208:211],v245 offset:35328
ds_read_b128 a[212:215],v246 offset:35328
M v[80:83],a[244:247],a[216:219],v[80:83]
s_add_u32 s48,s80,6144
ds_read_b128 a[216:219],v245 offset:35840
v_cvt_pk_bf16_f32 v148,v148,v149
M v[84:87],a[244:247],a[220:223],v[84:87]
ds_read_b128 a[220:223],v246 offset:35840
v_cvt_pk_bf16_f32 v149,v150,v151
M v[88:91],a[244:247],a[192:195],v[88:91]
ds_read_b128 a[192:195],v245 offset:36352
ds_write2st64_b64 v249,v[144:145],v[148:149] offset0:68 offset1:72
M v[92:95],a[244:247],a[196:199],v[92:95]
s_waitcnt vmcnt(25) lgkmcnt(7)
ds_read_b128 a[196:199],v246 offset:36352
v_cvt_pk_bf16_f32 v152,v152,v153
M v[32:35],a[140:143],a[200:203],v[32:35]
s_waitcnt lgkmcnt(7)
s_add_u32 s34,s33,6291456
buffer_store_dwordx4 v[96:99],v248,s[24:27],s34 offen offset:1152 nt
M v[36:39],a[140:143],a[204:207],v[36:39]
s_waitcnt lgkmcnt(6)
v_cvt_pk_bf16_f32 v153,v154,v155
v_cvt_pk_bf16_f32 v156,v156,v157
M v[40:43],a[140:143],a[208:211],v[40:43]
s_waitcnt lgkmcnt(5)
buffer_load_dwordx4 v[224:227],v247,s[20:23],s48 offen offset:0 sc1
M v[44:47],a[140:143],a[212:215],v[44:47]
s_waitcnt lgkmcnt(4)
v_cvt_pk_bf16_f32 v157,v158,v159
M v[48:51],a[140:143],a[216:219],v[48:51]
s_waitcnt lgkmcnt(3)
ds_write2st64_b64 v249,v[152:153],v[156:157] offset0:76 offset1:80
M v[52:55],a[140:143],a[220:223],v[52:55]
s_waitcnt lgkmcnt(3)
M v[56:59],a[140:143],a[192:195],v[56:59]
s_waitcnt lgkmcnt(1)
M v[60:63],a[140:143],a[196:199],v[60:63]
s_waitcnt vmcnt(26) lgkmcnt(0)
s_barrier
ds_read_b128 v[128:131],v247 offset:8704
M v[64:67],a[248:251],a[200:203],v[64:67]
ds_read_b128 v[136:139],v247 offset:12800
ds_read_b128 v[144:147],v247 offset:34816
M v[68:71],a[248:251],a[204:207],v[68:71]
ds_read_b128 v[152:155],v247 offset:38912
ds_read_b128 a[200:203],v246 offset:36864
M v[72:75],a[248:251],a[208:211],v[72:75]
buffer_load_dwordx4 a[228:231],v247,s[20:23],s47 offen offset:1024 sc1
M v[76:79],a[248:251],a[212:215],v[76:79]
M v[80:83],a[248:251],a[216:219],v[80:83]
M v[84:87],a[248:251],a[220:223],v[84:87]
s_waitcnt lgkmcnt(1)
s_barrier
M v[88:91],a[248:251],a[192:195],v[88:91]
M v[92:95],a[248:251],a[196:199],v[92:95]
s_waitcnt vmcnt(26)
M v[32:35],a[168:171],a[204:207],v[32:35]
M v[36:39],a[168:171],a[208:211],v[36:39]
M v[40:43],a[168:171],a[212:215],v[40:43]
buffer_load_dwordx4 a[108:111],v247,s[20:23],s48 offen offset:1024 sc1
M v[44:47],a[168:171],a[216:219],v[44:47]
M v[48:51],a[168:171],a[220:223],v[48:51]
M v[52:55],a[168:171],a[192:195],v[52:55]
M v[56:59],a[168:171],a[196:199],v[56:59]
s_waitcnt lgkmcnt(0)
s_add_u32 s34,s33,6684672
buffer_store_dwordx4 v[104:107],v248,s[24:27],s34 offen offset:1152 nt
M v[60:63],a[168:171],a[200:203],v[60:63]
s_waitcnt vmcnt(27)
M v[64:67],a[100:103],a[204:207],v[64:67]
ds_read_b128 a[204:207],v245 offset:36864
M v[68:71],a[100:103],a[208:211],v[68:71]
M v[72:75],a[100:103],a[212:215],v[72:75]
buffer_load_dwordx4 a[184:187],v247,s[20:23],s47 offen offset:2048 sc1
M v[76:79],a[100:103],a[216:219],v[76:79]
M v[80:83],a[100:103],a[220:223],v[80:83]
M v[84:87],a[100:103],a[192:195],v[84:87]
M v[88:91],a[100:103],a[196:199],v[88:91]
M v[92:95],a[100:103],a[200:203],v[92:95]
s_waitcnt vmcnt(27)
M v[32:35],a[252:255],a[208:211],v[32:35]
M v[36:39],a[252:255],a[212:215],v[36:39]
M v[40:43],a[252:255],a[216:219],v[40:43]
buffer_load_dwordx4 a[232:235],v247,s[20:23],s48 offen offset:2048 sc1
M v[44:47],a[252:255],a[220:223],v[44:47]
M v[48:51],a[252:255],a[192:195],v[48:51]
s_add_u32 s47,s81,3072
M v[52:55],a[252:255],a[196:199],v[52:55]
M v[56:59],a[252:255],a[200:203],v[56:59]
s_waitcnt lgkmcnt(0)
M v[60:63],a[252:255],a[204:207],v[60:63]
s_waitcnt vmcnt(27)
M v[64:67],a[116:119],a[208:211],v[64:67]
ds_read_b128 a[208:211],v245 offset:52224
M v[68:71],a[116:119],a[212:215],v[68:71]
ds_read_b128 a[212:215],v246 offset:52224
M v[72:75],a[116:119],a[216:219],v[72:75]
buffer_load_dwordx4 a[96:99],v247,s[20:23],s47 offen offset:0 sc1
M v[76:79],a[116:119],a[220:223],v[76:79]
ds_read_b128 a[216:219],v245 offset:52736
ds_read_b128 a[220:223],v246 offset:52736
M v[80:83],a[116:119],a[192:195],v[80:83]
s_add_u32 s48,s81,6144
ds_read_b128 a[192:195],v245 offset:53248
s_add_u32 s34,s33,7077888
M v[84:87],a[116:119],a[196:199],v[84:87]
buffer_store_dwordx4 v[112:115],v248,s[24:27],s34 offen offset:1152 nt
M v[88:91],a[116:119],a[200:203],v[88:91]
ds_read_b128 a[196:199],v246 offset:53248
ds_read_b128 a[200:203],v245 offset:53760
M v[92:95],a[116:119],a[204:207],v[92:95]
s_waitcnt vmcnt(28) lgkmcnt(6)
ds_read_b128 a[204:207],v246 offset:53760
M v[32:35],a[224:227],a[208:211],v[32:35]
s_waitcnt lgkmcnt(6)
M v[36:39],a[224:227],a[212:215],v[36:39]
s_waitcnt lgkmcnt(5)
M v[40:43],a[224:227],a[216:219],v[40:43]
s_waitcnt lgkmcnt(4)
buffer_load_dwordx4 a[128:131],v247,s[20:23],s48 offen offset:0 sc1
M v[44:47],a[224:227],a[220:223],v[44:47]
s_waitcnt lgkmcnt(3)
M v[48:51],a[224:227],a[192:195],v[48:51]
s_waitcnt lgkmcnt(2)
M v[52:55],a[224:227],a[196:199],v[52:55]
s_waitcnt lgkmcnt(1)
M v[56:59],a[224:227],a[200:203],v[56:59]
s_waitcnt lgkmcnt(0)
M v[60:63],a[224:227],a[204:207],v[60:63]
s_waitcnt vmcnt(28)
M v[64:67],v[216:219],a[208:211],v[64:67]
ds_read_b128 a[208:211],v246 offset:54272
M v[68:71],v[216:219],a[212:215],v[68:71]
M v[72:75],v[216:219],a[216:219],v[72:75]
buffer_load_dwordx4 a[160:163],v247,s[20:23],s47 offen offset:1024 sc1
M v[76:79],v[216:219],a[220:223],v[76:79]
M v[80:83],v[216:219],a[192:195],v[80:83]
M v[84:87],v[216:219],a[196:199],v[84:87]
M v[88:91],v[216:219],a[200:203],v[88:91]
M v[92:95],v[216:219],a[204:207],v[92:95]
s_waitcnt vmcnt(28)
M v[32:35],a[172:175],a[212:215],v[32:35]
M v[36:39],a[172:175],a[216:219],v[36:39]
M v[40:43],a[172:175],a[220:223],v[40:43]
s_add_u32 s34,s33,7471104
buffer_load_dwordx4 a[188:191],v247,s[20:23],s48 offen offset:1024 sc1
M v[44:47],a[172:175],a[192:195],v[44:47]
M v[48:51],a[172:175],a[196:199],v[48:51]
buffer_store_dwordx4 v[120:123],v248,s[24:27],s34 offen offset:1152 nt
M v[52:55],a[172:175],a[200:203],v[52:55]
M v[56:59],a[172:175],a[204:207],v[56:59]
s_waitcnt lgkmcnt(0)
M v[60:63],a[172:175],a[208:211],v[60:63]
s_waitcnt vmcnt(29)
M v[64:67],a[144:147],a[212:215],v[64:67]
ds_read_b128 a[212:215],v245 offset:54272
M v[68:71],a[144:147],a[216:219],v[68:71]
M v[72:75],a[144:147],a[220:223],v[72:75]
buffer_load_dwordx4 a[236:239],v247,s[20:23],s47 offen offset:2048 sc1
M v[76:79],a[144:147],a[192:195],v[76:79]
M v[80:83],a[144:147],a[196:199],v[80:83]
M v[84:87],a[144:147],a[200:203],v[84:87]
M v[88:91],a[144:147],a[204:207],v[88:91]
M v[92:95],a[144:147],a[208:211],v[92:95]
s_waitcnt vmcnt(29)
M v[32:35],v[220:223],a[216:219],v[32:35]
M v[36:39],v[220:223],a[220:223],v[36:39]
M v[40:43],v[220:223],a[192:195],v[40:43]
buffer_load_dwordx4 a[240:243],v247,s[20:23],s48 offen offset:2048 sc1
M v[44:47],v[220:223],a[196:199],v[44:47]
M v[48:51],v[220:223],a[200:203],v[48:51]
s_add_u32 s48,s76,52224
M v[52:55],v[220:223],a[204:207],v[52:55]
v_add_u32 v245,0x11000,v245
v_add_u32 v246,0x11000,v246
M v[56:59],v[220:223],a[208:211],v[56:59]
s_waitcnt lgkmcnt(0)
M v[60:63],v[220:223],a[212:215],v[60:63]
s_waitcnt vmcnt(29)
M v[64:67],a[148:151],a[216:219],v[64:67]
s_add_u32 s34,s33,6291456
buffer_store_dwordx4 v[128:131],v248,s[24:27],s34 offen offset:1280 nt
M v[68:71],a[148:151],a[220:223],v[68:71]
ds_read_b128 a[216:219],v245 offset:0
ds_read_b128 a[220:223],v246 offset:0
M v[72:75],a[148:151],a[192:195],v[72:75]
buffer_load_dwordx4 a[132:135],v247,s[20:23],s48 offen offset:0 sc1
M v[76:79],a[148:151],a[196:199],v[76:79]
ds_read_b128 a[192:195],v245 offset:512
ds_read_b128 a[196:199],v246 offset:512
M v[80:83],a[148:151],a[200:203],v[80:83]
ds_read_b128 a[200:203],v245 offset:1024
M v[84:87],a[148:151],a[204:207],v[84:87]
ds_read_b128 a[204:207],v246 offset:1024
M v[88:91],a[148:151],a[208:211],v[88:91]
ds_read_b128 a[208:211],v245 offset:1536
M v[92:95],a[148:151],a[212:215],v[92:95]
s_waitcnt vmcnt(30) lgkmcnt(6)
ds_read_b128 a[212:215],v246 offset:1536
M v[32:35],a[104:107],a[216:219],v[32:35]
s_waitcnt lgkmcnt(6)
M v[36:39],a[104:107],a[220:223],v[36:39]
s_waitcnt lgkmcnt(5)
M v[40:43],a[104:107],a[192:195],v[40:43]
s_waitcnt lgkmcnt(4)
buffer_load_dwordx4 a[164:167],v247,s[20:23],s48 offen offset:1024 sc1
M v[44:47],a[104:107],a[196:199],v[44:47]
s_waitcnt lgkmcnt(3)
M v[48:51],a[104:107],a[200:203],v[48:51]
s_waitcnt lgkmcnt(2)
M v[52:55],a[104:107],a[204:207],v[52:55]
s_waitcnt lgkmcnt(1)
M v[56:59],a[104:107],a[208:211],v[56:59]
s_waitcnt lgkmcnt(0)
M v[60:63],a[104:107],a[212:215],v[60:63]
s_waitcnt vmcnt(30)
M v[64:67],a[176:179],a[216:219],v[64:67]
ds_read_b128 a[216:219],v246 offset:2048
M v[68:71],a[176:179],a[220:223],v[68:71]
M v[72:75],a[176:179],a[192:195],v[72:75]
buffer_load_dwordx4 a[112:115],v247,s[20:23],s48 offen offset:2048 sc1
M v[76:79],a[176:179],a[196:199],v[76:79]
M v[80:83],a[176:179],a[200:203],v[80:83]
s_add_u32 s48,s77,52224
M v[84:87],a[176:179],a[204:207],v[84:87]
M v[88:91],a[176:179],a[208:211],v[88:91]
M v[92:95],a[176:179],a[212:215],v[92:95]
s_waitcnt vmcnt(29)
s_add_u32 s34,s33,6684672
buffer_store_dwordx4 v[136:139],v248,s[24:27],s34 offen offset:1280 nt
M v[32:35],a[152:155],a[220:223],v[32:35]
M v[36:39],a[152:155],a[192:195],v[36:39]
M v[40:43],a[152:155],a[196:199],v[40:43]
buffer_load_dwordx4 a[136:139],v247,s[20:23],s48 offen offset:0 sc1
M v[44:47],a[152:155],a[200:203],v[44:47]
M v[48:51],a[152:155],a[204:207],v[48:51]
M v[52:55],a[152:155],a[208:211],v[52:55]
M v[56:59],a[152:155],a[212:215],v[56:59]
s_waitcnt lgkmcnt(0)
M v[60:63],a[152:155],a[216:219],v[60:63]
s_waitcnt vmcnt(25)
M v[64:67],a[120:123],a[220:223],v[64:67]
ds_read_b128 a[220:223],v245 offset:2048
M v[68:71],a[120:123],a[192:195],v[68:71]
M v[72:75],a[120:123],a[196:199],v[72:75]
buffer_load_dwordx4 a[244:247],v247,s[20:23],s48 offen offset:1024 sc1
M v[76:79],a[120:123],a[200:203],v[76:79]
M v[80:83],a[120:123],a[204:207],v[80:83]
M v[84:87],a[120:123],a[208:211],v[84:87]
M v[88:91],a[120:123],a[212:215],v[88:91]
M v[92:95],a[120:123],a[216:219],v[92:95]
s_waitcnt vmcnt(25)
M v[32:35],a[124:127],a[192:195],v[32:35]
M v[36:39],a[124:127],a[196:199],v[36:39]
M v[40:43],a[124:127],a[200:203],v[40:43]
buffer_load_dwordx4 a[140:143],v247,s[20:23],s48 offen offset:2048 sc1
M v[44:47],a[124:127],a[204:207],v[44:47]
M v[48:51],a[124:127],a[208:211],v[48:51]
s_add_u32 s48,s78,52224
M v[52:55],a[124:127],a[212:215],v[52:55]
s_add_u32 s34,s33,7077888
buffer_store_dwordx4 v[144:147],v248,s[24:27],s34 offen offset:1280 nt
M v[56:59],a[124:127],a[216:219],v[56:59]
s_waitcnt lgkmcnt(0)
M v[60:63],a[124:127],a[220:223],v[60:63]
s_waitcnt vmcnt(25)
M v[64:67],a[180:183],a[192:195],v[64:67]
ds_read_b128 a[192:195],v245 offset:17408
M v[68:71],a[180:183],a[196:199],v[68:71]
ds_read_b128 a[196:199],v246 offset:17408
M v[72:75],a[180:183],a[200:203],v[72:75]
buffer_load_dwordx4 a[248:251],v247,s[20:23],s48 offen offset:0 sc1
M v[76:79],a[180:183],a[204:207],v[76:79]
ds_read_b128 a[200:203],v245 offset:17920
ds_read_b128 a[204:207],v246 offset:17920
M v[80:83],a[180:183],a[208:211],v[80:83]
ds_read_b128 a[208:211],v245 offset:18432
M v[84:87],a[180:183],a[212:215],v[84:87]
ds_read_b128 a[212:215],v246 offset:18432
M v[88:91],a[180:183],a[216:219],v[88:91]
ds_read_b128 a[216:219],v245 offset:18944
M v[92:95],a[180:183],a[220:223],v[92:95]
s_waitcnt vmcnt(25) lgkmcnt(6)
ds_read_b128 a[220:223],v246 offset:18944
M v[32:35],a[156:159],a[192:195],v[32:35]
s_waitcnt lgkmcnt(6)
M v[36:39],a[156:159],a[196:199],v[36:39]
s_waitcnt lgkmcnt(5)
M v[40:43],a[156:159],a[200:203],v[40:43]
s_waitcnt lgkmcnt(4)
buffer_load_dwordx4 a[168:171],v247,s[20:23],s48 offen offset:1024 sc1
M v[44:47],a[156:159],a[204:207],v[44:47]
s_waitcnt lgkmcnt(3)
M v[48:51],a[156:159],a[208:211],v[48:51]
s_waitcnt lgkmcnt(2)
M v[52:55],a[156:159],a[212:215],v[52:55]
s_waitcnt lgkmcnt(1)
M v[56:59],a[156:159],a[216:219],v[56:59]
s_waitcnt lgkmcnt(0)
M v[60:63],a[156:159],a[220:223],v[60:63]
s_waitcnt vmcnt(24)
M v[64:67],v[224:227],a[192:195],v[64:67]
ds_read_b128 a[192:195],v246 offset:19456
M v[68:71],v[224:227],a[196:199],v[68:71]
M v[72:75],v[224:227],a[200:203],v[72:75]
buffer_load_dwordx4 a[100:103],v247,s[20:23],s48 offen offset:2048 sc1
M v[76:79],v[224:227],a[204:207],v[76:79]
s_add_u32 s34,s33,7471104
M v[80:83],v[224:227],a[208:211],v[80:83]
s_add_u32 s48,s79,52224
buffer_store_dwordx4 v[152:155],v248,s[24:27],s34 offen offset:1280 nt
M v[84:87],v[224:227],a[212:215],v[84:87]
M v[88:91],v[224:227],a[216:219],v[88:91]
M v[92:95],v[224:227],a[220:223],v[92:95]
s_waitcnt vmcnt(25)
M v[32:35],a[228:231],a[196:199],v[32:35]
M v[36:39],a[228:231],a[200:203],v[36:39]
M v[40:43],a[228:231],a[204:207],v[40:43]
buffer_load_dwordx4 a[252:255],v247,s[20:23],s48 offen offset:0 sc1
M v[44:47],a[228:231],a[208:211],v[44:47]
M v[48:51],a[228:231],a[212:215],v[48:51]
M v[52:55],a[228:231],a[216:219],v[52:55]
M v[56:59],a[228:231],a[220:223],v[56:59]
s_waitcnt lgkmcnt(0)
M v[60:63],a[228:231],a[192:195],v[60:63]
s_waitcnt vmcnt(25)
M v[64:67],a[108:111],a[196:199],v[64:67]
ds_read_b128 a[196:199],v245 offset:19456
M v[68:71],a[108:111],a[200:203],v[68:71]
M v[72:75],a[108:111],a[204:207],v[72:75]
buffer_load_dwordx4 a[116:119],v247,s[20:23],s48 offen offset:1024 sc1
M v[76:79],a[108:111],a[208:211],v[76:79]
M v[80:83],a[108:111],a[212:215],v[80:83]
M v[84:87],a[108:111],a[216:219],v[84:87]
M v[88:91],a[108:111],a[220:223],v[88:91]
M v[92:95],a[108:111],a[192:195],v[92:95]
s_waitcnt vmcnt(24)
M v[32:35],a[184:187],a[200:203],v[32:35]
M v[36:39],a[184:187],a[204:207],v[36:39]
M v[40:43],a[184:187],a[208:211],v[40:43]
buffer_load_dwordx4 a[224:227],v247,s[20:23],s48 offen offset:2048 sc1
M v[44:47],a[184:187],a[212:215],v[44:47]
M v[48:51],a[184:187],a[216:219],v[48:51]
s_add_u32 s48,s80,52224
M v[52:55],a[184:187],a[220:223],v[52:55]
v_add_u32 v245,0xffff1200,v245
v_add_u32 v246,0xffff1200,v246
M v[56:59],a[184:187],a[192:195],v[56:59]
s_waitcnt lgkmcnt(0)
M v[60:63],a[184:187],a[196:199],v[60:63]
s_waitcnt vmcnt(24)
M v[64:67],a[232:235],a[200:203],v[64:67]
ds_read_b128 a[200:203],v245 offset:8704
M v[68:71],a[232:235],a[204:207],v[68:71]
ds_read_b128 a[204:207],v246 offset:8704
M v[72:75],a[232:235],a[208:211],v[72:75]
buffer_load_dwordx4 v[216:219],v247,s[20:23],s48 offen offset:0 sc1
M v[76:79],a[232:235],a[212:215],v[76:79]
ds_read_b128 a[208:211],v245 offset:9216
ds_read_b128 a[212:215],v246 offset:9216
M v[80:83],a[232:235],a[216:219],v[80:83]
ds_read_b128 a[216:219],v245 offset:9728
M v[84:87],a[232:235],a[220:223],v[84:87]
ds_read_b128 a[220:223],v246 offset:9728
M v[88:91],a[232:235],a[192:195],v[88:91]
ds_read_b128 a[192:195],v245 offset:10240
M v[92:95],a[232:235],a[196:199],v[92:95]
s_waitcnt vmcnt(24) lgkmcnt(6)
ds_read_b128 a[196:199],v246 offset:10240
M v[32:35],a[96:99],a[200:203],v[32:35]
s_waitcnt lgkmcnt(6)
M v[36:39],a[96:99],a[204:207],v[36:39]
s_waitcnt lgkmcnt(5)
M v[40:43],a[96:99],a[208:211],v[40:43]
s_waitcnt lgkmcnt(4)
buffer_load_dwordx4 a[172:175],v247,s[20:23],s48 offen offset:1024 sc1
M v[44:47],a[96:99],a[212:215],v[44:47]
s_waitcnt lgkmcnt(3)
M v[48:51],a[96:99],a[216:219],v[48:51]
s_waitcnt lgkmcnt(2)
M v[52:55],a[96:99],a[220:223],v[52:55]
s_waitcnt lgkmcnt(1)
M v[56:59],a[96:99],a[192:195],v[56:59]
s_waitcnt lgkmcnt(0)
M v[60:63],a[96:99],a[196:199],v[60:63]
s_waitcnt vmcnt(23)
M v[64:67],a[128:131],a[200:203],v[64:67]
ds_read_b128 a[200:203],v246 offset:10752
M v[68:71],a[128:131],a[204:207],v[68:71]
M v[72:75],a[128:131],a[208:211],v[72:75]
buffer_load_dwordx4 a[144:147],v247,s[20:23],s48 offen offset:2048 sc1
M v[76:79],a[128:131],a[212:215],v[76:79]
M v[80:83],a[128:131],a[216:219],v[80:83]
s_add_u32 s48,s81,52224
M v[84:87],a[128:131],a[220:223],v[84:87]
M v[88:91],a[128:131],a[192:195],v[88:91]
M v[92:95],a[128:131],a[196:199],v[92:95]
s_waitcnt vmcnt(23)
M v[32:35],a[160:163],a[204:207],v[32:35]
M v[36:39],a[160:163],a[208:211],v[36:39]
M v[40:43],a[160:163],a[212:215],v[40:43]
buffer_load_dwordx4 v[220:223],v247,s[20:23],s48 offen offset:0 sc1
M v[44:47],a[160:163],a[216:219],v[44:47]
M v[48:51],a[160:163],a[220:223],v[48:51]
M v[52:55],a[160:163],a[192:195],v[52:55]
M v[56:59],a[160:163],a[196:199],v[56:59]
s_waitcnt lgkmcnt(0)
M v[60:63],a[160:163],a[200:203],v[60:63]
s_waitcnt vmcnt(23)
M v[64:67],a[188:191],a[204:207],v[64:67]
ds_read_b128 a[204:207],v245 offset:10752
M v[68:71],a[188:191],a[208:211],v[68:71]
M v[72:75],a[188:191],a[212:215],v[72:75]
buffer_load_dwordx4 a[148:151],v247,s[20:23],s48 offen offset:1024 sc1
M v[76:79],a[188:191],a[216:219],v[76:79]
M v[80:83],a[188:191],a[220:223],v[80:83]
M v[84:87],a[188:191],a[192:195],v[84:87]
M v[88:91],a[188:191],a[196:199],v[88:91]
M v[92:95],a[188:191],a[200:203],v[92:95]
s_waitcnt vmcnt(22)
M v[32:35],a[236:239],a[208:211],v[32:35]
M v[36:39],a[236:239],a[212:215],v[36:39]
M v[40:43],a[236:239],a[216:219],v[40:43]
buffer_load_dwordx4 a[104:107],v247,s[20:23],s48 offen offset:2048 sc1
M v[44:47],a[236:239],a[220:223],v[44:47]
s_nop 3
v_cvt_pk_bf16_f32 v32,v32,v33
v_cvt_pk_bf16_f32 v33,v34,v35
M v[48:51],a[236:239],a[192:195],v[48:51]
v_cvt_pk_bf16_f32 v36,v36,v37
v_cvt_pk_bf16_f32 v37,v38,v39
M v[52:55],a[236:239],a[196:199],v[52:55]
ds_write2st64_b64 v249,v[32:33],v[36:37] offset0:34 offset1:38
M v[56:59],a[236:239],a[200:203],v[56:59]
s_waitcnt lgkmcnt(1)
v_cvt_pk_bf16_f32 v40,v40,v41
v_cvt_pk_bf16_f32 v41,v42,v43
M v[60:63],a[236:239],a[204:207],v[60:63]
s_waitcnt vmcnt(22)
v_cvt_pk_bf16_f32 v44,v44,v45
v_cvt_pk_bf16_f32 v45,v46,v47
M v[64:67],a[240:243],a[208:211],v[64:67]
ds_read_b128 a[208:211],v245 offset:0
ds_write2st64_b64 v249,v[40:41],v[44:45] offset0:42 offset1:46
M v[68:71],a[240:243],a[212:215],v[68:71]
ds_read_b128 a[212:215],v246 offset:0
v_cvt_pk_bf16_f32 v48,v48,v49
M v[72:75],a[240:243],a[216:219],v[72:75]
ds_read_b128 a[216:219],v245 offset:512
v_cvt_pk_bf16_f32 v49,v50,v51
M v[76:79],a[240:243],a[220:223],v[76:79]
ds_read_b128 a[220:223],v246 offset:512
v_cvt_pk_bf16_f32 v52,v52,v53
M v[80:83],a[240:243],a[192:195],v[80:83]
ds_read_b128 a[192:195],v245 offset:1024
v_cvt_pk_bf16_f32 v53,v54,v55
M v[84:87],a[240:243],a[196:199],v[84:87]
ds_read_b128 a[196:199],v246 offset:1024
ds_write2st64_b64 v249,v[48:49],v[52:53] offset0:51 offset1:55
M v[88:91],a[240:243],a[200:203],v[88:91]
ds_read_b128 a[200:203],v245 offset:1536
v_cvt_pk_bf16_f32 v56,v56,v57
M v[92:95],a[240:243],a[204:207],v[92:95]
s_waitcnt vmcnt(20) lgkmcnt(8)
ds_read_b128 a[204:207],v246 offset:1536
v_cvt_pk_bf16_f32 v57,v58,v59
M v[160:163],a[132:135],a[208:211],v[160:163]
s_waitcnt lgkmcnt(7)
ds_read_b128 a[208:211],v246 offset:2048
v_cvt_pk_bf16_f32 v60,v60,v61
M v[164:167],a[132:135],a[212:215],v[164:167]
s_waitcnt lgkmcnt(7)
v_cvt_pk_bf16_f32 v61,v62,v63
M v[168:171],a[132:135],a[216:219],v[168:171]
s_waitcnt lgkmcnt(6)
ds_write2st64_b64 v249,v[56:57],v[60:61] offset0:59 offset1:63
M v[172:175],a[132:135],a[220:223],v[172:175]
s_waitcnt lgkmcnt(6)
v_cvt_pk_bf16_f32 v64,v64,v65
v_cvt_pk_bf16_f32 v65,v66,v67
M v[176:179],a[132:135],a[192:195],v[176:179]
s_waitcnt lgkmcnt(5)
v_cvt_pk_bf16_f32 v68,v68,v69
v_cvt_pk_bf16_f32 v69,v70,v71
M v[180:183],a[132:135],a[196:199],v[180:183]
s_waitcnt lgkmcnt(3)
ds_write2st64_b64 v249,v[64:65],v[68:69] offset0:0 offset1:4
M v[184:187],a[132:135],a[200:203],v[184:187]
s_waitcnt lgkmcnt(3)
v_cvt_pk_bf16_f32 v72,v72,v73
v_cvt_pk_bf16_f32 v73,v74,v75
M v[188:191],a[132:135],a[204:207],v[188:191]
s_waitcnt vmcnt(19)
v_cvt_pk_bf16_f32 v76,v76,v77
v_cvt_pk_bf16_f32 v77,v78,v79
M v[160:163],a[164:167],a[212:215],v[160:163]
ds_read_b128 a[212:215],v245 offset:2048
ds_write2st64_b64 v249,v[72:73],v[76:77] offset0:8 offset1:12
M v[164:167],a[164:167],a[216:219],v[164:167]
v_cvt_pk_bf16_f32 v80,v80,v81
v_cvt_pk_bf16_f32 v81,v82,v83
M v[168:171],a[164:167],a[220:223],v[168:171]
v_cvt_pk_bf16_f32 v84,v84,v85
v_cvt_pk_bf16_f32 v85,v86,v87
M v[172:175],a[164:167],a[192:195],v[172:175]
ds_write2st64_b64 v249,v[80:81],v[84:85] offset0:17 offset1:21
M v[176:179],a[164:167],a[196:199],v[176:179]
v_cvt_pk_bf16_f32 v88,v88,v89
v_cvt_pk_bf16_f32 v89,v90,v91
M v[180:183],a[164:167],a[200:203],v[180:183]
v_cvt_pk_bf16_f32 v92,v92,v93
v_cvt_pk_bf16_f32 v93,v94,v95
M v[184:187],a[164:167],a[204:207],v[184:187]
s_waitcnt lgkmcnt(5)
ds_write2st64_b64 v249,v[88:89],v[92:93] offset0:25 offset1:29
M v[188:191],a[164:167],a[208:211],v[188:191]
s_waitcnt vmcnt(18)
M v[160:163],a[112:115],a[216:219],v[160:163]
ds_read_b128 a[216:219],v245 offset:34816
M v[164:167],a[112:115],a[220:223],v[164:167]
s_waitcnt lgkmcnt(1)
s_barrier
ds_read_b128 v[32:35],v247 offset:17408
M v[168:171],a[112:115],a[192:195],v[168:171]
ds_read_b128 v[40:43],v247 offset:21504
ds_read_b128 v[48:51],v247 offset:26112
M v[172:175],a[112:115],a[196:199],v[172:175]
ds_read_b128 v[56:59],v247 offset:30208
ds_read_b128 v[64:67],v247 offset:0
M v[176:179],a[112:115],a[200:203],v[176:179]
ds_read_b128 v[72:75],v247 offset:4096
ds_read_b128 v[80:83],v247 offset:8704
ds_read_b128 a[220:223],v246 offset:34816
M v[180:183],a[112:115],a[204:207],v[180:183]
ds_read_b128 v[88:91],v247 offset:12800
ds_read_b128 a[192:195],v245 offset:35328
M v[184:187],a[112:115],a[208:211],v[184:187]
s_waitcnt lgkmcnt(9)
s_add_u32 s34,s33,6291456
buffer_store_dwordx4 v[32:35],v248,s[24:27],s34 offen offset:128 nt
ds_read_b128 a[196:199],v246 offset:35328
M v[188:191],a[112:115],a[212:215],v[188:191]
s_waitcnt vmcnt(17) lgkmcnt(9)
s_add_u32 s34,s33,6684672
buffer_store_dwordx4 v[40:43],v248,s[24:27],s34 offen offset:128 nt
ds_read_b128 a[200:203],v245 offset:35840
M v[160:163],a[136:139],a[216:219],v[160:163]
s_waitcnt lgkmcnt(4)
s_add_u32 s34,s33,7077888
ds_read_b128 a[204:207],v246 offset:35840
ds_read_b128 a[208:211],v245 offset:36352
M v[164:167],a[136:139],a[220:223],v[164:167]
s_waitcnt lgkmcnt(4)
ds_read_b128 a[212:215],v246 offset:36352
ds_read_b128 a[216:219],v246 offset:36864
M v[168:171],a[136:139],a[192:195],v[168:171]
s_waitcnt lgkmcnt(5)
buffer_store_dwordx4 v[48:51],v248,s[24:27],s34 offen offset:128 nt
M v[172:175],a[136:139],a[196:199],v[172:175]
s_waitcnt lgkmcnt(4)
s_add_u32 s34,s33,7471104
M v[176:179],a[136:139],a[200:203],v[176:179]
s_waitcnt lgkmcnt(3)
M v[180:183],a[136:139],a[204:207],v[180:183]
s_waitcnt lgkmcnt(2)
buffer_store_dwordx4 v[56:59],v248,s[24:27],s34 offen offset:128 nt
M v[184:187],a[136:139],a[208:211],v[184:187]
s_waitcnt lgkmcnt(1)
s_add_u32 s34,s33,6291456
M v[188:191],a[136:139],a[212:215],v[188:191]
s_waitcnt vmcnt(19)
M v[160:163],a[244:247],a[220:223],v[160:163]
buffer_store_dwordx4 v[64:67],v248,s[24:27],s34 offen offset:256 nt
M v[164:167],a[244:247],a[192:195],v[164:167]
ds_read_b128 a[220:223],v245 offset:36864
M v[168:171],a[244:247],a[196:199],v[168:171]
M v[172:175],a[244:247],a[200:203],v[172:175]
M v[176:179],a[244:247],a[204:207],v[176:179]
M v[180:183],a[244:247],a[208:211],v[180:183]
M v[184:187],a[244:247],a[212:215],v[184:187]
s_waitcnt lgkmcnt(1)
M v[188:191],a[244:247],a[216:219],v[188:191]
s_waitcnt vmcnt(19)
M v[160:163],a[140:143],a[192:195],v[160:163]
ds_read_b128 a[192:195],v245 offset:52224
M v[164:167],a[140:143],a[196:199],v[164:167]
ds_read_b128 a[196:199],v246 offset:52224
M v[168:171],a[140:143],a[200:203],v[168:171]
ds_read_b128 a[200:203],v245 offset:52736
M v[172:175],a[140:143],a[204:207],v[172:175]
ds_read_b128 a[204:207],v246 offset:52736
M v[176:179],a[140:143],a[208:211],v[176:179]
ds_read_b128 a[208:211],v245 offset:53248
M v[180:183],a[140:143],a[212:215],v[180:183]
ds_read_b128 a[212:215],v246 offset:53248
M v[184:187],a[140:143],a[216:219],v[184:187]
s_waitcnt lgkmcnt(6)
ds_read_b128 a[216:219],v245 offset:53760
M v[188:191],a[140:143],a[220:223],v[188:191]
s_waitcnt vmcnt(17) lgkmcnt(6)
s_add_u32 s34,s33,6684672
buffer_store_dwordx4 v[72:75],v248,s[24:27],s34 offen offset:256 nt
M v[160:163],a[248:251],a[192:195],v[160:163]
s_waitcnt lgkmcnt(5)
ds_read_b128 a[220:223],v246 offset:53760
ds_read_b128 a[192:195],v246 offset:54272
M v[164:167],a[248:251],a[196:199],v[164:167]
s_waitcnt lgkmcnt(6)
M v[168:171],a[248:251],a[200:203],v[168:171]
s_waitcnt lgkmcnt(5)
M v[172:175],a[248:251],a[204:207],v[172:175]
s_waitcnt lgkmcnt(4)
M v[176:179],a[248:251],a[208:211],v[176:179]
s_waitcnt lgkmcnt(3)
M v[180:183],a[248:251],a[212:215],v[180:183]
s_waitcnt lgkmcnt(2)
M v[184:187],a[248:251],a[216:219],v[184:187]
s_waitcnt lgkmcnt(1)
M v[188:191],a[248:251],a[220:223],v[188:191]
s_waitcnt vmcnt(17)
M v[160:163],a[168:171],a[196:199],v[160:163]
ds_read_b128 a[196:199],v245 offset:54272
M v[164:167],a[168:171],a[200:203],v[164:167]
M v[168:171],a[168:171],a[204:207],v[168:171]
M v[172:175],a[168:171],a[208:211],v[172:175]
M v[176:179],a[168:171],a[212:215],v[176:179]
M v[180:183],a[168:171],a[216:219],v[180:183]
v_add_u32 v245,0x11000,v245
v_add_u32 v246,0x11000,v246
M v[184:187],a[168:171],a[220:223],v[184:187]
s_waitcnt lgkmcnt(1)
M v[188:191],a[168:171],a[192:195],v[188:191]
s_waitcnt vmcnt(16)
M v[160:163],a[100:103],a[200:203],v[160:163]
ds_read_b128 a[200:203],v245 offset:0
M v[164:167],a[100:103],a[204:207],v[164:167]
ds_read_b128 a[204:207],v246 offset:0
M v[168:171],a[100:103],a[208:211],v[168:171]
ds_read_b128 a[208:211],v245 offset:512
M v[172:175],a[100:103],a[212:215],v[172:175]
ds_read_b128 a[212:215],v246 offset:512
M v[176:179],a[100:103],a[216:219],v[176:179]
ds_read_b128 a[216:219],v245 offset:1024
M v[180:183],a[100:103],a[220:223],v[180:183]
s_add_u32 s34,s33,7077888
buffer_store_dwordx4 v[80:83],v248,s[24:27],s34 offen offset:256 nt
M v[184:187],a[100:103],a[192:195],v[184:187]
s_waitcnt lgkmcnt(5)
ds_read_b128 a[220:223],v246 offset:1024
ds_read_b128 a[192:195],v245 offset:1536
M v[188:191],a[100:103],a[196:199],v[188:191]
s_waitcnt vmcnt(15) lgkmcnt(6)
ds_read_b128 a[196:199],v246 offset:1536
M v[160:163],a[252:255],a[200:203],v[160:163]
s_waitcnt lgkmcnt(6)
ds_read_b128 a[200:203],v246 offset:2048
M v[164:167],a[252:255],a[204:207],v[164:167]
s_waitcnt lgkmcnt(6)
M v[168:171],a[252:255],a[208:211],v[168:171]
s_waitcnt lgkmcnt(5)
M v[172:175],a[252:255],a[212:215],v[172:175]
s_waitcnt lgkmcnt(4)
M v[176:179],a[252:255],a[216:219],v[176:179]
s_waitcnt lgkmcnt(3)
M v[180:183],a[252:255],a[220:223],v[180:183]
s_waitcnt lgkmcnt(2)
M v[184:187],a[252:255],a[192:195],v[184:187]
s_waitcnt lgkmcnt(1)
M v[188:191],a[252:255],a[196:199],v[188:191]
s_waitcnt vmcnt(14)
M v[160:163],a[116:119],a[204:207],v[160:163]
ds_read_b128 a[204:207],v245 offset:2048
M v[164:167],a[116:119],a[208:211],v[164:167]
M v[168:171],a[116:119],a[212:215],v[168:171]
M v[172:175],a[116:119],a[216:219],v[172:175]
M v[176:179],a[116:119],a[220:223],v[176:179]
M v[180:183],a[116:119],a[192:195],v[180:183]
M v[184:187],a[116:119],a[196:199],v[184:187]
s_waitcnt lgkmcnt(1)
M v[188:191],a[116:119],a[200:203],v[188:191]
s_waitcnt vmcnt(13)
M v[160:163],a[224:227],a[208:211],v[160:163]
ds_read_b128 a[208:211],v245 offset:17408
M v[164:167],a[224:227],a[212:215],v[164:167]
ds_read_b128 a[212:215],v246 offset:17408
M v[168:171],a[224:227],a[216:219],v[168:171]
ds_read_b128 a[216:219],v245 offset:17920
M v[172:175],a[224:227],a[220:223],v[172:175]
s_add_u32 s34,s33,7471104
buffer_store_dwordx4 v[88:91],v248,s[24:27],s34 offen offset:256 nt
M v[176:179],a[224:227],a[192:195],v[176:179]
ds_read_b128 a[220:223],v246 offset:17920
ds_read_b128 a[192:195],v245 offset:18432
M v[180:183],a[224:227],a[196:199],v[180:183]
ds_read_b128 a[196:199],v246 offset:18432
M v[184:187],a[224:227],a[200:203],v[184:187]
s_waitcnt lgkmcnt(6)
ds_read_b128 a[200:203],v245 offset:18944
M v[188:191],a[224:227],a[204:207],v[188:191]
s_waitcnt vmcnt(13) lgkmcnt(6)
ds_read_b128 a[204:207],v246 offset:18944
M v[160:163],v[216:219],a[208:211],v[160:163]
s_waitcnt lgkmcnt(6)
ds_read_b128 a[208:211],v246 offset:19456
M v[164:167],v[216:219],a[212:215],v[164:167]
s_waitcnt lgkmcnt(6)
M v[168:171],v[216:219],a[216:219],v[168:171]
s_waitcnt lgkmcnt(5)
M v[172:175],v[216:219],a[220:223],v[172:175]
s_waitcnt lgkmcnt(4)
M v[176:179],v[216:219],a[192:195],v[176:179]
s_waitcnt lgkmcnt(3)
M v[180:183],v[216:219],a[196:199],v[180:183]
s_waitcnt lgkmcnt(2)
M v[184:187],v[216:219],a[200:203],v[184:187]
s_waitcnt lgkmcnt(1)
M v[188:191],v[216:219],a[204:207],v[188:191]
s_waitcnt vmcnt(12)
M v[160:163],a[172:175],a[212:215],v[160:163]
ds_read_b128 a[212:215],v245 offset:19456
M v[164:167],a[172:175],a[216:219],v[164:167]
M v[168:171],a[172:175],a[220:223],v[168:171]
M v[172:175],a[172:175],a[192:195],v[172:175]
M v[176:179],a[172:175],a[196:199],v[176:179]
M v[180:183],a[172:175],a[200:203],v[180:183]
v_add_u32 v245,0xffff3400,v245
v_add_u32 v246,0xffff3400,v246
M v[184:187],a[172:175],a[204:207],v[184:187]
s_waitcnt lgkmcnt(1)
M v[188:191],a[172:175],a[208:211],v[188:191]
s_waitcnt vmcnt(11)
M v[160:163],a[144:147],a[216:219],v[160:163]
ds_read_b128 a[216:219],v245 offset:0
M v[164:167],a[144:147],a[220:223],v[164:167]
ds_read_b128 a[220:223],v246 offset:0
M v[168:171],a[144:147],a[192:195],v[168:171]
ds_read_b128 a[192:195],v245 offset:512
M v[172:175],a[144:147],a[196:199],v[172:175]
ds_read_b128 a[196:199],v246 offset:512
M v[176:179],a[144:147],a[200:203],v[176:179]
ds_read_b128 a[200:203],v245 offset:1024
M v[180:183],a[144:147],a[204:207],v[180:183]
ds_read_b128 a[204:207],v246 offset:1024
M v[184:187],a[144:147],a[208:211],v[184:187]
s_waitcnt lgkmcnt(6)
ds_read_b128 a[208:211],v245 offset:1536
M v[188:191],a[144:147],a[212:215],v[188:191]
s_waitcnt vmcnt(10) lgkmcnt(6)
ds_read_b128 a[212:215],v246 offset:1536
M v[160:163],v[220:223],a[216:219],v[160:163]
s_waitcnt lgkmcnt(6)
ds_read_b128 a[216:219],v246 offset:2048
M v[164:167],v[220:223],a[220:223],v[164:167]
s_waitcnt lgkmcnt(6)
M v[168:171],v[220:223],a[192:195],v[168:171]
s_waitcnt lgkmcnt(5)
M v[172:175],v[220:223],a[196:199],v[172:175]
s_waitcnt lgkmcnt(4)
M v[176:179],v[220:223],a[200:203],v[176:179]
s_waitcnt lgkmcnt(3)
M v[180:183],v[220:223],a[204:207],v[180:183]
s_waitcnt lgkmcnt(2)
M v[184:187],v[220:223],a[208:211],v[184:187]
s_waitcnt lgkmcnt(1)
M v[188:191],v[220:223],a[212:215],v[188:191]
s_waitcnt vmcnt(9)
M v[160:163],a[148:151],a[220:223],v[160:163]
ds_read_b128 a[220:223],v245 offset:2048
M v[164:167],a[148:151],a[192:195],v[164:167]
M v[168:171],a[148:151],a[196:199],v[168:171]
M v[172:175],a[148:151],a[200:203],v[172:175]
M v[176:179],a[148:151],a[204:207],v[176:179]
M v[180:183],a[148:151],a[208:211],v[180:183]
M v[184:187],a[148:151],a[212:215],v[184:187]
s_waitcnt lgkmcnt(1)
M v[188:191],a[148:151],a[216:219],v[188:191]
s_waitcnt vmcnt(8)
M v[160:163],a[104:107],a[192:195],v[160:163]
M v[164:167],a[104:107],a[196:199],v[164:167]
M v[168:171],a[104:107],a[200:203],v[168:171]
M v[172:175],a[104:107],a[204:207],v[172:175]
s_nop 4
v_cvt_pk_bf16_f32 v160,v160,v161
v_cvt_pk_bf16_f32 v161,v162,v163
M v[176:179],a[104:107],a[208:211],v[176:179]
v_cvt_pk_bf16_f32 v164,v164,v165
v_cvt_pk_bf16_f32 v165,v166,v167
M v[180:183],a[104:107],a[212:215],v[180:183]
ds_write2st64_b64 v249,v[160:161],v[164:165] offset0:68 offset1:72
M v[184:187],a[104:107],a[216:219],v[184:187]
s_waitcnt lgkmcnt(1)
v_cvt_pk_bf16_f32 v168,v168,v169
v_cvt_pk_bf16_f32 v169,v170,v171
M v[188:191],a[104:107],a[220:223],v[188:191]
v_cvt_pk_bf16_f32 v172,v172,v173
v_cvt_pk_bf16_f32 v173,v174,v175
ds_write2st64_b64 v249,v[168:169],v[172:173] offset0:76 offset1:80
v_cvt_pk_bf16_f32 v176,v176,v177
v_cvt_pk_bf16_f32 v177,v178,v179
v_cvt_pk_bf16_f32 v180,v180,v181
v_cvt_pk_bf16_f32 v181,v182,v183
ds_write2st64_b64 v249,v[176:177],v[180:181] offset0:85 offset1:89
v_cvt_pk_bf16_f32 v184,v184,v185
v_cvt_pk_bf16_f32 v185,v186,v187
v_cvt_pk_bf16_f32 v188,v188,v189
v_cvt_pk_bf16_f32 v189,v190,v191
ds_write2st64_b64 v249,v[184:185],v[188:189] offset0:93 offset1:97
s_waitcnt lgkmcnt(0)
s_barrier
ds_read_b128 v[160:163],v247 offset:34816
ds_read_b128 v[168:171],v247 offset:38912
ds_read_b128 v[176:179],v247 offset:43520
ds_read_b128 v[184:187],v247 offset:47616
s_add_u32 s34,s33,6291456
s_waitcnt lgkmcnt(3)
buffer_store_dwordx4 v[160:163],v248,s[24:27],s34 offen offset:1408 nt
s_add_u32 s34,s33,6684672
s_waitcnt lgkmcnt(2)
buffer_store_dwordx4 v[168:171],v248,s[24:27],s34 offen offset:1408 nt
s_add_u32 s34,s33,7077888
s_waitcnt lgkmcnt(1)
buffer_store_dwordx4 v[176:179],v248,s[24:27],s34 offen offset:1408 nt
s_add_u32 s34,s33,7471104
s_waitcnt lgkmcnt(0)
buffer_store_dwordx4 v[184:187],v248,s[24:27],s34 offen offset:1408 nt
s_endpgm
L_code_end:
L_fallback:
s_mov_b32 s84,0
L_itemF:
s_and_b32 s85,s84,3
s_lshr_b32 s86,s84,2
s_mul_hi_u32 s87,s86,0x55555556
s_mul_i32 s88,s87,3
s_sub_u32 s86,s86,s88
s_mul_hi_u32 s88,s87,0x2aaaaaab
s_mul_i32 s89,s88,6
s_sub_u32 s87,s87,s89
s_mul_i32 s89,s86,221184
s_mul_i32 s90,s87,12288
s_add_u32 s89,s89,s90
s_mul_i32 s90,s85,3072
s_add_u32 s89,s89,s90
s_lshl_b32 s90,s88,7
s_add_u32 s89,s89,s90
s_add_u32 s90,s89,73728
s_add_u32 s91,s90,73728
v_lshlrev_b32 v149,1,v64
buffer_load_short_d16_hi v68,v149,s[36:39],s89 offen offset:0
buffer_load_short_d16_hi v69,v149,s[36:39],s89 offen offset:384
buffer_load_short_d16_hi v70,v149,s[36:39],s89 offen offset:768
buffer_load_short_d16_hi v71,v149,s[36:39],s89 offen offset:1152
buffer_load_short_d16_hi v72,v149,s[36:39],s89 offen offset:1536
buffer_load_short_d16_hi v73,v149,s[36:39],s89 offen offset:1920
buffer_load_short_d16_hi v74,v149,s[36:39],s89 offen offset:2304
buffer_load_short_d16_hi v75,v149,s[36:39],s89 offen offset:2688
buffer_load_short_d16_hi v76,v149,s[36:39],s90 offen offset:0
buffer_load_short_d16_hi v77,v149,s[36:39],s90 offen offset:384
buffer_load_short_d16_hi v78,v149,s[36:39],s90 offen offset:768
buffer_load_short_d16_hi v79,v149,s[36:39],s90 offen offset:1152
buffer_load_short_d16_hi v80,v149,s[36:39],s90 offen offset:1536
buffer_load_short_d16_hi v81,v149,s[36:39],s90 offen offset:1920
buffer_load_short_d16_hi v82,v149,s[36:39],s90 offen offset:2304
buffer_load_short_d16_hi v83,v149,s[36:39],s90 offen offset:2688
buffer_load_short_d16_hi v84,v149,s[36:39],s91 offen offset:0
buffer_load_short_d16_hi v85,v149,s[36:39],s91 offen offset:384
buffer_load_short_d16_hi v86,v149,s[36:39],s91 offen offset:768
buffer_load_short_d16_hi v87,v149,s[36:39],s91 offen offset:1152
buffer_load_short_d16_hi v88,v149,s[36:39],s91 offen offset:1536
buffer_load_short_d16_hi v89,v149,s[36:39],s91 offen offset:1920
buffer_load_short_d16_hi v90,v149,s[36:39],s91 offen offset:2304
buffer_load_short_d16_hi v91,v149,s[36:39],s91 offen offset:2688
v_lshrrev_b32 v150,4,v64
v_mul_u32_u24 v150,331776,v150
v_and_b32 v148,15,v64
v_lshl_add_u32 v150,v148,4,v150
s_mul_i32 s87,s87,55296
s_mul_i32 s88,s88,3072
s_add_u32 s87,s87,s88
s_lshl_b32 s86,s86,10
s_add_u32 s87,s87,s86
s_lshl_b32 s85,s85,8
s_add_u32 s87,s87,s85
s_mov_b32 s85,0xbe2aaaab
s_mov_b32 s86,0x3d2aaaab
s_mov_b32 s88,0x3e2aaaab
s_mov_b32 s92,0x3daaaaab
s_waitcnt vmcnt(0)
v_add_f32 v148,v68,v84
v_add_f32 v92,v148,v76
v_sub_f32 v100,v148,v76
v_mul_f32 v92,s85,v92
v_mul_f32 v100,s85,v100
v_mul_f32 v148,s86,v68
v_fmac_f32 v148,s88,v84
v_fma_f32 v108,s92,v76,v148
v_fma_f32 v116,-s92,v76,v148
v_add_f32 v148,v69,v85
v_add_f32 v93,v148,v77
v_sub_f32 v101,v148,v77
v_mul_f32 v93,s85,v93
v_mul_f32 v101,s85,v101
v_mul_f32 v148,s86,v69
v_fmac_f32 v148,s88,v85
v_fma_f32 v109,s92,v77,v148
v_fma_f32 v117,-s92,v77,v148
v_add_f32 v148,v70,v86
v_add_f32 v94,v148,v78
v_sub_f32 v102,v148,v78
v_mul_f32 v94,s85,v94
v_mul_f32 v102,s85,v102
v_mul_f32 v148,s86,v70
v_fmac_f32 v148,s88,v86
v_fma_f32 v110,s92,v78,v148
v_fma_f32 v118,-s92,v78,v148
v_add_f32 v148,v71,v87
v_add_f32 v95,v148,v79
v_sub_f32 v103,v148,v79
v_mul_f32 v95,s85,v95
v_mul_f32 v103,s85,v103
v_mul_f32 v148,s86,v71
v_fmac_f32 v148,s88,v87
v_fma_f32 v111,s92,v79,v148
v_fma_f32 v119,-s92,v79,v148
v_add_f32 v148,v72,v88
v_add_f32 v96,v148,v80
v_sub_f32 v104,v148,v80
v_mul_f32 v96,s85,v96
v_mul_f32 v104,s85,v104
v_mul_f32 v148,s86,v72
v_fmac_f32 v148,s88,v88
v_fma_f32 v112,s92,v80,v148
v_fma_f32 v120,-s92,v80,v148
v_add_f32 v148,v73,v89
v_add_f32 v97,v148,v81
v_sub_f32 v105,v148,v81
v_mul_f32 v97,s85,v97
v_mul_f32 v105,s85,v105
v_mul_f32 v148,s86,v73
v_fmac_f32 v148,s88,v89
v_fma_f32 v113,s92,v81,v148
v_fma_f32 v121,-s92,v81,v148
v_add_f32 v148,v74,v90
v_add_f32 v98,v148,v82
v_sub_f32 v106,v148,v82
v_mul_f32 v98,s85,v98
v_mul_f32 v106,s85,v106
v_mul_f32 v148,s86,v74
v_fmac_f32 v148,s88,v90
v_fma_f32 v114,s92,v82,v148
v_fma_f32 v122,-s92,v82,v148
v_add_f32 v148,v75,v91
v_add_f32 v99,v148,v83
v_sub_f32 v107,v148,v83
v_mul_f32 v99,s85,v99
v_mul_f32 v107,s85,v107
v_mul_f32 v148,s86,v75
v_fmac_f32 v148,s88,v91
v_fma_f32 v115,s92,v83,v148
v_fma_f32 v123,-s92,v83,v148
v_cvt_pk_bf16_f32 v124,v68,v69
v_cvt_pk_bf16_f32 v125,v70,v71
v_cvt_pk_bf16_f32 v126,v72,v73
v_cvt_pk_bf16_f32 v127,v74,v75
s_add_u32 s89,s87,0
buffer_store_dwordx4 v[124:127],v150,s[20:23],s89 offen sc1
v_cvt_pk_bf16_f32 v144,v84,v85
v_cvt_pk_bf16_f32 v145,v86,v87
v_cvt_pk_bf16_f32 v146,v88,v89
v_cvt_pk_bf16_f32 v147,v90,v91
s_add_u32 s89,s87,46080
buffer_store_dwordx4 v[144:147],v150,s[20:23],s89 offen sc1
v_cvt_pk_bf16_f32 v128,v92,v93
v_cvt_pk_bf16_f32 v129,v94,v95
v_cvt_pk_bf16_f32 v130,v96,v97
v_cvt_pk_bf16_f32 v131,v98,v99
s_add_u32 s89,s87,9216
buffer_store_dwordx4 v[128:131],v150,s[20:23],s89 offen sc1
v_cvt_pk_bf16_f32 v132,v100,v101
v_cvt_pk_bf16_f32 v133,v102,v103
v_cvt_pk_bf16_f32 v134,v104,v105
v_cvt_pk_bf16_f32 v135,v106,v107
s_add_u32 s89,s87,18432
buffer_store_dwordx4 v[132:135],v150,s[20:23],s89 offen sc1
v_cvt_pk_bf16_f32 v136,v108,v109
v_cvt_pk_bf16_f32 v137,v110,v111
v_cvt_pk_bf16_f32 v138,v112,v113
v_cvt_pk_bf16_f32 v139,v114,v115
s_add_u32 s89,s87,27648
buffer_store_dwordx4 v[136:139],v150,s[20:23],s89 offen sc1
v_cvt_pk_bf16_f32 v140,v116,v117
v_cvt_pk_bf16_f32 v141,v118,v119
v_cvt_pk_bf16_f32 v142,v120,v121
v_cvt_pk_bf16_f32 v143,v122,v123
s_add_u32 s89,s87,36864
buffer_store_dwordx4 v[140:143],v150,s[20:23],s89 offen sc1
s_waitcnt vmcnt(0)
s_add_u32 s84,s84,1
s_cmp_lt_u32 s84,216
s_cbranch_scc1 L_itemF
s_branch L_uready
.section .rodata,"a"
.p2align 6
.amdhsa_kernel standalone__winograd__vision_kernel
  .amdhsa_next_free_vgpr 512
  .amdhsa_next_free_sgpr 96
  .amdhsa_accum_offset 256
  .amdhsa_group_segment_fixed_size 0
  .amdhsa_kernarg_size 40
  .amdhsa_user_sgpr_count 2
  .amdhsa_user_sgpr_kernarg_segment_ptr 1
  .amdhsa_system_sgpr_workgroup_id_x 1
  .amdhsa_float_denorm_mode_32 3
.end_amdhsa_kernel
```

```asm
; @launch grid=(256,1,1) block=(256,1,1) lds=156672
.amdgcn_target "amdgcn-amd-amdhsa--gfx950"
.macro M d,a,b,c
v_mfma_f32_16x16x32_bf16 \d,\a,\b,\c
.endm
.text
.globl standalone__winograd__vision_kernel
.p2align 8
.type standalone__winograd__vision_kernel,@function
standalone__winograd__vision_kernel:
s_cmp_ge_u32 s2,256
s_cbranch_scc0 L_go
s_endpgm
L_go:
s_load_dwordx4 s[4:7],s[0:1],0
s_load_dwordx4 s[24:27],s[0:1],16
s_load_dwordx2 s[20:21],s[0:1],32
v_lshrrev_b32 v160,6,v0
v_and_b32 v164,63,v0
v_readfirstlane_b32 s50,v160
v_lshrrev_b32 v160,4,v164
v_bfe_u32 v161,v164,3,1
v_lshl_add_u32 v161,v160,3,v161
v_and_b32 v162,7,v164
v_mul_u32_u24 v245,196608,v161
v_lshl_add_u32 v245,v162,3,v245
v_lshlrev_b32 v251,4,v0
s_and_b32 s54,s2,7
s_lshr_b32 s55,s2,3
s_lshl_b32 s49,s54,6
s_lshl_b32 s55,s55,4
s_lshl_b32 s56,s50,2
s_add_u32 s56,s56,s55
s_mul_i32 s30,s56,384
s_mul_i32 s57,s49,196608
s_add_u32 s30,s30,s57
s_cmp_eq_u32 s49,0
s_cselect_b32 s58,8,0
v_cmp_gt_u32 vcc,s58,v164
v_lshrrev_b32 v163,5,v164
v_add_u32 v163,32,v163
v_mul_u32_u24 v246,196608,v163
v_bfrev_b32 v163,1
v_cndmask_b32 v254,v245,v163,vcc
v_bfe_u32 v163,v251,3,6
v_add_u32 v246,v246,v163
v_mov_b32 v166,1
s_mov_b32 s38,663552
s_mov_b32 s39,0x20000
s_mov_b32 s62,0
s_mov_b32 s63,0x20000
s_mov_b32 s22,1327104
s_mov_b32 s23,0x20000
s_waitcnt lgkmcnt(0)
s_and_b32 s21,s21,0xffff
s_mov_b32 s36,s6
s_and_b32 s37,s7,0xffff
s_mov_b32 s60,s26
s_and_b32 s61,s27,0xffff
s_mov_b32 s52,s26
s_mov_b32 s53,s27
s_cmp_lt_u32 s2,54
s_cbranch_scc0 L_noitem
s_lshl_b32 s84,s2,2
s_add_u32 s84,s84,s50
s_mov_b32 s62,256
L_itemP:
s_and_b32 s85,s84,3
s_lshr_b32 s86,s84,2
s_mul_hi_u32 s87,s86,0x55555556
s_mul_i32 s88,s87,3
s_sub_u32 s86,s86,s88
s_mul_hi_u32 s88,s87,0x2aaaaaab
s_mul_i32 s89,s88,6
s_sub_u32 s87,s87,s89
s_mul_i32 s89,s86,221184
s_mul_i32 s90,s87,12288
s_add_u32 s89,s89,s90
s_mul_i32 s90,s85,3072
s_add_u32 s89,s89,s90
s_lshl_b32 s90,s88,7
s_add_u32 s89,s89,s90
s_add_u32 s90,s89,73728
s_add_u32 s91,s90,73728
v_lshlrev_b32 v149,1,v164
buffer_load_short_d16_hi v68,v149,s[36:39],s89 offen offset:0
buffer_load_short_d16_hi v69,v149,s[36:39],s89 offen offset:384
buffer_load_short_d16_hi v70,v149,s[36:39],s89 offen offset:768
buffer_load_short_d16_hi v71,v149,s[36:39],s89 offen offset:1152
buffer_load_short_d16_hi v72,v149,s[36:39],s89 offen offset:1536
buffer_load_short_d16_hi v73,v149,s[36:39],s89 offen offset:1920
buffer_load_short_d16_hi v74,v149,s[36:39],s89 offen offset:2304
buffer_load_short_d16_hi v75,v149,s[36:39],s89 offen offset:2688
buffer_load_short_d16_hi v76,v149,s[36:39],s90 offen offset:0
buffer_load_short_d16_hi v77,v149,s[36:39],s90 offen offset:384
buffer_load_short_d16_hi v78,v149,s[36:39],s90 offen offset:768
buffer_load_short_d16_hi v79,v149,s[36:39],s90 offen offset:1152
buffer_load_short_d16_hi v80,v149,s[36:39],s90 offen offset:1536
buffer_load_short_d16_hi v81,v149,s[36:39],s90 offen offset:1920
buffer_load_short_d16_hi v82,v149,s[36:39],s90 offen offset:2304
buffer_load_short_d16_hi v83,v149,s[36:39],s90 offen offset:2688
buffer_load_short_d16_hi v84,v149,s[36:39],s91 offen offset:0
buffer_load_short_d16_hi v85,v149,s[36:39],s91 offen offset:384
buffer_load_short_d16_hi v86,v149,s[36:39],s91 offen offset:768
buffer_load_short_d16_hi v87,v149,s[36:39],s91 offen offset:1152
buffer_load_short_d16_hi v88,v149,s[36:39],s91 offen offset:1536
buffer_load_short_d16_hi v89,v149,s[36:39],s91 offen offset:1920
buffer_load_short_d16_hi v90,v149,s[36:39],s91 offen offset:2304
buffer_load_short_d16_hi v91,v149,s[36:39],s91 offen offset:2688
v_lshrrev_b32 v150,4,v164
v_mul_u32_u24 v150,331776,v150
v_and_b32 v148,15,v164
v_lshl_add_u32 v150,v148,4,v150
s_mul_i32 s87,s87,55296
s_mul_i32 s88,s88,3072
s_add_u32 s87,s87,s88
s_lshl_b32 s86,s86,10
s_add_u32 s87,s87,s86
s_lshl_b32 s85,s85,8
s_add_u32 s87,s87,s85
s_mov_b32 s85,0xbe2aaaab
s_mov_b32 s86,0x3d2aaaab
s_mov_b32 s88,0x3e2aaaab
s_mov_b32 s92,0x3daaaaab
s_waitcnt vmcnt(0)
v_add_f32 v148,v68,v84
v_add_f32 v92,v148,v76
v_sub_f32 v100,v148,v76
v_mul_f32 v92,s85,v92
v_mul_f32 v100,s85,v100
v_mul_f32 v148,s86,v68
v_fmac_f32 v148,s88,v84
v_fma_f32 v108,s92,v76,v148
v_fma_f32 v116,-s92,v76,v148
v_add_f32 v148,v69,v85
v_add_f32 v93,v148,v77
v_sub_f32 v101,v148,v77
v_mul_f32 v93,s85,v93
v_mul_f32 v101,s85,v101
v_mul_f32 v148,s86,v69
v_fmac_f32 v148,s88,v85
v_fma_f32 v109,s92,v77,v148
v_fma_f32 v117,-s92,v77,v148
v_add_f32 v148,v70,v86
v_add_f32 v94,v148,v78
v_sub_f32 v102,v148,v78
v_mul_f32 v94,s85,v94
v_mul_f32 v102,s85,v102
v_mul_f32 v148,s86,v70
v_fmac_f32 v148,s88,v86
v_fma_f32 v110,s92,v78,v148
v_fma_f32 v118,-s92,v78,v148
v_add_f32 v148,v71,v87
v_add_f32 v95,v148,v79
v_sub_f32 v103,v148,v79
v_mul_f32 v95,s85,v95
v_mul_f32 v103,s85,v103
v_mul_f32 v148,s86,v71
v_fmac_f32 v148,s88,v87
v_fma_f32 v111,s92,v79,v148
v_fma_f32 v119,-s92,v79,v148
v_add_f32 v148,v72,v88
v_add_f32 v96,v148,v80
v_sub_f32 v104,v148,v80
v_mul_f32 v96,s85,v96
v_mul_f32 v104,s85,v104
v_mul_f32 v148,s86,v72
v_fmac_f32 v148,s88,v88
v_fma_f32 v112,s92,v80,v148
v_fma_f32 v120,-s92,v80,v148
v_add_f32 v148,v73,v89
v_add_f32 v97,v148,v81
v_sub_f32 v105,v148,v81
v_mul_f32 v97,s85,v97
v_mul_f32 v105,s85,v105
v_mul_f32 v148,s86,v73
v_fmac_f32 v148,s88,v89
v_fma_f32 v113,s92,v81,v148
v_fma_f32 v121,-s92,v81,v148
v_add_f32 v148,v74,v90
v_add_f32 v98,v148,v82
v_sub_f32 v106,v148,v82
v_mul_f32 v98,s85,v98
v_mul_f32 v106,s85,v106
v_mul_f32 v148,s86,v74
v_fmac_f32 v148,s88,v90
v_fma_f32 v114,s92,v82,v148
v_fma_f32 v122,-s92,v82,v148
v_add_f32 v148,v75,v91
v_add_f32 v99,v148,v83
v_sub_f32 v107,v148,v83
v_mul_f32 v99,s85,v99
v_mul_f32 v107,s85,v107
v_mul_f32 v148,s86,v75
v_fmac_f32 v148,s88,v91
v_fma_f32 v115,s92,v83,v148
v_fma_f32 v123,-s92,v83,v148
v_cvt_pk_bf16_f32 v124,v68,v69
v_cvt_pk_bf16_f32 v125,v70,v71
v_cvt_pk_bf16_f32 v126,v72,v73
v_cvt_pk_bf16_f32 v127,v74,v75
s_add_u32 s89,s87,0
buffer_store_dwordx4 v[124:127],v150,s[20:23],s89 offen sc1
v_cvt_pk_bf16_f32 v144,v84,v85
v_cvt_pk_bf16_f32 v145,v86,v87
v_cvt_pk_bf16_f32 v146,v88,v89
v_cvt_pk_bf16_f32 v147,v90,v91
s_add_u32 s89,s87,46080
buffer_store_dwordx4 v[144:147],v150,s[20:23],s89 offen sc1
v_cvt_pk_bf16_f32 v128,v92,v93
v_cvt_pk_bf16_f32 v129,v94,v95
v_cvt_pk_bf16_f32 v130,v96,v97
v_cvt_pk_bf16_f32 v131,v98,v99
s_add_u32 s89,s87,9216
buffer_store_dwordx4 v[128:131],v150,s[20:23],s89 offen sc1
v_cvt_pk_bf16_f32 v132,v100,v101
v_cvt_pk_bf16_f32 v133,v102,v103
v_cvt_pk_bf16_f32 v134,v104,v105
v_cvt_pk_bf16_f32 v135,v106,v107
s_add_u32 s89,s87,18432
buffer_store_dwordx4 v[132:135],v150,s[20:23],s89 offen sc1
v_cvt_pk_bf16_f32 v136,v108,v109
v_cvt_pk_bf16_f32 v137,v110,v111
v_cvt_pk_bf16_f32 v138,v112,v113
v_cvt_pk_bf16_f32 v139,v114,v115
s_add_u32 s89,s87,27648
buffer_store_dwordx4 v[136:139],v150,s[20:23],s89 offen sc1
v_cvt_pk_bf16_f32 v140,v116,v117
v_cvt_pk_bf16_f32 v141,v118,v119
v_cvt_pk_bf16_f32 v142,v120,v121
v_cvt_pk_bf16_f32 v143,v122,v123
s_add_u32 s89,s87,36864
buffer_store_dwordx4 v[140:143],v150,s[20:23],s89 offen sc1
s_waitcnt vmcnt(0)
L_noitem:
s_and_b32 s84,s50,1
s_lshl_b32 s59,s84,6
s_lshl_b32 s84,s84,2
s_mov_b64 exec,1
buffer_atomic_add v166,off,s[60:63],s59 sc0 sc1
s_mov_b64 exec,-1
s_and_b32 s5,s5,0xffff
s_sub_u32 s8,s4,196608
s_subb_u32 s9,s5,0
s_mov_b32 s10,100859904
s_mov_b32 s11,0x20000
s_sub_u32 s12,s4,196992
s_subb_u32 s13,s5,0
s_cmp_eq_u32 s56,0
s_cselect_b32 s14,0,100860288
s_mov_b32 s15,0x20000
s_mov_b32 s16,s8
s_mov_b32 s17,s9
s_cmp_eq_u32 s56,508
s_cselect_b32 s18,0,100859904
s_mov_b32 s19,0x20000
s_add_u32 s28,s30,0
buffer_load_dwordx2 v[0:1],v254,s[12:15],s28 offen offset:0
buffer_load_dwordx2 v[10:11],v254,s[16:19],s28 offen offset:1536
buffer_load_dwordx2 v[2:3],v254,s[8:11],s28 offen offset:0
buffer_load_dwordx2 v[4:5],v254,s[8:11],s28 offen offset:384
buffer_load_dwordx2 v[6:7],v254,s[8:11],s28 offen offset:768
buffer_load_dwordx2 v[8:9],v254,s[8:11],s28 offen offset:1152
s_mov_b64 exec,1
s_waitcnt vmcnt(6)
v_cmp_eq_u32 vcc,107,v166
v_mov_b32 v165,1
s_nop 2
s_and_b64 exec,exec,vcc
s_cselect_b32 s62,s62,0
s_mov_b64 exec,1
buffer_store_dword v165,off,s[60:63],s84 offset:128 sc1
s_mov_b64 exec,-1
s_add_u32 s28,s30,393216
buffer_load_dwordx2 v[12:13],v245,s[12:15],s28 offen offset:0
buffer_load_dwordx2 v[22:23],v245,s[16:19],s28 offen offset:1536
buffer_load_dwordx2 v[14:15],v245,s[8:11],s28 offen offset:0
buffer_load_dwordx2 v[16:17],v245,s[8:11],s28 offen offset:384
buffer_load_dwordx2 v[18:19],v245,s[8:11],s28 offen offset:768
buffer_load_dwordx2 v[20:21],v245,s[8:11],s28 offen offset:1152
s_add_u32 s28,s30,786432
buffer_load_dwordx2 v[24:25],v245,s[12:15],s28 offen offset:0
buffer_load_dwordx2 v[34:35],v245,s[16:19],s28 offen offset:1536
buffer_load_dwordx2 v[26:27],v245,s[8:11],s28 offen offset:0
buffer_load_dwordx2 v[28:29],v245,s[8:11],s28 offen offset:384
buffer_load_dwordx2 v[30:31],v245,s[8:11],s28 offen offset:768
buffer_load_dwordx2 v[32:33],v245,s[8:11],s28 offen offset:1152
s_add_u32 s28,s30,1179648
buffer_load_dwordx2 v[36:37],v245,s[12:15],s28 offen offset:0
buffer_load_dwordx2 v[46:47],v245,s[16:19],s28 offen offset:1536
buffer_load_dwordx2 v[38:39],v245,s[8:11],s28 offen offset:0
buffer_load_dwordx2 v[40:41],v245,s[8:11],s28 offen offset:384
buffer_load_dwordx2 v[42:43],v245,s[8:11],s28 offen offset:768
buffer_load_dwordx2 v[44:45],v245,s[8:11],s28 offen offset:1152
s_add_u32 s29,s30,0
buffer_load_short_d16_hi v48,v246,s[12:15],s29 offen offset:0
buffer_load_short_d16_hi v49,v246,s[8:11],s29 offen offset:0
buffer_load_short_d16_hi v50,v246,s[8:11],s29 offen offset:384
buffer_load_short_d16_hi v51,v246,s[8:11],s29 offen offset:768
buffer_load_short_d16_hi v52,v246,s[8:11],s29 offen offset:1152
buffer_load_short_d16_hi v53,v246,s[16:19],s29 offen offset:1536
s_getpc_b64 s[64:65]
L_pc:
s_lshl_b32 s58,s55,8
s_min_u32 s58,s58,L_code_end-L_pc-4096
s_add_u32 s64,s64,s58
s_addc_u32 s65,s65,0
global_load_dword v167,v251,s[64:65]
s_and_b32 s25,s25,0xffff
s_mov_b32 s26,100663296
s_mov_b32 s27,0x20000
s_mov_b32 s41,0xc0a00000
s_mov_b32 s40,0x41000000
s_mov_b32 s42,0xffff0000
s_mov_b32 s43,0xbfa00000
s_mov_b32 s45,0x3e800000
s_mul_i32 s44,s50,330752
s_mul_i32 s58,s55,384
s_add_u32 s58,s57,s58
s_lshr_b32 s59,s50,1
s_mul_i32 s32,s59,384
s_mul_i32 s33,s59,196608
s_add_u32 s32,s32,s58
s_add_u32 s33,s33,s58
s_lshl_b32 s58,s59,5
s_lshl_b32 s59,s50,7
v_lshlrev_b32 v247,11,v160
v_xor_b32 v163,v160,v161
v_and_b32 v163,1,v163
v_lshl_add_u32 v247,v163,6,v247
v_lshlrev_b32 v163,3,v162
v_xor_b32 v163,s58,v163
v_add3_u32 v247,v247,v163,s59
v_lshrrev_b32 v160,5,v164
v_lshlrev_b32 v160,6,v160
v_bfe_u32 v161,v251,3,6
v_xor_b32 v161,s58,v161
v_add3_u32 v248,v160,v161,s59
v_add_u32 v248,8192,v248
v_bfe_u32 v160,v164,2,2
v_and_b32 v161,3,v164
v_lshrrev_b32 v162,4,v164
v_lshlrev_b32 v249,11,v160
v_lshl_add_u32 v249,v161,7,v249
v_and_b32 v163,1,v160
v_lshl_add_u32 v249,v163,6,v249
v_and_b32 v163,2,v161
v_xor_b32 v163,v163,v162
v_lshl_add_u32 v249,v163,4,v249
v_xor_b32 v250,64,v249
v_lshrrev_b32 v160,1,v162
v_lshl_add_u32 v160,s50,1,v160
v_and_b32 v161,7,v164
v_xor_b32 v160,v160,v161
v_and_b32 v163,15,v164
v_lshlrev_b32 v253,7,v163
v_lshl_add_u32 v253,v160,4,v253
v_and_b32 v163,1,v162
v_lshl_add_u32 v253,v163,3,v253
v_bfe_u32 v160,v251,7,4
v_lshrrev_b32 v162,2,v160
v_mul_u32_u24 v252,1572864,v162
v_and_b32 v162,3,v160
v_mul_u32_u24 v162,1536,v162
v_and_b32 v160,7,v160
v_xor_b32 v160,v160,v161
v_lshl_add_u32 v160,v160,4,v162
v_add_u32 v252,v252,v160
s_waitcnt vmcnt(28)
v_lshlrev_b32 v234,16,v4
v_lshlrev_b32 v232,16,v0
v_lshlrev_b32 v233,16,v2
v_lshlrev_b32 v237,16,v10
s_waitcnt vmcnt(26)
v_lshlrev_b32 v236,16,v8
v_lshlrev_b32 v235,16,v6
v_fmac_f32 v232,s43,v234
v_fmac_f32 v237,4.0,v233
v_fma_f32 v238,-4.0,v234,v236
v_fmac_f32 v232,s45,v236
v_fmac_f32 v237,s41,v235
v_sub_f32 v236,v236,v234
v_fma_f32 v234,-4.0,v233,v235
v_sub_f32 v235,v235,v233
v_add_f32 v233,v238,v234
v_sub_f32 v238,v238,v234
v_fma_f32 v234,2.0,v235,v236
v_fmac_f32 v236,-2.0,v235
v_and_b32 v4,s42,v4
v_and_b32 v0,s42,v0
v_and_b32 v2,s42,v2
v_and_b32 v10,s42,v10
v_and_b32 v8,s42,v8
v_and_b32 v6,s42,v6
v_fmac_f32 v0,s43,v4
v_fmac_f32 v10,4.0,v2
v_fma_f32 v235,-4.0,v4,v8
v_fmac_f32 v0,s45,v8
v_fmac_f32 v10,s41,v6
v_sub_f32 v8,v8,v4
v_fma_f32 v4,-4.0,v2,v6
v_sub_f32 v6,v6,v2
v_add_f32 v2,v235,v4
v_sub_f32 v235,v235,v4
v_fma_f32 v4,2.0,v6,v8
v_fmac_f32 v8,-2.0,v6
v_cvt_pk_bf16_f32 v0,v232,v0
v_cvt_pk_bf16_f32 v10,v237,v10
v_cvt_pk_bf16_f32 v2,v233,v2
v_cvt_pk_bf16_f32 v6,v234,v4
v_cvt_pk_bf16_f32 v4,v238,v235
v_cvt_pk_bf16_f32 v8,v236,v8
v_lshlrev_b32 v234,16,v5
v_lshlrev_b32 v232,16,v1
v_lshlrev_b32 v233,16,v3
v_lshlrev_b32 v237,16,v11
v_lshlrev_b32 v236,16,v9
v_lshlrev_b32 v235,16,v7
v_fmac_f32 v232,s43,v234
v_fmac_f32 v237,4.0,v233
v_fma_f32 v238,-4.0,v234,v236
v_fmac_f32 v232,s45,v236
v_fmac_f32 v237,s41,v235
v_sub_f32 v236,v236,v234
v_fma_f32 v234,-4.0,v233,v235
v_sub_f32 v235,v235,v233
v_add_f32 v233,v238,v234
v_sub_f32 v238,v238,v234
v_fma_f32 v234,2.0,v235,v236
v_fmac_f32 v236,-2.0,v235
v_and_b32 v5,s42,v5
v_and_b32 v1,s42,v1
v_and_b32 v3,s42,v3
v_and_b32 v11,s42,v11
v_and_b32 v9,s42,v9
v_and_b32 v7,s42,v7
v_fmac_f32 v1,s43,v5
v_fmac_f32 v11,4.0,v3
v_fma_f32 v235,-4.0,v5,v9
v_fmac_f32 v1,s45,v9
v_fmac_f32 v11,s41,v7
v_sub_f32 v9,v9,v5
v_fma_f32 v5,-4.0,v3,v7
v_sub_f32 v7,v7,v3
v_add_f32 v3,v235,v5
v_sub_f32 v235,v235,v5
v_fma_f32 v5,2.0,v7,v9
v_fmac_f32 v9,-2.0,v7
v_cvt_pk_bf16_f32 v1,v232,v1
v_cvt_pk_bf16_f32 v11,v237,v11
v_cvt_pk_bf16_f32 v3,v233,v3
v_cvt_pk_bf16_f32 v7,v234,v5
v_cvt_pk_bf16_f32 v5,v238,v235
v_cvt_pk_bf16_f32 v9,v236,v9
ds_write2st64_b64 v247,v[0:1],v[10:11] offset0:0 offset1:17
ds_write2st64_b64 v247,v[2:3],v[4:5] offset0:34 offset1:51
ds_write2st64_b64 v247,v[6:7],v[8:9] offset0:68 offset1:85
s_waitcnt vmcnt(21)
v_lshlrev_b32 v234,16,v16
v_lshlrev_b32 v232,16,v12
v_lshlrev_b32 v233,16,v14
v_lshlrev_b32 v237,16,v22
s_waitcnt vmcnt(19)
v_lshlrev_b32 v236,16,v20
v_lshlrev_b32 v235,16,v18
v_fmac_f32 v232,s43,v234
v_fmac_f32 v237,4.0,v233
v_fma_f32 v238,-4.0,v234,v236
v_fmac_f32 v232,s45,v236
v_fmac_f32 v237,s41,v235
v_sub_f32 v236,v236,v234
v_fma_f32 v234,-4.0,v233,v235
v_sub_f32 v235,v235,v233
v_add_f32 v233,v238,v234
v_sub_f32 v238,v238,v234
v_fma_f32 v234,2.0,v235,v236
v_fmac_f32 v236,-2.0,v235
v_and_b32 v16,s42,v16
v_and_b32 v12,s42,v12
v_and_b32 v14,s42,v14
v_and_b32 v22,s42,v22
v_and_b32 v20,s42,v20
v_and_b32 v18,s42,v18
v_fmac_f32 v12,s43,v16
v_fmac_f32 v22,4.0,v14
v_fma_f32 v235,-4.0,v16,v20
v_fmac_f32 v12,s45,v20
v_fmac_f32 v22,s41,v18
v_sub_f32 v20,v20,v16
v_fma_f32 v16,-4.0,v14,v18
v_sub_f32 v18,v18,v14
v_add_f32 v14,v235,v16
v_sub_f32 v235,v235,v16
v_fma_f32 v16,2.0,v18,v20
v_fmac_f32 v20,-2.0,v18
v_cvt_pk_bf16_f32 v12,v232,v12
v_cvt_pk_bf16_f32 v22,v237,v22
v_cvt_pk_bf16_f32 v14,v233,v14
v_cvt_pk_bf16_f32 v18,v234,v16
v_cvt_pk_bf16_f32 v16,v238,v235
v_cvt_pk_bf16_f32 v20,v236,v20
v_lshlrev_b32 v234,16,v17
v_lshlrev_b32 v232,16,v13
v_lshlrev_b32 v233,16,v15
v_lshlrev_b32 v237,16,v23
v_lshlrev_b32 v236,16,v21
v_lshlrev_b32 v235,16,v19
v_fmac_f32 v232,s43,v234
v_fmac_f32 v237,4.0,v233
v_fma_f32 v238,-4.0,v234,v236
v_fmac_f32 v232,s45,v236
v_fmac_f32 v237,s41,v235
v_sub_f32 v236,v236,v234
v_fma_f32 v234,-4.0,v233,v235
v_sub_f32 v235,v235,v233
v_add_f32 v233,v238,v234
v_sub_f32 v238,v238,v234
v_fma_f32 v234,2.0,v235,v236
v_fmac_f32 v236,-2.0,v235
v_and_b32 v17,s42,v17
v_and_b32 v13,s42,v13
v_and_b32 v15,s42,v15
v_and_b32 v23,s42,v23
v_and_b32 v21,s42,v21
v_and_b32 v19,s42,v19
v_fmac_f32 v13,s43,v17
v_fmac_f32 v23,4.0,v15
v_fma_f32 v235,-4.0,v17,v21
v_fmac_f32 v13,s45,v21
v_fmac_f32 v23,s41,v19
v_sub_f32 v21,v21,v17
v_fma_f32 v17,-4.0,v15,v19
v_sub_f32 v19,v19,v15
v_add_f32 v15,v235,v17
v_sub_f32 v235,v235,v17
v_fma_f32 v17,2.0,v19,v21
v_fmac_f32 v21,-2.0,v19
v_cvt_pk_bf16_f32 v13,v232,v13
v_cvt_pk_bf16_f32 v23,v237,v23
v_cvt_pk_bf16_f32 v15,v233,v15
v_cvt_pk_bf16_f32 v19,v234,v17
v_cvt_pk_bf16_f32 v17,v238,v235
v_cvt_pk_bf16_f32 v21,v236,v21
ds_write2st64_b64 v247,v[12:13],v[22:23] offset0:1 offset1:18
ds_write2st64_b64 v247,v[14:15],v[16:17] offset0:35 offset1:52
ds_write2st64_b64 v247,v[18:19],v[20:21] offset0:69 offset1:86
s_add_u32 s28,s30,64
buffer_load_dwordx2 v[192:193],v254,s[12:15],s28 offen offset:0
buffer_load_dwordx2 v[202:203],v254,s[16:19],s28 offen offset:1536
buffer_load_dwordx2 v[194:195],v254,s[8:11],s28 offen offset:0
buffer_load_dwordx2 v[196:197],v254,s[8:11],s28 offen offset:384
buffer_load_dwordx2 v[198:199],v254,s[8:11],s28 offen offset:768
buffer_load_dwordx2 v[200:201],v254,s[8:11],s28 offen offset:1152
s_add_u32 s28,s30,393280
buffer_load_dwordx2 v[204:205],v245,s[12:15],s28 offen offset:0
buffer_load_dwordx2 v[214:215],v245,s[16:19],s28 offen offset:1536
buffer_load_dwordx2 v[206:207],v245,s[8:11],s28 offen offset:0
buffer_load_dwordx2 v[208:209],v245,s[8:11],s28 offen offset:384
buffer_load_dwordx2 v[210:211],v245,s[8:11],s28 offen offset:768
buffer_load_dwordx2 v[212:213],v245,s[8:11],s28 offen offset:1152
s_add_u32 s29,s30,64
buffer_load_short_d16_hi v239,v246,s[12:15],s29 offen offset:0
buffer_load_short_d16_hi v240,v246,s[8:11],s29 offen offset:0
buffer_load_short_d16_hi v241,v246,s[8:11],s29 offen offset:384
buffer_load_short_d16_hi v242,v246,s[8:11],s29 offen offset:768
buffer_load_short_d16_hi v243,v246,s[8:11],s29 offen offset:1152
buffer_load_short_d16_hi v244,v246,s[16:19],s29 offen offset:1536
s_waitcnt vmcnt(33)
v_lshlrev_b32 v234,16,v28
v_lshlrev_b32 v232,16,v24
v_lshlrev_b32 v233,16,v26
v_lshlrev_b32 v237,16,v34
s_waitcnt vmcnt(31)
v_lshlrev_b32 v236,16,v32
v_lshlrev_b32 v235,16,v30
v_fmac_f32 v232,s43,v234
v_fmac_f32 v237,4.0,v233
v_fma_f32 v238,-4.0,v234,v236
v_fmac_f32 v232,s45,v236
v_fmac_f32 v237,s41,v235
v_sub_f32 v236,v236,v234
v_fma_f32 v234,-4.0,v233,v235
v_sub_f32 v235,v235,v233
v_add_f32 v233,v238,v234
v_sub_f32 v238,v238,v234
v_fma_f32 v234,2.0,v235,v236
v_fmac_f32 v236,-2.0,v235
v_and_b32 v28,s42,v28
v_and_b32 v24,s42,v24
v_and_b32 v26,s42,v26
v_and_b32 v34,s42,v34
v_and_b32 v32,s42,v32
v_and_b32 v30,s42,v30
v_fmac_f32 v24,s43,v28
v_fmac_f32 v34,4.0,v26
v_fma_f32 v235,-4.0,v28,v32
v_fmac_f32 v24,s45,v32
v_fmac_f32 v34,s41,v30
v_sub_f32 v32,v32,v28
v_fma_f32 v28,-4.0,v26,v30
v_sub_f32 v30,v30,v26
v_add_f32 v26,v235,v28
v_sub_f32 v235,v235,v28
v_fma_f32 v28,2.0,v30,v32
v_fmac_f32 v32,-2.0,v30
v_cvt_pk_bf16_f32 v24,v232,v24
v_cvt_pk_bf16_f32 v34,v237,v34
v_cvt_pk_bf16_f32 v26,v233,v26
v_cvt_pk_bf16_f32 v30,v234,v28
v_cvt_pk_bf16_f32 v28,v238,v235
v_cvt_pk_bf16_f32 v32,v236,v32
v_lshlrev_b32 v234,16,v29
v_lshlrev_b32 v232,16,v25
v_lshlrev_b32 v233,16,v27
v_lshlrev_b32 v237,16,v35
v_lshlrev_b32 v236,16,v33
v_lshlrev_b32 v235,16,v31
v_fmac_f32 v232,s43,v234
v_fmac_f32 v237,4.0,v233
v_fma_f32 v238,-4.0,v234,v236
v_fmac_f32 v232,s45,v236
v_fmac_f32 v237,s41,v235
v_sub_f32 v236,v236,v234
v_fma_f32 v234,-4.0,v233,v235
v_sub_f32 v235,v235,v233
v_add_f32 v233,v238,v234
v_sub_f32 v238,v238,v234
v_fma_f32 v234,2.0,v235,v236
v_fmac_f32 v236,-2.0,v235
v_and_b32 v29,s42,v29
v_and_b32 v25,s42,v25
v_and_b32 v27,s42,v27
v_and_b32 v35,s42,v35
v_and_b32 v33,s42,v33
v_and_b32 v31,s42,v31
v_fmac_f32 v25,s43,v29
v_fmac_f32 v35,4.0,v27
v_fma_f32 v235,-4.0,v29,v33
v_fmac_f32 v25,s45,v33
v_fmac_f32 v35,s41,v31
v_sub_f32 v33,v33,v29
v_fma_f32 v29,-4.0,v27,v31
v_sub_f32 v31,v31,v27
v_add_f32 v27,v235,v29
v_sub_f32 v235,v235,v29
v_fma_f32 v29,2.0,v31,v33
v_fmac_f32 v33,-2.0,v31
v_cvt_pk_bf16_f32 v25,v232,v25
v_cvt_pk_bf16_f32 v35,v237,v35
v_cvt_pk_bf16_f32 v27,v233,v27
v_cvt_pk_bf16_f32 v31,v234,v29
v_cvt_pk_bf16_f32 v29,v238,v235
v_cvt_pk_bf16_f32 v33,v236,v33
ds_write2st64_b64 v247,v[24:25],v[34:35] offset0:2 offset1:19
ds_write2st64_b64 v247,v[26:27],v[28:29] offset0:36 offset1:53
ds_write2st64_b64 v247,v[30:31],v[32:33] offset0:70 offset1:87
s_waitcnt vmcnt(27)
v_lshlrev_b32 v234,16,v40
v_lshlrev_b32 v232,16,v36
v_lshlrev_b32 v233,16,v38
v_lshlrev_b32 v237,16,v46
s_waitcnt vmcnt(25)
v_lshlrev_b32 v236,16,v44
v_lshlrev_b32 v235,16,v42
v_fmac_f32 v232,s43,v234
v_fmac_f32 v237,4.0,v233
v_fma_f32 v238,-4.0,v234,v236
v_fmac_f32 v232,s45,v236
v_fmac_f32 v237,s41,v235
v_sub_f32 v236,v236,v234
v_fma_f32 v234,-4.0,v233,v235
v_sub_f32 v235,v235,v233
v_add_f32 v233,v238,v234
v_sub_f32 v238,v238,v234
v_fma_f32 v234,2.0,v235,v236
v_fmac_f32 v236,-2.0,v235
v_and_b32 v40,s42,v40
v_and_b32 v36,s42,v36
v_and_b32 v38,s42,v38
v_and_b32 v46,s42,v46
v_and_b32 v44,s42,v44
v_and_b32 v42,s42,v42
v_fmac_f32 v36,s43,v40
v_fmac_f32 v46,4.0,v38
v_fma_f32 v235,-4.0,v40,v44
v_fmac_f32 v36,s45,v44
v_fmac_f32 v46,s41,v42
v_sub_f32 v44,v44,v40
v_fma_f32 v40,-4.0,v38,v42
v_sub_f32 v42,v42,v38
v_add_f32 v38,v235,v40
v_sub_f32 v235,v235,v40
v_fma_f32 v40,2.0,v42,v44
v_fmac_f32 v44,-2.0,v42
v_cvt_pk_bf16_f32 v36,v232,v36
v_cvt_pk_bf16_f32 v46,v237,v46
v_cvt_pk_bf16_f32 v38,v233,v38
v_cvt_pk_bf16_f32 v42,v234,v40
v_cvt_pk_bf16_f32 v40,v238,v235
v_cvt_pk_bf16_f32 v44,v236,v44
v_lshlrev_b32 v234,16,v41
v_lshlrev_b32 v232,16,v37
v_lshlrev_b32 v233,16,v39
v_lshlrev_b32 v237,16,v47
v_lshlrev_b32 v236,16,v45
v_lshlrev_b32 v235,16,v43
v_fmac_f32 v232,s43,v234
v_fmac_f32 v237,4.0,v233
v_fma_f32 v238,-4.0,v234,v236
v_fmac_f32 v232,s45,v236
v_fmac_f32 v237,s41,v235
v_sub_f32 v236,v236,v234
v_fma_f32 v234,-4.0,v233,v235
v_sub_f32 v235,v235,v233
v_add_f32 v233,v238,v234
v_sub_f32 v238,v238,v234
v_fma_f32 v234,2.0,v235,v236
v_fmac_f32 v236,-2.0,v235
v_and_b32 v41,s42,v41
v_and_b32 v37,s42,v37
v_and_b32 v39,s42,v39
v_and_b32 v47,s42,v47
v_and_b32 v45,s42,v45
v_and_b32 v43,s42,v43
v_fmac_f32 v37,s43,v41
v_fmac_f32 v47,4.0,v39
v_fma_f32 v235,-4.0,v41,v45
v_fmac_f32 v37,s45,v45
v_fmac_f32 v47,s41,v43
v_sub_f32 v45,v45,v41
v_fma_f32 v41,-4.0,v39,v43
v_sub_f32 v43,v43,v39
v_add_f32 v39,v235,v41
v_sub_f32 v235,v235,v41
v_fma_f32 v41,2.0,v43,v45
v_fmac_f32 v45,-2.0,v43
v_cvt_pk_bf16_f32 v37,v232,v37
v_cvt_pk_bf16_f32 v47,v237,v47
v_cvt_pk_bf16_f32 v39,v233,v39
v_cvt_pk_bf16_f32 v43,v234,v41
v_cvt_pk_bf16_f32 v41,v238,v235
v_cvt_pk_bf16_f32 v45,v236,v45
ds_write2st64_b64 v247,v[36:37],v[46:47] offset0:3 offset1:20
ds_write2st64_b64 v247,v[38:39],v[40:41] offset0:37 offset1:54
ds_write2st64_b64 v247,v[42:43],v[44:45] offset0:71 offset1:88
s_waitcnt vmcnt(22)
v_fmac_f32 v48,s43,v50
s_waitcnt vmcnt(19)
v_fmac_f32 v53,4.0,v49
v_fma_f32 v232,-4.0,v50,v52
v_fmac_f32 v48,s45,v52
v_fmac_f32 v53,s41,v51
v_sub_f32 v52,v52,v50
v_fma_f32 v50,-4.0,v49,v51
v_sub_f32 v51,v51,v49
v_add_f32 v49,v232,v50
v_sub_f32 v232,v232,v50
v_fma_f32 v50,2.0,v51,v52
v_fmac_f32 v52,-2.0,v51
v_cvt_pk_bf16_f32 v233,v48,v53
v_cvt_pk_bf16_f32 v234,v49,v232
v_cvt_pk_bf16_f32 v235,v50,v52
ds_write_b16 v248,v233 offset:0
ds_write_b16_d16_hi v248,v233 offset:8704
ds_write_b16 v248,v234 offset:17408
ds_write_b16_d16_hi v248,v234 offset:26112
ds_write_b16 v248,v235 offset:34816
ds_write_b16_d16_hi v248,v235 offset:43520
s_waitcnt lgkmcnt(0)
s_barrier
ds_read_b128 a[216:219],v249 offset:17408
ds_read_b128 a[220:223],v250 offset:17408
ds_read_b128 a[224:227],v249 offset:17920
ds_read_b128 a[228:231],v250 offset:17920
ds_read_b128 a[232:235],v249 offset:18432
ds_read_b128 a[236:239],v250 offset:18432
v_and_b32 v165,1,v164
v_lshlrev_b32 v165,2,v165
s_mov_b32 s84,0
L_poll:
global_load_dword v166,v165,s[52:53] offset:128 sc1
s_add_u32 s84,s84,1
s_waitcnt vmcnt(0)
v_cmp_eq_u32 vcc,0,v166
s_cmp_gt_u32 s84,0x4000
s_cbranch_scc1 L_fallback
s_cbranch_vccnz L_poll
L_uready:
s_add_u32 s46,s44,9216
buffer_load_dwordx4 a[192:195],v251,s[20:23],s46 offen offset:0 sc1
buffer_load_dwordx4 a[196:199],v251,s[20:23],s46 offen offset:1024 sc1
buffer_load_dwordx4 a[200:203],v251,s[20:23],s46 offen offset:2048 sc1
s_add_u32 s47,s44,12288
buffer_load_dwordx4 a[204:207],v251,s[20:23],s47 offen offset:0 sc1
buffer_load_dwordx4 a[208:211],v251,s[20:23],s47 offen offset:1024 sc1
buffer_load_dwordx4 a[212:215],v251,s[20:23],s47 offen offset:2048 sc1
s_waitcnt vmcnt(5) lgkmcnt(5)
M a[0:3],a[192:195],a[216:219],0
s_waitcnt vmcnt(4) lgkmcnt(4)
s_add_u32 s48,s44,15360
buffer_load_dwordx4 a[240:243],v251,s[20:23],s48 offen offset:0 sc1
M a[0:3],a[196:199],a[220:223],a[0:3]
s_waitcnt vmcnt(4) lgkmcnt(3)
v_lshlrev_b32 v234,16,v196
v_lshlrev_b32 v232,16,v192
M a[0:3],a[200:203],a[224:227],a[0:3]
s_waitcnt lgkmcnt(2)
buffer_load_dwordx4 a[244:247],v251,s[20:23],s48 offen offset:1024 sc1
M a[4:7],a[200:203],a[228:231],0
v_lshlrev_b32 v233,16,v194
v_lshlrev_b32 v237,16,v202
M a[4:7],a[196:199],a[224:227],a[4:7]
ds_read_b128 a[252:255],v249 offset:18944
v_lshlrev_b32 v236,16,v200
M a[4:7],a[192:195],a[220:223],a[4:7]
ds_read_b128 v[216:219],v250 offset:18944
v_lshlrev_b32 v235,16,v198
M a[8:11],a[192:195],a[224:227],0
buffer_load_dwordx4 a[248:251],v251,s[20:23],s48 offen offset:2048 sc1
v_fmac_f32 v232,s43,v234
M a[8:11],a[196:199],a[228:231],a[8:11]
s_waitcnt lgkmcnt(3)
s_add_u32 s46,s44,18432
v_fmac_f32 v237,4.0,v233
v_fma_f32 v238,-4.0,v234,v236
M a[8:11],a[200:203],a[232:235],a[8:11]
s_waitcnt lgkmcnt(2)
v_fmac_f32 v232,s45,v236
v_fmac_f32 v237,s41,v235
M a[12:15],a[200:203],a[236:239],0
v_sub_f32 v236,v236,v234
v_fma_f32 v234,-4.0,v233,v235
M a[12:15],a[196:199],a[232:235],a[12:15]
buffer_load_dwordx4 v[220:223],v251,s[20:23],s46 offen offset:0 sc1
M a[12:15],a[192:195],a[228:231],a[12:15]
ds_read_b128 v[224:227],v250 offset:19456
ds_read_b128 v[228:231],v249 offset:19456
M a[16:19],a[192:195],a[232:235],0
v_sub_f32 v235,v235,v233
v_add_f32 v233,v238,v234
M a[16:19],a[196:199],a[236:239],a[16:19]
s_waitcnt lgkmcnt(3)
v_sub_f32 v238,v238,v234
v_fma_f32 v234,2.0,v235,v236
v_fmac_f32 v236,-2.0,v235
M a[16:19],a[200:203],a[252:255],a[16:19]
s_waitcnt lgkmcnt(2)
v_and_b32 v196,s42,v196
v_and_b32 v192,s42,v192
M a[20:23],a[200:203],v[216:219],0
v_and_b32 v194,s42,v194
v_and_b32 v202,s42,v202
M a[20:23],a[196:199],a[252:255],a[20:23]
v_and_b32 v200,s42,v200
v_and_b32 v198,s42,v198
M a[20:23],a[192:195],a[236:239],a[20:23]
v_fmac_f32 v192,s43,v196
v_fmac_f32 v202,4.0,v194
M a[24:27],a[192:195],a[252:255],0
v_fma_f32 v235,-4.0,v196,v200
v_fmac_f32 v192,s45,v200
M a[24:27],a[196:199],v[216:219],a[24:27]
s_waitcnt lgkmcnt(1)
v_fmac_f32 v202,s41,v198
v_sub_f32 v200,v200,v196
M a[24:27],a[200:203],v[224:227],a[24:27]
s_waitcnt lgkmcnt(0)
v_fma_f32 v196,-4.0,v194,v198
v_sub_f32 v198,v198,v194
v_add_f32 v194,v235,v196
M a[28:31],a[200:203],v[228:231],0
buffer_load_dwordx4 a[200:203],v251,s[20:23],s46 offen offset:1024 sc1
M a[28:31],a[196:199],v[224:227],a[28:31]
v_sub_f32 v235,v235,v196
v_fma_f32 v196,2.0,v198,v200
M a[28:31],a[192:195],v[216:219],a[28:31]
s_waitcnt vmcnt(7)
buffer_load_dwordx4 a[196:199],v251,s[20:23],s46 offen offset:2048 sc1
M a[32:35],a[204:207],a[216:219],0
s_waitcnt vmcnt(7)
s_add_u32 s47,s44,21504
v_fmac_f32 v200,-2.0,v198
v_cvt_pk_bf16_f32 v192,v232,v192
M a[32:35],a[208:211],a[220:223],a[32:35]
s_waitcnt vmcnt(6)
v_cvt_pk_bf16_f32 v202,v237,v202
v_cvt_pk_bf16_f32 v194,v233,v194
M a[32:35],a[212:215],a[224:227],a[32:35]
v_cvt_pk_bf16_f32 v198,v234,v196
v_cvt_pk_bf16_f32 v196,v238,v235
M a[36:39],a[212:215],a[228:231],0
buffer_load_dwordx4 a[192:195],v251,s[20:23],s47 offen offset:0 sc1
v_cvt_pk_bf16_f32 v200,v236,v200
M a[36:39],a[208:211],a[224:227],a[36:39]
v_lshlrev_b32 v234,16,v197
v_lshlrev_b32 v232,16,v193
M a[36:39],a[204:207],a[220:223],a[36:39]
v_lshlrev_b32 v233,16,v195
v_lshlrev_b32 v237,16,v203
M a[40:43],a[204:207],a[224:227],0
v_lshlrev_b32 v236,16,v201
v_lshlrev_b32 v235,16,v199
M a[40:43],a[208:211],a[228:231],a[40:43]
v_fmac_f32 v232,s43,v234
v_fmac_f32 v237,4.0,v233
M a[40:43],a[212:215],a[232:235],a[40:43]
v_fma_f32 v238,-4.0,v234,v236
v_fmac_f32 v232,s45,v236
M a[44:47],a[212:215],a[236:239],0
v_fmac_f32 v237,s41,v235
v_sub_f32 v236,v236,v234
v_fma_f32 v234,-4.0,v233,v235
M a[44:47],a[208:211],a[232:235],a[44:47]
v_sub_f32 v235,v235,v233
v_add_f32 v233,v238,v234
M a[44:47],a[204:207],a[228:231],a[44:47]
v_sub_f32 v238,v238,v234
v_fma_f32 v234,2.0,v235,v236
M a[48:51],a[204:207],a[232:235],0
v_fmac_f32 v236,-2.0,v235
v_and_b32 v197,s42,v197
M a[48:51],a[208:211],a[236:239],a[48:51]
v_and_b32 v193,s42,v193
v_and_b32 v195,s42,v195
M a[48:51],a[212:215],a[252:255],a[48:51]
v_and_b32 v203,s42,v203
v_and_b32 v201,s42,v201
M a[52:55],a[212:215],v[216:219],0
v_and_b32 v199,s42,v199
v_fmac_f32 v193,s43,v197
M a[52:55],a[208:211],a[252:255],a[52:55]
v_fmac_f32 v203,4.0,v195
v_fma_f32 v235,-4.0,v197,v201
v_fmac_f32 v193,s45,v201
M a[52:55],a[204:207],a[236:239],a[52:55]
v_fmac_f32 v203,s41,v199
v_sub_f32 v201,v201,v197
M a[56:59],a[204:207],a[252:255],0
v_fma_f32 v197,-4.0,v195,v199
v_sub_f32 v199,v199,v195
M a[56:59],a[208:211],v[216:219],a[56:59]
v_add_f32 v195,v235,v197
v_sub_f32 v235,v235,v197
M a[56:59],a[212:215],v[224:227],a[56:59]
v_fma_f32 v197,2.0,v199,v201
v_fmac_f32 v201,-2.0,v199
M a[60:63],a[212:215],v[228:231],0
buffer_load_dwordx4 a[212:215],v251,s[20:23],s47 offen offset:1024 sc1
M a[60:63],a[208:211],v[224:227],a[60:63]
v_cvt_pk_bf16_f32 v193,v232,v193
v_cvt_pk_bf16_f32 v203,v237,v203
M a[60:63],a[204:207],v[216:219],a[60:63]
s_waitcnt vmcnt(7)
buffer_load_dwordx4 a[208:211],v251,s[20:23],s47 offen offset:2048 sc1
v_cvt_pk_bf16_f32 v195,v233,v195
M a[64:67],a[240:243],a[216:219],0
s_waitcnt vmcnt(7)
s_add_u32 s48,s44,24576
v_cvt_pk_bf16_f32 v199,v234,v197
v_cvt_pk_bf16_f32 v197,v238,v235
M a[64:67],a[244:247],a[220:223],a[64:67]
s_waitcnt vmcnt(6)
v_cvt_pk_bf16_f32 v201,v236,v201
M a[64:67],a[248:251],a[224:227],a[64:67]
ds_write2st64_b64 v247,v[192:193],v[202:203] offset0:170 offset1:187
M a[68:71],a[248:251],a[228:231],0
s_add_u32 s28,s30,786496
buffer_load_dwordx2 v[192:193],v245,s[12:15],s28 offen offset:0
M a[68:71],a[244:247],a[224:227],a[68:71]
ds_write2st64_b64 v247,v[194:195],v[196:197] offset0:102 offset1:119
M a[68:71],a[240:243],a[220:223],a[68:71]
ds_write2st64_b64 v247,v[198:199],v[200:201] offset0:136 offset1:153
M a[72:75],a[240:243],a[224:227],0
buffer_load_dwordx2 v[202:203],v245,s[16:19],s28 offen offset:1536
M a[72:75],a[244:247],a[228:231],a[72:75]
v_lshlrev_b32 v234,16,v208
v_lshlrev_b32 v232,16,v204
M a[72:75],a[248:251],a[232:235],a[72:75]
v_lshlrev_b32 v233,16,v206
v_lshlrev_b32 v237,16,v214
M a[76:79],a[248:251],a[236:239],0
buffer_load_dwordx2 v[194:195],v245,s[8:11],s28 offen offset:0
M a[76:79],a[244:247],a[232:235],a[76:79]
v_lshlrev_b32 v236,16,v212
v_lshlrev_b32 v235,16,v210
M a[76:79],a[240:243],a[228:231],a[76:79]
v_fmac_f32 v232,s43,v234
v_fmac_f32 v237,4.0,v233
M a[80:83],a[240:243],a[232:235],0
v_fma_f32 v238,-4.0,v234,v236
v_fmac_f32 v232,s45,v236
M a[80:83],a[244:247],a[236:239],a[80:83]
buffer_load_dwordx2 v[196:197],v245,s[8:11],s28 offen offset:384
M a[80:83],a[248:251],a[252:255],a[80:83]
ds_read_b128 a[224:227],v249 offset:26112
v_fmac_f32 v237,s41,v235
M a[84:87],a[248:251],v[216:219],0
ds_read_b128 a[228:231],v250 offset:26112
v_sub_f32 v236,v236,v234
M a[84:87],a[244:247],a[252:255],a[84:87]
ds_read_b128 a[232:235],v249 offset:26624
v_fma_f32 v234,-4.0,v233,v235
M a[84:87],a[240:243],a[236:239],a[84:87]
buffer_load_dwordx2 v[198:199],v245,s[8:11],s28 offen offset:768
M a[88:91],a[240:243],a[252:255],0
ds_read_b128 a[236:239],v250 offset:26624
v_sub_f32 v235,v235,v233
M a[88:91],a[244:247],v[216:219],a[88:91]
v_add_f32 v233,v238,v234
v_sub_f32 v238,v238,v234
M a[88:91],a[248:251],v[224:227],a[88:91]
v_fma_f32 v234,2.0,v235,v236
v_fmac_f32 v236,-2.0,v235
M a[92:95],a[248:251],v[228:231],0
buffer_load_dwordx2 v[200:201],v245,s[8:11],s28 offen offset:1152
M a[92:95],a[244:247],v[224:227],a[92:95]
ds_read_b128 a[248:251],v249 offset:27136
v_and_b32 v208,s42,v208
M a[92:95],a[240:243],v[216:219],a[92:95]
s_waitcnt vmcnt(11) lgkmcnt(4)
ds_read_b128 v[228:231],v250 offset:27136
v_and_b32 v204,s42,v204
M a[96:99],v[220:223],a[224:227],0
s_waitcnt vmcnt(10) lgkmcnt(4)
v_and_b32 v206,s42,v206
v_and_b32 v214,s42,v214
M a[96:99],a[200:203],a[228:231],a[96:99]
s_waitcnt vmcnt(9) lgkmcnt(3)
buffer_load_dwordx4 a[204:207],v251,s[20:23],s48 offen offset:0 sc1
M a[96:99],a[196:199],a[232:235],a[96:99]
s_waitcnt lgkmcnt(2)
v_and_b32 v212,s42,v212
v_and_b32 v210,s42,v210
M a[100:103],a[196:199],a[236:239],0
v_fmac_f32 v204,s43,v208
v_fmac_f32 v214,4.0,v206
M a[100:103],a[200:203],a[232:235],a[100:103]
ds_read_b128 a[244:247],v249 offset:27648
v_fma_f32 v235,-4.0,v208,v212
M a[100:103],v[220:223],a[228:231],a[100:103]
buffer_load_dwordx4 a[216:219],v251,s[20:23],s48 offen offset:1024 sc1
M a[104:107],v[220:223],a[232:235],0
ds_read_b128 v[224:227],v250 offset:27648
v_fmac_f32 v204,s45,v212
M a[104:107],a[200:203],a[236:239],a[104:107]
s_waitcnt lgkmcnt(3)
v_fmac_f32 v214,s41,v210
v_sub_f32 v212,v212,v208
M a[104:107],a[196:199],a[248:251],a[104:107]
s_waitcnt lgkmcnt(2)
v_fma_f32 v208,-4.0,v206,v210
v_sub_f32 v210,v210,v206
M a[108:111],a[196:199],v[228:231],0
buffer_load_dwordx4 a[220:223],v251,s[20:23],s48 offen offset:2048 sc1
M a[108:111],a[200:203],a[248:251],a[108:111]
s_add_u32 s46,s44,27648
ds_read_b128 a[240:243],v250 offset:28160
v_add_f32 v206,v235,v208
M a[108:111],v[220:223],a[236:239],a[108:111]
ds_read_b128 v[216:219],v249 offset:28160
v_sub_f32 v235,v235,v208
M a[112:115],v[220:223],a[248:251],0
v_fma_f32 v208,2.0,v210,v212
v_fmac_f32 v212,-2.0,v210
M a[112:115],a[200:203],v[228:231],a[112:115]
s_waitcnt lgkmcnt(3)
buffer_load_dwordx4 a[252:255],v251,s[20:23],s46 offen offset:0 sc1
M a[112:115],a[196:199],a[244:247],a[112:115]
s_waitcnt lgkmcnt(2)
v_cvt_pk_bf16_f32 v204,v232,v204
v_cvt_pk_bf16_f32 v214,v237,v214
M a[116:119],a[196:199],v[224:227],0
v_cvt_pk_bf16_f32 v206,v233,v206
v_cvt_pk_bf16_f32 v210,v234,v208
M a[116:119],a[200:203],a[244:247],a[116:119]
v_cvt_pk_bf16_f32 v208,v238,v235
v_cvt_pk_bf16_f32 v212,v236,v212
M a[116:119],v[220:223],v[228:231],a[116:119]
v_lshlrev_b32 v234,16,v209
v_lshlrev_b32 v232,16,v205
M a[120:123],v[220:223],a[244:247],0
v_lshlrev_b32 v233,16,v207
v_lshlrev_b32 v237,16,v215
M a[120:123],a[200:203],v[224:227],a[120:123]
s_waitcnt lgkmcnt(1)
v_lshlrev_b32 v236,16,v213
v_lshlrev_b32 v235,16,v211
M a[120:123],a[196:199],a[240:243],a[120:123]
s_waitcnt lgkmcnt(0)
v_fmac_f32 v232,s43,v234
v_fmac_f32 v237,4.0,v233
M a[124:127],a[196:199],v[216:219],0
buffer_load_dwordx4 a[196:199],v251,s[20:23],s46 offen offset:1024 sc1
M a[124:127],a[200:203],a[240:243],a[124:127]
v_fma_f32 v238,-4.0,v234,v236
v_fmac_f32 v232,s45,v236
M a[124:127],v[220:223],v[224:227],a[124:127]
s_waitcnt vmcnt(13)
buffer_load_dwordx4 a[200:203],v251,s[20:23],s46 offen offset:2048 sc1
M a[128:131],a[192:195],a[224:227],0
s_waitcnt vmcnt(13)
s_add_u32 s47,s44,30720
v_fmac_f32 v237,s41,v235
v_sub_f32 v236,v236,v234
M a[128:131],a[212:215],a[228:231],a[128:131]
s_waitcnt vmcnt(12)
v_fma_f32 v234,-4.0,v233,v235
v_sub_f32 v235,v235,v233
M a[128:131],a[208:211],a[232:235],a[128:131]
v_add_f32 v233,v238,v234
v_sub_f32 v238,v238,v234
M a[132:135],a[208:211],a[236:239],0
buffer_load_dwordx4 v[220:223],v251,s[20:23],s47 offen offset:0 sc1
M a[132:135],a[212:215],a[232:235],a[132:135]
v_fma_f32 v234,2.0,v235,v236
v_fmac_f32 v236,-2.0,v235
M a[132:135],a[192:195],a[228:231],a[132:135]
v_and_b32 v209,s42,v209
v_and_b32 v205,s42,v205
M a[136:139],a[192:195],a[232:235],0
v_and_b32 v207,s42,v207
v_and_b32 v215,s42,v215
M a[136:139],a[212:215],a[236:239],a[136:139]
v_and_b32 v213,s42,v213
v_and_b32 v211,s42,v211
M a[136:139],a[208:211],a[248:251],a[136:139]
v_fmac_f32 v205,s43,v209
v_fmac_f32 v215,4.0,v207
M a[140:143],a[208:211],v[228:231],0
v_fma_f32 v235,-4.0,v209,v213
v_fmac_f32 v205,s45,v213
M a[140:143],a[212:215],a[248:251],a[140:143]
v_fmac_f32 v215,s41,v211
v_sub_f32 v213,v213,v209
M a[140:143],a[192:195],a[236:239],a[140:143]
v_fma_f32 v209,-4.0,v207,v211
v_sub_f32 v211,v211,v207
M a[144:147],a[192:195],a[248:251],0
v_add_f32 v207,v235,v209
v_sub_f32 v235,v235,v209
M a[144:147],a[212:215],v[228:231],a[144:147]
v_fma_f32 v209,2.0,v211,v213
v_fmac_f32 v213,-2.0,v211
M a[144:147],a[208:211],a[244:247],a[144:147]
v_cvt_pk_bf16_f32 v205,v232,v205
v_cvt_pk_bf16_f32 v215,v237,v215
M a[148:151],a[208:211],v[224:227],0
v_cvt_pk_bf16_f32 v207,v233,v207
v_cvt_pk_bf16_f32 v211,v234,v209
M a[148:151],a[212:215],a[244:247],a[148:151]
v_cvt_pk_bf16_f32 v209,v238,v235
v_cvt_pk_bf16_f32 v213,v236,v213
M a[148:151],a[192:195],v[228:231],a[148:151]
ds_write2st64_b64 v247,v[204:205],v[214:215] offset0:171 offset1:188
M a[152:155],a[192:195],a[244:247],0
s_add_u32 s28,s30,1179712
buffer_load_dwordx2 v[204:205],v245,s[12:15],s28 offen offset:0
M a[152:155],a[212:215],v[224:227],a[152:155]
ds_write2st64_b64 v247,v[206:207],v[208:209] offset0:103 offset1:120
M a[152:155],a[208:211],a[240:243],a[152:155]
buffer_load_dwordx2 v[214:215],v245,s[16:19],s28 offen offset:1536
M a[156:159],a[208:211],v[216:219],0
ds_write2st64_b64 v247,v[210:211],v[212:213] offset0:137 offset1:154
M a[156:159],a[212:215],a[240:243],a[156:159]
v_fmac_f32 v239,s43,v241
v_fmac_f32 v244,4.0,v240
M a[156:159],a[192:195],v[224:227],a[156:159]
s_waitcnt vmcnt(8)
buffer_load_dwordx4 a[208:211],v251,s[20:23],s47 offen offset:1024 sc1
M a[160:163],a[204:207],a[224:227],0
s_waitcnt vmcnt(8)
v_fma_f32 v232,-4.0,v241,v243
v_fmac_f32 v239,s45,v243
M a[160:163],a[216:219],a[228:231],a[160:163]
s_waitcnt vmcnt(7)
v_fmac_f32 v244,s41,v242
v_sub_f32 v243,v243,v241
M a[160:163],a[220:223],a[232:235],a[160:163]
v_fma_f32 v241,-4.0,v240,v242
v_sub_f32 v242,v242,v240
M a[164:167],a[220:223],a[236:239],0
buffer_load_dwordx4 a[212:215],v251,s[20:23],s47 offen offset:2048 sc1
M a[164:167],a[216:219],a[232:235],a[164:167]
s_add_u32 s48,s44,33792
v_add_f32 v240,v232,v241
v_sub_f32 v232,v232,v241
M a[164:167],a[204:207],a[228:231],a[164:167]
v_fma_f32 v241,2.0,v242,v243
v_fmac_f32 v243,-2.0,v242
M a[168:171],a[204:207],a[232:235],0
v_cvt_pk_bf16_f32 v233,v239,v244
v_cvt_pk_bf16_f32 v234,v240,v232
M a[168:171],a[216:219],a[236:239],a[168:171]
buffer_load_dwordx2 v[206:207],v245,s[8:11],s28 offen offset:0
M a[168:171],a[220:223],a[248:251],a[168:171]
v_cvt_pk_bf16_f32 v235,v241,v243
v_add_u32 v232,87040,v248
M a[172:175],a[220:223],v[228:231],0
ds_write_b16 v232,v233 offset:0
M a[172:175],a[216:219],a[248:251],a[172:175]
ds_write_b16_d16_hi v232,v233 offset:8704
M a[172:175],a[204:207],a[236:239],a[172:175]
buffer_load_dwordx2 v[208:209],v245,s[8:11],s28 offen offset:384
M a[176:179],a[204:207],a[248:251],0
ds_write_b16 v248,v234 offset:52224
M a[176:179],a[216:219],v[228:231],a[176:179]
ds_write_b16_d16_hi v248,v234 offset:60928
M a[176:179],a[220:223],a[244:247],a[176:179]
ds_read_b128 a[232:235],v249 offset:34816
v_add_u32 v232,69632,v248
M a[180:183],a[220:223],v[224:227],0
buffer_load_dwordx2 v[210:211],v245,s[8:11],s28 offen offset:768
M a[180:183],a[216:219],a[244:247],a[180:183]
ds_read_b128 a[236:239],v250 offset:34816
ds_read_b128 a[248:251],v249 offset:35328
M a[180:183],a[204:207],v[228:231],a[180:183]
ds_read_b128 v[228:231],v250 offset:35328
ds_write_b16 v232,v235 offset:0
M a[184:187],a[204:207],a[244:247],0
ds_write_b16_d16_hi v232,v235 offset:8704
M a[184:187],a[216:219],v[224:227],a[184:187]
buffer_load_dwordx2 v[212:213],v245,s[8:11],s28 offen offset:1152
M a[184:187],a[220:223],a[240:243],a[184:187]
s_add_u32 s29,s30,128
v_lshlrev_b32 v234,16,v196
v_lshlrev_b32 v232,16,v192
M a[188:191],a[220:223],v[216:219],0
v_lshlrev_b32 v233,16,v194
v_lshlrev_b32 v237,16,v202
M a[188:191],a[216:219],a[240:243],a[188:191]
ds_read_b128 a[220:223],v249 offset:35840
v_lshlrev_b32 v236,16,v200
M a[188:191],a[204:207],v[224:227],a[188:191]
s_waitcnt vmcnt(11) lgkmcnt(6)
buffer_load_short_d16_hi v239,v246,s[12:15],s29 offen offset:0
M v[0:3],a[252:255],a[232:235],0
s_waitcnt vmcnt(11) lgkmcnt(5)
ds_read_b128 v[216:219],v250 offset:35840
v_lshlrev_b32 v235,16,v198
M v[0:3],a[196:199],a[236:239],v[0:3]
s_waitcnt vmcnt(10) lgkmcnt(5)
buffer_load_short_d16_hi v240,v246,s[8:11],s29 offen offset:0
M v[0:3],a[200:203],a[248:251],v[0:3]
s_waitcnt lgkmcnt(4)
v_fmac_f32 v232,s43,v234
v_fmac_f32 v237,4.0,v233
M v[4:7],a[200:203],v[228:231],0
buffer_load_short_d16_hi v241,v246,s[8:11],s29 offen offset:384
M v[4:7],a[196:199],a[248:251],v[4:7]
ds_read_b128 a[216:219],v249 offset:36352
v_fma_f32 v238,-4.0,v234,v236
M v[4:7],a[252:255],a[236:239],v[4:7]
buffer_load_short_d16_hi v242,v246,s[8:11],s29 offen offset:768
M v[8:11],a[252:255],a[248:251],0
ds_read_b128 a[240:243],v250 offset:36352
v_fmac_f32 v232,s45,v236
M v[8:11],a[196:199],v[228:231],v[8:11]
s_waitcnt lgkmcnt(3)
buffer_load_short_d16_hi v243,v246,s[8:11],s29 offen offset:1152
M v[8:11],a[200:203],a[220:223],v[8:11]
s_waitcnt lgkmcnt(2)
buffer_load_dwordx4 a[192:195],v251,s[20:23],s48 offen offset:0 sc1
M v[12:15],a[200:203],v[216:219],0
buffer_load_dwordx4 a[224:227],v251,s[20:23],s48 offen offset:1024 sc1
M v[12:15],a[196:199],a[220:223],v[12:15]
buffer_load_dwordx4 a[228:231],v251,s[20:23],s48 offen offset:2048 sc1
M v[12:15],a[252:255],v[228:231],v[12:15]
s_add_u32 s46,s44,36864
ds_read_b128 a[204:207],v250 offset:36864
ds_read_b128 v[224:227],v249 offset:36864
M v[16:19],a[252:255],a[220:223],0
v_fmac_f32 v237,s41,v235
v_sub_f32 v236,v236,v234
M v[16:19],a[196:199],v[216:219],v[16:19]
s_waitcnt lgkmcnt(3)
v_fma_f32 v234,-4.0,v233,v235
v_sub_f32 v235,v235,v233
M v[16:19],a[200:203],a[216:219],v[16:19]
s_waitcnt lgkmcnt(2)
v_add_f32 v233,v238,v234
v_sub_f32 v238,v238,v234
M v[20:23],a[200:203],a[240:243],0
v_fma_f32 v234,2.0,v235,v236
v_fmac_f32 v236,-2.0,v235
M v[20:23],a[196:199],a[216:219],v[20:23]
v_and_b32 v196,s42,v196
v_and_b32 v192,s42,v192
M v[20:23],a[252:255],v[216:219],v[20:23]
v_and_b32 v194,s42,v194
v_and_b32 v202,s42,v202
M v[24:27],a[252:255],a[216:219],0
v_and_b32 v200,s42,v200
v_and_b32 v198,s42,v198
M v[24:27],a[196:199],a[240:243],v[24:27]
s_waitcnt lgkmcnt(1)
v_fmac_f32 v192,s43,v196
v_fmac_f32 v202,4.0,v194
M v[24:27],a[200:203],a[204:207],v[24:27]
s_waitcnt lgkmcnt(0)
v_fma_f32 v235,-4.0,v196,v200
v_fmac_f32 v192,s45,v200
M v[28:31],a[200:203],v[224:227],0
buffer_load_short_d16_hi v244,v246,s[16:19],s29 offen offset:1536
M v[28:31],a[196:199],a[204:207],v[28:31]
v_fmac_f32 v202,s41,v198
v_sub_f32 v200,v200,v196
M v[28:31],a[252:255],a[240:243],v[28:31]
s_waitcnt vmcnt(17)
buffer_load_dwordx4 a[244:247],v251,s[20:23],s46 offen offset:0 sc1
M v[32:35],v[220:223],a[232:235],0
s_waitcnt vmcnt(15)
v_fma_f32 v196,-4.0,v194,v198
v_sub_f32 v198,v198,v194
M v[32:35],a[208:211],a[236:239],v[32:35]
s_waitcnt vmcnt(14)
v_add_f32 v194,v235,v196
v_sub_f32 v235,v235,v196
M v[32:35],a[212:215],a[248:251],v[32:35]
v_fma_f32 v196,2.0,v198,v200
v_fmac_f32 v200,-2.0,v198
M v[36:39],a[212:215],v[228:231],0
global_load_dword a200,v251,s[64:65]
M v[36:39],a[208:211],a[248:251],v[36:39]
v_cvt_pk_bf16_f32 v192,v232,v192
v_cvt_pk_bf16_f32 v202,v237,v202
M v[36:39],v[220:223],a[236:239],v[36:39]
buffer_load_dwordx4 a[200:203],v251,s[20:23],s46 offen offset:1024 sc1
M v[40:43],v[220:223],a[248:251],0
v_cvt_pk_bf16_f32 v194,v233,v194
v_cvt_pk_bf16_f32 v198,v234,v196
M v[40:43],a[208:211],v[228:231],v[40:43]
v_cvt_pk_bf16_f32 v196,v238,v235
v_cvt_pk_bf16_f32 v200,v236,v200
M v[40:43],a[212:215],a[220:223],v[40:43]
v_lshlrev_b32 v234,16,v197
v_lshlrev_b32 v232,16,v193
M v[44:47],a[212:215],v[216:219],0
buffer_load_dwordx4 a[196:199],v251,s[20:23],s46 offen offset:2048 sc1
M v[44:47],a[208:211],a[220:223],v[44:47]
s_add_u32 s47,s44,39936
v_lshlrev_b32 v233,16,v195
v_lshlrev_b32 v237,16,v203
M v[44:47],v[220:223],v[228:231],v[44:47]
v_lshlrev_b32 v236,16,v201
v_lshlrev_b32 v235,16,v199
M v[48:51],v[220:223],a[220:223],0
v_fmac_f32 v232,s43,v234
v_fmac_f32 v237,4.0,v233
M v[48:51],a[208:211],v[216:219],v[48:51]
buffer_load_dwordx4 a[252:255],v251,s[20:23],s47 offen offset:0 sc1
M v[48:51],a[212:215],a[216:219],v[48:51]
v_fma_f32 v238,-4.0,v234,v236
v_fmac_f32 v232,s45,v236
v_fmac_f32 v237,s41,v235
M v[52:55],a[212:215],a[240:243],0
v_sub_f32 v236,v236,v234
v_fma_f32 v234,-4.0,v233,v235
M v[52:55],a[208:211],a[216:219],v[52:55]
v_sub_f32 v235,v235,v233
v_add_f32 v233,v238,v234
M v[52:55],v[220:223],v[216:219],v[52:55]
v_sub_f32 v238,v238,v234
v_fma_f32 v234,2.0,v235,v236
M v[56:59],v[220:223],a[216:219],0
v_fmac_f32 v236,-2.0,v235
v_and_b32 v197,s42,v197
M v[56:59],a[208:211],a[240:243],v[56:59]
v_and_b32 v193,s42,v193
v_and_b32 v195,s42,v195
M v[56:59],a[212:215],a[204:207],v[56:59]
v_and_b32 v203,s42,v203
v_and_b32 v201,s42,v201
M v[60:63],a[212:215],v[224:227],0
buffer_load_dwordx4 a[212:215],v251,s[20:23],s47 offen offset:1024 sc1
v_and_b32 v199,s42,v199
M v[60:63],a[208:211],a[204:207],v[60:63]
v_fmac_f32 v193,s43,v197
v_fmac_f32 v203,4.0,v195
M v[60:63],v[220:223],a[240:243],v[60:63]
s_waitcnt vmcnt(9)
buffer_load_dwordx4 a[208:211],v251,s[20:23],s47 offen offset:2048 sc1
M v[64:67],a[192:195],a[232:235],0
s_waitcnt vmcnt(9)
s_add_u32 s48,s44,43008
v_fma_f32 v235,-4.0,v197,v201
v_fmac_f32 v193,s45,v201
M v[64:67],a[224:227],a[236:239],v[64:67]
s_waitcnt vmcnt(8)
v_fmac_f32 v203,s41,v199
v_sub_f32 v201,v201,v197
M v[64:67],a[228:231],a[248:251],v[64:67]
v_fma_f32 v197,-4.0,v195,v199
v_sub_f32 v199,v199,v195
M v[68:71],a[228:231],v[228:231],0
buffer_load_dwordx4 v[220:223],v251,s[20:23],s48 offen offset:0 sc1
M v[68:71],a[224:227],a[248:251],v[68:71]
v_add_f32 v195,v235,v197
v_sub_f32 v235,v235,v197
v_fma_f32 v197,2.0,v199,v201
M v[68:71],a[192:195],a[236:239],v[68:71]
v_fmac_f32 v201,-2.0,v199
v_cvt_pk_bf16_f32 v193,v232,v193
M v[72:75],a[192:195],a[248:251],0
v_cvt_pk_bf16_f32 v203,v237,v203
v_cvt_pk_bf16_f32 v195,v233,v195
M v[72:75],a[224:227],v[228:231],v[72:75]
buffer_load_dwordx4 a[232:235],v251,s[20:23],s48 offen offset:1024 sc1
M v[72:75],a[228:231],a[220:223],v[72:75]
v_cvt_pk_bf16_f32 v199,v234,v197
v_cvt_pk_bf16_f32 v197,v238,v235
M v[76:79],a[228:231],v[216:219],0
v_cvt_pk_bf16_f32 v201,v236,v201
M v[76:79],a[224:227],a[220:223],v[76:79]
ds_write2st64_b64 v247,v[192:193],v[202:203] offset0:172 offset1:189
M v[76:79],a[192:195],v[228:231],v[76:79]
s_add_u32 s28,s30,128
buffer_load_dwordx4 a[236:239],v251,s[20:23],s48 offen offset:2048 sc1
M v[80:83],a[192:195],a[220:223],0
s_add_u32 s46,s44,64512
ds_write2st64_b64 v247,v[194:195],v[196:197] offset0:104 offset1:121
M v[80:83],a[224:227],v[216:219],v[80:83]
buffer_load_dwordx2 v[192:193],v254,s[12:15],s28 offen offset:0
M v[80:83],a[228:231],a[216:219],v[80:83]
ds_read_b128 a[248:251],v249 offset:43520
ds_write2st64_b64 v247,v[198:199],v[200:201] offset0:138 offset1:155
M v[84:87],a[228:231],a[240:243],0
ds_read_b128 v[228:231],v250 offset:43520
v_lshlrev_b32 v234,16,v208
M v[84:87],a[224:227],a[216:219],v[84:87]
buffer_load_dwordx2 v[202:203],v254,s[16:19],s28 offen offset:1536
M v[84:87],a[192:195],v[216:219],v[84:87]
ds_read_b128 a[220:223],v249 offset:44032
ds_read_b128 v[216:219],v250 offset:44032
M v[88:91],a[192:195],a[216:219],0
v_lshlrev_b32 v232,16,v204
v_lshlrev_b32 v233,16,v206
M v[88:91],a[224:227],a[240:243],v[88:91]
v_lshlrev_b32 v237,16,v214
v_lshlrev_b32 v236,16,v212
M v[88:91],a[228:231],a[204:207],v[88:91]
buffer_load_dwordx2 v[194:195],v254,s[8:11],s28 offen offset:0
M v[92:95],a[228:231],v[224:227],0
v_lshlrev_b32 v235,16,v210
v_fmac_f32 v232,s43,v234
M v[92:95],a[224:227],a[204:207],v[92:95]
ds_read_b128 a[228:231],v249 offset:44544
v_fmac_f32 v237,4.0,v233
M v[92:95],a[192:195],a[240:243],v[92:95]
s_waitcnt vmcnt(12) lgkmcnt(5)
ds_read_b128 v[224:227],v250 offset:44544
v_fma_f32 v238,-4.0,v234,v236
M v[96:99],a[244:247],a[248:251],0
s_waitcnt vmcnt(10) lgkmcnt(4)
buffer_load_dwordx2 v[196:197],v254,s[8:11],s28 offen offset:384
M v[96:99],a[200:203],v[228:231],v[96:99]
s_waitcnt vmcnt(10) lgkmcnt(3)
v_fmac_f32 v232,s45,v236
v_fmac_f32 v237,s41,v235
M v[96:99],a[196:199],a[220:223],v[96:99]
s_waitcnt lgkmcnt(2)
v_sub_f32 v236,v236,v234
v_fma_f32 v234,-4.0,v233,v235
M v[100:103],a[196:199],v[216:219],0
v_sub_f32 v235,v235,v233
v_add_f32 v233,v238,v234
M v[100:103],a[200:203],a[220:223],v[100:103]
buffer_load_dwordx2 v[198:199],v254,s[8:11],s28 offen offset:768
M v[100:103],a[244:247],v[228:231],v[100:103]
ds_read_b128 a[204:207],v249 offset:45056
ds_read_b128 a[224:227],v250 offset:45056
M v[104:107],a[244:247],a[220:223],0
v_sub_f32 v238,v238,v234
v_fma_f32 v234,2.0,v235,v236
M v[104:107],a[200:203],v[216:219],v[104:107]
s_waitcnt lgkmcnt(3)
v_fmac_f32 v236,-2.0,v235
v_and_b32 v208,s42,v208
M v[104:107],a[196:199],a[228:231],v[104:107]
s_waitcnt lgkmcnt(2)
buffer_load_dwordx2 v[200:201],v254,s[8:11],s28 offen offset:1152
M v[108:111],a[196:199],v[224:227],0
v_and_b32 v204,s42,v204
v_and_b32 v206,s42,v206
M v[108:111],a[200:203],a[228:231],v[108:111]
ds_read_b128 a[192:195],v250 offset:45568
v_and_b32 v214,s42,v214
M v[108:111],a[244:247],v[216:219],v[108:111]
ds_read_b128 a[240:243],v249 offset:45568
v_and_b32 v212,s42,v212
M v[112:115],a[244:247],a[228:231],0
buffer_load_dwordx4 a[216:219],v251,s[20:23],s46 offen offset:0 sc1
M v[112:115],a[200:203],v[224:227],v[112:115]
s_waitcnt lgkmcnt(3)
v_and_b32 v210,s42,v210
v_fmac_f32 v204,s43,v208
M v[112:115],a[196:199],a[204:207],v[112:115]
s_waitcnt lgkmcnt(2)
v_fmac_f32 v214,4.0,v206
v_fma_f32 v235,-4.0,v208,v212
M v[116:119],a[196:199],a[224:227],0
v_fmac_f32 v204,s45,v212
v_fmac_f32 v214,s41,v210
M v[116:119],a[200:203],a[204:207],v[116:119]
v_sub_f32 v212,v212,v208
v_fma_f32 v208,-4.0,v206,v210
M v[116:119],a[244:247],v[224:227],v[116:119]
v_sub_f32 v210,v210,v206
v_add_f32 v206,v235,v208
M v[120:123],a[244:247],a[204:207],0
v_sub_f32 v235,v235,v208
v_fma_f32 v208,2.0,v210,v212
M v[120:123],a[200:203],a[224:227],v[120:123]
s_waitcnt lgkmcnt(1)
v_fmac_f32 v212,-2.0,v210
v_cvt_pk_bf16_f32 v204,v232,v204
M v[120:123],a[196:199],a[192:195],v[120:123]
s_waitcnt lgkmcnt(0)
v_cvt_pk_bf16_f32 v214,v237,v214
v_cvt_pk_bf16_f32 v206,v233,v206
M v[124:127],a[196:199],a[240:243],0
buffer_load_dwordx4 a[196:199],v251,s[20:23],s46 offen offset:1024 sc1
M v[124:127],a[200:203],a[192:195],v[124:127]
v_cvt_pk_bf16_f32 v210,v234,v208
v_cvt_pk_bf16_f32 v208,v238,v235
M v[124:127],a[244:247],a[224:227],v[124:127]
s_waitcnt vmcnt(13)
buffer_load_dwordx4 a[200:203],v251,s[20:23],s46 offen offset:2048 sc1
M v[128:131],a[252:255],a[248:251],0
s_waitcnt vmcnt(13)
s_add_u32 s47,s44,67584
v_cvt_pk_bf16_f32 v212,v236,v212
v_lshlrev_b32 v234,16,v209
M v[128:131],a[212:215],v[228:231],v[128:131]
s_waitcnt vmcnt(12)
v_lshlrev_b32 v232,16,v205
v_lshlrev_b32 v233,16,v207
M v[128:131],a[208:211],a[220:223],v[128:131]
v_lshlrev_b32 v237,16,v215
v_lshlrev_b32 v236,16,v213
M v[132:135],a[208:211],v[216:219],0
buffer_load_dwordx4 a[244:247],v251,s[20:23],s47 offen offset:0 sc1
M v[132:135],a[212:215],a[220:223],v[132:135]
v_lshlrev_b32 v235,16,v211
v_fmac_f32 v232,s43,v234
M v[132:135],a[252:255],v[228:231],v[132:135]
v_fmac_f32 v237,4.0,v233
v_fma_f32 v238,-4.0,v234,v236
M v[136:139],a[252:255],a[220:223],0
v_fmac_f32 v232,s45,v236
v_fmac_f32 v237,s41,v235
M v[136:139],a[212:215],v[216:219],v[136:139]
v_sub_f32 v236,v236,v234
v_fma_f32 v234,-4.0,v233,v235
M v[136:139],a[208:211],a[228:231],v[136:139]
v_sub_f32 v235,v235,v233
v_add_f32 v233,v238,v234
M v[140:143],a[208:211],v[224:227],0
v_sub_f32 v238,v238,v234
v_fma_f32 v234,2.0,v235,v236
M v[140:143],a[212:215],a[228:231],v[140:143]
v_fmac_f32 v236,-2.0,v235
v_and_b32 v209,s42,v209
M v[140:143],a[252:255],v[216:219],v[140:143]
v_and_b32 v205,s42,v205
v_and_b32 v207,s42,v207
M v[144:147],a[252:255],a[228:231],0
v_and_b32 v215,s42,v215
v_and_b32 v213,s42,v213
M v[144:147],a[212:215],v[224:227],v[144:147]
v_and_b32 v211,s42,v211
v_fmac_f32 v205,s43,v209
M v[144:147],a[208:211],a[204:207],v[144:147]
v_fmac_f32 v215,4.0,v207
v_fma_f32 v235,-4.0,v209,v213
M v[148:151],a[208:211],a[224:227],0
v_fmac_f32 v205,s45,v213
v_fmac_f32 v215,s41,v211
M v[148:151],a[212:215],a[204:207],v[148:151]
v_sub_f32 v213,v213,v209
v_fma_f32 v209,-4.0,v207,v211
M v[148:151],a[252:255],v[224:227],v[148:151]
v_sub_f32 v211,v211,v207
v_add_f32 v207,v235,v209
M v[152:155],a[252:255],a[204:207],0
v_sub_f32 v235,v235,v209
v_fma_f32 v209,2.0,v211,v213
M v[152:155],a[212:215],a[224:227],v[152:155]
v_fmac_f32 v213,-2.0,v211
v_cvt_pk_bf16_f32 v205,v232,v205
M v[152:155],a[208:211],a[192:195],v[152:155]
v_cvt_pk_bf16_f32 v215,v237,v215
v_cvt_pk_bf16_f32 v207,v233,v207
M v[156:159],a[208:211],a[240:243],0
buffer_load_dwordx4 a[208:211],v251,s[20:23],s47 offen offset:1024 sc1
M v[156:159],a[212:215],a[192:195],v[156:159]
v_cvt_pk_bf16_f32 v211,v234,v209
v_cvt_pk_bf16_f32 v209,v238,v235
M v[156:159],a[252:255],a[224:227],v[156:159]
s_waitcnt vmcnt(13)
buffer_load_dwordx4 a[212:215],v251,s[20:23],s47 offen offset:2048 sc1
M v[160:163],v[220:223],a[248:251],0
s_waitcnt vmcnt(13)
s_add_u32 s48,s44,70656
v_cvt_pk_bf16_f32 v213,v236,v213
M v[160:163],a[232:235],v[228:231],v[160:163]
s_waitcnt vmcnt(12)
ds_write2st64_b64 v247,v[204:205],v[214:215] offset0:173 offset1:190
M v[160:163],a[236:239],a[220:223],v[160:163]
s_add_u32 s28,s30,393344
ds_write2st64_b64 v247,v[206:207],v[208:209] offset0:105 offset1:122
M v[164:167],a[236:239],v[216:219],0
buffer_load_dwordx2 v[204:205],v245,s[12:15],s28 offen offset:0
M v[164:167],a[232:235],a[220:223],v[164:167]
ds_write2st64_b64 v247,v[210:211],v[212:213] offset0:139 offset1:156
M v[164:167],v[220:223],v[228:231],v[164:167]
buffer_load_dwordx2 v[214:215],v245,s[16:19],s28 offen offset:1536
M v[168:171],v[220:223],a[220:223],0
s_waitcnt vmcnt(10)
v_lshlrev_b32 v234,16,v196
v_lshlrev_b32 v232,16,v192
M v[168:171],a[232:235],v[216:219],v[168:171]
v_lshlrev_b32 v233,16,v194
v_lshlrev_b32 v237,16,v202
M v[168:171],a[236:239],a[228:231],v[168:171]
s_waitcnt vmcnt(8)
v_lshlrev_b32 v236,16,v200
v_lshlrev_b32 v235,16,v198
M v[172:175],a[236:239],v[224:227],0
buffer_load_dwordx2 v[206:207],v245,s[8:11],s28 offen offset:0
M v[172:175],a[232:235],a[228:231],v[172:175]
v_fmac_f32 v232,s43,v234
v_fmac_f32 v237,4.0,v233
M v[172:175],v[220:223],v[216:219],v[172:175]
v_fma_f32 v238,-4.0,v234,v236
v_fmac_f32 v232,s45,v236
M v[176:179],v[220:223],a[228:231],0
v_fmac_f32 v237,s41,v235
v_sub_f32 v236,v236,v234
M v[176:179],a[232:235],v[224:227],v[176:179]
buffer_load_dwordx2 v[208:209],v245,s[8:11],s28 offen offset:384
M v[176:179],a[236:239],a[204:207],v[176:179]
s_waitcnt lgkmcnt(0)
s_barrier
ds_read_b128 a[220:223],v249 offset:52224
M v[180:183],a[236:239],a[224:227],0
ds_read_b128 v[216:219],v250 offset:52224
v_fma_f32 v234,-4.0,v233,v235
M v[180:183],a[232:235],a[204:207],v[180:183]
ds_read_b128 a[228:231],v249 offset:52736
v_sub_f32 v235,v235,v233
M v[180:183],v[220:223],v[224:227],v[180:183]
buffer_load_dwordx2 v[210:211],v245,s[8:11],s28 offen offset:768
M v[184:187],v[220:223],a[204:207],0
ds_read_b128 v[224:227],v250 offset:52736
v_add_f32 v233,v238,v234
M v[184:187],a[232:235],a[224:227],v[184:187]
v_sub_f32 v238,v238,v234
v_fma_f32 v234,2.0,v235,v236
M v[184:187],a[236:239],a[192:195],v[184:187]
v_fmac_f32 v236,-2.0,v235
v_and_b32 v196,s42,v196
M v[188:191],a[236:239],a[240:243],0
buffer_load_dwordx2 v[212:213],v245,s[8:11],s28 offen offset:1152
M v[188:191],a[232:235],a[192:195],v[188:191]
ds_read_b128 a[236:239],v249 offset:53248
v_and_b32 v192,s42,v192
M v[188:191],v[220:223],a[224:227],v[188:191]
s_waitcnt vmcnt(11) lgkmcnt(4)
ds_read_b128 a[240:243],v250 offset:53248
v_and_b32 v194,s42,v194
M a[0:3],a[216:219],a[220:223],a[0:3]
s_waitcnt vmcnt(10) lgkmcnt(4)
v_and_b32 v202,s42,v202
v_and_b32 v200,s42,v200
M a[0:3],a[196:199],v[216:219],a[0:3]
s_waitcnt vmcnt(9) lgkmcnt(3)
buffer_load_dwordx4 a[252:255],v251,s[20:23],s48 offen offset:0 sc1
M a[0:3],a[200:203],a[228:231],a[0:3]
s_waitcnt lgkmcnt(2)
v_and_b32 v198,s42,v198
v_fmac_f32 v192,s43,v196
M a[4:7],a[200:203],v[224:227],a[4:7]
v_fmac_f32 v202,4.0,v194
v_fma_f32 v235,-4.0,v196,v200
M a[4:7],a[196:199],a[228:231],a[4:7]
ds_read_b128 a[192:195],v249 offset:53760
v_fmac_f32 v192,s45,v200
M a[4:7],a[216:219],v[216:219],a[4:7]
buffer_load_dwordx4 a[248:251],v251,s[20:23],s48 offen offset:1024 sc1
M a[8:11],a[216:219],a[228:231],a[8:11]
ds_read_b128 a[232:235],v250 offset:53760
v_fmac_f32 v202,s41,v198
M a[8:11],a[196:199],v[224:227],a[8:11]
s_waitcnt lgkmcnt(3)
v_sub_f32 v200,v200,v196
v_fma_f32 v196,-4.0,v194,v198
M a[8:11],a[200:203],a[236:239],a[8:11]
s_waitcnt lgkmcnt(2)
v_sub_f32 v198,v198,v194
v_add_f32 v194,v235,v196
M a[12:15],a[200:203],a[240:243],a[12:15]
buffer_load_dwordx4 v[228:231],v251,s[20:23],s48 offen offset:2048 sc1
M a[12:15],a[196:199],a[236:239],a[12:15]
s_add_u32 s46,s44,73728
ds_read_b128 a[224:227],v250 offset:54272
v_sub_f32 v235,v235,v196
M a[12:15],a[216:219],v[224:227],a[12:15]
ds_read_b128 v[220:223],v249 offset:54272
v_fma_f32 v196,2.0,v198,v200
M a[16:19],a[216:219],a[236:239],a[16:19]
v_fmac_f32 v200,-2.0,v198
v_cvt_pk_bf16_f32 v192,v232,v192
M a[16:19],a[196:199],a[240:243],a[16:19]
s_waitcnt lgkmcnt(3)
buffer_load_dwordx4 a[204:207],v251,s[20:23],s46 offen offset:0 sc1
M a[16:19],a[200:203],a[192:195],a[16:19]
s_waitcnt lgkmcnt(2)
v_cvt_pk_bf16_f32 v202,v237,v202
v_cvt_pk_bf16_f32 v194,v233,v194
M a[20:23],a[200:203],a[232:235],a[20:23]
v_cvt_pk_bf16_f32 v198,v234,v196
v_cvt_pk_bf16_f32 v196,v238,v235
M a[20:23],a[196:199],a[192:195],a[20:23]
v_cvt_pk_bf16_f32 v200,v236,v200
v_lshlrev_b32 v234,16,v197
M a[20:23],a[216:219],a[240:243],a[20:23]
v_lshlrev_b32 v232,16,v193
v_lshlrev_b32 v233,16,v195
M a[24:27],a[216:219],a[192:195],a[24:27]
v_lshlrev_b32 v237,16,v203
v_lshlrev_b32 v236,16,v201
M a[24:27],a[196:199],a[232:235],a[24:27]
s_waitcnt lgkmcnt(1)
v_lshlrev_b32 v235,16,v199
v_fmac_f32 v232,s43,v234
M a[24:27],a[200:203],a[224:227],a[24:27]
s_waitcnt lgkmcnt(0)
v_fmac_f32 v237,4.0,v233
v_fma_f32 v238,-4.0,v234,v236
M a[28:31],a[200:203],v[220:223],a[28:31]
buffer_load_dwordx4 a[200:203],v251,s[20:23],s46 offen offset:1024 sc1
M a[28:31],a[196:199],a[224:227],a[28:31]
v_fmac_f32 v232,s45,v236
v_fmac_f32 v237,s41,v235
M a[28:31],a[216:219],a[232:235],a[28:31]
s_waitcnt vmcnt(13)
buffer_load_dwordx4 a[196:199],v251,s[20:23],s46 offen offset:2048 sc1
M a[32:35],a[244:247],a[220:223],a[32:35]
s_waitcnt vmcnt(13)
s_add_u32 s47,s44,76800
v_sub_f32 v236,v236,v234
v_fma_f32 v234,-4.0,v233,v235
M a[32:35],a[208:211],v[216:219],a[32:35]
s_waitcnt vmcnt(12)
v_sub_f32 v235,v235,v233
v_add_f32 v233,v238,v234
M a[32:35],a[212:215],a[228:231],a[32:35]
v_sub_f32 v238,v238,v234
v_fma_f32 v234,2.0,v235,v236
M a[36:39],a[212:215],v[224:227],a[36:39]
buffer_load_dwordx4 a[216:219],v251,s[20:23],s47 offen offset:0 sc1
M a[36:39],a[208:211],a[228:231],a[36:39]
v_fmac_f32 v236,-2.0,v235
v_and_b32 v197,s42,v197
M a[36:39],a[244:247],v[216:219],a[36:39]
v_and_b32 v193,s42,v193
v_and_b32 v195,s42,v195
M a[40:43],a[244:247],a[228:231],a[40:43]
v_and_b32 v203,s42,v203
v_and_b32 v201,s42,v201
M a[40:43],a[208:211],v[224:227],a[40:43]
v_and_b32 v199,s42,v199
v_fmac_f32 v193,s43,v197
M a[40:43],a[212:215],a[236:239],a[40:43]
v_fmac_f32 v203,4.0,v195
v_fma_f32 v235,-4.0,v197,v201
M a[44:47],a[212:215],a[240:243],a[44:47]
v_fmac_f32 v193,s45,v201
v_fmac_f32 v203,s41,v199
M a[44:47],a[208:211],a[236:239],a[44:47]
v_sub_f32 v201,v201,v197
v_fma_f32 v197,-4.0,v195,v199
M a[44:47],a[244:247],v[224:227],a[44:47]
v_sub_f32 v199,v199,v195
v_add_f32 v195,v235,v197
M a[48:51],a[244:247],a[236:239],a[48:51]
v_sub_f32 v235,v235,v197
v_fma_f32 v197,2.0,v199,v201
M a[48:51],a[208:211],a[240:243],a[48:51]
v_fmac_f32 v201,-2.0,v199
v_cvt_pk_bf16_f32 v193,v232,v193
M a[48:51],a[212:215],a[192:195],a[48:51]
v_cvt_pk_bf16_f32 v203,v237,v203
v_cvt_pk_bf16_f32 v195,v233,v195
M a[52:55],a[212:215],a[232:235],a[52:55]
v_cvt_pk_bf16_f32 v199,v234,v197
v_cvt_pk_bf16_f32 v197,v238,v235
M a[52:55],a[208:211],a[192:195],a[52:55]
v_cvt_pk_bf16_f32 v201,v236,v201
M a[52:55],a[244:247],a[240:243],a[52:55]
ds_write2st64_b64 v247,v[192:193],v[202:203] offset0:204 offset1:221
M a[56:59],a[244:247],a[192:195],a[56:59]
s_add_u32 s28,s30,786560
buffer_load_dwordx2 v[192:193],v245,s[12:15],s28 offen offset:0
M a[56:59],a[208:211],a[232:235],a[56:59]
ds_write2st64_b64 v247,v[194:195],v[196:197] offset0:34 offset1:51
M a[56:59],a[212:215],a[224:227],a[56:59]
buffer_load_dwordx2 v[202:203],v245,s[16:19],s28 offen offset:1536
M a[60:63],a[212:215],v[220:223],a[60:63]
ds_write2st64_b64 v247,v[198:199],v[200:201] offset0:68 offset1:85
M a[60:63],a[208:211],a[224:227],a[60:63]
s_waitcnt vmcnt(11)
v_lshlrev_b32 v234,16,v208
v_lshlrev_b32 v232,16,v204
M a[60:63],a[244:247],a[232:235],a[60:63]
s_waitcnt vmcnt(8)
buffer_load_dwordx4 a[212:215],v251,s[20:23],s47 offen offset:1024 sc1
M a[64:67],a[252:255],a[220:223],a[64:67]
s_waitcnt vmcnt(8)
v_lshlrev_b32 v233,16,v206
v_lshlrev_b32 v237,16,v214
M a[64:67],a[248:251],v[216:219],a[64:67]
s_waitcnt vmcnt(7)
v_lshlrev_b32 v236,16,v212
v_lshlrev_b32 v235,16,v210
M a[64:67],v[228:231],a[228:231],a[64:67]
v_fmac_f32 v232,s43,v234
v_fmac_f32 v237,4.0,v233
M a[68:71],v[228:231],v[224:227],a[68:71]
buffer_load_dwordx4 a[208:211],v251,s[20:23],s47 offen offset:2048 sc1
M a[68:71],a[248:251],a[228:231],a[68:71]
s_add_u32 s48,s44,79872
v_fma_f32 v238,-4.0,v234,v236
v_fmac_f32 v232,s45,v236
M a[68:71],a[252:255],v[216:219],a[68:71]
v_fmac_f32 v237,s41,v235
v_sub_f32 v236,v236,v234
M a[72:75],a[252:255],a[228:231],a[72:75]
v_fma_f32 v234,-4.0,v233,v235
v_sub_f32 v235,v235,v233
M a[72:75],a[248:251],v[224:227],a[72:75]
buffer_load_dwordx2 v[194:195],v245,s[8:11],s28 offen offset:0
M a[72:75],v[228:231],a[236:239],a[72:75]
v_add_f32 v233,v238,v234
v_sub_f32 v238,v238,v234
M a[76:79],v[228:231],a[240:243],a[76:79]
v_fma_f32 v234,2.0,v235,v236
v_fmac_f32 v236,-2.0,v235
M a[76:79],a[248:251],a[236:239],a[76:79]
v_and_b32 v208,s42,v208
v_and_b32 v204,s42,v204
M a[76:79],a[252:255],v[224:227],a[76:79]
buffer_load_dwordx2 v[196:197],v245,s[8:11],s28 offen offset:384
M a[80:83],a[252:255],a[236:239],a[80:83]
v_and_b32 v206,s42,v206
v_and_b32 v214,s42,v214
M a[80:83],a[248:251],a[240:243],a[80:83]
v_and_b32 v212,s42,v212
v_and_b32 v210,s42,v210
M a[80:83],v[228:231],a[192:195],a[80:83]
ds_read_b128 a[228:231],v249 offset:60928
v_fmac_f32 v204,s43,v208
M a[84:87],v[228:231],a[232:235],a[84:87]
buffer_load_dwordx2 v[198:199],v245,s[8:11],s28 offen offset:768
M a[84:87],a[248:251],a[192:195],a[84:87]
ds_read_b128 v[224:227],v250 offset:60928
ds_read_b128 a[236:239],v249 offset:61440
M a[84:87],a[252:255],a[240:243],a[84:87]
ds_read_b128 a[240:243],v250 offset:61440
v_fmac_f32 v214,4.0,v206
M a[88:91],a[252:255],a[192:195],a[88:91]
v_fma_f32 v235,-4.0,v208,v212
v_fmac_f32 v204,s45,v212
M a[88:91],a[248:251],a[232:235],a[88:91]
buffer_load_dwordx2 v[200:201],v245,s[8:11],s28 offen offset:1152
M a[88:91],v[228:231],a[224:227],a[88:91]
v_fmac_f32 v214,s41,v210
v_sub_f32 v212,v212,v208
M a[92:95],v[228:231],v[220:223],a[92:95]
v_fma_f32 v208,-4.0,v206,v210
v_sub_f32 v210,v210,v206
M a[92:95],a[248:251],a[224:227],a[92:95]
ds_read_b128 v[220:223],v249 offset:61952
v_add_f32 v206,v235,v208
M a[92:95],a[252:255],a[232:235],a[92:95]
s_waitcnt vmcnt(11) lgkmcnt(4)
buffer_load_dwordx4 a[244:247],v251,s[20:23],s48 offen offset:0 sc1
M a[96:99],a[204:207],a[228:231],a[96:99]
s_waitcnt vmcnt(11) lgkmcnt(3)
ds_read_b128 v[228:231],v250 offset:61952
v_sub_f32 v235,v235,v208
M a[96:99],a[200:203],v[224:227],a[96:99]
s_waitcnt vmcnt(10) lgkmcnt(3)
v_fma_f32 v208,2.0,v210,v212
v_fmac_f32 v212,-2.0,v210
M a[96:99],a[196:199],a[236:239],a[96:99]
s_waitcnt lgkmcnt(2)
v_cvt_pk_bf16_f32 v204,v232,v204
v_cvt_pk_bf16_f32 v214,v237,v214
M a[100:103],a[196:199],a[240:243],a[100:103]
buffer_load_dwordx4 a[220:223],v251,s[20:23],s48 offen offset:1024 sc1
M a[100:103],a[200:203],a[236:239],a[100:103]
ds_read_b128 a[224:227],v249 offset:62464
v_cvt_pk_bf16_f32 v206,v233,v206
M a[100:103],a[204:207],v[224:227],a[100:103]
ds_read_b128 a[248:251],v250 offset:62464
v_cvt_pk_bf16_f32 v210,v234,v208
M a[104:107],a[204:207],a[236:239],a[104:107]
v_cvt_pk_bf16_f32 v208,v238,v235
v_cvt_pk_bf16_f32 v212,v236,v212
M a[104:107],a[200:203],a[240:243],a[104:107]
s_waitcnt lgkmcnt(3)
buffer_load_dwordx4 v[216:219],v251,s[20:23],s48 offen offset:2048 sc1
M a[104:107],a[196:199],v[220:223],a[104:107]
s_waitcnt lgkmcnt(2)
s_add_u32 s46,s44,82944
v_lshlrev_b32 v234,16,v209
v_lshlrev_b32 v232,16,v205
M a[108:111],a[196:199],v[228:231],a[108:111]
v_lshlrev_b32 v233,16,v207
v_lshlrev_b32 v237,16,v215
M a[108:111],a[200:203],v[220:223],a[108:111]
ds_read_b128 a[232:235],v250 offset:62976
v_lshlrev_b32 v236,16,v213
M a[108:111],a[204:207],a[240:243],a[108:111]
buffer_load_dwordx4 a[192:195],v251,s[20:23],s46 offen offset:0 sc1
M a[112:115],a[204:207],v[220:223],a[112:115]
ds_read_b128 a[252:255],v249 offset:62976
v_lshlrev_b32 v235,16,v211
M a[112:115],a[200:203],v[228:231],a[112:115]
s_waitcnt lgkmcnt(3)
v_fmac_f32 v232,s43,v234
v_fmac_f32 v237,4.0,v233
M a[112:115],a[196:199],a[224:227],a[112:115]
s_waitcnt lgkmcnt(2)
v_fma_f32 v238,-4.0,v234,v236
v_fmac_f32 v232,s45,v236
M a[116:119],a[196:199],a[248:251],a[116:119]
v_fmac_f32 v237,s41,v235
v_sub_f32 v236,v236,v234
M a[116:119],a[200:203],a[224:227],a[116:119]
v_fma_f32 v234,-4.0,v233,v235
v_sub_f32 v235,v235,v233
M a[116:119],a[204:207],v[228:231],a[116:119]
v_add_f32 v233,v238,v234
v_sub_f32 v238,v238,v234
M a[120:123],a[204:207],a[224:227],a[120:123]
v_fma_f32 v234,2.0,v235,v236
v_fmac_f32 v236,-2.0,v235
M a[120:123],a[200:203],a[248:251],a[120:123]
s_waitcnt lgkmcnt(1)
v_and_b32 v209,s42,v209
v_and_b32 v205,s42,v205
M a[120:123],a[196:199],a[232:235],a[120:123]
s_waitcnt lgkmcnt(0)
v_and_b32 v207,s42,v207
v_and_b32 v215,s42,v215
M a[124:127],a[196:199],a[252:255],a[124:127]
buffer_load_dwordx4 a[196:199],v251,s[20:23],s46 offen offset:1024 sc1
M a[124:127],a[200:203],a[232:235],a[124:127]
v_and_b32 v213,s42,v213
v_and_b32 v211,s42,v211
M a[124:127],a[204:207],a[248:251],a[124:127]
s_waitcnt vmcnt(13)
buffer_load_dwordx4 a[200:203],v251,s[20:23],s46 offen offset:2048 sc1
M a[128:131],a[216:219],a[228:231],a[128:131]
s_waitcnt vmcnt(11)
s_add_u32 s47,s44,86016
v_fmac_f32 v205,s43,v209
v_fmac_f32 v215,4.0,v207
M a[128:131],a[212:215],v[224:227],a[128:131]
s_waitcnt vmcnt(10)
v_fma_f32 v235,-4.0,v209,v213
v_fmac_f32 v205,s45,v213
M a[128:131],a[208:211],a[236:239],a[128:131]
v_fmac_f32 v215,s41,v211
v_sub_f32 v213,v213,v209
M a[132:135],a[208:211],a[240:243],a[132:135]
buffer_load_dwordx4 a[204:207],v251,s[20:23],s47 offen offset:0 sc1
M a[132:135],a[212:215],a[236:239],a[132:135]
v_fma_f32 v209,-4.0,v207,v211
v_sub_f32 v211,v211,v207
M a[132:135],a[216:219],v[224:227],a[132:135]
v_add_f32 v207,v235,v209
v_sub_f32 v235,v235,v209
M a[136:139],a[216:219],a[236:239],a[136:139]
v_fma_f32 v209,2.0,v211,v213
v_fmac_f32 v213,-2.0,v211
M a[136:139],a[212:215],a[240:243],a[136:139]
v_cvt_pk_bf16_f32 v205,v232,v205
v_cvt_pk_bf16_f32 v215,v237,v215
M a[136:139],a[208:211],v[220:223],a[136:139]
v_cvt_pk_bf16_f32 v207,v233,v207
v_cvt_pk_bf16_f32 v211,v234,v209
M a[140:143],a[208:211],v[228:231],a[140:143]
v_cvt_pk_bf16_f32 v209,v238,v235
v_cvt_pk_bf16_f32 v213,v236,v213
M a[140:143],a[212:215],v[220:223],a[140:143]
ds_write2st64_b64 v247,v[204:205],v[214:215] offset0:205 offset1:222
M a[140:143],a[216:219],a[240:243],a[140:143]
s_add_u32 s28,s30,1179776
buffer_load_dwordx2 v[204:205],v245,s[12:15],s28 offen offset:0
M a[144:147],a[216:219],v[220:223],a[144:147]
ds_write2st64_b64 v247,v[206:207],v[208:209] offset0:35 offset1:52
M a[144:147],a[212:215],v[228:231],a[144:147]
buffer_load_dwordx2 v[214:215],v245,s[16:19],s28 offen offset:1536
M a[144:147],a[208:211],a[224:227],a[144:147]
ds_write2st64_b64 v247,v[210:211],v[212:213] offset0:69 offset1:86
M a[148:151],a[208:211],a[248:251],a[148:151]
v_fmac_f32 v239,s43,v241
v_fmac_f32 v244,4.0,v240
M a[148:151],a[212:215],a[224:227],a[148:151]
buffer_load_dwordx2 v[206:207],v245,s[8:11],s28 offen offset:0
M a[148:151],a[216:219],v[228:231],a[148:151]
v_fma_f32 v232,-4.0,v241,v243
v_fmac_f32 v239,s45,v243
M a[152:155],a[216:219],a[224:227],a[152:155]
v_fmac_f32 v244,s41,v242
v_sub_f32 v243,v243,v241
M a[152:155],a[212:215],a[248:251],a[152:155]
v_fma_f32 v241,-4.0,v240,v242
v_sub_f32 v242,v242,v240
M a[152:155],a[208:211],a[232:235],a[152:155]
buffer_load_dwordx2 v[208:209],v245,s[8:11],s28 offen offset:384
M a[156:159],a[208:211],a[252:255],a[156:159]
v_add_f32 v240,v232,v241
v_sub_f32 v232,v232,v241
M a[156:159],a[212:215],a[232:235],a[156:159]
v_fma_f32 v241,2.0,v242,v243
v_fmac_f32 v243,-2.0,v242
M a[156:159],a[216:219],a[248:251],a[156:159]
s_waitcnt vmcnt(10)
v_cvt_pk_bf16_f32 v233,v239,v244
v_cvt_pk_bf16_f32 v234,v240,v232
M a[160:163],a[244:247],a[228:231],a[160:163]
s_waitcnt vmcnt(9)
buffer_load_dwordx4 a[208:211],v251,s[20:23],s47 offen offset:1024 sc1
M a[160:163],a[220:223],v[224:227],a[160:163]
s_waitcnt vmcnt(9)
v_cvt_pk_bf16_f32 v235,v241,v243
v_add_u32 v232,104448,v248
M a[160:163],v[216:219],a[236:239],a[160:163]
ds_write_b16 v232,v233 offset:0
M a[164:167],v[216:219],a[240:243],a[164:167]
ds_write_b16_d16_hi v232,v233 offset:8704
M a[164:167],a[220:223],a[236:239],a[164:167]
buffer_load_dwordx4 a[212:215],v251,s[20:23],s47 offen offset:2048 sc1
M a[164:167],a[244:247],v[224:227],a[164:167]
s_add_u32 s48,s44,89088
ds_write_b16 v248,v234 offset:17408
M a[168:171],a[244:247],a[236:239],a[168:171]
ds_write_b16_d16_hi v248,v234 offset:26112
M a[168:171],a[220:223],a[240:243],a[168:171]
ds_write_b16 v248,v235 offset:34816
M a[168:171],v[216:219],v[220:223],a[168:171]
buffer_load_dwordx2 v[210:211],v245,s[8:11],s28 offen offset:768
M a[172:175],v[216:219],v[228:231],a[172:175]
ds_write_b16_d16_hi v248,v235 offset:43520
M a[172:175],a[220:223],v[220:223],a[172:175]
v_lshlrev_b32 v234,16,v196
v_lshlrev_b32 v232,16,v192
M a[172:175],a[244:247],a[240:243],a[172:175]
v_add_u32 v249,0x4400,v249
v_add_u32 v250,0x4400,v250
M a[176:179],a[244:247],v[220:223],a[176:179]
buffer_load_dwordx2 v[212:213],v245,s[8:11],s28 offen offset:1152
M a[176:179],a[220:223],v[228:231],a[176:179]
s_add_u32 s29,s30,192
v_lshlrev_b32 v233,16,v194
v_lshlrev_b32 v237,16,v202
M a[176:179],v[216:219],a[224:227],a[176:179]
ds_read_b128 a[236:239],v249 offset:52224
v_lshlrev_b32 v236,16,v200
M a[180:183],v[216:219],a[248:251],a[180:183]
ds_read_b128 a[240:243],v250 offset:52224
v_lshlrev_b32 v235,16,v198
M a[180:183],a[220:223],a[224:227],a[180:183]
buffer_load_short_d16_hi v239,v246,s[12:15],s29 offen offset:0
M a[180:183],a[244:247],v[228:231],a[180:183]
ds_read_b128 v[220:223],v249 offset:52736
ds_read_b128 v[228:231],v250 offset:52736
M a[184:187],a[244:247],a[224:227],a[184:187]
buffer_load_short_d16_hi v240,v246,s[8:11],s29 offen offset:0
M a[184:187],a[220:223],a[248:251],a[184:187]
v_fmac_f32 v232,s43,v234
v_fmac_f32 v237,4.0,v233
M a[184:187],v[216:219],a[232:235],a[184:187]
buffer_load_short_d16_hi v241,v246,s[8:11],s29 offen offset:384
M a[188:191],v[216:219],a[252:255],a[188:191]
v_fma_f32 v238,-4.0,v234,v236
v_fmac_f32 v232,s45,v236
M a[188:191],a[220:223],a[232:235],a[188:191]
buffer_load_short_d16_hi v242,v246,s[8:11],s29 offen offset:768
M a[188:191],a[244:247],a[248:251],a[188:191]
s_waitcnt vmcnt(15) lgkmcnt(3)
ds_read_b128 a[252:255],v249 offset:53248
ds_read_b128 v[216:219],v250 offset:53248
M v[0:3],a[192:195],a[236:239],v[0:3]
s_waitcnt vmcnt(14) lgkmcnt(4)
buffer_load_short_d16_hi v243,v246,s[8:11],s29 offen offset:1152
M v[0:3],a[196:199],a[240:243],v[0:3]
s_waitcnt vmcnt(14) lgkmcnt(3)
v_fmac_f32 v237,s41,v235
v_sub_f32 v236,v236,v234
M v[0:3],a[200:203],v[220:223],v[0:3]
s_waitcnt lgkmcnt(2)
buffer_load_short_d16_hi v244,v246,s[16:19],s29 offen offset:1536
M v[4:7],a[200:203],v[228:231],v[4:7]
v_fma_f32 v234,-4.0,v233,v235
v_sub_f32 v235,v235,v233
M v[4:7],a[196:199],v[220:223],v[4:7]
buffer_load_dwordx4 a[216:219],v251,s[20:23],s48 offen offset:0 sc1
M v[4:7],a[192:195],a[240:243],v[4:7]
ds_read_b128 a[220:223],v249 offset:53760
ds_read_b128 a[232:235],v250 offset:53760
M v[8:11],a[192:195],v[220:223],v[8:11]
v_add_f32 v233,v238,v234
v_sub_f32 v238,v238,v234
M v[8:11],a[196:199],v[228:231],v[8:11]
s_waitcnt lgkmcnt(3)
v_fma_f32 v234,2.0,v235,v236
v_fmac_f32 v236,-2.0,v235
M v[8:11],a[200:203],a[252:255],v[8:11]
s_waitcnt lgkmcnt(2)
buffer_load_dwordx4 a[228:231],v251,s[20:23],s48 offen offset:1024 sc1
M v[12:15],a[200:203],v[216:219],v[12:15]
v_and_b32 v196,s42,v196
v_and_b32 v192,s42,v192
M v[12:15],a[196:199],a[252:255],v[12:15]
buffer_load_dwordx4 v[224:227],v251,s[20:23],s48 offen offset:2048 sc1
M v[12:15],a[192:195],v[228:231],v[12:15]
s_add_u32 s46,s44,92160
ds_read_b128 a[244:247],v250 offset:54272
ds_read_b128 a[248:251],v249 offset:54272
M v[16:19],a[192:195],a[252:255],v[16:19]
v_and_b32 v194,s42,v194
v_and_b32 v202,s42,v202
M v[16:19],a[196:199],v[216:219],v[16:19]
s_waitcnt lgkmcnt(3)
v_and_b32 v200,s42,v200
v_and_b32 v198,s42,v198
M v[16:19],a[200:203],a[220:223],v[16:19]
s_waitcnt lgkmcnt(2)
v_fmac_f32 v192,s43,v196
v_fmac_f32 v202,4.0,v194
M v[20:23],a[200:203],a[232:235],v[20:23]
v_fma_f32 v235,-4.0,v196,v200
v_fmac_f32 v192,s45,v200
M v[20:23],a[196:199],a[220:223],v[20:23]
buffer_load_dwordx4 a[224:227],v251,s[20:23],s46 offen offset:0 sc1
M v[20:23],a[192:195],v[216:219],v[20:23]
v_fmac_f32 v202,s41,v198
v_sub_f32 v200,v200,v196
M v[24:27],a[192:195],a[220:223],v[24:27]
v_fma_f32 v196,-4.0,v194,v198
v_sub_f32 v198,v198,v194
M v[24:27],a[196:199],a[232:235],v[24:27]
s_waitcnt lgkmcnt(1)
v_add_f32 v194,v235,v196
v_sub_f32 v235,v235,v196
M v[24:27],a[200:203],a[244:247],v[24:27]
s_waitcnt lgkmcnt(0)
v_fma_f32 v196,2.0,v198,v200
v_fmac_f32 v200,-2.0,v198
M v[28:31],a[200:203],a[248:251],v[28:31]
global_load_dword a200,v251,s[64:65]
M v[28:31],a[196:199],a[244:247],v[28:31]
buffer_load_dwordx4 a[200:203],v251,s[20:23],s46 offen offset:1024 sc1
M v[28:31],a[192:195],a[232:235],v[28:31]
s_waitcnt vmcnt(20)
v_cvt_pk_bf16_f32 v192,v232,v192
v_cvt_pk_bf16_f32 v202,v237,v202
M v[32:35],a[204:207],a[236:239],v[32:35]
s_waitcnt vmcnt(15)
v_cvt_pk_bf16_f32 v194,v233,v194
v_cvt_pk_bf16_f32 v198,v234,v196
M v[32:35],a[208:211],a[240:243],v[32:35]
s_waitcnt vmcnt(14)
v_cvt_pk_bf16_f32 v196,v238,v235
v_cvt_pk_bf16_f32 v200,v236,v200
M v[32:35],a[212:215],v[220:223],v[32:35]
buffer_load_dwordx4 a[196:199],v251,s[20:23],s46 offen offset:2048 sc1
M v[36:39],a[212:215],v[228:231],v[36:39]
s_add_u32 s47,s44,95232
v_lshlrev_b32 v234,16,v197
v_lshlrev_b32 v232,16,v193
M v[36:39],a[208:211],v[220:223],v[36:39]
v_lshlrev_b32 v233,16,v195
v_lshlrev_b32 v237,16,v203
M v[36:39],a[204:207],a[240:243],v[36:39]
v_lshlrev_b32 v236,16,v201
v_lshlrev_b32 v235,16,v199
M v[40:43],a[204:207],v[220:223],v[40:43]
buffer_load_dwordx4 a[192:195],v251,s[20:23],s47 offen offset:0 sc1
M v[40:43],a[208:211],v[228:231],v[40:43]
v_fmac_f32 v232,s43,v234
v_fmac_f32 v237,4.0,v233
M v[40:43],a[212:215],a[252:255],v[40:43]
v_fma_f32 v238,-4.0,v234,v236
v_fmac_f32 v232,s45,v236
M v[44:47],a[212:215],v[216:219],v[44:47]
v_fmac_f32 v237,s41,v235
v_sub_f32 v236,v236,v234
M v[44:47],a[208:211],a[252:255],v[44:47]
v_fma_f32 v234,-4.0,v233,v235
v_sub_f32 v235,v235,v233
M v[44:47],a[204:207],v[228:231],v[44:47]
v_add_f32 v233,v238,v234
v_sub_f32 v238,v238,v234
M v[48:51],a[204:207],a[252:255],v[48:51]
v_fma_f32 v234,2.0,v235,v236
v_fmac_f32 v236,-2.0,v235
M v[48:51],a[208:211],v[216:219],v[48:51]
v_and_b32 v197,s42,v197
v_and_b32 v193,s42,v193
M v[48:51],a[212:215],a[220:223],v[48:51]
v_and_b32 v195,s42,v195
v_and_b32 v203,s42,v203
M v[52:55],a[212:215],a[232:235],v[52:55]
v_and_b32 v201,s42,v201
v_and_b32 v199,s42,v199
M v[52:55],a[208:211],a[220:223],v[52:55]
v_fmac_f32 v193,s43,v197
v_fmac_f32 v203,4.0,v195
M v[52:55],a[204:207],v[216:219],v[52:55]
v_fma_f32 v235,-4.0,v197,v201
v_fmac_f32 v193,s45,v201
M v[56:59],a[204:207],a[220:223],v[56:59]
v_fmac_f32 v203,s41,v199
v_sub_f32 v201,v201,v197
M v[56:59],a[208:211],a[232:235],v[56:59]
v_fma_f32 v197,-4.0,v195,v199
v_sub_f32 v199,v199,v195
M v[56:59],a[212:215],a[244:247],v[56:59]
v_add_f32 v195,v235,v197
v_sub_f32 v235,v235,v197
M v[60:63],a[212:215],a[248:251],v[60:63]
buffer_load_dwordx4 a[212:215],v251,s[20:23],s47 offen offset:1024 sc1
M v[60:63],a[208:211],a[244:247],v[60:63]
v_fma_f32 v197,2.0,v199,v201
v_fmac_f32 v201,-2.0,v199
M v[60:63],a[204:207],a[232:235],v[60:63]
s_waitcnt vmcnt(8)
buffer_load_dwordx4 a[208:211],v251,s[20:23],s47 offen offset:2048 sc1
M v[64:67],a[216:219],a[236:239],v[64:67]
s_waitcnt vmcnt(8)
s_add_u32 s48,s44,98304
v_cvt_pk_bf16_f32 v193,v232,v193
v_cvt_pk_bf16_f32 v203,v237,v203
M v[64:67],a[228:231],a[240:243],v[64:67]
s_waitcnt vmcnt(7)
v_cvt_pk_bf16_f32 v195,v233,v195
v_cvt_pk_bf16_f32 v199,v234,v197
M v[64:67],v[224:227],v[220:223],v[64:67]
v_cvt_pk_bf16_f32 v197,v238,v235
v_cvt_pk_bf16_f32 v201,v236,v201
M v[68:71],v[224:227],v[228:231],v[68:71]
buffer_load_dwordx4 a[204:207],v251,s[20:23],s48 offen offset:0 sc1
M v[68:71],a[228:231],v[220:223],v[68:71]
ds_write2st64_b64 v247,v[192:193],v[202:203] offset0:206 offset1:223
M v[68:71],a[216:219],a[240:243],v[68:71]
s_add_u32 s28,s30,192
ds_write2st64_b64 v247,v[194:195],v[196:197] offset0:36 offset1:53
M v[72:75],a[216:219],v[220:223],v[72:75]
buffer_load_dwordx2 v[192:193],v254,s[12:15],s28 offen offset:0
M v[72:75],a[228:231],v[228:231],v[72:75]
ds_write2st64_b64 v247,v[198:199],v[200:201] offset0:70 offset1:87
M v[72:75],v[224:227],a[252:255],v[72:75]
v_lshlrev_b32 v234,16,v208
v_lshlrev_b32 v232,16,v204
M v[76:79],v[224:227],v[216:219],v[76:79]
buffer_load_dwordx2 v[202:203],v254,s[16:19],s28 offen offset:1536
M v[76:79],a[228:231],a[252:255],v[76:79]
v_lshlrev_b32 v233,16,v206
v_lshlrev_b32 v237,16,v214
M v[76:79],a[216:219],v[228:231],v[76:79]
v_lshlrev_b32 v236,16,v212
v_lshlrev_b32 v235,16,v210
M v[80:83],a[216:219],a[252:255],v[80:83]
v_fmac_f32 v232,s43,v234
v_fmac_f32 v237,4.0,v233
M v[80:83],a[228:231],v[216:219],v[80:83]
buffer_load_dwordx2 v[194:195],v254,s[8:11],s28 offen offset:0
M v[80:83],v[224:227],a[220:223],v[80:83]
ds_read_b128 v[220:223],v249 offset:60928
v_fma_f32 v238,-4.0,v234,v236
M v[84:87],v[224:227],a[232:235],v[84:87]
ds_read_b128 v[228:231],v250 offset:60928
v_fmac_f32 v232,s45,v236
M v[84:87],a[228:231],a[220:223],v[84:87]
ds_read_b128 a[252:255],v249 offset:61440
v_fmac_f32 v237,s41,v235
M v[84:87],a[216:219],v[216:219],v[84:87]
buffer_load_dwordx2 v[196:197],v254,s[8:11],s28 offen offset:384
M v[88:91],a[216:219],a[220:223],v[88:91]
ds_read_b128 v[216:219],v250 offset:61440
v_sub_f32 v236,v236,v234
M v[88:91],a[228:231],a[232:235],v[88:91]
v_fma_f32 v234,-4.0,v233,v235
v_sub_f32 v235,v235,v233
M v[88:91],v[224:227],a[244:247],v[88:91]
v_add_f32 v233,v238,v234
v_sub_f32 v238,v238,v234
M v[92:95],v[224:227],a[248:251],v[92:95]
buffer_load_dwordx2 v[198:199],v254,s[8:11],s28 offen offset:768
M v[92:95],a[228:231],a[244:247],v[92:95]
ds_read_b128 a[248:251],v249 offset:61952
v_fma_f32 v234,2.0,v235,v236
M v[92:95],a[216:219],a[232:235],v[92:95]
s_waitcnt vmcnt(12) lgkmcnt(4)
ds_read_b128 v[224:227],v250 offset:61952
v_fmac_f32 v236,-2.0,v235
M v[96:99],a[224:227],v[220:223],v[96:99]
s_waitcnt vmcnt(10) lgkmcnt(4)
v_and_b32 v208,s42,v208
v_and_b32 v204,s42,v204
M v[96:99],a[200:203],v[228:231],v[96:99]
s_waitcnt vmcnt(9) lgkmcnt(3)
buffer_load_dwordx2 v[200:201],v254,s[8:11],s28 offen offset:1152
M v[96:99],a[196:199],a[252:255],v[96:99]
s_waitcnt lgkmcnt(2)
v_and_b32 v206,s42,v206
v_and_b32 v214,s42,v214
M v[100:103],a[196:199],v[216:219],v[100:103]
v_and_b32 v212,s42,v212
v_and_b32 v210,s42,v210
M v[100:103],a[200:203],a[252:255],v[100:103]
ds_read_b128 a[228:231],v249 offset:62464
v_fmac_f32 v204,s43,v208
M v[100:103],a[224:227],v[228:231],v[100:103]
buffer_load_dwordx4 a[236:239],v251,s[20:23],s48 offen offset:1024 sc1
M v[104:107],a[224:227],a[252:255],v[104:107]
ds_read_b128 a[244:247],v250 offset:62464
v_fmac_f32 v214,4.0,v206
M v[104:107],a[200:203],v[216:219],v[104:107]
s_waitcnt lgkmcnt(3)
v_fma_f32 v235,-4.0,v208,v212
v_fmac_f32 v204,s45,v212
M v[104:107],a[196:199],a[248:251],v[104:107]
s_waitcnt lgkmcnt(2)
v_fmac_f32 v214,s41,v210
v_sub_f32 v212,v212,v208
M v[108:111],a[196:199],v[224:227],v[108:111]
buffer_load_dwordx4 a[240:243],v251,s[20:23],s48 offen offset:2048 sc1
M v[108:111],a[200:203],a[248:251],v[108:111]
s_add_u32 s46,s44,119808
ds_read_b128 a[216:219],v250 offset:62976
v_fma_f32 v208,-4.0,v206,v210
M v[108:111],a[224:227],v[216:219],v[108:111]
ds_read_b128 a[232:235],v249 offset:62976
v_sub_f32 v210,v210,v206
M v[112:115],a[224:227],a[248:251],v[112:115]
v_add_f32 v206,v235,v208
v_sub_f32 v235,v235,v208
M v[112:115],a[200:203],v[224:227],v[112:115]
s_waitcnt lgkmcnt(3)
buffer_load_dwordx4 a[220:223],v251,s[20:23],s46 offen offset:0 sc1
M v[112:115],a[196:199],a[228:231],v[112:115]
s_waitcnt lgkmcnt(2)
v_fma_f32 v208,2.0,v210,v212
v_fmac_f32 v212,-2.0,v210
M v[116:119],a[196:199],a[244:247],v[116:119]
v_cvt_pk_bf16_f32 v204,v232,v204
v_cvt_pk_bf16_f32 v214,v237,v214
M v[116:119],a[200:203],a[228:231],v[116:119]
v_cvt_pk_bf16_f32 v206,v233,v206
v_cvt_pk_bf16_f32 v210,v234,v208
M v[116:119],a[224:227],v[224:227],v[116:119]
v_cvt_pk_bf16_f32 v208,v238,v235
v_cvt_pk_bf16_f32 v212,v236,v212
M v[120:123],a[224:227],a[228:231],v[120:123]
v_lshlrev_b32 v234,16,v209
v_lshlrev_b32 v232,16,v205
M v[120:123],a[200:203],a[244:247],v[120:123]
s_waitcnt lgkmcnt(1)
v_lshlrev_b32 v233,16,v207
v_lshlrev_b32 v237,16,v215
M v[120:123],a[196:199],a[216:219],v[120:123]
s_waitcnt lgkmcnt(0)
v_lshlrev_b32 v236,16,v213
v_lshlrev_b32 v235,16,v211
M v[124:127],a[196:199],a[232:235],v[124:127]
buffer_load_dwordx4 a[196:199],v251,s[20:23],s46 offen offset:1024 sc1
M v[124:127],a[200:203],a[216:219],v[124:127]
v_fmac_f32 v232,s43,v234
v_fmac_f32 v237,4.0,v233
M v[124:127],a[224:227],a[244:247],v[124:127]
s_waitcnt vmcnt(13)
buffer_load_dwordx4 a[200:203],v251,s[20:23],s46 offen offset:2048 sc1
M v[128:131],a[192:195],v[220:223],v[128:131]
s_waitcnt vmcnt(13)
s_add_u32 s47,s44,122880
v_fma_f32 v238,-4.0,v234,v236
v_fmac_f32 v232,s45,v236
M v[128:131],a[212:215],v[228:231],v[128:131]
s_waitcnt vmcnt(12)
v_fmac_f32 v237,s41,v235
v_sub_f32 v236,v236,v234
M v[128:131],a[208:211],a[252:255],v[128:131]
v_fma_f32 v234,-4.0,v233,v235
v_sub_f32 v235,v235,v233
M v[132:135],a[208:211],v[216:219],v[132:135]
buffer_load_dwordx4 a[224:227],v251,s[20:23],s47 offen offset:0 sc1
M v[132:135],a[212:215],a[252:255],v[132:135]
v_add_f32 v233,v238,v234
v_sub_f32 v238,v238,v234
M v[132:135],a[192:195],v[228:231],v[132:135]
v_fma_f32 v234,2.0,v235,v236
v_fmac_f32 v236,-2.0,v235
M v[136:139],a[192:195],a[252:255],v[136:139]
v_and_b32 v209,s42,v209
v_and_b32 v205,s42,v205
M v[136:139],a[212:215],v[216:219],v[136:139]
v_and_b32 v207,s42,v207
v_and_b32 v215,s42,v215
M v[136:139],a[208:211],a[248:251],v[136:139]
v_and_b32 v213,s42,v213
v_and_b32 v211,s42,v211
M v[140:143],a[208:211],v[224:227],v[140:143]
v_fmac_f32 v205,s43,v209
v_fmac_f32 v215,4.0,v207
M v[140:143],a[212:215],a[248:251],v[140:143]
v_fma_f32 v235,-4.0,v209,v213
v_fmac_f32 v205,s45,v213
M v[140:143],a[192:195],v[216:219],v[140:143]
v_fmac_f32 v215,s41,v211
v_sub_f32 v213,v213,v209
M v[144:147],a[192:195],a[248:251],v[144:147]
v_fma_f32 v209,-4.0,v207,v211
v_sub_f32 v211,v211,v207
M v[144:147],a[212:215],v[224:227],v[144:147]
v_add_f32 v207,v235,v209
v_sub_f32 v235,v235,v209
M v[144:147],a[208:211],a[228:231],v[144:147]
v_fma_f32 v209,2.0,v211,v213
v_fmac_f32 v213,-2.0,v211
M v[148:151],a[208:211],a[244:247],v[148:151]
v_cvt_pk_bf16_f32 v205,v232,v205
v_cvt_pk_bf16_f32 v215,v237,v215
M v[148:151],a[212:215],a[228:231],v[148:151]
v_cvt_pk_bf16_f32 v207,v233,v207
v_cvt_pk_bf16_f32 v211,v234,v209
M v[148:151],a[192:195],v[224:227],v[148:151]
v_cvt_pk_bf16_f32 v209,v238,v235
v_cvt_pk_bf16_f32 v213,v236,v213
M v[152:155],a[192:195],a[228:231],v[152:155]
ds_write2st64_b64 v247,v[204:205],v[214:215] offset0:207 offset1:224
M v[152:155],a[212:215],a[244:247],v[152:155]
s_add_u32 s28,s30,393408
buffer_load_dwordx2 v[204:205],v245,s[12:15],s28 offen offset:0
M v[152:155],a[208:211],a[216:219],v[152:155]
ds_write2st64_b64 v247,v[206:207],v[208:209] offset0:37 offset1:54
M v[156:159],a[208:211],a[232:235],v[156:159]
buffer_load_dwordx4 a[208:211],v251,s[20:23],s47 offen offset:1024 sc1
M v[156:159],a[212:215],a[216:219],v[156:159]
ds_write2st64_b64 v247,v[210:211],v[212:213] offset0:71 offset1:88
M v[156:159],a[192:195],a[244:247],v[156:159]
s_waitcnt vmcnt(10)
v_lshlrev_b32 v234,16,v196
v_lshlrev_b32 v232,16,v192
M v[160:163],a[204:207],v[220:223],v[160:163]
s_waitcnt vmcnt(7)
buffer_load_dwordx4 a[212:215],v251,s[20:23],s47 offen offset:2048 sc1
M v[160:163],a[236:239],v[228:231],v[160:163]
s_waitcnt vmcnt(7)
s_add_u32 s48,s44,125952
v_lshlrev_b32 v233,16,v194
v_lshlrev_b32 v237,16,v202
M v[160:163],a[240:243],a[252:255],v[160:163]
v_lshlrev_b32 v236,16,v200
v_lshlrev_b32 v235,16,v198
M v[164:167],a[240:243],v[216:219],v[164:167]
v_fmac_f32 v232,s43,v234
v_fmac_f32 v237,4.0,v233
M v[164:167],a[236:239],a[252:255],v[164:167]
buffer_load_dwordx2 v[214:215],v245,s[16:19],s28 offen offset:1536
M v[164:167],a[204:207],v[228:231],v[164:167]
v_fma_f32 v238,-4.0,v234,v236
v_fmac_f32 v232,s45,v236
M v[168:171],a[204:207],a[252:255],v[168:171]
v_fmac_f32 v237,s41,v235
v_sub_f32 v236,v236,v234
M v[168:171],a[236:239],v[216:219],v[168:171]
v_fma_f32 v234,-4.0,v233,v235
v_sub_f32 v235,v235,v233
M v[168:171],a[240:243],a[248:251],v[168:171]
buffer_load_dwordx2 v[206:207],v245,s[8:11],s28 offen offset:0
M v[172:175],a[240:243],v[224:227],v[172:175]
v_add_f32 v233,v238,v234
v_sub_f32 v238,v238,v234
M v[172:175],a[236:239],a[248:251],v[172:175]
v_fma_f32 v234,2.0,v235,v236
v_fmac_f32 v236,-2.0,v235
M v[172:175],a[204:207],v[216:219],v[172:175]
v_and_b32 v196,s42,v196
v_and_b32 v192,s42,v192
M v[176:179],a[204:207],a[248:251],v[176:179]
buffer_load_dwordx2 v[208:209],v245,s[8:11],s28 offen offset:384
M v[176:179],a[236:239],v[224:227],v[176:179]
v_and_b32 v194,s42,v194
v_and_b32 v202,s42,v202
M v[176:179],a[240:243],a[228:231],v[176:179]
s_waitcnt lgkmcnt(0)
s_barrier
ds_read_b128 a[252:255],v249 offset:0
M v[180:183],a[240:243],a[244:247],v[180:183]
ds_read_b128 v[216:219],v250 offset:0
v_and_b32 v200,s42,v200
M v[180:183],a[236:239],a[228:231],v[180:183]
buffer_load_dwordx2 v[210:211],v245,s[8:11],s28 offen offset:768
M v[180:183],a[204:207],v[224:227],v[180:183]
ds_read_b128 a[248:251],v249 offset:512
ds_read_b128 v[224:227],v250 offset:512
M v[184:187],a[204:207],a[228:231],v[184:187]
v_and_b32 v198,s42,v198
v_fmac_f32 v192,s43,v196
M v[184:187],a[236:239],a[244:247],v[184:187]
v_fmac_f32 v202,4.0,v194
v_fma_f32 v235,-4.0,v196,v200
M v[184:187],a[240:243],a[216:219],v[184:187]
buffer_load_dwordx2 v[212:213],v245,s[8:11],s28 offen offset:1152
M v[188:191],a[240:243],a[232:235],v[188:191]
v_fmac_f32 v192,s45,v200
v_fmac_f32 v202,s41,v198
M v[188:191],a[236:239],a[216:219],v[188:191]
ds_read_b128 a[232:235],v249 offset:1024
v_sub_f32 v200,v200,v196
M v[188:191],a[204:207],a[244:247],v[188:191]
s_waitcnt vmcnt(11) lgkmcnt(4)
ds_read_b128 a[240:243],v250 offset:1024
v_fma_f32 v196,-4.0,v194,v198
M a[0:3],a[220:223],a[252:255],a[0:3]
s_waitcnt vmcnt(10) lgkmcnt(4)
buffer_load_dwordx4 a[192:195],v251,s[20:23],s48 offen offset:0 sc1
M a[0:3],a[196:199],v[216:219],a[0:3]
s_waitcnt vmcnt(10) lgkmcnt(3)
v_sub_f32 v198,v198,v194
v_add_f32 v194,v235,v196
M a[0:3],a[200:203],a[248:251],a[0:3]
s_waitcnt lgkmcnt(2)
v_sub_f32 v235,v235,v196
v_fma_f32 v196,2.0,v198,v200
M a[4:7],a[200:203],v[224:227],a[4:7]
v_fmac_f32 v200,-2.0,v198
v_cvt_pk_bf16_f32 v192,v232,v192
M a[4:7],a[196:199],a[248:251],a[4:7]
buffer_load_dwordx4 v[220:223],v251,s[20:23],s48 offen offset:1024 sc1
M a[4:7],a[220:223],v[216:219],a[4:7]
ds_read_b128 a[216:219],v249 offset:1536
ds_read_b128 a[236:239],v250 offset:1536
M a[8:11],a[220:223],a[248:251],a[8:11]
v_cvt_pk_bf16_f32 v202,v237,v202
v_cvt_pk_bf16_f32 v194,v233,v194
M a[8:11],a[196:199],v[224:227],a[8:11]
s_waitcnt lgkmcnt(3)
v_cvt_pk_bf16_f32 v198,v234,v196
v_cvt_pk_bf16_f32 v196,v238,v235
M a[8:11],a[200:203],a[232:235],a[8:11]
s_waitcnt lgkmcnt(2)
buffer_load_dwordx4 v[228:231],v251,s[20:23],s48 offen offset:2048 sc1
M a[12:15],a[200:203],a[240:243],a[12:15]
s_add_u32 s46,s44,129024
v_cvt_pk_bf16_f32 v200,v236,v200
v_lshlrev_b32 v234,16,v197
M a[12:15],a[196:199],a[232:235],a[12:15]
ds_read_b128 a[204:207],v250 offset:2048
v_lshlrev_b32 v232,16,v193
M a[12:15],a[220:223],v[224:227],a[12:15]
ds_read_b128 a[244:247],v249 offset:2048
v_lshlrev_b32 v233,16,v195
M a[16:19],a[220:223],a[232:235],a[16:19]
buffer_load_dwordx4 a[228:231],v251,s[20:23],s46 offen offset:0 sc1
M a[16:19],a[196:199],a[240:243],a[16:19]
s_waitcnt lgkmcnt(3)
v_lshlrev_b32 v237,16,v203
v_lshlrev_b32 v236,16,v201
M a[16:19],a[200:203],a[216:219],a[16:19]
s_waitcnt lgkmcnt(2)
v_lshlrev_b32 v235,16,v199
v_fmac_f32 v232,s43,v234
M a[20:23],a[200:203],a[236:239],a[20:23]
v_fmac_f32 v237,4.0,v233
v_fma_f32 v238,-4.0,v234,v236
M a[20:23],a[196:199],a[216:219],a[20:23]
v_fmac_f32 v232,s45,v236
v_fmac_f32 v237,s41,v235
M a[20:23],a[220:223],a[240:243],a[20:23]
v_sub_f32 v236,v236,v234
v_fma_f32 v234,-4.0,v233,v235
M a[24:27],a[220:223],a[216:219],a[24:27]
v_sub_f32 v235,v235,v233
v_add_f32 v233,v238,v234
M a[24:27],a[196:199],a[236:239],a[24:27]
s_waitcnt lgkmcnt(1)
v_sub_f32 v238,v238,v234
v_fma_f32 v234,2.0,v235,v236
M a[24:27],a[200:203],a[204:207],a[24:27]
s_waitcnt lgkmcnt(0)
v_fmac_f32 v236,-2.0,v235
v_and_b32 v197,s42,v197
M a[28:31],a[200:203],a[244:247],a[28:31]
buffer_load_dwordx4 a[200:203],v251,s[20:23],s46 offen offset:1024 sc1
M a[28:31],a[196:199],a[204:207],a[28:31]
v_and_b32 v193,s42,v193
v_and_b32 v195,s42,v195
M a[28:31],a[220:223],a[236:239],a[28:31]
s_waitcnt vmcnt(13)
buffer_load_dwordx4 a[196:199],v251,s[20:23],s46 offen offset:2048 sc1
M a[32:35],a[224:227],a[252:255],a[32:35]
s_waitcnt vmcnt(12)
s_add_u32 s47,s44,132096
v_and_b32 v203,s42,v203
v_and_b32 v201,s42,v201
M a[32:35],a[208:211],v[216:219],a[32:35]
s_waitcnt vmcnt(11)
v_and_b32 v199,s42,v199
v_fmac_f32 v193,s43,v197
M a[32:35],a[212:215],a[248:251],a[32:35]
v_fmac_f32 v203,4.0,v195
v_fma_f32 v235,-4.0,v197,v201
M a[36:39],a[212:215],v[224:227],a[36:39]
buffer_load_dwordx4 a[220:223],v251,s[20:23],s47 offen offset:0 sc1
M a[36:39],a[208:211],a[248:251],a[36:39]
v_fmac_f32 v193,s45,v201
v_fmac_f32 v203,s41,v199
M a[36:39],a[224:227],v[216:219],a[36:39]
v_sub_f32 v201,v201,v197
v_fma_f32 v197,-4.0,v195,v199
M a[40:43],a[224:227],a[248:251],a[40:43]
v_sub_f32 v199,v199,v195
v_add_f32 v195,v235,v197
M a[40:43],a[208:211],v[224:227],a[40:43]
v_sub_f32 v235,v235,v197
v_fma_f32 v197,2.0,v199,v201
M a[40:43],a[212:215],a[232:235],a[40:43]
v_fmac_f32 v201,-2.0,v199
v_cvt_pk_bf16_f32 v193,v232,v193
M a[44:47],a[212:215],a[240:243],a[44:47]
v_cvt_pk_bf16_f32 v203,v237,v203
v_cvt_pk_bf16_f32 v195,v233,v195
M a[44:47],a[208:211],a[232:235],a[44:47]
v_cvt_pk_bf16_f32 v199,v234,v197
v_cvt_pk_bf16_f32 v197,v238,v235
M a[44:47],a[224:227],v[224:227],a[44:47]
v_cvt_pk_bf16_f32 v201,v236,v201
M a[48:51],a[224:227],a[232:235],a[48:51]
ds_write2st64_b64 v247,v[192:193],v[202:203] offset0:238 offset1:255
M a[48:51],a[208:211],a[240:243],a[48:51]
s_add_u32 s28,s30,786624
buffer_load_dwordx2 v[192:193],v245,s[12:15],s28 offen offset:0
M a[48:51],a[212:215],a[216:219],a[48:51]
ds_write2st64_b64 v247,v[194:195],v[196:197] offset0:102 offset1:119
M a[52:55],a[212:215],a[236:239],a[52:55]
buffer_load_dwordx2 v[202:203],v245,s[16:19],s28 offen offset:1536
M a[52:55],a[208:211],a[216:219],a[52:55]
ds_write2st64_b64 v247,v[198:199],v[200:201] offset0:136 offset1:153
M a[52:55],a[224:227],a[240:243],a[52:55]
s_waitcnt vmcnt(11)
v_lshlrev_b32 v234,16,v208
v_lshlrev_b32 v232,16,v204
M a[56:59],a[224:227],a[216:219],a[56:59]
buffer_load_dwordx2 v[194:195],v245,s[8:11],s28 offen offset:0
M a[56:59],a[208:211],a[236:239],a[56:59]
v_lshlrev_b32 v233,16,v206
v_lshlrev_b32 v237,16,v214
M a[56:59],a[212:215],a[204:207],a[56:59]
s_waitcnt vmcnt(10)
v_lshlrev_b32 v236,16,v212
v_lshlrev_b32 v235,16,v210
M a[60:63],a[212:215],a[244:247],a[60:63]
v_fmac_f32 v232,s43,v234
v_fmac_f32 v237,4.0,v233
M a[60:63],a[208:211],a[204:207],a[60:63]
buffer_load_dwordx4 a[212:215],v251,s[20:23],s47 offen offset:1024 sc1
M a[60:63],a[224:227],a[236:239],a[60:63]
s_waitcnt vmcnt(10)
v_fma_f32 v238,-4.0,v234,v236
v_fmac_f32 v232,s45,v236
M a[64:67],a[192:195],a[252:255],a[64:67]
s_waitcnt vmcnt(9)
v_fmac_f32 v237,s41,v235
v_sub_f32 v236,v236,v234
M a[64:67],v[220:223],v[216:219],a[64:67]
s_waitcnt vmcnt(8)
v_fma_f32 v234,-4.0,v233,v235
v_sub_f32 v235,v235,v233
M a[64:67],v[228:231],a[248:251],a[64:67]
buffer_load_dwordx4 a[208:211],v251,s[20:23],s47 offen offset:2048 sc1
M a[68:71],v[228:231],v[224:227],a[68:71]
s_add_u32 s48,s44,135168
v_add_f32 v233,v238,v234
v_sub_f32 v238,v238,v234
M a[68:71],v[220:223],a[248:251],a[68:71]
v_fma_f32 v234,2.0,v235,v236
v_fmac_f32 v236,-2.0,v235
M a[68:71],a[192:195],v[216:219],a[68:71]
v_and_b32 v208,s42,v208
v_and_b32 v204,s42,v204
M a[72:75],a[192:195],a[248:251],a[72:75]
buffer_load_dwordx2 v[196:197],v245,s[8:11],s28 offen offset:384
M a[72:75],v[220:223],v[224:227],a[72:75]
v_and_b32 v206,s42,v206
v_and_b32 v214,s42,v214
M a[72:75],v[228:231],a[232:235],a[72:75]
v_and_b32 v212,s42,v212
v_and_b32 v210,s42,v210
M a[76:79],v[228:231],a[240:243],a[76:79]
v_fmac_f32 v204,s43,v208
v_fmac_f32 v214,4.0,v206
M a[76:79],v[220:223],a[232:235],a[76:79]
buffer_load_dwordx2 v[198:199],v245,s[8:11],s28 offen offset:768
M a[76:79],a[192:195],v[224:227],a[76:79]
v_fma_f32 v235,-4.0,v208,v212
v_fmac_f32 v204,s45,v212
M a[80:83],a[192:195],a[232:235],a[80:83]
v_fmac_f32 v214,s41,v210
v_sub_f32 v212,v212,v208
M a[80:83],v[220:223],a[240:243],a[80:83]
v_fma_f32 v208,-4.0,v206,v210
v_sub_f32 v210,v210,v206
M a[80:83],v[228:231],a[216:219],a[80:83]
buffer_load_dwordx2 v[200:201],v245,s[8:11],s28 offen offset:1152
M a[84:87],v[228:231],a[236:239],a[84:87]
ds_read_b128 a[248:251],v249 offset:8704
ds_read_b128 v[224:227],v250 offset:8704
M a[84:87],v[220:223],a[216:219],a[84:87]
ds_read_b128 a[232:235],v249 offset:9216
v_add_f32 v206,v235,v208
M a[84:87],a[192:195],a[240:243],a[84:87]
ds_read_b128 a[240:243],v250 offset:9216
v_sub_f32 v235,v235,v208
M a[88:91],a[192:195],a[216:219],a[88:91]
buffer_load_dwordx4 a[224:227],v251,s[20:23],s48 offen offset:0 sc1
M a[88:91],v[220:223],a[236:239],a[88:91]
v_fma_f32 v208,2.0,v210,v212
v_fmac_f32 v212,-2.0,v210
M a[88:91],v[228:231],a[204:207],a[88:91]
v_cvt_pk_bf16_f32 v204,v232,v204
v_cvt_pk_bf16_f32 v214,v237,v214
M a[92:95],v[228:231],a[244:247],a[92:95]
v_cvt_pk_bf16_f32 v206,v233,v206
v_cvt_pk_bf16_f32 v210,v234,v208
M a[92:95],v[220:223],a[204:207],a[92:95]
buffer_load_dwordx4 a[252:255],v251,s[20:23],s48 offen offset:1024 sc1
M a[92:95],a[192:195],a[236:239],a[92:95]
s_waitcnt vmcnt(13) lgkmcnt(3)
ds_read_b128 a[244:247],v249 offset:9728
ds_read_b128 v[228:231],v250 offset:9728
M a[96:99],a[228:231],a[248:251],a[96:99]
s_waitcnt vmcnt(12) lgkmcnt(4)
v_cvt_pk_bf16_f32 v208,v238,v235
v_cvt_pk_bf16_f32 v212,v236,v212
M a[96:99],a[200:203],v[224:227],a[96:99]
s_waitcnt vmcnt(11) lgkmcnt(3)
v_lshlrev_b32 v234,16,v209
v_lshlrev_b32 v232,16,v205
M a[96:99],a[196:199],a[232:235],a[96:99]
s_waitcnt lgkmcnt(2)
buffer_load_dwordx4 v[216:219],v251,s[20:23],s48 offen offset:2048 sc1
M a[100:103],a[196:199],a[240:243],a[100:103]
s_add_u32 s46,s44,138240
v_lshlrev_b32 v233,16,v207
v_lshlrev_b32 v237,16,v215
M a[100:103],a[200:203],a[232:235],a[100:103]
ds_read_b128 a[204:207],v249 offset:10240
v_lshlrev_b32 v236,16,v213
M a[100:103],a[228:231],v[224:227],a[100:103]
ds_read_b128 v[220:223],v250 offset:10240
v_lshlrev_b32 v235,16,v211
M a[104:107],a[228:231],a[232:235],a[104:107]
buffer_load_dwordx4 a[216:219],v251,s[20:23],s46 offen offset:0 sc1
M a[104:107],a[200:203],a[240:243],a[104:107]
s_waitcnt lgkmcnt(3)
v_fmac_f32 v232,s43,v234
v_fmac_f32 v237,4.0,v233
M a[104:107],a[196:199],a[244:247],a[104:107]
s_waitcnt lgkmcnt(2)
v_fma_f32 v238,-4.0,v234,v236
v_fmac_f32 v232,s45,v236
M a[108:111],a[196:199],v[228:231],a[108:111]
v_fmac_f32 v237,s41,v235
v_sub_f32 v236,v236,v234
M a[108:111],a[200:203],a[244:247],a[108:111]
ds_read_b128 a[192:195],v250 offset:10752
v_fma_f32 v234,-4.0,v233,v235
M a[108:111],a[228:231],a[240:243],a[108:111]
ds_read_b128 a[236:239],v249 offset:10752
v_sub_f32 v235,v235,v233
M a[112:115],a[228:231],a[244:247],a[112:115]
v_add_f32 v233,v238,v234
v_sub_f32 v238,v238,v234
M a[112:115],a[200:203],v[228:231],a[112:115]
s_waitcnt lgkmcnt(3)
v_fma_f32 v234,2.0,v235,v236
v_fmac_f32 v236,-2.0,v235
M a[112:115],a[196:199],a[204:207],a[112:115]
s_waitcnt lgkmcnt(2)
v_and_b32 v209,s42,v209
v_and_b32 v205,s42,v205
M a[116:119],a[196:199],v[220:223],a[116:119]
v_and_b32 v207,s42,v207
v_and_b32 v215,s42,v215
M a[116:119],a[200:203],a[204:207],a[116:119]
v_and_b32 v213,s42,v213
v_and_b32 v211,s42,v211
M a[116:119],a[228:231],v[228:231],a[116:119]
v_fmac_f32 v205,s43,v209
v_fmac_f32 v215,4.0,v207
M a[120:123],a[228:231],a[204:207],a[120:123]
v_fma_f32 v235,-4.0,v209,v213
v_fmac_f32 v205,s45,v213
M a[120:123],a[200:203],v[220:223],a[120:123]
s_waitcnt lgkmcnt(1)
v_fmac_f32 v215,s41,v211
v_sub_f32 v213,v213,v209
M a[120:123],a[196:199],a[192:195],a[120:123]
s_waitcnt lgkmcnt(0)
v_fma_f32 v209,-4.0,v207,v211
v_sub_f32 v211,v211,v207
M a[124:127],a[196:199],a[236:239],a[124:127]
buffer_load_dwordx4 a[196:199],v251,s[20:23],s46 offen offset:1024 sc1
M a[124:127],a[200:203],a[192:195],a[124:127]
v_add_f32 v207,v235,v209
v_sub_f32 v235,v235,v209
M a[124:127],a[228:231],v[220:223],a[124:127]
s_waitcnt vmcnt(13)
buffer_load_dwordx4 a[200:203],v251,s[20:23],s46 offen offset:2048 sc1
M a[128:131],a[220:223],a[248:251],a[128:131]
s_waitcnt vmcnt(10)
s_add_u32 s47,s44,141312
v_fma_f32 v209,2.0,v211,v213
v_fmac_f32 v213,-2.0,v211
M a[128:131],a[212:215],v[224:227],a[128:131]
s_waitcnt vmcnt(9)
v_cvt_pk_bf16_f32 v205,v232,v205
v_cvt_pk_bf16_f32 v215,v237,v215
M a[128:131],a[208:211],a[232:235],a[128:131]
v_cvt_pk_bf16_f32 v207,v233,v207
v_cvt_pk_bf16_f32 v211,v234,v209
M a[132:135],a[208:211],a[240:243],a[132:135]
buffer_load_dwordx4 a[228:231],v251,s[20:23],s47 offen offset:0 sc1
M a[132:135],a[212:215],a[232:235],a[132:135]
v_cvt_pk_bf16_f32 v209,v238,v235
v_cvt_pk_bf16_f32 v213,v236,v213
M a[132:135],a[220:223],v[224:227],a[132:135]
v_add_u32 v232,121856,v247
M a[136:139],a[220:223],a[232:235],a[136:139]
ds_write2st64_b64 v232,v[204:205],v[214:215] offset0:1 offset1:18
M a[136:139],a[212:215],a[240:243],a[136:139]
s_add_u32 s28,s30,1179840
buffer_load_dwordx2 v[204:205],v245,s[12:15],s28 offen offset:0
M a[136:139],a[208:211],a[244:247],a[136:139]
ds_write2st64_b64 v247,v[206:207],v[208:209] offset0:103 offset1:120
M a[140:143],a[208:211],v[228:231],a[140:143]
ds_write2st64_b64 v247,v[210:211],v[212:213] offset0:137 offset1:154
M a[140:143],a[212:215],a[244:247],a[140:143]
buffer_load_dwordx2 v[214:215],v245,s[16:19],s28 offen offset:1536
M a[140:143],a[220:223],a[240:243],a[140:143]
v_fmac_f32 v239,s43,v241
v_fmac_f32 v244,4.0,v240
M a[144:147],a[220:223],a[244:247],a[144:147]
v_fma_f32 v232,-4.0,v241,v243
v_fmac_f32 v239,s45,v243
M a[144:147],a[212:215],v[228:231],a[144:147]
buffer_load_dwordx2 v[206:207],v245,s[8:11],s28 offen offset:0
M a[144:147],a[208:211],a[204:207],a[144:147]
v_fmac_f32 v244,s41,v242
v_sub_f32 v243,v243,v241
M a[148:151],a[208:211],v[220:223],a[148:151]
v_fma_f32 v241,-4.0,v240,v242
v_sub_f32 v242,v242,v240
M a[148:151],a[212:215],a[204:207],a[148:151]
v_add_f32 v240,v232,v241
v_sub_f32 v232,v232,v241
M a[148:151],a[220:223],v[228:231],a[148:151]
buffer_load_dwordx2 v[208:209],v245,s[8:11],s28 offen offset:384
M a[152:155],a[220:223],a[204:207],a[152:155]
v_fma_f32 v241,2.0,v242,v243
v_fmac_f32 v243,-2.0,v242
M a[152:155],a[212:215],v[220:223],a[152:155]
v_cvt_pk_bf16_f32 v233,v239,v244
v_cvt_pk_bf16_f32 v234,v240,v232
M a[152:155],a[208:211],a[192:195],a[152:155]
v_cvt_pk_bf16_f32 v235,v241,v243
v_add_u32 v232,121856,v248
M a[156:159],a[208:211],a[236:239],a[156:159]
buffer_load_dwordx4 a[208:211],v251,s[20:23],s47 offen offset:1024 sc1
M a[156:159],a[212:215],a[192:195],a[156:159]
ds_write_b16 v232,v233 offset:0
M a[156:159],a[220:223],v[220:223],a[156:159]
s_waitcnt vmcnt(11)
ds_write_b16_d16_hi v232,v233 offset:8704
M a[160:163],a[224:227],a[248:251],a[160:163]
s_waitcnt vmcnt(10)
ds_write_b16 v248,v234 offset:52224
M a[160:163],a[252:255],v[224:227],a[160:163]
s_waitcnt vmcnt(9)
buffer_load_dwordx4 a[212:215],v251,s[20:23],s47 offen offset:2048 sc1
M a[160:163],v[216:219],a[232:235],a[160:163]
s_add_u32 s48,s44,144384
ds_write_b16_d16_hi v248,v234 offset:60928
M a[164:167],v[216:219],a[240:243],a[164:167]
v_add_u32 v232,69632,v248
M a[164:167],a[252:255],a[232:235],a[164:167]
ds_write_b16 v232,v235 offset:0
M a[164:167],a[224:227],v[224:227],a[164:167]
buffer_load_dwordx2 v[210:211],v245,s[8:11],s28 offen offset:768
M a[168:171],a[224:227],a[232:235],a[168:171]
ds_write_b16_d16_hi v232,v235 offset:8704
M a[168:171],a[252:255],a[240:243],a[168:171]
v_lshlrev_b32 v234,16,v196
v_lshlrev_b32 v232,16,v192
M a[168:171],v[216:219],a[244:247],a[168:171]
v_lshlrev_b32 v233,16,v194
v_lshlrev_b32 v237,16,v202
M a[172:175],v[216:219],v[228:231],a[172:175]
buffer_load_dwordx2 v[212:213],v245,s[8:11],s28 offen offset:1152
M a[172:175],a[252:255],a[244:247],a[172:175]
s_add_u32 s29,s30,256
v_lshlrev_b32 v236,16,v200
v_lshlrev_b32 v235,16,v198
M a[172:175],a[224:227],a[240:243],a[172:175]
v_fmac_f32 v232,s43,v234
v_fmac_f32 v237,4.0,v233
M a[176:179],a[224:227],a[244:247],a[176:179]
v_fma_f32 v238,-4.0,v234,v236
v_fmac_f32 v232,s45,v236
M a[176:179],a[252:255],v[228:231],a[176:179]
buffer_load_short_d16_hi v239,v246,s[12:15],s29 offen offset:0
M a[176:179],v[216:219],a[204:207],a[176:179]
ds_read_b128 a[232:235],v249 offset:17408
v_fmac_f32 v237,s41,v235
M a[180:183],v[216:219],v[220:223],a[180:183]
buffer_load_short_d16_hi v240,v246,s[8:11],s29 offen offset:0
M a[180:183],a[252:255],a[204:207],a[180:183]
ds_read_b128 a[240:243],v250 offset:17408
ds_read_b128 a[244:247],v249 offset:17920
M a[180:183],a[224:227],v[228:231],a[180:183]
buffer_load_short_d16_hi v241,v246,s[8:11],s29 offen offset:384
M a[184:187],a[224:227],a[204:207],a[184:187]
ds_read_b128 v[228:231],v250 offset:17920
v_sub_f32 v236,v236,v234
M a[184:187],a[252:255],v[220:223],a[184:187]
buffer_load_short_d16_hi v242,v246,s[8:11],s29 offen offset:768
M a[184:187],v[216:219],a[192:195],a[184:187]
v_fma_f32 v234,-4.0,v233,v235
v_sub_f32 v235,v235,v233
M a[188:191],v[216:219],a[236:239],a[188:191]
buffer_load_short_d16_hi v243,v246,s[8:11],s29 offen offset:1152
M a[188:191],a[252:255],a[192:195],a[188:191]
ds_read_b128 a[236:239],v249 offset:18432
v_add_f32 v233,v238,v234
M a[188:191],a[224:227],v[220:223],a[188:191]
s_waitcnt vmcnt(16) lgkmcnt(4)
buffer_load_short_d16_hi v244,v246,s[16:19],s29 offen offset:1536
M v[0:3],a[216:219],a[232:235],v[0:3]
s_waitcnt vmcnt(16) lgkmcnt(3)
ds_read_b128 v[216:219],v250 offset:18432
v_sub_f32 v238,v238,v234
M v[0:3],a[196:199],a[240:243],v[0:3]
s_waitcnt vmcnt(15) lgkmcnt(3)
buffer_load_dwordx4 a[220:223],v251,s[20:23],s48 offen offset:0 sc1
M v[0:3],a[200:203],a[244:247],v[0:3]
s_waitcnt lgkmcnt(2)
v_fma_f32 v234,2.0,v235,v236
v_fmac_f32 v236,-2.0,v235
M v[4:7],a[200:203],v[228:231],v[4:7]
v_and_b32 v196,s42,v196
v_and_b32 v192,s42,v192
M v[4:7],a[196:199],a[244:247],v[4:7]
ds_read_b128 a[192:195],v249 offset:18944
v_and_b32 v194,s42,v194
M v[4:7],a[216:219],a[240:243],v[4:7]
buffer_load_dwordx4 a[248:251],v251,s[20:23],s48 offen offset:1024 sc1
M v[8:11],a[216:219],a[244:247],v[8:11]
ds_read_b128 a[252:255],v250 offset:18944
v_and_b32 v202,s42,v202
M v[8:11],a[196:199],v[228:231],v[8:11]
s_waitcnt lgkmcnt(3)
v_and_b32 v200,s42,v200
v_and_b32 v198,s42,v198
M v[8:11],a[200:203],a[236:239],v[8:11]
s_waitcnt lgkmcnt(2)
v_fmac_f32 v192,s43,v196
v_fmac_f32 v202,4.0,v194
M v[12:15],a[200:203],v[216:219],v[12:15]
buffer_load_dwordx4 v[224:227],v251,s[20:23],s48 offen offset:2048 sc1
M v[12:15],a[196:199],a[236:239],v[12:15]
s_add_u32 s46,s44,147456
ds_read_b128 a[224:227],v250 offset:19456
v_fma_f32 v235,-4.0,v196,v200
M v[12:15],a[216:219],v[228:231],v[12:15]
ds_read_b128 v[220:223],v249 offset:19456
v_fmac_f32 v192,s45,v200
M v[16:19],a[216:219],a[236:239],v[16:19]
v_fmac_f32 v202,s41,v198
v_sub_f32 v200,v200,v196
M v[16:19],a[196:199],v[216:219],v[16:19]
s_waitcnt lgkmcnt(3)
buffer_load_dwordx4 a[204:207],v251,s[20:23],s46 offen offset:0 sc1
M v[16:19],a[200:203],a[192:195],v[16:19]
s_waitcnt lgkmcnt(2)
v_fma_f32 v196,-4.0,v194,v198
v_sub_f32 v198,v198,v194
M v[20:23],a[200:203],a[252:255],v[20:23]
v_add_f32 v194,v235,v196
v_sub_f32 v235,v235,v196
M v[20:23],a[196:199],a[192:195],v[20:23]
v_fma_f32 v196,2.0,v198,v200
v_fmac_f32 v200,-2.0,v198
M v[20:23],a[216:219],v[216:219],v[20:23]
v_cvt_pk_bf16_f32 v192,v232,v192
v_cvt_pk_bf16_f32 v202,v237,v202
M v[24:27],a[216:219],a[192:195],v[24:27]
v_cvt_pk_bf16_f32 v194,v233,v194
v_cvt_pk_bf16_f32 v198,v234,v196
M v[24:27],a[196:199],a[252:255],v[24:27]
s_waitcnt lgkmcnt(1)
v_cvt_pk_bf16_f32 v196,v238,v235
v_cvt_pk_bf16_f32 v200,v236,v200
M v[24:27],a[200:203],a[224:227],v[24:27]
s_waitcnt lgkmcnt(0)
v_lshlrev_b32 v234,16,v197
v_lshlrev_b32 v232,16,v193
M v[28:31],a[200:203],v[220:223],v[28:31]
global_load_dword a200,v251,s[64:65]
M v[28:31],a[196:199],a[224:227],v[28:31]
buffer_load_dwordx4 a[200:203],v251,s[20:23],s46 offen offset:1024 sc1
M v[28:31],a[216:219],a[252:255],v[28:31]
s_waitcnt vmcnt(20)
v_lshlrev_b32 v233,16,v195
v_lshlrev_b32 v237,16,v203
M v[32:35],a[228:231],a[232:235],v[32:35]
s_waitcnt vmcnt(15)
v_lshlrev_b32 v236,16,v201
v_lshlrev_b32 v235,16,v199
M v[32:35],a[208:211],a[240:243],v[32:35]
s_waitcnt vmcnt(14)
buffer_load_dwordx4 a[196:199],v251,s[20:23],s46 offen offset:2048 sc1
M v[32:35],a[212:215],a[244:247],v[32:35]
s_add_u32 s47,s44,150528
v_fmac_f32 v232,s43,v234
v_fmac_f32 v237,4.0,v233
M v[36:39],a[212:215],v[228:231],v[36:39]
v_fma_f32 v238,-4.0,v234,v236
v_fmac_f32 v232,s45,v236
M v[36:39],a[208:211],a[244:247],v[36:39]
v_fmac_f32 v237,s41,v235
v_sub_f32 v236,v236,v234
M v[36:39],a[228:231],a[240:243],v[36:39]
buffer_load_dwordx4 a[216:219],v251,s[20:23],s47 offen offset:0 sc1
M v[40:43],a[228:231],a[244:247],v[40:43]
v_fma_f32 v234,-4.0,v233,v235
v_sub_f32 v235,v235,v233
M v[40:43],a[208:211],v[228:231],v[40:43]
v_add_f32 v233,v238,v234
v_sub_f32 v238,v238,v234
M v[40:43],a[212:215],a[236:239],v[40:43]
v_fma_f32 v234,2.0,v235,v236
v_fmac_f32 v236,-2.0,v235
M v[44:47],a[212:215],v[216:219],v[44:47]
v_and_b32 v197,s42,v197
v_and_b32 v193,s42,v193
M v[44:47],a[208:211],a[236:239],v[44:47]
v_and_b32 v195,s42,v195
v_and_b32 v203,s42,v203
M v[44:47],a[228:231],v[228:231],v[44:47]
v_and_b32 v201,s42,v201
v_and_b32 v199,s42,v199
M v[48:51],a[228:231],a[236:239],v[48:51]
v_fmac_f32 v193,s43,v197
v_fmac_f32 v203,4.0,v195
M v[48:51],a[208:211],v[216:219],v[48:51]
v_fma_f32 v235,-4.0,v197,v201
v_fmac_f32 v193,s45,v201
M v[48:51],a[212:215],a[192:195],v[48:51]
v_fmac_f32 v203,s41,v199
v_sub_f32 v201,v201,v197
M v[52:55],a[212:215],a[252:255],v[52:55]
v_fma_f32 v197,-4.0,v195,v199
v_sub_f32 v199,v199,v195
M v[52:55],a[208:211],a[192:195],v[52:55]
v_add_f32 v195,v235,v197
v_sub_f32 v235,v235,v197
M v[52:55],a[228:231],v[216:219],v[52:55]
v_fma_f32 v197,2.0,v199,v201
v_fmac_f32 v201,-2.0,v199
M v[56:59],a[228:231],a[192:195],v[56:59]
v_cvt_pk_bf16_f32 v193,v232,v193
v_cvt_pk_bf16_f32 v203,v237,v203
M v[56:59],a[208:211],a[252:255],v[56:59]
v_cvt_pk_bf16_f32 v195,v233,v195
v_cvt_pk_bf16_f32 v199,v234,v197
M v[56:59],a[212:215],a[224:227],v[56:59]
v_cvt_pk_bf16_f32 v197,v238,v235
v_cvt_pk_bf16_f32 v201,v236,v201
M v[60:63],a[212:215],v[220:223],v[60:63]
buffer_load_dwordx4 a[212:215],v251,s[20:23],s47 offen offset:1024 sc1
M v[60:63],a[208:211],a[224:227],v[60:63]
v_add_u32 v232,121856,v247
M v[60:63],a[228:231],a[252:255],v[60:63]
s_waitcnt vmcnt(8)
buffer_load_dwordx4 a[208:211],v251,s[20:23],s47 offen offset:2048 sc1
M v[64:67],a[220:223],a[232:235],v[64:67]
s_waitcnt vmcnt(8)
s_add_u32 s48,s44,153600
ds_write2st64_b64 v232,v[192:193],v[202:203] offset0:2 offset1:19
M v[64:67],a[248:251],a[240:243],v[64:67]
s_waitcnt vmcnt(7)
s_add_u32 s28,s30,256
ds_write2st64_b64 v247,v[194:195],v[196:197] offset0:104 offset1:121
M v[64:67],v[224:227],a[244:247],v[64:67]
buffer_load_dwordx2 v[192:193],v254,s[12:15],s28 offen offset:0
M v[68:71],v[224:227],v[228:231],v[68:71]
ds_write2st64_b64 v247,v[198:199],v[200:201] offset0:138 offset1:155
M v[68:71],a[248:251],a[244:247],v[68:71]
v_lshlrev_b32 v234,16,v208
v_lshlrev_b32 v232,16,v204
M v[68:71],a[220:223],a[240:243],v[68:71]
buffer_load_dwordx2 v[202:203],v254,s[16:19],s28 offen offset:1536
M v[72:75],a[220:223],a[244:247],v[72:75]
v_lshlrev_b32 v233,16,v206
v_lshlrev_b32 v237,16,v214
M v[72:75],a[248:251],v[228:231],v[72:75]
v_lshlrev_b32 v236,16,v212
v_lshlrev_b32 v235,16,v210
M v[72:75],v[224:227],a[236:239],v[72:75]
v_fmac_f32 v232,s43,v234
v_fmac_f32 v237,4.0,v233
M v[76:79],v[224:227],v[216:219],v[76:79]
buffer_load_dwordx2 v[194:195],v254,s[8:11],s28 offen offset:0
M v[76:79],a[248:251],a[236:239],v[76:79]
v_fma_f32 v238,-4.0,v234,v236
v_fmac_f32 v232,s45,v236
M v[76:79],a[220:223],v[228:231],v[76:79]
v_fmac_f32 v237,s41,v235
v_sub_f32 v236,v236,v234
M v[80:83],a[220:223],a[236:239],v[80:83]
v_fma_f32 v234,-4.0,v233,v235
v_sub_f32 v235,v235,v233
M v[80:83],a[248:251],v[216:219],v[80:83]
buffer_load_dwordx2 v[196:197],v254,s[8:11],s28 offen offset:384
M v[80:83],v[224:227],a[192:195],v[80:83]
ds_read_b128 a[244:247],v249 offset:26112
v_add_f32 v233,v238,v234
M v[84:87],v[224:227],a[252:255],v[84:87]
ds_read_b128 v[228:231],v250 offset:26112
v_sub_f32 v238,v238,v234
M v[84:87],a[248:251],a[192:195],v[84:87]
ds_read_b128 a[236:239],v249 offset:26624
v_fma_f32 v234,2.0,v235,v236
M v[84:87],a[220:223],v[216:219],v[84:87]
buffer_load_dwordx2 v[198:199],v254,s[8:11],s28 offen offset:768
M v[88:91],a[220:223],a[192:195],v[88:91]
ds_read_b128 v[216:219],v250 offset:26624
v_fmac_f32 v236,-2.0,v235
M v[88:91],a[248:251],a[252:255],v[88:91]
v_and_b32 v208,s42,v208
v_and_b32 v204,s42,v204
M v[88:91],v[224:227],a[224:227],v[88:91]
v_and_b32 v206,s42,v206
v_and_b32 v214,s42,v214
M v[92:95],v[224:227],v[220:223],v[92:95]
buffer_load_dwordx2 v[200:201],v254,s[8:11],s28 offen offset:1152
M v[92:95],a[248:251],a[224:227],v[92:95]
ds_read_b128 v[220:223],v249 offset:27136
v_and_b32 v212,s42,v212
M v[92:95],a[220:223],a[252:255],v[92:95]
s_waitcnt vmcnt(12) lgkmcnt(4)
ds_read_b128 v[224:227],v250 offset:27136
v_and_b32 v210,s42,v210
M v[96:99],a[204:207],a[244:247],v[96:99]
s_waitcnt vmcnt(10) lgkmcnt(4)
v_fmac_f32 v204,s43,v208
v_fmac_f32 v214,4.0,v206
M v[96:99],a[200:203],v[228:231],v[96:99]
s_waitcnt vmcnt(9) lgkmcnt(3)
buffer_load_dwordx4 a[228:231],v251,s[20:23],s48 offen offset:0 sc1
M v[96:99],a[196:199],a[236:239],v[96:99]
s_waitcnt lgkmcnt(2)
v_fma_f32 v235,-4.0,v208,v212
v_fmac_f32 v204,s45,v212
M v[100:103],a[196:199],v[216:219],v[100:103]
v_fmac_f32 v214,s41,v210
v_sub_f32 v212,v212,v208
M v[100:103],a[200:203],a[236:239],v[100:103]
ds_read_b128 a[224:227],v249 offset:27648
v_fma_f32 v208,-4.0,v206,v210
M v[100:103],a[204:207],v[228:231],v[100:103]
buffer_load_dwordx4 a[232:235],v251,s[20:23],s48 offen offset:1024 sc1
M v[104:107],a[204:207],a[236:239],v[104:107]
ds_read_b128 a[248:251],v250 offset:27648
v_sub_f32 v210,v210,v206
M v[104:107],a[200:203],v[216:219],v[104:107]
s_waitcnt lgkmcnt(3)
v_add_f32 v206,v235,v208
v_sub_f32 v235,v235,v208
M v[104:107],a[196:199],v[220:223],v[104:107]
s_waitcnt lgkmcnt(2)
v_fma_f32 v208,2.0,v210,v212
v_fmac_f32 v212,-2.0,v210
M v[108:111],a[196:199],v[224:227],v[108:111]
buffer_load_dwordx4 a[240:243],v251,s[20:23],s48 offen offset:2048 sc1
M v[108:111],a[200:203],v[220:223],v[108:111]
s_add_u32 s46,s44,175104
ds_read_b128 a[220:223],v250 offset:28160
v_cvt_pk_bf16_f32 v204,v232,v204
M v[108:111],a[204:207],v[216:219],v[108:111]
ds_read_b128 a[252:255],v249 offset:28160
v_cvt_pk_bf16_f32 v214,v237,v214
M v[112:115],a[204:207],v[220:223],v[112:115]
v_cvt_pk_bf16_f32 v206,v233,v206
v_cvt_pk_bf16_f32 v210,v234,v208
M v[112:115],a[200:203],v[224:227],v[112:115]
s_waitcnt lgkmcnt(3)
buffer_load_dwordx4 a[192:195],v251,s[20:23],s46 offen offset:0 sc1
M v[112:115],a[196:199],a[224:227],v[112:115]
s_waitcnt lgkmcnt(2)
v_cvt_pk_bf16_f32 v208,v238,v235
v_cvt_pk_bf16_f32 v212,v236,v212
M v[116:119],a[196:199],a[248:251],v[116:119]
v_lshlrev_b32 v234,16,v209
v_lshlrev_b32 v232,16,v205
M v[116:119],a[200:203],a[224:227],v[116:119]
v_lshlrev_b32 v233,16,v207
v_lshlrev_b32 v237,16,v215
M v[116:119],a[204:207],v[224:227],v[116:119]
v_lshlrev_b32 v236,16,v213
v_lshlrev_b32 v235,16,v211
M v[120:123],a[204:207],a[224:227],v[120:123]
v_fmac_f32 v232,s43,v234
v_fmac_f32 v237,4.0,v233
M v[120:123],a[200:203],a[248:251],v[120:123]
s_waitcnt lgkmcnt(1)
v_fma_f32 v238,-4.0,v234,v236
v_fmac_f32 v232,s45,v236
M v[120:123],a[196:199],a[220:223],v[120:123]
s_waitcnt lgkmcnt(0)
v_fmac_f32 v237,s41,v235
v_sub_f32 v236,v236,v234
M v[124:127],a[196:199],a[252:255],v[124:127]
buffer_load_dwordx4 a[196:199],v251,s[20:23],s46 offen offset:1024 sc1
M v[124:127],a[200:203],a[220:223],v[124:127]
v_fma_f32 v234,-4.0,v233,v235
v_sub_f32 v235,v235,v233
M v[124:127],a[204:207],a[248:251],v[124:127]
s_waitcnt vmcnt(13)
buffer_load_dwordx4 a[200:203],v251,s[20:23],s46 offen offset:2048 sc1
M v[128:131],a[216:219],a[244:247],v[128:131]
s_waitcnt vmcnt(13)
s_add_u32 s47,s44,178176
v_add_f32 v233,v238,v234
v_sub_f32 v238,v238,v234
M v[128:131],a[212:215],v[228:231],v[128:131]
s_waitcnt vmcnt(12)
v_fma_f32 v234,2.0,v235,v236
v_fmac_f32 v236,-2.0,v235
M v[128:131],a[208:211],a[236:239],v[128:131]
v_and_b32 v209,s42,v209
v_and_b32 v205,s42,v205
M v[132:135],a[208:211],v[216:219],v[132:135]
buffer_load_dwordx4 a[204:207],v251,s[20:23],s47 offen offset:0 sc1
M v[132:135],a[212:215],a[236:239],v[132:135]
v_and_b32 v207,s42,v207
v_and_b32 v215,s42,v215
M v[132:135],a[216:219],v[228:231],v[132:135]
v_and_b32 v213,s42,v213
v_and_b32 v211,s42,v211
M v[136:139],a[216:219],a[236:239],v[136:139]
v_fmac_f32 v205,s43,v209
v_fmac_f32 v215,4.0,v207
M v[136:139],a[212:215],v[216:219],v[136:139]
v_fma_f32 v235,-4.0,v209,v213
v_fmac_f32 v205,s45,v213
M v[136:139],a[208:211],v[220:223],v[136:139]
v_fmac_f32 v215,s41,v211
v_sub_f32 v213,v213,v209
M v[140:143],a[208:211],v[224:227],v[140:143]
v_fma_f32 v209,-4.0,v207,v211
v_sub_f32 v211,v211,v207
M v[140:143],a[212:215],v[220:223],v[140:143]
v_add_f32 v207,v235,v209
v_sub_f32 v235,v235,v209
M v[140:143],a[216:219],v[216:219],v[140:143]
v_fma_f32 v209,2.0,v211,v213
v_fmac_f32 v213,-2.0,v211
M v[144:147],a[216:219],v[220:223],v[144:147]
v_cvt_pk_bf16_f32 v205,v232,v205
v_cvt_pk_bf16_f32 v215,v237,v215
M v[144:147],a[212:215],v[224:227],v[144:147]
v_cvt_pk_bf16_f32 v207,v233,v207
v_cvt_pk_bf16_f32 v211,v234,v209
M v[144:147],a[208:211],a[224:227],v[144:147]
v_cvt_pk_bf16_f32 v209,v238,v235
v_cvt_pk_bf16_f32 v213,v236,v213
M v[148:151],a[208:211],a[248:251],v[148:151]
v_add_u32 v232,121856,v247
M v[148:151],a[212:215],a[224:227],v[148:151]
ds_write2st64_b64 v232,v[204:205],v[214:215] offset0:3 offset1:20
M v[148:151],a[216:219],v[224:227],v[148:151]
s_add_u32 s28,s30,393472
buffer_load_dwordx2 v[204:205],v245,s[12:15],s28 offen offset:0
M v[152:155],a[216:219],a[224:227],v[152:155]
ds_write2st64_b64 v247,v[206:207],v[208:209] offset0:105 offset1:122
M v[152:155],a[212:215],a[248:251],v[152:155]
buffer_load_dwordx2 v[214:215],v245,s[16:19],s28 offen offset:1536
M v[152:155],a[208:211],a[220:223],v[152:155]
ds_write2st64_b64 v247,v[210:211],v[212:213] offset0:139 offset1:156
M v[156:159],a[208:211],a[252:255],v[156:159]
s_waitcnt vmcnt(11)
v_lshlrev_b32 v234,16,v196
v_lshlrev_b32 v232,16,v192
M v[156:159],a[212:215],a[220:223],v[156:159]
buffer_load_dwordx4 a[208:211],v251,s[20:23],s47 offen offset:1024 sc1
M v[156:159],a[216:219],a[248:251],v[156:159]
s_waitcnt vmcnt(9)
v_lshlrev_b32 v233,16,v194
v_lshlrev_b32 v237,16,v202
M v[160:163],a[228:231],a[244:247],v[160:163]
s_waitcnt vmcnt(8)
v_lshlrev_b32 v236,16,v200
v_lshlrev_b32 v235,16,v198
M v[160:163],a[232:235],v[228:231],v[160:163]
s_waitcnt vmcnt(7)
v_fmac_f32 v232,s43,v234
v_fmac_f32 v237,4.0,v233
M v[160:163],a[240:243],a[236:239],v[160:163]
buffer_load_dwordx4 a[212:215],v251,s[20:23],s47 offen offset:2048 sc1
M v[164:167],a[240:243],v[216:219],v[164:167]
s_add_u32 s48,s44,181248
v_fma_f32 v238,-4.0,v234,v236
v_fmac_f32 v232,s45,v236
M v[164:167],a[232:235],a[236:239],v[164:167]
v_fmac_f32 v237,s41,v235
v_sub_f32 v236,v236,v234
M v[164:167],a[228:231],v[228:231],v[164:167]
v_fma_f32 v234,-4.0,v233,v235
v_sub_f32 v235,v235,v233
M v[168:171],a[228:231],a[236:239],v[168:171]
buffer_load_dwordx2 v[206:207],v245,s[8:11],s28 offen offset:0
M v[168:171],a[232:235],v[216:219],v[168:171]
v_add_f32 v233,v238,v234
v_sub_f32 v238,v238,v234
M v[168:171],a[240:243],v[220:223],v[168:171]
v_fma_f32 v234,2.0,v235,v236
v_fmac_f32 v236,-2.0,v235
M v[172:175],a[240:243],v[224:227],v[172:175]
v_and_b32 v196,s42,v196
v_and_b32 v192,s42,v192
M v[172:175],a[232:235],v[220:223],v[172:175]
buffer_load_dwordx2 v[208:209],v245,s[8:11],s28 offen offset:384
M v[172:175],a[228:231],v[216:219],v[172:175]
v_and_b32 v194,s42,v194
v_and_b32 v202,s42,v202
M v[176:179],a[228:231],v[220:223],v[176:179]
v_and_b32 v200,s42,v200
v_and_b32 v198,s42,v198
M v[176:179],a[232:235],v[224:227],v[176:179]
v_fmac_f32 v192,s43,v196
v_fmac_f32 v202,4.0,v194
M v[176:179],a[240:243],a[224:227],v[176:179]
s_waitcnt lgkmcnt(0)
s_barrier
ds_read_b128 a[236:239],v249 offset:34816
M v[180:183],a[240:243],a[248:251],v[180:183]
buffer_load_dwordx2 v[210:211],v245,s[8:11],s28 offen offset:768
M v[180:183],a[232:235],a[224:227],v[180:183]
ds_read_b128 v[216:219],v250 offset:34816
ds_read_b128 v[220:223],v249 offset:35328
M v[180:183],a[228:231],v[224:227],v[180:183]
ds_read_b128 v[224:227],v250 offset:35328
v_fma_f32 v235,-4.0,v196,v200
M v[184:187],a[228:231],a[224:227],v[184:187]
buffer_load_dwordx2 v[212:213],v245,s[8:11],s28 offen offset:1152
M v[184:187],a[232:235],a[248:251],v[184:187]
v_fmac_f32 v192,s45,v200
v_fmac_f32 v202,s41,v198
M v[184:187],a[240:243],a[220:223],v[184:187]
v_sub_f32 v200,v200,v196
v_fma_f32 v196,-4.0,v194,v198
M v[188:191],a[240:243],a[252:255],v[188:191]
v_sub_f32 v198,v198,v194
v_add_f32 v194,v235,v196
M v[188:191],a[232:235],a[220:223],v[188:191]
buffer_load_dwordx4 a[216:219],v251,s[20:23],s48 offen offset:0 sc1
M v[188:191],a[228:231],a[248:251],v[188:191]
s_waitcnt vmcnt(12) lgkmcnt(3)
ds_read_b128 a[240:243],v249 offset:35840
ds_read_b128 a[252:255],v250 offset:35840
M a[0:3],a[192:195],a[236:239],a[0:3]
s_waitcnt vmcnt(11) lgkmcnt(4)
v_sub_f32 v235,v235,v196
v_fma_f32 v196,2.0,v198,v200
M a[0:3],a[196:199],v[216:219],a[0:3]
s_waitcnt vmcnt(10) lgkmcnt(3)
v_fmac_f32 v200,-2.0,v198
v_cvt_pk_bf16_f32 v192,v232,v192
M a[0:3],a[200:203],v[220:223],a[0:3]
s_waitcnt lgkmcnt(2)
buffer_load_dwordx4 a[244:247],v251,s[20:23],s48 offen offset:1024 sc1
M a[4:7],a[200:203],v[224:227],a[4:7]
v_cvt_pk_bf16_f32 v202,v237,v202
v_cvt_pk_bf16_f32 v194,v233,v194
M a[4:7],a[196:199],v[220:223],a[4:7]
ds_read_b128 a[220:223],v249 offset:36352
v_cvt_pk_bf16_f32 v198,v234,v196
M a[4:7],a[192:195],v[216:219],a[4:7]
ds_read_b128 a[232:235],v250 offset:36352
v_cvt_pk_bf16_f32 v196,v238,v235
M a[8:11],a[192:195],v[220:223],a[8:11]
buffer_load_dwordx4 v[228:231],v251,s[20:23],s48 offen offset:2048 sc1
M a[8:11],a[196:199],v[224:227],a[8:11]
s_waitcnt lgkmcnt(3)
s_add_u32 s46,s44,184320
v_cvt_pk_bf16_f32 v200,v236,v200
v_lshlrev_b32 v234,16,v197
M a[8:11],a[200:203],a[240:243],a[8:11]
s_waitcnt lgkmcnt(2)
v_lshlrev_b32 v232,16,v193
v_lshlrev_b32 v233,16,v195
M a[12:15],a[200:203],a[252:255],a[12:15]
v_lshlrev_b32 v237,16,v203
v_lshlrev_b32 v236,16,v201
M a[12:15],a[196:199],a[240:243],a[12:15]
buffer_load_dwordx4 a[224:227],v251,s[20:23],s46 offen offset:0 sc1
M a[12:15],a[192:195],v[224:227],a[12:15]
ds_read_b128 a[228:231],v250 offset:36864
ds_read_b128 a[248:251],v249 offset:36864
M a[16:19],a[192:195],a[240:243],a[16:19]
v_lshlrev_b32 v235,16,v199
v_fmac_f32 v232,s43,v234
M a[16:19],a[196:199],a[252:255],a[16:19]
s_waitcnt lgkmcnt(3)
v_fmac_f32 v237,4.0,v233
v_fma_f32 v238,-4.0,v234,v236
M a[16:19],a[200:203],a[220:223],a[16:19]
s_waitcnt lgkmcnt(2)
v_fmac_f32 v232,s45,v236
v_fmac_f32 v237,s41,v235
M a[20:23],a[200:203],a[232:235],a[20:23]
v_sub_f32 v236,v236,v234
v_fma_f32 v234,-4.0,v233,v235
M a[20:23],a[196:199],a[220:223],a[20:23]
v_sub_f32 v235,v235,v233
v_add_f32 v233,v238,v234
M a[20:23],a[192:195],a[252:255],a[20:23]
v_sub_f32 v238,v238,v234
v_fma_f32 v234,2.0,v235,v236
M a[24:27],a[192:195],a[220:223],a[24:27]
v_fmac_f32 v236,-2.0,v235
v_and_b32 v197,s42,v197
M a[24:27],a[196:199],a[232:235],a[24:27]
s_waitcnt lgkmcnt(1)
v_and_b32 v193,s42,v193
v_and_b32 v195,s42,v195
M a[24:27],a[200:203],a[228:231],a[24:27]
s_waitcnt lgkmcnt(0)
v_and_b32 v203,s42,v203
v_and_b32 v201,s42,v201
M a[28:31],a[200:203],a[248:251],a[28:31]
buffer_load_dwordx4 a[200:203],v251,s[20:23],s46 offen offset:1024 sc1
M a[28:31],a[196:199],a[228:231],a[28:31]
v_and_b32 v199,s42,v199
v_fmac_f32 v193,s43,v197
M a[28:31],a[192:195],a[232:235],a[28:31]
s_waitcnt vmcnt(13)
buffer_load_dwordx4 a[196:199],v251,s[20:23],s46 offen offset:2048 sc1
M a[32:35],a[204:207],a[236:239],a[32:35]
s_waitcnt vmcnt(11)
s_add_u32 s47,s44,187392
v_fmac_f32 v203,4.0,v195
v_fma_f32 v235,-4.0,v197,v201
M a[32:35],a[208:211],v[216:219],a[32:35]
s_waitcnt vmcnt(10)
v_fmac_f32 v193,s45,v201
v_fmac_f32 v203,s41,v199
M a[32:35],a[212:215],v[220:223],a[32:35]
v_sub_f32 v201,v201,v197
v_fma_f32 v197,-4.0,v195,v199
M a[36:39],a[212:215],v[224:227],a[36:39]
buffer_load_dwordx4 a[192:195],v251,s[20:23],s47 offen offset:0 sc1
M a[36:39],a[208:211],v[220:223],a[36:39]
v_sub_f32 v199,v199,v195
v_add_f32 v195,v235,v197
M a[36:39],a[204:207],v[216:219],a[36:39]
v_sub_f32 v235,v235,v197
v_fma_f32 v197,2.0,v199,v201
M a[40:43],a[204:207],v[220:223],a[40:43]
v_fmac_f32 v201,-2.0,v199
v_cvt_pk_bf16_f32 v193,v232,v193
M a[40:43],a[208:211],v[224:227],a[40:43]
v_cvt_pk_bf16_f32 v203,v237,v203
v_cvt_pk_bf16_f32 v195,v233,v195
M a[40:43],a[212:215],a[240:243],a[40:43]
v_cvt_pk_bf16_f32 v199,v234,v197
v_cvt_pk_bf16_f32 v197,v238,v235
M a[44:47],a[212:215],a[252:255],a[44:47]
v_cvt_pk_bf16_f32 v201,v236,v201
v_add_u32 v232,139264,v247
M a[44:47],a[208:211],a[240:243],a[44:47]
ds_write2st64_b64 v232,v[192:193],v[202:203] offset0:0 offset1:17
M a[44:47],a[204:207],v[224:227],a[44:47]
s_add_u32 s28,s30,786688
buffer_load_dwordx2 v[192:193],v245,s[12:15],s28 offen offset:0
M a[48:51],a[204:207],a[240:243],a[48:51]
ds_write2st64_b64 v247,v[194:195],v[196:197] offset0:34 offset1:51
M a[48:51],a[208:211],a[252:255],a[48:51]
buffer_load_dwordx2 v[202:203],v245,s[16:19],s28 offen offset:1536
M a[48:51],a[212:215],a[220:223],a[48:51]
ds_write2st64_b64 v247,v[198:199],v[200:201] offset0:68 offset1:85
M a[52:55],a[212:215],a[232:235],a[52:55]
s_waitcnt vmcnt(11)
v_lshlrev_b32 v234,16,v208
v_lshlrev_b32 v232,16,v204
M a[52:55],a[208:211],a[220:223],a[52:55]
buffer_load_dwordx2 v[194:195],v245,s[8:11],s28 offen offset:0
M a[52:55],a[204:207],a[252:255],a[52:55]
v_lshlrev_b32 v233,16,v206
v_lshlrev_b32 v237,16,v214
M a[56:59],a[204:207],a[220:223],a[56:59]
s_waitcnt vmcnt(10)
v_lshlrev_b32 v236,16,v212
v_lshlrev_b32 v235,16,v210
M a[56:59],a[208:211],a[232:235],a[56:59]
v_fmac_f32 v232,s43,v234
v_fmac_f32 v237,4.0,v233
M a[56:59],a[212:215],a[228:231],a[56:59]
buffer_load_dwordx2 v[196:197],v245,s[8:11],s28 offen offset:384
M a[60:63],a[212:215],a[248:251],a[60:63]
v_fma_f32 v238,-4.0,v234,v236
v_fmac_f32 v232,s45,v236
M a[60:63],a[208:211],a[228:231],a[60:63]
v_fmac_f32 v237,s41,v235
v_sub_f32 v236,v236,v234
M a[60:63],a[204:207],a[232:235],a[60:63]
s_waitcnt vmcnt(10)
v_fma_f32 v234,-4.0,v233,v235
v_sub_f32 v235,v235,v233
M a[64:67],a[216:219],a[236:239],a[64:67]
s_waitcnt vmcnt(9)
buffer_load_dwordx4 a[212:215],v251,s[20:23],s47 offen offset:1024 sc1
M a[64:67],a[244:247],v[216:219],a[64:67]
s_waitcnt vmcnt(9)
v_add_f32 v233,v238,v234
v_sub_f32 v238,v238,v234
M a[64:67],v[228:231],v[220:223],a[64:67]
v_fma_f32 v234,2.0,v235,v236
v_fmac_f32 v236,-2.0,v235
M a[68:71],v[228:231],v[224:227],a[68:71]
v_and_b32 v208,s42,v208
v_and_b32 v204,s42,v204
M a[68:71],a[244:247],v[220:223],a[68:71]
buffer_load_dwordx4 a[208:211],v251,s[20:23],s47 offen offset:2048 sc1
M a[68:71],a[216:219],v[216:219],a[68:71]
s_add_u32 s48,s44,190464
v_and_b32 v206,s42,v206
v_and_b32 v214,s42,v214
M a[72:75],a[216:219],v[220:223],a[72:75]
v_and_b32 v212,s42,v212
v_and_b32 v210,s42,v210
M a[72:75],a[244:247],v[224:227],a[72:75]
v_fmac_f32 v204,s43,v208
v_fmac_f32 v214,4.0,v206
M a[72:75],v[228:231],a[240:243],a[72:75]
buffer_load_dwordx2 v[198:199],v245,s[8:11],s28 offen offset:768
M a[76:79],v[228:231],a[252:255],a[76:79]
v_fma_f32 v235,-4.0,v208,v212
v_fmac_f32 v204,s45,v212
M a[76:79],a[244:247],a[240:243],a[76:79]
v_fmac_f32 v214,s41,v210
v_sub_f32 v212,v212,v208
M a[76:79],a[216:219],v[224:227],a[76:79]
v_fma_f32 v208,-4.0,v206,v210
v_sub_f32 v210,v210,v206
M a[80:83],a[216:219],a[240:243],a[80:83]
buffer_load_dwordx2 v[200:201],v245,s[8:11],s28 offen offset:1152
M a[80:83],a[244:247],a[252:255],a[80:83]
v_add_f32 v206,v235,v208
v_sub_f32 v235,v235,v208
M a[80:83],v[228:231],a[220:223],a[80:83]
ds_read_b128 v[220:223],v249 offset:43520
v_fma_f32 v208,2.0,v210,v212
M a[84:87],v[228:231],a[232:235],a[84:87]
ds_read_b128 v[224:227],v250 offset:43520
v_fmac_f32 v212,-2.0,v210
M a[84:87],a[244:247],a[220:223],a[84:87]
buffer_load_dwordx4 a[204:207],v251,s[20:23],s48 offen offset:0 sc1
M a[84:87],a[216:219],a[252:255],a[84:87]
ds_read_b128 a[240:243],v249 offset:44032
ds_read_b128 a[252:255],v250 offset:44032
M a[88:91],a[216:219],a[220:223],a[88:91]
v_cvt_pk_bf16_f32 v204,v232,v204
v_cvt_pk_bf16_f32 v214,v237,v214
M a[88:91],a[244:247],a[232:235],a[88:91]
v_cvt_pk_bf16_f32 v206,v233,v206
v_cvt_pk_bf16_f32 v210,v234,v208
M a[88:91],v[228:231],a[228:231],a[88:91]
buffer_load_dwordx4 a[236:239],v251,s[20:23],s48 offen offset:1024 sc1
M a[92:95],v[228:231],a[248:251],a[92:95]
v_cvt_pk_bf16_f32 v208,v238,v235
v_cvt_pk_bf16_f32 v212,v236,v212
M a[92:95],a[244:247],a[228:231],a[92:95]
ds_read_b128 a[248:251],v249 offset:44544
v_lshlrev_b32 v234,16,v209
M a[92:95],a[216:219],a[232:235],a[92:95]
s_waitcnt vmcnt(13) lgkmcnt(4)
ds_read_b128 v[228:231],v250 offset:44544
v_lshlrev_b32 v232,16,v205
M a[96:99],a[224:227],v[220:223],a[96:99]
s_waitcnt vmcnt(12) lgkmcnt(4)
buffer_load_dwordx4 v[216:219],v251,s[20:23],s48 offen offset:2048 sc1
M a[96:99],a[200:203],v[224:227],a[96:99]
s_waitcnt vmcnt(12) lgkmcnt(3)
s_add_u32 s46,s44,193536
v_lshlrev_b32 v233,16,v207
v_lshlrev_b32 v237,16,v215
M a[96:99],a[196:199],a[240:243],a[96:99]
s_waitcnt lgkmcnt(2)
v_lshlrev_b32 v236,16,v213
v_lshlrev_b32 v235,16,v211
M a[100:103],a[196:199],a[252:255],a[100:103]
v_fmac_f32 v232,s43,v234
v_fmac_f32 v237,4.0,v233
M a[100:103],a[200:203],a[240:243],a[100:103]
buffer_load_dwordx4 a[220:223],v251,s[20:23],s46 offen offset:0 sc1
M a[100:103],a[224:227],v[224:227],a[100:103]
ds_read_b128 a[228:231],v249 offset:45056
ds_read_b128 a[244:247],v250 offset:45056
M a[104:107],a[224:227],a[240:243],a[104:107]
v_fma_f32 v238,-4.0,v234,v236
v_fmac_f32 v232,s45,v236
M a[104:107],a[200:203],a[252:255],a[104:107]
s_waitcnt lgkmcnt(3)
v_fmac_f32 v237,s41,v235
v_sub_f32 v236,v236,v234
M a[104:107],a[196:199],a[248:251],a[104:107]
s_waitcnt lgkmcnt(2)
v_fma_f32 v234,-4.0,v233,v235
v_sub_f32 v235,v235,v233
M a[108:111],a[196:199],v[228:231],a[108:111]
v_add_f32 v233,v238,v234
v_sub_f32 v238,v238,v234
M a[108:111],a[200:203],a[248:251],a[108:111]
ds_read_b128 a[216:219],v250 offset:45568
v_fma_f32 v234,2.0,v235,v236
M a[108:111],a[224:227],a[252:255],a[108:111]
ds_read_b128 a[232:235],v249 offset:45568
v_fmac_f32 v236,-2.0,v235
M a[112:115],a[224:227],a[248:251],a[112:115]
v_and_b32 v209,s42,v209
v_and_b32 v205,s42,v205
M a[112:115],a[200:203],v[228:231],a[112:115]
s_waitcnt lgkmcnt(3)
v_and_b32 v207,s42,v207
v_and_b32 v215,s42,v215
M a[112:115],a[196:199],a[228:231],a[112:115]
s_waitcnt lgkmcnt(2)
v_and_b32 v213,s42,v213
v_and_b32 v211,s42,v211
M a[116:119],a[196:199],a[244:247],a[116:119]
v_fmac_f32 v205,s43,v209
v_fmac_f32 v215,4.0,v207
M a[116:119],a[200:203],a[228:231],a[116:119]
v_fma_f32 v235,-4.0,v209,v213
v_fmac_f32 v205,s45,v213
M a[116:119],a[224:227],v[228:231],a[116:119]
v_fmac_f32 v215,s41,v211
v_sub_f32 v213,v213,v209
M a[120:123],a[224:227],a[228:231],a[120:123]
v_fma_f32 v209,-4.0,v207,v211
v_sub_f32 v211,v211,v207
M a[120:123],a[200:203],a[244:247],a[120:123]
s_waitcnt lgkmcnt(1)
v_add_f32 v207,v235,v209
v_sub_f32 v235,v235,v209
M a[120:123],a[196:199],a[216:219],a[120:123]
s_waitcnt lgkmcnt(0)
v_fma_f32 v209,2.0,v211,v213
v_fmac_f32 v213,-2.0,v211
M a[124:127],a[196:199],a[232:235],a[124:127]
buffer_load_dwordx4 a[196:199],v251,s[20:23],s46 offen offset:1024 sc1
M a[124:127],a[200:203],a[216:219],a[124:127]
v_cvt_pk_bf16_f32 v205,v232,v205
v_cvt_pk_bf16_f32 v215,v237,v215
M a[124:127],a[224:227],a[244:247],a[124:127]
s_waitcnt vmcnt(13)
buffer_load_dwordx4 a[200:203],v251,s[20:23],s46 offen offset:2048 sc1
M a[128:131],a[192:195],v[220:223],a[128:131]
s_waitcnt vmcnt(9)
s_add_u32 s47,s44,196608
v_cvt_pk_bf16_f32 v207,v233,v207
v_cvt_pk_bf16_f32 v211,v234,v209
M a[128:131],a[212:215],v[224:227],a[128:131]
s_waitcnt vmcnt(8)
v_cvt_pk_bf16_f32 v209,v238,v235
v_cvt_pk_bf16_f32 v213,v236,v213
M a[128:131],a[208:211],a[240:243],a[128:131]
v_add_u32 v232,139264,v247
M a[132:135],a[208:211],a[252:255],a[132:135]
buffer_load_dwordx4 a[224:227],v251,s[20:23],s47 offen offset:0 sc1
M a[132:135],a[212:215],a[240:243],a[132:135]
ds_write2st64_b64 v232,v[204:205],v[214:215] offset0:1 offset1:18
M a[132:135],a[192:195],v[224:227],a[132:135]
s_add_u32 s28,s30,1179904
ds_write2st64_b64 v247,v[206:207],v[208:209] offset0:35 offset1:52
M a[136:139],a[192:195],a[240:243],a[136:139]
buffer_load_dwordx2 v[204:205],v245,s[12:15],s28 offen offset:0
M a[136:139],a[212:215],a[252:255],a[136:139]
ds_write2st64_b64 v247,v[210:211],v[212:213] offset0:69 offset1:86
M a[136:139],a[208:211],a[248:251],a[136:139]
v_fmac_f32 v239,s43,v241
v_fmac_f32 v244,4.0,v240
M a[140:143],a[208:211],v[228:231],a[140:143]
buffer_load_dwordx2 v[214:215],v245,s[16:19],s28 offen offset:1536
M a[140:143],a[212:215],a[248:251],a[140:143]
v_fma_f32 v232,-4.0,v241,v243
v_fmac_f32 v239,s45,v243
M a[140:143],a[192:195],a[252:255],a[140:143]
v_fmac_f32 v244,s41,v242
v_sub_f32 v243,v243,v241
M a[144:147],a[192:195],a[248:251],a[144:147]
v_fma_f32 v241,-4.0,v240,v242
v_sub_f32 v242,v242,v240
M a[144:147],a[212:215],v[228:231],a[144:147]
buffer_load_dwordx2 v[206:207],v245,s[8:11],s28 offen offset:0
M a[144:147],a[208:211],a[228:231],a[144:147]
v_add_f32 v240,v232,v241
v_sub_f32 v232,v232,v241
M a[148:151],a[208:211],a[244:247],a[148:151]
v_fma_f32 v241,2.0,v242,v243
v_fmac_f32 v243,-2.0,v242
M a[148:151],a[212:215],a[228:231],a[148:151]
v_cvt_pk_bf16_f32 v233,v239,v244
v_cvt_pk_bf16_f32 v234,v240,v232
M a[148:151],a[192:195],v[228:231],a[148:151]
buffer_load_dwordx2 v[208:209],v245,s[8:11],s28 offen offset:384
M a[152:155],a[192:195],a[228:231],a[152:155]
v_cvt_pk_bf16_f32 v235,v241,v243
v_add_u32 v232,139264,v248
M a[152:155],a[212:215],a[244:247],a[152:155]
ds_write_b16 v232,v233 offset:0
M a[152:155],a[208:211],a[216:219],a[152:155]
ds_write_b16_d16_hi v232,v233 offset:8704
M a[156:159],a[208:211],a[232:235],a[156:159]
buffer_load_dwordx4 a[208:211],v251,s[20:23],s47 offen offset:1024 sc1
M a[156:159],a[212:215],a[216:219],a[156:159]
ds_write_b16 v248,v234 offset:17408
M a[156:159],a[192:195],a[244:247],a[156:159]
s_waitcnt vmcnt(11)
ds_write_b16_d16_hi v248,v234 offset:26112
M a[160:163],a[204:207],v[220:223],a[160:163]
s_waitcnt vmcnt(10)
ds_write_b16 v248,v235 offset:34816
M a[160:163],a[236:239],v[224:227],a[160:163]
s_waitcnt vmcnt(9)
buffer_load_dwordx4 a[212:215],v251,s[20:23],s47 offen offset:2048 sc1
M a[160:163],v[216:219],a[240:243],a[160:163]
s_add_u32 s48,s44,199680
ds_write_b16_d16_hi v248,v235 offset:43520
M a[164:167],v[216:219],a[252:255],a[164:167]
v_lshlrev_b32 v234,16,v196
v_lshlrev_b32 v232,16,v192
M a[164:167],a[236:239],a[240:243],a[164:167]
v_lshlrev_b32 v233,16,v194
v_lshlrev_b32 v237,16,v202
M a[164:167],a[204:207],v[224:227],a[164:167]
buffer_load_dwordx2 v[210:211],v245,s[8:11],s28 offen offset:768
M a[168:171],a[204:207],a[240:243],a[168:171]
v_lshlrev_b32 v236,16,v200
v_lshlrev_b32 v235,16,v198
M a[168:171],a[236:239],a[252:255],a[168:171]
v_fmac_f32 v232,s43,v234
v_fmac_f32 v237,4.0,v233
M a[168:171],v[216:219],a[248:251],a[168:171]
v_fma_f32 v238,-4.0,v234,v236
v_fmac_f32 v232,s45,v236
M a[172:175],v[216:219],v[228:231],a[172:175]
buffer_load_dwordx2 v[212:213],v245,s[8:11],s28 offen offset:1152
M a[172:175],a[236:239],a[248:251],a[172:175]
s_add_u32 s29,s30,320
v_fmac_f32 v237,s41,v235
v_sub_f32 v236,v236,v234
M a[172:175],a[204:207],a[252:255],a[172:175]
v_fma_f32 v234,-4.0,v233,v235
v_sub_f32 v235,v235,v233
M a[176:179],a[204:207],a[248:251],a[176:179]
v_add_f32 v233,v238,v234
v_sub_f32 v238,v238,v234
M a[176:179],a[236:239],v[228:231],a[176:179]
buffer_load_short_d16_hi v239,v246,s[12:15],s29 offen offset:0
M a[176:179],v[216:219],a[228:231],a[176:179]
ds_read_b128 a[240:243],v249 offset:52224
v_fma_f32 v234,2.0,v235,v236
M a[180:183],v[216:219],a[244:247],a[180:183]
buffer_load_short_d16_hi v240,v246,s[8:11],s29 offen offset:0
M a[180:183],a[236:239],a[228:231],a[180:183]
ds_read_b128 a[252:255],v250 offset:52224
ds_read_b128 a[248:251],v249 offset:52736
M a[180:183],a[204:207],v[228:231],a[180:183]
buffer_load_short_d16_hi v241,v246,s[8:11],s29 offen offset:384
M a[184:187],a[204:207],a[228:231],a[184:187]
ds_read_b128 v[228:231],v250 offset:52736
v_fmac_f32 v236,-2.0,v235
M a[184:187],a[236:239],a[244:247],a[184:187]
buffer_load_short_d16_hi v242,v246,s[8:11],s29 offen offset:768
M a[184:187],v[216:219],a[216:219],a[184:187]
v_and_b32 v196,s42,v196
v_and_b32 v192,s42,v192
M a[188:191],v[216:219],a[232:235],a[188:191]
buffer_load_short_d16_hi v243,v246,s[8:11],s29 offen offset:1152
M a[188:191],a[236:239],a[216:219],a[188:191]
ds_read_b128 a[232:235],v249 offset:53248
v_and_b32 v194,s42,v194
M a[188:191],a[204:207],a[244:247],a[188:191]
s_waitcnt vmcnt(16) lgkmcnt(4)
buffer_load_short_d16_hi v244,v246,s[16:19],s29 offen offset:1536
M v[0:3],a[220:223],a[240:243],v[0:3]
s_waitcnt vmcnt(16) lgkmcnt(3)
ds_read_b128 v[216:219],v250 offset:53248
v_and_b32 v202,s42,v202
M v[0:3],a[196:199],a[252:255],v[0:3]
s_waitcnt vmcnt(15) lgkmcnt(3)
buffer_load_dwordx4 a[192:195],v251,s[20:23],s48 offen offset:0 sc1
M v[0:3],a[200:203],a[248:251],v[0:3]
s_waitcnt lgkmcnt(2)
v_and_b32 v200,s42,v200
v_and_b32 v198,s42,v198
M v[4:7],a[200:203],v[228:231],v[4:7]
v_fmac_f32 v192,s43,v196
v_fmac_f32 v202,4.0,v194
M v[4:7],a[196:199],a[248:251],v[4:7]
ds_read_b128 a[216:219],v249 offset:53760
v_fma_f32 v235,-4.0,v196,v200
M v[4:7],a[220:223],a[252:255],v[4:7]
buffer_load_dwordx4 v[220:223],v251,s[20:23],s48 offen offset:1024 sc1
M v[8:11],a[220:223],a[248:251],v[8:11]
ds_read_b128 a[236:239],v250 offset:53760
v_fmac_f32 v192,s45,v200
M v[8:11],a[196:199],v[228:231],v[8:11]
s_waitcnt lgkmcnt(3)
v_fmac_f32 v202,s41,v198
v_sub_f32 v200,v200,v196
M v[8:11],a[200:203],a[232:235],v[8:11]
s_waitcnt lgkmcnt(2)
v_fma_f32 v196,-4.0,v194,v198
v_sub_f32 v198,v198,v194
M v[12:15],a[200:203],v[216:219],v[12:15]
buffer_load_dwordx4 v[224:227],v251,s[20:23],s48 offen offset:2048 sc1
M v[12:15],a[196:199],a[232:235],v[12:15]
s_add_u32 s46,s44,202752
ds_read_b128 a[204:207],v250 offset:54272
v_add_f32 v194,v235,v196
M v[12:15],a[220:223],v[228:231],v[12:15]
ds_read_b128 a[244:247],v249 offset:54272
v_sub_f32 v235,v235,v196
M v[16:19],a[220:223],a[232:235],v[16:19]
v_fma_f32 v196,2.0,v198,v200
v_fmac_f32 v200,-2.0,v198
M v[16:19],a[196:199],v[216:219],v[16:19]
s_waitcnt lgkmcnt(3)
buffer_load_dwordx4 a[228:231],v251,s[20:23],s46 offen offset:0 sc1
M v[16:19],a[200:203],a[216:219],v[16:19]
s_waitcnt lgkmcnt(2)
v_cvt_pk_bf16_f32 v192,v232,v192
v_cvt_pk_bf16_f32 v202,v237,v202
M v[20:23],a[200:203],a[236:239],v[20:23]
v_cvt_pk_bf16_f32 v194,v233,v194
v_cvt_pk_bf16_f32 v198,v234,v196
M v[20:23],a[196:199],a[216:219],v[20:23]
v_cvt_pk_bf16_f32 v196,v238,v235
v_cvt_pk_bf16_f32 v200,v236,v200
M v[20:23],a[220:223],v[216:219],v[20:23]
v_lshlrev_b32 v234,16,v197
v_lshlrev_b32 v232,16,v193
M v[24:27],a[220:223],a[216:219],v[24:27]
v_lshlrev_b32 v233,16,v195
v_lshlrev_b32 v237,16,v203
M v[24:27],a[196:199],a[236:239],v[24:27]
s_waitcnt lgkmcnt(1)
v_lshlrev_b32 v236,16,v201
v_lshlrev_b32 v235,16,v199
M v[24:27],a[200:203],a[204:207],v[24:27]
s_waitcnt lgkmcnt(0)
v_fmac_f32 v232,s43,v234
v_fmac_f32 v237,4.0,v233
M v[28:31],a[200:203],a[244:247],v[28:31]
global_load_dword a200,v251,s[64:65]
M v[28:31],a[196:199],a[204:207],v[28:31]
buffer_load_dwordx4 a[200:203],v251,s[20:23],s46 offen offset:1024 sc1
M v[28:31],a[220:223],a[236:239],v[28:31]
s_waitcnt vmcnt(20)
v_fma_f32 v238,-4.0,v234,v236
v_fmac_f32 v232,s45,v236
M v[32:35],a[224:227],a[240:243],v[32:35]
s_waitcnt vmcnt(15)
v_fmac_f32 v237,s41,v235
v_sub_f32 v236,v236,v234
M v[32:35],a[208:211],a[252:255],v[32:35]
s_waitcnt vmcnt(14)
buffer_load_dwordx4 a[196:199],v251,s[20:23],s46 offen offset:2048 sc1
M v[32:35],a[212:215],a[248:251],v[32:35]
s_add_u32 s47,s44,205824
v_fma_f32 v234,-4.0,v233,v235
v_sub_f32 v235,v235,v233
M v[36:39],a[212:215],v[228:231],v[36:39]
v_add_f32 v233,v238,v234
v_sub_f32 v238,v238,v234
M v[36:39],a[208:211],a[248:251],v[36:39]
v_fma_f32 v234,2.0,v235,v236
v_fmac_f32 v236,-2.0,v235
M v[36:39],a[224:227],a[252:255],v[36:39]
buffer_load_dwordx4 a[220:223],v251,s[20:23],s47 offen offset:0 sc1
M v[40:43],a[224:227],a[248:251],v[40:43]
v_and_b32 v197,s42,v197
v_and_b32 v193,s42,v193
M v[40:43],a[208:211],v[228:231],v[40:43]
v_and_b32 v195,s42,v195
v_and_b32 v203,s42,v203
M v[40:43],a[212:215],a[232:235],v[40:43]
v_and_b32 v201,s42,v201
v_and_b32 v199,s42,v199
M v[44:47],a[212:215],v[216:219],v[44:47]
v_fmac_f32 v193,s43,v197
v_fmac_f32 v203,4.0,v195
M v[44:47],a[208:211],a[232:235],v[44:47]
v_fma_f32 v235,-4.0,v197,v201
v_fmac_f32 v193,s45,v201
M v[44:47],a[224:227],v[228:231],v[44:47]
v_fmac_f32 v203,s41,v199
v_sub_f32 v201,v201,v197
M v[48:51],a[224:227],a[232:235],v[48:51]
v_fma_f32 v197,-4.0,v195,v199
v_sub_f32 v199,v199,v195
M v[48:51],a[208:211],v[216:219],v[48:51]
v_add_f32 v195,v235,v197
v_sub_f32 v235,v235,v197
M v[48:51],a[212:215],a[216:219],v[48:51]
v_fma_f32 v197,2.0,v199,v201
v_fmac_f32 v201,-2.0,v199
M v[52:55],a[212:215],a[236:239],v[52:55]
v_cvt_pk_bf16_f32 v193,v232,v193
v_cvt_pk_bf16_f32 v203,v237,v203
M v[52:55],a[208:211],a[216:219],v[52:55]
v_cvt_pk_bf16_f32 v195,v233,v195
v_cvt_pk_bf16_f32 v199,v234,v197
M v[52:55],a[224:227],v[216:219],v[52:55]
v_cvt_pk_bf16_f32 v197,v238,v235
v_cvt_pk_bf16_f32 v201,v236,v201
M v[56:59],a[224:227],a[216:219],v[56:59]
v_add_u32 v232,139264,v247
M v[56:59],a[208:211],a[236:239],v[56:59]
ds_write2st64_b64 v232,v[192:193],v[202:203] offset0:2 offset1:19
M v[56:59],a[212:215],a[204:207],v[56:59]
s_add_u32 s28,s30,320
buffer_load_dwordx2 v[192:193],v254,s[12:15],s28 offen offset:0
M v[60:63],a[212:215],a[244:247],v[60:63]
ds_write2st64_b64 v247,v[194:195],v[196:197] offset0:36 offset1:53
M v[60:63],a[208:211],a[204:207],v[60:63]
buffer_load_dwordx4 a[212:215],v251,s[20:23],s47 offen offset:1024 sc1
M v[60:63],a[224:227],a[236:239],v[60:63]
s_waitcnt vmcnt(9)
ds_write2st64_b64 v247,v[198:199],v[200:201] offset0:70 offset1:87
M v[64:67],a[192:195],a[240:243],v[64:67]
s_waitcnt vmcnt(8)
v_lshlrev_b32 v234,16,v208
v_lshlrev_b32 v232,16,v204
M v[64:67],v[220:223],a[252:255],v[64:67]
s_waitcnt vmcnt(7)
buffer_load_dwordx4 a[208:211],v251,s[20:23],s47 offen offset:2048 sc1
M v[64:67],v[224:227],a[248:251],v[64:67]
s_add_u32 s48,s44,208896
v_lshlrev_b32 v233,16,v206
v_lshlrev_b32 v237,16,v214
M v[68:71],v[224:227],v[228:231],v[68:71]
v_lshlrev_b32 v236,16,v212
v_lshlrev_b32 v235,16,v210
M v[68:71],v[220:223],a[248:251],v[68:71]
v_fmac_f32 v232,s43,v234
v_fmac_f32 v237,4.0,v233
M v[68:71],a[192:195],a[252:255],v[68:71]
buffer_load_dwordx2 v[202:203],v254,s[16:19],s28 offen offset:1536
M v[72:75],a[192:195],a[248:251],v[72:75]
v_fma_f32 v238,-4.0,v234,v236
v_fmac_f32 v232,s45,v236
M v[72:75],v[220:223],v[228:231],v[72:75]
v_fmac_f32 v237,s41,v235
v_sub_f32 v236,v236,v234
M v[72:75],v[224:227],a[232:235],v[72:75]
v_fma_f32 v234,-4.0,v233,v235
v_sub_f32 v235,v235,v233
M v[76:79],v[224:227],v[216:219],v[76:79]
buffer_load_dwordx2 v[194:195],v254,s[8:11],s28 offen offset:0
M v[76:79],v[220:223],a[232:235],v[76:79]
v_add_f32 v233,v238,v234
v_sub_f32 v238,v238,v234
M v[76:79],a[192:195],v[228:231],v[76:79]
v_fma_f32 v234,2.0,v235,v236
v_fmac_f32 v236,-2.0,v235
M v[80:83],a[192:195],a[232:235],v[80:83]
v_and_b32 v208,s42,v208
v_and_b32 v204,s42,v204
M v[80:83],v[220:223],v[216:219],v[80:83]
buffer_load_dwordx2 v[196:197],v254,s[8:11],s28 offen offset:384
M v[80:83],v[224:227],a[216:219],v[80:83]
ds_read_b128 a[248:251],v249 offset:60928
v_and_b32 v206,s42,v206
M v[84:87],v[224:227],a[236:239],v[84:87]
ds_read_b128 v[228:231],v250 offset:60928
v_and_b32 v214,s42,v214
M v[84:87],v[220:223],a[216:219],v[84:87]
ds_read_b128 a[232:235],v249 offset:61440
v_and_b32 v212,s42,v212
M v[84:87],a[192:195],v[216:219],v[84:87]
buffer_load_dwordx2 v[198:199],v254,s[8:11],s28 offen offset:768
M v[88:91],a[192:195],a[216:219],v[88:91]
ds_read_b128 v[216:219],v250 offset:61440
v_and_b32 v210,s42,v210
M v[88:91],v[220:223],a[236:239],v[88:91]
v_fmac_f32 v204,s43,v208
v_fmac_f32 v214,4.0,v206
M v[88:91],v[224:227],a[204:207],v[88:91]
v_fma_f32 v235,-4.0,v208,v212
v_fmac_f32 v204,s45,v212
M v[92:95],v[224:227],a[244:247],v[92:95]
buffer_load_dwordx2 v[200:201],v254,s[8:11],s28 offen offset:1152
M v[92:95],v[220:223],a[204:207],v[92:95]
ds_read_b128 a[244:247],v249 offset:61952
v_fmac_f32 v214,s41,v210
M v[92:95],a[192:195],a[236:239],v[92:95]
s_waitcnt vmcnt(12) lgkmcnt(4)
ds_read_b128 v[224:227],v250 offset:61952
v_sub_f32 v212,v212,v208
M v[96:99],a[228:231],a[248:251],v[96:99]
s_waitcnt vmcnt(10) lgkmcnt(4)
v_fma_f32 v208,-4.0,v206,v210
v_sub_f32 v210,v210,v206
M v[96:99],a[200:203],v[228:231],v[96:99]
s_waitcnt vmcnt(9) lgkmcnt(3)
buffer_load_dwordx4 a[224:227],v251,s[20:23],s48 offen offset:0 sc1
M v[96:99],a[196:199],a[232:235],v[96:99]
s_waitcnt lgkmcnt(2)
v_add_f32 v206,v235,v208
v_sub_f32 v235,v235,v208
M v[100:103],a[196:199],v[216:219],v[100:103]
v_fma_f32 v208,2.0,v210,v212
v_fmac_f32 v212,-2.0,v210
M v[100:103],a[200:203],a[232:235],v[100:103]
ds_read_b128 a[204:207],v249 offset:62464
v_cvt_pk_bf16_f32 v204,v232,v204
M v[100:103],a[228:231],v[228:231],v[100:103]
buffer_load_dwordx4 a[240:243],v251,s[20:23],s48 offen offset:1024 sc1
M v[104:107],a[228:231],a[232:235],v[104:107]
ds_read_b128 v[220:223],v250 offset:62464
v_cvt_pk_bf16_f32 v214,v237,v214
M v[104:107],a[200:203],v[216:219],v[104:107]
s_waitcnt lgkmcnt(3)
v_cvt_pk_bf16_f32 v206,v233,v206
v_cvt_pk_bf16_f32 v210,v234,v208
M v[104:107],a[196:199],a[244:247],v[104:107]
s_waitcnt lgkmcnt(2)
v_cvt_pk_bf16_f32 v208,v238,v235
v_cvt_pk_bf16_f32 v212,v236,v212
M v[108:111],a[196:199],v[224:227],v[108:111]
buffer_load_dwordx4 a[252:255],v251,s[20:23],s48 offen offset:2048 sc1
M v[108:111],a[200:203],a[244:247],v[108:111]
s_add_u32 s46,s44,230400
ds_read_b128 a[192:195],v250 offset:62976
v_lshlrev_b32 v234,16,v209
M v[108:111],a[228:231],v[216:219],v[108:111]
ds_read_b128 a[236:239],v249 offset:62976
v_lshlrev_b32 v232,16,v205
M v[112:115],a[228:231],a[244:247],v[112:115]
v_lshlrev_b32 v233,16,v207
v_lshlrev_b32 v237,16,v215
M v[112:115],a[200:203],v[224:227],v[112:115]
s_waitcnt lgkmcnt(3)
buffer_load_dwordx4 a[216:219],v251,s[20:23],s46 offen offset:0 sc1
M v[112:115],a[196:199],a[204:207],v[112:115]
s_waitcnt lgkmcnt(2)
v_lshlrev_b32 v236,16,v213
v_lshlrev_b32 v235,16,v211
M v[116:119],a[196:199],v[220:223],v[116:119]
v_fmac_f32 v232,s43,v234
v_fmac_f32 v237,4.0,v233
M v[116:119],a[200:203],a[204:207],v[116:119]
v_fma_f32 v238,-4.0,v234,v236
v_fmac_f32 v232,s45,v236
M v[116:119],a[228:231],v[224:227],v[116:119]
v_fmac_f32 v237,s41,v235
v_sub_f32 v236,v236,v234
M v[120:123],a[228:231],a[204:207],v[120:123]
v_fma_f32 v234,-4.0,v233,v235
v_sub_f32 v235,v235,v233
M v[120:123],a[200:203],v[220:223],v[120:123]
s_waitcnt lgkmcnt(1)
v_add_f32 v233,v238,v234
v_sub_f32 v238,v238,v234
M v[120:123],a[196:199],a[192:195],v[120:123]
s_waitcnt lgkmcnt(0)
v_fma_f32 v234,2.0,v235,v236
v_fmac_f32 v236,-2.0,v235
M v[124:127],a[196:199],a[236:239],v[124:127]
buffer_load_dwordx4 a[196:199],v251,s[20:23],s46 offen offset:1024 sc1
M v[124:127],a[200:203],a[192:195],v[124:127]
v_and_b32 v209,s42,v209
v_and_b32 v205,s42,v205
M v[124:127],a[228:231],v[220:223],v[124:127]
s_waitcnt vmcnt(13)
buffer_load_dwordx4 a[200:203],v251,s[20:23],s46 offen offset:2048 sc1
M v[128:131],a[220:223],a[248:251],v[128:131]
s_waitcnt vmcnt(12)
s_add_u32 s47,s44,233472
v_and_b32 v207,s42,v207
v_and_b32 v215,s42,v215
M v[128:131],a[212:215],v[228:231],v[128:131]
s_waitcnt vmcnt(11)
v_and_b32 v213,s42,v213
v_and_b32 v211,s42,v211
M v[128:131],a[208:211],a[232:235],v[128:131]
v_fmac_f32 v205,s43,v209
v_fmac_f32 v215,4.0,v207
M v[132:135],a[208:211],v[216:219],v[132:135]
buffer_load_dwordx4 a[228:231],v251,s[20:23],s47 offen offset:0 sc1
M v[132:135],a[212:215],a[232:235],v[132:135]
v_fma_f32 v235,-4.0,v209,v213
v_fmac_f32 v205,s45,v213
M v[132:135],a[220:223],v[228:231],v[132:135]
v_fmac_f32 v215,s41,v211
v_sub_f32 v213,v213,v209
M v[136:139],a[220:223],a[232:235],v[136:139]
v_fma_f32 v209,-4.0,v207,v211
v_sub_f32 v211,v211,v207
M v[136:139],a[212:215],v[216:219],v[136:139]
v_add_f32 v207,v235,v209
v_sub_f32 v235,v235,v209
M v[136:139],a[208:211],a[244:247],v[136:139]
v_fma_f32 v209,2.0,v211,v213
v_fmac_f32 v213,-2.0,v211
M v[140:143],a[208:211],v[224:227],v[140:143]
v_cvt_pk_bf16_f32 v205,v232,v205
v_cvt_pk_bf16_f32 v215,v237,v215
M v[140:143],a[212:215],a[244:247],v[140:143]
v_cvt_pk_bf16_f32 v207,v233,v207
v_cvt_pk_bf16_f32 v211,v234,v209
M v[140:143],a[220:223],v[216:219],v[140:143]
v_cvt_pk_bf16_f32 v209,v238,v235
v_cvt_pk_bf16_f32 v213,v236,v213
M v[144:147],a[220:223],a[244:247],v[144:147]
v_add_u32 v232,139264,v247
M v[144:147],a[212:215],v[224:227],v[144:147]
ds_write2st64_b64 v232,v[204:205],v[214:215] offset0:3 offset1:20
M v[144:147],a[208:211],a[204:207],v[144:147]
s_add_u32 s28,s30,393536
buffer_load_dwordx2 v[204:205],v245,s[12:15],s28 offen offset:0
M v[148:151],a[208:211],v[220:223],v[148:151]
ds_write2st64_b64 v247,v[206:207],v[208:209] offset0:37 offset1:54
M v[148:151],a[212:215],a[204:207],v[148:151]
buffer_load_dwordx2 v[214:215],v245,s[16:19],s28 offen offset:1536
M v[148:151],a[220:223],v[224:227],v[148:151]
ds_write2st64_b64 v247,v[210:211],v[212:213] offset0:71 offset1:88
M v[152:155],a[220:223],a[204:207],v[152:155]
s_waitcnt vmcnt(11)
v_lshlrev_b32 v234,16,v196
v_lshlrev_b32 v232,16,v192
M v[152:155],a[212:215],v[220:223],v[152:155]
buffer_load_dwordx2 v[206:207],v245,s[8:11],s28 offen offset:0
M v[152:155],a[208:211],a[192:195],v[152:155]
v_lshlrev_b32 v233,16,v194
v_lshlrev_b32 v237,16,v202
M v[156:159],a[208:211],a[236:239],v[156:159]
s_waitcnt vmcnt(10)
v_lshlrev_b32 v236,16,v200
v_lshlrev_b32 v235,16,v198
M v[156:159],a[212:215],a[192:195],v[156:159]
v_fmac_f32 v232,s43,v234
v_fmac_f32 v237,4.0,v233
M v[156:159],a[220:223],v[220:223],v[156:159]
s_waitcnt vmcnt(9)
buffer_load_dwordx4 a[208:211],v251,s[20:23],s47 offen offset:1024 sc1
M v[160:163],a[224:227],a[248:251],v[160:163]
s_waitcnt vmcnt(9)
v_fma_f32 v238,-4.0,v234,v236
v_fmac_f32 v232,s45,v236
M v[160:163],a[240:243],v[228:231],v[160:163]
s_waitcnt vmcnt(8)
v_fmac_f32 v237,s41,v235
v_sub_f32 v236,v236,v234
M v[160:163],a[252:255],a[232:235],v[160:163]
v_fma_f32 v234,-4.0,v233,v235
v_sub_f32 v235,v235,v233
M v[164:167],a[252:255],v[216:219],v[164:167]
buffer_load_dwordx4 a[212:215],v251,s[20:23],s47 offen offset:2048 sc1
M v[164:167],a[240:243],a[232:235],v[164:167]
s_add_u32 s48,s44,236544
v_add_f32 v233,v238,v234
v_sub_f32 v238,v238,v234
M v[164:167],a[224:227],v[228:231],v[164:167]
v_fma_f32 v234,2.0,v235,v236
v_fmac_f32 v236,-2.0,v235
M v[168:171],a[224:227],a[232:235],v[168:171]
v_and_b32 v196,s42,v196
v_and_b32 v192,s42,v192
M v[168:171],a[240:243],v[216:219],v[168:171]
buffer_load_dwordx2 v[208:209],v245,s[8:11],s28 offen offset:384
M v[168:171],a[252:255],a[244:247],v[168:171]
v_and_b32 v194,s42,v194
v_and_b32 v202,s42,v202
M v[172:175],a[252:255],v[224:227],v[172:175]
v_and_b32 v200,s42,v200
v_and_b32 v198,s42,v198
M v[172:175],a[240:243],a[244:247],v[172:175]
v_fmac_f32 v192,s43,v196
v_fmac_f32 v202,4.0,v194
M v[172:175],a[224:227],v[216:219],v[172:175]
buffer_load_dwordx2 v[210:211],v245,s[8:11],s28 offen offset:768
M v[176:179],a[224:227],a[244:247],v[176:179]
v_fma_f32 v235,-4.0,v196,v200
v_fmac_f32 v192,s45,v200
M v[176:179],a[240:243],v[224:227],v[176:179]
v_fmac_f32 v202,s41,v198
v_sub_f32 v200,v200,v196
M v[176:179],a[252:255],a[204:207],v[176:179]
s_waitcnt lgkmcnt(0)
s_barrier
ds_read_b128 a[232:235],v249 offset:0
M v[180:183],a[252:255],v[220:223],v[180:183]
buffer_load_dwordx2 v[212:213],v245,s[8:11],s28 offen offset:1152
M v[180:183],a[240:243],a[204:207],v[180:183]
ds_read_b128 v[216:219],v250 offset:0
ds_read_b128 a[244:247],v249 offset:512
M v[180:183],a[224:227],v[224:227],v[180:183]
ds_read_b128 v[224:227],v250 offset:512
v_fma_f32 v196,-4.0,v194,v198
M v[184:187],a[224:227],a[204:207],v[184:187]
v_sub_f32 v198,v198,v194
v_add_f32 v194,v235,v196
M v[184:187],a[240:243],v[220:223],v[184:187]
buffer_load_dwordx4 a[220:223],v251,s[20:23],s48 offen offset:0 sc1
M v[184:187],a[252:255],a[192:195],v[184:187]
v_sub_f32 v235,v235,v196
v_fma_f32 v196,2.0,v198,v200
M v[188:191],a[252:255],a[236:239],v[188:191]
v_fmac_f32 v200,-2.0,v198
v_cvt_pk_bf16_f32 v192,v232,v192
M v[188:191],a[240:243],a[192:195],v[188:191]
ds_read_b128 a[236:239],v249 offset:1024
v_cvt_pk_bf16_f32 v202,v237,v202
M v[188:191],a[224:227],v[220:223],v[188:191]
s_waitcnt vmcnt(12) lgkmcnt(4)
buffer_load_dwordx4 a[248:251],v251,s[20:23],s48 offen offset:1024 sc1
M a[0:3],a[216:219],a[232:235],a[0:3]
s_waitcnt vmcnt(12) lgkmcnt(3)
ds_read_b128 a[252:255],v250 offset:1024
v_cvt_pk_bf16_f32 v194,v233,v194
M a[0:3],a[196:199],v[216:219],a[0:3]
s_waitcnt vmcnt(11) lgkmcnt(3)
v_cvt_pk_bf16_f32 v198,v234,v196
v_cvt_pk_bf16_f32 v196,v238,v235
M a[0:3],a[200:203],a[244:247],a[0:3]
s_waitcnt lgkmcnt(2)
v_cvt_pk_bf16_f32 v200,v236,v200
v_lshlrev_b32 v234,16,v197
M a[4:7],a[200:203],v[224:227],a[4:7]
buffer_load_dwordx4 v[228:231],v251,s[20:23],s48 offen offset:2048 sc1
M a[4:7],a[196:199],a[244:247],a[4:7]
s_add_u32 s46,s44,239616
ds_read_b128 a[192:195],v249 offset:1536
v_lshlrev_b32 v232,16,v193
M a[4:7],a[216:219],v[216:219],a[4:7]
ds_read_b128 a[240:243],v250 offset:1536
v_lshlrev_b32 v233,16,v195
M a[8:11],a[216:219],a[244:247],a[8:11]
v_lshlrev_b32 v237,16,v203
v_lshlrev_b32 v236,16,v201
M a[8:11],a[196:199],v[224:227],a[8:11]
s_waitcnt lgkmcnt(3)
buffer_load_dwordx4 a[204:207],v251,s[20:23],s46 offen offset:0 sc1
M a[8:11],a[200:203],a[236:239],a[8:11]
s_waitcnt lgkmcnt(2)
v_lshlrev_b32 v235,16,v199
v_fmac_f32 v232,s43,v234
M a[12:15],a[200:203],a[252:255],a[12:15]
v_fmac_f32 v237,4.0,v233
v_fma_f32 v238,-4.0,v234,v236
M a[12:15],a[196:199],a[236:239],a[12:15]
ds_read_b128 a[224:227],v250 offset:2048
v_fmac_f32 v232,s45,v236
M a[12:15],a[216:219],v[224:227],a[12:15]
ds_read_b128 v[220:223],v249 offset:2048
v_fmac_f32 v237,s41,v235
M a[16:19],a[216:219],a[236:239],a[16:19]
v_sub_f32 v236,v236,v234
v_fma_f32 v234,-4.0,v233,v235
M a[16:19],a[196:199],a[252:255],a[16:19]
s_waitcnt lgkmcnt(3)
v_sub_f32 v235,v235,v233
v_add_f32 v233,v238,v234
M a[16:19],a[200:203],a[192:195],a[16:19]
s_waitcnt lgkmcnt(2)
v_sub_f32 v238,v238,v234
v_fma_f32 v234,2.0,v235,v236
M a[20:23],a[200:203],a[240:243],a[20:23]
v_fmac_f32 v236,-2.0,v235
v_and_b32 v197,s42,v197
M a[20:23],a[196:199],a[192:195],a[20:23]
v_and_b32 v193,s42,v193
v_and_b32 v195,s42,v195
M a[20:23],a[216:219],a[252:255],a[20:23]
v_and_b32 v203,s42,v203
v_and_b32 v201,s42,v201
M a[24:27],a[216:219],a[192:195],a[24:27]
v_and_b32 v199,s42,v199
v_fmac_f32 v193,s43,v197
M a[24:27],a[196:199],a[240:243],a[24:27]
s_waitcnt lgkmcnt(1)
v_fmac_f32 v203,4.0,v195
v_fma_f32 v235,-4.0,v197,v201
M a[24:27],a[200:203],a[224:227],a[24:27]
s_waitcnt lgkmcnt(0)
v_fmac_f32 v193,s45,v201
v_fmac_f32 v203,s41,v199
M a[28:31],a[200:203],v[220:223],a[28:31]
buffer_load_dwordx4 a[200:203],v251,s[20:23],s46 offen offset:1024 sc1
M a[28:31],a[196:199],a[224:227],a[28:31]
v_sub_f32 v201,v201,v197
v_fma_f32 v197,-4.0,v195,v199
M a[28:31],a[216:219],a[240:243],a[28:31]
s_waitcnt vmcnt(13)
buffer_load_dwordx4 a[196:199],v251,s[20:23],s46 offen offset:2048 sc1
M a[32:35],a[228:231],a[232:235],a[32:35]
s_waitcnt vmcnt(10)
s_add_u32 s47,s44,242688
v_sub_f32 v199,v199,v195
v_add_f32 v195,v235,v197
M a[32:35],a[208:211],v[216:219],a[32:35]
s_waitcnt vmcnt(9)
v_sub_f32 v235,v235,v197
v_fma_f32 v197,2.0,v199,v201
M a[32:35],a[212:215],a[244:247],a[32:35]
v_fmac_f32 v201,-2.0,v199
v_cvt_pk_bf16_f32 v193,v232,v193
M a[36:39],a[212:215],v[224:227],a[36:39]
buffer_load_dwordx4 a[216:219],v251,s[20:23],s47 offen offset:0 sc1
M a[36:39],a[208:211],a[244:247],a[36:39]
v_cvt_pk_bf16_f32 v203,v237,v203
v_cvt_pk_bf16_f32 v195,v233,v195
M a[36:39],a[228:231],v[216:219],a[36:39]
v_cvt_pk_bf16_f32 v199,v234,v197
v_cvt_pk_bf16_f32 v197,v238,v235
M a[40:43],a[228:231],a[244:247],a[40:43]
v_cvt_pk_bf16_f32 v201,v236,v201
M a[40:43],a[208:211],v[224:227],a[40:43]
ds_write2st64_b64 v247,v[192:193],v[202:203] offset0:136 offset1:153
M a[40:43],a[212:215],a[236:239],a[40:43]
s_add_u32 s28,s30,786752
buffer_load_dwordx2 v[192:193],v245,s[12:15],s28 offen offset:0
M a[44:47],a[212:215],a[252:255],a[44:47]
ds_write2st64_b64 v247,v[194:195],v[196:197] offset0:102 offset1:119
M a[44:47],a[208:211],a[236:239],a[44:47]
buffer_load_dwordx2 v[202:203],v245,s[16:19],s28 offen offset:1536
M a[44:47],a[228:231],v[224:227],a[44:47]
M a[48:51],a[228:231],a[236:239],a[48:51]
M a[48:51],a[208:211],a[252:255],a[48:51]
M a[48:51],a[212:215],a[192:195],a[48:51]
buffer_load_dwordx2 v[194:195],v245,s[8:11],s28 offen offset:0
M a[52:55],a[212:215],a[240:243],a[52:55]
M a[52:55],a[208:211],a[192:195],a[52:55]
M a[52:55],a[228:231],a[252:255],a[52:55]
M a[56:59],a[228:231],a[192:195],a[56:59]
buffer_load_dwordx2 v[196:197],v245,s[8:11],s28 offen offset:384
M a[56:59],a[208:211],a[240:243],a[56:59]
M a[56:59],a[212:215],a[224:227],a[56:59]
M a[60:63],a[212:215],v[220:223],a[60:63]
M a[60:63],a[208:211],a[224:227],a[60:63]
buffer_load_dwordx4 a[212:215],v251,s[20:23],s47 offen offset:1024 sc1
M a[60:63],a[228:231],a[240:243],a[60:63]
s_waitcnt vmcnt(11)
M a[64:67],a[220:223],a[232:235],a[64:67]
s_waitcnt vmcnt(10)
M a[64:67],a[248:251],v[216:219],a[64:67]
s_waitcnt vmcnt(9)
M a[64:67],v[228:231],a[244:247],a[64:67]
buffer_load_dwordx4 a[208:211],v251,s[20:23],s47 offen offset:2048 sc1
M a[68:71],v[228:231],v[224:227],a[68:71]
s_add_u32 s48,s44,245760
M a[68:71],a[248:251],a[244:247],a[68:71]
M a[68:71],a[220:223],v[216:219],a[68:71]
M a[72:75],a[220:223],a[244:247],a[72:75]
buffer_load_dwordx4 a[228:231],v251,s[20:23],s48 offen offset:0 sc1
M a[72:75],a[248:251],v[224:227],a[72:75]
M a[72:75],v[228:231],a[236:239],a[72:75]
M a[76:79],v[228:231],a[252:255],a[76:79]
M a[76:79],a[248:251],a[236:239],a[76:79]
buffer_load_dwordx4 a[232:235],v251,s[20:23],s48 offen offset:1024 sc1
M a[76:79],a[220:223],v[224:227],a[76:79]
M a[80:83],a[220:223],a[236:239],a[80:83]
M a[80:83],a[248:251],a[252:255],a[80:83]
M a[80:83],v[228:231],a[192:195],a[80:83]
buffer_load_dwordx4 v[216:219],v251,s[20:23],s48 offen offset:2048 sc1
M a[84:87],v[228:231],a[240:243],a[84:87]
s_add_u32 s46,s44,248832
ds_read_b128 a[244:247],v249 offset:8704
ds_read_b128 v[224:227],v250 offset:8704
M a[84:87],a[248:251],a[192:195],a[84:87]
ds_read_b128 a[236:239],v249 offset:9216
M a[84:87],a[220:223],a[252:255],a[84:87]
ds_read_b128 a[252:255],v250 offset:9216
M a[88:91],a[220:223],a[192:195],a[88:91]
buffer_load_dwordx4 a[192:195],v251,s[20:23],s46 offen offset:0 sc1
M a[88:91],a[248:251],a[240:243],a[88:91]
M a[88:91],v[228:231],a[224:227],a[88:91]
M a[92:95],v[228:231],v[220:223],a[92:95]
M a[92:95],a[248:251],a[224:227],a[92:95]
ds_read_b128 v[220:223],v249 offset:9728
M a[92:95],a[220:223],a[240:243],a[92:95]
s_waitcnt vmcnt(13) lgkmcnt(4)
ds_read_b128 v[228:231],v250 offset:9728
M a[96:99],a[204:207],a[244:247],a[96:99]
s_waitcnt vmcnt(12) lgkmcnt(4)
M a[96:99],a[200:203],v[224:227],a[96:99]
s_waitcnt vmcnt(11) lgkmcnt(3)
M a[96:99],a[196:199],a[236:239],a[96:99]
s_waitcnt lgkmcnt(2)
M a[100:103],a[196:199],a[252:255],a[100:103]
M a[100:103],a[200:203],a[236:239],a[100:103]
ds_read_b128 a[224:227],v249 offset:10240
M a[100:103],a[204:207],v[224:227],a[100:103]
ds_read_b128 a[248:251],v250 offset:10240
M a[104:107],a[204:207],a[236:239],a[104:107]
M a[104:107],a[200:203],a[252:255],a[104:107]
s_waitcnt lgkmcnt(3)
M a[104:107],a[196:199],v[220:223],a[104:107]
s_waitcnt lgkmcnt(2)
M a[108:111],a[196:199],v[228:231],a[108:111]
M a[108:111],a[200:203],v[220:223],a[108:111]
ds_read_b128 a[220:223],v250 offset:10752
M a[108:111],a[204:207],a[252:255],a[108:111]
ds_read_b128 a[240:243],v249 offset:10752
M a[112:115],a[204:207],v[220:223],a[112:115]
M a[112:115],a[200:203],v[228:231],a[112:115]
s_waitcnt lgkmcnt(3)
M a[112:115],a[196:199],a[224:227],a[112:115]
s_waitcnt lgkmcnt(2)
M a[116:119],a[196:199],a[248:251],a[116:119]
M a[116:119],a[200:203],a[224:227],a[116:119]
M a[116:119],a[204:207],v[228:231],a[116:119]
M a[120:123],a[204:207],a[224:227],a[120:123]
M a[120:123],a[200:203],a[248:251],a[120:123]
s_waitcnt lgkmcnt(1)
M a[120:123],a[196:199],a[220:223],a[120:123]
s_waitcnt lgkmcnt(0)
M a[124:127],a[196:199],a[240:243],a[124:127]
buffer_load_dwordx4 a[196:199],v251,s[20:23],s46 offen offset:1024 sc1
M a[124:127],a[200:203],a[220:223],a[124:127]
M a[124:127],a[204:207],a[248:251],a[124:127]
s_waitcnt vmcnt(11)
buffer_load_dwordx4 a[200:203],v251,s[20:23],s46 offen offset:2048 sc1
M a[128:131],a[216:219],a[244:247],a[128:131]
s_waitcnt vmcnt(7)
s_add_u32 s47,s44,251904
M a[128:131],a[212:215],v[224:227],a[128:131]
s_waitcnt vmcnt(6)
M a[128:131],a[208:211],a[236:239],a[128:131]
M a[132:135],a[208:211],a[252:255],a[132:135]
buffer_load_dwordx4 a[204:207],v251,s[20:23],s47 offen offset:0 sc1
M a[132:135],a[212:215],a[236:239],a[132:135]
M a[132:135],a[216:219],v[224:227],a[132:135]
M a[136:139],a[216:219],a[236:239],a[136:139]
s_barrier
ds_write2st64_b64 v247,v[198:199],v[200:201] offset0:34 offset1:51
M a[136:139],a[212:215],a[252:255],a[136:139]
buffer_load_dwordx2 v[198:199],v245,s[8:11],s28 offen offset:768
M a[136:139],a[208:211],v[220:223],a[136:139]
v_lshlrev_b32 v234,16,v208
v_lshlrev_b32 v232,16,v204
M a[140:143],a[208:211],v[228:231],a[140:143]
v_lshlrev_b32 v233,16,v206
v_lshlrev_b32 v237,16,v214
M a[140:143],a[212:215],v[220:223],a[140:143]
buffer_load_dwordx2 v[200:201],v245,s[8:11],s28 offen offset:1152
M a[140:143],a[216:219],a[252:255],a[140:143]
v_lshlrev_b32 v236,16,v212
v_lshlrev_b32 v235,16,v210
M a[144:147],a[216:219],v[220:223],a[144:147]
v_fmac_f32 v232,s43,v234
v_fmac_f32 v237,4.0,v233
M a[144:147],a[212:215],v[228:231],a[144:147]
v_fma_f32 v238,-4.0,v234,v236
v_fmac_f32 v232,s45,v236
M a[144:147],a[208:211],a[224:227],a[144:147]
v_fmac_f32 v237,s41,v235
v_sub_f32 v236,v236,v234
M a[148:151],a[208:211],a[248:251],a[148:151]
v_fma_f32 v234,-4.0,v233,v235
v_sub_f32 v235,v235,v233
M a[148:151],a[212:215],a[224:227],a[148:151]
v_add_f32 v233,v238,v234
v_sub_f32 v238,v238,v234
M a[148:151],a[216:219],v[228:231],a[148:151]
v_fma_f32 v234,2.0,v235,v236
v_fmac_f32 v236,-2.0,v235
M a[152:155],a[216:219],a[224:227],a[152:155]
v_and_b32 v208,s42,v208
v_and_b32 v204,s42,v204
M a[152:155],a[212:215],a[248:251],a[152:155]
v_and_b32 v206,s42,v206
v_and_b32 v214,s42,v214
M a[152:155],a[208:211],a[220:223],a[152:155]
v_and_b32 v212,s42,v212
v_and_b32 v210,s42,v210
M a[156:159],a[208:211],a[240:243],a[156:159]
buffer_load_dwordx4 a[208:211],v251,s[20:23],s47 offen offset:1024 sc1
M a[156:159],a[212:215],a[220:223],a[156:159]
v_fmac_f32 v204,s43,v208
v_fmac_f32 v214,4.0,v206
M a[156:159],a[216:219],a[248:251],a[156:159]
s_waitcnt vmcnt(9)
buffer_load_dwordx4 a[212:215],v251,s[20:23],s47 offen offset:2048 sc1
M a[160:163],a[228:231],a[244:247],a[160:163]
s_waitcnt vmcnt(9)
s_add_u32 s48,s44,254976
v_fma_f32 v235,-4.0,v208,v212
v_fmac_f32 v204,s45,v212
M a[160:163],a[232:235],v[224:227],a[160:163]
s_waitcnt vmcnt(8)
v_fmac_f32 v214,s41,v210
v_sub_f32 v212,v212,v208
M a[160:163],v[216:219],a[236:239],a[160:163]
v_fma_f32 v208,-4.0,v206,v210
v_sub_f32 v210,v210,v206
M a[164:167],v[216:219],a[252:255],a[164:167]
buffer_load_dwordx4 a[216:219],v251,s[20:23],s48 offen offset:0 sc1
M a[164:167],a[232:235],a[236:239],a[164:167]
v_add_f32 v206,v235,v208
v_sub_f32 v235,v235,v208
M a[164:167],a[228:231],v[224:227],a[164:167]
v_fma_f32 v208,2.0,v210,v212
v_fmac_f32 v212,-2.0,v210
M a[168:171],a[228:231],a[236:239],a[168:171]
v_cvt_pk_bf16_f32 v204,v232,v204
v_cvt_pk_bf16_f32 v214,v237,v214
M a[168:171],a[232:235],a[252:255],a[168:171]
buffer_load_dwordx4 a[244:247],v251,s[20:23],s48 offen offset:1024 sc1
M a[168:171],v[216:219],v[220:223],a[168:171]
v_cvt_pk_bf16_f32 v206,v233,v206
v_cvt_pk_bf16_f32 v210,v234,v208
M a[172:175],v[216:219],v[228:231],a[172:175]
v_cvt_pk_bf16_f32 v208,v238,v235
v_cvt_pk_bf16_f32 v212,v236,v212
M a[172:175],a[232:235],v[220:223],a[172:175]
v_lshlrev_b32 v234,16,v209
v_lshlrev_b32 v232,16,v205
M a[172:175],a[228:231],a[252:255],a[172:175]
buffer_load_dwordx4 v[224:227],v251,s[20:23],s48 offen offset:2048 sc1
M a[176:179],a[228:231],v[220:223],a[176:179]
s_add_u32 s46,s44,258048
v_lshlrev_b32 v233,16,v207
v_lshlrev_b32 v237,16,v215
M a[176:179],a[232:235],v[228:231],a[176:179]
v_lshlrev_b32 v236,16,v213
v_lshlrev_b32 v235,16,v211
M a[176:179],v[216:219],a[224:227],a[176:179]
ds_read_b128 a[236:239],v249 offset:17408
v_fmac_f32 v232,s43,v234
M a[180:183],v[216:219],a[248:251],a[180:183]
ds_read_b128 a[252:255],v250 offset:17408
v_fmac_f32 v237,4.0,v233
M a[180:183],a[232:235],a[224:227],a[180:183]
ds_read_b128 v[220:223],v249 offset:17920
v_fma_f32 v238,-4.0,v234,v236
M a[180:183],a[228:231],v[228:231],a[180:183]
ds_read_b128 v[228:231],v250 offset:17920
v_fmac_f32 v232,s45,v236
M a[184:187],a[228:231],a[224:227],a[184:187]
buffer_load_dwordx4 a[224:227],v251,s[20:23],s46 offen offset:0 sc1
M a[184:187],a[232:235],a[248:251],a[184:187]
v_fmac_f32 v237,s41,v235
v_sub_f32 v236,v236,v234
M a[184:187],v[216:219],a[220:223],a[184:187]
v_fma_f32 v234,-4.0,v233,v235
v_sub_f32 v235,v235,v233
M a[188:191],v[216:219],a[240:243],a[188:191]
v_add_f32 v233,v238,v234
v_sub_f32 v238,v238,v234
M a[188:191],a[232:235],a[220:223],a[188:191]
ds_read_b128 a[240:243],v249 offset:18432
v_fma_f32 v234,2.0,v235,v236
M a[188:191],a[228:231],a[248:251],a[188:191]
s_waitcnt vmcnt(11) lgkmcnt(4)
ds_read_b128 v[216:219],v250 offset:18432
v_fmac_f32 v236,-2.0,v235
M v[0:3],a[192:195],a[236:239],v[0:3]
s_waitcnt vmcnt(10) lgkmcnt(4)
v_and_b32 v209,s42,v209
v_and_b32 v205,s42,v205
M v[0:3],a[196:199],a[252:255],v[0:3]
s_waitcnt vmcnt(9) lgkmcnt(3)
v_and_b32 v207,s42,v207
v_and_b32 v215,s42,v215
M v[0:3],a[200:203],v[220:223],v[0:3]
s_waitcnt lgkmcnt(2)
v_and_b32 v213,s42,v213
v_and_b32 v211,s42,v211
M v[4:7],a[200:203],v[228:231],v[4:7]
v_fmac_f32 v205,s43,v209
v_fmac_f32 v215,4.0,v207
M v[4:7],a[196:199],v[220:223],v[4:7]
ds_read_b128 a[220:223],v249 offset:18944
v_fma_f32 v235,-4.0,v209,v213
M v[4:7],a[192:195],a[252:255],v[4:7]
ds_read_b128 a[232:235],v250 offset:18944
v_fmac_f32 v205,s45,v213
M v[8:11],a[192:195],v[220:223],v[8:11]
v_fmac_f32 v215,s41,v211
v_sub_f32 v213,v213,v209
M v[8:11],a[196:199],v[228:231],v[8:11]
s_waitcnt lgkmcnt(3)
v_fma_f32 v209,-4.0,v207,v211
v_sub_f32 v211,v211,v207
M v[8:11],a[200:203],a[240:243],v[8:11]
s_waitcnt lgkmcnt(2)
v_add_f32 v207,v235,v209
v_sub_f32 v235,v235,v209
M v[12:15],a[200:203],v[216:219],v[12:15]
v_fma_f32 v209,2.0,v211,v213
v_fmac_f32 v213,-2.0,v211
M v[12:15],a[196:199],a[240:243],v[12:15]
ds_read_b128 a[228:231],v250 offset:19456
v_cvt_pk_bf16_f32 v205,v232,v205
M v[12:15],a[192:195],v[228:231],v[12:15]
ds_read_b128 a[248:251],v249 offset:19456
v_cvt_pk_bf16_f32 v215,v237,v215
M v[16:19],a[192:195],a[240:243],v[16:19]
v_cvt_pk_bf16_f32 v207,v233,v207
v_cvt_pk_bf16_f32 v211,v234,v209
M v[16:19],a[196:199],v[216:219],v[16:19]
s_waitcnt lgkmcnt(3)
v_cvt_pk_bf16_f32 v209,v238,v235
v_cvt_pk_bf16_f32 v213,v236,v213
M v[16:19],a[200:203],a[220:223],v[16:19]
s_waitcnt lgkmcnt(2)
ds_write2st64_b64 v247,v[204:205],v[214:215] offset0:137 offset1:154
M v[20:23],a[200:203],a[232:235],v[20:23]
s_add_u32 s28,s30,1179968
buffer_load_dwordx2 v[204:205],v245,s[12:15],s28 offen offset:0
M v[20:23],a[196:199],a[220:223],v[20:23]
ds_write2st64_b64 v247,v[206:207],v[208:209] offset0:103 offset1:120
M v[20:23],a[192:195],v[216:219],v[20:23]
buffer_load_dwordx2 v[214:215],v245,s[16:19],s28 offen offset:1536
M v[24:27],a[192:195],a[220:223],v[24:27]
ds_write2st64_b64 v247,v[210:211],v[212:213] offset0:35 offset1:52
M v[24:27],a[196:199],a[232:235],v[24:27]
s_waitcnt lgkmcnt(4)
v_fmac_f32 v239,s43,v241
v_fmac_f32 v244,4.0,v240
M v[24:27],a[200:203],a[228:231],v[24:27]
s_waitcnt lgkmcnt(3)
buffer_load_dwordx2 v[206:207],v245,s[8:11],s28 offen offset:0
M v[28:31],a[200:203],a[248:251],v[28:31]
v_fma_f32 v232,-4.0,v241,v243
v_fmac_f32 v239,s45,v243
M v[28:31],a[196:199],a[228:231],v[28:31]
v_fmac_f32 v244,s41,v242
v_sub_f32 v243,v243,v241
M v[28:31],a[192:195],a[232:235],v[28:31]
s_waitcnt vmcnt(11)
v_fma_f32 v241,-4.0,v240,v242
v_sub_f32 v242,v242,v240
M v[32:35],a[204:207],a[236:239],v[32:35]
s_waitcnt vmcnt(8)
buffer_load_dwordx2 v[208:209],v245,s[8:11],s28 offen offset:384
M v[32:35],a[208:211],a[252:255],v[32:35]
s_waitcnt vmcnt(8)
v_add_f32 v240,v232,v241
v_sub_f32 v232,v232,v241
M v[32:35],a[212:215],v[220:223],v[32:35]
v_fma_f32 v241,2.0,v242,v243
v_fmac_f32 v243,-2.0,v242
M v[36:39],a[212:215],v[228:231],v[36:39]
v_cvt_pk_bf16_f32 v233,v239,v244
v_cvt_pk_bf16_f32 v234,v240,v232
M v[36:39],a[208:211],v[220:223],v[36:39]
buffer_load_dwordx2 v[210:211],v245,s[8:11],s28 offen offset:768
M v[36:39],a[204:207],a[252:255],v[36:39]
v_cvt_pk_bf16_f32 v235,v241,v243
v_add_u32 v232,69632,v248
M v[40:43],a[204:207],v[220:223],v[40:43]
ds_write_b16 v232,v233 offset:0
M v[40:43],a[208:211],v[228:231],v[40:43]
ds_write_b16_d16_hi v232,v233 offset:8704
M v[40:43],a[212:215],a[240:243],v[40:43]
buffer_load_dwordx2 v[212:213],v245,s[8:11],s28 offen offset:1152
global_load_dword a200,v251,s[64:65]
M v[44:47],a[212:215],v[216:219],v[44:47]
s_add_u32 s29,s30,6291456
buffer_load_dwordx4 a[200:203],v251,s[20:23],s46 offen offset:1024 sc1
M v[44:47],a[208:211],a[240:243],v[44:47]
buffer_load_dwordx4 a[196:199],v251,s[20:23],s46 offen offset:2048 sc1
M v[44:47],a[204:207],v[228:231],v[44:47]
s_add_u32 s47,s44,261120
ds_write_b16 v248,v234 offset:52224
M v[48:51],a[204:207],a[240:243],v[48:51]
ds_write_b16_d16_hi v248,v234 offset:60928
M v[48:51],a[208:211],v[216:219],v[48:51]
ds_write_b16 v248,v235 offset:17408
M v[48:51],a[212:215],a[220:223],v[48:51]
ds_write_b16_d16_hi v248,v235 offset:26112
M v[52:55],a[212:215],a[232:235],v[52:55]
v_lshlrev_b32 v234,16,v196
v_lshlrev_b32 v232,16,v192
M v[52:55],a[208:211],a[220:223],v[52:55]
v_lshlrev_b32 v233,16,v194
v_lshlrev_b32 v237,16,v202
M v[52:55],a[204:207],v[216:219],v[52:55]
v_lshlrev_b32 v236,16,v200
v_lshlrev_b32 v235,16,v198
M v[56:59],a[204:207],a[220:223],v[56:59]
v_fmac_f32 v232,s43,v234
v_fmac_f32 v237,4.0,v233
M v[56:59],a[208:211],a[232:235],v[56:59]
v_fma_f32 v238,-4.0,v234,v236
v_fmac_f32 v232,s45,v236
M v[56:59],a[212:215],a[228:231],v[56:59]
v_fmac_f32 v237,s41,v235
v_sub_f32 v236,v236,v234
M v[60:63],a[212:215],a[248:251],v[60:63]
buffer_load_short_d16_hi v239,v246,s[12:15],s29 offen offset:0
M v[60:63],a[208:211],a[228:231],v[60:63]
v_fma_f32 v234,-4.0,v233,v235
v_sub_f32 v235,v235,v233
M v[60:63],a[204:207],a[232:235],v[60:63]
s_waitcnt vmcnt(13)
buffer_load_short_d16_hi v240,v246,s[8:11],s29 offen offset:0
M v[64:67],a[216:219],a[236:239],v[64:67]
s_waitcnt vmcnt(13)
v_add_f32 v233,v238,v234
v_sub_f32 v238,v238,v234
M v[64:67],a[244:247],a[252:255],v[64:67]
s_waitcnt vmcnt(12)
buffer_load_short_d16_hi v241,v246,s[8:11],s29 offen offset:384
M v[64:67],v[224:227],v[220:223],v[64:67]
v_fma_f32 v234,2.0,v235,v236
v_fmac_f32 v236,-2.0,v235
M v[68:71],v[224:227],v[228:231],v[68:71]
buffer_load_short_d16_hi v242,v246,s[8:11],s29 offen offset:768
M v[68:71],a[244:247],v[220:223],v[68:71]
v_and_b32 v196,s42,v196
v_and_b32 v192,s42,v192
M v[68:71],a[216:219],a[252:255],v[68:71]
buffer_load_short_d16_hi v243,v246,s[8:11],s29 offen offset:1152
M v[72:75],a[216:219],v[220:223],v[72:75]
v_and_b32 v194,s42,v194
v_and_b32 v202,s42,v202
M v[72:75],a[244:247],v[228:231],v[72:75]
buffer_load_short_d16_hi v244,v246,s[16:19],s29 offen offset:1536
M v[72:75],v[224:227],a[240:243],v[72:75]
buffer_load_dwordx4 a[192:195],v251,s[20:23],s47 offen offset:0 sc1
M v[76:79],v[224:227],v[216:219],v[76:79]
buffer_load_dwordx4 a[212:215],v251,s[20:23],s47 offen offset:1024 sc1
M v[76:79],a[244:247],a[240:243],v[76:79]
buffer_load_dwordx4 a[208:211],v251,s[20:23],s47 offen offset:2048 sc1
M v[76:79],a[216:219],v[228:231],v[76:79]
s_add_u32 s48,s44,264192
v_and_b32 v200,s42,v200
v_and_b32 v198,s42,v198
M v[80:83],a[216:219],a[240:243],v[80:83]
v_fmac_f32 v192,s43,v196
v_fmac_f32 v202,4.0,v194
M v[80:83],a[244:247],v[216:219],v[80:83]
v_fma_f32 v235,-4.0,v196,v200
v_fmac_f32 v192,s45,v200
M v[80:83],v[224:227],a[220:223],v[80:83]
ds_read_b128 v[220:223],v249 offset:26112
v_fmac_f32 v202,s41,v198
M v[84:87],v[224:227],a[232:235],v[84:87]
ds_read_b128 v[228:231],v250 offset:26112
v_sub_f32 v200,v200,v196
M v[84:87],a[244:247],a[220:223],v[84:87]
ds_read_b128 a[240:243],v249 offset:26624
v_fma_f32 v196,-4.0,v194,v198
M v[84:87],a[216:219],v[216:219],v[84:87]
ds_read_b128 v[216:219],v250 offset:26624
v_sub_f32 v198,v198,v194
M v[88:91],a[216:219],a[220:223],v[88:91]
v_add_f32 v194,v235,v196
v_sub_f32 v235,v235,v196
M v[88:91],a[244:247],a[232:235],v[88:91]
v_fma_f32 v196,2.0,v198,v200
v_fmac_f32 v200,-2.0,v198
M v[88:91],v[224:227],a[228:231],v[88:91]
v_cvt_pk_bf16_f32 v192,v232,v192
v_cvt_pk_bf16_f32 v202,v237,v202
M v[92:95],v[224:227],a[248:251],v[92:95]
buffer_load_dwordx4 a[204:207],v251,s[20:23],s48 offen offset:0 sc1
M v[92:95],a[244:247],a[228:231],v[92:95]
ds_read_b128 a[248:251],v249 offset:27136
v_cvt_pk_bf16_f32 v194,v233,v194
M v[92:95],a[216:219],a[232:235],v[92:95]
s_waitcnt vmcnt(19) lgkmcnt(4)
ds_read_b128 v[224:227],v250 offset:27136
v_cvt_pk_bf16_f32 v198,v234,v196
M v[96:99],a[224:227],v[220:223],v[96:99]
s_waitcnt vmcnt(11) lgkmcnt(4)
v_cvt_pk_bf16_f32 v196,v238,v235
v_cvt_pk_bf16_f32 v200,v236,v200
M v[96:99],a[200:203],v[228:231],v[96:99]
s_waitcnt vmcnt(10) lgkmcnt(3)
buffer_load_dwordx4 a[236:239],v251,s[20:23],s48 offen offset:1024 sc1
M v[96:99],a[196:199],a[240:243],v[96:99]
s_waitcnt lgkmcnt(2)
v_lshlrev_b32 v234,16,v197
v_lshlrev_b32 v232,16,v193
M v[100:103],a[196:199],v[216:219],v[100:103]
v_lshlrev_b32 v233,16,v195
v_lshlrev_b32 v237,16,v203
M v[100:103],a[200:203],a[240:243],v[100:103]
ds_read_b128 a[228:231],v249 offset:27648
v_lshlrev_b32 v236,16,v201
M v[100:103],a[224:227],v[228:231],v[100:103]
buffer_load_dwordx4 a[252:255],v251,s[20:23],s48 offen offset:2048 sc1
M v[104:107],a[224:227],a[240:243],v[104:107]
s_add_u32 s46,s44,285696
ds_read_b128 a[244:247],v250 offset:27648
v_lshlrev_b32 v235,16,v199
M v[104:107],a[200:203],v[216:219],v[104:107]
s_waitcnt lgkmcnt(3)
v_fmac_f32 v232,s43,v234
v_fmac_f32 v237,4.0,v233
M v[104:107],a[196:199],a[248:251],v[104:107]
s_waitcnt lgkmcnt(2)
v_fma_f32 v238,-4.0,v234,v236
v_fmac_f32 v232,s45,v236
M v[108:111],a[196:199],v[224:227],v[108:111]
buffer_load_dwordx4 a[220:223],v251,s[20:23],s46 offen offset:0 sc1
M v[108:111],a[200:203],a[248:251],v[108:111]
ds_read_b128 a[216:219],v250 offset:28160
v_fmac_f32 v237,s41,v235
M v[108:111],a[224:227],v[216:219],v[108:111]
ds_read_b128 a[232:235],v249 offset:28160
v_sub_f32 v236,v236,v234
M v[112:115],a[224:227],a[248:251],v[112:115]
v_fma_f32 v234,-4.0,v233,v235
v_sub_f32 v235,v235,v233
M v[112:115],a[200:203],v[224:227],v[112:115]
s_waitcnt lgkmcnt(3)
v_add_f32 v233,v238,v234
v_sub_f32 v238,v238,v234
M v[112:115],a[196:199],a[228:231],v[112:115]
s_waitcnt lgkmcnt(2)
v_fma_f32 v234,2.0,v235,v236
v_fmac_f32 v236,-2.0,v235
M v[116:119],a[196:199],a[244:247],v[116:119]
v_and_b32 v197,s42,v197
v_and_b32 v193,s42,v193
M v[116:119],a[200:203],a[228:231],v[116:119]
v_and_b32 v195,s42,v195
v_and_b32 v203,s42,v203
M v[116:119],a[224:227],v[224:227],v[116:119]
v_and_b32 v201,s42,v201
v_and_b32 v199,s42,v199
M v[120:123],a[224:227],a[228:231],v[120:123]
v_fmac_f32 v193,s43,v197
v_fmac_f32 v203,4.0,v195
M v[120:123],a[200:203],a[244:247],v[120:123]
s_waitcnt lgkmcnt(1)
v_fma_f32 v235,-4.0,v197,v201
v_fmac_f32 v193,s45,v201
M v[120:123],a[196:199],a[216:219],v[120:123]
s_waitcnt lgkmcnt(0)
v_fmac_f32 v203,s41,v199
v_sub_f32 v201,v201,v197
M v[124:127],a[196:199],a[232:235],v[124:127]
buffer_load_dwordx4 a[196:199],v251,s[20:23],s46 offen offset:1024 sc1
M v[124:127],a[200:203],a[216:219],v[124:127]
v_fma_f32 v197,-4.0,v195,v199
v_sub_f32 v199,v199,v195
M v[124:127],a[224:227],a[244:247],v[124:127]
s_waitcnt vmcnt(7)
buffer_load_dwordx4 a[200:203],v251,s[20:23],s46 offen offset:2048 sc1
M v[128:131],a[192:195],v[220:223],v[128:131]
s_waitcnt vmcnt(7)
s_add_u32 s46,s44,294912
v_add_f32 v195,v235,v197
v_sub_f32 v235,v235,v197
M v[128:131],a[212:215],v[228:231],v[128:131]
s_waitcnt vmcnt(6)
v_fma_f32 v197,2.0,v199,v201
v_fmac_f32 v201,-2.0,v199
M v[128:131],a[208:211],a[240:243],v[128:131]
v_cvt_pk_bf16_f32 v193,v232,v193
v_cvt_pk_bf16_f32 v203,v237,v203
M v[132:135],a[208:211],v[216:219],v[132:135]
buffer_load_dwordx4 a[224:227],v251,s[20:23],s46 offen offset:0 sc1
M v[132:135],a[212:215],a[240:243],v[132:135]
v_cvt_pk_bf16_f32 v195,v233,v195
v_cvt_pk_bf16_f32 v199,v234,v197
M v[132:135],a[192:195],v[228:231],v[132:135]
v_cvt_pk_bf16_f32 v197,v238,v235
v_cvt_pk_bf16_f32 v201,v236,v201
M v[136:139],a[192:195],a[240:243],v[136:139]
ds_write2st64_b64 v247,v[192:193],v[202:203] offset0:138 offset1:155
M v[136:139],a[212:215],v[216:219],v[136:139]
s_add_u32 s28,s30,6291456
buffer_load_dwordx2 v[192:193],v245,s[12:15],s28 offen offset:0
ds_write2st64_b64 v247,v[194:195],v[196:197] offset0:104 offset1:121
M v[136:139],a[208:211],a[248:251],v[136:139]
ds_write2st64_b64 v247,v[198:199],v[200:201] offset0:36 offset1:53
M v[140:143],a[208:211],v[224:227],v[140:143]
buffer_load_dwordx2 v[202:203],v245,s[16:19],s28 offen offset:1536
M v[140:143],a[212:215],a[248:251],v[140:143]
v_lshlrev_b32 v234,16,v208
v_lshlrev_b32 v232,16,v204
M v[140:143],a[192:195],v[216:219],v[140:143]
v_lshlrev_b32 v233,16,v206
v_lshlrev_b32 v237,16,v214
v_lshlrev_b32 v236,16,v212
M v[144:147],a[192:195],a[248:251],v[144:147]
buffer_load_dwordx2 v[194:195],v245,s[8:11],s28 offen offset:0
v_lshlrev_b32 v235,16,v210
v_fmac_f32 v232,s43,v234
v_fmac_f32 v237,4.0,v233
v_fma_f32 v238,-4.0,v234,v236
M v[144:147],a[212:215],v[224:227],v[144:147]
v_fmac_f32 v232,s45,v236
v_fmac_f32 v237,s41,v235
v_sub_f32 v236,v236,v234
v_fma_f32 v234,-4.0,v233,v235
M v[144:147],a[208:211],a[228:231],v[144:147]
v_sub_f32 v235,v235,v233
v_add_f32 v233,v238,v234
v_sub_f32 v238,v238,v234
v_fma_f32 v234,2.0,v235,v236
M v[148:151],a[208:211],a[244:247],v[148:151]
buffer_load_dwordx2 v[196:197],v245,s[8:11],s28 offen offset:384
v_fmac_f32 v236,-2.0,v235
v_and_b32 v208,s42,v208
v_and_b32 v204,s42,v204
v_and_b32 v206,s42,v206
M v[148:151],a[212:215],a[228:231],v[148:151]
v_and_b32 v214,s42,v214
v_and_b32 v212,s42,v212
v_and_b32 v210,s42,v210
v_fmac_f32 v204,s43,v208
M v[148:151],a[192:195],v[224:227],v[148:151]
buffer_load_dwordx2 v[198:199],v245,s[8:11],s28 offen offset:768
v_fmac_f32 v214,4.0,v206
v_fma_f32 v235,-4.0,v208,v212
v_fmac_f32 v204,s45,v212
v_fmac_f32 v214,s41,v210
M v[152:155],a[192:195],a[228:231],v[152:155]
v_sub_f32 v212,v212,v208
v_fma_f32 v208,-4.0,v206,v210
v_sub_f32 v210,v210,v206
v_add_f32 v206,v235,v208
M v[152:155],a[212:215],a[244:247],v[152:155]
buffer_load_dwordx2 v[200:201],v245,s[8:11],s28 offen offset:1152
v_sub_f32 v235,v235,v208
v_fma_f32 v208,2.0,v210,v212
v_fmac_f32 v212,-2.0,v210
v_cvt_pk_bf16_f32 v204,v232,v204
M v[152:155],a[208:211],a[216:219],v[152:155]
v_cvt_pk_bf16_f32 v214,v237,v214
v_cvt_pk_bf16_f32 v206,v233,v206
v_cvt_pk_bf16_f32 v210,v234,v208
v_cvt_pk_bf16_f32 v208,v238,v235
M v[156:159],a[208:211],a[232:235],v[156:159]
v_cvt_pk_bf16_f32 v212,v236,v212
v_lshlrev_b32 v234,16,v209
v_lshlrev_b32 v232,16,v205
v_lshlrev_b32 v233,16,v207
M v[156:159],a[212:215],a[216:219],v[156:159]
buffer_load_dwordx4 a[208:211],v251,s[20:23],s46 offen offset:1024 sc1
v_lshlrev_b32 v237,16,v215
v_lshlrev_b32 v236,16,v213
v_lshlrev_b32 v235,16,v211
v_fmac_f32 v232,s43,v234
M v[156:159],a[192:195],a[244:247],v[156:159]
s_waitcnt vmcnt(13)
v_fmac_f32 v237,4.0,v233
v_fma_f32 v238,-4.0,v234,v236
v_fmac_f32 v232,s45,v236
v_fmac_f32 v237,s41,v235
M v[160:163],a[204:207],v[220:223],v[160:163]
s_waitcnt vmcnt(12)
buffer_load_dwordx4 a[212:215],v251,s[20:23],s46 offen offset:2048 sc1
v_sub_f32 v236,v236,v234
v_fma_f32 v234,-4.0,v233,v235
v_sub_f32 v235,v235,v233
v_add_f32 v233,v238,v234
M v[160:163],a[236:239],v[228:231],v[160:163]
s_waitcnt vmcnt(12)
s_add_u32 s46,s44,304128
v_sub_f32 v238,v238,v234
v_fma_f32 v234,2.0,v235,v236
v_fmac_f32 v236,-2.0,v235
v_and_b32 v209,s42,v209
M v[160:163],a[252:255],a[240:243],v[160:163]
buffer_load_dwordx4 a[192:195],v251,s[20:23],s46 offen offset:0 sc1
v_and_b32 v205,s42,v205
v_and_b32 v207,s42,v207
v_and_b32 v215,s42,v215
v_and_b32 v213,s42,v213
M v[164:167],a[252:255],v[216:219],v[164:167]
v_and_b32 v211,s42,v211
v_fmac_f32 v205,s43,v209
v_fmac_f32 v215,4.0,v207
v_fma_f32 v235,-4.0,v209,v213
M v[164:167],a[236:239],a[240:243],v[164:167]
v_fmac_f32 v205,s45,v213
v_fmac_f32 v215,s41,v211
v_sub_f32 v213,v213,v209
v_fma_f32 v209,-4.0,v207,v211
M v[164:167],a[204:207],v[228:231],v[164:167]
buffer_load_dwordx4 v[220:223],v251,s[20:23],s46 offen offset:1024 sc1
v_sub_f32 v211,v211,v207
v_add_f32 v207,v235,v209
v_sub_f32 v235,v235,v209
v_fma_f32 v209,2.0,v211,v213
M v[168:171],a[204:207],a[240:243],v[168:171]
v_fmac_f32 v213,-2.0,v211
v_cvt_pk_bf16_f32 v205,v232,v205
v_cvt_pk_bf16_f32 v215,v237,v215
v_cvt_pk_bf16_f32 v207,v233,v207
M v[168:171],a[236:239],v[216:219],v[168:171]
buffer_load_dwordx4 v[228:231],v251,s[20:23],s46 offen offset:2048 sc1
v_cvt_pk_bf16_f32 v211,v234,v209
v_cvt_pk_bf16_f32 v209,v238,v235
v_cvt_pk_bf16_f32 v213,v236,v213
M v[168:171],a[252:255],a[248:251],v[168:171]
ds_write2st64_b64 v247,v[204:205],v[214:215] offset0:139 offset1:156
M v[172:175],a[252:255],v[224:227],v[172:175]
ds_write2st64_b64 v247,v[206:207],v[208:209] offset0:105 offset1:122
M v[172:175],a[236:239],a[248:251],v[172:175]
ds_write2st64_b64 v247,v[210:211],v[212:213] offset0:37 offset1:54
M v[172:175],a[204:207],v[216:219],v[172:175]
M v[176:179],a[204:207],a[248:251],v[176:179]
s_add_u32 s46,s44,313344
M v[176:179],a[236:239],v[224:227],v[176:179]
M v[176:179],a[252:255],a[228:231],v[176:179]
s_waitcnt lgkmcnt(0)
s_barrier
ds_read_b128 a[240:243],v249 offset:34816
M v[180:183],a[252:255],a[244:247],v[180:183]
ds_read_b128 v[216:219],v250 offset:34816
M v[180:183],a[236:239],a[228:231],v[180:183]
ds_read_b128 a[248:251],v249 offset:35328
M v[180:183],a[204:207],v[224:227],v[180:183]
ds_read_b128 v[224:227],v250 offset:35328
M v[184:187],a[204:207],a[228:231],v[184:187]
buffer_load_dwordx4 a[228:231],v251,s[20:23],s46 offen offset:0 sc1
M v[184:187],a[236:239],a[244:247],v[184:187]
M v[184:187],a[252:255],a[216:219],v[184:187]
M v[188:191],a[252:255],a[232:235],v[188:191]
buffer_load_dwordx4 a[232:235],v251,s[20:23],s46 offen offset:1024 sc1
M v[188:191],a[236:239],a[216:219],v[188:191]
ds_read_b128 a[216:219],v249 offset:35840
M v[188:191],a[204:207],a[244:247],v[188:191]
s_waitcnt vmcnt(16) lgkmcnt(4)
ds_read_b128 a[236:239],v250 offset:35840
M a[0:3],a[220:223],a[240:243],a[0:3]
s_waitcnt vmcnt(15) lgkmcnt(4)
buffer_load_dwordx4 a[252:255],v251,s[20:23],s46 offen offset:2048 sc1
M a[0:3],a[196:199],v[216:219],a[0:3]
s_waitcnt vmcnt(10) lgkmcnt(3)
v_lshlrev_b32 v234,16,v196
v_lshlrev_b32 v232,16,v192
M a[0:3],a[200:203],a[248:251],a[0:3]
s_waitcnt lgkmcnt(2)
v_lshlrev_b32 v233,16,v194
v_lshlrev_b32 v237,16,v202
M a[4:7],a[200:203],v[224:227],a[4:7]
s_waitcnt vmcnt(8)
v_lshlrev_b32 v236,16,v200
v_lshlrev_b32 v235,16,v198
M a[4:7],a[196:199],a[248:251],a[4:7]
ds_read_b128 a[204:207],v249 offset:36352
v_fmac_f32 v232,s43,v234
M a[4:7],a[220:223],v[216:219],a[4:7]
ds_read_b128 a[244:247],v250 offset:36352
v_fmac_f32 v237,4.0,v233
M a[8:11],a[220:223],a[248:251],a[8:11]
v_fma_f32 v238,-4.0,v234,v236
v_fmac_f32 v232,s45,v236
M a[8:11],a[196:199],v[224:227],a[8:11]
s_waitcnt lgkmcnt(3)
v_fmac_f32 v237,s41,v235
v_sub_f32 v236,v236,v234
M a[8:11],a[200:203],a[216:219],a[8:11]
s_waitcnt lgkmcnt(2)
v_fma_f32 v234,-4.0,v233,v235
v_sub_f32 v235,v235,v233
M a[12:15],a[200:203],a[236:239],a[12:15]
v_add_f32 v233,v238,v234
v_sub_f32 v238,v238,v234
M a[12:15],a[196:199],a[216:219],a[12:15]
ds_read_b128 a[240:243],v250 offset:36864
v_fma_f32 v234,2.0,v235,v236
M a[12:15],a[220:223],v[224:227],a[12:15]
ds_read_b128 v[216:219],v249 offset:36864
v_fmac_f32 v236,-2.0,v235
M a[16:19],a[220:223],a[216:219],a[16:19]
s_add_u32 s47,s44,288768
v_and_b32 v196,s42,v196
v_and_b32 v192,s42,v192
M a[16:19],a[196:199],a[236:239],a[16:19]
s_waitcnt lgkmcnt(3)
v_and_b32 v194,s42,v194
v_and_b32 v202,s42,v202
M a[16:19],a[200:203],a[204:207],a[16:19]
s_waitcnt lgkmcnt(2)
ds_read_b128 a[248:251],v249 offset:43520
v_and_b32 v200,s42,v200
M a[20:23],a[200:203],a[244:247],a[20:23]
ds_read_b128 v[224:227],v250 offset:43520
v_and_b32 v198,s42,v198
M a[20:23],a[196:199],a[204:207],a[20:23]
ds_read_b128 a[216:219],v249 offset:44032
v_fmac_f32 v192,s43,v196
M a[20:23],a[220:223],a[236:239],a[20:23]
ds_read_b128 a[236:239],v250 offset:44032
v_fmac_f32 v202,4.0,v194
M a[24:27],a[220:223],a[204:207],a[24:27]
buffer_load_dwordx4 a[204:207],v251,s[20:23],s47 offen offset:0 sc1
M a[24:27],a[196:199],a[244:247],a[24:27]
s_waitcnt lgkmcnt(5)
v_fma_f32 v235,-4.0,v196,v200
v_fmac_f32 v192,s45,v200
M a[24:27],a[200:203],a[240:243],a[24:27]
s_waitcnt lgkmcnt(4)
v_fmac_f32 v202,s41,v198
v_sub_f32 v200,v200,v196
M a[28:31],a[200:203],v[216:219],a[28:31]
buffer_load_dwordx4 a[200:203],v251,s[20:23],s47 offen offset:1024 sc1
M a[28:31],a[196:199],a[240:243],a[28:31]
ds_read_b128 a[196:199],v249 offset:44544
v_fma_f32 v196,-4.0,v194,v198
M a[28:31],a[220:223],a[244:247],a[28:31]
s_waitcnt lgkmcnt(4)
ds_read_b128 a[240:243],v250 offset:44544
v_sub_f32 v198,v198,v194
M a[96:99],a[224:227],a[248:251],a[96:99]
s_waitcnt vmcnt(9) lgkmcnt(4)
buffer_load_dwordx4 v[216:219],v251,s[20:23],s47 offen offset:2048 sc1
M a[96:99],a[208:211],v[224:227],a[96:99]
s_waitcnt vmcnt(9) lgkmcnt(3)
v_add_f32 v194,v235,v196
v_sub_f32 v235,v235,v196
M a[96:99],a[212:215],a[216:219],a[96:99]
s_waitcnt lgkmcnt(2)
v_fma_f32 v196,2.0,v198,v200
v_fmac_f32 v200,-2.0,v198
M a[100:103],a[212:215],a[236:239],a[100:103]
v_cvt_pk_bf16_f32 v192,v232,v192
v_cvt_pk_bf16_f32 v202,v237,v202
M a[100:103],a[208:211],a[216:219],a[100:103]
ds_read_b128 a[220:223],v249 offset:45056
v_cvt_pk_bf16_f32 v194,v233,v194
M a[100:103],a[224:227],v[224:227],a[100:103]
ds_read_b128 a[244:247],v250 offset:45056
v_cvt_pk_bf16_f32 v198,v234,v196
M a[104:107],a[224:227],a[216:219],a[104:107]
v_cvt_pk_bf16_f32 v196,v238,v235
v_cvt_pk_bf16_f32 v200,v236,v200
M a[104:107],a[208:211],a[236:239],a[104:107]
s_waitcnt lgkmcnt(3)
v_lshlrev_b32 v234,16,v197
v_lshlrev_b32 v232,16,v193
M a[104:107],a[212:215],a[196:199],a[104:107]
s_waitcnt lgkmcnt(2)
v_lshlrev_b32 v233,16,v195
v_lshlrev_b32 v237,16,v203
M a[108:111],a[212:215],a[240:243],a[108:111]
v_lshlrev_b32 v236,16,v201
v_lshlrev_b32 v235,16,v199
M a[108:111],a[208:211],a[196:199],a[108:111]
ds_read_b128 a[248:251],v250 offset:45568
v_and_b32 v254,32,v245
M a[108:111],a[224:227],a[236:239],a[108:111]
ds_read_b128 v[224:227],v249 offset:45568
v_mul_u32_u24 v254,24,v254
M a[112:115],a[224:227],a[196:199],a[112:115]
v_and_or_b32 v254,v245,s42,v254
v_fmac_f32 v232,s43,v234
M a[112:115],a[208:211],a[240:243],a[112:115]
s_waitcnt lgkmcnt(3)
v_fmac_f32 v237,4.0,v233
v_fma_f32 v238,-4.0,v234,v236
M a[112:115],a[212:215],a[220:223],a[112:115]
s_waitcnt lgkmcnt(2)
s_add_u32 s31,s30,6684672
ds_read_b128 a[216:219],v249 offset:0
v_fmac_f32 v232,s45,v236
M a[116:119],a[212:215],a[244:247],a[116:119]
ds_read_b128 a[236:239],v250 offset:0
v_fmac_f32 v237,s41,v235
M a[116:119],a[208:211],a[220:223],a[116:119]
ds_read_b128 a[196:199],v249 offset:512
v_sub_f32 v236,v236,v234
M a[116:119],a[224:227],a[240:243],a[116:119]
ds_read_b128 a[240:243],v250 offset:512
v_fma_f32 v234,-4.0,v233,v235
M a[120:123],a[224:227],a[220:223],a[120:123]
buffer_load_dword a220,v254,s[8:11],s31 offen offset:0
M a[120:123],a[208:211],a[244:247],a[120:123]
s_waitcnt lgkmcnt(5)
v_sub_f32 v235,v235,v233
v_add_f32 v233,v238,v234
M a[120:123],a[212:215],a[248:251],a[120:123]
s_waitcnt lgkmcnt(4)
v_sub_f32 v238,v238,v234
v_fma_f32 v234,2.0,v235,v236
M a[124:127],a[212:215],v[224:227],a[124:127]
v_fmac_f32 v236,-2.0,v235
v_and_b32 v197,s42,v197
M a[124:127],a[208:211],a[248:251],a[124:127]
buffer_load_dword a220,v254,s[8:11],s31 offen offset:384
M a[124:127],a[224:227],a[244:247],a[124:127]
s_waitcnt vmcnt(10) lgkmcnt(3)
ds_read_b128 a[212:215],v249 offset:1024
ds_read_b128 v[224:227],v250 offset:1024
M v[0:3],a[192:195],a[216:219],v[0:3]
s_waitcnt vmcnt(9) lgkmcnt(4)
v_and_b32 v193,s42,v193
v_and_b32 v195,s42,v195
M v[0:3],v[220:223],a[236:239],v[0:3]
s_waitcnt vmcnt(8) lgkmcnt(3)
v_and_b32 v203,s42,v203
v_and_b32 v201,s42,v201
M v[0:3],v[228:231],a[196:199],v[0:3]
s_waitcnt lgkmcnt(2)
v_and_b32 v199,s42,v199
v_fmac_f32 v193,s43,v197
M v[4:7],v[228:231],a[240:243],v[4:7]
v_fmac_f32 v203,4.0,v195
v_fma_f32 v235,-4.0,v197,v201
M v[4:7],v[220:223],a[196:199],v[4:7]
ds_read_b128 a[208:211],v249 offset:1536
v_fmac_f32 v193,s45,v201
M v[4:7],a[192:195],a[236:239],v[4:7]
ds_read_b128 a[248:251],v250 offset:1536
v_fmac_f32 v203,s41,v199
M v[8:11],a[192:195],a[196:199],v[8:11]
s_add_u32 s48,s44,291840
v_sub_f32 v201,v201,v197
v_fma_f32 v197,-4.0,v195,v199
M v[8:11],v[220:223],a[240:243],v[8:11]
s_waitcnt lgkmcnt(3)
v_sub_f32 v199,v199,v195
v_add_f32 v195,v235,v197
M v[8:11],v[228:231],a[212:215],v[8:11]
s_waitcnt lgkmcnt(2)
v_sub_f32 v235,v235,v197
v_fma_f32 v197,2.0,v199,v201
M v[12:15],v[228:231],v[224:227],v[12:15]
v_fmac_f32 v201,-2.0,v199
v_cvt_pk_bf16_f32 v193,v232,v193
M v[12:15],v[220:223],a[212:215],v[12:15]
ds_read_b128 a[224:227],v250 offset:2048
v_cvt_pk_bf16_f32 v203,v237,v203
M v[12:15],a[192:195],a[240:243],v[12:15]
ds_read_b128 a[244:247],v249 offset:2048
v_cvt_pk_bf16_f32 v195,v233,v195
M v[16:19],a[192:195],a[212:215],v[16:19]
buffer_load_dwordx4 a[220:223],v251,s[20:23],s48 offen offset:0 sc1
M v[16:19],v[220:223],v[224:227],v[16:19]
s_waitcnt lgkmcnt(3)
v_cvt_pk_bf16_f32 v199,v234,v197
v_cvt_pk_bf16_f32 v197,v238,v235
M v[16:19],v[228:231],a[208:211],v[16:19]
s_waitcnt lgkmcnt(2)
buffer_load_dwordx4 a[216:219],v251,s[20:23],s48 offen offset:1024 sc1
M v[20:23],v[228:231],a[248:251],v[20:23]
ds_read_b128 a[196:199],v249 offset:8704
ds_read_b128 a[240:243],v250 offset:8704
M v[20:23],v[220:223],a[208:211],v[20:23]
ds_read_b128 a[212:215],v249 offset:9216
v_cvt_pk_bf16_f32 v201,v236,v201
M v[20:23],a[192:195],v[224:227],v[20:23]
ds_read_b128 v[224:227],v250 offset:9216
M v[24:27],a[192:195],a[208:211],v[24:27]
buffer_load_dwordx4 a[236:239],v251,s[20:23],s48 offen offset:2048 sc1
M v[24:27],v[220:223],a[248:251],v[24:27]
s_waitcnt lgkmcnt(5)
M v[24:27],v[228:231],a[224:227],v[24:27]
s_waitcnt lgkmcnt(4)
M v[28:31],v[228:231],a[244:247],v[28:31]
M v[28:31],v[220:223],a[224:227],v[28:31]
ds_read_b128 a[208:211],v249 offset:9728
M v[28:31],a[192:195],a[248:251],v[28:31]
s_waitcnt vmcnt(10) lgkmcnt(4)
s_add_u32 s47,s44,297984
ds_read_b128 a[244:247],v250 offset:9728
M v[96:99],a[228:231],a[196:199],v[96:99]
s_waitcnt vmcnt(9) lgkmcnt(4)
M v[96:99],a[232:235],a[240:243],v[96:99]
s_waitcnt vmcnt(8) lgkmcnt(3)
M v[96:99],a[252:255],a[212:215],v[96:99]
s_waitcnt lgkmcnt(2)
M v[100:103],a[252:255],v[224:227],v[100:103]
M v[100:103],a[232:235],a[212:215],v[100:103]
ds_read_b128 v[228:231],v249 offset:10240
M v[100:103],a[228:231],a[240:243],v[100:103]
buffer_load_dwordx4 a[224:227],v251,s[20:23],s47 offen offset:0 sc1
M v[104:107],a[228:231],a[212:215],v[104:107]
ds_read_b128 a[248:251],v250 offset:10240
v_accvgpr_read_b32 v238,a0
M v[104:107],a[232:235],v[224:227],v[104:107]
s_waitcnt lgkmcnt(3)
buffer_load_dwordx4 v[220:223],v251,s[20:23],s47 offen offset:1024 sc1
M v[104:107],a[252:255],a[208:211],v[104:107]
s_waitcnt lgkmcnt(2)
v_accvgpr_read_b32 v232,a96
v_add_f32 v234,v238,v232
M v[108:111],a[252:255],a[244:247],v[108:111]
v_sub_f32 v238,v238,v232
v_add_f32 v232,v0,v96
M v[108:111],a[232:235],a[208:211],v[108:111]
ds_read_b128 a[196:199],v250 offset:10752
v_sub_f32 v96,v0,v96
M v[108:111],a[228:231],v[224:227],v[108:111]
buffer_load_dwordx4 a[192:195],v251,s[20:23],s47 offen offset:2048 sc1
M v[112:115],a[228:231],a[208:211],v[112:115]
s_add_u32 s48,s44,301056
ds_read_b128 a[240:243],v249 offset:10752
v_add_f32 v0,v234,v232
M v[112:115],a[232:235],a[244:247],v[112:115]
s_waitcnt lgkmcnt(3)
v_fmac_f32 v234,4.0,v232
v_fma_f32 v232,2.0,v96,v238
M v[112:115],a[252:255],v[228:231],v[112:115]
s_waitcnt lgkmcnt(2)
ds_read_b128 a[212:215],v249 offset:34816
v_fma_f32 v96,s40,v96,v238
M v[116:119],a[252:255],a[248:251],v[116:119]
ds_read_b128 v[224:227],v250 offset:34816
v_accvgpr_read_b32 v238,a1
M v[116:119],a[232:235],v[228:231],v[116:119]
ds_read_b128 a[208:211],v249 offset:35328
v_accvgpr_read_b32 v237,a97
M v[116:119],a[228:231],a[244:247],v[116:119]
ds_read_b128 a[244:247],v250 offset:35328
v_add_f32 v236,v238,v237
M v[120:123],a[228:231],v[228:231],v[120:123]
buffer_load_dwordx4 v[228:231],v251,s[20:23],s48 offen offset:0 sc1
M v[120:123],a[232:235],a[248:251],v[120:123]
s_waitcnt lgkmcnt(5)
v_sub_f32 v238,v238,v237
v_add_f32 v237,v1,v97
M v[120:123],a[252:255],a[196:199],v[120:123]
s_waitcnt lgkmcnt(4)
v_sub_f32 v97,v1,v97
v_add_f32 v1,v236,v237
M v[124:127],a[252:255],a[240:243],v[124:127]
buffer_load_dwordx4 a[240:243],v251,s[20:23],s48 offen offset:1024 sc1
M v[124:127],a[232:235],a[196:199],v[124:127]
ds_read_b128 a[252:255],v249 offset:35840
v_fmac_f32 v236,4.0,v237
M v[124:127],a[228:231],a[248:251],v[124:127]
s_waitcnt vmcnt(12) lgkmcnt(4)
ds_read_b128 a[196:199],v250 offset:35840
v_fma_f32 v237,2.0,v97,v238
M a[32:35],a[204:207],a[212:215],a[32:35]
s_waitcnt vmcnt(11) lgkmcnt(4)
v_fma_f32 v97,s40,v97,v238
v_cvt_pk_bf16_f32 v232,v232,v237
M a[32:35],a[200:203],v[224:227],a[32:35]
s_waitcnt vmcnt(10) lgkmcnt(3)
v_cvt_pk_bf16_f32 v234,v234,v236
v_accvgpr_read_b32 v238,a2
M a[32:35],v[216:219],a[208:211],a[32:35]
s_waitcnt lgkmcnt(2)
v_accvgpr_read_b32 v233,a98
v_add_f32 v235,v238,v233
M a[36:39],v[216:219],a[244:247],a[36:39]
v_sub_f32 v238,v238,v233
v_add_f32 v233,v2,v98
M a[36:39],a[200:203],a[208:211],a[36:39]
ds_read_b128 a[232:235],v249 offset:36352
v_sub_f32 v98,v2,v98
M a[36:39],a[204:207],v[224:227],a[36:39]
ds_read_b128 a[228:231],v250 offset:36352
v_add_f32 v2,v235,v233
M a[40:43],a[204:207],a[208:211],a[40:43]
v_fmac_f32 v235,4.0,v233
v_fma_f32 v233,2.0,v98,v238
M a[40:43],a[200:203],a[244:247],a[40:43]
s_waitcnt lgkmcnt(3)
v_fma_f32 v98,s40,v98,v238
v_accvgpr_read_b32 v238,a3
M a[40:43],v[216:219],a[252:255],a[40:43]
s_waitcnt lgkmcnt(2)
v_accvgpr_read_b32 v237,a99
v_add_f32 v236,v238,v237
M a[44:47],v[216:219],a[196:199],a[44:47]
v_sub_f32 v238,v238,v237
v_add_f32 v237,v3,v99
M a[44:47],a[200:203],a[252:255],a[44:47]
ds_read_b128 a[96:99],v250 offset:36864
v_sub_f32 v99,v3,v99
M a[44:47],a[204:207],a[244:247],a[44:47]
ds_read_b128 a[248:251],v249 offset:36864
v_add_f32 v3,v236,v237
M a[48:51],a[204:207],a[252:255],a[48:51]
v_fmac_f32 v236,4.0,v237
v_fma_f32 v237,2.0,v99,v238
M a[48:51],a[200:203],a[196:199],a[48:51]
s_waitcnt lgkmcnt(3)
v_fma_f32 v99,s40,v99,v238
v_cvt_pk_bf16_f32 v233,v233,v237
M a[48:51],v[216:219],a[232:235],a[48:51]
s_waitcnt lgkmcnt(2)
v_cvt_pk_bf16_f32 v235,v235,v236
M a[52:55],v[216:219],a[228:231],a[52:55]
ds_write2st64_b64 v253,v[232:233],v[234:235] offset0:68 offset1:72
M a[52:55],a[200:203],a[232:235],a[52:55]
v_accvgpr_read_b32 v238,a4
v_accvgpr_read_b32 v232,a100
M a[52:55],a[204:207],a[196:199],a[52:55]
v_add_f32 v234,v238,v232
v_sub_f32 v238,v238,v232
M a[56:59],a[204:207],a[232:235],a[56:59]
v_add_f32 v232,v4,v100
v_sub_f32 v100,v4,v100
M a[56:59],a[200:203],a[228:231],a[56:59]
s_waitcnt lgkmcnt(2)
v_add_f32 v4,v234,v232
v_fmac_f32 v234,4.0,v232
M a[56:59],v[216:219],a[96:99],a[56:59]
s_waitcnt lgkmcnt(1)
v_fma_f32 v232,2.0,v100,v238
v_fma_f32 v100,s40,v100,v238
M a[60:63],v[216:219],a[248:251],a[60:63]
buffer_load_dwordx4 v[216:219],v251,s[20:23],s48 offen offset:2048 sc1
M a[60:63],a[200:203],a[96:99],a[60:63]
s_add_u32 s47,s44,307200
v_accvgpr_read_b32 v238,a5
v_accvgpr_read_b32 v237,a101
M a[60:63],a[204:207],a[228:231],a[60:63]
s_waitcnt vmcnt(8)
buffer_load_dwordx4 a[200:203],v251,s[20:23],s47 offen offset:0 sc1
M a[64:67],a[220:223],a[212:215],a[64:67]
s_waitcnt vmcnt(8)
v_add_f32 v236,v238,v237
v_sub_f32 v238,v238,v237
M a[64:67],a[216:219],v[224:227],a[64:67]
s_waitcnt vmcnt(7)
v_add_f32 v237,v5,v101
v_sub_f32 v101,v5,v101
M a[64:67],a[236:239],a[208:211],a[64:67]
v_add_f32 v5,v236,v237
v_fmac_f32 v236,4.0,v237
M a[68:71],a[236:239],a[244:247],a[68:71]
buffer_load_dwordx4 a[204:207],v251,s[20:23],s47 offen offset:1024 sc1
M a[68:71],a[216:219],a[208:211],a[68:71]
v_fma_f32 v237,2.0,v101,v238
v_fma_f32 v101,s40,v101,v238
M a[68:71],a[220:223],v[224:227],a[68:71]
v_cvt_pk_bf16_f32 v232,v232,v237
v_cvt_pk_bf16_f32 v234,v234,v236
M a[72:75],a[220:223],a[208:211],a[72:75]
v_accvgpr_read_b32 v238,a6
v_accvgpr_read_b32 v233,a102
M a[72:75],a[216:219],a[244:247],a[72:75]
buffer_load_dwordx4 a[212:215],v251,s[20:23],s47 offen offset:2048 sc1
M a[72:75],a[236:239],a[252:255],a[72:75]
s_add_u32 s48,s44,310272
v_add_f32 v235,v238,v233
v_sub_f32 v238,v238,v233
M a[76:79],a[236:239],a[196:199],a[76:79]
v_add_f32 v233,v6,v102
v_sub_f32 v102,v6,v102
M a[76:79],a[216:219],a[252:255],a[76:79]
v_add_f32 v6,v235,v233
v_fmac_f32 v235,4.0,v233
M a[76:79],a[220:223],a[244:247],a[76:79]
buffer_load_dwordx4 v[224:227],v251,s[20:23],s48 offen offset:0 sc1
M a[80:83],a[220:223],a[252:255],a[80:83]
v_fma_f32 v233,2.0,v102,v238
v_fma_f32 v102,s40,v102,v238
M a[80:83],a[216:219],a[196:199],a[80:83]
v_accvgpr_read_b32 v238,a7
v_accvgpr_read_b32 v237,a103
M a[80:83],a[236:239],a[232:235],a[80:83]
ds_read_b128 a[100:103],v249 offset:43520
v_add_f32 v236,v238,v237
M a[84:87],a[236:239],a[228:231],a[84:87]
buffer_load_dwordx4 a[208:211],v251,s[20:23],s48 offen offset:1024 sc1
M a[84:87],a[216:219],a[232:235],a[84:87]
s_add_u32 s31,s30,7077888
ds_read_b128 a[244:247],v250 offset:43520
ds_read_b128 a[252:255],v249 offset:44032
M a[84:87],a[220:223],a[196:199],a[84:87]
ds_read_b128 a[196:199],v250 offset:44032
v_sub_f32 v238,v238,v237
M a[88:91],a[220:223],a[232:235],a[88:91]
v_add_f32 v237,v7,v103
v_sub_f32 v103,v7,v103
M a[88:91],a[216:219],a[228:231],a[88:91]
buffer_load_dword a232,v254,s[8:11],s31 offen offset:0
M a[88:91],a[236:239],a[96:99],a[88:91]
v_add_f32 v7,v236,v237
v_fmac_f32 v236,4.0,v237
M a[92:95],a[236:239],a[248:251],a[92:95]
v_fma_f32 v237,2.0,v103,v238
v_fma_f32 v103,s40,v103,v238
M a[92:95],a[216:219],a[96:99],a[92:95]
ds_read_b128 a[96:99],v249 offset:44544
v_cvt_pk_bf16_f32 v233,v233,v237
M a[92:95],a[220:223],a[228:231],a[92:95]
s_waitcnt vmcnt(11) lgkmcnt(4)
buffer_load_dword a232,v254,s[8:11],s31 offen offset:384
M a[128:131],a[224:227],a[100:103],a[128:131]
s_waitcnt vmcnt(11) lgkmcnt(3)
ds_read_b128 a[236:239],v250 offset:44544
v_cvt_pk_bf16_f32 v235,v235,v236
M a[128:131],v[220:223],a[244:247],a[128:131]
s_waitcnt vmcnt(10) lgkmcnt(3)
ds_write2st64_b64 v253,v[232:233],v[234:235] offset0:76 offset1:80
M a[128:131],a[192:195],a[252:255],a[128:131]
s_waitcnt lgkmcnt(3)
v_accvgpr_read_b32 v238,a8
v_accvgpr_read_b32 v232,a104
M a[132:135],a[192:195],a[196:199],a[132:135]
v_add_f32 v234,v238,v232
v_sub_f32 v238,v238,v232
M a[132:135],v[220:223],a[252:255],a[132:135]
ds_read_b128 a[248:251],v249 offset:45056
v_add_f32 v232,v8,v104
M a[132:135],a[224:227],a[244:247],a[132:135]
ds_read_b128 a[216:219],v250 offset:45056
v_sub_f32 v104,v8,v104
M a[136:139],a[224:227],a[252:255],a[136:139]
s_waitcnt lgkmcnt(2)
s_barrier
ds_read_b128 a[0:3],v251 offset:34816
M a[136:139],v[220:223],a[196:199],a[136:139]
ds_read_b128 a[4:7],v251 offset:38912
v_add_f32 v8,v234,v232
M a[136:139],a[192:195],a[96:99],a[136:139]
v_fmac_f32 v234,4.0,v232
v_fma_f32 v232,2.0,v104,v238
M a[140:143],a[192:195],a[236:239],a[140:143]
v_fma_f32 v104,s40,v104,v238
v_accvgpr_read_b32 v238,a9
M a[140:143],v[220:223],a[96:99],a[140:143]
ds_read_b128 a[220:223],v250 offset:45568
v_accvgpr_read_b32 v237,a105
M a[140:143],a[224:227],a[196:199],a[140:143]
ds_read_b128 a[228:231],v249 offset:45568
v_add_f32 v236,v238,v237
M a[144:147],a[224:227],a[96:99],a[144:147]
v_sub_f32 v238,v238,v237
v_add_f32 v237,v9,v105
M a[144:147],v[220:223],a[236:239],a[144:147]
s_waitcnt lgkmcnt(5)
v_sub_f32 v105,v9,v105
v_add_f32 v9,v236,v237
M a[144:147],a[192:195],a[248:251],a[144:147]
s_waitcnt lgkmcnt(4)
buffer_load_dwordx4 a[232:235],v251,s[20:23],s48 offen offset:2048 sc1
M a[148:151],a[192:195],a[216:219],a[148:151]
v_fmac_f32 v236,4.0,v237
v_fma_f32 v237,2.0,v105,v238
M a[148:151],v[220:223],a[248:251],a[148:151]
v_fma_f32 v105,s40,v105,v238
v_cvt_pk_bf16_f32 v232,v232,v237
M a[148:151],a[224:227],a[236:239],a[148:151]
v_cvt_pk_bf16_f32 v234,v234,v236
v_accvgpr_read_b32 v238,a10
M a[152:155],a[224:227],a[248:251],a[152:155]
v_accvgpr_read_b32 v233,a106
v_add_f32 v235,v238,v233
M a[152:155],v[220:223],a[216:219],a[152:155]
s_waitcnt lgkmcnt(1)
v_sub_f32 v238,v238,v233
v_add_f32 v233,v10,v106
M a[152:155],a[192:195],a[220:223],a[152:155]
s_waitcnt lgkmcnt(0)
v_sub_f32 v106,v10,v106
v_add_f32 v10,v235,v233
M a[156:159],a[192:195],a[228:231],a[156:159]
global_load_dword a192,v251,s[64:65]
M a[156:159],v[220:223],a[220:223],a[156:159]
v_fmac_f32 v235,4.0,v233
v_fma_f32 v233,2.0,v106,v238
M a[156:159],a[224:227],a[216:219],a[156:159]
s_waitcnt vmcnt(11)
s_add_u32 s47,s44,316416
v_fma_f32 v106,s40,v106,v238
v_accvgpr_read_b32 v238,a11
M a[160:163],v[228:231],a[100:103],a[160:163]
s_waitcnt vmcnt(10)
v_accvgpr_read_b32 v237,a107
v_add_f32 v236,v238,v237
M a[160:163],a[240:243],a[244:247],a[160:163]
s_waitcnt vmcnt(9)
v_sub_f32 v238,v238,v237
v_add_f32 v237,v11,v107
M a[160:163],v[216:219],a[252:255],a[160:163]
v_sub_f32 v107,v11,v107
v_add_f32 v11,v236,v237
M a[164:167],v[216:219],a[196:199],a[164:167]
v_fmac_f32 v236,4.0,v237
v_fma_f32 v237,2.0,v107,v238
M a[164:167],a[240:243],a[252:255],a[164:167]
v_fma_f32 v107,s40,v107,v238
v_cvt_pk_bf16_f32 v233,v233,v237
M a[164:167],v[228:231],a[244:247],a[164:167]
buffer_load_dwordx4 a[192:195],v251,s[20:23],s47 offen offset:0 sc1
M a[168:171],v[228:231],a[252:255],a[168:171]
v_cvt_pk_bf16_f32 v235,v235,v236
M a[168:171],a[240:243],a[196:199],a[168:171]
buffer_load_dwordx4 a[100:103],v251,s[20:23],s47 offen offset:1024 sc1
M a[168:171],v[216:219],a[96:99],a[168:171]
ds_write2st64_b64 v253,v[232:233],v[234:235] offset0:85 offset1:89
M a[172:175],v[216:219],a[236:239],a[172:175]
v_accvgpr_read_b32 v204,a12
v_accvgpr_read_b32 v208,a108
M a[172:175],a[240:243],a[96:99],a[172:175]
v_accvgpr_read_b32 v205,a13
v_accvgpr_read_b32 v209,a109
M a[172:175],v[228:231],a[196:199],a[172:175]
buffer_load_dwordx4 a[104:107],v251,s[20:23],s47 offen offset:2048 sc1
M a[176:179],v[228:231],a[96:99],a[176:179]
s_add_u32 s48,s44,319488
v_accvgpr_read_b32 v206,a14
v_accvgpr_read_b32 v210,a110
v_accvgpr_read_b32 v207,a15
v_accvgpr_read_b32 v211,a111
v_pk_add_f32 v[212:213],v[204:205],v[208:209]
v_pk_add_f32 v[214:215],v[206:207],v[210:211]
v_pk_add_f32 v[204:205],v[204:205],v[208:209] neg_lo:[0,1] neg_hi:[0,1]
v_pk_add_f32 v[206:207],v[206:207],v[210:211] neg_lo:[0,1] neg_hi:[0,1]
v_pk_add_f32 v[208:209],v[12:13],v[108:109]
v_pk_add_f32 v[210:211],v[14:15],v[110:111]
v_pk_add_f32 v[108:109],v[12:13],v[108:109] neg_lo:[0,1] neg_hi:[0,1]
v_pk_add_f32 v[110:111],v[14:15],v[110:111] neg_lo:[0,1] neg_hi:[0,1]
v_pk_add_f32 v[12:13],v[212:213],v[208:209]
v_pk_add_f32 v[14:15],v[214:215],v[210:211]
v_pk_fma_f32 v[212:213],v[208:209],4.0,v[212:213] op_sel_hi:[1,0,1]
v_pk_fma_f32 v[214:215],v[210:211],4.0,v[214:215] op_sel_hi:[1,0,1]
v_pk_fma_f32 v[208:209],v[108:109],2.0,v[204:205] op_sel_hi:[1,0,1]
v_pk_fma_f32 v[210:211],v[110:111],2.0,v[206:207] op_sel_hi:[1,0,1]
v_pk_fma_f32 v[108:109],v[108:109],s[40:41],v[204:205] op_sel_hi:[1,0,1]
v_pk_fma_f32 v[110:111],v[110:111],s[40:41],v[206:207] op_sel_hi:[1,0,1]
M a[176:179],a[240:243],a[236:239],a[176:179]
buffer_load_dwordx4 v[220:223],v251,s[20:23],s48 offen offset:0 sc1
M a[176:179],v[216:219],a[248:251],a[176:179]
ds_read_b128 a[96:99],v249 offset:0
v_cvt_pk_bf16_f32 v208,v208,v209
M a[180:183],v[216:219],a[216:219],a[180:183]
buffer_load_dwordx4 a[224:227],v251,s[20:23],s48 offen offset:1024 sc1
M a[180:183],a[240:243],a[248:251],a[180:183]
ds_read_b128 a[108:111],v250 offset:0
ds_read_b128 a[196:199],v249 offset:512
M a[180:183],v[228:231],a[236:239],a[180:183]
ds_read_b128 a[236:239],v250 offset:512
v_cvt_pk_bf16_f32 v209,v210,v211
M a[184:187],v[228:231],a[248:251],a[184:187]
v_cvt_pk_bf16_f32 v212,v212,v213
v_cvt_pk_bf16_f32 v213,v214,v215
M a[184:187],a[240:243],a[216:219],a[184:187]
buffer_load_dwordx4 a[244:247],v251,s[20:23],s48 offen offset:2048 sc1
M a[184:187],v[216:219],a[220:223],a[184:187]
s_add_u32 s46,s44,0
ds_write2st64_b64 v253,v[208:209],v[212:213] offset0:93 offset1:97
M a[188:191],v[216:219],a[228:231],a[188:191]
v_accvgpr_read_b32 v238,a16
v_accvgpr_read_b32 v232,a112
M a[188:191],a[240:243],a[220:223],a[188:191]
ds_read_b128 a[228:231],v249 offset:1024
v_add_f32 v234,v238,v232
M a[188:191],v[228:231],a[216:219],a[188:191]
s_waitcnt vmcnt(14) lgkmcnt(5)
buffer_load_dwordx4 a[252:255],v251,s[20:23],s46 offen offset:0 sc1
M v[32:35],a[200:203],a[96:99],v[32:35]
s_waitcnt vmcnt(14) lgkmcnt(4)
ds_read_b128 v[216:219],v250 offset:1024
v_sub_f32 v238,v238,v232
M v[32:35],a[204:207],a[108:111],v[32:35]
s_waitcnt vmcnt(13) lgkmcnt(4)
v_add_f32 v232,v16,v112
v_sub_f32 v112,v16,v112
M v[32:35],a[212:215],a[196:199],v[32:35]
s_waitcnt lgkmcnt(2)
s_barrier
ds_read_b128 a[8:11],v251 offset:43520
M v[36:39],a[212:215],a[236:239],v[36:39]
ds_read_b128 a[12:15],v251 offset:47616
v_add_f32 v16,v234,v232
M v[36:39],a[204:207],a[196:199],v[36:39]
buffer_load_dwordx4 a[248:251],v251,s[20:23],s46 offen offset:1024 sc1
M v[36:39],a[200:203],a[108:111],v[36:39]
ds_read_b128 a[220:223],v249 offset:1536
ds_read_b128 a[240:243],v250 offset:1536
M v[40:43],a[200:203],a[196:199],v[40:43]
v_fmac_f32 v234,4.0,v232
v_fma_f32 v232,2.0,v112,v238
M v[40:43],a[204:207],a[236:239],v[40:43]
s_waitcnt lgkmcnt(5)
v_fma_f32 v112,s40,v112,v238
v_accvgpr_read_b32 v238,a17
M v[40:43],a[212:215],a[228:231],v[40:43]
s_waitcnt lgkmcnt(4)
v_accvgpr_read_b32 v237,a113
v_add_f32 v236,v238,v237
M v[44:47],a[212:215],v[216:219],v[44:47]
v_sub_f32 v238,v238,v237
v_add_f32 v237,v17,v113
M v[44:47],a[204:207],a[228:231],v[44:47]
ds_read_b128 a[216:219],v250 offset:2048
v_sub_f32 v113,v17,v113
M v[44:47],a[200:203],a[236:239],v[44:47]
ds_read_b128 v[228:231],v249 offset:2048
v_add_f32 v17,v236,v237
M v[48:51],a[200:203],a[228:231],v[48:51]
v_fmac_f32 v236,4.0,v237
v_fma_f32 v237,2.0,v113,v238
M v[48:51],a[204:207],v[216:219],v[48:51]
s_waitcnt lgkmcnt(3)
v_fma_f32 v113,s40,v113,v238
v_cvt_pk_bf16_f32 v232,v232,v237
M v[48:51],a[212:215],a[220:223],v[48:51]
s_waitcnt lgkmcnt(2)
v_cvt_pk_bf16_f32 v234,v234,v236
v_accvgpr_read_b32 v238,a18
M v[52:55],a[212:215],a[240:243],v[52:55]
v_accvgpr_read_b32 v233,a114
v_add_f32 v235,v238,v233
M v[52:55],a[204:207],a[220:223],v[52:55]
v_sub_f32 v238,v238,v233
v_add_f32 v233,v18,v114
M v[52:55],a[200:203],v[216:219],v[52:55]
v_sub_f32 v114,v18,v114
v_add_f32 v18,v235,v233
M v[56:59],a[200:203],a[220:223],v[56:59]
v_fmac_f32 v235,4.0,v233
v_fma_f32 v233,2.0,v114,v238
M v[56:59],a[204:207],a[240:243],v[56:59]
s_waitcnt lgkmcnt(1)
v_fma_f32 v114,s40,v114,v238
v_accvgpr_read_b32 v238,a19
M v[56:59],a[212:215],a[216:219],v[56:59]
s_waitcnt lgkmcnt(0)
v_accvgpr_read_b32 v237,a115
v_add_f32 v236,v238,v237
M v[60:63],a[212:215],v[228:231],v[60:63]
buffer_load_dwordx4 a[212:215],v251,s[20:23],s46 offen offset:2048 sc1
M v[60:63],a[204:207],a[216:219],v[60:63]
s_add_u32 s46,s44,55296
v_sub_f32 v238,v238,v237
v_add_f32 v237,v19,v115
M v[60:63],a[200:203],a[240:243],v[60:63]
s_waitcnt vmcnt(14)
buffer_load_dwordx4 a[112:115],v251,s[20:23],s46 offen offset:0 sc1
M v[64:67],v[224:227],a[96:99],v[64:67]
s_waitcnt vmcnt(14)
v_sub_f32 v115,v19,v115
v_add_f32 v19,v236,v237
M v[64:67],a[208:211],a[108:111],v[64:67]
s_waitcnt vmcnt(11)
v_fmac_f32 v236,4.0,v237
v_fma_f32 v237,2.0,v115,v238
M v[64:67],a[232:235],a[196:199],v[64:67]
v_fma_f32 v115,s40,v115,v238
v_cvt_pk_bf16_f32 v233,v233,v237
M v[68:71],a[232:235],a[236:239],v[68:71]
buffer_load_dwordx4 a[204:207],v251,s[20:23],s46 offen offset:1024 sc1
M v[68:71],a[208:211],a[196:199],v[68:71]
v_cvt_pk_bf16_f32 v235,v235,v236
M v[68:71],v[224:227],a[108:111],v[68:71]
ds_write2st64_b64 v253,v[232:233],v[234:235] offset0:68 offset1:72
M v[72:75],v[224:227],a[196:199],v[72:75]
v_accvgpr_read_b32 v238,a20
v_accvgpr_read_b32 v232,a116
M v[72:75],a[208:211],a[236:239],v[72:75]
buffer_load_dwordx4 a[200:203],v251,s[20:23],s46 offen offset:2048 sc1
M v[72:75],a[232:235],a[228:231],v[72:75]
s_add_u32 s46,s44,110592
v_add_f32 v234,v238,v232
v_sub_f32 v238,v238,v232
M v[76:79],a[232:235],v[216:219],v[76:79]
v_add_f32 v232,v20,v116
v_sub_f32 v116,v20,v116
M v[76:79],a[208:211],a[228:231],v[76:79]
v_add_f32 v20,v234,v232
v_fmac_f32 v234,4.0,v232
M v[76:79],v[224:227],a[236:239],v[76:79]
buffer_load_dwordx4 a[96:99],v251,s[20:23],s46 offen offset:0 sc1
M v[80:83],v[224:227],a[228:231],v[80:83]
s_add_u32 s31,s30,7471104
v_fma_f32 v232,2.0,v116,v238
v_fma_f32 v116,s40,v116,v238
M v[80:83],a[208:211],v[216:219],v[80:83]
v_accvgpr_read_b32 v238,a21
v_accvgpr_read_b32 v237,a117
M v[80:83],a[232:235],a[220:223],v[80:83]
ds_read_b128 a[196:199],v249 offset:8704
v_add_f32 v236,v238,v237
M v[84:87],a[232:235],a[240:243],v[84:87]
buffer_load_dword a108,v254,s[8:11],s31 offen offset:0
M v[84:87],a[208:211],a[220:223],v[84:87]
ds_read_b128 a[236:239],v250 offset:8704
ds_read_b128 a[228:231],v249 offset:9216
M v[84:87],v[224:227],v[216:219],v[84:87]
ds_read_b128 v[216:219],v250 offset:9216
v_sub_f32 v238,v238,v237
M v[88:91],v[224:227],a[220:223],v[88:91]
v_add_f32 v237,v21,v117
v_sub_f32 v117,v21,v117
M v[88:91],a[208:211],a[240:243],v[88:91]
buffer_load_dword a108,v254,s[8:11],s31 offen offset:384
M v[88:91],a[232:235],a[216:219],v[88:91]
v_add_f32 v21,v236,v237
v_fmac_f32 v236,4.0,v237
M v[92:95],a[232:235],v[228:231],v[92:95]
v_fma_f32 v237,2.0,v117,v238
v_fma_f32 v117,s40,v117,v238
M v[92:95],a[208:211],a[216:219],v[92:95]
ds_read_b128 a[220:223],v249 offset:9728
v_cvt_pk_bf16_f32 v232,v232,v237
M v[92:95],v[224:227],a[240:243],v[92:95]
s_waitcnt vmcnt(14) lgkmcnt(4)
ds_read_b128 a[232:235],v250 offset:9728
v_cvt_pk_bf16_f32 v234,v234,v236
M v[128:131],a[192:195],a[196:199],v[128:131]
s_waitcnt vmcnt(13) lgkmcnt(4)
v_accvgpr_read_b32 v238,a22
v_accvgpr_read_b32 v233,a118
M v[128:131],a[100:103],a[236:239],v[128:131]
s_waitcnt vmcnt(12) lgkmcnt(3)
v_add_f32 v235,v238,v233
v_sub_f32 v238,v238,v233
M v[128:131],a[104:107],a[228:231],v[128:131]
s_waitcnt lgkmcnt(2)
v_add_f32 v233,v22,v118
v_sub_f32 v118,v22,v118
M v[132:135],a[104:107],v[216:219],v[132:135]
v_add_f32 v22,v235,v233
v_fmac_f32 v235,4.0,v233
M v[132:135],a[100:103],a[228:231],v[132:135]
ds_read_b128 v[228:231],v249 offset:10240
v_fma_f32 v233,2.0,v118,v238
M v[132:135],a[192:195],a[236:239],v[132:135]
ds_read_b128 a[208:211],v250 offset:10240
v_fma_f32 v118,s40,v118,v238
M v[136:139],a[192:195],a[228:231],v[136:139]
v_accvgpr_read_b32 v238,a23
v_accvgpr_read_b32 v237,a119
M v[136:139],a[100:103],v[216:219],v[136:139]
s_waitcnt lgkmcnt(3)
v_add_f32 v236,v238,v237
v_sub_f32 v238,v238,v237
M v[136:139],a[104:107],a[220:223],v[136:139]
s_waitcnt lgkmcnt(2)
v_add_f32 v237,v23,v119
v_sub_f32 v119,v23,v119
M v[140:143],a[104:107],a[232:235],v[140:143]
v_add_f32 v23,v236,v237
v_fmac_f32 v236,4.0,v237
M v[140:143],a[100:103],a[220:223],v[140:143]
ds_read_b128 a[116:119],v250 offset:10752
v_fma_f32 v237,2.0,v119,v238
M v[140:143],a[192:195],v[216:219],v[140:143]
ds_read_b128 a[216:219],v249 offset:10752
v_fma_f32 v119,s40,v119,v238
M v[144:147],a[192:195],a[220:223],v[144:147]
v_cvt_pk_bf16_f32 v233,v233,v237
v_cvt_pk_bf16_f32 v235,v235,v236
M v[144:147],a[100:103],a[232:235],v[144:147]
s_waitcnt lgkmcnt(3)
ds_write2st64_b64 v253,v[232:233],v[234:235] offset0:76 offset1:80
M v[144:147],a[104:107],v[228:231],v[144:147]
s_waitcnt lgkmcnt(3)
v_accvgpr_read_b32 v238,a24
v_accvgpr_read_b32 v232,a120
M v[148:151],a[104:107],a[208:211],v[148:151]
v_add_f32 v234,v238,v232
v_sub_f32 v238,v238,v232
M v[148:151],a[100:103],v[228:231],v[148:151]
buffer_load_dwordx4 a[108:111],v251,s[20:23],s46 offen offset:1024 sc1
M v[148:151],a[192:195],a[232:235],v[148:151]
v_add_f32 v232,v24,v120
v_sub_f32 v120,v24,v120
M v[152:155],a[192:195],v[228:231],v[152:155]
s_waitcnt lgkmcnt(0)
s_barrier
ds_read_b128 a[16:19],v251 offset:34816
M v[152:155],a[100:103],a[208:211],v[152:155]
ds_read_b128 a[20:23],v251 offset:38912
v_add_f32 v24,v234,v232
M v[152:155],a[104:107],a[116:119],v[152:155]
buffer_load_dwordx4 a[240:243],v251,s[20:23],s46 offen offset:2048 sc1
M v[156:159],a[104:107],a[216:219],v[156:159]
s_add_u32 s46,s44,165888
v_fmac_f32 v234,4.0,v232
v_fma_f32 v232,2.0,v120,v238
M v[156:159],a[100:103],a[116:119],v[156:159]
buffer_load_dwordx4 v[224:227],v251,s[20:23],s46 offen offset:0 sc1
M v[156:159],a[192:195],a[208:211],v[156:159]
s_waitcnt vmcnt(14)
v_fma_f32 v120,s40,v120,v238
v_accvgpr_read_b32 v238,a25
M v[160:163],v[220:223],a[196:199],v[160:163]
s_waitcnt vmcnt(13)
v_accvgpr_read_b32 v237,a121
v_add_f32 v236,v238,v237
M v[160:163],a[224:227],a[236:239],v[160:163]
s_waitcnt vmcnt(12)
v_sub_f32 v238,v238,v237
v_add_f32 v237,v25,v121
M v[160:163],a[244:247],a[228:231],v[160:163]
buffer_load_dwordx4 a[104:107],v251,s[20:23],s46 offen offset:1024 sc1
M v[164:167],a[244:247],v[216:219],v[164:167]
v_sub_f32 v121,v25,v121
v_add_f32 v25,v236,v237
M v[164:167],a[224:227],a[228:231],v[164:167]
v_fmac_f32 v236,4.0,v237
v_fma_f32 v237,2.0,v121,v238
M v[164:167],v[220:223],a[236:239],v[164:167]
v_fma_f32 v121,s40,v121,v238
v_cvt_pk_bf16_f32 v232,v232,v237
M v[168:171],v[220:223],a[228:231],v[168:171]
buffer_load_dwordx4 a[100:103],v251,s[20:23],s46 offen offset:2048 sc1
M v[168:171],a[224:227],v[216:219],v[168:171]
s_add_u32 s46,s44,221184
v_cvt_pk_bf16_f32 v234,v234,v236
v_accvgpr_read_b32 v238,a26
M v[168:171],a[244:247],a[220:223],v[168:171]
s_waitcnt lgkmcnt(0)
s_barrier
v_accvgpr_read_b32 v233,a122
M v[172:175],a[244:247],a[232:235],v[172:175]
v_add_f32 v235,v238,v233
v_sub_f32 v238,v238,v233
M v[172:175],a[224:227],a[220:223],v[172:175]
buffer_load_dwordx4 a[192:195],v251,s[20:23],s46 offen offset:0 sc1
M v[172:175],v[220:223],v[216:219],v[172:175]
v_add_u32 v249,0xffffbc00,v249
v_add_u32 v250,0xffffbc00,v250
M v[176:179],v[220:223],a[220:223],v[176:179]
v_add_f32 v233,v26,v122
v_sub_f32 v122,v26,v122
M v[176:179],a[224:227],a[232:235],v[176:179]
v_add_f32 v26,v235,v233
v_fmac_f32 v235,4.0,v233
M v[176:179],a[244:247],v[228:231],v[176:179]
buffer_load_dwordx4 a[196:199],v251,s[20:23],s46 offen offset:1024 sc1
M v[180:183],a[244:247],a[208:211],v[180:183]
ds_read_b128 a[228:231],v249 offset:0
ds_read_b128 v[216:219],v250 offset:0
M v[180:183],a[224:227],v[228:231],v[180:183]
ds_read_b128 a[220:223],v249 offset:512
v_fma_f32 v233,2.0,v122,v238
M v[180:183],v[220:223],a[232:235],v[180:183]
v_fma_f32 v122,s40,v122,v238
v_accvgpr_read_b32 v238,a27
M v[184:187],v[220:223],v[228:231],v[184:187]
buffer_load_dwordx4 a[236:239],v251,s[20:23],s46 offen offset:2048 sc1
M v[184:187],a[224:227],a[208:211],v[184:187]
s_add_u32 s46,s44,276480
ds_read_b128 v[228:231],v250 offset:512
v_accvgpr_read_b32 v237,a123
M v[184:187],a[244:247],a[116:119],v[184:187]
v_add_f32 v236,v238,v237
v_sub_f32 v238,v238,v237
M v[188:191],a[244:247],a[216:219],v[188:191]
v_add_f32 v237,v27,v123
v_sub_f32 v123,v27,v123
M v[188:191],a[224:227],a[116:119],v[188:191]
buffer_load_dwordx4 a[232:235],v251,s[20:23],s46 offen offset:0 sc1
M v[188:191],v[220:223],a[208:211],v[188:191]
s_waitcnt vmcnt(17) lgkmcnt(3)
ds_read_b128 a[224:227],v249 offset:1024
ds_read_b128 a[208:211],v250 offset:1024
M v[0:3],a[252:255],a[228:231],v[0:3]
s_waitcnt vmcnt(16) lgkmcnt(4)
v_add_f32 v27,v236,v237
v_fmac_f32 v236,4.0,v237
M v[0:3],a[248:251],v[216:219],v[0:3]
s_waitcnt vmcnt(15) lgkmcnt(3)
v_fma_f32 v237,2.0,v123,v238
v_fma_f32 v123,s40,v123,v238
M v[0:3],a[212:215],a[220:223],v[0:3]
s_waitcnt lgkmcnt(2)
buffer_load_dwordx4 a[120:123],v251,s[20:23],s46 offen offset:1024 sc1
M v[4:7],a[212:215],v[228:231],v[4:7]
v_cvt_pk_bf16_f32 v233,v233,v237
v_cvt_pk_bf16_f32 v235,v235,v236
M v[4:7],a[248:251],a[220:223],v[4:7]
ds_read_b128 v[220:223],v249 offset:1536
ds_write2st64_b64 v253,v[232:233],v[234:235] offset0:85 offset1:89
M v[4:7],a[252:255],v[216:219],v[4:7]
buffer_load_dwordx4 a[216:219],v251,s[20:23],s46 offen offset:2048 sc1
M v[8:11],a[252:255],a[220:223],v[8:11]
s_add_u32 s46,s44,46080
ds_read_b128 a[228:231],v250 offset:1536
v_accvgpr_read_b32 v204,a28
M v[8:11],a[248:251],v[228:231],v[8:11]
s_waitcnt lgkmcnt(4)
v_accvgpr_read_b32 v208,a124
v_accvgpr_read_b32 v205,a29
M v[8:11],a[212:215],a[224:227],v[8:11]
s_waitcnt lgkmcnt(3)
v_accvgpr_read_b32 v209,a125
v_accvgpr_read_b32 v206,a30
M v[12:15],a[212:215],a[208:211],v[12:15]
buffer_load_dwordx4 a[244:247],v251,s[20:23],s46 offen offset:0 sc1
M v[12:15],a[248:251],a[224:227],v[12:15]
ds_read_b128 v[216:219],v250 offset:2048
v_accvgpr_read_b32 v210,a126
v_accvgpr_read_b32 v207,a31
v_accvgpr_read_b32 v211,a127
v_pk_add_f32 v[212:213],v[204:205],v[208:209]
v_pk_add_f32 v[214:215],v[206:207],v[210:211]
v_pk_add_f32 v[204:205],v[204:205],v[208:209] neg_lo:[0,1] neg_hi:[0,1]
v_pk_add_f32 v[206:207],v[206:207],v[210:211] neg_lo:[0,1] neg_hi:[0,1]
v_pk_add_f32 v[208:209],v[28:29],v[124:125]
v_pk_add_f32 v[210:211],v[30:31],v[126:127]
v_pk_add_f32 v[124:125],v[28:29],v[124:125] neg_lo:[0,1] neg_hi:[0,1]
v_pk_add_f32 v[126:127],v[30:31],v[126:127] neg_lo:[0,1] neg_hi:[0,1]
v_pk_add_f32 v[28:29],v[212:213],v[208:209]
v_pk_add_f32 v[30:31],v[214:215],v[210:211]
v_pk_fma_f32 v[212:213],v[208:209],4.0,v[212:213] op_sel_hi:[1,0,1]
v_pk_fma_f32 v[214:215],v[210:211],4.0,v[214:215] op_sel_hi:[1,0,1]
v_pk_fma_f32 v[208:209],v[124:125],2.0,v[204:205] op_sel_hi:[1,0,1]
v_pk_fma_f32 v[210:211],v[126:127],2.0,v[206:207] op_sel_hi:[1,0,1]
v_pk_fma_f32 v[124:125],v[124:125],s[40:41],v[204:205] op_sel_hi:[1,0,1]
v_pk_fma_f32 v[126:127],v[126:127],s[40:41],v[206:207] op_sel_hi:[1,0,1]
M v[12:15],a[252:255],v[228:231],v[12:15]
buffer_load_dwordx4 a[116:119],v251,s[20:23],s46 offen offset:1024 sc1
M v[16:19],a[252:255],a[224:227],v[16:19]
ds_read_b128 a[124:127],v249 offset:2048
v_add_u32 v249,0x15400,v249
M v[16:19],a[248:251],a[208:211],v[16:19]
s_waitcnt lgkmcnt(4)
v_add_u32 v250,0x15400,v250
v_cvt_pk_bf16_f32 v208,v208,v209
M v[16:19],a[212:215],v[220:223],v[16:19]
s_waitcnt lgkmcnt(2)
ds_read_b128 a[220:223],v249 offset:0
v_cvt_pk_bf16_f32 v209,v210,v211
M v[20:23],a[212:215],a[228:231],v[20:23]
ds_read_b128 v[228:231],v250 offset:0
v_cvt_pk_bf16_f32 v212,v212,v213
M v[20:23],a[248:251],v[220:223],v[20:23]
ds_read_b128 a[224:227],v249 offset:512
v_cvt_pk_bf16_f32 v213,v214,v215
M v[20:23],a[252:255],a[208:211],v[20:23]
ds_read_b128 a[208:211],v250 offset:512
ds_write2st64_b64 v253,v[208:209],v[212:213] offset0:93 offset1:97
M v[24:27],a[252:255],v[220:223],v[24:27]
buffer_load_dwordx4 v[220:223],v251,s[20:23],s46 offen offset:2048 sc1
M v[24:27],a[248:251],a[228:231],v[24:27]
s_waitcnt lgkmcnt(6)
s_add_u32 s47,s44,49152
v_accvgpr_read_b32 v238,a32
v_accvgpr_read_b32 v232,a128
M v[24:27],a[212:215],v[216:219],v[24:27]
s_waitcnt lgkmcnt(5)
v_add_f32 v234,v238,v232
v_sub_f32 v238,v238,v232
M v[28:31],a[212:215],a[124:127],v[28:31]
buffer_load_dwordx4 a[124:127],v251,s[20:23],s47 offen offset:0 sc1
M v[28:31],a[248:251],v[216:219],v[28:31]
ds_read_b128 a[248:251],v249 offset:1024
v_add_f32 v232,v32,v128
M v[28:31],a[252:255],a[228:231],v[28:31]
s_waitcnt vmcnt(20) lgkmcnt(5)
ds_read_b128 v[216:219],v250 offset:1024
v_sub_f32 v128,v32,v128
M v[0:3],a[112:115],a[220:223],v[0:3]
s_waitcnt vmcnt(19) lgkmcnt(2)
s_barrier
ds_read_b128 a[24:27],v251 offset:43520
M v[0:3],a[204:207],v[228:231],v[0:3]
s_waitcnt vmcnt(18)
ds_read_b128 a[28:31],v251 offset:47616
v_add_f32 v32,v234,v232
M v[0:3],a[200:203],a[224:227],v[0:3]
buffer_load_dwordx4 a[212:215],v251,s[20:23],s47 offen offset:1024 sc1
M v[4:7],a[200:203],a[208:211],v[4:7]
v_fmac_f32 v234,4.0,v232
v_fma_f32 v232,2.0,v128,v238
M v[4:7],a[204:207],a[224:227],v[4:7]
ds_read_b128 a[228:231],v249 offset:1536
v_fma_f32 v128,s40,v128,v238
M v[4:7],a[112:115],v[228:231],v[4:7]
ds_read_b128 a[252:255],v250 offset:1536
v_accvgpr_read_b32 v238,a33
M v[8:11],a[112:115],a[224:227],v[8:11]
v_accvgpr_read_b32 v237,a129
v_add_f32 v236,v238,v237
M v[8:11],a[204:207],a[208:211],v[8:11]
s_waitcnt lgkmcnt(5)
v_sub_f32 v238,v238,v237
v_add_f32 v237,v33,v129
M v[8:11],a[200:203],a[248:251],v[8:11]
s_waitcnt lgkmcnt(4)
s_add_u32 s34,s32,0
buffer_store_dwordx4 a[0:3],v252,s[24:27],s34 offen offset:384 nt
M v[12:15],a[200:203],v[216:219],v[12:15]
v_sub_f32 v129,v33,v129
v_add_f32 v33,v236,v237
M v[12:15],a[204:207],a[248:251],v[12:15]
ds_read_b128 a[220:223],v250 offset:2048
v_fmac_f32 v236,4.0,v237
M v[12:15],a[112:115],a[208:211],v[12:15]
ds_read_b128 v[228:231],v249 offset:2048
v_fma_f32 v237,2.0,v129,v238
M v[16:19],a[112:115],a[248:251],v[16:19]
v_fma_f32 v129,s40,v129,v238
v_cvt_pk_bf16_f32 v232,v232,v237
M v[16:19],a[204:207],v[216:219],v[16:19]
s_waitcnt lgkmcnt(3)
v_cvt_pk_bf16_f32 v234,v234,v236
v_accvgpr_read_b32 v238,a34
M v[16:19],a[200:203],a[228:231],v[16:19]
s_waitcnt lgkmcnt(2)
ds_read_b128 a[224:227],v249 offset:17408
v_accvgpr_read_b32 v233,a130
M v[20:23],a[200:203],a[252:255],v[20:23]
ds_read_b128 a[208:211],v250 offset:17408
v_add_f32 v235,v238,v233
M v[20:23],a[204:207],a[228:231],v[20:23]
ds_read_b128 a[248:251],v249 offset:17920
v_sub_f32 v238,v238,v233
M v[20:23],a[112:115],v[216:219],v[20:23]
ds_read_b128 v[216:219],v250 offset:17920
v_add_f32 v233,v34,v130
M v[24:27],a[112:115],a[228:231],v[24:27]
buffer_load_dwordx4 a[228:231],v251,s[20:23],s47 offen offset:2048 sc1
M v[24:27],a[204:207],a[252:255],v[24:27]
s_waitcnt lgkmcnt(5)
s_add_u32 s46,s44,101376
v_sub_f32 v130,v34,v130
v_add_f32 v34,v235,v233
M v[24:27],a[200:203],a[220:223],v[24:27]
s_waitcnt lgkmcnt(4)
v_fmac_f32 v235,4.0,v233
v_fma_f32 v233,2.0,v130,v238
M v[28:31],a[200:203],v[228:231],v[28:31]
buffer_load_dwordx4 a[200:203],v251,s[20:23],s46 offen offset:0 sc1
M v[28:31],a[204:207],a[220:223],v[28:31]
ds_read_b128 a[220:223],v249 offset:18432
v_fma_f32 v130,s40,v130,v238
M v[28:31],a[112:115],a[252:255],v[28:31]
s_waitcnt vmcnt(21) lgkmcnt(4)
ds_read_b128 a[112:115],v250 offset:18432
v_accvgpr_read_b32 v238,a35
M v[0:3],a[96:99],a[224:227],v[0:3]
s_waitcnt vmcnt(18) lgkmcnt(4)
buffer_load_dwordx4 v[228:231],v251,s[20:23],s46 offen offset:1024 sc1
M v[0:3],a[108:111],a[208:211],v[0:3]
s_waitcnt vmcnt(18) lgkmcnt(3)
v_accvgpr_read_b32 v237,a131
v_add_f32 v236,v238,v237
M v[0:3],a[240:243],a[248:251],v[0:3]
s_waitcnt lgkmcnt(2)
s_add_u32 s34,s32,196608
v_sub_f32 v238,v238,v237
v_add_f32 v237,v35,v131
M v[4:7],a[240:243],v[216:219],v[4:7]
v_sub_f32 v131,v35,v131
v_add_f32 v35,v236,v237
M v[4:7],a[108:111],a[248:251],v[4:7]
buffer_load_dwordx4 a[204:207],v251,s[20:23],s46 offen offset:2048 sc1
M v[4:7],a[96:99],a[208:211],v[4:7]
ds_read_b128 a[128:131],v249 offset:18944
ds_read_b128 a[252:255],v250 offset:18944
M v[8:11],a[96:99],a[248:251],v[8:11]
v_fmac_f32 v236,4.0,v237
v_fma_f32 v237,2.0,v131,v238
M v[8:11],a[108:111],v[216:219],v[8:11]
s_waitcnt lgkmcnt(3)
v_fma_f32 v131,s40,v131,v238
v_cvt_pk_bf16_f32 v233,v233,v237
M v[8:11],a[240:243],a[220:223],v[8:11]
s_waitcnt lgkmcnt(2)
buffer_store_dwordx4 a[4:7],v252,s[24:27],s34 offen offset:384 nt
M v[12:15],a[240:243],a[112:115],v[12:15]
v_cvt_pk_bf16_f32 v235,v235,v236
M v[12:15],a[108:111],a[220:223],v[12:15]
ds_read_b128 a[224:227],v250 offset:19456
ds_write2st64_b64 v253,v[232:233],v[234:235] offset0:34 offset1:38
M v[12:15],a[96:99],v[216:219],v[12:15]
ds_read_b128 a[208:211],v249 offset:19456
v_accvgpr_read_b32 v204,a36
M v[16:19],a[96:99],a[220:223],v[16:19]
s_add_u32 s47,s44,104448
v_accvgpr_read_b32 v208,a132
v_accvgpr_read_b32 v205,a37
M v[16:19],a[108:111],a[112:115],v[16:19]
s_waitcnt lgkmcnt(4)
v_accvgpr_read_b32 v209,a133
v_accvgpr_read_b32 v206,a38
M v[16:19],a[240:243],a[128:131],v[16:19]
s_waitcnt lgkmcnt(3)
ds_read_b128 a[248:251],v249 offset:34816
v_accvgpr_read_b32 v210,a134
v_accvgpr_read_b32 v207,a39
v_accvgpr_read_b32 v211,a135
v_pk_add_f32 v[212:213],v[204:205],v[208:209]
v_pk_add_f32 v[214:215],v[206:207],v[210:211]
v_pk_add_f32 v[204:205],v[204:205],v[208:209] neg_lo:[0,1] neg_hi:[0,1]
v_pk_add_f32 v[206:207],v[206:207],v[210:211] neg_lo:[0,1] neg_hi:[0,1]
v_pk_add_f32 v[208:209],v[36:37],v[132:133]
v_pk_add_f32 v[210:211],v[38:39],v[134:135]
v_pk_add_f32 v[132:133],v[36:37],v[132:133] neg_lo:[0,1] neg_hi:[0,1]
v_pk_add_f32 v[134:135],v[38:39],v[134:135] neg_lo:[0,1] neg_hi:[0,1]
v_pk_add_f32 v[36:37],v[212:213],v[208:209]
v_pk_add_f32 v[38:39],v[214:215],v[210:211]
v_pk_fma_f32 v[212:213],v[208:209],4.0,v[212:213] op_sel_hi:[1,0,1]
v_pk_fma_f32 v[214:215],v[210:211],4.0,v[214:215] op_sel_hi:[1,0,1]
v_pk_fma_f32 v[208:209],v[132:133],2.0,v[204:205] op_sel_hi:[1,0,1]
v_pk_fma_f32 v[210:211],v[134:135],2.0,v[206:207] op_sel_hi:[1,0,1]
v_pk_fma_f32 v[132:133],v[132:133],s[40:41],v[204:205] op_sel_hi:[1,0,1]
v_pk_fma_f32 v[134:135],v[134:135],s[40:41],v[206:207] op_sel_hi:[1,0,1]
M v[20:23],a[240:243],a[252:255],v[20:23]
ds_read_b128 a[132:135],v250 offset:34816
v_cvt_pk_bf16_f32 v208,v208,v209
M v[20:23],a[108:111],a[128:131],v[20:23]
ds_read_b128 v[216:219],v249 offset:35328
v_cvt_pk_bf16_f32 v209,v210,v211
M v[20:23],a[96:99],a[112:115],v[20:23]
ds_read_b128 a[112:115],v250 offset:35328
v_cvt_pk_bf16_f32 v212,v212,v213
M v[24:27],a[96:99],a[128:131],v[24:27]
buffer_load_dwordx4 a[128:131],v251,s[20:23],s47 offen offset:0 sc1
M v[24:27],a[108:111],a[252:255],v[24:27]
s_waitcnt lgkmcnt(6)
v_cvt_pk_bf16_f32 v213,v214,v215
M v[24:27],a[240:243],a[224:227],v[24:27]
s_waitcnt lgkmcnt(4)
s_add_u32 s34,s32,393216
buffer_load_dwordx4 a[220:223],v251,s[20:23],s47 offen offset:1024 sc1
M v[28:31],a[240:243],a[208:211],v[28:31]
ds_write2st64_b64 v253,v[208:209],v[212:213] offset0:42 offset1:46
M v[28:31],a[108:111],a[224:227],v[28:31]
ds_read_b128 a[108:111],v249 offset:35840
v_accvgpr_read_b32 v204,a40
M v[28:31],a[96:99],a[252:255],v[28:31]
s_waitcnt vmcnt(21) lgkmcnt(5)
ds_read_b128 a[96:99],v250 offset:35840
v_accvgpr_read_b32 v208,a136
M v[0:3],v[224:227],a[248:251],v[0:3]
s_waitcnt vmcnt(20) lgkmcnt(5)
buffer_store_dwordx4 a[8:11],v252,s[24:27],s34 offen offset:384 nt
M v[0:3],a[104:107],a[132:135],v[0:3]
s_waitcnt vmcnt(20) lgkmcnt(4)
v_accvgpr_read_b32 v205,a41
v_accvgpr_read_b32 v209,a137
M v[0:3],a[100:103],v[216:219],v[0:3]
s_waitcnt lgkmcnt(3)
v_accvgpr_read_b32 v206,a42
v_accvgpr_read_b32 v210,a138
v_accvgpr_read_b32 v207,a43
v_accvgpr_read_b32 v211,a139
v_pk_add_f32 v[212:213],v[204:205],v[208:209]
v_pk_add_f32 v[214:215],v[206:207],v[210:211]
v_pk_add_f32 v[204:205],v[204:205],v[208:209] neg_lo:[0,1] neg_hi:[0,1]
v_pk_add_f32 v[206:207],v[206:207],v[210:211] neg_lo:[0,1] neg_hi:[0,1]
v_pk_add_f32 v[208:209],v[40:41],v[136:137]
v_pk_add_f32 v[210:211],v[42:43],v[138:139]
v_pk_add_f32 v[136:137],v[40:41],v[136:137] neg_lo:[0,1] neg_hi:[0,1]
v_pk_add_f32 v[138:139],v[42:43],v[138:139] neg_lo:[0,1] neg_hi:[0,1]
v_pk_add_f32 v[40:41],v[212:213],v[208:209]
v_pk_add_f32 v[42:43],v[214:215],v[210:211]
v_pk_fma_f32 v[212:213],v[208:209],4.0,v[212:213] op_sel_hi:[1,0,1]
v_pk_fma_f32 v[214:215],v[210:211],4.0,v[214:215] op_sel_hi:[1,0,1]
v_pk_fma_f32 v[208:209],v[136:137],2.0,v[204:205] op_sel_hi:[1,0,1]
v_pk_fma_f32 v[210:211],v[138:139],2.0,v[206:207] op_sel_hi:[1,0,1]
v_pk_fma_f32 v[136:137],v[136:137],s[40:41],v[204:205] op_sel_hi:[1,0,1]
v_pk_fma_f32 v[138:139],v[138:139],s[40:41],v[206:207] op_sel_hi:[1,0,1]
M v[4:7],a[100:103],a[112:115],v[4:7]
buffer_load_dwordx4 a[208:211],v251,s[20:23],s47 offen offset:2048 sc1
M v[4:7],a[104:107],v[216:219],v[4:7]
ds_read_b128 a[136:139],v249 offset:36352
v_cvt_pk_bf16_f32 v208,v208,v209
M v[4:7],v[224:227],a[132:135],v[4:7]
ds_read_b128 a[132:135],v250 offset:36352
v_cvt_pk_bf16_f32 v209,v210,v211
M v[8:11],v[224:227],v[216:219],v[8:11]
v_cvt_pk_bf16_f32 v212,v212,v213
v_cvt_pk_bf16_f32 v213,v214,v215
M v[8:11],a[104:107],a[112:115],v[8:11]
s_waitcnt lgkmcnt(3)
ds_write2st64_b64 v253,v[208:209],v[212:213] offset0:51 offset1:55
M v[8:11],a[100:103],a[108:111],v[8:11]
s_waitcnt lgkmcnt(3)
v_accvgpr_read_b32 v204,a44
v_accvgpr_read_b32 v208,a140
M v[12:15],a[100:103],a[96:99],v[12:15]
v_accvgpr_read_b32 v205,a45
v_accvgpr_read_b32 v209,a141
M v[12:15],a[104:107],a[108:111],v[12:15]
ds_read_b128 a[240:243],v250 offset:36864
v_accvgpr_read_b32 v206,a46
M v[12:15],v[224:227],a[112:115],v[12:15]
ds_read_b128 a[112:115],v249 offset:36864
v_accvgpr_read_b32 v210,a142
v_accvgpr_read_b32 v207,a47
v_accvgpr_read_b32 v211,a143
v_pk_add_f32 v[212:213],v[204:205],v[208:209]
v_pk_add_f32 v[214:215],v[206:207],v[210:211]
v_pk_add_f32 v[204:205],v[204:205],v[208:209] neg_lo:[0,1] neg_hi:[0,1]
v_pk_add_f32 v[206:207],v[206:207],v[210:211] neg_lo:[0,1] neg_hi:[0,1]
v_pk_add_f32 v[208:209],v[44:45],v[140:141]
v_pk_add_f32 v[210:211],v[46:47],v[142:143]
v_pk_add_f32 v[140:141],v[44:45],v[140:141] neg_lo:[0,1] neg_hi:[0,1]
v_pk_add_f32 v[142:143],v[46:47],v[142:143] neg_lo:[0,1] neg_hi:[0,1]
v_pk_add_f32 v[44:45],v[212:213],v[208:209]
v_pk_add_f32 v[46:47],v[214:215],v[210:211]
v_pk_fma_f32 v[212:213],v[208:209],4.0,v[212:213] op_sel_hi:[1,0,1]
v_pk_fma_f32 v[214:215],v[210:211],4.0,v[214:215] op_sel_hi:[1,0,1]
v_pk_fma_f32 v[208:209],v[140:141],2.0,v[204:205] op_sel_hi:[1,0,1]
v_pk_fma_f32 v[210:211],v[142:143],2.0,v[206:207] op_sel_hi:[1,0,1]
v_pk_fma_f32 v[140:141],v[140:141],s[40:41],v[204:205] op_sel_hi:[1,0,1]
v_pk_fma_f32 v[142:143],v[142:143],s[40:41],v[206:207] op_sel_hi:[1,0,1]
M v[16:19],v[224:227],a[108:111],v[16:19]
s_add_u32 s46,s44,156672
v_cvt_pk_bf16_f32 v208,v208,v209
v_cvt_pk_bf16_f32 v209,v210,v211
M v[16:19],a[104:107],a[96:99],v[16:19]
s_waitcnt lgkmcnt(4)
v_cvt_pk_bf16_f32 v212,v212,v213
v_cvt_pk_bf16_f32 v213,v214,v215
M v[16:19],a[100:103],a[136:139],v[16:19]
s_waitcnt lgkmcnt(3)
s_add_u32 s34,s32,589824
buffer_store_dwordx4 a[12:15],v252,s[24:27],s34 offen offset:384 nt
M v[20:23],a[100:103],a[132:135],v[20:23]
ds_read_b128 a[108:111],v249 offset:52224
ds_read_b128 a[140:143],v250 offset:52224
M v[20:23],a[104:107],a[136:139],v[20:23]
ds_read_b128 a[224:227],v249 offset:52736
ds_write2st64_b64 v253,v[208:209],v[212:213] offset0:59 offset1:63
M v[20:23],v[224:227],a[96:99],v[20:23]
ds_read_b128 a[96:99],v250 offset:52736
v_accvgpr_read_b32 v238,a48
M v[24:27],v[224:227],a[136:139],v[24:27]
buffer_load_dwordx4 a[136:139],v251,s[20:23],s46 offen offset:0 sc1
M v[24:27],a[104:107],a[132:135],v[24:27]
s_waitcnt lgkmcnt(6)
v_accvgpr_read_b32 v232,a144
v_add_f32 v234,v238,v232
M v[24:27],a[100:103],a[240:243],v[24:27]
s_waitcnt lgkmcnt(5)
buffer_load_dwordx4 a[252:255],v251,s[20:23],s46 offen offset:1024 sc1
M v[28:31],a[100:103],a[112:115],v[28:31]
v_sub_f32 v238,v238,v232
v_add_f32 v232,v48,v144
M v[28:31],a[104:107],a[240:243],v[28:31]
ds_read_b128 a[100:103],v249 offset:53248
v_sub_f32 v144,v48,v144
M v[28:31],v[224:227],a[132:135],v[28:31]
s_waitcnt vmcnt(23) lgkmcnt(2)
s_barrier
ds_read_b128 a[32:35],v251 offset:17408
M v[0:3],a[192:195],a[108:111],v[0:3]
s_waitcnt vmcnt(22)
ds_read_b128 a[36:39],v251 offset:21504
ds_read_b128 a[40:43],v251 offset:26112
M v[0:3],a[196:199],a[140:143],v[0:3]
s_waitcnt vmcnt(21)
ds_read_b128 a[44:47],v251 offset:30208
ds_read_b128 a[104:107],v250 offset:53248
M v[0:3],a[236:239],a[224:227],v[0:3]
s_waitcnt lgkmcnt(6)
buffer_load_dwordx4 a[248:251],v251,s[20:23],s46 offen offset:2048 sc1
M v[4:7],a[236:239],a[96:99],v[4:7]
v_add_f32 v48,v234,v232
v_fmac_f32 v234,4.0,v232
M v[4:7],a[196:199],a[224:227],v[4:7]
ds_read_b128 a[108:111],v249 offset:53760
v_fma_f32 v232,2.0,v144,v238
M v[4:7],a[192:195],a[140:143],v[4:7]
ds_read_b128 a[112:115],v250 offset:53760
v_fma_f32 v144,s40,v144,v238
M v[8:11],a[192:195],a[224:227],v[8:11]
v_accvgpr_read_b32 v238,a49
v_accvgpr_read_b32 v237,a145
M v[8:11],a[196:199],a[96:99],v[8:11]
s_waitcnt lgkmcnt(7)
v_add_f32 v236,v238,v237
v_sub_f32 v238,v238,v237
M v[8:11],a[236:239],a[100:103],v[8:11]
s_waitcnt lgkmcnt(2)
s_add_u32 s34,s32,786432
buffer_store_dwordx4 a[16:19],v252,s[24:27],s34 offen offset:384 nt
M v[12:15],a[236:239],a[104:107],v[12:15]
v_add_f32 v237,v49,v145
v_sub_f32 v145,v49,v145
M v[12:15],a[196:199],a[100:103],v[12:15]
ds_read_b128 a[132:135],v250 offset:54272
v_add_f32 v49,v236,v237
M v[12:15],a[192:195],a[96:99],v[12:15]
ds_read_b128 a[96:99],v249 offset:54272
v_add_u32 v249,0xfffece00,v249
M v[16:19],a[192:195],a[100:103],v[16:19]
s_add_u32 s47,s44,159744
v_add_u32 v250,0xfffece00,v250
v_fmac_f32 v236,4.0,v237
M v[16:19],a[196:199],a[104:107],v[16:19]
s_waitcnt lgkmcnt(3)
v_fma_f32 v237,2.0,v145,v238
v_fma_f32 v145,s40,v145,v238
M v[16:19],a[236:239],a[108:111],v[16:19]
s_waitcnt lgkmcnt(2)
ds_read_b128 a[100:103],v249 offset:60928
v_cvt_pk_bf16_f32 v232,v232,v237
M v[20:23],a[236:239],a[112:115],v[20:23]
ds_read_b128 a[140:143],v250 offset:60928
v_cvt_pk_bf16_f32 v234,v234,v236
M v[20:23],a[196:199],a[108:111],v[20:23]
ds_read_b128 v[216:219],v249 offset:61440
v_accvgpr_read_b32 v238,a50
M v[20:23],a[192:195],a[104:107],v[20:23]
ds_read_b128 a[104:107],v250 offset:61440
v_accvgpr_read_b32 v233,a146
M v[24:27],a[192:195],a[108:111],v[24:27]
buffer_load_dwordx4 a[108:111],v251,s[20:23],s47 offen offset:0 sc1
M v[24:27],a[196:199],a[112:115],v[24:27]
s_waitcnt lgkmcnt(5)
v_add_f32 v235,v238,v233
v_sub_f32 v238,v238,v233
M v[24:27],a[236:239],a[132:135],v[24:27]
s_waitcnt lgkmcnt(4)
buffer_load_dwordx4 a[240:243],v251,s[20:23],s47 offen offset:1024 sc1
M v[28:31],a[236:239],a[96:99],v[28:31]
v_add_f32 v233,v50,v146
v_sub_f32 v146,v50,v146
M v[28:31],a[196:199],a[132:135],v[28:31]
ds_read_b128 a[96:99],v249 offset:61952
v_add_f32 v50,v235,v233
M v[28:31],a[192:195],a[112:115],v[28:31]
s_waitcnt vmcnt(24) lgkmcnt(4)
ds_read_b128 a[112:115],v250 offset:61952
v_fmac_f32 v235,4.0,v233
M v[0:3],a[232:235],a[100:103],v[0:3]
s_waitcnt vmcnt(23) lgkmcnt(4)
buffer_load_dwordx4 v[224:227],v251,s[20:23],s47 offen offset:2048 sc1
M v[0:3],a[120:123],a[140:143],v[0:3]
s_waitcnt vmcnt(23) lgkmcnt(3)
v_fma_f32 v233,2.0,v146,v238
v_fma_f32 v146,s40,v146,v238
M v[0:3],a[216:219],v[216:219],v[0:3]
s_waitcnt lgkmcnt(2)
s_add_u32 s34,s32,983040
v_accvgpr_read_b32 v238,a51
v_accvgpr_read_b32 v237,a147
M v[4:7],a[216:219],a[104:107],v[4:7]
v_add_f32 v236,v238,v237
v_sub_f32 v238,v238,v237
M v[4:7],a[120:123],v[216:219],v[4:7]
buffer_store_dwordx4 a[20:23],v252,s[24:27],s34 offen offset:384 nt
M v[4:7],a[232:235],a[140:143],v[4:7]
ds_read_b128 a[100:103],v249 offset:62464
ds_read_b128 a[132:135],v250 offset:62464
M v[8:11],a[232:235],v[216:219],v[8:11]
v_add_f32 v237,v51,v147
v_sub_f32 v147,v51,v147
M v[8:11],a[120:123],a[104:107],v[8:11]
s_waitcnt lgkmcnt(3)
v_add_f32 v51,v236,v237
v_fmac_f32 v236,4.0,v237
M v[8:11],a[216:219],a[96:99],v[8:11]
s_waitcnt lgkmcnt(2)
v_fma_f32 v237,2.0,v147,v238
v_fma_f32 v147,s40,v147,v238
M v[12:15],a[216:219],a[112:115],v[12:15]
v_cvt_pk_bf16_f32 v233,v233,v237
v_cvt_pk_bf16_f32 v235,v235,v236
M v[12:15],a[120:123],a[96:99],v[12:15]
ds_read_b128 a[140:143],v250 offset:62976
ds_write2st64_b64 v253,v[232:233],v[234:235] offset0:119 offset1:123
M v[12:15],a[232:235],a[104:107],v[12:15]
ds_read_b128 a[104:107],v249 offset:62976
v_accvgpr_read_b32 v204,a52
M v[16:19],a[232:235],a[96:99],v[16:19]
s_add_u32 s46,s44,211968
v_accvgpr_read_b32 v208,a148
v_accvgpr_read_b32 v205,a53
M v[16:19],a[120:123],a[112:115],v[16:19]
s_waitcnt lgkmcnt(4)
v_accvgpr_read_b32 v209,a149
v_accvgpr_read_b32 v206,a54
M v[16:19],a[216:219],a[100:103],v[16:19]
s_waitcnt lgkmcnt(3)
ds_read_b128 a[96:99],v249 offset:0
v_accvgpr_read_b32 v210,a150
v_accvgpr_read_b32 v207,a55
v_accvgpr_read_b32 v211,a151
v_pk_add_f32 v[212:213],v[204:205],v[208:209]
v_pk_add_f32 v[214:215],v[206:207],v[210:211]
v_pk_add_f32 v[204:205],v[204:205],v[208:209] neg_lo:[0,1] neg_hi:[0,1]
v_pk_add_f32 v[206:207],v[206:207],v[210:211] neg_lo:[0,1] neg_hi:[0,1]
v_pk_add_f32 v[208:209],v[52:53],v[148:149]
v_pk_add_f32 v[210:211],v[54:55],v[150:151]
v_pk_add_f32 v[148:149],v[52:53],v[148:149] neg_lo:[0,1] neg_hi:[0,1]
v_pk_add_f32 v[150:151],v[54:55],v[150:151] neg_lo:[0,1] neg_hi:[0,1]
v_pk_add_f32 v[52:53],v[212:213],v[208:209]
v_pk_add_f32 v[54:55],v[214:215],v[210:211]
v_pk_fma_f32 v[212:213],v[208:209],4.0,v[212:213] op_sel_hi:[1,0,1]
v_pk_fma_f32 v[214:215],v[210:211],4.0,v[214:215] op_sel_hi:[1,0,1]
v_pk_fma_f32 v[208:209],v[148:149],2.0,v[204:205] op_sel_hi:[1,0,1]
v_pk_fma_f32 v[210:211],v[150:151],2.0,v[206:207] op_sel_hi:[1,0,1]
v_pk_fma_f32 v[148:149],v[148:149],s[40:41],v[204:205] op_sel_hi:[1,0,1]
v_pk_fma_f32 v[150:151],v[150:151],s[40:41],v[206:207] op_sel_hi:[1,0,1]
M v[20:23],a[216:219],a[132:135],v[20:23]
ds_read_b128 a[144:147],v250 offset:0
v_cvt_pk_bf16_f32 v208,v208,v209
M v[20:23],a[120:123],a[100:103],v[20:23]
ds_read_b128 a[148:151],v249 offset:512
v_cvt_pk_bf16_f32 v209,v210,v211
M v[20:23],a[232:235],a[112:115],v[20:23]
ds_read_b128 a[112:115],v250 offset:512
v_cvt_pk_bf16_f32 v212,v212,v213
M v[24:27],a[232:235],a[100:103],v[24:27]
buffer_load_dwordx4 a[100:103],v251,s[20:23],s46 offen offset:0 sc1
M v[24:27],a[120:123],a[132:135],v[24:27]
s_waitcnt lgkmcnt(6)
v_cvt_pk_bf16_f32 v213,v214,v215
M v[24:27],a[216:219],a[140:143],v[24:27]
s_waitcnt lgkmcnt(4)
s_add_u32 s34,s32,1179648
buffer_load_dwordx4 a[224:227],v251,s[20:23],s46 offen offset:1024 sc1
M v[28:31],a[216:219],a[104:107],v[28:31]
ds_write2st64_b64 v253,v[208:209],v[212:213] offset0:127 offset1:131
M v[28:31],a[120:123],a[140:143],v[28:31]
ds_read_b128 a[104:107],v249 offset:1024
v_accvgpr_read_b32 v204,a56
M v[28:31],a[232:235],a[132:135],v[28:31]
s_waitcnt vmcnt(25) lgkmcnt(5)
ds_read_b128 a[120:123],v250 offset:1024
v_accvgpr_read_b32 v208,a152
M v[96:99],a[244:247],a[96:99],v[96:99]
s_waitcnt vmcnt(24) lgkmcnt(5)
buffer_load_dwordx4 a[236:239],v251,s[20:23],s46 offen offset:2048 sc1
M v[96:99],a[116:119],a[144:147],v[96:99]
s_waitcnt vmcnt(24) lgkmcnt(4)
v_accvgpr_read_b32 v205,a57
v_accvgpr_read_b32 v209,a153
M v[96:99],v[220:223],a[148:151],v[96:99]
s_waitcnt lgkmcnt(3)
v_accvgpr_read_b32 v206,a58
v_accvgpr_read_b32 v210,a154
v_accvgpr_read_b32 v207,a59
v_accvgpr_read_b32 v211,a155
v_pk_add_f32 v[212:213],v[204:205],v[208:209]
v_pk_add_f32 v[214:215],v[206:207],v[210:211]
v_pk_add_f32 v[204:205],v[204:205],v[208:209] neg_lo:[0,1] neg_hi:[0,1]
v_pk_add_f32 v[206:207],v[206:207],v[210:211] neg_lo:[0,1] neg_hi:[0,1]
v_pk_add_f32 v[208:209],v[56:57],v[152:153]
v_pk_add_f32 v[210:211],v[58:59],v[154:155]
v_pk_add_f32 v[152:153],v[56:57],v[152:153] neg_lo:[0,1] neg_hi:[0,1]
v_pk_add_f32 v[154:155],v[58:59],v[154:155] neg_lo:[0,1] neg_hi:[0,1]
v_pk_add_f32 v[56:57],v[212:213],v[208:209]
v_pk_add_f32 v[58:59],v[214:215],v[210:211]
v_pk_fma_f32 v[212:213],v[208:209],4.0,v[212:213] op_sel_hi:[1,0,1]
v_pk_fma_f32 v[214:215],v[210:211],4.0,v[214:215] op_sel_hi:[1,0,1]
v_pk_fma_f32 v[208:209],v[152:153],2.0,v[204:205] op_sel_hi:[1,0,1]
v_pk_fma_f32 v[210:211],v[154:155],2.0,v[206:207] op_sel_hi:[1,0,1]
v_pk_fma_f32 v[152:153],v[152:153],s[40:41],v[204:205] op_sel_hi:[1,0,1]
v_pk_fma_f32 v[154:155],v[154:155],s[40:41],v[206:207] op_sel_hi:[1,0,1]
M v[100:103],v[220:223],a[112:115],v[100:103]
buffer_store_dwordx4 a[24:27],v252,s[24:27],s34 offen offset:384 nt
M v[100:103],a[116:119],a[148:151],v[100:103]
ds_read_b128 a[132:135],v249 offset:1536
v_cvt_pk_bf16_f32 v208,v208,v209
M v[100:103],a[244:247],a[144:147],v[100:103]
ds_read_b128 a[140:143],v250 offset:1536
v_cvt_pk_bf16_f32 v209,v210,v211
M v[104:107],a[244:247],a[148:151],v[104:107]
v_cvt_pk_bf16_f32 v212,v212,v213
v_cvt_pk_bf16_f32 v213,v214,v215
M v[104:107],a[116:119],a[112:115],v[104:107]
s_waitcnt lgkmcnt(3)
ds_write2st64_b64 v253,v[208:209],v[212:213] offset0:68 offset1:72
M v[104:107],v[220:223],a[104:107],v[104:107]
s_waitcnt lgkmcnt(3)
v_accvgpr_read_b32 v204,a60
v_accvgpr_read_b32 v208,a156
M v[108:111],v[220:223],a[120:123],v[108:111]
v_accvgpr_read_b32 v205,a61
v_accvgpr_read_b32 v209,a157
M v[108:111],a[116:119],a[104:107],v[108:111]
ds_read_b128 a[152:155],v250 offset:2048
v_accvgpr_read_b32 v206,a62
M v[108:111],a[244:247],a[112:115],v[108:111]
v_accvgpr_read_b32 v210,a158
v_accvgpr_read_b32 v207,a63
v_accvgpr_read_b32 v211,a159
v_pk_add_f32 v[212:213],v[204:205],v[208:209]
v_pk_add_f32 v[214:215],v[206:207],v[210:211]
v_pk_add_f32 v[204:205],v[204:205],v[208:209] neg_lo:[0,1] neg_hi:[0,1]
v_pk_add_f32 v[206:207],v[206:207],v[210:211] neg_lo:[0,1] neg_hi:[0,1]
v_pk_add_f32 v[208:209],v[60:61],v[156:157]
v_pk_add_f32 v[210:211],v[62:63],v[158:159]
v_pk_add_f32 v[156:157],v[60:61],v[156:157] neg_lo:[0,1] neg_hi:[0,1]
v_pk_add_f32 v[158:159],v[62:63],v[158:159] neg_lo:[0,1] neg_hi:[0,1]
v_pk_add_f32 v[60:61],v[212:213],v[208:209]
v_pk_add_f32 v[62:63],v[214:215],v[210:211]
v_pk_fma_f32 v[212:213],v[208:209],4.0,v[212:213] op_sel_hi:[1,0,1]
v_pk_fma_f32 v[214:215],v[210:211],4.0,v[214:215] op_sel_hi:[1,0,1]
v_pk_fma_f32 v[208:209],v[156:157],2.0,v[204:205] op_sel_hi:[1,0,1]
v_pk_fma_f32 v[210:211],v[158:159],2.0,v[206:207] op_sel_hi:[1,0,1]
v_pk_fma_f32 v[156:157],v[156:157],s[40:41],v[204:205] op_sel_hi:[1,0,1]
v_pk_fma_f32 v[158:159],v[158:159],s[40:41],v[206:207] op_sel_hi:[1,0,1]
M v[112:115],a[244:247],a[104:107],v[112:115]
ds_read_b128 a[156:159],v249 offset:2048
v_cvt_pk_bf16_f32 v208,v208,v209
M v[112:115],a[116:119],a[120:123],v[112:115]
s_waitcnt lgkmcnt(4)
v_cvt_pk_bf16_f32 v209,v210,v211
v_cvt_pk_bf16_f32 v212,v212,v213
M v[112:115],v[220:223],a[132:135],v[112:115]
s_waitcnt lgkmcnt(3)
s_add_u32 s34,s32,1376256
buffer_store_dwordx4 a[28:31],v252,s[24:27],s34 offen offset:384 nt
M v[116:119],v[220:223],a[140:143],v[116:119]
v_cvt_pk_bf16_f32 v213,v214,v215
M v[116:119],a[116:119],a[132:135],v[116:119]
ds_write2st64_b64 v253,v[208:209],v[212:213] offset0:76 offset1:80
M v[116:119],a[244:247],a[120:123],v[116:119]
s_add_u32 s28,s30,6684672
buffer_load_dwordx2 v[204:205],v245,s[12:15],s28 offen offset:0
M v[120:123],a[244:247],a[132:135],v[120:123]
v_cvt_pk_bf16_f32 v0,v0,v1
v_cvt_pk_bf16_f32 v1,v2,v3
M v[120:123],a[116:119],a[140:143],v[120:123]
s_waitcnt lgkmcnt(2)
buffer_load_dwordx2 v[214:215],v245,s[16:19],s28 offen offset:1536
M v[120:123],v[220:223],a[152:155],v[120:123]
s_waitcnt lgkmcnt(1)
v_cvt_pk_bf16_f32 v4,v4,v5
v_cvt_pk_bf16_f32 v5,v6,v7
M v[124:127],v[220:223],a[156:159],v[124:127]
s_waitcnt lgkmcnt(0)
s_barrier
ds_read_b128 a[48:51],v251 offset:60928
M v[124:127],a[116:119],a[152:155],v[124:127]
ds_read_b128 a[52:55],v251 offset:65024
ds_read_b128 a[56:59],v251 offset:34816
M v[124:127],a[244:247],a[140:143],v[124:127]
s_waitcnt vmcnt(27)
buffer_load_dwordx2 v[206:207],v245,s[8:11],s28 offen offset:0
M v[128:131],a[124:127],a[96:99],v[128:131]
s_waitcnt vmcnt(27)
ds_read_b128 a[60:63],v251 offset:38912
ds_write2st64_b64 v253,v[0:1],v[4:5] offset0:34 offset1:38
M v[128:131],a[212:215],a[144:147],v[128:131]
s_waitcnt vmcnt(25)
v_cvt_pk_bf16_f32 v8,v8,v9
v_cvt_pk_bf16_f32 v9,v10,v11
M v[128:131],a[228:231],a[148:151],v[128:131]
buffer_load_dwordx2 v[208:209],v245,s[8:11],s28 offen offset:384
M v[132:135],a[228:231],a[112:115],v[132:135]
v_cvt_pk_bf16_f32 v12,v12,v13
v_cvt_pk_bf16_f32 v13,v14,v15
M v[132:135],a[212:215],a[148:151],v[132:135]
ds_write2st64_b64 v253,v[8:9],v[12:13] offset0:42 offset1:46
M v[132:135],a[124:127],a[144:147],v[132:135]
v_cvt_pk_bf16_f32 v16,v16,v17
v_cvt_pk_bf16_f32 v17,v18,v19
M v[136:139],a[124:127],a[148:151],v[136:139]
buffer_load_dwordx2 v[210:211],v245,s[8:11],s28 offen offset:768
M v[136:139],a[212:215],a[112:115],v[136:139]
v_cvt_pk_bf16_f32 v20,v20,v21
v_cvt_pk_bf16_f32 v21,v22,v23
M v[136:139],a[228:231],a[104:107],v[136:139]
s_add_u32 s34,s32,0
ds_write2st64_b64 v253,v[16:17],v[20:21] offset0:51 offset1:55
M v[140:143],a[228:231],a[120:123],v[140:143]
buffer_load_dwordx2 v[212:213],v245,s[8:11],s28 offen offset:1152
M v[140:143],a[212:215],a[104:107],v[140:143]
v_cvt_pk_bf16_f32 v24,v24,v25
v_cvt_pk_bf16_f32 v25,v26,v27
M v[140:143],a[124:127],a[112:115],v[140:143]
v_add_u32 v249,0x15400,v249
v_add_u32 v250,0x15400,v250
M v[144:147],a[124:127],a[104:107],v[144:147]
v_cvt_pk_bf16_f32 v28,v28,v29
v_cvt_pk_bf16_f32 v29,v30,v31
M v[144:147],a[212:215],a[120:123],v[144:147]
global_load_dword a196,v251,s[64:65]
M v[144:147],a[228:231],a[132:135],v[144:147]
s_add_u32 s47,s44,215040
ds_read_b128 a[96:99],v249 offset:0
ds_write2st64_b64 v253,v[24:25],v[28:29] offset0:59 offset1:63
M v[148:151],a[228:231],a[140:143],v[148:151]
buffer_load_dwordx4 a[196:199],v251,s[20:23],s47 offen offset:0 sc1
M v[148:151],a[212:215],a[132:135],v[148:151]
ds_read_b128 a[104:107],v250 offset:0
ds_read_b128 a[112:115],v249 offset:512
M v[148:151],a[124:127],a[120:123],v[148:151]
ds_read_b128 a[116:119],v250 offset:512
v_accvgpr_read_b32 v238,a64
M v[152:155],a[124:127],a[132:135],v[152:155]
buffer_load_dwordx4 a[192:195],v251,s[20:23],s47 offen offset:1024 sc1
M v[152:155],a[212:215],a[140:143],v[152:155]
v_accvgpr_read_b32 v232,a160
v_add_f32 v234,v238,v232
M v[152:155],a[228:231],a[152:155],v[152:155]
v_sub_f32 v238,v238,v232
v_add_f32 v232,v64,v160
M v[156:159],a[228:231],a[156:159],v[156:159]
v_sub_f32 v160,v64,v160
v_add_f32 v64,v234,v232
M v[156:159],a[212:215],a[152:155],v[156:159]
buffer_load_dwordx4 v[216:219],v251,s[20:23],s47 offen offset:2048 sc1
M v[156:159],a[124:127],a[140:143],v[156:159]
s_waitcnt vmcnt(31) lgkmcnt(4)
s_add_u32 s46,s44,267264
ds_read_b128 a[148:151],v249 offset:1024
ds_read_b128 a[124:127],v250 offset:1024
M v[96:99],a[200:203],a[96:99],v[96:99]
s_waitcnt vmcnt(30) lgkmcnt(4)
v_fmac_f32 v234,4.0,v232
v_fma_f32 v232,2.0,v160,v238
M v[96:99],v[228:231],a[104:107],v[96:99]
s_waitcnt vmcnt(29) lgkmcnt(3)
v_fma_f32 v160,s40,v160,v238
v_accvgpr_read_b32 v238,a65
M v[96:99],a[204:207],a[112:115],v[96:99]
s_waitcnt lgkmcnt(2)
buffer_store_dwordx4 a[32:35],v252,s[24:27],s34 offen offset:512 nt
M v[100:103],a[204:207],a[116:119],v[100:103]
s_add_u32 s34,s32,196608
v_accvgpr_read_b32 v237,a161
v_add_f32 v236,v238,v237
M v[100:103],v[228:231],a[112:115],v[100:103]
ds_read_b128 a[140:143],v249 offset:1536
v_sub_f32 v238,v238,v237
M v[100:103],a[200:203],a[104:107],v[100:103]
buffer_load_dwordx4 a[120:123],v251,s[20:23],s46 offen offset:0 sc1
M v[104:107],a[200:203],a[112:115],v[104:107]
ds_read_b128 a[152:155],v250 offset:1536
v_add_f32 v237,v65,v161
M v[104:107],v[228:231],a[116:119],v[104:107]
s_waitcnt lgkmcnt(3)
v_sub_f32 v161,v65,v161
v_add_f32 v65,v236,v237
M v[104:107],a[204:207],a[148:151],v[104:107]
s_waitcnt lgkmcnt(2)
v_fmac_f32 v236,4.0,v237
v_fma_f32 v237,2.0,v161,v238
M v[108:111],a[204:207],a[124:127],v[108:111]
buffer_load_dwordx4 a[132:135],v251,s[20:23],s46 offen offset:1024 sc1
M v[108:111],v[228:231],a[148:151],v[108:111]
ds_read_b128 a[156:159],v250 offset:2048
v_fma_f32 v161,s40,v161,v238
M v[108:111],a[200:203],a[116:119],v[108:111]
ds_read_b128 a[216:219],v249 offset:2048
v_cvt_pk_bf16_f32 v232,v232,v237
M v[112:115],a[200:203],a[148:151],v[112:115]
v_cvt_pk_bf16_f32 v234,v234,v236
v_accvgpr_read_b32 v238,a66
M v[112:115],v[228:231],a[124:127],v[112:115]
s_waitcnt lgkmcnt(3)
buffer_load_dwordx4 a[144:147],v251,s[20:23],s46 offen offset:2048 sc1
M v[112:115],a[204:207],a[140:143],v[112:115]
s_waitcnt lgkmcnt(2)
s_add_u32 s47,s44,270336
v_accvgpr_read_b32 v233,a162
v_add_f32 v235,v238,v233
M v[116:119],a[204:207],a[152:155],v[116:119]
v_sub_f32 v238,v238,v233
v_add_f32 v233,v66,v162
M v[116:119],v[228:231],a[140:143],v[116:119]
v_sub_f32 v162,v66,v162
v_add_f32 v66,v235,v233
M v[116:119],a[200:203],a[124:127],v[116:119]
buffer_store_dwordx4 a[36:39],v252,s[24:27],s34 offen offset:512 nt
M v[120:123],a[200:203],a[140:143],v[120:123]
v_fmac_f32 v235,4.0,v233
v_fma_f32 v233,2.0,v162,v238
M v[120:123],v[228:231],a[152:155],v[120:123]
s_waitcnt lgkmcnt(1)
v_fma_f32 v162,s40,v162,v238
v_accvgpr_read_b32 v238,a67
M v[120:123],a[204:207],a[156:159],v[120:123]
s_waitcnt lgkmcnt(0)
s_add_u32 s34,s32,393216
buffer_load_dwordx4 a[232:235],v251,s[20:23],s47 offen offset:0 sc1
M v[124:127],a[204:207],a[216:219],v[124:127]
v_accvgpr_read_b32 v237,a163
v_add_f32 v236,v238,v237
M v[124:127],v[228:231],a[156:159],v[124:127]
v_sub_f32 v238,v238,v237
v_add_f32 v237,v67,v163
M v[124:127],a[200:203],a[152:155],v[124:127]
s_waitcnt vmcnt(33)
v_sub_f32 v163,v67,v163
v_add_f32 v67,v236,v237
M v[128:131],a[128:131],a[96:99],v[128:131]
s_waitcnt vmcnt(32)
buffer_load_dwordx4 v[220:223],v251,s[20:23],s47 offen offset:1024 sc1
M v[128:131],a[220:223],a[104:107],v[128:131]
s_waitcnt vmcnt(31)
v_fmac_f32 v236,4.0,v237
v_fma_f32 v237,2.0,v163,v238
M v[128:131],a[208:211],a[112:115],v[128:131]
v_fma_f32 v163,s40,v163,v238
v_cvt_pk_bf16_f32 v233,v233,v237
M v[132:135],a[208:211],a[116:119],v[132:135]
v_cvt_pk_bf16_f32 v235,v235,v236
M v[132:135],a[220:223],a[112:115],v[132:135]
buffer_load_dwordx4 a[160:163],v251,s[20:23],s47 offen offset:2048 sc1
M v[132:135],a[128:131],a[104:107],v[132:135]
ds_write2st64_b64 v253,v[232:233],v[234:235] offset0:102 offset1:106
M v[136:139],a[128:131],a[112:115],v[136:139]
v_accvgpr_read_b32 v238,a68
v_accvgpr_read_b32 v232,a164
M v[136:139],a[220:223],a[116:119],v[136:139]
buffer_store_dwordx4 a[40:43],v252,s[24:27],s34 offen offset:512 nt
M v[136:139],a[208:211],a[148:151],v[136:139]
v_add_f32 v234,v238,v232
v_sub_f32 v238,v238,v232
M v[140:143],a[208:211],a[124:127],v[140:143]
v_add_f32 v232,v68,v164
v_sub_f32 v164,v68,v164
M v[140:143],a[220:223],a[148:151],v[140:143]
v_add_f32 v68,v234,v232
v_fmac_f32 v234,4.0,v232
M v[140:143],a[128:131],a[116:119],v[140:143]
v_fma_f32 v232,2.0,v164,v238
v_fma_f32 v164,s40,v164,v238
M v[144:147],a[128:131],a[148:151],v[144:147]
s_add_u32 s46,s44,322560
v_accvgpr_read_b32 v238,a69
v_accvgpr_read_b32 v237,a165
M v[144:147],a[220:223],a[124:127],v[144:147]
v_add_f32 v236,v238,v237
v_sub_f32 v238,v238,v237
M v[144:147],a[208:211],a[140:143],v[144:147]
s_add_u32 s34,s32,589824
buffer_store_dwordx4 a[44:47],v252,s[24:27],s34 offen offset:512 nt
M v[148:151],a[208:211],a[152:155],v[148:151]
ds_read_b128 a[96:99],v249 offset:17408
ds_read_b128 a[104:107],v250 offset:17408
M v[148:151],a[220:223],a[140:143],v[148:151]
ds_read_b128 a[112:115],v249 offset:17920
v_add_f32 v237,v69,v165
M v[148:151],a[128:131],a[124:127],v[148:151]
ds_read_b128 a[116:119],v250 offset:17920
v_sub_f32 v165,v69,v165
M v[152:155],a[128:131],a[140:143],v[152:155]
buffer_load_dwordx4 a[124:127],v251,s[20:23],s46 offen offset:0 sc1
M v[152:155],a[220:223],a[152:155],v[152:155]
v_add_f32 v69,v236,v237
v_fmac_f32 v236,4.0,v237
M v[152:155],a[208:211],a[156:159],v[152:155]
buffer_load_dwordx4 a[140:143],v251,s[20:23],s46 offen offset:1024 sc1
M v[156:159],a[208:211],a[216:219],v[156:159]
v_fma_f32 v237,2.0,v165,v238
v_fma_f32 v165,s40,v165,v238
M v[156:159],a[220:223],a[156:159],v[156:159]
ds_read_b128 a[156:159],v249 offset:18432
v_cvt_pk_bf16_f32 v232,v232,v237
M v[156:159],a[128:131],a[152:155],v[156:159]
s_waitcnt vmcnt(34) lgkmcnt(4)
ds_read_b128 a[128:131],v250 offset:18432
v_cvt_pk_bf16_f32 v234,v234,v236
M v[96:99],a[136:139],a[96:99],v[96:99]
s_waitcnt vmcnt(33) lgkmcnt(4)
buffer_load_dwordx4 a[148:151],v251,s[20:23],s46 offen offset:2048 sc1
M v[96:99],a[252:255],a[104:107],v[96:99]
s_waitcnt vmcnt(33) lgkmcnt(3)
v_accvgpr_read_b32 v238,a70
v_accvgpr_read_b32 v233,a166
M v[96:99],a[248:251],a[112:115],v[96:99]
s_waitcnt lgkmcnt(2)
v_add_f32 v235,v238,v233
v_sub_f32 v238,v238,v233
M v[100:103],a[248:251],a[116:119],v[100:103]
v_add_f32 v233,v70,v166
v_sub_f32 v166,v70,v166
M v[100:103],a[252:255],a[112:115],v[100:103]
ds_read_b128 a[152:155],v249 offset:18944
v_add_f32 v70,v235,v233
M v[100:103],a[136:139],a[104:107],v[100:103]
ds_read_b128 a[244:247],v250 offset:18944
v_fmac_f32 v235,4.0,v233
M v[104:107],a[136:139],a[112:115],v[104:107]
v_fma_f32 v233,2.0,v166,v238
v_fma_f32 v166,s40,v166,v238
M v[104:107],a[252:255],a[116:119],v[104:107]
s_waitcnt lgkmcnt(3)
v_accvgpr_read_b32 v238,a71
v_accvgpr_read_b32 v237,a167
M v[104:107],a[248:251],a[156:159],v[104:107]
s_waitcnt lgkmcnt(2)
s_add_u32 s34,s32,786432
buffer_store_dwordx4 a[48:51],v252,s[24:27],s34 offen offset:512 nt
M v[108:111],a[248:251],a[128:131],v[108:111]
v_add_f32 v236,v238,v237
v_sub_f32 v238,v238,v237
M v[108:111],a[252:255],a[156:159],v[108:111]
ds_read_b128 a[164:167],v250 offset:19456
v_add_f32 v237,v71,v167
M v[108:111],a[136:139],a[116:119],v[108:111]
ds_read_b128 a[228:231],v249 offset:19456
v_sub_f32 v167,v71,v167
M v[112:115],a[136:139],a[156:159],v[112:115]
s_add_u32 s47,s44,325632
v_add_f32 v71,v236,v237
v_fmac_f32 v236,4.0,v237
M v[112:115],a[252:255],a[128:131],v[112:115]
s_waitcnt lgkmcnt(3)
v_fma_f32 v237,2.0,v167,v238
v_fma_f32 v167,s40,v167,v238
M v[112:115],a[248:251],a[152:155],v[112:115]
s_waitcnt lgkmcnt(2)
v_cvt_pk_bf16_f32 v233,v233,v237
v_cvt_pk_bf16_f32 v235,v235,v236
M v[116:119],a[248:251],a[244:247],v[116:119]
ds_write2st64_b64 v253,v[232:233],v[234:235] offset0:110 offset1:114
M v[116:119],a[252:255],a[152:155],v[116:119]
v_accvgpr_read_b32 v238,a72
v_accvgpr_read_b32 v232,a168
M v[116:119],a[136:139],a[128:131],v[116:119]
v_add_f32 v234,v238,v232
v_sub_f32 v238,v238,v232
M v[120:123],a[136:139],a[152:155],v[120:123]
buffer_load_dwordx4 a[212:215],v251,s[20:23],s47 offen offset:0 sc1
M v[120:123],a[252:255],a[244:247],v[120:123]
s_waitcnt lgkmcnt(2)
v_add_f32 v232,v72,v168
v_sub_f32 v168,v72,v168
M v[120:123],a[248:251],a[164:167],v[120:123]
s_waitcnt lgkmcnt(0)
s_barrier
ds_read_b128 v[0:3],v251 offset:17408
M v[124:127],a[248:251],a[228:231],v[124:127]
ds_read_b128 v[8:11],v251 offset:21504
ds_read_b128 v[16:19],v251 offset:26112
M v[124:127],a[252:255],a[164:167],v[124:127]
ds_read_b128 v[24:27],v251 offset:30208
ds_read_b128 a[64:67],v251 offset:52224
M v[124:127],a[136:139],a[244:247],v[124:127]
s_waitcnt vmcnt(33)
ds_read_b128 a[68:71],v251 offset:56320
v_add_f32 v72,v234,v232
M v[128:131],a[108:111],a[96:99],v[128:131]
s_waitcnt vmcnt(32)
buffer_load_dwordx4 a[204:207],v251,s[20:23],s47 offen offset:1024 sc1
M v[128:131],a[240:243],a[104:107],v[128:131]
s_waitcnt vmcnt(32)
v_fmac_f32 v234,4.0,v232
v_fma_f32 v232,2.0,v168,v238
M v[128:131],v[224:227],a[112:115],v[128:131]
s_add_u32 s34,s32,983040
buffer_load_dwordx4 v[228:231],v251,s[20:23],s47 offen offset:2048 sc1
M v[132:135],v[224:227],a[116:119],v[132:135]
v_fma_f32 v168,s40,v168,v238
v_accvgpr_read_b32 v238,a73
M v[132:135],a[240:243],a[112:115],v[132:135]
v_accvgpr_read_b32 v237,a169
v_add_f32 v236,v238,v237
M v[132:135],a[108:111],a[104:107],v[132:135]
v_sub_f32 v238,v238,v237
v_add_f32 v237,v73,v169
M v[136:139],a[108:111],a[112:115],v[136:139]
buffer_store_dwordx4 a[52:55],v252,s[24:27],s34 offen offset:512 nt
M v[136:139],a[240:243],a[116:119],v[136:139]
v_sub_f32 v169,v73,v169
v_add_f32 v73,v236,v237
M v[136:139],v[224:227],a[156:159],v[136:139]
v_fmac_f32 v236,4.0,v237
v_fma_f32 v237,2.0,v169,v238
M v[140:143],v[224:227],a[128:131],v[140:143]
v_fma_f32 v169,s40,v169,v238
v_cvt_pk_bf16_f32 v232,v232,v237
M v[140:143],a[240:243],a[156:159],v[140:143]
v_cvt_pk_bf16_f32 v234,v234,v236
v_accvgpr_read_b32 v238,a74
M v[140:143],a[108:111],a[116:119],v[140:143]
v_accvgpr_read_b32 v233,a170
v_add_f32 v235,v238,v233
M v[144:147],a[108:111],a[156:159],v[144:147]
s_add_u32 s47,s44,3072
v_sub_f32 v238,v238,v233
v_add_f32 v233,v74,v170
M v[144:147],a[240:243],a[128:131],v[144:147]
v_sub_f32 v170,v74,v170
v_add_f32 v74,v235,v233
M v[144:147],v[224:227],a[152:155],v[144:147]
ds_read_b128 a[96:99],v249 offset:34816
v_fmac_f32 v235,4.0,v233
M v[148:151],v[224:227],a[244:247],v[148:151]
ds_read_b128 a[104:107],v250 offset:34816
v_fma_f32 v233,2.0,v170,v238
M v[148:151],a[240:243],a[152:155],v[148:151]
ds_read_b128 a[112:115],v249 offset:35328
v_fma_f32 v170,s40,v170,v238
M v[148:151],a[108:111],a[128:131],v[148:151]
ds_read_b128 a[116:119],v250 offset:35328
v_accvgpr_read_b32 v238,a75
M v[152:155],a[108:111],a[152:155],v[152:155]
buffer_load_dwordx4 a[128:131],v251,s[20:23],s47 offen offset:0 sc1
M v[152:155],a[240:243],a[244:247],v[152:155]
v_accvgpr_read_b32 v237,a171
v_add_f32 v236,v238,v237
M v[152:155],v[224:227],a[164:167],v[152:155]
s_add_u32 s34,s32,1179648
buffer_load_dwordx4 a[136:139],v251,s[20:23],s47 offen offset:1024 sc1
M v[156:159],v[224:227],a[228:231],v[156:159]
v_sub_f32 v238,v238,v237
v_add_f32 v237,v75,v171
M v[156:159],a[240:243],a[164:167],v[156:159]
ds_read_b128 a[156:159],v249 offset:35840
v_sub_f32 v171,v75,v171
M v[156:159],a[108:111],a[244:247],v[156:159]
s_waitcnt vmcnt(34) lgkmcnt(4)
ds_read_b128 a[108:111],v250 offset:35840
v_add_f32 v75,v236,v237
M v[96:99],a[100:103],a[96:99],v[96:99]
s_waitcnt vmcnt(33) lgkmcnt(4)
buffer_load_dwordx4 a[152:155],v251,s[20:23],s47 offen offset:2048 sc1
M v[96:99],a[224:227],a[104:107],v[96:99]
s_waitcnt vmcnt(33) lgkmcnt(3)
v_fmac_f32 v236,4.0,v237
v_fma_f32 v237,2.0,v171,v238
M v[96:99],a[236:239],a[112:115],v[96:99]
s_waitcnt lgkmcnt(2)
v_fma_f32 v171,s40,v171,v238
v_cvt_pk_bf16_f32 v233,v233,v237
M v[100:103],a[236:239],a[116:119],v[100:103]
v_cvt_pk_bf16_f32 v235,v235,v236
M v[100:103],a[224:227],a[112:115],v[100:103]
buffer_store_dwordx4 a[56:59],v252,s[24:27],s34 offen offset:512 nt
M v[100:103],a[100:103],a[104:107],v[100:103]
ds_read_b128 a[164:167],v249 offset:36352
ds_read_b128 a[168:171],v250 offset:36352
M v[104:107],a[100:103],a[112:115],v[104:107]
ds_write2st64_b64 v253,v[232:233],v[234:235] offset0:119 offset1:123
M v[104:107],a[224:227],a[116:119],v[104:107]
s_waitcnt lgkmcnt(4)
v_accvgpr_read_b32 v238,a76
v_accvgpr_read_b32 v232,a172
M v[104:107],a[236:239],a[156:159],v[104:107]
s_waitcnt lgkmcnt(3)
v_add_f32 v234,v238,v232
v_sub_f32 v238,v238,v232
M v[108:111],a[236:239],a[108:111],v[108:111]
v_add_f32 v232,v76,v172
v_sub_f32 v172,v76,v172
M v[108:111],a[224:227],a[156:159],v[108:111]
ds_read_b128 a[200:203],v250 offset:36864
v_add_f32 v76,v234,v232
M v[108:111],a[100:103],a[116:119],v[108:111]
ds_read_b128 a[208:211],v249 offset:36864
v_fmac_f32 v234,4.0,v232
M v[112:115],a[100:103],a[156:159],v[112:115]
s_add_u32 s48,s44,6144
v_fma_f32 v232,2.0,v172,v238
v_fma_f32 v172,s40,v172,v238
M v[112:115],a[224:227],a[108:111],v[112:115]
s_waitcnt lgkmcnt(4)
v_accvgpr_read_b32 v238,a77
v_accvgpr_read_b32 v237,a173
M v[112:115],a[236:239],a[164:167],v[112:115]
s_waitcnt lgkmcnt(3)
s_add_u32 s34,s32,1376256
buffer_store_dwordx4 a[60:63],v252,s[24:27],s34 offen offset:512 nt
M v[116:119],a[236:239],a[168:171],v[116:119]
v_add_f32 v236,v238,v237
v_sub_f32 v238,v238,v237
M v[116:119],a[224:227],a[164:167],v[116:119]
v_add_f32 v237,v77,v173
v_sub_f32 v173,v77,v173
M v[116:119],a[100:103],a[108:111],v[116:119]
v_add_f32 v77,v236,v237
v_fmac_f32 v236,4.0,v237
M v[120:123],a[100:103],a[164:167],v[120:123]
buffer_load_dwordx4 a[216:219],v251,s[20:23],s48 offen offset:0 sc1
M v[120:123],a[224:227],a[168:171],v[120:123]
s_waitcnt lgkmcnt(1)
v_fma_f32 v237,2.0,v173,v238
v_fma_f32 v173,s40,v173,v238
M v[120:123],a[236:239],a[200:203],v[120:123]
s_waitcnt lgkmcnt(0)
buffer_load_dwordx4 a[220:223],v251,s[20:23],s48 offen offset:1024 sc1
M v[124:127],a[236:239],a[208:211],v[124:127]
v_cvt_pk_bf16_f32 v232,v232,v237
v_cvt_pk_bf16_f32 v234,v234,v236
M v[124:127],a[224:227],a[200:203],v[124:127]
v_accvgpr_read_b32 v238,a78
v_accvgpr_read_b32 v233,a174
M v[124:127],a[100:103],a[168:171],v[124:127]
s_waitcnt vmcnt(27)
v_add_f32 v235,v238,v233
v_sub_f32 v238,v238,v233
M v[128:131],a[196:199],a[96:99],v[128:131]
s_waitcnt vmcnt(26)
buffer_load_dwordx4 a[248:251],v251,s[20:23],s48 offen offset:2048 sc1
M v[128:131],a[192:195],a[104:107],v[128:131]
s_waitcnt vmcnt(26)
v_add_f32 v233,v78,v174
v_sub_f32 v174,v78,v174
M v[128:131],v[216:219],a[112:115],v[128:131]
v_add_f32 v78,v235,v233
v_fmac_f32 v235,4.0,v233
M v[132:135],v[216:219],a[116:119],v[132:135]
v_fma_f32 v233,2.0,v174,v238
v_fma_f32 v174,s40,v174,v238
M v[132:135],a[192:195],a[112:115],v[132:135]
v_accvgpr_read_b32 v238,a79
v_accvgpr_read_b32 v237,a175
v_add_f32 v236,v238,v237
M v[132:135],a[196:199],a[104:107],v[132:135]
v_sub_f32 v238,v238,v237
v_add_f32 v237,v79,v175
M v[136:139],a[196:199],a[112:115],v[136:139]
v_sub_f32 v175,v79,v175
v_add_f32 v79,v236,v237
M v[136:139],a[192:195],a[116:119],v[136:139]
v_fmac_f32 v236,4.0,v237
v_fma_f32 v237,2.0,v175,v238
v_fma_f32 v175,s40,v175,v238
M v[136:139],v[216:219],a[156:159],v[136:139]
s_add_u32 s34,s33,0
buffer_store_dwordx4 v[0:3],v252,s[24:27],s34 offen offset:0 nt
M v[140:143],v[216:219],a[108:111],v[140:143]
v_cvt_pk_bf16_f32 v233,v233,v237
v_cvt_pk_bf16_f32 v235,v235,v236
M v[140:143],a[192:195],a[156:159],v[140:143]
ds_write2st64_b64 v253,v[232:233],v[234:235] offset0:127 offset1:131
M v[140:143],a[196:199],a[116:119],v[140:143]
v_accvgpr_read_b32 v238,a80
v_accvgpr_read_b32 v232,a176
M v[144:147],a[196:199],a[156:159],v[144:147]
s_add_u32 s47,s44,58368
v_add_f32 v234,v238,v232
v_sub_f32 v238,v238,v232
M v[144:147],a[192:195],a[108:111],v[144:147]
v_add_f32 v232,v80,v176
v_sub_f32 v176,v80,v176
M v[144:147],v[216:219],a[164:167],v[144:147]
ds_read_b128 a[96:99],v249 offset:52224
v_add_f32 v80,v234,v232
M v[148:151],v[216:219],a[168:171],v[148:151]
ds_read_b128 a[100:103],v250 offset:52224
v_fmac_f32 v234,4.0,v232
M v[148:151],a[192:195],a[164:167],v[148:151]
ds_read_b128 a[104:107],v249 offset:52736
v_fma_f32 v232,2.0,v176,v238
M v[148:151],a[196:199],a[108:111],v[148:151]
ds_read_b128 a[108:111],v250 offset:52736
v_fma_f32 v176,s40,v176,v238
M v[152:155],a[196:199],a[164:167],v[152:155]
buffer_load_dwordx4 a[112:115],v251,s[20:23],s47 offen offset:0 sc1
M v[152:155],a[192:195],a[168:171],v[152:155]
v_accvgpr_read_b32 v238,a81
v_accvgpr_read_b32 v237,a177
M v[152:155],v[216:219],a[200:203],v[152:155]
buffer_load_dwordx4 a[116:119],v251,s[20:23],s47 offen offset:1024 sc1
M v[156:159],v[216:219],a[208:211],v[156:159]
v_add_f32 v236,v238,v237
v_sub_f32 v238,v238,v237
M v[156:159],a[192:195],a[200:203],v[156:159]
ds_read_b128 a[164:167],v249 offset:53248
v_add_f32 v237,v81,v177
M v[156:159],a[196:199],a[168:171],v[156:159]
s_waitcnt vmcnt(27) lgkmcnt(4)
ds_read_b128 a[168:171],v250 offset:53248
v_sub_f32 v177,v81,v177
M v[96:99],a[120:123],a[96:99],v[96:99]
s_waitcnt vmcnt(26) lgkmcnt(4)
buffer_load_dwordx4 a[156:159],v251,s[20:23],s47 offen offset:2048 sc1
M v[96:99],a[132:135],a[100:103],v[96:99]
s_waitcnt vmcnt(26) lgkmcnt(3)
v_add_f32 v81,v236,v237
v_fmac_f32 v236,4.0,v237
v_fma_f32 v237,2.0,v177,v238
M v[96:99],a[144:147],a[104:107],v[96:99]
s_waitcnt lgkmcnt(2)
s_add_u32 s34,s33,393216
v_fma_f32 v177,s40,v177,v238
v_cvt_pk_bf16_f32 v232,v232,v237
M v[100:103],a[144:147],a[108:111],v[100:103]
v_cvt_pk_bf16_f32 v234,v234,v236
v_accvgpr_read_b32 v238,a82
v_accvgpr_read_b32 v233,a178
M v[100:103],a[132:135],a[104:107],v[100:103]
buffer_store_dwordx4 v[8:11],v252,s[24:27],s34 offen offset:0 nt
M v[100:103],a[120:123],a[100:103],v[100:103]
ds_read_b128 a[172:175],v249 offset:53760
ds_read_b128 a[252:255],v250 offset:53760
M v[104:107],a[120:123],a[104:107],v[104:107]
v_add_f32 v235,v238,v233
v_sub_f32 v238,v238,v233
M v[104:107],a[132:135],a[108:111],v[104:107]
s_waitcnt lgkmcnt(3)
v_add_f32 v233,v82,v178
v_sub_f32 v178,v82,v178
M v[104:107],a[144:147],a[164:167],v[104:107]
s_waitcnt lgkmcnt(2)
v_add_f32 v82,v235,v233
v_fmac_f32 v235,4.0,v233
M v[108:111],a[144:147],a[168:171],v[108:111]
v_fma_f32 v233,2.0,v178,v238
v_fma_f32 v178,s40,v178,v238
M v[108:111],a[132:135],a[164:167],v[108:111]
v_accvgpr_read_b32 v238,a83
v_accvgpr_read_b32 v237,a179
M v[108:111],a[120:123],a[108:111],v[108:111]
ds_read_b128 a[176:179],v250 offset:54272
ds_read_b128 a[228:231],v249 offset:54272
M v[112:115],a[120:123],a[164:167],v[112:115]
s_add_u32 s48,s44,61440
v_add_f32 v236,v238,v237
v_sub_f32 v238,v238,v237
M v[112:115],a[132:135],a[168:171],v[112:115]
s_waitcnt lgkmcnt(3)
v_add_f32 v237,v83,v179
v_sub_f32 v179,v83,v179
M v[112:115],a[144:147],a[172:175],v[112:115]
s_waitcnt lgkmcnt(2)
v_add_f32 v83,v236,v237
v_fmac_f32 v236,4.0,v237
M v[116:119],a[144:147],a[252:255],v[116:119]
v_fma_f32 v237,2.0,v179,v238
v_fma_f32 v179,s40,v179,v238
v_cvt_pk_bf16_f32 v233,v233,v237
M v[116:119],a[132:135],a[172:175],v[116:119]
v_cvt_pk_bf16_f32 v235,v235,v236
M v[116:119],a[120:123],a[168:171],v[116:119]
ds_write2st64_b64 v253,v[232:233],v[234:235] offset0:68 offset1:72
M v[120:123],a[120:123],a[172:175],v[120:123]
buffer_load_dwordx4 v[224:227],v251,s[20:23],s48 offen offset:0 sc1
M v[120:123],a[132:135],a[252:255],v[120:123]
s_waitcnt lgkmcnt(2)
v_accvgpr_read_b32 v238,a84
v_accvgpr_read_b32 v232,a180
M v[120:123],a[144:147],a[176:179],v[120:123]
s_waitcnt lgkmcnt(1)
s_add_u32 s34,s33,786432
buffer_load_dwordx4 a[240:243],v251,s[20:23],s48 offen offset:1024 sc1
M v[124:127],a[144:147],a[228:231],v[124:127]
v_add_f32 v234,v238,v232
v_sub_f32 v238,v238,v232
M v[124:127],a[132:135],a[176:179],v[124:127]
v_add_f32 v232,v84,v180
v_sub_f32 v180,v84,v180
M v[124:127],a[120:123],a[252:255],v[124:127]
s_waitcnt vmcnt(27)
v_add_f32 v84,v234,v232
v_fmac_f32 v234,4.0,v232
M v[128:131],a[232:235],a[96:99],v[128:131]
s_waitcnt vmcnt(26)
buffer_load_dwordx4 a[244:247],v251,s[20:23],s48 offen offset:2048 sc1
v_fma_f32 v232,2.0,v180,v238
M v[128:131],v[220:223],a[100:103],v[128:131]
s_waitcnt vmcnt(26)
v_fma_f32 v180,s40,v180,v238
v_accvgpr_read_b32 v238,a85
M v[128:131],a[160:163],a[104:107],v[128:131]
v_accvgpr_read_b32 v237,a181
v_add_f32 v236,v238,v237
v_sub_f32 v238,v238,v237
M v[132:135],a[160:163],a[108:111],v[132:135]
v_add_f32 v237,v85,v181
v_sub_f32 v181,v85,v181
M v[132:135],v[220:223],a[104:107],v[132:135]
buffer_store_dwordx4 v[16:19],v252,s[24:27],s34 offen offset:0 nt
M v[132:135],a[232:235],a[100:103],v[132:135]
v_add_f32 v85,v236,v237
v_fmac_f32 v236,4.0,v237
M v[136:139],a[232:235],a[104:107],v[136:139]
v_fma_f32 v237,2.0,v181,v238
v_fma_f32 v181,s40,v181,v238
M v[136:139],v[220:223],a[108:111],v[136:139]
v_cvt_pk_bf16_f32 v232,v232,v237
v_cvt_pk_bf16_f32 v234,v234,v236
M v[136:139],a[160:163],a[164:167],v[136:139]
v_accvgpr_read_b32 v238,a86
v_accvgpr_read_b32 v233,a182
M v[140:143],a[160:163],a[168:171],v[140:143]
v_add_f32 v235,v238,v233
v_sub_f32 v238,v238,v233
M v[140:143],v[220:223],a[164:167],v[140:143]
v_add_f32 v233,v86,v182
v_sub_f32 v182,v86,v182
M v[140:143],a[232:235],a[108:111],v[140:143]
v_add_u32 v249,0xffffbc00,v249
v_add_u32 v250,0xffffbc00,v250
M v[144:147],a[232:235],a[164:167],v[144:147]
s_add_u32 s47,s44,113664
v_add_f32 v86,v235,v233
v_fmac_f32 v235,4.0,v233
M v[144:147],v[220:223],a[168:171],v[144:147]
v_fma_f32 v233,2.0,v182,v238
v_fma_f32 v182,s40,v182,v238
M v[144:147],a[160:163],a[172:175],v[144:147]
s_add_u32 s34,s33,1179648
buffer_store_dwordx4 v[24:27],v252,s[24:27],s34 offen offset:0 nt
M v[148:151],a[160:163],a[252:255],v[148:151]
ds_read_b128 a[96:99],v249 offset:0
ds_read_b128 a[100:103],v250 offset:0
M v[148:151],v[220:223],a[172:175],v[148:151]
ds_read_b128 a[104:107],v249 offset:512
v_accvgpr_read_b32 v238,a87
M v[148:151],a[232:235],a[168:171],v[148:151]
ds_read_b128 a[108:111],v250 offset:512
v_accvgpr_read_b32 v237,a183
M v[152:155],a[232:235],a[172:175],v[152:155]
buffer_load_dwordx4 a[120:123],v251,s[20:23],s47 offen offset:0 sc1
M v[152:155],v[220:223],a[252:255],v[152:155]
v_add_f32 v236,v238,v237
v_sub_f32 v238,v238,v237
M v[152:155],a[160:163],a[176:179],v[152:155]
buffer_load_dwordx4 a[132:135],v251,s[20:23],s47 offen offset:1024 sc1
M v[156:159],a[160:163],a[228:231],v[156:159]
v_add_f32 v237,v87,v183
v_sub_f32 v183,v87,v183
M v[156:159],v[220:223],a[176:179],v[156:159]
ds_read_b128 a[160:163],v249 offset:1024
v_add_f32 v87,v236,v237
M v[156:159],a[232:235],a[252:255],v[156:159]
s_waitcnt vmcnt(27) lgkmcnt(4)
ds_read_b128 a[164:167],v250 offset:1024
v_fmac_f32 v236,4.0,v237
v_fma_f32 v237,2.0,v183,v238
M v[96:99],a[124:127],a[96:99],v[96:99]
s_waitcnt vmcnt(26) lgkmcnt(4)
buffer_load_dwordx4 a[144:147],v251,s[20:23],s47 offen offset:2048 sc1
M v[96:99],a[140:143],a[100:103],v[96:99]
s_waitcnt vmcnt(26) lgkmcnt(3)
v_fma_f32 v183,s40,v183,v238
v_cvt_pk_bf16_f32 v233,v233,v237
v_cvt_pk_bf16_f32 v235,v235,v236
M v[96:99],a[148:151],a[104:107],v[96:99]
s_waitcnt lgkmcnt(2)
ds_write2st64_b64 v253,v[232:233],v[234:235] offset0:76 offset1:80
M v[100:103],a[148:151],a[108:111],v[100:103]
v_accvgpr_read_b32 v238,a88
v_accvgpr_read_b32 v232,a184
M v[100:103],a[140:143],a[104:107],v[100:103]
ds_read_b128 a[168:171],v249 offset:1536
v_add_f32 v234,v238,v232
M v[100:103],a[124:127],a[100:103],v[100:103]
ds_read_b128 a[172:175],v250 offset:1536
v_sub_f32 v238,v238,v232
M v[104:107],a[124:127],a[104:107],v[104:107]
v_add_f32 v232,v88,v184
v_sub_f32 v184,v88,v184
M v[104:107],a[140:143],a[108:111],v[104:107]
s_waitcnt lgkmcnt(4)
v_add_f32 v88,v234,v232
v_fmac_f32 v234,4.0,v232
M v[104:107],a[148:151],a[160:163],v[104:107]
s_waitcnt lgkmcnt(3)
s_add_u32 s34,s32,0
buffer_store_dwordx4 a[64:67],v252,s[24:27],s34 offen offset:640 nt
M v[108:111],a[148:151],a[164:167],v[108:111]
v_fma_f32 v232,2.0,v184,v238
v_fma_f32 v184,s40,v184,v238
M v[108:111],a[140:143],a[160:163],v[108:111]
ds_read_b128 a[176:179],v250 offset:2048
v_accvgpr_read_b32 v238,a89
M v[108:111],a[124:127],a[108:111],v[108:111]
ds_read_b128 a[180:183],v249 offset:2048
v_accvgpr_read_b32 v237,a185
M v[112:115],a[124:127],a[160:163],v[112:115]
s_add_u32 s48,s44,116736
v_add_f32 v236,v238,v237
v_sub_f32 v238,v238,v237
M v[112:115],a[140:143],a[164:167],v[112:115]
s_waitcnt lgkmcnt(3)
v_add_f32 v237,v89,v185
v_sub_f32 v185,v89,v185
M v[112:115],a[148:151],a[168:171],v[112:115]
s_waitcnt lgkmcnt(2)
v_add_f32 v89,v236,v237
v_fmac_f32 v236,4.0,v237
M v[116:119],a[148:151],a[172:175],v[116:119]
v_fma_f32 v237,2.0,v185,v238
v_fma_f32 v185,s40,v185,v238
M v[116:119],a[140:143],a[168:171],v[116:119]
v_cvt_pk_bf16_f32 v232,v232,v237
v_cvt_pk_bf16_f32 v234,v234,v236
M v[116:119],a[124:127],a[164:167],v[116:119]
v_accvgpr_read_b32 v238,a90
v_accvgpr_read_b32 v233,a186
M v[120:123],a[124:127],a[168:171],v[120:123]
buffer_load_dwordx4 a[236:239],v251,s[20:23],s48 offen offset:0 sc1
M v[120:123],a[140:143],a[172:175],v[120:123]
s_waitcnt lgkmcnt(1)
v_add_f32 v235,v238,v233
v_sub_f32 v238,v238,v233
M v[120:123],a[148:151],a[176:179],v[120:123]
s_waitcnt lgkmcnt(0)
buffer_load_dwordx4 a[224:227],v251,s[20:23],s48 offen offset:1024 sc1
v_add_f32 v233,v90,v186
M v[124:127],a[148:151],a[180:183],v[124:127]
v_sub_f32 v186,v90,v186
v_add_f32 v90,v235,v233
M v[124:127],a[140:143],a[176:179],v[124:127]
v_fmac_f32 v235,4.0,v233
v_fma_f32 v233,2.0,v186,v238
v_fma_f32 v186,s40,v186,v238
M v[124:127],a[124:127],a[172:175],v[124:127]
s_waitcnt vmcnt(27)
v_accvgpr_read_b32 v238,a91
v_accvgpr_read_b32 v237,a187
M v[128:131],a[212:215],a[96:99],v[128:131]
s_waitcnt vmcnt(26)
buffer_load_dwordx4 a[208:211],v251,s[20:23],s48 offen offset:2048 sc1
v_add_f32 v236,v238,v237
M v[128:131],a[204:207],a[100:103],v[128:131]
s_waitcnt vmcnt(26)
v_sub_f32 v238,v238,v237
v_add_f32 v237,v91,v187
M v[128:131],v[228:231],a[104:107],v[128:131]
s_add_u32 s34,s32,196608
v_sub_f32 v187,v91,v187
v_add_f32 v91,v236,v237
M v[132:135],v[228:231],a[108:111],v[132:135]
v_fmac_f32 v236,4.0,v237
v_fma_f32 v237,2.0,v187,v238
v_fma_f32 v187,s40,v187,v238
M v[132:135],a[204:207],a[104:107],v[132:135]
buffer_store_dwordx4 a[68:71],v252,s[24:27],s34 offen offset:640 nt
M v[132:135],a[212:215],a[100:103],v[132:135]
v_cvt_pk_bf16_f32 v233,v233,v237
v_cvt_pk_bf16_f32 v235,v235,v236
M v[136:139],a[212:215],a[104:107],v[136:139]
ds_write2st64_b64 v253,v[232:233],v[234:235] offset0:85 offset1:89
M v[136:139],a[204:207],a[108:111],v[136:139]
v_accvgpr_read_b32 v238,a92
v_accvgpr_read_b32 v232,a188
M v[136:139],v[228:231],a[160:163],v[136:139]
v_add_f32 v234,v238,v232
v_sub_f32 v238,v238,v232
M v[140:143],v[228:231],a[164:167],v[140:143]
v_add_f32 v232,v92,v188
v_sub_f32 v188,v92,v188
M v[140:143],a[204:207],a[160:163],v[140:143]
v_add_f32 v92,v234,v232
v_fmac_f32 v234,4.0,v232
M v[140:143],a[212:215],a[108:111],v[140:143]
v_add_u32 v249,0xfffece00,v249
v_add_u32 v250,0xfffece00,v250
M v[144:147],a[212:215],a[160:163],v[144:147]
s_add_u32 s47,s44,168960
v_fma_f32 v232,2.0,v188,v238
v_fma_f32 v188,s40,v188,v238
M v[144:147],a[204:207],a[164:167],v[144:147]
v_accvgpr_read_b32 v238,a93
v_accvgpr_read_b32 v237,a189
M v[144:147],v[228:231],a[168:171],v[144:147]
ds_read_b128 a[96:99],v249 offset:0
v_add_f32 v236,v238,v237
M v[148:151],v[228:231],a[172:175],v[148:151]
ds_read_b128 a[100:103],v250 offset:0
v_sub_f32 v238,v238,v237
M v[148:151],a[204:207],a[168:171],v[148:151]
ds_read_b128 a[104:107],v249 offset:512
v_add_f32 v237,v93,v189
M v[148:151],a[212:215],a[164:167],v[148:151]
ds_read_b128 a[108:111],v250 offset:512
v_sub_f32 v189,v93,v189
M v[152:155],a[212:215],a[168:171],v[152:155]
buffer_load_dwordx4 a[124:127],v251,s[20:23],s47 offen offset:0 sc1
M v[152:155],a[204:207],a[172:175],v[152:155]
v_add_f32 v93,v236,v237
v_fmac_f32 v236,4.0,v237
M v[152:155],v[228:231],a[176:179],v[152:155]
buffer_load_dwordx4 a[140:143],v251,s[20:23],s47 offen offset:1024 sc1
M v[156:159],v[228:231],a[180:183],v[156:159]
v_fma_f32 v237,2.0,v189,v238
v_fma_f32 v189,s40,v189,v238
v_cvt_pk_bf16_f32 v232,v232,v237
M v[156:159],a[204:207],a[176:179],v[156:159]
ds_read_b128 a[160:163],v249 offset:1024
v_cvt_pk_bf16_f32 v234,v234,v236
M v[156:159],a[212:215],a[172:175],v[156:159]
s_waitcnt vmcnt(27) lgkmcnt(4)
ds_read_b128 a[164:167],v250 offset:1024
v_accvgpr_read_b32 v238,a94
v_accvgpr_read_b32 v233,a190
M v[32:35],a[128:131],a[96:99],v[32:35]
s_waitcnt vmcnt(26) lgkmcnt(4)
buffer_load_dwordx4 a[148:151],v251,s[20:23],s47 offen offset:2048 sc1
M v[32:35],a[136:139],a[100:103],v[32:35]
s_waitcnt vmcnt(26) lgkmcnt(3)
v_add_f32 v235,v238,v233
v_sub_f32 v238,v238,v233
M v[32:35],a[152:155],a[104:107],v[32:35]
s_waitcnt lgkmcnt(2)
v_add_f32 v233,v94,v190
v_sub_f32 v190,v94,v190
v_add_f32 v94,v235,v233
M v[36:39],a[152:155],a[108:111],v[36:39]
v_fmac_f32 v235,4.0,v233
v_fma_f32 v233,2.0,v190,v238
M v[36:39],a[136:139],a[104:107],v[36:39]
ds_read_b128 a[168:171],v249 offset:1536
v_fma_f32 v190,s40,v190,v238
v_accvgpr_read_b32 v238,a95
M v[36:39],a[128:131],a[100:103],v[36:39]
ds_read_b128 a[172:175],v250 offset:1536
v_accvgpr_read_b32 v237,a191
M v[40:43],a[128:131],a[104:107],v[40:43]
v_add_f32 v236,v238,v237
v_sub_f32 v238,v238,v237
v_add_f32 v237,v95,v191
M v[40:43],a[136:139],a[108:111],v[40:43]
s_waitcnt lgkmcnt(3)
v_sub_f32 v191,v95,v191
v_add_f32 v95,v236,v237
M v[40:43],a[152:155],a[160:163],v[40:43]
s_waitcnt lgkmcnt(2)
v_fmac_f32 v236,4.0,v237
v_fma_f32 v237,2.0,v191,v238
M v[44:47],a[152:155],a[164:167],v[44:47]
v_fma_f32 v191,s40,v191,v238
v_cvt_pk_bf16_f32 v233,v233,v237
v_cvt_pk_bf16_f32 v235,v235,v236
M v[44:47],a[136:139],a[160:163],v[44:47]
ds_read_b128 a[176:179],v250 offset:2048
ds_write2st64_b64 v253,v[232:233],v[234:235] offset0:93 offset1:97
M v[44:47],a[128:131],a[108:111],v[44:47]
ds_read_b128 a[180:183],v249 offset:2048
v_cvt_pk_bf16_f32 v96,v96,v97
M v[48:51],a[128:131],a[160:163],v[48:51]
v_cvt_pk_bf16_f32 v97,v98,v99
v_cvt_pk_bf16_f32 v100,v100,v101
M v[48:51],a[136:139],a[164:167],v[48:51]
s_waitcnt lgkmcnt(4)
v_cvt_pk_bf16_f32 v101,v102,v103
M v[48:51],a[152:155],a[168:171],v[48:51]
s_waitcnt lgkmcnt(1)
s_barrier
ds_read_b128 a[72:75],v251 offset:60928
M v[52:55],a[152:155],a[172:175],v[52:55]
ds_read_b128 a[76:79],v251 offset:65024
ds_read_b128 a[80:83],v251 offset:34816
M v[52:55],a[136:139],a[168:171],v[52:55]
ds_read_b128 a[84:87],v251 offset:38912
ds_read_b128 a[88:91],v251 offset:43520
M v[52:55],a[128:131],a[164:167],v[52:55]
ds_read_b128 a[92:95],v251 offset:47616
v_add_u32 v4,69632,v251
M v[56:59],a[128:131],a[168:171],v[56:59]
global_load_dword a184,v251,s[64:65]
M v[56:59],a[136:139],a[172:175],v[56:59]
s_waitcnt lgkmcnt(5)
s_add_u32 s34,s32,393216
buffer_store_dwordx4 a[72:75],v252,s[24:27],s34 offen offset:640 nt
M v[56:59],a[152:155],a[176:179],v[56:59]
s_add_u32 s48,s44,172032
ds_write2st64_b64 v253,v[96:97],v[100:101] offset0:34 offset1:38
M v[60:63],a[152:155],a[180:183],v[60:63]
s_waitcnt lgkmcnt(5)
s_add_u32 s34,s32,589824
buffer_store_dwordx4 a[76:79],v252,s[24:27],s34 offen offset:640 nt
M v[60:63],a[136:139],a[176:179],v[60:63]
v_cvt_pk_bf16_f32 v104,v104,v105
v_cvt_pk_bf16_f32 v105,v106,v107
M v[60:63],a[128:131],a[172:175],v[60:63]
s_waitcnt vmcnt(26)
v_cvt_pk_bf16_f32 v108,v108,v109
v_cvt_pk_bf16_f32 v109,v110,v111
M v[64:67],a[216:219],a[96:99],v[64:67]
s_waitcnt vmcnt(25)
buffer_load_dwordx4 a[184:187],v251,s[20:23],s48 offen offset:0 sc1
M v[64:67],a[220:223],a[100:103],v[64:67]
s_waitcnt vmcnt(25)
ds_write2st64_b64 v253,v[104:105],v[108:109] offset0:42 offset1:46
M v[64:67],a[248:251],a[104:107],v[64:67]
v_cvt_pk_bf16_f32 v112,v112,v113
v_cvt_pk_bf16_f32 v113,v114,v115
M v[68:71],a[248:251],a[108:111],v[68:71]
buffer_load_dwordx4 a[188:191],v251,s[20:23],s48 offen offset:1024 sc1
M v[68:71],a[220:223],a[104:107],v[68:71]
v_cvt_pk_bf16_f32 v116,v116,v117
v_cvt_pk_bf16_f32 v117,v118,v119
M v[68:71],a[216:219],a[100:103],v[68:71]
ds_write2st64_b64 v253,v[112:113],v[116:117] offset0:51 offset1:55
M v[72:75],a[216:219],a[104:107],v[72:75]
buffer_load_dwordx4 v[216:219],v251,s[20:23],s48 offen offset:2048 sc1
M v[72:75],a[220:223],a[108:111],v[72:75]
v_cvt_pk_bf16_f32 v120,v120,v121
v_cvt_pk_bf16_f32 v121,v122,v123
M v[72:75],a[248:251],a[160:163],v[72:75]
s_add_u32 s34,s32,786432
v_cvt_pk_bf16_f32 v124,v124,v125
v_cvt_pk_bf16_f32 v125,v126,v127
M v[76:79],a[248:251],a[164:167],v[76:79]
ds_write2st64_b64 v253,v[120:121],v[124:125] offset0:59 offset1:63
M v[76:79],a[220:223],a[160:163],v[76:79]
s_waitcnt lgkmcnt(7)
buffer_store_dwordx4 a[80:83],v252,s[24:27],s34 offen offset:640 nt
M v[76:79],a[216:219],a[108:111],v[76:79]
v_add_u32 v249,0x15400,v249
v_add_u32 v250,0x15400,v250
M v[80:83],a[216:219],a[160:163],v[80:83]
s_add_u32 s47,s44,224256
v_cvt_pk_bf16_f32 v128,v128,v129
v_cvt_pk_bf16_f32 v129,v130,v131
M v[80:83],a[220:223],a[164:167],v[80:83]
v_cvt_pk_bf16_f32 v132,v132,v133
v_cvt_pk_bf16_f32 v133,v134,v135
M v[80:83],a[248:251],a[168:171],v[80:83]
s_waitcnt lgkmcnt(0)
s_barrier
ds_read_b128 v[96:99],v251 offset:17408
M v[84:87],a[248:251],a[172:175],v[84:87]
ds_read_b128 v[104:107],v251 offset:21504
ds_read_b128 v[112:115],v251 offset:26112
M v[84:87],a[220:223],a[168:171],v[84:87]
ds_read_b128 v[120:123],v251 offset:30208
ds_read_b128 a[96:99],v249 offset:0
M v[84:87],a[216:219],a[164:167],v[84:87]
ds_read_b128 a[100:103],v250 offset:0
ds_read_b128 a[104:107],v249 offset:512
M v[88:91],a[216:219],a[168:171],v[88:91]
buffer_load_dwordx4 a[128:131],v251,s[20:23],s47 offen offset:0 sc1
M v[88:91],a[220:223],a[172:175],v[88:91]
ds_read_b128 a[108:111],v250 offset:512
ds_write2st64_b64 v253,v[128:129],v[132:133] offset0:119 offset1:123
M v[88:91],a[248:251],a[176:179],v[88:91]
buffer_load_dwordx4 a[136:139],v251,s[20:23],s47 offen offset:1024 sc1
M v[92:95],a[248:251],a[180:183],v[92:95]
v_cvt_pk_bf16_f32 v136,v136,v137
v_cvt_pk_bf16_f32 v137,v138,v139
M v[92:95],a[220:223],a[176:179],v[92:95]
ds_read_b128 a[160:163],v249 offset:1024
v_cvt_pk_bf16_f32 v140,v140,v141
M v[92:95],a[216:219],a[172:175],v[92:95]
s_waitcnt vmcnt(28) lgkmcnt(5)
buffer_load_dwordx4 a[152:155],v251,s[20:23],s47 offen offset:2048 sc1
M v[32:35],a[112:115],a[96:99],v[32:35]
s_waitcnt vmcnt(28) lgkmcnt(4)
ds_read_b128 a[164:167],v250 offset:1024
v_cvt_pk_bf16_f32 v141,v142,v143
M v[32:35],a[116:119],a[100:103],v[32:35]
s_waitcnt vmcnt(27) lgkmcnt(4)
ds_write2st64_b64 v253,v[136:137],v[140:141] offset0:127 offset1:131
M v[32:35],a[156:159],a[104:107],v[32:35]
s_waitcnt lgkmcnt(4)
s_add_u32 s34,s32,983040
v_cvt_pk_bf16_f32 v144,v144,v145
v_cvt_pk_bf16_f32 v145,v146,v147
M v[36:39],a[156:159],a[108:111],v[36:39]
buffer_store_dwordx4 a[84:87],v252,s[24:27],s34 offen offset:640 nt
M v[36:39],a[116:119],a[104:107],v[36:39]
ds_read_b128 a[168:171],v249 offset:1536
v_cvt_pk_bf16_f32 v148,v148,v149
M v[36:39],a[112:115],a[100:103],v[36:39]
ds_read_b128 a[172:175],v250 offset:1536
v_cvt_pk_bf16_f32 v149,v150,v151
M v[40:43],a[112:115],a[104:107],v[40:43]
ds_write2st64_b64 v253,v[144:145],v[148:149] offset0:68 offset1:72
M v[40:43],a[116:119],a[108:111],v[40:43]
s_waitcnt lgkmcnt(5)
v_cvt_pk_bf16_f32 v152,v152,v153
v_cvt_pk_bf16_f32 v153,v154,v155
M v[40:43],a[156:159],a[160:163],v[40:43]
s_waitcnt lgkmcnt(4)
v_cvt_pk_bf16_f32 v156,v156,v157
v_cvt_pk_bf16_f32 v157,v158,v159
M v[44:47],a[156:159],a[164:167],v[44:47]
ds_write2st64_b64 v253,v[152:153],v[156:157] offset0:76 offset1:80
M v[44:47],a[116:119],a[160:163],v[44:47]
ds_read_b128 a[176:179],v250 offset:2048
v_lshlrev_b32 v234,16,v208
M v[44:47],a[112:115],a[108:111],v[44:47]
ds_read_b128 a[180:183],v249 offset:2048
v_lshlrev_b32 v232,16,v204
M v[48:51],a[112:115],a[160:163],v[48:51]
s_add_u32 s48,s44,227328
v_lshlrev_b32 v233,16,v206
v_lshlrev_b32 v237,16,v214
M v[48:51],a[116:119],a[164:167],v[48:51]
s_waitcnt lgkmcnt(5)
v_lshlrev_b32 v236,16,v212
v_lshlrev_b32 v235,16,v210
M v[48:51],a[156:159],a[168:171],v[48:51]
s_waitcnt lgkmcnt(2)
s_barrier
ds_read_b128 v[128:131],v251 offset:60928
M v[52:55],a[156:159],a[172:175],v[52:55]
ds_read_b128 v[136:139],v251 offset:65024
ds_read_b128 v[144:147],v251 offset:34816
M v[52:55],a[116:119],a[168:171],v[52:55]
ds_read_b128 v[152:155],v251 offset:38912
v_fmac_f32 v232,s43,v234
M v[52:55],a[112:115],a[164:167],v[52:55]
v_fmac_f32 v237,4.0,v233
v_fma_f32 v238,-4.0,v234,v236
M v[56:59],a[112:115],a[168:171],v[56:59]
buffer_load_dwordx4 a[192:195],v251,s[20:23],s48 offen offset:0 sc1
M v[56:59],a[116:119],a[172:175],v[56:59]
s_waitcnt lgkmcnt(5)
v_fmac_f32 v232,s45,v236
v_fmac_f32 v237,s41,v235
M v[56:59],a[156:159],a[176:179],v[56:59]
s_waitcnt lgkmcnt(4)
s_add_u32 s34,s32,1179648
buffer_load_dwordx4 a[200:203],v251,s[20:23],s48 offen offset:1024 sc1
M v[60:63],a[156:159],a[180:183],v[60:63]
v_sub_f32 v236,v236,v234
v_fma_f32 v234,-4.0,v233,v235
M v[60:63],a[116:119],a[176:179],v[60:63]
v_sub_f32 v235,v235,v233
v_add_f32 v233,v238,v234
M v[60:63],a[112:115],a[172:175],v[60:63]
s_waitcnt vmcnt(28)
v_sub_f32 v238,v238,v234
v_fma_f32 v234,2.0,v235,v236
M v[64:67],v[224:227],a[96:99],v[64:67]
s_waitcnt vmcnt(27)
buffer_load_dwordx4 a[196:199],v251,s[20:23],s48 offen offset:2048 sc1
M v[64:67],a[240:243],a[100:103],v[64:67]
s_waitcnt vmcnt(27)
v_fmac_f32 v236,-2.0,v235
v_and_b32 v208,s42,v208
M v[64:67],a[244:247],a[104:107],v[64:67]
v_and_b32 v204,s42,v204
v_and_b32 v206,s42,v206
M v[68:71],a[244:247],a[108:111],v[68:71]
v_and_b32 v214,s42,v214
v_and_b32 v212,s42,v212
M v[68:71],a[240:243],a[104:107],v[68:71]
buffer_store_dwordx4 a[88:91],v252,s[24:27],s34 offen offset:640 nt
M v[68:71],v[224:227],a[100:103],v[68:71]
v_and_b32 v210,s42,v210
v_fmac_f32 v204,s43,v208
M v[72:75],v[224:227],a[104:107],v[72:75]
v_fmac_f32 v214,4.0,v206
v_fma_f32 v235,-4.0,v208,v212
M v[72:75],a[240:243],a[108:111],v[72:75]
v_fmac_f32 v204,s45,v212
v_fmac_f32 v214,s41,v210
M v[72:75],a[244:247],a[160:163],v[72:75]
v_sub_f32 v212,v212,v208
v_fma_f32 v208,-4.0,v206,v210
M v[76:79],a[244:247],a[164:167],v[76:79]
v_sub_f32 v210,v210,v206
v_add_f32 v206,v235,v208
M v[76:79],a[240:243],a[160:163],v[76:79]
v_sub_f32 v235,v235,v208
v_fma_f32 v208,2.0,v210,v212
M v[76:79],v[224:227],a[108:111],v[76:79]
v_fmac_f32 v212,-2.0,v210
v_cvt_pk_bf16_f32 v204,v232,v204
M v[80:83],v[224:227],a[160:163],v[80:83]
s_add_u32 s47,s44,279552
v_cvt_pk_bf16_f32 v214,v237,v214
v_cvt_pk_bf16_f32 v206,v233,v206
M v[80:83],a[240:243],a[164:167],v[80:83]
v_cvt_pk_bf16_f32 v210,v234,v208
v_cvt_pk_bf16_f32 v208,v238,v235
M v[80:83],a[244:247],a[168:171],v[80:83]
s_add_u32 s34,s32,1376256
buffer_store_dwordx4 a[92:95],v252,s[24:27],s34 offen offset:640 nt
M v[84:87],a[244:247],a[172:175],v[84:87]
ds_read_b128 a[96:99],v249 offset:17408
ds_read_b128 a[100:103],v250 offset:17408
M v[84:87],a[240:243],a[168:171],v[84:87]
ds_read_b128 a[104:107],v249 offset:17920
v_cvt_pk_bf16_f32 v212,v236,v212
M v[84:87],v[224:227],a[164:167],v[84:87]
ds_read_b128 a[108:111],v250 offset:17920
v_lshlrev_b32 v234,16,v209
M v[88:91],v[224:227],a[168:171],v[88:91]
buffer_load_dwordx4 a[112:115],v251,s[20:23],s47 offen offset:0 sc1
M v[88:91],a[240:243],a[172:175],v[88:91]
v_lshlrev_b32 v232,16,v205
v_lshlrev_b32 v233,16,v207
M v[88:91],a[244:247],a[176:179],v[88:91]
buffer_load_dwordx4 a[116:119],v251,s[20:23],s47 offen offset:1024 sc1
M v[92:95],a[244:247],a[180:183],v[92:95]
v_lshlrev_b32 v237,16,v215
v_lshlrev_b32 v236,16,v213
M v[92:95],a[240:243],a[176:179],v[92:95]
ds_read_b128 a[160:163],v249 offset:18432
v_lshlrev_b32 v235,16,v211
M v[92:95],v[224:227],a[172:175],v[92:95]
s_waitcnt vmcnt(28) lgkmcnt(4)
ds_read_b128 a[164:167],v250 offset:18432
v_fmac_f32 v232,s43,v234
M v[32:35],a[120:123],a[96:99],v[32:35]
s_waitcnt vmcnt(27) lgkmcnt(4)
buffer_load_dwordx4 a[156:159],v251,s[20:23],s47 offen offset:2048 sc1
M v[32:35],a[132:135],a[100:103],v[32:35]
s_waitcnt vmcnt(27) lgkmcnt(3)
v_fmac_f32 v237,4.0,v233
v_fma_f32 v238,-4.0,v234,v236
M v[32:35],a[144:147],a[104:107],v[32:35]
s_waitcnt lgkmcnt(2)
v_fmac_f32 v232,s45,v236
v_fmac_f32 v237,s41,v235
M v[36:39],a[144:147],a[108:111],v[36:39]
v_sub_f32 v236,v236,v234
v_fma_f32 v234,-4.0,v233,v235
M v[36:39],a[132:135],a[104:107],v[36:39]
ds_read_b128 a[168:171],v249 offset:18944
v_sub_f32 v235,v235,v233
M v[36:39],a[120:123],a[100:103],v[36:39]
ds_read_b128 a[172:175],v250 offset:18944
v_add_f32 v233,v238,v234
M v[40:43],a[120:123],a[104:107],v[40:43]
v_sub_f32 v238,v238,v234
v_fma_f32 v234,2.0,v235,v236
M v[40:43],a[132:135],a[108:111],v[40:43]
s_waitcnt lgkmcnt(3)
v_fmac_f32 v236,-2.0,v235
v_and_b32 v209,s42,v209
M v[40:43],a[144:147],a[160:163],v[40:43]
s_waitcnt lgkmcnt(2)
s_add_u32 s34,s33,0
buffer_store_dwordx4 v[96:99],v252,s[24:27],s34 offen offset:1152 nt
M v[44:47],a[144:147],a[164:167],v[44:47]
v_and_b32 v205,s42,v205
v_and_b32 v207,s42,v207
M v[44:47],a[132:135],a[160:163],v[44:47]
ds_read_b128 a[176:179],v250 offset:19456
v_and_b32 v215,s42,v215
M v[44:47],a[120:123],a[108:111],v[44:47]
ds_read_b128 a[180:183],v249 offset:19456
v_and_b32 v213,s42,v213
M v[48:51],a[120:123],a[160:163],v[48:51]
s_add_u32 s48,s44,282624
v_and_b32 v211,s42,v211
v_fmac_f32 v205,s43,v209
M v[48:51],a[132:135],a[164:167],v[48:51]
s_waitcnt lgkmcnt(3)
v_fmac_f32 v215,4.0,v207
v_fma_f32 v235,-4.0,v209,v213
M v[48:51],a[144:147],a[168:171],v[48:51]
s_waitcnt lgkmcnt(2)
v_fmac_f32 v205,s45,v213
v_fmac_f32 v215,s41,v211
M v[52:55],a[144:147],a[172:175],v[52:55]
v_sub_f32 v213,v213,v209
v_fma_f32 v209,-4.0,v207,v211
M v[52:55],a[132:135],a[168:171],v[52:55]
v_sub_f32 v211,v211,v207
v_add_f32 v207,v235,v209
M v[52:55],a[120:123],a[164:167],v[52:55]
v_sub_f32 v235,v235,v209
v_fma_f32 v209,2.0,v211,v213
M v[56:59],a[120:123],a[168:171],v[56:59]
buffer_load_dwordx4 a[228:231],v251,s[20:23],s48 offen offset:0 sc1
M v[56:59],a[132:135],a[172:175],v[56:59]
s_waitcnt lgkmcnt(1)
v_fmac_f32 v213,-2.0,v211
v_cvt_pk_bf16_f32 v205,v232,v205
M v[56:59],a[144:147],a[176:179],v[56:59]
s_waitcnt lgkmcnt(0)
buffer_load_dwordx4 v[220:223],v251,s[20:23],s48 offen offset:1024 sc1
M v[60:63],a[144:147],a[180:183],v[60:63]
v_cvt_pk_bf16_f32 v215,v237,v215
v_cvt_pk_bf16_f32 v207,v233,v207
M v[60:63],a[132:135],a[176:179],v[60:63]
v_cvt_pk_bf16_f32 v211,v234,v209
v_cvt_pk_bf16_f32 v209,v238,v235
M v[60:63],a[120:123],a[172:175],v[60:63]
s_waitcnt vmcnt(28)
v_cvt_pk_bf16_f32 v213,v236,v213
M v[64:67],a[236:239],a[96:99],v[64:67]
s_waitcnt vmcnt(27)
s_barrier
buffer_load_dwordx4 a[232:235],v251,s[20:23],s48 offen offset:2048 sc1
M v[64:67],a[224:227],a[100:103],v[64:67]
s_waitcnt vmcnt(27)
ds_write2st64_b64 v247,v[192:193],v[202:203] offset0:102 offset1:119
M v[64:67],a[208:211],a[104:107],v[64:67]
s_add_u32 s28,s30,7077888
ds_write2st64_b64 v247,v[194:195],v[196:197] offset0:34 offset1:51
M v[68:71],a[208:211],a[108:111],v[68:71]
s_add_u32 s34,s33,393216
buffer_load_dwordx2 v[192:193],v245,s[12:15],s28 offen offset:0
M v[68:71],a[224:227],a[104:107],v[68:71]
ds_write2st64_b64 v247,v[198:199],v[200:201] offset0:68 offset1:85
M v[68:71],a[236:239],a[100:103],v[68:71]
ds_write2st64_b64 v247,v[204:205],v[214:215] offset0:103 offset1:120
M v[72:75],a[236:239],a[104:107],v[72:75]
buffer_load_dwordx2 v[202:203],v245,s[16:19],s28 offen offset:1536
M v[72:75],a[224:227],a[108:111],v[72:75]
ds_write2st64_b64 v247,v[206:207],v[208:209] offset0:35 offset1:52
M v[72:75],a[208:211],a[160:163],v[72:75]
buffer_load_dwordx2 v[194:195],v245,s[8:11],s28 offen offset:0
M v[76:79],a[208:211],a[164:167],v[76:79]
ds_write2st64_b64 v247,v[210:211],v[212:213] offset0:69 offset1:86
M v[76:79],a[224:227],a[160:163],v[76:79]
v_fmac_f32 v239,s43,v241
v_fmac_f32 v244,4.0,v240
M v[76:79],a[236:239],a[108:111],v[76:79]
v_fma_f32 v232,-4.0,v241,v243
v_fmac_f32 v239,s45,v243
M v[80:83],a[236:239],a[160:163],v[80:83]
s_add_u32 s48,s44,52224
buffer_load_dwordx2 v[196:197],v245,s[8:11],s28 offen offset:384
M v[80:83],a[224:227],a[164:167],v[80:83]
v_fmac_f32 v244,s41,v242
v_sub_f32 v243,v243,v241
M v[80:83],a[208:211],a[168:171],v[80:83]
ds_read_b128 a[96:99],v249 offset:34816
v_fma_f32 v241,-4.0,v240,v242
M v[84:87],a[208:211],a[172:175],v[84:87]
ds_read_b128 a[100:103],v250 offset:34816
v_sub_f32 v242,v242,v240
M v[84:87],a[224:227],a[168:171],v[84:87]
buffer_load_dwordx2 v[198:199],v245,s[8:11],s28 offen offset:768
M v[84:87],a[236:239],a[164:167],v[84:87]
ds_read_b128 a[104:107],v249 offset:35328
ds_read_b128 a[108:111],v250 offset:35328
M v[88:91],a[236:239],a[168:171],v[88:91]
v_add_f32 v240,v232,v241
v_sub_f32 v232,v232,v241
M v[88:91],a[224:227],a[172:175],v[88:91]
v_fma_f32 v241,2.0,v242,v243
v_fmac_f32 v243,-2.0,v242
M v[88:91],a[208:211],a[176:179],v[88:91]
buffer_load_dwordx2 v[200:201],v245,s[8:11],s28 offen offset:1152
M v[92:95],a[208:211],a[180:183],v[92:95]
s_add_u32 s28,s30,7471104
v_cvt_pk_bf16_f32 v233,v239,v244
v_cvt_pk_bf16_f32 v234,v240,v232
M v[92:95],a[224:227],a[176:179],v[92:95]
ds_read_b128 a[160:163],v249 offset:35840
v_cvt_pk_bf16_f32 v235,v241,v243
M v[92:95],a[236:239],a[172:175],v[92:95]
s_waitcnt vmcnt(31) lgkmcnt(4)
ds_read_b128 a[164:167],v250 offset:35840
ds_write_b16 v248,v233 offset:52224
M v[32:35],a[124:127],a[96:99],v[32:35]
s_waitcnt vmcnt(30) lgkmcnt(5)
buffer_load_dwordx2 v[204:205],v245,s[12:15],s28 offen offset:0
M v[32:35],a[140:143],a[100:103],v[32:35]
s_waitcnt vmcnt(30) lgkmcnt(4)
ds_write_b16_d16_hi v248,v233 offset:60928
M v[32:35],a[148:151],a[104:107],v[32:35]
s_waitcnt lgkmcnt(4)
ds_write_b16 v248,v234 offset:17408
M v[36:39],a[148:151],a[108:111],v[36:39]
buffer_load_dwordx2 v[214:215],v245,s[16:19],s28 offen offset:1536
M v[36:39],a[140:143],a[104:107],v[36:39]
ds_read_b128 a[168:171],v249 offset:36352
ds_write_b16_d16_hi v248,v234 offset:26112
M v[36:39],a[124:127],a[100:103],v[36:39]
ds_read_b128 a[172:175],v250 offset:36352
ds_write_b16 v248,v235 offset:34816
M v[40:43],a[124:127],a[104:107],v[40:43]
ds_write_b16_d16_hi v248,v235 offset:43520
M v[40:43],a[140:143],a[108:111],v[40:43]
s_waitcnt lgkmcnt(9)
buffer_load_dwordx2 v[206:207],v245,s[8:11],s28 offen offset:0
M v[40:43],a[148:151],a[160:163],v[40:43]
s_waitcnt lgkmcnt(8)
M v[44:47],a[148:151],a[164:167],v[44:47]
M v[44:47],a[140:143],a[160:163],v[44:47]
ds_read_b128 a[176:179],v250 offset:36864
M v[44:47],a[124:127],a[108:111],v[44:47]
buffer_load_dwordx2 v[208:209],v245,s[8:11],s28 offen offset:384
M v[48:51],a[124:127],a[160:163],v[48:51]
ds_read_b128 a[180:183],v249 offset:36864
M v[48:51],a[140:143],a[164:167],v[48:51]
s_waitcnt lgkmcnt(6)
M v[48:51],a[148:151],a[168:171],v[48:51]
s_waitcnt lgkmcnt(4)
M v[52:55],a[148:151],a[172:175],v[52:55]
buffer_load_dwordx2 v[210:211],v245,s[8:11],s28 offen offset:768
M v[52:55],a[140:143],a[168:171],v[52:55]
M v[52:55],a[124:127],a[164:167],v[52:55]
M v[56:59],a[124:127],a[168:171],v[56:59]
M v[56:59],a[140:143],a[172:175],v[56:59]
s_waitcnt lgkmcnt(1)
buffer_load_dwordx2 v[212:213],v245,s[8:11],s28 offen offset:1152
M v[56:59],a[148:151],a[176:179],v[56:59]
s_waitcnt lgkmcnt(0)
s_add_u32 s29,s30,6291520
M v[60:63],a[148:151],a[180:183],v[60:63]
M v[60:63],a[140:143],a[176:179],v[60:63]
M v[60:63],a[124:127],a[172:175],v[60:63]
s_waitcnt vmcnt(31)
buffer_load_short_d16_hi v239,v246,s[12:15],s29 offen offset:0
M v[64:67],a[184:187],a[96:99],v[64:67]
s_waitcnt vmcnt(31)
M v[64:67],a[188:191],a[100:103],v[64:67]
s_waitcnt vmcnt(30)
buffer_load_short_d16_hi v240,v246,s[8:11],s29 offen offset:0
M v[64:67],v[216:219],a[104:107],v[64:67]
s_waitcnt vmcnt(10)
v_lshlrev_b32 v234,16,v196
v_lshlrev_b32 v232,16,v192
M v[68:71],v[216:219],a[108:111],v[68:71]
buffer_load_short_d16_hi v241,v246,s[8:11],s29 offen offset:384
M v[68:71],a[188:191],a[104:107],v[68:71]
v_lshlrev_b32 v233,16,v194
v_lshlrev_b32 v237,16,v202
M v[68:71],a[184:187],a[100:103],v[68:71]
buffer_load_short_d16_hi v242,v246,s[8:11],s29 offen offset:768
M v[72:75],a[184:187],a[104:107],v[72:75]
s_waitcnt vmcnt(10)
v_lshlrev_b32 v236,16,v200
v_lshlrev_b32 v235,16,v198
M v[72:75],a[188:191],a[108:111],v[72:75]
buffer_load_short_d16_hi v243,v246,s[8:11],s29 offen offset:1152
M v[72:75],v[216:219],a[160:163],v[72:75]
v_fmac_f32 v232,s43,v234
v_fmac_f32 v237,4.0,v233
M v[76:79],v[216:219],a[164:167],v[76:79]
buffer_load_short_d16_hi v244,v246,s[16:19],s29 offen offset:1536
M v[76:79],a[188:191],a[160:163],v[76:79]
v_fma_f32 v238,-4.0,v234,v236
v_fmac_f32 v232,s45,v236
M v[76:79],a[184:187],a[108:111],v[76:79]
buffer_store_dwordx4 v[104:107],v252,s[24:27],s34 offen offset:1152 nt
M v[80:83],a[184:187],a[160:163],v[80:83]
s_add_u32 s34,s33,786432
v_fmac_f32 v237,s41,v235
v_sub_f32 v236,v236,v234
M v[80:83],a[188:191],a[164:167],v[80:83]
v_fma_f32 v234,-4.0,v233,v235
v_sub_f32 v235,v235,v233
M v[80:83],v[216:219],a[168:171],v[80:83]
buffer_load_dwordx4 a[120:123],v251,s[20:23],s48 offen offset:0 sc1
M v[84:87],v[216:219],a[172:175],v[84:87]
ds_read_b128 a[96:99],v249 offset:52224
ds_read_b128 a[100:103],v250 offset:52224
M v[84:87],a[188:191],a[168:171],v[84:87]
ds_read_b128 a[104:107],v249 offset:52736
v_add_f32 v233,v238,v234
M v[84:87],a[184:187],a[164:167],v[84:87]
ds_read_b128 a[108:111],v250 offset:52736
v_sub_f32 v238,v238,v234
M v[88:91],a[184:187],a[168:171],v[88:91]
buffer_load_dwordx4 a[132:135],v251,s[20:23],s48 offen offset:1024 sc1
M v[88:91],a[188:191],a[172:175],v[88:91]
v_fma_f32 v234,2.0,v235,v236
v_fmac_f32 v236,-2.0,v235
M v[88:91],v[216:219],a[176:179],v[88:91]
v_and_b32 v196,s42,v196
v_and_b32 v192,s42,v192
M v[92:95],v[216:219],a[180:183],v[92:95]
v_and_b32 v194,s42,v194
v_and_b32 v202,s42,v202
M v[92:95],a[188:191],a[176:179],v[92:95]
buffer_load_dwordx4 a[144:147],v251,s[20:23],s48 offen offset:2048 sc1
M v[92:95],a[184:187],a[172:175],v[92:95]
s_waitcnt lgkmcnt(3)
s_add_u32 s48,s44,107520
ds_read_b128 a[160:163],v249 offset:53248
ds_read_b128 a[164:167],v250 offset:53248
M v[32:35],a[128:131],a[96:99],v[32:35]
s_waitcnt lgkmcnt(4)
v_and_b32 v200,s42,v200
v_and_b32 v198,s42,v198
M v[32:35],a[136:139],a[100:103],v[32:35]
s_waitcnt lgkmcnt(3)
v_fmac_f32 v192,s43,v196
v_fmac_f32 v202,4.0,v194
M v[32:35],a[152:155],a[104:107],v[32:35]
s_waitcnt lgkmcnt(2)
buffer_store_dwordx4 v[112:115],v252,s[24:27],s34 offen offset:1152 nt
M v[36:39],a[152:155],a[108:111],v[36:39]
s_add_u32 s34,s33,1179648
v_fma_f32 v235,-4.0,v196,v200
v_fmac_f32 v192,s45,v200
M v[36:39],a[136:139],a[104:107],v[36:39]
ds_read_b128 a[168:171],v249 offset:53760
v_fmac_f32 v202,s41,v198
M v[36:39],a[128:131],a[100:103],v[36:39]
buffer_store_dwordx4 v[120:123],v252,s[24:27],s34 offen offset:1152 nt
M v[40:43],a[128:131],a[104:107],v[40:43]
s_add_u32 s34,s33,0
ds_read_b128 a[172:175],v250 offset:53760
v_sub_f32 v200,v200,v196
M v[40:43],a[136:139],a[108:111],v[40:43]
s_waitcnt lgkmcnt(3)
v_fma_f32 v196,-4.0,v194,v198
v_sub_f32 v198,v198,v194
M v[40:43],a[152:155],a[160:163],v[40:43]
s_waitcnt lgkmcnt(2)
buffer_load_dwordx4 a[252:255],v251,s[20:23],s48 offen offset:0 sc1
M v[44:47],a[152:155],a[164:167],v[44:47]
v_add_f32 v194,v235,v196
v_sub_f32 v235,v235,v196
M v[44:47],a[136:139],a[160:163],v[44:47]
ds_read_b128 a[176:179],v250 offset:54272
v_fma_f32 v196,2.0,v198,v200
M v[44:47],a[128:131],a[108:111],v[44:47]
ds_read_b128 a[180:183],v249 offset:54272
v_fmac_f32 v200,-2.0,v198
M v[48:51],a[128:131],a[160:163],v[48:51]
buffer_load_dwordx4 v[228:231],v251,s[20:23],s48 offen offset:1024 sc1
M v[48:51],a[136:139],a[164:167],v[48:51]
s_waitcnt lgkmcnt(3)
v_cvt_pk_bf16_f32 v192,v232,v192
v_cvt_pk_bf16_f32 v202,v237,v202
M v[48:51],a[152:155],a[168:171],v[48:51]
s_waitcnt lgkmcnt(2)
v_cvt_pk_bf16_f32 v194,v233,v194
v_cvt_pk_bf16_f32 v198,v234,v196
M v[52:55],a[152:155],a[172:175],v[52:55]
v_cvt_pk_bf16_f32 v196,v238,v235
v_cvt_pk_bf16_f32 v200,v236,v200
M v[52:55],a[136:139],a[168:171],v[52:55]
buffer_load_dwordx4 a[204:207],v251,s[20:23],s48 offen offset:2048 sc1
M v[52:55],a[128:131],a[164:167],v[52:55]
s_add_u32 s48,s44,162816
v_lshlrev_b32 v234,16,v197
v_lshlrev_b32 v232,16,v193
M v[56:59],a[128:131],a[168:171],v[56:59]
v_lshlrev_b32 v233,16,v195
v_lshlrev_b32 v237,16,v203
M v[56:59],a[136:139],a[172:175],v[56:59]
s_waitcnt lgkmcnt(1)
v_lshlrev_b32 v236,16,v201
v_lshlrev_b32 v235,16,v199
M v[56:59],a[152:155],a[176:179],v[56:59]
s_waitcnt lgkmcnt(0)
buffer_store_dwordx4 v[128:131],v252,s[24:27],s34 offen offset:1280 nt
M v[60:63],a[152:155],a[180:183],v[60:63]
s_add_u32 s34,s33,393216
v_fmac_f32 v232,s43,v234
v_fmac_f32 v237,4.0,v233
M v[60:63],a[136:139],a[176:179],v[60:63]
v_fma_f32 v238,-4.0,v234,v236
v_fmac_f32 v232,s45,v236
M v[60:63],a[128:131],a[172:175],v[60:63]
buffer_load_dwordx4 a[124:127],v251,s[20:23],s48 offen offset:0 sc1
M v[64:67],a[192:195],a[96:99],v[64:67]
v_fmac_f32 v237,s41,v235
v_sub_f32 v236,v236,v234
M v[64:67],a[200:203],a[100:103],v[64:67]
v_fma_f32 v234,-4.0,v233,v235
v_sub_f32 v235,v235,v233
M v[64:67],a[196:199],a[104:107],v[64:67]
v_add_f32 v233,v238,v234
v_sub_f32 v238,v238,v234
M v[68:71],a[196:199],a[108:111],v[68:71]
buffer_load_dwordx4 a[140:143],v251,s[20:23],s48 offen offset:1024 sc1
M v[68:71],a[200:203],a[104:107],v[68:71]
v_fma_f32 v234,2.0,v235,v236
v_fmac_f32 v236,-2.0,v235
M v[68:71],a[192:195],a[100:103],v[68:71]
v_and_b32 v197,s42,v197
v_and_b32 v193,s42,v193
M v[72:75],a[192:195],a[104:107],v[72:75]
v_and_b32 v195,s42,v195
v_and_b32 v203,s42,v203
M v[72:75],a[200:203],a[108:111],v[72:75]
buffer_load_dwordx4 a[148:151],v251,s[20:23],s48 offen offset:2048 sc1
M v[72:75],a[196:199],a[160:163],v[72:75]
s_add_u32 s48,s44,218112
v_and_b32 v201,s42,v201
v_and_b32 v199,s42,v199
M v[76:79],a[196:199],a[164:167],v[76:79]
v_fmac_f32 v193,s43,v197
v_fmac_f32 v203,4.0,v195
M v[76:79],a[200:203],a[160:163],v[76:79]
v_fma_f32 v235,-4.0,v197,v201
v_fmac_f32 v193,s45,v201
M v[76:79],a[192:195],a[108:111],v[76:79]
buffer_store_dwordx4 v[136:139],v252,s[24:27],s34 offen offset:1280 nt
M v[80:83],a[192:195],a[160:163],v[80:83]
s_add_u32 s34,s33,786432
v_add_u32 v249,0xfffece00,v249
v_add_u32 v250,0xfffece00,v250
M v[80:83],a[200:203],a[164:167],v[80:83]
v_fmac_f32 v203,s41,v199
v_sub_f32 v201,v201,v197
M v[80:83],a[196:199],a[168:171],v[80:83]
buffer_load_dwordx4 a[184:187],v251,s[20:23],s48 offen offset:0 sc1
M v[84:87],a[196:199],a[172:175],v[84:87]
ds_read_b128 a[96:99],v249 offset:60928
ds_read_b128 a[100:103],v250 offset:60928
M v[84:87],a[200:203],a[168:171],v[84:87]
ds_read_b128 a[104:107],v249 offset:61440
v_fma_f32 v197,-4.0,v195,v199
M v[84:87],a[192:195],a[164:167],v[84:87]
ds_read_b128 a[108:111],v250 offset:61440
v_sub_f32 v199,v199,v195
M v[88:91],a[192:195],a[168:171],v[88:91]
buffer_load_dwordx4 a[188:191],v251,s[20:23],s48 offen offset:1024 sc1
M v[88:91],a[200:203],a[172:175],v[88:91]
v_add_f32 v195,v235,v197
v_sub_f32 v235,v235,v197
M v[88:91],a[196:199],a[176:179],v[88:91]
v_fma_f32 v197,2.0,v199,v201
v_fmac_f32 v201,-2.0,v199
M v[92:95],a[196:199],a[180:183],v[92:95]
v_cvt_pk_bf16_f32 v193,v232,v193
v_cvt_pk_bf16_f32 v203,v237,v203
M v[92:95],a[200:203],a[176:179],v[92:95]
buffer_load_dwordx4 a[212:215],v251,s[20:23],s48 offen offset:2048 sc1
M v[92:95],a[192:195],a[172:175],v[92:95]
s_waitcnt lgkmcnt(3)
s_add_u32 s48,s44,273408
ds_read_b128 a[160:163],v249 offset:61952
ds_read_b128 a[164:167],v250 offset:61952
M v[32:35],a[112:115],a[96:99],v[32:35]
s_waitcnt lgkmcnt(4)
v_cvt_pk_bf16_f32 v195,v233,v195
v_cvt_pk_bf16_f32 v199,v234,v197
M v[32:35],a[116:119],a[100:103],v[32:35]
s_waitcnt lgkmcnt(3)
v_cvt_pk_bf16_f32 v197,v238,v235
v_cvt_pk_bf16_f32 v201,v236,v201
M v[32:35],a[156:159],a[104:107],v[32:35]
s_waitcnt lgkmcnt(2)
buffer_store_dwordx4 v[144:147],v252,s[24:27],s34 offen offset:1280 nt
M v[36:39],a[156:159],a[108:111],v[36:39]
s_add_u32 s34,s33,1179648
ds_write2st64_b64 v247,v[192:193],v[202:203] offset0:104 offset1:121
M v[36:39],a[116:119],a[104:107],v[36:39]
s_add_u32 s28,s30,6291520
buffer_load_dwordx2 v[192:193],v245,s[12:15],s28 offen offset:0
M v[36:39],a[112:115],a[100:103],v[36:39]
ds_read_b128 a[168:171],v249 offset:62464
ds_read_b128 a[172:175],v250 offset:62464
M v[40:43],a[112:115],a[104:107],v[40:43]
ds_write2st64_b64 v247,v[194:195],v[196:197] offset0:36 offset1:53
M v[40:43],a[116:119],a[108:111],v[40:43]
s_waitcnt lgkmcnt(5)
buffer_load_dwordx2 v[202:203],v245,s[16:19],s28 offen offset:1536
M v[40:43],a[156:159],a[160:163],v[40:43]
s_waitcnt lgkmcnt(4)
ds_write2st64_b64 v247,v[198:199],v[200:201] offset0:70 offset1:87
M v[44:47],a[156:159],a[164:167],v[44:47]
s_waitcnt vmcnt(28)
v_lshlrev_b32 v234,16,v208
v_lshlrev_b32 v232,16,v204
M v[44:47],a[116:119],a[160:163],v[44:47]
ds_read_b128 a[176:179],v250 offset:62976
v_lshlrev_b32 v233,16,v206
M v[44:47],a[112:115],a[108:111],v[44:47]
buffer_load_dwordx2 v[194:195],v245,s[8:11],s28 offen offset:0
M v[48:51],a[112:115],a[160:163],v[48:51]
ds_read_b128 a[180:183],v249 offset:62976
v_lshlrev_b32 v237,16,v214
M v[48:51],a[116:119],a[164:167],v[48:51]
s_waitcnt vmcnt(27) lgkmcnt(5)
v_lshlrev_b32 v236,16,v212
v_lshlrev_b32 v235,16,v210
M v[48:51],a[156:159],a[168:171],v[48:51]
s_waitcnt lgkmcnt(4)
v_fmac_f32 v232,s43,v234
v_fmac_f32 v237,4.0,v233
M v[52:55],a[156:159],a[172:175],v[52:55]
buffer_load_dwordx2 v[196:197],v245,s[8:11],s28 offen offset:384
M v[52:55],a[116:119],a[168:171],v[52:55]
v_fma_f32 v238,-4.0,v234,v236
v_fmac_f32 v232,s45,v236
M v[52:55],a[112:115],a[164:167],v[52:55]
v_fmac_f32 v237,s41,v235
v_sub_f32 v236,v236,v234
M v[56:59],a[112:115],a[168:171],v[56:59]
v_fma_f32 v234,-4.0,v233,v235
v_sub_f32 v235,v235,v233
M v[56:59],a[116:119],a[172:175],v[56:59]
s_waitcnt lgkmcnt(1)
buffer_load_dwordx2 v[198:199],v245,s[8:11],s28 offen offset:768
M v[56:59],a[156:159],a[176:179],v[56:59]
s_waitcnt lgkmcnt(0)
v_add_f32 v233,v238,v234
v_sub_f32 v238,v238,v234
M v[60:63],a[156:159],a[180:183],v[60:63]
v_fma_f32 v234,2.0,v235,v236
v_fmac_f32 v236,-2.0,v235
M v[60:63],a[116:119],a[176:179],v[60:63]
v_and_b32 v208,s42,v208
v_and_b32 v204,s42,v204
M v[60:63],a[112:115],a[172:175],v[60:63]
buffer_load_dwordx2 v[200:201],v245,s[8:11],s28 offen offset:1152
M v[64:67],a[228:231],a[96:99],v[64:67]
v_and_b32 v206,s42,v206
v_and_b32 v214,s42,v214
M v[64:67],v[220:223],a[100:103],v[64:67]
v_and_b32 v212,s42,v212
v_and_b32 v210,s42,v210
M v[64:67],a[232:235],a[104:107],v[64:67]
v_fmac_f32 v204,s43,v208
v_fmac_f32 v214,4.0,v206
M v[68:71],a[232:235],a[108:111],v[68:71]
buffer_store_dwordx4 v[152:155],v252,s[24:27],s34 offen offset:1280 nt
M v[68:71],v[220:223],a[104:107],v[68:71]
v_fma_f32 v235,-4.0,v208,v212
v_fmac_f32 v204,s45,v212
M v[68:71],a[228:231],a[100:103],v[68:71]
v_fmac_f32 v214,s41,v210
v_sub_f32 v212,v212,v208
M v[72:75],a[228:231],a[104:107],v[72:75]
buffer_load_dwordx4 a[128:131],v251,s[20:23],s48 offen offset:0 sc1
M v[72:75],v[220:223],a[108:111],v[72:75]
v_fma_f32 v208,-4.0,v206,v210
v_sub_f32 v210,v210,v206
M v[72:75],a[232:235],a[160:163],v[72:75]
v_add_f32 v206,v235,v208
v_sub_f32 v235,v235,v208
M v[76:79],a[232:235],a[164:167],v[76:79]
v_fma_f32 v208,2.0,v210,v212
v_fmac_f32 v212,-2.0,v210
M v[76:79],v[220:223],a[160:163],v[76:79]
buffer_load_dwordx4 a[136:139],v251,s[20:23],s48 offen offset:1024 sc1
M v[76:79],a[228:231],a[108:111],v[76:79]
v_cvt_pk_bf16_f32 v204,v232,v204
v_cvt_pk_bf16_f32 v214,v237,v214
M v[80:83],a[228:231],a[160:163],v[80:83]
v_cvt_pk_bf16_f32 v206,v233,v206
v_cvt_pk_bf16_f32 v210,v234,v208
M v[80:83],v[220:223],a[164:167],v[80:83]
v_cvt_pk_bf16_f32 v208,v238,v235
v_cvt_pk_bf16_f32 v212,v236,v212
M v[80:83],a[232:235],a[168:171],v[80:83]
buffer_load_dwordx4 a[152:155],v251,s[20:23],s48 offen offset:2048 sc1
M v[84:87],a[232:235],a[172:175],v[84:87]
s_add_u32 s48,s44,328704
ds_read_b128 a[96:99],v249 offset:0
ds_read_b128 a[100:103],v250 offset:0
M v[84:87],v[220:223],a[168:171],v[84:87]
ds_read_b128 a[104:107],v249 offset:512
v_lshlrev_b32 v234,16,v209
M v[84:87],a[228:231],a[164:167],v[84:87]
ds_read_b128 a[108:111],v250 offset:512
v_lshlrev_b32 v232,16,v205
M v[88:91],a[228:231],a[168:171],v[88:91]
buffer_load_dwordx4 a[248:251],v251,s[20:23],s48 offen offset:0 sc1
M v[88:91],v[220:223],a[172:175],v[88:91]
v_lshlrev_b32 v233,16,v207
v_lshlrev_b32 v237,16,v215
M v[88:91],a[232:235],a[176:179],v[88:91]
v_lshlrev_b32 v236,16,v213
v_lshlrev_b32 v235,16,v211
M v[92:95],a[232:235],a[180:183],v[92:95]
v_fmac_f32 v232,s43,v234
v_fmac_f32 v237,4.0,v233
M v[92:95],v[220:223],a[176:179],v[92:95]
buffer_load_dwordx4 a[220:223],v251,s[20:23],s48 offen offset:1024 sc1
M v[92:95],a[228:231],a[172:175],v[92:95]
s_waitcnt vmcnt(28) lgkmcnt(3)
ds_read_b128 a[160:163],v249 offset:1024
ds_read_b128 a[164:167],v250 offset:1024
M v[160:163],a[120:123],a[96:99],v[160:163]
s_waitcnt vmcnt(27) lgkmcnt(4)
v_fma_f32 v238,-4.0,v234,v236
v_fmac_f32 v232,s45,v236
M v[160:163],a[132:135],a[100:103],v[160:163]
s_waitcnt vmcnt(26) lgkmcnt(3)
v_fmac_f32 v237,s41,v235
v_sub_f32 v236,v236,v234
M v[160:163],a[144:147],a[104:107],v[160:163]
s_waitcnt lgkmcnt(2)
buffer_load_dwordx4 a[216:219],v251,s[20:23],s48 offen offset:2048 sc1
M v[164:167],a[144:147],a[108:111],v[164:167]
s_add_u32 s46,s44,9216
v_fma_f32 v234,-4.0,v233,v235
v_sub_f32 v235,v235,v233
M v[164:167],a[132:135],a[104:107],v[164:167]
ds_read_b128 a[96:99],v249 offset:1536
v_add_f32 v233,v238,v234
M v[164:167],a[120:123],a[100:103],v[164:167]
ds_read_b128 a[100:103],v250 offset:1536
v_sub_f32 v238,v238,v234
M v[168:171],a[120:123],a[104:107],v[168:171]
buffer_load_dwordx4 a[112:115],v251,s[20:23],s46 offen offset:0 sc1
M v[168:171],a[132:135],a[108:111],v[168:171]
s_waitcnt lgkmcnt(3)
v_fma_f32 v234,2.0,v235,v236
v_fmac_f32 v236,-2.0,v235
M v[168:171],a[144:147],a[160:163],v[168:171]
s_waitcnt lgkmcnt(2)
v_and_b32 v209,s42,v209
v_and_b32 v205,s42,v205
M v[172:175],a[144:147],a[164:167],v[172:175]
v_and_b32 v207,s42,v207
v_and_b32 v215,s42,v215
M v[172:175],a[132:135],a[160:163],v[172:175]
buffer_load_dwordx4 a[116:119],v251,s[20:23],s46 offen offset:1024 sc1
M v[172:175],a[120:123],a[108:111],v[172:175]
ds_read_b128 a[104:107],v250 offset:2048
ds_read_b128 a[108:111],v249 offset:2048
M v[176:179],a[120:123],a[160:163],v[176:179]
v_add_u32 v249,0x15400,v249
v_add_u32 v250,0x15400,v250
M v[176:179],a[132:135],a[164:167],v[176:179]
s_waitcnt lgkmcnt(3)
v_and_b32 v213,s42,v213
v_and_b32 v211,s42,v211
M v[176:179],a[144:147],a[96:99],v[176:179]
s_waitcnt lgkmcnt(2)
buffer_load_dwordx4 a[156:159],v251,s[20:23],s46 offen offset:2048 sc1
M v[180:183],a[144:147],a[100:103],v[180:183]
ds_read_b128 a[160:163],v249 offset:0
ds_read_b128 a[168:171],v250 offset:0
M v[180:183],a[132:135],a[96:99],v[180:183]
ds_read_b128 a[172:175],v249 offset:512
v_fmac_f32 v205,s43,v209
M v[180:183],a[120:123],a[164:167],v[180:183]
ds_read_b128 a[164:167],v250 offset:512
v_fmac_f32 v215,4.0,v207
M v[184:187],a[120:123],a[96:99],v[184:187]
global_load_dword a96,v251,s[64:65]
M v[184:187],a[132:135],a[100:103],v[184:187]
s_waitcnt lgkmcnt(5)
s_add_u32 s47,s44,12288
v_fma_f32 v235,-4.0,v209,v213
v_fmac_f32 v205,s45,v213
M v[184:187],a[144:147],a[104:107],v[184:187]
s_waitcnt lgkmcnt(4)
buffer_load_dwordx4 a[96:99],v251,s[20:23],s47 offen offset:0 sc1
M v[188:191],a[144:147],a[108:111],v[188:191]
v_fmac_f32 v215,s41,v211
v_sub_f32 v213,v213,v209
M v[188:191],a[132:135],a[104:107],v[188:191]
ds_read_b128 a[104:107],v249 offset:1024
v_fma_f32 v209,-4.0,v207,v211
M v[188:191],a[120:123],a[100:103],v[188:191]
s_waitcnt vmcnt(29) lgkmcnt(4)
ds_read_b128 a[100:103],v250 offset:1024
v_sub_f32 v211,v211,v207
M v[160:163],a[252:255],a[160:163],v[160:163]
s_waitcnt vmcnt(28) lgkmcnt(4)
buffer_load_dwordx4 a[176:179],v251,s[20:23],s47 offen offset:1024 sc1
M v[160:163],v[228:231],a[168:171],v[160:163]
s_waitcnt vmcnt(28) lgkmcnt(3)
v_add_f32 v207,v235,v209
v_sub_f32 v235,v235,v209
M v[160:163],a[204:207],a[172:175],v[160:163]
s_waitcnt lgkmcnt(2)
v_fma_f32 v209,2.0,v211,v213
v_fmac_f32 v213,-2.0,v211
M v[164:167],a[204:207],a[164:167],v[164:167]
v_cvt_pk_bf16_f32 v205,v232,v205
v_cvt_pk_bf16_f32 v215,v237,v215
M v[164:167],v[228:231],a[172:175],v[164:167]
buffer_load_dwordx4 a[180:183],v251,s[20:23],s47 offen offset:2048 sc1
M v[164:167],a[252:255],a[168:171],v[164:167]
ds_read_b128 a[108:111],v249 offset:1536
ds_read_b128 a[120:123],v250 offset:1536
M v[168:171],a[252:255],a[172:175],v[168:171]
v_cvt_pk_bf16_f32 v207,v233,v207
v_cvt_pk_bf16_f32 v211,v234,v209
M v[168:171],v[228:231],a[164:167],v[168:171]
s_waitcnt lgkmcnt(3)
v_cvt_pk_bf16_f32 v209,v238,v235
v_cvt_pk_bf16_f32 v213,v236,v213
M v[168:171],a[204:207],a[104:107],v[168:171]
s_waitcnt lgkmcnt(2)
ds_write2st64_b64 v247,v[204:205],v[214:215] offset0:105 offset1:122
M v[172:175],a[204:207],a[100:103],v[172:175]
s_add_u32 s28,s30,6684736
buffer_load_dwordx2 v[204:205],v245,s[12:15],s28 offen offset:0
M v[172:175],v[228:231],a[104:107],v[172:175]
ds_read_b128 a[132:135],v250 offset:2048
ds_write2st64_b64 v247,v[206:207],v[208:209] offset0:37 offset1:54
M v[172:175],a[252:255],a[164:167],v[172:175]
buffer_load_dwordx2 v[214:215],v245,s[16:19],s28 offen offset:1536
M v[176:179],a[252:255],a[104:107],v[176:179]
s_add_u32 s48,s44,15360
ds_read_b128 a[144:147],v249 offset:2048
ds_write2st64_b64 v247,v[210:211],v[212:213] offset0:71 offset1:88
M v[176:179],v[228:231],a[100:103],v[176:179]
s_waitcnt lgkmcnt(6)
s_barrier
v_cvt_pk_bf16_f32 v32,v32,v33
M v[176:179],a[204:207],a[108:111],v[176:179]
s_waitcnt lgkmcnt(5)
buffer_load_dwordx2 v[206:207],v245,s[8:11],s28 offen offset:0
M v[180:183],a[204:207],a[120:123],v[180:183]
ds_read_b128 a[104:107],v249 offset:17408
ds_read_b128 a[160:163],v250 offset:17408
M v[180:183],v[228:231],a[108:111],v[180:183]
ds_read_b128 a[164:167],v249 offset:17920
v_cvt_pk_bf16_f32 v33,v34,v35
M v[180:183],a[252:255],a[100:103],v[180:183]
buffer_load_dwordx2 v[208:209],v245,s[8:11],s28 offen offset:384
M v[184:187],a[252:255],a[108:111],v[184:187]
ds_read_b128 a[100:103],v250 offset:17920
v_cvt_pk_bf16_f32 v36,v36,v37
M v[184:187],v[228:231],a[120:123],v[184:187]
s_waitcnt lgkmcnt(7)
v_cvt_pk_bf16_f32 v37,v38,v39
M v[184:187],a[204:207],a[132:135],v[184:187]
s_waitcnt lgkmcnt(5)
ds_write2st64_b64 v253,v[32:33],v[36:37] offset0:0 offset1:4
M v[188:191],a[204:207],a[144:147],v[188:191]
buffer_load_dwordx2 v[210:211],v245,s[8:11],s28 offen offset:768
M v[188:191],v[228:231],a[132:135],v[188:191]
ds_read_b128 a[132:135],v249 offset:18432
v_cvt_pk_bf16_f32 v40,v40,v41
M v[188:191],a[252:255],a[120:123],v[188:191]
s_waitcnt vmcnt(32) lgkmcnt(5)
ds_read_b128 a[120:123],v250 offset:18432
v_cvt_pk_bf16_f32 v41,v42,v43
M v[160:163],a[124:127],a[104:107],v[160:163]
s_waitcnt vmcnt(31) lgkmcnt(5)
v_cvt_pk_bf16_f32 v44,v44,v45
v_cvt_pk_bf16_f32 v45,v46,v47
M v[160:163],a[140:143],a[160:163],v[160:163]
s_waitcnt vmcnt(30) lgkmcnt(4)
buffer_load_dwordx2 v[212:213],v245,s[8:11],s28 offen offset:1152
M v[160:163],a[148:151],a[164:167],v[160:163]
s_waitcnt lgkmcnt(3)
ds_write2st64_b64 v253,v[40:41],v[44:45] offset0:8 offset1:12
M v[164:167],a[148:151],a[100:103],v[164:167]
v_cvt_pk_bf16_f32 v48,v48,v49
v_cvt_pk_bf16_f32 v49,v50,v51
M v[164:167],a[140:143],a[164:167],v[164:167]
buffer_load_dwordx4 a[108:111],v251,s[20:23],s48 offen offset:0 sc1
M v[164:167],a[124:127],a[160:163],v[164:167]
ds_read_b128 a[104:107],v249 offset:18944
ds_read_b128 a[144:147],v250 offset:18944
M v[168:171],a[124:127],a[164:167],v[168:171]
v_cvt_pk_bf16_f32 v52,v52,v53
v_cvt_pk_bf16_f32 v53,v54,v55
M v[168:171],a[140:143],a[100:103],v[168:171]
s_waitcnt lgkmcnt(4)
ds_write2st64_b64 v253,v[48:49],v[52:53] offset0:136 offset1:140
M v[168:171],a[148:151],a[132:135],v[168:171]
s_waitcnt lgkmcnt(4)
buffer_load_dwordx4 a[168:171],v251,s[20:23],s48 offen offset:1024 sc1
M v[172:175],a[148:151],a[120:123],v[172:175]
v_cvt_pk_bf16_f32 v56,v56,v57
v_cvt_pk_bf16_f32 v57,v58,v59
M v[172:175],a[140:143],a[132:135],v[172:175]
ds_read_b128 a[160:163],v250 offset:19456
v_cvt_pk_bf16_f32 v60,v60,v61
M v[172:175],a[124:127],a[100:103],v[172:175]
buffer_load_dwordx4 a[172:175],v251,s[20:23],s48 offen offset:2048 sc1
M v[176:179],a[124:127],a[132:135],v[176:179]
s_add_u32 s46,s44,18432
ds_read_b128 a[100:103],v249 offset:19456
v_cvt_pk_bf16_f32 v61,v62,v63
M v[176:179],a[140:143],a[120:123],v[176:179]
s_waitcnt lgkmcnt(4)
ds_write2st64_b64 v253,v[56:57],v[60:61] offset0:144 offset1:148
M v[176:179],a[148:151],a[104:107],v[176:179]
s_waitcnt lgkmcnt(4)
ds_read_b128 a[132:135],v249 offset:34816
v_cvt_pk_bf16_f32 v64,v64,v65
M v[180:183],a[148:151],a[144:147],v[180:183]
ds_read_b128 a[164:167],v250 offset:34816
v_cvt_pk_bf16_f32 v65,v66,v67
M v[180:183],a[140:143],a[104:107],v[180:183]
ds_read_b128 a[244:247],v249 offset:35328
v_cvt_pk_bf16_f32 v68,v68,v69
M v[180:183],a[124:127],a[120:123],v[180:183]
ds_read_b128 a[120:123],v250 offset:35328
v_cvt_pk_bf16_f32 v69,v70,v71
M v[184:187],a[124:127],a[104:107],v[184:187]
buffer_load_dwordx4 a[240:243],v251,s[20:23],s46 offen offset:0 sc1
M v[184:187],a[140:143],a[144:147],v[184:187]
s_waitcnt lgkmcnt(6)
ds_write2st64_b64 v253,v[64:65],v[68:69] offset0:170 offset1:174
M v[184:187],a[148:151],a[160:163],v[184:187]
s_waitcnt lgkmcnt(6)
buffer_load_dwordx4 v[224:227],v251,s[20:23],s46 offen offset:1024 sc1
M v[188:191],a[148:151],a[100:103],v[188:191]
v_cvt_pk_bf16_f32 v72,v72,v73
v_cvt_pk_bf16_f32 v73,v74,v75
M v[188:191],a[140:143],a[160:163],v[188:191]
ds_read_b128 a[100:103],v249 offset:35840
v_cvt_pk_bf16_f32 v76,v76,v77
M v[188:191],a[124:127],a[144:147],v[188:191]
s_waitcnt vmcnt(34) lgkmcnt(5)
ds_read_b128 a[104:107],v250 offset:35840
v_cvt_pk_bf16_f32 v77,v78,v79
M v[160:163],a[184:187],a[132:135],v[160:163]
s_waitcnt vmcnt(33) lgkmcnt(5)
buffer_load_dwordx4 a[208:211],v251,s[20:23],s46 offen offset:2048 sc1
M v[160:163],a[188:191],a[164:167],v[160:163]
s_waitcnt vmcnt(33) lgkmcnt(4)
ds_write2st64_b64 v253,v[72:73],v[76:77] offset0:178 offset1:182
M v[160:163],a[212:215],a[244:247],v[160:163]
s_waitcnt lgkmcnt(4)
v_cvt_pk_bf16_f32 v80,v80,v81
v_cvt_pk_bf16_f32 v81,v82,v83
M v[164:167],a[212:215],a[120:123],v[164:167]
v_cvt_pk_bf16_f32 v84,v84,v85
v_cvt_pk_bf16_f32 v85,v86,v87
M v[164:167],a[188:191],a[244:247],v[164:167]
ds_read_b128 a[124:127],v249 offset:36352
ds_write2st64_b64 v253,v[80:81],v[84:85] offset0:204 offset1:208
M v[164:167],a[184:187],a[164:167],v[164:167]
ds_read_b128 a[132:135],v250 offset:36352
v_cvt_pk_bf16_f32 v88,v88,v89
M v[168:171],a[184:187],a[244:247],v[168:171]
v_cvt_pk_bf16_f32 v89,v90,v91
v_cvt_pk_bf16_f32 v92,v92,v93
M v[168:171],a[188:191],a[120:123],v[168:171]
s_waitcnt lgkmcnt(5)
v_cvt_pk_bf16_f32 v93,v94,v95
M v[168:171],a[212:215],a[100:103],v[168:171]
s_waitcnt lgkmcnt(4)
ds_write2st64_b64 v253,v[88:89],v[92:93] offset0:212 offset1:216
M v[172:175],a[212:215],a[104:107],v[172:175]
M v[172:175],a[188:191],a[100:103],v[172:175]
ds_read_b128 a[140:143],v250 offset:36864
M v[172:175],a[184:187],a[120:123],v[172:175]
s_waitcnt lgkmcnt(1)
s_barrier
ds_read_b128 v[32:35],v251 offset:0
M v[176:179],a[184:187],a[100:103],v[176:179]
s_add_u32 s47,s44,21504
ds_read_b128 v[40:43],v251 offset:4096
ds_read_b128 v[48:51],v4 offset:0
M v[176:179],a[188:191],a[104:107],v[176:179]
ds_read_b128 v[56:59],v4 offset:4096
ds_read_b128 v[64:67],v4 offset:17408
M v[176:179],a[212:215],a[124:127],v[176:179]
ds_read_b128 v[72:75],v4 offset:21504
ds_read_b128 v[80:83],v4 offset:34816
M v[180:183],a[212:215],a[132:135],v[180:183]
ds_read_b128 v[88:91],v4 offset:38912
ds_read_b128 a[120:123],v249 offset:36864
M v[180:183],a[188:191],a[124:127],v[180:183]
s_waitcnt lgkmcnt(8)
s_add_u32 s34,s33,0
buffer_store_dwordx4 v[32:35],v252,s[24:27],s34 offen offset:128 nt
M v[180:183],a[184:187],a[104:107],v[180:183]
s_waitcnt lgkmcnt(7)
s_add_u32 s34,s33,393216
buffer_store_dwordx4 v[40:43],v252,s[24:27],s34 offen offset:128 nt
M v[184:187],a[184:187],a[124:127],v[184:187]
s_add_u32 s34,s33,786432
ds_read_b128 a[100:103],v249 offset:52224
ds_read_b128 a[144:147],v250 offset:52224
M v[184:187],a[188:191],a[132:135],v[184:187]
ds_read_b128 a[148:151],v249 offset:52736
ds_read_b128 a[104:107],v250 offset:52736
M v[184:187],a[212:215],a[140:143],v[184:187]
s_waitcnt lgkmcnt(4)
buffer_store_dwordx4 v[48:51],v252,s[24:27],s34 offen offset:128 nt
M v[188:191],a[212:215],a[120:123],v[188:191]
s_add_u32 s34,s33,1179648
M v[188:191],a[188:191],a[140:143],v[188:191]
ds_read_b128 a[120:123],v249 offset:53248
M v[188:191],a[184:187],a[132:135],v[188:191]
s_waitcnt vmcnt(27) lgkmcnt(4)
buffer_store_dwordx4 v[56:59],v252,s[24:27],s34 offen offset:128 nt
M v[160:163],a[128:131],a[100:103],v[160:163]
s_waitcnt vmcnt(27) lgkmcnt(3)
s_add_u32 s34,s33,0
ds_read_b128 a[124:127],v250 offset:53248
M v[160:163],a[136:139],a[144:147],v[160:163]
s_waitcnt vmcnt(26) lgkmcnt(3)
M v[160:163],a[152:155],a[148:151],v[160:163]
s_waitcnt lgkmcnt(2)
buffer_store_dwordx4 v[64:67],v252,s[24:27],s34 offen offset:256 nt
M v[164:167],a[152:155],a[104:107],v[164:167]
s_add_u32 s34,s33,393216
M v[164:167],a[136:139],a[148:151],v[164:167]
ds_read_b128 a[100:103],v249 offset:53760
M v[164:167],a[128:131],a[144:147],v[164:167]
buffer_store_dwordx4 v[72:75],v252,s[24:27],s34 offen offset:256 nt
M v[168:171],a[128:131],a[148:151],v[168:171]
s_add_u32 s34,s33,786432
ds_read_b128 a[132:135],v250 offset:53760
M v[168:171],a[136:139],a[104:107],v[168:171]
s_waitcnt lgkmcnt(3)
M v[168:171],a[152:155],a[120:123],v[168:171]
s_waitcnt lgkmcnt(2)
buffer_store_dwordx4 v[80:83],v252,s[24:27],s34 offen offset:256 nt
M v[172:175],a[152:155],a[124:127],v[172:175]
s_add_u32 s34,s33,1179648
M v[172:175],a[136:139],a[120:123],v[172:175]
ds_read_b128 a[140:143],v250 offset:54272
M v[172:175],a[128:131],a[104:107],v[172:175]
buffer_store_dwordx4 v[88:91],v252,s[24:27],s34 offen offset:256 nt
M v[176:179],a[128:131],a[120:123],v[176:179]
ds_read_b128 a[104:107],v249 offset:54272
v_add_u32 v249,0xfffece00,v249
M v[176:179],a[136:139],a[124:127],v[176:179]
s_waitcnt lgkmcnt(3)
v_add_u32 v250,0xfffece00,v250
M v[176:179],a[152:155],a[100:103],v[176:179]
s_waitcnt lgkmcnt(2)
buffer_load_dwordx4 a[164:167],v251,s[20:23],s47 offen offset:0 sc1
M v[180:183],a[152:155],a[132:135],v[180:183]
ds_read_b128 a[120:123],v249 offset:60928
ds_read_b128 a[144:147],v250 offset:60928
M v[180:183],a[136:139],a[100:103],v[180:183]
ds_read_b128 a[148:151],v249 offset:61440
M v[180:183],a[128:131],a[124:127],v[180:183]
ds_read_b128 a[124:127],v250 offset:61440
M v[184:187],a[128:131],a[100:103],v[184:187]
buffer_load_dwordx4 a[160:163],v251,s[20:23],s47 offen offset:1024 sc1
M v[184:187],a[136:139],a[132:135],v[184:187]
s_waitcnt lgkmcnt(5)
M v[184:187],a[152:155],a[140:143],v[184:187]
s_waitcnt lgkmcnt(4)
M v[188:191],a[152:155],a[104:107],v[188:191]
M v[188:191],a[136:139],a[140:143],v[188:191]
buffer_load_dwordx4 a[224:227],v251,s[20:23],s47 offen offset:2048 sc1
M v[188:191],a[128:131],a[132:135],v[188:191]
s_waitcnt vmcnt(32) lgkmcnt(3)
s_add_u32 s48,s44,24576
ds_read_b128 a[100:103],v249 offset:61952
ds_read_b128 a[104:107],v250 offset:61952
M v[160:163],a[248:251],a[120:123],v[160:163]
s_waitcnt vmcnt(31) lgkmcnt(4)
M v[160:163],a[220:223],a[144:147],v[160:163]
s_waitcnt vmcnt(30) lgkmcnt(3)
M v[160:163],a[216:219],a[148:151],v[160:163]
s_waitcnt lgkmcnt(2)
buffer_load_dwordx4 a[236:239],v251,s[20:23],s48 offen offset:0 sc1
M v[164:167],a[216:219],a[124:127],v[164:167]
M v[164:167],a[220:223],a[148:151],v[164:167]
ds_read_b128 a[120:123],v249 offset:62464
M v[164:167],a[248:251],a[144:147],v[164:167]
ds_read_b128 a[128:131],v250 offset:62464
s_nop 0
v_cvt_pk_bf16_f32 v160,v160,v161
M v[168:171],a[248:251],a[148:151],v[168:171]
buffer_load_dwordx4 v[216:219],v251,s[20:23],s48 offen offset:1024 sc1
M v[168:171],a[220:223],a[124:127],v[168:171]
s_waitcnt lgkmcnt(3)
v_cvt_pk_bf16_f32 v161,v162,v163
M v[168:171],a[216:219],a[100:103],v[168:171]
s_waitcnt lgkmcnt(2)
ds_read_b128 a[132:135],v250 offset:62976
ds_read_b128 a[136:139],v249 offset:62976
M v[172:175],a[216:219],a[104:107],v[172:175]
v_cvt_pk_bf16_f32 v164,v164,v165
v_cvt_pk_bf16_f32 v165,v166,v167
M v[172:175],a[220:223],a[100:103],v[172:175]
buffer_load_dwordx4 a[196:199],v251,s[20:23],s48 offen offset:2048 sc1
M v[172:175],a[248:251],a[124:127],v[172:175]
M v[176:179],a[248:251],a[100:103],v[176:179]
s_add_u32 s46,s44,27648
M v[176:179],a[220:223],a[104:107],v[176:179]
s_waitcnt lgkmcnt(3)
M v[176:179],a[216:219],a[120:123],v[176:179]
s_waitcnt lgkmcnt(0)
s_barrier
ds_read_b128 a[100:103],v249 offset:0
M v[180:183],a[216:219],a[128:131],v[180:183]
ds_read_b128 a[124:127],v250 offset:0
ds_write2st64_b64 v253,v[160:161],v[164:165] offset0:221 offset1:225
M v[180:183],a[220:223],a[120:123],v[180:183]
ds_read_b128 a[140:143],v249 offset:512
v_cvt_pk_bf16_f32 v168,v168,v169
M v[180:183],a[248:251],a[104:107],v[180:183]
ds_read_b128 a[104:107],v250 offset:512
v_cvt_pk_bf16_f32 v169,v170,v171
M v[184:187],a[248:251],a[120:123],v[184:187]
buffer_load_dwordx4 a[200:203],v251,s[20:23],s46 offen offset:0 sc1
M v[184:187],a[220:223],a[128:131],v[184:187]
v_cvt_pk_bf16_f32 v172,v172,v173
v_cvt_pk_bf16_f32 v173,v174,v175
M v[184:187],a[216:219],a[132:135],v[184:187]
ds_write2st64_b64 v253,v[168:169],v[172:173] offset0:229 offset1:233
M v[188:191],a[216:219],a[136:139],v[188:191]
v_cvt_pk_bf16_f32 v176,v176,v177
v_cvt_pk_bf16_f32 v177,v178,v179
M v[188:191],a[220:223],a[132:135],v[188:191]
ds_read_b128 a[120:123],v249 offset:1024
v_cvt_pk_bf16_f32 v180,v180,v181
M v[188:191],a[248:251],a[128:131],v[188:191]
s_waitcnt vmcnt(33) lgkmcnt(6)
ds_read_b128 a[128:131],v250 offset:1024
v_cvt_pk_bf16_f32 v181,v182,v183
M a[0:3],a[112:115],a[100:103],0
s_waitcnt vmcnt(32) lgkmcnt(6)
ds_write2st64_b64 v253,v[176:177],v[180:181] offset0:238 offset1:242
M a[0:3],a[116:119],a[124:127],a[0:3]
s_waitcnt vmcnt(31) lgkmcnt(5)
v_cvt_pk_bf16_f32 v184,v184,v185
v_cvt_pk_bf16_f32 v185,v186,v187
M a[0:3],a[156:159],a[140:143],a[0:3]
s_waitcnt lgkmcnt(4)
v_cvt_pk_bf16_f32 v188,v188,v189
v_cvt_pk_bf16_f32 v189,v190,v191
M a[4:7],a[156:159],a[104:107],0
ds_write2st64_b64 v253,v[184:185],v[188:189] offset0:246 offset1:250
M a[4:7],a[116:119],a[140:143],a[4:7]
ds_read_b128 a[132:135],v249 offset:1536
v_lshlrev_b32 v234,16,v196
M a[4:7],a[112:115],a[124:127],a[4:7]
ds_read_b128 a[136:139],v250 offset:1536
v_lshlrev_b32 v232,16,v192
M a[8:11],a[112:115],a[140:143],0
v_lshlrev_b32 v233,16,v194
v_lshlrev_b32 v237,16,v202
M a[8:11],a[116:119],a[104:107],a[8:11]
s_waitcnt lgkmcnt(5)
v_lshlrev_b32 v236,16,v200
v_lshlrev_b32 v235,16,v198
M a[8:11],a[156:159],a[120:123],a[8:11]
s_waitcnt lgkmcnt(2)
s_barrier
ds_read_b128 v[160:163],v4 offset:43520
M a[12:15],a[156:159],a[128:131],0
ds_read_b128 v[168:171],v4 offset:47616
ds_read_b128 v[176:179],v4 offset:52224
M a[12:15],a[116:119],a[120:123],a[12:15]
ds_read_b128 v[184:187],v4 offset:56320
ds_read_b128 a[144:147],v250 offset:2048
M a[12:15],a[112:115],a[104:107],a[12:15]
ds_read_b128 a[148:151],v249 offset:2048
v_fmac_f32 v232,s43,v234
M a[16:19],a[112:115],a[120:123],0
v_fmac_f32 v237,4.0,v233
v_fma_f32 v238,-4.0,v234,v236
M a[16:19],a[116:119],a[128:131],a[16:19]
s_waitcnt lgkmcnt(5)
s_add_u32 s34,s33,0
buffer_store_dwordx4 v[160:163],v252,s[24:27],s34 offen offset:1408 nt
M a[16:19],a[156:159],a[132:135],a[16:19]
s_waitcnt lgkmcnt(4)
s_add_u32 s34,s33,393216
buffer_store_dwordx4 v[168:171],v252,s[24:27],s34 offen offset:1408 nt
M a[20:23],a[156:159],a[136:139],0
s_add_u32 s34,s33,786432
v_fmac_f32 v232,s45,v236
v_fmac_f32 v237,s41,v235
M a[20:23],a[116:119],a[132:135],a[20:23]
v_sub_f32 v236,v236,v234
v_fma_f32 v234,-4.0,v233,v235
M a[20:23],a[112:115],a[128:131],a[20:23]
s_waitcnt lgkmcnt(3)
buffer_store_dwordx4 v[176:179],v252,s[24:27],s34 offen offset:1408 nt
M a[24:27],a[112:115],a[132:135],0
s_add_u32 s34,s33,1179648
v_sub_f32 v235,v235,v233
v_add_f32 v233,v238,v234
M a[24:27],a[116:119],a[136:139],a[24:27]
s_waitcnt lgkmcnt(1)
v_sub_f32 v238,v238,v234
v_fma_f32 v234,2.0,v235,v236
M a[24:27],a[156:159],a[144:147],a[24:27]
s_waitcnt lgkmcnt(0)
buffer_store_dwordx4 v[184:187],v252,s[24:27],s34 offen offset:1408 nt
M a[28:31],a[156:159],a[148:151],0
v_fmac_f32 v236,-2.0,v235
v_and_b32 v196,s42,v196
M a[28:31],a[116:119],a[144:147],a[28:31]
v_and_b32 v192,s42,v192
v_and_b32 v194,s42,v194
M a[28:31],a[112:115],a[136:139],a[28:31]
s_waitcnt vmcnt(33)
v_and_b32 v202,s42,v202
v_and_b32 v200,s42,v200
M a[32:35],a[96:99],a[100:103],0
s_waitcnt vmcnt(32)
v_and_b32 v198,s42,v198
v_fmac_f32 v192,s43,v196
M a[32:35],a[176:179],a[124:127],a[32:35]
s_waitcnt vmcnt(31)
v_fmac_f32 v202,4.0,v194
v_fma_f32 v235,-4.0,v196,v200
M a[32:35],a[180:183],a[140:143],a[32:35]
v_fmac_f32 v192,s45,v200
v_fmac_f32 v202,s41,v198
M a[36:39],a[180:183],a[104:107],0
v_sub_f32 v200,v200,v196
v_fma_f32 v196,-4.0,v194,v198
M a[36:39],a[176:179],a[140:143],a[36:39]
v_sub_f32 v198,v198,v194
v_add_f32 v194,v235,v196
M a[36:39],a[96:99],a[124:127],a[36:39]
v_sub_f32 v235,v235,v196
v_fma_f32 v196,2.0,v198,v200
M a[40:43],a[96:99],a[140:143],0
v_fmac_f32 v200,-2.0,v198
v_cvt_pk_bf16_f32 v192,v232,v192
M a[40:43],a[176:179],a[104:107],a[40:43]
v_cvt_pk_bf16_f32 v202,v237,v202
v_cvt_pk_bf16_f32 v194,v233,v194
M a[40:43],a[180:183],a[120:123],a[40:43]
v_cvt_pk_bf16_f32 v198,v234,v196
v_cvt_pk_bf16_f32 v196,v238,v235
M a[44:47],a[180:183],a[128:131],0
v_cvt_pk_bf16_f32 v200,v236,v200
v_lshlrev_b32 v234,16,v197
M a[44:47],a[176:179],a[120:123],a[44:47]
v_lshlrev_b32 v232,16,v193
v_lshlrev_b32 v233,16,v195
M a[44:47],a[96:99],a[104:107],a[44:47]
v_lshlrev_b32 v237,16,v203
v_lshlrev_b32 v236,16,v201
M a[48:51],a[96:99],a[120:123],0
v_lshlrev_b32 v235,16,v199
v_fmac_f32 v232,s43,v234
M a[48:51],a[176:179],a[128:131],a[48:51]
v_fmac_f32 v237,4.0,v233
v_fma_f32 v238,-4.0,v234,v236
M a[48:51],a[180:183],a[132:135],a[48:51]
v_fmac_f32 v232,s45,v236
v_fmac_f32 v237,s41,v235
M a[52:55],a[180:183],a[136:139],0
v_sub_f32 v236,v236,v234
v_fma_f32 v234,-4.0,v233,v235
M a[52:55],a[176:179],a[132:135],a[52:55]
v_sub_f32 v235,v235,v233
v_add_f32 v233,v238,v234
M a[52:55],a[96:99],a[128:131],a[52:55]
v_sub_f32 v238,v238,v234
v_fma_f32 v234,2.0,v235,v236
M a[56:59],a[96:99],a[132:135],0
v_fmac_f32 v236,-2.0,v235
v_and_b32 v197,s42,v197
M a[56:59],a[176:179],a[136:139],a[56:59]
v_and_b32 v193,s42,v193
v_and_b32 v195,s42,v195
M a[56:59],a[180:183],a[144:147],a[56:59]
v_and_b32 v203,s42,v203
v_and_b32 v201,s42,v201
M a[60:63],a[180:183],a[148:151],0
v_and_b32 v199,s42,v199
v_fmac_f32 v193,s43,v197
M a[60:63],a[176:179],a[144:147],a[60:63]
v_fmac_f32 v203,4.0,v195
v_fma_f32 v235,-4.0,v197,v201
M a[60:63],a[96:99],a[136:139],a[60:63]
s_waitcnt vmcnt(24)
v_fmac_f32 v193,s45,v201
v_fmac_f32 v203,s41,v199
M a[64:67],a[108:111],a[100:103],0
s_waitcnt vmcnt(23)
v_sub_f32 v201,v201,v197
v_fma_f32 v197,-4.0,v195,v199
M a[64:67],a[168:171],a[124:127],a[64:67]
s_waitcnt vmcnt(22)
v_sub_f32 v199,v199,v195
v_add_f32 v195,v235,v197
M a[64:67],a[172:175],a[140:143],a[64:67]
v_sub_f32 v235,v235,v197
v_fma_f32 v197,2.0,v199,v201
M a[68:71],a[172:175],a[104:107],0
v_fmac_f32 v201,-2.0,v199
v_cvt_pk_bf16_f32 v193,v232,v193
M a[68:71],a[168:171],a[140:143],a[68:71]
v_cvt_pk_bf16_f32 v203,v237,v203
v_cvt_pk_bf16_f32 v195,v233,v195
M a[68:71],a[108:111],a[124:127],a[68:71]
v_cvt_pk_bf16_f32 v199,v234,v197
v_cvt_pk_bf16_f32 v197,v238,v235
M a[72:75],a[108:111],a[140:143],0
v_cvt_pk_bf16_f32 v201,v236,v201
M a[72:75],a[168:171],a[104:107],a[72:75]
ds_write2st64_b64 v247,v[192:193],v[202:203] offset0:170 offset1:187
M a[72:75],a[172:175],a[120:123],a[72:75]
s_add_u32 s28,s30,7077952
buffer_load_dwordx2 v[192:193],v245,s[12:15],s28 offen offset:0
M a[76:79],a[172:175],a[128:131],0
ds_write2st64_b64 v247,v[194:195],v[196:197] offset0:0 offset1:17
M a[76:79],a[168:171],a[120:123],a[76:79]
buffer_load_dwordx2 v[202:203],v245,s[16:19],s28 offen offset:1536
M a[76:79],a[108:111],a[104:107],a[76:79]
ds_write2st64_b64 v247,v[198:199],v[200:201] offset0:136 offset1:153
M a[80:83],a[108:111],a[120:123],0
v_lshlrev_b32 v234,16,v208
v_lshlrev_b32 v232,16,v204
M a[80:83],a[168:171],a[128:131],a[80:83]
buffer_load_dwordx2 v[194:195],v245,s[8:11],s28 offen offset:0
M a[80:83],a[172:175],a[132:135],a[80:83]
ds_read_b128 a[176:179],v249 offset:8704
v_lshlrev_b32 v233,16,v206
M a[84:87],a[172:175],a[136:139],0
ds_read_b128 a[180:183],v250 offset:8704
v_lshlrev_b32 v237,16,v214
M a[84:87],a[168:171],a[132:135],a[84:87]
ds_read_b128 a[184:187],v249 offset:9216
v_lshlrev_b32 v236,16,v212
M a[84:87],a[108:111],a[128:131],a[84:87]
buffer_load_dwordx2 v[196:197],v245,s[8:11],s28 offen offset:384
M a[88:91],a[108:111],a[132:135],0
ds_read_b128 a[188:191],v250 offset:9216
v_lshlrev_b32 v235,16,v210
M a[88:91],a[168:171],a[136:139],a[88:91]
v_fmac_f32 v232,s43,v234
v_fmac_f32 v237,4.0,v233
M a[88:91],a[172:175],a[144:147],a[88:91]
v_fma_f32 v238,-4.0,v234,v236
v_fmac_f32 v232,s45,v236
M a[92:95],a[172:175],a[148:151],0
buffer_load_dwordx2 v[198:199],v245,s[8:11],s28 offen offset:768
M a[92:95],a[168:171],a[144:147],a[92:95]
ds_read_b128 a[192:195],v249 offset:9728
v_fmac_f32 v237,s41,v235
M a[92:95],a[108:111],a[136:139],a[92:95]
s_waitcnt vmcnt(26) lgkmcnt(4)
ds_read_b128 a[232:235],v250 offset:9728
v_sub_f32 v236,v236,v234
M a[96:99],a[240:243],a[176:179],0
s_waitcnt vmcnt(25) lgkmcnt(4)
v_fma_f32 v234,-4.0,v233,v235
v_sub_f32 v235,v235,v233
M a[96:99],v[224:227],a[180:183],a[96:99]
s_waitcnt vmcnt(24) lgkmcnt(3)
buffer_load_dwordx2 v[200:201],v245,s[8:11],s28 offen offset:1152
M a[96:99],a[208:211],a[184:187],a[96:99]
s_waitcnt lgkmcnt(2)
v_add_f32 v233,v238,v234
v_sub_f32 v238,v238,v234
M a[100:103],a[208:211],a[188:191],0
v_fma_f32 v234,2.0,v235,v236
v_fmac_f32 v236,-2.0,v235
M a[100:103],v[224:227],a[184:187],a[100:103]
ds_read_b128 v[220:223],v249 offset:10240
v_and_b32 v208,s42,v208
M a[100:103],a[240:243],a[180:183],a[100:103]
ds_read_b128 a[228:231],v250 offset:10240
v_and_b32 v204,s42,v204
M a[104:107],a[240:243],a[184:187],0
v_and_b32 v206,s42,v206
v_and_b32 v214,s42,v214
M a[104:107],v[224:227],a[188:191],a[104:107]
s_waitcnt lgkmcnt(3)
v_and_b32 v212,s42,v212
v_and_b32 v210,s42,v210
M a[104:107],a[208:211],a[192:195],a[104:107]
s_waitcnt lgkmcnt(2)
v_fmac_f32 v204,s43,v208
v_fmac_f32 v214,4.0,v206
M a[108:111],a[208:211],a[232:235],0
v_fma_f32 v235,-4.0,v208,v212
v_fmac_f32 v204,s45,v212
M a[108:111],v[224:227],a[192:195],a[108:111]
ds_read_b128 a[204:207],v250 offset:10752
v_fmac_f32 v214,s41,v210
M a[108:111],a[240:243],a[188:191],a[108:111]
ds_read_b128 v[228:231],v249 offset:10752
v_sub_f32 v212,v212,v208
M a[112:115],a[240:243],a[192:195],0
v_fma_f32 v208,-4.0,v206,v210
v_sub_f32 v210,v210,v206
M a[112:115],v[224:227],a[232:235],a[112:115]
s_waitcnt lgkmcnt(3)
v_add_f32 v206,v235,v208
v_sub_f32 v235,v235,v208
M a[112:115],a[208:211],v[220:223],a[112:115]
s_waitcnt lgkmcnt(2)
v_fma_f32 v208,2.0,v210,v212
v_fmac_f32 v212,-2.0,v210
M a[116:119],a[208:211],a[228:231],0
v_cvt_pk_bf16_f32 v204,v232,v204
v_cvt_pk_bf16_f32 v214,v237,v214
M a[116:119],v[224:227],v[220:223],a[116:119]
v_cvt_pk_bf16_f32 v206,v233,v206
v_cvt_pk_bf16_f32 v210,v234,v208
M a[116:119],a[240:243],a[232:235],a[116:119]
v_cvt_pk_bf16_f32 v208,v238,v235
v_cvt_pk_bf16_f32 v212,v236,v212
M a[120:123],a[240:243],v[220:223],0
v_lshlrev_b32 v234,16,v209
v_lshlrev_b32 v232,16,v205
M a[120:123],v[224:227],a[228:231],a[120:123]
s_waitcnt lgkmcnt(1)
v_lshlrev_b32 v233,16,v207
v_lshlrev_b32 v237,16,v215
M a[120:123],a[208:211],a[204:207],a[120:123]
s_waitcnt lgkmcnt(0)
v_lshlrev_b32 v236,16,v213
v_lshlrev_b32 v235,16,v211
M a[124:127],a[208:211],v[228:231],0
buffer_load_dwordx4 a[252:255],v251,s[20:23],s46 offen offset:1024 sc1
M a[124:127],v[224:227],a[204:207],a[124:127]
v_fmac_f32 v232,s43,v234
v_fmac_f32 v237,4.0,v233
M a[124:127],a[240:243],a[228:231],a[124:127]
s_waitcnt vmcnt(17)
buffer_load_dwordx4 a[244:247],v251,s[20:23],s46 offen offset:2048 sc1
M a[128:131],a[164:167],a[176:179],0
s_waitcnt vmcnt(17)
s_add_u32 s47,s44,30720
v_fma_f32 v238,-4.0,v234,v236
v_fmac_f32 v232,s45,v236
M a[128:131],a[160:163],a[180:183],a[128:131]
s_waitcnt vmcnt(16)
v_fmac_f32 v237,s41,v235
v_sub_f32 v236,v236,v234
M a[128:131],a[224:227],a[184:187],a[128:131]
v_fma_f32 v234,-4.0,v233,v235
v_sub_f32 v235,v235,v233
M a[132:135],a[224:227],a[188:191],0
buffer_load_dwordx4 a[212:215],v251,s[20:23],s47 offen offset:0 sc1
M a[132:135],a[160:163],a[184:187],a[132:135]
v_add_f32 v233,v238,v234
v_sub_f32 v238,v238,v234
M a[132:135],a[164:167],a[180:183],a[132:135]
v_fma_f32 v234,2.0,v235,v236
v_fmac_f32 v236,-2.0,v235
M a[136:139],a[164:167],a[184:187],0
v_and_b32 v209,s42,v209
v_and_b32 v205,s42,v205
M a[136:139],a[160:163],a[188:191],a[136:139]
v_and_b32 v207,s42,v207
v_and_b32 v215,s42,v215
M a[136:139],a[224:227],a[192:195],a[136:139]
v_and_b32 v213,s42,v213
v_and_b32 v211,s42,v211
M a[140:143],a[224:227],a[232:235],0
v_fmac_f32 v205,s43,v209
v_fmac_f32 v215,4.0,v207
M a[140:143],a[160:163],a[192:195],a[140:143]
v_fma_f32 v235,-4.0,v209,v213
v_fmac_f32 v205,s45,v213
M a[140:143],a[164:167],a[188:191],a[140:143]
v_fmac_f32 v215,s41,v211
v_sub_f32 v213,v213,v209
M a[144:147],a[164:167],a[192:195],0
v_fma_f32 v209,-4.0,v207,v211
v_sub_f32 v211,v211,v207
M a[144:147],a[160:163],a[232:235],a[144:147]
v_add_f32 v207,v235,v209
v_sub_f32 v235,v235,v209
M a[144:147],a[224:227],v[220:223],a[144:147]
v_fma_f32 v209,2.0,v211,v213
v_fmac_f32 v213,-2.0,v211
M a[148:151],a[224:227],a[228:231],0
v_cvt_pk_bf16_f32 v205,v232,v205
v_cvt_pk_bf16_f32 v215,v237,v215
M a[148:151],a[160:163],v[220:223],a[148:151]
v_cvt_pk_bf16_f32 v207,v233,v207
v_cvt_pk_bf16_f32 v211,v234,v209
M a[148:151],a[164:167],a[232:235],a[148:151]
v_cvt_pk_bf16_f32 v209,v238,v235
v_cvt_pk_bf16_f32 v213,v236,v213
M a[152:155],a[164:167],v[220:223],0
ds_write2st64_b64 v247,v[204:205],v[214:215] offset0:171 offset1:188
M a[152:155],a[160:163],a[228:231],a[152:155]
s_add_u32 s28,s30,7471168
buffer_load_dwordx2 v[204:205],v245,s[12:15],s28 offen offset:0
M a[152:155],a[224:227],a[204:207],a[152:155]
ds_write2st64_b64 v247,v[206:207],v[208:209] offset0:1 offset1:18
M a[156:159],a[224:227],v[228:231],0
buffer_load_dwordx4 a[216:219],v251,s[20:23],s47 offen offset:1024 sc1
M a[156:159],a[160:163],a[204:207],a[156:159]
ds_write2st64_b64 v247,v[210:211],v[212:213] offset0:137 offset1:154
M a[156:159],a[164:167],a[228:231],a[156:159]
s_waitcnt vmcnt(18)
v_fmac_f32 v239,s43,v241
v_fmac_f32 v244,4.0,v240
M a[160:163],a[236:239],a[176:179],0
s_waitcnt vmcnt(17)
buffer_load_dwordx4 a[220:223],v251,s[20:23],s47 offen offset:2048 sc1
M a[160:163],v[216:219],a[180:183],a[160:163]
s_waitcnt vmcnt(17)
s_add_u32 s48,s44,33792
v_fma_f32 v232,-4.0,v241,v243
v_fmac_f32 v239,s45,v243
M a[160:163],a[196:199],a[184:187],a[160:163]
v_fmac_f32 v244,s41,v242
v_sub_f32 v243,v243,v241
M a[164:167],a[196:199],a[188:191],0
v_fma_f32 v241,-4.0,v240,v242
v_sub_f32 v242,v242,v240
M a[164:167],v[216:219],a[184:187],a[164:167]
buffer_load_dwordx2 v[214:215],v245,s[16:19],s28 offen offset:1536
M a[164:167],a[236:239],a[180:183],a[164:167]
v_add_f32 v240,v232,v241
v_sub_f32 v232,v232,v241
M a[168:171],a[236:239],a[184:187],0
v_fma_f32 v241,2.0,v242,v243
v_fmac_f32 v243,-2.0,v242
M a[168:171],v[216:219],a[188:191],a[168:171]
v_cvt_pk_bf16_f32 v233,v239,v244
v_cvt_pk_bf16_f32 v234,v240,v232
M a[168:171],a[196:199],a[192:195],a[168:171]
buffer_load_dwordx2 v[206:207],v245,s[8:11],s28 offen offset:0
M a[172:175],a[196:199],a[232:235],0
v_cvt_pk_bf16_f32 v235,v241,v243
v_add_u32 v232,87040,v248
M a[172:175],v[216:219],a[192:195],a[172:175]
ds_write_b16 v232,v233 offset:0
M a[172:175],a[236:239],a[188:191],a[172:175]
ds_write_b16_d16_hi v232,v233 offset:8704
M a[176:179],a[236:239],a[192:195],0
buffer_load_dwordx2 v[208:209],v245,s[8:11],s28 offen offset:384
M a[176:179],v[216:219],a[232:235],a[176:179]
ds_write_b16 v248,v234 offset:0
M a[176:179],a[196:199],v[220:223],a[176:179]
ds_read_b128 a[240:243],v249 offset:17408
ds_write_b16_d16_hi v248,v234 offset:8704
M a[180:183],a[196:199],a[228:231],0
ds_read_b128 a[224:227],v250 offset:17408
v_add_u32 v232,69632,v248
M a[180:183],v[216:219],v[220:223],a[180:183]
buffer_load_dwordx2 v[210:211],v245,s[8:11],s28 offen offset:768
M a[180:183],a[236:239],a[232:235],a[180:183]
ds_read_b128 a[192:195],v249 offset:17920
ds_read_b128 a[232:235],v250 offset:17920
M a[184:187],a[236:239],v[220:223],0
ds_write_b16 v232,v235 offset:0
M a[184:187],v[216:219],a[228:231],a[184:187]
ds_write_b16_d16_hi v232,v235 offset:8704
M a[184:187],a[196:199],a[204:207],a[184:187]
buffer_load_dwordx2 v[212:213],v245,s[8:11],s28 offen offset:1152
M a[188:191],a[196:199],v[228:231],0
s_waitcnt vmcnt(13)
s_add_u32 s29,s30,6291584
v_lshlrev_b32 v234,16,v196
v_lshlrev_b32 v232,16,v192
M a[188:191],v[216:219],a[204:207],a[188:191]
ds_read_b128 a[196:199],v249 offset:18432
v_lshlrev_b32 v233,16,v194
M a[188:191],a[236:239],a[228:231],a[188:191]
s_waitcnt lgkmcnt(7)
ds_read_b128 v[228:231],v250 offset:18432
v_lshlrev_b32 v237,16,v202
M v[0:3],a[200:203],a[240:243],0
s_waitcnt vmcnt(10) lgkmcnt(6)
buffer_load_short_d16_hi v239,v246,s[12:15],s29 offen offset:0
M v[0:3],a[252:255],a[224:227],v[0:3]
s_waitcnt vmcnt(10) lgkmcnt(5)
v_lshlrev_b32 v236,16,v200
v_lshlrev_b32 v235,16,v198
M v[0:3],a[244:247],a[192:195],v[0:3]
s_waitcnt lgkmcnt(4)
buffer_load_short_d16_hi v240,v246,s[8:11],s29 offen offset:0
M v[4:7],a[244:247],a[232:235],0
v_fmac_f32 v232,s43,v234
v_fmac_f32 v237,4.0,v233
M v[4:7],a[252:255],a[192:195],v[4:7]
buffer_load_short_d16_hi v241,v246,s[8:11],s29 offen offset:384
M v[4:7],a[200:203],a[224:227],v[4:7]
ds_read_b128 a[204:207],v249 offset:18944
ds_read_b128 v[216:219],v250 offset:18944
M v[8:11],a[200:203],a[192:195],0
buffer_load_short_d16_hi v242,v246,s[8:11],s29 offen offset:768
M v[8:11],a[252:255],a[232:235],v[8:11]
s_waitcnt lgkmcnt(3)
v_fma_f32 v238,-4.0,v234,v236
v_fmac_f32 v232,s45,v236
M v[8:11],a[244:247],a[196:199],v[8:11]
s_waitcnt lgkmcnt(2)
buffer_load_short_d16_hi v243,v246,s[8:11],s29 offen offset:1152
buffer_load_dwordx4 a[248:251],v251,s[20:23],s48 offen offset:0 sc1
M v[12:15],a[244:247],v[228:231],0
buffer_load_dwordx4 a[208:211],v251,s[20:23],s48 offen offset:1024 sc1
M v[12:15],a[252:255],a[196:199],v[12:15]
buffer_load_dwordx4 v[224:227],v251,s[20:23],s48 offen offset:2048 sc1
M v[12:15],a[200:203],a[232:235],v[12:15]
s_add_u32 s46,s44,36864
ds_read_b128 a[228:231],v250 offset:19456
ds_read_b128 a[236:239],v249 offset:19456
M v[16:19],a[200:203],a[196:199],0
v_fmac_f32 v237,s41,v235
v_sub_f32 v236,v236,v234
M v[16:19],a[252:255],v[228:231],v[16:19]
s_waitcnt lgkmcnt(3)
v_fma_f32 v234,-4.0,v233,v235
v_sub_f32 v235,v235,v233
M v[16:19],a[244:247],a[204:207],v[16:19]
s_waitcnt lgkmcnt(2)
v_add_f32 v233,v238,v234
v_sub_f32 v238,v238,v234
M v[20:23],a[244:247],v[216:219],0
v_fma_f32 v234,2.0,v235,v236
v_fmac_f32 v236,-2.0,v235
M v[20:23],a[252:255],a[204:207],v[20:23]
v_and_b32 v196,s42,v196
v_and_b32 v192,s42,v192
M v[20:23],a[200:203],v[228:231],v[20:23]
v_and_b32 v194,s42,v194
v_and_b32 v202,s42,v202
M v[24:27],a[200:203],a[204:207],0
v_and_b32 v200,s42,v200
v_and_b32 v198,s42,v198
M v[24:27],a[252:255],v[216:219],v[24:27]
s_waitcnt lgkmcnt(1)
v_fmac_f32 v192,s43,v196
v_fmac_f32 v202,4.0,v194
M v[24:27],a[244:247],a[228:231],v[24:27]
s_waitcnt lgkmcnt(0)
v_fma_f32 v235,-4.0,v196,v200
v_fmac_f32 v192,s45,v200
M v[28:31],a[244:247],a[236:239],0
buffer_load_short_d16_hi v244,v246,s[16:19],s29 offen offset:1536
M v[28:31],a[252:255],a[228:231],v[28:31]
v_fmac_f32 v202,s41,v198
v_sub_f32 v200,v200,v196
M v[28:31],a[200:203],v[216:219],v[28:31]
s_waitcnt vmcnt(17)
buffer_load_dwordx4 v[220:223],v251,s[20:23],s46 offen offset:0 sc1
M v[32:35],a[212:215],a[240:243],0
s_waitcnt vmcnt(16)
v_fma_f32 v196,-4.0,v194,v198
v_sub_f32 v198,v198,v194
M v[32:35],a[216:219],a[224:227],v[32:35]
s_waitcnt vmcnt(15)
v_add_f32 v194,v235,v196
v_sub_f32 v235,v235,v196
M v[32:35],a[220:223],a[192:195],v[32:35]
v_fma_f32 v196,2.0,v198,v200
v_fmac_f32 v200,-2.0,v198
M v[36:39],a[220:223],a[232:235],0
global_load_dword a244,v251,s[64:65]
M v[36:39],a[216:219],a[192:195],v[36:39]
v_cvt_pk_bf16_f32 v192,v232,v192
v_cvt_pk_bf16_f32 v202,v237,v202
M v[36:39],a[212:215],a[224:227],v[36:39]
buffer_load_dwordx4 a[244:247],v251,s[20:23],s46 offen offset:1024 sc1
M v[40:43],a[212:215],a[192:195],0
v_cvt_pk_bf16_f32 v194,v233,v194
v_cvt_pk_bf16_f32 v198,v234,v196
M v[40:43],a[216:219],a[232:235],v[40:43]
v_cvt_pk_bf16_f32 v196,v238,v235
v_cvt_pk_bf16_f32 v200,v236,v200
M v[40:43],a[220:223],a[196:199],v[40:43]
v_lshlrev_b32 v234,16,v197
v_lshlrev_b32 v232,16,v193
M v[44:47],a[220:223],v[228:231],0
buffer_load_dwordx4 a[252:255],v251,s[20:23],s46 offen offset:2048 sc1
M v[44:47],a[216:219],a[196:199],v[44:47]
s_add_u32 s47,s44,39936
v_lshlrev_b32 v233,16,v195
v_lshlrev_b32 v237,16,v203
M v[44:47],a[212:215],a[232:235],v[44:47]
v_lshlrev_b32 v236,16,v201
v_lshlrev_b32 v235,16,v199
M v[48:51],a[212:215],a[196:199],0
v_fmac_f32 v232,s43,v234
v_fmac_f32 v237,4.0,v233
M v[48:51],a[216:219],v[228:231],v[48:51]
buffer_load_dwordx4 a[200:203],v251,s[20:23],s47 offen offset:0 sc1
M v[48:51],a[220:223],a[204:207],v[48:51]
v_fma_f32 v238,-4.0,v234,v236
v_fmac_f32 v232,s45,v236
M v[52:55],a[220:223],v[216:219],0
v_fmac_f32 v237,s41,v235
v_sub_f32 v236,v236,v234
M v[52:55],a[216:219],a[204:207],v[52:55]
v_fma_f32 v234,-4.0,v233,v235
v_sub_f32 v235,v235,v233
M v[52:55],a[212:215],v[228:231],v[52:55]
v_add_f32 v233,v238,v234
v_sub_f32 v238,v238,v234
M v[56:59],a[212:215],a[204:207],0
v_fma_f32 v234,2.0,v235,v236
v_fmac_f32 v236,-2.0,v235
M v[56:59],a[216:219],v[216:219],v[56:59]
v_and_b32 v197,s42,v197
v_and_b32 v193,s42,v193
M v[56:59],a[220:223],a[228:231],v[56:59]
v_and_b32 v195,s42,v195
v_and_b32 v203,s42,v203
M v[60:63],a[220:223],a[236:239],0
buffer_load_dwordx4 a[220:223],v251,s[20:23],s47 offen offset:1024 sc1
M v[60:63],a[216:219],a[228:231],v[60:63]
v_and_b32 v201,s42,v201
v_and_b32 v199,s42,v199
M v[60:63],a[212:215],v[216:219],v[60:63]
s_waitcnt vmcnt(9)
buffer_load_dwordx4 a[216:219],v251,s[20:23],s47 offen offset:2048 sc1
M v[64:67],a[248:251],a[240:243],0
s_waitcnt vmcnt(9)
s_add_u32 s48,s44,43008
v_fmac_f32 v193,s43,v197
v_fmac_f32 v203,4.0,v195
M v[64:67],a[208:211],a[224:227],v[64:67]
s_waitcnt vmcnt(8)
v_fma_f32 v235,-4.0,v197,v201
v_fmac_f32 v193,s45,v201
M v[64:67],v[224:227],a[192:195],v[64:67]
v_fmac_f32 v203,s41,v199
v_sub_f32 v201,v201,v197
M v[68:71],v[224:227],a[232:235],0
buffer_load_dwordx4 a[212:215],v251,s[20:23],s48 offen offset:0 sc1
M v[68:71],a[208:211],a[192:195],v[68:71]
v_fma_f32 v197,-4.0,v195,v199
v_sub_f32 v199,v199,v195
M v[68:71],a[248:251],a[224:227],v[68:71]
v_add_f32 v195,v235,v197
v_sub_f32 v235,v235,v197
M v[72:75],a[248:251],a[192:195],0
v_fma_f32 v197,2.0,v199,v201
v_fmac_f32 v201,-2.0,v199
M v[72:75],a[208:211],a[232:235],v[72:75]
buffer_load_dwordx4 a[240:243],v251,s[20:23],s48 offen offset:1024 sc1
M v[72:75],v[224:227],a[196:199],v[72:75]
v_cvt_pk_bf16_f32 v193,v232,v193
v_cvt_pk_bf16_f32 v203,v237,v203
M v[76:79],v[224:227],v[228:231],0
v_cvt_pk_bf16_f32 v195,v233,v195
v_cvt_pk_bf16_f32 v199,v234,v197
M v[76:79],a[208:211],a[196:199],v[76:79]
v_cvt_pk_bf16_f32 v197,v238,v235
v_cvt_pk_bf16_f32 v201,v236,v201
M v[76:79],a[248:251],a[232:235],v[76:79]
buffer_load_dwordx4 a[224:227],v251,s[20:23],s48 offen offset:2048 sc1
M v[80:83],a[248:251],a[196:199],0
s_add_u32 s46,s44,64512
ds_write2st64_b64 v247,v[192:193],v[202:203] offset0:172 offset1:189
M v[80:83],a[208:211],v[228:231],v[80:83]
s_add_u32 s28,s30,6291584
ds_write2st64_b64 v247,v[194:195],v[196:197] offset0:2 offset1:19
M v[80:83],v[224:227],a[204:207],v[80:83]
buffer_load_dwordx2 v[192:193],v245,s[12:15],s28 offen offset:0
M v[84:87],v[224:227],v[216:219],0
ds_read_b128 a[192:195],v249 offset:26112
ds_read_b128 a[232:235],v250 offset:26112
M v[84:87],a[208:211],a[204:207],v[84:87]
ds_read_b128 a[196:199],v249 offset:26624
ds_write2st64_b64 v247,v[198:199],v[200:201] offset0:138 offset1:155
M v[84:87],a[248:251],v[228:231],v[84:87]
buffer_load_dwordx2 v[202:203],v245,s[16:19],s28 offen offset:1536
M v[88:91],a[248:251],a[204:207],0
ds_read_b128 v[228:231],v250 offset:26624
v_lshlrev_b32 v234,16,v208
M v[88:91],a[208:211],v[216:219],v[88:91]
v_lshlrev_b32 v232,16,v204
v_lshlrev_b32 v233,16,v206
M v[88:91],v[224:227],a[228:231],v[88:91]
v_lshlrev_b32 v237,16,v214
v_lshlrev_b32 v236,16,v212
M v[92:95],v[224:227],a[236:239],0
buffer_load_dwordx2 v[194:195],v245,s[8:11],s28 offen offset:0
M v[92:95],a[208:211],a[228:231],v[92:95]
ds_read_b128 a[236:239],v249 offset:27136
v_lshlrev_b32 v235,16,v210
M v[92:95],a[248:251],v[216:219],v[92:95]
s_waitcnt vmcnt(12) lgkmcnt(5)
ds_read_b128 v[224:227],v250 offset:27136
v_fmac_f32 v232,s43,v234
M v[96:99],v[220:223],a[192:195],0
s_waitcnt vmcnt(10) lgkmcnt(5)
v_fmac_f32 v237,4.0,v233
v_fma_f32 v238,-4.0,v234,v236
M v[96:99],a[244:247],a[232:235],v[96:99]
s_waitcnt vmcnt(9) lgkmcnt(4)
buffer_load_dwordx2 v[196:197],v245,s[8:11],s28 offen offset:384
M v[96:99],a[252:255],a[196:199],v[96:99]
s_waitcnt lgkmcnt(2)
v_fmac_f32 v232,s45,v236
v_fmac_f32 v237,s41,v235
M v[100:103],a[252:255],v[228:231],0
v_sub_f32 v236,v236,v234
v_fma_f32 v234,-4.0,v233,v235
M v[100:103],a[244:247],a[196:199],v[100:103]
ds_read_b128 a[208:211],v249 offset:27648
v_sub_f32 v235,v235,v233
M v[100:103],v[220:223],a[232:235],v[100:103]
buffer_load_dwordx2 v[198:199],v245,s[8:11],s28 offen offset:768
M v[104:107],v[220:223],a[196:199],0
ds_read_b128 a[228:231],v250 offset:27648
v_add_f32 v233,v238,v234
M v[104:107],a[244:247],v[228:231],v[104:107]
s_waitcnt lgkmcnt(3)
v_sub_f32 v238,v238,v234
v_fma_f32 v234,2.0,v235,v236
M v[104:107],a[252:255],a[236:239],v[104:107]
s_waitcnt lgkmcnt(2)
v_fmac_f32 v236,-2.0,v235
v_and_b32 v208,s42,v208
M v[108:111],a[252:255],v[224:227],0
buffer_load_dwordx2 v[200:201],v245,s[8:11],s28 offen offset:1152
M v[108:111],a[244:247],a[236:239],v[108:111]
ds_read_b128 a[248:251],v250 offset:28160
v_and_b32 v204,s42,v204
M v[108:111],v[220:223],v[228:231],v[108:111]
ds_read_b128 v[216:219],v249 offset:28160
v_and_b32 v206,s42,v206
M v[112:115],v[220:223],a[236:239],0
v_and_b32 v214,s42,v214
v_and_b32 v212,s42,v212
M v[112:115],a[244:247],v[224:227],v[112:115]
s_waitcnt lgkmcnt(3)
buffer_load_dwordx4 a[204:207],v251,s[20:23],s46 offen offset:0 sc1
M v[112:115],a[252:255],a[208:211],v[112:115]
s_waitcnt lgkmcnt(2)
v_and_b32 v210,s42,v210
v_fmac_f32 v204,s43,v208
M v[116:119],a[252:255],a[228:231],0
v_fmac_f32 v214,4.0,v206
v_fma_f32 v235,-4.0,v208,v212
M v[116:119],a[244:247],a[208:211],v[116:119]
v_fmac_f32 v204,s45,v212
v_fmac_f32 v214,s41,v210
M v[116:119],v[220:223],v[224:227],v[116:119]
v_sub_f32 v212,v212,v208
v_fma_f32 v208,-4.0,v206,v210
M v[120:123],v[220:223],a[208:211],0
v_sub_f32 v210,v210,v206
v_add_f32 v206,v235,v208
M v[120:123],a[244:247],a[228:231],v[120:123]
s_waitcnt lgkmcnt(1)
v_sub_f32 v235,v235,v208
v_fma_f32 v208,2.0,v210,v212
M v[120:123],a[252:255],a[248:251],v[120:123]
s_waitcnt lgkmcnt(0)
v_fmac_f32 v212,-2.0,v210
v_cvt_pk_bf16_f32 v204,v232,v204
M v[124:127],a[252:255],v[216:219],0
buffer_load_dwordx4 a[252:255],v251,s[20:23],s46 offen offset:1024 sc1
M v[124:127],a[244:247],a[248:251],v[124:127]
v_cvt_pk_bf16_f32 v214,v237,v214
v_cvt_pk_bf16_f32 v206,v233,v206
M v[124:127],v[220:223],a[228:231],v[124:127]
s_waitcnt vmcnt(13)
buffer_load_dwordx4 a[244:247],v251,s[20:23],s46 offen offset:2048 sc1
M v[128:131],a[200:203],a[192:195],0
s_waitcnt vmcnt(13)
s_add_u32 s47,s44,67584
v_cvt_pk_bf16_f32 v210,v234,v208
v_cvt_pk_bf16_f32 v208,v238,v235
M v[128:131],a[220:223],a[232:235],v[128:131]
s_waitcnt vmcnt(12)
v_cvt_pk_bf16_f32 v212,v236,v212
v_lshlrev_b32 v234,16,v209
M v[128:131],a[216:219],a[196:199],v[128:131]
v_lshlrev_b32 v232,16,v205
v_lshlrev_b32 v233,16,v207
M v[132:135],a[216:219],v[228:231],0
buffer_load_dwordx4 v[220:223],v251,s[20:23],s47 offen offset:0 sc1
M v[132:135],a[220:223],a[196:199],v[132:135]
v_lshlrev_b32 v237,16,v215
v_lshlrev_b32 v236,16,v213
M v[132:135],a[200:203],a[232:235],v[132:135]
v_lshlrev_b32 v235,16,v211
v_fmac_f32 v232,s43,v234
M v[136:139],a[200:203],a[196:199],0
v_fmac_f32 v237,4.0,v233
v_fma_f32 v238,-4.0,v234,v236
M v[136:139],a[220:223],v[228:231],v[136:139]
v_fmac_f32 v232,s45,v236
v_fmac_f32 v237,s41,v235
M v[136:139],a[216:219],a[236:239],v[136:139]
v_sub_f32 v236,v236,v234
v_fma_f32 v234,-4.0,v233,v235
M v[140:143],a[216:219],v[224:227],0
v_sub_f32 v235,v235,v233
v_add_f32 v233,v238,v234
M v[140:143],a[220:223],a[236:239],v[140:143]
v_sub_f32 v238,v238,v234
v_fma_f32 v234,2.0,v235,v236
M v[140:143],a[200:203],v[228:231],v[140:143]
v_fmac_f32 v236,-2.0,v235
v_and_b32 v209,s42,v209
M v[144:147],a[200:203],a[236:239],0
v_and_b32 v205,s42,v205
v_and_b32 v207,s42,v207
M v[144:147],a[220:223],v[224:227],v[144:147]
v_and_b32 v215,s42,v215
v_and_b32 v213,s42,v213
M v[144:147],a[216:219],a[208:211],v[144:147]
v_and_b32 v211,s42,v211
v_fmac_f32 v205,s43,v209
M v[148:151],a[216:219],a[228:231],0
v_fmac_f32 v215,4.0,v207
v_fma_f32 v235,-4.0,v209,v213
M v[148:151],a[220:223],a[208:211],v[148:151]
v_fmac_f32 v205,s45,v213
v_fmac_f32 v215,s41,v211
M v[148:151],a[200:203],v[224:227],v[148:151]
v_sub_f32 v213,v213,v209
v_fma_f32 v209,-4.0,v207,v211
M v[152:155],a[200:203],a[208:211],0
v_sub_f32 v211,v211,v207
v_add_f32 v207,v235,v209
M v[152:155],a[220:223],a[228:231],v[152:155]
v_sub_f32 v235,v235,v209
v_fma_f32 v209,2.0,v211,v213
M v[152:155],a[216:219],a[248:251],v[152:155]
v_fmac_f32 v213,-2.0,v211
v_cvt_pk_bf16_f32 v205,v232,v205
M v[156:159],a[216:219],v[216:219],0
buffer_load_dwordx4 a[216:219],v251,s[20:23],s47 offen offset:1024 sc1
M v[156:159],a[220:223],a[248:251],v[156:159]
v_cvt_pk_bf16_f32 v215,v237,v215
v_cvt_pk_bf16_f32 v207,v233,v207
M v[156:159],a[200:203],a[228:231],v[156:159]
s_waitcnt vmcnt(13)
buffer_load_dwordx4 a[220:223],v251,s[20:23],s47 offen offset:2048 sc1
M v[160:163],a[212:215],a[192:195],0
s_waitcnt vmcnt(13)
s_add_u32 s48,s44,70656
v_cvt_pk_bf16_f32 v211,v234,v209
v_cvt_pk_bf16_f32 v209,v238,v235
M v[160:163],a[240:243],a[232:235],v[160:163]
s_waitcnt vmcnt(12)
v_cvt_pk_bf16_f32 v213,v236,v213
M v[160:163],a[224:227],a[196:199],v[160:163]
ds_write2st64_b64 v247,v[204:205],v[214:215] offset0:173 offset1:190
M v[164:167],a[224:227],v[228:231],0
s_add_u32 s28,s30,6684800
buffer_load_dwordx2 v[204:205],v245,s[12:15],s28 offen offset:0
M v[164:167],a[240:243],a[196:199],v[164:167]
ds_write2st64_b64 v247,v[206:207],v[208:209] offset0:3 offset1:20
M v[164:167],a[212:215],a[232:235],v[164:167]
ds_write2st64_b64 v247,v[210:211],v[212:213] offset0:139 offset1:156
M v[168:171],a[212:215],a[196:199],0
buffer_load_dwordx2 v[214:215],v245,s[16:19],s28 offen offset:1536
M v[168:171],a[240:243],v[228:231],v[168:171]
s_waitcnt vmcnt(10)
v_lshlrev_b32 v234,16,v196
v_lshlrev_b32 v232,16,v192
M v[168:171],a[224:227],a[236:239],v[168:171]
v_lshlrev_b32 v233,16,v194
v_lshlrev_b32 v237,16,v202
M v[172:175],a[224:227],v[224:227],0
buffer_load_dwordx2 v[206:207],v245,s[8:11],s28 offen offset:0
M v[172:175],a[240:243],a[236:239],v[172:175]
s_waitcnt vmcnt(9)
v_lshlrev_b32 v236,16,v200
v_lshlrev_b32 v235,16,v198
M v[172:175],a[212:215],v[228:231],v[172:175]
v_add_u32 v249,0xffffbc00,v249
v_add_u32 v250,0xffffbc00,v250
M v[176:179],a[212:215],a[236:239],0
v_fmac_f32 v232,s43,v234
v_fmac_f32 v237,4.0,v233
M v[176:179],a[240:243],v[224:227],v[176:179]
buffer_load_dwordx2 v[208:209],v245,s[8:11],s28 offen offset:384
M v[176:179],a[224:227],a[208:211],v[176:179]
s_waitcnt lgkmcnt(0)
s_barrier
ds_read_b128 a[196:199],v249 offset:0
M v[180:183],a[224:227],a[228:231],0
ds_read_b128 v[228:231],v250 offset:0
v_fma_f32 v238,-4.0,v234,v236
M v[180:183],a[240:243],a[208:211],v[180:183]
ds_read_b128 a[236:239],v249 offset:512
v_fmac_f32 v232,s45,v236
M v[180:183],a[212:215],v[224:227],v[180:183]
buffer_load_dwordx2 v[210:211],v245,s[8:11],s28 offen offset:768
M v[184:187],a[212:215],a[208:211],0
ds_read_b128 v[224:227],v250 offset:512
v_fmac_f32 v237,s41,v235
M v[184:187],a[240:243],a[228:231],v[184:187]
v_sub_f32 v236,v236,v234
v_fma_f32 v234,-4.0,v233,v235
M v[184:187],a[224:227],a[248:251],v[184:187]
v_sub_f32 v235,v235,v233
v_add_f32 v233,v238,v234
M v[188:191],a[224:227],v[216:219],0
buffer_load_dwordx2 v[212:213],v245,s[8:11],s28 offen offset:1152
M v[188:191],a[240:243],a[248:251],v[188:191]
ds_read_b128 a[224:227],v249 offset:1024
v_sub_f32 v238,v238,v234
M v[188:191],a[212:215],a[228:231],v[188:191]
s_waitcnt vmcnt(11) lgkmcnt(4)
ds_read_b128 v[216:219],v250 offset:1024
v_fma_f32 v234,2.0,v235,v236
M a[0:3],a[204:207],a[196:199],a[0:3]
s_waitcnt vmcnt(10) lgkmcnt(4)
v_fmac_f32 v236,-2.0,v235
v_and_b32 v196,s42,v196
M a[0:3],a[252:255],v[228:231],a[0:3]
s_waitcnt vmcnt(9) lgkmcnt(3)
buffer_load_dwordx4 a[200:203],v251,s[20:23],s48 offen offset:0 sc1
M a[0:3],a[244:247],a[236:239],a[0:3]
s_waitcnt lgkmcnt(2)
v_and_b32 v192,s42,v192
v_and_b32 v194,s42,v194
M a[4:7],a[244:247],v[224:227],a[4:7]
v_and_b32 v202,s42,v202
v_and_b32 v200,s42,v200
M a[4:7],a[252:255],a[236:239],a[4:7]
ds_read_b128 a[240:243],v249 offset:1536
v_and_b32 v198,s42,v198
M a[4:7],a[204:207],v[228:231],a[4:7]
buffer_load_dwordx4 a[192:195],v251,s[20:23],s48 offen offset:1024 sc1
M a[8:11],a[204:207],a[236:239],a[8:11]
ds_read_b128 a[248:251],v250 offset:1536
v_fmac_f32 v192,s43,v196
M a[8:11],a[252:255],v[224:227],a[8:11]
s_waitcnt lgkmcnt(3)
v_fmac_f32 v202,4.0,v194
v_fma_f32 v235,-4.0,v196,v200
M a[8:11],a[244:247],a[224:227],a[8:11]
s_waitcnt lgkmcnt(2)
v_fmac_f32 v192,s45,v200
v_fmac_f32 v202,s41,v198
M a[12:15],a[244:247],v[216:219],a[12:15]
buffer_load_dwordx4 a[232:235],v251,s[20:23],s48 offen offset:2048 sc1
M a[12:15],a[252:255],a[224:227],a[12:15]
s_add_u32 s46,s44,73728
ds_read_b128 a[212:215],v250 offset:2048
v_sub_f32 v200,v200,v196
M a[12:15],a[204:207],v[224:227],a[12:15]
ds_read_b128 a[228:231],v249 offset:2048
v_fma_f32 v196,-4.0,v194,v198
M a[16:19],a[204:207],a[224:227],a[16:19]
v_sub_f32 v198,v198,v194
v_add_f32 v194,v235,v196
M a[16:19],a[252:255],v[216:219],a[16:19]
s_waitcnt lgkmcnt(3)
buffer_load_dwordx4 a[208:211],v251,s[20:23],s46 offen offset:0 sc1
M a[16:19],a[244:247],a[240:243],a[16:19]
s_waitcnt lgkmcnt(2)
v_sub_f32 v235,v235,v196
v_fma_f32 v196,2.0,v198,v200
M a[20:23],a[244:247],a[248:251],a[20:23]
v_fmac_f32 v200,-2.0,v198
v_cvt_pk_bf16_f32 v192,v232,v192
M a[20:23],a[252:255],a[240:243],a[20:23]
v_cvt_pk_bf16_f32 v202,v237,v202
v_cvt_pk_bf16_f32 v194,v233,v194
M a[20:23],a[204:207],v[216:219],a[20:23]
v_cvt_pk_bf16_f32 v198,v234,v196
v_cvt_pk_bf16_f32 v196,v238,v235
M a[24:27],a[204:207],a[240:243],a[24:27]
v_cvt_pk_bf16_f32 v200,v236,v200
v_lshlrev_b32 v234,16,v197
M a[24:27],a[252:255],a[248:251],a[24:27]
s_waitcnt lgkmcnt(1)
v_lshlrev_b32 v232,16,v193
v_lshlrev_b32 v233,16,v195
M a[24:27],a[244:247],a[212:215],a[24:27]
s_waitcnt lgkmcnt(0)
v_lshlrev_b32 v237,16,v203
v_lshlrev_b32 v236,16,v201
M a[28:31],a[244:247],a[228:231],a[28:31]
buffer_load_dwordx4 a[244:247],v251,s[20:23],s46 offen offset:1024 sc1
M a[28:31],a[252:255],a[212:215],a[28:31]
v_lshlrev_b32 v235,16,v199
v_fmac_f32 v232,s43,v234
M a[28:31],a[204:207],a[248:251],a[28:31]
s_waitcnt vmcnt(13)
buffer_load_dwordx4 a[252:255],v251,s[20:23],s46 offen offset:2048 sc1
M a[32:35],v[220:223],a[196:199],a[32:35]
s_waitcnt vmcnt(13)
s_add_u32 s47,s44,76800
v_fmac_f32 v237,4.0,v233
v_fma_f32 v238,-4.0,v234,v236
M a[32:35],a[216:219],v[228:231],a[32:35]
s_waitcnt vmcnt(12)
v_fmac_f32 v232,s45,v236
v_fmac_f32 v237,s41,v235
M a[32:35],a[220:223],a[236:239],a[32:35]
v_sub_f32 v236,v236,v234
v_fma_f32 v234,-4.0,v233,v235
M a[36:39],a[220:223],v[224:227],a[36:39]
buffer_load_dwordx4 a[204:207],v251,s[20:23],s47 offen offset:0 sc1
M a[36:39],a[216:219],a[236:239],a[36:39]
v_sub_f32 v235,v235,v233
v_add_f32 v233,v238,v234
M a[36:39],v[220:223],v[228:231],a[36:39]
v_sub_f32 v238,v238,v234
v_fma_f32 v234,2.0,v235,v236
M a[40:43],v[220:223],a[236:239],a[40:43]
v_fmac_f32 v236,-2.0,v235
v_and_b32 v197,s42,v197
M a[40:43],a[216:219],v[224:227],a[40:43]
v_and_b32 v193,s42,v193
v_and_b32 v195,s42,v195
M a[40:43],a[220:223],a[224:227],a[40:43]
v_and_b32 v203,s42,v203
v_and_b32 v201,s42,v201
M a[44:47],a[220:223],v[216:219],a[44:47]
v_and_b32 v199,s42,v199
v_fmac_f32 v193,s43,v197
M a[44:47],a[216:219],a[224:227],a[44:47]
v_fmac_f32 v203,4.0,v195
v_fma_f32 v235,-4.0,v197,v201
M a[44:47],v[220:223],v[224:227],a[44:47]
v_fmac_f32 v193,s45,v201
v_fmac_f32 v203,s41,v199
M a[48:51],v[220:223],a[224:227],a[48:51]
v_sub_f32 v201,v201,v197
v_fma_f32 v197,-4.0,v195,v199
M a[48:51],a[216:219],v[216:219],a[48:51]
v_sub_f32 v199,v199,v195
v_add_f32 v195,v235,v197
M a[48:51],a[220:223],a[240:243],a[48:51]
v_sub_f32 v235,v235,v197
v_fma_f32 v197,2.0,v199,v201
M a[52:55],a[220:223],a[248:251],a[52:55]
v_fmac_f32 v201,-2.0,v199
v_cvt_pk_bf16_f32 v193,v232,v193
M a[52:55],a[216:219],a[240:243],a[52:55]
v_cvt_pk_bf16_f32 v203,v237,v203
v_cvt_pk_bf16_f32 v195,v233,v195
M a[52:55],v[220:223],v[216:219],a[52:55]
v_cvt_pk_bf16_f32 v199,v234,v197
v_cvt_pk_bf16_f32 v197,v238,v235
M a[56:59],v[220:223],a[240:243],a[56:59]
v_cvt_pk_bf16_f32 v201,v236,v201
M a[56:59],a[216:219],a[248:251],a[56:59]
ds_write2st64_b64 v247,v[192:193],v[202:203] offset0:204 offset1:221
M a[56:59],a[220:223],a[212:215],a[56:59]
s_add_u32 s28,s30,7078016
buffer_load_dwordx2 v[192:193],v245,s[12:15],s28 offen offset:0
M a[60:63],a[220:223],a[228:231],a[60:63]
ds_write2st64_b64 v247,v[194:195],v[196:197] offset0:34 offset1:51
M a[60:63],a[216:219],a[212:215],a[60:63]
buffer_load_dwordx4 a[220:223],v251,s[20:23],s47 offen offset:1024 sc1
M a[60:63],v[220:223],a[248:251],a[60:63]
s_waitcnt vmcnt(8)
ds_write2st64_b64 v247,v[198:199],v[200:201] offset0:68 offset1:85
M a[64:67],a[200:203],a[196:199],a[64:67]
s_waitcnt vmcnt(7)
v_lshlrev_b32 v234,16,v208
v_lshlrev_b32 v232,16,v204
M a[64:67],a[192:195],v[228:231],a[64:67]
s_waitcnt vmcnt(6)
buffer_load_dwordx4 a[216:219],v251,s[20:23],s47 offen offset:2048 sc1
M a[64:67],a[232:235],a[236:239],a[64:67]
s_add_u32 s48,s44,79872
v_lshlrev_b32 v233,16,v206
v_lshlrev_b32 v237,16,v214
M a[68:71],a[232:235],v[224:227],a[68:71]
v_lshlrev_b32 v236,16,v212
v_lshlrev_b32 v235,16,v210
M a[68:71],a[192:195],a[236:239],a[68:71]
v_fmac_f32 v232,s43,v234
v_fmac_f32 v237,4.0,v233
M a[68:71],a[200:203],v[228:231],a[68:71]
buffer_load_dwordx2 v[202:203],v245,s[16:19],s28 offen offset:1536
M a[72:75],a[200:203],a[236:239],a[72:75]
v_fma_f32 v238,-4.0,v234,v236
v_fmac_f32 v232,s45,v236
M a[72:75],a[192:195],v[224:227],a[72:75]
v_fmac_f32 v237,s41,v235
v_sub_f32 v236,v236,v234
M a[72:75],a[232:235],a[224:227],a[72:75]
v_fma_f32 v234,-4.0,v233,v235
v_sub_f32 v235,v235,v233
M a[76:79],a[232:235],v[216:219],a[76:79]
buffer_load_dwordx2 v[194:195],v245,s[8:11],s28 offen offset:0
M a[76:79],a[192:195],a[224:227],a[76:79]
v_add_f32 v233,v238,v234
v_sub_f32 v238,v238,v234
M a[76:79],a[200:203],v[224:227],a[76:79]
v_fma_f32 v234,2.0,v235,v236
v_fmac_f32 v236,-2.0,v235
M a[80:83],a[200:203],a[224:227],a[80:83]
v_and_b32 v208,s42,v208
v_and_b32 v204,s42,v204
M a[80:83],a[192:195],v[216:219],a[80:83]
buffer_load_dwordx2 v[196:197],v245,s[8:11],s28 offen offset:384
M a[80:83],a[232:235],a[240:243],a[80:83]
ds_read_b128 a[236:239],v249 offset:8704
v_and_b32 v206,s42,v206
M a[84:87],a[232:235],a[248:251],a[84:87]
ds_read_b128 v[224:227],v250 offset:8704
v_and_b32 v214,s42,v214
M a[84:87],a[192:195],a[240:243],a[84:87]
ds_read_b128 a[224:227],v249 offset:9216
v_and_b32 v212,s42,v212
M a[84:87],a[200:203],v[216:219],a[84:87]
buffer_load_dwordx2 v[198:199],v245,s[8:11],s28 offen offset:768
M a[88:91],a[200:203],a[240:243],a[88:91]
ds_read_b128 v[216:219],v250 offset:9216
v_and_b32 v210,s42,v210
M a[88:91],a[192:195],a[248:251],a[88:91]
v_fmac_f32 v204,s43,v208
v_fmac_f32 v214,4.0,v206
M a[88:91],a[232:235],a[212:215],a[88:91]
v_fma_f32 v235,-4.0,v208,v212
v_fmac_f32 v204,s45,v212
M a[92:95],a[232:235],a[228:231],a[92:95]
buffer_load_dwordx2 v[200:201],v245,s[8:11],s28 offen offset:1152
M a[92:95],a[192:195],a[212:215],a[92:95]
ds_read_b128 a[228:231],v249 offset:9728
v_fmac_f32 v214,s41,v210
M a[92:95],a[200:203],a[248:251],a[92:95]
s_waitcnt vmcnt(11) lgkmcnt(4)
ds_read_b128 a[232:235],v250 offset:9728
v_sub_f32 v212,v212,v208
M a[96:99],a[208:211],a[236:239],a[96:99]
s_waitcnt vmcnt(10) lgkmcnt(4)
v_fma_f32 v208,-4.0,v206,v210
v_sub_f32 v210,v210,v206
M a[96:99],a[244:247],v[224:227],a[96:99]
s_waitcnt vmcnt(9) lgkmcnt(3)
buffer_load_dwordx4 v[220:223],v251,s[20:23],s48 offen offset:0 sc1
M a[96:99],a[252:255],a[224:227],a[96:99]
s_waitcnt lgkmcnt(2)
v_add_f32 v206,v235,v208
v_sub_f32 v235,v235,v208
M a[100:103],a[252:255],v[216:219],a[100:103]
v_fma_f32 v208,2.0,v210,v212
v_fmac_f32 v212,-2.0,v210
M a[100:103],a[244:247],a[224:227],a[100:103]
ds_read_b128 a[192:195],v249 offset:10240
v_cvt_pk_bf16_f32 v204,v232,v204
M a[100:103],a[208:211],v[224:227],a[100:103]
buffer_load_dwordx4 a[196:199],v251,s[20:23],s48 offen offset:1024 sc1
M a[104:107],a[208:211],a[224:227],a[104:107]
ds_read_b128 a[212:215],v250 offset:10240
v_cvt_pk_bf16_f32 v214,v237,v214
M a[104:107],a[244:247],v[216:219],a[104:107]
s_waitcnt lgkmcnt(3)
v_cvt_pk_bf16_f32 v206,v233,v206
v_cvt_pk_bf16_f32 v210,v234,v208
M a[104:107],a[252:255],a[228:231],a[104:107]
s_waitcnt lgkmcnt(2)
v_cvt_pk_bf16_f32 v208,v238,v235
v_cvt_pk_bf16_f32 v212,v236,v212
M a[108:111],a[252:255],a[232:235],a[108:111]
buffer_load_dwordx4 v[228:231],v251,s[20:23],s48 offen offset:2048 sc1
M a[108:111],a[244:247],a[228:231],a[108:111]
s_add_u32 s46,s44,82944
ds_read_b128 a[200:203],v250 offset:10752
v_lshlrev_b32 v234,16,v209
M a[108:111],a[208:211],v[216:219],a[108:111]
ds_read_b128 a[248:251],v249 offset:10752
v_lshlrev_b32 v232,16,v205
M a[112:115],a[208:211],a[228:231],a[112:115]
v_lshlrev_b32 v233,16,v207
v_lshlrev_b32 v237,16,v215
M a[112:115],a[244:247],a[232:235],a[112:115]
s_waitcnt lgkmcnt(3)
buffer_load_dwordx4 a[240:243],v251,s[20:23],s46 offen offset:0 sc1
M a[112:115],a[252:255],a[192:195],a[112:115]
s_waitcnt lgkmcnt(2)
v_lshlrev_b32 v236,16,v213
v_lshlrev_b32 v235,16,v211
M a[116:119],a[252:255],a[212:215],a[116:119]
v_fmac_f32 v232,s43,v234
v_fmac_f32 v237,4.0,v233
M a[116:119],a[244:247],a[192:195],a[116:119]
v_fma_f32 v238,-4.0,v234,v236
v_fmac_f32 v232,s45,v236
M a[116:119],a[208:211],a[232:235],a[116:119]
v_fmac_f32 v237,s41,v235
v_sub_f32 v236,v236,v234
M a[120:123],a[208:211],a[192:195],a[120:123]
v_fma_f32 v234,-4.0,v233,v235
v_sub_f32 v235,v235,v233
M a[120:123],a[244:247],a[212:215],a[120:123]
s_waitcnt lgkmcnt(1)
v_add_f32 v233,v238,v234
v_sub_f32 v238,v238,v234
M a[120:123],a[252:255],a[200:203],a[120:123]
s_waitcnt lgkmcnt(0)
v_fma_f32 v234,2.0,v235,v236
v_fmac_f32 v236,-2.0,v235
M a[124:127],a[252:255],a[248:251],a[124:127]
buffer_load_dwordx4 a[252:255],v251,s[20:23],s46 offen offset:1024 sc1
M a[124:127],a[244:247],a[200:203],a[124:127]
v_and_b32 v209,s42,v209
v_and_b32 v205,s42,v205
M a[124:127],a[208:211],a[212:215],a[124:127]
s_waitcnt vmcnt(13)
buffer_load_dwordx4 a[244:247],v251,s[20:23],s46 offen offset:2048 sc1
M a[128:131],a[204:207],a[236:239],a[128:131]
s_waitcnt vmcnt(12)
s_add_u32 s47,s44,86016
v_and_b32 v207,s42,v207
v_and_b32 v215,s42,v215
M a[128:131],a[220:223],v[224:227],a[128:131]
s_waitcnt vmcnt(11)
v_and_b32 v213,s42,v213
v_and_b32 v211,s42,v211
M a[128:131],a[216:219],a[224:227],a[128:131]
v_fmac_f32 v205,s43,v209
v_fmac_f32 v215,4.0,v207
M a[132:135],a[216:219],v[216:219],a[132:135]
buffer_load_dwordx4 a[208:211],v251,s[20:23],s47 offen offset:0 sc1
M a[132:135],a[220:223],a[224:227],a[132:135]
v_fma_f32 v235,-4.0,v209,v213
v_fmac_f32 v205,s45,v213
M a[132:135],a[204:207],v[224:227],a[132:135]
v_fmac_f32 v215,s41,v211
v_sub_f32 v213,v213,v209
M a[136:139],a[204:207],a[224:227],a[136:139]
v_fma_f32 v209,-4.0,v207,v211
v_sub_f32 v211,v211,v207
M a[136:139],a[220:223],v[216:219],a[136:139]
v_add_f32 v207,v235,v209
v_sub_f32 v235,v235,v209
M a[136:139],a[216:219],a[228:231],a[136:139]
v_fma_f32 v209,2.0,v211,v213
v_fmac_f32 v213,-2.0,v211
M a[140:143],a[216:219],a[232:235],a[140:143]
v_cvt_pk_bf16_f32 v205,v232,v205
v_cvt_pk_bf16_f32 v215,v237,v215
M a[140:143],a[220:223],a[228:231],a[140:143]
v_cvt_pk_bf16_f32 v207,v233,v207
v_cvt_pk_bf16_f32 v211,v234,v209
M a[140:143],a[204:207],v[216:219],a[140:143]
v_cvt_pk_bf16_f32 v209,v238,v235
v_cvt_pk_bf16_f32 v213,v236,v213
M a[144:147],a[204:207],a[228:231],a[144:147]
ds_write2st64_b64 v247,v[204:205],v[214:215] offset0:205 offset1:222
M a[144:147],a[220:223],a[232:235],a[144:147]
s_add_u32 s28,s30,7471232
buffer_load_dwordx2 v[204:205],v245,s[12:15],s28 offen offset:0
M a[144:147],a[216:219],a[192:195],a[144:147]
ds_write2st64_b64 v247,v[206:207],v[208:209] offset0:35 offset1:52
M a[148:151],a[216:219],a[212:215],a[148:151]
buffer_load_dwordx2 v[214:215],v245,s[16:19],s28 offen offset:1536
M a[148:151],a[220:223],a[192:195],a[148:151]
ds_write2st64_b64 v247,v[210:211],v[212:213] offset0:69 offset1:86
M a[148:151],a[204:207],a[232:235],a[148:151]
v_fmac_f32 v239,s43,v241
v_fmac_f32 v244,4.0,v240
M a[152:155],a[204:207],a[192:195],a[152:155]
buffer_load_dwordx2 v[206:207],v245,s[8:11],s28 offen offset:0
M a[152:155],a[220:223],a[212:215],a[152:155]
v_fma_f32 v232,-4.0,v241,v243
v_fmac_f32 v239,s45,v243
M a[152:155],a[216:219],a[200:203],a[152:155]
v_fmac_f32 v244,s41,v242
v_sub_f32 v243,v243,v241
M a[156:159],a[216:219],a[248:251],a[156:159]
v_fma_f32 v241,-4.0,v240,v242
v_sub_f32 v242,v242,v240
M a[156:159],a[220:223],a[200:203],a[156:159]
buffer_load_dwordx4 a[216:219],v251,s[20:23],s47 offen offset:1024 sc1
M a[156:159],a[204:207],a[212:215],a[156:159]
s_waitcnt vmcnt(10)
v_add_f32 v240,v232,v241
v_sub_f32 v232,v232,v241
M a[160:163],v[220:223],a[236:239],a[160:163]
s_waitcnt vmcnt(9)
v_fma_f32 v241,2.0,v242,v243
v_fmac_f32 v243,-2.0,v242
M a[160:163],a[196:199],v[224:227],a[160:163]
s_waitcnt vmcnt(8)
v_cvt_pk_bf16_f32 v233,v239,v244
v_cvt_pk_bf16_f32 v234,v240,v232
M a[160:163],v[228:231],a[224:227],a[160:163]
buffer_load_dwordx4 a[220:223],v251,s[20:23],s47 offen offset:2048 sc1
M a[164:167],v[228:231],v[216:219],a[164:167]
s_add_u32 s48,s44,89088
v_cvt_pk_bf16_f32 v235,v241,v243
v_add_u32 v232,104448,v248
M a[164:167],a[196:199],a[224:227],a[164:167]
ds_write_b16 v232,v233 offset:0
M a[164:167],v[220:223],v[224:227],a[164:167]
ds_write_b16_d16_hi v232,v233 offset:8704
M a[168:171],v[220:223],a[224:227],a[168:171]
buffer_load_dwordx2 v[208:209],v245,s[8:11],s28 offen offset:384
M a[168:171],a[196:199],v[216:219],a[168:171]
ds_write_b16 v248,v234 offset:17408
M a[168:171],v[228:231],a[228:231],a[168:171]
ds_write_b16_d16_hi v248,v234 offset:26112
M a[172:175],v[228:231],a[232:235],a[172:175]
ds_write_b16 v248,v235 offset:34816
M a[172:175],a[196:199],a[228:231],a[172:175]
buffer_load_dwordx2 v[210:211],v245,s[8:11],s28 offen offset:768
M a[172:175],v[220:223],v[216:219],a[172:175]
ds_write_b16_d16_hi v248,v235 offset:43520
M a[176:179],v[220:223],a[228:231],a[176:179]
v_add_u32 v249,0x4400,v249
v_add_u32 v250,0x4400,v250
M a[176:179],a[196:199],a[232:235],a[176:179]
v_lshlrev_b32 v234,16,v196
v_lshlrev_b32 v232,16,v192
M a[176:179],v[228:231],a[192:195],a[176:179]
buffer_load_dwordx2 v[212:213],v245,s[8:11],s28 offen offset:1152
M a[180:183],v[228:231],a[212:215],a[180:183]
s_add_u32 s29,s30,6291648
ds_read_b128 a[224:227],v249 offset:52224
ds_read_b128 v[216:219],v250 offset:52224
M a[180:183],a[196:199],a[192:195],a[180:183]
ds_read_b128 a[228:231],v249 offset:52736
v_lshlrev_b32 v233,16,v194
M a[180:183],v[220:223],a[232:235],a[180:183]
ds_read_b128 a[232:235],v250 offset:52736
v_lshlrev_b32 v237,16,v202
M a[184:187],v[220:223],a[192:195],a[184:187]
buffer_load_short_d16_hi v239,v246,s[12:15],s29 offen offset:0
M a[184:187],a[196:199],a[212:215],a[184:187]
v_lshlrev_b32 v236,16,v200
v_lshlrev_b32 v235,16,v198
M a[184:187],v[228:231],a[200:203],a[184:187]
buffer_load_short_d16_hi v240,v246,s[8:11],s29 offen offset:0
M a[188:191],v[228:231],a[248:251],a[188:191]
v_fmac_f32 v232,s43,v234
v_fmac_f32 v237,4.0,v233
M a[188:191],a[196:199],a[200:203],a[188:191]
buffer_load_short_d16_hi v241,v246,s[8:11],s29 offen offset:384
M a[188:191],v[220:223],a[212:215],a[188:191]
s_waitcnt vmcnt(14) lgkmcnt(3)
ds_read_b128 a[248:251],v249 offset:53248
ds_read_b128 v[228:231],v250 offset:53248
M v[0:3],a[240:243],a[224:227],v[0:3]
s_waitcnt vmcnt(13) lgkmcnt(4)
buffer_load_short_d16_hi v242,v246,s[8:11],s29 offen offset:768
M v[0:3],a[252:255],v[216:219],v[0:3]
s_waitcnt vmcnt(13) lgkmcnt(3)
v_fma_f32 v238,-4.0,v234,v236
v_fmac_f32 v232,s45,v236
M v[0:3],a[244:247],a[228:231],v[0:3]
s_waitcnt lgkmcnt(2)
buffer_load_short_d16_hi v243,v246,s[8:11],s29 offen offset:1152
M v[4:7],a[244:247],a[232:235],v[4:7]
v_fmac_f32 v237,s41,v235
v_sub_f32 v236,v236,v234
M v[4:7],a[252:255],a[228:231],v[4:7]
buffer_load_short_d16_hi v244,v246,s[16:19],s29 offen offset:1536
M v[4:7],a[240:243],v[216:219],v[4:7]
ds_read_b128 a[196:199],v249 offset:53760
ds_read_b128 a[200:203],v250 offset:53760
M v[8:11],a[240:243],a[228:231],v[8:11]
buffer_load_dwordx4 a[204:207],v251,s[20:23],s48 offen offset:0 sc1
M v[8:11],a[252:255],a[232:235],v[8:11]
s_waitcnt lgkmcnt(3)
v_fma_f32 v234,-4.0,v233,v235
v_sub_f32 v235,v235,v233
M v[8:11],a[244:247],a[248:251],v[8:11]
s_waitcnt lgkmcnt(2)
v_add_f32 v233,v238,v234
v_sub_f32 v238,v238,v234
M v[12:15],a[244:247],v[228:231],v[12:15]
buffer_load_dwordx4 a[236:239],v251,s[20:23],s48 offen offset:1024 sc1
M v[12:15],a[252:255],a[248:251],v[12:15]
buffer_load_dwordx4 v[224:227],v251,s[20:23],s48 offen offset:2048 sc1
M v[12:15],a[240:243],a[232:235],v[12:15]
s_add_u32 s46,s44,92160
ds_read_b128 a[212:215],v250 offset:54272
ds_read_b128 v[220:223],v249 offset:54272
M v[16:19],a[240:243],a[248:251],v[16:19]
v_fma_f32 v234,2.0,v235,v236
v_fmac_f32 v236,-2.0,v235
M v[16:19],a[252:255],v[228:231],v[16:19]
s_waitcnt lgkmcnt(3)
v_and_b32 v196,s42,v196
v_and_b32 v192,s42,v192
M v[16:19],a[244:247],a[196:199],v[16:19]
s_waitcnt lgkmcnt(2)
v_and_b32 v194,s42,v194
v_and_b32 v202,s42,v202
M v[20:23],a[244:247],a[200:203],v[20:23]
v_and_b32 v200,s42,v200
v_and_b32 v198,s42,v198
M v[20:23],a[252:255],a[196:199],v[20:23]
v_fmac_f32 v192,s43,v196
v_fmac_f32 v202,4.0,v194
M v[20:23],a[240:243],v[228:231],v[20:23]
v_fma_f32 v235,-4.0,v196,v200
v_fmac_f32 v192,s45,v200
M v[24:27],a[240:243],a[196:199],v[24:27]
buffer_load_dwordx4 a[192:195],v251,s[20:23],s46 offen offset:0 sc1
M v[24:27],a[252:255],a[200:203],v[24:27]
s_waitcnt lgkmcnt(1)
v_fmac_f32 v202,s41,v198
v_sub_f32 v200,v200,v196
M v[24:27],a[244:247],a[212:215],v[24:27]
s_waitcnt lgkmcnt(0)
v_fma_f32 v196,-4.0,v194,v198
v_sub_f32 v198,v198,v194
M v[28:31],a[244:247],v[220:223],v[28:31]
v_add_f32 v194,v235,v196
v_sub_f32 v235,v235,v196
M v[28:31],a[252:255],a[212:215],v[28:31]
global_load_dword a244,v251,s[64:65]
M v[28:31],a[240:243],a[200:203],v[28:31]
s_waitcnt vmcnt(19)
v_fma_f32 v196,2.0,v198,v200
v_fmac_f32 v200,-2.0,v198
M v[32:35],a[208:211],a[224:227],v[32:35]
s_waitcnt vmcnt(15)
buffer_load_dwordx4 a[244:247],v251,s[20:23],s46 offen offset:1024 sc1
M v[32:35],a[216:219],v[216:219],v[32:35]
s_waitcnt vmcnt(15)
v_cvt_pk_bf16_f32 v192,v232,v192
v_cvt_pk_bf16_f32 v202,v237,v202
M v[32:35],a[220:223],a[228:231],v[32:35]
v_cvt_pk_bf16_f32 v194,v233,v194
v_cvt_pk_bf16_f32 v198,v234,v196
M v[36:39],a[220:223],a[232:235],v[36:39]
v_cvt_pk_bf16_f32 v196,v238,v235
v_cvt_pk_bf16_f32 v200,v236,v200
M v[36:39],a[216:219],a[228:231],v[36:39]
buffer_load_dwordx4 a[252:255],v251,s[20:23],s46 offen offset:2048 sc1
M v[36:39],a[208:211],v[216:219],v[36:39]
s_add_u32 s47,s44,95232
v_lshlrev_b32 v234,16,v197
v_lshlrev_b32 v232,16,v193
M v[40:43],a[208:211],a[228:231],v[40:43]
v_lshlrev_b32 v233,16,v195
v_lshlrev_b32 v237,16,v203
M v[40:43],a[216:219],a[232:235],v[40:43]
v_lshlrev_b32 v236,16,v201
v_lshlrev_b32 v235,16,v199
M v[40:43],a[220:223],a[248:251],v[40:43]
buffer_load_dwordx4 a[240:243],v251,s[20:23],s47 offen offset:0 sc1
M v[44:47],a[220:223],v[228:231],v[44:47]
v_fmac_f32 v232,s43,v234
v_fmac_f32 v237,4.0,v233
M v[44:47],a[216:219],a[248:251],v[44:47]
v_fma_f32 v238,-4.0,v234,v236
v_fmac_f32 v232,s45,v236
M v[44:47],a[208:211],a[232:235],v[44:47]
v_fmac_f32 v237,s41,v235
v_sub_f32 v236,v236,v234
M v[48:51],a[208:211],a[248:251],v[48:51]
v_fma_f32 v234,-4.0,v233,v235
v_sub_f32 v235,v235,v233
M v[48:51],a[216:219],v[228:231],v[48:51]
v_add_f32 v233,v238,v234
v_sub_f32 v238,v238,v234
M v[48:51],a[220:223],a[196:199],v[48:51]
v_fma_f32 v234,2.0,v235,v236
v_fmac_f32 v236,-2.0,v235
M v[52:55],a[220:223],a[200:203],v[52:55]
v_and_b32 v197,s42,v197
v_and_b32 v193,s42,v193
M v[52:55],a[216:219],a[196:199],v[52:55]
v_and_b32 v195,s42,v195
v_and_b32 v203,s42,v203
M v[52:55],a[208:211],v[228:231],v[52:55]
v_and_b32 v201,s42,v201
v_and_b32 v199,s42,v199
M v[56:59],a[208:211],a[196:199],v[56:59]
v_fmac_f32 v193,s43,v197
v_fmac_f32 v203,4.0,v195
M v[56:59],a[216:219],a[200:203],v[56:59]
v_fma_f32 v235,-4.0,v197,v201
v_fmac_f32 v193,s45,v201
M v[56:59],a[220:223],a[212:215],v[56:59]
v_fmac_f32 v203,s41,v199
v_sub_f32 v201,v201,v197
M v[60:63],a[220:223],v[220:223],v[60:63]
buffer_load_dwordx4 a[220:223],v251,s[20:23],s47 offen offset:1024 sc1
M v[60:63],a[216:219],a[212:215],v[60:63]
v_fma_f32 v197,-4.0,v195,v199
v_sub_f32 v199,v199,v195
M v[60:63],a[208:211],a[200:203],v[60:63]
s_waitcnt vmcnt(8)
buffer_load_dwordx4 a[216:219],v251,s[20:23],s47 offen offset:2048 sc1
M v[64:67],a[204:207],a[224:227],v[64:67]
s_waitcnt vmcnt(8)
s_add_u32 s48,s44,98304
v_add_f32 v195,v235,v197
v_sub_f32 v235,v235,v197
M v[64:67],a[236:239],v[216:219],v[64:67]
s_waitcnt vmcnt(7)
v_fma_f32 v197,2.0,v199,v201
v_fmac_f32 v201,-2.0,v199
M v[64:67],v[224:227],a[228:231],v[64:67]
v_cvt_pk_bf16_f32 v193,v232,v193
v_cvt_pk_bf16_f32 v203,v237,v203
M v[68:71],v[224:227],a[232:235],v[68:71]
buffer_load_dwordx4 a[208:211],v251,s[20:23],s48 offen offset:0 sc1
M v[68:71],a[236:239],a[228:231],v[68:71]
v_cvt_pk_bf16_f32 v195,v233,v195
v_cvt_pk_bf16_f32 v199,v234,v197
M v[68:71],a[204:207],v[216:219],v[68:71]
v_cvt_pk_bf16_f32 v197,v238,v235
v_cvt_pk_bf16_f32 v201,v236,v201
M v[72:75],a[204:207],a[228:231],v[72:75]
ds_write2st64_b64 v247,v[192:193],v[202:203] offset0:206 offset1:223
M v[72:75],a[236:239],a[232:235],v[72:75]
s_add_u32 s28,s30,6291648
buffer_load_dwordx2 v[192:193],v245,s[12:15],s28 offen offset:0
M v[72:75],v[224:227],a[248:251],v[72:75]
ds_write2st64_b64 v247,v[194:195],v[196:197] offset0:36 offset1:53
M v[76:79],v[224:227],v[228:231],v[76:79]
ds_write2st64_b64 v247,v[198:199],v[200:201] offset0:70 offset1:87
M v[76:79],a[236:239],a[248:251],v[76:79]
buffer_load_dwordx2 v[202:203],v245,s[16:19],s28 offen offset:1536
M v[76:79],a[204:207],a[232:235],v[76:79]
v_lshlrev_b32 v234,16,v208
v_lshlrev_b32 v232,16,v204
M v[80:83],a[204:207],a[248:251],v[80:83]
v_lshlrev_b32 v233,16,v206
v_lshlrev_b32 v237,16,v214
M v[80:83],a[236:239],v[228:231],v[80:83]
buffer_load_dwordx2 v[194:195],v245,s[8:11],s28 offen offset:0
M v[80:83],v[224:227],a[196:199],v[80:83]
ds_read_b128 a[228:231],v249 offset:60928
v_lshlrev_b32 v236,16,v212
M v[84:87],v[224:227],a[200:203],v[84:87]
ds_read_b128 a[232:235],v250 offset:60928
v_lshlrev_b32 v235,16,v210
M v[84:87],a[236:239],a[196:199],v[84:87]
ds_read_b128 a[248:251],v249 offset:61440
v_fmac_f32 v232,s43,v234
M v[84:87],a[204:207],v[228:231],v[84:87]
buffer_load_dwordx2 v[196:197],v245,s[8:11],s28 offen offset:384
M v[88:91],a[204:207],a[196:199],v[88:91]
ds_read_b128 v[228:231],v250 offset:61440
v_fmac_f32 v237,4.0,v233
M v[88:91],a[236:239],a[200:203],v[88:91]
v_fma_f32 v238,-4.0,v234,v236
v_fmac_f32 v232,s45,v236
M v[88:91],v[224:227],a[212:215],v[88:91]
v_fmac_f32 v237,s41,v235
v_sub_f32 v236,v236,v234
M v[92:95],v[224:227],v[220:223],v[92:95]
buffer_load_dwordx2 v[198:199],v245,s[8:11],s28 offen offset:768
M v[92:95],a[236:239],a[212:215],v[92:95]
ds_read_b128 v[220:223],v249 offset:61952
v_fma_f32 v234,-4.0,v233,v235
M v[92:95],a[204:207],a[200:203],v[92:95]
s_waitcnt vmcnt(12) lgkmcnt(4)
ds_read_b128 v[224:227],v250 offset:61952
v_sub_f32 v235,v235,v233
M v[96:99],a[192:195],a[228:231],v[96:99]
s_waitcnt vmcnt(10) lgkmcnt(4)
v_add_f32 v233,v238,v234
v_sub_f32 v238,v238,v234
M v[96:99],a[244:247],a[232:235],v[96:99]
s_waitcnt vmcnt(9) lgkmcnt(3)
buffer_load_dwordx2 v[200:201],v245,s[8:11],s28 offen offset:1152
M v[96:99],a[252:255],a[248:251],v[96:99]
s_waitcnt lgkmcnt(2)
v_fma_f32 v234,2.0,v235,v236
v_fmac_f32 v236,-2.0,v235
M v[100:103],a[252:255],v[228:231],v[100:103]
v_and_b32 v208,s42,v208
v_and_b32 v204,s42,v204
M v[100:103],a[244:247],a[248:251],v[100:103]
ds_read_b128 a[212:215],v249 offset:62464
v_and_b32 v206,s42,v206
M v[100:103],a[192:195],a[232:235],v[100:103]
buffer_load_dwordx4 a[224:227],v251,s[20:23],s48 offen offset:1024 sc1
M v[104:107],a[192:195],a[248:251],v[104:107]
ds_read_b128 a[236:239],v250 offset:62464
v_and_b32 v214,s42,v214
M v[104:107],a[244:247],v[228:231],v[104:107]
s_waitcnt lgkmcnt(3)
v_and_b32 v212,s42,v212
v_and_b32 v210,s42,v210
M v[104:107],a[252:255],v[220:223],v[104:107]
s_waitcnt lgkmcnt(2)
v_fmac_f32 v204,s43,v208
v_fmac_f32 v214,4.0,v206
M v[108:111],a[252:255],v[224:227],v[108:111]
buffer_load_dwordx4 v[216:219],v251,s[20:23],s48 offen offset:2048 sc1
M v[108:111],a[244:247],v[220:223],v[108:111]
s_add_u32 s46,s44,119808
ds_read_b128 a[200:203],v250 offset:62976
v_fma_f32 v235,-4.0,v208,v212
M v[108:111],a[192:195],v[228:231],v[108:111]
ds_read_b128 a[204:207],v249 offset:62976
v_fmac_f32 v204,s45,v212
M v[112:115],a[192:195],v[220:223],v[112:115]
v_fmac_f32 v214,s41,v210
v_sub_f32 v212,v212,v208
M v[112:115],a[244:247],v[224:227],v[112:115]
s_waitcnt lgkmcnt(3)
buffer_load_dwordx4 a[196:199],v251,s[20:23],s46 offen offset:0 sc1
M v[112:115],a[252:255],a[212:215],v[112:115]
s_waitcnt lgkmcnt(2)
v_fma_f32 v208,-4.0,v206,v210
v_sub_f32 v210,v210,v206
M v[116:119],a[252:255],a[236:239],v[116:119]
v_add_f32 v206,v235,v208
v_sub_f32 v235,v235,v208
M v[116:119],a[244:247],a[212:215],v[116:119]
v_fma_f32 v208,2.0,v210,v212
v_fmac_f32 v212,-2.0,v210
M v[116:119],a[192:195],v[224:227],v[116:119]
v_cvt_pk_bf16_f32 v204,v232,v204
v_cvt_pk_bf16_f32 v214,v237,v214
M v[120:123],a[192:195],a[212:215],v[120:123]
v_cvt_pk_bf16_f32 v206,v233,v206
v_cvt_pk_bf16_f32 v210,v234,v208
M v[120:123],a[244:247],a[236:239],v[120:123]
s_waitcnt lgkmcnt(1)
v_cvt_pk_bf16_f32 v208,v238,v235
v_cvt_pk_bf16_f32 v212,v236,v212
M v[120:123],a[252:255],a[200:203],v[120:123]
s_waitcnt lgkmcnt(0)
v_lshlrev_b32 v234,16,v209
v_lshlrev_b32 v232,16,v205
M v[124:127],a[252:255],a[204:207],v[124:127]
buffer_load_dwordx4 a[252:255],v251,s[20:23],s46 offen offset:1024 sc1
M v[124:127],a[244:247],a[200:203],v[124:127]
v_lshlrev_b32 v233,16,v207
v_lshlrev_b32 v237,16,v215
M v[124:127],a[192:195],a[236:239],v[124:127]
s_waitcnt vmcnt(13)
buffer_load_dwordx4 a[244:247],v251,s[20:23],s46 offen offset:2048 sc1
M v[128:131],a[240:243],a[228:231],v[128:131]
s_waitcnt vmcnt(13)
s_add_u32 s47,s44,122880
v_lshlrev_b32 v236,16,v213
v_lshlrev_b32 v235,16,v211
M v[128:131],a[220:223],a[232:235],v[128:131]
s_waitcnt vmcnt(12)
v_fmac_f32 v232,s43,v234
v_fmac_f32 v237,4.0,v233
M v[128:131],a[216:219],a[248:251],v[128:131]
v_fma_f32 v238,-4.0,v234,v236
v_fmac_f32 v232,s45,v236
M v[132:135],a[216:219],v[228:231],v[132:135]
buffer_load_dwordx4 a[192:195],v251,s[20:23],s47 offen offset:0 sc1
M v[132:135],a[220:223],a[248:251],v[132:135]
v_fmac_f32 v237,s41,v235
v_sub_f32 v236,v236,v234
M v[132:135],a[240:243],a[232:235],v[132:135]
v_fma_f32 v234,-4.0,v233,v235
v_sub_f32 v235,v235,v233
M v[136:139],a[240:243],a[248:251],v[136:139]
v_add_f32 v233,v238,v234
v_sub_f32 v238,v238,v234
M v[136:139],a[220:223],v[228:231],v[136:139]
v_fma_f32 v234,2.0,v235,v236
v_fmac_f32 v236,-2.0,v235
M v[136:139],a[216:219],v[220:223],v[136:139]
v_and_b32 v209,s42,v209
v_and_b32 v205,s42,v205
M v[140:143],a[216:219],v[224:227],v[140:143]
v_and_b32 v207,s42,v207
v_and_b32 v215,s42,v215
M v[140:143],a[220:223],v[220:223],v[140:143]
v_and_b32 v213,s42,v213
v_and_b32 v211,s42,v211
M v[140:143],a[240:243],v[228:231],v[140:143]
v_fmac_f32 v205,s43,v209
v_fmac_f32 v215,4.0,v207
M v[144:147],a[240:243],v[220:223],v[144:147]
v_fma_f32 v235,-4.0,v209,v213
v_fmac_f32 v205,s45,v213
M v[144:147],a[220:223],v[224:227],v[144:147]
v_fmac_f32 v215,s41,v211
v_sub_f32 v213,v213,v209
M v[144:147],a[216:219],a[212:215],v[144:147]
v_fma_f32 v209,-4.0,v207,v211
v_sub_f32 v211,v211,v207
M v[148:151],a[216:219],a[236:239],v[148:151]
v_add_f32 v207,v235,v209
v_sub_f32 v235,v235,v209
M v[148:151],a[220:223],a[212:215],v[148:151]
v_fma_f32 v209,2.0,v211,v213
v_fmac_f32 v213,-2.0,v211
M v[148:151],a[240:243],v[224:227],v[148:151]
v_cvt_pk_bf16_f32 v205,v232,v205
v_cvt_pk_bf16_f32 v215,v237,v215
M v[152:155],a[240:243],a[212:215],v[152:155]
v_cvt_pk_bf16_f32 v207,v233,v207
v_cvt_pk_bf16_f32 v211,v234,v209
M v[152:155],a[220:223],a[236:239],v[152:155]
v_cvt_pk_bf16_f32 v209,v238,v235
v_cvt_pk_bf16_f32 v213,v236,v213
M v[152:155],a[216:219],a[200:203],v[152:155]
ds_write2st64_b64 v247,v[204:205],v[214:215] offset0:207 offset1:224
M v[156:159],a[216:219],a[204:207],v[156:159]
s_add_u32 s28,s30,6684864
buffer_load_dwordx4 a[216:219],v251,s[20:23],s47 offen offset:1024 sc1
M v[156:159],a[220:223],a[200:203],v[156:159]
ds_write2st64_b64 v247,v[206:207],v[208:209] offset0:37 offset1:54
M v[156:159],a[240:243],a[236:239],v[156:159]
s_waitcnt vmcnt(13)
buffer_load_dwordx4 a[220:223],v251,s[20:23],s47 offen offset:2048 sc1
M v[160:163],a[208:211],a[228:231],v[160:163]
s_waitcnt vmcnt(7)
s_add_u32 s48,s44,125952
ds_write2st64_b64 v247,v[210:211],v[212:213] offset0:71 offset1:88
M v[160:163],a[224:227],a[232:235],v[160:163]
s_waitcnt vmcnt(6)
v_lshlrev_b32 v234,16,v196
v_lshlrev_b32 v232,16,v192
M v[160:163],v[216:219],a[248:251],v[160:163]
buffer_load_dwordx2 v[204:205],v245,s[12:15],s28 offen offset:0
M v[164:167],v[216:219],v[228:231],v[164:167]
v_lshlrev_b32 v233,16,v194
v_lshlrev_b32 v237,16,v202
M v[164:167],a[224:227],a[248:251],v[164:167]
v_lshlrev_b32 v236,16,v200
v_lshlrev_b32 v235,16,v198
M v[164:167],a[208:211],a[232:235],v[164:167]
v_fmac_f32 v232,s43,v234
v_fmac_f32 v237,4.0,v233
M v[168:171],a[208:211],a[248:251],v[168:171]
buffer_load_dwordx2 v[214:215],v245,s[16:19],s28 offen offset:1536
M v[168:171],a[224:227],v[228:231],v[168:171]
v_fma_f32 v238,-4.0,v234,v236
v_fmac_f32 v232,s45,v236
M v[168:171],v[216:219],v[220:223],v[168:171]
v_fmac_f32 v237,s41,v235
v_sub_f32 v236,v236,v234
M v[172:175],v[216:219],v[224:227],v[172:175]
v_fma_f32 v234,-4.0,v233,v235
v_sub_f32 v235,v235,v233
M v[172:175],a[224:227],v[220:223],v[172:175]
buffer_load_dwordx2 v[206:207],v245,s[8:11],s28 offen offset:0
M v[172:175],a[208:211],v[228:231],v[172:175]
v_add_f32 v233,v238,v234
v_sub_f32 v238,v238,v234
M v[176:179],a[208:211],v[220:223],v[176:179]
v_fma_f32 v234,2.0,v235,v236
v_fmac_f32 v236,-2.0,v235
M v[176:179],a[224:227],v[224:227],v[176:179]
v_and_b32 v196,s42,v196
v_and_b32 v192,s42,v192
M v[176:179],v[216:219],a[212:215],v[176:179]
s_waitcnt lgkmcnt(0)
s_barrier
ds_read_b128 a[248:251],v249 offset:0
M v[180:183],v[216:219],a[236:239],v[180:183]
buffer_load_dwordx2 v[208:209],v245,s[8:11],s28 offen offset:384
M v[180:183],a[224:227],a[212:215],v[180:183]
ds_read_b128 v[228:231],v250 offset:0
ds_read_b128 v[220:223],v249 offset:512
M v[180:183],a[208:211],v[224:227],v[180:183]
ds_read_b128 v[224:227],v250 offset:512
v_and_b32 v194,s42,v194
M v[184:187],a[208:211],a[212:215],v[184:187]
buffer_load_dwordx2 v[210:211],v245,s[8:11],s28 offen offset:768
M v[184:187],a[224:227],a[236:239],v[184:187]
v_and_b32 v202,s42,v202
v_and_b32 v200,s42,v200
M v[184:187],v[216:219],a[200:203],v[184:187]
v_and_b32 v198,s42,v198
v_fmac_f32 v192,s43,v196
M v[188:191],v[216:219],a[204:207],v[188:191]
v_fmac_f32 v202,4.0,v194
v_fma_f32 v235,-4.0,v196,v200
M v[188:191],a[224:227],a[200:203],v[188:191]
buffer_load_dwordx2 v[212:213],v245,s[8:11],s28 offen offset:1152
M v[188:191],a[208:211],a[236:239],v[188:191]
s_waitcnt vmcnt(11) lgkmcnt(3)
ds_read_b128 a[204:207],v249 offset:1024
ds_read_b128 v[216:219],v250 offset:1024
M a[0:3],a[196:199],a[248:251],a[0:3]
s_waitcnt vmcnt(10) lgkmcnt(4)
v_fmac_f32 v192,s45,v200
v_fmac_f32 v202,s41,v198
M a[0:3],a[252:255],v[228:231],a[0:3]
s_waitcnt vmcnt(9) lgkmcnt(3)
v_sub_f32 v200,v200,v196
v_fma_f32 v196,-4.0,v194,v198
M a[0:3],a[244:247],v[220:223],a[0:3]
s_waitcnt lgkmcnt(2)
buffer_load_dwordx4 a[240:243],v251,s[20:23],s48 offen offset:0 sc1
M a[4:7],a[244:247],v[224:227],a[4:7]
v_sub_f32 v198,v198,v194
v_add_f32 v194,v235,v196
M a[4:7],a[252:255],v[220:223],a[4:7]
ds_read_b128 a[200:203],v249 offset:1536
v_sub_f32 v235,v235,v196
M a[4:7],a[196:199],v[228:231],a[4:7]
ds_read_b128 a[224:227],v250 offset:1536
v_fma_f32 v196,2.0,v198,v200
M a[8:11],a[196:199],v[220:223],a[8:11]
buffer_load_dwordx4 a[228:231],v251,s[20:23],s48 offen offset:1024 sc1
M a[8:11],a[252:255],v[224:227],a[8:11]
s_waitcnt lgkmcnt(3)
v_fmac_f32 v200,-2.0,v198
v_cvt_pk_bf16_f32 v192,v232,v192
M a[8:11],a[244:247],a[204:207],a[8:11]
s_waitcnt lgkmcnt(2)
v_cvt_pk_bf16_f32 v202,v237,v202
v_cvt_pk_bf16_f32 v194,v233,v194
M a[12:15],a[244:247],v[216:219],a[12:15]
v_cvt_pk_bf16_f32 v198,v234,v196
v_cvt_pk_bf16_f32 v196,v238,v235
M a[12:15],a[252:255],a[204:207],a[12:15]
buffer_load_dwordx4 a[232:235],v251,s[20:23],s48 offen offset:2048 sc1
M a[12:15],a[196:199],v[224:227],a[12:15]
s_add_u32 s46,s44,129024
ds_read_b128 a[208:211],v250 offset:2048
ds_read_b128 a[236:239],v249 offset:2048
M a[16:19],a[196:199],a[204:207],a[16:19]
v_cvt_pk_bf16_f32 v200,v236,v200
v_lshlrev_b32 v234,16,v197
M a[16:19],a[252:255],v[216:219],a[16:19]
s_waitcnt lgkmcnt(3)
v_lshlrev_b32 v232,16,v193
v_lshlrev_b32 v233,16,v195
M a[16:19],a[244:247],a[200:203],a[16:19]
s_waitcnt lgkmcnt(2)
buffer_load_dwordx4 a[212:215],v251,s[20:23],s46 offen offset:0 sc1
M a[20:23],a[244:247],a[224:227],a[20:23]
v_lshlrev_b32 v237,16,v203
v_lshlrev_b32 v236,16,v201
M a[20:23],a[252:255],a[200:203],a[20:23]
v_lshlrev_b32 v235,16,v199
v_fmac_f32 v232,s43,v234
M a[20:23],a[196:199],v[216:219],a[20:23]
v_fmac_f32 v237,4.0,v233
v_fma_f32 v238,-4.0,v234,v236
M a[24:27],a[196:199],a[200:203],a[24:27]
v_fmac_f32 v232,s45,v236
v_fmac_f32 v237,s41,v235
M a[24:27],a[252:255],a[224:227],a[24:27]
s_waitcnt lgkmcnt(1)
v_sub_f32 v236,v236,v234
v_fma_f32 v234,-4.0,v233,v235
M a[24:27],a[244:247],a[208:211],a[24:27]
s_waitcnt lgkmcnt(0)
v_sub_f32 v235,v235,v233
v_add_f32 v233,v238,v234
M a[28:31],a[244:247],a[236:239],a[28:31]
buffer_load_dwordx4 a[244:247],v251,s[20:23],s46 offen offset:1024 sc1
M a[28:31],a[252:255],a[208:211],a[28:31]
v_sub_f32 v238,v238,v234
v_fma_f32 v234,2.0,v235,v236
M a[28:31],a[196:199],a[224:227],a[28:31]
s_waitcnt vmcnt(13)
buffer_load_dwordx4 a[252:255],v251,s[20:23],s46 offen offset:2048 sc1
M a[32:35],a[192:195],a[248:251],a[32:35]
s_waitcnt vmcnt(13)
s_add_u32 s47,s44,132096
v_fmac_f32 v236,-2.0,v235
v_and_b32 v197,s42,v197
M a[32:35],a[216:219],v[228:231],a[32:35]
s_waitcnt vmcnt(12)
v_and_b32 v193,s42,v193
v_and_b32 v195,s42,v195
M a[32:35],a[220:223],v[220:223],a[32:35]
v_and_b32 v203,s42,v203
v_and_b32 v201,s42,v201
M a[36:39],a[220:223],v[224:227],a[36:39]
buffer_load_dwordx4 a[196:199],v251,s[20:23],s47 offen offset:0 sc1
M a[36:39],a[216:219],v[220:223],a[36:39]
v_and_b32 v199,s42,v199
v_fmac_f32 v193,s43,v197
M a[36:39],a[192:195],v[228:231],a[36:39]
v_fmac_f32 v203,4.0,v195
v_fma_f32 v235,-4.0,v197,v201
M a[40:43],a[192:195],v[220:223],a[40:43]
v_fmac_f32 v193,s45,v201
v_fmac_f32 v203,s41,v199
M a[40:43],a[216:219],v[224:227],a[40:43]
v_sub_f32 v201,v201,v197
v_fma_f32 v197,-4.0,v195,v199
M a[40:43],a[220:223],a[204:207],a[40:43]
v_sub_f32 v199,v199,v195
v_add_f32 v195,v235,v197
M a[44:47],a[220:223],v[216:219],a[44:47]
v_sub_f32 v235,v235,v197
v_fma_f32 v197,2.0,v199,v201
M a[44:47],a[216:219],a[204:207],a[44:47]
v_fmac_f32 v201,-2.0,v199
v_cvt_pk_bf16_f32 v193,v232,v193
M a[44:47],a[192:195],v[224:227],a[44:47]
v_cvt_pk_bf16_f32 v203,v237,v203
v_cvt_pk_bf16_f32 v195,v233,v195
M a[48:51],a[192:195],a[204:207],a[48:51]
v_cvt_pk_bf16_f32 v199,v234,v197
v_cvt_pk_bf16_f32 v197,v238,v235
M a[48:51],a[216:219],v[216:219],a[48:51]
v_cvt_pk_bf16_f32 v201,v236,v201
M a[48:51],a[220:223],a[200:203],a[48:51]
ds_write2st64_b64 v247,v[192:193],v[202:203] offset0:238 offset1:255
M a[52:55],a[220:223],a[224:227],a[52:55]
s_add_u32 s28,s30,7078080
buffer_load_dwordx2 v[192:193],v245,s[12:15],s28 offen offset:0
M a[52:55],a[216:219],a[200:203],a[52:55]
ds_write2st64_b64 v247,v[194:195],v[196:197] offset0:0 offset1:17
M a[52:55],a[192:195],v[216:219],a[52:55]
buffer_load_dwordx2 v[202:203],v245,s[16:19],s28 offen offset:1536
M a[56:59],a[192:195],a[200:203],a[56:59]
ds_write2st64_b64 v247,v[198:199],v[200:201] offset0:136 offset1:153
M a[56:59],a[216:219],a[224:227],a[56:59]
s_waitcnt vmcnt(11)
v_lshlrev_b32 v234,16,v208
v_lshlrev_b32 v232,16,v204
M a[56:59],a[220:223],a[208:211],a[56:59]
buffer_load_dwordx2 v[194:195],v245,s[8:11],s28 offen offset:0
M a[60:63],a[220:223],a[236:239],a[60:63]
v_lshlrev_b32 v233,16,v206
v_lshlrev_b32 v237,16,v214
M a[60:63],a[216:219],a[208:211],a[60:63]
s_waitcnt vmcnt(10)
v_lshlrev_b32 v236,16,v212
v_lshlrev_b32 v235,16,v210
M a[60:63],a[192:195],a[224:227],a[60:63]
s_waitcnt vmcnt(9)
v_fmac_f32 v232,s43,v234
v_fmac_f32 v237,4.0,v233
M a[64:67],a[240:243],a[248:251],a[64:67]
s_waitcnt vmcnt(8)
buffer_load_dwordx4 a[220:223],v251,s[20:23],s47 offen offset:1024 sc1
M a[64:67],a[228:231],v[228:231],a[64:67]
s_waitcnt vmcnt(8)
v_fma_f32 v238,-4.0,v234,v236
v_fmac_f32 v232,s45,v236
M a[64:67],a[232:235],v[220:223],a[64:67]
v_fmac_f32 v237,s41,v235
v_sub_f32 v236,v236,v234
M a[68:71],a[232:235],v[224:227],a[68:71]
v_fma_f32 v234,-4.0,v233,v235
v_sub_f32 v235,v235,v233
M a[68:71],a[228:231],v[220:223],a[68:71]
buffer_load_dwordx4 a[216:219],v251,s[20:23],s47 offen offset:2048 sc1
M a[68:71],a[240:243],v[228:231],a[68:71]
s_add_u32 s48,s44,135168
v_add_f32 v233,v238,v234
v_sub_f32 v238,v238,v234
M a[72:75],a[240:243],v[220:223],a[72:75]
v_fma_f32 v234,2.0,v235,v236
v_fmac_f32 v236,-2.0,v235
M a[72:75],a[228:231],v[224:227],a[72:75]
v_and_b32 v208,s42,v208
v_and_b32 v204,s42,v204
M a[72:75],a[232:235],a[204:207],a[72:75]
buffer_load_dwordx2 v[196:197],v245,s[8:11],s28 offen offset:384
M a[76:79],a[232:235],v[216:219],a[76:79]
v_and_b32 v206,s42,v206
v_and_b32 v214,s42,v214
M a[76:79],a[228:231],a[204:207],a[76:79]
v_and_b32 v212,s42,v212
v_and_b32 v210,s42,v210
M a[76:79],a[240:243],v[224:227],a[76:79]
v_fmac_f32 v204,s43,v208
v_fmac_f32 v214,4.0,v206
M a[80:83],a[240:243],a[204:207],a[80:83]
buffer_load_dwordx2 v[198:199],v245,s[8:11],s28 offen offset:768
M a[80:83],a[228:231],v[216:219],a[80:83]
v_fma_f32 v235,-4.0,v208,v212
v_fmac_f32 v204,s45,v212
M a[80:83],a[232:235],a[200:203],a[80:83]
ds_read_b128 v[220:223],v249 offset:8704
v_fmac_f32 v214,s41,v210
M a[84:87],a[232:235],a[224:227],a[84:87]
ds_read_b128 v[224:227],v250 offset:8704
v_sub_f32 v212,v212,v208
M a[84:87],a[228:231],a[200:203],a[84:87]
buffer_load_dwordx2 v[200:201],v245,s[8:11],s28 offen offset:1152
M a[84:87],a[240:243],v[216:219],a[84:87]
ds_read_b128 a[204:207],v249 offset:9216
ds_read_b128 v[216:219],v250 offset:9216
M a[88:91],a[240:243],a[200:203],a[88:91]
v_fma_f32 v208,-4.0,v206,v210
v_sub_f32 v210,v210,v206
M a[88:91],a[228:231],a[224:227],a[88:91]
v_add_f32 v206,v235,v208
v_sub_f32 v235,v235,v208
M a[88:91],a[232:235],a[208:211],a[88:91]
buffer_load_dwordx4 a[192:195],v251,s[20:23],s48 offen offset:0 sc1
M a[92:95],a[232:235],a[236:239],a[92:95]
v_fma_f32 v208,2.0,v210,v212
v_fmac_f32 v212,-2.0,v210
M a[92:95],a[228:231],a[208:211],a[92:95]
ds_read_b128 a[232:235],v249 offset:9728
v_cvt_pk_bf16_f32 v204,v232,v204
M a[92:95],a[240:243],a[224:227],a[92:95]
s_waitcnt vmcnt(12) lgkmcnt(4)
ds_read_b128 a[236:239],v250 offset:9728
v_cvt_pk_bf16_f32 v214,v237,v214
M a[96:99],a[212:215],v[220:223],a[96:99]
s_waitcnt vmcnt(11) lgkmcnt(4)
buffer_load_dwordx4 a[248:251],v251,s[20:23],s48 offen offset:1024 sc1
M a[96:99],a[244:247],v[224:227],a[96:99]
s_waitcnt vmcnt(11) lgkmcnt(3)
v_cvt_pk_bf16_f32 v206,v233,v206
v_cvt_pk_bf16_f32 v210,v234,v208
M a[96:99],a[252:255],a[204:207],a[96:99]
s_waitcnt lgkmcnt(2)
v_cvt_pk_bf16_f32 v208,v238,v235
v_cvt_pk_bf16_f32 v212,v236,v212
M a[100:103],a[252:255],v[216:219],a[100:103]
v_lshlrev_b32 v234,16,v209
v_lshlrev_b32 v232,16,v205
M a[100:103],a[244:247],a[204:207],a[100:103]
buffer_load_dwordx4 v[228:231],v251,s[20:23],s48 offen offset:2048 sc1
M a[100:103],a[212:215],v[224:227],a[100:103]
s_add_u32 s46,s44,138240
ds_read_b128 a[208:211],v249 offset:10240
ds_read_b128 a[228:231],v250 offset:10240
M a[104:107],a[212:215],a[204:207],a[104:107]
v_lshlrev_b32 v233,16,v207
v_lshlrev_b32 v237,16,v215
M a[104:107],a[244:247],v[216:219],a[104:107]
s_waitcnt lgkmcnt(3)
v_lshlrev_b32 v236,16,v213
v_lshlrev_b32 v235,16,v211
M a[104:107],a[252:255],a[232:235],a[104:107]
s_waitcnt lgkmcnt(2)
buffer_load_dwordx4 a[200:203],v251,s[20:23],s46 offen offset:0 sc1
M a[108:111],a[252:255],a[236:239],a[108:111]
v_fmac_f32 v232,s43,v234
v_fmac_f32 v237,4.0,v233
M a[108:111],a[244:247],a[232:235],a[108:111]
ds_read_b128 a[224:227],v250 offset:10752
v_fma_f32 v238,-4.0,v234,v236
M a[108:111],a[212:215],v[216:219],a[108:111]
ds_read_b128 a[240:243],v249 offset:10752
v_fmac_f32 v232,s45,v236
M a[112:115],a[212:215],a[232:235],a[112:115]
v_fmac_f32 v237,s41,v235
v_sub_f32 v236,v236,v234
M a[112:115],a[244:247],a[236:239],a[112:115]
s_waitcnt lgkmcnt(3)
v_fma_f32 v234,-4.0,v233,v235
v_sub_f32 v235,v235,v233
M a[112:115],a[252:255],a[208:211],a[112:115]
s_waitcnt lgkmcnt(2)
v_add_f32 v233,v238,v234
v_sub_f32 v238,v238,v234
M a[116:119],a[252:255],a[228:231],a[116:119]
v_fma_f32 v234,2.0,v235,v236
v_fmac_f32 v236,-2.0,v235
M a[116:119],a[244:247],a[208:211],a[116:119]
v_and_b32 v209,s42,v209
v_and_b32 v205,s42,v205
M a[116:119],a[212:215],a[236:239],a[116:119]
v_and_b32 v207,s42,v207
v_and_b32 v215,s42,v215
M a[120:123],a[212:215],a[208:211],a[120:123]
v_and_b32 v213,s42,v213
v_and_b32 v211,s42,v211
M a[120:123],a[244:247],a[228:231],a[120:123]
s_waitcnt lgkmcnt(1)
v_fmac_f32 v205,s43,v209
v_fmac_f32 v215,4.0,v207
M a[120:123],a[252:255],a[224:227],a[120:123]
s_waitcnt lgkmcnt(0)
v_fma_f32 v235,-4.0,v209,v213
v_fmac_f32 v205,s45,v213
M a[124:127],a[252:255],a[240:243],a[124:127]
buffer_load_dwordx4 a[252:255],v251,s[20:23],s46 offen offset:1024 sc1
M a[124:127],a[244:247],a[224:227],a[124:127]
v_fmac_f32 v215,s41,v211
v_sub_f32 v213,v213,v209
M a[124:127],a[212:215],a[228:231],a[124:127]
s_waitcnt vmcnt(13)
buffer_load_dwordx4 a[244:247],v251,s[20:23],s46 offen offset:2048 sc1
M a[128:131],a[196:199],v[220:223],a[128:131]
s_waitcnt vmcnt(10)
s_add_u32 s47,s44,141312
v_fma_f32 v209,-4.0,v207,v211
v_sub_f32 v211,v211,v207
M a[128:131],a[220:223],v[224:227],a[128:131]
s_waitcnt vmcnt(9)
v_add_f32 v207,v235,v209
v_sub_f32 v235,v235,v209
M a[128:131],a[216:219],a[204:207],a[128:131]
v_fma_f32 v209,2.0,v211,v213
v_fmac_f32 v213,-2.0,v211
M a[132:135],a[216:219],v[216:219],a[132:135]
buffer_load_dwordx4 a[212:215],v251,s[20:23],s47 offen offset:0 sc1
M a[132:135],a[220:223],a[204:207],a[132:135]
v_cvt_pk_bf16_f32 v205,v232,v205
v_cvt_pk_bf16_f32 v215,v237,v215
M a[132:135],a[196:199],v[224:227],a[132:135]
v_cvt_pk_bf16_f32 v207,v233,v207
v_cvt_pk_bf16_f32 v211,v234,v209
M a[136:139],a[196:199],a[204:207],a[136:139]
v_cvt_pk_bf16_f32 v209,v238,v235
v_cvt_pk_bf16_f32 v213,v236,v213
M a[136:139],a[220:223],v[216:219],a[136:139]
v_add_u32 v232,121856,v247
M a[136:139],a[216:219],a[232:235],a[136:139]
ds_write2st64_b64 v232,v[204:205],v[214:215] offset0:1 offset1:18
M a[140:143],a[216:219],a[236:239],a[140:143]
s_add_u32 s28,s30,7471296
buffer_load_dwordx2 v[204:205],v245,s[12:15],s28 offen offset:0
M a[140:143],a[220:223],a[232:235],a[140:143]
ds_write2st64_b64 v247,v[206:207],v[208:209] offset0:1 offset1:18
M a[140:143],a[196:199],v[216:219],a[140:143]
buffer_load_dwordx2 v[214:215],v245,s[16:19],s28 offen offset:1536
M a[144:147],a[196:199],a[232:235],a[144:147]
ds_write2st64_b64 v247,v[210:211],v[212:213] offset0:137 offset1:154
M a[144:147],a[220:223],a[236:239],a[144:147]
v_fmac_f32 v239,s43,v241
v_fmac_f32 v244,4.0,v240
M a[144:147],a[216:219],a[208:211],a[144:147]
buffer_load_dwordx2 v[206:207],v245,s[8:11],s28 offen offset:0
M a[148:151],a[216:219],a[228:231],a[148:151]
v_fma_f32 v232,-4.0,v241,v243
v_fmac_f32 v239,s45,v243
M a[148:151],a[220:223],a[208:211],a[148:151]
v_fmac_f32 v244,s41,v242
v_sub_f32 v243,v243,v241
M a[148:151],a[196:199],a[236:239],a[148:151]
v_fma_f32 v241,-4.0,v240,v242
v_sub_f32 v242,v242,v240
M a[152:155],a[196:199],a[208:211],a[152:155]
buffer_load_dwordx2 v[208:209],v245,s[8:11],s28 offen offset:384
M a[152:155],a[220:223],a[228:231],a[152:155]
v_add_f32 v240,v232,v241
v_sub_f32 v232,v232,v241
M a[152:155],a[216:219],a[224:227],a[152:155]
v_fma_f32 v241,2.0,v242,v243
v_fmac_f32 v243,-2.0,v242
M a[156:159],a[216:219],a[240:243],a[156:159]
v_cvt_pk_bf16_f32 v233,v239,v244
v_cvt_pk_bf16_f32 v234,v240,v232
M a[156:159],a[220:223],a[224:227],a[156:159]
buffer_load_dwordx4 a[216:219],v251,s[20:23],s47 offen offset:1024 sc1
M a[156:159],a[196:199],a[228:231],a[156:159]
s_waitcnt vmcnt(11)
v_cvt_pk_bf16_f32 v235,v241,v243
v_add_u32 v232,121856,v248
M a[160:163],a[192:195],v[220:223],a[160:163]
s_waitcnt vmcnt(10)
ds_write_b16 v232,v233 offset:0
M a[160:163],a[248:251],v[224:227],a[160:163]
s_waitcnt vmcnt(9)
ds_write_b16_d16_hi v232,v233 offset:8704
M a[160:163],v[228:231],a[204:207],a[160:163]
buffer_load_dwordx4 a[220:223],v251,s[20:23],s47 offen offset:2048 sc1
M a[164:167],v[228:231],v[216:219],a[164:167]
s_add_u32 s48,s44,144384
ds_write_b16 v248,v234 offset:0
M a[164:167],a[248:251],a[204:207],a[164:167]
ds_write_b16_d16_hi v248,v234 offset:8704
M a[164:167],a[192:195],v[224:227],a[164:167]
v_add_u32 v232,69632,v248
M a[168:171],a[192:195],a[204:207],a[168:171]
buffer_load_dwordx2 v[210:211],v245,s[8:11],s28 offen offset:768
M a[168:171],a[248:251],v[216:219],a[168:171]
ds_write_b16 v232,v235 offset:0
M a[168:171],v[228:231],a[232:235],a[168:171]
ds_write_b16_d16_hi v232,v235 offset:8704
M a[172:175],v[228:231],a[236:239],a[172:175]
v_lshlrev_b32 v234,16,v196
v_lshlrev_b32 v232,16,v192
M a[172:175],a[248:251],a[232:235],a[172:175]
buffer_load_dwordx2 v[212:213],v245,s[8:11],s28 offen offset:1152
M a[172:175],a[192:195],v[216:219],a[172:175]
s_add_u32 s29,s30,6291712
v_lshlrev_b32 v233,16,v194
v_lshlrev_b32 v237,16,v202
M a[176:179],a[192:195],a[232:235],a[176:179]
v_lshlrev_b32 v236,16,v200
v_lshlrev_b32 v235,16,v198
M a[176:179],a[248:251],a[236:239],a[176:179]
v_fmac_f32 v232,s43,v234
v_fmac_f32 v237,4.0,v233
M a[176:179],v[228:231],a[208:211],a[176:179]
buffer_load_short_d16_hi v239,v246,s[12:15],s29 offen offset:0
M a[180:183],v[228:231],a[228:231],a[180:183]
ds_read_b128 a[204:207],v249 offset:17408
ds_read_b128 v[216:219],v250 offset:17408
M a[180:183],a[248:251],a[208:211],a[180:183]
buffer_load_short_d16_hi v240,v246,s[8:11],s29 offen offset:0
M a[180:183],a[192:195],a[236:239],a[180:183]
ds_read_b128 a[232:235],v249 offset:17920
ds_read_b128 a[236:239],v250 offset:17920
M a[184:187],a[192:195],a[208:211],a[184:187]
buffer_load_short_d16_hi v241,v246,s[8:11],s29 offen offset:384
M a[184:187],a[248:251],a[228:231],a[184:187]
v_fma_f32 v238,-4.0,v234,v236
v_fmac_f32 v232,s45,v236
M a[184:187],v[228:231],a[224:227],a[184:187]
buffer_load_short_d16_hi v242,v246,s[8:11],s29 offen offset:768
M a[188:191],v[228:231],a[240:243],a[188:191]
v_fmac_f32 v237,s41,v235
v_sub_f32 v236,v236,v234
M a[188:191],a[248:251],a[224:227],a[188:191]
buffer_load_short_d16_hi v243,v246,s[8:11],s29 offen offset:1152
M a[188:191],a[192:195],a[228:231],a[188:191]
s_waitcnt vmcnt(16) lgkmcnt(3)
ds_read_b128 a[240:243],v249 offset:18432
ds_read_b128 v[228:231],v250 offset:18432
M v[0:3],a[200:203],a[204:207],v[0:3]
s_waitcnt vmcnt(15) lgkmcnt(4)
buffer_load_short_d16_hi v244,v246,s[16:19],s29 offen offset:1536
M v[0:3],a[252:255],v[216:219],v[0:3]
s_waitcnt vmcnt(15) lgkmcnt(3)
v_fma_f32 v234,-4.0,v233,v235
v_sub_f32 v235,v235,v233
M v[0:3],a[244:247],a[232:235],v[0:3]
s_waitcnt lgkmcnt(2)
buffer_load_dwordx4 a[196:199],v251,s[20:23],s48 offen offset:0 sc1
M v[4:7],a[244:247],a[236:239],v[4:7]
v_add_f32 v233,v238,v234
v_sub_f32 v238,v238,v234
M v[4:7],a[252:255],a[232:235],v[4:7]
ds_read_b128 a[224:227],v249 offset:18944
v_fma_f32 v234,2.0,v235,v236
M v[4:7],a[200:203],v[216:219],v[4:7]
ds_read_b128 a[248:251],v250 offset:18944
v_fmac_f32 v236,-2.0,v235
M v[8:11],a[200:203],a[232:235],v[8:11]
buffer_load_dwordx4 v[220:223],v251,s[20:23],s48 offen offset:1024 sc1
M v[8:11],a[252:255],a[236:239],v[8:11]
s_waitcnt lgkmcnt(3)
v_and_b32 v196,s42,v196
v_and_b32 v192,s42,v192
M v[8:11],a[244:247],a[240:243],v[8:11]
s_waitcnt lgkmcnt(2)
v_and_b32 v194,s42,v194
v_and_b32 v202,s42,v202
M v[12:15],a[244:247],v[228:231],v[12:15]
v_and_b32 v200,s42,v200
v_and_b32 v198,s42,v198
M v[12:15],a[252:255],a[240:243],v[12:15]
buffer_load_dwordx4 v[224:227],v251,s[20:23],s48 offen offset:2048 sc1
M v[12:15],a[200:203],a[236:239],v[12:15]
s_add_u32 s46,s44,147456
ds_read_b128 a[192:195],v250 offset:19456
ds_read_b128 a[228:231],v249 offset:19456
M v[16:19],a[200:203],a[240:243],v[16:19]
v_fmac_f32 v192,s43,v196
v_fmac_f32 v202,4.0,v194
M v[16:19],a[252:255],v[228:231],v[16:19]
s_waitcnt lgkmcnt(3)
v_fma_f32 v235,-4.0,v196,v200
v_fmac_f32 v192,s45,v200
M v[16:19],a[244:247],a[224:227],v[16:19]
s_waitcnt lgkmcnt(2)
buffer_load_dwordx4 a[208:211],v251,s[20:23],s46 offen offset:0 sc1
M v[20:23],a[244:247],a[248:251],v[20:23]
v_fmac_f32 v202,s41,v198
v_sub_f32 v200,v200,v196
M v[20:23],a[252:255],a[224:227],v[20:23]
v_fma_f32 v196,-4.0,v194,v198
v_sub_f32 v198,v198,v194
M v[20:23],a[200:203],v[228:231],v[20:23]
v_add_f32 v194,v235,v196
v_sub_f32 v235,v235,v196
M v[24:27],a[200:203],a[224:227],v[24:27]
v_fma_f32 v196,2.0,v198,v200
v_fmac_f32 v200,-2.0,v198
M v[24:27],a[252:255],a[248:251],v[24:27]
s_waitcnt lgkmcnt(1)
v_cvt_pk_bf16_f32 v192,v232,v192
v_cvt_pk_bf16_f32 v202,v237,v202
M v[24:27],a[244:247],a[192:195],v[24:27]
s_waitcnt lgkmcnt(0)
v_cvt_pk_bf16_f32 v194,v233,v194
v_cvt_pk_bf16_f32 v198,v234,v196
M v[28:31],a[244:247],a[228:231],v[28:31]
global_load_dword a244,v251,s[64:65]
M v[28:31],a[252:255],a[192:195],v[28:31]
buffer_load_dwordx4 a[244:247],v251,s[20:23],s46 offen offset:1024 sc1
M v[28:31],a[200:203],a[248:251],v[28:31]
s_waitcnt vmcnt(20)
v_cvt_pk_bf16_f32 v196,v238,v235
v_cvt_pk_bf16_f32 v200,v236,v200
M v[32:35],a[212:215],a[204:207],v[32:35]
s_waitcnt vmcnt(15)
v_lshlrev_b32 v234,16,v197
v_lshlrev_b32 v232,16,v193
M v[32:35],a[216:219],v[216:219],v[32:35]
s_waitcnt vmcnt(14)
buffer_load_dwordx4 a[252:255],v251,s[20:23],s46 offen offset:2048 sc1
M v[32:35],a[220:223],a[232:235],v[32:35]
s_add_u32 s47,s44,150528
v_lshlrev_b32 v233,16,v195
v_lshlrev_b32 v237,16,v203
M v[36:39],a[220:223],a[236:239],v[36:39]
v_lshlrev_b32 v236,16,v201
v_lshlrev_b32 v235,16,v199
M v[36:39],a[216:219],a[232:235],v[36:39]
v_fmac_f32 v232,s43,v234
v_fmac_f32 v237,4.0,v233
M v[36:39],a[212:215],v[216:219],v[36:39]
buffer_load_dwordx4 a[200:203],v251,s[20:23],s47 offen offset:0 sc1
M v[40:43],a[212:215],a[232:235],v[40:43]
v_fma_f32 v238,-4.0,v234,v236
v_fmac_f32 v232,s45,v236
M v[40:43],a[216:219],a[236:239],v[40:43]
v_fmac_f32 v237,s41,v235
v_sub_f32 v236,v236,v234
M v[40:43],a[220:223],a[240:243],v[40:43]
v_fma_f32 v234,-4.0,v233,v235
v_sub_f32 v235,v235,v233
M v[44:47],a[220:223],v[228:231],v[44:47]
v_add_f32 v233,v238,v234
v_sub_f32 v238,v238,v234
M v[44:47],a[216:219],a[240:243],v[44:47]
v_fma_f32 v234,2.0,v235,v236
v_fmac_f32 v236,-2.0,v235
M v[44:47],a[212:215],a[236:239],v[44:47]
v_and_b32 v197,s42,v197
v_and_b32 v193,s42,v193
M v[48:51],a[212:215],a[240:243],v[48:51]
v_and_b32 v195,s42,v195
v_and_b32 v203,s42,v203
M v[48:51],a[216:219],v[228:231],v[48:51]
v_and_b32 v201,s42,v201
v_and_b32 v199,s42,v199
M v[48:51],a[220:223],a[224:227],v[48:51]
v_fmac_f32 v193,s43,v197
v_fmac_f32 v203,4.0,v195
M v[52:55],a[220:223],a[248:251],v[52:55]
v_fma_f32 v235,-4.0,v197,v201
v_fmac_f32 v193,s45,v201
M v[52:55],a[216:219],a[224:227],v[52:55]
v_fmac_f32 v203,s41,v199
v_sub_f32 v201,v201,v197
M v[52:55],a[212:215],v[228:231],v[52:55]
v_fma_f32 v197,-4.0,v195,v199
v_sub_f32 v199,v199,v195
M v[56:59],a[212:215],a[224:227],v[56:59]
v_add_f32 v195,v235,v197
v_sub_f32 v235,v235,v197
M v[56:59],a[216:219],a[248:251],v[56:59]
v_fma_f32 v197,2.0,v199,v201
v_fmac_f32 v201,-2.0,v199
M v[56:59],a[220:223],a[192:195],v[56:59]
v_cvt_pk_bf16_f32 v193,v232,v193
v_cvt_pk_bf16_f32 v203,v237,v203
M v[60:63],a[220:223],a[228:231],v[60:63]
buffer_load_dwordx4 a[220:223],v251,s[20:23],s47 offen offset:1024 sc1
M v[60:63],a[216:219],a[192:195],v[60:63]
v_cvt_pk_bf16_f32 v195,v233,v195
v_cvt_pk_bf16_f32 v199,v234,v197
M v[60:63],a[212:215],a[248:251],v[60:63]
s_waitcnt vmcnt(8)
buffer_load_dwordx4 a[216:219],v251,s[20:23],s47 offen offset:2048 sc1
M v[64:67],a[196:199],a[204:207],v[64:67]
s_waitcnt vmcnt(8)
s_add_u32 s48,s44,153600
v_cvt_pk_bf16_f32 v197,v238,v235
v_cvt_pk_bf16_f32 v201,v236,v201
M v[64:67],v[220:223],v[216:219],v[64:67]
s_waitcnt vmcnt(7)
v_add_u32 v232,121856,v247
M v[64:67],v[224:227],a[232:235],v[64:67]
ds_write2st64_b64 v232,v[192:193],v[202:203] offset0:2 offset1:19
M v[68:71],v[224:227],a[236:239],v[68:71]
s_add_u32 s28,s30,6291712
buffer_load_dwordx2 v[192:193],v245,s[12:15],s28 offen offset:0
M v[68:71],v[220:223],a[232:235],v[68:71]
ds_write2st64_b64 v247,v[194:195],v[196:197] offset0:2 offset1:19
M v[68:71],a[196:199],v[216:219],v[68:71]
ds_write2st64_b64 v247,v[198:199],v[200:201] offset0:138 offset1:155
M v[72:75],a[196:199],a[232:235],v[72:75]
buffer_load_dwordx2 v[202:203],v245,s[16:19],s28 offen offset:1536
M v[72:75],v[220:223],a[236:239],v[72:75]
v_lshlrev_b32 v234,16,v208
v_lshlrev_b32 v232,16,v204
M v[72:75],v[224:227],a[240:243],v[72:75]
v_lshlrev_b32 v233,16,v206
v_lshlrev_b32 v237,16,v214
M v[76:79],v[224:227],v[228:231],v[76:79]
buffer_load_dwordx2 v[194:195],v245,s[8:11],s28 offen offset:0
M v[76:79],v[220:223],a[240:243],v[76:79]
v_lshlrev_b32 v236,16,v212
v_lshlrev_b32 v235,16,v210
M v[76:79],a[196:199],a[236:239],v[76:79]
v_fmac_f32 v232,s43,v234
v_fmac_f32 v237,4.0,v233
M v[80:83],a[196:199],a[240:243],v[80:83]
v_fma_f32 v238,-4.0,v234,v236
v_fmac_f32 v232,s45,v236
M v[80:83],v[220:223],v[228:231],v[80:83]
buffer_load_dwordx2 v[196:197],v245,s[8:11],s28 offen offset:384
M v[80:83],v[224:227],a[224:227],v[80:83]
ds_read_b128 a[232:235],v249 offset:26112
v_fmac_f32 v237,s41,v235
M v[84:87],v[224:227],a[248:251],v[84:87]
ds_read_b128 a[236:239],v250 offset:26112
v_sub_f32 v236,v236,v234
M v[84:87],v[220:223],a[224:227],v[84:87]
ds_read_b128 a[240:243],v249 offset:26624
v_fma_f32 v234,-4.0,v233,v235
M v[84:87],a[196:199],v[228:231],v[84:87]
buffer_load_dwordx2 v[198:199],v245,s[8:11],s28 offen offset:768
M v[88:91],a[196:199],a[224:227],v[88:91]
ds_read_b128 v[228:231],v250 offset:26624
v_sub_f32 v235,v235,v233
M v[88:91],v[220:223],a[248:251],v[88:91]
v_add_f32 v233,v238,v234
v_sub_f32 v238,v238,v234
M v[88:91],v[224:227],a[192:195],v[88:91]
v_fma_f32 v234,2.0,v235,v236
v_fmac_f32 v236,-2.0,v235
M v[92:95],v[224:227],a[228:231],v[92:95]
buffer_load_dwordx2 v[200:201],v245,s[8:11],s28 offen offset:1152
M v[92:95],v[220:223],a[192:195],v[92:95]
ds_read_b128 a[228:231],v249 offset:27136
v_and_b32 v208,s42,v208
M v[92:95],a[196:199],a[248:251],v[92:95]
s_waitcnt vmcnt(12) lgkmcnt(4)
ds_read_b128 v[224:227],v250 offset:27136
v_and_b32 v204,s42,v204
M v[96:99],a[208:211],a[232:235],v[96:99]
s_waitcnt vmcnt(10) lgkmcnt(4)
v_and_b32 v206,s42,v206
v_and_b32 v214,s42,v214
M v[96:99],a[244:247],a[236:239],v[96:99]
s_waitcnt vmcnt(9) lgkmcnt(3)
buffer_load_dwordx4 a[212:215],v251,s[20:23],s48 offen offset:0 sc1
M v[96:99],a[252:255],a[240:243],v[96:99]
s_waitcnt lgkmcnt(2)
v_and_b32 v212,s42,v212
v_and_b32 v210,s42,v210
M v[100:103],a[252:255],v[228:231],v[100:103]
v_fmac_f32 v204,s43,v208
v_fmac_f32 v214,4.0,v206
M v[100:103],a[244:247],a[240:243],v[100:103]
ds_read_b128 a[192:195],v249 offset:27648
v_fma_f32 v235,-4.0,v208,v212
M v[100:103],a[208:211],a[236:239],v[100:103]
buffer_load_dwordx4 a[204:207],v251,s[20:23],s48 offen offset:1024 sc1
M v[104:107],a[208:211],a[240:243],v[104:107]
ds_read_b128 v[220:223],v250 offset:27648
v_fmac_f32 v204,s45,v212
M v[104:107],a[244:247],v[228:231],v[104:107]
s_waitcnt lgkmcnt(3)
v_fmac_f32 v214,s41,v210
v_sub_f32 v212,v212,v208
M v[104:107],a[252:255],a[228:231],v[104:107]
s_waitcnt lgkmcnt(2)
v_fma_f32 v208,-4.0,v206,v210
v_sub_f32 v210,v210,v206
M v[108:111],a[252:255],v[224:227],v[108:111]
buffer_load_dwordx4 v[216:219],v251,s[20:23],s48 offen offset:2048 sc1
M v[108:111],a[244:247],a[228:231],v[108:111]
s_add_u32 s46,s44,175104
ds_read_b128 a[196:199],v250 offset:28160
v_add_f32 v206,v235,v208
M v[108:111],a[208:211],v[228:231],v[108:111]
ds_read_b128 a[248:251],v249 offset:28160
v_sub_f32 v235,v235,v208
M v[112:115],a[208:211],a[228:231],v[112:115]
v_fma_f32 v208,2.0,v210,v212
v_fmac_f32 v212,-2.0,v210
M v[112:115],a[244:247],v[224:227],v[112:115]
s_waitcnt lgkmcnt(3)
buffer_load_dwordx4 a[224:227],v251,s[20:23],s46 offen offset:0 sc1
M v[112:115],a[252:255],a[192:195],v[112:115]
s_waitcnt lgkmcnt(2)
v_cvt_pk_bf16_f32 v204,v232,v204
v_cvt_pk_bf16_f32 v214,v237,v214
M v[116:119],a[252:255],v[220:223],v[116:119]
v_cvt_pk_bf16_f32 v206,v233,v206
v_cvt_pk_bf16_f32 v210,v234,v208
M v[116:119],a[244:247],a[192:195],v[116:119]
v_cvt_pk_bf16_f32 v208,v238,v235
v_cvt_pk_bf16_f32 v212,v236,v212
M v[116:119],a[208:211],v[224:227],v[116:119]
v_lshlrev_b32 v234,16,v209
v_lshlrev_b32 v232,16,v205
M v[120:123],a[208:211],a[192:195],v[120:123]
v_lshlrev_b32 v233,16,v207
v_lshlrev_b32 v237,16,v215
M v[120:123],a[244:247],v[220:223],v[120:123]
s_waitcnt lgkmcnt(1)
v_lshlrev_b32 v236,16,v213
v_lshlrev_b32 v235,16,v211
M v[120:123],a[252:255],a[196:199],v[120:123]
s_waitcnt lgkmcnt(0)
v_fmac_f32 v232,s43,v234
v_fmac_f32 v237,4.0,v233
M v[124:127],a[252:255],a[248:251],v[124:127]
buffer_load_dwordx4 a[252:255],v251,s[20:23],s46 offen offset:1024 sc1
M v[124:127],a[244:247],a[196:199],v[124:127]
v_fma_f32 v238,-4.0,v234,v236
v_fmac_f32 v232,s45,v236
M v[124:127],a[208:211],v[220:223],v[124:127]
s_waitcnt vmcnt(13)
buffer_load_dwordx4 a[244:247],v251,s[20:23],s46 offen offset:2048 sc1
M v[128:131],a[200:203],a[232:235],v[128:131]
s_waitcnt vmcnt(13)
s_add_u32 s47,s44,178176
v_fmac_f32 v237,s41,v235
v_sub_f32 v236,v236,v234
M v[128:131],a[220:223],a[236:239],v[128:131]
s_waitcnt vmcnt(12)
v_fma_f32 v234,-4.0,v233,v235
v_sub_f32 v235,v235,v233
M v[128:131],a[216:219],a[240:243],v[128:131]
v_add_f32 v233,v238,v234
v_sub_f32 v238,v238,v234
M v[132:135],a[216:219],v[228:231],v[132:135]
buffer_load_dwordx4 a[208:211],v251,s[20:23],s47 offen offset:0 sc1
M v[132:135],a[220:223],a[240:243],v[132:135]
v_fma_f32 v234,2.0,v235,v236
v_fmac_f32 v236,-2.0,v235
M v[132:135],a[200:203],a[236:239],v[132:135]
v_and_b32 v209,s42,v209
v_and_b32 v205,s42,v205
M v[136:139],a[200:203],a[240:243],v[136:139]
v_and_b32 v207,s42,v207
v_and_b32 v215,s42,v215
M v[136:139],a[220:223],v[228:231],v[136:139]
v_and_b32 v213,s42,v213
v_and_b32 v211,s42,v211
M v[136:139],a[216:219],a[228:231],v[136:139]
v_fmac_f32 v205,s43,v209
v_fmac_f32 v215,4.0,v207
M v[140:143],a[216:219],v[224:227],v[140:143]
v_fma_f32 v235,-4.0,v209,v213
v_fmac_f32 v205,s45,v213
M v[140:143],a[220:223],a[228:231],v[140:143]
v_fmac_f32 v215,s41,v211
v_sub_f32 v213,v213,v209
M v[140:143],a[200:203],v[228:231],v[140:143]
v_fma_f32 v209,-4.0,v207,v211
v_sub_f32 v211,v211,v207
M v[144:147],a[200:203],a[228:231],v[144:147]
v_add_f32 v207,v235,v209
v_sub_f32 v235,v235,v209
M v[144:147],a[220:223],v[224:227],v[144:147]
v_fma_f32 v209,2.0,v211,v213
v_fmac_f32 v213,-2.0,v211
M v[144:147],a[216:219],a[192:195],v[144:147]
v_cvt_pk_bf16_f32 v205,v232,v205
v_cvt_pk_bf16_f32 v215,v237,v215
M v[148:151],a[216:219],v[220:223],v[148:151]
v_cvt_pk_bf16_f32 v207,v233,v207
v_cvt_pk_bf16_f32 v211,v234,v209
M v[148:151],a[220:223],a[192:195],v[148:151]
v_cvt_pk_bf16_f32 v209,v238,v235
v_cvt_pk_bf16_f32 v213,v236,v213
M v[148:151],a[200:203],v[224:227],v[148:151]
v_add_u32 v232,121856,v247
M v[152:155],a[200:203],a[192:195],v[152:155]
ds_write2st64_b64 v232,v[204:205],v[214:215] offset0:3 offset1:20
M v[152:155],a[220:223],v[220:223],v[152:155]
s_add_u32 s28,s30,6684928
buffer_load_dwordx2 v[204:205],v245,s[12:15],s28 offen offset:0
M v[152:155],a[216:219],a[196:199],v[152:155]
ds_write2st64_b64 v247,v[206:207],v[208:209] offset0:3 offset1:20
M v[156:159],a[216:219],a[248:251],v[156:159]
buffer_load_dwordx4 a[216:219],v251,s[20:23],s47 offen offset:1024 sc1
M v[156:159],a[220:223],a[196:199],v[156:159]
ds_write2st64_b64 v247,v[210:211],v[212:213] offset0:139 offset1:156
M v[156:159],a[200:203],v[220:223],v[156:159]
s_waitcnt vmcnt(8)
v_lshlrev_b32 v234,16,v196
v_lshlrev_b32 v232,16,v192
M v[160:163],a[212:215],a[232:235],v[160:163]
s_waitcnt vmcnt(7)
buffer_load_dwordx4 a[220:223],v251,s[20:23],s47 offen offset:2048 sc1
M v[160:163],a[204:207],a[236:239],v[160:163]
s_waitcnt vmcnt(7)
s_add_u32 s48,s44,181248
v_lshlrev_b32 v233,16,v194
v_lshlrev_b32 v237,16,v202
M v[160:163],v[216:219],a[240:243],v[160:163]
v_lshlrev_b32 v236,16,v200
v_lshlrev_b32 v235,16,v198
M v[164:167],v[216:219],v[228:231],v[164:167]
v_fmac_f32 v232,s43,v234
v_fmac_f32 v237,4.0,v233
M v[164:167],a[204:207],a[240:243],v[164:167]
buffer_load_dwordx2 v[214:215],v245,s[16:19],s28 offen offset:1536
M v[164:167],a[212:215],a[236:239],v[164:167]
v_fma_f32 v238,-4.0,v234,v236
v_fmac_f32 v232,s45,v236
M v[168:171],a[212:215],a[240:243],v[168:171]
v_fmac_f32 v237,s41,v235
v_sub_f32 v236,v236,v234
M v[168:171],a[204:207],v[228:231],v[168:171]
v_fma_f32 v234,-4.0,v233,v235
v_sub_f32 v235,v235,v233
M v[168:171],v[216:219],a[228:231],v[168:171]
buffer_load_dwordx2 v[206:207],v245,s[8:11],s28 offen offset:0
M v[172:175],v[216:219],v[224:227],v[172:175]
v_add_f32 v233,v238,v234
v_sub_f32 v238,v238,v234
M v[172:175],a[204:207],a[228:231],v[172:175]
v_fma_f32 v234,2.0,v235,v236
v_fmac_f32 v236,-2.0,v235
M v[172:175],a[212:215],v[228:231],v[172:175]
v_add_u32 v249,0xffffbc00,v249
v_add_u32 v250,0xffffbc00,v250
M v[176:179],a[212:215],a[228:231],v[176:179]
buffer_load_dwordx2 v[208:209],v245,s[8:11],s28 offen offset:384
M v[176:179],a[204:207],v[224:227],v[176:179]
v_and_b32 v196,s42,v196
v_and_b32 v192,s42,v192
M v[176:179],v[216:219],a[192:195],v[176:179]
s_waitcnt lgkmcnt(0)
s_barrier
ds_read_b128 a[240:243],v249 offset:0
M v[180:183],v[216:219],v[220:223],v[180:183]
ds_read_b128 v[228:231],v250 offset:0
v_and_b32 v194,s42,v194
M v[180:183],a[204:207],a[192:195],v[180:183]
buffer_load_dwordx2 v[210:211],v245,s[8:11],s28 offen offset:768
M v[180:183],a[212:215],v[224:227],v[180:183]
ds_read_b128 a[228:231],v249 offset:512
ds_read_b128 v[224:227],v250 offset:512
M v[184:187],a[212:215],a[192:195],v[184:187]
v_and_b32 v202,s42,v202
v_and_b32 v200,s42,v200
M v[184:187],a[204:207],v[220:223],v[184:187]
v_and_b32 v198,s42,v198
v_fmac_f32 v192,s43,v196
M v[184:187],v[216:219],a[196:199],v[184:187]
buffer_load_dwordx2 v[212:213],v245,s[8:11],s28 offen offset:1152
M v[188:191],v[216:219],a[248:251],v[188:191]
v_fmac_f32 v202,4.0,v194
v_fma_f32 v235,-4.0,v196,v200
M v[188:191],a[204:207],a[196:199],v[188:191]
ds_read_b128 a[248:251],v249 offset:1024
v_fmac_f32 v192,s45,v200
M v[188:191],a[212:215],v[220:223],v[188:191]
s_waitcnt vmcnt(11) lgkmcnt(4)
ds_read_b128 v[216:219],v250 offset:1024
v_fmac_f32 v202,s41,v198
M a[0:3],a[224:227],a[240:243],a[0:3]
s_waitcnt vmcnt(10) lgkmcnt(4)
buffer_load_dwordx4 a[200:203],v251,s[20:23],s48 offen offset:0 sc1
M a[0:3],a[252:255],v[228:231],a[0:3]
s_waitcnt vmcnt(10) lgkmcnt(3)
v_sub_f32 v200,v200,v196
v_fma_f32 v196,-4.0,v194,v198
M a[0:3],a[244:247],a[228:231],a[0:3]
s_waitcnt lgkmcnt(2)
v_sub_f32 v198,v198,v194
v_add_f32 v194,v235,v196
M a[4:7],a[244:247],v[224:227],a[4:7]
v_sub_f32 v235,v235,v196
v_fma_f32 v196,2.0,v198,v200
M a[4:7],a[252:255],a[228:231],a[4:7]
buffer_load_dwordx4 a[232:235],v251,s[20:23],s48 offen offset:1024 sc1
M a[4:7],a[224:227],v[228:231],a[4:7]
ds_read_b128 a[196:199],v249 offset:1536
ds_read_b128 a[204:207],v250 offset:1536
M a[8:11],a[224:227],a[228:231],a[8:11]
v_fmac_f32 v200,-2.0,v198
v_cvt_pk_bf16_f32 v192,v232,v192
M a[8:11],a[252:255],v[224:227],a[8:11]
s_waitcnt lgkmcnt(3)
v_cvt_pk_bf16_f32 v202,v237,v202
v_cvt_pk_bf16_f32 v194,v233,v194
M a[8:11],a[244:247],a[248:251],a[8:11]
s_waitcnt lgkmcnt(2)
buffer_load_dwordx4 a[236:239],v251,s[20:23],s48 offen offset:2048 sc1
M a[12:15],a[244:247],v[216:219],a[12:15]
s_add_u32 s46,s44,184320
v_cvt_pk_bf16_f32 v198,v234,v196
v_cvt_pk_bf16_f32 v196,v238,v235
M a[12:15],a[252:255],a[248:251],a[12:15]
ds_read_b128 a[212:215],v250 offset:2048
v_cvt_pk_bf16_f32 v200,v236,v200
M a[12:15],a[224:227],v[224:227],a[12:15]
ds_read_b128 v[220:223],v249 offset:2048
v_lshlrev_b32 v234,16,v197
M a[16:19],a[224:227],a[248:251],a[16:19]
buffer_load_dwordx4 a[192:195],v251,s[20:23],s46 offen offset:0 sc1
M a[16:19],a[252:255],v[216:219],a[16:19]
s_waitcnt lgkmcnt(3)
v_lshlrev_b32 v232,16,v193
v_lshlrev_b32 v233,16,v195
M a[16:19],a[244:247],a[196:199],a[16:19]
s_waitcnt lgkmcnt(2)
v_lshlrev_b32 v237,16,v203
v_lshlrev_b32 v236,16,v201
M a[20:23],a[244:247],a[204:207],a[20:23]
v_lshlrev_b32 v235,16,v199
v_fmac_f32 v232,s43,v234
M a[20:23],a[252:255],a[196:199],a[20:23]
v_fmac_f32 v237,4.0,v233
v_fma_f32 v238,-4.0,v234,v236
M a[20:23],a[224:227],v[216:219],a[20:23]
v_fmac_f32 v232,s45,v236
v_fmac_f32 v237,s41,v235
M a[24:27],a[224:227],a[196:199],a[24:27]
v_sub_f32 v236,v236,v234
v_fma_f32 v234,-4.0,v233,v235
M a[24:27],a[252:255],a[204:207],a[24:27]
s_waitcnt lgkmcnt(1)
v_sub_f32 v235,v235,v233
v_add_f32 v233,v238,v234
M a[24:27],a[244:247],a[212:215],a[24:27]
s_waitcnt lgkmcnt(0)
v_sub_f32 v238,v238,v234
v_fma_f32 v234,2.0,v235,v236
M a[28:31],a[244:247],v[220:223],a[28:31]
buffer_load_dwordx4 a[244:247],v251,s[20:23],s46 offen offset:1024 sc1
M a[28:31],a[252:255],a[212:215],a[28:31]
v_fmac_f32 v236,-2.0,v235
v_and_b32 v197,s42,v197
M a[28:31],a[224:227],a[204:207],a[28:31]
s_waitcnt vmcnt(13)
buffer_load_dwordx4 a[252:255],v251,s[20:23],s46 offen offset:2048 sc1
M a[32:35],a[208:211],a[240:243],a[32:35]
s_waitcnt vmcnt(12)
s_add_u32 s47,s44,187392
v_and_b32 v193,s42,v193
v_and_b32 v195,s42,v195
M a[32:35],a[216:219],v[228:231],a[32:35]
s_waitcnt vmcnt(11)
v_and_b32 v203,s42,v203
v_and_b32 v201,s42,v201
M a[32:35],a[220:223],a[228:231],a[32:35]
v_and_b32 v199,s42,v199
v_fmac_f32 v193,s43,v197
M a[36:39],a[220:223],v[224:227],a[36:39]
buffer_load_dwordx4 a[224:227],v251,s[20:23],s47 offen offset:0 sc1
M a[36:39],a[216:219],a[228:231],a[36:39]
v_fmac_f32 v203,4.0,v195
v_fma_f32 v235,-4.0,v197,v201
M a[36:39],a[208:211],v[228:231],a[36:39]
v_fmac_f32 v193,s45,v201
v_fmac_f32 v203,s41,v199
M a[40:43],a[208:211],a[228:231],a[40:43]
v_sub_f32 v201,v201,v197
v_fma_f32 v197,-4.0,v195,v199
M a[40:43],a[216:219],v[224:227],a[40:43]
v_sub_f32 v199,v199,v195
v_add_f32 v195,v235,v197
M a[40:43],a[220:223],a[248:251],a[40:43]
v_sub_f32 v235,v235,v197
v_fma_f32 v197,2.0,v199,v201
M a[44:47],a[220:223],v[216:219],a[44:47]
v_fmac_f32 v201,-2.0,v199
v_cvt_pk_bf16_f32 v193,v232,v193
M a[44:47],a[216:219],a[248:251],a[44:47]
v_cvt_pk_bf16_f32 v203,v237,v203
v_cvt_pk_bf16_f32 v195,v233,v195
M a[44:47],a[208:211],v[224:227],a[44:47]
v_cvt_pk_bf16_f32 v199,v234,v197
v_cvt_pk_bf16_f32 v197,v238,v235
M a[48:51],a[208:211],a[248:251],a[48:51]
v_cvt_pk_bf16_f32 v201,v236,v201
v_add_u32 v232,139264,v247
M a[48:51],a[216:219],v[216:219],a[48:51]
ds_write2st64_b64 v232,v[192:193],v[202:203] offset0:0 offset1:17
M a[48:51],a[220:223],a[196:199],a[48:51]
s_add_u32 s28,s30,7078144
buffer_load_dwordx2 v[192:193],v245,s[12:15],s28 offen offset:0
M a[52:55],a[220:223],a[204:207],a[52:55]
ds_write2st64_b64 v247,v[194:195],v[196:197] offset0:34 offset1:51
M a[52:55],a[216:219],a[196:199],a[52:55]
buffer_load_dwordx2 v[202:203],v245,s[16:19],s28 offen offset:1536
M a[52:55],a[208:211],v[216:219],a[52:55]
ds_write2st64_b64 v247,v[198:199],v[200:201] offset0:68 offset1:85
M a[56:59],a[208:211],a[196:199],a[56:59]
s_waitcnt vmcnt(11)
v_lshlrev_b32 v234,16,v208
v_lshlrev_b32 v232,16,v204
M a[56:59],a[216:219],a[204:207],a[56:59]
buffer_load_dwordx2 v[194:195],v245,s[8:11],s28 offen offset:0
M a[56:59],a[220:223],a[212:215],a[56:59]
v_lshlrev_b32 v233,16,v206
v_lshlrev_b32 v237,16,v214
M a[60:63],a[220:223],v[220:223],a[60:63]
s_waitcnt vmcnt(10)
v_lshlrev_b32 v236,16,v212
v_lshlrev_b32 v235,16,v210
M a[60:63],a[216:219],a[212:215],a[60:63]
v_fmac_f32 v232,s43,v234
v_fmac_f32 v237,4.0,v233
M a[60:63],a[208:211],a[204:207],a[60:63]
s_waitcnt vmcnt(9)
buffer_load_dwordx4 a[220:223],v251,s[20:23],s47 offen offset:1024 sc1
M a[64:67],a[200:203],a[240:243],a[64:67]
s_waitcnt vmcnt(9)
v_fma_f32 v238,-4.0,v234,v236
v_fmac_f32 v232,s45,v236
M a[64:67],a[232:235],v[228:231],a[64:67]
s_waitcnt vmcnt(8)
v_fmac_f32 v237,s41,v235
v_sub_f32 v236,v236,v234
M a[64:67],a[236:239],a[228:231],a[64:67]
v_fma_f32 v234,-4.0,v233,v235
v_sub_f32 v235,v235,v233
M a[68:71],a[236:239],v[224:227],a[68:71]
buffer_load_dwordx4 a[216:219],v251,s[20:23],s47 offen offset:2048 sc1
M a[68:71],a[232:235],a[228:231],a[68:71]
s_add_u32 s48,s44,190464
v_add_f32 v233,v238,v234
v_sub_f32 v238,v238,v234
M a[68:71],a[200:203],v[228:231],a[68:71]
v_fma_f32 v234,2.0,v235,v236
v_fmac_f32 v236,-2.0,v235
M a[72:75],a[200:203],a[228:231],a[72:75]
v_and_b32 v208,s42,v208
v_and_b32 v204,s42,v204
M a[72:75],a[232:235],v[224:227],a[72:75]
buffer_load_dwordx2 v[196:197],v245,s[8:11],s28 offen offset:384
M a[72:75],a[236:239],a[248:251],a[72:75]
v_and_b32 v206,s42,v206
v_and_b32 v214,s42,v214
M a[76:79],a[236:239],v[216:219],a[76:79]
v_and_b32 v212,s42,v212
v_and_b32 v210,s42,v210
M a[76:79],a[232:235],a[248:251],a[76:79]
v_fmac_f32 v204,s43,v208
v_fmac_f32 v214,4.0,v206
M a[76:79],a[200:203],v[224:227],a[76:79]
buffer_load_dwordx2 v[198:199],v245,s[8:11],s28 offen offset:768
M a[80:83],a[200:203],a[248:251],a[80:83]
v_fma_f32 v235,-4.0,v208,v212
v_fmac_f32 v204,s45,v212
M a[80:83],a[232:235],v[216:219],a[80:83]
v_fmac_f32 v214,s41,v210
v_sub_f32 v212,v212,v208
M a[80:83],a[236:239],a[196:199],a[80:83]
ds_read_b128 a[228:231],v249 offset:8704
v_fma_f32 v208,-4.0,v206,v210
M a[84:87],a[236:239],a[204:207],a[84:87]
buffer_load_dwordx2 v[200:201],v245,s[8:11],s28 offen offset:1152
M a[84:87],a[232:235],a[196:199],a[84:87]
ds_read_b128 v[224:227],v250 offset:8704
ds_read_b128 a[248:251],v249 offset:9216
M a[84:87],a[200:203],v[216:219],a[84:87]
ds_read_b128 v[216:219],v250 offset:9216
v_sub_f32 v210,v210,v206
M a[88:91],a[200:203],a[196:199],a[88:91]
v_add_f32 v206,v235,v208
v_sub_f32 v235,v235,v208
M a[88:91],a[232:235],a[204:207],a[88:91]
buffer_load_dwordx4 a[208:211],v251,s[20:23],s48 offen offset:0 sc1
M a[88:91],a[236:239],a[212:215],a[88:91]
v_fma_f32 v208,2.0,v210,v212
v_fmac_f32 v212,-2.0,v210
M a[92:95],a[236:239],v[220:223],a[92:95]
v_cvt_pk_bf16_f32 v204,v232,v204
v_cvt_pk_bf16_f32 v214,v237,v214
M a[92:95],a[232:235],a[212:215],a[92:95]
ds_read_b128 a[236:239],v249 offset:9728
v_cvt_pk_bf16_f32 v206,v233,v206
M a[92:95],a[200:203],a[204:207],a[92:95]
s_waitcnt vmcnt(12) lgkmcnt(4)
buffer_load_dwordx4 a[240:243],v251,s[20:23],s48 offen offset:1024 sc1
M a[96:99],a[192:195],a[228:231],a[96:99]
s_waitcnt vmcnt(12) lgkmcnt(3)
ds_read_b128 v[220:223],v250 offset:9728
v_cvt_pk_bf16_f32 v210,v234,v208
M a[96:99],a[244:247],v[224:227],a[96:99]
s_waitcnt vmcnt(11) lgkmcnt(3)
v_cvt_pk_bf16_f32 v208,v238,v235
v_cvt_pk_bf16_f32 v212,v236,v212
M a[96:99],a[252:255],a[248:251],a[96:99]
s_waitcnt lgkmcnt(2)
v_lshlrev_b32 v234,16,v209
v_lshlrev_b32 v232,16,v205
M a[100:103],a[252:255],v[216:219],a[100:103]
buffer_load_dwordx4 v[228:231],v251,s[20:23],s48 offen offset:2048 sc1
M a[100:103],a[244:247],a[248:251],a[100:103]
s_add_u32 s46,s44,193536
ds_read_b128 a[212:215],v249 offset:10240
v_lshlrev_b32 v233,16,v207
M a[100:103],a[192:195],v[224:227],a[100:103]
ds_read_b128 a[232:235],v250 offset:10240
v_lshlrev_b32 v237,16,v215
M a[104:107],a[192:195],a[248:251],a[104:107]
v_lshlrev_b32 v236,16,v213
v_lshlrev_b32 v235,16,v211
M a[104:107],a[244:247],v[216:219],a[104:107]
s_waitcnt lgkmcnt(3)
buffer_load_dwordx4 a[196:199],v251,s[20:23],s46 offen offset:0 sc1
M a[104:107],a[252:255],a[236:239],a[104:107]
s_waitcnt lgkmcnt(2)
v_fmac_f32 v232,s43,v234
v_fmac_f32 v237,4.0,v233
M a[108:111],a[252:255],v[220:223],a[108:111]
v_fma_f32 v238,-4.0,v234,v236
v_fmac_f32 v232,s45,v236
M a[108:111],a[244:247],a[236:239],a[108:111]
ds_read_b128 a[200:203],v250 offset:10752
v_fmac_f32 v237,s41,v235
M a[108:111],a[192:195],v[216:219],a[108:111]
ds_read_b128 a[204:207],v249 offset:10752
v_sub_f32 v236,v236,v234
M a[112:115],a[192:195],a[236:239],a[112:115]
v_fma_f32 v234,-4.0,v233,v235
v_sub_f32 v235,v235,v233
M a[112:115],a[244:247],v[220:223],a[112:115]
s_waitcnt lgkmcnt(3)
v_add_f32 v233,v238,v234
v_sub_f32 v238,v238,v234
M a[112:115],a[252:255],a[212:215],a[112:115]
s_waitcnt lgkmcnt(2)
v_fma_f32 v234,2.0,v235,v236
v_fmac_f32 v236,-2.0,v235
M a[116:119],a[252:255],a[232:235],a[116:119]
v_and_b32 v209,s42,v209
v_and_b32 v205,s42,v205
M a[116:119],a[244:247],a[212:215],a[116:119]
v_and_b32 v207,s42,v207
v_and_b32 v215,s42,v215
M a[116:119],a[192:195],v[220:223],a[116:119]
v_and_b32 v213,s42,v213
v_and_b32 v211,s42,v211
M a[120:123],a[192:195],a[212:215],a[120:123]
v_fmac_f32 v205,s43,v209
v_fmac_f32 v215,4.0,v207
M a[120:123],a[244:247],a[232:235],a[120:123]
s_waitcnt lgkmcnt(1)
v_fma_f32 v235,-4.0,v209,v213
v_fmac_f32 v205,s45,v213
M a[120:123],a[252:255],a[200:203],a[120:123]
s_waitcnt lgkmcnt(0)
v_fmac_f32 v215,s41,v211
v_sub_f32 v213,v213,v209
M a[124:127],a[252:255],a[204:207],a[124:127]
buffer_load_dwordx4 a[252:255],v251,s[20:23],s46 offen offset:1024 sc1
M a[124:127],a[244:247],a[200:203],a[124:127]
v_fma_f32 v209,-4.0,v207,v211
v_sub_f32 v211,v211,v207
M a[124:127],a[192:195],a[232:235],a[124:127]
s_waitcnt vmcnt(13)
buffer_load_dwordx4 a[244:247],v251,s[20:23],s46 offen offset:2048 sc1
M a[128:131],a[224:227],a[228:231],a[128:131]
s_waitcnt vmcnt(10)
s_add_u32 s47,s44,196608
v_add_f32 v207,v235,v209
v_sub_f32 v235,v235,v209
M a[128:131],a[220:223],v[224:227],a[128:131]
s_waitcnt vmcnt(9)
v_fma_f32 v209,2.0,v211,v213
v_fmac_f32 v213,-2.0,v211
M a[128:131],a[216:219],a[248:251],a[128:131]
v_cvt_pk_bf16_f32 v205,v232,v205
v_cvt_pk_bf16_f32 v215,v237,v215
M a[132:135],a[216:219],v[216:219],a[132:135]
buffer_load_dwordx4 a[192:195],v251,s[20:23],s47 offen offset:0 sc1
M a[132:135],a[220:223],a[248:251],a[132:135]
v_cvt_pk_bf16_f32 v207,v233,v207
v_cvt_pk_bf16_f32 v211,v234,v209
M a[132:135],a[224:227],v[224:227],a[132:135]
v_cvt_pk_bf16_f32 v209,v238,v235
v_cvt_pk_bf16_f32 v213,v236,v213
M a[136:139],a[224:227],a[248:251],a[136:139]
v_add_u32 v232,139264,v247
M a[136:139],a[220:223],v[216:219],a[136:139]
ds_write2st64_b64 v232,v[204:205],v[214:215] offset0:1 offset1:18
M a[136:139],a[216:219],a[236:239],a[136:139]
s_add_u32 s28,s30,7471360
buffer_load_dwordx2 v[204:205],v245,s[12:15],s28 offen offset:0
M a[140:143],a[216:219],v[220:223],a[140:143]
ds_write2st64_b64 v247,v[206:207],v[208:209] offset0:35 offset1:52
M a[140:143],a[220:223],a[236:239],a[140:143]
buffer_load_dwordx2 v[214:215],v245,s[16:19],s28 offen offset:1536
M a[140:143],a[224:227],v[216:219],a[140:143]
ds_write2st64_b64 v247,v[210:211],v[212:213] offset0:69 offset1:86
M a[144:147],a[224:227],a[236:239],a[144:147]
v_fmac_f32 v239,s43,v241
v_fmac_f32 v244,4.0,v240
M a[144:147],a[220:223],v[220:223],a[144:147]
buffer_load_dwordx2 v[206:207],v245,s[8:11],s28 offen offset:0
M a[144:147],a[216:219],a[212:215],a[144:147]
v_fma_f32 v232,-4.0,v241,v243
v_fmac_f32 v239,s45,v243
M a[148:151],a[216:219],a[232:235],a[148:151]
v_fmac_f32 v244,s41,v242
v_sub_f32 v243,v243,v241
M a[148:151],a[220:223],a[212:215],a[148:151]
v_fma_f32 v241,-4.0,v240,v242
v_sub_f32 v242,v242,v240
M a[148:151],a[224:227],v[220:223],a[148:151]
buffer_load_dwordx2 v[208:209],v245,s[8:11],s28 offen offset:384
M a[152:155],a[224:227],a[212:215],a[152:155]
v_add_f32 v240,v232,v241
v_sub_f32 v232,v232,v241
M a[152:155],a[220:223],a[232:235],a[152:155]
v_fma_f32 v241,2.0,v242,v243
v_fmac_f32 v243,-2.0,v242
M a[152:155],a[216:219],a[200:203],a[152:155]
v_cvt_pk_bf16_f32 v233,v239,v244
v_cvt_pk_bf16_f32 v234,v240,v232
M a[156:159],a[216:219],a[204:207],a[156:159]
buffer_load_dwordx4 a[216:219],v251,s[20:23],s47 offen offset:1024 sc1
M a[156:159],a[220:223],a[200:203],a[156:159]
v_cvt_pk_bf16_f32 v235,v241,v243
v_add_u32 v232,139264,v248
M a[156:159],a[224:227],a[232:235],a[156:159]
s_waitcnt vmcnt(11)
ds_write_b16 v232,v233 offset:0
M a[160:163],a[208:211],a[228:231],a[160:163]
s_waitcnt vmcnt(10)
ds_write_b16_d16_hi v232,v233 offset:8704
M a[160:163],a[240:243],v[224:227],a[160:163]
s_waitcnt vmcnt(9)
buffer_load_dwordx4 a[220:223],v251,s[20:23],s47 offen offset:2048 sc1
M a[160:163],v[228:231],a[248:251],a[160:163]
s_add_u32 s48,s44,199680
ds_write_b16 v248,v234 offset:17408
M a[164:167],v[228:231],v[216:219],a[164:167]
ds_write_b16_d16_hi v248,v234 offset:26112
M a[164:167],a[240:243],a[248:251],a[164:167]
ds_write_b16 v248,v235 offset:34816
M a[164:167],a[208:211],v[224:227],a[164:167]
buffer_load_dwordx2 v[210:211],v245,s[8:11],s28 offen offset:768
M a[168:171],a[208:211],a[248:251],a[168:171]
ds_write_b16_d16_hi v248,v235 offset:43520
M a[168:171],a[240:243],v[216:219],a[168:171]
v_lshlrev_b32 v234,16,v196
v_lshlrev_b32 v232,16,v192
M a[168:171],v[228:231],a[236:239],a[168:171]
v_lshlrev_b32 v233,16,v194
v_lshlrev_b32 v237,16,v202
M a[172:175],v[228:231],v[220:223],a[172:175]
buffer_load_dwordx2 v[212:213],v245,s[8:11],s28 offen offset:1152
M a[172:175],a[240:243],a[236:239],a[172:175]
s_add_u32 s29,s30,6291776
v_lshlrev_b32 v236,16,v200
v_lshlrev_b32 v235,16,v198
M a[172:175],a[208:211],v[216:219],a[172:175]
v_add_u32 v249,0x4400,v249
v_add_u32 v250,0x4400,v250
M a[176:179],a[208:211],a[236:239],a[176:179]
v_fmac_f32 v232,s43,v234
v_fmac_f32 v237,4.0,v233
M a[176:179],a[240:243],v[220:223],a[176:179]
buffer_load_short_d16_hi v239,v246,s[12:15],s29 offen offset:0
M a[176:179],v[228:231],a[212:215],a[176:179]
ds_read_b128 a[248:251],v249 offset:52224
v_fma_f32 v238,-4.0,v234,v236
M a[180:183],v[228:231],a[232:235],a[180:183]
buffer_load_short_d16_hi v240,v246,s[8:11],s29 offen offset:0
M a[180:183],a[240:243],a[212:215],a[180:183]
ds_read_b128 v[216:219],v250 offset:52224
ds_read_b128 a[236:239],v249 offset:52736
M a[180:183],a[208:211],v[220:223],a[180:183]
buffer_load_short_d16_hi v241,v246,s[8:11],s29 offen offset:384
M a[184:187],a[208:211],a[212:215],a[184:187]
ds_read_b128 v[220:223],v250 offset:52736
v_fmac_f32 v232,s45,v236
M a[184:187],a[240:243],a[232:235],a[184:187]
buffer_load_short_d16_hi v242,v246,s[8:11],s29 offen offset:768
M a[184:187],v[228:231],a[200:203],a[184:187]
v_fmac_f32 v237,s41,v235
v_sub_f32 v236,v236,v234
M a[188:191],v[228:231],a[204:207],a[188:191]
buffer_load_short_d16_hi v243,v246,s[8:11],s29 offen offset:1152
M a[188:191],a[240:243],a[200:203],a[188:191]
ds_read_b128 a[204:207],v249 offset:53248
v_fma_f32 v234,-4.0,v233,v235
M a[188:191],a[208:211],a[232:235],a[188:191]
s_waitcnt vmcnt(16) lgkmcnt(4)
buffer_load_short_d16_hi v244,v246,s[16:19],s29 offen offset:1536
M v[0:3],a[196:199],a[248:251],v[0:3]
s_waitcnt vmcnt(16) lgkmcnt(3)
ds_read_b128 v[228:231],v250 offset:53248
v_sub_f32 v235,v235,v233
M v[0:3],a[252:255],v[216:219],v[0:3]
s_waitcnt vmcnt(15) lgkmcnt(3)
buffer_load_dwordx4 a[224:227],v251,s[20:23],s48 offen offset:0 sc1
M v[0:3],a[244:247],a[236:239],v[0:3]
s_waitcnt lgkmcnt(2)
v_add_f32 v233,v238,v234
v_sub_f32 v238,v238,v234
M v[4:7],a[244:247],v[220:223],v[4:7]
v_fma_f32 v234,2.0,v235,v236
v_fmac_f32 v236,-2.0,v235
M v[4:7],a[252:255],a[236:239],v[4:7]
ds_read_b128 a[200:203],v249 offset:53760
v_and_b32 v196,s42,v196
M v[4:7],a[196:199],v[216:219],v[4:7]
buffer_load_dwordx4 a[228:231],v251,s[20:23],s48 offen offset:1024 sc1
M v[8:11],a[196:199],a[236:239],v[8:11]
ds_read_b128 a[240:243],v250 offset:53760
v_and_b32 v192,s42,v192
M v[8:11],a[252:255],v[220:223],v[8:11]
s_waitcnt lgkmcnt(3)
v_and_b32 v194,s42,v194
v_and_b32 v202,s42,v202
M v[8:11],a[244:247],a[204:207],v[8:11]
s_waitcnt lgkmcnt(2)
v_and_b32 v200,s42,v200
v_and_b32 v198,s42,v198
M v[12:15],a[244:247],v[228:231],v[12:15]
buffer_load_dwordx4 v[224:227],v251,s[20:23],s48 offen offset:2048 sc1
M v[12:15],a[252:255],a[204:207],v[12:15]
s_add_u32 s46,s44,202752
ds_read_b128 a[208:211],v250 offset:54272
v_fmac_f32 v192,s43,v196
M v[12:15],a[196:199],v[220:223],v[12:15]
ds_read_b128 a[232:235],v249 offset:54272
v_fmac_f32 v202,4.0,v194
M v[16:19],a[196:199],a[204:207],v[16:19]
v_fma_f32 v235,-4.0,v196,v200
v_fmac_f32 v192,s45,v200
M v[16:19],a[252:255],v[228:231],v[16:19]
s_waitcnt lgkmcnt(3)
buffer_load_dwordx4 a[212:215],v251,s[20:23],s46 offen offset:0 sc1
M v[16:19],a[244:247],a[200:203],v[16:19]
s_waitcnt lgkmcnt(2)
v_fmac_f32 v202,s41,v198
v_sub_f32 v200,v200,v196
M v[20:23],a[244:247],a[240:243],v[20:23]
v_fma_f32 v196,-4.0,v194,v198
v_sub_f32 v198,v198,v194
M v[20:23],a[252:255],a[200:203],v[20:23]
v_add_f32 v194,v235,v196
v_sub_f32 v235,v235,v196
M v[20:23],a[196:199],v[228:231],v[20:23]
v_fma_f32 v196,2.0,v198,v200
v_fmac_f32 v200,-2.0,v198
M v[24:27],a[196:199],a[200:203],v[24:27]
v_cvt_pk_bf16_f32 v192,v232,v192
v_cvt_pk_bf16_f32 v202,v237,v202
M v[24:27],a[252:255],a[240:243],v[24:27]
s_waitcnt lgkmcnt(1)
v_cvt_pk_bf16_f32 v194,v233,v194
v_cvt_pk_bf16_f32 v198,v234,v196
M v[24:27],a[244:247],a[208:211],v[24:27]
s_waitcnt lgkmcnt(0)
v_cvt_pk_bf16_f32 v196,v238,v235
v_cvt_pk_bf16_f32 v200,v236,v200
M v[28:31],a[244:247],a[232:235],v[28:31]
global_load_dword a244,v251,s[64:65]
M v[28:31],a[252:255],a[208:211],v[28:31]
buffer_load_dwordx4 a[244:247],v251,s[20:23],s46 offen offset:1024 sc1
M v[28:31],a[196:199],a[240:243],v[28:31]
s_waitcnt vmcnt(20)
v_lshlrev_b32 v234,16,v197
v_lshlrev_b32 v232,16,v193
M v[32:35],a[192:195],a[248:251],v[32:35]
s_waitcnt vmcnt(15)
v_lshlrev_b32 v233,16,v195
v_lshlrev_b32 v237,16,v203
M v[32:35],a[216:219],v[216:219],v[32:35]
s_waitcnt vmcnt(14)
buffer_load_dwordx4 a[252:255],v251,s[20:23],s46 offen offset:2048 sc1
M v[32:35],a[220:223],a[236:239],v[32:35]
s_add_u32 s47,s44,205824
v_lshlrev_b32 v236,16,v201
v_lshlrev_b32 v235,16,v199
M v[36:39],a[220:223],v[220:223],v[36:39]
v_fmac_f32 v232,s43,v234
v_fmac_f32 v237,4.0,v233
M v[36:39],a[216:219],a[236:239],v[36:39]
v_fma_f32 v238,-4.0,v234,v236
v_fmac_f32 v232,s45,v236
M v[36:39],a[192:195],v[216:219],v[36:39]
buffer_load_dwordx4 a[196:199],v251,s[20:23],s47 offen offset:0 sc1
M v[40:43],a[192:195],a[236:239],v[40:43]
v_fmac_f32 v237,s41,v235
v_sub_f32 v236,v236,v234
M v[40:43],a[216:219],v[220:223],v[40:43]
v_fma_f32 v234,-4.0,v233,v235
v_sub_f32 v235,v235,v233
M v[40:43],a[220:223],a[204:207],v[40:43]
v_add_f32 v233,v238,v234
v_sub_f32 v238,v238,v234
M v[44:47],a[220:223],v[228:231],v[44:47]
v_fma_f32 v234,2.0,v235,v236
v_fmac_f32 v236,-2.0,v235
M v[44:47],a[216:219],a[204:207],v[44:47]
v_and_b32 v197,s42,v197
v_and_b32 v193,s42,v193
M v[44:47],a[192:195],v[220:223],v[44:47]
v_and_b32 v195,s42,v195
v_and_b32 v203,s42,v203
M v[48:51],a[192:195],a[204:207],v[48:51]
v_and_b32 v201,s42,v201
v_and_b32 v199,s42,v199
M v[48:51],a[216:219],v[228:231],v[48:51]
v_fmac_f32 v193,s43,v197
v_fmac_f32 v203,4.0,v195
M v[48:51],a[220:223],a[200:203],v[48:51]
v_fma_f32 v235,-4.0,v197,v201
v_fmac_f32 v193,s45,v201
M v[52:55],a[220:223],a[240:243],v[52:55]
v_fmac_f32 v203,s41,v199
v_sub_f32 v201,v201,v197
M v[52:55],a[216:219],a[200:203],v[52:55]
v_fma_f32 v197,-4.0,v195,v199
v_sub_f32 v199,v199,v195
M v[52:55],a[192:195],v[228:231],v[52:55]
v_add_f32 v195,v235,v197
v_sub_f32 v235,v235,v197
M v[56:59],a[192:195],a[200:203],v[56:59]
v_fma_f32 v197,2.0,v199,v201
v_fmac_f32 v201,-2.0,v199
M v[56:59],a[216:219],a[240:243],v[56:59]
v_cvt_pk_bf16_f32 v193,v232,v193
v_cvt_pk_bf16_f32 v203,v237,v203
M v[56:59],a[220:223],a[208:211],v[56:59]
v_cvt_pk_bf16_f32 v195,v233,v195
v_cvt_pk_bf16_f32 v199,v234,v197
M v[60:63],a[220:223],a[232:235],v[60:63]
buffer_load_dwordx4 a[220:223],v251,s[20:23],s47 offen offset:1024 sc1
M v[60:63],a[216:219],a[208:211],v[60:63]
v_cvt_pk_bf16_f32 v197,v238,v235
v_cvt_pk_bf16_f32 v201,v236,v201
M v[60:63],a[192:195],a[240:243],v[60:63]
s_waitcnt vmcnt(8)
buffer_load_dwordx4 a[216:219],v251,s[20:23],s47 offen offset:2048 sc1
M v[64:67],a[224:227],a[248:251],v[64:67]
s_waitcnt vmcnt(8)
s_add_u32 s48,s44,208896
v_add_u32 v232,139264,v247
M v[64:67],a[228:231],v[216:219],v[64:67]
s_waitcnt vmcnt(7)
ds_write2st64_b64 v232,v[192:193],v[202:203] offset0:2 offset1:19
M v[64:67],v[224:227],a[236:239],v[64:67]
s_add_u32 s28,s30,6291776
ds_write2st64_b64 v247,v[194:195],v[196:197] offset0:36 offset1:53
M v[68:71],v[224:227],v[220:223],v[68:71]
buffer_load_dwordx2 v[192:193],v245,s[12:15],s28 offen offset:0
M v[68:71],a[228:231],a[236:239],v[68:71]
ds_write2st64_b64 v247,v[198:199],v[200:201] offset0:70 offset1:87
M v[68:71],a[224:227],v[216:219],v[68:71]
buffer_load_dwordx2 v[202:203],v245,s[16:19],s28 offen offset:1536
M v[72:75],a[224:227],a[236:239],v[72:75]
v_lshlrev_b32 v234,16,v208
v_lshlrev_b32 v232,16,v204
M v[72:75],a[228:231],v[220:223],v[72:75]
v_lshlrev_b32 v233,16,v206
v_lshlrev_b32 v237,16,v214
M v[72:75],v[224:227],a[204:207],v[72:75]
v_lshlrev_b32 v236,16,v212
v_lshlrev_b32 v235,16,v210
M v[76:79],v[224:227],v[228:231],v[76:79]
buffer_load_dwordx2 v[194:195],v245,s[8:11],s28 offen offset:0
M v[76:79],a[228:231],a[204:207],v[76:79]
v_fmac_f32 v232,s43,v234
v_fmac_f32 v237,4.0,v233
M v[76:79],a[224:227],v[220:223],v[76:79]
v_fma_f32 v238,-4.0,v234,v236
v_fmac_f32 v232,s45,v236
M v[80:83],a[224:227],a[204:207],v[80:83]
v_fmac_f32 v237,s41,v235
v_sub_f32 v236,v236,v234
M v[80:83],a[228:231],v[228:231],v[80:83]
buffer_load_dwordx2 v[196:197],v245,s[8:11],s28 offen offset:384
M v[80:83],v[224:227],a[200:203],v[80:83]
ds_read_b128 a[236:239],v249 offset:60928
v_fma_f32 v234,-4.0,v233,v235
M v[84:87],v[224:227],a[240:243],v[84:87]
ds_read_b128 v[220:223],v250 offset:60928
v_sub_f32 v235,v235,v233
M v[84:87],a[228:231],a[200:203],v[84:87]
ds_read_b128 a[204:207],v249 offset:61440
v_add_f32 v233,v238,v234
M v[84:87],a[224:227],v[228:231],v[84:87]
buffer_load_dwordx2 v[198:199],v245,s[8:11],s28 offen offset:768
M v[88:91],a[224:227],a[200:203],v[88:91]
ds_read_b128 v[228:231],v250 offset:61440
v_sub_f32 v238,v238,v234
M v[88:91],a[228:231],a[240:243],v[88:91]
v_fma_f32 v234,2.0,v235,v236
v_fmac_f32 v236,-2.0,v235
M v[88:91],v[224:227],a[208:211],v[88:91]
v_and_b32 v208,s42,v208
v_and_b32 v204,s42,v204
M v[92:95],v[224:227],a[232:235],v[92:95]
buffer_load_dwordx2 v[200:201],v245,s[8:11],s28 offen offset:1152
M v[92:95],a[228:231],a[208:211],v[92:95]
ds_read_b128 a[232:235],v249 offset:61952
v_and_b32 v206,s42,v206
M v[92:95],a[224:227],a[240:243],v[92:95]
s_waitcnt vmcnt(12) lgkmcnt(4)
ds_read_b128 v[224:227],v250 offset:61952
v_and_b32 v214,s42,v214
M v[96:99],a[212:215],a[236:239],v[96:99]
s_waitcnt vmcnt(10) lgkmcnt(4)
v_and_b32 v212,s42,v212
v_and_b32 v210,s42,v210
M v[96:99],a[244:247],v[220:223],v[96:99]
s_waitcnt vmcnt(9) lgkmcnt(3)
buffer_load_dwordx4 a[192:195],v251,s[20:23],s48 offen offset:0 sc1
M v[96:99],a[252:255],a[204:207],v[96:99]
s_waitcnt lgkmcnt(2)
v_fmac_f32 v204,s43,v208
v_fmac_f32 v214,4.0,v206
M v[100:103],a[252:255],v[228:231],v[100:103]
v_fma_f32 v235,-4.0,v208,v212
v_fmac_f32 v204,s45,v212
M v[100:103],a[244:247],a[204:207],v[100:103]
ds_read_b128 a[208:211],v249 offset:62464
v_fmac_f32 v214,s41,v210
M v[100:103],a[212:215],v[220:223],v[100:103]
buffer_load_dwordx4 a[248:251],v251,s[20:23],s48 offen offset:1024 sc1
M v[104:107],a[212:215],a[204:207],v[104:107]
ds_read_b128 a[228:231],v250 offset:62464
v_sub_f32 v212,v212,v208
M v[104:107],a[244:247],v[228:231],v[104:107]
s_waitcnt lgkmcnt(3)
v_fma_f32 v208,-4.0,v206,v210
v_sub_f32 v210,v210,v206
M v[104:107],a[252:255],a[232:235],v[104:107]
s_waitcnt lgkmcnt(2)
v_add_f32 v206,v235,v208
v_sub_f32 v235,v235,v208
M v[108:111],a[252:255],v[224:227],v[108:111]
buffer_load_dwordx4 v[216:219],v251,s[20:23],s48 offen offset:2048 sc1
M v[108:111],a[244:247],a[232:235],v[108:111]
s_add_u32 s46,s44,230400
ds_read_b128 a[224:227],v250 offset:62976
v_fma_f32 v208,2.0,v210,v212
M v[108:111],a[212:215],v[228:231],v[108:111]
ds_read_b128 a[240:243],v249 offset:62976
v_fmac_f32 v212,-2.0,v210
M v[112:115],a[212:215],a[232:235],v[112:115]
v_cvt_pk_bf16_f32 v204,v232,v204
v_cvt_pk_bf16_f32 v214,v237,v214
M v[112:115],a[244:247],v[224:227],v[112:115]
s_waitcnt lgkmcnt(3)
buffer_load_dwordx4 a[200:203],v251,s[20:23],s46 offen offset:0 sc1
M v[112:115],a[252:255],a[208:211],v[112:115]
s_waitcnt lgkmcnt(2)
v_cvt_pk_bf16_f32 v206,v233,v206
v_cvt_pk_bf16_f32 v210,v234,v208
M v[116:119],a[252:255],a[228:231],v[116:119]
v_cvt_pk_bf16_f32 v208,v238,v235
v_cvt_pk_bf16_f32 v212,v236,v212
M v[116:119],a[244:247],a[208:211],v[116:119]
v_lshlrev_b32 v234,16,v209
v_lshlrev_b32 v232,16,v205
M v[116:119],a[212:215],v[224:227],v[116:119]
v_lshlrev_b32 v233,16,v207
v_lshlrev_b32 v237,16,v215
M v[120:123],a[212:215],a[208:211],v[120:123]
v_lshlrev_b32 v236,16,v213
v_lshlrev_b32 v235,16,v211
M v[120:123],a[244:247],a[228:231],v[120:123]
s_waitcnt lgkmcnt(1)
v_fmac_f32 v232,s43,v234
v_fmac_f32 v237,4.0,v233
M v[120:123],a[252:255],a[224:227],v[120:123]
s_waitcnt lgkmcnt(0)
v_fma_f32 v238,-4.0,v234,v236
v_fmac_f32 v232,s45,v236
M v[124:127],a[252:255],a[240:243],v[124:127]
buffer_load_dwordx4 a[252:255],v251,s[20:23],s46 offen offset:1024 sc1
M v[124:127],a[244:247],a[224:227],v[124:127]
v_fmac_f32 v237,s41,v235
v_sub_f32 v236,v236,v234
M v[124:127],a[212:215],a[228:231],v[124:127]
s_waitcnt vmcnt(13)
buffer_load_dwordx4 a[244:247],v251,s[20:23],s46 offen offset:2048 sc1
M v[128:131],a[196:199],a[236:239],v[128:131]
s_waitcnt vmcnt(13)
s_add_u32 s47,s44,233472
v_fma_f32 v234,-4.0,v233,v235
v_sub_f32 v235,v235,v233
M v[128:131],a[220:223],v[220:223],v[128:131]
s_waitcnt vmcnt(12)
v_add_f32 v233,v238,v234
v_sub_f32 v238,v238,v234
M v[128:131],a[216:219],a[204:207],v[128:131]
v_fma_f32 v234,2.0,v235,v236
v_fmac_f32 v236,-2.0,v235
M v[132:135],a[216:219],v[228:231],v[132:135]
buffer_load_dwordx4 a[212:215],v251,s[20:23],s47 offen offset:0 sc1
M v[132:135],a[220:223],a[204:207],v[132:135]
v_and_b32 v209,s42,v209
v_and_b32 v205,s42,v205
M v[132:135],a[196:199],v[220:223],v[132:135]
v_and_b32 v207,s42,v207
v_and_b32 v215,s42,v215
M v[136:139],a[196:199],a[204:207],v[136:139]
v_and_b32 v213,s42,v213
v_and_b32 v211,s42,v211
M v[136:139],a[220:223],v[228:231],v[136:139]
v_fmac_f32 v205,s43,v209
v_fmac_f32 v215,4.0,v207
M v[136:139],a[216:219],a[232:235],v[136:139]
v_fma_f32 v235,-4.0,v209,v213
v_fmac_f32 v205,s45,v213
M v[140:143],a[216:219],v[224:227],v[140:143]
v_fmac_f32 v215,s41,v211
v_sub_f32 v213,v213,v209
M v[140:143],a[220:223],a[232:235],v[140:143]
v_fma_f32 v209,-4.0,v207,v211
v_sub_f32 v211,v211,v207
M v[140:143],a[196:199],v[228:231],v[140:143]
v_add_f32 v207,v235,v209
v_sub_f32 v235,v235,v209
M v[144:147],a[196:199],a[232:235],v[144:147]
v_fma_f32 v209,2.0,v211,v213
v_fmac_f32 v213,-2.0,v211
M v[144:147],a[220:223],v[224:227],v[144:147]
v_cvt_pk_bf16_f32 v205,v232,v205
v_cvt_pk_bf16_f32 v215,v237,v215
M v[144:147],a[216:219],a[208:211],v[144:147]
v_cvt_pk_bf16_f32 v207,v233,v207
v_cvt_pk_bf16_f32 v211,v234,v209
M v[148:151],a[216:219],a[228:231],v[148:151]
v_cvt_pk_bf16_f32 v209,v238,v235
v_cvt_pk_bf16_f32 v213,v236,v213
M v[148:151],a[220:223],a[208:211],v[148:151]
v_add_u32 v232,139264,v247
M v[148:151],a[196:199],v[224:227],v[148:151]
ds_write2st64_b64 v232,v[204:205],v[214:215] offset0:3 offset1:20
M v[152:155],a[196:199],a[208:211],v[152:155]
s_add_u32 s28,s30,6684992
buffer_load_dwordx2 v[204:205],v245,s[12:15],s28 offen offset:0
M v[152:155],a[220:223],a[228:231],v[152:155]
ds_write2st64_b64 v247,v[206:207],v[208:209] offset0:37 offset1:54
M v[152:155],a[216:219],a[224:227],v[152:155]
buffer_load_dwordx2 v[214:215],v245,s[16:19],s28 offen offset:1536
M v[156:159],a[216:219],a[240:243],v[156:159]
ds_write2st64_b64 v247,v[210:211],v[212:213] offset0:71 offset1:88
M v[156:159],a[220:223],a[224:227],v[156:159]
s_waitcnt vmcnt(11)
v_lshlrev_b32 v234,16,v196
v_lshlrev_b32 v232,16,v192
M v[156:159],a[196:199],a[228:231],v[156:159]
s_waitcnt vmcnt(8)
buffer_load_dwordx4 a[216:219],v251,s[20:23],s47 offen offset:1024 sc1
M v[160:163],a[192:195],a[236:239],v[160:163]
s_waitcnt vmcnt(8)
v_lshlrev_b32 v233,16,v194
v_lshlrev_b32 v237,16,v202
M v[160:163],a[248:251],v[220:223],v[160:163]
s_waitcnt vmcnt(7)
v_lshlrev_b32 v236,16,v200
v_lshlrev_b32 v235,16,v198
M v[160:163],v[216:219],a[204:207],v[160:163]
v_fmac_f32 v232,s43,v234
v_fmac_f32 v237,4.0,v233
M v[164:167],v[216:219],v[228:231],v[164:167]
buffer_load_dwordx4 a[220:223],v251,s[20:23],s47 offen offset:2048 sc1
M v[164:167],a[248:251],a[204:207],v[164:167]
s_add_u32 s48,s44,236544
v_fma_f32 v238,-4.0,v234,v236
v_fmac_f32 v232,s45,v236
M v[164:167],a[192:195],v[220:223],v[164:167]
v_fmac_f32 v237,s41,v235
v_sub_f32 v236,v236,v234
M v[168:171],a[192:195],a[204:207],v[168:171]
v_fma_f32 v234,-4.0,v233,v235
v_sub_f32 v235,v235,v233
M v[168:171],a[248:251],v[228:231],v[168:171]
buffer_load_dwordx2 v[206:207],v245,s[8:11],s28 offen offset:0
M v[168:171],v[216:219],a[232:235],v[168:171]
v_add_f32 v233,v238,v234
v_sub_f32 v238,v238,v234
M v[172:175],v[216:219],v[224:227],v[172:175]
v_fma_f32 v234,2.0,v235,v236
v_fmac_f32 v236,-2.0,v235
M v[172:175],a[248:251],a[232:235],v[172:175]
v_and_b32 v196,s42,v196
v_and_b32 v192,s42,v192
M v[172:175],a[192:195],v[228:231],v[172:175]
buffer_load_dwordx2 v[208:209],v245,s[8:11],s28 offen offset:384
M v[176:179],a[192:195],a[232:235],v[176:179]
v_and_b32 v194,s42,v194
v_and_b32 v202,s42,v202
M v[176:179],a[248:251],v[224:227],v[176:179]
v_and_b32 v200,s42,v200
v_and_b32 v198,s42,v198
M v[176:179],v[216:219],a[208:211],v[176:179]
s_waitcnt lgkmcnt(0)
s_barrier
ds_read_b128 a[204:207],v249 offset:0
M v[180:183],v[216:219],a[228:231],v[180:183]
buffer_load_dwordx2 v[210:211],v245,s[8:11],s28 offen offset:768
M v[180:183],a[248:251],a[208:211],v[180:183]
ds_read_b128 v[228:231],v250 offset:0
ds_read_b128 a[232:235],v249 offset:512
M v[180:183],a[192:195],v[224:227],v[180:183]
ds_read_b128 v[224:227],v250 offset:512
v_fmac_f32 v192,s43,v196
M v[184:187],a[192:195],a[208:211],v[184:187]
v_fmac_f32 v202,4.0,v194
v_fma_f32 v235,-4.0,v196,v200
M v[184:187],a[248:251],a[228:231],v[184:187]
buffer_load_dwordx2 v[212:213],v245,s[8:11],s28 offen offset:1152
M v[184:187],v[216:219],a[224:227],v[184:187]
v_fmac_f32 v192,s45,v200
v_fmac_f32 v202,s41,v198
M v[188:191],v[216:219],a[240:243],v[188:191]
v_sub_f32 v200,v200,v196
v_fma_f32 v196,-4.0,v194,v198
M v[188:191],a[248:251],a[224:227],v[188:191]
ds_read_b128 a[240:243],v249 offset:1024
v_sub_f32 v198,v198,v194
M v[188:191],a[192:195],a[228:231],v[188:191]
s_waitcnt vmcnt(11) lgkmcnt(4)
buffer_load_dwordx4 a[196:199],v251,s[20:23],s48 offen offset:0 sc1
M a[0:3],a[200:203],a[204:207],a[0:3]
s_waitcnt vmcnt(11) lgkmcnt(3)
ds_read_b128 v[216:219],v250 offset:1024
v_add_f32 v194,v235,v196
M a[0:3],a[252:255],v[228:231],a[0:3]
s_waitcnt vmcnt(10) lgkmcnt(3)
v_sub_f32 v235,v235,v196
v_fma_f32 v196,2.0,v198,v200
M a[0:3],a[244:247],a[232:235],a[0:3]
s_waitcnt lgkmcnt(2)
v_fmac_f32 v200,-2.0,v198
v_cvt_pk_bf16_f32 v192,v232,v192
M a[4:7],a[244:247],v[224:227],a[4:7]
buffer_load_dwordx4 a[236:239],v251,s[20:23],s48 offen offset:1024 sc1
M a[4:7],a[252:255],a[232:235],a[4:7]
ds_read_b128 a[224:227],v249 offset:1536
v_cvt_pk_bf16_f32 v202,v237,v202
M a[4:7],a[200:203],v[228:231],a[4:7]
ds_read_b128 a[248:251],v250 offset:1536
v_cvt_pk_bf16_f32 v194,v233,v194
M a[8:11],a[200:203],a[232:235],a[8:11]
v_cvt_pk_bf16_f32 v198,v234,v196
v_cvt_pk_bf16_f32 v196,v238,v235
M a[8:11],a[252:255],v[224:227],a[8:11]
s_waitcnt lgkmcnt(3)
buffer_load_dwordx4 v[220:223],v251,s[20:23],s48 offen offset:2048 sc1
M a[8:11],a[244:247],a[240:243],a[8:11]
s_waitcnt lgkmcnt(2)
s_add_u32 s46,s44,239616
v_cvt_pk_bf16_f32 v200,v236,v200
v_lshlrev_b32 v234,16,v197
M a[12:15],a[244:247],v[216:219],a[12:15]
v_lshlrev_b32 v232,16,v193
v_lshlrev_b32 v233,16,v195
M a[12:15],a[252:255],a[240:243],a[12:15]
ds_read_b128 a[192:195],v250 offset:2048
v_lshlrev_b32 v237,16,v203
M a[12:15],a[200:203],v[224:227],a[12:15]
buffer_load_dwordx4 a[208:211],v251,s[20:23],s46 offen offset:0 sc1
M a[16:19],a[200:203],a[240:243],a[16:19]
ds_read_b128 a[228:231],v249 offset:2048
v_lshlrev_b32 v236,16,v201
M a[16:19],a[252:255],v[216:219],a[16:19]
s_waitcnt lgkmcnt(3)
v_lshlrev_b32 v235,16,v199
v_fmac_f32 v232,s43,v234
M a[16:19],a[244:247],a[224:227],a[16:19]
s_waitcnt lgkmcnt(2)
v_fmac_f32 v237,4.0,v233
v_fma_f32 v238,-4.0,v234,v236
M a[20:23],a[244:247],a[248:251],a[20:23]
v_fmac_f32 v232,s45,v236
v_fmac_f32 v237,s41,v235
M a[20:23],a[252:255],a[224:227],a[20:23]
v_sub_f32 v236,v236,v234
v_fma_f32 v234,-4.0,v233,v235
M a[20:23],a[200:203],v[216:219],a[20:23]
v_sub_f32 v235,v235,v233
v_add_f32 v233,v238,v234
M a[24:27],a[200:203],a[224:227],a[24:27]
v_sub_f32 v238,v238,v234
v_fma_f32 v234,2.0,v235,v236
M a[24:27],a[252:255],a[248:251],a[24:27]
s_waitcnt lgkmcnt(1)
v_fmac_f32 v236,-2.0,v235
v_and_b32 v197,s42,v197
M a[24:27],a[244:247],a[192:195],a[24:27]
s_waitcnt lgkmcnt(0)
v_and_b32 v193,s42,v193
v_and_b32 v195,s42,v195
M a[28:31],a[244:247],a[228:231],a[28:31]
buffer_load_dwordx4 a[244:247],v251,s[20:23],s46 offen offset:1024 sc1
M a[28:31],a[252:255],a[192:195],a[28:31]
v_and_b32 v203,s42,v203
v_and_b32 v201,s42,v201
M a[28:31],a[200:203],a[248:251],a[28:31]
s_waitcnt vmcnt(13)
buffer_load_dwordx4 a[252:255],v251,s[20:23],s46 offen offset:2048 sc1
M a[32:35],a[212:215],a[204:207],a[32:35]
s_waitcnt vmcnt(11)
s_add_u32 s47,s44,242688
v_and_b32 v199,s42,v199
v_fmac_f32 v193,s43,v197
M a[32:35],a[216:219],v[228:231],a[32:35]
s_waitcnt vmcnt(10)
v_fmac_f32 v203,4.0,v195
v_fma_f32 v235,-4.0,v197,v201
M a[32:35],a[220:223],a[232:235],a[32:35]
v_fmac_f32 v193,s45,v201
v_fmac_f32 v203,s41,v199
M a[36:39],a[220:223],v[224:227],a[36:39]
buffer_load_dwordx4 a[200:203],v251,s[20:23],s47 offen offset:0 sc1
M a[36:39],a[216:219],a[232:235],a[36:39]
v_sub_f32 v201,v201,v197
v_fma_f32 v197,-4.0,v195,v199
M a[36:39],a[212:215],v[228:231],a[36:39]
v_sub_f32 v199,v199,v195
v_add_f32 v195,v235,v197
M a[40:43],a[212:215],a[232:235],a[40:43]
v_sub_f32 v235,v235,v197
v_fma_f32 v197,2.0,v199,v201
M a[40:43],a[216:219],v[224:227],a[40:43]
v_fmac_f32 v201,-2.0,v199
v_cvt_pk_bf16_f32 v193,v232,v193
M a[40:43],a[220:223],a[240:243],a[40:43]
v_cvt_pk_bf16_f32 v203,v237,v203
v_cvt_pk_bf16_f32 v195,v233,v195
M a[44:47],a[220:223],v[216:219],a[44:47]
v_cvt_pk_bf16_f32 v199,v234,v197
v_cvt_pk_bf16_f32 v197,v238,v235
M a[44:47],a[216:219],a[240:243],a[44:47]
v_cvt_pk_bf16_f32 v201,v236,v201
M a[44:47],a[212:215],v[224:227],a[44:47]
ds_write2st64_b64 v247,v[192:193],v[202:203] offset0:136 offset1:153
M a[48:51],a[212:215],a[240:243],a[48:51]
s_add_u32 s28,s30,7078208
buffer_load_dwordx2 v[192:193],v245,s[12:15],s28 offen offset:0
M a[48:51],a[216:219],v[216:219],a[48:51]
ds_write2st64_b64 v247,v[194:195],v[196:197] offset0:0 offset1:17
M a[48:51],a[220:223],a[224:227],a[48:51]
buffer_load_dwordx2 v[202:203],v245,s[16:19],s28 offen offset:1536
M a[52:55],a[220:223],a[248:251],a[52:55]
M a[52:55],a[216:219],a[224:227],a[52:55]
M a[52:55],a[212:215],v[216:219],a[52:55]
M a[56:59],a[212:215],a[224:227],a[56:59]
buffer_load_dwordx2 v[194:195],v245,s[8:11],s28 offen offset:0
M a[56:59],a[216:219],a[248:251],a[56:59]
M a[56:59],a[220:223],a[192:195],a[56:59]
M a[60:63],a[220:223],a[228:231],a[60:63]
M a[60:63],a[216:219],a[192:195],a[60:63]
buffer_load_dwordx4 a[220:223],v251,s[20:23],s47 offen offset:1024 sc1
M a[60:63],a[212:215],a[248:251],a[60:63]
s_waitcnt vmcnt(10)
M a[64:67],a[196:199],a[204:207],a[64:67]
s_waitcnt vmcnt(9)
M a[64:67],a[236:239],v[228:231],a[64:67]
s_waitcnt vmcnt(8)
M a[64:67],v[220:223],a[232:235],a[64:67]
buffer_load_dwordx4 a[216:219],v251,s[20:23],s47 offen offset:2048 sc1
M a[68:71],v[220:223],v[224:227],a[68:71]
s_add_u32 s48,s44,245760
M a[68:71],a[236:239],a[232:235],a[68:71]
M a[68:71],a[196:199],v[228:231],a[68:71]
M a[72:75],a[196:199],a[232:235],a[72:75]
buffer_load_dwordx2 v[196:197],v245,s[8:11],s28 offen offset:384
M a[72:75],a[236:239],v[224:227],a[72:75]
M a[72:75],v[220:223],a[240:243],a[72:75]
M a[76:79],v[220:223],v[216:219],a[76:79]
M a[76:79],a[236:239],a[240:243],a[76:79]
buffer_load_dwordx4 a[212:215],v251,s[20:23],s48 offen offset:0 sc1
M a[76:79],a[196:199],v[224:227],a[76:79]
M a[80:83],a[196:199],a[240:243],a[80:83]
M a[80:83],a[236:239],v[216:219],a[80:83]
M a[80:83],v[220:223],a[224:227],a[80:83]
buffer_load_dwordx4 a[204:207],v251,s[20:23],s48 offen offset:1024 sc1
M a[84:87],v[220:223],a[248:251],a[84:87]
ds_read_b128 a[232:235],v249 offset:8704
ds_read_b128 v[224:227],v250 offset:8704
M a[84:87],a[236:239],a[224:227],a[84:87]
ds_read_b128 a[240:243],v249 offset:9216
M a[84:87],a[196:199],v[216:219],a[84:87]
ds_read_b128 v[216:219],v250 offset:9216
M a[88:91],a[196:199],a[224:227],a[88:91]
buffer_load_dwordx4 v[228:231],v251,s[20:23],s48 offen offset:2048 sc1
M a[88:91],a[236:239],a[248:251],a[88:91]
s_add_u32 s46,s44,248832
M a[88:91],v[220:223],a[192:195],a[88:91]
M a[92:95],v[220:223],a[228:231],a[92:95]
M a[92:95],a[236:239],a[192:195],a[92:95]
buffer_load_dwordx4 a[224:227],v251,s[20:23],s46 offen offset:0 sc1
M a[92:95],a[196:199],a[248:251],a[92:95]
s_waitcnt vmcnt(13) lgkmcnt(3)
ds_read_b128 a[228:231],v249 offset:9728
ds_read_b128 v[220:223],v250 offset:9728
M a[96:99],a[208:211],a[232:235],a[96:99]
s_waitcnt vmcnt(12) lgkmcnt(4)
M a[96:99],a[244:247],v[224:227],a[96:99]
s_waitcnt vmcnt(11) lgkmcnt(3)
M a[96:99],a[252:255],a[240:243],a[96:99]
s_waitcnt lgkmcnt(2)
M a[100:103],a[252:255],v[216:219],a[100:103]
M a[100:103],a[244:247],a[240:243],a[100:103]
ds_read_b128 a[192:195],v249 offset:10240
M a[100:103],a[208:211],v[224:227],a[100:103]
ds_read_b128 a[236:239],v250 offset:10240
M a[104:107],a[208:211],a[240:243],a[104:107]
M a[104:107],a[244:247],v[216:219],a[104:107]
s_waitcnt lgkmcnt(3)
M a[104:107],a[252:255],a[228:231],a[104:107]
s_waitcnt lgkmcnt(2)
M a[108:111],a[252:255],v[220:223],a[108:111]
M a[108:111],a[244:247],a[228:231],a[108:111]
ds_read_b128 a[196:199],v250 offset:10752
M a[108:111],a[208:211],v[216:219],a[108:111]
ds_read_b128 a[248:251],v249 offset:10752
M a[112:115],a[208:211],a[228:231],a[112:115]
M a[112:115],a[244:247],v[220:223],a[112:115]
s_waitcnt lgkmcnt(3)
M a[112:115],a[252:255],a[192:195],a[112:115]
s_waitcnt lgkmcnt(2)
M a[116:119],a[252:255],a[236:239],a[116:119]
M a[116:119],a[244:247],a[192:195],a[116:119]
M a[116:119],a[208:211],v[220:223],a[116:119]
M a[120:123],a[208:211],a[192:195],a[120:123]
M a[120:123],a[244:247],a[236:239],a[120:123]
s_waitcnt lgkmcnt(1)
M a[120:123],a[252:255],a[196:199],a[120:123]
s_waitcnt lgkmcnt(0)
M a[124:127],a[252:255],a[248:251],a[124:127]
buffer_load_dwordx4 a[252:255],v251,s[20:23],s46 offen offset:1024 sc1
M a[124:127],a[244:247],a[196:199],a[124:127]
M a[124:127],a[208:211],a[236:239],a[124:127]
s_waitcnt vmcnt(11)
buffer_load_dwordx4 a[244:247],v251,s[20:23],s46 offen offset:2048 sc1
M a[128:131],a[200:203],a[232:235],a[128:131]
s_waitcnt vmcnt(8)
s_add_u32 s47,s44,251904
M a[128:131],a[220:223],v[224:227],a[128:131]
s_waitcnt vmcnt(7)
M a[128:131],a[216:219],a[240:243],a[128:131]
M a[132:135],a[216:219],v[216:219],a[132:135]
buffer_load_dwordx4 a[208:211],v251,s[20:23],s47 offen offset:0 sc1
M a[132:135],a[220:223],a[240:243],a[132:135]
M a[132:135],a[200:203],v[224:227],a[132:135]
M a[136:139],a[200:203],a[240:243],a[136:139]
s_barrier
ds_write2st64_b64 v247,v[198:199],v[200:201] offset0:34 offset1:51
M a[136:139],a[220:223],v[216:219],a[136:139]
buffer_load_dwordx2 v[198:199],v245,s[8:11],s28 offen offset:768
M a[136:139],a[216:219],a[228:231],a[136:139]
v_lshlrev_b32 v234,16,v208
v_lshlrev_b32 v232,16,v204
M a[140:143],a[216:219],v[220:223],a[140:143]
v_lshlrev_b32 v233,16,v206
v_lshlrev_b32 v237,16,v214
M a[140:143],a[220:223],a[228:231],a[140:143]
buffer_load_dwordx2 v[200:201],v245,s[8:11],s28 offen offset:1152
M a[140:143],a[200:203],v[216:219],a[140:143]
v_lshlrev_b32 v236,16,v212
v_lshlrev_b32 v235,16,v210
M a[144:147],a[200:203],a[228:231],a[144:147]
v_fmac_f32 v232,s43,v234
v_fmac_f32 v237,4.0,v233
M a[144:147],a[220:223],v[220:223],a[144:147]
v_fma_f32 v238,-4.0,v234,v236
v_fmac_f32 v232,s45,v236
M a[144:147],a[216:219],a[192:195],a[144:147]
v_fmac_f32 v237,s41,v235
v_sub_f32 v236,v236,v234
M a[148:151],a[216:219],a[236:239],a[148:151]
v_fma_f32 v234,-4.0,v233,v235
v_sub_f32 v235,v235,v233
M a[148:151],a[220:223],a[192:195],a[148:151]
v_add_f32 v233,v238,v234
v_sub_f32 v238,v238,v234
M a[148:151],a[200:203],v[220:223],a[148:151]
v_fma_f32 v234,2.0,v235,v236
v_fmac_f32 v236,-2.0,v235
M a[152:155],a[200:203],a[192:195],a[152:155]
v_and_b32 v208,s42,v208
v_and_b32 v204,s42,v204
M a[152:155],a[220:223],a[236:239],a[152:155]
v_and_b32 v206,s42,v206
v_and_b32 v214,s42,v214
M a[152:155],a[216:219],a[196:199],a[152:155]
v_and_b32 v212,s42,v212
v_and_b32 v210,s42,v210
M a[156:159],a[216:219],a[248:251],a[156:159]
buffer_load_dwordx4 a[216:219],v251,s[20:23],s47 offen offset:1024 sc1
M a[156:159],a[220:223],a[196:199],a[156:159]
v_fmac_f32 v204,s43,v208
v_fmac_f32 v214,4.0,v206
M a[156:159],a[200:203],a[236:239],a[156:159]
s_waitcnt vmcnt(9)
buffer_load_dwordx4 a[220:223],v251,s[20:23],s47 offen offset:2048 sc1
M a[160:163],a[212:215],a[232:235],a[160:163]
s_waitcnt vmcnt(9)
s_add_u32 s48,s44,254976
v_fma_f32 v235,-4.0,v208,v212
v_fmac_f32 v204,s45,v212
M a[160:163],a[204:207],v[224:227],a[160:163]
s_waitcnt vmcnt(8)
v_fmac_f32 v214,s41,v210
v_sub_f32 v212,v212,v208
M a[160:163],v[228:231],a[240:243],a[160:163]
v_fma_f32 v208,-4.0,v206,v210
v_sub_f32 v210,v210,v206
M a[164:167],v[228:231],v[216:219],a[164:167]
buffer_load_dwordx4 a[200:203],v251,s[20:23],s48 offen offset:0 sc1
M a[164:167],a[204:207],a[240:243],a[164:167]
v_add_f32 v206,v235,v208
v_sub_f32 v235,v235,v208
M a[164:167],a[212:215],v[224:227],a[164:167]
v_fma_f32 v208,2.0,v210,v212
v_fmac_f32 v212,-2.0,v210
M a[168:171],a[212:215],a[240:243],a[168:171]
v_cvt_pk_bf16_f32 v204,v232,v204
v_cvt_pk_bf16_f32 v214,v237,v214
M a[168:171],a[204:207],v[216:219],a[168:171]
buffer_load_dwordx4 a[232:235],v251,s[20:23],s48 offen offset:1024 sc1
M a[168:171],v[228:231],a[228:231],a[168:171]
v_cvt_pk_bf16_f32 v206,v233,v206
v_cvt_pk_bf16_f32 v210,v234,v208
M a[172:175],v[228:231],v[220:223],a[172:175]
v_cvt_pk_bf16_f32 v208,v238,v235
v_cvt_pk_bf16_f32 v212,v236,v212
M a[172:175],a[204:207],a[228:231],a[172:175]
v_lshlrev_b32 v234,16,v209
v_lshlrev_b32 v232,16,v205
M a[172:175],a[212:215],v[216:219],a[172:175]
buffer_load_dwordx4 v[224:227],v251,s[20:23],s48 offen offset:2048 sc1
M a[176:179],a[212:215],a[228:231],a[176:179]
s_add_u32 s46,s44,258048
v_lshlrev_b32 v233,16,v207
v_lshlrev_b32 v237,16,v215
M a[176:179],a[204:207],v[220:223],a[176:179]
v_lshlrev_b32 v236,16,v213
v_lshlrev_b32 v235,16,v211
M a[176:179],v[228:231],a[192:195],a[176:179]
ds_read_b128 a[240:243],v249 offset:17408
v_fmac_f32 v232,s43,v234
M a[180:183],v[228:231],a[236:239],a[180:183]
ds_read_b128 v[216:219],v250 offset:17408
v_fmac_f32 v237,4.0,v233
M a[180:183],a[204:207],a[192:195],a[180:183]
ds_read_b128 a[228:231],v249 offset:17920
v_fma_f32 v238,-4.0,v234,v236
M a[180:183],a[212:215],v[220:223],a[180:183]
ds_read_b128 v[220:223],v250 offset:17920
v_fmac_f32 v232,s45,v236
M a[184:187],a[212:215],a[192:195],a[184:187]
buffer_load_dwordx4 a[192:195],v251,s[20:23],s46 offen offset:0 sc1
M a[184:187],a[204:207],a[236:239],a[184:187]
v_fmac_f32 v237,s41,v235
v_sub_f32 v236,v236,v234
M a[184:187],v[228:231],a[196:199],a[184:187]
v_fma_f32 v234,-4.0,v233,v235
v_sub_f32 v235,v235,v233
M a[188:191],v[228:231],a[248:251],a[188:191]
v_add_f32 v233,v238,v234
v_sub_f32 v238,v238,v234
M a[188:191],a[204:207],a[196:199],a[188:191]
ds_read_b128 a[248:251],v249 offset:18432
v_fma_f32 v234,2.0,v235,v236
M a[188:191],a[212:215],a[236:239],a[188:191]
s_waitcnt vmcnt(11) lgkmcnt(4)
ds_read_b128 v[228:231],v250 offset:18432
v_fmac_f32 v236,-2.0,v235
M v[0:3],a[224:227],a[240:243],v[0:3]
s_waitcnt vmcnt(10) lgkmcnt(4)
v_and_b32 v209,s42,v209
v_and_b32 v205,s42,v205
M v[0:3],a[252:255],v[216:219],v[0:3]
s_waitcnt vmcnt(9) lgkmcnt(3)
v_and_b32 v207,s42,v207
v_and_b32 v215,s42,v215
M v[0:3],a[244:247],a[228:231],v[0:3]
s_waitcnt lgkmcnt(2)
v_and_b32 v213,s42,v213
v_and_b32 v211,s42,v211
M v[4:7],a[244:247],v[220:223],v[4:7]
v_fmac_f32 v205,s43,v209
v_fmac_f32 v215,4.0,v207
M v[4:7],a[252:255],a[228:231],v[4:7]
ds_read_b128 a[196:199],v249 offset:18944
v_fma_f32 v235,-4.0,v209,v213
M v[4:7],a[224:227],v[216:219],v[4:7]
ds_read_b128 a[204:207],v250 offset:18944
v_fmac_f32 v205,s45,v213
M v[8:11],a[224:227],a[228:231],v[8:11]
v_fmac_f32 v215,s41,v211
v_sub_f32 v213,v213,v209
M v[8:11],a[252:255],v[220:223],v[8:11]
s_waitcnt lgkmcnt(3)
v_fma_f32 v209,-4.0,v207,v211
v_sub_f32 v211,v211,v207
M v[8:11],a[244:247],a[248:251],v[8:11]
s_waitcnt lgkmcnt(2)
v_add_f32 v207,v235,v209
v_sub_f32 v235,v235,v209
M v[12:15],a[244:247],v[228:231],v[12:15]
v_fma_f32 v209,2.0,v211,v213
v_fmac_f32 v213,-2.0,v211
M v[12:15],a[252:255],a[248:251],v[12:15]
ds_read_b128 a[212:215],v250 offset:19456
v_cvt_pk_bf16_f32 v205,v232,v205
M v[12:15],a[224:227],v[220:223],v[12:15]
ds_read_b128 a[236:239],v249 offset:19456
v_cvt_pk_bf16_f32 v215,v237,v215
M v[16:19],a[224:227],a[248:251],v[16:19]
v_cvt_pk_bf16_f32 v207,v233,v207
v_cvt_pk_bf16_f32 v211,v234,v209
M v[16:19],a[252:255],v[228:231],v[16:19]
s_waitcnt lgkmcnt(3)
v_cvt_pk_bf16_f32 v209,v238,v235
v_cvt_pk_bf16_f32 v213,v236,v213
M v[16:19],a[244:247],a[196:199],v[16:19]
s_waitcnt lgkmcnt(2)
ds_write2st64_b64 v247,v[204:205],v[214:215] offset0:137 offset1:154
M v[20:23],a[244:247],a[204:207],v[20:23]
s_add_u32 s28,s30,7471424
buffer_load_dwordx2 v[204:205],v245,s[12:15],s28 offen offset:0
M v[20:23],a[252:255],a[196:199],v[20:23]
ds_write2st64_b64 v247,v[206:207],v[208:209] offset0:1 offset1:18
M v[20:23],a[224:227],v[228:231],v[20:23]
buffer_load_dwordx2 v[214:215],v245,s[16:19],s28 offen offset:1536
M v[24:27],a[224:227],a[196:199],v[24:27]
ds_write2st64_b64 v247,v[210:211],v[212:213] offset0:35 offset1:52
M v[24:27],a[252:255],a[204:207],v[24:27]
s_waitcnt lgkmcnt(4)
v_fmac_f32 v239,s43,v241
v_fmac_f32 v244,4.0,v240
M v[24:27],a[244:247],a[212:215],v[24:27]
s_waitcnt lgkmcnt(3)
buffer_load_dwordx2 v[206:207],v245,s[8:11],s28 offen offset:0
M v[28:31],a[244:247],a[236:239],v[28:31]
v_fma_f32 v232,-4.0,v241,v243
v_fmac_f32 v239,s45,v243
M v[28:31],a[252:255],a[212:215],v[28:31]
v_fmac_f32 v244,s41,v242
v_sub_f32 v243,v243,v241
M v[28:31],a[224:227],a[204:207],v[28:31]
s_waitcnt vmcnt(11)
v_fma_f32 v241,-4.0,v240,v242
v_sub_f32 v242,v242,v240
M v[32:35],a[208:211],a[240:243],v[32:35]
s_waitcnt vmcnt(8)
buffer_load_dwordx2 v[208:209],v245,s[8:11],s28 offen offset:384
M v[32:35],a[216:219],v[216:219],v[32:35]
s_waitcnt vmcnt(8)
v_add_f32 v240,v232,v241
v_sub_f32 v232,v232,v241
M v[32:35],a[220:223],a[228:231],v[32:35]
v_fma_f32 v241,2.0,v242,v243
v_fmac_f32 v243,-2.0,v242
M v[36:39],a[220:223],v[220:223],v[36:39]
v_cvt_pk_bf16_f32 v233,v239,v244
v_cvt_pk_bf16_f32 v234,v240,v232
M v[36:39],a[216:219],a[228:231],v[36:39]
buffer_load_dwordx2 v[210:211],v245,s[8:11],s28 offen offset:768
M v[36:39],a[208:211],v[216:219],v[36:39]
v_cvt_pk_bf16_f32 v235,v241,v243
v_add_u32 v232,69632,v248
M v[40:43],a[208:211],a[228:231],v[40:43]
ds_write_b16 v232,v233 offset:0
M v[40:43],a[216:219],v[220:223],v[40:43]
ds_write_b16_d16_hi v232,v233 offset:8704
M v[40:43],a[220:223],a[248:251],v[40:43]
buffer_load_dwordx2 v[212:213],v245,s[8:11],s28 offen offset:1152
global_load_dword a244,v251,s[64:65]
M v[44:47],a[220:223],v[228:231],v[44:47]
buffer_load_dwordx4 a[244:247],v251,s[20:23],s46 offen offset:1024 sc1
M v[44:47],a[216:219],a[248:251],v[44:47]
buffer_load_dwordx4 a[252:255],v251,s[20:23],s46 offen offset:2048 sc1
M v[44:47],a[208:211],v[220:223],v[44:47]
s_add_u32 s47,s44,261120
ds_write_b16 v248,v234 offset:0
M v[48:51],a[208:211],a[248:251],v[48:51]
ds_write_b16_d16_hi v248,v234 offset:8704
M v[48:51],a[216:219],v[228:231],v[48:51]
ds_write_b16 v248,v235 offset:17408
M v[48:51],a[220:223],a[196:199],v[48:51]
ds_write_b16_d16_hi v248,v235 offset:26112
M v[52:55],a[220:223],a[204:207],v[52:55]
v_lshlrev_b32 v234,16,v196
v_lshlrev_b32 v232,16,v192
M v[52:55],a[216:219],a[196:199],v[52:55]
v_lshlrev_b32 v233,16,v194
v_lshlrev_b32 v237,16,v202
M v[52:55],a[208:211],v[228:231],v[52:55]
v_lshlrev_b32 v236,16,v200
v_lshlrev_b32 v235,16,v198
M v[56:59],a[208:211],a[196:199],v[56:59]
v_fmac_f32 v232,s43,v234
v_fmac_f32 v237,4.0,v233
M v[56:59],a[216:219],a[204:207],v[56:59]
v_fma_f32 v238,-4.0,v234,v236
v_fmac_f32 v232,s45,v236
M v[56:59],a[220:223],a[212:215],v[56:59]
v_fmac_f32 v237,s41,v235
v_sub_f32 v236,v236,v234
M v[60:63],a[220:223],a[236:239],v[60:63]
buffer_load_dwordx4 a[224:227],v251,s[20:23],s47 offen offset:0 sc1
M v[60:63],a[216:219],a[212:215],v[60:63]
v_fma_f32 v234,-4.0,v233,v235
v_sub_f32 v235,v235,v233
M v[60:63],a[208:211],a[204:207],v[60:63]
s_waitcnt vmcnt(13)
v_add_f32 v233,v238,v234
v_sub_f32 v238,v238,v234
M v[64:67],a[200:203],a[240:243],v[64:67]
s_waitcnt vmcnt(12)
v_fma_f32 v234,2.0,v235,v236
v_fmac_f32 v236,-2.0,v235
M v[64:67],a[232:235],v[216:219],v[64:67]
s_waitcnt vmcnt(11)
buffer_load_dwordx4 a[220:223],v251,s[20:23],s47 offen offset:1024 sc1
M v[64:67],v[224:227],a[228:231],v[64:67]
v_and_b32 v196,s42,v196
v_and_b32 v192,s42,v192
M v[68:71],v[224:227],v[220:223],v[68:71]
v_and_b32 v194,s42,v194
v_and_b32 v202,s42,v202
M v[68:71],a[232:235],a[228:231],v[68:71]
v_and_b32 v200,s42,v200
v_and_b32 v198,s42,v198
M v[68:71],a[200:203],v[216:219],v[68:71]
buffer_load_dwordx4 a[216:219],v251,s[20:23],s47 offen offset:2048 sc1
M v[72:75],a[200:203],a[228:231],v[72:75]
s_add_u32 s48,s44,264192
v_fmac_f32 v192,s43,v196
v_fmac_f32 v202,4.0,v194
M v[72:75],a[232:235],v[220:223],v[72:75]
v_fma_f32 v235,-4.0,v196,v200
v_fmac_f32 v192,s45,v200
M v[72:75],v[224:227],a[248:251],v[72:75]
v_fmac_f32 v202,s41,v198
v_sub_f32 v200,v200,v196
M v[76:79],v[224:227],v[228:231],v[76:79]
buffer_load_dwordx4 a[208:211],v251,s[20:23],s48 offen offset:0 sc1
M v[76:79],a[232:235],a[248:251],v[76:79]
v_fma_f32 v196,-4.0,v194,v198
v_sub_f32 v198,v198,v194
M v[76:79],a[200:203],v[220:223],v[76:79]
v_add_f32 v194,v235,v196
v_sub_f32 v235,v235,v196
M v[80:83],a[200:203],a[248:251],v[80:83]
v_fma_f32 v196,2.0,v198,v200
v_fmac_f32 v200,-2.0,v198
M v[80:83],a[232:235],v[228:231],v[80:83]
buffer_load_dwordx4 a[240:243],v251,s[20:23],s48 offen offset:1024 sc1
M v[80:83],v[224:227],a[196:199],v[80:83]
ds_read_b128 a[228:231],v249 offset:26112
v_cvt_pk_bf16_f32 v192,v232,v192
M v[84:87],v[224:227],a[204:207],v[84:87]
ds_read_b128 v[220:223],v250 offset:26112
v_cvt_pk_bf16_f32 v202,v237,v202
M v[84:87],a[232:235],a[196:199],v[84:87]
ds_read_b128 a[248:251],v249 offset:26624
v_cvt_pk_bf16_f32 v194,v233,v194
M v[84:87],a[200:203],v[228:231],v[84:87]
buffer_load_dwordx4 v[216:219],v251,s[20:23],s48 offen offset:2048 sc1
M v[88:91],a[200:203],a[196:199],v[88:91]
s_add_u32 s46,s44,285696
ds_read_b128 v[228:231],v250 offset:26624
v_cvt_pk_bf16_f32 v198,v234,v196
M v[88:91],a[232:235],a[204:207],v[88:91]
v_cvt_pk_bf16_f32 v196,v238,v235
v_cvt_pk_bf16_f32 v200,v236,v200
M v[88:91],v[224:227],a[212:215],v[88:91]
v_lshlrev_b32 v234,16,v197
v_lshlrev_b32 v232,16,v193
M v[92:95],v[224:227],a[236:239],v[92:95]
buffer_load_dwordx4 a[196:199],v251,s[20:23],s46 offen offset:0 sc1
M v[92:95],a[232:235],a[212:215],v[92:95]
ds_read_b128 a[236:239],v249 offset:27136
v_lshlrev_b32 v233,16,v195
M v[92:95],a[200:203],a[204:207],v[92:95]
s_waitcnt vmcnt(16) lgkmcnt(4)
ds_read_b128 v[224:227],v250 offset:27136
v_lshlrev_b32 v237,16,v203
M v[96:99],a[192:195],a[228:231],v[96:99]
s_waitcnt vmcnt(8) lgkmcnt(4)
v_lshlrev_b32 v236,16,v201
v_lshlrev_b32 v235,16,v199
M v[96:99],a[244:247],v[220:223],v[96:99]
s_waitcnt vmcnt(7) lgkmcnt(3)
v_fmac_f32 v232,s43,v234
v_fmac_f32 v237,4.0,v233
M v[96:99],a[252:255],a[248:251],v[96:99]
s_waitcnt lgkmcnt(2)
v_fma_f32 v238,-4.0,v234,v236
v_fmac_f32 v232,s45,v236
M v[100:103],a[252:255],v[228:231],v[100:103]
v_fmac_f32 v237,s41,v235
v_sub_f32 v236,v236,v234
M v[100:103],a[244:247],a[248:251],v[100:103]
ds_read_b128 a[212:215],v249 offset:27648
v_fma_f32 v234,-4.0,v233,v235
M v[100:103],a[192:195],v[220:223],v[100:103]
ds_read_b128 a[232:235],v250 offset:27648
v_sub_f32 v235,v235,v233
M v[104:107],a[192:195],a[248:251],v[104:107]
v_add_f32 v233,v238,v234
v_sub_f32 v238,v238,v234
M v[104:107],a[244:247],v[228:231],v[104:107]
s_waitcnt lgkmcnt(3)
v_fma_f32 v234,2.0,v235,v236
v_fmac_f32 v236,-2.0,v235
M v[104:107],a[252:255],a[236:239],v[104:107]
s_waitcnt lgkmcnt(2)
v_and_b32 v197,s42,v197
v_and_b32 v193,s42,v193
M v[108:111],a[252:255],v[224:227],v[108:111]
v_and_b32 v195,s42,v195
v_and_b32 v203,s42,v203
M v[108:111],a[244:247],a[236:239],v[108:111]
ds_read_b128 a[200:203],v250 offset:28160
v_and_b32 v201,s42,v201
M v[108:111],a[192:195],v[228:231],v[108:111]
ds_read_b128 a[204:207],v249 offset:28160
v_and_b32 v199,s42,v199
M v[112:115],a[192:195],a[236:239],v[112:115]
v_fmac_f32 v193,s43,v197
v_fmac_f32 v203,4.0,v195
M v[112:115],a[244:247],v[224:227],v[112:115]
s_waitcnt lgkmcnt(3)
v_fma_f32 v235,-4.0,v197,v201
v_fmac_f32 v193,s45,v201
M v[112:115],a[252:255],a[212:215],v[112:115]
s_waitcnt lgkmcnt(2)
v_fmac_f32 v203,s41,v199
v_sub_f32 v201,v201,v197
M v[116:119],a[252:255],a[232:235],v[116:119]
v_fma_f32 v197,-4.0,v195,v199
v_sub_f32 v199,v199,v195
M v[116:119],a[244:247],a[212:215],v[116:119]
v_add_f32 v195,v235,v197
v_sub_f32 v235,v235,v197
M v[116:119],a[192:195],v[224:227],v[116:119]
v_fma_f32 v197,2.0,v199,v201
v_fmac_f32 v201,-2.0,v199
M v[120:123],a[192:195],a[212:215],v[120:123]
v_cvt_pk_bf16_f32 v193,v232,v193
v_cvt_pk_bf16_f32 v203,v237,v203
M v[120:123],a[244:247],a[232:235],v[120:123]
s_waitcnt lgkmcnt(1)
v_cvt_pk_bf16_f32 v195,v233,v195
v_cvt_pk_bf16_f32 v199,v234,v197
M v[120:123],a[252:255],a[200:203],v[120:123]
s_waitcnt lgkmcnt(0)
v_cvt_pk_bf16_f32 v197,v238,v235
v_cvt_pk_bf16_f32 v201,v236,v201
M v[124:127],a[252:255],a[204:207],v[124:127]
buffer_load_dwordx4 a[252:255],v251,s[20:23],s46 offen offset:1024 sc1
M v[124:127],a[244:247],a[200:203],v[124:127]
ds_write2st64_b64 v247,v[192:193],v[202:203] offset0:138 offset1:155
M v[124:127],a[192:195],a[232:235],v[124:127]
s_waitcnt vmcnt(7)
buffer_load_dwordx4 a[244:247],v251,s[20:23],s46 offen offset:2048 sc1
M v[128:131],a[224:227],a[228:231],v[128:131]
s_waitcnt vmcnt(7)
s_add_u32 s46,s44,294912
ds_write2st64_b64 v247,v[194:195],v[196:197] offset0:2 offset1:19
M v[128:131],a[220:223],v[220:223],v[128:131]
s_waitcnt vmcnt(6)
ds_write2st64_b64 v247,v[198:199],v[200:201] offset0:36 offset1:53
M v[128:131],a[216:219],a[248:251],v[128:131]
buffer_load_dwordx4 a[192:195],v251,s[20:23],s46 offen offset:0 sc1
M v[132:135],a[216:219],v[228:231],v[132:135]
v_lshlrev_b32 v234,16,v208
v_lshlrev_b32 v232,16,v204
M v[132:135],a[220:223],a[248:251],v[132:135]
v_lshlrev_b32 v233,16,v206
v_lshlrev_b32 v237,16,v214
M v[132:135],a[224:227],v[220:223],v[132:135]
v_lshlrev_b32 v236,16,v212
v_lshlrev_b32 v235,16,v210
M v[136:139],a[224:227],a[248:251],v[136:139]
v_fmac_f32 v232,s43,v234
v_fmac_f32 v237,4.0,v233
M v[136:139],a[220:223],v[228:231],v[136:139]
v_fma_f32 v238,-4.0,v234,v236
v_fmac_f32 v232,s45,v236
M v[136:139],a[216:219],a[236:239],v[136:139]
v_fmac_f32 v237,s41,v235
v_sub_f32 v236,v236,v234
M v[140:143],a[216:219],v[224:227],v[140:143]
v_fma_f32 v234,-4.0,v233,v235
v_sub_f32 v235,v235,v233
M v[140:143],a[220:223],a[236:239],v[140:143]
v_add_f32 v233,v238,v234
v_sub_f32 v238,v238,v234
M v[140:143],a[224:227],v[228:231],v[140:143]
v_fma_f32 v234,2.0,v235,v236
v_fmac_f32 v236,-2.0,v235
M v[144:147],a[224:227],a[236:239],v[144:147]
v_and_b32 v208,s42,v208
v_and_b32 v204,s42,v204
M v[144:147],a[220:223],v[224:227],v[144:147]
v_and_b32 v206,s42,v206
v_and_b32 v214,s42,v214
M v[144:147],a[216:219],a[212:215],v[144:147]
v_and_b32 v212,s42,v212
v_and_b32 v210,s42,v210
M v[148:151],a[216:219],a[232:235],v[148:151]
v_fmac_f32 v204,s43,v208
v_fmac_f32 v214,4.0,v206
M v[148:151],a[220:223],a[212:215],v[148:151]
v_fma_f32 v235,-4.0,v208,v212
v_fmac_f32 v204,s45,v212
M v[148:151],a[224:227],v[224:227],v[148:151]
v_fmac_f32 v214,s41,v210
v_sub_f32 v212,v212,v208
M v[152:155],a[224:227],a[212:215],v[152:155]
v_fma_f32 v208,-4.0,v206,v210
v_sub_f32 v210,v210,v206
v_add_f32 v206,v235,v208
M v[152:155],a[220:223],a[232:235],v[152:155]
v_sub_f32 v235,v235,v208
v_fma_f32 v208,2.0,v210,v212
v_fmac_f32 v212,-2.0,v210
v_cvt_pk_bf16_f32 v204,v232,v204
M v[152:155],a[216:219],a[200:203],v[152:155]
v_cvt_pk_bf16_f32 v214,v237,v214
v_cvt_pk_bf16_f32 v206,v233,v206
v_cvt_pk_bf16_f32 v210,v234,v208
v_cvt_pk_bf16_f32 v208,v238,v235
M v[156:159],a[216:219],a[204:207],v[156:159]
buffer_load_dwordx4 a[216:219],v251,s[20:23],s46 offen offset:1024 sc1
v_cvt_pk_bf16_f32 v212,v236,v212
v_lshlrev_b32 v234,16,v209
v_lshlrev_b32 v232,16,v205
v_lshlrev_b32 v233,16,v207
M v[156:159],a[220:223],a[200:203],v[156:159]
buffer_load_dwordx4 a[220:223],v251,s[20:23],s46 offen offset:2048 sc1
v_lshlrev_b32 v237,16,v215
v_lshlrev_b32 v236,16,v213
v_lshlrev_b32 v235,16,v211
v_fmac_f32 v232,s43,v234
M v[156:159],a[224:227],a[232:235],v[156:159]
s_waitcnt vmcnt(8)
s_add_u32 s46,s44,304128
v_fmac_f32 v237,4.0,v233
v_fma_f32 v238,-4.0,v234,v236
v_fmac_f32 v232,s45,v236
v_fmac_f32 v237,s41,v235
M v[160:163],a[208:211],a[228:231],v[160:163]
s_waitcnt vmcnt(7)
v_sub_f32 v236,v236,v234
v_fma_f32 v234,-4.0,v233,v235
v_sub_f32 v235,v235,v233
v_add_f32 v233,v238,v234
M v[160:163],a[240:243],v[220:223],v[160:163]
s_waitcnt vmcnt(6)
buffer_load_dwordx4 a[224:227],v251,s[20:23],s46 offen offset:0 sc1
v_sub_f32 v238,v238,v234
v_fma_f32 v234,2.0,v235,v236
v_fmac_f32 v236,-2.0,v235
v_and_b32 v209,s42,v209
M v[160:163],v[216:219],a[248:251],v[160:163]
v_and_b32 v205,s42,v205
v_and_b32 v207,s42,v207
v_and_b32 v215,s42,v215
v_and_b32 v213,s42,v213
M v[164:167],v[216:219],v[228:231],v[164:167]
buffer_load_dwordx4 a[228:231],v251,s[20:23],s46 offen offset:1024 sc1
v_and_b32 v211,s42,v211
v_fmac_f32 v205,s43,v209
v_fmac_f32 v215,4.0,v207
v_fma_f32 v235,-4.0,v209,v213
M v[164:167],a[240:243],a[248:251],v[164:167]
v_fmac_f32 v205,s45,v213
v_fmac_f32 v215,s41,v211
v_sub_f32 v213,v213,v209
v_fma_f32 v209,-4.0,v207,v211
M v[164:167],a[208:211],v[220:223],v[164:167]
buffer_load_dwordx4 v[220:223],v251,s[20:23],s46 offen offset:2048 sc1
v_sub_f32 v211,v211,v207
v_add_f32 v207,v235,v209
v_sub_f32 v235,v235,v209
v_fma_f32 v209,2.0,v211,v213
M v[168:171],a[208:211],a[248:251],v[168:171]
v_fmac_f32 v213,-2.0,v211
v_cvt_pk_bf16_f32 v205,v232,v205
v_cvt_pk_bf16_f32 v215,v237,v215
v_cvt_pk_bf16_f32 v207,v233,v207
M v[168:171],a[240:243],v[228:231],v[168:171]
v_cvt_pk_bf16_f32 v211,v234,v209
v_cvt_pk_bf16_f32 v209,v238,v235
v_cvt_pk_bf16_f32 v213,v236,v213
M v[168:171],v[216:219],a[236:239],v[168:171]
ds_write2st64_b64 v247,v[204:205],v[214:215] offset0:139 offset1:156
M v[172:175],v[216:219],v[224:227],v[172:175]
ds_write2st64_b64 v247,v[206:207],v[208:209] offset0:3 offset1:20
M v[172:175],a[240:243],a[236:239],v[172:175]
ds_write2st64_b64 v247,v[210:211],v[212:213] offset0:37 offset1:54
M v[172:175],a[208:211],v[228:231],v[172:175]
v_add_u32 v249,0xffffbc00,v249
v_add_u32 v250,0xffffbc00,v250
M v[176:179],a[208:211],a[236:239],v[176:179]
s_add_u32 s46,s44,313344
M v[176:179],a[240:243],v[224:227],v[176:179]
M v[176:179],v[216:219],a[212:215],v[176:179]
s_waitcnt lgkmcnt(0)
s_barrier
ds_read_b128 a[248:251],v249 offset:0
M v[180:183],v[216:219],a[232:235],v[180:183]
ds_read_b128 v[228:231],v250 offset:0
M v[180:183],a[240:243],a[212:215],v[180:183]
ds_read_b128 a[236:239],v249 offset:512
M v[180:183],a[208:211],v[224:227],v[180:183]
ds_read_b128 v[224:227],v250 offset:512
M v[184:187],a[208:211],a[212:215],v[184:187]
buffer_load_dwordx4 a[212:215],v251,s[20:23],s46 offen offset:0 sc1
M v[184:187],a[240:243],a[232:235],v[184:187]
M v[184:187],v[216:219],a[200:203],v[184:187]
M v[188:191],v[216:219],a[204:207],v[188:191]
buffer_load_dwordx4 a[204:207],v251,s[20:23],s46 offen offset:1024 sc1
M v[188:191],a[240:243],a[200:203],v[188:191]
ds_read_b128 a[200:203],v249 offset:1024
M v[188:191],a[208:211],a[232:235],v[188:191]
s_waitcnt vmcnt(10) lgkmcnt(4)
ds_read_b128 a[240:243],v250 offset:1024
M a[0:3],a[196:199],a[248:251],a[0:3]
s_waitcnt vmcnt(9) lgkmcnt(4)
buffer_load_dwordx4 v[216:219],v251,s[20:23],s46 offen offset:2048 sc1
M a[0:3],a[252:255],v[228:231],a[0:3]
s_waitcnt vmcnt(9) lgkmcnt(3)
M a[0:3],a[244:247],a[236:239],a[0:3]
s_waitcnt lgkmcnt(2)
M a[4:7],a[244:247],v[224:227],a[4:7]
M a[4:7],a[252:255],a[236:239],a[4:7]
ds_read_b128 a[208:211],v249 offset:1536
M a[4:7],a[196:199],v[228:231],a[4:7]
ds_read_b128 a[232:235],v250 offset:1536
M a[8:11],a[196:199],a[236:239],a[8:11]
M a[8:11],a[252:255],v[224:227],a[8:11]
s_waitcnt lgkmcnt(3)
M a[8:11],a[244:247],a[200:203],a[8:11]
s_waitcnt lgkmcnt(2)
M a[12:15],a[244:247],a[240:243],a[12:15]
M a[12:15],a[252:255],a[200:203],a[12:15]
ds_read_b128 a[248:251],v250 offset:2048
M a[12:15],a[196:199],v[224:227],a[12:15]
ds_read_b128 v[228:231],v249 offset:2048
M a[16:19],a[196:199],a[200:203],a[16:19]
s_add_u32 s47,s44,288768
M a[16:19],a[252:255],a[240:243],a[16:19]
s_waitcnt lgkmcnt(3)
M a[16:19],a[244:247],a[208:211],a[16:19]
s_waitcnt lgkmcnt(2)
ds_read_b128 a[236:239],v249 offset:8704
M a[20:23],a[244:247],a[232:235],a[20:23]
ds_read_b128 v[224:227],v250 offset:8704
M a[20:23],a[252:255],a[208:211],a[20:23]
ds_read_b128 a[200:203],v249 offset:9216
M a[20:23],a[196:199],a[240:243],a[20:23]
ds_read_b128 a[240:243],v250 offset:9216
M a[24:27],a[196:199],a[208:211],a[24:27]
buffer_load_dwordx4 a[208:211],v251,s[20:23],s47 offen offset:0 sc1
M a[24:27],a[252:255],a[232:235],a[24:27]
s_waitcnt lgkmcnt(5)
M a[24:27],a[244:247],a[248:251],a[24:27]
s_waitcnt lgkmcnt(4)
M a[28:31],a[244:247],v[228:231],a[28:31]
buffer_load_dwordx4 a[244:247],v251,s[20:23],s47 offen offset:1024 sc1
M a[28:31],a[252:255],a[248:251],a[28:31]
ds_read_b128 a[248:251],v249 offset:9728
M a[28:31],a[196:199],a[232:235],a[28:31]
s_waitcnt vmcnt(10) lgkmcnt(4)
ds_read_b128 a[252:255],v250 offset:9728
M a[96:99],a[192:195],a[236:239],a[96:99]
s_waitcnt vmcnt(9) lgkmcnt(4)
buffer_load_dwordx4 v[228:231],v251,s[20:23],s47 offen offset:2048 sc1
M a[96:99],a[216:219],v[224:227],a[96:99]
s_waitcnt vmcnt(9) lgkmcnt(3)
M a[96:99],a[220:223],a[200:203],a[96:99]
s_waitcnt lgkmcnt(2)
M a[100:103],a[220:223],a[240:243],a[100:103]
M a[100:103],a[216:219],a[200:203],a[100:103]
ds_read_b128 a[196:199],v249 offset:10240
M a[100:103],a[192:195],v[224:227],a[100:103]
ds_read_b128 a[232:235],v250 offset:10240
M a[104:107],a[192:195],a[200:203],a[104:107]
M a[104:107],a[216:219],a[240:243],a[104:107]
s_waitcnt lgkmcnt(3)
M a[104:107],a[220:223],a[248:251],a[104:107]
s_waitcnt lgkmcnt(2)
M a[108:111],a[220:223],a[252:255],a[108:111]
M a[108:111],a[216:219],a[248:251],a[108:111]
ds_read_b128 a[236:239],v250 offset:10752
M a[108:111],a[192:195],a[240:243],a[108:111]
ds_read_b128 v[224:227],v249 offset:10752
M a[112:115],a[192:195],a[248:251],a[112:115]
s_add_u32 s48,s44,291840
M a[112:115],a[216:219],a[252:255],a[112:115]
s_waitcnt lgkmcnt(3)
M a[112:115],a[220:223],a[196:199],a[112:115]
s_waitcnt lgkmcnt(2)
ds_read_b128 a[200:203],v249 offset:17408
M a[116:119],a[220:223],a[232:235],a[116:119]
ds_read_b128 a[240:243],v250 offset:17408
M a[116:119],a[216:219],a[196:199],a[116:119]
ds_read_b128 a[248:251],v249 offset:17920
M a[116:119],a[192:195],a[252:255],a[116:119]
ds_read_b128 a[252:255],v250 offset:17920
M a[120:123],a[192:195],a[196:199],a[120:123]
buffer_load_dwordx4 a[196:199],v251,s[20:23],s48 offen offset:0 sc1
M a[120:123],a[216:219],a[232:235],a[120:123]
s_waitcnt lgkmcnt(5)
M a[120:123],a[220:223],a[236:239],a[120:123]
s_waitcnt lgkmcnt(4)
M a[124:127],a[220:223],v[224:227],a[124:127]
buffer_load_dwordx4 a[220:223],v251,s[20:23],s48 offen offset:1024 sc1
M a[124:127],a[216:219],a[236:239],a[124:127]
ds_read_b128 a[216:219],v249 offset:18432
M a[124:127],a[192:195],a[232:235],a[124:127]
s_waitcnt vmcnt(10) lgkmcnt(4)
ds_read_b128 a[236:239],v250 offset:18432
M v[0:3],a[224:227],a[200:203],v[0:3]
s_waitcnt vmcnt(9) lgkmcnt(4)
buffer_load_dwordx4 v[224:227],v251,s[20:23],s48 offen offset:2048 sc1
M v[0:3],a[228:231],a[240:243],v[0:3]
s_waitcnt vmcnt(9) lgkmcnt(3)
M v[0:3],v[220:223],a[248:251],v[0:3]
s_waitcnt lgkmcnt(2)
M v[4:7],v[220:223],a[252:255],v[4:7]
M v[4:7],a[228:231],a[248:251],v[4:7]
ds_read_b128 a[192:195],v249 offset:18944
M v[4:7],a[224:227],a[240:243],v[4:7]
ds_read_b128 a[232:235],v250 offset:18944
M v[8:11],a[224:227],a[248:251],v[8:11]
M v[8:11],a[228:231],a[252:255],v[8:11]
s_waitcnt lgkmcnt(3)
M v[8:11],v[220:223],a[216:219],v[8:11]
s_waitcnt lgkmcnt(2)
M v[12:15],v[220:223],a[236:239],v[12:15]
M v[12:15],a[228:231],a[216:219],v[12:15]
ds_read_b128 a[200:203],v250 offset:19456
M v[12:15],a[224:227],a[252:255],v[12:15]
ds_read_b128 a[240:243],v249 offset:19456
M v[16:19],a[224:227],a[216:219],v[16:19]
s_add_u32 s47,s44,297984
M v[16:19],a[228:231],a[236:239],v[16:19]
s_waitcnt lgkmcnt(3)
M v[16:19],v[220:223],a[192:195],v[16:19]
s_waitcnt lgkmcnt(2)
ds_read_b128 a[248:251],v249 offset:26112
M v[20:23],v[220:223],a[232:235],v[20:23]
ds_read_b128 a[252:255],v250 offset:26112
M v[20:23],a[228:231],a[192:195],v[20:23]
ds_read_b128 a[216:219],v249 offset:26624
M v[20:23],a[224:227],a[236:239],v[20:23]
ds_read_b128 a[236:239],v250 offset:26624
M v[24:27],a[224:227],a[192:195],v[24:27]
buffer_load_dwordx4 a[192:195],v251,s[20:23],s47 offen offset:0 sc1
M v[24:27],a[228:231],a[232:235],v[24:27]
s_waitcnt lgkmcnt(5)
M v[24:27],v[220:223],a[200:203],v[24:27]
s_waitcnt lgkmcnt(4)
M v[28:31],v[220:223],a[240:243],v[28:31]
buffer_load_dwordx4 a[240:243],v251,s[20:23],s47 offen offset:1024 sc1
M v[28:31],a[228:231],a[200:203],v[28:31]
ds_read_b128 a[200:203],v249 offset:27136
M v[28:31],a[224:227],a[232:235],v[28:31]
s_waitcnt vmcnt(10) lgkmcnt(4)
ds_read_b128 a[228:231],v250 offset:27136
M v[96:99],a[212:215],a[248:251],v[96:99]
s_waitcnt vmcnt(9) lgkmcnt(4)
buffer_load_dwordx4 v[220:223],v251,s[20:23],s47 offen offset:2048 sc1
M v[96:99],a[204:207],a[252:255],v[96:99]
s_waitcnt vmcnt(9) lgkmcnt(3)
M v[96:99],v[216:219],a[216:219],v[96:99]
s_waitcnt lgkmcnt(2)
M v[100:103],v[216:219],a[236:239],v[100:103]
M v[100:103],a[204:207],a[216:219],v[100:103]
ds_read_b128 a[224:227],v249 offset:27648
M v[100:103],a[212:215],a[252:255],v[100:103]
ds_read_b128 a[232:235],v250 offset:27648
v_accvgpr_read_b32 v238,a0
M v[104:107],a[212:215],a[216:219],v[104:107]
v_accvgpr_read_b32 v232,a96
v_add_f32 v234,v238,v232
M v[104:107],a[204:207],a[236:239],v[104:107]
s_waitcnt lgkmcnt(3)
v_sub_f32 v238,v238,v232
v_add_f32 v232,v0,v96
M v[104:107],v[216:219],a[200:203],v[104:107]
s_waitcnt lgkmcnt(2)
v_sub_f32 v96,v0,v96
v_add_f32 v0,v234,v232
M v[108:111],v[216:219],a[228:231],v[108:111]
v_fmac_f32 v234,4.0,v232
v_fma_f32 v232,2.0,v96,v238
M v[108:111],a[204:207],a[200:203],v[108:111]
ds_read_b128 a[248:251],v250 offset:28160
v_fma_f32 v96,s40,v96,v238
M v[108:111],a[212:215],a[236:239],v[108:111]
ds_read_b128 a[252:255],v249 offset:28160
v_accvgpr_read_b32 v238,a1
M v[112:115],a[212:215],a[200:203],v[112:115]
s_add_u32 s48,s44,301056
v_accvgpr_read_b32 v237,a97
v_add_f32 v236,v238,v237
M v[112:115],a[204:207],a[228:231],v[112:115]
s_waitcnt lgkmcnt(3)
v_sub_f32 v238,v238,v237
v_add_f32 v237,v1,v97
M v[112:115],v[216:219],a[224:227],v[112:115]
s_waitcnt lgkmcnt(2)
ds_read_b128 a[216:219],v249 offset:0
v_sub_f32 v97,v1,v97
M v[116:119],v[216:219],a[232:235],v[116:119]
ds_read_b128 a[236:239],v250 offset:0
v_add_f32 v1,v236,v237
M v[116:119],a[204:207],a[224:227],v[116:119]
ds_read_b128 a[200:203],v249 offset:512
v_fmac_f32 v236,4.0,v237
M v[116:119],a[212:215],a[228:231],v[116:119]
ds_read_b128 a[228:231],v250 offset:512
v_fma_f32 v237,2.0,v97,v238
M v[120:123],a[212:215],a[224:227],v[120:123]
buffer_load_dwordx4 a[224:227],v251,s[20:23],s48 offen offset:0 sc1
M v[120:123],a[204:207],a[232:235],v[120:123]
s_waitcnt lgkmcnt(5)
v_fma_f32 v97,s40,v97,v238
v_cvt_pk_bf16_f32 v232,v232,v237
M v[120:123],v[216:219],a[248:251],v[120:123]
s_waitcnt lgkmcnt(4)
v_cvt_pk_bf16_f32 v234,v234,v236
v_accvgpr_read_b32 v238,a2
M v[124:127],v[216:219],a[252:255],v[124:127]
buffer_load_dwordx4 a[252:255],v251,s[20:23],s48 offen offset:1024 sc1
M v[124:127],a[204:207],a[248:251],v[124:127]
ds_read_b128 v[216:219],v249 offset:1024
v_accvgpr_read_b32 v233,a98
M v[124:127],a[212:215],a[232:235],v[124:127]
s_waitcnt vmcnt(10) lgkmcnt(4)
ds_read_b128 a[204:207],v250 offset:1024
v_add_f32 v235,v238,v233
M a[32:35],a[208:211],a[216:219],a[32:35]
s_waitcnt vmcnt(9) lgkmcnt(4)
v_sub_f32 v238,v238,v233
v_add_f32 v233,v2,v98
M a[32:35],a[244:247],a[236:239],a[32:35]
s_waitcnt vmcnt(8) lgkmcnt(3)
v_sub_f32 v98,v2,v98
v_add_f32 v2,v235,v233
M a[32:35],v[228:231],a[200:203],a[32:35]
s_waitcnt lgkmcnt(2)
v_fmac_f32 v235,4.0,v233
v_fma_f32 v233,2.0,v98,v238
M a[36:39],v[228:231],a[228:231],a[36:39]
v_fma_f32 v98,s40,v98,v238
v_accvgpr_read_b32 v238,a3
M a[36:39],a[244:247],a[200:203],a[36:39]
ds_read_b128 a[248:251],v249 offset:1536
v_accvgpr_read_b32 v237,a99
M a[36:39],a[208:211],a[236:239],a[36:39]
ds_read_b128 a[96:99],v250 offset:1536
v_add_f32 v236,v238,v237
M a[40:43],a[208:211],a[200:203],a[40:43]
v_sub_f32 v238,v238,v237
v_add_f32 v237,v3,v99
M a[40:43],a[244:247],a[228:231],a[40:43]
s_waitcnt lgkmcnt(3)
v_sub_f32 v99,v3,v99
v_add_f32 v3,v236,v237
M a[40:43],v[228:231],v[216:219],a[40:43]
s_waitcnt lgkmcnt(2)
v_fmac_f32 v236,4.0,v237
v_fma_f32 v237,2.0,v99,v238
M a[44:47],v[228:231],a[204:207],a[44:47]
v_fma_f32 v99,s40,v99,v238
v_cvt_pk_bf16_f32 v233,v233,v237
M a[44:47],a[244:247],v[216:219],a[44:47]
ds_read_b128 a[212:215],v250 offset:2048
v_cvt_pk_bf16_f32 v235,v235,v236
M a[44:47],a[208:211],a[228:231],a[44:47]
ds_read_b128 a[232:235],v249 offset:2048
ds_write2st64_b64 v253,v[232:233],v[234:235] offset0:68 offset1:72
M a[48:51],a[208:211],v[216:219],a[48:51]
v_accvgpr_read_b32 v238,a4
v_accvgpr_read_b32 v232,a100
M a[48:51],a[244:247],a[204:207],a[48:51]
s_waitcnt lgkmcnt(4)
v_add_f32 v234,v238,v232
v_sub_f32 v238,v238,v232
M a[48:51],v[228:231],a[248:251],a[48:51]
s_waitcnt lgkmcnt(3)
v_add_f32 v232,v4,v100
v_sub_f32 v100,v4,v100
M a[52:55],v[228:231],a[96:99],a[52:55]
v_add_f32 v4,v234,v232
v_fmac_f32 v234,4.0,v232
M a[52:55],a[244:247],a[248:251],a[52:55]
v_fma_f32 v232,2.0,v100,v238
v_fma_f32 v100,s40,v100,v238
M a[52:55],a[208:211],a[204:207],a[52:55]
v_accvgpr_read_b32 v238,a5
v_accvgpr_read_b32 v237,a101
M a[56:59],a[208:211],a[248:251],a[56:59]
v_add_f32 v236,v238,v237
v_sub_f32 v238,v238,v237
M a[56:59],a[244:247],a[96:99],a[56:59]
s_waitcnt lgkmcnt(2)
v_add_f32 v237,v5,v101
v_sub_f32 v101,v5,v101
M a[56:59],v[228:231],a[212:215],a[56:59]
s_waitcnt lgkmcnt(1)
v_add_f32 v5,v236,v237
v_fmac_f32 v236,4.0,v237
M a[60:63],v[228:231],a[232:235],a[60:63]
buffer_load_dwordx4 v[228:231],v251,s[20:23],s48 offen offset:2048 sc1
M a[60:63],a[244:247],a[212:215],a[60:63]
s_add_u32 s47,s44,307200
v_fma_f32 v237,2.0,v101,v238
v_fma_f32 v101,s40,v101,v238
M a[60:63],a[208:211],a[96:99],a[60:63]
s_waitcnt vmcnt(8)
buffer_load_dwordx4 a[244:247],v251,s[20:23],s47 offen offset:0 sc1
M a[64:67],a[196:199],a[216:219],a[64:67]
s_waitcnt vmcnt(8)
v_cvt_pk_bf16_f32 v232,v232,v237
v_cvt_pk_bf16_f32 v234,v234,v236
M a[64:67],a[220:223],a[236:239],a[64:67]
s_waitcnt vmcnt(7)
v_accvgpr_read_b32 v238,a6
v_accvgpr_read_b32 v233,a102
M a[64:67],v[224:227],a[200:203],a[64:67]
v_add_f32 v235,v238,v233
v_sub_f32 v238,v238,v233
M a[68:71],v[224:227],a[228:231],a[68:71]
buffer_load_dwordx4 a[208:211],v251,s[20:23],s47 offen offset:1024 sc1
M a[68:71],a[220:223],a[200:203],a[68:71]
v_add_f32 v233,v6,v102
v_sub_f32 v102,v6,v102
M a[68:71],a[196:199],a[236:239],a[68:71]
v_add_f32 v6,v235,v233
v_fmac_f32 v235,4.0,v233
M a[72:75],a[196:199],a[200:203],a[72:75]
v_fma_f32 v233,2.0,v102,v238
v_fma_f32 v102,s40,v102,v238
M a[72:75],a[220:223],a[228:231],a[72:75]
buffer_load_dwordx4 a[216:219],v251,s[20:23],s47 offen offset:2048 sc1
M a[72:75],v[224:227],v[216:219],a[72:75]
s_add_u32 s48,s44,310272
v_accvgpr_read_b32 v238,a7
v_accvgpr_read_b32 v237,a103
M a[76:79],v[224:227],a[204:207],a[76:79]
v_add_f32 v236,v238,v237
v_sub_f32 v238,v238,v237
M a[76:79],a[220:223],v[216:219],a[76:79]
v_add_f32 v237,v7,v103
v_sub_f32 v103,v7,v103
M a[76:79],a[196:199],a[228:231],a[76:79]
buffer_load_dwordx4 a[236:239],v251,s[20:23],s48 offen offset:0 sc1
M a[80:83],a[196:199],v[216:219],a[80:83]
v_add_f32 v7,v236,v237
v_fmac_f32 v236,4.0,v237
M a[80:83],a[220:223],a[204:207],a[80:83]
v_fma_f32 v237,2.0,v103,v238
v_fma_f32 v103,s40,v103,v238
M a[80:83],v[224:227],a[248:251],a[80:83]
ds_read_b128 a[100:103],v249 offset:8704
v_cvt_pk_bf16_f32 v233,v233,v237
M a[84:87],v[224:227],a[96:99],a[84:87]
buffer_load_dwordx4 a[200:203],v251,s[20:23],s48 offen offset:1024 sc1
M a[84:87],a[220:223],a[248:251],a[84:87]
ds_read_b128 a[228:231],v250 offset:8704
ds_read_b128 v[216:219],v249 offset:9216
M a[84:87],a[196:199],a[204:207],a[84:87]
ds_read_b128 a[204:207],v250 offset:9216
v_cvt_pk_bf16_f32 v235,v235,v236
M a[88:91],a[196:199],a[248:251],a[88:91]
ds_write2st64_b64 v253,v[232:233],v[234:235] offset0:76 offset1:80
M a[88:91],a[220:223],a[96:99],a[88:91]
buffer_load_dwordx4 a[248:251],v251,s[20:23],s48 offen offset:2048 sc1
M a[88:91],v[224:227],a[212:215],a[88:91]
v_accvgpr_read_b32 v238,a8
v_accvgpr_read_b32 v232,a104
M a[92:95],v[224:227],a[232:235],a[92:95]
v_add_f32 v234,v238,v232
v_sub_f32 v238,v238,v232
M a[92:95],a[220:223],a[212:215],a[92:95]
ds_read_b128 a[232:235],v249 offset:9728
v_add_f32 v232,v8,v104
M a[92:95],a[196:199],a[96:99],a[92:95]
s_waitcnt vmcnt(11) lgkmcnt(5)
ds_read_b128 a[96:99],v250 offset:9728
v_sub_f32 v104,v8,v104
M a[128:131],a[192:195],a[100:103],a[128:131]
s_waitcnt vmcnt(10) lgkmcnt(2)
s_barrier
ds_read_b128 a[0:3],v251 offset:34816
M a[128:131],a[240:243],a[228:231],a[128:131]
s_waitcnt vmcnt(9)
ds_read_b128 a[4:7],v251 offset:38912
v_add_f32 v8,v234,v232
M a[128:131],v[220:223],v[216:219],a[128:131]
v_fmac_f32 v234,4.0,v232
v_fma_f32 v232,2.0,v104,v238
M a[132:135],v[220:223],a[204:207],a[132:135]
v_fma_f32 v104,s40,v104,v238
v_accvgpr_read_b32 v238,a9
M a[132:135],a[240:243],v[216:219],a[132:135]
ds_read_b128 v[224:227],v249 offset:10240
v_accvgpr_read_b32 v237,a105
M a[132:135],a[192:195],a[228:231],a[132:135]
ds_read_b128 a[212:215],v250 offset:10240
v_add_f32 v236,v238,v237
M a[136:139],a[192:195],v[216:219],a[136:139]
s_waitcnt lgkmcnt(3)
s_add_u32 s34,s32,6291456
buffer_store_dwordx4 a[0:3],v252,s[24:27],s34 offen offset:384 sc1
M a[136:139],a[240:243],a[204:207],a[136:139]
v_sub_f32 v238,v238,v237
v_add_f32 v237,v9,v105
M a[136:139],v[220:223],a[232:235],a[136:139]
v_sub_f32 v105,v9,v105
v_add_f32 v9,v236,v237
M a[140:143],v[220:223],a[96:99],a[140:143]
v_fmac_f32 v236,4.0,v237
v_fma_f32 v237,2.0,v105,v238
M a[140:143],a[240:243],a[232:235],a[140:143]
ds_read_b128 a[220:223],v250 offset:10752
v_fma_f32 v105,s40,v105,v238
M a[140:143],a[192:195],a[204:207],a[140:143]
ds_read_b128 a[196:199],v249 offset:10752
v_cvt_pk_bf16_f32 v232,v232,v237
M a[144:147],a[192:195],a[232:235],a[144:147]
v_cvt_pk_bf16_f32 v234,v234,v236
v_accvgpr_read_b32 v238,a10
M a[144:147],a[240:243],a[96:99],a[144:147]
s_waitcnt lgkmcnt(3)
v_accvgpr_read_b32 v233,a106
v_add_f32 v235,v238,v233
M a[144:147],v[220:223],v[224:227],a[144:147]
s_waitcnt lgkmcnt(2)
v_sub_f32 v238,v238,v233
v_add_f32 v233,v10,v106
M a[148:151],v[220:223],a[212:215],a[148:151]
v_sub_f32 v106,v10,v106
v_add_f32 v10,v235,v233
M a[148:151],a[240:243],v[224:227],a[148:151]
v_fmac_f32 v235,4.0,v233
v_fma_f32 v233,2.0,v106,v238
M a[148:151],a[192:195],a[96:99],a[148:151]
v_fma_f32 v106,s40,v106,v238
v_accvgpr_read_b32 v238,a11
M a[152:155],a[192:195],v[224:227],a[152:155]
v_accvgpr_read_b32 v237,a107
v_add_f32 v236,v238,v237
M a[152:155],a[240:243],a[212:215],a[152:155]
s_waitcnt lgkmcnt(1)
v_sub_f32 v238,v238,v237
v_add_f32 v237,v11,v107
M a[152:155],v[220:223],a[220:223],a[152:155]
s_waitcnt lgkmcnt(0)
v_sub_f32 v107,v11,v107
v_add_f32 v11,v236,v237
M a[156:159],v[220:223],a[196:199],a[156:159]
global_load_dword v220,v251,s[64:65]
M a[156:159],a[240:243],a[220:223],a[156:159]
s_add_u32 s47,s44,316416
buffer_load_dwordx4 v[220:223],v251,s[20:23],s47 offen offset:0 sc1
M a[156:159],a[192:195],a[212:215],a[156:159]
s_waitcnt vmcnt(11)
v_fmac_f32 v236,4.0,v237
v_fma_f32 v237,2.0,v107,v238
M a[160:163],a[224:227],a[100:103],a[160:163]
s_waitcnt vmcnt(10)
v_fma_f32 v107,s40,v107,v238
v_cvt_pk_bf16_f32 v233,v233,v237
M a[160:163],a[252:255],a[228:231],a[160:163]
s_waitcnt vmcnt(9)
buffer_load_dwordx4 a[104:107],v251,s[20:23],s47 offen offset:1024 sc1
M a[160:163],v[228:231],v[216:219],a[160:163]
v_cvt_pk_bf16_f32 v235,v235,v236
M a[164:167],v[228:231],a[204:207],a[164:167]
ds_write2st64_b64 v253,v[232:233],v[234:235] offset0:85 offset1:89
M a[164:167],a[252:255],v[216:219],a[164:167]
s_add_u32 s34,s32,6488064
v_accvgpr_read_b32 v204,a12
v_accvgpr_read_b32 v208,a108
M a[164:167],a[224:227],a[228:231],a[164:167]
buffer_load_dwordx4 a[240:243],v251,s[20:23],s47 offen offset:2048 sc1
M a[168:171],a[224:227],v[216:219],a[168:171]
s_add_u32 s48,s44,319488
v_accvgpr_read_b32 v205,a13
v_accvgpr_read_b32 v209,a109
M a[168:171],a[252:255],a[204:207],a[168:171]
v_accvgpr_read_b32 v206,a14
v_accvgpr_read_b32 v210,a110
v_accvgpr_read_b32 v207,a15
v_accvgpr_read_b32 v211,a111
v_pk_add_f32 v[212:213],v[204:205],v[208:209]
v_pk_add_f32 v[214:215],v[206:207],v[210:211]
v_pk_add_f32 v[204:205],v[204:205],v[208:209] neg_lo:[0,1] neg_hi:[0,1]
v_pk_add_f32 v[206:207],v[206:207],v[210:211] neg_lo:[0,1] neg_hi:[0,1]
v_pk_add_f32 v[208:209],v[12:13],v[108:109]
v_pk_add_f32 v[210:211],v[14:15],v[110:111]
v_pk_add_f32 v[108:109],v[12:13],v[108:109] neg_lo:[0,1] neg_hi:[0,1]
v_pk_add_f32 v[110:111],v[14:15],v[110:111] neg_lo:[0,1] neg_hi:[0,1]
v_pk_add_f32 v[12:13],v[212:213],v[208:209]
v_pk_add_f32 v[14:15],v[214:215],v[210:211]
v_pk_fma_f32 v[212:213],v[208:209],4.0,v[212:213] op_sel_hi:[1,0,1]
v_pk_fma_f32 v[214:215],v[210:211],4.0,v[214:215] op_sel_hi:[1,0,1]
v_pk_fma_f32 v[208:209],v[108:109],2.0,v[204:205] op_sel_hi:[1,0,1]
v_pk_fma_f32 v[210:211],v[110:111],2.0,v[206:207] op_sel_hi:[1,0,1]
v_pk_fma_f32 v[108:109],v[108:109],s[40:41],v[204:205] op_sel_hi:[1,0,1]
v_pk_fma_f32 v[110:111],v[110:111],s[40:41],v[206:207] op_sel_hi:[1,0,1]
M a[168:171],v[228:231],a[232:235],a[168:171]
buffer_load_dwordx4 a[192:195],v251,s[20:23],s48 offen offset:0 sc1
M a[172:175],v[228:231],a[96:99],a[172:175]
v_cvt_pk_bf16_f32 v208,v208,v209
v_cvt_pk_bf16_f32 v209,v210,v211
M a[172:175],a[252:255],a[232:235],a[172:175]
buffer_load_dwordx4 a[100:103],v251,s[20:23],s48 offen offset:1024 sc1
M a[172:175],a[224:227],a[204:207],a[172:175]
v_cvt_pk_bf16_f32 v212,v212,v213
v_cvt_pk_bf16_f32 v213,v214,v215
M a[176:179],a[224:227],a[232:235],a[176:179]
ds_write2st64_b64 v253,v[208:209],v[212:213] offset0:93 offset1:97
M a[176:179],a[252:255],a[96:99],a[176:179]
v_accvgpr_read_b32 v238,a16
v_accvgpr_read_b32 v232,a112
M a[176:179],v[228:231],v[224:227],a[176:179]
buffer_store_dwordx4 a[4:7],v252,s[24:27],s34 offen offset:384 sc1
M a[180:183],v[228:231],a[212:215],a[180:183]
ds_read_b128 a[108:111],v249 offset:17408
ds_read_b128 a[204:207],v250 offset:17408
M a[180:183],a[252:255],v[224:227],a[180:183]
ds_read_b128 a[232:235],v249 offset:17920
v_add_f32 v234,v238,v232
M a[180:183],a[224:227],a[96:99],a[180:183]
buffer_load_dwordx4 a[228:231],v251,s[20:23],s48 offen offset:2048 sc1
M a[184:187],a[224:227],v[224:227],a[184:187]
s_add_u32 s46,s44,0
ds_read_b128 a[96:99],v250 offset:17920
v_sub_f32 v238,v238,v232
M a[184:187],a[252:255],a[212:215],a[184:187]
v_add_f32 v232,v16,v112
v_sub_f32 v112,v16,v112
M a[184:187],v[228:231],a[220:223],a[184:187]
s_waitcnt lgkmcnt(4)
s_barrier
ds_read_b128 a[8:11],v251 offset:43520
M a[188:191],v[228:231],a[196:199],a[188:191]
ds_read_b128 a[12:15],v251 offset:47616
v_add_f32 v16,v234,v232
M a[188:191],a[252:255],a[220:223],a[188:191]
buffer_load_dwordx4 v[216:219],v251,s[20:23],s46 offen offset:0 sc1
M a[188:191],a[224:227],a[212:215],a[188:191]
s_waitcnt vmcnt(15) lgkmcnt(5)
ds_read_b128 a[196:199],v249 offset:18432
ds_read_b128 v[228:231],v250 offset:18432
M v[32:35],a[244:247],a[108:111],v[32:35]
s_waitcnt vmcnt(14) lgkmcnt(6)
v_fmac_f32 v234,4.0,v232
v_fma_f32 v232,2.0,v112,v238
M v[32:35],a[208:211],a[204:207],v[32:35]
s_waitcnt vmcnt(13) lgkmcnt(5)
buffer_load_dwordx4 v[224:227],v251,s[20:23],s46 offen offset:1024 sc1
M v[32:35],a[216:219],a[232:235],v[32:35]
s_waitcnt lgkmcnt(4)
s_add_u32 s34,s32,6684672
v_fma_f32 v112,s40,v112,v238
v_accvgpr_read_b32 v238,a17
M v[36:39],a[216:219],a[96:99],v[36:39]
v_accvgpr_read_b32 v237,a113
v_add_f32 v236,v238,v237
M v[36:39],a[208:211],a[232:235],v[36:39]
ds_read_b128 a[220:223],v249 offset:18944
v_sub_f32 v238,v238,v237
M v[36:39],a[244:247],a[204:207],v[36:39]
s_waitcnt lgkmcnt(4)
buffer_store_dwordx4 a[8:11],v252,s[24:27],s34 offen offset:384 sc1
M v[40:43],a[244:247],a[232:235],v[40:43]
ds_read_b128 a[252:255],v250 offset:18944
v_add_f32 v237,v17,v113
M v[40:43],a[208:211],a[96:99],v[40:43]
s_waitcnt lgkmcnt(3)
v_sub_f32 v113,v17,v113
v_add_f32 v17,v236,v237
M v[40:43],a[216:219],a[196:199],v[40:43]
s_waitcnt lgkmcnt(2)
v_fmac_f32 v236,4.0,v237
v_fma_f32 v237,2.0,v113,v238
M v[44:47],a[216:219],v[228:231],v[44:47]
v_fma_f32 v113,s40,v113,v238
v_cvt_pk_bf16_f32 v232,v232,v237
M v[44:47],a[208:211],a[196:199],v[44:47]
ds_read_b128 a[212:215],v250 offset:19456
v_cvt_pk_bf16_f32 v234,v234,v236
M v[44:47],a[244:247],a[96:99],v[44:47]
ds_read_b128 a[224:227],v249 offset:19456
v_accvgpr_read_b32 v238,a18
M v[48:51],a[244:247],a[196:199],v[48:51]
v_accvgpr_read_b32 v233,a114
v_add_f32 v235,v238,v233
M v[48:51],a[208:211],v[228:231],v[48:51]
s_waitcnt lgkmcnt(3)
v_sub_f32 v238,v238,v233
v_add_f32 v233,v18,v114
M v[48:51],a[216:219],a[220:223],v[48:51]
s_waitcnt lgkmcnt(2)
v_sub_f32 v114,v18,v114
v_add_f32 v18,v235,v233
M v[52:55],a[216:219],a[252:255],v[52:55]
v_fmac_f32 v235,4.0,v233
v_fma_f32 v233,2.0,v114,v238
M v[52:55],a[208:211],a[220:223],v[52:55]
v_fma_f32 v114,s40,v114,v238
v_accvgpr_read_b32 v238,a19
M v[52:55],a[244:247],v[228:231],v[52:55]
v_accvgpr_read_b32 v237,a115
v_add_f32 v236,v238,v237
M v[56:59],a[244:247],a[220:223],v[56:59]
v_sub_f32 v238,v238,v237
v_add_f32 v237,v19,v115
M v[56:59],a[208:211],a[252:255],v[56:59]
s_waitcnt lgkmcnt(1)
v_sub_f32 v115,v19,v115
v_add_f32 v19,v236,v237
M v[56:59],a[216:219],a[212:215],v[56:59]
s_waitcnt lgkmcnt(0)
v_fmac_f32 v236,4.0,v237
v_fma_f32 v237,2.0,v115,v238
M v[60:63],a[216:219],a[224:227],v[60:63]
buffer_load_dwordx4 a[216:219],v251,s[20:23],s46 offen offset:2048 sc1
M v[60:63],a[208:211],a[212:215],v[60:63]
s_add_u32 s46,s44,55296
v_fma_f32 v115,s40,v115,v238
v_cvt_pk_bf16_f32 v233,v233,v237
M v[60:63],a[244:247],a[252:255],v[60:63]
s_waitcnt vmcnt(15)
buffer_load_dwordx4 a[112:115],v251,s[20:23],s46 offen offset:0 sc1
M v[64:67],a[236:239],a[108:111],v[64:67]
s_waitcnt vmcnt(15)
s_add_u32 s34,s32,6881280
v_cvt_pk_bf16_f32 v235,v235,v236
M v[64:67],a[200:203],a[204:207],v[64:67]
s_waitcnt vmcnt(14)
ds_write2st64_b64 v253,v[232:233],v[234:235] offset0:68 offset1:72
M v[64:67],a[248:251],a[232:235],v[64:67]
v_accvgpr_read_b32 v238,a20
v_accvgpr_read_b32 v232,a116
M v[68:71],a[248:251],a[96:99],v[68:71]
buffer_load_dwordx4 a[208:211],v251,s[20:23],s46 offen offset:1024 sc1
M v[68:71],a[200:203],a[232:235],v[68:71]
v_add_f32 v234,v238,v232
v_sub_f32 v238,v238,v232
M v[68:71],a[236:239],a[204:207],v[68:71]
v_add_f32 v232,v20,v116
v_sub_f32 v116,v20,v116
M v[72:75],a[236:239],a[232:235],v[72:75]
v_add_f32 v20,v234,v232
v_fmac_f32 v234,4.0,v232
M v[72:75],a[200:203],a[96:99],v[72:75]
buffer_load_dwordx4 a[244:247],v251,s[20:23],s46 offen offset:2048 sc1
M v[72:75],a[248:251],a[196:199],v[72:75]
s_add_u32 s46,s44,110592
v_fma_f32 v232,2.0,v116,v238
v_fma_f32 v116,s40,v116,v238
M v[76:79],a[248:251],v[228:231],v[76:79]
v_accvgpr_read_b32 v238,a21
v_accvgpr_read_b32 v237,a117
M v[76:79],a[200:203],a[196:199],v[76:79]
v_add_f32 v236,v238,v237
v_sub_f32 v238,v238,v237
M v[76:79],a[236:239],a[96:99],v[76:79]
buffer_load_dwordx4 a[108:111],v251,s[20:23],s46 offen offset:0 sc1
M v[80:83],a[236:239],a[196:199],v[80:83]
v_add_f32 v237,v21,v117
v_sub_f32 v117,v21,v117
M v[80:83],a[200:203],v[228:231],v[80:83]
v_add_f32 v21,v236,v237
v_fmac_f32 v236,4.0,v237
M v[80:83],a[248:251],a[220:223],v[80:83]
ds_read_b128 a[96:99],v249 offset:26112
v_fma_f32 v237,2.0,v117,v238
M v[84:87],a[248:251],a[252:255],v[84:87]
buffer_store_dwordx4 a[12:15],v252,s[24:27],s34 offen offset:384 sc1
M v[84:87],a[200:203],a[220:223],v[84:87]
ds_read_b128 a[232:235],v250 offset:26112
ds_read_b128 a[196:199],v249 offset:26624
M v[84:87],a[236:239],v[228:231],v[84:87]
ds_read_b128 v[228:231],v250 offset:26624
v_fma_f32 v117,s40,v117,v238
M v[88:91],a[236:239],a[220:223],v[88:91]
buffer_load_dwordx4 a[204:207],v251,s[20:23],s46 offen offset:1024 sc1
M v[88:91],a[200:203],a[252:255],v[88:91]
v_cvt_pk_bf16_f32 v232,v232,v237
v_cvt_pk_bf16_f32 v234,v234,v236
M v[88:91],a[248:251],a[212:215],v[88:91]
v_accvgpr_read_b32 v238,a22
v_accvgpr_read_b32 v233,a118
M v[92:95],a[248:251],a[224:227],v[92:95]
v_add_f32 v235,v238,v233
v_sub_f32 v238,v238,v233
M v[92:95],a[200:203],a[212:215],v[92:95]
buffer_load_dwordx4 a[220:223],v251,s[20:23],s46 offen offset:2048 sc1
M v[92:95],a[236:239],a[252:255],v[92:95]
s_waitcnt vmcnt(17) lgkmcnt(3)
s_add_u32 s46,s44,165888
ds_read_b128 a[248:251],v249 offset:27136
ds_read_b128 a[200:203],v250 offset:27136
M v[128:131],v[220:223],a[96:99],v[128:131]
s_waitcnt vmcnt(16) lgkmcnt(4)
v_add_f32 v233,v22,v118
v_sub_f32 v118,v22,v118
M v[128:131],a[104:107],a[232:235],v[128:131]
s_waitcnt vmcnt(15) lgkmcnt(3)
v_add_f32 v22,v235,v233
v_fmac_f32 v235,4.0,v233
M v[128:131],a[240:243],a[196:199],v[128:131]
s_waitcnt lgkmcnt(2)
buffer_load_dwordx4 a[224:227],v251,s[20:23],s46 offen offset:0 sc1
M v[132:135],a[240:243],v[228:231],v[132:135]
v_fma_f32 v233,2.0,v118,v238
v_fma_f32 v118,s40,v118,v238
M v[132:135],a[104:107],a[196:199],v[132:135]
ds_read_b128 a[212:215],v249 offset:27648
v_accvgpr_read_b32 v238,a23
M v[132:135],v[220:223],a[232:235],v[132:135]
ds_read_b128 a[236:239],v250 offset:27648
v_accvgpr_read_b32 v237,a119
M v[136:139],v[220:223],a[196:199],v[136:139]
v_add_f32 v236,v238,v237
v_sub_f32 v238,v238,v237
M v[136:139],a[104:107],v[228:231],v[136:139]
s_waitcnt lgkmcnt(3)
v_add_f32 v237,v23,v119
v_sub_f32 v119,v23,v119
M v[136:139],a[240:243],a[248:251],v[136:139]
s_waitcnt lgkmcnt(2)
v_add_f32 v23,v236,v237
v_fmac_f32 v236,4.0,v237
M v[140:143],a[240:243],a[200:203],v[140:143]
v_fma_f32 v237,2.0,v119,v238
v_fma_f32 v119,s40,v119,v238
M v[140:143],a[104:107],a[248:251],v[140:143]
ds_read_b128 a[116:119],v250 offset:28160
v_cvt_pk_bf16_f32 v233,v233,v237
M v[140:143],v[220:223],v[228:231],v[140:143]
ds_read_b128 a[252:255],v249 offset:28160
v_cvt_pk_bf16_f32 v235,v235,v236
M v[144:147],v[220:223],a[248:251],v[144:147]
ds_write2st64_b64 v253,v[232:233],v[234:235] offset0:76 offset1:80
M v[144:147],a[104:107],a[200:203],v[144:147]
s_waitcnt lgkmcnt(4)
v_accvgpr_read_b32 v238,a24
v_accvgpr_read_b32 v232,a120
M v[144:147],a[240:243],a[212:215],v[144:147]
s_waitcnt lgkmcnt(3)
v_add_f32 v234,v238,v232
v_sub_f32 v238,v238,v232
M v[148:151],a[240:243],a[236:239],v[148:151]
v_add_f32 v232,v24,v120
v_sub_f32 v120,v24,v120
M v[148:151],a[104:107],a[212:215],v[148:151]
s_waitcnt lgkmcnt(0)
s_barrier
ds_read_b128 a[16:19],v251 offset:34816
M v[148:151],v[220:223],a[200:203],v[148:151]
ds_read_b128 a[20:23],v251 offset:38912
v_add_f32 v24,v234,v232
M v[152:155],v[220:223],a[212:215],v[152:155]
v_fmac_f32 v234,4.0,v232
v_fma_f32 v232,2.0,v120,v238
M v[152:155],a[104:107],a[236:239],v[152:155]
v_fma_f32 v120,s40,v120,v238
v_accvgpr_read_b32 v238,a25
M v[152:155],a[240:243],a[116:119],v[152:155]
v_accvgpr_read_b32 v237,a121
v_add_f32 v236,v238,v237
M v[156:159],a[240:243],a[252:255],v[156:159]
s_waitcnt lgkmcnt(1)
s_add_u32 s34,s32,7077888
buffer_store_dwordx4 a[16:19],v252,s[24:27],s34 offen offset:384 sc1
M v[156:159],a[104:107],a[116:119],v[156:159]
s_waitcnt lgkmcnt(0)
s_add_u32 s34,s32,7274496
buffer_store_dwordx4 a[20:23],v252,s[24:27],s34 offen offset:384 sc1
M v[156:159],v[220:223],a[236:239],v[156:159]
s_waitcnt vmcnt(17)
v_sub_f32 v238,v238,v237
v_add_f32 v237,v25,v121
M v[160:163],a[192:195],a[96:99],v[160:163]
s_waitcnt vmcnt(16)
v_sub_f32 v121,v25,v121
v_add_f32 v25,v236,v237
M v[160:163],a[100:103],a[232:235],v[160:163]
s_waitcnt vmcnt(14)
buffer_load_dwordx4 a[240:243],v251,s[20:23],s46 offen offset:1024 sc1
M v[160:163],a[228:231],a[196:199],v[160:163]
v_fmac_f32 v236,4.0,v237
v_fma_f32 v237,2.0,v121,v238
M v[164:167],a[228:231],v[228:231],v[164:167]
v_fma_f32 v121,s40,v121,v238
v_cvt_pk_bf16_f32 v232,v232,v237
M v[164:167],a[100:103],a[196:199],v[164:167]
v_cvt_pk_bf16_f32 v234,v234,v236
v_accvgpr_read_b32 v238,a26
M v[164:167],a[192:195],a[232:235],v[164:167]
buffer_load_dwordx4 a[104:107],v251,s[20:23],s46 offen offset:2048 sc1
M v[168:171],a[192:195],a[196:199],v[168:171]
s_add_u32 s46,s44,221184
v_accvgpr_read_b32 v233,a122
v_add_f32 v235,v238,v233
M v[168:171],a[100:103],v[228:231],v[168:171]
v_sub_f32 v238,v238,v233
v_add_f32 v233,v26,v122
M v[168:171],a[228:231],a[248:251],v[168:171]
s_barrier
v_sub_f32 v122,v26,v122
M v[172:175],a[228:231],a[200:203],v[172:175]
buffer_load_dwordx4 v[220:223],v251,s[20:23],s46 offen offset:0 sc1
M v[172:175],a[100:103],a[248:251],v[172:175]
v_add_f32 v26,v235,v233
v_fmac_f32 v235,4.0,v233
M v[172:175],a[192:195],v[228:231],v[172:175]
v_fma_f32 v233,2.0,v122,v238
v_fma_f32 v122,s40,v122,v238
M v[176:179],a[192:195],a[248:251],v[176:179]
v_accvgpr_read_b32 v238,a27
v_accvgpr_read_b32 v237,a123
M v[176:179],a[100:103],a[200:203],v[176:179]
buffer_load_dwordx4 a[96:99],v251,s[20:23],s46 offen offset:1024 sc1
M v[176:179],a[228:231],a[212:215],v[176:179]
ds_read_b128 a[120:123],v249 offset:52224
v_add_f32 v236,v238,v237
M v[180:183],a[228:231],a[236:239],v[180:183]
ds_read_b128 v[228:231],v250 offset:52224
v_sub_f32 v238,v238,v237
M v[180:183],a[100:103],a[212:215],v[180:183]
ds_read_b128 a[248:251],v249 offset:52736
v_add_f32 v237,v27,v123
M v[180:183],a[192:195],a[200:203],v[180:183]
buffer_load_dwordx4 a[232:235],v251,s[20:23],s46 offen offset:2048 sc1
M v[184:187],a[192:195],a[212:215],v[184:187]
s_add_u32 s46,s44,276480
ds_read_b128 a[200:203],v250 offset:52736
v_sub_f32 v123,v27,v123
M v[184:187],a[100:103],a[236:239],v[184:187]
v_add_f32 v27,v236,v237
v_fmac_f32 v236,4.0,v237
M v[184:187],a[228:231],a[116:119],v[184:187]
v_fma_f32 v237,2.0,v123,v238
v_fma_f32 v123,s40,v123,v238
M v[188:191],a[228:231],a[252:255],v[188:191]
buffer_load_dwordx4 a[196:199],v251,s[20:23],s46 offen offset:0 sc1
M v[188:191],a[100:103],a[116:119],v[188:191]
ds_read_b128 a[116:119],v249 offset:53248
v_cvt_pk_bf16_f32 v233,v233,v237
M v[188:191],a[192:195],a[236:239],v[188:191]
s_waitcnt vmcnt(19) lgkmcnt(4)
ds_read_b128 a[192:195],v250 offset:53248
v_cvt_pk_bf16_f32 v235,v235,v236
M v[0:3],v[216:219],a[120:123],v[0:3]
s_waitcnt vmcnt(18) lgkmcnt(4)
ds_write2st64_b64 v253,v[232:233],v[234:235] offset0:85 offset1:89
M v[0:3],v[224:227],v[228:231],v[0:3]
s_waitcnt vmcnt(16) lgkmcnt(4)
buffer_load_dwordx4 a[212:215],v251,s[20:23],s46 offen offset:1024 sc1
M v[0:3],a[216:219],a[248:251],v[0:3]
s_waitcnt lgkmcnt(3)
v_accvgpr_read_b32 v204,a28
v_accvgpr_read_b32 v208,a124
M v[4:7],a[216:219],a[200:203],v[4:7]
v_accvgpr_read_b32 v205,a29
v_accvgpr_read_b32 v209,a125
M v[4:7],v[224:227],a[248:251],v[4:7]
ds_read_b128 a[120:123],v249 offset:53760
v_accvgpr_read_b32 v206,a30
M v[4:7],v[216:219],v[228:231],v[4:7]
buffer_load_dwordx4 a[228:231],v251,s[20:23],s46 offen offset:2048 sc1
M v[8:11],v[216:219],a[248:251],v[8:11]
s_add_u32 s46,s44,46080
ds_read_b128 a[236:239],v250 offset:53760
v_accvgpr_read_b32 v210,a126
v_accvgpr_read_b32 v207,a31
v_accvgpr_read_b32 v211,a127
v_pk_add_f32 v[212:213],v[204:205],v[208:209]
v_pk_add_f32 v[214:215],v[206:207],v[210:211]
v_pk_add_f32 v[204:205],v[204:205],v[208:209] neg_lo:[0,1] neg_hi:[0,1]
v_pk_add_f32 v[206:207],v[206:207],v[210:211] neg_lo:[0,1] neg_hi:[0,1]
v_pk_add_f32 v[208:209],v[28:29],v[124:125]
v_pk_add_f32 v[210:211],v[30:31],v[126:127]
v_pk_add_f32 v[124:125],v[28:29],v[124:125] neg_lo:[0,1] neg_hi:[0,1]
v_pk_add_f32 v[126:127],v[30:31],v[126:127] neg_lo:[0,1] neg_hi:[0,1]
v_pk_add_f32 v[28:29],v[212:213],v[208:209]
v_pk_add_f32 v[30:31],v[214:215],v[210:211]
v_pk_fma_f32 v[212:213],v[208:209],4.0,v[212:213] op_sel_hi:[1,0,1]
v_pk_fma_f32 v[214:215],v[210:211],4.0,v[214:215] op_sel_hi:[1,0,1]
v_pk_fma_f32 v[208:209],v[124:125],2.0,v[204:205] op_sel_hi:[1,0,1]
v_pk_fma_f32 v[210:211],v[126:127],2.0,v[206:207] op_sel_hi:[1,0,1]
v_pk_fma_f32 v[124:125],v[124:125],s[40:41],v[204:205] op_sel_hi:[1,0,1]
v_pk_fma_f32 v[126:127],v[126:127],s[40:41],v[206:207] op_sel_hi:[1,0,1]
M v[8:11],v[224:227],a[200:203],v[8:11]
s_waitcnt lgkmcnt(4)
buffer_load_dwordx4 a[252:255],v251,s[20:23],s46 offen offset:0 sc1
M v[8:11],a[216:219],a[116:119],v[8:11]
s_waitcnt lgkmcnt(3)
v_cvt_pk_bf16_f32 v208,v208,v209
v_cvt_pk_bf16_f32 v209,v210,v211
M v[12:15],a[216:219],a[192:195],v[12:15]
buffer_load_dwordx4 a[100:103],v251,s[20:23],s46 offen offset:1024 sc1
M v[12:15],v[224:227],a[116:119],v[12:15]
ds_read_b128 a[124:127],v250 offset:54272
v_cvt_pk_bf16_f32 v212,v212,v213
M v[12:15],v[216:219],a[200:203],v[12:15]
ds_read_b128 v[228:231],v249 offset:54272
v_add_u32 v249,0x15400,v249
M v[16:19],v[216:219],a[116:119],v[16:19]
v_add_u32 v250,0x15400,v250
v_cvt_pk_bf16_f32 v213,v214,v215
M v[16:19],v[224:227],a[192:195],v[16:19]
s_waitcnt lgkmcnt(3)
ds_write2st64_b64 v253,v[208:209],v[212:213] offset0:93 offset1:97
M v[16:19],a[216:219],a[120:123],v[16:19]
s_waitcnt lgkmcnt(3)
ds_read_b128 a[116:119],v249 offset:0
v_accvgpr_read_b32 v238,a32
M v[20:23],a[216:219],a[236:239],v[20:23]
ds_read_b128 a[248:251],v250 offset:0
v_accvgpr_read_b32 v232,a128
M v[20:23],v[224:227],a[120:123],v[20:23]
ds_read_b128 a[200:203],v249 offset:512
v_add_f32 v234,v238,v232
M v[20:23],v[216:219],a[192:195],v[20:23]
ds_read_b128 a[192:195],v250 offset:512
v_sub_f32 v238,v238,v232
M v[24:27],v[216:219],a[120:123],v[24:27]
buffer_load_dwordx4 a[120:123],v251,s[20:23],s46 offen offset:2048 sc1
M v[24:27],v[224:227],a[236:239],v[24:27]
s_waitcnt lgkmcnt(6)
s_add_u32 s47,s44,49152
v_add_f32 v232,v32,v128
v_sub_f32 v128,v32,v128
M v[24:27],a[216:219],a[124:127],v[24:27]
s_waitcnt lgkmcnt(4)
s_barrier
ds_read_b128 a[24:27],v251 offset:43520
M v[28:31],a[216:219],v[228:231],v[28:31]
ds_read_b128 a[28:31],v251 offset:47616
v_add_f32 v32,v234,v232
M v[28:31],v[224:227],a[124:127],v[28:31]
buffer_load_dwordx4 a[216:219],v251,s[20:23],s47 offen offset:0 sc1
M v[28:31],v[216:219],a[236:239],v[28:31]
s_waitcnt vmcnt(21) lgkmcnt(5)
ds_read_b128 a[124:127],v249 offset:1024
ds_read_b128 v[224:227],v250 offset:1024
M v[0:3],a[112:115],a[116:119],v[0:3]
s_waitcnt vmcnt(20) lgkmcnt(6)
buffer_load_dwordx4 v[228:231],v251,s[20:23],s47 offen offset:1024 sc1
M v[0:3],a[208:211],a[248:251],v[0:3]
s_waitcnt vmcnt(20) lgkmcnt(5)
s_add_u32 s34,s32,7471104
v_fmac_f32 v234,4.0,v232
v_fma_f32 v232,2.0,v128,v238
M v[0:3],a[244:247],a[200:203],v[0:3]
s_waitcnt lgkmcnt(4)
v_fma_f32 v128,s40,v128,v238
v_accvgpr_read_b32 v238,a33
M v[4:7],a[244:247],a[192:195],v[4:7]
v_accvgpr_read_b32 v237,a129
v_add_f32 v236,v238,v237
M v[4:7],a[208:211],a[200:203],v[4:7]
s_waitcnt lgkmcnt(3)
buffer_store_dwordx4 a[24:27],v252,s[24:27],s34 offen offset:384 sc1
M v[4:7],a[112:115],a[248:251],v[4:7]
s_add_u32 s34,s32,7667712
ds_read_b128 a[116:119],v249 offset:1536
ds_read_b128 a[236:239],v250 offset:1536
M v[8:11],a[112:115],a[200:203],v[8:11]
v_sub_f32 v238,v238,v237
v_add_f32 v237,v33,v129
M v[8:11],a[208:211],a[192:195],v[8:11]
s_waitcnt lgkmcnt(3)
buffer_store_dwordx4 a[28:31],v252,s[24:27],s34 offen offset:384 sc1
M v[8:11],a[244:247],a[124:127],v[8:11]
s_waitcnt lgkmcnt(2)
v_sub_f32 v129,v33,v129
v_add_f32 v33,v236,v237
M v[12:15],a[244:247],v[224:227],v[12:15]
v_fmac_f32 v236,4.0,v237
v_fma_f32 v237,2.0,v129,v238
M v[12:15],a[208:211],a[124:127],v[12:15]
ds_read_b128 v[216:219],v250 offset:2048
v_fma_f32 v129,s40,v129,v238
M v[12:15],a[112:115],a[192:195],v[12:15]
ds_read_b128 a[248:251],v249 offset:2048
v_cvt_pk_bf16_f32 v232,v232,v237
M v[16:19],a[112:115],a[124:127],v[16:19]
v_cvt_pk_bf16_f32 v234,v234,v236
v_accvgpr_read_b32 v238,a34
M v[16:19],a[208:211],v[224:227],v[16:19]
s_waitcnt lgkmcnt(3)
v_accvgpr_read_b32 v233,a130
v_add_f32 v235,v238,v233
M v[16:19],a[244:247],a[116:119],v[16:19]
s_waitcnt lgkmcnt(2)
ds_read_b128 a[124:127],v249 offset:17408
v_sub_f32 v238,v238,v233
M v[20:23],a[244:247],a[236:239],v[20:23]
ds_read_b128 a[200:203],v250 offset:17408
v_add_f32 v233,v34,v130
M v[20:23],a[208:211],a[116:119],v[20:23]
ds_read_b128 a[192:195],v249 offset:17920
v_sub_f32 v130,v34,v130
M v[20:23],a[112:115],v[224:227],v[20:23]
ds_read_b128 v[224:227],v250 offset:17920
v_add_f32 v34,v235,v233
M v[24:27],a[112:115],a[116:119],v[24:27]
buffer_load_dwordx4 a[116:119],v251,s[20:23],s47 offen offset:2048 sc1
M v[24:27],a[208:211],a[236:239],v[24:27]
s_waitcnt lgkmcnt(5)
s_add_u32 s46,s44,101376
v_fmac_f32 v235,4.0,v233
v_fma_f32 v233,2.0,v130,v238
M v[24:27],a[244:247],v[216:219],v[24:27]
s_waitcnt lgkmcnt(4)
v_fma_f32 v130,s40,v130,v238
v_accvgpr_read_b32 v238,a35
M v[28:31],a[244:247],a[248:251],v[28:31]
buffer_load_dwordx4 a[244:247],v251,s[20:23],s46 offen offset:0 sc1
M v[28:31],a[208:211],v[216:219],v[28:31]
ds_read_b128 v[216:219],v249 offset:18432
v_accvgpr_read_b32 v237,a131
M v[28:31],a[112:115],a[236:239],v[28:31]
s_waitcnt vmcnt(23) lgkmcnt(4)
ds_read_b128 a[112:115],v250 offset:18432
v_add_f32 v236,v238,v237
M v[0:3],a[108:111],a[124:127],v[0:3]
s_waitcnt vmcnt(21) lgkmcnt(4)
buffer_load_dwordx4 a[248:251],v251,s[20:23],s46 offen offset:1024 sc1
M v[0:3],a[204:207],a[200:203],v[0:3]
s_waitcnt vmcnt(21) lgkmcnt(3)
v_sub_f32 v238,v238,v237
v_add_f32 v237,v35,v131
M v[0:3],a[220:223],a[192:195],v[0:3]
s_waitcnt lgkmcnt(2)
v_sub_f32 v131,v35,v131
v_add_f32 v35,v236,v237
M v[4:7],a[220:223],v[224:227],v[4:7]
v_fmac_f32 v236,4.0,v237
v_fma_f32 v237,2.0,v131,v238
M v[4:7],a[204:207],a[192:195],v[4:7]
buffer_load_dwordx4 a[208:211],v251,s[20:23],s46 offen offset:2048 sc1
M v[4:7],a[108:111],a[200:203],v[4:7]
ds_read_b128 a[128:131],v249 offset:18944
ds_read_b128 a[124:127],v250 offset:18944
M v[8:11],a[108:111],a[192:195],v[8:11]
v_fma_f32 v131,s40,v131,v238
v_cvt_pk_bf16_f32 v233,v233,v237
M v[8:11],a[204:207],v[224:227],v[8:11]
s_waitcnt lgkmcnt(3)
v_cvt_pk_bf16_f32 v235,v235,v236
M v[8:11],a[220:223],v[216:219],v[8:11]
s_waitcnt lgkmcnt(2)
ds_write2st64_b64 v253,v[232:233],v[234:235] offset0:34 offset1:38
M v[12:15],a[220:223],a[112:115],v[12:15]
v_accvgpr_read_b32 v204,a36
v_accvgpr_read_b32 v208,a132
M v[12:15],a[204:207],v[216:219],v[12:15]
ds_read_b128 a[236:239],v250 offset:19456
v_accvgpr_read_b32 v205,a37
M v[12:15],a[108:111],v[224:227],v[12:15]
ds_read_b128 a[200:203],v249 offset:19456
v_accvgpr_read_b32 v209,a133
M v[16:19],a[108:111],v[216:219],v[16:19]
s_add_u32 s47,s44,104448
v_accvgpr_read_b32 v206,a38
v_accvgpr_read_b32 v210,a134
v_accvgpr_read_b32 v207,a39
v_accvgpr_read_b32 v211,a135
v_pk_add_f32 v[212:213],v[204:205],v[208:209]
v_pk_add_f32 v[214:215],v[206:207],v[210:211]
v_pk_add_f32 v[204:205],v[204:205],v[208:209] neg_lo:[0,1] neg_hi:[0,1]
v_pk_add_f32 v[206:207],v[206:207],v[210:211] neg_lo:[0,1] neg_hi:[0,1]
v_pk_add_f32 v[208:209],v[36:37],v[132:133]
v_pk_add_f32 v[210:211],v[38:39],v[134:135]
v_pk_add_f32 v[132:133],v[36:37],v[132:133] neg_lo:[0,1] neg_hi:[0,1]
v_pk_add_f32 v[134:135],v[38:39],v[134:135] neg_lo:[0,1] neg_hi:[0,1]
v_pk_add_f32 v[36:37],v[212:213],v[208:209]
v_pk_add_f32 v[38:39],v[214:215],v[210:211]
v_pk_fma_f32 v[212:213],v[208:209],4.0,v[212:213] op_sel_hi:[1,0,1]
v_pk_fma_f32 v[214:215],v[210:211],4.0,v[214:215] op_sel_hi:[1,0,1]
v_pk_fma_f32 v[208:209],v[132:133],2.0,v[204:205] op_sel_hi:[1,0,1]
v_pk_fma_f32 v[210:211],v[134:135],2.0,v[206:207] op_sel_hi:[1,0,1]
v_pk_fma_f32 v[132:133],v[132:133],s[40:41],v[204:205] op_sel_hi:[1,0,1]
v_pk_fma_f32 v[134:135],v[134:135],s[40:41],v[206:207] op_sel_hi:[1,0,1]
M v[16:19],a[204:207],a[112:115],v[16:19]
s_waitcnt lgkmcnt(4)
v_cvt_pk_bf16_f32 v208,v208,v209
v_cvt_pk_bf16_f32 v209,v210,v211
M v[16:19],a[220:223],a[128:131],v[16:19]
s_waitcnt lgkmcnt(3)
ds_read_b128 a[132:135],v249 offset:34816
v_cvt_pk_bf16_f32 v212,v212,v213
M v[20:23],a[220:223],a[124:127],v[20:23]
ds_read_b128 a[192:195],v250 offset:34816
v_cvt_pk_bf16_f32 v213,v214,v215
M v[20:23],a[204:207],a[128:131],v[20:23]
ds_read_b128 v[224:227],v249 offset:35328
ds_write2st64_b64 v253,v[208:209],v[212:213] offset0:42 offset1:46
M v[20:23],a[108:111],a[112:115],v[20:23]
ds_read_b128 a[112:115],v250 offset:35328
v_accvgpr_read_b32 v204,a40
M v[24:27],a[108:111],a[128:131],v[24:27]
buffer_load_dwordx4 a[128:131],v251,s[20:23],s47 offen offset:0 sc1
M v[24:27],a[204:207],a[124:127],v[24:27]
s_waitcnt lgkmcnt(6)
v_accvgpr_read_b32 v208,a136
v_accvgpr_read_b32 v205,a41
M v[24:27],a[220:223],a[236:239],v[24:27]
s_waitcnt lgkmcnt(5)
buffer_load_dwordx4 v[216:219],v251,s[20:23],s47 offen offset:1024 sc1
M v[28:31],a[220:223],a[200:203],v[28:31]
v_accvgpr_read_b32 v209,a137
v_accvgpr_read_b32 v206,a42
M v[28:31],a[204:207],a[236:239],v[28:31]
ds_read_b128 a[220:223],v249 offset:35840
v_accvgpr_read_b32 v210,a138
v_accvgpr_read_b32 v207,a43
v_accvgpr_read_b32 v211,a139
v_pk_add_f32 v[212:213],v[204:205],v[208:209]
v_pk_add_f32 v[214:215],v[206:207],v[210:211]
v_pk_add_f32 v[204:205],v[204:205],v[208:209] neg_lo:[0,1] neg_hi:[0,1]
v_pk_add_f32 v[206:207],v[206:207],v[210:211] neg_lo:[0,1] neg_hi:[0,1]
v_pk_add_f32 v[208:209],v[40:41],v[136:137]
v_pk_add_f32 v[210:211],v[42:43],v[138:139]
v_pk_add_f32 v[136:137],v[40:41],v[136:137] neg_lo:[0,1] neg_hi:[0,1]
v_pk_add_f32 v[138:139],v[42:43],v[138:139] neg_lo:[0,1] neg_hi:[0,1]
v_pk_add_f32 v[40:41],v[212:213],v[208:209]
v_pk_add_f32 v[42:43],v[214:215],v[210:211]
v_pk_fma_f32 v[212:213],v[208:209],4.0,v[212:213] op_sel_hi:[1,0,1]
v_pk_fma_f32 v[214:215],v[210:211],4.0,v[214:215] op_sel_hi:[1,0,1]
v_pk_fma_f32 v[208:209],v[136:137],2.0,v[204:205] op_sel_hi:[1,0,1]
v_pk_fma_f32 v[210:211],v[138:139],2.0,v[206:207] op_sel_hi:[1,0,1]
v_pk_fma_f32 v[136:137],v[136:137],s[40:41],v[204:205] op_sel_hi:[1,0,1]
v_pk_fma_f32 v[138:139],v[138:139],s[40:41],v[206:207] op_sel_hi:[1,0,1]
M v[28:31],a[108:111],a[124:127],v[28:31]
s_waitcnt vmcnt(23) lgkmcnt(5)
buffer_load_dwordx4 a[200:203],v251,s[20:23],s47 offen offset:2048 sc1
M v[0:3],a[224:227],a[132:135],v[0:3]
s_waitcnt vmcnt(21) lgkmcnt(4)
ds_read_b128 a[108:111],v250 offset:35840
v_cvt_pk_bf16_f32 v208,v208,v209
M v[0:3],a[240:243],a[192:195],v[0:3]
s_waitcnt vmcnt(20) lgkmcnt(4)
v_cvt_pk_bf16_f32 v209,v210,v211
v_cvt_pk_bf16_f32 v212,v212,v213
M v[0:3],a[104:107],v[224:227],v[0:3]
s_waitcnt lgkmcnt(2)
v_cvt_pk_bf16_f32 v213,v214,v215
M v[4:7],a[104:107],a[112:115],v[4:7]
ds_write2st64_b64 v253,v[208:209],v[212:213] offset0:51 offset1:55
M v[4:7],a[240:243],v[224:227],v[4:7]
ds_read_b128 a[124:127],v249 offset:36352
v_accvgpr_read_b32 v204,a44
M v[4:7],a[224:227],a[192:195],v[4:7]
ds_read_b128 a[136:139],v250 offset:36352
v_accvgpr_read_b32 v208,a140
M v[8:11],a[224:227],v[224:227],v[8:11]
v_accvgpr_read_b32 v205,a45
v_accvgpr_read_b32 v209,a141
M v[8:11],a[240:243],a[112:115],v[8:11]
s_waitcnt lgkmcnt(4)
v_accvgpr_read_b32 v206,a46
v_accvgpr_read_b32 v210,a142
v_accvgpr_read_b32 v207,a47
v_accvgpr_read_b32 v211,a143
v_pk_add_f32 v[212:213],v[204:205],v[208:209]
v_pk_add_f32 v[214:215],v[206:207],v[210:211]
v_pk_add_f32 v[204:205],v[204:205],v[208:209] neg_lo:[0,1] neg_hi:[0,1]
v_pk_add_f32 v[206:207],v[206:207],v[210:211] neg_lo:[0,1] neg_hi:[0,1]
v_pk_add_f32 v[208:209],v[44:45],v[140:141]
v_pk_add_f32 v[210:211],v[46:47],v[142:143]
v_pk_add_f32 v[140:141],v[44:45],v[140:141] neg_lo:[0,1] neg_hi:[0,1]
v_pk_add_f32 v[142:143],v[46:47],v[142:143] neg_lo:[0,1] neg_hi:[0,1]
v_pk_add_f32 v[44:45],v[212:213],v[208:209]
v_pk_add_f32 v[46:47],v[214:215],v[210:211]
v_pk_fma_f32 v[212:213],v[208:209],4.0,v[212:213] op_sel_hi:[1,0,1]
v_pk_fma_f32 v[214:215],v[210:211],4.0,v[214:215] op_sel_hi:[1,0,1]
v_pk_fma_f32 v[208:209],v[140:141],2.0,v[204:205] op_sel_hi:[1,0,1]
v_pk_fma_f32 v[210:211],v[142:143],2.0,v[206:207] op_sel_hi:[1,0,1]
v_pk_fma_f32 v[140:141],v[140:141],s[40:41],v[204:205] op_sel_hi:[1,0,1]
v_pk_fma_f32 v[142:143],v[142:143],s[40:41],v[206:207] op_sel_hi:[1,0,1]
M v[8:11],a[104:107],a[220:223],v[8:11]
s_waitcnt lgkmcnt(3)
v_cvt_pk_bf16_f32 v208,v208,v209
v_cvt_pk_bf16_f32 v209,v210,v211
M v[12:15],a[104:107],a[108:111],v[12:15]
v_cvt_pk_bf16_f32 v212,v212,v213
v_cvt_pk_bf16_f32 v213,v214,v215
M v[12:15],a[240:243],a[220:223],v[12:15]
ds_read_b128 a[132:135],v250 offset:36864
ds_write2st64_b64 v253,v[208:209],v[212:213] offset0:59 offset1:63
M v[12:15],a[224:227],a[112:115],v[12:15]
ds_read_b128 a[140:143],v249 offset:36864
v_accvgpr_read_b32 v238,a48
M v[16:19],a[224:227],a[220:223],v[16:19]
s_add_u32 s46,s44,156672
v_accvgpr_read_b32 v232,a144
v_add_f32 v234,v238,v232
M v[16:19],a[240:243],a[108:111],v[16:19]
s_waitcnt lgkmcnt(4)
v_sub_f32 v238,v238,v232
v_add_f32 v232,v48,v144
M v[16:19],a[104:107],a[124:127],v[16:19]
s_waitcnt lgkmcnt(3)
ds_read_b128 a[112:115],v249 offset:52224
v_sub_f32 v144,v48,v144
M v[20:23],a[104:107],a[136:139],v[20:23]
s_waitcnt lgkmcnt(2)
s_barrier
ds_read_b128 a[32:35],v251 offset:17408
M v[20:23],a[240:243],a[124:127],v[20:23]
ds_read_b128 a[36:39],v251 offset:21504
ds_read_b128 a[40:43],v251 offset:26112
M v[20:23],a[224:227],a[108:111],v[20:23]
ds_read_b128 a[44:47],v251 offset:30208
ds_read_b128 a[204:207],v250 offset:52224
M v[24:27],a[224:227],a[124:127],v[24:27]
buffer_load_dwordx4 a[124:127],v251,s[20:23],s46 offen offset:0 sc1
M v[24:27],a[240:243],a[136:139],v[24:27]
ds_read_b128 a[236:239],v249 offset:52736
ds_read_b128 a[108:111],v250 offset:52736
M v[24:27],a[104:107],a[132:135],v[24:27]
s_waitcnt lgkmcnt(6)
s_add_u32 s34,s32,6291456
buffer_store_dwordx4 a[32:35],v252,s[24:27],s34 offen offset:512 sc1
M v[28:31],a[104:107],a[140:143],v[28:31]
s_add_u32 s34,s32,6488064
v_add_f32 v48,v234,v232
v_fmac_f32 v234,4.0,v232
M v[28:31],a[240:243],a[132:135],v[28:31]
ds_read_b128 a[104:107],v249 offset:53248
v_fma_f32 v232,2.0,v144,v238
M v[28:31],a[224:227],a[136:139],v[28:31]
s_waitcnt vmcnt(21) lgkmcnt(6)
buffer_store_dwordx4 a[36:39],v252,s[24:27],s34 offen offset:512 sc1
M v[0:3],v[220:223],a[112:115],v[0:3]
s_waitcnt vmcnt(21) lgkmcnt(3)
s_add_u32 s34,s32,6684672
ds_read_b128 a[140:143],v250 offset:53248
v_fma_f32 v144,s40,v144,v238
M v[0:3],a[96:99],a[204:207],v[0:3]
s_waitcnt vmcnt(20) lgkmcnt(3)
v_accvgpr_read_b32 v238,a49
v_accvgpr_read_b32 v237,a145
M v[0:3],a[232:235],a[236:239],v[0:3]
s_waitcnt lgkmcnt(2)
buffer_store_dwordx4 a[40:43],v252,s[24:27],s34 offen offset:512 sc1
M v[4:7],a[232:235],a[108:111],v[4:7]
v_add_f32 v236,v238,v237
v_sub_f32 v238,v238,v237
M v[4:7],a[96:99],a[236:239],v[4:7]
ds_read_b128 a[132:135],v249 offset:53760
v_add_f32 v237,v49,v145
M v[4:7],v[220:223],a[204:207],v[4:7]
buffer_load_dwordx4 a[192:195],v251,s[20:23],s46 offen offset:1024 sc1
M v[8:11],v[220:223],a[236:239],v[8:11]
ds_read_b128 a[136:139],v250 offset:53760
v_sub_f32 v145,v49,v145
M v[8:11],a[96:99],a[108:111],v[8:11]
s_waitcnt lgkmcnt(3)
v_add_f32 v49,v236,v237
v_fmac_f32 v236,4.0,v237
M v[8:11],a[232:235],a[104:107],v[8:11]
s_waitcnt lgkmcnt(2)
v_fma_f32 v237,2.0,v145,v238
v_fma_f32 v145,s40,v145,v238
M v[12:15],a[232:235],a[140:143],v[12:15]
s_add_u32 s34,s32,6881280
buffer_load_dwordx4 v[224:227],v251,s[20:23],s46 offen offset:2048 sc1
M v[12:15],a[96:99],a[104:107],v[12:15]
ds_read_b128 a[112:115],v250 offset:54272
v_cvt_pk_bf16_f32 v232,v232,v237
M v[12:15],v[220:223],a[108:111],v[12:15]
ds_read_b128 a[108:111],v249 offset:54272
v_add_u32 v249,0xffff9a00,v249
M v[16:19],v[220:223],a[104:107],v[16:19]
s_add_u32 s47,s44,159744
v_add_u32 v250,0xffff9a00,v250
v_cvt_pk_bf16_f32 v234,v234,v236
M v[16:19],a[96:99],a[140:143],v[16:19]
s_waitcnt lgkmcnt(3)
buffer_store_dwordx4 a[44:47],v252,s[24:27],s34 offen offset:512 sc1
M v[16:19],a[232:235],a[132:135],v[16:19]
s_waitcnt lgkmcnt(2)
ds_read_b128 a[104:107],v249 offset:8704
v_accvgpr_read_b32 v238,a50
M v[20:23],a[232:235],a[136:139],v[20:23]
ds_read_b128 a[220:223],v250 offset:8704
v_accvgpr_read_b32 v233,a146
M v[20:23],a[96:99],a[132:135],v[20:23]
ds_read_b128 a[240:243],v249 offset:9216
v_add_f32 v235,v238,v233
M v[20:23],v[220:223],a[140:143],v[20:23]
ds_read_b128 a[140:143],v250 offset:9216
v_sub_f32 v238,v238,v233
M v[24:27],v[220:223],a[132:135],v[24:27]
buffer_load_dwordx4 a[132:135],v251,s[20:23],s47 offen offset:0 sc1
M v[24:27],a[96:99],a[136:139],v[24:27]
s_waitcnt lgkmcnt(5)
v_add_f32 v233,v50,v146
v_sub_f32 v146,v50,v146
M v[24:27],a[232:235],a[112:115],v[24:27]
s_waitcnt lgkmcnt(4)
buffer_load_dwordx4 a[224:227],v251,s[20:23],s47 offen offset:1024 sc1
M v[28:31],a[232:235],a[108:111],v[28:31]
v_add_f32 v50,v235,v233
v_fmac_f32 v235,4.0,v233
M v[28:31],a[96:99],a[112:115],v[28:31]
ds_read_b128 a[108:111],v249 offset:9728
v_fma_f32 v233,2.0,v146,v238
M v[28:31],v[220:223],a[136:139],v[28:31]
s_waitcnt vmcnt(25) lgkmcnt(4)
ds_read_b128 a[96:99],v250 offset:9728
v_fma_f32 v146,s40,v146,v238
M v[0:3],a[196:199],a[104:107],v[0:3]
s_waitcnt vmcnt(24) lgkmcnt(4)
buffer_load_dwordx4 a[204:207],v251,s[20:23],s47 offen offset:2048 sc1
M v[0:3],a[212:215],a[220:223],v[0:3]
s_waitcnt vmcnt(24) lgkmcnt(3)
v_accvgpr_read_b32 v238,a51
v_accvgpr_read_b32 v237,a147
M v[0:3],a[228:231],a[240:243],v[0:3]
s_waitcnt lgkmcnt(2)
v_add_f32 v236,v238,v237
v_sub_f32 v238,v238,v237
M v[4:7],a[228:231],a[140:143],v[4:7]
v_add_f32 v237,v51,v147
v_sub_f32 v147,v51,v147
M v[4:7],a[212:215],a[240:243],v[4:7]
ds_read_b128 a[112:115],v249 offset:10240
v_add_f32 v51,v236,v237
M v[4:7],a[196:199],a[220:223],v[4:7]
ds_read_b128 a[136:139],v250 offset:10240
v_fmac_f32 v236,4.0,v237
M v[8:11],a[196:199],a[240:243],v[8:11]
v_fma_f32 v237,2.0,v147,v238
v_fma_f32 v147,s40,v147,v238
M v[8:11],a[212:215],a[140:143],v[8:11]
s_waitcnt lgkmcnt(3)
v_cvt_pk_bf16_f32 v233,v233,v237
v_cvt_pk_bf16_f32 v235,v235,v236
M v[8:11],a[228:231],a[108:111],v[8:11]
s_waitcnt lgkmcnt(2)
ds_write2st64_b64 v253,v[232:233],v[234:235] offset0:17 offset1:21
M v[12:15],a[228:231],a[96:99],v[12:15]
v_accvgpr_read_b32 v204,a52
v_accvgpr_read_b32 v208,a148
M v[12:15],a[212:215],a[108:111],v[12:15]
ds_read_b128 a[104:107],v250 offset:10752
v_accvgpr_read_b32 v205,a53
M v[12:15],a[196:199],a[140:143],v[12:15]
ds_read_b128 a[144:147],v249 offset:10752
v_accvgpr_read_b32 v209,a149
M v[16:19],a[196:199],a[108:111],v[16:19]
s_add_u32 s46,s44,211968
v_accvgpr_read_b32 v206,a54
v_accvgpr_read_b32 v210,a150
v_accvgpr_read_b32 v207,a55
v_accvgpr_read_b32 v211,a151
v_pk_add_f32 v[212:213],v[204:205],v[208:209]
v_pk_add_f32 v[214:215],v[206:207],v[210:211]
v_pk_add_f32 v[204:205],v[204:205],v[208:209] neg_lo:[0,1] neg_hi:[0,1]
v_pk_add_f32 v[206:207],v[206:207],v[210:211] neg_lo:[0,1] neg_hi:[0,1]
v_pk_add_f32 v[208:209],v[52:53],v[148:149]
v_pk_add_f32 v[210:211],v[54:55],v[150:151]
v_pk_add_f32 v[148:149],v[52:53],v[148:149] neg_lo:[0,1] neg_hi:[0,1]
v_pk_add_f32 v[150:151],v[54:55],v[150:151] neg_lo:[0,1] neg_hi:[0,1]
v_pk_add_f32 v[52:53],v[212:213],v[208:209]
v_pk_add_f32 v[54:55],v[214:215],v[210:211]
v_pk_fma_f32 v[212:213],v[208:209],4.0,v[212:213] op_sel_hi:[1,0,1]
v_pk_fma_f32 v[214:215],v[210:211],4.0,v[214:215] op_sel_hi:[1,0,1]
v_pk_fma_f32 v[208:209],v[148:149],2.0,v[204:205] op_sel_hi:[1,0,1]
v_pk_fma_f32 v[210:211],v[150:151],2.0,v[206:207] op_sel_hi:[1,0,1]
v_pk_fma_f32 v[148:149],v[148:149],s[40:41],v[204:205] op_sel_hi:[1,0,1]
v_pk_fma_f32 v[150:151],v[150:151],s[40:41],v[206:207] op_sel_hi:[1,0,1]
M v[16:19],a[212:215],a[96:99],v[16:19]
s_waitcnt lgkmcnt(4)
v_cvt_pk_bf16_f32 v208,v208,v209
v_cvt_pk_bf16_f32 v209,v210,v211
M v[16:19],a[228:231],a[112:115],v[16:19]
s_waitcnt lgkmcnt(3)
ds_read_b128 a[140:143],v249 offset:0
v_cvt_pk_bf16_f32 v212,v212,v213
M v[20:23],a[228:231],a[136:139],v[20:23]
ds_read_b128 a[108:111],v250 offset:0
v_cvt_pk_bf16_f32 v213,v214,v215
M v[20:23],a[212:215],a[112:115],v[20:23]
ds_read_b128 a[148:151],v249 offset:512
ds_write2st64_b64 v253,v[208:209],v[212:213] offset0:25 offset1:29
M v[20:23],a[196:199],a[96:99],v[20:23]
ds_read_b128 a[96:99],v250 offset:512
v_accvgpr_read_b32 v204,a56
M v[24:27],a[196:199],a[112:115],v[24:27]
buffer_load_dwordx4 a[112:115],v251,s[20:23],s46 offen offset:0 sc1
M v[24:27],a[212:215],a[136:139],v[24:27]
s_waitcnt lgkmcnt(6)
v_accvgpr_read_b32 v208,a152
v_accvgpr_read_b32 v205,a57
M v[24:27],a[228:231],a[104:107],v[24:27]
s_waitcnt lgkmcnt(5)
buffer_load_dwordx4 a[236:239],v251,s[20:23],s46 offen offset:1024 sc1
M v[28:31],a[228:231],a[144:147],v[28:31]
v_accvgpr_read_b32 v209,a153
v_accvgpr_read_b32 v206,a58
M v[28:31],a[212:215],a[104:107],v[28:31]
ds_read_b128 a[144:147],v249 offset:1024
v_accvgpr_read_b32 v210,a154
v_accvgpr_read_b32 v207,a59
v_accvgpr_read_b32 v211,a155
v_pk_add_f32 v[212:213],v[204:205],v[208:209]
v_pk_add_f32 v[214:215],v[206:207],v[210:211]
v_pk_add_f32 v[204:205],v[204:205],v[208:209] neg_lo:[0,1] neg_hi:[0,1]
v_pk_add_f32 v[206:207],v[206:207],v[210:211] neg_lo:[0,1] neg_hi:[0,1]
v_pk_add_f32 v[208:209],v[56:57],v[152:153]
v_pk_add_f32 v[210:211],v[58:59],v[154:155]
v_pk_add_f32 v[152:153],v[56:57],v[152:153] neg_lo:[0,1] neg_hi:[0,1]
v_pk_add_f32 v[154:155],v[58:59],v[154:155] neg_lo:[0,1] neg_hi:[0,1]
v_pk_add_f32 v[56:57],v[212:213],v[208:209]
v_pk_add_f32 v[58:59],v[214:215],v[210:211]
v_pk_fma_f32 v[212:213],v[208:209],4.0,v[212:213] op_sel_hi:[1,0,1]
v_pk_fma_f32 v[214:215],v[210:211],4.0,v[214:215] op_sel_hi:[1,0,1]
v_pk_fma_f32 v[208:209],v[152:153],2.0,v[204:205] op_sel_hi:[1,0,1]
v_pk_fma_f32 v[210:211],v[154:155],2.0,v[206:207] op_sel_hi:[1,0,1]
v_pk_fma_f32 v[152:153],v[152:153],s[40:41],v[204:205] op_sel_hi:[1,0,1]
v_pk_fma_f32 v[154:155],v[154:155],s[40:41],v[206:207] op_sel_hi:[1,0,1]
M v[28:31],a[196:199],a[136:139],v[28:31]
s_waitcnt vmcnt(25) lgkmcnt(5)
buffer_load_dwordx4 a[232:235],v251,s[20:23],s46 offen offset:2048 sc1
M v[96:99],a[252:255],a[140:143],v[96:99]
s_waitcnt vmcnt(25) lgkmcnt(4)
ds_read_b128 a[104:107],v250 offset:1024
v_cvt_pk_bf16_f32 v208,v208,v209
M v[96:99],a[100:103],a[108:111],v[96:99]
s_waitcnt vmcnt(24) lgkmcnt(4)
v_cvt_pk_bf16_f32 v209,v210,v211
v_cvt_pk_bf16_f32 v212,v212,v213
M v[96:99],a[120:123],a[148:151],v[96:99]
s_waitcnt lgkmcnt(2)
v_cvt_pk_bf16_f32 v213,v214,v215
M v[100:103],a[120:123],a[96:99],v[100:103]
ds_write2st64_b64 v253,v[208:209],v[212:213] offset0:68 offset1:72
M v[100:103],a[100:103],a[148:151],v[100:103]
ds_read_b128 a[136:139],v249 offset:1536
v_accvgpr_read_b32 v204,a60
M v[100:103],a[252:255],a[108:111],v[100:103]
ds_read_b128 a[152:155],v250 offset:1536
v_accvgpr_read_b32 v208,a156
M v[104:107],a[252:255],a[148:151],v[104:107]
v_accvgpr_read_b32 v205,a61
v_accvgpr_read_b32 v209,a157
M v[104:107],a[100:103],a[96:99],v[104:107]
s_waitcnt lgkmcnt(4)
v_accvgpr_read_b32 v206,a62
v_accvgpr_read_b32 v210,a158
v_accvgpr_read_b32 v207,a63
v_accvgpr_read_b32 v211,a159
v_pk_add_f32 v[212:213],v[204:205],v[208:209]
v_pk_add_f32 v[214:215],v[206:207],v[210:211]
v_pk_add_f32 v[204:205],v[204:205],v[208:209] neg_lo:[0,1] neg_hi:[0,1]
v_pk_add_f32 v[206:207],v[206:207],v[210:211] neg_lo:[0,1] neg_hi:[0,1]
v_pk_add_f32 v[208:209],v[60:61],v[156:157]
v_pk_add_f32 v[210:211],v[62:63],v[158:159]
v_pk_add_f32 v[156:157],v[60:61],v[156:157] neg_lo:[0,1] neg_hi:[0,1]
v_pk_add_f32 v[158:159],v[62:63],v[158:159] neg_lo:[0,1] neg_hi:[0,1]
v_pk_add_f32 v[60:61],v[212:213],v[208:209]
v_pk_add_f32 v[62:63],v[214:215],v[210:211]
v_pk_fma_f32 v[212:213],v[208:209],4.0,v[212:213] op_sel_hi:[1,0,1]
v_pk_fma_f32 v[214:215],v[210:211],4.0,v[214:215] op_sel_hi:[1,0,1]
v_pk_fma_f32 v[208:209],v[156:157],2.0,v[204:205] op_sel_hi:[1,0,1]
v_pk_fma_f32 v[210:211],v[158:159],2.0,v[206:207] op_sel_hi:[1,0,1]
v_pk_fma_f32 v[156:157],v[156:157],s[40:41],v[204:205] op_sel_hi:[1,0,1]
v_pk_fma_f32 v[158:159],v[158:159],s[40:41],v[206:207] op_sel_hi:[1,0,1]
M v[104:107],a[120:123],a[144:147],v[104:107]
s_waitcnt lgkmcnt(3)
v_cvt_pk_bf16_f32 v208,v208,v209
v_cvt_pk_bf16_f32 v209,v210,v211
M v[108:111],a[120:123],a[104:107],v[108:111]
v_cvt_pk_bf16_f32 v212,v212,v213
v_cvt_pk_bf16_f32 v213,v214,v215
M v[108:111],a[100:103],a[144:147],v[108:111]
ds_read_b128 a[156:159],v250 offset:2048
ds_write2st64_b64 v253,v[208:209],v[212:213] offset0:76 offset1:80
M v[108:111],a[252:255],a[96:99],v[108:111]
ds_read_b128 v[220:223],v249 offset:2048
v_cvt_pk_bf16_f32 v0,v0,v1
M v[112:115],a[252:255],a[144:147],v[112:115]
v_cvt_pk_bf16_f32 v1,v2,v3
v_cvt_pk_bf16_f32 v4,v4,v5
M v[112:115],a[100:103],a[104:107],v[112:115]
s_waitcnt lgkmcnt(4)
v_cvt_pk_bf16_f32 v5,v6,v7
M v[112:115],a[120:123],a[136:139],v[112:115]
s_waitcnt lgkmcnt(1)
s_barrier
ds_read_b128 a[48:51],v251 offset:8704
M v[116:119],a[120:123],a[152:155],v[116:119]
ds_read_b128 a[52:55],v251 offset:12800
ds_read_b128 a[56:59],v251 offset:34816
M v[116:119],a[100:103],a[136:139],v[116:119]
ds_read_b128 a[60:63],v251 offset:38912
ds_write2st64_b64 v253,v[0:1],v[4:5] offset0:34 offset1:38
M v[116:119],a[252:255],a[104:107],v[116:119]
v_cvt_pk_bf16_f32 v8,v8,v9
v_cvt_pk_bf16_f32 v9,v10,v11
M v[120:123],a[252:255],a[136:139],v[120:123]
global_load_dword a220,v251,s[64:65]
M v[120:123],a[100:103],a[152:155],v[120:123]
s_waitcnt lgkmcnt(4)
s_add_u32 s34,s32,7077888
buffer_store_dwordx4 a[48:51],v252,s[24:27],s34 offen offset:512 sc1
M v[120:123],a[120:123],a[156:159],v[120:123]
s_add_u32 s34,s32,7274496
s_add_u32 s47,s44,215040
v_cvt_pk_bf16_f32 v12,v12,v13
M v[124:127],a[120:123],v[220:223],v[124:127]
s_waitcnt lgkmcnt(3)
buffer_store_dwordx4 a[52:55],v252,s[24:27],s34 offen offset:512 sc1
M v[124:127],a[100:103],a[156:159],v[124:127]
v_cvt_pk_bf16_f32 v13,v14,v15
M v[124:127],a[252:255],a[152:155],v[124:127]
s_waitcnt vmcnt(26)
ds_write2st64_b64 v253,v[8:9],v[12:13] offset0:42 offset1:46
M v[128:131],a[216:219],a[140:143],v[128:131]
s_waitcnt vmcnt(25)
buffer_load_dwordx4 a[220:223],v251,s[20:23],s47 offen offset:0 sc1
M v[128:131],v[228:231],a[108:111],v[128:131]
s_waitcnt vmcnt(23)
v_cvt_pk_bf16_f32 v16,v16,v17
v_cvt_pk_bf16_f32 v17,v18,v19
M v[128:131],a[116:119],a[148:151],v[128:131]
v_cvt_pk_bf16_f32 v20,v20,v21
v_cvt_pk_bf16_f32 v21,v22,v23
M v[132:135],a[116:119],a[96:99],v[132:135]
s_add_u32 s34,s32,7471104
ds_write2st64_b64 v253,v[16:17],v[20:21] offset0:51 offset1:55
M v[132:135],v[228:231],a[148:151],v[132:135]
buffer_load_dwordx4 a[240:243],v251,s[20:23],s47 offen offset:1024 sc1
M v[132:135],a[216:219],a[108:111],v[132:135]
v_cvt_pk_bf16_f32 v24,v24,v25
v_cvt_pk_bf16_f32 v25,v26,v27
M v[136:139],a[216:219],a[148:151],v[136:139]
v_cvt_pk_bf16_f32 v28,v28,v29
v_cvt_pk_bf16_f32 v29,v30,v31
M v[136:139],v[228:231],a[96:99],v[136:139]
buffer_load_dwordx4 a[228:231],v251,s[20:23],s47 offen offset:2048 sc1
M v[136:139],a[116:119],a[144:147],v[136:139]
ds_write2st64_b64 v253,v[24:25],v[28:29] offset0:59 offset1:63
M v[140:143],a[116:119],a[104:107],v[140:143]
v_accvgpr_read_b32 v238,a64
v_accvgpr_read_b32 v232,a160
M v[140:143],v[228:231],a[144:147],v[140:143]
s_waitcnt lgkmcnt(5)
buffer_store_dwordx4 a[56:59],v252,s[24:27],s34 offen offset:512 sc1
M v[140:143],a[216:219],a[96:99],v[140:143]
v_add_f32 v234,v238,v232
v_sub_f32 v238,v238,v232
M v[144:147],a[216:219],a[144:147],v[144:147]
s_add_u32 s46,s44,267264
v_add_f32 v232,v64,v160
v_sub_f32 v160,v64,v160
M v[144:147],v[228:231],a[104:107],v[144:147]
v_add_f32 v64,v234,v232
v_fmac_f32 v234,4.0,v232
M v[144:147],a[116:119],a[136:139],v[144:147]
ds_read_b128 a[120:123],v249 offset:34816
v_fma_f32 v232,2.0,v160,v238
M v[148:151],a[116:119],a[152:155],v[148:151]
ds_read_b128 a[100:103],v250 offset:34816
v_fma_f32 v160,s40,v160,v238
M v[148:151],v[228:231],a[136:139],v[148:151]
ds_read_b128 a[140:143],v249 offset:35328
v_accvgpr_read_b32 v238,a65
M v[148:151],a[216:219],a[104:107],v[148:151]
ds_read_b128 a[108:111],v250 offset:35328
v_accvgpr_read_b32 v237,a161
M v[152:155],a[216:219],a[136:139],v[152:155]
buffer_load_dwordx4 a[148:151],v251,s[20:23],s46 offen offset:0 sc1
M v[152:155],v[228:231],a[152:155],v[152:155]
v_add_f32 v236,v238,v237
v_sub_f32 v238,v238,v237
M v[152:155],a[116:119],a[156:159],v[152:155]
buffer_load_dwordx4 a[96:99],v251,s[20:23],s46 offen offset:1024 sc1
M v[156:159],a[116:119],v[220:223],v[156:159]
v_add_f32 v237,v65,v161
v_sub_f32 v161,v65,v161
M v[156:159],v[228:231],a[156:159],v[156:159]
ds_read_b128 a[104:107],v249 offset:35840
v_add_f32 v65,v236,v237
M v[156:159],a[216:219],a[152:155],v[156:159]
s_waitcnt vmcnt(27) lgkmcnt(4)
ds_read_b128 a[136:139],v250 offset:35840
v_fmac_f32 v236,4.0,v237
M v[96:99],a[244:247],a[120:123],v[96:99]
s_waitcnt vmcnt(26) lgkmcnt(4)
buffer_load_dwordx4 a[144:147],v251,s[20:23],s46 offen offset:2048 sc1
M v[96:99],a[248:251],a[100:103],v[96:99]
s_waitcnt vmcnt(26) lgkmcnt(3)
s_add_u32 s34,s32,7667712
v_fma_f32 v237,2.0,v161,v238
v_fma_f32 v161,s40,v161,v238
M v[96:99],a[208:211],a[140:143],v[96:99]
s_waitcnt lgkmcnt(2)
v_cvt_pk_bf16_f32 v232,v232,v237
v_cvt_pk_bf16_f32 v234,v234,v236
M v[100:103],a[208:211],a[108:111],v[100:103]
v_accvgpr_read_b32 v238,a66
v_accvgpr_read_b32 v233,a162
M v[100:103],a[248:251],a[140:143],v[100:103]
buffer_store_dwordx4 a[60:63],v252,s[24:27],s34 offen offset:512 sc1
M v[100:103],a[244:247],a[100:103],v[100:103]
ds_read_b128 a[116:119],v249 offset:36352
ds_read_b128 a[156:159],v250 offset:36352
M v[104:107],a[244:247],a[140:143],v[104:107]
v_add_f32 v235,v238,v233
v_sub_f32 v238,v238,v233
M v[104:107],a[248:251],a[108:111],v[104:107]
s_waitcnt lgkmcnt(3)
v_add_f32 v233,v66,v162
v_sub_f32 v162,v66,v162
M v[104:107],a[208:211],a[104:107],v[104:107]
s_waitcnt lgkmcnt(2)
v_add_f32 v66,v235,v233
v_fmac_f32 v235,4.0,v233
M v[108:111],a[208:211],a[136:139],v[108:111]
v_fma_f32 v233,2.0,v162,v238
v_fma_f32 v162,s40,v162,v238
M v[108:111],a[248:251],a[104:107],v[108:111]
ds_read_b128 a[152:155],v250 offset:36864
v_accvgpr_read_b32 v238,a67
M v[108:111],a[244:247],a[108:111],v[108:111]
v_accvgpr_read_b32 v237,a163
v_add_f32 v236,v238,v237
M v[112:115],a[244:247],a[104:107],v[112:115]
s_add_u32 s47,s44,270336
ds_read_b128 a[160:163],v249 offset:36864
v_sub_f32 v238,v238,v237
M v[112:115],a[248:251],a[136:139],v[112:115]
s_waitcnt lgkmcnt(3)
v_add_f32 v237,v67,v163
v_sub_f32 v163,v67,v163
M v[112:115],a[208:211],a[116:119],v[112:115]
s_waitcnt lgkmcnt(2)
v_add_f32 v67,v236,v237
v_fmac_f32 v236,4.0,v237
M v[116:119],a[208:211],a[156:159],v[116:119]
v_fma_f32 v237,2.0,v163,v238
v_fma_f32 v163,s40,v163,v238
M v[116:119],a[248:251],a[116:119],v[116:119]
v_cvt_pk_bf16_f32 v233,v233,v237
v_cvt_pk_bf16_f32 v235,v235,v236
M v[116:119],a[244:247],a[136:139],v[116:119]
ds_write2st64_b64 v253,v[232:233],v[234:235] offset0:0 offset1:4
M v[120:123],a[244:247],a[116:119],v[120:123]
buffer_load_dwordx4 a[212:215],v251,s[20:23],s47 offen offset:0 sc1
M v[120:123],a[248:251],a[156:159],v[120:123]
s_waitcnt lgkmcnt(2)
v_accvgpr_read_b32 v238,a68
v_accvgpr_read_b32 v232,a164
M v[120:123],a[208:211],a[152:155],v[120:123]
s_waitcnt lgkmcnt(1)
buffer_load_dwordx4 a[196:199],v251,s[20:23],s47 offen offset:1024 sc1
M v[124:127],a[208:211],a[160:163],v[124:127]
v_add_f32 v234,v238,v232
v_sub_f32 v238,v238,v232
M v[124:127],a[248:251],a[152:155],v[124:127]
v_add_f32 v232,v68,v164
v_sub_f32 v164,v68,v164
M v[124:127],a[244:247],a[156:159],v[124:127]
s_waitcnt vmcnt(28)
v_add_f32 v68,v234,v232
v_fmac_f32 v234,4.0,v232
M v[128:131],a[128:131],a[120:123],v[128:131]
s_waitcnt vmcnt(27)
buffer_load_dwordx4 a[252:255],v251,s[20:23],s47 offen offset:2048 sc1
M v[128:131],v[216:219],a[100:103],v[128:131]
s_waitcnt vmcnt(27)
v_fma_f32 v232,2.0,v164,v238
v_fma_f32 v164,s40,v164,v238
M v[128:131],a[200:203],a[140:143],v[128:131]
v_accvgpr_read_b32 v238,a69
v_accvgpr_read_b32 v237,a165
M v[132:135],a[200:203],a[108:111],v[132:135]
v_add_f32 v236,v238,v237
v_sub_f32 v238,v238,v237
M v[132:135],v[216:219],a[140:143],v[132:135]
v_add_f32 v237,v69,v165
v_sub_f32 v165,v69,v165
M v[132:135],a[128:131],a[100:103],v[132:135]
v_add_f32 v69,v236,v237
v_fmac_f32 v236,4.0,v237
M v[136:139],a[128:131],a[140:143],v[136:139]
v_fma_f32 v237,2.0,v165,v238
v_fma_f32 v165,s40,v165,v238
M v[136:139],v[216:219],a[108:111],v[136:139]
v_cvt_pk_bf16_f32 v232,v232,v237
v_cvt_pk_bf16_f32 v234,v234,v236
M v[136:139],a[200:203],a[104:107],v[136:139]
v_accvgpr_read_b32 v238,a70
v_accvgpr_read_b32 v233,a166
M v[140:143],a[200:203],a[136:139],v[140:143]
v_add_f32 v235,v238,v233
v_sub_f32 v238,v238,v233
M v[140:143],v[216:219],a[104:107],v[140:143]
v_add_f32 v233,v70,v166
v_sub_f32 v166,v70,v166
M v[140:143],a[128:131],a[108:111],v[140:143]
v_add_f32 v70,v235,v233
v_fmac_f32 v235,4.0,v233
M v[144:147],a[128:131],a[104:107],v[144:147]
s_add_u32 s46,s44,322560
v_fma_f32 v233,2.0,v166,v238
v_fma_f32 v166,s40,v166,v238
M v[144:147],v[216:219],a[136:139],v[144:147]
v_accvgpr_read_b32 v238,a71
v_accvgpr_read_b32 v237,a167
M v[144:147],a[200:203],a[116:119],v[144:147]
ds_read_b128 a[120:123],v249 offset:52224
v_add_f32 v236,v238,v237
M v[148:151],a[200:203],a[156:159],v[148:151]
ds_read_b128 a[100:103],v250 offset:52224
v_sub_f32 v238,v238,v237
M v[148:151],v[216:219],a[116:119],v[148:151]
ds_read_b128 a[140:143],v249 offset:52736
v_add_f32 v237,v71,v167
M v[148:151],a[128:131],a[136:139],v[148:151]
ds_read_b128 a[108:111],v250 offset:52736
v_sub_f32 v167,v71,v167
M v[152:155],a[128:131],a[116:119],v[152:155]
buffer_load_dwordx4 a[104:107],v251,s[20:23],s46 offen offset:0 sc1
M v[152:155],v[216:219],a[156:159],v[152:155]
v_add_f32 v71,v236,v237
v_fmac_f32 v236,4.0,v237
M v[152:155],a[200:203],a[152:155],v[152:155]
buffer_load_dwordx4 a[164:167],v251,s[20:23],s46 offen offset:1024 sc1
M v[156:159],a[200:203],a[160:163],v[156:159]
v_fma_f32 v237,2.0,v167,v238
v_fma_f32 v167,s40,v167,v238
M v[156:159],v[216:219],a[152:155],v[156:159]
ds_read_b128 a[116:119],v249 offset:53248
v_cvt_pk_bf16_f32 v233,v233,v237
M v[156:159],a[128:131],a[156:159],v[156:159]
s_waitcnt vmcnt(28) lgkmcnt(4)
ds_read_b128 a[160:163],v250 offset:53248
v_cvt_pk_bf16_f32 v235,v235,v236
M v[96:99],a[124:127],a[120:123],v[96:99]
s_waitcnt vmcnt(24) lgkmcnt(4)
buffer_load_dwordx4 a[136:139],v251,s[20:23],s46 offen offset:2048 sc1
M v[96:99],a[192:195],a[100:103],v[96:99]
s_waitcnt vmcnt(24) lgkmcnt(3)
ds_write2st64_b64 v253,v[232:233],v[234:235] offset0:8 offset1:12
M v[96:99],v[224:227],a[140:143],v[96:99]
s_waitcnt lgkmcnt(3)
v_accvgpr_read_b32 v238,a72
v_accvgpr_read_b32 v232,a168
M v[100:103],v[224:227],a[108:111],v[100:103]
v_add_f32 v234,v238,v232
v_sub_f32 v238,v238,v232
M v[100:103],a[192:195],a[140:143],v[100:103]
ds_read_b128 a[152:155],v249 offset:53760
v_add_f32 v232,v72,v168
M v[100:103],a[124:127],a[100:103],v[100:103]
ds_read_b128 a[128:131],v250 offset:53760
v_sub_f32 v168,v72,v168
M v[104:107],a[124:127],a[140:143],v[104:107]
s_waitcnt lgkmcnt(2)
s_barrier
ds_read_b128 v[0:3],v251 offset:17408
M v[104:107],a[192:195],a[108:111],v[104:107]
ds_read_b128 v[8:11],v251 offset:21504
ds_read_b128 v[16:19],v251 offset:26112
M v[104:107],v[224:227],a[116:119],v[104:107]
ds_read_b128 v[24:27],v251 offset:30208
ds_read_b128 a[64:67],v251 offset:0
M v[108:111],v[224:227],a[160:163],v[108:111]
ds_read_b128 a[68:71],v251 offset:4096
v_add_f32 v72,v234,v232
M v[108:111],a[192:195],a[116:119],v[108:111]
ds_read_b128 a[156:159],v250 offset:54272
v_fmac_f32 v234,4.0,v232
M v[108:111],a[124:127],a[108:111],v[108:111]
s_waitcnt lgkmcnt(6)
s_add_u32 s34,s33,6291456
buffer_store_dwordx4 v[0:3],v252,s[24:27],s34 offen offset:0 sc1
M v[112:115],a[124:127],a[116:119],v[112:115]
s_waitcnt lgkmcnt(5)
s_add_u32 s34,s33,6684672
buffer_store_dwordx4 v[8:11],v252,s[24:27],s34 offen offset:0 sc1
M v[112:115],a[192:195],a[160:163],v[112:115]
s_add_u32 s47,s44,325632
ds_read_b128 v[220:223],v249 offset:54272
v_fma_f32 v232,2.0,v168,v238
M v[112:115],v[224:227],a[152:155],v[112:115]
v_fma_f32 v168,s40,v168,v238
v_accvgpr_read_b32 v238,a73
M v[116:119],v[224:227],a[128:131],v[116:119]
v_accvgpr_read_b32 v237,a169
v_add_f32 v236,v238,v237
M v[116:119],a[192:195],a[152:155],v[116:119]
v_sub_f32 v238,v238,v237
v_add_f32 v237,v73,v169
M v[116:119],a[124:127],a[160:163],v[116:119]
v_sub_f32 v169,v73,v169
v_add_f32 v73,v236,v237
M v[120:123],a[124:127],a[152:155],v[120:123]
buffer_load_dwordx4 v[228:231],v251,s[20:23],s47 offen offset:0 sc1
M v[120:123],a[192:195],a[128:131],v[120:123]
s_waitcnt lgkmcnt(1)
s_add_u32 s34,s33,7077888
v_fmac_f32 v236,4.0,v237
v_fma_f32 v237,2.0,v169,v238
M v[120:123],v[224:227],a[156:159],v[120:123]
s_waitcnt lgkmcnt(0)
buffer_load_dwordx4 a[216:219],v251,s[20:23],s47 offen offset:1024 sc1
M v[124:127],v[224:227],v[220:223],v[124:127]
v_fma_f32 v169,s40,v169,v238
v_cvt_pk_bf16_f32 v232,v232,v237
M v[124:127],a[192:195],a[156:159],v[124:127]
v_cvt_pk_bf16_f32 v234,v234,v236
v_accvgpr_read_b32 v238,a74
M v[124:127],a[124:127],a[128:131],v[124:127]
s_waitcnt vmcnt(26)
v_accvgpr_read_b32 v233,a170
v_add_f32 v235,v238,v233
M v[128:131],a[132:135],a[120:123],v[128:131]
s_waitcnt vmcnt(25)
buffer_store_dwordx4 v[16:19],v252,s[24:27],s34 offen offset:0 sc1
M v[128:131],a[224:227],a[100:103],v[128:131]
s_waitcnt vmcnt(25)
v_sub_f32 v238,v238,v233
v_add_f32 v233,v74,v170
M v[128:131],a[204:207],a[140:143],v[128:131]
v_sub_f32 v170,v74,v170
v_add_f32 v74,v235,v233
M v[132:135],a[204:207],a[108:111],v[132:135]
buffer_load_dwordx4 a[208:211],v251,s[20:23],s47 offen offset:2048 sc1
M v[132:135],a[224:227],a[140:143],v[132:135]
v_fmac_f32 v235,4.0,v233
v_fma_f32 v233,2.0,v170,v238
M v[132:135],a[132:135],a[100:103],v[132:135]
v_fma_f32 v170,s40,v170,v238
v_accvgpr_read_b32 v238,a75
M v[136:139],a[132:135],a[140:143],v[136:139]
v_accvgpr_read_b32 v237,a171
v_add_f32 v236,v238,v237
M v[136:139],a[224:227],a[108:111],v[136:139]
v_sub_f32 v238,v238,v237
v_add_f32 v237,v75,v171
M v[136:139],a[204:207],a[116:119],v[136:139]
v_sub_f32 v171,v75,v171
v_add_f32 v75,v236,v237
M v[140:143],a[204:207],a[160:163],v[140:143]
v_fmac_f32 v236,4.0,v237
v_fma_f32 v237,2.0,v171,v238
M v[140:143],a[224:227],a[116:119],v[140:143]
v_fma_f32 v171,s40,v171,v238
v_cvt_pk_bf16_f32 v233,v233,v237
M v[140:143],a[132:135],a[108:111],v[140:143]
v_add_u32 v249,0x11000,v249
v_add_u32 v250,0x11000,v250
M v[144:147],a[132:135],a[116:119],v[144:147]
s_add_u32 s47,s44,3072
v_cvt_pk_bf16_f32 v235,v235,v236
M v[144:147],a[224:227],a[160:163],v[144:147]
ds_write2st64_b64 v253,v[232:233],v[234:235] offset0:17 offset1:21
M v[144:147],a[204:207],a[152:155],v[144:147]
ds_read_b128 a[124:127],v249 offset:0
v_accvgpr_read_b32 v238,a76
M v[148:151],a[204:207],a[128:131],v[148:151]
ds_read_b128 a[120:123],v250 offset:0
v_accvgpr_read_b32 v232,a172
M v[148:151],a[224:227],a[152:155],v[148:151]
ds_read_b128 a[100:103],v249 offset:512
v_add_f32 v234,v238,v232
M v[148:151],a[132:135],a[160:163],v[148:151]
s_add_u32 s34,s33,7471104
buffer_store_dwordx4 v[24:27],v252,s[24:27],s34 offen offset:0 sc1
M v[152:155],a[132:135],a[152:155],v[152:155]
buffer_load_dwordx4 a[168:171],v251,s[20:23],s47 offen offset:0 sc1
M v[152:155],a[224:227],a[128:131],v[152:155]
ds_read_b128 a[140:143],v250 offset:512
v_sub_f32 v238,v238,v232
M v[152:155],a[204:207],a[156:159],v[152:155]
v_add_f32 v232,v76,v172
v_sub_f32 v172,v76,v172
M v[156:159],a[204:207],v[220:223],v[156:159]
v_add_f32 v76,v234,v232
v_fmac_f32 v234,4.0,v232
M v[156:159],a[224:227],a[156:159],v[156:159]
buffer_load_dwordx4 a[108:111],v251,s[20:23],s47 offen offset:1024 sc1
M v[156:159],a[132:135],a[128:131],v[156:159]
s_waitcnt vmcnt(28) lgkmcnt(3)
ds_read_b128 a[160:163],v249 offset:1024
ds_read_b128 a[152:155],v250 offset:1024
M v[96:99],a[112:115],a[124:127],v[96:99]
s_waitcnt vmcnt(27) lgkmcnt(4)
v_fma_f32 v232,2.0,v172,v238
v_fma_f32 v172,s40,v172,v238
M v[96:99],a[236:239],a[120:123],v[96:99]
s_waitcnt vmcnt(26) lgkmcnt(3)
v_accvgpr_read_b32 v238,a77
v_accvgpr_read_b32 v237,a173
M v[96:99],a[232:235],a[100:103],v[96:99]
s_waitcnt lgkmcnt(2)
buffer_load_dwordx4 a[116:119],v251,s[20:23],s47 offen offset:2048 sc1
M v[100:103],a[232:235],a[140:143],v[100:103]
v_add_f32 v236,v238,v237
v_sub_f32 v238,v238,v237
M v[100:103],a[236:239],a[100:103],v[100:103]
ds_read_b128 a[156:159],v249 offset:1536
v_add_f32 v237,v77,v173
M v[100:103],a[112:115],a[120:123],v[100:103]
ds_read_b128 a[128:131],v250 offset:1536
v_sub_f32 v173,v77,v173
M v[104:107],a[112:115],a[100:103],v[104:107]
v_add_f32 v77,v236,v237
v_fmac_f32 v236,4.0,v237
M v[104:107],a[236:239],a[140:143],v[104:107]
s_waitcnt lgkmcnt(3)
v_fma_f32 v237,2.0,v173,v238
v_fma_f32 v173,s40,v173,v238
M v[104:107],a[232:235],a[160:163],v[104:107]
s_waitcnt lgkmcnt(2)
v_cvt_pk_bf16_f32 v232,v232,v237
v_cvt_pk_bf16_f32 v234,v234,v236
M v[108:111],a[232:235],a[152:155],v[108:111]
v_accvgpr_read_b32 v238,a78
v_accvgpr_read_b32 v233,a174
M v[108:111],a[236:239],a[160:163],v[108:111]
ds_read_b128 a[132:135],v250 offset:2048
v_add_f32 v235,v238,v233
M v[108:111],a[112:115],a[140:143],v[108:111]
ds_read_b128 a[248:251],v249 offset:2048
v_sub_f32 v238,v238,v233
M v[112:115],a[112:115],a[160:163],v[112:115]
s_add_u32 s48,s44,6144
v_add_f32 v233,v78,v174
v_sub_f32 v174,v78,v174
M v[112:115],a[236:239],a[152:155],v[112:115]
s_waitcnt lgkmcnt(3)
v_add_f32 v78,v235,v233
v_fmac_f32 v235,4.0,v233
M v[112:115],a[232:235],a[156:159],v[112:115]
s_waitcnt lgkmcnt(2)
v_fma_f32 v233,2.0,v174,v238
v_fma_f32 v174,s40,v174,v238
M v[116:119],a[232:235],a[128:131],v[116:119]
s_add_u32 s34,s32,6291456
buffer_store_dwordx4 a[64:67],v252,s[24:27],s34 offen offset:640 sc1
M v[116:119],a[236:239],a[156:159],v[116:119]
v_accvgpr_read_b32 v238,a79
v_accvgpr_read_b32 v237,a175
M v[116:119],a[112:115],a[152:155],v[116:119]
v_add_f32 v236,v238,v237
v_sub_f32 v238,v238,v237
M v[120:123],a[112:115],a[156:159],v[120:123]
buffer_load_dwordx4 a[172:175],v251,s[20:23],s48 offen offset:0 sc1
M v[120:123],a[236:239],a[128:131],v[120:123]
s_waitcnt lgkmcnt(1)
v_add_f32 v237,v79,v175
v_sub_f32 v175,v79,v175
M v[120:123],a[232:235],a[132:135],v[120:123]
s_waitcnt lgkmcnt(0)
buffer_load_dwordx4 a[244:247],v251,s[20:23],s48 offen offset:1024 sc1
M v[124:127],a[232:235],a[248:251],v[124:127]
v_add_f32 v79,v236,v237
v_fmac_f32 v236,4.0,v237
M v[124:127],a[236:239],a[132:135],v[124:127]
v_fma_f32 v237,2.0,v175,v238
v_fma_f32 v175,s40,v175,v238
M v[124:127],a[112:115],a[128:131],v[124:127]
s_waitcnt vmcnt(26)
v_cvt_pk_bf16_f32 v233,v233,v237
v_cvt_pk_bf16_f32 v235,v235,v236
M v[128:131],a[220:223],a[124:127],v[128:131]
s_waitcnt vmcnt(25)
buffer_load_dwordx4 a[200:203],v251,s[20:23],s48 offen offset:2048 sc1
M v[128:131],a[240:243],a[120:123],v[128:131]
s_waitcnt vmcnt(25)
ds_write2st64_b64 v253,v[232:233],v[234:235] offset0:25 offset1:29
M v[128:131],a[228:231],a[100:103],v[128:131]
v_accvgpr_read_b32 v238,a80
v_accvgpr_read_b32 v232,a176
M v[132:135],a[228:231],a[140:143],v[132:135]
v_add_f32 v234,v238,v232
v_sub_f32 v238,v238,v232
M v[132:135],a[240:243],a[100:103],v[132:135]
v_add_f32 v232,v80,v176
v_sub_f32 v176,v80,v176
M v[132:135],a[220:223],a[120:123],v[132:135]
v_add_f32 v80,v234,v232
v_fmac_f32 v234,4.0,v232
M v[136:139],a[220:223],a[100:103],v[136:139]
v_fma_f32 v232,2.0,v176,v238
v_fma_f32 v176,s40,v176,v238
M v[136:139],a[240:243],a[140:143],v[136:139]
v_accvgpr_read_b32 v238,a81
v_accvgpr_read_b32 v237,a177
M v[136:139],a[228:231],a[160:163],v[136:139]
v_add_f32 v236,v238,v237
v_sub_f32 v238,v238,v237
M v[140:143],a[228:231],a[152:155],v[140:143]
v_add_f32 v237,v81,v177
v_sub_f32 v177,v81,v177
M v[140:143],a[240:243],a[160:163],v[140:143]
v_add_f32 v81,v236,v237
v_fmac_f32 v236,4.0,v237
M v[140:143],a[220:223],a[140:143],v[140:143]
v_fma_f32 v237,2.0,v177,v238
v_fma_f32 v177,s40,v177,v238
M v[144:147],a[220:223],a[160:163],v[144:147]
s_add_u32 s47,s44,58368
v_cvt_pk_bf16_f32 v232,v232,v237
v_cvt_pk_bf16_f32 v234,v234,v236
M v[144:147],a[240:243],a[152:155],v[144:147]
s_add_u32 s34,s32,6488064
buffer_store_dwordx4 a[68:71],v252,s[24:27],s34 offen offset:640 sc1
M v[144:147],a[228:231],a[156:159],v[144:147]
ds_read_b128 a[112:115],v249 offset:17408
v_accvgpr_read_b32 v238,a82
M v[148:151],a[228:231],a[128:131],v[148:151]
ds_read_b128 a[124:127],v250 offset:17408
v_accvgpr_read_b32 v233,a178
M v[148:151],a[240:243],a[156:159],v[148:151]
ds_read_b128 a[120:123],v249 offset:17920
v_add_f32 v235,v238,v233
M v[148:151],a[220:223],a[152:155],v[148:151]
ds_read_b128 a[100:103],v250 offset:17920
v_sub_f32 v238,v238,v233
M v[152:155],a[220:223],a[156:159],v[152:155]
buffer_load_dwordx4 a[140:143],v251,s[20:23],s47 offen offset:0 sc1
M v[152:155],a[240:243],a[128:131],v[152:155]
v_add_f32 v233,v82,v178
v_sub_f32 v178,v82,v178
M v[152:155],a[228:231],a[132:135],v[152:155]
buffer_load_dwordx4 a[160:163],v251,s[20:23],s47 offen offset:1024 sc1
M v[156:159],a[228:231],a[248:251],v[156:159]
v_add_f32 v82,v235,v233
v_fmac_f32 v235,4.0,v233
M v[156:159],a[240:243],a[132:135],v[156:159]
ds_read_b128 a[156:159],v249 offset:18432
v_fma_f32 v233,2.0,v178,v238
M v[156:159],a[220:223],a[128:131],v[156:159]
s_waitcnt vmcnt(26) lgkmcnt(4)
ds_read_b128 a[132:135],v250 offset:18432
v_fma_f32 v178,s40,v178,v238
M v[96:99],a[148:151],a[112:115],v[96:99]
s_waitcnt vmcnt(25) lgkmcnt(4)
buffer_load_dwordx4 a[152:155],v251,s[20:23],s47 offen offset:2048 sc1
M v[96:99],a[96:99],a[124:127],v[96:99]
s_waitcnt vmcnt(25) lgkmcnt(3)
v_accvgpr_read_b32 v238,a83
v_accvgpr_read_b32 v237,a179
M v[96:99],a[144:147],a[120:123],v[96:99]
s_waitcnt lgkmcnt(2)
v_add_f32 v236,v238,v237
v_sub_f32 v238,v238,v237
M v[100:103],a[144:147],a[100:103],v[100:103]
v_add_f32 v237,v83,v179
v_sub_f32 v179,v83,v179
M v[100:103],a[96:99],a[120:123],v[100:103]
ds_read_b128 a[128:131],v249 offset:18944
v_add_f32 v83,v236,v237
M v[100:103],a[148:151],a[124:127],v[100:103]
ds_read_b128 a[176:179],v250 offset:18944
v_fmac_f32 v236,4.0,v237
M v[104:107],a[148:151],a[120:123],v[104:107]
v_fma_f32 v237,2.0,v179,v238
v_fma_f32 v179,s40,v179,v238
M v[104:107],a[96:99],a[100:103],v[104:107]
s_waitcnt lgkmcnt(3)
v_cvt_pk_bf16_f32 v233,v233,v237
v_cvt_pk_bf16_f32 v235,v235,v236
M v[104:107],a[144:147],a[156:159],v[104:107]
s_waitcnt lgkmcnt(2)
ds_write2st64_b64 v253,v[232:233],v[234:235] offset0:68 offset1:72
M v[108:111],a[144:147],a[132:135],v[108:111]
v_accvgpr_read_b32 v238,a84
v_accvgpr_read_b32 v232,a180
M v[108:111],a[96:99],a[156:159],v[108:111]
ds_read_b128 v[216:219],v250 offset:19456
v_add_f32 v234,v238,v232
M v[108:111],a[148:151],a[100:103],v[108:111]
ds_read_b128 v[224:227],v249 offset:19456
v_sub_f32 v238,v238,v232
M v[112:115],a[148:151],a[156:159],v[112:115]
s_add_u32 s48,s44,61440
v_add_f32 v232,v84,v180
v_sub_f32 v180,v84,v180
M v[112:115],a[96:99],a[132:135],v[112:115]
s_waitcnt lgkmcnt(4)
v_add_f32 v84,v234,v232
v_fmac_f32 v234,4.0,v232
M v[112:115],a[144:147],a[128:131],v[112:115]
s_waitcnt lgkmcnt(3)
v_fma_f32 v232,2.0,v180,v238
v_fma_f32 v180,s40,v180,v238
M v[116:119],a[144:147],a[176:179],v[116:119]
v_accvgpr_read_b32 v238,a85
v_accvgpr_read_b32 v237,a181
M v[116:119],a[96:99],a[128:131],v[116:119]
v_add_f32 v236,v238,v237
v_sub_f32 v238,v238,v237
M v[116:119],a[148:151],a[132:135],v[116:119]
v_add_f32 v237,v85,v181
v_sub_f32 v181,v85,v181
M v[120:123],a[148:151],a[128:131],v[120:123]
buffer_load_dwordx4 a[192:195],v251,s[20:23],s48 offen offset:0 sc1
M v[120:123],a[96:99],a[176:179],v[120:123]
s_waitcnt lgkmcnt(1)
v_add_f32 v85,v236,v237
v_fmac_f32 v236,4.0,v237
M v[120:123],a[144:147],v[216:219],v[120:123]
s_waitcnt lgkmcnt(0)
buffer_load_dwordx4 a[204:207],v251,s[20:23],s48 offen offset:1024 sc1
M v[124:127],a[144:147],v[224:227],v[124:127]
v_fma_f32 v237,2.0,v181,v238
v_fma_f32 v181,s40,v181,v238
M v[124:127],a[96:99],v[216:219],v[124:127]
v_cvt_pk_bf16_f32 v232,v232,v237
v_cvt_pk_bf16_f32 v234,v234,v236
M v[124:127],a[148:151],a[176:179],v[124:127]
s_waitcnt vmcnt(25)
v_accvgpr_read_b32 v238,a86
v_accvgpr_read_b32 v233,a182
M v[128:131],a[212:215],a[112:115],v[128:131]
s_waitcnt vmcnt(24)
buffer_load_dwordx4 v[220:223],v251,s[20:23],s48 offen offset:2048 sc1
M v[128:131],a[196:199],a[124:127],v[128:131]
s_waitcnt vmcnt(24)
v_add_f32 v235,v238,v233
v_sub_f32 v238,v238,v233
M v[128:131],a[252:255],a[120:123],v[128:131]
v_add_f32 v233,v86,v182
v_sub_f32 v182,v86,v182
M v[132:135],a[252:255],a[100:103],v[132:135]
v_add_f32 v86,v235,v233
v_fmac_f32 v235,4.0,v233
M v[132:135],a[196:199],a[120:123],v[132:135]
v_fma_f32 v233,2.0,v182,v238
v_fma_f32 v182,s40,v182,v238
M v[132:135],a[212:215],a[124:127],v[132:135]
v_accvgpr_read_b32 v238,a87
v_accvgpr_read_b32 v237,a183
M v[136:139],a[212:215],a[120:123],v[136:139]
v_add_f32 v236,v238,v237
v_sub_f32 v238,v238,v237
M v[136:139],a[196:199],a[100:103],v[136:139]
v_add_f32 v237,v87,v183
v_sub_f32 v183,v87,v183
M v[136:139],a[252:255],a[156:159],v[136:139]
v_add_f32 v87,v236,v237
v_fmac_f32 v236,4.0,v237
M v[140:143],a[252:255],a[132:135],v[140:143]
v_fma_f32 v237,2.0,v183,v238
v_fma_f32 v183,s40,v183,v238
M v[140:143],a[196:199],a[156:159],v[140:143]
v_cvt_pk_bf16_f32 v233,v233,v237
v_cvt_pk_bf16_f32 v235,v235,v236
M v[140:143],a[212:215],a[100:103],v[140:143]
ds_write2st64_b64 v253,v[232:233],v[234:235] offset0:76 offset1:80
M v[144:147],a[212:215],a[156:159],v[144:147]
s_add_u32 s47,s44,113664
v_add_u32 v249,0xfffece00,v249
v_add_u32 v250,0xfffece00,v250
M v[144:147],a[196:199],a[132:135],v[144:147]
v_accvgpr_read_b32 v238,a88
v_accvgpr_read_b32 v232,a184
M v[144:147],a[252:255],a[128:131],v[144:147]
ds_read_b128 a[144:147],v249 offset:26112
v_add_f32 v234,v238,v232
M v[148:151],a[252:255],a[176:179],v[148:151]
ds_read_b128 a[96:99],v250 offset:26112
v_sub_f32 v238,v238,v232
M v[148:151],a[196:199],a[128:131],v[148:151]
ds_read_b128 a[148:151],v249 offset:26624
v_add_f32 v232,v88,v184
M v[148:151],a[212:215],a[132:135],v[148:151]
ds_read_b128 a[112:115],v250 offset:26624
v_sub_f32 v184,v88,v184
M v[152:155],a[212:215],a[128:131],v[152:155]
buffer_load_dwordx4 a[124:127],v251,s[20:23],s47 offen offset:0 sc1
M v[152:155],a[196:199],a[176:179],v[152:155]
v_add_f32 v88,v234,v232
v_fmac_f32 v234,4.0,v232
M v[152:155],a[252:255],v[216:219],v[152:155]
buffer_load_dwordx4 a[120:123],v251,s[20:23],s47 offen offset:1024 sc1
M v[156:159],a[252:255],v[224:227],v[156:159]
v_fma_f32 v232,2.0,v184,v238
v_fma_f32 v184,s40,v184,v238
M v[156:159],a[196:199],v[216:219],v[156:159]
ds_read_b128 a[100:103],v249 offset:27136
v_accvgpr_read_b32 v238,a89
M v[156:159],a[212:215],a[176:179],v[156:159]
s_waitcnt vmcnt(25) lgkmcnt(4)
ds_read_b128 a[156:159],v250 offset:27136
v_accvgpr_read_b32 v237,a185
M v[96:99],a[104:107],a[144:147],v[96:99]
s_waitcnt vmcnt(24) lgkmcnt(4)
buffer_load_dwordx4 a[180:183],v251,s[20:23],s47 offen offset:2048 sc1
M v[96:99],a[164:167],a[96:99],v[96:99]
s_waitcnt vmcnt(24) lgkmcnt(3)
v_add_f32 v236,v238,v237
v_sub_f32 v238,v238,v237
M v[96:99],a[136:139],a[148:151],v[96:99]
s_waitcnt lgkmcnt(2)
v_add_f32 v237,v89,v185
v_sub_f32 v185,v89,v185
M v[100:103],a[136:139],a[112:115],v[100:103]
v_add_f32 v89,v236,v237
v_fmac_f32 v236,4.0,v237
M v[100:103],a[164:167],a[148:151],v[100:103]
ds_read_b128 a[132:135],v249 offset:27648
v_fma_f32 v237,2.0,v185,v238
M v[100:103],a[104:107],a[96:99],v[100:103]
ds_read_b128 a[128:131],v250 offset:27648
v_fma_f32 v185,s40,v185,v238
M v[104:107],a[104:107],a[148:151],v[104:107]
v_cvt_pk_bf16_f32 v232,v232,v237
v_cvt_pk_bf16_f32 v234,v234,v236
M v[104:107],a[164:167],a[112:115],v[104:107]
s_waitcnt lgkmcnt(3)
v_accvgpr_read_b32 v238,a90
v_accvgpr_read_b32 v233,a186
M v[104:107],a[136:139],a[100:103],v[104:107]
s_waitcnt lgkmcnt(2)
v_add_f32 v235,v238,v233
v_sub_f32 v238,v238,v233
M v[108:111],a[136:139],a[156:159],v[108:111]
v_add_f32 v233,v90,v186
v_sub_f32 v186,v90,v186
M v[108:111],a[164:167],a[100:103],v[108:111]
ds_read_b128 a[176:179],v250 offset:28160
v_add_f32 v90,v235,v233
M v[108:111],a[104:107],a[112:115],v[108:111]
ds_read_b128 a[224:227],v249 offset:28160
v_fmac_f32 v235,4.0,v233
M v[112:115],a[104:107],a[100:103],v[112:115]
s_add_u32 s48,s44,116736
v_fma_f32 v233,2.0,v186,v238
v_fma_f32 v186,s40,v186,v238
M v[112:115],a[164:167],a[156:159],v[112:115]
s_waitcnt lgkmcnt(3)
v_accvgpr_read_b32 v238,a91
v_accvgpr_read_b32 v237,a187
M v[112:115],a[136:139],a[132:135],v[112:115]
s_waitcnt lgkmcnt(2)
v_add_f32 v236,v238,v237
v_sub_f32 v238,v238,v237
M v[116:119],a[136:139],a[128:131],v[116:119]
v_add_f32 v237,v91,v187
v_sub_f32 v187,v91,v187
M v[116:119],a[164:167],a[132:135],v[116:119]
v_add_f32 v91,v236,v237
v_fmac_f32 v236,4.0,v237
M v[116:119],a[104:107],a[156:159],v[116:119]
v_fma_f32 v237,2.0,v187,v238
v_fma_f32 v187,s40,v187,v238
M v[120:123],a[104:107],a[132:135],v[120:123]
buffer_load_dwordx4 a[184:187],v251,s[20:23],s48 offen offset:0 sc1
M v[120:123],a[164:167],a[128:131],v[120:123]
s_waitcnt lgkmcnt(1)
v_cvt_pk_bf16_f32 v233,v233,v237
v_cvt_pk_bf16_f32 v235,v235,v236
M v[120:123],a[136:139],a[176:179],v[120:123]
s_waitcnt lgkmcnt(0)
buffer_load_dwordx4 a[232:235],v251,s[20:23],s48 offen offset:1024 sc1
M v[124:127],a[136:139],a[224:227],v[124:127]
ds_write2st64_b64 v253,v[232:233],v[234:235] offset0:85 offset1:89
M v[124:127],a[164:167],a[176:179],v[124:127]
v_accvgpr_read_b32 v238,a92
v_accvgpr_read_b32 v232,a188
M v[124:127],a[104:107],a[128:131],v[124:127]
s_waitcnt vmcnt(23)
v_add_f32 v234,v238,v232
v_sub_f32 v238,v238,v232
M v[128:131],v[228:231],a[144:147],v[128:131]
s_waitcnt vmcnt(22)
buffer_load_dwordx4 a[236:239],v251,s[20:23],s48 offen offset:2048 sc1
M v[128:131],a[216:219],a[96:99],v[128:131]
s_waitcnt vmcnt(21)
v_add_f32 v232,v92,v188
v_sub_f32 v188,v92,v188
M v[128:131],a[208:211],a[148:151],v[128:131]
v_add_f32 v92,v234,v232
v_fmac_f32 v234,4.0,v232
M v[132:135],a[208:211],a[112:115],v[132:135]
v_fma_f32 v232,2.0,v188,v238
v_fma_f32 v188,s40,v188,v238
M v[132:135],a[216:219],a[148:151],v[132:135]
v_accvgpr_read_b32 v238,a93
v_accvgpr_read_b32 v237,a189
M v[132:135],v[228:231],a[96:99],v[132:135]
v_add_f32 v236,v238,v237
v_sub_f32 v238,v238,v237
M v[136:139],v[228:231],a[148:151],v[136:139]
v_add_f32 v237,v93,v189
v_sub_f32 v189,v93,v189
M v[136:139],a[216:219],a[112:115],v[136:139]
v_add_f32 v93,v236,v237
v_fmac_f32 v236,4.0,v237
M v[136:139],a[208:211],a[100:103],v[136:139]
v_fma_f32 v237,2.0,v189,v238
v_fma_f32 v189,s40,v189,v238
M v[140:143],a[208:211],a[156:159],v[140:143]
v_cvt_pk_bf16_f32 v232,v232,v237
v_cvt_pk_bf16_f32 v234,v234,v236
M v[140:143],a[216:219],a[100:103],v[140:143]
v_accvgpr_read_b32 v238,a94
v_accvgpr_read_b32 v233,a190
M v[140:143],v[228:231],a[112:115],v[140:143]
v_add_f32 v235,v238,v233
v_sub_f32 v238,v238,v233
M v[144:147],v[228:231],a[100:103],v[144:147]
s_add_u32 s47,s44,168960
v_add_f32 v233,v94,v190
v_sub_f32 v190,v94,v190
M v[144:147],a[216:219],a[156:159],v[144:147]
v_add_f32 v94,v235,v233
v_fmac_f32 v235,4.0,v233
M v[144:147],a[208:211],a[132:135],v[144:147]
ds_read_b128 a[136:139],v249 offset:0
v_fma_f32 v233,2.0,v190,v238
M v[148:151],a[208:211],a[128:131],v[148:151]
ds_read_b128 a[164:167],v250 offset:0
v_fma_f32 v190,s40,v190,v238
M v[148:151],a[216:219],a[132:135],v[148:151]
ds_read_b128 a[104:107],v249 offset:512
v_accvgpr_read_b32 v238,a95
M v[148:151],v[228:231],a[156:159],v[148:151]
ds_read_b128 a[144:147],v250 offset:512
v_accvgpr_read_b32 v237,a191
M v[152:155],v[228:231],a[132:135],v[152:155]
buffer_load_dwordx4 a[96:99],v251,s[20:23],s47 offen offset:0 sc1
M v[152:155],a[216:219],a[128:131],v[152:155]
v_add_f32 v236,v238,v237
v_sub_f32 v238,v238,v237
M v[152:155],a[208:211],a[176:179],v[152:155]
buffer_load_dwordx4 a[148:151],v251,s[20:23],s47 offen offset:1024 sc1
M v[156:159],a[208:211],a[224:227],v[156:159]
v_add_f32 v237,v95,v191
v_sub_f32 v191,v95,v191
M v[156:159],a[216:219],a[176:179],v[156:159]
ds_read_b128 a[100:103],v249 offset:1024
v_add_f32 v95,v236,v237
M v[156:159],v[228:231],a[128:131],v[156:159]
s_waitcnt vmcnt(21) lgkmcnt(4)
ds_read_b128 a[156:159],v250 offset:1024
v_fmac_f32 v236,4.0,v237
M v[32:35],a[168:171],a[136:139],v[32:35]
s_waitcnt vmcnt(20) lgkmcnt(4)
buffer_load_dwordx4 a[112:115],v251,s[20:23],s47 offen offset:2048 sc1
M v[32:35],a[108:111],a[164:167],v[32:35]
s_waitcnt vmcnt(20) lgkmcnt(3)
v_fma_f32 v237,2.0,v191,v238
v_fma_f32 v191,s40,v191,v238
M v[32:35],a[116:119],a[104:107],v[32:35]
s_waitcnt lgkmcnt(2)
v_cvt_pk_bf16_f32 v233,v233,v237
v_cvt_pk_bf16_f32 v235,v235,v236
M v[36:39],a[116:119],a[144:147],v[36:39]
ds_write2st64_b64 v253,v[232:233],v[234:235] offset0:93 offset1:97
M v[36:39],a[108:111],a[104:107],v[36:39]
ds_read_b128 a[132:135],v249 offset:1536
v_cvt_pk_bf16_f32 v96,v96,v97
M v[36:39],a[168:171],a[164:167],v[36:39]
ds_read_b128 a[188:191],v250 offset:1536
v_cvt_pk_bf16_f32 v97,v98,v99
M v[40:43],a[168:171],a[104:107],v[40:43]
v_cvt_pk_bf16_f32 v100,v100,v101
v_cvt_pk_bf16_f32 v101,v102,v103
M v[40:43],a[108:111],a[144:147],v[40:43]
s_waitcnt lgkmcnt(2)
s_barrier
ds_read_b128 a[72:75],v251 offset:8704
M v[40:43],a[116:119],a[100:103],v[40:43]
ds_read_b128 a[76:79],v251 offset:12800
ds_read_b128 a[80:83],v251 offset:34816
M v[44:47],a[116:119],a[156:159],v[44:47]
ds_read_b128 a[84:87],v251 offset:38912
ds_read_b128 a[88:91],v251 offset:43520
M v[44:47],a[108:111],a[100:103],v[44:47]
ds_read_b128 a[92:95],v251 offset:47616
ds_read_b128 a[176:179],v250 offset:2048
M v[44:47],a[168:171],a[144:147],v[44:47]
ds_read_b128 a[128:131],v249 offset:2048
ds_write2st64_b64 v253,v[96:97],v[100:101] offset0:34 offset1:38
M v[48:51],a[168:171],a[100:103],v[48:51]
s_waitcnt lgkmcnt(8)
s_add_u32 s34,s32,6684672
buffer_store_dwordx4 a[72:75],v252,s[24:27],s34 offen offset:640 sc1
M v[48:51],a[108:111],a[156:159],v[48:51]
s_waitcnt lgkmcnt(7)
s_add_u32 s34,s32,6881280
buffer_store_dwordx4 a[76:79],v252,s[24:27],s34 offen offset:640 sc1
M v[48:51],a[116:119],a[132:135],v[48:51]
s_add_u32 s34,s32,7077888
v_cvt_pk_bf16_f32 v104,v104,v105
v_cvt_pk_bf16_f32 v105,v106,v107
M v[52:55],a[116:119],a[188:191],v[52:55]
v_cvt_pk_bf16_f32 v108,v108,v109
v_cvt_pk_bf16_f32 v109,v110,v111
M v[52:55],a[108:111],a[132:135],v[52:55]
s_waitcnt lgkmcnt(6)
buffer_store_dwordx4 a[80:83],v252,s[24:27],s34 offen offset:640 sc1
M v[52:55],a[168:171],a[156:159],v[52:55]
s_add_u32 s34,s32,7274496
ds_write2st64_b64 v253,v[104:105],v[108:109] offset0:42 offset1:46
M v[56:59],a[168:171],a[132:135],v[56:59]
v_cvt_pk_bf16_f32 v112,v112,v113
v_cvt_pk_bf16_f32 v113,v114,v115
M v[56:59],a[108:111],a[188:191],v[56:59]
s_waitcnt lgkmcnt(3)
buffer_store_dwordx4 a[84:87],v252,s[24:27],s34 offen offset:640 sc1
M v[56:59],a[116:119],a[176:179],v[56:59]
s_waitcnt lgkmcnt(2)
s_add_u32 s34,s32,7471104
v_cvt_pk_bf16_f32 v116,v116,v117
v_cvt_pk_bf16_f32 v117,v118,v119
M v[60:63],a[116:119],a[128:131],v[60:63]
ds_write2st64_b64 v253,v[112:113],v[116:117] offset0:51 offset1:55
M v[60:63],a[108:111],a[176:179],v[60:63]
buffer_store_dwordx4 a[88:91],v252,s[24:27],s34 offen offset:640 sc1
M v[60:63],a[168:171],a[188:191],v[60:63]
s_waitcnt vmcnt(23)
v_cvt_pk_bf16_f32 v120,v120,v121
v_cvt_pk_bf16_f32 v121,v122,v123
M v[64:67],a[172:175],a[136:139],v[64:67]
s_waitcnt vmcnt(22)
global_load_dword a228,v251,s[64:65]
M v[64:67],a[244:247],a[164:167],v[64:67]
s_waitcnt vmcnt(22)
s_add_u32 s48,s44,172032
v_cvt_pk_bf16_f32 v124,v124,v125
v_cvt_pk_bf16_f32 v125,v126,v127
M v[64:67],a[200:203],a[104:107],v[64:67]
s_add_u32 s34,s32,7667712
buffer_load_dwordx4 a[228:231],v251,s[20:23],s48 offen offset:0 sc1
M v[68:71],a[200:203],a[144:147],v[68:71]
ds_write2st64_b64 v253,v[120:121],v[124:125] offset0:59 offset1:63
M v[68:71],a[244:247],a[104:107],v[68:71]
v_cvt_pk_bf16_f32 v128,v128,v129
v_cvt_pk_bf16_f32 v129,v130,v131
M v[68:71],a[172:175],a[164:167],v[68:71]
buffer_load_dwordx4 a[248:251],v251,s[20:23],s48 offen offset:1024 sc1
M v[72:75],a[172:175],a[104:107],v[72:75]
v_cvt_pk_bf16_f32 v132,v132,v133
v_cvt_pk_bf16_f32 v133,v134,v135
M v[72:75],a[244:247],a[144:147],v[72:75]
s_waitcnt lgkmcnt(0)
s_barrier
ds_read_b128 v[96:99],v251 offset:17408
M v[72:75],a[200:203],a[100:103],v[72:75]
ds_read_b128 v[104:107],v251 offset:21504
ds_read_b128 v[112:115],v251 offset:26112
M v[76:79],a[200:203],a[156:159],v[76:79]
ds_read_b128 v[120:123],v251 offset:30208
buffer_load_dwordx4 a[240:243],v251,s[20:23],s48 offen offset:2048 sc1
M v[76:79],a[244:247],a[100:103],v[76:79]
ds_write2st64_b64 v253,v[128:129],v[132:133] offset0:17 offset1:21
M v[76:79],a[172:175],a[144:147],v[76:79]
v_cvt_pk_bf16_f32 v136,v136,v137
v_cvt_pk_bf16_f32 v137,v138,v139
M v[80:83],a[172:175],a[100:103],v[80:83]
s_add_u32 s47,s44,224256
buffer_store_dwordx4 a[92:95],v252,s[24:27],s34 offen offset:640 sc1
M v[80:83],a[244:247],a[156:159],v[80:83]
v_cvt_pk_bf16_f32 v140,v140,v141
v_cvt_pk_bf16_f32 v141,v142,v143
M v[80:83],a[200:203],a[132:135],v[80:83]
ds_read_b128 a[116:119],v249 offset:34816
ds_write2st64_b64 v253,v[136:137],v[140:141] offset0:25 offset1:29
M v[84:87],a[200:203],a[188:191],v[84:87]
ds_read_b128 a[108:111],v250 offset:34816
v_cvt_pk_bf16_f32 v144,v144,v145
M v[84:87],a[244:247],a[132:135],v[84:87]
ds_read_b128 a[168:171],v249 offset:35328
v_cvt_pk_bf16_f32 v145,v146,v147
M v[84:87],a[172:175],a[156:159],v[84:87]
ds_read_b128 a[136:139],v250 offset:35328
v_cvt_pk_bf16_f32 v148,v148,v149
M v[88:91],a[172:175],a[132:135],v[88:91]
buffer_load_dwordx4 a[164:167],v251,s[20:23],s47 offen offset:0 sc1
M v[88:91],a[244:247],a[188:191],v[88:91]
v_cvt_pk_bf16_f32 v149,v150,v151
M v[88:91],a[200:203],a[176:179],v[88:91]
buffer_load_dwordx4 a[104:107],v251,s[20:23],s47 offen offset:1024 sc1
M v[92:95],a[200:203],a[128:131],v[92:95]
ds_write2st64_b64 v253,v[144:145],v[148:149] offset0:68 offset1:72
M v[92:95],a[244:247],a[176:179],v[92:95]
ds_read_b128 a[100:103],v249 offset:35840
v_cvt_pk_bf16_f32 v152,v152,v153
M v[92:95],a[172:175],a[188:191],v[92:95]
s_waitcnt vmcnt(26) lgkmcnt(6)
ds_read_b128 a[156:159],v250 offset:35840
v_cvt_pk_bf16_f32 v153,v154,v155
M v[32:35],a[140:143],a[116:119],v[32:35]
s_waitcnt vmcnt(25) lgkmcnt(5)
s_add_u32 s34,s33,6291456
buffer_load_dwordx4 a[144:147],v251,s[20:23],s47 offen offset:2048 sc1
M v[32:35],a[160:163],a[108:111],v[32:35]
s_waitcnt vmcnt(25) lgkmcnt(4)
v_cvt_pk_bf16_f32 v156,v156,v157
v_cvt_pk_bf16_f32 v157,v158,v159
M v[32:35],a[152:155],a[168:171],v[32:35]
s_waitcnt lgkmcnt(3)
ds_write2st64_b64 v253,v[152:153],v[156:157] offset0:76 offset1:80
M v[36:39],a[152:155],a[136:139],v[36:39]
buffer_store_dwordx4 v[96:99],v252,s[24:27],s34 offen offset:1152 sc1
M v[36:39],a[160:163],a[168:171],v[36:39]
ds_read_b128 a[132:135],v249 offset:36352
M v[36:39],a[140:143],a[108:111],v[36:39]
s_waitcnt lgkmcnt(1)
s_barrier
ds_read_b128 v[128:131],v251 offset:8704
M v[40:43],a[140:143],a[168:171],v[40:43]
ds_read_b128 v[136:139],v251 offset:12800
ds_read_b128 v[144:147],v251 offset:34816
M v[40:43],a[160:163],a[136:139],v[40:43]
ds_read_b128 v[152:155],v251 offset:38912
ds_read_b128 a[128:131],v250 offset:36352
M v[40:43],a[152:155],a[100:103],v[40:43]
M v[44:47],a[152:155],a[156:159],v[44:47]
M v[44:47],a[160:163],a[100:103],v[44:47]
ds_read_b128 a[176:179],v250 offset:36864
M v[44:47],a[140:143],a[136:139],v[44:47]
s_waitcnt lgkmcnt(2)
s_barrier
ds_read_b128 a[172:175],v249 offset:36864
M v[48:51],a[140:143],a[100:103],v[48:51]
s_add_u32 s48,s44,227328
M v[48:51],a[160:163],a[156:159],v[48:51]
M v[48:51],a[152:155],a[132:135],v[48:51]
s_waitcnt lgkmcnt(2)
M v[52:55],a[152:155],a[128:131],v[52:55]
M v[52:55],a[160:163],a[132:135],v[52:55]
M v[52:55],a[140:143],a[156:159],v[52:55]
M v[56:59],a[140:143],a[132:135],v[56:59]
buffer_load_dwordx4 a[188:191],v251,s[20:23],s48 offen offset:0 sc1
M v[56:59],a[160:163],a[128:131],v[56:59]
s_waitcnt lgkmcnt(1)
M v[56:59],a[152:155],a[176:179],v[56:59]
s_waitcnt lgkmcnt(0)
buffer_load_dwordx4 a[220:223],v251,s[20:23],s48 offen offset:1024 sc1
M v[60:63],a[152:155],a[172:175],v[60:63]
M v[60:63],a[160:163],a[176:179],v[60:63]
s_add_u32 s34,s33,6684672
M v[60:63],a[140:143],a[128:131],v[60:63]
s_waitcnt vmcnt(27)
M v[64:67],a[192:195],a[116:119],v[64:67]
s_waitcnt vmcnt(26)
buffer_load_dwordx4 a[252:255],v251,s[20:23],s48 offen offset:2048 sc1
M v[64:67],a[204:207],a[108:111],v[64:67]
s_waitcnt vmcnt(26)
M v[64:67],v[220:223],a[168:171],v[64:67]
M v[68:71],v[220:223],a[136:139],v[68:71]
M v[68:71],a[204:207],a[168:171],v[68:71]
buffer_store_dwordx4 v[104:107],v252,s[24:27],s34 offen offset:1152 sc1
M v[68:71],a[192:195],a[108:111],v[68:71]
M v[72:75],a[192:195],a[168:171],v[72:75]
M v[72:75],a[204:207],a[136:139],v[72:75]
M v[72:75],v[220:223],a[100:103],v[72:75]
M v[76:79],v[220:223],a[156:159],v[76:79]
M v[76:79],a[204:207],a[100:103],v[76:79]
M v[76:79],a[192:195],a[136:139],v[76:79]
M v[80:83],a[192:195],a[100:103],v[80:83]
s_add_u32 s47,s44,279552
M v[80:83],a[204:207],a[156:159],v[80:83]
M v[80:83],v[220:223],a[132:135],v[80:83]
ds_read_b128 a[152:155],v249 offset:52224
M v[84:87],v[220:223],a[128:131],v[84:87]
ds_read_b128 a[160:163],v250 offset:52224
M v[84:87],a[204:207],a[132:135],v[84:87]
ds_read_b128 a[140:143],v249 offset:52736
M v[84:87],a[192:195],a[156:159],v[84:87]
ds_read_b128 a[116:119],v250 offset:52736
M v[88:91],a[192:195],a[132:135],v[88:91]
buffer_load_dwordx4 a[108:111],v251,s[20:23],s47 offen offset:0 sc1
M v[88:91],a[204:207],a[128:131],v[88:91]
M v[88:91],v[220:223],a[176:179],v[88:91]
s_add_u32 s34,s33,7077888
buffer_load_dwordx4 a[168:171],v251,s[20:23],s47 offen offset:1024 sc1
M v[92:95],v[220:223],a[172:175],v[92:95]
M v[92:95],a[204:207],a[176:179],v[92:95]
ds_read_b128 a[100:103],v249 offset:53248
M v[92:95],a[192:195],a[128:131],v[92:95]
s_waitcnt vmcnt(28) lgkmcnt(4)
ds_read_b128 a[156:159],v250 offset:53248
M v[32:35],a[124:127],a[152:155],v[32:35]
s_waitcnt vmcnt(27) lgkmcnt(4)
buffer_load_dwordx4 a[136:139],v251,s[20:23],s47 offen offset:2048 sc1
M v[32:35],a[120:123],a[160:163],v[32:35]
s_waitcnt vmcnt(27) lgkmcnt(3)
M v[32:35],a[180:183],a[140:143],v[32:35]
s_waitcnt lgkmcnt(2)
M v[36:39],a[180:183],a[116:119],v[36:39]
M v[36:39],a[120:123],a[140:143],v[36:39]
buffer_store_dwordx4 v[112:115],v252,s[24:27],s34 offen offset:1152 sc1
M v[36:39],a[124:127],a[160:163],v[36:39]
ds_read_b128 a[132:135],v249 offset:53760
ds_read_b128 a[172:175],v250 offset:53760
M v[40:43],a[124:127],a[140:143],v[40:43]
M v[40:43],a[120:123],a[116:119],v[40:43]
s_waitcnt lgkmcnt(3)
M v[40:43],a[180:183],a[100:103],v[40:43]
s_waitcnt lgkmcnt(2)
M v[44:47],a[180:183],a[156:159],v[44:47]
M v[44:47],a[120:123],a[100:103],v[44:47]
ds_read_b128 a[176:179],v250 offset:54272
M v[44:47],a[124:127],a[116:119],v[44:47]
ds_read_b128 a[128:131],v249 offset:54272
M v[48:51],a[124:127],a[100:103],v[48:51]
s_add_u32 s48,s44,282624
M v[48:51],a[120:123],a[156:159],v[48:51]
s_waitcnt lgkmcnt(3)
M v[48:51],a[180:183],a[132:135],v[48:51]
s_waitcnt lgkmcnt(2)
M v[52:55],a[180:183],a[172:175],v[52:55]
M v[52:55],a[120:123],a[132:135],v[52:55]
M v[52:55],a[124:127],a[156:159],v[52:55]
M v[56:59],a[124:127],a[132:135],v[56:59]
s_add_u32 s34,s33,7471104
buffer_load_dwordx4 v[224:227],v251,s[20:23],s48 offen offset:0 sc1
M v[56:59],a[120:123],a[172:175],v[56:59]
s_waitcnt lgkmcnt(1)
M v[56:59],a[180:183],a[176:179],v[56:59]
s_waitcnt lgkmcnt(0)
buffer_store_dwordx4 v[120:123],v252,s[24:27],s34 offen offset:1152 sc1
M v[60:63],a[180:183],a[128:131],v[60:63]
M v[60:63],a[120:123],a[176:179],v[60:63]
M v[60:63],a[124:127],a[172:175],v[60:63]
s_waitcnt vmcnt(29)
buffer_load_dwordx4 a[196:199],v251,s[20:23],s48 offen offset:1024 sc1
M v[64:67],a[184:187],a[152:155],v[64:67]
s_waitcnt vmcnt(29)
M v[64:67],a[232:235],a[160:163],v[64:67]
s_waitcnt vmcnt(28)
M v[64:67],a[236:239],a[140:143],v[64:67]
M v[68:71],a[236:239],a[116:119],v[68:71]
buffer_load_dwordx4 v[216:219],v251,s[20:23],s48 offen offset:2048 sc1
M v[68:71],a[232:235],a[140:143],v[68:71]
M v[68:71],a[184:187],a[160:163],v[68:71]
M v[72:75],a[184:187],a[140:143],v[72:75]
M v[72:75],a[232:235],a[116:119],v[72:75]
M v[72:75],a[236:239],a[100:103],v[72:75]
M v[76:79],a[236:239],a[156:159],v[76:79]
M v[76:79],a[232:235],a[100:103],v[76:79]
M v[76:79],a[184:187],a[116:119],v[76:79]
v_add_u32 v249,0x11000,v249
v_add_u32 v250,0x11000,v250
M v[80:83],a[184:187],a[100:103],v[80:83]
s_add_u32 s48,s44,52224
M v[80:83],a[232:235],a[156:159],v[80:83]
M v[80:83],a[236:239],a[132:135],v[80:83]
ds_read_b128 a[180:183],v249 offset:0
M v[84:87],a[236:239],a[172:175],v[84:87]
ds_read_b128 a[120:123],v250 offset:0
M v[84:87],a[232:235],a[132:135],v[84:87]
s_add_u32 s34,s33,6291456
buffer_store_dwordx4 v[128:131],v252,s[24:27],s34 offen offset:1280 sc1
M v[84:87],a[184:187],a[156:159],v[84:87]
ds_read_b128 a[124:127],v249 offset:512
ds_read_b128 a[152:155],v250 offset:512
M v[88:91],a[184:187],a[132:135],v[88:91]
buffer_load_dwordx4 a[160:163],v251,s[20:23],s48 offen offset:0 sc1
M v[88:91],a[232:235],a[172:175],v[88:91]
M v[88:91],a[236:239],a[176:179],v[88:91]
M v[92:95],a[236:239],a[128:131],v[92:95]
buffer_load_dwordx4 a[140:143],v251,s[20:23],s48 offen offset:1024 sc1
M v[92:95],a[232:235],a[176:179],v[92:95]
ds_read_b128 a[100:103],v249 offset:1024
M v[92:95],a[184:187],a[172:175],v[92:95]
s_waitcnt vmcnt(31) lgkmcnt(4)
ds_read_b128 a[156:159],v250 offset:1024
M v[32:35],a[96:99],a[180:183],v[32:35]
s_waitcnt vmcnt(30) lgkmcnt(4)
M v[32:35],a[148:151],a[120:123],v[32:35]
s_waitcnt vmcnt(29) lgkmcnt(3)
buffer_load_dwordx4 a[116:119],v251,s[20:23],s48 offen offset:2048 sc1
M v[32:35],a[112:115],a[124:127],v[32:35]
s_waitcnt lgkmcnt(2)
M v[36:39],a[112:115],a[152:155],v[36:39]
M v[36:39],a[148:151],a[124:127],v[36:39]
ds_read_b128 a[132:135],v249 offset:1536
M v[36:39],a[96:99],a[120:123],v[36:39]
ds_read_b128 a[128:131],v250 offset:1536
M v[40:43],a[96:99],a[124:127],v[40:43]
M v[40:43],a[148:151],a[152:155],v[40:43]
s_waitcnt lgkmcnt(3)
M v[40:43],a[112:115],a[100:103],v[40:43]
s_waitcnt lgkmcnt(2)
M v[44:47],a[112:115],a[156:159],v[44:47]
M v[44:47],a[148:151],a[100:103],v[44:47]
ds_read_b128 a[176:179],v250 offset:2048
M v[44:47],a[96:99],a[152:155],v[44:47]
ds_read_b128 a[172:175],v249 offset:2048
M v[48:51],a[96:99],a[100:103],v[48:51]
s_add_u32 s48,s44,107520
M v[48:51],a[148:151],a[156:159],v[48:51]
s_waitcnt lgkmcnt(3)
M v[48:51],a[112:115],a[132:135],v[48:51]
s_waitcnt lgkmcnt(2)
M v[52:55],a[112:115],a[128:131],v[52:55]
s_add_u32 s34,s33,6684672
buffer_store_dwordx4 v[136:139],v252,s[24:27],s34 offen offset:1280 sc1
M v[52:55],a[148:151],a[132:135],v[52:55]
M v[52:55],a[96:99],a[156:159],v[52:55]
M v[56:59],a[96:99],a[132:135],v[56:59]
buffer_load_dwordx4 a[184:187],v251,s[20:23],s48 offen offset:0 sc1
M v[56:59],a[148:151],a[128:131],v[56:59]
s_waitcnt lgkmcnt(1)
M v[56:59],a[112:115],a[176:179],v[56:59]
s_waitcnt lgkmcnt(0)
buffer_load_dwordx4 a[212:215],v251,s[20:23],s48 offen offset:1024 sc1
M v[60:63],a[112:115],a[172:175],v[60:63]
M v[60:63],a[148:151],a[176:179],v[60:63]
M v[60:63],a[96:99],a[128:131],v[60:63]
s_waitcnt vmcnt(26)
M v[64:67],a[228:231],a[180:183],v[64:67]
s_waitcnt vmcnt(25)
buffer_load_dwordx4 a[208:211],v251,s[20:23],s48 offen offset:2048 sc1
M v[64:67],a[248:251],a[120:123],v[64:67]
s_waitcnt vmcnt(25)
M v[64:67],a[240:243],a[124:127],v[64:67]
M v[68:71],a[240:243],a[152:155],v[68:71]
M v[68:71],a[248:251],a[124:127],v[68:71]
M v[68:71],a[228:231],a[120:123],v[68:71]
M v[72:75],a[228:231],a[124:127],v[72:75]
M v[72:75],a[248:251],a[152:155],v[72:75]
M v[72:75],a[240:243],a[100:103],v[72:75]
M v[76:79],a[240:243],a[156:159],v[76:79]
M v[76:79],a[248:251],a[100:103],v[76:79]
M v[76:79],a[228:231],a[152:155],v[76:79]
M v[80:83],a[228:231],a[100:103],v[80:83]
s_add_u32 s48,s44,162816
M v[80:83],a[248:251],a[156:159],v[80:83]
s_add_u32 s34,s33,7077888
buffer_store_dwordx4 v[144:147],v252,s[24:27],s34 offen offset:1280 sc1
M v[80:83],a[240:243],a[132:135],v[80:83]
ds_read_b128 a[112:115],v249 offset:17408
M v[84:87],a[240:243],a[128:131],v[84:87]
ds_read_b128 a[148:151],v250 offset:17408
M v[84:87],a[248:251],a[132:135],v[84:87]
ds_read_b128 a[96:99],v249 offset:17920
M v[84:87],a[228:231],a[156:159],v[84:87]
ds_read_b128 a[180:183],v250 offset:17920
M v[88:91],a[228:231],a[132:135],v[88:91]
buffer_load_dwordx4 a[120:123],v251,s[20:23],s48 offen offset:0 sc1
M v[88:91],a[248:251],a[128:131],v[88:91]
M v[88:91],a[240:243],a[176:179],v[88:91]
buffer_load_dwordx4 a[124:127],v251,s[20:23],s48 offen offset:1024 sc1
M v[92:95],a[240:243],a[172:175],v[92:95]
M v[92:95],a[248:251],a[176:179],v[92:95]
ds_read_b128 a[100:103],v249 offset:18432
M v[92:95],a[228:231],a[128:131],v[92:95]
s_waitcnt vmcnt(26) lgkmcnt(4)
ds_read_b128 a[156:159],v250 offset:18432
M v[32:35],a[164:167],a[112:115],v[32:35]
s_waitcnt vmcnt(25) lgkmcnt(4)
buffer_load_dwordx4 a[152:155],v251,s[20:23],s48 offen offset:2048 sc1
M v[32:35],a[104:107],a[148:151],v[32:35]
s_waitcnt vmcnt(25) lgkmcnt(3)
M v[32:35],a[144:147],a[96:99],v[32:35]
s_waitcnt lgkmcnt(2)
M v[36:39],a[144:147],a[180:183],v[36:39]
M v[36:39],a[104:107],a[96:99],v[36:39]
ds_read_b128 a[132:135],v249 offset:18944
M v[36:39],a[164:167],a[148:151],v[36:39]
ds_read_b128 a[172:175],v250 offset:18944
M v[40:43],a[164:167],a[96:99],v[40:43]
M v[40:43],a[104:107],a[180:183],v[40:43]
s_waitcnt lgkmcnt(3)
M v[40:43],a[144:147],a[100:103],v[40:43]
s_waitcnt lgkmcnt(2)
M v[44:47],a[144:147],a[156:159],v[44:47]
M v[44:47],a[104:107],a[100:103],v[44:47]
ds_read_b128 a[176:179],v250 offset:19456
M v[44:47],a[164:167],a[180:183],v[44:47]
s_add_u32 s34,s33,7471104
buffer_store_dwordx4 v[152:155],v252,s[24:27],s34 offen offset:1280 sc1
M v[48:51],a[164:167],a[100:103],v[48:51]
s_add_u32 s48,s44,218112
ds_read_b128 a[128:131],v249 offset:19456
M v[48:51],a[104:107],a[156:159],v[48:51]
s_waitcnt lgkmcnt(3)
M v[48:51],a[144:147],a[132:135],v[48:51]
s_waitcnt lgkmcnt(2)
M v[52:55],a[144:147],a[172:175],v[52:55]
M v[52:55],a[104:107],a[132:135],v[52:55]
M v[52:55],a[164:167],a[156:159],v[52:55]
M v[56:59],a[164:167],a[132:135],v[56:59]
buffer_load_dwordx4 a[224:227],v251,s[20:23],s48 offen offset:0 sc1
M v[56:59],a[104:107],a[172:175],v[56:59]
s_waitcnt lgkmcnt(1)
M v[56:59],a[144:147],a[176:179],v[56:59]
s_waitcnt lgkmcnt(0)
buffer_load_dwordx4 a[216:219],v251,s[20:23],s48 offen offset:1024 sc1
M v[60:63],a[144:147],a[128:131],v[60:63]
M v[60:63],a[104:107],a[176:179],v[60:63]
M v[60:63],a[164:167],a[172:175],v[60:63]
s_waitcnt vmcnt(26)
M v[64:67],a[188:191],a[112:115],v[64:67]
s_waitcnt vmcnt(25)
buffer_load_dwordx4 v[228:231],v251,s[20:23],s48 offen offset:2048 sc1
M v[64:67],a[220:223],a[148:151],v[64:67]
s_waitcnt vmcnt(25)
M v[64:67],a[252:255],a[96:99],v[64:67]
M v[68:71],a[252:255],a[180:183],v[68:71]
M v[68:71],a[220:223],a[96:99],v[68:71]
M v[68:71],a[188:191],a[148:151],v[68:71]
M v[72:75],a[188:191],a[96:99],v[72:75]
M v[72:75],a[220:223],a[180:183],v[72:75]
M v[72:75],a[252:255],a[100:103],v[72:75]
M v[76:79],a[252:255],a[156:159],v[76:79]
M v[76:79],a[220:223],a[100:103],v[76:79]
M v[76:79],a[188:191],a[180:183],v[76:79]
v_add_u32 v249,0xffff1200,v249
v_add_u32 v250,0xffff1200,v250
M v[80:83],a[188:191],a[100:103],v[80:83]
s_add_u32 s48,s44,273408
M v[80:83],a[220:223],a[156:159],v[80:83]
M v[80:83],a[252:255],a[132:135],v[80:83]
ds_read_b128 a[144:147],v249 offset:8704
M v[84:87],a[252:255],a[172:175],v[84:87]
ds_read_b128 a[104:107],v250 offset:8704
M v[84:87],a[220:223],a[132:135],v[84:87]
ds_read_b128 a[164:167],v249 offset:9216
M v[84:87],a[188:191],a[156:159],v[84:87]
ds_read_b128 a[112:115],v250 offset:9216
M v[88:91],a[188:191],a[132:135],v[88:91]
buffer_load_dwordx4 a[148:151],v251,s[20:23],s48 offen offset:0 sc1
M v[88:91],a[220:223],a[172:175],v[88:91]
M v[88:91],a[252:255],a[176:179],v[88:91]
buffer_load_dwordx4 a[96:99],v251,s[20:23],s48 offen offset:1024 sc1
M v[92:95],a[252:255],a[128:131],v[92:95]
M v[92:95],a[220:223],a[176:179],v[92:95]
ds_read_b128 a[100:103],v249 offset:9728
M v[92:95],a[188:191],a[172:175],v[92:95]
s_waitcnt vmcnt(25) lgkmcnt(4)
ds_read_b128 a[156:159],v250 offset:9728
M v[32:35],a[108:111],a[144:147],v[32:35]
s_waitcnt vmcnt(24) lgkmcnt(4)
buffer_load_dwordx4 a[180:183],v251,s[20:23],s48 offen offset:2048 sc1
M v[32:35],a[168:171],a[104:107],v[32:35]
s_waitcnt vmcnt(24) lgkmcnt(3)
M v[32:35],a[136:139],a[164:167],v[32:35]
s_waitcnt lgkmcnt(2)
M v[36:39],a[136:139],a[112:115],v[36:39]
M v[36:39],a[168:171],a[164:167],v[36:39]
ds_read_b128 a[132:135],v249 offset:10240
M v[36:39],a[108:111],a[104:107],v[36:39]
ds_read_b128 a[128:131],v250 offset:10240
s_nop 1
v_cvt_pk_bf16_f32 v32,v32,v33
M v[40:43],a[108:111],a[164:167],v[40:43]
v_cvt_pk_bf16_f32 v33,v34,v35
M v[40:43],a[168:171],a[112:115],v[40:43]
s_waitcnt lgkmcnt(3)
M v[40:43],a[136:139],a[100:103],v[40:43]
s_waitcnt lgkmcnt(2)
v_cvt_pk_bf16_f32 v36,v36,v37
v_cvt_pk_bf16_f32 v37,v38,v39
M v[44:47],a[136:139],a[156:159],v[44:47]
ds_write2st64_b64 v253,v[32:33],v[36:37] offset0:34 offset1:38
M v[44:47],a[168:171],a[100:103],v[44:47]
ds_read_b128 a[176:179],v250 offset:10752
M v[44:47],a[108:111],a[112:115],v[44:47]
ds_read_b128 a[172:175],v249 offset:10752
v_cvt_pk_bf16_f32 v40,v40,v41
M v[48:51],a[108:111],a[100:103],v[48:51]
s_add_u32 s48,s44,328704
v_cvt_pk_bf16_f32 v41,v42,v43
M v[48:51],a[168:171],a[156:159],v[48:51]
s_waitcnt lgkmcnt(4)
M v[48:51],a[136:139],a[132:135],v[48:51]
s_waitcnt lgkmcnt(3)
v_cvt_pk_bf16_f32 v44,v44,v45
v_cvt_pk_bf16_f32 v45,v46,v47
M v[52:55],a[136:139],a[128:131],v[52:55]
ds_write2st64_b64 v253,v[40:41],v[44:45] offset0:42 offset1:46
M v[52:55],a[168:171],a[132:135],v[52:55]
M v[52:55],a[108:111],a[156:159],v[52:55]
s_nop 0
v_cvt_pk_bf16_f32 v48,v48,v49
v_cvt_pk_bf16_f32 v49,v50,v51
M v[56:59],a[108:111],a[132:135],v[56:59]
buffer_load_dwordx4 a[188:191],v251,s[20:23],s48 offen offset:0 sc1
M v[56:59],a[168:171],a[128:131],v[56:59]
s_waitcnt lgkmcnt(2)
M v[56:59],a[136:139],a[176:179],v[56:59]
s_waitcnt lgkmcnt(1)
buffer_load_dwordx4 a[200:203],v251,s[20:23],s48 offen offset:1024 sc1
M v[60:63],a[136:139],a[172:175],v[60:63]
v_cvt_pk_bf16_f32 v52,v52,v53
v_cvt_pk_bf16_f32 v53,v54,v55
M v[60:63],a[168:171],a[176:179],v[60:63]
ds_write2st64_b64 v253,v[48:49],v[52:53] offset0:51 offset1:55
M v[60:63],a[108:111],a[128:131],v[60:63]
s_waitcnt vmcnt(24)
v_cvt_pk_bf16_f32 v56,v56,v57
v_cvt_pk_bf16_f32 v57,v58,v59
M v[64:67],v[224:227],a[144:147],v[64:67]
s_waitcnt vmcnt(22)
buffer_load_dwordx4 a[244:247],v251,s[20:23],s48 offen offset:2048 sc1
M v[64:67],a[196:199],a[104:107],v[64:67]
s_waitcnt vmcnt(22)
M v[64:67],v[216:219],a[164:167],v[64:67]
v_cvt_pk_bf16_f32 v60,v60,v61
v_cvt_pk_bf16_f32 v61,v62,v63
M v[68:71],v[216:219],a[112:115],v[68:71]
ds_write2st64_b64 v253,v[56:57],v[60:61] offset0:59 offset1:63
M v[68:71],a[196:199],a[164:167],v[68:71]
M v[68:71],v[224:227],a[104:107],v[68:71]
s_nop 1
v_cvt_pk_bf16_f32 v64,v64,v65
v_cvt_pk_bf16_f32 v65,v66,v67
M v[72:75],v[224:227],a[164:167],v[72:75]
M v[72:75],a[196:199],a[112:115],v[72:75]
M v[72:75],v[216:219],a[100:103],v[72:75]
s_nop 0
v_cvt_pk_bf16_f32 v68,v68,v69
v_cvt_pk_bf16_f32 v69,v70,v71
M v[76:79],v[216:219],a[156:159],v[76:79]
ds_write2st64_b64 v253,v[64:65],v[68:69] offset0:0 offset1:4
M v[76:79],a[196:199],a[100:103],v[76:79]
M v[76:79],v[224:227],a[112:115],v[76:79]
s_nop 0
v_cvt_pk_bf16_f32 v72,v72,v73
v_cvt_pk_bf16_f32 v73,v74,v75
M v[80:83],v[224:227],a[100:103],v[80:83]
M v[80:83],a[196:199],a[156:159],v[80:83]
M v[80:83],v[216:219],a[132:135],v[80:83]
ds_read_b128 a[136:139],v249 offset:0
s_nop 0
v_cvt_pk_bf16_f32 v76,v76,v77
M v[84:87],v[216:219],a[128:131],v[84:87]
ds_read_b128 a[168:171],v250 offset:0
v_cvt_pk_bf16_f32 v77,v78,v79
M v[84:87],a[196:199],a[132:135],v[84:87]
ds_read_b128 a[108:111],v249 offset:512
ds_write2st64_b64 v253,v[72:73],v[76:77] offset0:8 offset1:12
M v[84:87],v[224:227],a[156:159],v[84:87]
ds_read_b128 a[144:147],v250 offset:512
v_cvt_pk_bf16_f32 v80,v80,v81
M v[88:91],v[224:227],a[132:135],v[88:91]
v_cvt_pk_bf16_f32 v81,v82,v83
M v[88:91],a[196:199],a[128:131],v[88:91]
M v[88:91],v[216:219],a[176:179],v[88:91]
s_nop 1
v_cvt_pk_bf16_f32 v84,v84,v85
v_cvt_pk_bf16_f32 v85,v86,v87
M v[92:95],v[216:219],a[172:175],v[92:95]
ds_write2st64_b64 v253,v[80:81],v[84:85] offset0:17 offset1:21
M v[92:95],a[196:199],a[176:179],v[92:95]
ds_read_b128 a[104:107],v249 offset:1024
M v[92:95],v[224:227],a[128:131],v[92:95]
s_waitcnt vmcnt(20) lgkmcnt(6)
ds_read_b128 a[164:167],v250 offset:1024
v_cvt_pk_bf16_f32 v88,v88,v89
M v[160:163],a[160:163],a[136:139],v[160:163]
s_waitcnt vmcnt(19) lgkmcnt(6)
v_cvt_pk_bf16_f32 v89,v90,v91
M v[160:163],a[140:143],a[168:171],v[160:163]
s_waitcnt vmcnt(18) lgkmcnt(5)
M v[160:163],a[116:119],a[108:111],v[160:163]
s_waitcnt lgkmcnt(3)
v_cvt_pk_bf16_f32 v92,v92,v93
v_cvt_pk_bf16_f32 v93,v94,v95
M v[164:167],a[116:119],a[144:147],v[164:167]
ds_write2st64_b64 v253,v[88:89],v[92:93] offset0:25 offset1:29
M v[164:167],a[140:143],a[108:111],v[164:167]
ds_read_b128 a[112:115],v249 offset:1536
M v[164:167],a[160:163],a[168:171],v[164:167]
ds_read_b128 a[100:103],v250 offset:1536
M v[168:171],a[160:163],a[108:111],v[168:171]
s_waitcnt lgkmcnt(2)
s_barrier
ds_read_b128 v[32:35],v251 offset:17408
M v[168:171],a[140:143],a[144:147],v[168:171]
ds_read_b128 v[40:43],v251 offset:21504
ds_read_b128 v[48:51],v251 offset:26112
M v[168:171],a[116:119],a[104:107],v[168:171]
ds_read_b128 v[56:59],v251 offset:30208
ds_read_b128 v[64:67],v251 offset:0
M v[172:175],a[116:119],a[164:167],v[172:175]
ds_read_b128 v[72:75],v251 offset:4096
ds_read_b128 v[80:83],v251 offset:8704
M v[172:175],a[140:143],a[104:107],v[172:175]
ds_read_b128 v[88:91],v251 offset:12800
ds_read_b128 a[156:159],v250 offset:2048
M v[172:175],a[160:163],a[144:147],v[172:175]
s_waitcnt lgkmcnt(8)
s_add_u32 s34,s33,6291456
buffer_store_dwordx4 v[32:35],v252,s[24:27],s34 offen offset:128 sc1
M v[176:179],a[160:163],a[104:107],v[176:179]
s_waitcnt lgkmcnt(7)
s_add_u32 s34,s33,6684672
buffer_store_dwordx4 v[40:43],v252,s[24:27],s34 offen offset:128 sc1
M v[176:179],a[140:143],a[164:167],v[176:179]
s_add_u32 s34,s33,7077888
ds_read_b128 a[132:135],v249 offset:2048
M v[176:179],a[116:119],a[112:115],v[176:179]
ds_read_b128 a[172:175],v249 offset:34816
M v[180:183],a[116:119],a[100:103],v[180:183]
s_waitcnt lgkmcnt(8)
buffer_store_dwordx4 v[48:51],v252,s[24:27],s34 offen offset:128 sc1
M v[180:183],a[140:143],a[112:115],v[180:183]
s_add_u32 s34,s33,7471104
ds_read_b128 a[176:179],v250 offset:34816
ds_read_b128 a[128:131],v249 offset:35328
M v[180:183],a[160:163],a[164:167],v[180:183]
ds_read_b128 a[136:139],v250 offset:35328
M v[184:187],a[160:163],a[112:115],v[184:187]
s_waitcnt lgkmcnt(10)
buffer_store_dwordx4 v[56:59],v252,s[24:27],s34 offen offset:128 sc1
M v[184:187],a[140:143],a[100:103],v[184:187]
s_waitcnt lgkmcnt(5)
M v[184:187],a[116:119],a[156:159],v[184:187]
s_waitcnt lgkmcnt(4)
M v[188:191],a[116:119],a[132:135],v[188:191]
M v[188:191],a[140:143],a[156:159],v[188:191]
ds_read_b128 a[168:171],v249 offset:35840
M v[188:191],a[160:163],a[100:103],v[188:191]
s_waitcnt vmcnt(20) lgkmcnt(4)
ds_read_b128 a[108:111],v250 offset:35840
M v[160:163],a[184:187],a[172:175],v[160:163]
s_waitcnt vmcnt(19) lgkmcnt(4)
M v[160:163],a[212:215],a[176:179],v[160:163]
s_waitcnt vmcnt(18) lgkmcnt(3)
s_add_u32 s34,s33,6291456
buffer_store_dwordx4 v[64:67],v252,s[24:27],s34 offen offset:256 sc1
M v[160:163],a[208:211],a[128:131],v[160:163]
s_waitcnt lgkmcnt(2)
M v[164:167],a[208:211],a[136:139],v[164:167]
M v[164:167],a[212:215],a[128:131],v[164:167]
ds_read_b128 a[144:147],v249 offset:36352
M v[164:167],a[184:187],a[176:179],v[164:167]
ds_read_b128 a[104:107],v250 offset:36352
M v[168:171],a[184:187],a[128:131],v[168:171]
M v[168:171],a[212:215],a[136:139],v[168:171]
s_waitcnt lgkmcnt(3)
M v[168:171],a[208:211],a[168:171],v[168:171]
s_waitcnt lgkmcnt(2)
M v[172:175],a[208:211],a[108:111],v[172:175]
M v[172:175],a[212:215],a[168:171],v[172:175]
ds_read_b128 a[164:167],v250 offset:36864
M v[172:175],a[184:187],a[136:139],v[172:175]
ds_read_b128 a[112:115],v249 offset:36864
M v[176:179],a[184:187],a[168:171],v[176:179]
M v[176:179],a[212:215],a[108:111],v[176:179]
s_waitcnt lgkmcnt(3)
M v[176:179],a[208:211],a[144:147],v[176:179]
s_waitcnt lgkmcnt(2)
ds_read_b128 a[116:119],v249 offset:52224
M v[180:183],a[208:211],a[104:107],v[180:183]
ds_read_b128 a[132:135],v250 offset:52224
M v[180:183],a[212:215],a[144:147],v[180:183]
ds_read_b128 a[140:143],v249 offset:52736
M v[180:183],a[184:187],a[108:111],v[180:183]
ds_read_b128 a[156:159],v250 offset:52736
M v[184:187],a[184:187],a[144:147],v[184:187]
M v[184:187],a[212:215],a[104:107],v[184:187]
s_waitcnt lgkmcnt(5)
M v[184:187],a[208:211],a[164:167],v[184:187]
s_waitcnt lgkmcnt(4)
M v[188:191],a[208:211],a[112:115],v[188:191]
M v[188:191],a[212:215],a[164:167],v[188:191]
ds_read_b128 a[100:103],v249 offset:53248
M v[188:191],a[184:187],a[104:107],v[188:191]
s_waitcnt vmcnt(17) lgkmcnt(4)
s_add_u32 s34,s33,6684672
buffer_store_dwordx4 v[72:75],v252,s[24:27],s34 offen offset:256 sc1
M v[160:163],a[120:123],a[116:119],v[160:163]
s_waitcnt vmcnt(17) lgkmcnt(3)
ds_read_b128 a[160:163],v250 offset:53248
M v[160:163],a[124:127],a[132:135],v[160:163]
s_waitcnt vmcnt(16) lgkmcnt(3)
M v[160:163],a[152:155],a[140:143],v[160:163]
s_waitcnt lgkmcnt(2)
M v[164:167],a[152:155],a[156:159],v[164:167]
M v[164:167],a[124:127],a[140:143],v[164:167]
ds_read_b128 a[172:175],v249 offset:53760
M v[164:167],a[120:123],a[132:135],v[164:167]
ds_read_b128 a[176:179],v250 offset:53760
M v[168:171],a[120:123],a[140:143],v[168:171]
M v[168:171],a[124:127],a[156:159],v[168:171]
s_waitcnt lgkmcnt(3)
M v[168:171],a[152:155],a[100:103],v[168:171]
s_waitcnt lgkmcnt(2)
M v[172:175],a[152:155],a[160:163],v[172:175]
M v[172:175],a[124:127],a[100:103],v[172:175]
ds_read_b128 a[128:131],v250 offset:54272
M v[172:175],a[120:123],a[156:159],v[172:175]
ds_read_b128 a[136:139],v249 offset:54272
v_add_u32 v249,0x11000,v249
M v[176:179],a[120:123],a[100:103],v[176:179]
v_add_u32 v250,0x11000,v250
M v[176:179],a[124:127],a[160:163],v[176:179]
s_waitcnt lgkmcnt(3)
M v[176:179],a[152:155],a[172:175],v[176:179]
s_waitcnt lgkmcnt(2)
ds_read_b128 a[168:171],v249 offset:0
M v[180:183],a[152:155],a[176:179],v[180:183]
ds_read_b128 a[108:111],v250 offset:0
M v[180:183],a[124:127],a[172:175],v[180:183]
ds_read_b128 a[144:147],v249 offset:512
M v[180:183],a[120:123],a[160:163],v[180:183]
ds_read_b128 a[112:115],v250 offset:512
M v[184:187],a[120:123],a[172:175],v[184:187]
M v[184:187],a[124:127],a[176:179],v[184:187]
s_waitcnt lgkmcnt(5)
M v[184:187],a[152:155],a[128:131],v[184:187]
s_waitcnt lgkmcnt(4)
M v[188:191],a[152:155],a[136:139],v[188:191]
s_add_u32 s34,s33,7077888
buffer_store_dwordx4 v[80:83],v252,s[24:27],s34 offen offset:256 sc1
M v[188:191],a[124:127],a[128:131],v[188:191]
ds_read_b128 a[164:167],v249 offset:1024
M v[188:191],a[120:123],a[176:179],v[188:191]
s_waitcnt vmcnt(15) lgkmcnt(4)
ds_read_b128 a[104:107],v250 offset:1024
M v[160:163],a[224:227],a[168:171],v[160:163]
s_waitcnt vmcnt(14) lgkmcnt(4)
M v[160:163],a[216:219],a[108:111],v[160:163]
s_waitcnt vmcnt(13) lgkmcnt(3)
M v[160:163],v[228:231],a[144:147],v[160:163]
s_waitcnt lgkmcnt(2)
M v[164:167],v[228:231],a[112:115],v[164:167]
M v[164:167],a[216:219],a[144:147],v[164:167]
ds_read_b128 a[184:187],v249 offset:1536
M v[164:167],a[224:227],a[108:111],v[164:167]
ds_read_b128 a[116:119],v250 offset:1536
M v[168:171],a[224:227],a[144:147],v[168:171]
M v[168:171],a[216:219],a[112:115],v[168:171]
s_waitcnt lgkmcnt(3)
M v[168:171],v[228:231],a[164:167],v[168:171]
s_waitcnt lgkmcnt(2)
M v[172:175],v[228:231],a[104:107],v[172:175]
M v[172:175],a[216:219],a[164:167],v[172:175]
ds_read_b128 a[132:135],v250 offset:2048
M v[172:175],a[224:227],a[112:115],v[172:175]
ds_read_b128 a[140:143],v249 offset:2048
M v[176:179],a[224:227],a[164:167],v[176:179]
M v[176:179],a[216:219],a[104:107],v[176:179]
s_waitcnt lgkmcnt(3)
M v[176:179],v[228:231],a[184:187],v[176:179]
s_waitcnt lgkmcnt(2)
ds_read_b128 a[156:159],v249 offset:17408
M v[180:183],v[228:231],a[116:119],v[180:183]
ds_read_b128 a[100:103],v250 offset:17408
M v[180:183],a[216:219],a[184:187],v[180:183]
ds_read_b128 a[160:163],v249 offset:17920
M v[180:183],a[224:227],a[104:107],v[180:183]
ds_read_b128 a[172:175],v250 offset:17920
M v[184:187],a[224:227],a[184:187],v[184:187]
M v[184:187],a[216:219],a[116:119],v[184:187]
s_waitcnt lgkmcnt(5)
s_add_u32 s34,s33,7471104
buffer_store_dwordx4 v[88:91],v252,s[24:27],s34 offen offset:256 sc1
M v[184:187],v[228:231],a[132:135],v[184:187]
s_waitcnt lgkmcnt(4)
M v[188:191],v[228:231],a[140:143],v[188:191]
M v[188:191],a[216:219],a[132:135],v[188:191]
ds_read_b128 a[136:139],v249 offset:18432
M v[188:191],a[224:227],a[116:119],v[188:191]
s_waitcnt vmcnt(13) lgkmcnt(4)
ds_read_b128 a[152:155],v250 offset:18432
M v[160:163],a[148:151],a[156:159],v[160:163]
s_waitcnt vmcnt(12) lgkmcnt(4)
M v[160:163],a[96:99],a[100:103],v[160:163]
s_waitcnt vmcnt(11) lgkmcnt(3)
M v[160:163],a[180:183],a[160:163],v[160:163]
s_waitcnt lgkmcnt(2)
M v[164:167],a[180:183],a[172:175],v[164:167]
M v[164:167],a[96:99],a[160:163],v[164:167]
ds_read_b128 a[124:127],v249 offset:18944
M v[164:167],a[148:151],a[100:103],v[164:167]
ds_read_b128 a[128:131],v250 offset:18944
M v[168:171],a[148:151],a[160:163],v[168:171]
M v[168:171],a[96:99],a[172:175],v[168:171]
s_waitcnt lgkmcnt(3)
M v[168:171],a[180:183],a[136:139],v[168:171]
s_waitcnt lgkmcnt(2)
M v[172:175],a[180:183],a[152:155],v[172:175]
M v[172:175],a[96:99],a[136:139],v[172:175]
ds_read_b128 a[120:123],v250 offset:19456
M v[172:175],a[148:151],a[172:175],v[172:175]
ds_read_b128 a[176:179],v249 offset:19456
v_add_u32 v249,0xffff3400,v249
M v[176:179],a[148:151],a[136:139],v[176:179]
v_add_u32 v250,0xffff3400,v250
M v[176:179],a[96:99],a[152:155],v[176:179]
s_waitcnt lgkmcnt(3)
M v[176:179],a[180:183],a[124:127],v[176:179]
s_waitcnt lgkmcnt(2)
ds_read_b128 a[168:171],v249 offset:0
M v[180:183],a[180:183],a[128:131],v[180:183]
ds_read_b128 a[108:111],v250 offset:0
M v[180:183],a[96:99],a[124:127],v[180:183]
ds_read_b128 a[144:147],v249 offset:512
M v[180:183],a[148:151],a[152:155],v[180:183]
ds_read_b128 a[112:115],v250 offset:512
M v[184:187],a[148:151],a[124:127],v[184:187]
M v[184:187],a[96:99],a[128:131],v[184:187]
s_waitcnt lgkmcnt(5)
M v[184:187],a[180:183],a[120:123],v[184:187]
s_waitcnt lgkmcnt(4)
M v[188:191],a[180:183],a[176:179],v[188:191]
M v[188:191],a[96:99],a[120:123],v[188:191]
ds_read_b128 a[164:167],v249 offset:1024
M v[188:191],a[148:151],a[128:131],v[188:191]
s_waitcnt vmcnt(10) lgkmcnt(4)
ds_read_b128 a[104:107],v250 offset:1024
M v[160:163],a[188:191],a[168:171],v[160:163]
s_waitcnt vmcnt(9) lgkmcnt(4)
M v[160:163],a[200:203],a[108:111],v[160:163]
s_waitcnt vmcnt(8) lgkmcnt(3)
M v[160:163],a[244:247],a[144:147],v[160:163]
s_waitcnt lgkmcnt(2)
M v[164:167],a[244:247],a[112:115],v[164:167]
M v[164:167],a[200:203],a[144:147],v[164:167]
ds_read_b128 a[184:187],v249 offset:1536
M v[164:167],a[188:191],a[108:111],v[164:167]
ds_read_b128 a[140:143],v250 offset:1536
s_nop 1
v_cvt_pk_bf16_f32 v160,v160,v161
M v[168:171],a[188:191],a[144:147],v[168:171]
v_cvt_pk_bf16_f32 v161,v162,v163
M v[168:171],a[200:203],a[112:115],v[168:171]
s_waitcnt lgkmcnt(3)
M v[168:171],a[244:247],a[164:167],v[168:171]
s_waitcnt lgkmcnt(2)
v_cvt_pk_bf16_f32 v164,v164,v165
v_cvt_pk_bf16_f32 v165,v166,v167
M v[172:175],a[244:247],a[104:107],v[172:175]
ds_write2st64_b64 v253,v[160:161],v[164:165] offset0:68 offset1:72
M v[172:175],a[200:203],a[164:167],v[172:175]
ds_read_b128 a[132:135],v250 offset:2048
M v[172:175],a[188:191],a[112:115],v[172:175]
ds_read_b128 a[116:119],v249 offset:2048
v_cvt_pk_bf16_f32 v168,v168,v169
M v[176:179],a[188:191],a[164:167],v[176:179]
v_cvt_pk_bf16_f32 v169,v170,v171
M v[176:179],a[200:203],a[104:107],v[176:179]
s_waitcnt lgkmcnt(4)
M v[176:179],a[244:247],a[184:187],v[176:179]
s_waitcnt lgkmcnt(3)
v_cvt_pk_bf16_f32 v172,v172,v173
v_cvt_pk_bf16_f32 v173,v174,v175
M v[180:183],a[244:247],a[140:143],v[180:183]
ds_write2st64_b64 v253,v[168:169],v[172:173] offset0:76 offset1:80
M v[180:183],a[200:203],a[184:187],v[180:183]
M v[180:183],a[188:191],a[104:107],v[180:183]
s_nop 0
v_cvt_pk_bf16_f32 v176,v176,v177
v_cvt_pk_bf16_f32 v177,v178,v179
M v[184:187],a[188:191],a[184:187],v[184:187]
M v[184:187],a[200:203],a[140:143],v[184:187]
s_waitcnt lgkmcnt(2)
M v[184:187],a[244:247],a[132:135],v[184:187]
s_waitcnt lgkmcnt(1)
v_cvt_pk_bf16_f32 v180,v180,v181
v_cvt_pk_bf16_f32 v181,v182,v183
M v[188:191],a[244:247],a[116:119],v[188:191]
ds_write2st64_b64 v253,v[176:177],v[180:181] offset0:85 offset1:89
M v[188:191],a[200:203],a[132:135],v[188:191]
M v[188:191],a[188:191],a[140:143],v[188:191]
s_nop 0
v_cvt_pk_bf16_f32 v184,v184,v185
v_cvt_pk_bf16_f32 v185,v186,v187
s_nop 4
v_cvt_pk_bf16_f32 v188,v188,v189
v_cvt_pk_bf16_f32 v189,v190,v191
ds_write2st64_b64 v253,v[184:185],v[188:189] offset0:93 offset1:97
s_waitcnt lgkmcnt(0)
s_barrier
ds_read_b128 v[160:163],v251 offset:34816
ds_read_b128 v[168:171],v251 offset:38912
ds_read_b128 v[176:179],v251 offset:43520
ds_read_b128 v[184:187],v251 offset:47616
s_add_u32 s34,s33,6291456
s_waitcnt lgkmcnt(3)
buffer_store_dwordx4 v[160:163],v252,s[24:27],s34 offen offset:1408 sc1
s_add_u32 s34,s33,6684672
s_waitcnt lgkmcnt(2)
buffer_store_dwordx4 v[168:171],v252,s[24:27],s34 offen offset:1408 sc1
s_add_u32 s34,s33,7077888
s_waitcnt lgkmcnt(1)
buffer_store_dwordx4 v[176:179],v252,s[24:27],s34 offen offset:1408 sc1
s_add_u32 s34,s33,7471104
s_waitcnt lgkmcnt(0)
buffer_store_dwordx4 v[184:187],v252,s[24:27],s34 offen offset:1408 sc1
s_endpgm
L_code_end:
L_fallback:
s_mov_b32 s84,0
L_itemF:
s_and_b32 s85,s84,3
s_lshr_b32 s86,s84,2
s_mul_hi_u32 s87,s86,0x55555556
s_mul_i32 s88,s87,3
s_sub_u32 s86,s86,s88
s_mul_hi_u32 s88,s87,0x2aaaaaab
s_mul_i32 s89,s88,6
s_sub_u32 s87,s87,s89
s_mul_i32 s89,s86,221184
s_mul_i32 s90,s87,12288
s_add_u32 s89,s89,s90
s_mul_i32 s90,s85,3072
s_add_u32 s89,s89,s90
s_lshl_b32 s90,s88,7
s_add_u32 s89,s89,s90
s_add_u32 s90,s89,73728
s_add_u32 s91,s90,73728
v_lshlrev_b32 v149,1,v164
buffer_load_short_d16_hi v68,v149,s[36:39],s89 offen offset:0
buffer_load_short_d16_hi v69,v149,s[36:39],s89 offen offset:384
buffer_load_short_d16_hi v70,v149,s[36:39],s89 offen offset:768
buffer_load_short_d16_hi v71,v149,s[36:39],s89 offen offset:1152
buffer_load_short_d16_hi v72,v149,s[36:39],s89 offen offset:1536
buffer_load_short_d16_hi v73,v149,s[36:39],s89 offen offset:1920
buffer_load_short_d16_hi v74,v149,s[36:39],s89 offen offset:2304
buffer_load_short_d16_hi v75,v149,s[36:39],s89 offen offset:2688
buffer_load_short_d16_hi v76,v149,s[36:39],s90 offen offset:0
buffer_load_short_d16_hi v77,v149,s[36:39],s90 offen offset:384
buffer_load_short_d16_hi v78,v149,s[36:39],s90 offen offset:768
buffer_load_short_d16_hi v79,v149,s[36:39],s90 offen offset:1152
buffer_load_short_d16_hi v80,v149,s[36:39],s90 offen offset:1536
buffer_load_short_d16_hi v81,v149,s[36:39],s90 offen offset:1920
buffer_load_short_d16_hi v82,v149,s[36:39],s90 offen offset:2304
buffer_load_short_d16_hi v83,v149,s[36:39],s90 offen offset:2688
buffer_load_short_d16_hi v84,v149,s[36:39],s91 offen offset:0
buffer_load_short_d16_hi v85,v149,s[36:39],s91 offen offset:384
buffer_load_short_d16_hi v86,v149,s[36:39],s91 offen offset:768
buffer_load_short_d16_hi v87,v149,s[36:39],s91 offen offset:1152
buffer_load_short_d16_hi v88,v149,s[36:39],s91 offen offset:1536
buffer_load_short_d16_hi v89,v149,s[36:39],s91 offen offset:1920
buffer_load_short_d16_hi v90,v149,s[36:39],s91 offen offset:2304
buffer_load_short_d16_hi v91,v149,s[36:39],s91 offen offset:2688
v_lshrrev_b32 v150,4,v164
v_mul_u32_u24 v150,331776,v150
v_and_b32 v148,15,v164
v_lshl_add_u32 v150,v148,4,v150
s_mul_i32 s87,s87,55296
s_mul_i32 s88,s88,3072
s_add_u32 s87,s87,s88
s_lshl_b32 s86,s86,10
s_add_u32 s87,s87,s86
s_lshl_b32 s85,s85,8
s_add_u32 s87,s87,s85
s_mov_b32 s85,0xbe2aaaab
s_mov_b32 s86,0x3d2aaaab
s_mov_b32 s88,0x3e2aaaab
s_mov_b32 s92,0x3daaaaab
s_waitcnt vmcnt(0)
v_add_f32 v148,v68,v84
v_add_f32 v92,v148,v76
v_sub_f32 v100,v148,v76
v_mul_f32 v92,s85,v92
v_mul_f32 v100,s85,v100
v_mul_f32 v148,s86,v68
v_fmac_f32 v148,s88,v84
v_fma_f32 v108,s92,v76,v148
v_fma_f32 v116,-s92,v76,v148
v_add_f32 v148,v69,v85
v_add_f32 v93,v148,v77
v_sub_f32 v101,v148,v77
v_mul_f32 v93,s85,v93
v_mul_f32 v101,s85,v101
v_mul_f32 v148,s86,v69
v_fmac_f32 v148,s88,v85
v_fma_f32 v109,s92,v77,v148
v_fma_f32 v117,-s92,v77,v148
v_add_f32 v148,v70,v86
v_add_f32 v94,v148,v78
v_sub_f32 v102,v148,v78
v_mul_f32 v94,s85,v94
v_mul_f32 v102,s85,v102
v_mul_f32 v148,s86,v70
v_fmac_f32 v148,s88,v86
v_fma_f32 v110,s92,v78,v148
v_fma_f32 v118,-s92,v78,v148
v_add_f32 v148,v71,v87
v_add_f32 v95,v148,v79
v_sub_f32 v103,v148,v79
v_mul_f32 v95,s85,v95
v_mul_f32 v103,s85,v103
v_mul_f32 v148,s86,v71
v_fmac_f32 v148,s88,v87
v_fma_f32 v111,s92,v79,v148
v_fma_f32 v119,-s92,v79,v148
v_add_f32 v148,v72,v88
v_add_f32 v96,v148,v80
v_sub_f32 v104,v148,v80
v_mul_f32 v96,s85,v96
v_mul_f32 v104,s85,v104
v_mul_f32 v148,s86,v72
v_fmac_f32 v148,s88,v88
v_fma_f32 v112,s92,v80,v148
v_fma_f32 v120,-s92,v80,v148
v_add_f32 v148,v73,v89
v_add_f32 v97,v148,v81
v_sub_f32 v105,v148,v81
v_mul_f32 v97,s85,v97
v_mul_f32 v105,s85,v105
v_mul_f32 v148,s86,v73
v_fmac_f32 v148,s88,v89
v_fma_f32 v113,s92,v81,v148
v_fma_f32 v121,-s92,v81,v148
v_add_f32 v148,v74,v90
v_add_f32 v98,v148,v82
v_sub_f32 v106,v148,v82
v_mul_f32 v98,s85,v98
v_mul_f32 v106,s85,v106
v_mul_f32 v148,s86,v74
v_fmac_f32 v148,s88,v90
v_fma_f32 v114,s92,v82,v148
v_fma_f32 v122,-s92,v82,v148
v_add_f32 v148,v75,v91
v_add_f32 v99,v148,v83
v_sub_f32 v107,v148,v83
v_mul_f32 v99,s85,v99
v_mul_f32 v107,s85,v107
v_mul_f32 v148,s86,v75
v_fmac_f32 v148,s88,v91
v_fma_f32 v115,s92,v83,v148
v_fma_f32 v123,-s92,v83,v148
v_cvt_pk_bf16_f32 v124,v68,v69
v_cvt_pk_bf16_f32 v125,v70,v71
v_cvt_pk_bf16_f32 v126,v72,v73
v_cvt_pk_bf16_f32 v127,v74,v75
s_add_u32 s89,s87,0
buffer_store_dwordx4 v[124:127],v150,s[20:23],s89 offen sc1
v_cvt_pk_bf16_f32 v144,v84,v85
v_cvt_pk_bf16_f32 v145,v86,v87
v_cvt_pk_bf16_f32 v146,v88,v89
v_cvt_pk_bf16_f32 v147,v90,v91
s_add_u32 s89,s87,46080
buffer_store_dwordx4 v[144:147],v150,s[20:23],s89 offen sc1
v_cvt_pk_bf16_f32 v128,v92,v93
v_cvt_pk_bf16_f32 v129,v94,v95
v_cvt_pk_bf16_f32 v130,v96,v97
v_cvt_pk_bf16_f32 v131,v98,v99
s_add_u32 s89,s87,9216
buffer_store_dwordx4 v[128:131],v150,s[20:23],s89 offen sc1
v_cvt_pk_bf16_f32 v132,v100,v101
v_cvt_pk_bf16_f32 v133,v102,v103
v_cvt_pk_bf16_f32 v134,v104,v105
v_cvt_pk_bf16_f32 v135,v106,v107
s_add_u32 s89,s87,18432
buffer_store_dwordx4 v[132:135],v150,s[20:23],s89 offen sc1
v_cvt_pk_bf16_f32 v136,v108,v109
v_cvt_pk_bf16_f32 v137,v110,v111
v_cvt_pk_bf16_f32 v138,v112,v113
v_cvt_pk_bf16_f32 v139,v114,v115
s_add_u32 s89,s87,27648
buffer_store_dwordx4 v[136:139],v150,s[20:23],s89 offen sc1
v_cvt_pk_bf16_f32 v140,v116,v117
v_cvt_pk_bf16_f32 v141,v118,v119
v_cvt_pk_bf16_f32 v142,v120,v121
v_cvt_pk_bf16_f32 v143,v122,v123
s_add_u32 s89,s87,36864
buffer_store_dwordx4 v[140:143],v150,s[20:23],s89 offen sc1
s_waitcnt vmcnt(0)
s_add_u32 s84,s84,1
s_cmp_lt_u32 s84,216
s_cbranch_scc1 L_itemF
s_branch L_uready
.section .rodata,"a"
.p2align 6
.amdhsa_kernel standalone__winograd__vision_kernel
  .amdhsa_next_free_vgpr 512
  .amdhsa_next_free_sgpr 96
  .amdhsa_accum_offset 256
  .amdhsa_group_segment_fixed_size 0
  .amdhsa_kernarg_size 40
  .amdhsa_user_sgpr_count 2
  .amdhsa_user_sgpr_kernarg_segment_ptr 1
  .amdhsa_system_sgpr_workgroup_id_x 1
  .amdhsa_float_denorm_mode_32 3
.end_amdhsa_kernel
```

```asm
; @launch grid=(256,1,1) block=(256,1,1) lds=156672
.amdgcn_target "amdgcn-amd-amdhsa--gfx950"
.macro M d,a,b,c
v_mfma_f32_16x16x32_bf16 \d,\a,\b,\c
.endm
.text
.globl standalone__winograd__vision_kernel
.p2align 8
.type standalone__winograd__vision_kernel,@function
standalone__winograd__vision_kernel:
s_cmp_ge_u32 s2,256
s_cbranch_scc0 L_go
s_endpgm
L_go:
s_load_dwordx4 s[4:7],s[0:1],0
s_load_dwordx4 s[24:27],s[0:1],16
s_load_dwordx2 s[20:21],s[0:1],32
v_lshrrev_b32 v160,6,v0
v_and_b32 v164,63,v0
v_readfirstlane_b32 s50,v160
v_bfe_u32 v160,v164,3,2
v_bfe_u32 v161,v164,2,1
v_lshl_add_u32 v161,v160,3,v161
v_lshrrev_b32 v162,5,v164
v_xor_b32 v162,v162,v160
v_and_b32 v162,1,v162
v_and_b32 v163,3,v164
v_lshl_add_u32 v162,v162,2,v163
v_mul_u32_u24 v245,196608,v161
v_lshl_add_u32 v245,v162,3,v245
s_and_b32 s54,s2,7
s_lshr_b32 s55,s2,3
s_lshl_b32 s49,s54,6
s_lshl_b32 s55,s55,4
s_lshl_b32 s56,s50,2
s_add_u32 s56,s56,s55
s_mul_i32 s30,s56,384
s_mul_i32 s57,s49,196608
s_add_u32 s30,s30,s57
s_mul_i32 s44,s50,330752
s_mov_b32 s58,0
s_add_u32 s59,s58,0
s_lshl_b32 s84,s59,6
s_add_u32 s66,s30,s84
s_mul_i32 s84,s59,55296
s_add_u32 s72,s44,s84
s_add_u32 s59,s58,1
s_lshl_b32 s84,s59,6
s_add_u32 s67,s30,s84
s_mul_i32 s84,s59,55296
s_add_u32 s73,s44,s84
s_add_u32 s59,s58,2
s_lshl_b32 s84,s59,6
s_add_u32 s68,s30,s84
s_mul_i32 s84,s59,55296
s_add_u32 s74,s44,s84
s_add_u32 s59,s58,3
s_lshl_b32 s84,s59,6
s_add_u32 s69,s30,s84
s_mul_i32 s84,s59,55296
s_add_u32 s75,s44,s84
s_add_u32 s59,s58,4
s_lshl_b32 s84,s59,6
s_add_u32 s70,s30,s84
s_mul_i32 s84,s59,55296
s_add_u32 s76,s44,s84
s_add_u32 s59,s58,5
s_cmp_eq_u32 s59,6
s_cselect_b32 s59,0,s59
s_lshl_b32 s84,s59,6
s_add_u32 s71,s30,s84
s_mul_i32 s84,s59,55296
s_add_u32 s77,s44,s84
s_cmp_eq_u32 s49,0
s_cselect_b32 s58,1,0
v_cmp_gt_u32 vcc,s58,v161
v_lshrrev_b32 v163,5,v164
v_add_u32 v163,32,v163
v_mul_u32_u24 v246,196608,v163
v_bfrev_b32 v163,1
v_cndmask_b32 v251,v245,v163,vcc
v_lshl_add_u32 v168,v162,3,v245
v_cndmask_b32 v169,v168,v163,vcc
v_and_b32 v163,31,v164
v_lshlrev_b32 v163,1,v163
v_lshl_add_u32 v170,v163,1,v246
v_add_u32 v246,v246,v163
v_mov_b32 v166,1
s_mov_b32 s38,663552
s_mov_b32 s39,0x20000
s_mov_b32 s62,0
s_mov_b32 s63,0x20000
s_mov_b32 s22,1327104
s_mov_b32 s23,0x20000
s_waitcnt lgkmcnt(0)
s_and_b32 s21,s21,0xffff
s_mov_b32 s36,s6
s_and_b32 s37,s7,0xffff
s_mov_b32 s60,s26
s_and_b32 s61,s27,0xffff
s_mov_b32 s52,s26
s_mov_b32 s53,s27
s_cmp_lt_u32 s2,54
s_cbranch_scc0 L_noitem
s_lshl_b32 s84,s2,2
s_add_u32 s84,s84,s50
L_itemP:
s_and_b32 s85,s84,3
s_lshr_b32 s86,s84,2
s_mul_hi_u32 s87,s86,0x55555556
s_mul_i32 s88,s87,3
s_sub_u32 s86,s86,s88
s_mul_hi_u32 s88,s87,0x2aaaaaab
s_mul_i32 s89,s88,6
s_sub_u32 s87,s87,s89
s_mul_i32 s89,s86,221184
s_mul_i32 s90,s87,12288
s_add_u32 s89,s89,s90
s_mul_i32 s90,s85,3072
s_add_u32 s89,s89,s90
s_lshl_b32 s90,s88,7
s_add_u32 s89,s89,s90
s_add_u32 s90,s89,73728
s_add_u32 s91,s90,73728
v_lshlrev_b32 v149,1,v164
buffer_load_short_d16_hi v68,v149,s[36:39],s89 offen offset:0
buffer_load_short_d16_hi v69,v149,s[36:39],s89 offen offset:384
buffer_load_short_d16_hi v70,v149,s[36:39],s89 offen offset:768
buffer_load_short_d16_hi v71,v149,s[36:39],s89 offen offset:1152
buffer_load_short_d16_hi v72,v149,s[36:39],s89 offen offset:1536
buffer_load_short_d16_hi v73,v149,s[36:39],s89 offen offset:1920
buffer_load_short_d16_hi v74,v149,s[36:39],s89 offen offset:2304
buffer_load_short_d16_hi v75,v149,s[36:39],s89 offen offset:2688
buffer_load_short_d16_hi v76,v149,s[36:39],s90 offen offset:0
buffer_load_short_d16_hi v77,v149,s[36:39],s90 offen offset:384
buffer_load_short_d16_hi v78,v149,s[36:39],s90 offen offset:768
buffer_load_short_d16_hi v79,v149,s[36:39],s90 offen offset:1152
buffer_load_short_d16_hi v80,v149,s[36:39],s90 offen offset:1536
buffer_load_short_d16_hi v81,v149,s[36:39],s90 offen offset:1920
buffer_load_short_d16_hi v82,v149,s[36:39],s90 offen offset:2304
buffer_load_short_d16_hi v83,v149,s[36:39],s90 offen offset:2688
buffer_load_short_d16_hi v84,v149,s[36:39],s91 offen offset:0
buffer_load_short_d16_hi v85,v149,s[36:39],s91 offen offset:384
buffer_load_short_d16_hi v86,v149,s[36:39],s91 offen offset:768
buffer_load_short_d16_hi v87,v149,s[36:39],s91 offen offset:1152
buffer_load_short_d16_hi v88,v149,s[36:39],s91 offen offset:1536
buffer_load_short_d16_hi v89,v149,s[36:39],s91 offen offset:1920
buffer_load_short_d16_hi v90,v149,s[36:39],s91 offen offset:2304
buffer_load_short_d16_hi v91,v149,s[36:39],s91 offen offset:2688
s_and_b32 s92,s85,1
s_lshl_b32 s92,s92,2
s_lshr_b32 s85,s85,1
s_lshl_b32 s85,s85,2
v_bfe_u32 v148,v164,2,2
v_or_b32 v148,s92,v148
v_and_b32 v151,3,v164
v_or_b32 v151,s85,v151
v_xor_b32 v151,v151,v148
v_lshrrev_b32 v150,4,v164
v_mul_u32_u24 v150,331776,v150
v_lshl_add_u32 v150,v148,7,v150
v_lshl_add_u32 v150,v151,4,v150
s_mul_i32 s87,s87,55296
s_mul_i32 s88,s88,3072
s_add_u32 s87,s87,s88
s_lshl_b32 s86,s86,10
s_add_u32 s87,s87,s86
s_mov_b32 s85,0xbe2aaaab
s_mov_b32 s86,0x3d2aaaab
s_mov_b32 s88,0x3e2aaaab
s_mov_b32 s92,0x3daaaaab
s_waitcnt vmcnt(0)
v_add_f32 v148,v68,v84
v_add_f32 v92,v148,v76
v_sub_f32 v100,v148,v76
v_mul_f32 v92,s85,v92
v_mul_f32 v100,s85,v100
v_mul_f32 v148,s86,v68
v_fmac_f32 v148,s88,v84
v_fma_f32 v108,s92,v76,v148
v_fma_f32 v116,-s92,v76,v148
v_add_f32 v148,v69,v85
v_add_f32 v93,v148,v77
v_sub_f32 v101,v148,v77
v_mul_f32 v93,s85,v93
v_mul_f32 v101,s85,v101
v_mul_f32 v148,s86,v69
v_fmac_f32 v148,s88,v85
v_fma_f32 v109,s92,v77,v148
v_fma_f32 v117,-s92,v77,v148
v_add_f32 v148,v70,v86
v_add_f32 v94,v148,v78
v_sub_f32 v102,v148,v78
v_mul_f32 v94,s85,v94
v_mul_f32 v102,s85,v102
v_mul_f32 v148,s86,v70
v_fmac_f32 v148,s88,v86
v_fma_f32 v110,s92,v78,v148
v_fma_f32 v118,-s92,v78,v148
v_add_f32 v148,v71,v87
v_add_f32 v95,v148,v79
v_sub_f32 v103,v148,v79
v_mul_f32 v95,s85,v95
v_mul_f32 v103,s85,v103
v_mul_f32 v148,s86,v71
v_fmac_f32 v148,s88,v87
v_fma_f32 v111,s92,v79,v148
v_fma_f32 v119,-s92,v79,v148
v_add_f32 v148,v72,v88
v_add_f32 v96,v148,v80
v_sub_f32 v104,v148,v80
v_mul_f32 v96,s85,v96
v_mul_f32 v104,s85,v104
v_mul_f32 v148,s86,v72
v_fmac_f32 v148,s88,v88
v_fma_f32 v112,s92,v80,v148
v_fma_f32 v120,-s92,v80,v148
v_add_f32 v148,v73,v89
v_add_f32 v97,v148,v81
v_sub_f32 v105,v148,v81
v_mul_f32 v97,s85,v97
v_mul_f32 v105,s85,v105
v_mul_f32 v148,s86,v73
v_fmac_f32 v148,s88,v89
v_fma_f32 v113,s92,v81,v148
v_fma_f32 v121,-s92,v81,v148
v_add_f32 v148,v74,v90
v_add_f32 v98,v148,v82
v_sub_f32 v106,v148,v82
v_mul_f32 v98,s85,v98
v_mul_f32 v106,s85,v106
v_mul_f32 v148,s86,v74
v_fmac_f32 v148,s88,v90
v_fma_f32 v114,s92,v82,v148
v_fma_f32 v122,-s92,v82,v148
v_add_f32 v148,v75,v91
v_add_f32 v99,v148,v83
v_sub_f32 v107,v148,v83
v_mul_f32 v99,s85,v99
v_mul_f32 v107,s85,v107
v_mul_f32 v148,s86,v75
v_fmac_f32 v148,s88,v91
v_fma_f32 v115,s92,v83,v148
v_fma_f32 v123,-s92,v83,v148
v_cvt_pk_bf16_f32 v124,v68,v69
v_cvt_pk_bf16_f32 v125,v70,v71
v_cvt_pk_bf16_f32 v126,v72,v73
v_cvt_pk_bf16_f32 v127,v74,v75
s_add_u32 s89,s87,0
buffer_store_dwordx4 v[124:127],v150,s[20:23],s89 offen sc1
v_cvt_pk_bf16_f32 v144,v84,v85
v_cvt_pk_bf16_f32 v145,v86,v87
v_cvt_pk_bf16_f32 v146,v88,v89
v_cvt_pk_bf16_f32 v147,v90,v91
s_add_u32 s89,s87,46080
buffer_store_dwordx4 v[144:147],v150,s[20:23],s89 offen sc1
v_cvt_pk_bf16_f32 v128,v92,v93
v_cvt_pk_bf16_f32 v129,v94,v95
v_cvt_pk_bf16_f32 v130,v96,v97
v_cvt_pk_bf16_f32 v131,v98,v99
s_add_u32 s89,s87,9216
buffer_store_dwordx4 v[128:131],v150,s[20:23],s89 offen sc1
v_cvt_pk_bf16_f32 v132,v100,v101
v_cvt_pk_bf16_f32 v133,v102,v103
v_cvt_pk_bf16_f32 v134,v104,v105
v_cvt_pk_bf16_f32 v135,v106,v107
s_add_u32 s89,s87,18432
buffer_store_dwordx4 v[132:135],v150,s[20:23],s89 offen sc1
v_cvt_pk_bf16_f32 v136,v108,v109
v_cvt_pk_bf16_f32 v137,v110,v111
v_cvt_pk_bf16_f32 v138,v112,v113
v_cvt_pk_bf16_f32 v139,v114,v115
s_add_u32 s89,s87,27648
buffer_store_dwordx4 v[136:139],v150,s[20:23],s89 offen sc1
v_cvt_pk_bf16_f32 v140,v116,v117
v_cvt_pk_bf16_f32 v141,v118,v119
v_cvt_pk_bf16_f32 v142,v120,v121
v_cvt_pk_bf16_f32 v143,v122,v123
s_add_u32 s89,s87,36864
buffer_store_dwordx4 v[140:143],v150,s[20:23],s89 offen sc1
s_waitcnt vmcnt(0)
s_barrier
s_cmp_eq_u32 s50,0
s_cselect_b32 s62,256,0
L_noitem:
s_and_b32 s84,s2,1
s_lshl_b32 s59,s84,6
s_lshl_b32 s84,s84,2
s_mov_b64 exec,1
buffer_atomic_add v166,off,s[60:63],s59 sc0 sc1
s_mov_b64 exec,-1
s_and_b32 s5,s5,0xffff
s_sub_u32 s8,s4,196608
s_subb_u32 s9,s5,0
s_mov_b32 s10,100859904
s_mov_b32 s11,0x20000
s_sub_u32 s12,s4,196992
s_subb_u32 s13,s5,0
s_cmp_eq_u32 s56,0
s_cselect_b32 s14,0,100860288
s_mov_b32 s15,0x20000
s_mov_b32 s16,s8
s_mov_b32 s17,s9
s_cmp_eq_u32 s56,508
s_cselect_b32 s18,0,100859904
s_mov_b32 s19,0x20000
s_add_u32 s28,s30,0
buffer_load_dwordx4 v[8:11],v169,s[8:11],s28 offen offset:384
buffer_load_dwordx4 v[0:3],v169,s[12:15],s28 offen offset:0
buffer_load_dwordx4 v[4:7],v169,s[8:11],s28 offen offset:0
buffer_load_dwordx4 v[20:23],v169,s[16:19],s28 offen offset:1536
buffer_load_dwordx4 v[16:19],v169,s[8:11],s28 offen offset:1152
buffer_load_dwordx4 v[12:15],v169,s[8:11],s28 offen offset:768
s_mov_b64 exec,1
s_waitcnt vmcnt(6)
v_cmp_eq_u32 vcc,26,v166
v_mov_b32 v165,1
s_nop 2
s_and_b64 exec,exec,vcc
s_cselect_b32 s62,s62,0
s_mov_b64 exec,1
buffer_store_dword v165,off,s[60:63],s84 offset:128 sc1
s_mov_b64 exec,-1
s_add_u32 s28,s30,393216
buffer_load_dwordx4 v[32:35],v168,s[8:11],s28 offen offset:384
buffer_load_dwordx4 v[24:27],v168,s[12:15],s28 offen offset:0
buffer_load_dwordx4 v[28:31],v168,s[8:11],s28 offen offset:0
buffer_load_dwordx4 v[44:47],v168,s[16:19],s28 offen offset:1536
buffer_load_dwordx4 v[40:43],v168,s[8:11],s28 offen offset:1152
buffer_load_dwordx4 v[36:39],v168,s[8:11],s28 offen offset:768
s_add_u32 s28,s30,786432
buffer_load_dwordx4 v[56:59],v168,s[8:11],s28 offen offset:384
buffer_load_dwordx4 v[48:51],v168,s[12:15],s28 offen offset:0
buffer_load_dwordx4 v[52:55],v168,s[8:11],s28 offen offset:0
buffer_load_dwordx4 v[68:71],v168,s[16:19],s28 offen offset:1536
buffer_load_dwordx4 v[64:67],v168,s[8:11],s28 offen offset:1152
buffer_load_dwordx4 v[60:63],v168,s[8:11],s28 offen offset:768
s_add_u32 s28,s30,1179648
buffer_load_dwordx4 v[80:83],v168,s[8:11],s28 offen offset:384
buffer_load_dwordx4 v[72:75],v168,s[12:15],s28 offen offset:0
buffer_load_dwordx4 v[76:79],v168,s[8:11],s28 offen offset:0
buffer_load_dwordx4 v[92:95],v168,s[16:19],s28 offen offset:1536
buffer_load_dwordx4 v[88:91],v168,s[8:11],s28 offen offset:1152
buffer_load_dwordx4 v[84:87],v168,s[8:11],s28 offen offset:768
buffer_load_dword v96,v170,s[12:15],s30 offen offset:0
buffer_load_dword v97,v170,s[8:11],s30 offen offset:0
buffer_load_dword v98,v170,s[8:11],s30 offen offset:384
buffer_load_dword v99,v170,s[8:11],s30 offen offset:768
buffer_load_dword v100,v170,s[8:11],s30 offen offset:1152
buffer_load_dword v101,v170,s[16:19],s30 offen offset:1536
v_bfe_u32 v165,v164,2,3
v_lshrrev_b32 v159,5,v164
v_and_b32 v163,3,v164
v_lshl_add_u32 v159,v159,2,v163
v_xor_b32 v163,v159,v165
v_lshlrev_b32 v163,4,v163
v_lshl_add_u32 v163,v165,7,v163
v_lshl_add_u32 v250,s50,10,v163
s_getpc_b64 s[64:65]
L_pc:
s_lshl_b32 s58,s55,8
s_min_u32 s58,s58,L_code_end-L_pc-4096
s_add_u32 s64,s64,s58
s_addc_u32 s65,s65,0
global_load_dword v167,v250,s[64:65]
s_and_b32 s25,s25,0xffff
s_mov_b32 s26,100663296
s_mov_b32 s27,0x20000
s_mov_b32 s41,0xc0a00000
s_mov_b32 s40,0x41000000
s_mov_b32 s42,0xffff0000
s_mov_b32 s43,0xbfa00000
s_mov_b32 s45,0x3e800000
s_mul_i32 s58,s55,384
s_add_u32 s58,s57,s58
s_lshr_b32 s59,s50,1
s_mul_i32 s32,s59,384
s_mul_i32 s33,s59,196608
s_add_u32 s32,s32,s58
s_add_u32 s33,s33,s58
s_lshl_b32 s58,s59,5
s_lshl_b32 s59,s50,7
v_lshlrev_b32 v247,11,v160
v_xor_b32 v163,v160,v161
v_and_b32 v163,1,v163
v_lshl_add_u32 v247,v163,6,v247
v_lshlrev_b32 v163,3,v162
v_xor_b32 v163,s58,v163
v_add3_u32 v247,v247,v163,s59
v_and_b32 v171,0xffffffc0,v247
v_and_b32 v163,3,v162
v_lshlrev_b32 v163,4,v163
v_xor_b32 v163,s58,v163
v_add_u32 v171,v171,v163
v_lshrrev_b32 v163,2,v162
v_mul_u32_u24 v163,17408,v163
v_mad_u32_u24 v172,v163,5,v171
v_lshl_add_u32 v171,v163,1,v171
v_and_b32 v163,15,v164
v_lshlrev_b32 v163,2,v163
v_xor_b32 v163,s58,v163
v_lshrrev_b32 v173,5,v164
v_lshl_add_u32 v173,v173,6,v163
v_add_u32 v173,s59,v173
v_add_u32 v173,8192,v173
v_bfe_u32 v163,v164,4,1
v_mul_u32_u24 v163,17408,v163
v_mad_u32_u24 v174,v163,5,v173
v_lshl_add_u32 v173,v163,1,v173
v_lshrrev_b32 v160,5,v164
v_lshlrev_b32 v160,6,v160
v_and_b32 v161,63,v246
v_xor_b32 v161,s58,v161
v_add3_u32 v252,v160,v161,s59
v_add_u32 v252,8192,v252
v_bfe_u32 v160,v164,2,2
v_and_b32 v161,3,v164
v_lshrrev_b32 v162,4,v164
v_lshlrev_b32 v248,11,v160
v_lshl_add_u32 v248,v161,7,v248
v_and_b32 v163,1,v160
v_lshl_add_u32 v248,v163,6,v248
v_and_b32 v163,2,v161
v_xor_b32 v163,v163,v162
v_lshl_add_u32 v248,v163,4,v248
v_xor_b32 v249,64,v248
v_lshrrev_b32 v160,1,v162
v_lshl_add_u32 v160,s50,1,v160
v_and_b32 v161,7,v164
v_xor_b32 v160,v160,v161
v_and_b32 v163,15,v164
v_lshlrev_b32 v254,7,v163
v_lshl_add_u32 v254,v160,4,v254
v_and_b32 v163,1,v162
v_lshl_add_u32 v254,v163,3,v254
v_bfe_u32 v160,v250,7,4
v_lshrrev_b32 v162,2,v160
v_mul_u32_u24 v253,1572864,v162
v_and_b32 v162,3,v160
v_mul_u32_u24 v162,1536,v162
v_lshl_add_u32 v160,v159,4,v162
v_add_u32 v253,v253,v160
s_waitcnt vmcnt(31)
v_lshlrev_b32 v180,16,v8
v_and_b32 v181,s42,v8
s_waitcnt vmcnt(30)
v_lshlrev_b32 v176,16,v0
v_and_b32 v177,s42,v0
s_waitcnt vmcnt(29)
v_lshlrev_b32 v178,16,v4
v_and_b32 v179,s42,v4
s_waitcnt vmcnt(28)
v_lshlrev_b32 v186,16,v20
v_and_b32 v187,s42,v20
s_waitcnt vmcnt(27)
v_lshlrev_b32 v184,16,v16
v_and_b32 v185,s42,v16
s_waitcnt vmcnt(26)
v_lshlrev_b32 v182,16,v12
v_and_b32 v183,s42,v12
v_pk_fma_f32 v[176:177],v[180:181],s[42:43],v[176:177] op_sel:[0,1,0] op_sel_hi:[1,1,1]
v_pk_fma_f32 v[186:187],v[178:179],4.0,v[186:187] op_sel_hi:[1,0,1]
v_pk_fma_f32 v[188:189],v[180:181],-4.0,v[184:185] op_sel_hi:[1,0,1]
v_pk_fma_f32 v[176:177],v[184:185],s[44:45],v[176:177] op_sel:[0,1,0] op_sel_hi:[1,1,1]
v_pk_fma_f32 v[186:187],v[182:183],s[40:41],v[186:187] op_sel:[0,1,0] op_sel_hi:[1,1,1]
v_pk_add_f32 v[184:185],v[184:185],v[180:181] neg_lo:[0,1] neg_hi:[0,1]
v_pk_fma_f32 v[180:181],v[178:179],-4.0,v[182:183] op_sel_hi:[1,0,1]
v_pk_add_f32 v[182:183],v[182:183],v[178:179] neg_lo:[0,1] neg_hi:[0,1]
v_pk_add_f32 v[178:179],v[188:189],v[180:181]
v_pk_add_f32 v[188:189],v[188:189],v[180:181] neg_lo:[0,1] neg_hi:[0,1]
v_pk_fma_f32 v[180:181],v[182:183],2.0,v[184:185] op_sel_hi:[1,0,1]
v_pk_fma_f32 v[184:185],v[182:183],-2.0,v[184:185] op_sel_hi:[1,0,1]
v_cvt_pk_bf16_f32 v0,v176,v177
v_cvt_pk_bf16_f32 v4,v178,v179
v_cvt_pk_bf16_f32 v8,v188,v189
v_cvt_pk_bf16_f32 v12,v180,v181
v_cvt_pk_bf16_f32 v16,v184,v185
v_cvt_pk_bf16_f32 v20,v186,v187
v_lshlrev_b32 v180,16,v9
v_and_b32 v181,s42,v9
v_lshlrev_b32 v176,16,v1
v_and_b32 v177,s42,v1
v_lshlrev_b32 v178,16,v5
v_and_b32 v179,s42,v5
v_lshlrev_b32 v186,16,v21
v_and_b32 v187,s42,v21
v_lshlrev_b32 v184,16,v17
v_and_b32 v185,s42,v17
v_lshlrev_b32 v182,16,v13
v_and_b32 v183,s42,v13
v_pk_fma_f32 v[176:177],v[180:181],s[42:43],v[176:177] op_sel:[0,1,0] op_sel_hi:[1,1,1]
v_pk_fma_f32 v[186:187],v[178:179],4.0,v[186:187] op_sel_hi:[1,0,1]
v_pk_fma_f32 v[188:189],v[180:181],-4.0,v[184:185] op_sel_hi:[1,0,1]
v_pk_fma_f32 v[176:177],v[184:185],s[44:45],v[176:177] op_sel:[0,1,0] op_sel_hi:[1,1,1]
v_pk_fma_f32 v[186:187],v[182:183],s[40:41],v[186:187] op_sel:[0,1,0] op_sel_hi:[1,1,1]
v_pk_add_f32 v[184:185],v[184:185],v[180:181] neg_lo:[0,1] neg_hi:[0,1]
v_pk_fma_f32 v[180:181],v[178:179],-4.0,v[182:183] op_sel_hi:[1,0,1]
v_pk_add_f32 v[182:183],v[182:183],v[178:179] neg_lo:[0,1] neg_hi:[0,1]
v_pk_add_f32 v[178:179],v[188:189],v[180:181]
v_pk_add_f32 v[188:189],v[188:189],v[180:181] neg_lo:[0,1] neg_hi:[0,1]
v_pk_fma_f32 v[180:181],v[182:183],2.0,v[184:185] op_sel_hi:[1,0,1]
v_pk_fma_f32 v[184:185],v[182:183],-2.0,v[184:185] op_sel_hi:[1,0,1]
v_cvt_pk_bf16_f32 v1,v176,v177
v_cvt_pk_bf16_f32 v5,v178,v179
v_cvt_pk_bf16_f32 v9,v188,v189
v_cvt_pk_bf16_f32 v13,v180,v181
v_cvt_pk_bf16_f32 v17,v184,v185
v_cvt_pk_bf16_f32 v21,v186,v187
v_lshlrev_b32 v180,16,v10
v_and_b32 v181,s42,v10
v_lshlrev_b32 v176,16,v2
v_and_b32 v177,s42,v2
v_lshlrev_b32 v178,16,v6
v_and_b32 v179,s42,v6
v_lshlrev_b32 v186,16,v22
v_and_b32 v187,s42,v22
v_lshlrev_b32 v184,16,v18
v_and_b32 v185,s42,v18
v_lshlrev_b32 v182,16,v14
v_and_b32 v183,s42,v14
v_pk_fma_f32 v[176:177],v[180:181],s[42:43],v[176:177] op_sel:[0,1,0] op_sel_hi:[1,1,1]
v_pk_fma_f32 v[186:187],v[178:179],4.0,v[186:187] op_sel_hi:[1,0,1]
v_pk_fma_f32 v[188:189],v[180:181],-4.0,v[184:185] op_sel_hi:[1,0,1]
v_pk_fma_f32 v[176:177],v[184:185],s[44:45],v[176:177] op_sel:[0,1,0] op_sel_hi:[1,1,1]
v_pk_fma_f32 v[186:187],v[182:183],s[40:41],v[186:187] op_sel:[0,1,0] op_sel_hi:[1,1,1]
v_pk_add_f32 v[184:185],v[184:185],v[180:181] neg_lo:[0,1] neg_hi:[0,1]
v_pk_fma_f32 v[180:181],v[178:179],-4.0,v[182:183] op_sel_hi:[1,0,1]
v_pk_add_f32 v[182:183],v[182:183],v[178:179] neg_lo:[0,1] neg_hi:[0,1]
v_pk_add_f32 v[178:179],v[188:189],v[180:181]
v_pk_add_f32 v[188:189],v[188:189],v[180:181] neg_lo:[0,1] neg_hi:[0,1]
v_pk_fma_f32 v[180:181],v[182:183],2.0,v[184:185] op_sel_hi:[1,0,1]
v_pk_fma_f32 v[184:185],v[182:183],-2.0,v[184:185] op_sel_hi:[1,0,1]
v_cvt_pk_bf16_f32 v2,v176,v177
v_cvt_pk_bf16_f32 v6,v178,v179
v_cvt_pk_bf16_f32 v10,v188,v189
v_cvt_pk_bf16_f32 v14,v180,v181
v_cvt_pk_bf16_f32 v18,v184,v185
v_cvt_pk_bf16_f32 v22,v186,v187
v_lshlrev_b32 v180,16,v11
v_and_b32 v181,s42,v11
v_lshlrev_b32 v176,16,v3
v_and_b32 v177,s42,v3
v_lshlrev_b32 v178,16,v7
v_and_b32 v179,s42,v7
v_lshlrev_b32 v186,16,v23
v_and_b32 v187,s42,v23
v_lshlrev_b32 v184,16,v19
v_and_b32 v185,s42,v19
v_lshlrev_b32 v182,16,v15
v_and_b32 v183,s42,v15
v_pk_fma_f32 v[176:177],v[180:181],s[42:43],v[176:177] op_sel:[0,1,0] op_sel_hi:[1,1,1]
v_pk_fma_f32 v[186:187],v[178:179],4.0,v[186:187] op_sel_hi:[1,0,1]
v_pk_fma_f32 v[188:189],v[180:181],-4.0,v[184:185] op_sel_hi:[1,0,1]
v_pk_fma_f32 v[176:177],v[184:185],s[44:45],v[176:177] op_sel:[0,1,0] op_sel_hi:[1,1,1]
v_pk_fma_f32 v[186:187],v[182:183],s[40:41],v[186:187] op_sel:[0,1,0] op_sel_hi:[1,1,1]
v_pk_add_f32 v[184:185],v[184:185],v[180:181] neg_lo:[0,1] neg_hi:[0,1]
v_pk_fma_f32 v[180:181],v[178:179],-4.0,v[182:183] op_sel_hi:[1,0,1]
v_pk_add_f32 v[182:183],v[182:183],v[178:179] neg_lo:[0,1] neg_hi:[0,1]
v_pk_add_f32 v[178:179],v[188:189],v[180:181]
v_pk_add_f32 v[188:189],v[188:189],v[180:181] neg_lo:[0,1] neg_hi:[0,1]
v_pk_fma_f32 v[180:181],v[182:183],2.0,v[184:185] op_sel_hi:[1,0,1]
v_pk_fma_f32 v[184:185],v[182:183],-2.0,v[184:185] op_sel_hi:[1,0,1]
v_cvt_pk_bf16_f32 v3,v176,v177
v_cvt_pk_bf16_f32 v7,v178,v179
v_cvt_pk_bf16_f32 v11,v188,v189
v_cvt_pk_bf16_f32 v15,v180,v181
v_cvt_pk_bf16_f32 v19,v184,v185
v_cvt_pk_bf16_f32 v23,v186,v187
ds_write_b128 v172,v[0:3] offset:0
ds_write_b128 v171,v[4:7] offset:17408
ds_write_b128 v171,v[8:11] offset:26112
ds_write_b128 v171,v[12:15] offset:34816
ds_write_b128 v171,v[16:19] offset:43520
ds_write_b128 v172,v[20:23] offset:8704
s_waitcnt vmcnt(24)
v_lshlrev_b32 v180,16,v32
v_and_b32 v181,s42,v32
s_waitcnt vmcnt(23)
v_lshlrev_b32 v176,16,v24
v_and_b32 v177,s42,v24
s_waitcnt vmcnt(22)
v_lshlrev_b32 v178,16,v28
v_and_b32 v179,s42,v28
s_waitcnt vmcnt(21)
v_lshlrev_b32 v186,16,v44
v_and_b32 v187,s42,v44
s_waitcnt vmcnt(20)
v_lshlrev_b32 v184,16,v40
v_and_b32 v185,s42,v40
s_waitcnt vmcnt(19)
v_lshlrev_b32 v182,16,v36
v_and_b32 v183,s42,v36
v_pk_fma_f32 v[176:177],v[180:181],s[42:43],v[176:177] op_sel:[0,1,0] op_sel_hi:[1,1,1]
v_pk_fma_f32 v[186:187],v[178:179],4.0,v[186:187] op_sel_hi:[1,0,1]
v_pk_fma_f32 v[188:189],v[180:181],-4.0,v[184:185] op_sel_hi:[1,0,1]
v_pk_fma_f32 v[176:177],v[184:185],s[44:45],v[176:177] op_sel:[0,1,0] op_sel_hi:[1,1,1]
v_pk_fma_f32 v[186:187],v[182:183],s[40:41],v[186:187] op_sel:[0,1,0] op_sel_hi:[1,1,1]
v_pk_add_f32 v[184:185],v[184:185],v[180:181] neg_lo:[0,1] neg_hi:[0,1]
v_pk_fma_f32 v[180:181],v[178:179],-4.0,v[182:183] op_sel_hi:[1,0,1]
v_pk_add_f32 v[182:183],v[182:183],v[178:179] neg_lo:[0,1] neg_hi:[0,1]
v_pk_add_f32 v[178:179],v[188:189],v[180:181]
v_pk_add_f32 v[188:189],v[188:189],v[180:181] neg_lo:[0,1] neg_hi:[0,1]
v_pk_fma_f32 v[180:181],v[182:183],2.0,v[184:185] op_sel_hi:[1,0,1]
v_pk_fma_f32 v[184:185],v[182:183],-2.0,v[184:185] op_sel_hi:[1,0,1]
v_cvt_pk_bf16_f32 v24,v176,v177
v_cvt_pk_bf16_f32 v28,v178,v179
v_cvt_pk_bf16_f32 v32,v188,v189
v_cvt_pk_bf16_f32 v36,v180,v181
v_cvt_pk_bf16_f32 v40,v184,v185
v_cvt_pk_bf16_f32 v44,v186,v187
v_lshlrev_b32 v180,16,v33
v_and_b32 v181,s42,v33
v_lshlrev_b32 v176,16,v25
v_and_b32 v177,s42,v25
v_lshlrev_b32 v178,16,v29
v_and_b32 v179,s42,v29
v_lshlrev_b32 v186,16,v45
v_and_b32 v187,s42,v45
v_lshlrev_b32 v184,16,v41
v_and_b32 v185,s42,v41
v_lshlrev_b32 v182,16,v37
v_and_b32 v183,s42,v37
v_pk_fma_f32 v[176:177],v[180:181],s[42:43],v[176:177] op_sel:[0,1,0] op_sel_hi:[1,1,1]
v_pk_fma_f32 v[186:187],v[178:179],4.0,v[186:187] op_sel_hi:[1,0,1]
v_pk_fma_f32 v[188:189],v[180:181],-4.0,v[184:185] op_sel_hi:[1,0,1]
v_pk_fma_f32 v[176:177],v[184:185],s[44:45],v[176:177] op_sel:[0,1,0] op_sel_hi:[1,1,1]
v_pk_fma_f32 v[186:187],v[182:183],s[40:41],v[186:187] op_sel:[0,1,0] op_sel_hi:[1,1,1]
v_pk_add_f32 v[184:185],v[184:185],v[180:181] neg_lo:[0,1] neg_hi:[0,1]
v_pk_fma_f32 v[180:181],v[178:179],-4.0,v[182:183] op_sel_hi:[1,0,1]
v_pk_add_f32 v[182:183],v[182:183],v[178:179] neg_lo:[0,1] neg_hi:[0,1]
v_pk_add_f32 v[178:179],v[188:189],v[180:181]
v_pk_add_f32 v[188:189],v[188:189],v[180:181] neg_lo:[0,1] neg_hi:[0,1]
v_pk_fma_f32 v[180:181],v[182:183],2.0,v[184:185] op_sel_hi:[1,0,1]
v_pk_fma_f32 v[184:185],v[182:183],-2.0,v[184:185] op_sel_hi:[1,0,1]
v_cvt_pk_bf16_f32 v25,v176,v177
v_cvt_pk_bf16_f32 v29,v178,v179
v_cvt_pk_bf16_f32 v33,v188,v189
v_cvt_pk_bf16_f32 v37,v180,v181
v_cvt_pk_bf16_f32 v41,v184,v185
v_cvt_pk_bf16_f32 v45,v186,v187
v_lshlrev_b32 v180,16,v34
v_and_b32 v181,s42,v34
v_lshlrev_b32 v176,16,v26
v_and_b32 v177,s42,v26
v_lshlrev_b32 v178,16,v30
v_and_b32 v179,s42,v30
v_lshlrev_b32 v186,16,v46
v_and_b32 v187,s42,v46
v_lshlrev_b32 v184,16,v42
v_and_b32 v185,s42,v42
v_lshlrev_b32 v182,16,v38
v_and_b32 v183,s42,v38
v_pk_fma_f32 v[176:177],v[180:181],s[42:43],v[176:177] op_sel:[0,1,0] op_sel_hi:[1,1,1]
v_pk_fma_f32 v[186:187],v[178:179],4.0,v[186:187] op_sel_hi:[1,0,1]
v_pk_fma_f32 v[188:189],v[180:181],-4.0,v[184:185] op_sel_hi:[1,0,1]
v_pk_fma_f32 v[176:177],v[184:185],s[44:45],v[176:177] op_sel:[0,1,0] op_sel_hi:[1,1,1]
v_pk_fma_f32 v[186:187],v[182:183],s[40:41],v[186:187] op_sel:[0,1,0] op_sel_hi:[1,1,1]
v_pk_add_f32 v[184:185],v[184:185],v[180:181] neg_lo:[0,1] neg_hi:[0,1]
v_pk_fma_f32 v[180:181],v[178:179],-4.0,v[182:183] op_sel_hi:[1,0,1]
v_pk_add_f32 v[182:183],v[182:183],v[178:179] neg_lo:[0,1] neg_hi:[0,1]
v_pk_add_f32 v[178:179],v[188:189],v[180:181]
v_pk_add_f32 v[188:189],v[188:189],v[180:181] neg_lo:[0,1] neg_hi:[0,1]
v_pk_fma_f32 v[180:181],v[182:183],2.0,v[184:185] op_sel_hi:[1,0,1]
v_pk_fma_f32 v[184:185],v[182:183],-2.0,v[184:185] op_sel_hi:[1,0,1]
v_cvt_pk_bf16_f32 v26,v176,v177
v_cvt_pk_bf16_f32 v30,v178,v179
v_cvt_pk_bf16_f32 v34,v188,v189
v_cvt_pk_bf16_f32 v38,v180,v181
v_cvt_pk_bf16_f32 v42,v184,v185
v_cvt_pk_bf16_f32 v46,v186,v187
v_lshlrev_b32 v180,16,v35
v_and_b32 v181,s42,v35
v_lshlrev_b32 v176,16,v27
v_and_b32 v177,s42,v27
v_lshlrev_b32 v178,16,v31
v_and_b32 v179,s42,v31
v_lshlrev_b32 v186,16,v47
v_and_b32 v187,s42,v47
v_lshlrev_b32 v184,16,v43
v_and_b32 v185,s42,v43
v_lshlrev_b32 v182,16,v39
v_and_b32 v183,s42,v39
v_pk_fma_f32 v[176:177],v[180:181],s[42:43],v[176:177] op_sel:[0,1,0] op_sel_hi:[1,1,1]
v_pk_fma_f32 v[186:187],v[178:179],4.0,v[186:187] op_sel_hi:[1,0,1]
v_pk_fma_f32 v[188:189],v[180:181],-4.0,v[184:185] op_sel_hi:[1,0,1]
v_pk_fma_f32 v[176:177],v[184:185],s[44:45],v[176:177] op_sel:[0,1,0] op_sel_hi:[1,1,1]
v_pk_fma_f32 v[186:187],v[182:183],s[40:41],v[186:187] op_sel:[0,1,0] op_sel_hi:[1,1,1]
v_pk_add_f32 v[184:185],v[184:185],v[180:181] neg_lo:[0,1] neg_hi:[0,1]
v_pk_fma_f32 v[180:181],v[178:179],-4.0,v[182:183] op_sel_hi:[1,0,1]
v_pk_add_f32 v[182:183],v[182:183],v[178:179] neg_lo:[0,1] neg_hi:[0,1]
v_pk_add_f32 v[178:179],v[188:189],v[180:181]
v_pk_add_f32 v[188:189],v[188:189],v[180:181] neg_lo:[0,1] neg_hi:[0,1]
v_pk_fma_f32 v[180:181],v[182:183],2.0,v[184:185] op_sel_hi:[1,0,1]
v_pk_fma_f32 v[184:185],v[182:183],-2.0,v[184:185] op_sel_hi:[1,0,1]
v_cvt_pk_bf16_f32 v27,v176,v177
v_cvt_pk_bf16_f32 v31,v178,v179
v_cvt_pk_bf16_f32 v35,v188,v189
v_cvt_pk_bf16_f32 v39,v180,v181
v_cvt_pk_bf16_f32 v43,v184,v185
v_cvt_pk_bf16_f32 v47,v186,v187
ds_write_b128 v172,v[24:27] offset:512
ds_write_b128 v171,v[28:31] offset:17920
ds_write_b128 v171,v[32:35] offset:26624
ds_write_b128 v171,v[36:39] offset:35328
ds_write_b128 v171,v[40:43] offset:44032
ds_write_b128 v172,v[44:47] offset:9216
s_waitcnt vmcnt(18)
v_lshlrev_b32 v180,16,v56
v_and_b32 v181,s42,v56
s_waitcnt vmcnt(17)
v_lshlrev_b32 v176,16,v48
v_and_b32 v177,s42,v48
s_waitcnt vmcnt(16)
v_lshlrev_b32 v178,16,v52
v_and_b32 v179,s42,v52
s_waitcnt vmcnt(15)
v_lshlrev_b32 v186,16,v68
v_and_b32 v187,s42,v68
s_waitcnt vmcnt(14)
v_lshlrev_b32 v184,16,v64
v_and_b32 v185,s42,v64
s_waitcnt vmcnt(13)
v_lshlrev_b32 v182,16,v60
v_and_b32 v183,s42,v60
v_pk_fma_f32 v[176:177],v[180:181],s[42:43],v[176:177] op_sel:[0,1,0] op_sel_hi:[1,1,1]
v_pk_fma_f32 v[186:187],v[178:179],4.0,v[186:187] op_sel_hi:[1,0,1]
v_pk_fma_f32 v[188:189],v[180:181],-4.0,v[184:185] op_sel_hi:[1,0,1]
v_pk_fma_f32 v[176:177],v[184:185],s[44:45],v[176:177] op_sel:[0,1,0] op_sel_hi:[1,1,1]
v_pk_fma_f32 v[186:187],v[182:183],s[40:41],v[186:187] op_sel:[0,1,0] op_sel_hi:[1,1,1]
v_pk_add_f32 v[184:185],v[184:185],v[180:181] neg_lo:[0,1] neg_hi:[0,1]
v_pk_fma_f32 v[180:181],v[178:179],-4.0,v[182:183] op_sel_hi:[1,0,1]
v_pk_add_f32 v[182:183],v[182:183],v[178:179] neg_lo:[0,1] neg_hi:[0,1]
v_pk_add_f32 v[178:179],v[188:189],v[180:181]
v_pk_add_f32 v[188:189],v[188:189],v[180:181] neg_lo:[0,1] neg_hi:[0,1]
v_pk_fma_f32 v[180:181],v[182:183],2.0,v[184:185] op_sel_hi:[1,0,1]
v_pk_fma_f32 v[184:185],v[182:183],-2.0,v[184:185] op_sel_hi:[1,0,1]
v_cvt_pk_bf16_f32 v48,v176,v177
v_cvt_pk_bf16_f32 v52,v178,v179
v_cvt_pk_bf16_f32 v56,v188,v189
v_cvt_pk_bf16_f32 v60,v180,v181
v_cvt_pk_bf16_f32 v64,v184,v185
v_cvt_pk_bf16_f32 v68,v186,v187
v_lshlrev_b32 v180,16,v57
v_and_b32 v181,s42,v57
v_lshlrev_b32 v176,16,v49
v_and_b32 v177,s42,v49
v_lshlrev_b32 v178,16,v53
v_and_b32 v179,s42,v53
v_lshlrev_b32 v186,16,v69
v_and_b32 v187,s42,v69
v_lshlrev_b32 v184,16,v65
v_and_b32 v185,s42,v65
v_lshlrev_b32 v182,16,v61
v_and_b32 v183,s42,v61
v_pk_fma_f32 v[176:177],v[180:181],s[42:43],v[176:177] op_sel:[0,1,0] op_sel_hi:[1,1,1]
v_pk_fma_f32 v[186:187],v[178:179],4.0,v[186:187] op_sel_hi:[1,0,1]
v_pk_fma_f32 v[188:189],v[180:181],-4.0,v[184:185] op_sel_hi:[1,0,1]
v_pk_fma_f32 v[176:177],v[184:185],s[44:45],v[176:177] op_sel:[0,1,0] op_sel_hi:[1,1,1]
v_pk_fma_f32 v[186:187],v[182:183],s[40:41],v[186:187] op_sel:[0,1,0] op_sel_hi:[1,1,1]
v_pk_add_f32 v[184:185],v[184:185],v[180:181] neg_lo:[0,1] neg_hi:[0,1]
v_pk_fma_f32 v[180:181],v[178:179],-4.0,v[182:183] op_sel_hi:[1,0,1]
v_pk_add_f32 v[182:183],v[182:183],v[178:179] neg_lo:[0,1] neg_hi:[0,1]
v_pk_add_f32 v[178:179],v[188:189],v[180:181]
v_pk_add_f32 v[188:189],v[188:189],v[180:181] neg_lo:[0,1] neg_hi:[0,1]
v_pk_fma_f32 v[180:181],v[182:183],2.0,v[184:185] op_sel_hi:[1,0,1]
v_pk_fma_f32 v[184:185],v[182:183],-2.0,v[184:185] op_sel_hi:[1,0,1]
v_cvt_pk_bf16_f32 v49,v176,v177
v_cvt_pk_bf16_f32 v53,v178,v179
v_cvt_pk_bf16_f32 v57,v188,v189
v_cvt_pk_bf16_f32 v61,v180,v181
v_cvt_pk_bf16_f32 v65,v184,v185
v_cvt_pk_bf16_f32 v69,v186,v187
v_lshlrev_b32 v180,16,v58
v_and_b32 v181,s42,v58
v_lshlrev_b32 v176,16,v50
v_and_b32 v177,s42,v50
v_lshlrev_b32 v178,16,v54
v_and_b32 v179,s42,v54
v_lshlrev_b32 v186,16,v70
v_and_b32 v187,s42,v70
v_lshlrev_b32 v184,16,v66
v_and_b32 v185,s42,v66
v_lshlrev_b32 v182,16,v62
v_and_b32 v183,s42,v62
v_pk_fma_f32 v[176:177],v[180:181],s[42:43],v[176:177] op_sel:[0,1,0] op_sel_hi:[1,1,1]
v_pk_fma_f32 v[186:187],v[178:179],4.0,v[186:187] op_sel_hi:[1,0,1]
v_pk_fma_f32 v[188:189],v[180:181],-4.0,v[184:185] op_sel_hi:[1,0,1]
v_pk_fma_f32 v[176:177],v[184:185],s[44:45],v[176:177] op_sel:[0,1,0] op_sel_hi:[1,1,1]
v_pk_fma_f32 v[186:187],v[182:183],s[40:41],v[186:187] op_sel:[0,1,0] op_sel_hi:[1,1,1]
v_pk_add_f32 v[184:185],v[184:185],v[180:181] neg_lo:[0,1] neg_hi:[0,1]
v_pk_fma_f32 v[180:181],v[178:179],-4.0,v[182:183] op_sel_hi:[1,0,1]
v_pk_add_f32 v[182:183],v[182:183],v[178:179] neg_lo:[0,1] neg_hi:[0,1]
v_pk_add_f32 v[178:179],v[188:189],v[180:181]
v_pk_add_f32 v[188:189],v[188:189],v[180:181] neg_lo:[0,1] neg_hi:[0,1]
v_pk_fma_f32 v[180:181],v[182:183],2.0,v[184:185] op_sel_hi:[1,0,1]
v_pk_fma_f32 v[184:185],v[182:183],-2.0,v[184:185] op_sel_hi:[1,0,1]
v_cvt_pk_bf16_f32 v50,v176,v177
v_cvt_pk_bf16_f32 v54,v178,v179
v_cvt_pk_bf16_f32 v58,v188,v189
v_cvt_pk_bf16_f32 v62,v180,v181
v_cvt_pk_bf16_f32 v66,v184,v185
v_cvt_pk_bf16_f32 v70,v186,v187
v_lshlrev_b32 v180,16,v59
v_and_b32 v181,s42,v59
v_lshlrev_b32 v176,16,v51
v_and_b32 v177,s42,v51
v_lshlrev_b32 v178,16,v55
v_and_b32 v179,s42,v55
v_lshlrev_b32 v186,16,v71
v_and_b32 v187,s42,v71
v_lshlrev_b32 v184,16,v67
v_and_b32 v185,s42,v67
v_lshlrev_b32 v182,16,v63
v_and_b32 v183,s42,v63
v_pk_fma_f32 v[176:177],v[180:181],s[42:43],v[176:177] op_sel:[0,1,0] op_sel_hi:[1,1,1]
v_pk_fma_f32 v[186:187],v[178:179],4.0,v[186:187] op_sel_hi:[1,0,1]
v_pk_fma_f32 v[188:189],v[180:181],-4.0,v[184:185] op_sel_hi:[1,0,1]
v_pk_fma_f32 v[176:177],v[184:185],s[44:45],v[176:177] op_sel:[0,1,0] op_sel_hi:[1,1,1]
v_pk_fma_f32 v[186:187],v[182:183],s[40:41],v[186:187] op_sel:[0,1,0] op_sel_hi:[1,1,1]
v_pk_add_f32 v[184:185],v[184:185],v[180:181] neg_lo:[0,1] neg_hi:[0,1]
v_pk_fma_f32 v[180:181],v[178:179],-4.0,v[182:183] op_sel_hi:[1,0,1]
v_pk_add_f32 v[182:183],v[182:183],v[178:179] neg_lo:[0,1] neg_hi:[0,1]
v_pk_add_f32 v[178:179],v[188:189],v[180:181]
v_pk_add_f32 v[188:189],v[188:189],v[180:181] neg_lo:[0,1] neg_hi:[0,1]
v_pk_fma_f32 v[180:181],v[182:183],2.0,v[184:185] op_sel_hi:[1,0,1]
v_pk_fma_f32 v[184:185],v[182:183],-2.0,v[184:185] op_sel_hi:[1,0,1]
v_cvt_pk_bf16_f32 v51,v176,v177
v_cvt_pk_bf16_f32 v55,v178,v179
v_cvt_pk_bf16_f32 v59,v188,v189
v_cvt_pk_bf16_f32 v63,v180,v181
v_cvt_pk_bf16_f32 v67,v184,v185
v_cvt_pk_bf16_f32 v71,v186,v187
ds_write_b128 v172,v[48:51] offset:1024
ds_write_b128 v171,v[52:55] offset:18432
ds_write_b128 v171,v[56:59] offset:27136
ds_write_b128 v171,v[60:63] offset:35840
ds_write_b128 v171,v[64:67] offset:44544
ds_write_b128 v172,v[68:71] offset:9728
s_waitcnt vmcnt(12)
v_lshlrev_b32 v180,16,v80
v_and_b32 v181,s42,v80
s_waitcnt vmcnt(11)
v_lshlrev_b32 v176,16,v72
v_and_b32 v177,s42,v72
s_waitcnt vmcnt(10)
v_lshlrev_b32 v178,16,v76
v_and_b32 v179,s42,v76
s_waitcnt vmcnt(9)
v_lshlrev_b32 v186,16,v92
v_and_b32 v187,s42,v92
s_waitcnt vmcnt(8)
v_lshlrev_b32 v184,16,v88
v_and_b32 v185,s42,v88
s_waitcnt vmcnt(7)
v_lshlrev_b32 v182,16,v84
v_and_b32 v183,s42,v84
v_pk_fma_f32 v[176:177],v[180:181],s[42:43],v[176:177] op_sel:[0,1,0] op_sel_hi:[1,1,1]
v_pk_fma_f32 v[186:187],v[178:179],4.0,v[186:187] op_sel_hi:[1,0,1]
v_pk_fma_f32 v[188:189],v[180:181],-4.0,v[184:185] op_sel_hi:[1,0,1]
v_pk_fma_f32 v[176:177],v[184:185],s[44:45],v[176:177] op_sel:[0,1,0] op_sel_hi:[1,1,1]
v_pk_fma_f32 v[186:187],v[182:183],s[40:41],v[186:187] op_sel:[0,1,0] op_sel_hi:[1,1,1]
v_pk_add_f32 v[184:185],v[184:185],v[180:181] neg_lo:[0,1] neg_hi:[0,1]
v_pk_fma_f32 v[180:181],v[178:179],-4.0,v[182:183] op_sel_hi:[1,0,1]
v_pk_add_f32 v[182:183],v[182:183],v[178:179] neg_lo:[0,1] neg_hi:[0,1]
v_pk_add_f32 v[178:179],v[188:189],v[180:181]
v_pk_add_f32 v[188:189],v[188:189],v[180:181] neg_lo:[0,1] neg_hi:[0,1]
v_pk_fma_f32 v[180:181],v[182:183],2.0,v[184:185] op_sel_hi:[1,0,1]
v_pk_fma_f32 v[184:185],v[182:183],-2.0,v[184:185] op_sel_hi:[1,0,1]
v_cvt_pk_bf16_f32 v72,v176,v177
v_cvt_pk_bf16_f32 v76,v178,v179
v_cvt_pk_bf16_f32 v80,v188,v189
v_cvt_pk_bf16_f32 v84,v180,v181
v_cvt_pk_bf16_f32 v88,v184,v185
v_cvt_pk_bf16_f32 v92,v186,v187
v_lshlrev_b32 v180,16,v81
v_and_b32 v181,s42,v81
v_lshlrev_b32 v176,16,v73
v_and_b32 v177,s42,v73
v_lshlrev_b32 v178,16,v77
v_and_b32 v179,s42,v77
v_lshlrev_b32 v186,16,v93
v_and_b32 v187,s42,v93
v_lshlrev_b32 v184,16,v89
v_and_b32 v185,s42,v89
v_lshlrev_b32 v182,16,v85
v_and_b32 v183,s42,v85
v_pk_fma_f32 v[176:177],v[180:181],s[42:43],v[176:177] op_sel:[0,1,0] op_sel_hi:[1,1,1]
v_pk_fma_f32 v[186:187],v[178:179],4.0,v[186:187] op_sel_hi:[1,0,1]
v_pk_fma_f32 v[188:189],v[180:181],-4.0,v[184:185] op_sel_hi:[1,0,1]
v_pk_fma_f32 v[176:177],v[184:185],s[44:45],v[176:177] op_sel:[0,1,0] op_sel_hi:[1,1,1]
v_pk_fma_f32 v[186:187],v[182:183],s[40:41],v[186:187] op_sel:[0,1,0] op_sel_hi:[1,1,1]
v_pk_add_f32 v[184:185],v[184:185],v[180:181] neg_lo:[0,1] neg_hi:[0,1]
v_pk_fma_f32 v[180:181],v[178:179],-4.0,v[182:183] op_sel_hi:[1,0,1]
v_pk_add_f32 v[182:183],v[182:183],v[178:179] neg_lo:[0,1] neg_hi:[0,1]
v_pk_add_f32 v[178:179],v[188:189],v[180:181]
v_pk_add_f32 v[188:189],v[188:189],v[180:181] neg_lo:[0,1] neg_hi:[0,1]
v_pk_fma_f32 v[180:181],v[182:183],2.0,v[184:185] op_sel_hi:[1,0,1]
v_pk_fma_f32 v[184:185],v[182:183],-2.0,v[184:185] op_sel_hi:[1,0,1]
v_cvt_pk_bf16_f32 v73,v176,v177
v_cvt_pk_bf16_f32 v77,v178,v179
v_cvt_pk_bf16_f32 v81,v188,v189
v_cvt_pk_bf16_f32 v85,v180,v181
v_cvt_pk_bf16_f32 v89,v184,v185
v_cvt_pk_bf16_f32 v93,v186,v187
v_lshlrev_b32 v180,16,v82
v_and_b32 v181,s42,v82
v_lshlrev_b32 v176,16,v74
v_and_b32 v177,s42,v74
v_lshlrev_b32 v178,16,v78
v_and_b32 v179,s42,v78
v_lshlrev_b32 v186,16,v94
v_and_b32 v187,s42,v94
v_lshlrev_b32 v184,16,v90
v_and_b32 v185,s42,v90
v_lshlrev_b32 v182,16,v86
v_and_b32 v183,s42,v86
v_pk_fma_f32 v[176:177],v[180:181],s[42:43],v[176:177] op_sel:[0,1,0] op_sel_hi:[1,1,1]
v_pk_fma_f32 v[186:187],v[178:179],4.0,v[186:187] op_sel_hi:[1,0,1]
v_pk_fma_f32 v[188:189],v[180:181],-4.0,v[184:185] op_sel_hi:[1,0,1]
v_pk_fma_f32 v[176:177],v[184:185],s[44:45],v[176:177] op_sel:[0,1,0] op_sel_hi:[1,1,1]
v_pk_fma_f32 v[186:187],v[182:183],s[40:41],v[186:187] op_sel:[0,1,0] op_sel_hi:[1,1,1]
v_pk_add_f32 v[184:185],v[184:185],v[180:181] neg_lo:[0,1] neg_hi:[0,1]
v_pk_fma_f32 v[180:181],v[178:179],-4.0,v[182:183] op_sel_hi:[1,0,1]
v_pk_add_f32 v[182:183],v[182:183],v[178:179] neg_lo:[0,1] neg_hi:[0,1]
v_pk_add_f32 v[178:179],v[188:189],v[180:181]
v_pk_add_f32 v[188:189],v[188:189],v[180:181] neg_lo:[0,1] neg_hi:[0,1]
v_pk_fma_f32 v[180:181],v[182:183],2.0,v[184:185] op_sel_hi:[1,0,1]
v_pk_fma_f32 v[184:185],v[182:183],-2.0,v[184:185] op_sel_hi:[1,0,1]
v_cvt_pk_bf16_f32 v74,v176,v177
v_cvt_pk_bf16_f32 v78,v178,v179
v_cvt_pk_bf16_f32 v82,v188,v189
v_cvt_pk_bf16_f32 v86,v180,v181
v_cvt_pk_bf16_f32 v90,v184,v185
v_cvt_pk_bf16_f32 v94,v186,v187
v_lshlrev_b32 v180,16,v83
v_and_b32 v181,s42,v83
v_lshlrev_b32 v176,16,v75
v_and_b32 v177,s42,v75
v_lshlrev_b32 v178,16,v79
v_and_b32 v179,s42,v79
v_lshlrev_b32 v186,16,v95
v_and_b32 v187,s42,v95
v_lshlrev_b32 v184,16,v91
v_and_b32 v185,s42,v91
v_lshlrev_b32 v182,16,v87
v_and_b32 v183,s42,v87
v_pk_fma_f32 v[176:177],v[180:181],s[42:43],v[176:177] op_sel:[0,1,0] op_sel_hi:[1,1,1]
v_pk_fma_f32 v[186:187],v[178:179],4.0,v[186:187] op_sel_hi:[1,0,1]
v_pk_fma_f32 v[188:189],v[180:181],-4.0,v[184:185] op_sel_hi:[1,0,1]
v_pk_fma_f32 v[176:177],v[184:185],s[44:45],v[176:177] op_sel:[0,1,0] op_sel_hi:[1,1,1]
v_pk_fma_f32 v[186:187],v[182:183],s[40:41],v[186:187] op_sel:[0,1,0] op_sel_hi:[1,1,1]
v_pk_add_f32 v[184:185],v[184:185],v[180:181] neg_lo:[0,1] neg_hi:[0,1]
v_pk_fma_f32 v[180:181],v[178:179],-4.0,v[182:183] op_sel_hi:[1,0,1]
v_pk_add_f32 v[182:183],v[182:183],v[178:179] neg_lo:[0,1] neg_hi:[0,1]
v_pk_add_f32 v[178:179],v[188:189],v[180:181]
v_pk_add_f32 v[188:189],v[188:189],v[180:181] neg_lo:[0,1] neg_hi:[0,1]
v_pk_fma_f32 v[180:181],v[182:183],2.0,v[184:185] op_sel_hi:[1,0,1]
v_pk_fma_f32 v[184:185],v[182:183],-2.0,v[184:185] op_sel_hi:[1,0,1]
v_cvt_pk_bf16_f32 v75,v176,v177
v_cvt_pk_bf16_f32 v79,v178,v179
v_cvt_pk_bf16_f32 v83,v188,v189
v_cvt_pk_bf16_f32 v87,v180,v181
v_cvt_pk_bf16_f32 v91,v184,v185
v_cvt_pk_bf16_f32 v95,v186,v187
ds_write_b128 v172,v[72:75] offset:1536
ds_write_b128 v171,v[76:79] offset:18944
ds_write_b128 v171,v[80:83] offset:27648
ds_write_b128 v171,v[84:87] offset:36352
ds_write_b128 v171,v[88:91] offset:45056
ds_write_b128 v172,v[92:95] offset:10240
s_waitcnt vmcnt(4)
v_lshlrev_b32 v180,16,v98
v_and_b32 v181,s42,v98
v_lshlrev_b32 v176,16,v96
v_and_b32 v177,s42,v96
v_lshlrev_b32 v178,16,v97
v_and_b32 v179,s42,v97
s_waitcnt vmcnt(1)
v_lshlrev_b32 v186,16,v101
v_and_b32 v187,s42,v101
v_lshlrev_b32 v184,16,v100
v_and_b32 v185,s42,v100
v_lshlrev_b32 v182,16,v99
v_and_b32 v183,s42,v99
v_pk_fma_f32 v[176:177],v[180:181],s[42:43],v[176:177] op_sel:[0,1,0] op_sel_hi:[1,1,1]
v_pk_fma_f32 v[186:187],v[178:179],4.0,v[186:187] op_sel_hi:[1,0,1]
v_pk_fma_f32 v[188:189],v[180:181],-4.0,v[184:185] op_sel_hi:[1,0,1]
v_pk_fma_f32 v[176:177],v[184:185],s[44:45],v[176:177] op_sel:[0,1,0] op_sel_hi:[1,1,1]
v_pk_fma_f32 v[186:187],v[182:183],s[40:41],v[186:187] op_sel:[0,1,0] op_sel_hi:[1,1,1]
v_pk_add_f32 v[184:185],v[184:185],v[180:181] neg_lo:[0,1] neg_hi:[0,1]
v_pk_fma_f32 v[180:181],v[178:179],-4.0,v[182:183] op_sel_hi:[1,0,1]
v_pk_add_f32 v[182:183],v[182:183],v[178:179] neg_lo:[0,1] neg_hi:[0,1]
v_pk_add_f32 v[178:179],v[188:189],v[180:181]
v_pk_add_f32 v[188:189],v[188:189],v[180:181] neg_lo:[0,1] neg_hi:[0,1]
v_pk_fma_f32 v[180:181],v[182:183],2.0,v[184:185] op_sel_hi:[1,0,1]
v_pk_fma_f32 v[184:185],v[182:183],-2.0,v[184:185] op_sel_hi:[1,0,1]
v_cvt_pk_bf16_f32 v96,v176,v177
v_cvt_pk_bf16_f32 v97,v178,v179
v_cvt_pk_bf16_f32 v98,v188,v189
v_cvt_pk_bf16_f32 v99,v180,v181
v_cvt_pk_bf16_f32 v100,v184,v185
v_cvt_pk_bf16_f32 v101,v186,v187
ds_write_b32 v174,v96 offset:0
ds_write_b32 v173,v97 offset:17408
ds_write_b32 v173,v98 offset:26112
ds_write_b32 v173,v99 offset:34816
ds_write_b32 v173,v100 offset:43520
ds_write_b32 v174,v101 offset:8704
s_waitcnt lgkmcnt(0)
s_barrier
ds_read_b128 a[216:219],v248 offset:17408
ds_read_b128 a[220:223],v249 offset:17408
ds_read_b128 a[224:227],v248 offset:17920
ds_read_b128 a[228:231],v249 offset:17920
v_and_b32 v165,1,v164
v_lshlrev_b32 v165,2,v165
s_mov_b32 s84,0
L_poll:
global_load_dword v166,v165,s[52:53] offset:128 sc1
s_add_u32 s84,s84,1
s_waitcnt vmcnt(0)
v_cmp_eq_u32 vcc,0,v166
s_cmp_gt_u32 s84,0x4000
s_cbranch_scc1 L_fallback
s_cbranch_vccnz L_poll
L_uready:
s_add_u32 s46,s72,9216
buffer_load_dwordx4 a[192:195],v250,s[20:23],s46 offen offset:0 sc1
buffer_load_dwordx4 a[196:199],v250,s[20:23],s46 offen offset:1024 sc1
buffer_load_dwordx4 a[200:203],v250,s[20:23],s46 offen offset:2048 sc1
s_add_u32 s47,s72,12288
buffer_load_dwordx4 a[204:207],v250,s[20:23],s47 offen offset:0 sc1
buffer_load_dwordx4 a[208:211],v250,s[20:23],s47 offen offset:1024 sc1
buffer_load_dwordx4 a[212:215],v250,s[20:23],s47 offen offset:2048 sc1
s_waitcnt vmcnt(5) lgkmcnt(3)
M a[0:3],a[192:195],a[216:219],0
s_waitcnt vmcnt(4) lgkmcnt(2)
s_add_u32 s48,s72,15360
buffer_load_dwordx4 a[232:235],v250,s[20:23],s48 offen offset:0 sc1
M a[0:3],a[196:199],a[220:223],a[0:3]
s_waitcnt vmcnt(4) lgkmcnt(1)
ds_read_b128 a[236:239],v248 offset:18432
ds_read_b128 a[240:243],v249 offset:18432
M a[0:3],a[200:203],a[224:227],a[0:3]
s_waitcnt lgkmcnt(2)
buffer_load_dwordx4 a[244:247],v250,s[20:23],s48 offen offset:1024 sc1
M a[4:7],a[200:203],a[228:231],0
M a[4:7],a[196:199],a[224:227],a[4:7]
M a[4:7],a[192:195],a[220:223],a[4:7]
M a[8:11],a[192:195],a[224:227],0
buffer_load_dwordx4 a[248:251],v250,s[20:23],s48 offen offset:2048 sc1
M a[8:11],a[196:199],a[228:231],a[8:11]
s_waitcnt lgkmcnt(1)
s_add_u32 s46,s72,18432
ds_read_b128 v[216:219],v248 offset:18944
ds_read_b128 v[220:223],v249 offset:18944
M a[8:11],a[200:203],a[236:239],a[8:11]
s_waitcnt lgkmcnt(2)
M a[12:15],a[200:203],a[240:243],0
M a[12:15],a[196:199],a[236:239],a[12:15]
buffer_load_dwordx4 a[252:255],v250,s[20:23],s46 offen offset:0 sc1
M a[12:15],a[192:195],a[228:231],a[12:15]
M a[16:19],a[192:195],a[236:239],0
ds_read_b128 v[224:227],v249 offset:19456
M a[16:19],a[196:199],a[240:243],a[16:19]
s_waitcnt lgkmcnt(2)
ds_read_b128 v[228:231],v248 offset:19456
M a[16:19],a[200:203],v[216:219],a[16:19]
s_waitcnt lgkmcnt(2)
M a[20:23],a[200:203],v[220:223],0
M a[20:23],a[196:199],v[216:219],a[20:23]
M a[20:23],a[192:195],a[240:243],a[20:23]
M a[24:27],a[192:195],v[216:219],0
M a[24:27],a[196:199],v[220:223],a[24:27]
s_waitcnt lgkmcnt(1)
M a[24:27],a[200:203],v[224:227],a[24:27]
s_waitcnt lgkmcnt(0)
M a[28:31],a[200:203],v[228:231],0
buffer_load_dwordx4 a[200:203],v250,s[20:23],s46 offen offset:1024 sc1
M a[28:31],a[196:199],v[224:227],a[28:31]
M a[28:31],a[192:195],v[220:223],a[28:31]
s_waitcnt vmcnt(7)
buffer_load_dwordx4 a[196:199],v250,s[20:23],s46 offen offset:2048 sc1
M a[32:35],a[204:207],a[216:219],0
s_waitcnt vmcnt(7)
s_add_u32 s47,s72,21504
M a[32:35],a[208:211],a[220:223],a[32:35]
s_waitcnt vmcnt(6)
M a[32:35],a[212:215],a[224:227],a[32:35]
M a[36:39],a[212:215],a[228:231],0
buffer_load_dwordx4 a[192:195],v250,s[20:23],s47 offen offset:0 sc1
M a[36:39],a[208:211],a[224:227],a[36:39]
M a[36:39],a[204:207],a[220:223],a[36:39]
M a[40:43],a[204:207],a[224:227],0
s_add_u32 s28,s68,0
M a[40:43],a[208:211],a[228:231],a[40:43]
buffer_load_dwordx2 v[192:193],v251,s[12:15],s28 offen offset:0
M a[40:43],a[212:215],a[236:239],a[40:43]
M a[44:47],a[212:215],a[240:243],0
M a[44:47],a[208:211],a[236:239],a[44:47]
M a[44:47],a[204:207],a[228:231],a[44:47]
buffer_load_dwordx2 v[202:203],v251,s[16:19],s28 offen offset:1536
M a[48:51],a[204:207],a[236:239],0
M a[48:51],a[208:211],a[240:243],a[48:51]
M a[48:51],a[212:215],v[216:219],a[48:51]
M a[52:55],a[212:215],v[220:223],0
buffer_load_dwordx2 v[194:195],v251,s[8:11],s28 offen offset:0
M a[52:55],a[208:211],v[216:219],a[52:55]
M a[52:55],a[204:207],a[240:243],a[52:55]
M a[56:59],a[204:207],v[216:219],0
M a[56:59],a[208:211],v[220:223],a[56:59]
buffer_load_dwordx2 v[196:197],v251,s[8:11],s28 offen offset:384
M a[56:59],a[212:215],v[224:227],a[56:59]
M a[60:63],a[212:215],v[228:231],0
M a[60:63],a[208:211],v[224:227],a[60:63]
M a[60:63],a[204:207],v[220:223],a[60:63]
s_waitcnt vmcnt(10)
buffer_load_dwordx4 a[212:215],v250,s[20:23],s47 offen offset:1024 sc1
M a[64:67],a[232:235],a[216:219],0
s_waitcnt vmcnt(10)
M a[64:67],a[244:247],a[220:223],a[64:67]
s_waitcnt vmcnt(9)
M a[64:67],a[248:251],a[224:227],a[64:67]
M a[68:71],a[248:251],a[228:231],0
buffer_load_dwordx4 a[208:211],v250,s[20:23],s47 offen offset:2048 sc1
M a[68:71],a[244:247],a[224:227],a[68:71]
M a[68:71],a[232:235],a[220:223],a[68:71]
M a[72:75],a[232:235],a[224:227],0
s_add_u32 s48,s72,24576
M a[72:75],a[244:247],a[228:231],a[72:75]
buffer_load_dwordx2 v[198:199],v251,s[8:11],s28 offen offset:768
M a[72:75],a[248:251],a[236:239],a[72:75]
M a[76:79],a[248:251],a[240:243],0
M a[76:79],a[244:247],a[236:239],a[76:79]
M a[76:79],a[232:235],a[228:231],a[76:79]
buffer_load_dwordx2 v[200:201],v251,s[8:11],s28 offen offset:1152
M a[80:83],a[232:235],a[236:239],0
M a[80:83],a[244:247],a[240:243],a[80:83]
M a[80:83],a[248:251],v[216:219],a[80:83]
M a[84:87],a[248:251],v[220:223],0
buffer_load_dwordx4 a[204:207],v250,s[20:23],s48 offen offset:0 sc1
M a[84:87],a[244:247],v[216:219],a[84:87]
ds_read_b128 a[224:227],v248 offset:26112
M a[84:87],a[232:235],a[240:243],a[84:87]
ds_read_b128 a[228:231],v249 offset:26112
M a[88:91],a[232:235],v[216:219],0
ds_read_b128 a[236:239],v248 offset:26624
M a[88:91],a[244:247],v[220:223],a[88:91]
buffer_load_dwordx4 a[216:219],v250,s[20:23],s48 offen offset:1024 sc1
M a[88:91],a[248:251],v[224:227],a[88:91]
ds_read_b128 a[240:243],v249 offset:26624
M a[92:95],a[248:251],v[228:231],0
M a[92:95],a[244:247],v[224:227],a[92:95]
M a[92:95],a[232:235],v[220:223],a[92:95]
s_waitcnt vmcnt(13) lgkmcnt(3)
buffer_load_dwordx4 a[220:223],v250,s[20:23],s48 offen offset:2048 sc1
M a[96:99],a[252:255],a[224:227],0
s_waitcnt vmcnt(13) lgkmcnt(2)
ds_read_b128 v[216:219],v248 offset:27136
M a[96:99],a[200:203],a[228:231],a[96:99]
s_waitcnt vmcnt(12) lgkmcnt(2)
ds_read_b128 a[248:251],v249 offset:27136
M a[96:99],a[196:199],a[236:239],a[96:99]
s_waitcnt lgkmcnt(2)
M a[100:103],a[196:199],a[240:243],0
M a[100:103],a[200:203],a[236:239],a[100:103]
M a[100:103],a[252:255],a[228:231],a[100:103]
M a[104:107],a[252:255],a[236:239],0
s_add_u32 s46,s72,27648
ds_read_b128 v[228:231],v248 offset:27648
M a[104:107],a[200:203],a[240:243],a[104:107]
s_waitcnt lgkmcnt(2)
ds_read_b128 a[244:247],v249 offset:27648
M a[104:107],a[196:199],v[216:219],a[104:107]
s_waitcnt lgkmcnt(2)
M a[108:111],a[196:199],a[248:251],0
M a[108:111],a[200:203],v[216:219],a[108:111]
M a[108:111],a[252:255],a[240:243],a[108:111]
M a[112:115],a[252:255],v[216:219],0
buffer_load_dwordx4 v[224:227],v250,s[20:23],s46 offen offset:0 sc1
M a[112:115],a[200:203],a[248:251],a[112:115]
s_waitcnt lgkmcnt(1)
ds_read_b128 a[232:235],v249 offset:28160
ds_read_b128 v[220:223],v248 offset:28160
M a[112:115],a[196:199],v[228:231],a[112:115]
s_waitcnt lgkmcnt(2)
M a[116:119],a[196:199],a[244:247],0
M a[116:119],a[200:203],v[228:231],a[116:119]
M a[116:119],a[252:255],a[248:251],a[116:119]
M a[120:123],a[252:255],v[228:231],0
M a[120:123],a[200:203],a[244:247],a[120:123]
s_waitcnt lgkmcnt(1)
M a[120:123],a[196:199],a[232:235],a[120:123]
s_waitcnt lgkmcnt(0)
M a[124:127],a[196:199],v[220:223],0
buffer_load_dwordx4 a[196:199],v250,s[20:23],s46 offen offset:1024 sc1
M a[124:127],a[200:203],a[232:235],a[124:127]
M a[124:127],a[252:255],a[244:247],a[124:127]
s_waitcnt vmcnt(13)
buffer_load_dwordx4 a[200:203],v250,s[20:23],s46 offen offset:2048 sc1
M a[128:131],a[192:195],a[224:227],0
s_waitcnt vmcnt(9)
s_add_u32 s47,s72,30720
M a[128:131],a[212:215],a[228:231],a[128:131]
s_waitcnt vmcnt(8)
M a[128:131],a[208:211],a[236:239],a[128:131]
M a[132:135],a[208:211],a[240:243],0
buffer_load_dwordx4 a[252:255],v250,s[20:23],s47 offen offset:0 sc1
M a[132:135],a[212:215],a[236:239],a[132:135]
M a[132:135],a[192:195],a[228:231],a[132:135]
M a[136:139],a[192:195],a[236:239],0
M a[136:139],a[212:215],a[240:243],a[136:139]
M a[136:139],a[208:211],v[216:219],a[136:139]
M a[140:143],a[208:211],a[248:251],0
M a[140:143],a[212:215],v[216:219],a[140:143]
M a[140:143],a[192:195],a[240:243],a[140:143]
M a[144:147],a[192:195],v[216:219],0
M a[144:147],a[212:215],a[248:251],a[144:147]
M a[144:147],a[208:211],v[228:231],a[144:147]
M a[148:151],a[208:211],a[244:247],0
M a[148:151],a[212:215],v[228:231],a[148:151]
M a[148:151],a[192:195],a[248:251],a[148:151]
M a[152:155],a[192:195],v[228:231],0
M a[152:155],a[212:215],a[244:247],a[152:155]
s_add_u32 s28,s68,393216
buffer_load_dwordx2 v[204:205],v245,s[12:15],s28 offen offset:0
M a[152:155],a[208:211],a[232:235],a[152:155]
M a[156:159],a[208:211],v[220:223],0
buffer_load_dwordx4 a[208:211],v250,s[20:23],s47 offen offset:1024 sc1
M a[156:159],a[212:215],a[232:235],a[156:159]
M a[156:159],a[192:195],a[244:247],a[156:159]
s_waitcnt vmcnt(8)
M a[160:163],a[204:207],a[224:227],0
s_waitcnt vmcnt(7)
M a[160:163],a[216:219],a[228:231],a[160:163]
s_waitcnt vmcnt(6)
buffer_load_dwordx4 a[212:215],v250,s[20:23],s47 offen offset:2048 sc1
M a[160:163],a[220:223],a[236:239],a[160:163]
M a[164:167],a[220:223],a[240:243],0
M a[164:167],a[216:219],a[236:239],a[164:167]
M a[164:167],a[204:207],a[228:231],a[164:167]
buffer_load_dwordx2 v[214:215],v245,s[16:19],s28 offen offset:1536
M a[168:171],a[204:207],a[236:239],0
s_add_u32 s48,s72,33792
M a[168:171],a[216:219],a[240:243],a[168:171]
M a[168:171],a[220:223],v[216:219],a[168:171]
M a[172:175],a[220:223],a[248:251],0
buffer_load_dwordx2 v[206:207],v245,s[8:11],s28 offen offset:0
M a[172:175],a[216:219],v[216:219],a[172:175]
M a[172:175],a[204:207],a[240:243],a[172:175]
M a[176:179],a[204:207],v[216:219],0
M a[176:179],a[216:219],a[248:251],a[176:179]
buffer_load_dwordx4 a[192:195],v250,s[20:23],s48 offen offset:0 sc1
M a[176:179],a[220:223],v[228:231],a[176:179]
M a[180:183],a[220:223],a[244:247],0
M a[180:183],a[216:219],v[228:231],a[180:183]
ds_read_b128 a[236:239],v248 offset:34816
M a[180:183],a[204:207],a[248:251],a[180:183]
buffer_load_dwordx4 a[224:227],v250,s[20:23],s48 offen offset:1024 sc1
M a[184:187],a[204:207],v[228:231],0
ds_read_b128 a[240:243],v249 offset:34816
ds_read_b128 v[216:219],v248 offset:35328
M a[184:187],a[216:219],a[244:247],a[184:187]
ds_read_b128 a[248:251],v249 offset:35328
M a[184:187],a[220:223],a[232:235],a[184:187]
M a[188:191],a[220:223],v[220:223],0
buffer_load_dwordx4 a[228:231],v250,s[20:23],s48 offen offset:2048 sc1
M a[188:191],a[216:219],a[232:235],a[188:191]
M a[188:191],a[204:207],a[244:247],a[188:191]
s_waitcnt vmcnt(11) lgkmcnt(3)
M v[0:3],v[224:227],a[236:239],0
s_waitcnt vmcnt(10) lgkmcnt(2)
ds_read_b128 v[228:231],v248 offset:35840
M v[0:3],a[196:199],a[240:243],v[0:3]
s_waitcnt vmcnt(9) lgkmcnt(2)
buffer_load_dwordx2 v[208:209],v245,s[8:11],s28 offen offset:384
M v[0:3],a[200:203],v[216:219],v[0:3]
s_waitcnt lgkmcnt(1)
ds_read_b128 a[220:223],v249 offset:35840
M v[4:7],a[200:203],a[248:251],0
M v[4:7],a[196:199],v[216:219],v[4:7]
M v[4:7],v[224:227],a[240:243],v[4:7]
buffer_load_dwordx2 v[210:211],v245,s[8:11],s28 offen offset:768
M v[8:11],v[224:227],v[216:219],0
s_add_u32 s46,s72,36864
ds_read_b128 v[220:223],v248 offset:36352
M v[8:11],a[196:199],a[248:251],v[8:11]
s_waitcnt lgkmcnt(2)
ds_read_b128 a[216:219],v249 offset:36352
M v[8:11],a[200:203],v[228:231],v[8:11]
s_waitcnt lgkmcnt(2)
M v[12:15],a[200:203],a[220:223],0
buffer_load_dwordx2 v[212:213],v245,s[8:11],s28 offen offset:1152
M v[12:15],a[196:199],v[228:231],v[12:15]
s_add_u32 s29,s68,0
M v[12:15],v[224:227],a[248:251],v[12:15]
M v[16:19],v[224:227],v[228:231],0
ds_read_b128 a[204:207],v249 offset:36864
M v[16:19],a[196:199],a[220:223],v[16:19]
s_waitcnt lgkmcnt(2)
buffer_load_dwordx4 a[232:235],v250,s[20:23],s46 offen offset:0 sc1
M v[16:19],a[200:203],v[220:223],v[16:19]
s_waitcnt lgkmcnt(1)
ds_read_b128 a[244:247],v248 offset:36864
M v[20:23],a[200:203],a[216:219],0
M v[20:23],a[196:199],v[220:223],v[20:23]
M v[20:23],v[224:227],a[220:223],v[20:23]
buffer_load_short_d16_hi v239,v246,s[12:15],s29 offen offset:0
M v[24:27],v[224:227],v[220:223],0
M v[24:27],a[196:199],a[216:219],v[24:27]
s_waitcnt lgkmcnt(1)
buffer_load_short_d16_hi v240,v246,s[8:11],s29 offen offset:0
M v[24:27],a[200:203],a[204:207],v[24:27]
s_waitcnt lgkmcnt(0)
M v[28:31],a[200:203],a[244:247],0
buffer_load_dwordx4 a[200:203],v250,s[20:23],s46 offen offset:1024 sc1
M v[28:31],a[196:199],a[204:207],v[28:31]
M v[28:31],v[224:227],a[216:219],v[28:31]
s_waitcnt vmcnt(15)
M v[32:35],a[252:255],a[236:239],0
s_waitcnt vmcnt(13)
M v[32:35],a[208:211],a[240:243],v[32:35]
s_waitcnt vmcnt(12)
buffer_load_dwordx4 a[196:199],v250,s[20:23],s46 offen offset:2048 sc1
M v[32:35],a[212:215],v[216:219],v[32:35]
s_add_u32 s47,s72,39936
M v[36:39],a[212:215],a[248:251],0
M v[36:39],a[208:211],v[216:219],v[36:39]
M v[36:39],a[252:255],a[240:243],v[36:39]
buffer_load_dwordx4 v[224:227],v250,s[20:23],s47 offen offset:0 sc1
M v[40:43],a[252:255],v[216:219],0
M v[40:43],a[208:211],a[248:251],v[40:43]
M v[40:43],a[212:215],v[228:231],v[40:43]
M v[44:47],a[212:215],a[220:223],0
buffer_load_short_d16_hi v241,v246,s[8:11],s29 offen offset:384
M v[44:47],a[208:211],v[228:231],v[44:47]
M v[44:47],a[252:255],a[248:251],v[44:47]
buffer_load_short_d16_hi v242,v246,s[8:11],s29 offen offset:768
M v[48:51],a[252:255],v[228:231],0
M v[48:51],a[208:211],a[220:223],v[48:51]
buffer_load_short_d16_hi v243,v246,s[8:11],s29 offen offset:1152
M v[48:51],a[212:215],v[220:223],v[48:51]
M v[52:55],a[212:215],a[216:219],0
buffer_load_short_d16_hi v244,v246,s[16:19],s29 offen offset:1536
M v[52:55],a[208:211],v[220:223],v[52:55]
M v[52:55],a[252:255],a[220:223],v[52:55]
M v[56:59],a[252:255],v[220:223],0
M v[56:59],a[208:211],a[216:219],v[56:59]
M v[56:59],a[212:215],a[204:207],v[56:59]
M v[60:63],a[212:215],a[244:247],0
buffer_load_dwordx4 a[212:215],v250,s[20:23],s47 offen offset:1024 sc1
M v[60:63],a[208:211],a[204:207],v[60:63]
M v[60:63],a[252:255],a[216:219],v[60:63]
s_waitcnt vmcnt(16)
buffer_load_dwordx4 a[208:211],v250,s[20:23],s47 offen offset:2048 sc1
M v[64:67],a[192:195],a[236:239],0
s_waitcnt vmcnt(16)
s_add_u32 s48,s72,43008
M v[64:67],a[224:227],a[240:243],v[64:67]
s_waitcnt vmcnt(15)
M v[64:67],a[228:231],v[216:219],v[64:67]
M v[68:71],a[228:231],a[248:251],0
buffer_load_dwordx4 a[252:255],v250,s[20:23],s48 offen offset:0 sc1
M v[68:71],a[224:227],v[216:219],v[68:71]
M v[68:71],a[192:195],a[240:243],v[68:71]
M v[72:75],a[192:195],v[216:219],0
M v[72:75],a[224:227],a[248:251],v[72:75]
buffer_load_dwordx4 a[236:239],v250,s[20:23],s48 offen offset:1024 sc1
M v[72:75],a[228:231],v[228:231],v[72:75]
M v[76:79],a[228:231],a[220:223],0
M v[76:79],a[224:227],v[228:231],v[76:79]
M v[76:79],a[192:195],a[248:251],v[76:79]
buffer_load_dwordx4 a[240:243],v250,s[20:23],s48 offen offset:2048 sc1
M v[80:83],a[192:195],v[228:231],0
s_add_u32 s46,s73,9216
M v[80:83],a[224:227],a[220:223],v[80:83]
M v[80:83],a[228:231],v[220:223],v[80:83]
M v[84:87],a[228:231],a[216:219],0
buffer_load_dwordx4 v[216:219],v250,s[20:23],s46 offen offset:0 sc1
M v[84:87],a[224:227],v[220:223],v[84:87]
ds_read_b128 a[248:251],v248 offset:43520
M v[84:87],a[192:195],a[220:223],v[84:87]
ds_read_b128 v[228:231],v249 offset:43520
M v[88:91],a[192:195],v[220:223],0
ds_read_b128 a[220:223],v248 offset:44032
M v[88:91],a[224:227],a[216:219],v[88:91]
ds_read_b128 v[220:223],v249 offset:44032
M v[88:91],a[228:231],a[204:207],v[88:91]
M v[92:95],a[228:231],a[244:247],0
M v[92:95],a[224:227],a[204:207],v[92:95]
M v[92:95],a[192:195],a[216:219],v[92:95]
s_waitcnt vmcnt(15) lgkmcnt(3)
M v[96:99],a[232:235],a[248:251],0
s_waitcnt vmcnt(12) lgkmcnt(2)
ds_read_b128 a[228:231],v248 offset:44544
M v[96:99],a[200:203],v[228:231],v[96:99]
s_waitcnt vmcnt(11) lgkmcnt(2)
ds_read_b128 a[244:247],v249 offset:44544
M v[96:99],a[196:199],a[220:223],v[96:99]
s_waitcnt lgkmcnt(2)
M v[100:103],a[196:199],v[220:223],0
M v[100:103],a[200:203],a[220:223],v[100:103]
M v[100:103],a[232:235],v[228:231],v[100:103]
M v[104:107],a[232:235],a[220:223],0
ds_read_b128 a[204:207],v248 offset:45056
M v[104:107],a[200:203],v[220:223],v[104:107]
s_waitcnt lgkmcnt(2)
ds_read_b128 a[224:227],v249 offset:45056
M v[104:107],a[196:199],a[228:231],v[104:107]
s_waitcnt lgkmcnt(2)
M v[108:111],a[196:199],a[244:247],0
v_lshlrev_b32 v234,16,v196
v_lshlrev_b32 v232,16,v192
M v[108:111],a[200:203],a[228:231],v[108:111]
v_lshlrev_b32 v233,16,v194
v_lshlrev_b32 v237,16,v202
M v[108:111],a[232:235],v[220:223],v[108:111]
v_lshlrev_b32 v236,16,v200
v_lshlrev_b32 v235,16,v198
M v[112:115],a[232:235],a[228:231],0
ds_read_b128 a[192:195],v249 offset:45568
v_fmac_f32 v232,s43,v234
M v[112:115],a[200:203],a[244:247],v[112:115]
s_waitcnt lgkmcnt(2)
ds_read_b128 a[216:219],v248 offset:45568
v_fmac_f32 v237,4.0,v233
M v[112:115],a[196:199],a[204:207],v[112:115]
s_waitcnt lgkmcnt(2)
v_fma_f32 v238,-4.0,v234,v236
v_fmac_f32 v232,s45,v236
M v[116:119],a[196:199],a[224:227],0
v_fmac_f32 v237,s41,v235
v_sub_f32 v236,v236,v234
M v[116:119],a[200:203],a[204:207],v[116:119]
v_fma_f32 v234,-4.0,v233,v235
v_sub_f32 v235,v235,v233
M v[116:119],a[232:235],a[244:247],v[116:119]
v_add_f32 v233,v238,v234
v_sub_f32 v238,v238,v234
M v[120:123],a[232:235],a[204:207],0
v_fma_f32 v234,2.0,v235,v236
v_fmac_f32 v236,-2.0,v235
M v[120:123],a[200:203],a[224:227],v[120:123]
s_waitcnt lgkmcnt(1)
v_and_b32 v196,s42,v196
v_and_b32 v192,s42,v192
M v[120:123],a[196:199],a[192:195],v[120:123]
s_waitcnt lgkmcnt(0)
v_and_b32 v194,s42,v194
v_and_b32 v202,s42,v202
M v[124:127],a[196:199],a[216:219],0
buffer_load_dwordx4 a[196:199],v250,s[20:23],s46 offen offset:1024 sc1
M v[124:127],a[200:203],a[192:195],v[124:127]
v_and_b32 v200,s42,v200
v_and_b32 v198,s42,v198
M v[124:127],a[232:235],a[224:227],v[124:127]
s_waitcnt vmcnt(11)
buffer_load_dwordx4 a[200:203],v250,s[20:23],s46 offen offset:2048 sc1
M v[128:131],v[224:227],a[248:251],0
s_waitcnt vmcnt(7)
s_add_u32 s47,s73,12288
v_fmac_f32 v192,s43,v196
v_fmac_f32 v202,4.0,v194
M v[128:131],a[212:215],v[228:231],v[128:131]
s_waitcnt vmcnt(6)
v_fma_f32 v235,-4.0,v196,v200
v_fmac_f32 v192,s45,v200
M v[128:131],a[208:211],a[220:223],v[128:131]
v_fmac_f32 v202,s41,v198
v_sub_f32 v200,v200,v196
M v[132:135],a[208:211],v[220:223],0
buffer_load_dwordx4 a[232:235],v250,s[20:23],s47 offen offset:0 sc1
M v[132:135],a[212:215],a[220:223],v[132:135]
v_fma_f32 v196,-4.0,v194,v198
v_sub_f32 v198,v198,v194
M v[132:135],v[224:227],v[228:231],v[132:135]
v_add_f32 v194,v235,v196
v_sub_f32 v235,v235,v196
M v[136:139],v[224:227],a[220:223],0
v_fma_f32 v196,2.0,v198,v200
v_fmac_f32 v200,-2.0,v198
M v[136:139],a[212:215],v[220:223],v[136:139]
v_cvt_pk_bf16_f32 v192,v232,v192
v_cvt_pk_bf16_f32 v202,v237,v202
M v[136:139],a[208:211],a[228:231],v[136:139]
v_cvt_pk_bf16_f32 v194,v233,v194
v_cvt_pk_bf16_f32 v198,v234,v196
M v[140:143],a[208:211],a[244:247],0
v_cvt_pk_bf16_f32 v196,v238,v235
v_cvt_pk_bf16_f32 v200,v236,v200
M v[140:143],a[212:215],a[228:231],v[140:143]
v_lshlrev_b32 v234,16,v197
v_lshlrev_b32 v232,16,v193
M v[140:143],v[224:227],v[220:223],v[140:143]
v_lshlrev_b32 v233,16,v195
v_lshlrev_b32 v237,16,v203
M v[144:147],v[224:227],a[228:231],0
v_lshlrev_b32 v236,16,v201
v_lshlrev_b32 v235,16,v199
M v[144:147],a[212:215],a[244:247],v[144:147]
v_fmac_f32 v232,s43,v234
v_fmac_f32 v237,4.0,v233
M v[144:147],a[208:211],a[204:207],v[144:147]
v_fma_f32 v238,-4.0,v234,v236
v_fmac_f32 v232,s45,v236
M v[148:151],a[208:211],a[224:227],0
v_fmac_f32 v237,s41,v235
v_sub_f32 v236,v236,v234
M v[148:151],a[212:215],a[204:207],v[148:151]
v_fma_f32 v234,-4.0,v233,v235
v_sub_f32 v235,v235,v233
M v[148:151],v[224:227],a[244:247],v[148:151]
v_add_f32 v233,v238,v234
v_sub_f32 v238,v238,v234
M v[152:155],v[224:227],a[204:207],0
v_fma_f32 v234,2.0,v235,v236
v_fmac_f32 v236,-2.0,v235
M v[152:155],a[212:215],a[224:227],v[152:155]
v_and_b32 v197,s42,v197
v_and_b32 v193,s42,v193
M v[152:155],a[208:211],a[192:195],v[152:155]
v_and_b32 v195,s42,v195
v_and_b32 v203,s42,v203
M v[156:159],a[208:211],a[216:219],0
buffer_load_dwordx4 a[208:211],v250,s[20:23],s47 offen offset:1024 sc1
M v[156:159],a[212:215],a[192:195],v[156:159]
v_and_b32 v201,s42,v201
v_and_b32 v199,s42,v199
M v[156:159],v[224:227],a[224:227],v[156:159]
s_waitcnt vmcnt(7)
buffer_load_dwordx4 a[212:215],v250,s[20:23],s47 offen offset:2048 sc1
M v[160:163],a[252:255],a[248:251],0
s_waitcnt vmcnt(7)
s_add_u32 s48,s73,15360
v_fmac_f32 v193,s43,v197
v_fmac_f32 v203,4.0,v195
M v[160:163],a[236:239],v[228:231],v[160:163]
s_waitcnt vmcnt(6)
v_fma_f32 v235,-4.0,v197,v201
v_fmac_f32 v193,s45,v201
M v[160:163],a[240:243],a[220:223],v[160:163]
v_fmac_f32 v203,s41,v199
v_sub_f32 v201,v201,v197
M v[164:167],a[240:243],v[220:223],0
buffer_load_dwordx4 v[224:227],v250,s[20:23],s48 offen offset:0 sc1
M v[164:167],a[236:239],a[220:223],v[164:167]
v_fma_f32 v197,-4.0,v195,v199
v_sub_f32 v199,v199,v195
M v[164:167],a[252:255],v[228:231],v[164:167]
v_add_f32 v195,v235,v197
v_sub_f32 v235,v235,v197
M v[168:171],a[252:255],a[220:223],0
v_fma_f32 v197,2.0,v199,v201
v_fmac_f32 v201,-2.0,v199
M v[168:171],a[236:239],v[220:223],v[168:171]
buffer_load_dwordx4 a[248:251],v250,s[20:23],s48 offen offset:1024 sc1
M v[168:171],a[240:243],a[228:231],v[168:171]
v_cvt_pk_bf16_f32 v193,v232,v193
v_cvt_pk_bf16_f32 v203,v237,v203
M v[172:175],a[240:243],a[244:247],0
v_cvt_pk_bf16_f32 v195,v233,v195
v_cvt_pk_bf16_f32 v199,v234,v197
M v[172:175],a[236:239],a[228:231],v[172:175]
v_cvt_pk_bf16_f32 v197,v238,v235
v_cvt_pk_bf16_f32 v201,v236,v201
M v[172:175],a[252:255],v[220:223],v[172:175]
buffer_load_dwordx4 v[228:231],v250,s[20:23],s48 offen offset:2048 sc1
M v[176:179],a[252:255],a[228:231],0
s_add_u32 s46,s73,18432
v_lshlrev_b32 v234,16,v208
v_lshlrev_b32 v232,16,v204
M v[176:179],a[236:239],a[244:247],v[176:179]
v_lshlrev_b32 v233,16,v206
v_lshlrev_b32 v237,16,v214
M v[176:179],a[240:243],a[204:207],v[176:179]
s_barrier
v_lshlrev_b32 v236,16,v212
M v[180:183],a[240:243],a[224:227],0
buffer_load_dwordx4 a[220:223],v250,s[20:23],s46 offen offset:0 sc1
M v[180:183],a[236:239],a[204:207],v[180:183]
ds_read_b128 v[220:223],v248 offset:52224
v_lshlrev_b32 v235,16,v210
M v[180:183],a[252:255],a[244:247],v[180:183]
ds_write2st64_b64 v247,v[192:193],v[202:203] offset0:204 offset1:221
M v[184:187],a[252:255],a[204:207],0
s_add_u32 s28,s68,786432
ds_read_b128 a[228:231],v249 offset:52224
ds_read_b128 a[244:247],v248 offset:52736
M v[184:187],a[236:239],a[224:227],v[184:187]
buffer_load_dwordx2 v[192:193],v245,s[12:15],s28 offen offset:0
M v[184:187],a[240:243],a[192:195],v[184:187]
ds_write2st64_b64 v247,v[194:195],v[196:197] offset0:34 offset1:51
M v[188:191],a[240:243],a[216:219],0
ds_read_b128 a[204:207],v249 offset:52736
v_fmac_f32 v232,s43,v234
M v[188:191],a[236:239],a[192:195],v[188:191]
buffer_load_dwordx2 v[202:203],v245,s[16:19],s28 offen offset:1536
M v[188:191],a[252:255],a[224:227],v[188:191]
s_waitcnt vmcnt(11) lgkmcnt(5)
ds_write2st64_b64 v247,v[198:199],v[200:201] offset0:68 offset1:85
M a[0:3],v[216:219],v[220:223],a[0:3]
s_waitcnt vmcnt(10) lgkmcnt(4)
ds_read_b128 a[216:219],v248 offset:53248
v_fmac_f32 v237,4.0,v233
M a[0:3],a[196:199],a[228:231],a[0:3]
s_waitcnt vmcnt(9) lgkmcnt(4)
buffer_load_dwordx2 v[194:195],v245,s[8:11],s28 offen offset:0
M a[0:3],a[200:203],a[244:247],a[0:3]
s_waitcnt lgkmcnt(2)
ds_read_b128 a[240:243],v249 offset:53248
v_fma_f32 v238,-4.0,v234,v236
M a[4:7],a[200:203],a[204:207],a[4:7]
v_fmac_f32 v232,s45,v236
v_fmac_f32 v237,s41,v235
M a[4:7],a[196:199],a[244:247],a[4:7]
v_sub_f32 v236,v236,v234
v_fma_f32 v234,-4.0,v233,v235
M a[4:7],v[216:219],a[228:231],a[4:7]
buffer_load_dwordx2 v[196:197],v245,s[8:11],s28 offen offset:384
M a[8:11],v[216:219],a[244:247],a[8:11]
ds_read_b128 a[192:195],v248 offset:53760
v_sub_f32 v235,v235,v233
M a[8:11],a[196:199],a[204:207],a[8:11]
s_waitcnt lgkmcnt(2)
ds_read_b128 a[236:239],v249 offset:53760
v_add_f32 v233,v238,v234
M a[8:11],a[200:203],a[216:219],a[8:11]
s_waitcnt lgkmcnt(2)
v_sub_f32 v238,v238,v234
v_fma_f32 v234,2.0,v235,v236
M a[12:15],a[200:203],a[240:243],a[12:15]
buffer_load_dwordx2 v[198:199],v245,s[8:11],s28 offen offset:768
M a[12:15],a[196:199],a[216:219],a[12:15]
v_fmac_f32 v236,-2.0,v235
v_and_b32 v208,s42,v208
M a[12:15],v[216:219],a[204:207],a[12:15]
v_and_b32 v204,s42,v204
v_and_b32 v206,s42,v206
M a[16:19],v[216:219],a[216:219],a[16:19]
ds_read_b128 a[224:227],v249 offset:54272
v_and_b32 v214,s42,v214
M a[16:19],a[196:199],a[240:243],a[16:19]
s_waitcnt lgkmcnt(2)
buffer_load_dwordx2 v[200:201],v245,s[8:11],s28 offen offset:1152
M a[16:19],a[200:203],a[192:195],a[16:19]
s_waitcnt lgkmcnt(1)
ds_read_b128 a[252:255],v248 offset:54272
v_and_b32 v212,s42,v212
M a[20:23],a[200:203],a[236:239],a[20:23]
v_and_b32 v210,s42,v210
v_fmac_f32 v204,s43,v208
M a[20:23],a[196:199],a[192:195],a[20:23]
v_fmac_f32 v214,4.0,v206
v_fma_f32 v235,-4.0,v208,v212
M a[20:23],v[216:219],a[240:243],a[20:23]
v_fmac_f32 v204,s45,v212
v_fmac_f32 v214,s41,v210
M a[24:27],v[216:219],a[192:195],a[24:27]
v_sub_f32 v212,v212,v208
v_fma_f32 v208,-4.0,v206,v210
M a[24:27],a[196:199],a[236:239],a[24:27]
s_waitcnt lgkmcnt(1)
v_sub_f32 v210,v210,v206
v_add_f32 v206,v235,v208
M a[24:27],a[200:203],a[224:227],a[24:27]
s_waitcnt lgkmcnt(0)
v_sub_f32 v235,v235,v208
v_fma_f32 v208,2.0,v210,v212
M a[28:31],a[200:203],a[252:255],a[28:31]
buffer_load_dwordx4 a[200:203],v250,s[20:23],s46 offen offset:1024 sc1
M a[28:31],a[196:199],a[224:227],a[28:31]
v_fmac_f32 v212,-2.0,v210
v_cvt_pk_bf16_f32 v204,v232,v204
M a[28:31],v[216:219],a[236:239],a[28:31]
s_waitcnt vmcnt(13)
buffer_load_dwordx4 a[196:199],v250,s[20:23],s46 offen offset:2048 sc1
M a[32:35],a[232:235],v[220:223],a[32:35]
s_waitcnt vmcnt(13)
s_add_u32 s47,s73,21504
v_cvt_pk_bf16_f32 v214,v237,v214
v_cvt_pk_bf16_f32 v206,v233,v206
M a[32:35],a[208:211],a[228:231],a[32:35]
s_waitcnt vmcnt(12)
v_cvt_pk_bf16_f32 v210,v234,v208
v_cvt_pk_bf16_f32 v208,v238,v235
M a[32:35],a[212:215],a[244:247],a[32:35]
v_cvt_pk_bf16_f32 v212,v236,v212
v_lshlrev_b32 v234,16,v209
M a[36:39],a[212:215],a[204:207],a[36:39]
buffer_load_dwordx4 v[216:219],v250,s[20:23],s47 offen offset:0 sc1
M a[36:39],a[208:211],a[244:247],a[36:39]
v_lshlrev_b32 v232,16,v205
v_lshlrev_b32 v233,16,v207
M a[36:39],a[232:235],a[228:231],a[36:39]
v_lshlrev_b32 v237,16,v215
v_lshlrev_b32 v236,16,v213
M a[40:43],a[232:235],a[244:247],a[40:43]
v_lshlrev_b32 v235,16,v211
v_fmac_f32 v232,s43,v234
M a[40:43],a[208:211],a[204:207],a[40:43]
v_fmac_f32 v237,4.0,v233
v_fma_f32 v238,-4.0,v234,v236
M a[40:43],a[212:215],a[216:219],a[40:43]
v_fmac_f32 v232,s45,v236
v_fmac_f32 v237,s41,v235
M a[44:47],a[212:215],a[240:243],a[44:47]
v_sub_f32 v236,v236,v234
v_fma_f32 v234,-4.0,v233,v235
M a[44:47],a[208:211],a[216:219],a[44:47]
v_sub_f32 v235,v235,v233
v_add_f32 v233,v238,v234
M a[44:47],a[232:235],a[204:207],a[44:47]
v_sub_f32 v238,v238,v234
v_fma_f32 v234,2.0,v235,v236
M a[48:51],a[232:235],a[216:219],a[48:51]
v_fmac_f32 v236,-2.0,v235
v_and_b32 v209,s42,v209
M a[48:51],a[208:211],a[240:243],a[48:51]
v_and_b32 v205,s42,v205
v_and_b32 v207,s42,v207
M a[48:51],a[212:215],a[192:195],a[48:51]
v_and_b32 v215,s42,v215
v_and_b32 v213,s42,v213
M a[52:55],a[212:215],a[236:239],a[52:55]
v_and_b32 v211,s42,v211
v_fmac_f32 v205,s43,v209
M a[52:55],a[208:211],a[192:195],a[52:55]
v_fmac_f32 v215,4.0,v207
v_fma_f32 v235,-4.0,v209,v213
M a[52:55],a[232:235],a[240:243],a[52:55]
v_fmac_f32 v205,s45,v213
v_fmac_f32 v215,s41,v211
M a[56:59],a[232:235],a[192:195],a[56:59]
v_sub_f32 v213,v213,v209
v_fma_f32 v209,-4.0,v207,v211
M a[56:59],a[208:211],a[236:239],a[56:59]
v_sub_f32 v211,v211,v207
v_add_f32 v207,v235,v209
M a[56:59],a[212:215],a[224:227],a[56:59]
v_sub_f32 v235,v235,v209
v_fma_f32 v209,2.0,v211,v213
M a[60:63],a[212:215],a[252:255],a[60:63]
buffer_load_dwordx4 a[212:215],v250,s[20:23],s47 offen offset:1024 sc1
M a[60:63],a[208:211],a[224:227],a[60:63]
v_fmac_f32 v213,-2.0,v211
v_cvt_pk_bf16_f32 v205,v232,v205
M a[60:63],a[232:235],a[236:239],a[60:63]
s_waitcnt vmcnt(13)
buffer_load_dwordx4 a[208:211],v250,s[20:23],s47 offen offset:2048 sc1
M a[64:67],v[224:227],v[220:223],a[64:67]
s_waitcnt vmcnt(13)
s_add_u32 s48,s73,24576
v_cvt_pk_bf16_f32 v215,v237,v215
v_cvt_pk_bf16_f32 v207,v233,v207
M a[64:67],a[248:251],a[228:231],a[64:67]
s_waitcnt vmcnt(12)
v_cvt_pk_bf16_f32 v211,v234,v209
v_cvt_pk_bf16_f32 v209,v238,v235
M a[64:67],v[228:231],a[244:247],a[64:67]
v_cvt_pk_bf16_f32 v213,v236,v213
v_fmac_f32 v239,s43,v241
M a[68:71],v[228:231],a[204:207],a[68:71]
buffer_load_dwordx4 a[232:235],v250,s[20:23],s48 offen offset:0 sc1
M a[68:71],a[248:251],a[244:247],a[68:71]
v_fmac_f32 v244,4.0,v240
v_fma_f32 v232,-4.0,v241,v243
M a[68:71],v[224:227],a[228:231],a[68:71]
ds_write2st64_b64 v247,v[204:205],v[214:215] offset0:205 offset1:222
M a[72:75],v[224:227],a[244:247],a[72:75]
s_add_u32 s28,s68,1179648
v_fmac_f32 v239,s45,v243
v_fmac_f32 v244,s41,v242
M a[72:75],a[248:251],a[204:207],a[72:75]
buffer_load_dwordx4 v[220:223],v250,s[20:23],s48 offen offset:1024 sc1
M a[72:75],v[228:231],a[216:219],a[72:75]
ds_write2st64_b64 v247,v[206:207],v[208:209] offset0:35 offset1:52
M a[76:79],v[228:231],a[240:243],a[76:79]
v_sub_f32 v243,v243,v241
v_fma_f32 v241,-4.0,v240,v242
M a[76:79],a[248:251],a[216:219],a[76:79]
buffer_load_dwordx4 a[228:231],v250,s[20:23],s48 offen offset:2048 sc1
M a[76:79],v[224:227],a[204:207],a[76:79]
s_add_u32 s46,s73,27648
ds_write2st64_b64 v247,v[210:211],v[212:213] offset0:69 offset1:86
M a[80:83],v[224:227],a[216:219],a[80:83]
v_sub_f32 v242,v242,v240
v_add_f32 v240,v232,v241
M a[80:83],a[248:251],a[240:243],a[80:83]
buffer_load_dwordx4 a[244:247],v250,s[20:23],s46 offen offset:0 sc1
M a[80:83],v[228:231],a[192:195],a[80:83]
v_sub_f32 v232,v232,v241
v_fma_f32 v241,2.0,v242,v243
M a[84:87],v[228:231],a[236:239],a[84:87]
v_fmac_f32 v243,-2.0,v242
v_cvt_pk_bf16_f32 v233,v239,v244
M a[84:87],a[248:251],a[192:195],a[84:87]
ds_read_b128 a[204:207],v248 offset:60928
v_cvt_pk_bf16_f32 v234,v240,v232
M a[84:87],v[224:227],a[240:243],a[84:87]
buffer_load_dwordx2 v[204:205],v245,s[12:15],s28 offen offset:0
M a[88:91],v[224:227],a[192:195],a[88:91]
ds_read_b128 a[216:219],v249 offset:60928
ds_read_b128 a[240:243],v248 offset:61440
M a[88:91],a[248:251],a[236:239],a[88:91]
ds_read_b128 a[192:195],v249 offset:61440
v_cvt_pk_bf16_f32 v235,v241,v243
M a[88:91],v[228:231],a[224:227],a[88:91]
v_add_u32 v232,104448,v252
M a[92:95],v[228:231],a[252:255],a[92:95]
buffer_load_dwordx2 v[214:215],v245,s[16:19],s28 offen offset:1536
M a[92:95],a[248:251],a[224:227],a[92:95]
ds_write_b16 v232,v233 offset:0
M a[92:95],v[224:227],a[236:239],a[92:95]
s_waitcnt vmcnt(17) lgkmcnt(4)
ds_write_b16_d16_hi v232,v233 offset:8704
M a[96:99],a[220:223],a[204:207],a[96:99]
s_waitcnt vmcnt(10) lgkmcnt(4)
ds_read_b128 a[252:255],v248 offset:61952
ds_write_b16 v252,v234 offset:17408
M a[96:99],a[200:203],a[216:219],a[96:99]
s_waitcnt vmcnt(9) lgkmcnt(5)
buffer_load_dwordx2 v[206:207],v245,s[8:11],s28 offen offset:0
M a[96:99],a[196:199],a[240:243],a[96:99]
s_waitcnt lgkmcnt(4)
ds_read_b128 v[228:231],v249 offset:61952
ds_write_b16_d16_hi v252,v234 offset:26112
M a[100:103],a[196:199],a[192:195],a[100:103]
ds_write_b16 v252,v235 offset:34816
M a[100:103],a[200:203],a[240:243],a[100:103]
ds_write_b16_d16_hi v252,v235 offset:43520
M a[100:103],a[220:223],a[216:219],a[100:103]
buffer_load_dwordx2 v[208:209],v245,s[8:11],s28 offen offset:384
M a[104:107],a[220:223],a[240:243],a[104:107]
ds_read_b128 a[224:227],v248 offset:62464
v_lshlrev_b32 v234,16,v196
M a[104:107],a[200:203],a[192:195],a[104:107]
s_waitcnt lgkmcnt(6)
ds_read_b128 a[248:251],v249 offset:62464
v_lshlrev_b32 v232,16,v192
M a[104:107],a[196:199],a[252:255],a[104:107]
s_waitcnt lgkmcnt(5)
v_lshlrev_b32 v233,16,v194
v_lshlrev_b32 v237,16,v202
M a[108:111],a[196:199],v[228:231],a[108:111]
buffer_load_dwordx2 v[210:211],v245,s[8:11],s28 offen offset:768
M a[108:111],a[200:203],a[252:255],a[108:111]
v_lshlrev_b32 v236,16,v200
v_lshlrev_b32 v235,16,v198
M a[108:111],a[220:223],a[192:195],a[108:111]
v_fmac_f32 v232,s43,v234
v_fmac_f32 v237,4.0,v233
M a[112:115],a[220:223],a[252:255],a[112:115]
ds_read_b128 a[236:239],v249 offset:62976
v_fma_f32 v238,-4.0,v234,v236
M a[112:115],a[200:203],v[228:231],a[112:115]
s_waitcnt lgkmcnt(2)
buffer_load_dwordx2 v[212:213],v245,s[8:11],s28 offen offset:1152
M a[112:115],a[196:199],a[224:227],a[112:115]
s_waitcnt lgkmcnt(1)
s_add_u32 s29,s69,0
ds_read_b128 v[224:227],v248 offset:62976
v_fmac_f32 v232,s45,v236
M a[116:119],a[196:199],a[248:251],a[116:119]
v_fmac_f32 v237,s41,v235
v_sub_f32 v236,v236,v234
M a[116:119],a[200:203],a[224:227],a[116:119]
v_fma_f32 v234,-4.0,v233,v235
v_sub_f32 v235,v235,v233
M a[116:119],a[220:223],v[228:231],a[116:119]
buffer_load_short_d16_hi v239,v246,s[12:15],s29 offen offset:0
M a[120:123],a[220:223],a[224:227],a[120:123]
v_add_f32 v233,v238,v234
v_sub_f32 v238,v238,v234
M a[120:123],a[200:203],a[248:251],a[120:123]
s_waitcnt lgkmcnt(1)
buffer_load_short_d16_hi v240,v246,s[8:11],s29 offen offset:0
M a[120:123],a[196:199],a[236:239],a[120:123]
s_waitcnt lgkmcnt(0)
v_fma_f32 v234,2.0,v235,v236
v_fmac_f32 v236,-2.0,v235
M a[124:127],a[196:199],v[224:227],a[124:127]
buffer_load_dwordx4 a[196:199],v250,s[20:23],s46 offen offset:1024 sc1
M a[124:127],a[200:203],a[236:239],a[124:127]
v_and_b32 v196,s42,v196
v_and_b32 v192,s42,v192
M a[124:127],a[220:223],a[248:251],a[124:127]
s_waitcnt vmcnt(15)
v_and_b32 v194,s42,v194
v_and_b32 v202,s42,v202
M a[128:131],v[216:219],a[204:207],a[128:131]
s_waitcnt vmcnt(14)
v_and_b32 v200,s42,v200
v_and_b32 v198,s42,v198
M a[128:131],a[212:215],a[216:219],a[128:131]
s_waitcnt vmcnt(13)
buffer_load_dwordx4 a[200:203],v250,s[20:23],s46 offen offset:2048 sc1
M a[128:131],a[208:211],a[240:243],a[128:131]
s_add_u32 s47,s73,30720
v_fmac_f32 v192,s43,v196
v_fmac_f32 v202,4.0,v194
M a[132:135],a[208:211],a[192:195],a[132:135]
v_fma_f32 v235,-4.0,v196,v200
v_fmac_f32 v192,s45,v200
M a[132:135],a[212:215],a[240:243],a[132:135]
v_fmac_f32 v202,s41,v198
v_sub_f32 v200,v200,v196
M a[132:135],v[216:219],a[216:219],a[132:135]
buffer_load_dwordx4 a[220:223],v250,s[20:23],s47 offen offset:0 sc1
M a[136:139],v[216:219],a[240:243],a[136:139]
v_fma_f32 v196,-4.0,v194,v198
v_sub_f32 v198,v198,v194
M a[136:139],a[212:215],a[192:195],a[136:139]
v_add_f32 v194,v235,v196
v_sub_f32 v235,v235,v196
M a[136:139],a[208:211],a[252:255],a[136:139]
v_fma_f32 v196,2.0,v198,v200
v_fmac_f32 v200,-2.0,v198
M a[140:143],a[208:211],v[228:231],a[140:143]
buffer_load_short_d16_hi v241,v246,s[8:11],s29 offen offset:384
M a[140:143],a[212:215],a[252:255],a[140:143]
v_cvt_pk_bf16_f32 v192,v232,v192
v_cvt_pk_bf16_f32 v202,v237,v202
M a[140:143],v[216:219],a[192:195],a[140:143]
buffer_load_short_d16_hi v242,v246,s[8:11],s29 offen offset:768
M a[144:147],v[216:219],a[252:255],a[144:147]
v_cvt_pk_bf16_f32 v194,v233,v194
v_cvt_pk_bf16_f32 v198,v234,v196
M a[144:147],a[212:215],v[228:231],a[144:147]
buffer_load_short_d16_hi v243,v246,s[8:11],s29 offen offset:1152
M a[144:147],a[208:211],a[224:227],a[144:147]
v_cvt_pk_bf16_f32 v196,v238,v235
v_cvt_pk_bf16_f32 v200,v236,v200
M a[148:151],a[208:211],a[248:251],a[148:151]
buffer_load_short_d16_hi v244,v246,s[16:19],s29 offen offset:1536
M a[148:151],a[212:215],a[224:227],a[148:151]
v_lshlrev_b32 v234,16,v197
v_lshlrev_b32 v232,16,v193
M a[148:151],v[216:219],v[228:231],a[148:151]
v_lshlrev_b32 v233,16,v195
v_lshlrev_b32 v237,16,v203
M a[152:155],v[216:219],a[224:227],a[152:155]
v_lshlrev_b32 v236,16,v201
v_lshlrev_b32 v235,16,v199
M a[152:155],a[212:215],a[248:251],a[152:155]
v_fmac_f32 v232,s43,v234
v_fmac_f32 v237,4.0,v233
M a[152:155],a[208:211],a[236:239],a[152:155]
v_fma_f32 v238,-4.0,v234,v236
v_fmac_f32 v232,s45,v236
M a[156:159],a[208:211],v[224:227],a[156:159]
buffer_load_dwordx4 a[208:211],v250,s[20:23],s47 offen offset:1024 sc1
M a[156:159],a[212:215],a[236:239],a[156:159]
v_fmac_f32 v237,s41,v235
v_sub_f32 v236,v236,v234
M a[156:159],v[216:219],a[248:251],a[156:159]
s_waitcnt vmcnt(19)
buffer_load_dwordx4 a[212:215],v250,s[20:23],s47 offen offset:2048 sc1
M a[160:163],a[232:235],a[204:207],a[160:163]
s_waitcnt vmcnt(19)
s_add_u32 s48,s73,33792
v_fma_f32 v234,-4.0,v233,v235
v_sub_f32 v235,v235,v233
M a[160:163],v[220:223],a[216:219],a[160:163]
s_waitcnt vmcnt(18)
v_add_f32 v233,v238,v234
v_sub_f32 v238,v238,v234
M a[160:163],a[228:231],a[240:243],a[160:163]
v_fma_f32 v234,2.0,v235,v236
v_fmac_f32 v236,-2.0,v235
M a[164:167],a[228:231],a[192:195],a[164:167]
buffer_load_dwordx4 v[216:219],v250,s[20:23],s48 offen offset:0 sc1
M a[164:167],v[220:223],a[240:243],a[164:167]
v_and_b32 v197,s42,v197
v_and_b32 v193,s42,v193
M a[164:167],a[232:235],a[216:219],a[164:167]
v_and_b32 v195,s42,v195
v_and_b32 v203,s42,v203
M a[168:171],a[232:235],a[240:243],a[168:171]
v_and_b32 v201,s42,v201
v_and_b32 v199,s42,v199
M a[168:171],v[220:223],a[192:195],a[168:171]
buffer_load_dwordx4 a[204:207],v250,s[20:23],s48 offen offset:1024 sc1
M a[168:171],a[228:231],a[252:255],a[168:171]
v_fmac_f32 v193,s43,v197
v_fmac_f32 v203,4.0,v195
M a[172:175],a[228:231],v[228:231],a[172:175]
v_fma_f32 v235,-4.0,v197,v201
v_fmac_f32 v193,s45,v201
M a[172:175],v[220:223],a[252:255],a[172:175]
v_fmac_f32 v203,s41,v199
v_sub_f32 v201,v201,v197
M a[172:175],a[232:235],a[192:195],a[172:175]
buffer_load_dwordx4 a[216:219],v250,s[20:23],s48 offen offset:2048 sc1
M a[176:179],a[232:235],a[252:255],a[176:179]
s_add_u32 s46,s73,36864
v_fma_f32 v197,-4.0,v195,v199
v_sub_f32 v199,v199,v195
M a[176:179],v[220:223],v[228:231],a[176:179]
v_add_u32 v248,0x4400,v248
v_add_u32 v249,0x4400,v249
M a[176:179],a[228:231],a[224:227],a[176:179]
v_add_f32 v195,v235,v197
v_sub_f32 v235,v235,v197
M a[180:183],a[228:231],a[248:251],a[180:183]
buffer_load_dwordx4 a[240:243],v250,s[20:23],s46 offen offset:0 sc1
M a[180:183],v[220:223],a[224:227],a[180:183]
ds_read_b128 a[192:195],v248 offset:52224
v_fma_f32 v197,2.0,v199,v201
M a[180:183],a[232:235],v[228:231],a[180:183]
ds_read_b128 a[252:255],v249 offset:52224
v_fmac_f32 v201,-2.0,v199
M a[184:187],a[232:235],a[224:227],a[184:187]
ds_read_b128 v[228:231],v248 offset:52736
v_cvt_pk_bf16_f32 v193,v232,v193
M a[184:187],v[220:223],a[248:251],a[184:187]
ds_read_b128 a[224:227],v249 offset:52736
v_cvt_pk_bf16_f32 v203,v237,v203
M a[184:187],a[228:231],a[236:239],a[184:187]
v_cvt_pk_bf16_f32 v195,v233,v195
v_cvt_pk_bf16_f32 v199,v234,v197
M a[188:191],a[228:231],v[224:227],a[188:191]
v_cvt_pk_bf16_f32 v197,v238,v235
v_cvt_pk_bf16_f32 v201,v236,v201
M a[188:191],v[220:223],a[236:239],a[188:191]
M a[188:191],a[232:235],a[248:251],a[188:191]
s_waitcnt vmcnt(21) lgkmcnt(3)
ds_write2st64_b64 v247,v[192:193],v[202:203] offset0:206 offset1:223
M v[0:3],a[244:247],a[192:195],v[0:3]
s_waitcnt vmcnt(12) lgkmcnt(3)
s_add_u32 s28,s69,0
buffer_load_dwordx2 v[192:193],v251,s[12:15],s28 offen offset:0
M v[0:3],a[196:199],a[252:255],v[0:3]
s_waitcnt vmcnt(12) lgkmcnt(2)
ds_read_b128 a[228:231],v248 offset:53248
ds_read_b128 v[224:227],v249 offset:53248
M v[0:3],a[200:203],v[228:231],v[0:3]
s_waitcnt lgkmcnt(3)
buffer_load_dwordx2 v[202:203],v251,s[16:19],s28 offen offset:1536
M v[4:7],a[200:203],a[224:227],v[4:7]
v_lshlrev_b32 v234,16,v208
v_lshlrev_b32 v232,16,v204
M v[4:7],a[196:199],v[228:231],v[4:7]
v_lshlrev_b32 v233,16,v206
v_lshlrev_b32 v237,16,v214
M v[4:7],a[244:247],a[252:255],v[4:7]
ds_write2st64_b64 v247,v[194:195],v[196:197] offset0:36 offset1:53
M v[8:11],a[244:247],v[228:231],v[8:11]
buffer_load_dwordx2 v[194:195],v251,s[8:11],s28 offen offset:0
M v[8:11],a[196:199],a[224:227],v[8:11]
s_waitcnt lgkmcnt(2)
ds_read_b128 a[236:239],v248 offset:53760
ds_read_b128 v[220:223],v249 offset:53760
M v[8:11],a[200:203],a[228:231],v[8:11]
s_waitcnt lgkmcnt(3)
ds_write2st64_b64 v247,v[198:199],v[200:201] offset0:70 offset1:87
M v[12:15],a[200:203],v[224:227],v[12:15]
buffer_load_dwordx2 v[196:197],v251,s[8:11],s28 offen offset:384
M v[12:15],a[196:199],a[228:231],v[12:15]
v_lshlrev_b32 v236,16,v212
v_lshlrev_b32 v235,16,v210
M v[12:15],a[244:247],a[224:227],v[12:15]
v_fmac_f32 v232,s43,v234
v_fmac_f32 v237,4.0,v233
M v[16:19],a[244:247],a[228:231],v[16:19]
ds_read_b128 a[232:235],v249 offset:54272
v_fma_f32 v238,-4.0,v234,v236
M v[16:19],a[196:199],v[224:227],v[16:19]
s_waitcnt lgkmcnt(3)
buffer_load_dwordx2 v[198:199],v251,s[8:11],s28 offen offset:768
M v[16:19],a[200:203],a[236:239],v[16:19]
s_waitcnt lgkmcnt(2)
ds_read_b128 a[248:251],v248 offset:54272
v_fmac_f32 v232,s45,v236
M v[20:23],a[200:203],v[220:223],v[20:23]
v_fmac_f32 v237,s41,v235
v_sub_f32 v236,v236,v234
M v[20:23],a[196:199],a[236:239],v[20:23]
v_fma_f32 v234,-4.0,v233,v235
v_sub_f32 v235,v235,v233
M v[20:23],a[244:247],v[224:227],v[20:23]
buffer_load_dwordx2 v[200:201],v251,s[8:11],s28 offen offset:1152
M v[24:27],a[244:247],a[236:239],v[24:27]
v_add_f32 v233,v238,v234
v_sub_f32 v238,v238,v234
M v[24:27],a[196:199],v[220:223],v[24:27]
s_waitcnt lgkmcnt(1)
v_fma_f32 v234,2.0,v235,v236
v_fmac_f32 v236,-2.0,v235
M v[24:27],a[200:203],a[232:235],v[24:27]
s_waitcnt lgkmcnt(0)
v_and_b32 v208,s42,v208
v_and_b32 v204,s42,v204
M v[28:31],a[200:203],a[248:251],v[28:31]
global_load_dword a200,v250,s[64:65]
M v[28:31],a[196:199],a[232:235],v[28:31]
v_and_b32 v206,s42,v206
v_and_b32 v214,s42,v214
M v[28:31],a[244:247],v[220:223],v[28:31]
s_waitcnt vmcnt(17)
buffer_load_dwordx4 a[200:203],v250,s[20:23],s46 offen offset:1024 sc1
M v[32:35],a[220:223],a[192:195],v[32:35]
s_waitcnt vmcnt(13)
v_and_b32 v212,s42,v212
v_and_b32 v210,s42,v210
M v[32:35],a[208:211],a[252:255],v[32:35]
s_waitcnt vmcnt(12)
v_fmac_f32 v204,s43,v208
v_fmac_f32 v214,4.0,v206
M v[32:35],a[212:215],v[228:231],v[32:35]
v_fma_f32 v235,-4.0,v208,v212
v_fmac_f32 v204,s45,v212
M v[36:39],a[212:215],a[224:227],v[36:39]
buffer_load_dwordx4 a[196:199],v250,s[20:23],s46 offen offset:2048 sc1
M v[36:39],a[208:211],v[228:231],v[36:39]
s_add_u32 s47,s73,39936
v_fmac_f32 v214,s41,v210
v_sub_f32 v212,v212,v208
M v[36:39],a[220:223],a[252:255],v[36:39]
v_fma_f32 v208,-4.0,v206,v210
v_sub_f32 v210,v210,v206
M v[40:43],a[220:223],v[228:231],v[40:43]
v_add_f32 v206,v235,v208
v_sub_f32 v235,v235,v208
M v[40:43],a[208:211],a[224:227],v[40:43]
buffer_load_dwordx4 a[244:247],v250,s[20:23],s47 offen offset:0 sc1
M v[40:43],a[212:215],a[228:231],v[40:43]
v_fma_f32 v208,2.0,v210,v212
v_fmac_f32 v212,-2.0,v210
M v[44:47],a[212:215],v[224:227],v[44:47]
v_cvt_pk_bf16_f32 v204,v232,v204
v_cvt_pk_bf16_f32 v214,v237,v214
M v[44:47],a[208:211],a[228:231],v[44:47]
v_cvt_pk_bf16_f32 v206,v233,v206
v_cvt_pk_bf16_f32 v210,v234,v208
M v[44:47],a[220:223],a[224:227],v[44:47]
v_cvt_pk_bf16_f32 v208,v238,v235
v_cvt_pk_bf16_f32 v212,v236,v212
M v[48:51],a[220:223],a[228:231],v[48:51]
v_lshlrev_b32 v234,16,v209
v_lshlrev_b32 v232,16,v205
M v[48:51],a[208:211],v[224:227],v[48:51]
v_lshlrev_b32 v233,16,v207
v_lshlrev_b32 v237,16,v215
M v[48:51],a[212:215],a[236:239],v[48:51]
v_lshlrev_b32 v236,16,v213
v_lshlrev_b32 v235,16,v211
M v[52:55],a[212:215],v[220:223],v[52:55]
v_fmac_f32 v232,s43,v234
v_fmac_f32 v237,4.0,v233
M v[52:55],a[208:211],a[236:239],v[52:55]
v_fma_f32 v238,-4.0,v234,v236
v_fmac_f32 v232,s45,v236
M v[52:55],a[220:223],v[224:227],v[52:55]
v_fmac_f32 v237,s41,v235
v_sub_f32 v236,v236,v234
M v[56:59],a[220:223],a[236:239],v[56:59]
v_fma_f32 v234,-4.0,v233,v235
v_sub_f32 v235,v235,v233
M v[56:59],a[208:211],v[220:223],v[56:59]
v_add_f32 v233,v238,v234
v_sub_f32 v238,v238,v234
M v[56:59],a[212:215],a[232:235],v[56:59]
v_fma_f32 v234,2.0,v235,v236
v_fmac_f32 v236,-2.0,v235
M v[60:63],a[212:215],a[248:251],v[60:63]
buffer_load_dwordx4 a[212:215],v250,s[20:23],s47 offen offset:1024 sc1
M v[60:63],a[208:211],a[232:235],v[60:63]
v_and_b32 v209,s42,v209
v_and_b32 v205,s42,v205
M v[60:63],a[220:223],v[220:223],v[60:63]
s_waitcnt vmcnt(14)
buffer_load_dwordx4 a[208:211],v250,s[20:23],s47 offen offset:2048 sc1
M v[64:67],v[216:219],a[192:195],v[64:67]
s_waitcnt vmcnt(14)
s_add_u32 s48,s73,43008
v_and_b32 v207,s42,v207
v_and_b32 v215,s42,v215
M v[64:67],a[204:207],a[252:255],v[64:67]
s_waitcnt vmcnt(13)
v_and_b32 v213,s42,v213
v_and_b32 v211,s42,v211
M v[64:67],a[216:219],v[228:231],v[64:67]
v_fmac_f32 v205,s43,v209
v_fmac_f32 v215,4.0,v207
M v[68:71],a[216:219],a[224:227],v[68:71]
buffer_load_dwordx4 a[220:223],v250,s[20:23],s48 offen offset:0 sc1
M v[68:71],a[204:207],v[228:231],v[68:71]
v_fma_f32 v235,-4.0,v209,v213
v_fmac_f32 v205,s45,v213
M v[68:71],v[216:219],a[252:255],v[68:71]
v_fmac_f32 v215,s41,v211
v_sub_f32 v213,v213,v209
M v[72:75],v[216:219],v[228:231],v[72:75]
v_fma_f32 v209,-4.0,v207,v211
v_sub_f32 v211,v211,v207
M v[72:75],a[204:207],a[224:227],v[72:75]
buffer_load_dwordx4 a[192:195],v250,s[20:23],s48 offen offset:1024 sc1
M v[72:75],a[216:219],a[228:231],v[72:75]
v_add_f32 v207,v235,v209
v_sub_f32 v235,v235,v209
M v[76:79],a[216:219],v[224:227],v[76:79]
v_fma_f32 v209,2.0,v211,v213
v_fmac_f32 v213,-2.0,v211
M v[76:79],a[204:207],a[228:231],v[76:79]
v_cvt_pk_bf16_f32 v205,v232,v205
v_cvt_pk_bf16_f32 v215,v237,v215
M v[76:79],v[216:219],a[224:227],v[76:79]
buffer_load_dwordx4 a[252:255],v250,s[20:23],s48 offen offset:2048 sc1
M v[80:83],v[216:219],a[228:231],v[80:83]
s_add_u32 s46,s74,9216
v_cvt_pk_bf16_f32 v207,v233,v207
v_cvt_pk_bf16_f32 v211,v234,v209
M v[80:83],a[204:207],v[224:227],v[80:83]
v_cvt_pk_bf16_f32 v209,v238,v235
v_cvt_pk_bf16_f32 v213,v236,v213
M v[80:83],a[216:219],a[236:239],v[80:83]
ds_write2st64_b64 v247,v[204:205],v[214:215] offset0:207 offset1:224
M v[84:87],a[216:219],v[220:223],v[84:87]
s_add_u32 s28,s69,393216
buffer_load_dwordx4 v[228:231],v250,s[20:23],s46 offen offset:0 sc1
M v[84:87],a[204:207],a[236:239],v[84:87]
s_waitcnt vmcnt(12)
ds_read_b128 a[224:227],v248 offset:60928
v_lshlrev_b32 v234,16,v196
M v[84:87],v[216:219],v[224:227],v[84:87]
ds_write2st64_b64 v247,v[206:207],v[208:209] offset0:37 offset1:54
M v[88:91],v[216:219],a[236:239],v[88:91]
buffer_load_dwordx2 v[204:205],v245,s[12:15],s28 offen offset:0
M v[88:91],a[204:207],v[220:223],v[88:91]
ds_read_b128 a[228:231],v249 offset:60928
ds_read_b128 v[224:227],v248 offset:61440
M v[88:91],a[216:219],a[232:235],v[88:91]
ds_write2st64_b64 v247,v[210:211],v[212:213] offset0:71 offset1:88
M v[92:95],a[216:219],a[248:251],v[92:95]
buffer_load_dwordx2 v[214:215],v245,s[16:19],s28 offen offset:1536
M v[92:95],a[204:207],a[232:235],v[92:95]
ds_read_b128 a[236:239],v249 offset:61440
v_lshlrev_b32 v232,16,v192
M v[92:95],v[216:219],v[220:223],v[92:95]
s_waitcnt lgkmcnt(5)
v_lshlrev_b32 v233,16,v194
v_lshlrev_b32 v237,16,v202
M v[96:99],a[240:243],a[224:227],v[96:99]
s_waitcnt vmcnt(10) lgkmcnt(3)
ds_read_b128 a[216:219],v248 offset:61952
v_lshlrev_b32 v236,16,v200
M v[96:99],a[200:203],a[228:231],v[96:99]
s_waitcnt vmcnt(9) lgkmcnt(3)
buffer_load_dwordx2 v[206:207],v245,s[8:11],s28 offen offset:0
M v[96:99],a[196:199],v[224:227],v[96:99]
s_waitcnt lgkmcnt(1)
ds_read_b128 a[248:251],v249 offset:61952
v_lshlrev_b32 v235,16,v198
M v[100:103],a[196:199],a[236:239],v[100:103]
v_fmac_f32 v232,s43,v234
v_fmac_f32 v237,4.0,v233
M v[100:103],a[200:203],v[224:227],v[100:103]
v_fma_f32 v238,-4.0,v234,v236
v_fmac_f32 v232,s45,v236
M v[100:103],a[240:243],a[228:231],v[100:103]
buffer_load_dwordx2 v[208:209],v245,s[8:11],s28 offen offset:384
M v[104:107],a[240:243],v[224:227],v[104:107]
ds_read_b128 a[204:207],v248 offset:62464
v_fmac_f32 v237,s41,v235
M v[104:107],a[200:203],a[236:239],v[104:107]
s_waitcnt lgkmcnt(2)
ds_read_b128 a[232:235],v249 offset:62464
v_sub_f32 v236,v236,v234
M v[104:107],a[196:199],a[216:219],v[104:107]
s_waitcnt lgkmcnt(2)
v_fma_f32 v234,-4.0,v233,v235
v_sub_f32 v235,v235,v233
M v[108:111],a[196:199],a[248:251],v[108:111]
buffer_load_dwordx2 v[210:211],v245,s[8:11],s28 offen offset:768
M v[108:111],a[200:203],a[216:219],v[108:111]
v_add_f32 v233,v238,v234
v_sub_f32 v238,v238,v234
M v[108:111],a[240:243],a[236:239],v[108:111]
v_fma_f32 v234,2.0,v235,v236
v_fmac_f32 v236,-2.0,v235
M v[112:115],a[240:243],a[216:219],v[112:115]
ds_read_b128 v[216:219],v249 offset:62976
v_and_b32 v196,s42,v196
M v[112:115],a[200:203],a[248:251],v[112:115]
s_waitcnt lgkmcnt(2)
buffer_load_dwordx2 v[212:213],v245,s[8:11],s28 offen offset:1152
M v[112:115],a[196:199],a[204:207],v[112:115]
s_waitcnt lgkmcnt(1)
ds_read_b128 v[220:223],v248 offset:62976
v_and_b32 v192,s42,v192
M v[116:119],a[196:199],a[232:235],v[116:119]
v_and_b32 v194,s42,v194
v_and_b32 v202,s42,v202
M v[116:119],a[200:203],a[204:207],v[116:119]
v_and_b32 v200,s42,v200
v_and_b32 v198,s42,v198
M v[116:119],a[240:243],a[248:251],v[116:119]
v_fmac_f32 v192,s43,v196
v_fmac_f32 v202,4.0,v194
M v[120:123],a[240:243],a[204:207],v[120:123]
v_fma_f32 v235,-4.0,v196,v200
v_fmac_f32 v192,s45,v200
M v[120:123],a[200:203],a[232:235],v[120:123]
s_waitcnt lgkmcnt(1)
v_fmac_f32 v202,s41,v198
v_sub_f32 v200,v200,v196
M v[120:123],a[196:199],v[216:219],v[120:123]
s_waitcnt lgkmcnt(0)
v_fma_f32 v196,-4.0,v194,v198
v_sub_f32 v198,v198,v194
M v[124:127],a[196:199],v[220:223],v[124:127]
buffer_load_dwordx4 a[196:199],v250,s[20:23],s46 offen offset:1024 sc1
M v[124:127],a[200:203],v[216:219],v[124:127]
v_add_f32 v194,v235,v196
v_sub_f32 v235,v235,v196
M v[124:127],a[240:243],a[232:235],v[124:127]
s_waitcnt vmcnt(13)
buffer_load_dwordx4 a[200:203],v250,s[20:23],s46 offen offset:2048 sc1
M v[128:131],a[244:247],a[224:227],v[128:131]
s_waitcnt vmcnt(13)
s_add_u32 s47,s74,12288
v_fma_f32 v196,2.0,v198,v200
v_fmac_f32 v200,-2.0,v198
M v[128:131],a[212:215],a[228:231],v[128:131]
s_waitcnt vmcnt(12)
v_cvt_pk_bf16_f32 v192,v232,v192
v_cvt_pk_bf16_f32 v202,v237,v202
M v[128:131],a[208:211],v[224:227],v[128:131]
v_cvt_pk_bf16_f32 v194,v233,v194
v_cvt_pk_bf16_f32 v198,v234,v196
M v[132:135],a[208:211],a[236:239],v[132:135]
buffer_load_dwordx4 a[240:243],v250,s[20:23],s47 offen offset:0 sc1
M v[132:135],a[212:215],v[224:227],v[132:135]
v_cvt_pk_bf16_f32 v196,v238,v235
v_cvt_pk_bf16_f32 v200,v236,v200
M v[132:135],a[244:247],a[228:231],v[132:135]
v_lshlrev_b32 v234,16,v197
v_lshlrev_b32 v232,16,v193
M v[136:139],a[244:247],v[224:227],v[136:139]
v_lshlrev_b32 v233,16,v195
v_lshlrev_b32 v237,16,v203
M v[136:139],a[212:215],a[236:239],v[136:139]
v_lshlrev_b32 v236,16,v201
v_lshlrev_b32 v235,16,v199
M v[136:139],a[208:211],a[216:219],v[136:139]
v_fmac_f32 v232,s43,v234
v_fmac_f32 v237,4.0,v233
M v[140:143],a[208:211],a[248:251],v[140:143]
v_fma_f32 v238,-4.0,v234,v236
v_fmac_f32 v232,s45,v236
M v[140:143],a[212:215],a[216:219],v[140:143]
v_fmac_f32 v237,s41,v235
v_sub_f32 v236,v236,v234
M v[140:143],a[244:247],a[236:239],v[140:143]
v_fma_f32 v234,-4.0,v233,v235
v_sub_f32 v235,v235,v233
M v[144:147],a[244:247],a[216:219],v[144:147]
v_add_f32 v233,v238,v234
v_sub_f32 v238,v238,v234
M v[144:147],a[212:215],a[248:251],v[144:147]
v_fma_f32 v234,2.0,v235,v236
v_fmac_f32 v236,-2.0,v235
M v[144:147],a[208:211],a[204:207],v[144:147]
v_and_b32 v197,s42,v197
v_and_b32 v193,s42,v193
M v[148:151],a[208:211],a[232:235],v[148:151]
v_and_b32 v195,s42,v195
v_and_b32 v203,s42,v203
M v[148:151],a[212:215],a[204:207],v[148:151]
v_and_b32 v201,s42,v201
v_and_b32 v199,s42,v199
M v[148:151],a[244:247],a[248:251],v[148:151]
v_fmac_f32 v193,s43,v197
v_fmac_f32 v203,4.0,v195
M v[152:155],a[244:247],a[204:207],v[152:155]
v_fma_f32 v235,-4.0,v197,v201
v_fmac_f32 v193,s45,v201
M v[152:155],a[212:215],a[232:235],v[152:155]
v_fmac_f32 v203,s41,v199
v_sub_f32 v201,v201,v197
M v[152:155],a[208:211],v[216:219],v[152:155]
v_fma_f32 v197,-4.0,v195,v199
v_sub_f32 v199,v199,v195
M v[156:159],a[208:211],v[220:223],v[156:159]
buffer_load_dwordx4 a[208:211],v250,s[20:23],s47 offen offset:1024 sc1
M v[156:159],a[212:215],v[216:219],v[156:159]
v_add_f32 v195,v235,v197
v_sub_f32 v235,v235,v197
M v[156:159],a[244:247],a[232:235],v[156:159]
s_waitcnt vmcnt(13)
buffer_load_dwordx4 a[212:215],v250,s[20:23],s47 offen offset:2048 sc1
M v[160:163],a[220:223],a[224:227],v[160:163]
s_waitcnt vmcnt(13)
s_add_u32 s48,s74,15360
v_fma_f32 v197,2.0,v199,v201
v_fmac_f32 v201,-2.0,v199
M v[160:163],a[192:195],a[228:231],v[160:163]
s_waitcnt vmcnt(12)
v_cvt_pk_bf16_f32 v193,v232,v193
v_cvt_pk_bf16_f32 v203,v237,v203
M v[160:163],a[252:255],v[224:227],v[160:163]
v_cvt_pk_bf16_f32 v195,v233,v195
v_cvt_pk_bf16_f32 v199,v234,v197
M v[164:167],a[252:255],a[236:239],v[164:167]
buffer_load_dwordx4 a[244:247],v250,s[20:23],s48 offen offset:0 sc1
M v[164:167],a[192:195],v[224:227],v[164:167]
v_cvt_pk_bf16_f32 v197,v238,v235
v_cvt_pk_bf16_f32 v201,v236,v201
M v[164:167],a[220:223],a[228:231],v[164:167]
s_waitcnt vmcnt(8)
v_lshlrev_b32 v234,16,v208
v_lshlrev_b32 v232,16,v204
M v[168:171],a[220:223],v[224:227],v[168:171]
v_lshlrev_b32 v233,16,v206
v_lshlrev_b32 v237,16,v214
M v[168:171],a[192:195],a[236:239],v[168:171]
buffer_load_dwordx4 a[224:227],v250,s[20:23],s48 offen offset:1024 sc1
M v[168:171],a[252:255],a[216:219],v[168:171]
s_waitcnt vmcnt(7)
v_lshlrev_b32 v236,16,v212
v_lshlrev_b32 v235,16,v210
M v[172:175],a[252:255],a[248:251],v[172:175]
v_fmac_f32 v232,s43,v234
v_fmac_f32 v237,4.0,v233
M v[172:175],a[192:195],a[216:219],v[172:175]
v_fma_f32 v238,-4.0,v234,v236
v_fmac_f32 v232,s45,v236
M v[172:175],a[220:223],a[236:239],v[172:175]
buffer_load_dwordx4 a[228:231],v250,s[20:23],s48 offen offset:2048 sc1
M v[176:179],a[220:223],a[216:219],v[176:179]
s_add_u32 s46,s74,18432
v_fmac_f32 v237,s41,v235
v_sub_f32 v236,v236,v234
M v[176:179],a[192:195],a[248:251],v[176:179]
v_fma_f32 v234,-4.0,v233,v235
v_sub_f32 v235,v235,v233
M v[176:179],a[252:255],a[204:207],v[176:179]
s_barrier
v_add_f32 v233,v238,v234
M v[180:183],a[252:255],a[232:235],v[180:183]
buffer_load_dwordx4 v[224:227],v250,s[20:23],s46 offen offset:0 sc1
M v[180:183],a[192:195],a[204:207],v[180:183]
ds_read_b128 a[236:239],v248 offset:0
v_sub_f32 v238,v238,v234
M v[180:183],a[220:223],a[248:251],v[180:183]
ds_write2st64_b64 v247,v[192:193],v[202:203] offset0:238 offset1:255
M v[184:187],a[220:223],a[204:207],v[184:187]
s_add_u32 s28,s69,786432
ds_read_b128 a[216:219],v249 offset:0
ds_read_b128 a[248:251],v248 offset:512
M v[184:187],a[192:195],a[232:235],v[184:187]
buffer_load_dwordx2 v[192:193],v245,s[12:15],s28 offen offset:0
M v[184:187],a[252:255],v[216:219],v[184:187]
ds_write2st64_b64 v247,v[194:195],v[196:197] offset0:102 offset1:119
M v[188:191],a[252:255],v[220:223],v[188:191]
ds_read_b128 a[204:207],v249 offset:512
v_fma_f32 v234,2.0,v235,v236
M v[188:191],a[192:195],v[216:219],v[188:191]
buffer_load_dwordx2 v[202:203],v245,s[16:19],s28 offen offset:1536
M v[188:191],a[220:223],a[232:235],v[188:191]
s_waitcnt lgkmcnt(5)
ds_write2st64_b64 v247,v[198:199],v[200:201] offset0:136 offset1:153
M a[0:3],v[228:231],a[236:239],a[0:3]
s_waitcnt vmcnt(10) lgkmcnt(4)
ds_read_b128 a[252:255],v248 offset:1024
v_fmac_f32 v236,-2.0,v235
M a[0:3],a[196:199],a[216:219],a[0:3]
s_waitcnt vmcnt(9) lgkmcnt(4)
buffer_load_dwordx2 v[194:195],v245,s[8:11],s28 offen offset:0
M a[0:3],a[200:203],a[248:251],a[0:3]
s_waitcnt lgkmcnt(2)
ds_read_b128 v[220:223],v249 offset:1024
v_and_b32 v208,s42,v208
M a[4:7],a[200:203],a[204:207],a[4:7]
v_and_b32 v204,s42,v204
v_and_b32 v206,s42,v206
M a[4:7],a[196:199],a[248:251],a[4:7]
v_and_b32 v214,s42,v214
v_and_b32 v212,s42,v212
M a[4:7],v[228:231],a[216:219],a[4:7]
buffer_load_dwordx2 v[196:197],v245,s[8:11],s28 offen offset:384
M a[8:11],v[228:231],a[248:251],a[8:11]
ds_read_b128 a[192:195],v248 offset:1536
v_and_b32 v210,s42,v210
M a[8:11],a[196:199],a[204:207],a[8:11]
s_waitcnt lgkmcnt(2)
ds_read_b128 v[216:219],v249 offset:1536
v_fmac_f32 v204,s43,v208
M a[8:11],a[200:203],a[252:255],a[8:11]
s_waitcnt lgkmcnt(2)
v_fmac_f32 v214,4.0,v206
v_fma_f32 v235,-4.0,v208,v212
M a[12:15],a[200:203],v[220:223],a[12:15]
buffer_load_dwordx2 v[198:199],v245,s[8:11],s28 offen offset:768
M a[12:15],a[196:199],a[252:255],a[12:15]
v_fmac_f32 v204,s45,v212
v_fmac_f32 v214,s41,v210
M a[12:15],v[228:231],a[204:207],a[12:15]
v_sub_f32 v212,v212,v208
v_fma_f32 v208,-4.0,v206,v210
M a[16:19],v[228:231],a[252:255],a[16:19]
ds_read_b128 a[220:223],v249 offset:2048
v_sub_f32 v210,v210,v206
M a[16:19],a[196:199],v[220:223],a[16:19]
s_waitcnt lgkmcnt(2)
buffer_load_dwordx2 v[200:201],v245,s[8:11],s28 offen offset:1152
M a[16:19],a[200:203],a[192:195],a[16:19]
s_waitcnt lgkmcnt(1)
ds_read_b128 a[232:235],v248 offset:2048
v_add_f32 v206,v235,v208
M a[20:23],a[200:203],v[216:219],a[20:23]
v_sub_f32 v235,v235,v208
v_fma_f32 v208,2.0,v210,v212
M a[20:23],a[196:199],a[192:195],a[20:23]
v_fmac_f32 v212,-2.0,v210
v_cvt_pk_bf16_f32 v204,v232,v204
M a[20:23],v[228:231],v[220:223],a[20:23]
v_cvt_pk_bf16_f32 v214,v237,v214
v_cvt_pk_bf16_f32 v206,v233,v206
M a[24:27],v[228:231],a[192:195],a[24:27]
v_cvt_pk_bf16_f32 v210,v234,v208
v_cvt_pk_bf16_f32 v208,v238,v235
M a[24:27],a[196:199],v[216:219],a[24:27]
s_waitcnt lgkmcnt(1)
v_cvt_pk_bf16_f32 v212,v236,v212
v_lshlrev_b32 v234,16,v209
M a[24:27],a[200:203],a[220:223],a[24:27]
s_waitcnt lgkmcnt(0)
v_lshlrev_b32 v232,16,v205
v_lshlrev_b32 v233,16,v207
M a[28:31],a[200:203],a[232:235],a[28:31]
buffer_load_dwordx4 a[200:203],v250,s[20:23],s46 offen offset:1024 sc1
M a[28:31],a[196:199],a[220:223],a[28:31]
v_lshlrev_b32 v237,16,v215
v_lshlrev_b32 v236,16,v213
M a[28:31],v[228:231],v[216:219],a[28:31]
s_waitcnt vmcnt(13)
buffer_load_dwordx4 a[196:199],v250,s[20:23],s46 offen offset:2048 sc1
M a[32:35],a[240:243],a[236:239],a[32:35]
s_waitcnt vmcnt(13)
s_add_u32 s47,s74,21504
v_lshlrev_b32 v235,16,v211
v_fmac_f32 v232,s43,v234
M a[32:35],a[208:211],a[216:219],a[32:35]
s_waitcnt vmcnt(12)
v_fmac_f32 v237,4.0,v233
v_fma_f32 v238,-4.0,v234,v236
M a[32:35],a[212:215],a[248:251],a[32:35]
v_fmac_f32 v232,s45,v236
v_fmac_f32 v237,s41,v235
M a[36:39],a[212:215],a[204:207],a[36:39]
buffer_load_dwordx4 v[228:231],v250,s[20:23],s47 offen offset:0 sc1
M a[36:39],a[208:211],a[248:251],a[36:39]
v_sub_f32 v236,v236,v234
v_fma_f32 v234,-4.0,v233,v235
M a[36:39],a[240:243],a[216:219],a[36:39]
v_sub_f32 v235,v235,v233
v_add_f32 v233,v238,v234
M a[40:43],a[240:243],a[248:251],a[40:43]
v_sub_f32 v238,v238,v234
v_fma_f32 v234,2.0,v235,v236
M a[40:43],a[208:211],a[204:207],a[40:43]
v_fmac_f32 v236,-2.0,v235
v_and_b32 v209,s42,v209
M a[40:43],a[212:215],a[252:255],a[40:43]
v_and_b32 v205,s42,v205
v_and_b32 v207,s42,v207
M a[44:47],a[212:215],v[220:223],a[44:47]
v_and_b32 v215,s42,v215
v_and_b32 v213,s42,v213
M a[44:47],a[208:211],a[252:255],a[44:47]
v_and_b32 v211,s42,v211
v_fmac_f32 v205,s43,v209
M a[44:47],a[240:243],a[204:207],a[44:47]
v_fmac_f32 v215,4.0,v207
v_fma_f32 v235,-4.0,v209,v213
M a[48:51],a[240:243],a[252:255],a[48:51]
v_fmac_f32 v205,s45,v213
v_fmac_f32 v215,s41,v211
M a[48:51],a[208:211],v[220:223],a[48:51]
v_sub_f32 v213,v213,v209
v_fma_f32 v209,-4.0,v207,v211
M a[48:51],a[212:215],a[192:195],a[48:51]
v_sub_f32 v211,v211,v207
v_add_f32 v207,v235,v209
M a[52:55],a[212:215],v[216:219],a[52:55]
v_sub_f32 v235,v235,v209
v_fma_f32 v209,2.0,v211,v213
M a[52:55],a[208:211],a[192:195],a[52:55]
v_fmac_f32 v213,-2.0,v211
v_cvt_pk_bf16_f32 v205,v232,v205
M a[52:55],a[240:243],v[220:223],a[52:55]
v_cvt_pk_bf16_f32 v215,v237,v215
v_cvt_pk_bf16_f32 v207,v233,v207
M a[56:59],a[240:243],a[192:195],a[56:59]
v_cvt_pk_bf16_f32 v211,v234,v209
v_cvt_pk_bf16_f32 v209,v238,v235
M a[56:59],a[208:211],v[216:219],a[56:59]
v_cvt_pk_bf16_f32 v213,v236,v213
v_add_u32 v238,121856,v247
M a[56:59],a[212:215],a[220:223],a[56:59]
ds_write2st64_b64 v238,v[204:205],v[214:215] offset0:1 offset1:18
M a[60:63],a[212:215],a[232:235],a[60:63]
s_add_u32 s28,s69,1179648
buffer_load_dwordx4 a[212:215],v250,s[20:23],s47 offen offset:1024 sc1
M a[60:63],a[208:211],a[220:223],a[60:63]
v_fmac_f32 v239,s43,v241
v_fmac_f32 v244,4.0,v240
M a[60:63],a[240:243],v[216:219],a[60:63]
s_waitcnt vmcnt(13)
buffer_load_dwordx4 a[208:211],v250,s[20:23],s47 offen offset:2048 sc1
M a[64:67],a[244:247],a[236:239],a[64:67]
s_waitcnt vmcnt(13)
s_add_u32 s48,s74,24576
v_fma_f32 v232,-4.0,v241,v243
v_fmac_f32 v239,s45,v243
M a[64:67],a[224:227],a[216:219],a[64:67]
s_waitcnt vmcnt(12)
v_fmac_f32 v244,s41,v242
v_sub_f32 v243,v243,v241
M a[64:67],a[228:231],a[248:251],a[64:67]
ds_write2st64_b64 v247,v[206:207],v[208:209] offset0:103 offset1:120
M a[68:71],a[228:231],a[204:207],a[68:71]
buffer_load_dwordx4 a[240:243],v250,s[20:23],s48 offen offset:0 sc1
M a[68:71],a[224:227],a[248:251],a[68:71]
v_fma_f32 v241,-4.0,v240,v242
v_sub_f32 v242,v242,v240
M a[68:71],a[244:247],a[216:219],a[68:71]
ds_write2st64_b64 v247,v[210:211],v[212:213] offset0:137 offset1:154
M a[72:75],a[244:247],a[248:251],a[72:75]
buffer_load_dwordx4 a[236:239],v250,s[20:23],s48 offen offset:1024 sc1
M a[72:75],a[224:227],a[204:207],a[72:75]
v_add_f32 v240,v232,v241
v_sub_f32 v232,v232,v241
M a[72:75],a[228:231],a[252:255],a[72:75]
v_fma_f32 v241,2.0,v242,v243
v_fmac_f32 v243,-2.0,v242
M a[76:79],a[228:231],v[220:223],a[76:79]
v_cvt_pk_bf16_f32 v233,v239,v244
v_cvt_pk_bf16_f32 v234,v240,v232
M a[76:79],a[224:227],a[252:255],a[76:79]
buffer_load_dwordx4 a[216:219],v250,s[20:23],s48 offen offset:2048 sc1
M a[76:79],a[244:247],a[204:207],a[76:79]
s_add_u32 s46,s74,27648
v_cvt_pk_bf16_f32 v235,v241,v243
v_add_u32 v232,121856,v252
M a[80:83],a[244:247],a[252:255],a[80:83]
ds_write_b16 v232,v233 offset:0
M a[80:83],a[224:227],v[220:223],a[80:83]
ds_write_b16_d16_hi v232,v233 offset:8704
M a[80:83],a[228:231],a[192:195],a[80:83]
buffer_load_dwordx4 a[248:251],v250,s[20:23],s46 offen offset:0 sc1
M a[84:87],a[228:231],v[216:219],a[84:87]
ds_write_b16 v252,v234 offset:52224
M a[84:87],a[224:227],a[192:195],a[84:87]
ds_read_b128 a[204:207],v248 offset:8704
ds_write_b16_d16_hi v252,v234 offset:60928
M a[84:87],a[244:247],v[220:223],a[84:87]
ds_read_b128 a[252:255],v249 offset:8704
v_add_u32 v232,69632,v252
M a[88:91],a[244:247],a[192:195],a[88:91]
buffer_load_dwordx2 v[204:205],v245,s[12:15],s28 offen offset:0
M a[88:91],a[224:227],v[216:219],a[88:91]
ds_read_b128 v[220:223],v248 offset:9216
ds_read_b128 a[192:195],v249 offset:9216
M a[88:91],a[228:231],a[220:223],a[88:91]
ds_write_b16 v232,v235 offset:0
M a[92:95],a[228:231],a[232:235],a[92:95]
ds_write_b16_d16_hi v232,v235 offset:8704
M a[92:95],a[224:227],a[220:223],a[92:95]
buffer_load_dwordx2 v[214:215],v245,s[16:19],s28 offen offset:1536
M a[92:95],a[244:247],v[216:219],a[92:95]
s_waitcnt vmcnt(13) lgkmcnt(6)
v_lshlrev_b32 v234,16,v196
v_lshlrev_b32 v232,16,v192
M a[96:99],v[224:227],a[204:207],a[96:99]
s_waitcnt vmcnt(10) lgkmcnt(4)
ds_read_b128 a[228:231],v248 offset:9728
v_lshlrev_b32 v233,16,v194
M a[96:99],a[200:203],a[252:255],a[96:99]
s_waitcnt vmcnt(9) lgkmcnt(4)
ds_read_b128 a[232:235],v249 offset:9728
v_lshlrev_b32 v237,16,v202
M a[96:99],a[196:199],v[220:223],a[96:99]
s_waitcnt lgkmcnt(4)
buffer_load_dwordx2 v[206:207],v245,s[8:11],s28 offen offset:0
M a[100:103],a[196:199],a[192:195],a[100:103]
v_lshlrev_b32 v236,16,v200
v_lshlrev_b32 v235,16,v198
M a[100:103],a[200:203],v[220:223],a[100:103]
v_fmac_f32 v232,s43,v234
v_fmac_f32 v237,4.0,v233
M a[100:103],v[224:227],a[252:255],a[100:103]
v_fma_f32 v238,-4.0,v234,v236
v_fmac_f32 v232,s45,v236
M a[104:107],v[224:227],v[220:223],a[104:107]
buffer_load_dwordx2 v[208:209],v245,s[8:11],s28 offen offset:384
M a[104:107],a[200:203],a[192:195],a[104:107]
s_waitcnt lgkmcnt(1)
ds_read_b128 a[220:223],v248 offset:10240
ds_read_b128 a[224:227],v249 offset:10240
M a[104:107],a[196:199],a[228:231],a[104:107]
s_waitcnt lgkmcnt(2)
v_fmac_f32 v237,s41,v235
v_sub_f32 v236,v236,v234
M a[108:111],a[196:199],a[232:235],a[108:111]
v_fma_f32 v234,-4.0,v233,v235
v_sub_f32 v235,v235,v233
M a[108:111],a[200:203],a[228:231],a[108:111]
buffer_load_dwordx2 v[210:211],v245,s[8:11],s28 offen offset:768
M a[108:111],v[224:227],a[192:195],a[108:111]
v_add_f32 v233,v238,v234
v_sub_f32 v238,v238,v234
M a[112:115],v[224:227],a[228:231],a[112:115]
ds_read_b128 a[244:247],v249 offset:10752
v_fma_f32 v234,2.0,v235,v236
M a[112:115],a[200:203],a[232:235],a[112:115]
s_waitcnt lgkmcnt(2)
ds_read_b128 v[216:219],v248 offset:10752
v_fmac_f32 v236,-2.0,v235
M a[112:115],a[196:199],a[220:223],a[112:115]
s_waitcnt lgkmcnt(2)
buffer_load_dwordx2 v[212:213],v245,s[8:11],s28 offen offset:1152
M a[116:119],a[196:199],a[224:227],a[116:119]
s_add_u32 s29,s70,0
v_and_b32 v196,s42,v196
v_and_b32 v192,s42,v192
M a[116:119],a[200:203],a[220:223],a[116:119]
v_and_b32 v194,s42,v194
v_and_b32 v202,s42,v202
M a[116:119],v[224:227],a[232:235],a[116:119]
v_and_b32 v200,s42,v200
v_and_b32 v198,s42,v198
M a[120:123],v[224:227],a[220:223],a[120:123]
buffer_load_short_d16_hi v239,v246,s[12:15],s29 offen offset:0
M a[120:123],a[200:203],a[224:227],a[120:123]
s_waitcnt lgkmcnt(1)
v_fmac_f32 v192,s43,v196
v_fmac_f32 v202,4.0,v194
M a[120:123],a[196:199],a[244:247],a[120:123]
s_waitcnt lgkmcnt(0)
buffer_load_short_d16_hi v240,v246,s[8:11],s29 offen offset:0
M a[124:127],a[196:199],v[216:219],a[124:127]
v_fma_f32 v235,-4.0,v196,v200
v_fmac_f32 v192,s45,v200
M a[124:127],a[200:203],a[244:247],a[124:127]
buffer_load_dwordx4 a[196:199],v250,s[20:23],s46 offen offset:1024 sc1
M a[124:127],v[224:227],a[224:227],a[124:127]
s_waitcnt vmcnt(15)
v_fmac_f32 v202,s41,v198
v_sub_f32 v200,v200,v196
M a[128:131],v[228:231],a[204:207],a[128:131]
s_waitcnt vmcnt(14)
v_fma_f32 v196,-4.0,v194,v198
v_sub_f32 v198,v198,v194
M a[128:131],a[212:215],a[252:255],a[128:131]
s_waitcnt vmcnt(13)
v_add_f32 v194,v235,v196
v_sub_f32 v235,v235,v196
M a[128:131],a[208:211],v[220:223],a[128:131]
buffer_load_dwordx4 a[200:203],v250,s[20:23],s46 offen offset:2048 sc1
M a[132:135],a[208:211],a[192:195],a[132:135]
s_add_u32 s47,s74,30720
v_fma_f32 v196,2.0,v198,v200
v_fmac_f32 v200,-2.0,v198
M a[132:135],a[212:215],v[220:223],a[132:135]
v_cvt_pk_bf16_f32 v192,v232,v192
v_cvt_pk_bf16_f32 v202,v237,v202
M a[132:135],v[228:231],a[252:255],a[132:135]
v_cvt_pk_bf16_f32 v194,v233,v194
v_cvt_pk_bf16_f32 v198,v234,v196
M a[136:139],v[228:231],v[220:223],a[136:139]
buffer_load_dwordx4 v[224:227],v250,s[20:23],s47 offen offset:0 sc1
M a[136:139],a[212:215],a[192:195],a[136:139]
v_cvt_pk_bf16_f32 v196,v238,v235
v_cvt_pk_bf16_f32 v200,v236,v200
M a[136:139],a[208:211],a[228:231],a[136:139]
v_lshlrev_b32 v234,16,v197
v_lshlrev_b32 v232,16,v193
M a[140:143],a[208:211],a[232:235],a[140:143]
v_lshlrev_b32 v233,16,v195
v_lshlrev_b32 v237,16,v203
M a[140:143],a[212:215],a[228:231],a[140:143]
buffer_load_short_d16_hi v241,v246,s[8:11],s29 offen offset:384
M a[140:143],v[228:231],a[192:195],a[140:143]
v_lshlrev_b32 v236,16,v201
v_lshlrev_b32 v235,16,v199
M a[144:147],v[228:231],a[228:231],a[144:147]
buffer_load_short_d16_hi v242,v246,s[8:11],s29 offen offset:768
M a[144:147],a[212:215],a[232:235],a[144:147]
v_fmac_f32 v232,s43,v234
v_fmac_f32 v237,4.0,v233
M a[144:147],a[208:211],a[220:223],a[144:147]
buffer_load_short_d16_hi v243,v246,s[8:11],s29 offen offset:1152
M a[148:151],a[208:211],a[224:227],a[148:151]
v_fma_f32 v238,-4.0,v234,v236
v_fmac_f32 v232,s45,v236
M a[148:151],a[212:215],a[220:223],a[148:151]
buffer_load_short_d16_hi v244,v246,s[16:19],s29 offen offset:1536
M a[148:151],v[228:231],a[232:235],a[148:151]
v_fmac_f32 v237,s41,v235
v_sub_f32 v236,v236,v234
M a[152:155],v[228:231],a[220:223],a[152:155]
v_fma_f32 v234,-4.0,v233,v235
v_sub_f32 v235,v235,v233
M a[152:155],a[212:215],a[224:227],a[152:155]
v_add_f32 v233,v238,v234
v_sub_f32 v238,v238,v234
M a[152:155],a[208:211],a[244:247],a[152:155]
v_fma_f32 v234,2.0,v235,v236
v_fmac_f32 v236,-2.0,v235
M a[156:159],a[208:211],v[216:219],a[156:159]
buffer_load_dwordx4 a[208:211],v250,s[20:23],s47 offen offset:1024 sc1
M a[156:159],a[212:215],a[244:247],a[156:159]
v_and_b32 v197,s42,v197
v_and_b32 v193,s42,v193
M a[156:159],v[228:231],a[224:227],a[156:159]
s_waitcnt vmcnt(19)
buffer_load_dwordx4 a[212:215],v250,s[20:23],s47 offen offset:2048 sc1
M a[160:163],a[240:243],a[204:207],a[160:163]
s_waitcnt vmcnt(19)
s_add_u32 s48,s74,33792
v_and_b32 v195,s42,v195
v_and_b32 v203,s42,v203
M a[160:163],a[236:239],a[252:255],a[160:163]
s_waitcnt vmcnt(18)
v_and_b32 v201,s42,v201
v_and_b32 v199,s42,v199
M a[160:163],a[216:219],v[220:223],a[160:163]
v_fmac_f32 v193,s43,v197
v_fmac_f32 v203,4.0,v195
M a[164:167],a[216:219],a[192:195],a[164:167]
buffer_load_dwordx4 v[228:231],v250,s[20:23],s48 offen offset:0 sc1
M a[164:167],a[236:239],v[220:223],a[164:167]
v_fma_f32 v235,-4.0,v197,v201
v_fmac_f32 v193,s45,v201
M a[164:167],a[240:243],a[252:255],a[164:167]
v_fmac_f32 v203,s41,v199
v_sub_f32 v201,v201,v197
M a[168:171],a[240:243],v[220:223],a[168:171]
v_fma_f32 v197,-4.0,v195,v199
v_sub_f32 v199,v199,v195
M a[168:171],a[236:239],a[192:195],a[168:171]
buffer_load_dwordx4 a[204:207],v250,s[20:23],s48 offen offset:1024 sc1
M a[168:171],a[216:219],a[228:231],a[168:171]
v_add_f32 v195,v235,v197
v_sub_f32 v235,v235,v197
M a[172:175],a[216:219],a[232:235],a[172:175]
v_fma_f32 v197,2.0,v199,v201
v_fmac_f32 v201,-2.0,v199
M a[172:175],a[236:239],a[228:231],a[172:175]
v_cvt_pk_bf16_f32 v193,v232,v193
v_cvt_pk_bf16_f32 v203,v237,v203
M a[172:175],a[240:243],a[192:195],a[172:175]
buffer_load_dwordx4 a[252:255],v250,s[20:23],s48 offen offset:2048 sc1
M a[176:179],a[240:243],a[228:231],a[176:179]
s_add_u32 s46,s74,36864
v_cvt_pk_bf16_f32 v195,v233,v195
v_cvt_pk_bf16_f32 v199,v234,v197
M a[176:179],a[236:239],a[232:235],a[176:179]
v_cvt_pk_bf16_f32 v197,v238,v235
v_cvt_pk_bf16_f32 v201,v236,v201
M a[176:179],a[216:219],a[220:223],a[176:179]
s_waitcnt vmcnt(16)
v_add_u32 v238,121856,v247
v_lshlrev_b32 v234,16,v208
M a[180:183],a[216:219],a[224:227],a[180:183]
buffer_load_dwordx4 v[220:223],v250,s[20:23],s46 offen offset:0 sc1
M a[180:183],a[236:239],a[220:223],a[180:183]
ds_read_b128 a[192:195],v248 offset:17408
v_lshlrev_b32 v232,16,v204
M a[180:183],a[240:243],a[232:235],a[180:183]
ds_write2st64_b64 v238,v[192:193],v[202:203] offset0:2 offset1:19
M a[184:187],a[240:243],a[220:223],a[184:187]
s_add_u32 s28,s70,0
ds_read_b128 a[228:231],v249 offset:17408
ds_read_b128 a[232:235],v248 offset:17920
M a[184:187],a[236:239],a[224:227],a[184:187]
buffer_load_dwordx2 v[192:193],v251,s[12:15],s28 offen offset:0
M a[184:187],a[216:219],a[244:247],a[184:187]
ds_write2st64_b64 v247,v[194:195],v[196:197] offset0:104 offset1:121
M a[188:191],a[216:219],v[216:219],a[188:191]
ds_read_b128 a[220:223],v249 offset:17920
v_lshlrev_b32 v233,16,v206
M a[188:191],a[236:239],a[244:247],a[188:191]
buffer_load_dwordx2 v[202:203],v251,s[16:19],s28 offen offset:1536
M a[188:191],a[240:243],a[224:227],a[188:191]
s_waitcnt lgkmcnt(5)
ds_write2st64_b64 v247,v[198:199],v[200:201] offset0:138 offset1:155
M v[0:3],a[248:251],a[192:195],v[0:3]
s_waitcnt vmcnt(14) lgkmcnt(4)
ds_read_b128 a[216:219],v248 offset:18432
v_lshlrev_b32 v237,16,v214
M v[0:3],a[196:199],a[228:231],v[0:3]
s_waitcnt vmcnt(13) lgkmcnt(4)
buffer_load_dwordx2 v[194:195],v251,s[8:11],s28 offen offset:0
M v[0:3],a[200:203],a[232:235],v[0:3]
s_waitcnt lgkmcnt(2)
ds_read_b128 v[216:219],v249 offset:18432
v_lshlrev_b32 v236,16,v212
M v[4:7],a[200:203],a[220:223],v[4:7]
v_lshlrev_b32 v235,16,v210
v_fmac_f32 v232,s43,v234
M v[4:7],a[196:199],a[232:235],v[4:7]
v_fmac_f32 v237,4.0,v233
v_fma_f32 v238,-4.0,v234,v236
M v[4:7],a[248:251],a[228:231],v[4:7]
buffer_load_dwordx2 v[196:197],v251,s[8:11],s28 offen offset:384
M v[8:11],a[248:251],a[232:235],v[8:11]
ds_read_b128 a[236:239],v248 offset:18944
v_fmac_f32 v232,s45,v236
M v[8:11],a[196:199],a[220:223],v[8:11]
s_waitcnt lgkmcnt(2)
ds_read_b128 a[244:247],v249 offset:18944
v_fmac_f32 v237,s41,v235
M v[8:11],a[200:203],a[216:219],v[8:11]
s_waitcnt lgkmcnt(2)
v_sub_f32 v236,v236,v234
v_fma_f32 v234,-4.0,v233,v235
M v[12:15],a[200:203],v[216:219],v[12:15]
buffer_load_dwordx2 v[198:199],v251,s[8:11],s28 offen offset:768
M v[12:15],a[196:199],a[216:219],v[12:15]
v_sub_f32 v235,v235,v233
v_add_f32 v233,v238,v234
M v[12:15],a[248:251],a[220:223],v[12:15]
v_sub_f32 v238,v238,v234
v_fma_f32 v234,2.0,v235,v236
M v[16:19],a[248:251],a[216:219],v[16:19]
ds_read_b128 a[224:227],v249 offset:19456
v_fmac_f32 v236,-2.0,v235
M v[16:19],a[196:199],v[216:219],v[16:19]
s_waitcnt lgkmcnt(2)
buffer_load_dwordx2 v[200:201],v251,s[8:11],s28 offen offset:1152
M v[16:19],a[200:203],a[236:239],v[16:19]
s_waitcnt lgkmcnt(1)
ds_read_b128 a[240:243],v248 offset:19456
v_and_b32 v208,s42,v208
M v[20:23],a[200:203],a[244:247],v[20:23]
v_and_b32 v204,s42,v204
v_and_b32 v206,s42,v206
M v[20:23],a[196:199],a[236:239],v[20:23]
v_and_b32 v214,s42,v214
v_and_b32 v212,s42,v212
M v[20:23],a[248:251],v[216:219],v[20:23]
v_and_b32 v210,s42,v210
v_fmac_f32 v204,s43,v208
M v[24:27],a[248:251],a[236:239],v[24:27]
v_fmac_f32 v214,4.0,v206
v_fma_f32 v235,-4.0,v208,v212
M v[24:27],a[196:199],a[244:247],v[24:27]
s_waitcnt lgkmcnt(1)
v_fmac_f32 v204,s45,v212
v_fmac_f32 v214,s41,v210
M v[24:27],a[200:203],a[224:227],v[24:27]
s_waitcnt lgkmcnt(0)
v_sub_f32 v212,v212,v208
v_fma_f32 v208,-4.0,v206,v210
M v[28:31],a[200:203],a[240:243],v[28:31]
buffer_load_dwordx4 a[200:203],v250,s[20:23],s46 offen offset:1024 sc1
M v[28:31],a[196:199],a[224:227],v[28:31]
v_sub_f32 v210,v210,v206
v_add_f32 v206,v235,v208
M v[28:31],a[248:251],a[244:247],v[28:31]
s_waitcnt vmcnt(17)
buffer_load_dwordx4 a[196:199],v250,s[20:23],s46 offen offset:2048 sc1
M v[32:35],v[224:227],a[192:195],v[32:35]
s_waitcnt vmcnt(13)
s_add_u32 s47,s74,39936
v_sub_f32 v235,v235,v208
v_fma_f32 v208,2.0,v210,v212
M v[32:35],a[208:211],a[228:231],v[32:35]
s_waitcnt vmcnt(12)
v_fmac_f32 v212,-2.0,v210
v_cvt_pk_bf16_f32 v204,v232,v204
M v[32:35],a[212:215],a[232:235],v[32:35]
v_cvt_pk_bf16_f32 v214,v237,v214
v_cvt_pk_bf16_f32 v206,v233,v206
M v[36:39],a[212:215],a[220:223],v[36:39]
buffer_load_dwordx4 a[248:251],v250,s[20:23],s47 offen offset:0 sc1
M v[36:39],a[208:211],a[232:235],v[36:39]
v_cvt_pk_bf16_f32 v210,v234,v208
v_cvt_pk_bf16_f32 v208,v238,v235
M v[36:39],v[224:227],a[228:231],v[36:39]
v_cvt_pk_bf16_f32 v212,v236,v212
v_lshlrev_b32 v234,16,v209
M v[40:43],v[224:227],a[232:235],v[40:43]
v_lshlrev_b32 v232,16,v205
v_lshlrev_b32 v233,16,v207
M v[40:43],a[208:211],a[220:223],v[40:43]
v_lshlrev_b32 v237,16,v215
v_lshlrev_b32 v236,16,v213
M v[40:43],a[212:215],a[216:219],v[40:43]
v_lshlrev_b32 v235,16,v211
v_fmac_f32 v232,s43,v234
M v[44:47],a[212:215],v[216:219],v[44:47]
v_fmac_f32 v237,4.0,v233
v_fma_f32 v238,-4.0,v234,v236
M v[44:47],a[208:211],a[216:219],v[44:47]
v_fmac_f32 v232,s45,v236
v_fmac_f32 v237,s41,v235
M v[44:47],v[224:227],a[220:223],v[44:47]
v_sub_f32 v236,v236,v234
v_fma_f32 v234,-4.0,v233,v235
M v[48:51],v[224:227],a[216:219],v[48:51]
v_sub_f32 v235,v235,v233
v_add_f32 v233,v238,v234
M v[48:51],a[208:211],v[216:219],v[48:51]
v_sub_f32 v238,v238,v234
v_fma_f32 v234,2.0,v235,v236
M v[48:51],a[212:215],a[236:239],v[48:51]
v_fmac_f32 v236,-2.0,v235
v_and_b32 v209,s42,v209
M v[52:55],a[212:215],a[244:247],v[52:55]
v_and_b32 v205,s42,v205
v_and_b32 v207,s42,v207
M v[52:55],a[208:211],a[236:239],v[52:55]
v_and_b32 v215,s42,v215
v_and_b32 v213,s42,v213
M v[52:55],v[224:227],v[216:219],v[52:55]
v_and_b32 v211,s42,v211
v_fmac_f32 v205,s43,v209
M v[56:59],v[224:227],a[236:239],v[56:59]
v_fmac_f32 v215,4.0,v207
v_fma_f32 v235,-4.0,v209,v213
M v[56:59],a[208:211],a[244:247],v[56:59]
v_fmac_f32 v205,s45,v213
v_fmac_f32 v215,s41,v211
M v[56:59],a[212:215],a[224:227],v[56:59]
v_sub_f32 v213,v213,v209
v_fma_f32 v209,-4.0,v207,v211
M v[60:63],a[212:215],a[240:243],v[60:63]
buffer_load_dwordx4 a[212:215],v250,s[20:23],s47 offen offset:1024 sc1
M v[60:63],a[208:211],a[224:227],v[60:63]
v_sub_f32 v211,v211,v207
v_add_f32 v207,v235,v209
M v[60:63],v[224:227],a[244:247],v[60:63]
s_waitcnt vmcnt(13)
buffer_load_dwordx4 a[208:211],v250,s[20:23],s47 offen offset:2048 sc1
M v[64:67],v[228:231],a[192:195],v[64:67]
s_waitcnt vmcnt(13)
s_add_u32 s48,s74,43008
v_sub_f32 v235,v235,v209
v_fma_f32 v209,2.0,v211,v213
M v[64:67],a[204:207],a[228:231],v[64:67]
s_waitcnt vmcnt(12)
v_fmac_f32 v213,-2.0,v211
v_cvt_pk_bf16_f32 v205,v232,v205
M v[64:67],a[252:255],a[232:235],v[64:67]
v_cvt_pk_bf16_f32 v215,v237,v215
v_cvt_pk_bf16_f32 v207,v233,v207
M v[68:71],a[252:255],a[220:223],v[68:71]
buffer_load_dwordx4 v[224:227],v250,s[20:23],s48 offen offset:0 sc1
M v[68:71],a[204:207],a[232:235],v[68:71]
v_cvt_pk_bf16_f32 v211,v234,v209
v_cvt_pk_bf16_f32 v209,v238,v235
M v[68:71],v[228:231],a[228:231],v[68:71]
v_cvt_pk_bf16_f32 v213,v236,v213
v_add_u32 v238,121856,v247
M v[72:75],v[228:231],a[232:235],v[72:75]
M v[72:75],a[204:207],a[220:223],v[72:75]
buffer_load_dwordx4 a[192:195],v250,s[20:23],s48 offen offset:1024 sc1
M v[72:75],a[252:255],a[216:219],v[72:75]
ds_write2st64_b64 v238,v[204:205],v[214:215] offset0:3 offset1:20
M v[76:79],a[252:255],v[216:219],v[76:79]
s_add_u32 s28,s70,393216
M v[76:79],a[204:207],a[216:219],v[76:79]
M v[76:79],v[228:231],a[220:223],v[76:79]
buffer_load_dwordx4 a[228:231],v250,s[20:23],s48 offen offset:2048 sc1
M v[80:83],v[228:231],a[216:219],v[80:83]
s_add_u32 s46,s75,9216
M v[80:83],a[204:207],v[216:219],v[80:83]
M v[80:83],a[252:255],a[236:239],v[80:83]
ds_write2st64_b64 v247,v[206:207],v[208:209] offset0:105 offset1:122
M v[84:87],a[252:255],a[244:247],v[84:87]
buffer_load_dwordx4 a[232:235],v250,s[20:23],s46 offen offset:0 sc1
M v[84:87],a[204:207],a[236:239],v[84:87]
ds_read_b128 a[220:223],v248 offset:26112
M v[84:87],v[228:231],v[216:219],v[84:87]
ds_write2st64_b64 v247,v[210:211],v[212:213] offset0:139 offset1:156
M v[88:91],v[228:231],a[236:239],v[88:91]
buffer_load_dwordx2 v[204:205],v245,s[12:15],s28 offen offset:0
M v[88:91],a[204:207],a[244:247],v[88:91]
ds_read_b128 a[216:219],v249 offset:26112
ds_read_b128 v[216:219],v248 offset:26624
M v[88:91],a[252:255],a[224:227],v[88:91]
ds_read_b128 a[236:239],v249 offset:26624
M v[92:95],a[252:255],a[240:243],v[92:95]
buffer_load_dwordx2 v[214:215],v245,s[16:19],s28 offen offset:1536
M v[92:95],a[204:207],a[224:227],v[92:95]
M v[92:95],v[228:231],a[244:247],v[92:95]
s_waitcnt vmcnt(17) lgkmcnt(4)
M v[96:99],v[220:223],a[220:223],v[96:99]
s_waitcnt vmcnt(10) lgkmcnt(2)
ds_read_b128 a[240:243],v248 offset:27136
M v[96:99],a[200:203],a[216:219],v[96:99]
s_waitcnt vmcnt(9) lgkmcnt(2)
buffer_load_dwordx2 v[206:207],v245,s[8:11],s28 offen offset:0
M v[96:99],a[196:199],v[216:219],v[96:99]
s_waitcnt lgkmcnt(1)
ds_read_b128 a[252:255],v249 offset:27136
v_lshlrev_b32 v234,16,v196
M v[100:103],a[196:199],a[236:239],v[100:103]
v_lshlrev_b32 v232,16,v192
v_lshlrev_b32 v233,16,v194
M v[100:103],a[200:203],v[216:219],v[100:103]
v_lshlrev_b32 v237,16,v202
v_lshlrev_b32 v236,16,v200
M v[100:103],v[220:223],a[216:219],v[100:103]
buffer_load_dwordx2 v[208:209],v245,s[8:11],s28 offen offset:384
M v[104:107],v[220:223],v[216:219],v[104:107]
ds_read_b128 a[204:207],v248 offset:27648
v_lshlrev_b32 v235,16,v198
M v[104:107],a[200:203],a[236:239],v[104:107]
s_waitcnt lgkmcnt(2)
ds_read_b128 a[224:227],v249 offset:27648
v_fmac_f32 v232,s43,v234
M v[104:107],a[196:199],a[240:243],v[104:107]
s_waitcnt lgkmcnt(2)
v_fmac_f32 v237,4.0,v233
v_fma_f32 v238,-4.0,v234,v236
M v[108:111],a[196:199],a[252:255],v[108:111]
buffer_load_dwordx2 v[210:211],v245,s[8:11],s28 offen offset:768
M v[108:111],a[200:203],a[240:243],v[108:111]
v_fmac_f32 v232,s45,v236
v_fmac_f32 v237,s41,v235
M v[108:111],v[220:223],a[236:239],v[108:111]
v_sub_f32 v236,v236,v234
v_fma_f32 v234,-4.0,v233,v235
M v[112:115],v[220:223],a[240:243],v[112:115]
ds_read_b128 a[244:247],v249 offset:28160
v_sub_f32 v235,v235,v233
M v[112:115],a[200:203],a[252:255],v[112:115]
s_waitcnt lgkmcnt(2)
buffer_load_dwordx2 v[212:213],v245,s[8:11],s28 offen offset:1152
M v[112:115],a[196:199],a[204:207],v[112:115]
s_waitcnt lgkmcnt(1)
ds_read_b128 v[228:231],v248 offset:28160
v_add_f32 v233,v238,v234
M v[116:119],a[196:199],a[224:227],v[116:119]
v_sub_f32 v238,v238,v234
v_fma_f32 v234,2.0,v235,v236
M v[116:119],a[200:203],a[204:207],v[116:119]
v_fmac_f32 v236,-2.0,v235
v_and_b32 v196,s42,v196
M v[116:119],v[220:223],a[252:255],v[116:119]
v_and_b32 v192,s42,v192
v_and_b32 v194,s42,v194
M v[120:123],v[220:223],a[204:207],v[120:123]
v_and_b32 v202,s42,v202
v_and_b32 v200,s42,v200
M v[120:123],a[200:203],a[224:227],v[120:123]
s_waitcnt lgkmcnt(1)
v_and_b32 v198,s42,v198
v_fmac_f32 v192,s43,v196
M v[120:123],a[196:199],a[244:247],v[120:123]
s_waitcnt lgkmcnt(0)
v_fmac_f32 v202,4.0,v194
v_fma_f32 v235,-4.0,v196,v200
M v[124:127],a[196:199],v[228:231],v[124:127]
buffer_load_dwordx4 a[196:199],v250,s[20:23],s46 offen offset:1024 sc1
M v[124:127],a[200:203],a[244:247],v[124:127]
v_fmac_f32 v192,s45,v200
v_fmac_f32 v202,s41,v198
M v[124:127],v[220:223],a[224:227],v[124:127]
s_waitcnt vmcnt(13)
buffer_load_dwordx4 a[200:203],v250,s[20:23],s46 offen offset:2048 sc1
M v[128:131],a[248:251],a[220:223],v[128:131]
s_waitcnt vmcnt(13)
s_add_u32 s47,s75,12288
v_sub_f32 v200,v200,v196
v_fma_f32 v196,-4.0,v194,v198
M v[128:131],a[212:215],a[216:219],v[128:131]
s_waitcnt vmcnt(12)
v_sub_f32 v198,v198,v194
v_add_f32 v194,v235,v196
M v[128:131],a[208:211],v[216:219],v[128:131]
v_sub_f32 v235,v235,v196
v_fma_f32 v196,2.0,v198,v200
M v[132:135],a[208:211],a[236:239],v[132:135]
buffer_load_dwordx4 v[220:223],v250,s[20:23],s47 offen offset:0 sc1
M v[132:135],a[212:215],v[216:219],v[132:135]
v_fmac_f32 v200,-2.0,v198
v_cvt_pk_bf16_f32 v192,v232,v192
M v[132:135],a[248:251],a[216:219],v[132:135]
v_cvt_pk_bf16_f32 v202,v237,v202
v_cvt_pk_bf16_f32 v194,v233,v194
M v[136:139],a[248:251],v[216:219],v[136:139]
v_cvt_pk_bf16_f32 v198,v234,v196
v_cvt_pk_bf16_f32 v196,v238,v235
M v[136:139],a[212:215],a[236:239],v[136:139]
v_cvt_pk_bf16_f32 v200,v236,v200
v_lshlrev_b32 v234,16,v197
M v[136:139],a[208:211],a[240:243],v[136:139]
v_lshlrev_b32 v232,16,v193
v_lshlrev_b32 v233,16,v195
M v[140:143],a[208:211],a[252:255],v[140:143]
v_lshlrev_b32 v237,16,v203
v_lshlrev_b32 v236,16,v201
M v[140:143],a[212:215],a[240:243],v[140:143]
v_lshlrev_b32 v235,16,v199
v_fmac_f32 v232,s43,v234
M v[140:143],a[248:251],a[236:239],v[140:143]
v_fmac_f32 v237,4.0,v233
v_fma_f32 v238,-4.0,v234,v236
M v[144:147],a[248:251],a[240:243],v[144:147]
v_fmac_f32 v232,s45,v236
v_fmac_f32 v237,s41,v235
M v[144:147],a[212:215],a[252:255],v[144:147]
v_sub_f32 v236,v236,v234
v_fma_f32 v234,-4.0,v233,v235
M v[144:147],a[208:211],a[204:207],v[144:147]
v_sub_f32 v235,v235,v233
v_add_f32 v233,v238,v234
M v[148:151],a[208:211],a[224:227],v[148:151]
v_sub_f32 v238,v238,v234
v_fma_f32 v234,2.0,v235,v236
M v[148:151],a[212:215],a[204:207],v[148:151]
v_fmac_f32 v236,-2.0,v235
v_and_b32 v197,s42,v197
M v[148:151],a[248:251],a[252:255],v[148:151]
v_and_b32 v193,s42,v193
v_and_b32 v195,s42,v195
M v[152:155],a[248:251],a[204:207],v[152:155]
v_and_b32 v203,s42,v203
v_and_b32 v201,s42,v201
M v[152:155],a[212:215],a[224:227],v[152:155]
v_and_b32 v199,s42,v199
v_fmac_f32 v193,s43,v197
M v[152:155],a[208:211],a[244:247],v[152:155]
v_fmac_f32 v203,4.0,v195
v_fma_f32 v235,-4.0,v197,v201
M v[156:159],a[208:211],v[228:231],v[156:159]
buffer_load_dwordx4 a[208:211],v250,s[20:23],s47 offen offset:1024 sc1
M v[156:159],a[212:215],a[244:247],v[156:159]
v_fmac_f32 v193,s45,v201
v_fmac_f32 v203,s41,v199
M v[156:159],a[248:251],a[224:227],v[156:159]
s_waitcnt vmcnt(13)
buffer_load_dwordx4 a[212:215],v250,s[20:23],s47 offen offset:2048 sc1
M v[160:163],v[224:227],a[220:223],v[160:163]
s_waitcnt vmcnt(13)
s_add_u32 s48,s75,15360
v_sub_f32 v201,v201,v197
v_fma_f32 v197,-4.0,v195,v199
M v[160:163],a[192:195],a[216:219],v[160:163]
s_waitcnt vmcnt(12)
v_sub_f32 v199,v199,v195
v_add_f32 v195,v235,v197
M v[160:163],a[228:231],v[216:219],v[160:163]
v_sub_f32 v235,v235,v197
v_fma_f32 v197,2.0,v199,v201
M v[164:167],a[228:231],a[236:239],v[164:167]
buffer_load_dwordx4 a[248:251],v250,s[20:23],s48 offen offset:0 sc1
M v[164:167],a[192:195],v[216:219],v[164:167]
v_fmac_f32 v201,-2.0,v199
v_cvt_pk_bf16_f32 v193,v232,v193
M v[164:167],v[224:227],a[216:219],v[164:167]
v_cvt_pk_bf16_f32 v203,v237,v203
v_cvt_pk_bf16_f32 v195,v233,v195
M v[168:171],v[224:227],v[216:219],v[168:171]
v_cvt_pk_bf16_f32 v199,v234,v197
v_cvt_pk_bf16_f32 v197,v238,v235
M v[168:171],a[192:195],a[236:239],v[168:171]
buffer_load_dwordx4 a[220:223],v250,s[20:23],s48 offen offset:1024 sc1
M v[168:171],a[228:231],a[240:243],v[168:171]
v_cvt_pk_bf16_f32 v201,v236,v201
v_add_u32 v238,139264,v247
M v[172:175],a[228:231],a[252:255],v[172:175]
M v[172:175],a[192:195],a[240:243],v[172:175]
M v[172:175],v[224:227],a[236:239],v[172:175]
buffer_load_dwordx4 a[216:219],v250,s[20:23],s48 offen offset:2048 sc1
M v[176:179],v[224:227],a[240:243],v[176:179]
s_add_u32 s46,s75,18432
M v[176:179],a[192:195],a[252:255],v[176:179]
M v[176:179],a[228:231],a[204:207],v[176:179]
s_barrier
ds_write2st64_b64 v238,v[192:193],v[202:203] offset0:0 offset1:17
M v[180:183],a[228:231],a[224:227],v[180:183]
s_add_u32 s28,s70,786432
buffer_load_dwordx4 v[216:219],v250,s[20:23],s46 offen offset:0 sc1
M v[180:183],a[192:195],a[204:207],v[180:183]
ds_read_b128 a[236:239],v248 offset:34816
M v[180:183],v[224:227],a[252:255],v[180:183]
ds_write2st64_b64 v247,v[194:195],v[196:197] offset0:34 offset1:51
M v[184:187],v[224:227],a[204:207],v[184:187]
buffer_load_dwordx2 v[192:193],v245,s[12:15],s28 offen offset:0
M v[184:187],a[192:195],a[224:227],v[184:187]
ds_read_b128 a[240:243],v249 offset:34816
ds_read_b128 a[252:255],v248 offset:35328
M v[184:187],a[228:231],a[244:247],v[184:187]
ds_write2st64_b64 v247,v[198:199],v[200:201] offset0:68 offset1:85
M v[188:191],a[228:231],v[228:231],v[188:191]
buffer_load_dwordx2 v[202:203],v245,s[16:19],s28 offen offset:1536
M v[188:191],a[192:195],a[244:247],v[188:191]
ds_read_b128 a[204:207],v249 offset:35328
M v[188:191],v[224:227],a[224:227],v[188:191]
s_waitcnt vmcnt(17) lgkmcnt(5)
M a[0:3],a[232:235],a[236:239],a[0:3]
s_waitcnt vmcnt(10) lgkmcnt(3)
ds_read_b128 a[228:231],v248 offset:35840
M a[0:3],a[196:199],a[240:243],a[0:3]
s_waitcnt vmcnt(9) lgkmcnt(3)
buffer_load_dwordx2 v[194:195],v245,s[8:11],s28 offen offset:0
M a[0:3],a[200:203],a[252:255],a[0:3]
s_waitcnt lgkmcnt(1)
ds_read_b128 v[228:231],v249 offset:35840
v_lshlrev_b32 v234,16,v208
M a[4:7],a[200:203],a[204:207],a[4:7]
v_lshlrev_b32 v232,16,v204
v_lshlrev_b32 v233,16,v206
M a[4:7],a[196:199],a[252:255],a[4:7]
v_lshlrev_b32 v237,16,v214
v_lshlrev_b32 v236,16,v212
M a[4:7],a[232:235],a[240:243],a[4:7]
buffer_load_dwordx2 v[196:197],v245,s[8:11],s28 offen offset:384
M a[8:11],a[232:235],a[252:255],a[8:11]
ds_read_b128 a[192:195],v248 offset:36352
v_lshlrev_b32 v235,16,v210
M a[8:11],a[196:199],a[204:207],a[8:11]
s_waitcnt lgkmcnt(2)
ds_read_b128 a[244:247],v249 offset:36352
v_fmac_f32 v232,s43,v234
M a[8:11],a[200:203],a[228:231],a[8:11]
s_waitcnt lgkmcnt(2)
v_fmac_f32 v237,4.0,v233
v_fma_f32 v238,-4.0,v234,v236
M a[12:15],a[200:203],v[228:231],a[12:15]
buffer_load_dwordx2 v[198:199],v245,s[8:11],s28 offen offset:768
M a[12:15],a[196:199],a[228:231],a[12:15]
v_fmac_f32 v232,s45,v236
v_fmac_f32 v237,s41,v235
M a[12:15],a[232:235],a[204:207],a[12:15]
v_sub_f32 v236,v236,v234
v_fma_f32 v234,-4.0,v233,v235
M a[16:19],a[232:235],a[228:231],a[16:19]
ds_read_b128 a[224:227],v249 offset:36864
v_sub_f32 v235,v235,v233
M a[16:19],a[196:199],v[228:231],a[16:19]
s_waitcnt lgkmcnt(2)
buffer_load_dwordx2 v[200:201],v245,s[8:11],s28 offen offset:1152
M a[16:19],a[200:203],a[192:195],a[16:19]
s_waitcnt lgkmcnt(1)
ds_read_b128 v[224:227],v248 offset:36864
v_add_f32 v233,v238,v234
M a[20:23],a[200:203],a[244:247],a[20:23]
v_sub_f32 v238,v238,v234
v_fma_f32 v234,2.0,v235,v236
M a[20:23],a[196:199],a[192:195],a[20:23]
v_fmac_f32 v236,-2.0,v235
v_and_b32 v208,s42,v208
M a[20:23],a[232:235],v[228:231],a[20:23]
v_and_b32 v204,s42,v204
v_and_b32 v206,s42,v206
M a[24:27],a[232:235],a[192:195],a[24:27]
v_and_b32 v214,s42,v214
v_and_b32 v212,s42,v212
M a[24:27],a[196:199],a[244:247],a[24:27]
s_waitcnt lgkmcnt(1)
v_and_b32 v210,s42,v210
v_fmac_f32 v204,s43,v208
M a[24:27],a[200:203],a[224:227],a[24:27]
s_waitcnt lgkmcnt(0)
v_fmac_f32 v214,4.0,v206
v_fma_f32 v235,-4.0,v208,v212
M a[28:31],a[200:203],v[224:227],a[28:31]
buffer_load_dwordx4 a[200:203],v250,s[20:23],s46 offen offset:1024 sc1
M a[28:31],a[196:199],a[224:227],a[28:31]
v_fmac_f32 v204,s45,v212
v_fmac_f32 v214,s41,v210
M a[28:31],a[232:235],a[244:247],a[28:31]
s_waitcnt vmcnt(13)
buffer_load_dwordx4 a[196:199],v250,s[20:23],s46 offen offset:2048 sc1
M a[32:35],v[220:223],a[236:239],a[32:35]
s_waitcnt vmcnt(13)
s_add_u32 s47,s75,21504
v_sub_f32 v212,v212,v208
v_fma_f32 v208,-4.0,v206,v210
M a[32:35],a[208:211],a[240:243],a[32:35]
s_waitcnt vmcnt(12)
v_sub_f32 v210,v210,v206
v_add_f32 v206,v235,v208
M a[32:35],a[212:215],a[252:255],a[32:35]
v_sub_f32 v235,v235,v208
v_fma_f32 v208,2.0,v210,v212
M a[36:39],a[212:215],a[204:207],a[36:39]
buffer_load_dwordx4 a[232:235],v250,s[20:23],s47 offen offset:0 sc1
M a[36:39],a[208:211],a[252:255],a[36:39]
v_fmac_f32 v212,-2.0,v210
v_cvt_pk_bf16_f32 v204,v232,v204
M a[36:39],v[220:223],a[240:243],a[36:39]
v_cvt_pk_bf16_f32 v214,v237,v214
v_cvt_pk_bf16_f32 v206,v233,v206
M a[40:43],v[220:223],a[252:255],a[40:43]
v_cvt_pk_bf16_f32 v210,v234,v208
v_cvt_pk_bf16_f32 v208,v238,v235
M a[40:43],a[208:211],a[204:207],a[40:43]
v_cvt_pk_bf16_f32 v212,v236,v212
v_lshlrev_b32 v234,16,v209
M a[40:43],a[212:215],a[228:231],a[40:43]
v_lshlrev_b32 v232,16,v205
v_lshlrev_b32 v233,16,v207
M a[44:47],a[212:215],v[228:231],a[44:47]
v_lshlrev_b32 v237,16,v215
v_lshlrev_b32 v236,16,v213
M a[44:47],a[208:211],a[228:231],a[44:47]
v_lshlrev_b32 v235,16,v211
v_fmac_f32 v232,s43,v234
M a[44:47],v[220:223],a[204:207],a[44:47]
v_fmac_f32 v237,4.0,v233
v_fma_f32 v238,-4.0,v234,v236
M a[48:51],v[220:223],a[228:231],a[48:51]
v_fmac_f32 v232,s45,v236
v_fmac_f32 v237,s41,v235
M a[48:51],a[208:211],v[228:231],a[48:51]
v_sub_f32 v236,v236,v234
v_fma_f32 v234,-4.0,v233,v235
M a[48:51],a[212:215],a[192:195],a[48:51]
v_sub_f32 v235,v235,v233
v_add_f32 v233,v238,v234
M a[52:55],a[212:215],a[244:247],a[52:55]
v_sub_f32 v238,v238,v234
v_fma_f32 v234,2.0,v235,v236
M a[52:55],a[208:211],a[192:195],a[52:55]
v_fmac_f32 v236,-2.0,v235
v_and_b32 v209,s42,v209
M a[52:55],v[220:223],v[228:231],a[52:55]
v_and_b32 v205,s42,v205
v_and_b32 v207,s42,v207
M a[56:59],v[220:223],a[192:195],a[56:59]
v_and_b32 v215,s42,v215
v_and_b32 v213,s42,v213
M a[56:59],a[208:211],a[244:247],a[56:59]
v_and_b32 v211,s42,v211
v_fmac_f32 v205,s43,v209
M a[56:59],a[212:215],a[224:227],a[56:59]
v_fmac_f32 v215,4.0,v207
v_fma_f32 v235,-4.0,v209,v213
M a[60:63],a[212:215],v[224:227],a[60:63]
buffer_load_dwordx4 a[212:215],v250,s[20:23],s47 offen offset:1024 sc1
M a[60:63],a[208:211],a[224:227],a[60:63]
v_fmac_f32 v205,s45,v213
v_fmac_f32 v215,s41,v211
M a[60:63],v[220:223],a[244:247],a[60:63]
s_waitcnt vmcnt(13)
buffer_load_dwordx4 a[208:211],v250,s[20:23],s47 offen offset:2048 sc1
M a[64:67],a[248:251],a[236:239],a[64:67]
s_waitcnt vmcnt(13)
s_add_u32 s48,s75,24576
v_sub_f32 v213,v213,v209
v_fma_f32 v209,-4.0,v207,v211
M a[64:67],a[220:223],a[240:243],a[64:67]
s_waitcnt vmcnt(12)
v_sub_f32 v211,v211,v207
v_add_f32 v207,v235,v209
M a[64:67],a[216:219],a[252:255],a[64:67]
v_sub_f32 v235,v235,v209
v_fma_f32 v209,2.0,v211,v213
M a[68:71],a[216:219],a[204:207],a[68:71]
buffer_load_dwordx4 v[220:223],v250,s[20:23],s48 offen offset:0 sc1
M a[68:71],a[220:223],a[252:255],a[68:71]
v_fmac_f32 v213,-2.0,v211
v_cvt_pk_bf16_f32 v205,v232,v205
M a[68:71],a[248:251],a[240:243],a[68:71]
v_cvt_pk_bf16_f32 v215,v237,v215
v_cvt_pk_bf16_f32 v207,v233,v207
M a[72:75],a[248:251],a[252:255],a[72:75]
v_cvt_pk_bf16_f32 v211,v234,v209
v_cvt_pk_bf16_f32 v209,v238,v235
M a[72:75],a[220:223],a[204:207],a[72:75]
buffer_load_dwordx4 a[236:239],v250,s[20:23],s48 offen offset:1024 sc1
M a[72:75],a[216:219],a[228:231],a[72:75]
v_cvt_pk_bf16_f32 v213,v236,v213
v_add_u32 v238,139264,v247
M a[76:79],a[216:219],v[228:231],a[76:79]
v_fmac_f32 v239,s43,v241
v_fmac_f32 v244,4.0,v240
M a[76:79],a[220:223],a[228:231],a[76:79]
v_fma_f32 v232,-4.0,v241,v243
v_fmac_f32 v239,s45,v243
M a[76:79],a[248:251],a[204:207],a[76:79]
buffer_load_dwordx4 a[240:243],v250,s[20:23],s48 offen offset:2048 sc1
M a[80:83],a[248:251],a[228:231],a[80:83]
s_add_u32 s46,s75,27648
v_fmac_f32 v244,s41,v242
v_sub_f32 v243,v243,v241
M a[80:83],a[220:223],v[228:231],a[80:83]
v_fma_f32 v241,-4.0,v240,v242
v_sub_f32 v242,v242,v240
M a[80:83],a[216:219],a[192:195],a[80:83]
ds_write2st64_b64 v238,v[204:205],v[214:215] offset0:1 offset1:18
M a[84:87],a[216:219],a[244:247],a[84:87]
s_add_u32 s28,s70,1179648
buffer_load_dwordx4 a[252:255],v250,s[20:23],s46 offen offset:0 sc1
M a[84:87],a[220:223],a[192:195],a[84:87]
ds_read_b128 a[204:207],v248 offset:43520
v_add_f32 v240,v232,v241
M a[84:87],a[248:251],v[228:231],a[84:87]
ds_write2st64_b64 v247,v[206:207],v[208:209] offset0:35 offset1:52
M a[88:91],a[248:251],a[192:195],a[88:91]
buffer_load_dwordx2 v[204:205],v245,s[12:15],s28 offen offset:0
M a[88:91],a[220:223],a[244:247],a[88:91]
ds_read_b128 a[228:231],v249 offset:43520
ds_read_b128 v[228:231],v248 offset:44032
M a[88:91],a[216:219],a[224:227],a[88:91]
ds_write2st64_b64 v247,v[210:211],v[212:213] offset0:69 offset1:86
M a[92:95],a[216:219],v[224:227],a[92:95]
buffer_load_dwordx2 v[214:215],v245,s[16:19],s28 offen offset:1536
M a[92:95],a[220:223],a[224:227],a[92:95]
ds_read_b128 a[192:195],v249 offset:44032
v_sub_f32 v232,v232,v241
M a[92:95],a[248:251],a[244:247],a[92:95]
s_waitcnt vmcnt(17) lgkmcnt(5)
v_fma_f32 v241,2.0,v242,v243
v_fmac_f32 v243,-2.0,v242
M a[96:99],v[216:219],a[204:207],a[96:99]
s_waitcnt vmcnt(10) lgkmcnt(3)
ds_read_b128 a[216:219],v248 offset:44544
v_cvt_pk_bf16_f32 v233,v239,v244
M a[96:99],a[200:203],a[228:231],a[96:99]
s_waitcnt vmcnt(9) lgkmcnt(3)
buffer_load_dwordx2 v[206:207],v245,s[8:11],s28 offen offset:0
M a[96:99],a[196:199],v[228:231],a[96:99]
s_waitcnt lgkmcnt(1)
ds_read_b128 v[224:227],v249 offset:44544
v_cvt_pk_bf16_f32 v234,v240,v232
M a[100:103],a[196:199],a[192:195],a[100:103]
v_cvt_pk_bf16_f32 v235,v241,v243
v_add_u32 v232,139264,v252
M a[100:103],a[200:203],v[228:231],a[100:103]
ds_write_b16 v232,v233 offset:0
M a[100:103],v[216:219],a[228:231],a[100:103]
buffer_load_dwordx2 v[208:209],v245,s[8:11],s28 offen offset:384
M a[104:107],v[216:219],v[228:231],a[104:107]
ds_read_b128 a[220:223],v248 offset:45056
ds_write_b16_d16_hi v232,v233 offset:8704
M a[104:107],a[200:203],a[192:195],a[104:107]
s_waitcnt lgkmcnt(4)
ds_read_b128 a[224:227],v249 offset:45056
ds_write_b16 v252,v234 offset:17408
M a[104:107],a[196:199],a[216:219],a[104:107]
s_waitcnt lgkmcnt(5)
ds_write_b16_d16_hi v252,v234 offset:26112
M a[108:111],a[196:199],v[224:227],a[108:111]
buffer_load_dwordx2 v[210:211],v245,s[8:11],s28 offen offset:768
M a[108:111],a[200:203],a[216:219],a[108:111]
ds_write_b16 v252,v235 offset:34816
M a[108:111],v[216:219],a[192:195],a[108:111]
ds_write_b16_d16_hi v252,v235 offset:43520
M a[112:115],v[216:219],a[216:219],a[112:115]
ds_read_b128 a[244:247],v249 offset:45568
v_lshlrev_b32 v234,16,v196
M a[112:115],a[200:203],v[224:227],a[112:115]
s_waitcnt lgkmcnt(7)
buffer_load_dwordx2 v[212:213],v245,s[8:11],s28 offen offset:1152
M a[112:115],a[196:199],a[220:223],a[112:115]
s_waitcnt lgkmcnt(5)
s_add_u32 s29,s71,0
ds_read_b128 a[248:251],v248 offset:45568
v_lshlrev_b32 v232,16,v192
M a[116:119],a[196:199],a[224:227],a[116:119]
v_lshlrev_b32 v233,16,v194
v_lshlrev_b32 v237,16,v202
M a[116:119],a[200:203],a[220:223],a[116:119]
v_lshlrev_b32 v236,16,v200
v_lshlrev_b32 v235,16,v198
M a[116:119],v[216:219],v[224:227],a[116:119]
buffer_load_short_d16_hi v239,v246,s[12:15],s29 offen offset:0
M a[120:123],v[216:219],a[220:223],a[120:123]
v_fmac_f32 v232,s43,v234
v_fmac_f32 v237,4.0,v233
M a[120:123],a[200:203],a[224:227],a[120:123]
s_waitcnt lgkmcnt(1)
buffer_load_short_d16_hi v240,v246,s[8:11],s29 offen offset:0
M a[120:123],a[196:199],a[244:247],a[120:123]
s_waitcnt lgkmcnt(0)
v_fma_f32 v238,-4.0,v234,v236
v_fmac_f32 v232,s45,v236
M a[124:127],a[196:199],a[248:251],a[124:127]
buffer_load_dwordx4 a[196:199],v250,s[20:23],s46 offen offset:1024 sc1
M a[124:127],a[200:203],a[244:247],a[124:127]
v_fmac_f32 v237,s41,v235
v_sub_f32 v236,v236,v234
M a[124:127],v[216:219],a[224:227],a[124:127]
s_waitcnt vmcnt(15)
v_fma_f32 v234,-4.0,v233,v235
v_sub_f32 v235,v235,v233
M a[128:131],a[232:235],a[204:207],a[128:131]
s_waitcnt vmcnt(14)
v_add_f32 v233,v238,v234
v_sub_f32 v238,v238,v234
M a[128:131],a[212:215],a[228:231],a[128:131]
s_waitcnt vmcnt(13)
buffer_load_dwordx4 a[200:203],v250,s[20:23],s46 offen offset:2048 sc1
M a[128:131],a[208:211],v[228:231],a[128:131]
s_add_u32 s47,s75,30720
v_fma_f32 v234,2.0,v235,v236
v_fmac_f32 v236,-2.0,v235
M a[132:135],a[208:211],a[192:195],a[132:135]
v_and_b32 v196,s42,v196
v_and_b32 v192,s42,v192
M a[132:135],a[212:215],v[228:231],a[132:135]
v_and_b32 v194,s42,v194
v_and_b32 v202,s42,v202
M a[132:135],a[232:235],a[228:231],a[132:135]
buffer_load_dwordx4 v[216:219],v250,s[20:23],s47 offen offset:0 sc1
M a[136:139],a[232:235],v[228:231],a[136:139]
v_and_b32 v200,s42,v200
v_and_b32 v198,s42,v198
M a[136:139],a[212:215],a[192:195],a[136:139]
v_fmac_f32 v192,s43,v196
v_fmac_f32 v202,4.0,v194
M a[136:139],a[208:211],a[216:219],a[136:139]
v_fma_f32 v235,-4.0,v196,v200
v_fmac_f32 v192,s45,v200
M a[140:143],a[208:211],v[224:227],a[140:143]
buffer_load_short_d16_hi v241,v246,s[8:11],s29 offen offset:384
M a[140:143],a[212:215],a[216:219],a[140:143]
v_fmac_f32 v202,s41,v198
v_sub_f32 v200,v200,v196
M a[140:143],a[232:235],a[192:195],a[140:143]
buffer_load_short_d16_hi v242,v246,s[8:11],s29 offen offset:768
M a[144:147],a[232:235],a[216:219],a[144:147]
v_fma_f32 v196,-4.0,v194,v198
v_sub_f32 v198,v198,v194
M a[144:147],a[212:215],v[224:227],a[144:147]
buffer_load_short_d16_hi v243,v246,s[8:11],s29 offen offset:1152
M a[144:147],a[208:211],a[220:223],a[144:147]
v_add_f32 v194,v235,v196
v_sub_f32 v235,v235,v196
M a[148:151],a[208:211],a[224:227],a[148:151]
buffer_load_short_d16_hi v244,v246,s[16:19],s29 offen offset:1536
M a[148:151],a[212:215],a[220:223],a[148:151]
v_fma_f32 v196,2.0,v198,v200
v_fmac_f32 v200,-2.0,v198
M a[148:151],a[232:235],v[224:227],a[148:151]
v_cvt_pk_bf16_f32 v192,v232,v192
v_cvt_pk_bf16_f32 v202,v237,v202
M a[152:155],a[232:235],a[220:223],a[152:155]
v_cvt_pk_bf16_f32 v194,v233,v194
v_cvt_pk_bf16_f32 v198,v234,v196
M a[152:155],a[212:215],a[224:227],a[152:155]
v_cvt_pk_bf16_f32 v196,v238,v235
v_cvt_pk_bf16_f32 v200,v236,v200
M a[152:155],a[208:211],a[244:247],a[152:155]
v_lshlrev_b32 v234,16,v197
v_lshlrev_b32 v232,16,v193
M a[156:159],a[208:211],a[248:251],a[156:159]
buffer_load_dwordx4 a[208:211],v250,s[20:23],s47 offen offset:1024 sc1
M a[156:159],a[212:215],a[244:247],a[156:159]
v_lshlrev_b32 v233,16,v195
v_lshlrev_b32 v237,16,v203
M a[156:159],a[232:235],a[224:227],a[156:159]
s_waitcnt vmcnt(19)
buffer_load_dwordx4 a[212:215],v250,s[20:23],s47 offen offset:2048 sc1
M a[160:163],v[220:223],a[204:207],a[160:163]
s_waitcnt vmcnt(19)
s_add_u32 s48,s75,33792
v_lshlrev_b32 v236,16,v201
v_lshlrev_b32 v235,16,v199
M a[160:163],a[236:239],a[228:231],a[160:163]
s_waitcnt vmcnt(18)
v_fmac_f32 v232,s43,v234
v_fmac_f32 v237,4.0,v233
M a[160:163],a[240:243],v[228:231],a[160:163]
v_fma_f32 v238,-4.0,v234,v236
v_fmac_f32 v232,s45,v236
M a[164:167],a[240:243],a[192:195],a[164:167]
buffer_load_dwordx4 a[232:235],v250,s[20:23],s48 offen offset:0 sc1
M a[164:167],a[236:239],v[228:231],a[164:167]
v_fmac_f32 v237,s41,v235
v_sub_f32 v236,v236,v234
M a[164:167],v[220:223],a[228:231],a[164:167]
v_fma_f32 v234,-4.0,v233,v235
v_sub_f32 v235,v235,v233
M a[168:171],v[220:223],v[228:231],a[168:171]
v_add_f32 v233,v238,v234
v_sub_f32 v238,v238,v234
M a[168:171],a[236:239],a[192:195],a[168:171]
buffer_load_dwordx4 a[204:207],v250,s[20:23],s48 offen offset:1024 sc1
M a[168:171],a[240:243],a[216:219],a[168:171]
v_fma_f32 v234,2.0,v235,v236
v_fmac_f32 v236,-2.0,v235
M a[172:175],a[240:243],v[224:227],a[172:175]
v_and_b32 v197,s42,v197
v_and_b32 v193,s42,v193
M a[172:175],a[236:239],a[216:219],a[172:175]
v_and_b32 v195,s42,v195
v_and_b32 v203,s42,v203
M a[172:175],v[220:223],a[192:195],a[172:175]
buffer_load_dwordx4 a[228:231],v250,s[20:23],s48 offen offset:2048 sc1
M a[176:179],v[220:223],a[216:219],a[176:179]
s_add_u32 s46,s75,36864
v_and_b32 v201,s42,v201
v_and_b32 v199,s42,v199
M a[176:179],a[236:239],v[224:227],a[176:179]
v_fmac_f32 v193,s43,v197
v_fmac_f32 v203,4.0,v195
M a[176:179],a[240:243],a[220:223],a[176:179]
v_fma_f32 v235,-4.0,v197,v201
v_fmac_f32 v193,s45,v201
M a[180:183],a[240:243],a[224:227],a[180:183]
buffer_load_dwordx4 v[228:231],v250,s[20:23],s46 offen offset:0 sc1
M a[180:183],a[236:239],a[220:223],a[180:183]
ds_read_b128 a[192:195],v248 offset:52224
v_fmac_f32 v203,s41,v199
M a[180:183],v[220:223],v[224:227],a[180:183]
ds_read_b128 a[216:219],v249 offset:52224
v_sub_f32 v201,v201,v197
M a[184:187],v[220:223],a[220:223],a[184:187]
ds_read_b128 v[224:227],v248 offset:52736
v_fma_f32 v197,-4.0,v195,v199
M a[184:187],a[236:239],a[224:227],a[184:187]
ds_read_b128 a[220:223],v249 offset:52736
v_sub_f32 v199,v199,v195
M a[184:187],a[240:243],a[244:247],a[184:187]
v_add_f32 v195,v235,v197
v_sub_f32 v235,v235,v197
M a[188:191],a[240:243],a[248:251],a[188:191]
v_fma_f32 v197,2.0,v199,v201
v_fmac_f32 v201,-2.0,v199
M a[188:191],a[236:239],a[244:247],a[188:191]
v_cvt_pk_bf16_f32 v193,v232,v193
v_cvt_pk_bf16_f32 v203,v237,v203
M a[188:191],v[220:223],a[224:227],a[188:191]
s_waitcnt vmcnt(21) lgkmcnt(3)
v_cvt_pk_bf16_f32 v195,v233,v195
v_cvt_pk_bf16_f32 v199,v234,v197
M v[0:3],a[252:255],a[192:195],v[0:3]
s_waitcnt vmcnt(12) lgkmcnt(2)
ds_read_b128 a[240:243],v248 offset:53248
v_cvt_pk_bf16_f32 v197,v238,v235
M v[0:3],a[196:199],a[216:219],v[0:3]
s_waitcnt vmcnt(11) lgkmcnt(2)
ds_read_b128 a[248:251],v249 offset:53248
v_cvt_pk_bf16_f32 v201,v236,v201
M v[0:3],a[200:203],v[224:227],v[0:3]
s_waitcnt lgkmcnt(2)
v_add_u32 v238,139264,v247
v_lshlrev_b32 v234,16,v208
M v[4:7],a[200:203],a[220:223],v[4:7]
v_lshlrev_b32 v232,16,v204
v_lshlrev_b32 v233,16,v206
M v[4:7],a[196:199],v[224:227],v[4:7]
v_lshlrev_b32 v237,16,v214
v_lshlrev_b32 v236,16,v212
M v[4:7],a[252:255],a[216:219],v[4:7]
ds_write2st64_b64 v238,v[192:193],v[202:203] offset0:2 offset1:19
M v[8:11],a[252:255],v[224:227],v[8:11]
s_add_u32 s28,s71,0
buffer_load_dwordx2 v[192:193],v251,s[12:15],s28 offen offset:0
M v[8:11],a[196:199],a[220:223],v[8:11]
s_waitcnt lgkmcnt(2)
ds_read_b128 a[236:239],v248 offset:53760
ds_read_b128 a[244:247],v249 offset:53760
M v[8:11],a[200:203],a[240:243],v[8:11]
s_waitcnt lgkmcnt(3)
buffer_load_dwordx2 v[202:203],v251,s[16:19],s28 offen offset:1536
M v[12:15],a[200:203],a[248:251],v[12:15]
v_lshlrev_b32 v235,16,v210
v_fmac_f32 v232,s43,v234
M v[12:15],a[196:199],a[240:243],v[12:15]
v_fmac_f32 v237,4.0,v233
v_fma_f32 v238,-4.0,v234,v236
M v[12:15],a[252:255],a[220:223],v[12:15]
ds_write2st64_b64 v247,v[194:195],v[196:197] offset0:36 offset1:53
M v[16:19],a[252:255],a[240:243],v[16:19]
buffer_load_dwordx2 v[194:195],v251,s[8:11],s28 offen offset:0
M v[16:19],a[196:199],a[248:251],v[16:19]
s_waitcnt lgkmcnt(2)
ds_read_b128 a[224:227],v249 offset:54272
ds_read_b128 v[220:223],v248 offset:54272
M v[16:19],a[200:203],a[236:239],v[16:19]
s_waitcnt lgkmcnt(3)
ds_write2st64_b64 v247,v[198:199],v[200:201] offset0:70 offset1:87
M v[20:23],a[200:203],a[244:247],v[20:23]
buffer_load_dwordx2 v[196:197],v251,s[8:11],s28 offen offset:384
M v[20:23],a[196:199],a[236:239],v[20:23]
v_fmac_f32 v232,s45,v236
v_fmac_f32 v237,s41,v235
M v[20:23],a[252:255],a[248:251],v[20:23]
v_sub_f32 v236,v236,v234
v_fma_f32 v234,-4.0,v233,v235
M v[24:27],a[252:255],a[236:239],v[24:27]
v_sub_f32 v235,v235,v233
v_add_f32 v233,v238,v234
M v[24:27],a[196:199],a[244:247],v[24:27]
s_waitcnt lgkmcnt(2)
buffer_load_dwordx2 v[198:199],v251,s[8:11],s28 offen offset:768
M v[24:27],a[200:203],a[224:227],v[24:27]
s_waitcnt lgkmcnt(1)
v_sub_f32 v238,v238,v234
v_fma_f32 v234,2.0,v235,v236
M v[28:31],a[200:203],v[220:223],v[28:31]
v_fmac_f32 v236,-2.0,v235
v_and_b32 v208,s42,v208
M v[28:31],a[196:199],a[224:227],v[28:31]
v_and_b32 v204,s42,v204
v_and_b32 v206,s42,v206
M v[28:31],a[252:255],a[244:247],v[28:31]
s_waitcnt vmcnt(15)
buffer_load_dwordx2 v[200:201],v251,s[8:11],s28 offen offset:1152
M v[32:35],v[216:219],a[192:195],v[32:35]
s_waitcnt vmcnt(11)
v_and_b32 v214,s42,v214
v_and_b32 v212,s42,v212
M v[32:35],a[208:211],a[216:219],v[32:35]
s_waitcnt vmcnt(10)
v_and_b32 v210,s42,v210
v_fmac_f32 v204,s43,v208
M v[32:35],a[212:215],v[224:227],v[32:35]
v_fmac_f32 v214,4.0,v206
v_fma_f32 v235,-4.0,v208,v212
M v[36:39],a[212:215],a[220:223],v[36:39]
global_load_dword a200,v250,s[64:65]
M v[36:39],a[208:211],v[224:227],v[36:39]
v_fmac_f32 v204,s45,v212
v_fmac_f32 v214,s41,v210
M v[36:39],v[216:219],a[216:219],v[36:39]
buffer_load_dwordx4 a[200:203],v250,s[20:23],s46 offen offset:1024 sc1
M v[40:43],v[216:219],v[224:227],v[40:43]
v_sub_f32 v212,v212,v208
v_fma_f32 v208,-4.0,v206,v210
M v[40:43],a[208:211],a[220:223],v[40:43]
v_sub_f32 v210,v210,v206
v_add_f32 v206,v235,v208
M v[40:43],a[212:215],a[240:243],v[40:43]
v_sub_f32 v235,v235,v208
v_fma_f32 v208,2.0,v210,v212
M v[44:47],a[212:215],a[248:251],v[44:47]
buffer_load_dwordx4 a[196:199],v250,s[20:23],s46 offen offset:2048 sc1
M v[44:47],a[208:211],a[240:243],v[44:47]
s_add_u32 s47,s75,39936
v_fmac_f32 v212,-2.0,v210
v_cvt_pk_bf16_f32 v204,v232,v204
M v[44:47],v[216:219],a[220:223],v[44:47]
v_cvt_pk_bf16_f32 v214,v237,v214
v_cvt_pk_bf16_f32 v206,v233,v206
M v[48:51],v[216:219],a[240:243],v[48:51]
v_cvt_pk_bf16_f32 v210,v234,v208
v_cvt_pk_bf16_f32 v208,v238,v235
M v[48:51],a[208:211],a[248:251],v[48:51]
buffer_load_dwordx4 a[252:255],v250,s[20:23],s47 offen offset:0 sc1
M v[48:51],a[212:215],a[236:239],v[48:51]
v_cvt_pk_bf16_f32 v212,v236,v212
v_lshlrev_b32 v234,16,v209
M v[52:55],a[212:215],a[244:247],v[52:55]
v_lshlrev_b32 v232,16,v205
v_lshlrev_b32 v233,16,v207
M v[52:55],a[208:211],a[236:239],v[52:55]
v_lshlrev_b32 v237,16,v215
v_lshlrev_b32 v236,16,v213
M v[52:55],v[216:219],a[248:251],v[52:55]
v_lshlrev_b32 v235,16,v211
v_fmac_f32 v232,s43,v234
M v[56:59],v[216:219],a[236:239],v[56:59]
v_fmac_f32 v237,4.0,v233
v_fma_f32 v238,-4.0,v234,v236
M v[56:59],a[208:211],a[244:247],v[56:59]
v_fmac_f32 v232,s45,v236
v_fmac_f32 v237,s41,v235
M v[56:59],a[212:215],a[224:227],v[56:59]
v_sub_f32 v236,v236,v234
v_fma_f32 v234,-4.0,v233,v235
M v[60:63],a[212:215],v[220:223],v[60:63]
buffer_load_dwordx4 a[212:215],v250,s[20:23],s47 offen offset:1024 sc1
M v[60:63],a[208:211],a[224:227],v[60:63]
v_sub_f32 v235,v235,v233
v_add_f32 v233,v238,v234
M v[60:63],v[216:219],a[244:247],v[60:63]
s_waitcnt vmcnt(14)
buffer_load_dwordx4 a[208:211],v250,s[20:23],s47 offen offset:2048 sc1
M v[64:67],a[232:235],a[192:195],v[64:67]
s_waitcnt vmcnt(14)
s_add_u32 s48,s75,43008
v_sub_f32 v238,v238,v234
v_fma_f32 v234,2.0,v235,v236
M v[64:67],a[204:207],a[216:219],v[64:67]
s_waitcnt vmcnt(13)
v_fmac_f32 v236,-2.0,v235
v_and_b32 v209,s42,v209
M v[64:67],a[228:231],v[224:227],v[64:67]
v_and_b32 v205,s42,v205
v_and_b32 v207,s42,v207
M v[68:71],a[228:231],a[220:223],v[68:71]
buffer_load_dwordx4 v[216:219],v250,s[20:23],s48 offen offset:0 sc1
M v[68:71],a[204:207],v[224:227],v[68:71]
v_and_b32 v215,s42,v215
v_and_b32 v213,s42,v213
M v[68:71],a[232:235],a[216:219],v[68:71]
v_and_b32 v211,s42,v211
v_fmac_f32 v205,s43,v209
M v[72:75],a[232:235],v[224:227],v[72:75]
v_fmac_f32 v215,4.0,v207
v_fma_f32 v235,-4.0,v209,v213
M v[72:75],a[204:207],a[220:223],v[72:75]
buffer_load_dwordx4 a[192:195],v250,s[20:23],s48 offen offset:1024 sc1
M v[72:75],a[228:231],a[240:243],v[72:75]
v_fmac_f32 v205,s45,v213
v_fmac_f32 v215,s41,v211
M v[76:79],a[228:231],a[248:251],v[76:79]
v_sub_f32 v213,v213,v209
v_fma_f32 v209,-4.0,v207,v211
M v[76:79],a[204:207],a[240:243],v[76:79]
v_sub_f32 v211,v211,v207
v_add_f32 v207,v235,v209
M v[76:79],a[232:235],a[220:223],v[76:79]
buffer_load_dwordx4 a[216:219],v250,s[20:23],s48 offen offset:2048 sc1
M v[80:83],a[232:235],a[240:243],v[80:83]
s_add_u32 s46,s76,9216
v_sub_f32 v235,v235,v209
v_fma_f32 v209,2.0,v211,v213
M v[80:83],a[204:207],a[248:251],v[80:83]
v_fmac_f32 v213,-2.0,v211
v_cvt_pk_bf16_f32 v205,v232,v205
M v[80:83],a[228:231],a[236:239],v[80:83]
v_cvt_pk_bf16_f32 v215,v237,v215
v_cvt_pk_bf16_f32 v207,v233,v207
M v[84:87],a[228:231],a[244:247],v[84:87]
buffer_load_dwordx4 v[224:227],v250,s[20:23],s46 offen offset:0 sc1
M v[84:87],a[204:207],a[236:239],v[84:87]
ds_read_b128 a[220:223],v248 offset:60928
v_cvt_pk_bf16_f32 v211,v234,v209
M v[84:87],a[232:235],a[248:251],v[84:87]
ds_read_b128 a[240:243],v249 offset:60928
v_cvt_pk_bf16_f32 v209,v238,v235
M v[88:91],a[232:235],a[236:239],v[88:91]
ds_read_b128 a[248:251],v248 offset:61440
v_cvt_pk_bf16_f32 v213,v236,v213
M v[88:91],a[204:207],a[244:247],v[88:91]
ds_read_b128 a[236:239],v249 offset:61440
v_add_u32 v238,139264,v247
M v[88:91],a[228:231],a[224:227],v[88:91]
ds_write2st64_b64 v238,v[204:205],v[214:215] offset0:3 offset1:20
M v[92:95],a[228:231],v[220:223],v[92:95]
s_add_u32 s28,s71,393216
buffer_load_dwordx2 v[204:205],v245,s[12:15],s28 offen offset:0
M v[92:95],a[204:207],a[224:227],v[92:95]
s_waitcnt vmcnt(13)
v_lshlrev_b32 v234,16,v196
v_lshlrev_b32 v232,16,v192
M v[92:95],a[232:235],a[244:247],v[92:95]
s_waitcnt lgkmcnt(4)
buffer_load_dwordx2 v[214:215],v245,s[16:19],s28 offen offset:1536
M v[96:99],v[228:231],a[220:223],v[96:99]
s_waitcnt vmcnt(10) lgkmcnt(3)
ds_read_b128 a[228:231],v248 offset:61952
v_lshlrev_b32 v233,16,v194
M v[96:99],a[200:203],a[240:243],v[96:99]
s_waitcnt vmcnt(9) lgkmcnt(3)
ds_read_b128 v[220:223],v249 offset:61952
v_lshlrev_b32 v237,16,v202
M v[96:99],a[196:199],a[248:251],v[96:99]
s_waitcnt lgkmcnt(3)
ds_write2st64_b64 v247,v[206:207],v[208:209] offset0:37 offset1:54
M v[100:103],a[196:199],a[236:239],v[100:103]
buffer_load_dwordx2 v[206:207],v245,s[8:11],s28 offen offset:0
M v[100:103],a[200:203],a[248:251],v[100:103]
v_lshlrev_b32 v236,16,v200
v_lshlrev_b32 v235,16,v198
M v[100:103],v[228:231],a[240:243],v[100:103]
ds_write2st64_b64 v247,v[210:211],v[212:213] offset0:71 offset1:88
M v[104:107],v[228:231],a[248:251],v[104:107]
buffer_load_dwordx2 v[208:209],v245,s[8:11],s28 offen offset:384
M v[104:107],a[200:203],a[236:239],v[104:107]
s_waitcnt lgkmcnt(3)
ds_read_b128 a[204:207],v248 offset:62464
ds_read_b128 a[224:227],v249 offset:62464
M v[104:107],a[196:199],a[228:231],v[104:107]
s_waitcnt lgkmcnt(4)
v_fmac_f32 v232,s43,v234
v_fmac_f32 v237,4.0,v233
M v[108:111],a[196:199],v[220:223],v[108:111]
v_fma_f32 v238,-4.0,v234,v236
v_fmac_f32 v232,s45,v236
M v[108:111],a[200:203],a[228:231],v[108:111]
buffer_load_dwordx2 v[210:211],v245,s[8:11],s28 offen offset:768
M v[108:111],v[228:231],a[236:239],v[108:111]
v_fmac_f32 v237,s41,v235
v_sub_f32 v236,v236,v234
M v[112:115],v[228:231],a[228:231],v[112:115]
ds_read_b128 a[232:235],v249 offset:62976
v_fma_f32 v234,-4.0,v233,v235
M v[112:115],a[200:203],v[220:223],v[112:115]
s_waitcnt lgkmcnt(2)
ds_read_b128 a[244:247],v248 offset:62976
v_sub_f32 v235,v235,v233
M v[112:115],a[196:199],a[204:207],v[112:115]
s_waitcnt lgkmcnt(2)
buffer_load_dwordx2 v[212:213],v245,s[8:11],s28 offen offset:1152
M v[116:119],a[196:199],a[224:227],v[116:119]
v_add_f32 v233,v238,v234
v_sub_f32 v238,v238,v234
M v[116:119],a[200:203],a[204:207],v[116:119]
v_fma_f32 v234,2.0,v235,v236
v_fmac_f32 v236,-2.0,v235
M v[116:119],v[228:231],v[220:223],v[116:119]
v_and_b32 v196,s42,v196
v_and_b32 v192,s42,v192
M v[120:123],v[228:231],a[204:207],v[120:123]
v_and_b32 v194,s42,v194
v_and_b32 v202,s42,v202
M v[120:123],a[200:203],a[224:227],v[120:123]
s_waitcnt lgkmcnt(1)
v_and_b32 v200,s42,v200
v_and_b32 v198,s42,v198
M v[120:123],a[196:199],a[232:235],v[120:123]
s_waitcnt lgkmcnt(0)
v_fmac_f32 v192,s43,v196
v_fmac_f32 v202,4.0,v194
M v[124:127],a[196:199],a[244:247],v[124:127]
buffer_load_dwordx4 a[196:199],v250,s[20:23],s46 offen offset:1024 sc1
M v[124:127],a[200:203],a[232:235],v[124:127]
v_fma_f32 v235,-4.0,v196,v200
v_fmac_f32 v192,s45,v200
M v[124:127],v[228:231],a[224:227],v[124:127]
s_waitcnt vmcnt(13)
buffer_load_dwordx4 a[200:203],v250,s[20:23],s46 offen offset:2048 sc1
M v[128:131],a[252:255],a[220:223],v[128:131]
s_waitcnt vmcnt(13)
s_add_u32 s47,s76,12288
v_fmac_f32 v202,s41,v198
v_sub_f32 v200,v200,v196
M v[128:131],a[212:215],a[240:243],v[128:131]
s_waitcnt vmcnt(12)
v_fma_f32 v196,-4.0,v194,v198
v_sub_f32 v198,v198,v194
M v[128:131],a[208:211],a[248:251],v[128:131]
v_add_f32 v194,v235,v196
v_sub_f32 v235,v235,v196
M v[132:135],a[208:211],a[236:239],v[132:135]
buffer_load_dwordx4 v[228:231],v250,s[20:23],s47 offen offset:0 sc1
M v[132:135],a[212:215],a[248:251],v[132:135]
v_fma_f32 v196,2.0,v198,v200
v_fmac_f32 v200,-2.0,v198
M v[132:135],a[252:255],a[240:243],v[132:135]
v_cvt_pk_bf16_f32 v192,v232,v192
v_cvt_pk_bf16_f32 v202,v237,v202
M v[136:139],a[252:255],a[248:251],v[136:139]
v_cvt_pk_bf16_f32 v194,v233,v194
v_cvt_pk_bf16_f32 v198,v234,v196
M v[136:139],a[212:215],a[236:239],v[136:139]
v_cvt_pk_bf16_f32 v196,v238,v235
v_cvt_pk_bf16_f32 v200,v236,v200
M v[136:139],a[208:211],a[228:231],v[136:139]
v_lshlrev_b32 v234,16,v197
v_lshlrev_b32 v232,16,v193
M v[140:143],a[208:211],v[220:223],v[140:143]
v_lshlrev_b32 v233,16,v195
v_lshlrev_b32 v237,16,v203
M v[140:143],a[212:215],a[228:231],v[140:143]
v_lshlrev_b32 v236,16,v201
v_lshlrev_b32 v235,16,v199
M v[140:143],a[252:255],a[236:239],v[140:143]
v_fmac_f32 v232,s43,v234
v_fmac_f32 v237,4.0,v233
M v[144:147],a[252:255],a[228:231],v[144:147]
v_fma_f32 v238,-4.0,v234,v236
v_fmac_f32 v232,s45,v236
M v[144:147],a[212:215],v[220:223],v[144:147]
v_fmac_f32 v237,s41,v235
v_sub_f32 v236,v236,v234
M v[144:147],a[208:211],a[204:207],v[144:147]
v_fma_f32 v234,-4.0,v233,v235
v_sub_f32 v235,v235,v233
M v[148:151],a[208:211],a[224:227],v[148:151]
v_add_f32 v233,v238,v234
v_sub_f32 v238,v238,v234
M v[148:151],a[212:215],a[204:207],v[148:151]
v_fma_f32 v234,2.0,v235,v236
v_fmac_f32 v236,-2.0,v235
M v[148:151],a[252:255],v[220:223],v[148:151]
v_and_b32 v197,s42,v197
v_and_b32 v193,s42,v193
M v[152:155],a[252:255],a[204:207],v[152:155]
v_and_b32 v195,s42,v195
v_and_b32 v203,s42,v203
M v[152:155],a[212:215],a[224:227],v[152:155]
v_and_b32 v201,s42,v201
v_and_b32 v199,s42,v199
M v[152:155],a[208:211],a[232:235],v[152:155]
v_fmac_f32 v193,s43,v197
v_fmac_f32 v203,4.0,v195
M v[156:159],a[208:211],a[244:247],v[156:159]
buffer_load_dwordx4 a[208:211],v250,s[20:23],s47 offen offset:1024 sc1
M v[156:159],a[212:215],a[232:235],v[156:159]
v_fma_f32 v235,-4.0,v197,v201
v_fmac_f32 v193,s45,v201
M v[156:159],a[252:255],a[224:227],v[156:159]
s_waitcnt vmcnt(13)
buffer_load_dwordx4 a[212:215],v250,s[20:23],s47 offen offset:2048 sc1
M v[160:163],v[216:219],a[220:223],v[160:163]
s_waitcnt vmcnt(13)
s_add_u32 s48,s76,15360
v_fmac_f32 v203,s41,v199
v_sub_f32 v201,v201,v197
M v[160:163],a[192:195],a[240:243],v[160:163]
s_waitcnt vmcnt(12)
v_fma_f32 v197,-4.0,v195,v199
v_sub_f32 v199,v199,v195
M v[160:163],a[216:219],a[248:251],v[160:163]
v_add_f32 v195,v235,v197
v_sub_f32 v235,v235,v197
M v[164:167],a[216:219],a[236:239],v[164:167]
buffer_load_dwordx4 a[252:255],v250,s[20:23],s48 offen offset:0 sc1
M v[164:167],a[192:195],a[248:251],v[164:167]
v_fma_f32 v197,2.0,v199,v201
v_fmac_f32 v201,-2.0,v199
M v[164:167],v[216:219],a[240:243],v[164:167]
v_cvt_pk_bf16_f32 v193,v232,v193
v_cvt_pk_bf16_f32 v203,v237,v203
M v[168:171],v[216:219],a[248:251],v[168:171]
v_cvt_pk_bf16_f32 v195,v233,v195
v_cvt_pk_bf16_f32 v199,v234,v197
M v[168:171],a[192:195],a[236:239],v[168:171]
buffer_load_dwordx4 a[220:223],v250,s[20:23],s48 offen offset:1024 sc1
M v[168:171],a[216:219],a[228:231],v[168:171]
v_cvt_pk_bf16_f32 v197,v238,v235
v_cvt_pk_bf16_f32 v201,v236,v201
M v[172:175],a[216:219],v[220:223],v[172:175]
s_waitcnt vmcnt(9)
v_lshlrev_b32 v234,16,v208
v_lshlrev_b32 v232,16,v204
M v[172:175],a[192:195],a[228:231],v[172:175]
v_lshlrev_b32 v233,16,v206
v_lshlrev_b32 v237,16,v214
M v[172:175],v[216:219],a[236:239],v[172:175]
buffer_load_dwordx4 a[240:243],v250,s[20:23],s48 offen offset:2048 sc1
M v[176:179],v[216:219],a[228:231],v[176:179]
s_waitcnt vmcnt(8)
s_add_u32 s46,s76,18432
v_lshlrev_b32 v236,16,v212
v_lshlrev_b32 v235,16,v210
M v[176:179],a[192:195],v[220:223],v[176:179]
v_fmac_f32 v232,s43,v234
v_fmac_f32 v237,4.0,v233
M v[176:179],a[216:219],a[204:207],v[176:179]
s_barrier
v_fma_f32 v238,-4.0,v234,v236
M v[180:183],a[216:219],a[224:227],v[180:183]
buffer_load_dwordx4 a[248:251],v250,s[20:23],s46 offen offset:0 sc1
M v[180:183],a[192:195],a[204:207],v[180:183]
ds_read_b128 a[236:239],v248 offset:0
v_fmac_f32 v232,s45,v236
M v[180:183],v[216:219],v[220:223],v[180:183]
ds_write2st64_b64 v247,v[192:193],v[202:203] offset0:136 offset1:153
M v[184:187],v[216:219],a[204:207],v[184:187]
s_add_u32 s28,s71,786432
ds_read_b128 a[228:231],v249 offset:0
ds_read_b128 v[220:223],v248 offset:512
M v[184:187],a[192:195],a[224:227],v[184:187]
buffer_load_dwordx2 v[192:193],v245,s[12:15],s28 offen offset:0
M v[184:187],a[216:219],a[232:235],v[184:187]
ds_write2st64_b64 v247,v[194:195],v[196:197] offset0:102 offset1:119
M v[188:191],a[216:219],a[244:247],v[188:191]
ds_read_b128 a[204:207],v249 offset:512
v_fmac_f32 v237,s41,v235
M v[188:191],a[192:195],a[232:235],v[188:191]
buffer_load_dwordx2 v[202:203],v245,s[16:19],s28 offen offset:1536
M v[188:191],v[216:219],a[224:227],v[188:191]
s_waitcnt lgkmcnt(5)
v_sub_f32 v236,v236,v234
v_fma_f32 v234,-4.0,v233,v235
M a[0:3],v[224:227],a[236:239],a[0:3]
s_waitcnt vmcnt(10) lgkmcnt(3)
ds_read_b128 a[216:219],v248 offset:1024
v_sub_f32 v235,v235,v233
M a[0:3],a[196:199],a[228:231],a[0:3]
s_waitcnt vmcnt(9) lgkmcnt(3)
ds_read_b128 a[244:247],v249 offset:1024
v_add_f32 v233,v238,v234
M a[0:3],a[200:203],v[220:223],a[0:3]
s_waitcnt lgkmcnt(2)
buffer_load_dwordx2 v[194:195],v245,s[8:11],s28 offen offset:0
M a[4:7],a[200:203],a[204:207],a[4:7]
v_sub_f32 v238,v238,v234
v_fma_f32 v234,2.0,v235,v236
M a[4:7],a[196:199],v[220:223],a[4:7]
v_fmac_f32 v236,-2.0,v235
v_and_b32 v208,s42,v208
M a[4:7],v[224:227],a[228:231],a[4:7]
v_and_b32 v204,s42,v204
v_and_b32 v206,s42,v206
M a[8:11],v[224:227],v[220:223],a[8:11]
buffer_load_dwordx2 v[196:197],v245,s[8:11],s28 offen offset:384
M a[8:11],a[196:199],a[204:207],a[8:11]
s_waitcnt lgkmcnt(1)
ds_read_b128 a[192:195],v248 offset:1536
ds_read_b128 a[232:235],v249 offset:1536
M a[8:11],a[200:203],a[216:219],a[8:11]
s_waitcnt lgkmcnt(2)
v_and_b32 v214,s42,v214
v_and_b32 v212,s42,v212
M a[12:15],a[200:203],a[244:247],a[12:15]
v_and_b32 v210,s42,v210
v_fmac_f32 v204,s43,v208
M a[12:15],a[196:199],a[216:219],a[12:15]
v_fmac_f32 v214,4.0,v206
v_fma_f32 v235,-4.0,v208,v212
M a[12:15],v[224:227],a[204:207],a[12:15]
v_fmac_f32 v204,s45,v212
v_fmac_f32 v214,s41,v210
M a[16:19],v[224:227],a[216:219],a[16:19]
ds_read_b128 a[224:227],v249 offset:2048
v_sub_f32 v212,v212,v208
M a[16:19],a[196:199],a[244:247],a[16:19]
s_waitcnt lgkmcnt(2)
ds_read_b128 v[216:219],v248 offset:2048
v_fma_f32 v208,-4.0,v206,v210
M a[16:19],a[200:203],a[192:195],a[16:19]
s_waitcnt lgkmcnt(2)
v_sub_f32 v210,v210,v206
v_add_f32 v206,v235,v208
M a[20:23],a[200:203],a[232:235],a[20:23]
v_sub_f32 v235,v235,v208
v_fma_f32 v208,2.0,v210,v212
M a[20:23],a[196:199],a[192:195],a[20:23]
v_fmac_f32 v212,-2.0,v210
v_cvt_pk_bf16_f32 v204,v232,v204
M a[20:23],v[224:227],a[244:247],a[20:23]
v_cvt_pk_bf16_f32 v214,v237,v214
v_cvt_pk_bf16_f32 v206,v233,v206
M a[24:27],v[224:227],a[192:195],a[24:27]
v_cvt_pk_bf16_f32 v210,v234,v208
v_cvt_pk_bf16_f32 v208,v238,v235
M a[24:27],a[196:199],a[232:235],a[24:27]
s_waitcnt lgkmcnt(1)
v_cvt_pk_bf16_f32 v212,v236,v212
v_lshlrev_b32 v234,16,v209
M a[24:27],a[200:203],a[224:227],a[24:27]
s_waitcnt lgkmcnt(0)
v_lshlrev_b32 v232,16,v205
v_lshlrev_b32 v233,16,v207
M a[28:31],a[200:203],v[216:219],a[28:31]
buffer_load_dwordx4 a[200:203],v250,s[20:23],s46 offen offset:1024 sc1
M a[28:31],a[196:199],a[224:227],a[28:31]
v_lshlrev_b32 v237,16,v215
v_lshlrev_b32 v236,16,v213
M a[28:31],v[224:227],a[232:235],a[28:31]
s_waitcnt vmcnt(11)
buffer_load_dwordx4 a[196:199],v250,s[20:23],s46 offen offset:2048 sc1
M a[32:35],v[228:231],a[236:239],a[32:35]
s_waitcnt vmcnt(11)
s_add_u32 s47,s76,21504
v_lshlrev_b32 v235,16,v211
v_fmac_f32 v232,s43,v234
M a[32:35],a[208:211],a[228:231],a[32:35]
s_waitcnt vmcnt(10)
v_fmac_f32 v237,4.0,v233
v_fma_f32 v238,-4.0,v234,v236
M a[32:35],a[212:215],v[220:223],a[32:35]
v_fmac_f32 v232,s45,v236
v_fmac_f32 v237,s41,v235
M a[36:39],a[212:215],a[204:207],a[36:39]
buffer_load_dwordx4 v[224:227],v250,s[20:23],s47 offen offset:0 sc1
M a[36:39],a[208:211],v[220:223],a[36:39]
v_sub_f32 v236,v236,v234
v_fma_f32 v234,-4.0,v233,v235
M a[36:39],v[228:231],a[228:231],a[36:39]
v_sub_f32 v235,v235,v233
v_add_f32 v233,v238,v234
M a[40:43],v[228:231],v[220:223],a[40:43]
v_sub_f32 v238,v238,v234
v_fma_f32 v234,2.0,v235,v236
M a[40:43],a[208:211],a[204:207],a[40:43]
v_fmac_f32 v236,-2.0,v235
v_and_b32 v209,s42,v209
M a[40:43],a[212:215],a[216:219],a[40:43]
v_and_b32 v205,s42,v205
v_and_b32 v207,s42,v207
M a[44:47],a[212:215],a[244:247],a[44:47]
v_and_b32 v215,s42,v215
v_and_b32 v213,s42,v213
M a[44:47],a[208:211],a[216:219],a[44:47]
v_and_b32 v211,s42,v211
v_fmac_f32 v205,s43,v209
M a[44:47],v[228:231],a[204:207],a[44:47]
v_fmac_f32 v215,4.0,v207
v_fma_f32 v235,-4.0,v209,v213
M a[48:51],v[228:231],a[216:219],a[48:51]
v_fmac_f32 v205,s45,v213
v_fmac_f32 v215,s41,v211
M a[48:51],a[208:211],a[244:247],a[48:51]
v_sub_f32 v213,v213,v209
v_fma_f32 v209,-4.0,v207,v211
M a[48:51],a[212:215],a[192:195],a[48:51]
v_sub_f32 v211,v211,v207
v_add_f32 v207,v235,v209
M a[52:55],a[212:215],a[232:235],a[52:55]
v_sub_f32 v235,v235,v209
v_fma_f32 v209,2.0,v211,v213
M a[52:55],a[208:211],a[192:195],a[52:55]
v_fmac_f32 v213,-2.0,v211
v_cvt_pk_bf16_f32 v205,v232,v205
M a[52:55],v[228:231],a[244:247],a[52:55]
v_cvt_pk_bf16_f32 v215,v237,v215
v_cvt_pk_bf16_f32 v207,v233,v207
M a[56:59],v[228:231],a[192:195],a[56:59]
v_cvt_pk_bf16_f32 v211,v234,v209
v_cvt_pk_bf16_f32 v209,v238,v235
M a[56:59],a[208:211],a[232:235],a[56:59]
v_cvt_pk_bf16_f32 v213,v236,v213
v_fmac_f32 v239,s43,v241
M a[56:59],a[212:215],a[224:227],a[56:59]
v_fmac_f32 v244,4.0,v240
v_fma_f32 v232,-4.0,v241,v243
M a[60:63],a[212:215],v[216:219],a[60:63]
buffer_load_dwordx4 a[212:215],v250,s[20:23],s47 offen offset:1024 sc1
M a[60:63],a[208:211],a[224:227],a[60:63]
v_fmac_f32 v239,s45,v243
v_fmac_f32 v244,s41,v242
M a[60:63],v[228:231],a[232:235],a[60:63]
s_waitcnt vmcnt(11)
buffer_load_dwordx4 a[208:211],v250,s[20:23],s47 offen offset:2048 sc1
M a[64:67],a[252:255],a[236:239],a[64:67]
s_waitcnt vmcnt(11)
s_add_u32 s48,s76,24576
v_sub_f32 v243,v243,v241
v_fma_f32 v241,-4.0,v240,v242
M a[64:67],a[220:223],a[228:231],a[64:67]
s_waitcnt vmcnt(10)
v_sub_f32 v242,v242,v240
v_add_f32 v240,v232,v241
M a[64:67],a[240:243],v[220:223],a[64:67]
v_sub_f32 v232,v232,v241
v_fma_f32 v241,2.0,v242,v243
M a[68:71],a[240:243],a[204:207],a[68:71]
buffer_load_dwordx4 v[228:231],v250,s[20:23],s48 offen offset:0 sc1
M a[68:71],a[220:223],v[220:223],a[68:71]
v_fmac_f32 v243,-2.0,v242
v_cvt_pk_bf16_f32 v233,v239,v244
M a[68:71],a[252:255],a[228:231],a[68:71]
v_cvt_pk_bf16_f32 v234,v240,v232
v_cvt_pk_bf16_f32 v235,v241,v243
M a[72:75],a[252:255],v[220:223],a[72:75]
v_add_u32 v232,69632,v252
M a[72:75],a[220:223],a[204:207],a[72:75]
buffer_load_dwordx4 a[236:239],v250,s[20:23],s48 offen offset:1024 sc1
M a[72:75],a[240:243],a[216:219],a[72:75]
ds_write_b16 v232,v233 offset:0
M a[76:79],a[240:243],a[244:247],a[76:79]
ds_write_b16_d16_hi v232,v233 offset:8704
M a[76:79],a[220:223],a[216:219],a[76:79]
ds_write_b16 v252,v234 offset:52224
M a[76:79],a[252:255],a[204:207],a[76:79]
buffer_load_dwordx4 a[228:231],v250,s[20:23],s48 offen offset:2048 sc1
M a[80:83],a[252:255],a[216:219],a[80:83]
s_add_u32 s46,s76,27648
ds_write_b16_d16_hi v252,v234 offset:60928
M a[80:83],a[220:223],a[244:247],a[80:83]
M a[80:83],a[240:243],a[192:195],a[80:83]
M a[84:87],a[240:243],a[232:235],a[84:87]
buffer_load_dwordx4 v[220:223],v250,s[20:23],s46 offen offset:0 sc1
M a[84:87],a[220:223],a[192:195],a[84:87]
ds_read_b128 a[204:207],v248 offset:8704
M a[84:87],a[252:255],a[244:247],a[84:87]
ds_read_b128 a[216:219],v249 offset:8704
M a[88:91],a[252:255],a[192:195],a[88:91]
ds_read_b128 a[244:247],v248 offset:9216
M a[88:91],a[220:223],a[232:235],a[88:91]
ds_read_b128 a[192:195],v249 offset:9216
M a[88:91],a[240:243],a[224:227],a[88:91]
M a[92:95],a[240:243],v[216:219],a[92:95]
M a[92:95],a[220:223],a[224:227],a[92:95]
M a[92:95],a[252:255],a[232:235],a[92:95]
s_waitcnt vmcnt(13) lgkmcnt(3)
M a[96:99],a[248:251],a[204:207],a[96:99]
s_waitcnt vmcnt(8) lgkmcnt(2)
ds_read_b128 a[240:243],v248 offset:9728
M a[96:99],a[200:203],a[216:219],a[96:99]
s_waitcnt vmcnt(7) lgkmcnt(2)
ds_read_b128 v[216:219],v249 offset:9728
M a[96:99],a[196:199],a[244:247],a[96:99]
s_waitcnt lgkmcnt(2)
M a[100:103],a[196:199],a[192:195],a[100:103]
M a[100:103],a[200:203],a[244:247],a[100:103]
M a[100:103],a[248:251],a[216:219],a[100:103]
M a[104:107],a[248:251],a[244:247],a[104:107]
ds_read_b128 a[220:223],v248 offset:10240
M a[104:107],a[200:203],a[192:195],a[104:107]
s_waitcnt lgkmcnt(2)
ds_read_b128 a[224:227],v249 offset:10240
M a[104:107],a[196:199],a[240:243],a[104:107]
s_waitcnt lgkmcnt(2)
M a[108:111],a[196:199],v[216:219],a[108:111]
M a[108:111],a[200:203],a[240:243],a[108:111]
M a[108:111],a[248:251],a[192:195],a[108:111]
M a[112:115],a[248:251],a[240:243],a[112:115]
ds_read_b128 a[232:235],v249 offset:10752
M a[112:115],a[200:203],v[216:219],a[112:115]
s_waitcnt lgkmcnt(2)
ds_read_b128 a[252:255],v248 offset:10752
M a[112:115],a[196:199],a[220:223],a[112:115]
s_waitcnt lgkmcnt(2)
M a[116:119],a[196:199],a[224:227],a[116:119]
M a[116:119],a[200:203],a[220:223],a[116:119]
M a[116:119],a[248:251],v[216:219],a[116:119]
M a[120:123],a[248:251],a[220:223],a[120:123]
M a[120:123],a[200:203],a[224:227],a[120:123]
s_waitcnt lgkmcnt(1)
M a[120:123],a[196:199],a[232:235],a[120:123]
s_waitcnt lgkmcnt(0)
M a[124:127],a[196:199],a[252:255],a[124:127]
buffer_load_dwordx4 a[196:199],v250,s[20:23],s46 offen offset:1024 sc1
M a[124:127],a[200:203],a[232:235],a[124:127]
M a[124:127],a[248:251],a[224:227],a[124:127]
s_waitcnt vmcnt(7)
buffer_load_dwordx4 a[200:203],v250,s[20:23],s46 offen offset:2048 sc1
M a[128:131],v[224:227],a[204:207],a[128:131]
s_waitcnt vmcnt(7)
s_add_u32 s47,s76,30720
M a[128:131],a[212:215],a[216:219],a[128:131]
s_waitcnt vmcnt(6)
M a[128:131],a[208:211],a[244:247],a[128:131]
M a[132:135],a[208:211],a[192:195],a[132:135]
buffer_load_dwordx4 a[248:251],v250,s[20:23],s47 offen offset:0 sc1
M a[132:135],a[212:215],a[244:247],a[132:135]
M a[132:135],v[224:227],a[216:219],a[132:135]
M a[136:139],v[224:227],a[244:247],a[136:139]
s_barrier
ds_write_b16 v252,v235 offset:17408
M a[136:139],a[212:215],a[192:195],a[136:139]
ds_write_b16_d16_hi v252,v235 offset:26112
M a[136:139],a[208:211],a[240:243],a[136:139]
ds_write2st64_b64 v247,v[198:199],v[200:201] offset0:34 offset1:51
M a[140:143],a[208:211],v[216:219],a[140:143]
buffer_load_dwordx2 v[198:199],v245,s[8:11],s28 offen offset:768
M a[140:143],a[212:215],a[240:243],a[140:143]
M a[140:143],v[224:227],a[192:195],a[140:143]
buffer_load_dwordx2 v[200:201],v245,s[8:11],s28 offen offset:1152
M a[144:147],v[224:227],a[240:243],a[144:147]
M a[144:147],a[212:215],v[216:219],a[144:147]
M a[144:147],a[208:211],a[220:223],a[144:147]
ds_write2st64_b64 v247,v[204:205],v[214:215] offset0:137 offset1:154
M a[148:151],a[208:211],a[224:227],a[148:151]
s_add_u32 s28,s71,1179648
buffer_load_dwordx2 v[204:205],v245,s[12:15],s28 offen offset:0
M a[148:151],a[212:215],a[220:223],a[148:151]
M a[148:151],v[224:227],v[216:219],a[148:151]
ds_write2st64_b64 v247,v[206:207],v[208:209] offset0:103 offset1:120
M a[152:155],v[224:227],a[220:223],a[152:155]
buffer_load_dwordx2 v[214:215],v245,s[16:19],s28 offen offset:1536
M a[152:155],a[212:215],a[224:227],a[152:155]
M a[152:155],a[208:211],a[232:235],a[152:155]
ds_write2st64_b64 v247,v[210:211],v[212:213] offset0:35 offset1:52
M a[156:159],a[208:211],a[252:255],a[156:159]
buffer_load_dwordx4 a[208:211],v250,s[20:23],s47 offen offset:1024 sc1
M a[156:159],a[212:215],a[232:235],a[156:159]
M a[156:159],v[224:227],a[224:227],a[156:159]
s_waitcnt vmcnt(11)
M a[160:163],v[228:231],a[204:207],a[160:163]
s_waitcnt vmcnt(10)
M a[160:163],a[236:239],a[216:219],a[160:163]
s_waitcnt vmcnt(9)
buffer_load_dwordx4 a[212:215],v250,s[20:23],s47 offen offset:2048 sc1
M a[160:163],a[228:231],a[244:247],a[160:163]
s_add_u32 s48,s76,33792
M a[164:167],a[228:231],a[192:195],a[164:167]
M a[164:167],a[236:239],a[244:247],a[164:167]
M a[164:167],v[228:231],a[216:219],a[164:167]
buffer_load_dwordx4 v[224:227],v250,s[20:23],s48 offen offset:0 sc1
M a[168:171],v[228:231],a[244:247],a[168:171]
M a[168:171],a[236:239],a[192:195],a[168:171]
M a[168:171],a[228:231],a[240:243],a[168:171]
M a[172:175],a[228:231],v[216:219],a[172:175]
buffer_load_dwordx4 a[204:207],v250,s[20:23],s48 offen offset:1024 sc1
M a[172:175],a[236:239],a[240:243],a[172:175]
M a[172:175],v[228:231],a[192:195],a[172:175]
M a[176:179],v[228:231],a[240:243],a[176:179]
M a[176:179],a[236:239],v[216:219],a[176:179]
buffer_load_dwordx4 a[216:219],v250,s[20:23],s48 offen offset:2048 sc1
M a[176:179],a[228:231],a[220:223],a[176:179]
s_add_u32 s46,s76,36864
M a[180:183],a[228:231],a[224:227],a[180:183]
M a[180:183],a[236:239],a[220:223],a[180:183]
ds_read_b128 a[192:195],v248 offset:17408
M a[180:183],v[228:231],v[216:219],a[180:183]
buffer_load_dwordx4 a[244:247],v250,s[20:23],s46 offen offset:0 sc1
M a[184:187],v[228:231],a[220:223],a[184:187]
ds_read_b128 a[240:243],v249 offset:17408
ds_read_b128 v[216:219],v248 offset:17920
M a[184:187],a[236:239],a[224:227],a[184:187]
ds_read_b128 a[220:223],v249 offset:17920
v_lshlrev_b32 v234,16,v196
M a[184:187],a[228:231],a[232:235],a[184:187]
v_lshlrev_b32 v232,16,v192
v_lshlrev_b32 v233,16,v194
M a[188:191],a[228:231],a[252:255],a[188:191]
buffer_load_dwordx2 v[206:207],v245,s[8:11],s28 offen offset:0
M a[188:191],a[236:239],a[232:235],a[188:191]
s_waitcnt vmcnt(9)
v_lshlrev_b32 v237,16,v202
v_lshlrev_b32 v236,16,v200
M a[188:191],v[228:231],a[224:227],a[188:191]
s_waitcnt lgkmcnt(3)
v_lshlrev_b32 v235,16,v198
v_fmac_f32 v232,s43,v234
M v[0:3],v[220:223],a[192:195],v[0:3]
s_waitcnt lgkmcnt(2)
ds_read_b128 a[228:231],v248 offset:18432
v_fmac_f32 v237,4.0,v233
M v[0:3],a[196:199],a[240:243],v[0:3]
s_waitcnt lgkmcnt(2)
buffer_load_dwordx2 v[208:209],v245,s[8:11],s28 offen offset:384
M v[0:3],a[200:203],v[216:219],v[0:3]
s_waitcnt lgkmcnt(1)
ds_read_b128 a[252:255],v249 offset:18432
v_fma_f32 v238,-4.0,v234,v236
M v[4:7],a[200:203],a[220:223],v[4:7]
v_fmac_f32 v232,s45,v236
v_fmac_f32 v237,s41,v235
M v[4:7],a[196:199],v[216:219],v[4:7]
v_sub_f32 v236,v236,v234
v_fma_f32 v234,-4.0,v233,v235
M v[4:7],v[220:223],a[240:243],v[4:7]
buffer_load_dwordx2 v[210:211],v245,s[8:11],s28 offen offset:768
M v[8:11],v[220:223],v[216:219],v[8:11]
ds_read_b128 a[232:235],v248 offset:18944
v_sub_f32 v235,v235,v233
M v[8:11],a[196:199],a[220:223],v[8:11]
s_waitcnt lgkmcnt(2)
ds_read_b128 a[236:239],v249 offset:18944
v_add_f32 v233,v238,v234
M v[8:11],a[200:203],a[228:231],v[8:11]
s_waitcnt lgkmcnt(2)
v_sub_f32 v238,v238,v234
v_fma_f32 v234,2.0,v235,v236
M v[12:15],a[200:203],a[252:255],v[12:15]
buffer_load_dwordx2 v[212:213],v245,s[8:11],s28 offen offset:1152
M v[12:15],a[196:199],a[228:231],v[12:15]
s_add_u32 s29,s66,6291456
v_fmac_f32 v236,-2.0,v235
v_and_b32 v196,s42,v196
M v[12:15],v[220:223],a[220:223],v[12:15]
v_and_b32 v192,s42,v192
v_and_b32 v194,s42,v194
M v[16:19],v[220:223],a[228:231],v[16:19]
ds_read_b128 a[224:227],v249 offset:19456
v_and_b32 v202,s42,v202
M v[16:19],a[196:199],a[252:255],v[16:19]
s_waitcnt lgkmcnt(2)
buffer_load_short_d16_hi v239,v246,s[12:15],s29 offen offset:0
M v[16:19],a[200:203],a[232:235],v[16:19]
s_waitcnt lgkmcnt(1)
ds_read_b128 v[228:231],v248 offset:19456
v_and_b32 v200,s42,v200
M v[20:23],a[200:203],a[236:239],v[20:23]
buffer_load_short_d16_hi v240,v246,s[8:11],s29 offen offset:0
M v[20:23],a[196:199],a[232:235],v[20:23]
v_and_b32 v198,s42,v198
v_fmac_f32 v192,s43,v196
M v[20:23],v[220:223],a[252:255],v[20:23]
buffer_load_short_d16_hi v241,v246,s[8:11],s29 offen offset:384
M v[24:27],v[220:223],a[232:235],v[24:27]
v_fmac_f32 v202,4.0,v194
v_fma_f32 v235,-4.0,v196,v200
M v[24:27],a[196:199],a[236:239],v[24:27]
s_waitcnt lgkmcnt(1)
buffer_load_short_d16_hi v242,v246,s[8:11],s29 offen offset:768
M v[24:27],a[200:203],a[224:227],v[24:27]
s_waitcnt lgkmcnt(0)
v_fmac_f32 v192,s45,v200
v_fmac_f32 v202,s41,v198
M v[28:31],a[200:203],v[228:231],v[28:31]
buffer_load_dwordx4 a[200:203],v250,s[20:23],s46 offen offset:1024 sc1
M v[28:31],a[196:199],a[224:227],v[28:31]
v_sub_f32 v200,v200,v196
v_fma_f32 v196,-4.0,v194,v198
M v[28:31],v[220:223],a[236:239],v[28:31]
v_sub_f32 v198,v198,v194
v_add_f32 v194,v235,v196
M v[32:35],a[248:251],a[192:195],v[32:35]
s_waitcnt vmcnt(14)
v_sub_f32 v235,v235,v196
v_fma_f32 v196,2.0,v198,v200
M v[32:35],a[208:211],a[240:243],v[32:35]
s_waitcnt vmcnt(13)
buffer_load_dwordx4 a[196:199],v250,s[20:23],s46 offen offset:2048 sc1
M v[32:35],a[212:215],v[216:219],v[32:35]
s_add_u32 s47,s76,39936
v_fmac_f32 v200,-2.0,v198
v_cvt_pk_bf16_f32 v192,v232,v192
M v[36:39],a[212:215],a[220:223],v[36:39]
v_cvt_pk_bf16_f32 v202,v237,v202
v_cvt_pk_bf16_f32 v194,v233,v194
M v[36:39],a[208:211],v[216:219],v[36:39]
v_cvt_pk_bf16_f32 v198,v234,v196
v_cvt_pk_bf16_f32 v196,v238,v235
M v[36:39],a[248:251],a[240:243],v[36:39]
buffer_load_dwordx4 v[220:223],v250,s[20:23],s47 offen offset:0 sc1
M v[40:43],a[248:251],v[216:219],v[40:43]
v_cvt_pk_bf16_f32 v200,v236,v200
v_lshlrev_b32 v234,16,v197
M v[40:43],a[208:211],a[220:223],v[40:43]
v_lshlrev_b32 v232,16,v193
v_lshlrev_b32 v233,16,v195
M v[40:43],a[212:215],a[228:231],v[40:43]
v_lshlrev_b32 v237,16,v203
v_lshlrev_b32 v236,16,v201
M v[44:47],a[212:215],a[252:255],v[44:47]
buffer_load_short_d16_hi v243,v246,s[8:11],s29 offen offset:1152
M v[44:47],a[208:211],a[228:231],v[44:47]
v_lshlrev_b32 v235,16,v199
v_fmac_f32 v232,s43,v234
M v[44:47],a[248:251],a[220:223],v[44:47]
buffer_load_short_d16_hi v244,v246,s[16:19],s29 offen offset:1536
M v[48:51],a[248:251],a[228:231],v[48:51]
v_fmac_f32 v237,4.0,v233
v_fma_f32 v238,-4.0,v234,v236
M v[48:51],a[208:211],a[252:255],v[48:51]
v_fmac_f32 v232,s45,v236
v_fmac_f32 v237,s41,v235
M v[48:51],a[212:215],a[232:235],v[48:51]
v_sub_f32 v236,v236,v234
v_fma_f32 v234,-4.0,v233,v235
M v[52:55],a[212:215],a[236:239],v[52:55]
v_sub_f32 v235,v235,v233
v_add_f32 v233,v238,v234
M v[52:55],a[208:211],a[232:235],v[52:55]
v_sub_f32 v238,v238,v234
v_fma_f32 v234,2.0,v235,v236
M v[52:55],a[248:251],a[252:255],v[52:55]
v_fmac_f32 v236,-2.0,v235
v_and_b32 v197,s42,v197
M v[56:59],a[248:251],a[232:235],v[56:59]
v_and_b32 v193,s42,v193
v_and_b32 v195,s42,v195
M v[56:59],a[208:211],a[236:239],v[56:59]
v_and_b32 v203,s42,v203
v_and_b32 v201,s42,v201
M v[56:59],a[212:215],a[224:227],v[56:59]
v_and_b32 v199,s42,v199
v_fmac_f32 v193,s43,v197
M v[60:63],a[212:215],v[228:231],v[60:63]
buffer_load_dwordx4 a[212:215],v250,s[20:23],s47 offen offset:1024 sc1
M v[60:63],a[208:211],a[224:227],v[60:63]
v_fmac_f32 v203,4.0,v195
v_fma_f32 v235,-4.0,v197,v201
M v[60:63],a[248:251],a[236:239],v[60:63]
s_waitcnt vmcnt(17)
buffer_load_dwordx4 a[208:211],v250,s[20:23],s47 offen offset:2048 sc1
M v[64:67],v[224:227],a[192:195],v[64:67]
s_waitcnt vmcnt(17)
s_add_u32 s48,s76,43008
v_fmac_f32 v193,s45,v201
v_fmac_f32 v203,s41,v199
M v[64:67],a[204:207],a[240:243],v[64:67]
s_waitcnt vmcnt(16)
v_sub_f32 v201,v201,v197
v_fma_f32 v197,-4.0,v195,v199
M v[64:67],a[216:219],v[216:219],v[64:67]
v_sub_f32 v199,v199,v195
v_add_f32 v195,v235,v197
M v[68:71],a[216:219],a[220:223],v[68:71]
buffer_load_dwordx4 a[248:251],v250,s[20:23],s48 offen offset:0 sc1
M v[68:71],a[204:207],v[216:219],v[68:71]
v_sub_f32 v235,v235,v197
v_fma_f32 v197,2.0,v199,v201
M v[68:71],v[224:227],a[240:243],v[68:71]
v_fmac_f32 v201,-2.0,v199
v_cvt_pk_bf16_f32 v193,v232,v193
M v[72:75],v[224:227],v[216:219],v[72:75]
v_cvt_pk_bf16_f32 v203,v237,v203
v_cvt_pk_bf16_f32 v195,v233,v195
M v[72:75],a[204:207],a[220:223],v[72:75]
buffer_load_dwordx4 a[192:195],v250,s[20:23],s48 offen offset:1024 sc1
M v[72:75],a[216:219],a[228:231],v[72:75]
v_cvt_pk_bf16_f32 v199,v234,v197
v_cvt_pk_bf16_f32 v197,v238,v235
M v[76:79],a[216:219],a[252:255],v[76:79]
s_waitcnt vmcnt(15)
v_cvt_pk_bf16_f32 v201,v236,v201
v_lshlrev_b32 v234,16,v208
M v[76:79],a[204:207],a[228:231],v[76:79]
v_lshlrev_b32 v232,16,v204
v_lshlrev_b32 v233,16,v206
M v[76:79],v[224:227],a[220:223],v[76:79]
buffer_load_dwordx4 a[240:243],v250,s[20:23],s48 offen offset:2048 sc1
M v[80:83],v[224:227],a[228:231],v[80:83]
s_waitcnt vmcnt(14)
s_add_u32 s46,s77,9216
v_lshlrev_b32 v237,16,v214
v_lshlrev_b32 v236,16,v212
M v[80:83],a[204:207],a[252:255],v[80:83]
v_lshlrev_b32 v235,16,v210
v_fmac_f32 v232,s43,v234
M v[80:83],a[216:219],a[232:235],v[80:83]
ds_write2st64_b64 v247,v[192:193],v[202:203] offset0:138 offset1:155
M v[84:87],a[216:219],a[236:239],v[84:87]
s_add_u32 s28,s66,6291456
buffer_load_dwordx4 v[216:219],v250,s[20:23],s46 offen offset:0 sc1
M v[84:87],a[204:207],a[232:235],v[84:87]
ds_read_b128 a[220:223],v248 offset:26112
v_fmac_f32 v237,4.0,v233
M v[84:87],v[224:227],a[252:255],v[84:87]
ds_write2st64_b64 v247,v[194:195],v[196:197] offset0:104 offset1:121
M v[88:91],v[224:227],a[232:235],v[88:91]
buffer_load_dwordx2 v[192:193],v245,s[12:15],s28 offen offset:0
M v[88:91],a[204:207],a[236:239],v[88:91]
ds_read_b128 a[228:231],v249 offset:26112
ds_read_b128 a[252:255],v248 offset:26624
M v[88:91],a[216:219],a[224:227],v[88:91]
ds_write2st64_b64 v247,v[198:199],v[200:201] offset0:36 offset1:53
M v[92:95],a[216:219],v[228:231],v[92:95]
buffer_load_dwordx2 v[202:203],v245,s[16:19],s28 offen offset:1536
M v[92:95],a[204:207],a[224:227],v[92:95]
ds_read_b128 a[232:235],v249 offset:26624
v_fma_f32 v238,-4.0,v234,v236
M v[92:95],v[224:227],a[236:239],v[92:95]
s_waitcnt lgkmcnt(5)
v_fmac_f32 v232,s45,v236
v_fmac_f32 v237,s41,v235
M v[96:99],a[244:247],a[220:223],v[96:99]
s_waitcnt vmcnt(12) lgkmcnt(3)
ds_read_b128 a[216:219],v248 offset:27136
v_sub_f32 v236,v236,v234
M v[96:99],a[200:203],a[228:231],v[96:99]
s_waitcnt vmcnt(11) lgkmcnt(3)
buffer_load_dwordx2 v[194:195],v245,s[8:11],s28 offen offset:0
M v[96:99],a[196:199],a[252:255],v[96:99]
s_waitcnt lgkmcnt(1)
ds_read_b128 v[228:231],v249 offset:27136
v_fma_f32 v234,-4.0,v233,v235
M v[100:103],a[196:199],a[232:235],v[100:103]
v_sub_f32 v235,v235,v233
v_add_f32 v233,v238,v234
M v[100:103],a[200:203],a[252:255],v[100:103]
v_sub_f32 v238,v238,v234
v_fma_f32 v234,2.0,v235,v236
M v[100:103],a[244:247],a[228:231],v[100:103]
buffer_load_dwordx2 v[196:197],v245,s[8:11],s28 offen offset:384
M v[104:107],a[244:247],a[252:255],v[104:107]
ds_read_b128 a[204:207],v248 offset:27648
v_fmac_f32 v236,-2.0,v235
M v[104:107],a[200:203],a[232:235],v[104:107]
s_waitcnt lgkmcnt(2)
ds_read_b128 a[224:227],v249 offset:27648
v_and_b32 v208,s42,v208
M v[104:107],a[196:199],a[216:219],v[104:107]
s_waitcnt lgkmcnt(2)
v_and_b32 v204,s42,v204
v_and_b32 v206,s42,v206
M v[108:111],a[196:199],v[228:231],v[108:111]
buffer_load_dwordx2 v[198:199],v245,s[8:11],s28 offen offset:768
M v[108:111],a[200:203],a[216:219],v[108:111]
v_and_b32 v214,s42,v214
v_and_b32 v212,s42,v212
M v[108:111],a[244:247],a[232:235],v[108:111]
v_and_b32 v210,s42,v210
v_fmac_f32 v204,s43,v208
M v[112:115],a[244:247],a[216:219],v[112:115]
ds_read_b128 a[236:239],v249 offset:28160
v_fmac_f32 v214,4.0,v206
M v[112:115],a[200:203],v[228:231],v[112:115]
s_waitcnt lgkmcnt(2)
buffer_load_dwordx2 v[200:201],v245,s[8:11],s28 offen offset:1152
M v[112:115],a[196:199],a[204:207],v[112:115]
s_waitcnt lgkmcnt(1)
ds_read_b128 v[224:227],v248 offset:28160
v_fma_f32 v235,-4.0,v208,v212
M v[116:119],a[196:199],a[224:227],v[116:119]
v_fmac_f32 v204,s45,v212
v_fmac_f32 v214,s41,v210
M v[116:119],a[200:203],a[204:207],v[116:119]
v_sub_f32 v212,v212,v208
v_fma_f32 v208,-4.0,v206,v210
M v[116:119],a[244:247],v[228:231],v[116:119]
v_sub_f32 v210,v210,v206
v_add_f32 v206,v235,v208
M v[120:123],a[244:247],a[204:207],v[120:123]
v_sub_f32 v235,v235,v208
v_fma_f32 v208,2.0,v210,v212
M v[120:123],a[200:203],a[224:227],v[120:123]
s_waitcnt lgkmcnt(1)
v_fmac_f32 v212,-2.0,v210
v_cvt_pk_bf16_f32 v204,v232,v204
M v[120:123],a[196:199],a[236:239],v[120:123]
s_waitcnt lgkmcnt(0)
v_cvt_pk_bf16_f32 v214,v237,v214
v_cvt_pk_bf16_f32 v206,v233,v206
M v[124:127],a[196:199],v[224:227],v[124:127]
buffer_load_dwordx4 a[196:199],v250,s[20:23],s46 offen offset:1024 sc1
M v[124:127],a[200:203],a[236:239],v[124:127]
v_cvt_pk_bf16_f32 v210,v234,v208
v_cvt_pk_bf16_f32 v208,v238,v235
M v[124:127],a[244:247],a[224:227],v[124:127]
s_waitcnt vmcnt(15)
buffer_load_dwordx4 a[200:203],v250,s[20:23],s46 offen offset:2048 sc1
M v[128:131],v[220:223],a[220:223],v[128:131]
s_waitcnt vmcnt(13)
s_add_u32 s46,s77,18432
v_cvt_pk_bf16_f32 v212,v236,v212
v_lshlrev_b32 v234,16,v209
M v[128:131],a[212:215],a[228:231],v[128:131]
s_waitcnt vmcnt(12)
v_lshlrev_b32 v232,16,v205
v_lshlrev_b32 v233,16,v207
M v[128:131],a[208:211],a[252:255],v[128:131]
v_lshlrev_b32 v237,16,v215
v_lshlrev_b32 v236,16,v213
M v[132:135],a[208:211],a[232:235],v[132:135]
buffer_load_dwordx4 a[244:247],v250,s[20:23],s46 offen offset:0 sc1
M v[132:135],a[212:215],a[252:255],v[132:135]
v_lshlrev_b32 v235,16,v211
v_fmac_f32 v232,s43,v234
M v[132:135],v[220:223],a[228:231],v[132:135]
v_fmac_f32 v237,4.0,v233
v_fma_f32 v238,-4.0,v234,v236
M v[136:139],v[220:223],a[252:255],v[136:139]
v_fmac_f32 v232,s45,v236
v_fmac_f32 v237,s41,v235
M v[136:139],a[212:215],a[232:235],v[136:139]
v_sub_f32 v236,v236,v234
v_fma_f32 v234,-4.0,v233,v235
M v[136:139],a[208:211],a[216:219],v[136:139]
v_sub_f32 v235,v235,v233
v_add_f32 v233,v238,v234
M v[140:143],a[208:211],v[228:231],v[140:143]
v_sub_f32 v238,v238,v234
v_fma_f32 v234,2.0,v235,v236
M v[140:143],a[212:215],a[216:219],v[140:143]
v_fmac_f32 v236,-2.0,v235
v_and_b32 v209,s42,v209
M v[140:143],v[220:223],a[232:235],v[140:143]
v_and_b32 v205,s42,v205
v_and_b32 v207,s42,v207
M v[144:147],v[220:223],a[216:219],v[144:147]
v_and_b32 v215,s42,v215
v_and_b32 v213,s42,v213
M v[144:147],a[212:215],v[228:231],v[144:147]
v_and_b32 v211,s42,v211
v_fmac_f32 v205,s43,v209
M v[144:147],a[208:211],a[204:207],v[144:147]
v_fmac_f32 v215,4.0,v207
v_fma_f32 v235,-4.0,v209,v213
M v[148:151],a[208:211],a[224:227],v[148:151]
v_fmac_f32 v205,s45,v213
v_fmac_f32 v215,s41,v211
M v[148:151],a[212:215],a[204:207],v[148:151]
v_sub_f32 v213,v213,v209
v_fma_f32 v209,-4.0,v207,v211
M v[148:151],v[220:223],v[228:231],v[148:151]
v_sub_f32 v211,v211,v207
v_add_f32 v207,v235,v209
M v[152:155],v[220:223],a[204:207],v[152:155]
v_sub_f32 v235,v235,v209
v_fma_f32 v209,2.0,v211,v213
M v[152:155],a[212:215],a[224:227],v[152:155]
v_fmac_f32 v213,-2.0,v211
v_cvt_pk_bf16_f32 v205,v232,v205
M v[152:155],a[208:211],a[236:239],v[152:155]
v_cvt_pk_bf16_f32 v215,v237,v215
v_cvt_pk_bf16_f32 v207,v233,v207
M v[156:159],a[208:211],v[224:227],v[156:159]
buffer_load_dwordx4 a[208:211],v250,s[20:23],s46 offen offset:1024 sc1
M v[156:159],a[212:215],a[236:239],v[156:159]
v_cvt_pk_bf16_f32 v211,v234,v209
v_cvt_pk_bf16_f32 v209,v238,v235
M v[156:159],v[220:223],a[224:227],v[156:159]
s_waitcnt vmcnt(13)
buffer_load_dwordx4 a[212:215],v250,s[20:23],s46 offen offset:2048 sc1
M v[160:163],a[248:251],a[220:223],v[160:163]
s_waitcnt vmcnt(13)
s_add_u32 s46,s77,27648
v_cvt_pk_bf16_f32 v213,v236,v213
M v[160:163],a[192:195],a[228:231],v[160:163]
s_waitcnt vmcnt(12)
M v[160:163],a[240:243],a[252:255],v[160:163]
ds_write2st64_b64 v247,v[204:205],v[214:215] offset0:139 offset1:156
M v[164:167],a[240:243],a[232:235],v[164:167]
buffer_load_dwordx4 v[220:223],v250,s[20:23],s46 offen offset:0 sc1
M v[164:167],a[192:195],a[252:255],v[164:167]
M v[164:167],a[248:251],a[228:231],v[164:167]
ds_write2st64_b64 v247,v[206:207],v[208:209] offset0:105 offset1:122
M v[168:171],a[248:251],a[252:255],v[168:171]
buffer_load_dwordx4 a[220:223],v250,s[20:23],s46 offen offset:1024 sc1
M v[168:171],a[192:195],a[232:235],v[168:171]
M v[168:171],a[240:243],a[216:219],v[168:171]
ds_write2st64_b64 v247,v[210:211],v[212:213] offset0:37 offset1:54
M v[172:175],a[240:243],v[228:231],v[172:175]
buffer_load_dwordx4 a[228:231],v250,s[20:23],s46 offen offset:2048 sc1
M v[172:175],a[192:195],a[216:219],v[172:175]
s_add_u32 s46,s77,36864
M v[172:175],a[248:251],a[232:235],v[172:175]
M v[176:179],a[248:251],a[216:219],v[176:179]
M v[176:179],a[192:195],v[228:231],v[176:179]
buffer_load_dwordx4 a[252:255],v250,s[20:23],s46 offen offset:0 sc1
M v[176:179],a[240:243],a[204:207],v[176:179]
s_waitcnt lgkmcnt(0)
s_barrier
M v[180:183],a[240:243],a[224:227],v[180:183]
M v[180:183],a[192:195],a[204:207],v[180:183]
ds_read_b128 a[232:235],v248 offset:34816
M v[180:183],a[248:251],v[228:231],v[180:183]
ds_read_b128 a[216:219],v249 offset:34816
M v[184:187],a[248:251],a[204:207],v[184:187]
ds_read_b128 v[228:231],v248 offset:35328
M v[184:187],a[192:195],a[224:227],v[184:187]
ds_read_b128 a[204:207],v249 offset:35328
M v[184:187],a[240:243],a[236:239],v[184:187]
M v[188:191],a[240:243],v[224:227],v[188:191]
buffer_load_dwordx4 a[240:243],v250,s[20:23],s46 offen offset:1024 sc1
M v[188:191],a[192:195],a[236:239],v[188:191]
M v[188:191],a[248:251],a[224:227],v[188:191]
s_waitcnt vmcnt(16) lgkmcnt(3)
buffer_load_dwordx4 v[224:227],v250,s[20:23],s46 offen offset:2048 sc1
M a[0:3],v[216:219],a[232:235],a[0:3]
s_waitcnt vmcnt(10) lgkmcnt(2)
s_add_u32 s47,s77,12288
ds_read_b128 a[236:239],v248 offset:35840
M a[0:3],a[196:199],a[216:219],a[0:3]
s_waitcnt vmcnt(9) lgkmcnt(2)
ds_read_b128 a[224:227],v249 offset:35840
v_lshlrev_b32 v234,16,v196
M a[0:3],a[200:203],v[228:231],a[0:3]
s_waitcnt lgkmcnt(2)
v_lshlrev_b32 v232,16,v192
v_lshlrev_b32 v233,16,v194
M a[4:7],a[200:203],a[204:207],a[4:7]
buffer_load_dwordx4 a[192:195],v250,s[20:23],s47 offen offset:0 sc1
M a[4:7],a[196:199],v[228:231],a[4:7]
v_lshlrev_b32 v237,16,v202
v_lshlrev_b32 v236,16,v200
M a[4:7],v[216:219],a[216:219],a[4:7]
v_lshlrev_b32 v235,16,v198
v_fmac_f32 v232,s43,v234
M a[8:11],v[216:219],v[228:231],a[8:11]
ds_read_b128 a[248:251],v248 offset:36352
v_fmac_f32 v237,4.0,v233
M a[8:11],a[196:199],a[204:207],a[8:11]
s_waitcnt lgkmcnt(2)
ds_read_b128 a[232:235],v249 offset:36352
v_fma_f32 v238,-4.0,v234,v236
M a[8:11],a[200:203],a[236:239],a[8:11]
s_waitcnt lgkmcnt(2)
v_fmac_f32 v232,s45,v236
v_fmac_f32 v237,s41,v235
M a[12:15],a[200:203],a[224:227],a[12:15]
v_sub_f32 v236,v236,v234
v_fma_f32 v234,-4.0,v233,v235
M a[12:15],a[196:199],a[236:239],a[12:15]
v_sub_f32 v235,v235,v233
v_add_f32 v233,v238,v234
M a[12:15],v[216:219],a[204:207],a[12:15]
v_sub_f32 v238,v238,v234
v_fma_f32 v234,2.0,v235,v236
M a[16:19],v[216:219],a[236:239],a[16:19]
ds_read_b128 a[216:219],v249 offset:36864
v_fmac_f32 v236,-2.0,v235
M a[16:19],a[196:199],a[224:227],a[16:19]
s_waitcnt lgkmcnt(2)
ds_read_b128 v[228:231],v248 offset:36864
v_and_b32 v196,s42,v196
M a[16:19],a[200:203],a[248:251],a[16:19]
s_waitcnt lgkmcnt(2)
v_and_b32 v192,s42,v192
v_and_b32 v194,s42,v194
M a[20:23],a[200:203],a[232:235],a[20:23]
v_and_b32 v202,s42,v202
v_and_b32 v200,s42,v200
M a[20:23],a[196:199],a[248:251],a[20:23]
ds_read_b128 a[204:207],v248 offset:43520
v_and_b32 v198,s42,v198
M a[20:23],v[216:219],a[224:227],a[20:23]
ds_read_b128 a[236:239],v249 offset:43520
v_fmac_f32 v192,s43,v196
M a[24:27],v[216:219],a[248:251],a[24:27]
ds_read_b128 a[224:227],v248 offset:44032
v_fmac_f32 v202,4.0,v194
M a[24:27],a[196:199],a[232:235],a[24:27]
s_waitcnt lgkmcnt(4)
ds_read_b128 a[248:251],v249 offset:44032
v_fma_f32 v235,-4.0,v196,v200
M a[24:27],a[200:203],a[216:219],a[24:27]
s_waitcnt lgkmcnt(4)
v_fmac_f32 v192,s45,v200
v_fmac_f32 v202,s41,v198
M a[28:31],a[200:203],v[228:231],a[28:31]
buffer_load_dwordx4 a[200:203],v250,s[20:23],s47 offen offset:1024 sc1
M a[28:31],a[196:199],a[216:219],a[28:31]
v_sub_f32 v200,v200,v196
v_fma_f32 v196,-4.0,v194,v198
M a[28:31],v[216:219],a[232:235],a[28:31]
s_waitcnt vmcnt(10) lgkmcnt(3)
buffer_load_dwordx4 v[228:231],v250,s[20:23],s47 offen offset:2048 sc1
M a[96:99],a[244:247],a[204:207],a[96:99]
s_waitcnt vmcnt(10) lgkmcnt(2)
s_add_u32 s48,s77,15360
ds_read_b128 a[216:219],v248 offset:44544
v_sub_f32 v198,v198,v194
M a[96:99],a[208:211],a[236:239],a[96:99]
s_waitcnt vmcnt(9) lgkmcnt(2)
ds_read_b128 a[232:235],v249 offset:44544
v_add_f32 v194,v235,v196
M a[96:99],a[212:215],a[224:227],a[96:99]
s_waitcnt lgkmcnt(2)
v_sub_f32 v235,v235,v196
v_fma_f32 v196,2.0,v198,v200
M a[100:103],a[212:215],a[248:251],a[100:103]
buffer_load_dwordx4 a[196:199],v250,s[20:23],s48 offen offset:0 sc1
M a[100:103],a[208:211],a[224:227],a[100:103]
v_fmac_f32 v200,-2.0,v198
v_cvt_pk_bf16_f32 v192,v232,v192
M a[100:103],a[244:247],a[236:239],a[100:103]
v_cvt_pk_bf16_f32 v202,v237,v202
v_cvt_pk_bf16_f32 v194,v233,v194
M a[104:107],a[244:247],a[224:227],a[104:107]
ds_read_b128 v[216:219],v248 offset:45056
v_cvt_pk_bf16_f32 v198,v234,v196
M a[104:107],a[208:211],a[248:251],a[104:107]
s_waitcnt lgkmcnt(2)
ds_read_b128 a[204:207],v249 offset:45056
v_cvt_pk_bf16_f32 v196,v238,v235
M a[104:107],a[212:215],a[216:219],a[104:107]
s_waitcnt lgkmcnt(2)
v_cvt_pk_bf16_f32 v200,v236,v200
v_lshlrev_b32 v234,16,v197
M a[108:111],a[212:215],a[232:235],a[108:111]
v_lshlrev_b32 v232,16,v193
v_lshlrev_b32 v233,16,v195
M a[108:111],a[208:211],a[216:219],a[108:111]
v_lshlrev_b32 v237,16,v203
v_lshlrev_b32 v236,16,v201
M a[108:111],a[244:247],a[248:251],a[108:111]
v_lshlrev_b32 v235,16,v199
v_fmac_f32 v232,s43,v234
M a[112:115],a[244:247],a[216:219],a[112:115]
ds_read_b128 a[236:239],v249 offset:45568
v_fmac_f32 v237,4.0,v233
M a[112:115],a[208:211],a[232:235],a[112:115]
s_waitcnt lgkmcnt(2)
ds_read_b128 a[224:227],v248 offset:45568
v_and_b32 v255,32,v245
M a[112:115],a[212:215],v[216:219],a[112:115]
s_waitcnt lgkmcnt(2)
v_mul_u32_u24 v255,24,v255
v_and_or_b32 v255,v245,s42,v255
M a[116:119],a[212:215],a[204:207],a[116:119]
v_fma_f32 v238,-4.0,v234,v236
v_fmac_f32 v232,s45,v236
M a[116:119],a[208:211],v[216:219],a[116:119]
ds_read_b128 a[248:251],v248 offset:0
v_fmac_f32 v237,s41,v235
M a[116:119],a[244:247],a[232:235],a[116:119]
s_add_u32 s31,s66,6684672
ds_read_b128 a[216:219],v249 offset:0
v_sub_f32 v236,v236,v234
M a[120:123],a[244:247],v[216:219],a[120:123]
ds_read_b128 a[232:235],v248 offset:512
v_fma_f32 v234,-4.0,v233,v235
M a[120:123],a[208:211],a[204:207],a[120:123]
s_waitcnt lgkmcnt(4)
ds_read_b128 v[216:219],v249 offset:512
v_sub_f32 v235,v235,v233
M a[120:123],a[212:215],a[236:239],a[120:123]
s_waitcnt lgkmcnt(4)
v_add_f32 v233,v238,v234
v_sub_f32 v238,v238,v234
M a[124:127],a[212:215],a[224:227],a[124:127]
buffer_load_dword a212,v255,s[8:11],s31 offen offset:0
M a[124:127],a[208:211],a[236:239],a[124:127]
v_fma_f32 v234,2.0,v235,v236
v_fmac_f32 v236,-2.0,v235
M a[124:127],a[244:247],a[204:207],a[124:127]
s_waitcnt vmcnt(10) lgkmcnt(3)
v_and_b32 v197,s42,v197
v_and_b32 v193,s42,v193
M v[0:3],v[220:223],a[248:251],v[0:3]
s_waitcnt vmcnt(9) lgkmcnt(2)
ds_read_b128 a[224:227],v248 offset:1024
v_and_b32 v195,s42,v195
M v[0:3],a[220:223],a[216:219],v[0:3]
s_waitcnt vmcnt(8) lgkmcnt(2)
buffer_load_dword a212,v255,s[8:11],s31 offen offset:384
M v[0:3],a[228:231],a[232:235],v[0:3]
s_waitcnt lgkmcnt(1)
ds_read_b128 a[208:211],v249 offset:1024
v_and_b32 v203,s42,v203
M v[4:7],a[228:231],v[216:219],v[4:7]
v_and_b32 v201,s42,v201
v_and_b32 v199,s42,v199
M v[4:7],a[220:223],a[232:235],v[4:7]
v_fmac_f32 v193,s43,v197
v_fmac_f32 v203,4.0,v195
M v[4:7],v[220:223],a[216:219],v[4:7]
v_fma_f32 v235,-4.0,v197,v201
v_fmac_f32 v193,s45,v201
M v[8:11],v[220:223],a[232:235],v[8:11]
ds_read_b128 a[236:239],v248 offset:1536
v_fmac_f32 v203,s41,v199
M v[8:11],a[220:223],v[216:219],v[8:11]
s_waitcnt lgkmcnt(2)
ds_read_b128 a[204:207],v249 offset:1536
v_sub_f32 v201,v201,v197
M v[8:11],a[228:231],a[224:227],v[8:11]
s_waitcnt lgkmcnt(2)
v_fma_f32 v197,-4.0,v195,v199
v_sub_f32 v199,v199,v195
M v[12:15],a[228:231],a[208:211],v[12:15]
v_add_f32 v195,v235,v197
v_sub_f32 v235,v235,v197
M v[12:15],a[220:223],a[224:227],v[12:15]
v_fma_f32 v197,2.0,v199,v201
v_fmac_f32 v201,-2.0,v199
M v[12:15],v[220:223],v[216:219],v[12:15]
v_cvt_pk_bf16_f32 v193,v232,v193
v_cvt_pk_bf16_f32 v203,v237,v203
M v[16:19],v[220:223],a[224:227],v[16:19]
ds_read_b128 a[244:247],v249 offset:2048
v_cvt_pk_bf16_f32 v195,v233,v195
M v[16:19],a[220:223],a[208:211],v[16:19]
s_waitcnt lgkmcnt(2)
buffer_load_dwordx4 a[212:215],v250,s[20:23],s48 offen offset:1024 sc1
M v[16:19],a[228:231],a[236:239],v[16:19]
s_waitcnt lgkmcnt(1)
ds_read_b128 a[248:251],v248 offset:2048
v_cvt_pk_bf16_f32 v199,v234,v197
M v[20:23],a[228:231],a[204:207],v[20:23]
buffer_load_dwordx4 a[216:219],v250,s[20:23],s48 offen offset:2048 sc1
M v[20:23],a[220:223],a[236:239],v[20:23]
ds_read_b128 a[232:235],v248 offset:8704
v_cvt_pk_bf16_f32 v197,v238,v235
M v[20:23],v[220:223],a[208:211],v[20:23]
ds_read_b128 v[216:219],v249 offset:8704
v_cvt_pk_bf16_f32 v201,v236,v201
M v[24:27],v[220:223],a[236:239],v[24:27]
ds_read_b128 a[224:227],v248 offset:9216
M v[24:27],a[220:223],a[204:207],v[24:27]
s_waitcnt lgkmcnt(4)
ds_read_b128 a[208:211],v249 offset:9216
M v[24:27],a[228:231],a[244:247],v[24:27]
s_waitcnt lgkmcnt(4)
M v[28:31],a[228:231],a[248:251],v[28:31]
s_add_u32 s47,s77,21504
M v[28:31],a[220:223],a[244:247],v[28:31]
M v[28:31],v[220:223],a[204:207],v[28:31]
s_waitcnt vmcnt(10) lgkmcnt(3)
M v[96:99],a[252:255],a[232:235],v[96:99]
s_waitcnt vmcnt(9) lgkmcnt(2)
ds_read_b128 a[236:239],v248 offset:9728
M v[96:99],a[240:243],v[216:219],v[96:99]
s_waitcnt vmcnt(8) lgkmcnt(2)
ds_read_b128 a[228:231],v249 offset:9728
M v[96:99],v[224:227],a[224:227],v[96:99]
s_waitcnt lgkmcnt(2)
M v[100:103],v[224:227],a[208:211],v[100:103]
buffer_load_dwordx4 a[248:251],v250,s[20:23],s47 offen offset:0 sc1
M v[100:103],a[240:243],a[224:227],v[100:103]
M v[100:103],a[252:255],v[216:219],v[100:103]
buffer_load_dwordx4 a[220:223],v250,s[20:23],s47 offen offset:1024 sc1
M v[104:107],a[252:255],a[224:227],v[104:107]
ds_read_b128 v[220:223],v248 offset:10240
v_accvgpr_read_b32 v238,a0
M v[104:107],a[240:243],a[208:211],v[104:107]
s_waitcnt lgkmcnt(2)
ds_read_b128 a[232:235],v249 offset:10240
v_accvgpr_read_b32 v232,a96
M v[104:107],v[224:227],a[236:239],v[104:107]
s_waitcnt lgkmcnt(2)
v_add_f32 v234,v238,v232
v_sub_f32 v238,v238,v232
M v[108:111],v[224:227],a[228:231],v[108:111]
buffer_load_dwordx4 a[244:247],v250,s[20:23],s47 offen offset:2048 sc1
M v[108:111],a[240:243],a[236:239],v[108:111]
s_add_u32 s48,s77,24576
v_add_f32 v232,v0,v96
v_sub_f32 v96,v0,v96
M v[108:111],a[252:255],a[208:211],v[108:111]
v_add_f32 v0,v234,v232
v_fmac_f32 v234,4.0,v232
M v[112:115],a[252:255],a[236:239],v[112:115]
ds_read_b128 v[216:219],v249 offset:10752
v_fma_f32 v232,2.0,v96,v238
M v[112:115],a[240:243],a[228:231],v[112:115]
s_waitcnt lgkmcnt(2)
buffer_load_dwordx4 a[204:207],v250,s[20:23],s48 offen offset:0 sc1
M v[112:115],v[224:227],v[220:223],v[112:115]
s_waitcnt lgkmcnt(1)
ds_read_b128 a[224:227],v248 offset:10752
v_fma_f32 v96,s40,v96,v238
M v[116:119],v[224:227],a[232:235],v[116:119]
v_accvgpr_read_b32 v238,a1
v_accvgpr_read_b32 v237,a97
M v[116:119],a[240:243],v[220:223],v[116:119]
ds_read_b128 a[208:211],v248 offset:34816
v_add_f32 v236,v238,v237
M v[116:119],a[252:255],a[228:231],v[116:119]
ds_read_b128 a[236:239],v249 offset:34816
v_sub_f32 v238,v238,v237
M v[120:123],a[252:255],v[220:223],v[120:123]
ds_read_b128 a[228:231],v248 offset:35328
v_add_f32 v237,v1,v97
M v[120:123],a[240:243],a[232:235],v[120:123]
s_waitcnt lgkmcnt(4)
ds_read_b128 v[220:223],v249 offset:35328
v_sub_f32 v97,v1,v97
M v[120:123],v[224:227],v[216:219],v[120:123]
s_waitcnt lgkmcnt(4)
v_add_f32 v1,v236,v237
v_fmac_f32 v236,4.0,v237
M v[124:127],v[224:227],a[224:227],v[124:127]
v_fma_f32 v237,2.0,v97,v238
v_fma_f32 v97,s40,v97,v238
M v[124:127],a[240:243],v[216:219],v[124:127]
v_cvt_pk_bf16_f32 v232,v232,v237
v_cvt_pk_bf16_f32 v234,v234,v236
M v[124:127],a[252:255],a[232:235],v[124:127]
s_waitcnt vmcnt(11) lgkmcnt(3)
v_accvgpr_read_b32 v238,a2
v_accvgpr_read_b32 v233,a98
M a[32:35],a[192:195],a[208:211],a[32:35]
s_waitcnt vmcnt(10) lgkmcnt(2)
ds_read_b128 a[224:227],v248 offset:35840
v_add_f32 v235,v238,v233
M a[32:35],a[200:203],a[236:239],a[32:35]
s_waitcnt vmcnt(9) lgkmcnt(2)
ds_read_b128 v[224:227],v249 offset:35840
v_sub_f32 v238,v238,v233
M a[32:35],v[228:231],a[228:231],a[32:35]
s_waitcnt lgkmcnt(2)
v_add_f32 v233,v2,v98
v_sub_f32 v98,v2,v98
M a[36:39],v[228:231],v[220:223],a[36:39]
v_add_f32 v2,v235,v233
v_fmac_f32 v235,4.0,v233
M a[36:39],a[200:203],a[228:231],a[36:39]
v_fma_f32 v233,2.0,v98,v238
v_fma_f32 v98,s40,v98,v238
M a[36:39],a[192:195],a[236:239],a[36:39]
v_accvgpr_read_b32 v238,a3
v_accvgpr_read_b32 v237,a99
M a[40:43],a[192:195],a[228:231],a[40:43]
ds_read_b128 a[96:99],v248 offset:36352
v_add_f32 v236,v238,v237
M a[40:43],a[200:203],v[220:223],a[40:43]
s_waitcnt lgkmcnt(2)
ds_read_b128 a[240:243],v249 offset:36352
v_sub_f32 v238,v238,v237
M a[40:43],v[228:231],a[224:227],a[40:43]
s_waitcnt lgkmcnt(2)
v_add_f32 v237,v3,v99
v_sub_f32 v99,v3,v99
M a[44:47],v[228:231],v[224:227],a[44:47]
v_add_f32 v3,v236,v237
v_fmac_f32 v236,4.0,v237
M a[44:47],a[200:203],a[224:227],a[44:47]
v_fma_f32 v237,2.0,v99,v238
v_fma_f32 v99,s40,v99,v238
M a[44:47],a[192:195],v[220:223],a[44:47]
v_cvt_pk_bf16_f32 v233,v233,v237
v_cvt_pk_bf16_f32 v235,v235,v236
M a[48:51],a[192:195],a[224:227],a[48:51]
ds_read_b128 v[216:219],v249 offset:36864
ds_write2st64_b64 v254,v[232:233],v[234:235] offset0:68 offset1:72
M a[48:51],a[200:203],v[224:227],a[48:51]
s_waitcnt lgkmcnt(3)
ds_read_b128 a[232:235],v248 offset:36864
v_accvgpr_read_b32 v238,a4
M a[48:51],v[228:231],a[96:99],a[48:51]
s_waitcnt lgkmcnt(3)
v_accvgpr_read_b32 v232,a100
v_add_f32 v234,v238,v232
M a[52:55],v[228:231],a[240:243],a[52:55]
buffer_load_dwordx4 a[252:255],v250,s[20:23],s48 offen offset:1024 sc1
M a[52:55],a[200:203],a[96:99],a[52:55]
v_sub_f32 v238,v238,v232
v_add_f32 v232,v4,v100
M a[52:55],a[192:195],v[224:227],a[52:55]
v_sub_f32 v100,v4,v100
v_add_f32 v4,v234,v232
M a[56:59],a[192:195],a[96:99],a[56:59]
v_fmac_f32 v234,4.0,v232
v_fma_f32 v232,2.0,v100,v238
M a[56:59],a[200:203],a[240:243],a[56:59]
s_waitcnt lgkmcnt(2)
v_fma_f32 v100,s40,v100,v238
v_accvgpr_read_b32 v238,a5
M a[56:59],v[228:231],v[216:219],a[56:59]
s_waitcnt lgkmcnt(0)
v_accvgpr_read_b32 v237,a101
v_add_f32 v236,v238,v237
M a[60:63],v[228:231],a[232:235],a[60:63]
buffer_load_dwordx4 v[228:231],v250,s[20:23],s48 offen offset:2048 sc1
M a[60:63],a[200:203],v[216:219],a[60:63]
s_add_u32 s47,s77,30720
v_sub_f32 v238,v238,v237
v_add_f32 v237,v5,v101
M a[60:63],a[192:195],a[240:243],a[60:63]
s_waitcnt vmcnt(10)
buffer_load_dwordx4 a[200:203],v250,s[20:23],s47 offen offset:0 sc1
M a[64:67],a[196:199],a[208:211],a[64:67]
s_waitcnt vmcnt(8)
v_sub_f32 v101,v5,v101
v_add_f32 v5,v236,v237
M a[64:67],a[212:215],a[236:239],a[64:67]
s_waitcnt vmcnt(7)
v_fmac_f32 v236,4.0,v237
v_fma_f32 v237,2.0,v101,v238
M a[64:67],a[216:219],a[228:231],a[64:67]
v_fma_f32 v101,s40,v101,v238
v_cvt_pk_bf16_f32 v232,v232,v237
M a[68:71],a[216:219],v[220:223],a[68:71]
buffer_load_dwordx4 a[192:195],v250,s[20:23],s47 offen offset:1024 sc1
M a[68:71],a[212:215],a[228:231],a[68:71]
v_cvt_pk_bf16_f32 v234,v234,v236
v_accvgpr_read_b32 v238,a6
M a[68:71],a[196:199],a[236:239],a[68:71]
v_accvgpr_read_b32 v233,a102
v_add_f32 v235,v238,v233
M a[72:75],a[196:199],a[228:231],a[72:75]
v_sub_f32 v238,v238,v233
v_add_f32 v233,v6,v102
M a[72:75],a[212:215],v[220:223],a[72:75]
buffer_load_dwordx4 a[208:211],v250,s[20:23],s47 offen offset:2048 sc1
M a[72:75],a[216:219],a[224:227],a[72:75]
s_add_u32 s48,s77,33792
v_sub_f32 v102,v6,v102
v_add_f32 v6,v235,v233
M a[76:79],a[216:219],v[224:227],a[76:79]
v_fmac_f32 v235,4.0,v233
v_fma_f32 v233,2.0,v102,v238
M a[76:79],a[212:215],a[224:227],a[76:79]
v_fma_f32 v102,s40,v102,v238
v_accvgpr_read_b32 v238,a7
M a[76:79],a[196:199],v[220:223],a[76:79]
buffer_load_dwordx4 a[236:239],v250,s[20:23],s48 offen offset:0 sc1
M a[80:83],a[196:199],a[224:227],a[80:83]
v_accvgpr_read_b32 v237,a103
v_add_f32 v236,v238,v237
M a[80:83],a[212:215],v[224:227],a[80:83]
v_sub_f32 v238,v238,v237
v_add_f32 v237,v7,v103
M a[80:83],a[216:219],a[96:99],a[80:83]
v_sub_f32 v103,v7,v103
v_add_f32 v7,v236,v237
M a[84:87],a[216:219],a[240:243],a[84:87]
buffer_load_dwordx4 a[228:231],v250,s[20:23],s48 offen offset:1024 sc1
M a[84:87],a[212:215],a[96:99],a[84:87]
ds_read_b128 a[100:103],v248 offset:43520
v_fmac_f32 v236,4.0,v237
M a[84:87],a[196:199],v[224:227],a[84:87]
s_add_u32 s31,s66,7077888
ds_read_b128 v[220:223],v249 offset:43520
v_fma_f32 v237,2.0,v103,v238
M a[88:91],a[196:199],a[96:99],a[88:91]
ds_read_b128 a[96:99],v248 offset:44032
v_fma_f32 v103,s40,v103,v238
M a[88:91],a[212:215],a[240:243],a[88:91]
ds_read_b128 a[224:227],v249 offset:44032
v_cvt_pk_bf16_f32 v233,v233,v237
M a[88:91],a[216:219],v[216:219],a[88:91]
v_cvt_pk_bf16_f32 v235,v235,v236
M a[92:95],a[216:219],a[232:235],a[92:95]
buffer_load_dword v224,v255,s[8:11],s31 offen offset:0
M a[92:95],a[212:215],v[216:219],a[92:95]
ds_write2st64_b64 v254,v[232:233],v[234:235] offset0:76 offset1:80
M a[92:95],a[196:199],a[240:243],a[92:95]
s_waitcnt vmcnt(11) lgkmcnt(4)
v_accvgpr_read_b32 v238,a8
v_accvgpr_read_b32 v232,a104
M a[128:131],a[248:251],a[100:103],a[128:131]
s_waitcnt vmcnt(10) lgkmcnt(3)
ds_read_b128 a[216:219],v248 offset:44544
v_add_f32 v234,v238,v232
M a[128:131],a[220:223],v[220:223],a[128:131]
s_waitcnt vmcnt(9) lgkmcnt(3)
buffer_load_dword v224,v255,s[8:11],s31 offen offset:384
M a[128:131],a[244:247],a[96:99],a[128:131]
s_waitcnt lgkmcnt(2)
ds_read_b128 a[232:235],v249 offset:44544
v_sub_f32 v238,v238,v232
M a[132:135],a[244:247],a[224:227],a[132:135]
v_add_f32 v232,v8,v104
v_sub_f32 v104,v8,v104
M a[132:135],a[220:223],a[96:99],a[132:135]
s_waitcnt lgkmcnt(2)
s_barrier
ds_read_b128 a[0:3],v250 offset:34816
M a[132:135],a[248:251],v[220:223],a[132:135]
ds_read_b128 a[4:7],v250 offset:38912
v_add_f32 v8,v234,v232
M a[136:139],a[248:251],a[96:99],a[136:139]
ds_read_b128 a[212:215],v248 offset:45056
v_fmac_f32 v234,4.0,v232
M a[136:139],a[220:223],a[224:227],a[136:139]
s_waitcnt lgkmcnt(4)
ds_read_b128 v[216:219],v249 offset:45056
v_fma_f32 v232,2.0,v104,v238
M a[136:139],a[244:247],a[216:219],a[136:139]
s_waitcnt lgkmcnt(4)
v_fma_f32 v104,s40,v104,v238
v_accvgpr_read_b32 v238,a9
M a[140:143],a[244:247],a[232:235],a[140:143]
v_accvgpr_read_b32 v237,a105
v_add_f32 v236,v238,v237
M a[140:143],a[220:223],a[216:219],a[140:143]
v_sub_f32 v238,v238,v237
v_add_f32 v237,v9,v105
M a[140:143],a[248:251],a[224:227],a[140:143]
v_sub_f32 v105,v9,v105
v_add_f32 v9,v236,v237
M a[144:147],a[248:251],a[216:219],a[144:147]
ds_read_b128 a[196:199],v249 offset:45568
v_fmac_f32 v236,4.0,v237
M a[144:147],a[220:223],a[232:235],a[144:147]
s_waitcnt lgkmcnt(2)
ds_read_b128 a[240:243],v248 offset:45568
v_fma_f32 v237,2.0,v105,v238
M a[144:147],a[244:247],a[212:215],a[144:147]
s_waitcnt lgkmcnt(2)
buffer_load_dwordx4 v[224:227],v250,s[20:23],s48 offen offset:2048 sc1
M a[148:151],a[244:247],v[216:219],a[148:151]
v_fma_f32 v105,s40,v105,v238
v_cvt_pk_bf16_f32 v232,v232,v237
M a[148:151],a[220:223],a[212:215],a[148:151]
v_cvt_pk_bf16_f32 v234,v234,v236
v_accvgpr_read_b32 v238,a10
M a[148:151],a[248:251],a[232:235],a[148:151]
v_accvgpr_read_b32 v233,a106
v_add_f32 v235,v238,v233
M a[152:155],a[248:251],a[212:215],a[152:155]
v_sub_f32 v238,v238,v233
v_add_f32 v233,v10,v106
M a[152:155],a[220:223],v[216:219],a[152:155]
s_waitcnt lgkmcnt(1)
v_sub_f32 v106,v10,v106
v_add_f32 v10,v235,v233
M a[152:155],a[244:247],a[196:199],a[152:155]
s_waitcnt lgkmcnt(0)
v_fmac_f32 v235,4.0,v233
v_fma_f32 v233,2.0,v106,v238
M a[156:159],a[244:247],a[240:243],a[156:159]
global_load_dword a244,v250,s[64:65]
M a[156:159],a[220:223],a[196:199],a[156:159]
s_add_u32 s47,s77,39936
v_fma_f32 v106,s40,v106,v238
v_accvgpr_read_b32 v238,a11
M a[156:159],a[248:251],v[216:219],a[156:159]
s_waitcnt vmcnt(11)
v_accvgpr_read_b32 v237,a107
v_add_f32 v236,v238,v237
M a[160:163],a[204:207],a[100:103],a[160:163]
s_waitcnt vmcnt(10)
v_sub_f32 v238,v238,v237
v_add_f32 v237,v11,v107
M a[160:163],a[252:255],v[220:223],a[160:163]
s_waitcnt vmcnt(9)
v_sub_f32 v107,v11,v107
v_add_f32 v11,v236,v237
M a[160:163],v[228:231],a[96:99],a[160:163]
v_fmac_f32 v236,4.0,v237
v_fma_f32 v237,2.0,v107,v238
M a[164:167],v[228:231],a[224:227],a[164:167]
buffer_load_dwordx4 a[244:247],v250,s[20:23],s47 offen offset:0 sc1
M a[164:167],a[252:255],a[96:99],a[164:167]
v_fma_f32 v107,s40,v107,v238
v_cvt_pk_bf16_f32 v233,v233,v237
M a[164:167],a[204:207],v[220:223],a[164:167]
buffer_load_dwordx4 a[100:103],v250,s[20:23],s47 offen offset:1024 sc1
M a[168:171],a[204:207],a[96:99],a[168:171]
v_cvt_pk_bf16_f32 v235,v235,v236
M a[168:171],a[252:255],a[224:227],a[168:171]
ds_write2st64_b64 v254,v[232:233],v[234:235] offset0:85 offset1:89
M a[168:171],v[228:231],a[216:219],a[168:171]
v_accvgpr_read_b32 v204,a12
v_accvgpr_read_b32 v208,a108
M a[172:175],v[228:231],a[232:235],a[172:175]
buffer_load_dwordx4 a[104:107],v250,s[20:23],s47 offen offset:2048 sc1
M a[172:175],a[252:255],a[216:219],a[172:175]
s_add_u32 s48,s77,43008
v_accvgpr_read_b32 v205,a13
v_accvgpr_read_b32 v209,a109
M a[172:175],a[204:207],a[224:227],a[172:175]
v_accvgpr_read_b32 v206,a14
v_accvgpr_read_b32 v210,a110
v_accvgpr_read_b32 v207,a15
v_accvgpr_read_b32 v211,a111
v_pk_add_f32 v[212:213],v[204:205],v[208:209]
v_pk_add_f32 v[214:215],v[206:207],v[210:211]
v_pk_add_f32 v[204:205],v[204:205],v[208:209] neg_lo:[0,1] neg_hi:[0,1]
v_pk_add_f32 v[206:207],v[206:207],v[210:211] neg_lo:[0,1] neg_hi:[0,1]
v_pk_add_f32 v[208:209],v[12:13],v[108:109]
v_pk_add_f32 v[210:211],v[14:15],v[110:111]
v_pk_add_f32 v[108:109],v[12:13],v[108:109] neg_lo:[0,1] neg_hi:[0,1]
v_pk_add_f32 v[110:111],v[14:15],v[110:111] neg_lo:[0,1] neg_hi:[0,1]
v_pk_add_f32 v[12:13],v[212:213],v[208:209]
v_pk_add_f32 v[14:15],v[214:215],v[210:211]
v_pk_fma_f32 v[212:213],v[208:209],4.0,v[212:213] op_sel_hi:[1,0,1]
v_pk_fma_f32 v[214:215],v[210:211],4.0,v[214:215] op_sel_hi:[1,0,1]
v_pk_fma_f32 v[208:209],v[108:109],2.0,v[204:205] op_sel_hi:[1,0,1]
v_pk_fma_f32 v[210:211],v[110:111],2.0,v[206:207] op_sel_hi:[1,0,1]
v_pk_fma_f32 v[108:109],v[108:109],s[40:41],v[204:205] op_sel_hi:[1,0,1]
v_pk_fma_f32 v[110:111],v[110:111],s[40:41],v[206:207] op_sel_hi:[1,0,1]
M a[176:179],a[204:207],a[216:219],a[176:179]
buffer_load_dwordx4 a[220:223],v250,s[20:23],s48 offen offset:0 sc1
M a[176:179],a[252:255],a[232:235],a[176:179]
v_cvt_pk_bf16_f32 v208,v208,v209
v_cvt_pk_bf16_f32 v209,v210,v211
M a[176:179],v[228:231],a[212:215],a[176:179]
buffer_load_dwordx4 a[248:251],v250,s[20:23],s48 offen offset:1024 sc1
M a[180:183],v[228:231],v[216:219],a[180:183]
v_cvt_pk_bf16_f32 v212,v212,v213
v_cvt_pk_bf16_f32 v213,v214,v215
M a[180:183],a[252:255],a[212:215],a[180:183]
ds_read_b128 a[108:111],v248 offset:0
ds_write2st64_b64 v254,v[208:209],v[212:213] offset0:93 offset1:97
M a[180:183],a[204:207],a[232:235],a[180:183]
buffer_load_dwordx4 a[96:99],v250,s[20:23],s48 offen offset:2048 sc1
M a[184:187],a[204:207],a[212:215],a[184:187]
s_add_u32 s46,s72,0
ds_read_b128 a[224:227],v249 offset:0
ds_read_b128 a[216:219],v248 offset:512
M a[184:187],a[252:255],v[216:219],a[184:187]
ds_read_b128 a[232:235],v249 offset:512
v_accvgpr_read_b32 v238,a16
M a[184:187],v[228:231],a[196:199],a[184:187]
v_accvgpr_read_b32 v232,a112
v_add_f32 v234,v238,v232
M a[188:191],v[228:231],a[240:243],a[188:191]
buffer_load_dwordx4 v[220:223],v250,s[20:23],s46 offen offset:0 sc1
M a[188:191],a[252:255],a[196:199],a[188:191]
v_sub_f32 v238,v238,v232
v_add_f32 v232,v16,v112
M a[188:191],a[204:207],v[216:219],a[188:191]
s_waitcnt vmcnt(15) lgkmcnt(4)
v_sub_f32 v112,v16,v112
M v[32:35],a[200:203],a[108:111],v[32:35]
s_waitcnt vmcnt(14) lgkmcnt(2)
s_barrier
ds_read_b128 a[8:11],v250 offset:43520
M v[32:35],a[192:195],a[224:227],v[32:35]
s_waitcnt vmcnt(13) lgkmcnt(2)
ds_read_b128 a[12:15],v250 offset:47616
ds_read_b128 a[240:243],v248 offset:1024
M v[32:35],a[208:211],a[216:219],v[32:35]
s_waitcnt lgkmcnt(3)
buffer_load_dwordx4 a[212:215],v250,s[20:23],s46 offen offset:1024 sc1
M v[36:39],a[208:211],a[232:235],v[36:39]
ds_read_b128 v[228:231],v249 offset:1024
v_add_f32 v16,v234,v232
M v[36:39],a[192:195],a[216:219],v[36:39]
v_fmac_f32 v234,4.0,v232
v_fma_f32 v232,2.0,v112,v238
M v[36:39],a[200:203],a[224:227],v[36:39]
v_fma_f32 v112,s40,v112,v238
v_accvgpr_read_b32 v238,a17
M v[40:43],a[200:203],a[216:219],v[40:43]
ds_read_b128 a[196:199],v248 offset:1536
v_accvgpr_read_b32 v237,a113
M v[40:43],a[192:195],a[232:235],v[40:43]
s_waitcnt lgkmcnt(2)
ds_read_b128 a[252:255],v249 offset:1536
v_add_f32 v236,v238,v237
M v[40:43],a[208:211],a[240:243],v[40:43]
s_waitcnt lgkmcnt(2)
v_sub_f32 v238,v238,v237
v_add_f32 v237,v17,v113
M v[44:47],a[208:211],v[228:231],v[44:47]
v_sub_f32 v113,v17,v113
v_add_f32 v17,v236,v237
M v[44:47],a[192:195],a[240:243],v[44:47]
v_fmac_f32 v236,4.0,v237
v_fma_f32 v237,2.0,v113,v238
M v[44:47],a[200:203],a[232:235],v[44:47]
v_fma_f32 v113,s40,v113,v238
v_cvt_pk_bf16_f32 v232,v232,v237
M v[48:51],a[200:203],a[240:243],v[48:51]
ds_read_b128 a[204:207],v249 offset:2048
v_cvt_pk_bf16_f32 v234,v234,v236
M v[48:51],a[192:195],v[228:231],v[48:51]
s_waitcnt lgkmcnt(2)
ds_read_b128 v[216:219],v248 offset:2048
v_accvgpr_read_b32 v238,a18
M v[48:51],a[208:211],a[196:199],v[48:51]
s_waitcnt lgkmcnt(2)
v_accvgpr_read_b32 v233,a114
v_add_f32 v235,v238,v233
M v[52:55],a[208:211],a[252:255],v[52:55]
v_sub_f32 v238,v238,v233
v_add_f32 v233,v18,v114
M v[52:55],a[192:195],a[196:199],v[52:55]
v_sub_f32 v114,v18,v114
v_add_f32 v18,v235,v233
M v[52:55],a[200:203],v[228:231],v[52:55]
v_fmac_f32 v235,4.0,v233
v_fma_f32 v233,2.0,v114,v238
M v[56:59],a[200:203],a[196:199],v[56:59]
v_fma_f32 v114,s40,v114,v238
v_accvgpr_read_b32 v238,a19
M v[56:59],a[192:195],a[252:255],v[56:59]
s_waitcnt lgkmcnt(1)
v_accvgpr_read_b32 v237,a115
v_add_f32 v236,v238,v237
M v[56:59],a[208:211],a[204:207],v[56:59]
s_waitcnt lgkmcnt(0)
v_sub_f32 v238,v238,v237
v_add_f32 v237,v19,v115
M v[60:63],a[208:211],v[216:219],v[60:63]
buffer_load_dwordx4 a[112:115],v250,s[20:23],s46 offen offset:2048 sc1
M v[60:63],a[192:195],a[204:207],v[60:63]
s_add_u32 s46,s73,0
v_sub_f32 v115,v19,v115
v_add_f32 v19,v236,v237
M v[60:63],a[200:203],a[252:255],v[60:63]
s_waitcnt vmcnt(14)
buffer_load_dwordx4 a[208:211],v250,s[20:23],s46 offen offset:0 sc1
M v[64:67],a[236:239],a[108:111],v[64:67]
s_waitcnt vmcnt(14)
v_fmac_f32 v236,4.0,v237
v_fma_f32 v237,2.0,v115,v238
M v[64:67],a[228:231],a[224:227],v[64:67]
s_waitcnt vmcnt(11)
v_fma_f32 v115,s40,v115,v238
v_cvt_pk_bf16_f32 v233,v233,v237
M v[64:67],v[224:227],a[216:219],v[64:67]
v_cvt_pk_bf16_f32 v235,v235,v236
M v[68:71],v[224:227],a[232:235],v[68:71]
buffer_load_dwordx4 a[192:195],v250,s[20:23],s46 offen offset:1024 sc1
M v[68:71],a[228:231],a[216:219],v[68:71]
ds_write2st64_b64 v254,v[232:233],v[234:235] offset0:68 offset1:72
M v[68:71],a[236:239],a[224:227],v[68:71]
v_accvgpr_read_b32 v238,a20
v_accvgpr_read_b32 v232,a116
M v[72:75],a[236:239],a[216:219],v[72:75]
v_add_f32 v234,v238,v232
v_sub_f32 v238,v238,v232
M v[72:75],a[228:231],a[232:235],v[72:75]
buffer_load_dwordx4 a[108:111],v250,s[20:23],s46 offen offset:2048 sc1
M v[72:75],v[224:227],a[240:243],v[72:75]
s_add_u32 s31,s66,7471104
v_add_f32 v232,v20,v116
v_sub_f32 v116,v20,v116
M v[76:79],v[224:227],v[228:231],v[76:79]
v_add_f32 v20,v234,v232
v_fmac_f32 v234,4.0,v232
M v[76:79],a[228:231],a[240:243],v[76:79]
v_fma_f32 v232,2.0,v116,v238
v_fma_f32 v116,s40,v116,v238
M v[76:79],a[236:239],a[232:235],v[76:79]
buffer_load_dword a200,v255,s[8:11],s31 offen offset:0
M v[80:83],a[236:239],a[240:243],v[80:83]
v_accvgpr_read_b32 v238,a21
v_accvgpr_read_b32 v237,a117
M v[80:83],a[228:231],v[228:231],v[80:83]
v_add_f32 v236,v238,v237
v_sub_f32 v238,v238,v237
M v[80:83],v[224:227],a[196:199],v[80:83]
v_add_f32 v237,v21,v117
v_sub_f32 v117,v21,v117
M v[84:87],v[224:227],a[252:255],v[84:87]
buffer_load_dword a200,v255,s[8:11],s31 offen offset:384
M v[84:87],a[228:231],a[196:199],v[84:87]
ds_read_b128 a[224:227],v248 offset:8704
v_add_f32 v21,v236,v237
M v[84:87],a[236:239],v[228:231],v[84:87]
ds_read_b128 a[216:219],v249 offset:8704
v_fmac_f32 v236,4.0,v237
M v[88:91],a[236:239],a[196:199],v[88:91]
ds_read_b128 a[232:235],v248 offset:9216
v_fma_f32 v237,2.0,v117,v238
M v[88:91],a[228:231],a[252:255],v[88:91]
ds_read_b128 a[240:243],v249 offset:9216
v_fma_f32 v117,s40,v117,v238
M v[88:91],v[224:227],a[204:207],v[88:91]
v_cvt_pk_bf16_f32 v232,v232,v237
v_cvt_pk_bf16_f32 v234,v234,v236
M v[92:95],v[224:227],v[216:219],v[92:95]
v_accvgpr_read_b32 v238,a22
v_accvgpr_read_b32 v233,a118
M v[92:95],a[228:231],a[204:207],v[92:95]
v_add_f32 v235,v238,v233
v_sub_f32 v238,v238,v233
M v[92:95],a[236:239],a[252:255],v[92:95]
s_waitcnt vmcnt(13) lgkmcnt(3)
v_add_f32 v233,v22,v118
v_sub_f32 v118,v22,v118
M v[128:131],a[244:247],a[224:227],v[128:131]
s_waitcnt vmcnt(12) lgkmcnt(2)
ds_read_b128 v[228:231],v248 offset:9728
v_add_f32 v22,v235,v233
M v[128:131],a[100:103],a[216:219],v[128:131]
s_waitcnt vmcnt(11) lgkmcnt(2)
ds_read_b128 a[196:199],v249 offset:9728
v_fmac_f32 v235,4.0,v233
M v[128:131],a[104:107],a[232:235],v[128:131]
s_waitcnt lgkmcnt(2)
v_fma_f32 v233,2.0,v118,v238
v_fma_f32 v118,s40,v118,v238
M v[132:135],a[104:107],a[240:243],v[132:135]
v_accvgpr_read_b32 v238,a23
v_accvgpr_read_b32 v237,a119
M v[132:135],a[100:103],a[232:235],v[132:135]
v_add_f32 v236,v238,v237
v_sub_f32 v238,v238,v237
M v[132:135],a[244:247],a[216:219],v[132:135]
s_add_u32 s46,s74,0
v_add_f32 v237,v23,v119
v_sub_f32 v119,v23,v119
M v[136:139],a[244:247],a[232:235],v[136:139]
ds_read_b128 a[116:119],v248 offset:10240
v_add_f32 v23,v236,v237
M v[136:139],a[100:103],a[240:243],v[136:139]
s_waitcnt lgkmcnt(2)
ds_read_b128 v[216:219],v249 offset:10240
v_fmac_f32 v236,4.0,v237
M v[136:139],a[104:107],v[228:231],v[136:139]
s_waitcnt lgkmcnt(2)
v_fma_f32 v237,2.0,v119,v238
v_fma_f32 v119,s40,v119,v238
M v[140:143],a[104:107],a[196:199],v[140:143]
v_cvt_pk_bf16_f32 v233,v233,v237
v_cvt_pk_bf16_f32 v235,v235,v236
M v[140:143],a[100:103],v[228:231],v[140:143]
ds_write2st64_b64 v254,v[232:233],v[234:235] offset0:76 offset1:80
M v[140:143],a[244:247],a[240:243],v[140:143]
buffer_load_dwordx4 a[200:203],v250,s[20:23],s46 offen offset:0 sc1
M v[144:147],a[244:247],v[228:231],v[144:147]
ds_read_b128 a[228:231],v249 offset:10752
v_accvgpr_read_b32 v238,a24
M v[144:147],a[100:103],a[196:199],v[144:147]
s_waitcnt lgkmcnt(3)
buffer_load_dwordx4 v[224:227],v250,s[20:23],s46 offen offset:1024 sc1
M v[144:147],a[104:107],a[116:119],v[144:147]
s_waitcnt lgkmcnt(2)
ds_read_b128 a[236:239],v248 offset:10752
v_accvgpr_read_b32 v232,a120
M v[148:151],a[104:107],v[216:219],v[148:151]
v_add_f32 v234,v238,v232
v_sub_f32 v238,v238,v232
M v[148:151],a[100:103],a[116:119],v[148:151]
v_add_f32 v232,v24,v120
v_sub_f32 v120,v24,v120
M v[148:151],a[244:247],a[196:199],v[148:151]
s_waitcnt lgkmcnt(2)
s_barrier
ds_read_b128 a[16:19],v250 offset:34816
M v[152:155],a[244:247],a[116:119],v[152:155]
buffer_load_dwordx4 a[204:207],v250,s[20:23],s46 offen offset:2048 sc1
M v[152:155],a[100:103],v[216:219],v[152:155]
s_waitcnt lgkmcnt(2)
s_add_u32 s46,s75,0
ds_read_b128 a[20:23],v250 offset:38912
v_add_f32 v24,v234,v232
M v[152:155],a[104:107],a[228:231],v[152:155]
s_waitcnt lgkmcnt(2)
v_fmac_f32 v234,4.0,v232
v_fma_f32 v232,2.0,v120,v238
M v[156:159],a[104:107],a[236:239],v[156:159]
buffer_load_dwordx4 a[252:255],v250,s[20:23],s46 offen offset:0 sc1
M v[156:159],a[100:103],a[228:231],v[156:159]
v_fma_f32 v120,s40,v120,v238
v_accvgpr_read_b32 v238,a25
M v[156:159],a[244:247],v[216:219],v[156:159]
s_waitcnt vmcnt(14)
v_accvgpr_read_b32 v237,a121
v_add_f32 v236,v238,v237
M v[160:163],a[220:223],a[224:227],v[160:163]
s_waitcnt vmcnt(13)
v_sub_f32 v238,v238,v237
v_add_f32 v237,v25,v121
M v[160:163],a[248:251],a[216:219],v[160:163]
s_waitcnt vmcnt(12)
buffer_load_dwordx4 a[104:107],v250,s[20:23],s46 offen offset:1024 sc1
M v[160:163],a[96:99],a[232:235],v[160:163]
v_sub_f32 v121,v25,v121
v_add_f32 v25,v236,v237
M v[164:167],a[96:99],a[240:243],v[164:167]
v_fmac_f32 v236,4.0,v237
v_fma_f32 v237,2.0,v121,v238
M v[164:167],a[248:251],a[232:235],v[164:167]
v_fma_f32 v121,s40,v121,v238
v_cvt_pk_bf16_f32 v232,v232,v237
M v[164:167],a[220:223],a[216:219],v[164:167]
buffer_load_dwordx4 a[100:103],v250,s[20:23],s46 offen offset:2048 sc1
M v[168:171],a[220:223],a[232:235],v[168:171]
s_add_u32 s46,s76,0
v_cvt_pk_bf16_f32 v234,v234,v236
v_accvgpr_read_b32 v238,a26
M v[168:171],a[248:251],a[240:243],v[168:171]
v_accvgpr_read_b32 v233,a122
v_add_f32 v235,v238,v233
M v[168:171],a[96:99],v[228:231],v[168:171]
s_waitcnt lgkmcnt(0)
s_barrier
v_sub_f32 v238,v238,v233
M v[172:175],a[96:99],a[196:199],v[172:175]
buffer_load_dwordx4 a[244:247],v250,s[20:23],s46 offen offset:0 sc1
M v[172:175],a[248:251],v[228:231],v[172:175]
v_add_f32 v233,v26,v122
v_sub_f32 v122,v26,v122
M v[172:175],a[220:223],a[240:243],v[172:175]
v_add_f32 v26,v235,v233
v_fmac_f32 v235,4.0,v233
M v[176:179],a[220:223],v[228:231],v[176:179]
v_fma_f32 v233,2.0,v122,v238
v_fma_f32 v122,s40,v122,v238
M v[176:179],a[248:251],a[196:199],v[176:179]
buffer_load_dwordx4 a[224:227],v250,s[20:23],s46 offen offset:1024 sc1
M v[176:179],a[96:99],a[116:119],v[176:179]
v_add_u32 v248,0xffffbc00,v248
v_add_u32 v249,0xffffbc00,v249
M v[180:183],a[96:99],v[216:219],v[180:183]
v_accvgpr_read_b32 v238,a27
v_accvgpr_read_b32 v237,a123
M v[180:183],a[248:251],a[116:119],v[180:183]
ds_read_b128 a[240:243],v248 offset:0
v_add_f32 v236,v238,v237
M v[180:183],a[220:223],a[196:199],v[180:183]
buffer_load_dwordx4 a[216:219],v250,s[20:23],s46 offen offset:2048 sc1
M v[184:187],a[220:223],a[116:119],v[184:187]
s_add_u32 s46,s77,0
ds_read_b128 v[228:231],v249 offset:0
ds_read_b128 a[116:119],v248 offset:512
M v[184:187],a[248:251],v[216:219],v[184:187]
ds_read_b128 a[120:123],v249 offset:512
v_sub_f32 v238,v238,v237
M v[184:187],a[96:99],a[228:231],v[184:187]
v_add_f32 v237,v27,v123
v_sub_f32 v123,v27,v123
M v[188:191],a[96:99],a[236:239],v[188:191]
buffer_load_dwordx4 a[232:235],v250,s[20:23],s46 offen offset:0 sc1
M v[188:191],a[248:251],a[228:231],v[188:191]
v_add_f32 v27,v236,v237
v_fmac_f32 v236,4.0,v237
M v[188:191],a[220:223],v[216:219],v[188:191]
s_waitcnt vmcnt(17) lgkmcnt(3)
v_fma_f32 v237,2.0,v123,v238
v_fma_f32 v123,s40,v123,v238
M v[0:3],v[220:223],a[240:243],v[0:3]
s_waitcnt vmcnt(16) lgkmcnt(2)
ds_read_b128 a[248:251],v248 offset:1024
v_cvt_pk_bf16_f32 v233,v233,v237
M v[0:3],a[212:215],v[228:231],v[0:3]
s_waitcnt vmcnt(15) lgkmcnt(2)
buffer_load_dwordx4 a[96:99],v250,s[20:23],s46 offen offset:1024 sc1
M v[0:3],a[112:115],a[116:119],v[0:3]
s_waitcnt lgkmcnt(1)
ds_read_b128 a[220:223],v249 offset:1024
v_cvt_pk_bf16_f32 v235,v235,v236
M v[4:7],a[112:115],a[120:123],v[4:7]
ds_write2st64_b64 v254,v[232:233],v[234:235] offset0:85 offset1:89
M v[4:7],a[212:215],a[116:119],v[4:7]
v_accvgpr_read_b32 v204,a28
v_accvgpr_read_b32 v208,a124
M v[4:7],v[220:223],v[228:231],v[4:7]
buffer_load_dwordx4 a[196:199],v250,s[20:23],s46 offen offset:2048 sc1
M v[8:11],v[220:223],a[116:119],v[8:11]
s_add_u32 s46,s72,46080
ds_read_b128 a[116:119],v248 offset:1536
v_accvgpr_read_b32 v205,a29
M v[8:11],a[212:215],a[120:123],v[8:11]
s_waitcnt lgkmcnt(3)
ds_read_b128 v[216:219],v249 offset:1536
v_accvgpr_read_b32 v209,a125
M v[8:11],a[112:115],a[248:251],v[8:11]
s_waitcnt lgkmcnt(3)
v_accvgpr_read_b32 v206,a30
v_accvgpr_read_b32 v210,a126
v_accvgpr_read_b32 v207,a31
v_accvgpr_read_b32 v211,a127
v_pk_add_f32 v[212:213],v[204:205],v[208:209]
v_pk_add_f32 v[214:215],v[206:207],v[210:211]
v_pk_add_f32 v[204:205],v[204:205],v[208:209] neg_lo:[0,1] neg_hi:[0,1]
v_pk_add_f32 v[206:207],v[206:207],v[210:211] neg_lo:[0,1] neg_hi:[0,1]
v_pk_add_f32 v[208:209],v[28:29],v[124:125]
v_pk_add_f32 v[210:211],v[30:31],v[126:127]
v_pk_add_f32 v[124:125],v[28:29],v[124:125] neg_lo:[0,1] neg_hi:[0,1]
v_pk_add_f32 v[126:127],v[30:31],v[126:127] neg_lo:[0,1] neg_hi:[0,1]
v_pk_add_f32 v[28:29],v[212:213],v[208:209]
v_pk_add_f32 v[30:31],v[214:215],v[210:211]
v_pk_fma_f32 v[212:213],v[208:209],4.0,v[212:213] op_sel_hi:[1,0,1]
v_pk_fma_f32 v[214:215],v[210:211],4.0,v[214:215] op_sel_hi:[1,0,1]
v_pk_fma_f32 v[208:209],v[124:125],2.0,v[204:205] op_sel_hi:[1,0,1]
v_pk_fma_f32 v[210:211],v[126:127],2.0,v[206:207] op_sel_hi:[1,0,1]
v_pk_fma_f32 v[124:125],v[124:125],s[40:41],v[204:205] op_sel_hi:[1,0,1]
v_pk_fma_f32 v[126:127],v[126:127],s[40:41],v[206:207] op_sel_hi:[1,0,1]
M v[12:15],a[112:115],a[220:223],v[12:15]
buffer_load_dwordx4 a[236:239],v250,s[20:23],s46 offen offset:0 sc1
M v[12:15],a[212:215],a[248:251],v[12:15]
v_cvt_pk_bf16_f32 v208,v208,v209
v_cvt_pk_bf16_f32 v209,v210,v211
M v[12:15],v[220:223],a[120:123],v[12:15]
buffer_load_dwordx4 a[228:231],v250,s[20:23],s46 offen offset:1024 sc1
M v[16:19],v[220:223],a[248:251],v[16:19]
ds_read_b128 a[120:123],v249 offset:2048
v_cvt_pk_bf16_f32 v212,v212,v213
M v[16:19],a[212:215],a[220:223],v[16:19]
s_waitcnt lgkmcnt(2)
ds_read_b128 a[124:127],v248 offset:2048
v_add_u32 v248,0x15400,v248
M v[16:19],a[112:115],a[116:119],v[16:19]
s_waitcnt lgkmcnt(2)
v_add_u32 v249,0x15400,v249
v_cvt_pk_bf16_f32 v213,v214,v215
M v[20:23],a[112:115],v[216:219],v[20:23]
ds_write2st64_b64 v254,v[208:209],v[212:213] offset0:93 offset1:97
M v[20:23],a[212:215],a[116:119],v[20:23]
ds_read_b128 a[240:243],v248 offset:0
v_accvgpr_read_b32 v238,a32
M v[20:23],v[220:223],a[220:223],v[20:23]
ds_read_b128 v[228:231],v249 offset:0
v_accvgpr_read_b32 v232,a128
M v[24:27],v[220:223],a[116:119],v[24:27]
ds_read_b128 a[116:119],v248 offset:512
v_add_f32 v234,v238,v232
M v[24:27],a[212:215],v[216:219],v[24:27]
s_waitcnt lgkmcnt(5)
ds_read_b128 a[248:251],v249 offset:512
v_sub_f32 v238,v238,v232
M v[24:27],a[112:115],a[120:123],v[24:27]
s_waitcnt lgkmcnt(5)
buffer_load_dwordx4 a[220:223],v250,s[20:23],s46 offen offset:2048 sc1
M v[28:31],a[112:115],a[124:127],v[28:31]
s_add_u32 s47,s72,49152
v_add_f32 v232,v32,v128
v_sub_f32 v128,v32,v128
M v[28:31],a[212:215],a[120:123],v[28:31]
s_waitcnt lgkmcnt(4)
s_barrier
ds_read_b128 a[24:27],v250 offset:43520
M v[28:31],v[220:223],v[216:219],v[28:31]
s_waitcnt vmcnt(19) lgkmcnt(4)
ds_read_b128 a[28:31],v250 offset:47616
v_add_f32 v32,v234,v232
M v[0:3],a[208:211],a[240:243],v[0:3]
s_waitcnt vmcnt(18) lgkmcnt(4)
buffer_load_dwordx4 a[112:115],v250,s[20:23],s47 offen offset:0 sc1
M v[0:3],a[192:195],v[228:231],v[0:3]
s_waitcnt vmcnt(18) lgkmcnt(3)
ds_read_b128 a[212:215],v248 offset:1024
ds_read_b128 v[216:219],v249 offset:1024
M v[0:3],a[108:111],a[116:119],v[0:3]
s_waitcnt lgkmcnt(4)
buffer_load_dwordx4 a[124:127],v250,s[20:23],s47 offen offset:1024 sc1
M v[4:7],a[108:111],a[248:251],v[4:7]
v_fmac_f32 v234,4.0,v232
v_fma_f32 v232,2.0,v128,v238
M v[4:7],a[192:195],a[116:119],v[4:7]
v_fma_f32 v128,s40,v128,v238
v_accvgpr_read_b32 v238,a33
M v[4:7],a[208:211],v[228:231],v[4:7]
v_accvgpr_read_b32 v237,a129
v_add_f32 v236,v238,v237
M v[8:11],a[208:211],a[116:119],v[8:11]
buffer_load_dwordx4 a[120:123],v250,s[20:23],s47 offen offset:2048 sc1
M v[8:11],a[192:195],a[248:251],v[8:11]
s_waitcnt lgkmcnt(1)
ds_read_b128 a[116:119],v248 offset:1536
ds_read_b128 v[220:223],v249 offset:1536
M v[8:11],a[108:111],a[212:215],v[8:11]
s_waitcnt lgkmcnt(2)
s_add_u32 s34,s32,0
v_sub_f32 v238,v238,v237
v_add_f32 v237,v33,v129
M v[12:15],a[108:111],v[216:219],v[12:15]
v_sub_f32 v129,v33,v129
v_add_f32 v33,v236,v237
M v[12:15],a[192:195],a[212:215],v[12:15]
v_fmac_f32 v236,4.0,v237
v_fma_f32 v237,2.0,v129,v238
M v[12:15],a[208:211],a[248:251],v[12:15]
buffer_store_dwordx4 a[0:3],v253,s[24:27],s34 offen offset:384 nt
M v[16:19],a[208:211],a[212:215],v[16:19]
ds_read_b128 a[240:243],v249 offset:2048
v_fma_f32 v129,s40,v129,v238
M v[16:19],a[192:195],v[216:219],v[16:19]
s_waitcnt lgkmcnt(2)
ds_read_b128 v[228:231],v248 offset:2048
v_cvt_pk_bf16_f32 v232,v232,v237
M v[16:19],a[108:111],a[116:119],v[16:19]
s_waitcnt lgkmcnt(2)
v_cvt_pk_bf16_f32 v234,v234,v236
v_accvgpr_read_b32 v238,a34
M v[20:23],a[108:111],v[220:223],v[20:23]
s_add_u32 s46,s73,46080
v_accvgpr_read_b32 v233,a130
v_add_f32 v235,v238,v233
M v[20:23],a[192:195],a[116:119],v[20:23]
ds_read_b128 a[248:251],v248 offset:17408
v_sub_f32 v238,v238,v233
M v[20:23],a[208:211],v[216:219],v[20:23]
ds_read_b128 a[212:215],v249 offset:17408
v_add_f32 v233,v34,v130
M v[24:27],a[208:211],a[116:119],v[24:27]
ds_read_b128 a[116:119],v248 offset:17920
v_sub_f32 v130,v34,v130
M v[24:27],a[192:195],v[220:223],v[24:27]
s_waitcnt lgkmcnt(4)
ds_read_b128 v[216:219],v249 offset:17920
v_add_f32 v34,v235,v233
M v[24:27],a[108:111],a[240:243],v[24:27]
s_waitcnt lgkmcnt(4)
v_fmac_f32 v235,4.0,v233
v_fma_f32 v233,2.0,v130,v238
M v[28:31],a[108:111],v[228:231],v[28:31]
buffer_load_dwordx4 a[108:111],v250,s[20:23],s46 offen offset:0 sc1
M v[28:31],a[192:195],a[240:243],v[28:31]
v_fma_f32 v130,s40,v130,v238
v_accvgpr_read_b32 v238,a35
M v[28:31],a[208:211],v[220:223],v[28:31]
s_waitcnt vmcnt(19) lgkmcnt(3)
buffer_load_dwordx4 v[228:231],v250,s[20:23],s46 offen offset:1024 sc1
M v[0:3],a[200:203],a[248:251],v[0:3]
s_waitcnt vmcnt(19) lgkmcnt(2)
v_accvgpr_read_b32 v237,a131
v_add_f32 v236,v238,v237
M v[0:3],v[224:227],a[212:215],v[0:3]
s_waitcnt vmcnt(18) lgkmcnt(1)
ds_read_b128 a[128:131],v248 offset:18432
ds_read_b128 a[240:243],v249 offset:18432
M v[0:3],a[204:207],a[116:119],v[0:3]
s_waitcnt lgkmcnt(2)
s_add_u32 s34,s32,196608
v_sub_f32 v238,v238,v237
v_add_f32 v237,v35,v131
M v[4:7],a[204:207],v[216:219],v[4:7]
buffer_load_dwordx4 a[192:195],v250,s[20:23],s46 offen offset:2048 sc1
M v[4:7],v[224:227],a[116:119],v[4:7]
v_sub_f32 v131,v35,v131
v_add_f32 v35,v236,v237
M v[4:7],a[200:203],a[212:215],v[4:7]
v_fmac_f32 v236,4.0,v237
v_fma_f32 v237,2.0,v131,v238
M v[8:11],a[200:203],a[116:119],v[8:11]
ds_read_b128 a[116:119],v248 offset:18944
v_fma_f32 v131,s40,v131,v238
M v[8:11],v[224:227],v[216:219],v[8:11]
s_waitcnt lgkmcnt(2)
ds_read_b128 a[208:211],v249 offset:18944
v_cvt_pk_bf16_f32 v233,v233,v237
M v[8:11],a[204:207],a[128:131],v[8:11]
s_waitcnt lgkmcnt(2)
buffer_store_dwordx4 a[4:7],v253,s[24:27],s34 offen offset:384 nt
M v[12:15],a[204:207],a[240:243],v[12:15]
v_cvt_pk_bf16_f32 v235,v235,v236
M v[12:15],v[224:227],a[128:131],v[12:15]
ds_write2st64_b64 v254,v[232:233],v[234:235] offset0:34 offset1:38
M v[12:15],a[200:203],v[216:219],v[12:15]
v_accvgpr_read_b32 v204,a36
v_accvgpr_read_b32 v208,a132
M v[16:19],a[200:203],a[128:131],v[16:19]
s_add_u32 s47,s73,49152
ds_read_b128 a[128:131],v249 offset:19456
v_accvgpr_read_b32 v205,a37
M v[16:19],v[224:227],a[240:243],v[16:19]
s_waitcnt lgkmcnt(3)
ds_read_b128 v[220:223],v248 offset:19456
v_accvgpr_read_b32 v209,a133
M v[16:19],a[204:207],a[116:119],v[16:19]
s_waitcnt lgkmcnt(3)
v_accvgpr_read_b32 v206,a38
v_accvgpr_read_b32 v210,a134
v_accvgpr_read_b32 v207,a39
v_accvgpr_read_b32 v211,a135
v_pk_add_f32 v[212:213],v[204:205],v[208:209]
v_pk_add_f32 v[214:215],v[206:207],v[210:211]
v_pk_add_f32 v[204:205],v[204:205],v[208:209] neg_lo:[0,1] neg_hi:[0,1]
v_pk_add_f32 v[206:207],v[206:207],v[210:211] neg_lo:[0,1] neg_hi:[0,1]
v_pk_add_f32 v[208:209],v[36:37],v[132:133]
v_pk_add_f32 v[210:211],v[38:39],v[134:135]
v_pk_add_f32 v[132:133],v[36:37],v[132:133] neg_lo:[0,1] neg_hi:[0,1]
v_pk_add_f32 v[134:135],v[38:39],v[134:135] neg_lo:[0,1] neg_hi:[0,1]
v_pk_add_f32 v[36:37],v[212:213],v[208:209]
v_pk_add_f32 v[38:39],v[214:215],v[210:211]
v_pk_fma_f32 v[212:213],v[208:209],4.0,v[212:213] op_sel_hi:[1,0,1]
v_pk_fma_f32 v[214:215],v[210:211],4.0,v[214:215] op_sel_hi:[1,0,1]
v_pk_fma_f32 v[208:209],v[132:133],2.0,v[204:205] op_sel_hi:[1,0,1]
v_pk_fma_f32 v[210:211],v[134:135],2.0,v[206:207] op_sel_hi:[1,0,1]
v_pk_fma_f32 v[132:133],v[132:133],s[40:41],v[204:205] op_sel_hi:[1,0,1]
v_pk_fma_f32 v[134:135],v[134:135],s[40:41],v[206:207] op_sel_hi:[1,0,1]
M v[20:23],a[204:207],a[208:211],v[20:23]
v_cvt_pk_bf16_f32 v208,v208,v209
v_cvt_pk_bf16_f32 v209,v210,v211
M v[20:23],v[224:227],a[116:119],v[20:23]
ds_read_b128 a[132:135],v248 offset:34816
v_cvt_pk_bf16_f32 v212,v212,v213
M v[20:23],a[200:203],a[240:243],v[20:23]
ds_read_b128 a[248:251],v249 offset:34816
v_cvt_pk_bf16_f32 v213,v214,v215
M v[24:27],a[200:203],a[116:119],v[24:27]
buffer_load_dwordx4 a[116:119],v250,s[20:23],s47 offen offset:0 sc1
M v[24:27],v[224:227],a[208:211],v[24:27]
s_waitcnt lgkmcnt(3)
ds_read_b128 a[212:215],v248 offset:35328
ds_read_b128 v[216:219],v249 offset:35328
M v[24:27],a[204:207],a[128:131],v[24:27]
s_waitcnt lgkmcnt(4)
s_add_u32 s34,s32,393216
buffer_store_dwordx4 a[8:11],v253,s[24:27],s34 offen offset:384 nt
M v[28:31],a[204:207],v[220:223],v[28:31]
ds_write2st64_b64 v254,v[208:209],v[212:213] offset0:42 offset1:46
M v[28:31],v[224:227],a[128:131],v[28:31]
v_accvgpr_read_b32 v204,a40
v_accvgpr_read_b32 v208,a136
M v[28:31],a[200:203],a[208:211],v[28:31]
s_waitcnt vmcnt(21) lgkmcnt(4)
buffer_load_dwordx4 a[240:243],v250,s[20:23],s47 offen offset:1024 sc1
M v[0:3],a[252:255],a[132:135],v[0:3]
s_waitcnt vmcnt(21) lgkmcnt(3)
ds_read_b128 a[128:131],v248 offset:35840
v_accvgpr_read_b32 v205,a41
M v[0:3],a[104:107],a[248:251],v[0:3]
s_waitcnt vmcnt(20) lgkmcnt(3)
ds_read_b128 a[132:135],v249 offset:35840
v_accvgpr_read_b32 v209,a137
M v[0:3],a[100:103],a[212:215],v[0:3]
s_waitcnt lgkmcnt(3)
v_accvgpr_read_b32 v206,a42
v_accvgpr_read_b32 v210,a138
v_accvgpr_read_b32 v207,a43
v_accvgpr_read_b32 v211,a139
v_pk_add_f32 v[212:213],v[204:205],v[208:209]
v_pk_add_f32 v[214:215],v[206:207],v[210:211]
v_pk_add_f32 v[204:205],v[204:205],v[208:209] neg_lo:[0,1] neg_hi:[0,1]
v_pk_add_f32 v[206:207],v[206:207],v[210:211] neg_lo:[0,1] neg_hi:[0,1]
v_pk_add_f32 v[208:209],v[40:41],v[136:137]
v_pk_add_f32 v[210:211],v[42:43],v[138:139]
v_pk_add_f32 v[136:137],v[40:41],v[136:137] neg_lo:[0,1] neg_hi:[0,1]
v_pk_add_f32 v[138:139],v[42:43],v[138:139] neg_lo:[0,1] neg_hi:[0,1]
v_pk_add_f32 v[40:41],v[212:213],v[208:209]
v_pk_add_f32 v[42:43],v[214:215],v[210:211]
v_pk_fma_f32 v[212:213],v[208:209],4.0,v[212:213] op_sel_hi:[1,0,1]
v_pk_fma_f32 v[214:215],v[210:211],4.0,v[214:215] op_sel_hi:[1,0,1]
v_pk_fma_f32 v[208:209],v[136:137],2.0,v[204:205] op_sel_hi:[1,0,1]
v_pk_fma_f32 v[210:211],v[138:139],2.0,v[206:207] op_sel_hi:[1,0,1]
v_pk_fma_f32 v[136:137],v[136:137],s[40:41],v[204:205] op_sel_hi:[1,0,1]
v_pk_fma_f32 v[138:139],v[138:139],s[40:41],v[206:207] op_sel_hi:[1,0,1]
M v[4:7],a[100:103],v[216:219],v[4:7]
buffer_load_dwordx4 a[204:207],v250,s[20:23],s47 offen offset:2048 sc1
M v[4:7],a[104:107],a[212:215],v[4:7]
v_cvt_pk_bf16_f32 v208,v208,v209
v_cvt_pk_bf16_f32 v209,v210,v211
M v[4:7],a[252:255],a[248:251],v[4:7]
v_cvt_pk_bf16_f32 v212,v212,v213
v_cvt_pk_bf16_f32 v213,v214,v215
M v[8:11],a[252:255],a[212:215],v[8:11]
ds_read_b128 a[136:139],v248 offset:36352
ds_write2st64_b64 v254,v[208:209],v[212:213] offset0:51 offset1:55
M v[8:11],a[104:107],v[216:219],v[8:11]
s_waitcnt lgkmcnt(3)
ds_read_b128 v[220:223],v249 offset:36352
v_accvgpr_read_b32 v204,a44
M v[8:11],a[100:103],a[128:131],v[8:11]
s_waitcnt lgkmcnt(3)
v_accvgpr_read_b32 v208,a140
v_accvgpr_read_b32 v205,a45
M v[12:15],a[100:103],a[132:135],v[12:15]
v_accvgpr_read_b32 v209,a141
v_accvgpr_read_b32 v206,a46
M v[12:15],a[104:107],a[128:131],v[12:15]
v_accvgpr_read_b32 v210,a142
v_accvgpr_read_b32 v207,a47
v_accvgpr_read_b32 v211,a143
v_pk_add_f32 v[212:213],v[204:205],v[208:209]
v_pk_add_f32 v[214:215],v[206:207],v[210:211]
v_pk_add_f32 v[204:205],v[204:205],v[208:209] neg_lo:[0,1] neg_hi:[0,1]
v_pk_add_f32 v[206:207],v[206:207],v[210:211] neg_lo:[0,1] neg_hi:[0,1]
v_pk_add_f32 v[208:209],v[44:45],v[140:141]
v_pk_add_f32 v[210:211],v[46:47],v[142:143]
v_pk_add_f32 v[140:141],v[44:45],v[140:141] neg_lo:[0,1] neg_hi:[0,1]
v_pk_add_f32 v[142:143],v[46:47],v[142:143] neg_lo:[0,1] neg_hi:[0,1]
v_pk_add_f32 v[44:45],v[212:213],v[208:209]
v_pk_add_f32 v[46:47],v[214:215],v[210:211]
v_pk_fma_f32 v[212:213],v[208:209],4.0,v[212:213] op_sel_hi:[1,0,1]
v_pk_fma_f32 v[214:215],v[210:211],4.0,v[214:215] op_sel_hi:[1,0,1]
v_pk_fma_f32 v[208:209],v[140:141],2.0,v[204:205] op_sel_hi:[1,0,1]
v_pk_fma_f32 v[210:211],v[142:143],2.0,v[206:207] op_sel_hi:[1,0,1]
v_pk_fma_f32 v[140:141],v[140:141],s[40:41],v[204:205] op_sel_hi:[1,0,1]
v_pk_fma_f32 v[142:143],v[142:143],s[40:41],v[206:207] op_sel_hi:[1,0,1]
M v[12:15],a[252:255],v[216:219],v[12:15]
v_cvt_pk_bf16_f32 v208,v208,v209
v_cvt_pk_bf16_f32 v209,v210,v211
M v[16:19],a[252:255],a[128:131],v[16:19]
s_add_u32 s46,s74,46080
ds_read_b128 a[128:131],v249 offset:36864
v_cvt_pk_bf16_f32 v212,v212,v213
M v[16:19],a[104:107],a[132:135],v[16:19]
s_waitcnt lgkmcnt(3)
ds_read_b128 v[224:227],v248 offset:36864
v_cvt_pk_bf16_f32 v213,v214,v215
M v[16:19],a[100:103],a[136:139],v[16:19]
s_waitcnt lgkmcnt(2)
s_add_u32 s34,s32,589824
buffer_store_dwordx4 a[12:15],v253,s[24:27],s34 offen offset:384 nt
M v[20:23],a[100:103],v[220:223],v[20:23]
ds_write2st64_b64 v254,v[208:209],v[212:213] offset0:59 offset1:63
M v[20:23],a[104:107],a[136:139],v[20:23]
ds_read_b128 a[140:143],v248 offset:52224
v_accvgpr_read_b32 v238,a48
M v[20:23],a[252:255],a[132:135],v[20:23]
ds_read_b128 a[132:135],v249 offset:52224
v_accvgpr_read_b32 v232,a144
M v[24:27],a[252:255],a[136:139],v[24:27]
buffer_load_dwordx4 a[136:139],v250,s[20:23],s46 offen offset:0 sc1
M v[24:27],a[104:107],v[220:223],v[24:27]
s_waitcnt lgkmcnt(4)
ds_read_b128 a[200:203],v248 offset:52736
ds_read_b128 a[248:251],v249 offset:52736
M v[24:27],a[100:103],a[128:131],v[24:27]
s_waitcnt lgkmcnt(5)
buffer_load_dwordx4 a[208:211],v250,s[20:23],s46 offen offset:1024 sc1
M v[28:31],a[100:103],v[224:227],v[28:31]
v_add_f32 v234,v238,v232
v_sub_f32 v238,v238,v232
M v[28:31],a[104:107],a[128:131],v[28:31]
v_add_f32 v232,v48,v144
v_sub_f32 v144,v48,v144
M v[28:31],a[252:255],v[220:223],v[28:31]
s_waitcnt vmcnt(23) lgkmcnt(3)
s_barrier
ds_read_b128 a[32:35],v250 offset:17408
M v[0:3],a[244:247],a[140:143],v[0:3]
s_waitcnt vmcnt(22) lgkmcnt(3)
ds_read_b128 a[36:39],v250 offset:21504
ds_read_b128 a[40:43],v250 offset:26112
M v[0:3],a[224:227],a[132:135],v[0:3]
s_waitcnt vmcnt(21) lgkmcnt(4)
ds_read_b128 a[44:47],v250 offset:30208
ds_read_b128 a[100:103],v248 offset:53248
M v[0:3],a[216:219],a[200:203],v[0:3]
s_waitcnt lgkmcnt(5)
buffer_load_dwordx4 a[212:215],v250,s[20:23],s46 offen offset:2048 sc1
M v[4:7],a[216:219],a[248:251],v[4:7]
ds_read_b128 a[104:107],v249 offset:53248
v_add_f32 v48,v234,v232
M v[4:7],a[224:227],a[200:203],v[4:7]
v_fmac_f32 v234,4.0,v232
v_fma_f32 v232,2.0,v144,v238
M v[4:7],a[244:247],a[132:135],v[4:7]
v_fma_f32 v144,s40,v144,v238
v_accvgpr_read_b32 v238,a49
M v[8:11],a[244:247],a[200:203],v[8:11]
ds_read_b128 a[128:131],v248 offset:53760
v_accvgpr_read_b32 v237,a145
M v[8:11],a[224:227],a[248:251],v[8:11]
s_waitcnt lgkmcnt(2)
ds_read_b128 a[132:135],v249 offset:53760
v_add_f32 v236,v238,v237
M v[8:11],a[216:219],a[100:103],v[8:11]
s_waitcnt lgkmcnt(2)
s_add_u32 s34,s32,786432
buffer_store_dwordx4 a[16:19],v253,s[24:27],s34 offen offset:384 nt
M v[12:15],a[216:219],a[104:107],v[12:15]
v_sub_f32 v238,v238,v237
v_add_f32 v237,v49,v145
M v[12:15],a[224:227],a[100:103],v[12:15]
v_sub_f32 v145,v49,v145
v_add_f32 v49,v236,v237
M v[12:15],a[244:247],a[248:251],v[12:15]
v_fmac_f32 v236,4.0,v237
v_fma_f32 v237,2.0,v145,v238
M v[16:19],a[244:247],a[100:103],v[16:19]
s_add_u32 s47,s74,49152
ds_read_b128 a[100:103],v249 offset:54272
v_fma_f32 v145,s40,v145,v238
M v[16:19],a[224:227],a[104:107],v[16:19]
s_waitcnt lgkmcnt(2)
ds_read_b128 a[140:143],v248 offset:54272
v_add_u32 v248,0xfffece00,v248
M v[16:19],a[216:219],a[128:131],v[16:19]
s_waitcnt lgkmcnt(2)
v_add_u32 v249,0xfffece00,v249
v_cvt_pk_bf16_f32 v232,v232,v237
M v[20:23],a[216:219],a[132:135],v[20:23]
v_cvt_pk_bf16_f32 v234,v234,v236
v_accvgpr_read_b32 v238,a50
M v[20:23],a[224:227],a[128:131],v[20:23]
ds_read_b128 v[216:219],v248 offset:60928
v_accvgpr_read_b32 v233,a146
M v[20:23],a[244:247],a[104:107],v[20:23]
ds_read_b128 a[104:107],v249 offset:60928
v_add_f32 v235,v238,v233
M v[24:27],a[244:247],a[128:131],v[24:27]
buffer_load_dwordx4 a[128:131],v250,s[20:23],s47 offen offset:0 sc1
M v[24:27],a[224:227],a[132:135],v[24:27]
s_waitcnt lgkmcnt(3)
ds_read_b128 v[224:227],v248 offset:61440
ds_read_b128 v[220:223],v249 offset:61440
M v[24:27],a[216:219],a[100:103],v[24:27]
s_waitcnt lgkmcnt(4)
buffer_load_dwordx4 a[252:255],v250,s[20:23],s47 offen offset:1024 sc1
M v[28:31],a[216:219],a[140:143],v[28:31]
v_sub_f32 v238,v238,v233
v_add_f32 v233,v50,v146
M v[28:31],a[224:227],a[100:103],v[28:31]
v_sub_f32 v146,v50,v146
v_add_f32 v50,v235,v233
M v[28:31],a[244:247],a[132:135],v[28:31]
s_waitcnt vmcnt(24) lgkmcnt(3)
v_fmac_f32 v235,4.0,v233
v_fma_f32 v233,2.0,v146,v238
M v[0:3],a[232:235],v[216:219],v[0:3]
s_waitcnt vmcnt(23) lgkmcnt(2)
buffer_load_dwordx4 a[200:203],v250,s[20:23],s47 offen offset:2048 sc1
M v[0:3],a[96:99],a[104:107],v[0:3]
s_waitcnt vmcnt(23) lgkmcnt(1)
ds_read_b128 a[100:103],v248 offset:61952
ds_read_b128 a[132:135],v249 offset:61952
M v[0:3],a[196:199],v[224:227],v[0:3]
s_waitcnt lgkmcnt(2)
s_add_u32 s34,s32,983040
v_fma_f32 v146,s40,v146,v238
v_accvgpr_read_b32 v238,a51
M v[4:7],a[196:199],v[220:223],v[4:7]
v_accvgpr_read_b32 v237,a147
v_add_f32 v236,v238,v237
M v[4:7],a[96:99],v[224:227],v[4:7]
v_sub_f32 v238,v238,v237
v_add_f32 v237,v51,v147
M v[4:7],a[232:235],a[104:107],v[4:7]
buffer_store_dwordx4 a[20:23],v253,s[24:27],s34 offen offset:384 nt
M v[8:11],a[232:235],v[224:227],v[8:11]
ds_read_b128 a[104:107],v248 offset:62464
v_sub_f32 v147,v51,v147
M v[8:11],a[96:99],v[220:223],v[8:11]
s_waitcnt lgkmcnt(2)
ds_read_b128 a[140:143],v249 offset:62464
v_add_f32 v51,v236,v237
M v[8:11],a[196:199],a[100:103],v[8:11]
s_waitcnt lgkmcnt(2)
v_fmac_f32 v236,4.0,v237
v_fma_f32 v237,2.0,v147,v238
M v[12:15],a[196:199],a[132:135],v[12:15]
v_fma_f32 v147,s40,v147,v238
v_cvt_pk_bf16_f32 v233,v233,v237
M v[12:15],a[96:99],a[100:103],v[12:15]
v_cvt_pk_bf16_f32 v235,v235,v236
M v[12:15],a[232:235],v[220:223],v[12:15]
ds_write2st64_b64 v254,v[232:233],v[234:235] offset0:119 offset1:123
M v[16:19],a[232:235],a[100:103],v[16:19]
s_add_u32 s46,s75,46080
ds_read_b128 a[100:103],v249 offset:62976
v_accvgpr_read_b32 v204,a52
M v[16:19],a[96:99],a[132:135],v[16:19]
s_waitcnt lgkmcnt(3)
ds_read_b128 a[144:147],v248 offset:62976
v_accvgpr_read_b32 v208,a148
M v[16:19],a[196:199],a[104:107],v[16:19]
s_waitcnt lgkmcnt(3)
v_accvgpr_read_b32 v205,a53
v_accvgpr_read_b32 v209,a149
M v[20:23],a[196:199],a[140:143],v[20:23]
v_accvgpr_read_b32 v206,a54
v_accvgpr_read_b32 v210,a150
v_accvgpr_read_b32 v207,a55
v_accvgpr_read_b32 v211,a151
v_pk_add_f32 v[212:213],v[204:205],v[208:209]
v_pk_add_f32 v[214:215],v[206:207],v[210:211]
v_pk_add_f32 v[204:205],v[204:205],v[208:209] neg_lo:[0,1] neg_hi:[0,1]
v_pk_add_f32 v[206:207],v[206:207],v[210:211] neg_lo:[0,1] neg_hi:[0,1]
v_pk_add_f32 v[208:209],v[52:53],v[148:149]
v_pk_add_f32 v[210:211],v[54:55],v[150:151]
v_pk_add_f32 v[148:149],v[52:53],v[148:149] neg_lo:[0,1] neg_hi:[0,1]
v_pk_add_f32 v[150:151],v[54:55],v[150:151] neg_lo:[0,1] neg_hi:[0,1]
v_pk_add_f32 v[52:53],v[212:213],v[208:209]
v_pk_add_f32 v[54:55],v[214:215],v[210:211]
v_pk_fma_f32 v[212:213],v[208:209],4.0,v[212:213] op_sel_hi:[1,0,1]
v_pk_fma_f32 v[214:215],v[210:211],4.0,v[214:215] op_sel_hi:[1,0,1]
v_pk_fma_f32 v[208:209],v[148:149],2.0,v[204:205] op_sel_hi:[1,0,1]
v_pk_fma_f32 v[210:211],v[150:151],2.0,v[206:207] op_sel_hi:[1,0,1]
v_pk_fma_f32 v[148:149],v[148:149],s[40:41],v[204:205] op_sel_hi:[1,0,1]
v_pk_fma_f32 v[150:151],v[150:151],s[40:41],v[206:207] op_sel_hi:[1,0,1]
M v[20:23],a[96:99],a[104:107],v[20:23]
ds_read_b128 a[248:251],v248 offset:0
v_cvt_pk_bf16_f32 v208,v208,v209
M v[20:23],a[232:235],a[132:135],v[20:23]
ds_read_b128 a[132:135],v249 offset:0
v_cvt_pk_bf16_f32 v209,v210,v211
M v[24:27],a[232:235],a[104:107],v[24:27]
buffer_load_dwordx4 a[104:107],v250,s[20:23],s46 offen offset:0 sc1
M v[24:27],a[96:99],a[140:143],v[24:27]
s_waitcnt lgkmcnt(3)
ds_read_b128 a[148:151],v248 offset:512
ds_read_b128 a[224:227],v249 offset:512
M v[24:27],a[196:199],a[100:103],v[24:27]
s_waitcnt lgkmcnt(4)
s_add_u32 s34,s32,1179648
buffer_load_dwordx4 a[216:219],v250,s[20:23],s46 offen offset:1024 sc1
M v[28:31],a[196:199],a[144:147],v[28:31]
v_cvt_pk_bf16_f32 v212,v212,v213
v_cvt_pk_bf16_f32 v213,v214,v215
M v[28:31],a[96:99],a[100:103],v[28:31]
ds_write2st64_b64 v254,v[208:209],v[212:213] offset0:127 offset1:131
M v[28:31],a[232:235],a[140:143],v[28:31]
s_waitcnt vmcnt(25) lgkmcnt(4)
v_accvgpr_read_b32 v204,a56
v_accvgpr_read_b32 v208,a152
M v[96:99],a[236:239],a[248:251],v[96:99]
s_waitcnt vmcnt(24) lgkmcnt(3)
buffer_load_dwordx4 a[244:247],v250,s[20:23],s46 offen offset:2048 sc1
M v[96:99],a[228:231],a[132:135],v[96:99]
s_waitcnt vmcnt(24) lgkmcnt(2)
ds_read_b128 a[96:99],v248 offset:1024
ds_read_b128 a[100:103],v249 offset:1024
M v[96:99],a[220:223],a[148:151],v[96:99]
s_waitcnt lgkmcnt(3)
v_accvgpr_read_b32 v205,a57
v_accvgpr_read_b32 v209,a153
M v[100:103],a[220:223],a[224:227],v[100:103]
v_accvgpr_read_b32 v206,a58
v_accvgpr_read_b32 v210,a154
v_accvgpr_read_b32 v207,a59
v_accvgpr_read_b32 v211,a155
v_pk_add_f32 v[212:213],v[204:205],v[208:209]
v_pk_add_f32 v[214:215],v[206:207],v[210:211]
v_pk_add_f32 v[204:205],v[204:205],v[208:209] neg_lo:[0,1] neg_hi:[0,1]
v_pk_add_f32 v[206:207],v[206:207],v[210:211] neg_lo:[0,1] neg_hi:[0,1]
v_pk_add_f32 v[208:209],v[56:57],v[152:153]
v_pk_add_f32 v[210:211],v[58:59],v[154:155]
v_pk_add_f32 v[152:153],v[56:57],v[152:153] neg_lo:[0,1] neg_hi:[0,1]
v_pk_add_f32 v[154:155],v[58:59],v[154:155] neg_lo:[0,1] neg_hi:[0,1]
v_pk_add_f32 v[56:57],v[212:213],v[208:209]
v_pk_add_f32 v[58:59],v[214:215],v[210:211]
v_pk_fma_f32 v[212:213],v[208:209],4.0,v[212:213] op_sel_hi:[1,0,1]
v_pk_fma_f32 v[214:215],v[210:211],4.0,v[214:215] op_sel_hi:[1,0,1]
v_pk_fma_f32 v[208:209],v[152:153],2.0,v[204:205] op_sel_hi:[1,0,1]
v_pk_fma_f32 v[210:211],v[154:155],2.0,v[206:207] op_sel_hi:[1,0,1]
v_pk_fma_f32 v[152:153],v[152:153],s[40:41],v[204:205] op_sel_hi:[1,0,1]
v_pk_fma_f32 v[154:155],v[154:155],s[40:41],v[206:207] op_sel_hi:[1,0,1]
M v[100:103],a[228:231],a[148:151],v[100:103]
v_cvt_pk_bf16_f32 v208,v208,v209
v_cvt_pk_bf16_f32 v209,v210,v211
M v[100:103],a[236:239],a[132:135],v[100:103]
buffer_store_dwordx4 a[24:27],v253,s[24:27],s34 offen offset:384 nt
M v[104:107],a[236:239],a[148:151],v[104:107]
ds_read_b128 a[140:143],v248 offset:1536
v_cvt_pk_bf16_f32 v212,v212,v213
M v[104:107],a[228:231],a[224:227],v[104:107]
s_waitcnt lgkmcnt(2)
ds_read_b128 a[144:147],v249 offset:1536
v_cvt_pk_bf16_f32 v213,v214,v215
M v[104:107],a[220:223],a[96:99],v[104:107]
s_waitcnt lgkmcnt(2)
ds_write2st64_b64 v254,v[208:209],v[212:213] offset0:68 offset1:72
M v[108:111],a[220:223],a[100:103],v[108:111]
v_accvgpr_read_b32 v204,a60
v_accvgpr_read_b32 v208,a156
M v[108:111],a[228:231],a[96:99],v[108:111]
v_accvgpr_read_b32 v205,a61
v_accvgpr_read_b32 v209,a157
M v[108:111],a[236:239],a[224:227],v[108:111]
v_accvgpr_read_b32 v206,a62
v_accvgpr_read_b32 v210,a158
v_accvgpr_read_b32 v207,a63
v_accvgpr_read_b32 v211,a159
v_pk_add_f32 v[212:213],v[204:205],v[208:209]
v_pk_add_f32 v[214:215],v[206:207],v[210:211]
v_pk_add_f32 v[204:205],v[204:205],v[208:209] neg_lo:[0,1] neg_hi:[0,1]
v_pk_add_f32 v[206:207],v[206:207],v[210:211] neg_lo:[0,1] neg_hi:[0,1]
v_pk_add_f32 v[208:209],v[60:61],v[156:157]
v_pk_add_f32 v[210:211],v[62:63],v[158:159]
v_pk_add_f32 v[156:157],v[60:61],v[156:157] neg_lo:[0,1] neg_hi:[0,1]
v_pk_add_f32 v[158:159],v[62:63],v[158:159] neg_lo:[0,1] neg_hi:[0,1]
v_pk_add_f32 v[60:61],v[212:213],v[208:209]
v_pk_add_f32 v[62:63],v[214:215],v[210:211]
v_pk_fma_f32 v[212:213],v[208:209],4.0,v[212:213] op_sel_hi:[1,0,1]
v_pk_fma_f32 v[214:215],v[210:211],4.0,v[214:215] op_sel_hi:[1,0,1]
v_pk_fma_f32 v[208:209],v[156:157],2.0,v[204:205] op_sel_hi:[1,0,1]
v_pk_fma_f32 v[210:211],v[158:159],2.0,v[206:207] op_sel_hi:[1,0,1]
v_pk_fma_f32 v[156:157],v[156:157],s[40:41],v[204:205] op_sel_hi:[1,0,1]
v_pk_fma_f32 v[158:159],v[158:159],s[40:41],v[206:207] op_sel_hi:[1,0,1]
M v[112:115],a[236:239],a[96:99],v[112:115]
s_add_u32 s47,s75,49152
ds_read_b128 a[152:155],v249 offset:2048
v_cvt_pk_bf16_f32 v208,v208,v209
M v[112:115],a[228:231],a[100:103],v[112:115]
s_waitcnt lgkmcnt(3)
ds_read_b128 v[216:219],v248 offset:2048
v_cvt_pk_bf16_f32 v209,v210,v211
M v[112:115],a[220:223],a[140:143],v[112:115]
s_waitcnt lgkmcnt(3)
s_add_u32 s34,s32,1376256
buffer_store_dwordx4 a[28:31],v253,s[24:27],s34 offen offset:384 nt
M v[116:119],a[220:223],a[144:147],v[116:119]
v_cvt_pk_bf16_f32 v212,v212,v213
v_cvt_pk_bf16_f32 v213,v214,v215
M v[116:119],a[228:231],a[140:143],v[116:119]
ds_write2st64_b64 v254,v[208:209],v[212:213] offset0:76 offset1:80
M v[116:119],a[236:239],a[100:103],v[116:119]
s_add_u32 s28,s66,6684672
buffer_load_dwordx2 v[204:205],v245,s[12:15],s28 offen offset:0
M v[120:123],a[236:239],a[140:143],v[120:123]
v_cvt_pk_bf16_f32 v0,v0,v1
v_cvt_pk_bf16_f32 v1,v2,v3
M v[120:123],a[228:231],a[144:147],v[120:123]
s_waitcnt lgkmcnt(2)
buffer_load_dwordx2 v[214:215],v245,s[16:19],s28 offen offset:1536
M v[120:123],a[220:223],a[152:155],v[120:123]
s_waitcnt lgkmcnt(1)
v_cvt_pk_bf16_f32 v4,v4,v5
v_cvt_pk_bf16_f32 v5,v6,v7
M v[124:127],a[220:223],v[216:219],v[124:127]
s_waitcnt lgkmcnt(0)
s_barrier
ds_read_b128 a[48:51],v250 offset:60928
M v[124:127],a[228:231],a[152:155],v[124:127]
ds_read_b128 a[52:55],v250 offset:65024
ds_read_b128 a[56:59],v250 offset:34816
M v[124:127],a[236:239],a[144:147],v[124:127]
s_waitcnt vmcnt(27)
buffer_load_dwordx2 v[206:207],v245,s[8:11],s28 offen offset:0
ds_read_b128 a[60:63],v250 offset:38912
M v[128:131],a[112:115],a[248:251],v[128:131]
s_waitcnt vmcnt(27)
ds_write2st64_b64 v254,v[0:1],v[4:5] offset0:34 offset1:38
M v[128:131],a[124:127],a[132:135],v[128:131]
s_waitcnt vmcnt(26)
v_cvt_pk_bf16_f32 v8,v8,v9
v_cvt_pk_bf16_f32 v9,v10,v11
M v[128:131],a[120:123],a[148:151],v[128:131]
buffer_load_dwordx2 v[208:209],v245,s[8:11],s28 offen offset:384
v_cvt_pk_bf16_f32 v12,v12,v13
v_cvt_pk_bf16_f32 v13,v14,v15
M v[132:135],a[120:123],a[224:227],v[132:135]
ds_write2st64_b64 v254,v[8:9],v[12:13] offset0:42 offset1:46
M v[132:135],a[124:127],a[148:151],v[132:135]
v_cvt_pk_bf16_f32 v16,v16,v17
v_cvt_pk_bf16_f32 v17,v18,v19
M v[132:135],a[112:115],a[132:135],v[132:135]
buffer_load_dwordx2 v[210:211],v245,s[8:11],s28 offen offset:768
M v[136:139],a[112:115],a[148:151],v[136:139]
v_cvt_pk_bf16_f32 v20,v20,v21
v_cvt_pk_bf16_f32 v21,v22,v23
M v[136:139],a[124:127],a[224:227],v[136:139]
ds_write2st64_b64 v254,v[16:17],v[20:21] offset0:51 offset1:55
M v[136:139],a[120:123],a[96:99],v[136:139]
s_add_u32 s34,s32,0
buffer_load_dwordx2 v[212:213],v245,s[8:11],s28 offen offset:1152
M v[140:143],a[120:123],a[100:103],v[140:143]
v_cvt_pk_bf16_f32 v24,v24,v25
v_cvt_pk_bf16_f32 v25,v26,v27
M v[140:143],a[124:127],a[96:99],v[140:143]
v_cvt_pk_bf16_f32 v28,v28,v29
v_cvt_pk_bf16_f32 v29,v30,v31
M v[140:143],a[112:115],a[224:227],v[140:143]
ds_write2st64_b64 v254,v[24:25],v[28:29] offset0:59 offset1:63
M v[144:147],a[112:115],a[96:99],v[144:147]
buffer_load_dwordx4 a[156:159],v250,s[20:23],s47 offen offset:0 sc1
M v[144:147],a[124:127],a[100:103],v[144:147]
v_add_u32 v248,0x15400,v248
v_add_u32 v249,0x15400,v249
M v[144:147],a[120:123],a[140:143],v[144:147]
v_accvgpr_read_b32 v238,a64
v_accvgpr_read_b32 v232,a160
v_add_f32 v234,v238,v232
v_sub_f32 v238,v238,v232
M v[148:151],a[120:123],a[144:147],v[148:151]
buffer_load_dwordx4 v[224:227],v250,s[20:23],s47 offen offset:1024 sc1
M v[148:151],a[124:127],a[140:143],v[148:151]
ds_read_b128 a[96:99],v248 offset:0
v_add_f32 v232,v64,v160
M v[148:151],a[112:115],a[100:103],v[148:151]
ds_read_b128 a[100:103],v249 offset:0
v_sub_f32 v160,v64,v160
v_add_f32 v64,v234,v232
v_fmac_f32 v234,4.0,v232
M v[152:155],a[112:115],a[140:143],v[152:155]
ds_read_b128 a[140:143],v248 offset:512
v_fma_f32 v232,2.0,v160,v238
M v[152:155],a[124:127],a[144:147],v[152:155]
buffer_load_dwordx4 v[220:223],v250,s[20:23],s47 offen offset:2048 sc1
M v[152:155],a[120:123],a[152:155],v[152:155]
s_add_u32 s46,s76,46080
ds_read_b128 a[196:199],v249 offset:512
v_fma_f32 v160,s40,v160,v238
v_accvgpr_read_b32 v238,a65
v_accvgpr_read_b32 v237,a161
v_add_f32 v236,v238,v237
M v[156:159],a[120:123],v[216:219],v[156:159]
v_sub_f32 v238,v238,v237
v_add_f32 v237,v65,v161
M v[156:159],a[124:127],a[152:155],v[156:159]
buffer_load_dwordx4 a[132:135],v250,s[20:23],s46 offen offset:0 sc1
M v[156:159],a[112:115],a[144:147],v[156:159]
s_waitcnt vmcnt(31) lgkmcnt(3)
v_sub_f32 v161,v65,v161
v_add_f32 v65,v236,v237
v_fmac_f32 v236,4.0,v237
v_fma_f32 v237,2.0,v161,v238
M v[96:99],a[108:111],a[96:99],v[96:99]
s_waitcnt vmcnt(30) lgkmcnt(2)
ds_read_b128 a[112:115],v248 offset:1024
v_fma_f32 v161,s40,v161,v238
M v[96:99],v[228:231],a[100:103],v[96:99]
s_waitcnt vmcnt(29) lgkmcnt(2)
buffer_load_dwordx4 a[148:151],v250,s[20:23],s46 offen offset:1024 sc1
M v[96:99],a[192:195],a[140:143],v[96:99]
s_waitcnt lgkmcnt(1)
ds_read_b128 a[120:123],v249 offset:1024
v_cvt_pk_bf16_f32 v232,v232,v237
v_cvt_pk_bf16_f32 v234,v234,v236
v_accvgpr_read_b32 v238,a66
v_accvgpr_read_b32 v233,a162
M v[100:103],a[192:195],a[196:199],v[100:103]
v_add_f32 v235,v238,v233
v_sub_f32 v238,v238,v233
M v[100:103],v[228:231],a[140:143],v[100:103]
v_add_f32 v233,v66,v162
v_sub_f32 v162,v66,v162
M v[100:103],a[108:111],a[100:103],v[100:103]
buffer_store_dwordx4 a[32:35],v253,s[24:27],s34 offen offset:512 nt
M v[104:107],a[108:111],a[140:143],v[104:107]
s_add_u32 s34,s32,196608
ds_read_b128 a[124:127],v248 offset:1536
v_add_f32 v66,v235,v233
M v[104:107],v[228:231],a[196:199],v[104:107]
s_waitcnt lgkmcnt(2)
ds_read_b128 a[144:147],v249 offset:1536
v_fmac_f32 v235,4.0,v233
M v[104:107],a[192:195],a[112:115],v[104:107]
s_waitcnt lgkmcnt(2)
buffer_load_dwordx4 a[232:235],v250,s[20:23],s46 offen offset:2048 sc1
v_fma_f32 v233,2.0,v162,v238
M v[108:111],a[192:195],a[120:123],v[108:111]
v_fma_f32 v162,s40,v162,v238
v_accvgpr_read_b32 v238,a67
M v[108:111],v[228:231],a[112:115],v[108:111]
v_accvgpr_read_b32 v237,a163
v_add_f32 v236,v238,v237
M v[108:111],a[108:111],a[196:199],v[108:111]
buffer_store_dwordx4 a[36:39],v253,s[24:27],s34 offen offset:512 nt
M v[112:115],a[108:111],a[112:115],v[112:115]
s_add_u32 s47,s76,49152
ds_read_b128 a[152:155],v249 offset:2048
v_sub_f32 v238,v238,v237
M v[112:115],v[228:231],a[120:123],v[112:115]
s_waitcnt lgkmcnt(2)
ds_read_b128 a[220:223],v248 offset:2048
v_add_f32 v237,v67,v163
M v[112:115],a[192:195],a[124:127],v[112:115]
s_waitcnt lgkmcnt(2)
v_sub_f32 v163,v67,v163
v_add_f32 v67,v236,v237
v_fmac_f32 v236,4.0,v237
M v[116:119],a[192:195],a[144:147],v[116:119]
v_fma_f32 v237,2.0,v163,v238
v_fma_f32 v163,s40,v163,v238
M v[116:119],v[228:231],a[124:127],v[116:119]
v_cvt_pk_bf16_f32 v233,v233,v237
v_cvt_pk_bf16_f32 v235,v235,v236
M v[116:119],a[108:111],a[120:123],v[116:119]
ds_write2st64_b64 v254,v[232:233],v[234:235] offset0:102 offset1:106
M v[120:123],a[108:111],a[124:127],v[120:123]
buffer_load_dwordx4 a[160:163],v250,s[20:23],s47 offen offset:0 sc1
M v[120:123],v[228:231],a[144:147],v[120:123]
s_waitcnt lgkmcnt(2)
v_accvgpr_read_b32 v238,a68
v_accvgpr_read_b32 v232,a164
M v[120:123],a[192:195],a[152:155],v[120:123]
s_waitcnt lgkmcnt(1)
s_add_u32 s34,s32,393216
buffer_load_dwordx4 a[228:231],v250,s[20:23],s47 offen offset:1024 sc1
v_add_f32 v234,v238,v232
v_sub_f32 v238,v238,v232
v_add_f32 v232,v68,v164
M v[124:127],a[192:195],a[220:223],v[124:127]
v_sub_f32 v164,v68,v164
v_add_f32 v68,v234,v232
M v[124:127],v[228:231],a[152:155],v[124:127]
v_fmac_f32 v234,4.0,v232
v_fma_f32 v232,2.0,v164,v238
M v[124:127],a[108:111],a[144:147],v[124:127]
s_waitcnt vmcnt(33)
v_fma_f32 v164,s40,v164,v238
v_accvgpr_read_b32 v238,a69
v_accvgpr_read_b32 v237,a165
v_add_f32 v236,v238,v237
M v[128:131],a[116:119],a[96:99],v[128:131]
s_waitcnt vmcnt(31)
buffer_load_dwordx4 a[236:239],v250,s[20:23],s47 offen offset:2048 sc1
M v[128:131],a[240:243],a[100:103],v[128:131]
s_waitcnt vmcnt(31)
v_sub_f32 v238,v238,v237
v_add_f32 v237,v69,v165
M v[128:131],a[204:207],a[140:143],v[128:131]
v_sub_f32 v165,v69,v165
v_add_f32 v69,v236,v237
v_fmac_f32 v236,4.0,v237
v_fma_f32 v237,2.0,v165,v238
v_fma_f32 v165,s40,v165,v238
M v[132:135],a[204:207],a[196:199],v[132:135]
v_cvt_pk_bf16_f32 v232,v232,v237
v_cvt_pk_bf16_f32 v234,v234,v236
M v[132:135],a[240:243],a[140:143],v[132:135]
v_accvgpr_read_b32 v238,a70
v_accvgpr_read_b32 v233,a166
M v[132:135],a[116:119],a[100:103],v[132:135]
buffer_store_dwordx4 a[40:43],v253,s[24:27],s34 offen offset:512 nt
M v[136:139],a[116:119],a[140:143],v[136:139]
v_add_f32 v235,v238,v233
v_sub_f32 v238,v238,v233
M v[136:139],a[240:243],a[196:199],v[136:139]
v_add_f32 v233,v70,v166
v_sub_f32 v166,v70,v166
M v[136:139],a[204:207],a[112:115],v[136:139]
v_add_f32 v70,v235,v233
v_fmac_f32 v235,4.0,v233
v_fma_f32 v233,2.0,v166,v238
M v[140:143],a[204:207],a[120:123],v[140:143]
v_fma_f32 v166,s40,v166,v238
v_accvgpr_read_b32 v238,a71
M v[140:143],a[240:243],a[112:115],v[140:143]
v_accvgpr_read_b32 v237,a167
v_add_f32 v236,v238,v237
M v[140:143],a[116:119],a[196:199],v[140:143]
v_sub_f32 v238,v238,v237
v_add_f32 v237,v71,v167
v_sub_f32 v167,v71,v167
v_add_f32 v71,v236,v237
v_fmac_f32 v236,4.0,v237
M v[144:147],a[116:119],a[112:115],v[144:147]
s_add_u32 s46,s77,46080
v_fma_f32 v237,2.0,v167,v238
v_fma_f32 v167,s40,v167,v238
M v[144:147],a[240:243],a[120:123],v[144:147]
v_cvt_pk_bf16_f32 v233,v233,v237
v_cvt_pk_bf16_f32 v235,v235,v236
M v[144:147],a[204:207],a[124:127],v[144:147]
s_add_u32 s34,s32,589824
buffer_store_dwordx4 a[44:47],v253,s[24:27],s34 offen offset:512 nt
M v[148:151],a[204:207],a[144:147],v[148:151]
ds_write2st64_b64 v254,v[232:233],v[234:235] offset0:110 offset1:114
M v[148:151],a[240:243],a[124:127],v[148:151]
ds_read_b128 a[96:99],v248 offset:17408
v_accvgpr_read_b32 v238,a72
M v[148:151],a[116:119],a[120:123],v[148:151]
ds_read_b128 a[100:103],v249 offset:17408
v_accvgpr_read_b32 v232,a168
M v[152:155],a[116:119],a[124:127],v[152:155]
buffer_load_dwordx4 a[108:111],v250,s[20:23],s46 offen offset:0 sc1
M v[152:155],a[240:243],a[144:147],v[152:155]
ds_read_b128 a[112:115],v248 offset:17920
ds_read_b128 a[124:127],v249 offset:17920
M v[152:155],a[204:207],a[152:155],v[152:155]
buffer_load_dwordx4 a[120:123],v250,s[20:23],s46 offen offset:1024 sc1
M v[156:159],a[204:207],a[220:223],v[156:159]
v_add_f32 v234,v238,v232
v_sub_f32 v238,v238,v232
M v[156:159],a[240:243],a[152:155],v[156:159]
v_add_f32 v232,v72,v168
v_sub_f32 v168,v72,v168
M v[156:159],a[116:119],a[144:147],v[156:159]
s_waitcnt vmcnt(33) lgkmcnt(3)
s_barrier
ds_read_b128 v[0:3],v250 offset:17408
ds_read_b128 v[8:11],v250 offset:21504
ds_read_b128 v[16:19],v250 offset:26112
ds_read_b128 v[24:27],v250 offset:30208
M v[96:99],a[136:139],a[96:99],v[96:99]
s_waitcnt vmcnt(32) lgkmcnt(6)
ds_read_b128 a[64:67],v250 offset:52224
ds_read_b128 a[68:71],v250 offset:56320
M v[96:99],a[208:211],a[100:103],v[96:99]
s_waitcnt vmcnt(31) lgkmcnt(7)
buffer_load_dwordx4 a[140:143],v250,s[20:23],s46 offen offset:2048 sc1
M v[96:99],a[212:215],a[112:115],v[96:99]
s_waitcnt lgkmcnt(6)
ds_read_b128 a[116:119],v248 offset:18432
ds_read_b128 a[144:147],v249 offset:18432
v_add_f32 v72,v234,v232
v_fmac_f32 v234,4.0,v232
v_fma_f32 v232,2.0,v168,v238
M v[100:103],a[212:215],a[124:127],v[100:103]
v_fma_f32 v168,s40,v168,v238
v_accvgpr_read_b32 v238,a73
M v[100:103],a[208:211],a[112:115],v[100:103]
v_accvgpr_read_b32 v237,a169
v_add_f32 v236,v238,v237
M v[100:103],a[136:139],a[100:103],v[100:103]
v_sub_f32 v238,v238,v237
v_add_f32 v237,v73,v169
v_sub_f32 v169,v73,v169
v_add_f32 v73,v236,v237
M v[104:107],a[136:139],a[112:115],v[104:107]
ds_read_b128 a[152:155],v248 offset:18944
v_fmac_f32 v236,4.0,v237
M v[104:107],a[208:211],a[124:127],v[104:107]
s_waitcnt lgkmcnt(2)
ds_read_b128 a[164:167],v249 offset:18944
v_fma_f32 v237,2.0,v169,v238
M v[104:107],a[212:215],a[116:119],v[104:107]
s_waitcnt lgkmcnt(2)
s_add_u32 s34,s32,786432
buffer_store_dwordx4 a[48:51],v253,s[24:27],s34 offen offset:512 nt
M v[108:111],a[212:215],a[144:147],v[108:111]
v_fma_f32 v169,s40,v169,v238
v_cvt_pk_bf16_f32 v232,v232,v237
M v[108:111],a[208:211],a[116:119],v[108:111]
v_cvt_pk_bf16_f32 v234,v234,v236
v_accvgpr_read_b32 v238,a74
M v[108:111],a[136:139],a[124:127],v[108:111]
v_accvgpr_read_b32 v233,a170
v_add_f32 v235,v238,v233
v_sub_f32 v238,v238,v233
M v[112:115],a[136:139],a[116:119],v[112:115]
s_add_u32 s47,s77,49152
ds_read_b128 a[248:251],v249 offset:19456
v_add_f32 v233,v74,v170
M v[112:115],a[208:211],a[144:147],v[112:115]
s_waitcnt lgkmcnt(2)
ds_read_b128 a[224:227],v248 offset:19456
v_sub_f32 v170,v74,v170
M v[112:115],a[212:215],a[152:155],v[112:115]
s_waitcnt lgkmcnt(2)
v_add_f32 v74,v235,v233
v_fmac_f32 v235,4.0,v233
v_fma_f32 v233,2.0,v170,v238
v_fma_f32 v170,s40,v170,v238
v_accvgpr_read_b32 v238,a75
M v[116:119],a[212:215],a[164:167],v[116:119]
v_accvgpr_read_b32 v237,a171
v_add_f32 v236,v238,v237
M v[116:119],a[208:211],a[152:155],v[116:119]
v_sub_f32 v238,v238,v237
v_add_f32 v237,v75,v171
M v[116:119],a[136:139],a[144:147],v[116:119]
v_sub_f32 v171,v75,v171
v_add_f32 v75,v236,v237
v_fmac_f32 v236,4.0,v237
v_fma_f32 v237,2.0,v171,v238
v_fma_f32 v171,s40,v171,v238
M v[120:123],a[136:139],a[152:155],v[120:123]
buffer_load_dwordx4 v[216:219],v250,s[20:23],s47 offen offset:0 sc1
M v[120:123],a[208:211],a[164:167],v[120:123]
s_waitcnt lgkmcnt(1)
v_cvt_pk_bf16_f32 v233,v233,v237
v_cvt_pk_bf16_f32 v235,v235,v236
M v[120:123],a[212:215],a[248:251],v[120:123]
s_waitcnt lgkmcnt(0)
buffer_load_dwordx4 a[192:195],v250,s[20:23],s47 offen offset:1024 sc1
M v[124:127],a[212:215],a[224:227],v[124:127]
ds_write2st64_b64 v254,v[232:233],v[234:235] offset0:119 offset1:123
M v[124:127],a[208:211],a[248:251],v[124:127]
v_accvgpr_read_b32 v238,a76
v_accvgpr_read_b32 v232,a172
M v[124:127],a[136:139],a[164:167],v[124:127]
s_waitcnt vmcnt(33)
v_add_f32 v234,v238,v232
v_sub_f32 v238,v238,v232
v_add_f32 v232,v76,v172
v_sub_f32 v172,v76,v172
M v[128:131],a[128:131],a[96:99],v[128:131]
s_waitcnt vmcnt(32)
buffer_load_dwordx4 v[228:231],v250,s[20:23],s47 offen offset:2048 sc1
M v[128:131],a[252:255],a[100:103],v[128:131]
s_waitcnt vmcnt(32)
v_add_f32 v76,v234,v232
v_fmac_f32 v234,4.0,v232
M v[128:131],a[200:203],a[112:115],v[128:131]
s_add_u32 s34,s32,983040
v_fma_f32 v232,2.0,v172,v238
v_fma_f32 v172,s40,v172,v238
v_accvgpr_read_b32 v238,a77
v_accvgpr_read_b32 v237,a173
M v[132:135],a[200:203],a[124:127],v[132:135]
v_add_f32 v236,v238,v237
v_sub_f32 v238,v238,v237
M v[132:135],a[252:255],a[112:115],v[132:135]
v_add_f32 v237,v77,v173
v_sub_f32 v173,v77,v173
M v[132:135],a[128:131],a[100:103],v[132:135]
buffer_store_dwordx4 a[52:55],v253,s[24:27],s34 offen offset:512 nt
M v[136:139],a[128:131],a[112:115],v[136:139]
v_add_f32 v77,v236,v237
v_fmac_f32 v236,4.0,v237
M v[136:139],a[252:255],a[124:127],v[136:139]
v_fma_f32 v237,2.0,v173,v238
v_fma_f32 v173,s40,v173,v238
M v[136:139],a[200:203],a[116:119],v[136:139]
v_cvt_pk_bf16_f32 v232,v232,v237
v_cvt_pk_bf16_f32 v234,v234,v236
v_accvgpr_read_b32 v238,a78
v_accvgpr_read_b32 v233,a174
M v[140:143],a[200:203],a[144:147],v[140:143]
v_add_f32 v235,v238,v233
v_sub_f32 v238,v238,v233
M v[140:143],a[252:255],a[116:119],v[140:143]
v_add_f32 v233,v78,v174
v_sub_f32 v174,v78,v174
M v[140:143],a[128:131],a[124:127],v[140:143]
v_add_f32 v78,v235,v233
v_fmac_f32 v235,4.0,v233
v_fma_f32 v233,2.0,v174,v238
v_fma_f32 v174,s40,v174,v238
M v[144:147],a[128:131],a[116:119],v[144:147]
s_add_u32 s47,s72,3072
v_accvgpr_read_b32 v238,a79
v_accvgpr_read_b32 v237,a175
M v[144:147],a[252:255],a[144:147],v[144:147]
v_add_f32 v236,v238,v237
v_sub_f32 v238,v238,v237
M v[144:147],a[200:203],a[152:155],v[144:147]
v_add_f32 v237,v79,v175
v_sub_f32 v175,v79,v175
v_add_f32 v79,v236,v237
v_fmac_f32 v236,4.0,v237
v_fma_f32 v237,2.0,v175,v238
M v[148:151],a[200:203],a[164:167],v[148:151]
v_fma_f32 v175,s40,v175,v238
v_cvt_pk_bf16_f32 v233,v233,v237
M v[148:151],a[252:255],a[152:155],v[148:151]
ds_read_b128 a[96:99],v248 offset:34816
v_cvt_pk_bf16_f32 v235,v235,v236
M v[148:151],a[128:131],a[144:147],v[148:151]
ds_read_b128 a[100:103],v249 offset:34816
ds_write2st64_b64 v254,v[232:233],v[234:235] offset0:127 offset1:131
M v[152:155],a[128:131],a[152:155],v[152:155]
buffer_load_dwordx4 a[112:115],v250,s[20:23],s47 offen offset:0 sc1
M v[152:155],a[252:255],a[164:167],v[152:155]
ds_read_b128 a[116:119],v248 offset:35328
ds_read_b128 a[136:139],v249 offset:35328
M v[152:155],a[200:203],a[248:251],v[152:155]
s_add_u32 s34,s32,1179648
buffer_load_dwordx4 a[124:127],v250,s[20:23],s47 offen offset:1024 sc1
v_accvgpr_read_b32 v238,a80
M v[156:159],a[200:203],a[224:227],v[156:159]
v_accvgpr_read_b32 v232,a176
v_add_f32 v234,v238,v232
M v[156:159],a[252:255],a[248:251],v[156:159]
v_sub_f32 v238,v238,v232
v_add_f32 v232,v80,v176
M v[156:159],a[128:131],a[164:167],v[156:159]
s_waitcnt vmcnt(33) lgkmcnt(4)
v_sub_f32 v176,v80,v176
v_add_f32 v80,v234,v232
v_fmac_f32 v234,4.0,v232
v_fma_f32 v232,2.0,v176,v238
v_fma_f32 v176,s40,v176,v238
M v[96:99],a[104:107],a[96:99],v[96:99]
s_waitcnt vmcnt(32) lgkmcnt(3)
buffer_load_dwordx4 a[144:147],v250,s[20:23],s47 offen offset:2048 sc1
M v[96:99],a[216:219],a[100:103],v[96:99]
s_waitcnt vmcnt(32) lgkmcnt(1)
ds_read_b128 a[128:131],v248 offset:35840
ds_read_b128 a[152:155],v249 offset:35840
M v[96:99],a[244:247],a[116:119],v[96:99]
s_waitcnt lgkmcnt(2)
v_accvgpr_read_b32 v238,a81
v_accvgpr_read_b32 v237,a177
v_add_f32 v236,v238,v237
M v[100:103],a[244:247],a[136:139],v[100:103]
v_sub_f32 v238,v238,v237
v_add_f32 v237,v81,v177
M v[100:103],a[216:219],a[116:119],v[100:103]
v_sub_f32 v177,v81,v177
v_add_f32 v81,v236,v237
M v[100:103],a[104:107],a[100:103],v[100:103]
buffer_store_dwordx4 a[56:59],v253,s[24:27],s34 offen offset:512 nt
M v[104:107],a[104:107],a[116:119],v[104:107]
ds_read_b128 a[164:167],v248 offset:36352
v_fmac_f32 v236,4.0,v237
M v[104:107],a[216:219],a[136:139],v[104:107]
s_waitcnt lgkmcnt(2)
ds_read_b128 a[168:171],v249 offset:36352
v_fma_f32 v237,2.0,v177,v238
M v[104:107],a[244:247],a[128:131],v[104:107]
s_waitcnt lgkmcnt(2)
v_fma_f32 v177,s40,v177,v238
v_cvt_pk_bf16_f32 v232,v232,v237
M v[108:111],a[244:247],a[152:155],v[108:111]
v_cvt_pk_bf16_f32 v234,v234,v236
v_accvgpr_read_b32 v238,a82
M v[108:111],a[216:219],a[128:131],v[108:111]
v_accvgpr_read_b32 v233,a178
v_add_f32 v235,v238,v233
M v[108:111],a[104:107],a[136:139],v[108:111]
v_sub_f32 v238,v238,v233
v_add_f32 v233,v82,v178
M v[112:115],a[104:107],a[128:131],v[112:115]
s_add_u32 s48,s72,6144
ds_read_b128 a[172:175],v249 offset:36864
v_sub_f32 v178,v82,v178
M v[112:115],a[216:219],a[152:155],v[112:115]
s_waitcnt lgkmcnt(2)
ds_read_b128 a[196:199],v248 offset:36864
v_add_f32 v82,v235,v233
M v[112:115],a[244:247],a[164:167],v[112:115]
s_waitcnt lgkmcnt(2)
s_add_u32 s34,s32,1376256
buffer_store_dwordx4 a[60:63],v253,s[24:27],s34 offen offset:512 nt
M v[116:119],a[244:247],a[168:171],v[116:119]
v_fmac_f32 v235,4.0,v233
v_fma_f32 v233,2.0,v178,v238
M v[116:119],a[216:219],a[164:167],v[116:119]
v_fma_f32 v178,s40,v178,v238
v_accvgpr_read_b32 v238,a83
M v[116:119],a[104:107],a[152:155],v[116:119]
v_accvgpr_read_b32 v237,a179
v_add_f32 v236,v238,v237
M v[120:123],a[104:107],a[164:167],v[120:123]
buffer_load_dwordx4 a[204:207],v250,s[20:23],s48 offen offset:0 sc1
M v[120:123],a[216:219],a[168:171],v[120:123]
s_waitcnt lgkmcnt(1)
v_sub_f32 v238,v238,v237
v_add_f32 v237,v83,v179
M v[120:123],a[244:247],a[172:175],v[120:123]
s_waitcnt lgkmcnt(0)
buffer_load_dwordx4 a[220:223],v250,s[20:23],s48 offen offset:1024 sc1
M v[124:127],a[244:247],a[196:199],v[124:127]
v_sub_f32 v179,v83,v179
v_add_f32 v83,v236,v237
M v[124:127],a[216:219],a[172:175],v[124:127]
v_fmac_f32 v236,4.0,v237
v_fma_f32 v237,2.0,v179,v238
M v[124:127],a[104:107],a[168:171],v[124:127]
s_waitcnt vmcnt(27)
v_fma_f32 v179,s40,v179,v238
v_cvt_pk_bf16_f32 v233,v233,v237
M v[128:131],a[156:159],a[96:99],v[128:131]
s_waitcnt vmcnt(26)
buffer_load_dwordx4 a[240:243],v250,s[20:23],s48 offen offset:2048 sc1
M v[128:131],v[224:227],a[100:103],v[128:131]
s_waitcnt vmcnt(26)
v_cvt_pk_bf16_f32 v235,v235,v236
M v[128:131],v[220:223],a[116:119],v[128:131]
ds_write2st64_b64 v254,v[232:233],v[234:235] offset0:68 offset1:72
M v[132:135],v[220:223],a[136:139],v[132:135]
v_accvgpr_read_b32 v238,a84
v_accvgpr_read_b32 v232,a180
M v[132:135],v[224:227],a[116:119],v[132:135]
v_add_f32 v234,v238,v232
v_sub_f32 v238,v238,v232
M v[132:135],a[156:159],a[100:103],v[132:135]
v_add_f32 v232,v84,v180
v_sub_f32 v180,v84,v180
M v[136:139],a[156:159],a[116:119],v[136:139]
v_add_f32 v84,v234,v232
v_fmac_f32 v234,4.0,v232
M v[136:139],v[224:227],a[136:139],v[136:139]
v_fma_f32 v232,2.0,v180,v238
v_fma_f32 v180,s40,v180,v238
M v[136:139],v[220:223],a[128:131],v[136:139]
s_add_u32 s34,s33,0
buffer_store_dwordx4 v[0:3],v253,s[24:27],s34 offen offset:0 nt
M v[140:143],v[220:223],a[152:155],v[140:143]
v_accvgpr_read_b32 v238,a85
v_accvgpr_read_b32 v237,a181
M v[140:143],v[224:227],a[128:131],v[140:143]
v_add_f32 v236,v238,v237
v_sub_f32 v238,v238,v237
M v[140:143],a[156:159],a[136:139],v[140:143]
v_add_f32 v237,v85,v181
v_sub_f32 v181,v85,v181
M v[144:147],a[156:159],a[128:131],v[144:147]
s_add_u32 s47,s73,3072
v_add_f32 v85,v236,v237
v_fmac_f32 v236,4.0,v237
M v[144:147],v[224:227],a[152:155],v[144:147]
v_fma_f32 v237,2.0,v181,v238
v_fma_f32 v181,s40,v181,v238
M v[144:147],v[220:223],a[164:167],v[144:147]
v_cvt_pk_bf16_f32 v232,v232,v237
v_cvt_pk_bf16_f32 v234,v234,v236
M v[148:151],v[220:223],a[168:171],v[148:151]
v_accvgpr_read_b32 v238,a86
v_accvgpr_read_b32 v233,a182
M v[148:151],v[224:227],a[164:167],v[148:151]
ds_read_b128 a[96:99],v248 offset:52224
v_add_f32 v235,v238,v233
M v[148:151],a[156:159],a[152:155],v[148:151]
ds_read_b128 a[100:103],v249 offset:52224
v_sub_f32 v238,v238,v233
M v[152:155],a[156:159],a[164:167],v[152:155]
buffer_load_dwordx4 a[104:107],v250,s[20:23],s47 offen offset:0 sc1
M v[152:155],v[224:227],a[168:171],v[152:155]
ds_read_b128 a[116:119],v248 offset:52736
ds_read_b128 a[136:139],v249 offset:52736
M v[152:155],v[220:223],a[172:175],v[152:155]
buffer_load_dwordx4 a[128:131],v250,s[20:23],s47 offen offset:1024 sc1
v_add_f32 v233,v86,v182
M v[156:159],v[220:223],a[196:199],v[156:159]
v_sub_f32 v182,v86,v182
v_add_f32 v86,v235,v233
M v[156:159],v[224:227],a[172:175],v[156:159]
v_fmac_f32 v235,4.0,v233
v_fma_f32 v233,2.0,v182,v238
M v[156:159],a[156:159],a[168:171],v[156:159]
s_waitcnt vmcnt(28) lgkmcnt(3)
v_fma_f32 v182,s40,v182,v238
v_accvgpr_read_b32 v238,a87
v_accvgpr_read_b32 v237,a183
M v[96:99],a[132:135],a[96:99],v[96:99]
s_waitcnt vmcnt(27) lgkmcnt(2)
buffer_load_dwordx4 a[152:155],v250,s[20:23],s47 offen offset:2048 sc1
M v[96:99],a[148:151],a[100:103],v[96:99]
s_waitcnt vmcnt(26) lgkmcnt(1)
ds_read_b128 a[156:159],v248 offset:53248
ds_read_b128 a[164:167],v249 offset:53248
M v[96:99],a[232:235],a[116:119],v[96:99]
s_waitcnt lgkmcnt(2)
s_add_u32 s34,s33,393216
v_add_f32 v236,v238,v237
v_sub_f32 v238,v238,v237
v_add_f32 v237,v87,v183
M v[100:103],a[232:235],a[136:139],v[100:103]
v_sub_f32 v183,v87,v183
v_add_f32 v87,v236,v237
M v[100:103],a[148:151],a[116:119],v[100:103]
v_fmac_f32 v236,4.0,v237
v_fma_f32 v237,2.0,v183,v238
M v[100:103],a[132:135],a[100:103],v[100:103]
buffer_store_dwordx4 v[8:11],v253,s[24:27],s34 offen offset:0 nt
M v[104:107],a[132:135],a[116:119],v[104:107]
ds_read_b128 a[168:171],v248 offset:53760
v_fma_f32 v183,s40,v183,v238
M v[104:107],a[148:151],a[136:139],v[104:107]
s_waitcnt lgkmcnt(2)
ds_read_b128 a[172:175],v249 offset:53760
v_cvt_pk_bf16_f32 v233,v233,v237
M v[104:107],a[232:235],a[156:159],v[104:107]
s_waitcnt lgkmcnt(2)
v_cvt_pk_bf16_f32 v235,v235,v236
M v[108:111],a[232:235],a[164:167],v[108:111]
ds_write2st64_b64 v254,v[232:233],v[234:235] offset0:76 offset1:80
M v[108:111],a[148:151],a[156:159],v[108:111]
v_accvgpr_read_b32 v238,a88
v_accvgpr_read_b32 v232,a184
M v[108:111],a[132:135],a[136:139],v[108:111]
v_add_f32 v234,v238,v232
v_sub_f32 v238,v238,v232
M v[112:115],a[132:135],a[156:159],v[112:115]
s_add_u32 s48,s73,6144
ds_read_b128 a[176:179],v249 offset:54272
v_add_f32 v232,v88,v184
M v[112:115],a[148:151],a[164:167],v[112:115]
s_waitcnt lgkmcnt(3)
ds_read_b128 a[180:183],v248 offset:54272
v_sub_f32 v184,v88,v184
M v[112:115],a[232:235],a[168:171],v[112:115]
s_waitcnt lgkmcnt(3)
v_add_f32 v88,v234,v232
v_fmac_f32 v234,4.0,v232
M v[116:119],a[232:235],a[172:175],v[116:119]
v_fma_f32 v232,2.0,v184,v238
v_fma_f32 v184,s40,v184,v238
M v[116:119],a[148:151],a[168:171],v[116:119]
v_accvgpr_read_b32 v238,a89
v_accvgpr_read_b32 v237,a185
M v[116:119],a[132:135],a[164:167],v[116:119]
v_add_f32 v236,v238,v237
v_sub_f32 v238,v238,v237
M v[120:123],a[132:135],a[168:171],v[120:123]
buffer_load_dwordx4 a[212:215],v250,s[20:23],s48 offen offset:0 sc1
M v[120:123],a[148:151],a[172:175],v[120:123]
s_waitcnt lgkmcnt(1)
v_add_f32 v237,v89,v185
v_sub_f32 v185,v89,v185
M v[120:123],a[232:235],a[176:179],v[120:123]
s_waitcnt lgkmcnt(0)
s_add_u32 s34,s33,786432
buffer_load_dwordx4 a[208:211],v250,s[20:23],s48 offen offset:1024 sc1
M v[124:127],a[232:235],a[180:183],v[124:127]
v_add_f32 v89,v236,v237
v_fmac_f32 v236,4.0,v237
M v[124:127],a[148:151],a[176:179],v[124:127]
v_fma_f32 v237,2.0,v185,v238
v_fma_f32 v185,s40,v185,v238
M v[124:127],a[132:135],a[172:175],v[124:127]
s_waitcnt vmcnt(27)
v_cvt_pk_bf16_f32 v232,v232,v237
v_cvt_pk_bf16_f32 v234,v234,v236
v_accvgpr_read_b32 v238,a90
M v[128:131],a[160:163],a[96:99],v[128:131]
s_waitcnt vmcnt(26)
buffer_load_dwordx4 a[200:203],v250,s[20:23],s48 offen offset:2048 sc1
M v[128:131],a[228:231],a[100:103],v[128:131]
s_waitcnt vmcnt(26)
v_accvgpr_read_b32 v233,a186
v_add_f32 v235,v238,v233
M v[128:131],a[236:239],a[116:119],v[128:131]
v_sub_f32 v238,v238,v233
v_add_f32 v233,v90,v186
v_sub_f32 v186,v90,v186
M v[132:135],a[236:239],a[136:139],v[132:135]
v_add_f32 v90,v235,v233
v_fmac_f32 v235,4.0,v233
M v[132:135],a[228:231],a[116:119],v[132:135]
v_fma_f32 v233,2.0,v186,v238
v_fma_f32 v186,s40,v186,v238
M v[132:135],a[160:163],a[100:103],v[132:135]
buffer_store_dwordx4 v[16:19],v253,s[24:27],s34 offen offset:0 nt
M v[136:139],a[160:163],a[116:119],v[136:139]
v_accvgpr_read_b32 v238,a91
v_accvgpr_read_b32 v237,a187
M v[136:139],a[228:231],a[136:139],v[136:139]
v_add_f32 v236,v238,v237
v_sub_f32 v238,v238,v237
M v[136:139],a[236:239],a[156:159],v[136:139]
v_add_f32 v237,v91,v187
v_sub_f32 v187,v91,v187
M v[140:143],a[236:239],a[164:167],v[140:143]
v_add_f32 v91,v236,v237
v_fmac_f32 v236,4.0,v237
M v[140:143],a[228:231],a[156:159],v[140:143]
v_fma_f32 v237,2.0,v187,v238
v_fma_f32 v187,s40,v187,v238
M v[140:143],a[160:163],a[136:139],v[140:143]
v_cvt_pk_bf16_f32 v233,v233,v237
v_cvt_pk_bf16_f32 v235,v235,v236
M v[144:147],a[160:163],a[156:159],v[144:147]
s_add_u32 s47,s74,3072
ds_write2st64_b64 v254,v[232:233],v[234:235] offset0:85 offset1:89
M v[144:147],a[228:231],a[164:167],v[144:147]
v_add_u32 v248,0xffffbc00,v248
v_add_u32 v249,0xffffbc00,v249
M v[144:147],a[236:239],a[168:171],v[144:147]
s_add_u32 s34,s33,1179648
buffer_store_dwordx4 v[24:27],v253,s[24:27],s34 offen offset:0 nt
M v[148:151],a[236:239],a[172:175],v[148:151]
v_accvgpr_read_b32 v238,a92
v_accvgpr_read_b32 v232,a188
M v[148:151],a[228:231],a[168:171],v[148:151]
ds_read_b128 a[96:99],v248 offset:0
v_add_f32 v234,v238,v232
M v[148:151],a[160:163],a[164:167],v[148:151]
ds_read_b128 a[100:103],v249 offset:0
v_sub_f32 v238,v238,v232
M v[152:155],a[160:163],a[168:171],v[152:155]
buffer_load_dwordx4 a[116:119],v250,s[20:23],s47 offen offset:0 sc1
M v[152:155],a[228:231],a[172:175],v[152:155]
ds_read_b128 a[132:135],v248 offset:512
ds_read_b128 a[148:151],v249 offset:512
M v[152:155],a[236:239],a[176:179],v[152:155]
buffer_load_dwordx4 a[136:139],v250,s[20:23],s47 offen offset:1024 sc1
M v[156:159],a[236:239],a[180:183],v[156:159]
v_add_f32 v232,v92,v188
v_sub_f32 v188,v92,v188
M v[156:159],a[228:231],a[176:179],v[156:159]
v_add_f32 v92,v234,v232
v_fmac_f32 v234,4.0,v232
M v[156:159],a[160:163],a[172:175],v[156:159]
s_waitcnt vmcnt(27) lgkmcnt(3)
v_fma_f32 v232,2.0,v188,v238
v_fma_f32 v188,s40,v188,v238
M v[96:99],a[108:111],a[96:99],v[96:99]
s_waitcnt vmcnt(26) lgkmcnt(2)
buffer_load_dwordx4 a[156:159],v250,s[20:23],s47 offen offset:2048 sc1
M v[96:99],a[120:123],a[100:103],v[96:99]
s_waitcnt vmcnt(26) lgkmcnt(1)
ds_read_b128 a[160:163],v248 offset:1024
ds_read_b128 a[164:167],v249 offset:1024
M v[96:99],a[140:143],a[132:135],v[96:99]
s_waitcnt lgkmcnt(2)
v_accvgpr_read_b32 v238,a93
v_accvgpr_read_b32 v237,a189
M v[100:103],a[140:143],a[148:151],v[100:103]
v_add_f32 v236,v238,v237
v_sub_f32 v238,v238,v237
M v[100:103],a[120:123],a[132:135],v[100:103]
v_add_f32 v237,v93,v189
v_sub_f32 v189,v93,v189
M v[100:103],a[108:111],a[100:103],v[100:103]
v_add_f32 v93,v236,v237
v_fmac_f32 v236,4.0,v237
M v[104:107],a[108:111],a[132:135],v[104:107]
ds_read_b128 a[168:171],v248 offset:1536
v_fma_f32 v237,2.0,v189,v238
M v[104:107],a[120:123],a[148:151],v[104:107]
s_waitcnt lgkmcnt(2)
ds_read_b128 a[172:175],v249 offset:1536
v_fma_f32 v189,s40,v189,v238
M v[104:107],a[140:143],a[160:163],v[104:107]
s_waitcnt lgkmcnt(2)
s_add_u32 s34,s32,0
buffer_store_dwordx4 a[64:67],v253,s[24:27],s34 offen offset:640 nt
M v[108:111],a[140:143],a[164:167],v[108:111]
v_cvt_pk_bf16_f32 v232,v232,v237
v_cvt_pk_bf16_f32 v234,v234,v236
M v[108:111],a[120:123],a[160:163],v[108:111]
v_accvgpr_read_b32 v238,a94
v_accvgpr_read_b32 v233,a190
M v[108:111],a[108:111],a[148:151],v[108:111]
v_add_f32 v235,v238,v233
v_sub_f32 v238,v238,v233
M v[112:115],a[108:111],a[160:163],v[112:115]
s_add_u32 s48,s74,6144
ds_read_b128 a[176:179],v249 offset:2048
v_add_f32 v233,v94,v190
M v[112:115],a[120:123],a[164:167],v[112:115]
s_waitcnt lgkmcnt(2)
ds_read_b128 a[180:183],v248 offset:2048
v_sub_f32 v190,v94,v190
M v[112:115],a[140:143],a[168:171],v[112:115]
s_waitcnt lgkmcnt(2)
v_add_f32 v94,v235,v233
v_fmac_f32 v235,4.0,v233
M v[116:119],a[140:143],a[172:175],v[116:119]
v_fma_f32 v233,2.0,v190,v238
v_fma_f32 v190,s40,v190,v238
M v[116:119],a[120:123],a[168:171],v[116:119]
v_accvgpr_read_b32 v238,a95
v_accvgpr_read_b32 v237,a191
M v[116:119],a[108:111],a[164:167],v[116:119]
v_add_f32 v236,v238,v237
v_sub_f32 v238,v238,v237
M v[120:123],a[108:111],a[168:171],v[120:123]
buffer_load_dwordx4 a[184:187],v250,s[20:23],s48 offen offset:0 sc1
M v[120:123],a[120:123],a[172:175],v[120:123]
s_waitcnt lgkmcnt(1)
v_add_f32 v237,v95,v191
v_sub_f32 v191,v95,v191
M v[120:123],a[140:143],a[176:179],v[120:123]
s_waitcnt lgkmcnt(0)
buffer_load_dwordx4 a[224:227],v250,s[20:23],s48 offen offset:1024 sc1
v_add_f32 v95,v236,v237
M v[124:127],a[140:143],a[180:183],v[124:127]
v_fmac_f32 v236,4.0,v237
v_fma_f32 v237,2.0,v191,v238
M v[124:127],a[120:123],a[176:179],v[124:127]
v_fma_f32 v191,s40,v191,v238
v_cvt_pk_bf16_f32 v233,v233,v237
M v[124:127],a[108:111],a[172:175],v[124:127]
s_waitcnt vmcnt(27)
v_cvt_pk_bf16_f32 v235,v235,v236
M v[128:131],v[216:219],a[96:99],v[128:131]
s_waitcnt vmcnt(26)
buffer_load_dwordx4 a[248:251],v250,s[20:23],s48 offen offset:2048 sc1
M v[128:131],a[192:195],a[100:103],v[128:131]
s_waitcnt vmcnt(26)
ds_write2st64_b64 v254,v[232:233],v[234:235] offset0:93 offset1:97
M v[128:131],v[228:231],a[132:135],v[128:131]
s_add_u32 s34,s32,196608
v_cvt_pk_bf16_f32 v96,v96,v97
v_cvt_pk_bf16_f32 v97,v98,v99
M v[132:135],v[228:231],a[148:151],v[132:135]
v_cvt_pk_bf16_f32 v100,v100,v101
v_cvt_pk_bf16_f32 v101,v102,v103
M v[132:135],a[192:195],a[132:135],v[132:135]
s_waitcnt lgkmcnt(0)
s_barrier
ds_read_b128 a[72:75],v250 offset:60928
M v[132:135],v[216:219],a[100:103],v[132:135]
ds_read_b128 a[76:79],v250 offset:65024
ds_read_b128 a[80:83],v250 offset:34816
M v[136:139],v[216:219],a[132:135],v[136:139]
ds_read_b128 a[84:87],v250 offset:38912
ds_read_b128 a[88:91],v250 offset:43520
M v[136:139],a[192:195],a[148:151],v[136:139]
ds_read_b128 a[92:95],v250 offset:47616
v_add_u32 v4,69632,v250
M v[136:139],v[228:231],a[160:163],v[136:139]
buffer_store_dwordx4 a[68:71],v253,s[24:27],s34 offen offset:640 nt
M v[140:143],v[228:231],a[164:167],v[140:143]
ds_write2st64_b64 v254,v[96:97],v[100:101] offset0:34 offset1:38
M v[140:143],a[192:195],a[160:163],v[140:143]
v_cvt_pk_bf16_f32 v104,v104,v105
v_cvt_pk_bf16_f32 v105,v106,v107
M v[140:143],v[216:219],a[148:151],v[140:143]
v_cvt_pk_bf16_f32 v108,v108,v109
v_cvt_pk_bf16_f32 v109,v110,v111
M v[144:147],v[216:219],a[160:163],v[144:147]
s_add_u32 s47,s75,3072
ds_write2st64_b64 v254,v[104:105],v[108:109] offset0:42 offset1:46
M v[144:147],a[192:195],a[164:167],v[144:147]
v_add_u32 v248,0xfffece00,v248
v_add_u32 v249,0xfffece00,v249
M v[144:147],v[228:231],a[168:171],v[144:147]
v_cvt_pk_bf16_f32 v112,v112,v113
v_cvt_pk_bf16_f32 v113,v114,v115
M v[148:151],v[228:231],a[172:175],v[148:151]
v_cvt_pk_bf16_f32 v116,v116,v117
v_cvt_pk_bf16_f32 v117,v118,v119
M v[148:151],a[192:195],a[168:171],v[148:151]
ds_read_b128 a[96:99],v248 offset:0
ds_write2st64_b64 v254,v[112:113],v[116:117] offset0:51 offset1:55
M v[148:151],v[216:219],a[164:167],v[148:151]
ds_read_b128 a[100:103],v249 offset:0
v_cvt_pk_bf16_f32 v120,v120,v121
M v[152:155],v[216:219],a[168:171],v[152:155]
buffer_load_dwordx4 a[108:111],v250,s[20:23],s47 offen offset:0 sc1
M v[152:155],a[192:195],a[172:175],v[152:155]
ds_read_b128 a[120:123],v248 offset:512
ds_read_b128 a[140:143],v249 offset:512
M v[152:155],v[228:231],a[176:179],v[152:155]
s_add_u32 s34,s32,393216
buffer_load_dwordx4 a[132:135],v250,s[20:23],s47 offen offset:1024 sc1
M v[156:159],v[228:231],a[180:183],v[156:159]
v_cvt_pk_bf16_f32 v121,v122,v123
v_cvt_pk_bf16_f32 v124,v124,v125
M v[156:159],a[192:195],a[176:179],v[156:159]
v_cvt_pk_bf16_f32 v125,v126,v127
M v[156:159],v[216:219],a[172:175],v[156:159]
s_waitcnt vmcnt(27) lgkmcnt(4)
ds_write2st64_b64 v254,v[120:121],v[124:125] offset0:59 offset1:63
M v[32:35],a[112:115],a[96:99],v[32:35]
s_waitcnt vmcnt(26) lgkmcnt(3)
buffer_load_dwordx4 a[148:151],v250,s[20:23],s47 offen offset:2048 sc1
M v[32:35],a[124:127],a[100:103],v[32:35]
s_waitcnt vmcnt(26) lgkmcnt(2)
ds_read_b128 a[160:163],v248 offset:1024
ds_read_b128 a[164:167],v249 offset:1024
M v[32:35],a[144:147],a[120:123],v[32:35]
s_waitcnt lgkmcnt(3)
v_cvt_pk_bf16_f32 v128,v128,v129
v_cvt_pk_bf16_f32 v129,v130,v131
M v[36:39],a[144:147],a[140:143],v[36:39]
v_cvt_pk_bf16_f32 v132,v132,v133
v_cvt_pk_bf16_f32 v133,v134,v135
M v[36:39],a[124:127],a[120:123],v[36:39]
s_waitcnt lgkmcnt(2)
s_barrier
ds_read_b128 v[96:99],v250 offset:17408
M v[36:39],a[112:115],a[100:103],v[36:39]
ds_read_b128 v[104:107],v250 offset:21504
ds_read_b128 v[112:115],v250 offset:26112
M v[40:43],a[112:115],a[120:123],v[40:43]
ds_read_b128 v[120:123],v250 offset:30208
ds_read_b128 a[168:171],v248 offset:1536
M v[40:43],a[124:127],a[140:143],v[40:43]
s_waitcnt lgkmcnt(6)
ds_read_b128 a[172:175],v249 offset:1536
ds_write2st64_b64 v254,v[128:129],v[132:133] offset0:119 offset1:123
M v[40:43],a[144:147],a[160:163],v[40:43]
s_waitcnt lgkmcnt(7)
buffer_store_dwordx4 a[72:75],v253,s[24:27],s34 offen offset:640 nt
M v[44:47],a[144:147],a[164:167],v[44:47]
v_cvt_pk_bf16_f32 v136,v136,v137
v_cvt_pk_bf16_f32 v137,v138,v139
M v[44:47],a[124:127],a[160:163],v[44:47]
v_cvt_pk_bf16_f32 v140,v140,v141
v_cvt_pk_bf16_f32 v141,v142,v143
M v[44:47],a[112:115],a[140:143],v[44:47]
ds_write2st64_b64 v254,v[136:137],v[140:141] offset0:127 offset1:131
M v[48:51],a[112:115],a[160:163],v[48:51]
ds_read_b128 a[176:179],v249 offset:2048
v_cvt_pk_bf16_f32 v144,v144,v145
M v[48:51],a[124:127],a[164:167],v[48:51]
s_waitcnt lgkmcnt(4)
ds_read_b128 a[180:183],v248 offset:2048
v_cvt_pk_bf16_f32 v145,v146,v147
M v[48:51],a[144:147],a[168:171],v[48:51]
s_waitcnt lgkmcnt(4)
s_add_u32 s34,s32,589824
buffer_store_dwordx4 a[76:79],v253,s[24:27],s34 offen offset:640 nt
M v[52:55],a[144:147],a[172:175],v[52:55]
v_cvt_pk_bf16_f32 v148,v148,v149
v_cvt_pk_bf16_f32 v149,v150,v151
M v[52:55],a[124:127],a[168:171],v[52:55]
ds_write2st64_b64 v254,v[144:145],v[148:149] offset0:68 offset1:72
M v[52:55],a[112:115],a[164:167],v[52:55]
v_cvt_pk_bf16_f32 v152,v152,v153
v_cvt_pk_bf16_f32 v153,v154,v155
M v[56:59],a[112:115],a[168:171],v[56:59]
global_load_dword a188,v250,s[64:65]
M v[56:59],a[124:127],a[172:175],v[56:59]
s_waitcnt lgkmcnt(2)
s_add_u32 s48,s75,6144
buffer_load_dwordx4 a[188:191],v250,s[20:23],s48 offen offset:0 sc1
M v[56:59],a[144:147],a[176:179],v[56:59]
s_waitcnt lgkmcnt(1)
v_cvt_pk_bf16_f32 v156,v156,v157
v_cvt_pk_bf16_f32 v157,v158,v159
M v[60:63],a[144:147],a[180:183],v[60:63]
ds_write2st64_b64 v254,v[152:153],v[156:157] offset0:76 offset1:80
M v[60:63],a[124:127],a[176:179],v[60:63]
buffer_load_dwordx4 a[252:255],v250,s[20:23],s48 offen offset:1024 sc1
M v[60:63],a[112:115],a[172:175],v[60:63]
s_waitcnt vmcnt(28)
v_lshlrev_b32 v234,16,v208
v_lshlrev_b32 v232,16,v204
M v[64:67],a[204:207],a[96:99],v[64:67]
s_waitcnt vmcnt(27)
v_lshlrev_b32 v233,16,v206
v_lshlrev_b32 v237,16,v214
M v[64:67],a[220:223],a[100:103],v[64:67]
s_waitcnt vmcnt(26)
v_lshlrev_b32 v236,16,v212
v_lshlrev_b32 v235,16,v210
M v[64:67],a[240:243],a[120:123],v[64:67]
s_waitcnt lgkmcnt(0)
s_barrier
ds_read_b128 v[128:131],v250 offset:60928
M v[68:71],a[240:243],a[140:143],v[68:71]
ds_read_b128 v[136:139],v250 offset:65024
ds_read_b128 v[144:147],v250 offset:34816
M v[68:71],a[220:223],a[120:123],v[68:71]
ds_read_b128 v[152:155],v250 offset:38912
v_fmac_f32 v232,s43,v234
M v[68:71],a[204:207],a[100:103],v[68:71]
buffer_load_dwordx4 a[244:247],v250,s[20:23],s48 offen offset:2048 sc1
M v[72:75],a[204:207],a[120:123],v[72:75]
v_fmac_f32 v237,4.0,v233
v_fma_f32 v238,-4.0,v234,v236
M v[72:75],a[220:223],a[140:143],v[72:75]
v_fmac_f32 v232,s45,v236
v_fmac_f32 v237,s41,v235
M v[72:75],a[240:243],a[160:163],v[72:75]
s_add_u32 s34,s32,786432
buffer_store_dwordx4 a[80:83],v253,s[24:27],s34 offen offset:640 nt
M v[76:79],a[240:243],a[164:167],v[76:79]
v_sub_f32 v236,v236,v234
v_fma_f32 v234,-4.0,v233,v235
M v[76:79],a[220:223],a[160:163],v[76:79]
v_sub_f32 v235,v235,v233
v_add_f32 v233,v238,v234
M v[76:79],a[204:207],a[140:143],v[76:79]
v_sub_f32 v238,v238,v234
v_fma_f32 v234,2.0,v235,v236
M v[80:83],a[204:207],a[160:163],v[80:83]
s_add_u32 s47,s76,3072
v_fmac_f32 v236,-2.0,v235
v_and_b32 v208,s42,v208
M v[80:83],a[220:223],a[164:167],v[80:83]
v_add_u32 v248,0x15400,v248
v_add_u32 v249,0x15400,v249
M v[80:83],a[240:243],a[168:171],v[80:83]
v_and_b32 v204,s42,v204
v_and_b32 v206,s42,v206
M v[84:87],a[240:243],a[172:175],v[84:87]
v_and_b32 v214,s42,v214
v_and_b32 v212,s42,v212
M v[84:87],a[220:223],a[168:171],v[84:87]
ds_read_b128 a[96:99],v248 offset:0
v_and_b32 v210,s42,v210
M v[84:87],a[204:207],a[164:167],v[84:87]
ds_read_b128 a[100:103],v249 offset:0
v_fmac_f32 v204,s43,v208
M v[88:91],a[204:207],a[168:171],v[88:91]
buffer_load_dwordx4 a[112:115],v250,s[20:23],s47 offen offset:0 sc1
M v[88:91],a[220:223],a[172:175],v[88:91]
ds_read_b128 a[120:123],v248 offset:512
ds_read_b128 a[140:143],v249 offset:512
M v[88:91],a[240:243],a[176:179],v[88:91]
buffer_load_dwordx4 a[124:127],v250,s[20:23],s47 offen offset:1024 sc1
M v[92:95],a[240:243],a[180:183],v[92:95]
v_fmac_f32 v214,4.0,v206
v_fma_f32 v235,-4.0,v208,v212
M v[92:95],a[220:223],a[176:179],v[92:95]
v_fmac_f32 v204,s45,v212
v_fmac_f32 v214,s41,v210
M v[92:95],a[204:207],a[172:175],v[92:95]
s_waitcnt vmcnt(28) lgkmcnt(3)
v_sub_f32 v212,v212,v208
v_fma_f32 v208,-4.0,v206,v210
M v[32:35],a[104:107],a[96:99],v[32:35]
s_waitcnt vmcnt(27) lgkmcnt(2)
buffer_load_dwordx4 a[144:147],v250,s[20:23],s47 offen offset:2048 sc1
M v[32:35],a[128:131],a[100:103],v[32:35]
s_waitcnt vmcnt(27) lgkmcnt(1)
ds_read_b128 a[160:163],v248 offset:1024
ds_read_b128 a[164:167],v249 offset:1024
M v[32:35],a[152:155],a[120:123],v[32:35]
s_waitcnt lgkmcnt(2)
s_add_u32 s34,s32,983040
v_sub_f32 v210,v210,v206
v_add_f32 v206,v235,v208
M v[36:39],a[152:155],a[140:143],v[36:39]
v_sub_f32 v235,v235,v208
v_fma_f32 v208,2.0,v210,v212
M v[36:39],a[128:131],a[120:123],v[36:39]
v_fmac_f32 v212,-2.0,v210
v_cvt_pk_bf16_f32 v204,v232,v204
M v[36:39],a[104:107],a[100:103],v[36:39]
buffer_store_dwordx4 a[84:87],v253,s[24:27],s34 offen offset:640 nt
M v[40:43],a[104:107],a[120:123],v[40:43]
ds_read_b128 a[168:171],v248 offset:1536
v_cvt_pk_bf16_f32 v214,v237,v214
M v[40:43],a[128:131],a[140:143],v[40:43]
s_waitcnt lgkmcnt(2)
ds_read_b128 a[172:175],v249 offset:1536
v_cvt_pk_bf16_f32 v206,v233,v206
M v[40:43],a[152:155],a[160:163],v[40:43]
s_waitcnt lgkmcnt(2)
v_cvt_pk_bf16_f32 v210,v234,v208
v_cvt_pk_bf16_f32 v208,v238,v235
M v[44:47],a[152:155],a[164:167],v[44:47]
v_cvt_pk_bf16_f32 v212,v236,v212
v_lshlrev_b32 v234,16,v209
M v[44:47],a[128:131],a[160:163],v[44:47]
v_lshlrev_b32 v232,16,v205
v_lshlrev_b32 v233,16,v207
M v[44:47],a[104:107],a[140:143],v[44:47]
v_lshlrev_b32 v237,16,v215
v_lshlrev_b32 v236,16,v213
M v[48:51],a[104:107],a[160:163],v[48:51]
s_add_u32 s48,s76,6144
ds_read_b128 a[176:179],v249 offset:2048
v_lshlrev_b32 v235,16,v211
M v[48:51],a[128:131],a[164:167],v[48:51]
s_waitcnt lgkmcnt(2)
ds_read_b128 a[180:183],v248 offset:2048
v_fmac_f32 v232,s43,v234
M v[48:51],a[152:155],a[168:171],v[48:51]
s_waitcnt lgkmcnt(2)
v_fmac_f32 v237,4.0,v233
v_fma_f32 v238,-4.0,v234,v236
M v[52:55],a[152:155],a[172:175],v[52:55]
v_fmac_f32 v232,s45,v236
v_fmac_f32 v237,s41,v235
M v[52:55],a[128:131],a[168:171],v[52:55]
v_sub_f32 v236,v236,v234
v_fma_f32 v234,-4.0,v233,v235
M v[52:55],a[104:107],a[164:167],v[52:55]
v_sub_f32 v235,v235,v233
v_add_f32 v233,v238,v234
M v[56:59],a[104:107],a[168:171],v[56:59]
buffer_load_dwordx4 a[216:219],v250,s[20:23],s48 offen offset:0 sc1
M v[56:59],a[128:131],a[172:175],v[56:59]
s_waitcnt lgkmcnt(1)
v_sub_f32 v238,v238,v234
v_fma_f32 v234,2.0,v235,v236
M v[56:59],a[152:155],a[176:179],v[56:59]
s_waitcnt lgkmcnt(0)
s_add_u32 s34,s32,1179648
buffer_load_dwordx4 a[196:199],v250,s[20:23],s48 offen offset:1024 sc1
M v[60:63],a[152:155],a[180:183],v[60:63]
v_fmac_f32 v236,-2.0,v235
v_and_b32 v209,s42,v209
M v[60:63],a[128:131],a[176:179],v[60:63]
v_and_b32 v205,s42,v205
v_and_b32 v207,s42,v207
M v[60:63],a[104:107],a[172:175],v[60:63]
s_waitcnt vmcnt(28)
v_and_b32 v215,s42,v215
v_and_b32 v213,s42,v213
M v[64:67],a[212:215],a[96:99],v[64:67]
s_waitcnt vmcnt(27)
buffer_load_dwordx4 v[220:223],v250,s[20:23],s48 offen offset:2048 sc1
M v[64:67],a[208:211],a[100:103],v[64:67]
s_waitcnt vmcnt(27)
v_and_b32 v211,s42,v211
v_fmac_f32 v205,s43,v209
M v[64:67],a[200:203],a[120:123],v[64:67]
v_fmac_f32 v215,4.0,v207
v_fma_f32 v235,-4.0,v209,v213
M v[68:71],a[200:203],a[140:143],v[68:71]
v_fmac_f32 v205,s45,v213
v_fmac_f32 v215,s41,v211
M v[68:71],a[208:211],a[120:123],v[68:71]
v_sub_f32 v213,v213,v209
v_fma_f32 v209,-4.0,v207,v211
M v[68:71],a[212:215],a[100:103],v[68:71]
buffer_store_dwordx4 a[88:91],v253,s[24:27],s34 offen offset:640 nt
M v[72:75],a[212:215],a[120:123],v[72:75]
v_sub_f32 v211,v211,v207
v_add_f32 v207,v235,v209
M v[72:75],a[208:211],a[140:143],v[72:75]
v_sub_f32 v235,v235,v209
v_fma_f32 v209,2.0,v211,v213
M v[72:75],a[200:203],a[160:163],v[72:75]
v_fmac_f32 v213,-2.0,v211
v_cvt_pk_bf16_f32 v205,v232,v205
M v[76:79],a[200:203],a[164:167],v[76:79]
v_cvt_pk_bf16_f32 v215,v237,v215
v_cvt_pk_bf16_f32 v207,v233,v207
M v[76:79],a[208:211],a[160:163],v[76:79]
v_cvt_pk_bf16_f32 v211,v234,v209
v_cvt_pk_bf16_f32 v209,v238,v235
M v[76:79],a[212:215],a[140:143],v[76:79]
v_cvt_pk_bf16_f32 v213,v236,v213
M v[80:83],a[212:215],a[160:163],v[80:83]
s_add_u32 s47,s77,3072
M v[80:83],a[208:211],a[164:167],v[80:83]
s_barrier
v_fmac_f32 v239,s43,v241
M v[80:83],a[200:203],a[168:171],v[80:83]
s_add_u32 s34,s32,1376256
ds_write2st64_b64 v247,v[192:193],v[202:203] offset0:102 offset1:119
M v[84:87],a[200:203],a[172:175],v[84:87]
s_add_u32 s28,s66,7077888
buffer_load_dwordx2 v[192:193],v245,s[12:15],s28 offen offset:0
M v[84:87],a[208:211],a[168:171],v[84:87]
ds_read_b128 a[96:99],v248 offset:17408
v_fmac_f32 v244,4.0,v240
M v[84:87],a[212:215],a[164:167],v[84:87]
buffer_load_dwordx2 v[202:203],v245,s[16:19],s28 offen offset:1536
M v[88:91],a[212:215],a[168:171],v[88:91]
ds_read_b128 a[100:103],v249 offset:17408
ds_read_b128 a[120:123],v248 offset:17920
M v[88:91],a[208:211],a[172:175],v[88:91]
ds_read_b128 a[140:143],v249 offset:17920
v_fma_f32 v232,-4.0,v241,v243
M v[88:91],a[200:203],a[176:179],v[88:91]
ds_write2st64_b64 v247,v[194:195],v[196:197] offset0:34 offset1:51
M v[92:95],a[200:203],a[180:183],v[92:95]
buffer_load_dwordx2 v[194:195],v245,s[8:11],s28 offen offset:0
M v[92:95],a[208:211],a[176:179],v[92:95]
v_fmac_f32 v239,s45,v243
v_fmac_f32 v244,s41,v242
M v[92:95],a[212:215],a[172:175],v[92:95]
s_waitcnt vmcnt(28) lgkmcnt(4)
ds_write2st64_b64 v247,v[198:199],v[200:201] offset0:68 offset1:85
M v[32:35],a[116:119],a[96:99],v[32:35]
s_waitcnt vmcnt(27) lgkmcnt(4)
buffer_load_dwordx2 v[196:197],v245,s[8:11],s28 offen offset:384
M v[32:35],a[136:139],a[100:103],v[32:35]
s_waitcnt vmcnt(27) lgkmcnt(3)
ds_read_b128 a[160:163],v248 offset:18432
ds_read_b128 a[164:167],v249 offset:18432
M v[32:35],a[156:159],a[120:123],v[32:35]
s_waitcnt lgkmcnt(4)
ds_write2st64_b64 v247,v[204:205],v[214:215] offset0:103 offset1:120
M v[36:39],a[156:159],a[140:143],v[36:39]
buffer_load_dwordx2 v[198:199],v245,s[8:11],s28 offen offset:768
M v[36:39],a[136:139],a[120:123],v[36:39]
v_sub_f32 v243,v243,v241
v_fma_f32 v241,-4.0,v240,v242
M v[36:39],a[116:119],a[100:103],v[36:39]
ds_write2st64_b64 v247,v[206:207],v[208:209] offset0:35 offset1:52
M v[40:43],a[116:119],a[120:123],v[40:43]
buffer_load_dwordx2 v[200:201],v245,s[8:11],s28 offen offset:1152
M v[40:43],a[136:139],a[140:143],v[40:43]
s_waitcnt lgkmcnt(3)
s_add_u32 s28,s66,7471104
ds_read_b128 a[168:171],v248 offset:18944
ds_read_b128 a[172:175],v249 offset:18944
M v[40:43],a[156:159],a[160:163],v[40:43]
s_waitcnt lgkmcnt(4)
ds_write2st64_b64 v247,v[210:211],v[212:213] offset0:69 offset1:86
M v[44:47],a[156:159],a[164:167],v[44:47]
v_sub_f32 v242,v242,v240
v_add_f32 v240,v232,v241
M v[44:47],a[136:139],a[160:163],v[44:47]
buffer_load_dwordx2 v[204:205],v245,s[12:15],s28 offen offset:0
M v[44:47],a[116:119],a[140:143],v[44:47]
v_sub_f32 v232,v232,v241
v_fma_f32 v241,2.0,v242,v243
M v[48:51],a[116:119],a[160:163],v[48:51]
ds_read_b128 a[176:179],v249 offset:19456
v_fmac_f32 v243,-2.0,v242
M v[48:51],a[136:139],a[164:167],v[48:51]
s_waitcnt lgkmcnt(3)
ds_read_b128 a[180:183],v248 offset:19456
v_cvt_pk_bf16_f32 v233,v239,v244
M v[48:51],a[156:159],a[168:171],v[48:51]
s_waitcnt lgkmcnt(3)
buffer_load_dwordx2 v[214:215],v245,s[16:19],s28 offen offset:1536
M v[52:55],a[156:159],a[172:175],v[52:55]
v_cvt_pk_bf16_f32 v234,v240,v232
v_cvt_pk_bf16_f32 v235,v241,v243
M v[52:55],a[136:139],a[168:171],v[52:55]
ds_write_b16 v252,v233 offset:52224
M v[52:55],a[116:119],a[164:167],v[52:55]
ds_write_b16_d16_hi v252,v233 offset:60928
M v[56:59],a[116:119],a[168:171],v[56:59]
buffer_load_dwordx2 v[206:207],v245,s[8:11],s28 offen offset:0
M v[56:59],a[136:139],a[172:175],v[56:59]
s_waitcnt lgkmcnt(3)
ds_write_b16 v252,v234 offset:17408
M v[56:59],a[156:159],a[176:179],v[56:59]
s_waitcnt lgkmcnt(3)
ds_write_b16_d16_hi v252,v234 offset:26112
M v[60:63],a[156:159],a[180:183],v[60:63]
ds_write_b16 v252,v235 offset:34816
M v[60:63],a[136:139],a[176:179],v[60:63]
buffer_load_dwordx2 v[208:209],v245,s[8:11],s28 offen offset:384
M v[60:63],a[116:119],a[172:175],v[60:63]
s_waitcnt vmcnt(31)
ds_write_b16_d16_hi v252,v235 offset:43520
M v[64:67],a[184:187],a[96:99],v[64:67]
s_waitcnt vmcnt(30)
M v[64:67],a[224:227],a[100:103],v[64:67]
s_waitcnt vmcnt(29)
M v[64:67],a[248:251],a[120:123],v[64:67]
buffer_load_dwordx2 v[210:211],v245,s[8:11],s28 offen offset:768
M v[68:71],a[248:251],a[140:143],v[68:71]
M v[68:71],a[224:227],a[120:123],v[68:71]
M v[68:71],a[184:187],a[100:103],v[68:71]
M v[72:75],a[184:187],a[120:123],v[72:75]
buffer_load_dwordx2 v[212:213],v245,s[8:11],s28 offen offset:1152
M v[72:75],a[224:227],a[140:143],v[72:75]
s_add_u32 s29,s67,6291456
M v[72:75],a[248:251],a[160:163],v[72:75]
M v[76:79],a[248:251],a[164:167],v[76:79]
M v[76:79],a[224:227],a[160:163],v[76:79]
buffer_load_short_d16_hi v239,v246,s[12:15],s29 offen offset:0
M v[76:79],a[184:187],a[140:143],v[76:79]
M v[80:83],a[184:187],a[160:163],v[80:83]
buffer_load_short_d16_hi v240,v246,s[8:11],s29 offen offset:0
M v[80:83],a[224:227],a[164:167],v[80:83]
s_waitcnt vmcnt(10)
v_lshlrev_b32 v234,16,v196
v_lshlrev_b32 v232,16,v192
M v[80:83],a[248:251],a[168:171],v[80:83]
buffer_load_short_d16_hi v241,v246,s[8:11],s29 offen offset:384
M v[84:87],a[248:251],a[172:175],v[84:87]
v_lshlrev_b32 v233,16,v194
v_lshlrev_b32 v237,16,v202
M v[84:87],a[224:227],a[168:171],v[84:87]
buffer_load_short_d16_hi v242,v246,s[8:11],s29 offen offset:768
M v[84:87],a[184:187],a[164:167],v[84:87]
ds_read_b128 a[96:99],v248 offset:34816
ds_read_b128 a[100:103],v249 offset:34816
M v[88:91],a[184:187],a[168:171],v[88:91]
buffer_load_short_d16_hi v243,v246,s[8:11],s29 offen offset:1152
M v[88:91],a[224:227],a[172:175],v[88:91]
ds_read_b128 a[120:123],v248 offset:35328
ds_read_b128 a[140:143],v249 offset:35328
M v[88:91],a[248:251],a[176:179],v[88:91]
buffer_load_short_d16_hi v244,v246,s[16:19],s29 offen offset:1536
M v[92:95],a[248:251],a[180:183],v[92:95]
s_waitcnt vmcnt(12)
v_lshlrev_b32 v236,16,v200
v_lshlrev_b32 v235,16,v198
M v[92:95],a[224:227],a[176:179],v[92:95]
buffer_load_dwordx4 a[104:107],v250,s[20:23],s47 offen offset:0 sc1
M v[92:95],a[184:187],a[172:175],v[92:95]
s_waitcnt lgkmcnt(3)
v_fmac_f32 v232,s43,v234
v_fmac_f32 v237,4.0,v233
M v[32:35],a[108:111],a[96:99],v[32:35]
s_waitcnt lgkmcnt(2)
ds_read_b128 a[160:163],v248 offset:35840
v_fma_f32 v238,-4.0,v234,v236
M v[32:35],a[132:135],a[100:103],v[32:35]
s_waitcnt lgkmcnt(2)
ds_read_b128 a[164:167],v249 offset:35840
v_fmac_f32 v232,s45,v236
M v[32:35],a[148:151],a[120:123],v[32:35]
s_waitcnt lgkmcnt(2)
buffer_store_dwordx4 a[92:95],v253,s[24:27],s34 offen offset:640 nt
M v[36:39],a[148:151],a[140:143],v[36:39]
s_add_u32 s34,s33,0
v_fmac_f32 v237,s41,v235
v_sub_f32 v236,v236,v234
M v[36:39],a[132:135],a[120:123],v[36:39]
v_fma_f32 v234,-4.0,v233,v235
v_sub_f32 v235,v235,v233
M v[36:39],a[108:111],a[100:103],v[36:39]
buffer_load_dwordx4 a[128:131],v250,s[20:23],s47 offen offset:1024 sc1
M v[40:43],a[108:111],a[120:123],v[40:43]
ds_read_b128 a[168:171],v248 offset:36352
v_add_f32 v233,v238,v234
M v[40:43],a[132:135],a[140:143],v[40:43]
s_waitcnt lgkmcnt(2)
ds_read_b128 a[172:175],v249 offset:36352
v_sub_f32 v238,v238,v234
M v[40:43],a[148:151],a[160:163],v[40:43]
s_waitcnt lgkmcnt(2)
v_fma_f32 v234,2.0,v235,v236
v_fmac_f32 v236,-2.0,v235
M v[44:47],a[148:151],a[164:167],v[44:47]
buffer_load_dwordx4 a[152:155],v250,s[20:23],s47 offen offset:2048 sc1
M v[44:47],a[132:135],a[160:163],v[44:47]
s_add_u32 s48,s77,6144
v_and_b32 v196,s42,v196
v_and_b32 v192,s42,v192
M v[44:47],a[108:111],a[140:143],v[44:47]
v_and_b32 v194,s42,v194
v_and_b32 v202,s42,v202
M v[48:51],a[108:111],a[160:163],v[48:51]
ds_read_b128 a[176:179],v249 offset:36864
v_and_b32 v200,s42,v200
M v[48:51],a[132:135],a[164:167],v[48:51]
s_waitcnt lgkmcnt(2)
buffer_load_dwordx4 v[224:227],v250,s[20:23],s48 offen offset:0 sc1
M v[48:51],a[148:151],a[168:171],v[48:51]
s_waitcnt lgkmcnt(1)
ds_read_b128 a[180:183],v248 offset:36864
v_and_b32 v198,s42,v198
M v[52:55],a[148:151],a[172:175],v[52:55]
v_fmac_f32 v192,s43,v196
v_fmac_f32 v202,4.0,v194
M v[52:55],a[132:135],a[168:171],v[52:55]
v_fma_f32 v235,-4.0,v196,v200
v_fmac_f32 v192,s45,v200
M v[52:55],a[108:111],a[164:167],v[52:55]
buffer_store_dwordx4 v[96:99],v253,s[24:27],s34 offen offset:1152 nt
M v[56:59],a[108:111],a[168:171],v[56:59]
s_add_u32 s34,s33,393216
v_fmac_f32 v202,s41,v198
v_sub_f32 v200,v200,v196
M v[56:59],a[132:135],a[172:175],v[56:59]
s_waitcnt lgkmcnt(1)
v_fma_f32 v196,-4.0,v194,v198
v_sub_f32 v198,v198,v194
M v[56:59],a[148:151],a[176:179],v[56:59]
s_waitcnt lgkmcnt(0)
buffer_load_dwordx4 a[232:235],v250,s[20:23],s48 offen offset:1024 sc1
M v[60:63],a[148:151],a[180:183],v[60:63]
v_add_f32 v194,v235,v196
v_sub_f32 v235,v235,v196
M v[60:63],a[132:135],a[176:179],v[60:63]
v_fma_f32 v196,2.0,v198,v200
v_fmac_f32 v200,-2.0,v198
M v[60:63],a[108:111],a[172:175],v[60:63]
v_cvt_pk_bf16_f32 v192,v232,v192
v_cvt_pk_bf16_f32 v202,v237,v202
M v[64:67],a[188:191],a[96:99],v[64:67]
buffer_load_dwordx4 a[236:239],v250,s[20:23],s48 offen offset:2048 sc1
M v[64:67],a[252:255],a[100:103],v[64:67]
s_add_u32 s48,s72,52224
v_cvt_pk_bf16_f32 v194,v233,v194
v_cvt_pk_bf16_f32 v198,v234,v196
M v[64:67],a[244:247],a[120:123],v[64:67]
v_cvt_pk_bf16_f32 v196,v238,v235
v_cvt_pk_bf16_f32 v200,v236,v200
M v[68:71],a[244:247],a[140:143],v[68:71]
v_lshlrev_b32 v234,16,v197
v_lshlrev_b32 v232,16,v193
M v[68:71],a[252:255],a[120:123],v[68:71]
buffer_load_dwordx4 a[116:119],v250,s[20:23],s48 offen offset:0 sc1
M v[68:71],a[188:191],a[100:103],v[68:71]
v_lshlrev_b32 v233,16,v195
v_lshlrev_b32 v237,16,v203
M v[72:75],a[188:191],a[120:123],v[72:75]
v_lshlrev_b32 v236,16,v201
v_lshlrev_b32 v235,16,v199
M v[72:75],a[252:255],a[140:143],v[72:75]
v_fmac_f32 v232,s43,v234
v_fmac_f32 v237,4.0,v233
M v[72:75],a[244:247],a[160:163],v[72:75]
buffer_store_dwordx4 v[104:107],v253,s[24:27],s34 offen offset:1152 nt
M v[76:79],a[244:247],a[164:167],v[76:79]
s_add_u32 s34,s33,786432
v_fma_f32 v238,-4.0,v234,v236
v_fmac_f32 v232,s45,v236
M v[76:79],a[252:255],a[160:163],v[76:79]
v_fmac_f32 v237,s41,v235
v_sub_f32 v236,v236,v234
M v[76:79],a[188:191],a[140:143],v[76:79]
buffer_load_dwordx4 a[136:139],v250,s[20:23],s48 offen offset:1024 sc1
M v[80:83],a[188:191],a[160:163],v[80:83]
v_fma_f32 v234,-4.0,v233,v235
v_sub_f32 v235,v235,v233
M v[80:83],a[252:255],a[164:167],v[80:83]
v_add_f32 v233,v238,v234
v_sub_f32 v238,v238,v234
M v[80:83],a[244:247],a[168:171],v[80:83]
v_fma_f32 v234,2.0,v235,v236
v_fmac_f32 v236,-2.0,v235
M v[84:87],a[244:247],a[172:175],v[84:87]
buffer_load_dwordx4 a[156:159],v250,s[20:23],s48 offen offset:2048 sc1
M v[84:87],a[252:255],a[168:171],v[84:87]
s_add_u32 s48,s73,52224
ds_read_b128 a[96:99],v248 offset:52224
v_and_b32 v197,s42,v197
M v[84:87],a[188:191],a[164:167],v[84:87]
ds_read_b128 a[100:103],v249 offset:52224
v_and_b32 v193,s42,v193
M v[88:91],a[188:191],a[168:171],v[88:91]
ds_read_b128 a[120:123],v248 offset:52736
v_and_b32 v195,s42,v195
M v[88:91],a[252:255],a[172:175],v[88:91]
buffer_load_dwordx4 a[184:187],v250,s[20:23],s48 offen offset:0 sc1
M v[88:91],a[244:247],a[176:179],v[88:91]
ds_read_b128 a[140:143],v249 offset:52736
v_and_b32 v203,s42,v203
M v[92:95],a[244:247],a[180:183],v[92:95]
v_and_b32 v201,s42,v201
v_and_b32 v199,s42,v199
M v[92:95],a[252:255],a[176:179],v[92:95]
v_fmac_f32 v193,s43,v197
v_fmac_f32 v203,4.0,v195
M v[92:95],a[188:191],a[172:175],v[92:95]
s_waitcnt lgkmcnt(3)
buffer_store_dwordx4 v[112:115],v253,s[24:27],s34 offen offset:1152 nt
M v[32:35],a[112:115],a[96:99],v[32:35]
s_waitcnt lgkmcnt(2)
s_add_u32 s34,s33,1179648
ds_read_b128 a[160:163],v248 offset:53248
v_fma_f32 v235,-4.0,v197,v201
M v[32:35],a[124:127],a[100:103],v[32:35]
s_waitcnt lgkmcnt(2)
ds_read_b128 a[164:167],v249 offset:53248
v_fmac_f32 v193,s45,v201
M v[32:35],a[144:147],a[120:123],v[32:35]
s_waitcnt lgkmcnt(2)
buffer_store_dwordx4 v[120:123],v253,s[24:27],s34 offen offset:1152 nt
M v[36:39],a[144:147],a[140:143],v[36:39]
s_add_u32 s34,s33,0
v_fmac_f32 v203,s41,v199
v_sub_f32 v201,v201,v197
M v[36:39],a[124:127],a[120:123],v[36:39]
v_fma_f32 v197,-4.0,v195,v199
v_sub_f32 v199,v199,v195
M v[36:39],a[112:115],a[100:103],v[36:39]
buffer_load_dwordx4 a[228:231],v250,s[20:23],s48 offen offset:1024 sc1
M v[40:43],a[112:115],a[120:123],v[40:43]
ds_read_b128 a[168:171],v248 offset:53760
v_add_f32 v195,v235,v197
M v[40:43],a[124:127],a[140:143],v[40:43]
s_waitcnt lgkmcnt(2)
ds_read_b128 a[172:175],v249 offset:53760
v_sub_f32 v235,v235,v197
M v[40:43],a[144:147],a[160:163],v[40:43]
s_waitcnt lgkmcnt(2)
v_fma_f32 v197,2.0,v199,v201
v_fmac_f32 v201,-2.0,v199
M v[44:47],a[144:147],a[164:167],v[44:47]
buffer_load_dwordx4 v[228:231],v250,s[20:23],s48 offen offset:2048 sc1
M v[44:47],a[124:127],a[160:163],v[44:47]
s_add_u32 s48,s74,52224
v_cvt_pk_bf16_f32 v193,v232,v193
v_cvt_pk_bf16_f32 v203,v237,v203
M v[44:47],a[112:115],a[140:143],v[44:47]
v_cvt_pk_bf16_f32 v195,v233,v195
v_cvt_pk_bf16_f32 v199,v234,v197
M v[48:51],a[112:115],a[160:163],v[48:51]
ds_read_b128 a[176:179],v249 offset:54272
v_cvt_pk_bf16_f32 v197,v238,v235
M v[48:51],a[124:127],a[164:167],v[48:51]
s_waitcnt lgkmcnt(2)
buffer_load_dwordx4 a[108:111],v250,s[20:23],s48 offen offset:0 sc1
M v[48:51],a[144:147],a[168:171],v[48:51]
s_waitcnt lgkmcnt(1)
ds_read_b128 a[180:183],v248 offset:54272
v_cvt_pk_bf16_f32 v201,v236,v201
M v[52:55],a[144:147],a[172:175],v[52:55]
s_waitcnt vmcnt(26)
v_lshlrev_b32 v234,16,v208
v_lshlrev_b32 v232,16,v204
M v[52:55],a[124:127],a[168:171],v[52:55]
v_lshlrev_b32 v233,16,v206
v_lshlrev_b32 v237,16,v214
M v[52:55],a[112:115],a[164:167],v[52:55]
ds_write2st64_b64 v247,v[192:193],v[202:203] offset0:104 offset1:121
M v[56:59],a[112:115],a[168:171],v[56:59]
s_add_u32 s28,s67,6291456
buffer_load_dwordx2 v[192:193],v245,s[12:15],s28 offen offset:0
M v[56:59],a[124:127],a[172:175],v[56:59]
s_waitcnt vmcnt(25) lgkmcnt(2)
v_lshlrev_b32 v236,16,v212
v_lshlrev_b32 v235,16,v210
M v[56:59],a[144:147],a[176:179],v[56:59]
s_waitcnt lgkmcnt(1)
buffer_load_dwordx2 v[202:203],v245,s[16:19],s28 offen offset:1536
M v[60:63],a[144:147],a[180:183],v[60:63]
v_fmac_f32 v232,s43,v234
v_fmac_f32 v237,4.0,v233
M v[60:63],a[124:127],a[176:179],v[60:63]
v_fma_f32 v238,-4.0,v234,v236
v_fmac_f32 v232,s45,v236
M v[60:63],a[112:115],a[172:175],v[60:63]
ds_write2st64_b64 v247,v[194:195],v[196:197] offset0:36 offset1:53
M v[64:67],a[216:219],a[96:99],v[64:67]
buffer_load_dwordx2 v[194:195],v245,s[8:11],s28 offen offset:0
M v[64:67],a[196:199],a[100:103],v[64:67]
v_fmac_f32 v237,s41,v235
v_sub_f32 v236,v236,v234
M v[64:67],v[220:223],a[120:123],v[64:67]
ds_write2st64_b64 v247,v[198:199],v[200:201] offset0:70 offset1:87
M v[68:71],v[220:223],a[140:143],v[68:71]
buffer_load_dwordx2 v[196:197],v245,s[8:11],s28 offen offset:384
M v[68:71],a[196:199],a[120:123],v[68:71]
v_fma_f32 v234,-4.0,v233,v235
v_sub_f32 v235,v235,v233
M v[68:71],a[216:219],a[100:103],v[68:71]
v_add_f32 v233,v238,v234
v_sub_f32 v238,v238,v234
M v[72:75],a[216:219],a[120:123],v[72:75]
v_fma_f32 v234,2.0,v235,v236
v_fmac_f32 v236,-2.0,v235
M v[72:75],a[196:199],a[140:143],v[72:75]
buffer_load_dwordx2 v[198:199],v245,s[8:11],s28 offen offset:768
M v[72:75],v[220:223],a[160:163],v[72:75]
v_and_b32 v208,s42,v208
v_and_b32 v204,s42,v204
M v[76:79],v[220:223],a[164:167],v[76:79]
v_and_b32 v206,s42,v206
v_and_b32 v214,s42,v214
M v[76:79],a[196:199],a[160:163],v[76:79]
v_and_b32 v212,s42,v212
v_and_b32 v210,s42,v210
M v[76:79],a[216:219],a[140:143],v[76:79]
buffer_load_dwordx2 v[200:201],v245,s[8:11],s28 offen offset:1152
M v[80:83],a[216:219],a[160:163],v[80:83]
v_fmac_f32 v204,s43,v208
v_fmac_f32 v214,4.0,v206
M v[80:83],a[196:199],a[164:167],v[80:83]
v_add_u32 v248,0xfffece00,v248
v_add_u32 v249,0xfffece00,v249
M v[80:83],v[220:223],a[168:171],v[80:83]
v_fma_f32 v235,-4.0,v208,v212
v_fmac_f32 v204,s45,v212
M v[84:87],v[220:223],a[172:175],v[84:87]
buffer_load_dwordx4 a[132:135],v250,s[20:23],s48 offen offset:1024 sc1
M v[84:87],a[196:199],a[168:171],v[84:87]
ds_read_b128 a[96:99],v248 offset:60928
v_fmac_f32 v214,s41,v210
M v[84:87],a[216:219],a[164:167],v[84:87]
ds_read_b128 a[100:103],v249 offset:60928
v_sub_f32 v212,v212,v208
M v[88:91],a[216:219],a[168:171],v[88:91]
ds_read_b128 a[120:123],v248 offset:61440
v_fma_f32 v208,-4.0,v206,v210
M v[88:91],a[196:199],a[172:175],v[88:91]
buffer_load_dwordx4 a[148:151],v250,s[20:23],s48 offen offset:2048 sc1
M v[88:91],v[220:223],a[176:179],v[88:91]
s_add_u32 s48,s75,52224
ds_read_b128 a[140:143],v249 offset:61440
v_sub_f32 v210,v210,v206
M v[92:95],v[220:223],a[180:183],v[92:95]
v_add_f32 v206,v235,v208
v_sub_f32 v235,v235,v208
M v[92:95],a[196:199],a[176:179],v[92:95]
v_fma_f32 v208,2.0,v210,v212
v_fmac_f32 v212,-2.0,v210
M v[92:95],a[216:219],a[172:175],v[92:95]
s_waitcnt vmcnt(25) lgkmcnt(3)
buffer_store_dwordx4 v[128:131],v253,s[24:27],s34 offen offset:1280 nt
M v[32:35],a[104:107],a[96:99],v[32:35]
s_waitcnt vmcnt(24) lgkmcnt(2)
s_add_u32 s34,s33,393216
ds_read_b128 a[160:163],v248 offset:61952
v_cvt_pk_bf16_f32 v204,v232,v204
M v[32:35],a[128:131],a[100:103],v[32:35]
s_waitcnt vmcnt(23) lgkmcnt(2)
ds_read_b128 a[164:167],v249 offset:61952
v_cvt_pk_bf16_f32 v214,v237,v214
M v[32:35],a[152:155],a[120:123],v[32:35]
s_waitcnt lgkmcnt(2)
buffer_store_dwordx4 v[136:139],v253,s[24:27],s34 offen offset:1280 nt
M v[36:39],a[152:155],a[140:143],v[36:39]
s_add_u32 s34,s33,786432
v_cvt_pk_bf16_f32 v206,v233,v206
v_cvt_pk_bf16_f32 v210,v234,v208
M v[36:39],a[128:131],a[120:123],v[36:39]
v_cvt_pk_bf16_f32 v208,v238,v235
v_cvt_pk_bf16_f32 v212,v236,v212
M v[36:39],a[104:107],a[100:103],v[36:39]
buffer_load_dwordx4 a[188:191],v250,s[20:23],s48 offen offset:0 sc1
M v[40:43],a[104:107],a[120:123],v[40:43]
ds_read_b128 a[168:171],v248 offset:62464
v_lshlrev_b32 v234,16,v209
M v[40:43],a[128:131],a[140:143],v[40:43]
s_waitcnt lgkmcnt(2)
ds_read_b128 a[172:175],v249 offset:62464
v_lshlrev_b32 v232,16,v205
M v[40:43],a[152:155],a[160:163],v[40:43]
s_waitcnt lgkmcnt(2)
v_lshlrev_b32 v233,16,v207
v_lshlrev_b32 v237,16,v215
M v[44:47],a[152:155],a[164:167],v[44:47]
buffer_load_dwordx4 a[192:195],v250,s[20:23],s48 offen offset:1024 sc1
M v[44:47],a[128:131],a[160:163],v[44:47]
v_lshlrev_b32 v236,16,v213
v_lshlrev_b32 v235,16,v211
M v[44:47],a[104:107],a[140:143],v[44:47]
v_fmac_f32 v232,s43,v234
v_fmac_f32 v237,4.0,v233
M v[48:51],a[104:107],a[160:163],v[48:51]
ds_read_b128 a[176:179],v249 offset:62976
v_fma_f32 v238,-4.0,v234,v236
M v[48:51],a[128:131],a[164:167],v[48:51]
s_waitcnt lgkmcnt(2)
buffer_load_dwordx4 v[216:219],v250,s[20:23],s48 offen offset:2048 sc1
M v[48:51],a[152:155],a[168:171],v[48:51]
s_waitcnt lgkmcnt(1)
s_add_u32 s48,s76,52224
ds_read_b128 a[180:183],v248 offset:62976
v_fmac_f32 v232,s45,v236
M v[52:55],a[152:155],a[172:175],v[52:55]
v_fmac_f32 v237,s41,v235
v_sub_f32 v236,v236,v234
M v[52:55],a[128:131],a[168:171],v[52:55]
v_fma_f32 v234,-4.0,v233,v235
v_sub_f32 v235,v235,v233
M v[52:55],a[104:107],a[164:167],v[52:55]
buffer_store_dwordx4 v[144:147],v253,s[24:27],s34 offen offset:1280 nt
M v[56:59],a[104:107],a[168:171],v[56:59]
s_add_u32 s34,s33,1179648
v_add_f32 v233,v238,v234
v_sub_f32 v238,v238,v234
M v[56:59],a[128:131],a[172:175],v[56:59]
s_waitcnt lgkmcnt(1)
v_fma_f32 v234,2.0,v235,v236
v_fmac_f32 v236,-2.0,v235
M v[56:59],a[152:155],a[176:179],v[56:59]
s_waitcnt lgkmcnt(0)
buffer_store_dwordx4 v[152:155],v253,s[24:27],s34 offen offset:1280 nt
M v[60:63],a[152:155],a[180:183],v[60:63]
v_and_b32 v209,s42,v209
v_and_b32 v205,s42,v205
M v[60:63],a[128:131],a[176:179],v[60:63]
v_and_b32 v207,s42,v207
v_and_b32 v215,s42,v215
M v[60:63],a[104:107],a[172:175],v[60:63]
s_waitcnt vmcnt(28)
buffer_load_dwordx4 a[112:115],v250,s[20:23],s48 offen offset:0 sc1
M v[64:67],v[224:227],a[96:99],v[64:67]
s_waitcnt vmcnt(27)
v_and_b32 v213,s42,v213
v_and_b32 v211,s42,v211
M v[64:67],a[232:235],a[100:103],v[64:67]
s_waitcnt vmcnt(26)
v_fmac_f32 v205,s43,v209
v_fmac_f32 v215,4.0,v207
M v[64:67],a[236:239],a[120:123],v[64:67]
v_fma_f32 v235,-4.0,v209,v213
v_fmac_f32 v205,s45,v213
M v[68:71],a[236:239],a[140:143],v[68:71]
buffer_load_dwordx4 a[124:127],v250,s[20:23],s48 offen offset:1024 sc1
M v[68:71],a[232:235],a[120:123],v[68:71]
v_fmac_f32 v215,s41,v211
v_sub_f32 v213,v213,v209
M v[68:71],v[224:227],a[100:103],v[68:71]
v_fma_f32 v209,-4.0,v207,v211
v_sub_f32 v211,v211,v207
M v[72:75],v[224:227],a[120:123],v[72:75]
v_add_f32 v207,v235,v209
v_sub_f32 v235,v235,v209
M v[72:75],a[232:235],a[140:143],v[72:75]
buffer_load_dwordx4 a[144:147],v250,s[20:23],s48 offen offset:2048 sc1
M v[72:75],a[236:239],a[160:163],v[72:75]
s_add_u32 s48,s77,52224
v_fma_f32 v209,2.0,v211,v213
v_fmac_f32 v213,-2.0,v211
M v[76:79],a[236:239],a[164:167],v[76:79]
v_cvt_pk_bf16_f32 v205,v232,v205
v_cvt_pk_bf16_f32 v215,v237,v215
M v[76:79],a[232:235],a[160:163],v[76:79]
v_cvt_pk_bf16_f32 v207,v233,v207
v_cvt_pk_bf16_f32 v211,v234,v209
M v[76:79],v[224:227],a[140:143],v[76:79]
buffer_load_dwordx4 a[240:243],v250,s[20:23],s48 offen offset:0 sc1
M v[80:83],v[224:227],a[160:163],v[80:83]
v_cvt_pk_bf16_f32 v209,v238,v235
v_cvt_pk_bf16_f32 v213,v236,v213
M v[80:83],a[232:235],a[164:167],v[80:83]
s_barrier
v_cvt_pk_bf16_f32 v32,v32,v33
M v[80:83],a[236:239],a[168:171],v[80:83]
ds_write2st64_b64 v247,v[204:205],v[214:215] offset0:105 offset1:122
M v[84:87],a[236:239],a[172:175],v[84:87]
s_add_u32 s28,s67,6684672
buffer_load_dwordx2 v[204:205],v245,s[12:15],s28 offen offset:0
M v[84:87],a[232:235],a[168:171],v[84:87]
ds_read_b128 a[96:99],v248 offset:0
v_cvt_pk_bf16_f32 v33,v34,v35
M v[84:87],v[224:227],a[164:167],v[84:87]
ds_write2st64_b64 v247,v[206:207],v[208:209] offset0:37 offset1:54
M v[88:91],v[224:227],a[168:171],v[88:91]
buffer_load_dwordx2 v[214:215],v245,s[16:19],s28 offen offset:1536
M v[88:91],a[232:235],a[172:175],v[88:91]
ds_read_b128 a[100:103],v249 offset:0
ds_read_b128 a[120:123],v248 offset:512
M v[88:91],a[236:239],a[176:179],v[88:91]
ds_write2st64_b64 v247,v[210:211],v[212:213] offset0:71 offset1:88
M v[92:95],a[236:239],a[180:183],v[92:95]
buffer_load_dwordx2 v[206:207],v245,s[8:11],s28 offen offset:0
M v[92:95],a[232:235],a[176:179],v[92:95]
ds_read_b128 a[140:143],v249 offset:512
v_cvt_pk_bf16_f32 v36,v36,v37
M v[92:95],v[224:227],a[172:175],v[92:95]
s_waitcnt vmcnt(31) lgkmcnt(5)
v_cvt_pk_bf16_f32 v37,v38,v39
M v[160:163],a[116:119],a[96:99],v[160:163]
s_waitcnt vmcnt(29) lgkmcnt(3)
ds_read_b128 a[96:99],v248 offset:1024
ds_write2st64_b64 v254,v[32:33],v[36:37] offset0:0 offset1:4
M v[160:163],a[136:139],a[100:103],v[160:163]
s_waitcnt vmcnt(28) lgkmcnt(4)
buffer_load_dwordx2 v[208:209],v245,s[8:11],s28 offen offset:384
M v[160:163],a[156:159],a[120:123],v[160:163]
s_waitcnt lgkmcnt(2)
ds_read_b128 a[160:163],v249 offset:1024
v_cvt_pk_bf16_f32 v40,v40,v41
M v[164:167],a[156:159],a[140:143],v[164:167]
v_cvt_pk_bf16_f32 v41,v42,v43
v_cvt_pk_bf16_f32 v44,v44,v45
M v[164:167],a[136:139],a[120:123],v[164:167]
buffer_load_dwordx2 v[210:211],v245,s[8:11],s28 offen offset:768
M v[164:167],a[116:119],a[100:103],v[164:167]
v_cvt_pk_bf16_f32 v45,v46,v47
M v[168:171],a[116:119],a[120:123],v[168:171]
ds_read_b128 a[100:103],v248 offset:1536
ds_write2st64_b64 v254,v[40:41],v[44:45] offset0:8 offset1:12
M v[168:171],a[136:139],a[140:143],v[168:171]
s_waitcnt lgkmcnt(4)
buffer_load_dwordx2 v[212:213],v245,s[8:11],s28 offen offset:1152
M v[168:171],a[156:159],a[96:99],v[168:171]
s_waitcnt lgkmcnt(2)
ds_read_b128 a[120:123],v249 offset:1536
v_cvt_pk_bf16_f32 v48,v48,v49
M v[172:175],a[156:159],a[160:163],v[172:175]
v_cvt_pk_bf16_f32 v49,v50,v51
v_cvt_pk_bf16_f32 v52,v52,v53
M v[172:175],a[136:139],a[96:99],v[172:175]
v_cvt_pk_bf16_f32 v53,v54,v55
M v[172:175],a[116:119],a[140:143],v[172:175]
buffer_load_dwordx4 a[220:223],v250,s[20:23],s48 offen offset:1024 sc1
M v[176:179],a[116:119],a[96:99],v[176:179]
ds_read_b128 a[96:99],v249 offset:2048
ds_write2st64_b64 v254,v[48:49],v[52:53] offset0:136 offset1:140
M v[176:179],a[136:139],a[160:163],v[176:179]
s_waitcnt lgkmcnt(4)
ds_read_b128 a[140:143],v248 offset:2048
v_add_u32 v248,0x15400,v248
M v[176:179],a[156:159],a[100:103],v[176:179]
s_waitcnt lgkmcnt(3)
buffer_load_dwordx4 a[204:207],v250,s[20:23],s48 offen offset:2048 sc1
M v[180:183],a[156:159],a[120:123],v[180:183]
s_add_u32 s46,s72,9216
v_add_u32 v249,0x15400,v249
v_cvt_pk_bf16_f32 v56,v56,v57
M v[180:183],a[136:139],a[100:103],v[180:183]
ds_read_b128 a[164:167],v248 offset:0
v_cvt_pk_bf16_f32 v57,v58,v59
M v[180:183],a[116:119],a[160:163],v[180:183]
ds_read_b128 a[160:163],v249 offset:0
v_cvt_pk_bf16_f32 v60,v60,v61
M v[184:187],a[116:119],a[100:103],v[184:187]
buffer_load_dwordx4 a[104:107],v250,s[20:23],s46 offen offset:0 sc1
M v[184:187],a[136:139],a[120:123],v[184:187]
s_waitcnt lgkmcnt(4)
ds_read_b128 a[168:171],v248 offset:512
ds_read_b128 a[176:179],v249 offset:512
M v[184:187],a[156:159],a[96:99],v[184:187]
s_waitcnt lgkmcnt(4)
v_cvt_pk_bf16_f32 v61,v62,v63
M v[188:191],a[156:159],a[140:143],v[188:191]
ds_write2st64_b64 v254,v[56:57],v[60:61] offset0:144 offset1:148
M v[188:191],a[136:139],a[96:99],v[188:191]
buffer_load_dwordx4 a[128:131],v250,s[20:23],s46 offen offset:1024 sc1
M v[188:191],a[116:119],a[120:123],v[188:191]
s_waitcnt vmcnt(34) lgkmcnt(4)
v_cvt_pk_bf16_f32 v64,v64,v65
v_cvt_pk_bf16_f32 v65,v66,v67
M v[160:163],a[184:187],a[164:167],v[160:163]
s_waitcnt vmcnt(31) lgkmcnt(3)
ds_read_b128 a[96:99],v248 offset:1024
v_cvt_pk_bf16_f32 v68,v68,v69
M v[160:163],a[228:231],a[160:163],v[160:163]
s_waitcnt vmcnt(30) lgkmcnt(3)
buffer_load_dwordx4 a[152:155],v250,s[20:23],s46 offen offset:2048 sc1
M v[160:163],v[228:231],a[168:171],v[160:163]
s_waitcnt lgkmcnt(2)
s_add_u32 s47,s72,12288
ds_read_b128 a[116:119],v249 offset:1024
v_cvt_pk_bf16_f32 v69,v70,v71
M v[164:167],v[228:231],a[176:179],v[164:167]
ds_write2st64_b64 v254,v[64:65],v[68:69] offset0:170 offset1:174
M v[164:167],a[228:231],a[168:171],v[164:167]
buffer_load_dwordx4 a[100:103],v250,s[20:23],s47 offen offset:0 sc1
M v[164:167],a[184:187],a[160:163],v[164:167]
v_cvt_pk_bf16_f32 v72,v72,v73
v_cvt_pk_bf16_f32 v73,v74,v75
M v[168:171],a[184:187],a[168:171],v[168:171]
ds_read_b128 a[120:123],v248 offset:1536
v_cvt_pk_bf16_f32 v76,v76,v77
M v[168:171],a[228:231],a[176:179],v[168:171]
s_waitcnt lgkmcnt(3)
ds_read_b128 a[136:139],v249 offset:1536
v_cvt_pk_bf16_f32 v77,v78,v79
M v[168:171],v[228:231],a[96:99],v[168:171]
s_waitcnt lgkmcnt(3)
buffer_load_dwordx4 a[172:175],v250,s[20:23],s47 offen offset:1024 sc1
M v[172:175],v[228:231],a[116:119],v[172:175]
ds_write2st64_b64 v254,v[72:73],v[76:77] offset0:178 offset1:182
M v[172:175],a[228:231],a[96:99],v[172:175]
v_cvt_pk_bf16_f32 v80,v80,v81
v_cvt_pk_bf16_f32 v81,v82,v83
M v[172:175],a[184:187],a[176:179],v[172:175]
buffer_load_dwordx4 a[180:183],v250,s[20:23],s47 offen offset:2048 sc1
M v[176:179],a[184:187],a[96:99],v[176:179]
s_add_u32 s48,s72,15360
ds_read_b128 a[96:99],v249 offset:2048
v_cvt_pk_bf16_f32 v84,v84,v85
M v[176:179],a[228:231],a[116:119],v[176:179]
s_waitcnt lgkmcnt(3)
ds_read_b128 a[140:143],v248 offset:2048
v_cvt_pk_bf16_f32 v85,v86,v87
M v[176:179],v[228:231],a[120:123],v[176:179]
s_waitcnt lgkmcnt(3)
ds_write2st64_b64 v254,v[80:81],v[84:85] offset0:204 offset1:208
M v[180:183],v[228:231],a[136:139],v[180:183]
v_cvt_pk_bf16_f32 v88,v88,v89
v_cvt_pk_bf16_f32 v89,v90,v91
M v[180:183],a[228:231],a[120:123],v[180:183]
ds_read_b128 a[156:159],v248 offset:17408
v_cvt_pk_bf16_f32 v92,v92,v93
M v[180:183],a[184:187],a[116:119],v[180:183]
ds_read_b128 a[116:119],v249 offset:17408
v_cvt_pk_bf16_f32 v93,v94,v95
M v[184:187],a[184:187],a[120:123],v[184:187]
buffer_load_dwordx4 a[120:123],v250,s[20:23],s48 offen offset:0 sc1
M v[184:187],a[228:231],a[136:139],v[184:187]
s_waitcnt lgkmcnt(4)
ds_read_b128 a[160:163],v248 offset:17920
ds_read_b128 a[168:171],v249 offset:17920
M v[184:187],v[228:231],a[96:99],v[184:187]
s_waitcnt lgkmcnt(5)
buffer_load_dwordx4 a[164:167],v250,s[20:23],s48 offen offset:1024 sc1
M v[188:191],v[228:231],a[140:143],v[188:191]
ds_write2st64_b64 v254,v[88:89],v[92:93] offset0:212 offset1:216
M v[188:191],a[228:231],a[96:99],v[188:191]
M v[188:191],a[184:187],a[136:139],v[188:191]
s_waitcnt vmcnt(35) lgkmcnt(4)
M v[160:163],a[108:111],a[156:159],v[160:163]
s_waitcnt vmcnt(28) lgkmcnt(0)
s_barrier
ds_read_b128 v[32:35],v250 offset:0
M v[160:163],a[132:135],a[116:119],v[160:163]
s_waitcnt vmcnt(27)
ds_read_b128 v[40:43],v250 offset:4096
ds_read_b128 v[48:51],v4 offset:0
M v[160:163],a[148:151],a[160:163],v[160:163]
ds_read_b128 v[56:59],v4 offset:4096
ds_read_b128 v[64:67],v4 offset:17408
M v[164:167],a[148:151],a[168:171],v[164:167]
ds_read_b128 v[72:75],v4 offset:21504
ds_read_b128 v[80:83],v4 offset:34816
ds_read_b128 a[96:99],v248 offset:18432
M v[164:167],a[132:135],a[160:163],v[164:167]
ds_read_b128 v[88:91],v4 offset:38912
ds_read_b128 a[136:139],v249 offset:18432
M v[164:167],a[108:111],a[116:119],v[164:167]
s_waitcnt lgkmcnt(9)
s_add_u32 s34,s33,0
buffer_store_dwordx4 v[32:35],v253,s[24:27],s34 offen offset:128 nt
M v[168:171],a[108:111],a[160:163],v[168:171]
s_add_u32 s34,s33,393216
buffer_load_dwordx4 a[176:179],v250,s[20:23],s48 offen offset:2048 sc1
M v[168:171],a[132:135],a[168:171],v[168:171]
s_waitcnt lgkmcnt(2)
ds_read_b128 a[116:119],v248 offset:18944
ds_read_b128 a[140:143],v249 offset:18944
M v[168:171],a[148:151],a[96:99],v[168:171]
s_waitcnt lgkmcnt(2)
M v[172:175],a[148:151],a[136:139],v[172:175]
M v[172:175],a[132:135],a[96:99],v[172:175]
M v[172:175],a[108:111],a[168:171],v[172:175]
buffer_store_dwordx4 v[40:43],v253,s[24:27],s34 offen offset:128 nt
M v[176:179],a[108:111],a[96:99],v[176:179]
s_add_u32 s34,s33,786432
ds_read_b128 a[96:99],v249 offset:19456
s_add_u32 s46,s72,18432
M v[176:179],a[132:135],a[136:139],v[176:179]
s_waitcnt lgkmcnt(2)
ds_read_b128 a[156:159],v248 offset:19456
M v[176:179],a[148:151],a[116:119],v[176:179]
s_waitcnt lgkmcnt(2)
buffer_store_dwordx4 v[48:51],v253,s[24:27],s34 offen offset:128 nt
M v[180:183],a[148:151],a[140:143],v[180:183]
s_add_u32 s34,s33,1179648
M v[180:183],a[132:135],a[116:119],v[180:183]
ds_read_b128 a[160:163],v248 offset:34816
M v[180:183],a[108:111],a[136:139],v[180:183]
buffer_store_dwordx4 v[56:59],v253,s[24:27],s34 offen offset:128 nt
M v[184:187],a[108:111],a[116:119],v[184:187]
s_add_u32 s34,s33,0
ds_read_b128 a[136:139],v249 offset:34816
ds_read_b128 a[116:119],v248 offset:35328
M v[184:187],a[132:135],a[140:143],v[184:187]
s_waitcnt lgkmcnt(4)
buffer_load_dwordx4 a[168:171],v250,s[20:23],s46 offen offset:0 sc1
M v[184:187],a[148:151],a[96:99],v[184:187]
s_waitcnt lgkmcnt(3)
ds_read_b128 a[200:203],v249 offset:35328
M v[188:191],a[148:151],a[156:159],v[188:191]
M v[188:191],a[132:135],a[96:99],v[188:191]
M v[188:191],a[108:111],a[140:143],v[188:191]
s_waitcnt vmcnt(30) lgkmcnt(3)
buffer_store_dwordx4 v[64:67],v253,s[24:27],s34 offen offset:256 nt
M v[160:163],a[188:191],a[160:163],v[160:163]
s_waitcnt vmcnt(30) lgkmcnt(2)
s_add_u32 s34,s33,393216
ds_read_b128 a[96:99],v248 offset:35840
M v[160:163],a[192:195],a[136:139],v[160:163]
s_waitcnt vmcnt(29) lgkmcnt(2)
ds_read_b128 a[108:111],v249 offset:35840
M v[160:163],v[216:219],a[116:119],v[160:163]
s_waitcnt lgkmcnt(2)
buffer_store_dwordx4 v[72:75],v253,s[24:27],s34 offen offset:256 nt
M v[164:167],v[216:219],a[200:203],v[164:167]
s_add_u32 s34,s33,786432
M v[164:167],a[192:195],a[116:119],v[164:167]
M v[164:167],a[188:191],a[136:139],v[164:167]
buffer_load_dwordx4 a[184:187],v250,s[20:23],s46 offen offset:1024 sc1
M v[168:171],a[188:191],a[116:119],v[168:171]
ds_read_b128 a[116:119],v248 offset:36352
M v[168:171],a[192:195],a[200:203],v[168:171]
s_waitcnt lgkmcnt(2)
ds_read_b128 a[132:135],v249 offset:36352
M v[168:171],v[216:219],a[96:99],v[168:171]
s_waitcnt lgkmcnt(2)
M v[172:175],v[216:219],a[108:111],v[172:175]
buffer_load_dwordx4 a[208:211],v250,s[20:23],s46 offen offset:2048 sc1
M v[172:175],a[192:195],a[96:99],v[172:175]
M v[172:175],a[188:191],a[200:203],v[172:175]
M v[176:179],a[188:191],a[96:99],v[176:179]
s_add_u32 s47,s72,21504
ds_read_b128 a[96:99],v249 offset:36864
M v[176:179],a[192:195],a[108:111],v[176:179]
s_waitcnt lgkmcnt(2)
ds_read_b128 a[136:139],v248 offset:36864
M v[176:179],v[216:219],a[116:119],v[176:179]
s_waitcnt lgkmcnt(2)
buffer_store_dwordx4 v[80:83],v253,s[24:27],s34 offen offset:256 nt
M v[180:183],v[216:219],a[132:135],v[180:183]
s_add_u32 s34,s33,1179648
M v[180:183],a[192:195],a[116:119],v[180:183]
ds_read_b128 a[140:143],v248 offset:52224
M v[180:183],a[188:191],a[108:111],v[180:183]
buffer_store_dwordx4 v[88:91],v253,s[24:27],s34 offen offset:256 nt
M v[184:187],a[188:191],a[116:119],v[184:187]
ds_read_b128 a[108:111],v249 offset:52224
ds_read_b128 a[116:119],v248 offset:52736
M v[184:187],a[192:195],a[132:135],v[184:187]
s_waitcnt lgkmcnt(4)
buffer_load_dwordx4 a[212:215],v250,s[20:23],s47 offen offset:0 sc1
M v[184:187],v[216:219],a[96:99],v[184:187]
s_waitcnt lgkmcnt(3)
ds_read_b128 a[148:151],v249 offset:52736
M v[188:191],v[216:219],a[136:139],v[188:191]
M v[188:191],a[192:195],a[96:99],v[188:191]
M v[188:191],a[188:191],a[132:135],v[188:191]
s_waitcnt vmcnt(32) lgkmcnt(3)
buffer_load_dwordx4 a[160:163],v250,s[20:23],s47 offen offset:1024 sc1
M v[160:163],a[112:115],a[140:143],v[160:163]
s_waitcnt vmcnt(32) lgkmcnt(2)
ds_read_b128 a[96:99],v248 offset:53248
M v[160:163],a[124:127],a[108:111],v[160:163]
s_waitcnt vmcnt(31) lgkmcnt(2)
ds_read_b128 a[132:135],v249 offset:53248
M v[160:163],a[144:147],a[116:119],v[160:163]
s_waitcnt lgkmcnt(2)
M v[164:167],a[144:147],a[148:151],v[164:167]
buffer_load_dwordx4 a[248:251],v250,s[20:23],s47 offen offset:2048 sc1
M v[164:167],a[124:127],a[116:119],v[164:167]
M v[164:167],a[112:115],a[108:111],v[164:167]
M v[168:171],a[112:115],a[116:119],v[168:171]
ds_read_b128 a[108:111],v248 offset:53760
M v[168:171],a[124:127],a[148:151],v[168:171]
s_waitcnt lgkmcnt(2)
ds_read_b128 a[116:119],v249 offset:53760
M v[168:171],a[144:147],a[96:99],v[168:171]
s_waitcnt lgkmcnt(2)
M v[172:175],a[144:147],a[132:135],v[172:175]
M v[172:175],a[124:127],a[96:99],v[172:175]
M v[172:175],a[112:115],a[148:151],v[172:175]
M v[176:179],a[112:115],a[96:99],v[176:179]
s_add_u32 s48,s72,24576
ds_read_b128 a[96:99],v249 offset:54272
M v[176:179],a[124:127],a[132:135],v[176:179]
s_waitcnt lgkmcnt(2)
ds_read_b128 a[136:139],v248 offset:54272
v_add_u32 v248,0xfffece00,v248
M v[176:179],a[144:147],a[108:111],v[176:179]
s_waitcnt lgkmcnt(2)
v_add_u32 v249,0xfffece00,v249
M v[180:183],a[144:147],a[116:119],v[180:183]
M v[180:183],a[124:127],a[108:111],v[180:183]
ds_read_b128 a[140:143],v248 offset:60928
M v[180:183],a[112:115],a[132:135],v[180:183]
ds_read_b128 a[132:135],v249 offset:60928
M v[184:187],a[112:115],a[108:111],v[184:187]
buffer_load_dwordx4 a[224:227],v250,s[20:23],s48 offen offset:0 sc1
M v[184:187],a[124:127],a[116:119],v[184:187]
s_waitcnt lgkmcnt(3)
ds_read_b128 a[108:111],v248 offset:61440
ds_read_b128 a[148:151],v249 offset:61440
M v[184:187],a[144:147],a[96:99],v[184:187]
s_waitcnt lgkmcnt(4)
buffer_load_dwordx4 a[244:247],v250,s[20:23],s48 offen offset:1024 sc1
M v[188:191],a[144:147],a[136:139],v[188:191]
M v[188:191],a[124:127],a[96:99],v[188:191]
M v[188:191],a[112:115],a[116:119],v[188:191]
s_waitcnt vmcnt(33) lgkmcnt(3)
M v[160:163],a[240:243],a[140:143],v[160:163]
s_waitcnt vmcnt(26) lgkmcnt(2)
buffer_load_dwordx4 a[252:255],v250,s[20:23],s48 offen offset:2048 sc1
M v[160:163],a[220:223],a[132:135],v[160:163]
s_waitcnt vmcnt(26) lgkmcnt(1)
ds_read_b128 a[96:99],v248 offset:61952
ds_read_b128 a[112:115],v249 offset:61952
M v[160:163],a[204:207],a[108:111],v[160:163]
s_waitcnt lgkmcnt(2)
M v[164:167],a[204:207],a[148:151],v[164:167]
M v[164:167],a[220:223],a[108:111],v[164:167]
M v[164:167],a[240:243],a[132:135],v[164:167]
s_nop 3
v_cvt_pk_bf16_f32 v160,v160,v161
v_cvt_pk_bf16_f32 v161,v162,v163
M v[168:171],a[240:243],a[108:111],v[168:171]
ds_read_b128 a[108:111],v248 offset:62464
M v[168:171],a[220:223],a[148:151],v[168:171]
s_waitcnt lgkmcnt(2)
ds_read_b128 a[116:119],v249 offset:62464
M v[168:171],a[204:207],a[96:99],v[168:171]
s_waitcnt lgkmcnt(2)
v_cvt_pk_bf16_f32 v164,v164,v165
v_cvt_pk_bf16_f32 v165,v166,v167
M v[172:175],a[204:207],a[112:115],v[172:175]
M v[172:175],a[220:223],a[96:99],v[172:175]
ds_read_b128 a[124:127],v249 offset:62976
ds_read_b128 a[132:135],v248 offset:62976
M v[172:175],a[240:243],a[148:151],v[172:175]
M v[176:179],a[240:243],a[96:99],v[176:179]
s_add_u32 s46,s72,27648
M v[176:179],a[220:223],a[112:115],v[176:179]
s_waitcnt lgkmcnt(3)
M v[176:179],a[204:207],a[108:111],v[176:179]
s_waitcnt lgkmcnt(0)
s_barrier
ds_write2st64_b64 v254,v[160:161],v[164:165] offset0:221 offset1:225
M v[180:183],a[204:207],a[116:119],v[180:183]
v_cvt_pk_bf16_f32 v168,v168,v169
v_cvt_pk_bf16_f32 v169,v170,v171
M v[180:183],a[220:223],a[108:111],v[180:183]
ds_read_b128 a[96:99],v248 offset:0
v_cvt_pk_bf16_f32 v172,v172,v173
M v[180:183],a[240:243],a[112:115],v[180:183]
ds_read_b128 a[112:115],v249 offset:0
v_cvt_pk_bf16_f32 v173,v174,v175
M v[184:187],a[240:243],a[108:111],v[184:187]
buffer_load_dwordx4 v[220:223],v250,s[20:23],s46 offen offset:0 sc1
M v[184:187],a[220:223],a[116:119],v[184:187]
ds_read_b128 a[108:111],v248 offset:512
ds_read_b128 a[136:139],v249 offset:512
M v[184:187],a[204:207],a[124:127],v[184:187]
ds_write2st64_b64 v254,v[168:169],v[172:173] offset0:229 offset1:233
M v[188:191],a[204:207],a[132:135],v[188:191]
v_cvt_pk_bf16_f32 v176,v176,v177
v_cvt_pk_bf16_f32 v177,v178,v179
M v[188:191],a[220:223],a[124:127],v[188:191]
v_cvt_pk_bf16_f32 v180,v180,v181
v_cvt_pk_bf16_f32 v181,v182,v183
M v[188:191],a[240:243],a[116:119],v[188:191]
s_waitcnt vmcnt(26) lgkmcnt(4)
ds_write2st64_b64 v254,v[176:177],v[180:181] offset0:238 offset1:242
M a[0:3],a[104:107],a[96:99],0
s_waitcnt vmcnt(25) lgkmcnt(4)
ds_read_b128 a[116:119],v248 offset:1024
v_cvt_pk_bf16_f32 v184,v184,v185
M a[0:3],a[128:131],a[112:115],a[0:3]
s_waitcnt vmcnt(24) lgkmcnt(4)
ds_read_b128 a[124:127],v249 offset:1024
v_cvt_pk_bf16_f32 v185,v186,v187
M a[0:3],a[152:155],a[108:111],a[0:3]
s_waitcnt lgkmcnt(4)
v_cvt_pk_bf16_f32 v188,v188,v189
v_cvt_pk_bf16_f32 v189,v190,v191
M a[4:7],a[152:155],a[136:139],0
ds_write2st64_b64 v254,v[184:185],v[188:189] offset0:246 offset1:250
M a[4:7],a[128:131],a[108:111],a[4:7]
v_lshlrev_b32 v234,16,v196
v_lshlrev_b32 v232,16,v192
M a[4:7],a[104:107],a[112:115],a[4:7]
v_lshlrev_b32 v233,16,v194
v_lshlrev_b32 v237,16,v202
M a[8:11],a[104:107],a[108:111],0
ds_read_b128 a[132:135],v248 offset:1536
v_lshlrev_b32 v236,16,v200
M a[8:11],a[128:131],a[136:139],a[8:11]
s_waitcnt lgkmcnt(3)
ds_read_b128 a[140:143],v249 offset:1536
v_lshlrev_b32 v235,16,v198
M a[8:11],a[152:155],a[116:119],a[8:11]
s_waitcnt lgkmcnt(2)
s_barrier
ds_read_b128 v[160:163],v4 offset:43520
M a[12:15],a[152:155],a[124:127],0
ds_read_b128 v[168:171],v4 offset:47616
ds_read_b128 v[176:179],v4 offset:52224
M a[12:15],a[128:131],a[116:119],a[12:15]
ds_read_b128 v[184:187],v4 offset:56320
v_fmac_f32 v232,s43,v234
M a[12:15],a[104:107],a[136:139],a[12:15]
v_fmac_f32 v237,4.0,v233
v_fma_f32 v238,-4.0,v234,v236
M a[16:19],a[104:107],a[116:119],0
ds_read_b128 a[144:147],v249 offset:2048
v_fmac_f32 v232,s45,v236
M a[16:19],a[128:131],a[124:127],a[16:19]
s_waitcnt lgkmcnt(6)
s_add_u32 s34,s33,0
ds_read_b128 a[148:151],v248 offset:2048
v_fmac_f32 v237,s41,v235
M a[16:19],a[152:155],a[132:135],a[16:19]
s_waitcnt lgkmcnt(5)
buffer_store_dwordx4 v[160:163],v253,s[24:27],s34 offen offset:1408 nt
M a[20:23],a[152:155],a[140:143],0
s_add_u32 s34,s33,393216
v_sub_f32 v236,v236,v234
v_fma_f32 v234,-4.0,v233,v235
M a[20:23],a[128:131],a[132:135],a[20:23]
v_sub_f32 v235,v235,v233
v_add_f32 v233,v238,v234
M a[20:23],a[104:107],a[124:127],a[20:23]
s_waitcnt lgkmcnt(4)
buffer_store_dwordx4 v[168:171],v253,s[24:27],s34 offen offset:1408 nt
M a[24:27],a[104:107],a[132:135],0
s_add_u32 s34,s33,786432
v_sub_f32 v238,v238,v234
v_fma_f32 v234,2.0,v235,v236
M a[24:27],a[128:131],a[140:143],a[24:27]
s_waitcnt lgkmcnt(1)
v_fmac_f32 v236,-2.0,v235
v_and_b32 v196,s42,v196
M a[24:27],a[152:155],a[144:147],a[24:27]
s_waitcnt lgkmcnt(0)
buffer_store_dwordx4 v[176:179],v253,s[24:27],s34 offen offset:1408 nt
M a[28:31],a[152:155],a[148:151],0
s_add_u32 s34,s33,1179648
v_and_b32 v192,s42,v192
v_and_b32 v194,s42,v194
M a[28:31],a[128:131],a[144:147],a[28:31]
v_and_b32 v202,s42,v202
v_and_b32 v200,s42,v200
M a[28:31],a[104:107],a[140:143],a[28:31]
s_waitcnt vmcnt(26)
buffer_store_dwordx4 v[184:187],v253,s[24:27],s34 offen offset:1408 nt
M a[32:35],a[100:103],a[96:99],0
s_waitcnt vmcnt(26)
v_and_b32 v198,s42,v198
v_fmac_f32 v192,s43,v196
M a[32:35],a[172:175],a[112:115],a[32:35]
s_waitcnt vmcnt(25)
v_fmac_f32 v202,4.0,v194
v_fma_f32 v235,-4.0,v196,v200
M a[32:35],a[180:183],a[108:111],a[32:35]
v_fmac_f32 v192,s45,v200
v_fmac_f32 v202,s41,v198
M a[36:39],a[180:183],a[136:139],0
v_sub_f32 v200,v200,v196
v_fma_f32 v196,-4.0,v194,v198
M a[36:39],a[172:175],a[108:111],a[36:39]
v_sub_f32 v198,v198,v194
v_add_f32 v194,v235,v196
M a[36:39],a[100:103],a[112:115],a[36:39]
v_sub_f32 v235,v235,v196
v_fma_f32 v196,2.0,v198,v200
M a[40:43],a[100:103],a[108:111],0
v_fmac_f32 v200,-2.0,v198
v_cvt_pk_bf16_f32 v192,v232,v192
M a[40:43],a[172:175],a[136:139],a[40:43]
v_cvt_pk_bf16_f32 v202,v237,v202
v_cvt_pk_bf16_f32 v194,v233,v194
M a[40:43],a[180:183],a[116:119],a[40:43]
v_cvt_pk_bf16_f32 v198,v234,v196
v_cvt_pk_bf16_f32 v196,v238,v235
M a[44:47],a[180:183],a[124:127],0
v_cvt_pk_bf16_f32 v200,v236,v200
v_lshlrev_b32 v234,16,v197
M a[44:47],a[172:175],a[116:119],a[44:47]
v_lshlrev_b32 v232,16,v193
v_lshlrev_b32 v233,16,v195
M a[44:47],a[100:103],a[136:139],a[44:47]
v_lshlrev_b32 v237,16,v203
v_lshlrev_b32 v236,16,v201
M a[48:51],a[100:103],a[116:119],0
v_lshlrev_b32 v235,16,v199
v_fmac_f32 v232,s43,v234
M a[48:51],a[172:175],a[124:127],a[48:51]
v_fmac_f32 v237,4.0,v233
v_fma_f32 v238,-4.0,v234,v236
M a[48:51],a[180:183],a[132:135],a[48:51]
v_fmac_f32 v232,s45,v236
v_fmac_f32 v237,s41,v235
M a[52:55],a[180:183],a[140:143],0
v_sub_f32 v236,v236,v234
v_fma_f32 v234,-4.0,v233,v235
M a[52:55],a[172:175],a[132:135],a[52:55]
v_sub_f32 v235,v235,v233
v_add_f32 v233,v238,v234
M a[52:55],a[100:103],a[124:127],a[52:55]
v_sub_f32 v238,v238,v234
v_fma_f32 v234,2.0,v235,v236
M a[56:59],a[100:103],a[132:135],0
v_fmac_f32 v236,-2.0,v235
v_and_b32 v197,s42,v197
M a[56:59],a[172:175],a[140:143],a[56:59]
v_and_b32 v193,s42,v193
v_and_b32 v195,s42,v195
M a[56:59],a[180:183],a[144:147],a[56:59]
v_and_b32 v203,s42,v203
v_and_b32 v201,s42,v201
M a[60:63],a[180:183],a[148:151],0
v_and_b32 v199,s42,v199
v_fmac_f32 v193,s43,v197
M a[60:63],a[172:175],a[144:147],a[60:63]
v_fmac_f32 v203,4.0,v195
v_fma_f32 v235,-4.0,v197,v201
M a[60:63],a[100:103],a[140:143],a[60:63]
s_waitcnt vmcnt(24)
v_fmac_f32 v193,s45,v201
v_fmac_f32 v203,s41,v199
M a[64:67],a[120:123],a[96:99],0
s_waitcnt vmcnt(23)
v_sub_f32 v201,v201,v197
v_fma_f32 v197,-4.0,v195,v199
M a[64:67],a[164:167],a[112:115],a[64:67]
s_waitcnt vmcnt(21)
v_sub_f32 v199,v199,v195
v_add_f32 v195,v235,v197
M a[64:67],a[176:179],a[108:111],a[64:67]
v_sub_f32 v235,v235,v197
v_fma_f32 v197,2.0,v199,v201
M a[68:71],a[176:179],a[136:139],0
v_fmac_f32 v201,-2.0,v199
v_cvt_pk_bf16_f32 v193,v232,v193
M a[68:71],a[164:167],a[108:111],a[68:71]
v_cvt_pk_bf16_f32 v203,v237,v203
v_cvt_pk_bf16_f32 v195,v233,v195
M a[68:71],a[120:123],a[112:115],a[68:71]
v_cvt_pk_bf16_f32 v199,v234,v197
v_cvt_pk_bf16_f32 v197,v238,v235
M a[72:75],a[120:123],a[108:111],0
v_cvt_pk_bf16_f32 v201,v236,v201
v_lshlrev_b32 v234,16,v208
M a[72:75],a[164:167],a[136:139],a[72:75]
v_lshlrev_b32 v232,16,v204
v_lshlrev_b32 v233,16,v206
M a[72:75],a[176:179],a[116:119],a[72:75]
ds_write2st64_b64 v247,v[192:193],v[202:203] offset0:170 offset1:187
M a[76:79],a[176:179],a[124:127],0
s_add_u32 s28,s67,7077888
buffer_load_dwordx2 v[192:193],v245,s[12:15],s28 offen offset:0
M a[76:79],a[164:167],a[116:119],a[76:79]
v_lshlrev_b32 v237,16,v214
v_lshlrev_b32 v236,16,v212
M a[76:79],a[120:123],a[136:139],a[76:79]
buffer_load_dwordx2 v[202:203],v245,s[16:19],s28 offen offset:1536
M a[80:83],a[120:123],a[116:119],0
v_lshlrev_b32 v235,16,v210
v_fmac_f32 v232,s43,v234
M a[80:83],a[164:167],a[124:127],a[80:83]
v_fmac_f32 v237,4.0,v233
v_fma_f32 v238,-4.0,v234,v236
M a[80:83],a[176:179],a[132:135],a[80:83]
ds_write2st64_b64 v247,v[194:195],v[196:197] offset0:0 offset1:17
M a[84:87],a[176:179],a[140:143],0
buffer_load_dwordx2 v[194:195],v245,s[8:11],s28 offen offset:0
M a[84:87],a[164:167],a[132:135],a[84:87]
ds_read_b128 a[172:175],v248 offset:8704
v_fmac_f32 v232,s45,v236
M a[84:87],a[120:123],a[124:127],a[84:87]
ds_write2st64_b64 v247,v[198:199],v[200:201] offset0:136 offset1:153
M a[88:91],a[120:123],a[132:135],0
buffer_load_dwordx2 v[196:197],v245,s[8:11],s28 offen offset:384
M a[88:91],a[164:167],a[140:143],a[88:91]
ds_read_b128 a[180:183],v249 offset:8704
ds_read_b128 a[188:191],v248 offset:9216
M a[88:91],a[176:179],a[144:147],a[88:91]
ds_read_b128 a[196:199],v249 offset:9216
v_fmac_f32 v237,s41,v235
M a[92:95],a[176:179],a[148:151],0
v_sub_f32 v236,v236,v234
v_fma_f32 v234,-4.0,v233,v235
M a[92:95],a[164:167],a[144:147],a[92:95]
buffer_load_dwordx2 v[198:199],v245,s[8:11],s28 offen offset:768
M a[92:95],a[120:123],a[140:143],a[92:95]
s_waitcnt vmcnt(22) lgkmcnt(4)
v_sub_f32 v235,v235,v233
v_add_f32 v233,v238,v234
M a[96:99],a[168:171],a[172:175],0
s_waitcnt vmcnt(19) lgkmcnt(2)
ds_read_b128 a[216:219],v248 offset:9728
v_sub_f32 v238,v238,v234
M a[96:99],a[184:187],a[180:183],a[96:99]
s_waitcnt vmcnt(18) lgkmcnt(2)
ds_read_b128 a[236:239],v249 offset:9728
v_fma_f32 v234,2.0,v235,v236
M a[96:99],a[208:211],a[188:191],a[96:99]
s_waitcnt lgkmcnt(2)
buffer_load_dwordx2 v[200:201],v245,s[8:11],s28 offen offset:1152
M a[100:103],a[208:211],a[196:199],0
v_fmac_f32 v236,-2.0,v235
v_and_b32 v208,s42,v208
M a[100:103],a[184:187],a[188:191],a[100:103]
v_and_b32 v204,s42,v204
v_and_b32 v206,s42,v206
M a[100:103],a[168:171],a[180:183],a[100:103]
v_and_b32 v214,s42,v214
v_and_b32 v212,s42,v212
M a[104:107],a[168:171],a[188:191],0
ds_read_b128 a[232:235],v248 offset:10240
v_and_b32 v210,s42,v210
M a[104:107],a[184:187],a[196:199],a[104:107]
s_waitcnt lgkmcnt(2)
ds_read_b128 v[224:227],v249 offset:10240
v_fmac_f32 v204,s43,v208
M a[104:107],a[208:211],a[216:219],a[104:107]
s_waitcnt lgkmcnt(2)
v_fmac_f32 v214,4.0,v206
v_fma_f32 v235,-4.0,v208,v212
M a[108:111],a[208:211],a[236:239],0
v_fmac_f32 v204,s45,v212
v_fmac_f32 v214,s41,v210
M a[108:111],a[184:187],a[216:219],a[108:111]
v_sub_f32 v212,v212,v208
v_fma_f32 v208,-4.0,v206,v210
M a[108:111],a[168:171],a[196:199],a[108:111]
v_sub_f32 v210,v210,v206
v_add_f32 v206,v235,v208
M a[112:115],a[168:171],a[216:219],0
ds_read_b128 v[228:231],v249 offset:10752
v_sub_f32 v235,v235,v208
M a[112:115],a[184:187],a[236:239],a[112:115]
s_waitcnt lgkmcnt(2)
ds_read_b128 a[228:231],v248 offset:10752
v_fma_f32 v208,2.0,v210,v212
M a[112:115],a[208:211],a[232:235],a[112:115]
s_waitcnt lgkmcnt(2)
v_fmac_f32 v212,-2.0,v210
v_cvt_pk_bf16_f32 v204,v232,v204
M a[116:119],a[208:211],v[224:227],0
v_cvt_pk_bf16_f32 v214,v237,v214
v_cvt_pk_bf16_f32 v206,v233,v206
M a[116:119],a[184:187],a[232:235],a[116:119]
v_cvt_pk_bf16_f32 v210,v234,v208
v_cvt_pk_bf16_f32 v208,v238,v235
M a[116:119],a[168:171],a[236:239],a[116:119]
v_cvt_pk_bf16_f32 v212,v236,v212
v_lshlrev_b32 v234,16,v209
M a[120:123],a[168:171],a[232:235],0
v_lshlrev_b32 v232,16,v205
v_lshlrev_b32 v233,16,v207
M a[120:123],a[184:187],v[224:227],a[120:123]
s_waitcnt lgkmcnt(1)
v_lshlrev_b32 v237,16,v215
v_lshlrev_b32 v236,16,v213
M a[120:123],a[208:211],v[228:231],a[120:123]
s_waitcnt lgkmcnt(0)
v_lshlrev_b32 v235,16,v211
v_fmac_f32 v232,s43,v234
M a[124:127],a[208:211],a[228:231],0
buffer_load_dwordx4 a[200:203],v250,s[20:23],s46 offen offset:1024 sc1
M a[124:127],a[184:187],v[228:231],a[124:127]
v_fmac_f32 v237,4.0,v233
v_fma_f32 v238,-4.0,v234,v236
M a[124:127],a[168:171],v[224:227],a[124:127]
s_waitcnt vmcnt(17)
buffer_load_dwordx4 v[216:219],v250,s[20:23],s46 offen offset:2048 sc1
M a[128:131],a[212:215],a[172:175],0
s_waitcnt vmcnt(17)
s_add_u32 s47,s72,30720
v_fmac_f32 v232,s45,v236
v_fmac_f32 v237,s41,v235
M a[128:131],a[160:163],a[180:183],a[128:131]
s_waitcnt vmcnt(16)
v_sub_f32 v236,v236,v234
v_fma_f32 v234,-4.0,v233,v235
M a[128:131],a[248:251],a[188:191],a[128:131]
v_sub_f32 v235,v235,v233
v_add_f32 v233,v238,v234
M a[132:135],a[248:251],a[196:199],0
buffer_load_dwordx4 a[192:195],v250,s[20:23],s47 offen offset:0 sc1
M a[132:135],a[160:163],a[188:191],a[132:135]
v_sub_f32 v238,v238,v234
v_fma_f32 v234,2.0,v235,v236
M a[132:135],a[212:215],a[180:183],a[132:135]
v_fmac_f32 v236,-2.0,v235
v_and_b32 v209,s42,v209
M a[136:139],a[212:215],a[188:191],0
v_and_b32 v205,s42,v205
v_and_b32 v207,s42,v207
M a[136:139],a[160:163],a[196:199],a[136:139]
v_and_b32 v215,s42,v215
v_and_b32 v213,s42,v213
M a[136:139],a[248:251],a[216:219],a[136:139]
v_and_b32 v211,s42,v211
v_fmac_f32 v205,s43,v209
M a[140:143],a[248:251],a[236:239],0
v_fmac_f32 v215,4.0,v207
v_fma_f32 v235,-4.0,v209,v213
M a[140:143],a[160:163],a[216:219],a[140:143]
v_fmac_f32 v205,s45,v213
v_fmac_f32 v215,s41,v211
M a[140:143],a[212:215],a[196:199],a[140:143]
v_sub_f32 v213,v213,v209
v_fma_f32 v209,-4.0,v207,v211
M a[144:147],a[212:215],a[216:219],0
v_sub_f32 v211,v211,v207
v_add_f32 v207,v235,v209
M a[144:147],a[160:163],a[236:239],a[144:147]
v_sub_f32 v235,v235,v209
v_fma_f32 v209,2.0,v211,v213
M a[144:147],a[248:251],a[232:235],a[144:147]
v_fmac_f32 v213,-2.0,v211
v_cvt_pk_bf16_f32 v205,v232,v205
M a[148:151],a[248:251],v[224:227],0
v_cvt_pk_bf16_f32 v215,v237,v215
v_cvt_pk_bf16_f32 v207,v233,v207
M a[148:151],a[160:163],a[232:235],a[148:151]
v_cvt_pk_bf16_f32 v211,v234,v209
v_cvt_pk_bf16_f32 v209,v238,v235
M a[148:151],a[212:215],a[236:239],a[148:151]
v_cvt_pk_bf16_f32 v213,v236,v213
v_fmac_f32 v239,s43,v241
M a[152:155],a[212:215],a[232:235],0
v_fmac_f32 v244,4.0,v240
v_fma_f32 v232,-4.0,v241,v243
M a[152:155],a[160:163],v[224:227],a[152:155]
v_fmac_f32 v239,s45,v243
v_fmac_f32 v244,s41,v242
M a[152:155],a[248:251],v[228:231],a[152:155]
ds_write2st64_b64 v247,v[204:205],v[214:215] offset0:171 offset1:188
M a[156:159],a[248:251],a[228:231],0
s_add_u32 s28,s67,7471104
buffer_load_dwordx4 a[204:207],v250,s[20:23],s47 offen offset:1024 sc1
M a[156:159],a[160:163],v[228:231],a[156:159]
v_sub_f32 v243,v243,v241
v_fma_f32 v241,-4.0,v240,v242
M a[156:159],a[212:215],v[224:227],a[156:159]
s_waitcnt vmcnt(17)
buffer_load_dwordx4 a[220:223],v250,s[20:23],s47 offen offset:2048 sc1
M a[160:163],a[224:227],a[172:175],0
s_waitcnt vmcnt(17)
s_add_u32 s48,s72,33792
v_sub_f32 v242,v242,v240
v_add_f32 v240,v232,v241
M a[160:163],a[244:247],a[180:183],a[160:163]
s_waitcnt vmcnt(16)
v_sub_f32 v232,v232,v241
v_fma_f32 v241,2.0,v242,v243
M a[160:163],a[252:255],a[188:191],a[160:163]
ds_write2st64_b64 v247,v[206:207],v[208:209] offset0:1 offset1:18
M a[164:167],a[252:255],a[196:199],0
buffer_load_dwordx4 a[240:243],v250,s[20:23],s48 offen offset:0 sc1
M a[164:167],a[244:247],a[188:191],a[164:167]
v_fmac_f32 v243,-2.0,v242
v_cvt_pk_bf16_f32 v233,v239,v244
M a[164:167],a[224:227],a[180:183],a[164:167]
ds_write2st64_b64 v247,v[210:211],v[212:213] offset0:137 offset1:154
M a[168:171],a[224:227],a[188:191],0
buffer_load_dwordx4 a[208:211],v250,s[20:23],s48 offen offset:1024 sc1
M a[168:171],a[244:247],a[196:199],a[168:171]
v_cvt_pk_bf16_f32 v234,v240,v232
v_cvt_pk_bf16_f32 v235,v241,v243
M a[168:171],a[252:255],a[216:219],a[168:171]
v_add_u32 v232,87040,v252
M a[172:175],a[252:255],a[236:239],0
ds_write_b16 v232,v233 offset:0
M a[172:175],a[244:247],a[216:219],a[172:175]
buffer_load_dwordx4 a[248:251],v250,s[20:23],s48 offen offset:2048 sc1
M a[172:175],a[224:227],a[196:199],a[172:175]
s_add_u32 s46,s72,36864
ds_write_b16_d16_hi v232,v233 offset:8704
M a[176:179],a[224:227],a[216:219],0
ds_write_b16 v252,v234 offset:0
M a[176:179],a[244:247],a[236:239],a[176:179]
ds_write_b16_d16_hi v252,v234 offset:8704
M a[176:179],a[252:255],a[232:235],a[176:179]
buffer_load_dwordx4 a[212:215],v250,s[20:23],s46 offen offset:0 sc1
M a[180:183],a[252:255],v[224:227],0
v_add_u32 v232,69632,v252
M a[180:183],a[244:247],a[232:235],a[180:183]
ds_read_b128 a[196:199],v248 offset:17408
ds_write_b16 v232,v235 offset:0
M a[180:183],a[224:227],a[236:239],a[180:183]
ds_read_b128 a[216:219],v249 offset:17408
ds_write_b16_d16_hi v232,v235 offset:8704
M a[184:187],a[224:227],a[232:235],0
buffer_load_dwordx2 v[204:205],v245,s[12:15],s28 offen offset:0
M a[184:187],a[244:247],v[224:227],a[184:187]
ds_read_b128 a[236:239],v248 offset:17920
ds_read_b128 a[232:235],v249 offset:17920
M a[184:187],a[252:255],v[228:231],a[184:187]
s_waitcnt vmcnt(12)
v_lshlrev_b32 v234,16,v196
v_lshlrev_b32 v232,16,v192
M a[188:191],a[252:255],a[228:231],0
buffer_load_dwordx2 v[214:215],v245,s[16:19],s28 offen offset:1536
M a[188:191],a[244:247],v[228:231],a[188:191]
v_lshlrev_b32 v233,16,v194
v_lshlrev_b32 v237,16,v202
M a[188:191],a[224:227],v[224:227],a[188:191]
s_waitcnt vmcnt(11) lgkmcnt(5)
v_lshlrev_b32 v236,16,v200
v_lshlrev_b32 v235,16,v198
M v[0:3],v[220:223],a[196:199],0
s_waitcnt vmcnt(10) lgkmcnt(3)
ds_read_b128 a[228:231],v248 offset:18432
v_fmac_f32 v232,s43,v234
M v[0:3],a[200:203],a[216:219],v[0:3]
s_waitcnt vmcnt(9) lgkmcnt(2)
buffer_load_dwordx2 v[206:207],v245,s[8:11],s28 offen offset:0
M v[0:3],v[216:219],a[236:239],v[0:3]
s_waitcnt lgkmcnt(1)
ds_read_b128 a[252:255],v249 offset:18432
v_fmac_f32 v237,4.0,v233
M v[4:7],v[216:219],a[232:235],0
v_fma_f32 v238,-4.0,v234,v236
v_fmac_f32 v232,s45,v236
M v[4:7],a[200:203],a[236:239],v[4:7]
v_fmac_f32 v237,s41,v235
v_sub_f32 v236,v236,v234
M v[4:7],v[220:223],a[216:219],v[4:7]
buffer_load_dwordx2 v[208:209],v245,s[8:11],s28 offen offset:384
M v[8:11],v[220:223],a[236:239],0
ds_read_b128 a[244:247],v248 offset:18944
v_fma_f32 v234,-4.0,v233,v235
M v[8:11],a[200:203],a[232:235],v[8:11]
s_waitcnt lgkmcnt(2)
ds_read_b128 v[228:231],v249 offset:18944
v_sub_f32 v235,v235,v233
M v[8:11],v[216:219],a[228:231],v[8:11]
s_waitcnt lgkmcnt(2)
v_add_f32 v233,v238,v234
v_sub_f32 v238,v238,v234
M v[12:15],v[216:219],a[252:255],0
buffer_load_dwordx2 v[210:211],v245,s[8:11],s28 offen offset:768
M v[12:15],a[200:203],a[228:231],v[12:15]
v_fma_f32 v234,2.0,v235,v236
v_fmac_f32 v236,-2.0,v235
M v[12:15],v[220:223],a[232:235],v[12:15]
v_and_b32 v196,s42,v196
v_and_b32 v192,s42,v192
M v[16:19],v[220:223],a[228:231],0
ds_read_b128 a[224:227],v249 offset:19456
v_and_b32 v194,s42,v194
M v[16:19],a[200:203],a[252:255],v[16:19]
s_waitcnt lgkmcnt(2)
buffer_load_dwordx2 v[212:213],v245,s[8:11],s28 offen offset:1152
M v[16:19],v[216:219],a[244:247],v[16:19]
s_waitcnt lgkmcnt(1)
s_add_u32 s29,s68,6291456
ds_read_b128 v[224:227],v248 offset:19456
v_and_b32 v202,s42,v202
M v[20:23],v[216:219],v[228:231],0
v_and_b32 v200,s42,v200
v_and_b32 v198,s42,v198
M v[20:23],a[200:203],a[244:247],v[20:23]
v_fmac_f32 v192,s43,v196
v_fmac_f32 v202,4.0,v194
M v[20:23],v[220:223],a[252:255],v[20:23]
buffer_load_short_d16_hi v239,v246,s[12:15],s29 offen offset:0
M v[24:27],v[220:223],a[244:247],0
v_fma_f32 v235,-4.0,v196,v200
v_fmac_f32 v192,s45,v200
M v[24:27],a[200:203],v[228:231],v[24:27]
s_waitcnt lgkmcnt(1)
buffer_load_short_d16_hi v240,v246,s[8:11],s29 offen offset:0
M v[24:27],v[216:219],a[224:227],v[24:27]
s_waitcnt lgkmcnt(0)
v_fmac_f32 v202,s41,v198
v_sub_f32 v200,v200,v196
M v[28:31],v[216:219],v[224:227],0
buffer_load_short_d16_hi v241,v246,s[8:11],s29 offen offset:384
M v[28:31],a[200:203],a[224:227],v[28:31]
v_fma_f32 v196,-4.0,v194,v198
v_sub_f32 v198,v198,v194
M v[28:31],v[220:223],v[228:231],v[28:31]
s_waitcnt vmcnt(15)
buffer_load_short_d16_hi v242,v246,s[8:11],s29 offen offset:768
M v[32:35],a[192:195],a[196:199],0
s_waitcnt vmcnt(15)
v_add_f32 v194,v235,v196
v_sub_f32 v235,v235,v196
M v[32:35],a[204:207],a[216:219],v[32:35]
s_waitcnt vmcnt(14)
buffer_load_short_d16_hi v243,v246,s[8:11],s29 offen offset:1152
M v[32:35],a[220:223],a[236:239],v[32:35]
v_fma_f32 v196,2.0,v198,v200
v_fmac_f32 v200,-2.0,v198
M v[36:39],a[220:223],a[232:235],0
buffer_load_short_d16_hi v244,v246,s[16:19],s29 offen offset:1536
M v[36:39],a[204:207],a[236:239],v[36:39]
v_cvt_pk_bf16_f32 v192,v232,v192
v_cvt_pk_bf16_f32 v202,v237,v202
M v[36:39],a[192:195],a[216:219],v[36:39]
global_load_dword v216,v250,s[64:65]
M v[40:43],a[192:195],a[236:239],0
v_cvt_pk_bf16_f32 v194,v233,v194
v_cvt_pk_bf16_f32 v198,v234,v196
M v[40:43],a[204:207],a[232:235],v[40:43]
buffer_load_dwordx4 v[216:219],v250,s[20:23],s46 offen offset:1024 sc1
M v[40:43],a[220:223],a[228:231],v[40:43]
v_cvt_pk_bf16_f32 v196,v238,v235
v_cvt_pk_bf16_f32 v200,v236,v200
M v[44:47],a[220:223],a[252:255],0
v_lshlrev_b32 v234,16,v197
v_lshlrev_b32 v232,16,v193
M v[44:47],a[204:207],a[228:231],v[44:47]
buffer_load_dwordx4 a[200:203],v250,s[20:23],s46 offen offset:2048 sc1
M v[44:47],a[192:195],a[232:235],v[44:47]
s_add_u32 s47,s72,39936
v_lshlrev_b32 v233,16,v195
v_lshlrev_b32 v237,16,v203
M v[48:51],a[192:195],a[228:231],0
v_lshlrev_b32 v236,16,v201
v_lshlrev_b32 v235,16,v199
M v[48:51],a[204:207],a[252:255],v[48:51]
v_fmac_f32 v232,s43,v234
v_fmac_f32 v237,4.0,v233
M v[48:51],a[220:223],a[244:247],v[48:51]
v_fma_f32 v238,-4.0,v234,v236
v_fmac_f32 v232,s45,v236
M v[52:55],a[220:223],v[228:231],0
buffer_load_dwordx4 v[220:223],v250,s[20:23],s47 offen offset:0 sc1
M v[52:55],a[204:207],a[244:247],v[52:55]
v_fmac_f32 v237,s41,v235
v_sub_f32 v236,v236,v234
M v[52:55],a[192:195],a[252:255],v[52:55]
v_fma_f32 v234,-4.0,v233,v235
v_sub_f32 v235,v235,v233
M v[56:59],a[192:195],a[244:247],0
v_add_f32 v233,v238,v234
v_sub_f32 v238,v238,v234
M v[56:59],a[204:207],v[228:231],v[56:59]
v_fma_f32 v234,2.0,v235,v236
v_fmac_f32 v236,-2.0,v235
M v[56:59],a[220:223],a[224:227],v[56:59]
v_and_b32 v197,s42,v197
v_and_b32 v193,s42,v193
M v[60:63],a[220:223],v[224:227],0
buffer_load_dwordx4 a[220:223],v250,s[20:23],s47 offen offset:1024 sc1
M v[60:63],a[204:207],a[224:227],v[60:63]
v_and_b32 v195,s42,v195
v_and_b32 v203,s42,v203
M v[60:63],a[192:195],v[228:231],v[60:63]
s_waitcnt vmcnt(20)
buffer_load_dwordx4 a[204:207],v250,s[20:23],s47 offen offset:2048 sc1
M v[64:67],a[240:243],a[196:199],0
s_waitcnt vmcnt(20)
s_add_u32 s48,s72,43008
v_and_b32 v201,s42,v201
v_and_b32 v199,s42,v199
M v[64:67],a[208:211],a[216:219],v[64:67]
s_waitcnt vmcnt(19)
v_fmac_f32 v193,s43,v197
v_fmac_f32 v203,4.0,v195
M v[64:67],a[248:251],a[236:239],v[64:67]
v_fma_f32 v235,-4.0,v197,v201
v_fmac_f32 v193,s45,v201
M v[68:71],a[248:251],a[232:235],0
buffer_load_dwordx4 a[192:195],v250,s[20:23],s48 offen offset:0 sc1
M v[68:71],a[208:211],a[236:239],v[68:71]
v_fmac_f32 v203,s41,v199
v_sub_f32 v201,v201,v197
M v[68:71],a[240:243],a[216:219],v[68:71]
v_fma_f32 v197,-4.0,v195,v199
v_sub_f32 v199,v199,v195
M v[72:75],a[240:243],a[236:239],0
v_add_f32 v195,v235,v197
v_sub_f32 v235,v235,v197
M v[72:75],a[208:211],a[232:235],v[72:75]
buffer_load_dwordx4 a[196:199],v250,s[20:23],s48 offen offset:1024 sc1
M v[72:75],a[248:251],a[228:231],v[72:75]
v_fma_f32 v197,2.0,v199,v201
v_fmac_f32 v201,-2.0,v199
M v[76:79],a[248:251],a[252:255],0
v_cvt_pk_bf16_f32 v193,v232,v193
v_cvt_pk_bf16_f32 v203,v237,v203
M v[76:79],a[208:211],a[228:231],v[76:79]
v_cvt_pk_bf16_f32 v195,v233,v195
v_cvt_pk_bf16_f32 v199,v234,v197
M v[76:79],a[240:243],a[232:235],v[76:79]
buffer_load_dwordx4 a[216:219],v250,s[20:23],s48 offen offset:2048 sc1
M v[80:83],a[240:243],a[228:231],0
s_add_u32 s46,s73,9216
v_cvt_pk_bf16_f32 v197,v238,v235
v_cvt_pk_bf16_f32 v201,v236,v201
M v[80:83],a[208:211],a[252:255],v[80:83]
s_waitcnt vmcnt(17)
v_lshlrev_b32 v234,16,v208
v_lshlrev_b32 v232,16,v204
M v[80:83],a[248:251],a[244:247],v[80:83]
ds_write2st64_b64 v247,v[192:193],v[202:203] offset0:172 offset1:189
M v[84:87],a[248:251],v[228:231],0
s_add_u32 s28,s68,6291456
buffer_load_dwordx4 a[236:239],v250,s[20:23],s46 offen offset:0 sc1
M v[84:87],a[208:211],a[244:247],v[84:87]
ds_read_b128 a[232:235],v248 offset:26112
v_lshlrev_b32 v233,16,v206
M v[84:87],a[240:243],a[252:255],v[84:87]
ds_write2st64_b64 v247,v[194:195],v[196:197] offset0:2 offset1:19
M v[88:91],a[240:243],a[244:247],0
buffer_load_dwordx2 v[192:193],v245,s[12:15],s28 offen offset:0
M v[88:91],a[208:211],v[228:231],v[88:91]
ds_read_b128 a[228:231],v249 offset:26112
ds_read_b128 a[252:255],v248 offset:26624
M v[88:91],a[248:251],a[224:227],v[88:91]
ds_write2st64_b64 v247,v[198:199],v[200:201] offset0:138 offset1:155
M v[92:95],a[248:251],v[224:227],0
buffer_load_dwordx2 v[202:203],v245,s[16:19],s28 offen offset:1536
M v[92:95],a[208:211],a[224:227],v[92:95]
ds_read_b128 a[244:247],v249 offset:26624
v_lshlrev_b32 v237,16,v214
M v[92:95],a[240:243],v[228:231],v[92:95]
s_waitcnt vmcnt(18) lgkmcnt(5)
v_lshlrev_b32 v236,16,v212
v_lshlrev_b32 v235,16,v210
M v[96:99],a[212:215],a[232:235],0
s_waitcnt vmcnt(10) lgkmcnt(3)
ds_read_b128 a[248:251],v248 offset:27136
v_fmac_f32 v232,s43,v234
M v[96:99],v[216:219],a[228:231],v[96:99]
s_waitcnt vmcnt(9) lgkmcnt(3)
buffer_load_dwordx2 v[194:195],v245,s[8:11],s28 offen offset:0
M v[96:99],a[200:203],a[252:255],v[96:99]
s_waitcnt lgkmcnt(1)
ds_read_b128 v[224:227],v249 offset:27136
v_fmac_f32 v237,4.0,v233
M v[100:103],a[200:203],a[244:247],0
v_fma_f32 v238,-4.0,v234,v236
v_fmac_f32 v232,s45,v236
M v[100:103],v[216:219],a[252:255],v[100:103]
v_fmac_f32 v237,s41,v235
v_sub_f32 v236,v236,v234
M v[100:103],a[212:215],a[228:231],v[100:103]
buffer_load_dwordx2 v[196:197],v245,s[8:11],s28 offen offset:384
M v[104:107],a[212:215],a[252:255],0
ds_read_b128 a[208:211],v248 offset:27648
v_fma_f32 v234,-4.0,v233,v235
M v[104:107],v[216:219],a[244:247],v[104:107]
s_waitcnt lgkmcnt(2)
ds_read_b128 a[224:227],v249 offset:27648
v_sub_f32 v235,v235,v233
M v[104:107],a[200:203],a[248:251],v[104:107]
s_waitcnt lgkmcnt(2)
v_add_f32 v233,v238,v234
v_sub_f32 v238,v238,v234
M v[108:111],a[200:203],v[224:227],0
buffer_load_dwordx2 v[198:199],v245,s[8:11],s28 offen offset:768
M v[108:111],v[216:219],a[248:251],v[108:111]
v_fma_f32 v234,2.0,v235,v236
v_fmac_f32 v236,-2.0,v235
M v[108:111],a[212:215],a[244:247],v[108:111]
v_and_b32 v208,s42,v208
v_and_b32 v204,s42,v204
M v[112:115],a[212:215],a[248:251],0
ds_read_b128 a[240:243],v249 offset:28160
v_and_b32 v206,s42,v206
M v[112:115],v[216:219],v[224:227],v[112:115]
s_waitcnt lgkmcnt(2)
buffer_load_dwordx2 v[200:201],v245,s[8:11],s28 offen offset:1152
M v[112:115],a[200:203],a[208:211],v[112:115]
s_waitcnt lgkmcnt(1)
ds_read_b128 v[228:231],v248 offset:28160
v_and_b32 v214,s42,v214
M v[116:119],a[200:203],a[224:227],0
v_and_b32 v212,s42,v212
v_and_b32 v210,s42,v210
M v[116:119],v[216:219],a[208:211],v[116:119]
v_fmac_f32 v204,s43,v208
v_fmac_f32 v214,4.0,v206
M v[116:119],a[212:215],v[224:227],v[116:119]
v_fma_f32 v235,-4.0,v208,v212
v_fmac_f32 v204,s45,v212
M v[120:123],a[212:215],a[208:211],0
v_fmac_f32 v214,s41,v210
v_sub_f32 v212,v212,v208
M v[120:123],v[216:219],a[224:227],v[120:123]
s_waitcnt lgkmcnt(1)
v_fma_f32 v208,-4.0,v206,v210
v_sub_f32 v210,v210,v206
M v[120:123],a[200:203],a[240:243],v[120:123]
s_waitcnt lgkmcnt(0)
v_add_f32 v206,v235,v208
v_sub_f32 v235,v235,v208
M v[124:127],a[200:203],v[228:231],0
buffer_load_dwordx4 a[200:203],v250,s[20:23],s46 offen offset:1024 sc1
M v[124:127],v[216:219],a[240:243],v[124:127]
v_fma_f32 v208,2.0,v210,v212
v_fmac_f32 v212,-2.0,v210
M v[124:127],a[212:215],a[224:227],v[124:127]
s_waitcnt vmcnt(13)
buffer_load_dwordx4 v[216:219],v250,s[20:23],s46 offen offset:2048 sc1
M v[128:131],v[220:223],a[232:235],0
s_waitcnt vmcnt(13)
s_add_u32 s47,s73,12288
v_cvt_pk_bf16_f32 v204,v232,v204
v_cvt_pk_bf16_f32 v214,v237,v214
M v[128:131],a[220:223],a[228:231],v[128:131]
s_waitcnt vmcnt(12)
v_cvt_pk_bf16_f32 v206,v233,v206
v_cvt_pk_bf16_f32 v210,v234,v208
M v[128:131],a[204:207],a[252:255],v[128:131]
v_cvt_pk_bf16_f32 v208,v238,v235
v_cvt_pk_bf16_f32 v212,v236,v212
M v[132:135],a[204:207],a[244:247],0
buffer_load_dwordx4 a[212:215],v250,s[20:23],s47 offen offset:0 sc1
M v[132:135],a[220:223],a[252:255],v[132:135]
v_lshlrev_b32 v234,16,v209
v_lshlrev_b32 v232,16,v205
M v[132:135],v[220:223],a[228:231],v[132:135]
v_lshlrev_b32 v233,16,v207
v_lshlrev_b32 v237,16,v215
M v[136:139],v[220:223],a[252:255],0
v_lshlrev_b32 v236,16,v213
v_lshlrev_b32 v235,16,v211
M v[136:139],a[220:223],a[244:247],v[136:139]
v_fmac_f32 v232,s43,v234
v_fmac_f32 v237,4.0,v233
M v[136:139],a[204:207],a[248:251],v[136:139]
v_fma_f32 v238,-4.0,v234,v236
v_fmac_f32 v232,s45,v236
M v[140:143],a[204:207],v[224:227],0
v_fmac_f32 v237,s41,v235
v_sub_f32 v236,v236,v234
M v[140:143],a[220:223],a[248:251],v[140:143]
v_fma_f32 v234,-4.0,v233,v235
v_sub_f32 v235,v235,v233
M v[140:143],v[220:223],a[244:247],v[140:143]
v_add_f32 v233,v238,v234
v_sub_f32 v238,v238,v234
M v[144:147],v[220:223],a[248:251],0
v_fma_f32 v234,2.0,v235,v236
v_fmac_f32 v236,-2.0,v235
M v[144:147],a[220:223],v[224:227],v[144:147]
v_and_b32 v209,s42,v209
v_and_b32 v205,s42,v205
M v[144:147],a[204:207],a[208:211],v[144:147]
v_and_b32 v207,s42,v207
v_and_b32 v215,s42,v215
M v[148:151],a[204:207],a[224:227],0
v_and_b32 v213,s42,v213
v_and_b32 v211,s42,v211
M v[148:151],a[220:223],a[208:211],v[148:151]
v_fmac_f32 v205,s43,v209
v_fmac_f32 v215,4.0,v207
M v[148:151],v[220:223],v[224:227],v[148:151]
v_fma_f32 v235,-4.0,v209,v213
v_fmac_f32 v205,s45,v213
M v[152:155],v[220:223],a[208:211],0
v_fmac_f32 v215,s41,v211
v_sub_f32 v213,v213,v209
M v[152:155],a[220:223],a[224:227],v[152:155]
v_fma_f32 v209,-4.0,v207,v211
v_sub_f32 v211,v211,v207
M v[152:155],a[204:207],a[240:243],v[152:155]
v_add_f32 v207,v235,v209
v_sub_f32 v235,v235,v209
M v[156:159],a[204:207],v[228:231],0
buffer_load_dwordx4 a[204:207],v250,s[20:23],s47 offen offset:1024 sc1
M v[156:159],a[220:223],a[240:243],v[156:159]
v_fma_f32 v209,2.0,v211,v213
v_fmac_f32 v213,-2.0,v211
M v[156:159],v[220:223],a[224:227],v[156:159]
s_waitcnt vmcnt(13)
buffer_load_dwordx4 a[220:223],v250,s[20:23],s47 offen offset:2048 sc1
M v[160:163],a[192:195],a[232:235],0
s_waitcnt vmcnt(13)
s_add_u32 s48,s73,15360
v_cvt_pk_bf16_f32 v205,v232,v205
v_cvt_pk_bf16_f32 v215,v237,v215
M v[160:163],a[196:199],a[228:231],v[160:163]
s_waitcnt vmcnt(12)
v_cvt_pk_bf16_f32 v207,v233,v207
v_cvt_pk_bf16_f32 v211,v234,v209
M v[160:163],a[216:219],a[252:255],v[160:163]
v_cvt_pk_bf16_f32 v209,v238,v235
v_cvt_pk_bf16_f32 v213,v236,v213
M v[164:167],a[216:219],a[244:247],0
buffer_load_dwordx4 v[220:223],v250,s[20:23],s48 offen offset:0 sc1
M v[164:167],a[196:199],a[252:255],v[164:167]
M v[164:167],a[192:195],a[228:231],v[164:167]
ds_write2st64_b64 v247,v[204:205],v[214:215] offset0:173 offset1:190
M v[168:171],a[192:195],a[252:255],0
s_add_u32 s28,s68,6684672
M v[168:171],a[196:199],a[244:247],v[168:171]
buffer_load_dwordx4 a[232:235],v250,s[20:23],s48 offen offset:1024 sc1
M v[168:171],a[216:219],a[248:251],v[168:171]
ds_write2st64_b64 v247,v[206:207],v[208:209] offset0:3 offset1:20
M v[172:175],a[216:219],v[224:227],0
M v[172:175],a[196:199],a[248:251],v[172:175]
buffer_load_dwordx4 a[228:231],v250,s[20:23],s48 offen offset:2048 sc1
M v[172:175],a[192:195],a[244:247],v[172:175]
s_add_u32 s46,s73,18432
ds_write2st64_b64 v247,v[210:211],v[212:213] offset0:139 offset1:156
M v[176:179],a[192:195],a[248:251],0
M v[176:179],a[196:199],v[224:227],v[176:179]
buffer_load_dwordx4 a[252:255],v250,s[20:23],s46 offen offset:0 sc1
M v[176:179],a[216:219],a[208:211],v[176:179]
s_waitcnt lgkmcnt(0)
s_barrier
v_add_u32 v248,0xffffbc00,v248
M v[180:183],a[216:219],a[224:227],0
v_add_u32 v249,0xffffbc00,v249
M v[180:183],a[196:199],a[208:211],v[180:183]
ds_read_b128 a[244:247],v248 offset:0
M v[180:183],a[192:195],v[224:227],v[180:183]
buffer_load_dwordx2 v[204:205],v245,s[12:15],s28 offen offset:0
M v[184:187],a[192:195],a[208:211],0
ds_read_b128 a[248:251],v249 offset:0
ds_read_b128 v[224:227],v248 offset:512
M v[184:187],a[196:199],a[224:227],v[184:187]
ds_read_b128 a[208:211],v249 offset:512
M v[184:187],a[216:219],a[240:243],v[184:187]
M v[188:191],a[216:219],v[228:231],0
buffer_load_dwordx2 v[214:215],v245,s[16:19],s28 offen offset:1536
M v[188:191],a[196:199],a[240:243],v[188:191]
M v[188:191],a[192:195],a[224:227],v[188:191]
s_waitcnt vmcnt(17) lgkmcnt(3)
M a[0:3],a[236:239],a[244:247],a[0:3]
s_waitcnt vmcnt(10) lgkmcnt(2)
ds_read_b128 a[216:219],v248 offset:1024
M a[0:3],a[200:203],a[248:251],a[0:3]
s_waitcnt vmcnt(9) lgkmcnt(2)
buffer_load_dwordx2 v[206:207],v245,s[8:11],s28 offen offset:0
M a[0:3],v[216:219],v[224:227],a[0:3]
s_waitcnt lgkmcnt(1)
ds_read_b128 v[228:231],v249 offset:1024
v_lshlrev_b32 v234,16,v196
M a[4:7],v[216:219],a[208:211],a[4:7]
v_lshlrev_b32 v232,16,v192
v_lshlrev_b32 v233,16,v194
M a[4:7],a[200:203],v[224:227],a[4:7]
v_lshlrev_b32 v237,16,v202
v_lshlrev_b32 v236,16,v200
M a[4:7],a[236:239],a[248:251],a[4:7]
buffer_load_dwordx2 v[208:209],v245,s[8:11],s28 offen offset:384
M a[8:11],a[236:239],v[224:227],a[8:11]
ds_read_b128 a[196:199],v248 offset:1536
v_lshlrev_b32 v235,16,v198
M a[8:11],a[200:203],a[208:211],a[8:11]
s_waitcnt lgkmcnt(2)
ds_read_b128 a[240:243],v249 offset:1536
v_fmac_f32 v232,s43,v234
M a[8:11],v[216:219],a[216:219],a[8:11]
s_waitcnt lgkmcnt(2)
v_fmac_f32 v237,4.0,v233
v_fma_f32 v238,-4.0,v234,v236
M a[12:15],v[216:219],v[228:231],a[12:15]
buffer_load_dwordx2 v[210:211],v245,s[8:11],s28 offen offset:768
M a[12:15],a[200:203],a[216:219],a[12:15]
v_fmac_f32 v232,s45,v236
v_fmac_f32 v237,s41,v235
M a[12:15],a[236:239],a[208:211],a[12:15]
v_sub_f32 v236,v236,v234
v_fma_f32 v234,-4.0,v233,v235
M a[16:19],a[236:239],a[216:219],a[16:19]
ds_read_b128 a[192:195],v249 offset:2048
v_sub_f32 v235,v235,v233
M a[16:19],a[200:203],v[228:231],a[16:19]
s_waitcnt lgkmcnt(2)
buffer_load_dwordx2 v[212:213],v245,s[8:11],s28 offen offset:1152
M a[16:19],v[216:219],a[196:199],a[16:19]
s_waitcnt lgkmcnt(1)
ds_read_b128 a[224:227],v248 offset:2048
v_add_f32 v233,v238,v234
M a[20:23],v[216:219],a[240:243],a[20:23]
v_sub_f32 v238,v238,v234
v_fma_f32 v234,2.0,v235,v236
M a[20:23],a[200:203],a[196:199],a[20:23]
v_fmac_f32 v236,-2.0,v235
v_and_b32 v196,s42,v196
M a[20:23],a[236:239],v[228:231],a[20:23]
v_and_b32 v192,s42,v192
v_and_b32 v194,s42,v194
M a[24:27],a[236:239],a[196:199],a[24:27]
v_and_b32 v202,s42,v202
v_and_b32 v200,s42,v200
M a[24:27],a[200:203],a[240:243],a[24:27]
s_waitcnt lgkmcnt(1)
v_and_b32 v198,s42,v198
v_fmac_f32 v192,s43,v196
M a[24:27],v[216:219],a[192:195],a[24:27]
s_waitcnt lgkmcnt(0)
v_fmac_f32 v202,4.0,v194
v_fma_f32 v235,-4.0,v196,v200
M a[28:31],v[216:219],a[224:227],a[28:31]
buffer_load_dwordx4 v[216:219],v250,s[20:23],s46 offen offset:1024 sc1
M a[28:31],a[200:203],a[192:195],a[28:31]
v_fmac_f32 v192,s45,v200
v_fmac_f32 v202,s41,v198
M a[28:31],a[236:239],a[240:243],a[28:31]
s_waitcnt vmcnt(13)
buffer_load_dwordx4 a[200:203],v250,s[20:23],s46 offen offset:2048 sc1
M a[32:35],a[212:215],a[244:247],a[32:35]
s_waitcnt vmcnt(13)
s_add_u32 s47,s73,21504
v_sub_f32 v200,v200,v196
v_fma_f32 v196,-4.0,v194,v198
M a[32:35],a[204:207],a[248:251],a[32:35]
s_waitcnt vmcnt(12)
v_sub_f32 v198,v198,v194
v_add_f32 v194,v235,v196
M a[32:35],a[220:223],v[224:227],a[32:35]
v_sub_f32 v235,v235,v196
v_fma_f32 v196,2.0,v198,v200
M a[36:39],a[220:223],a[208:211],a[36:39]
buffer_load_dwordx4 a[236:239],v250,s[20:23],s47 offen offset:0 sc1
M a[36:39],a[204:207],v[224:227],a[36:39]
v_fmac_f32 v200,-2.0,v198
v_cvt_pk_bf16_f32 v192,v232,v192
M a[36:39],a[212:215],a[248:251],a[36:39]
v_cvt_pk_bf16_f32 v202,v237,v202
v_cvt_pk_bf16_f32 v194,v233,v194
M a[40:43],a[212:215],v[224:227],a[40:43]
v_cvt_pk_bf16_f32 v198,v234,v196
v_cvt_pk_bf16_f32 v196,v238,v235
M a[40:43],a[204:207],a[208:211],a[40:43]
v_cvt_pk_bf16_f32 v200,v236,v200
v_lshlrev_b32 v234,16,v197
M a[40:43],a[220:223],a[216:219],a[40:43]
v_lshlrev_b32 v232,16,v193
v_lshlrev_b32 v233,16,v195
M a[44:47],a[220:223],v[228:231],a[44:47]
v_lshlrev_b32 v237,16,v203
v_lshlrev_b32 v236,16,v201
M a[44:47],a[204:207],a[216:219],a[44:47]
v_lshlrev_b32 v235,16,v199
v_fmac_f32 v232,s43,v234
M a[44:47],a[212:215],a[208:211],a[44:47]
v_fmac_f32 v237,4.0,v233
v_fma_f32 v238,-4.0,v234,v236
M a[48:51],a[212:215],a[216:219],a[48:51]
v_fmac_f32 v232,s45,v236
v_fmac_f32 v237,s41,v235
M a[48:51],a[204:207],v[228:231],a[48:51]
v_sub_f32 v236,v236,v234
v_fma_f32 v234,-4.0,v233,v235
M a[48:51],a[220:223],a[196:199],a[48:51]
v_sub_f32 v235,v235,v233
v_add_f32 v233,v238,v234
M a[52:55],a[220:223],a[240:243],a[52:55]
v_sub_f32 v238,v238,v234
v_fma_f32 v234,2.0,v235,v236
M a[52:55],a[204:207],a[196:199],a[52:55]
v_fmac_f32 v236,-2.0,v235
v_and_b32 v197,s42,v197
M a[52:55],a[212:215],v[228:231],a[52:55]
v_and_b32 v193,s42,v193
v_and_b32 v195,s42,v195
M a[56:59],a[212:215],a[196:199],a[56:59]
v_and_b32 v203,s42,v203
v_and_b32 v201,s42,v201
M a[56:59],a[204:207],a[240:243],a[56:59]
v_and_b32 v199,s42,v199
v_fmac_f32 v193,s43,v197
M a[56:59],a[220:223],a[192:195],a[56:59]
v_fmac_f32 v203,4.0,v195
v_fma_f32 v235,-4.0,v197,v201
M a[60:63],a[220:223],a[224:227],a[60:63]
buffer_load_dwordx4 a[220:223],v250,s[20:23],s47 offen offset:1024 sc1
M a[60:63],a[204:207],a[192:195],a[60:63]
v_fmac_f32 v193,s45,v201
v_fmac_f32 v203,s41,v199
M a[60:63],a[212:215],a[240:243],a[60:63]
s_waitcnt vmcnt(13)
buffer_load_dwordx4 a[204:207],v250,s[20:23],s47 offen offset:2048 sc1
M a[64:67],v[220:223],a[244:247],a[64:67]
s_waitcnt vmcnt(13)
s_add_u32 s48,s73,24576
v_sub_f32 v201,v201,v197
v_fma_f32 v197,-4.0,v195,v199
M a[64:67],a[232:235],a[248:251],a[64:67]
s_waitcnt vmcnt(12)
v_sub_f32 v199,v199,v195
v_add_f32 v195,v235,v197
M a[64:67],a[228:231],v[224:227],a[64:67]
v_sub_f32 v235,v235,v197
v_fma_f32 v197,2.0,v199,v201
M a[68:71],a[228:231],a[208:211],a[68:71]
buffer_load_dwordx4 a[212:215],v250,s[20:23],s48 offen offset:0 sc1
M a[68:71],a[232:235],v[224:227],a[68:71]
v_fmac_f32 v201,-2.0,v199
v_cvt_pk_bf16_f32 v193,v232,v193
M a[68:71],v[220:223],a[248:251],a[68:71]
v_cvt_pk_bf16_f32 v203,v237,v203
v_cvt_pk_bf16_f32 v195,v233,v195
M a[72:75],v[220:223],v[224:227],a[72:75]
v_cvt_pk_bf16_f32 v199,v234,v197
v_cvt_pk_bf16_f32 v197,v238,v235
M a[72:75],a[232:235],a[208:211],a[72:75]
buffer_load_dwordx4 a[244:247],v250,s[20:23],s48 offen offset:1024 sc1
M a[72:75],a[228:231],a[216:219],a[72:75]
v_cvt_pk_bf16_f32 v201,v236,v201
M a[76:79],a[228:231],v[228:231],a[76:79]
M a[76:79],a[232:235],a[216:219],a[76:79]
M a[76:79],v[220:223],a[208:211],a[76:79]
buffer_load_dwordx4 a[248:251],v250,s[20:23],s48 offen offset:2048 sc1
M a[80:83],v[220:223],a[216:219],a[80:83]
s_add_u32 s46,s73,27648
M a[80:83],a[232:235],v[228:231],a[80:83]
M a[80:83],a[228:231],a[196:199],a[80:83]
ds_write2st64_b64 v247,v[192:193],v[202:203] offset0:204 offset1:221
M a[84:87],a[228:231],a[240:243],a[84:87]
s_add_u32 s28,s68,7077888
buffer_load_dwordx4 v[224:227],v250,s[20:23],s46 offen offset:0 sc1
M a[84:87],a[232:235],a[196:199],a[84:87]
ds_read_b128 a[208:211],v248 offset:8704
M a[84:87],v[220:223],v[228:231],a[84:87]
ds_write2st64_b64 v247,v[194:195],v[196:197] offset0:34 offset1:51
M a[88:91],v[220:223],a[196:199],a[88:91]
buffer_load_dwordx2 v[192:193],v245,s[12:15],s28 offen offset:0
M a[88:91],a[232:235],a[240:243],a[88:91]
ds_read_b128 a[216:219],v249 offset:8704
ds_read_b128 v[228:231],v248 offset:9216
M a[88:91],a[228:231],a[192:195],a[88:91]
ds_write2st64_b64 v247,v[198:199],v[200:201] offset0:68 offset1:85
M a[92:95],a[228:231],a[224:227],a[92:95]
buffer_load_dwordx2 v[202:203],v245,s[16:19],s28 offen offset:1536
M a[92:95],a[232:235],a[192:195],a[92:95]
ds_read_b128 a[196:199],v249 offset:9216
M a[92:95],v[220:223],a[240:243],a[92:95]
s_waitcnt vmcnt(17) lgkmcnt(5)
M a[96:99],a[252:255],a[208:211],a[96:99]
s_waitcnt vmcnt(10) lgkmcnt(3)
ds_read_b128 a[224:227],v248 offset:9728
M a[96:99],v[216:219],a[216:219],a[96:99]
s_waitcnt vmcnt(9) lgkmcnt(3)
buffer_load_dwordx2 v[194:195],v245,s[8:11],s28 offen offset:0
M a[96:99],a[200:203],v[228:231],a[96:99]
s_waitcnt lgkmcnt(1)
ds_read_b128 a[228:231],v249 offset:9728
v_lshlrev_b32 v234,16,v208
M a[100:103],a[200:203],a[196:199],a[100:103]
v_lshlrev_b32 v232,16,v204
v_lshlrev_b32 v233,16,v206
M a[100:103],v[216:219],v[228:231],a[100:103]
v_lshlrev_b32 v237,16,v214
v_lshlrev_b32 v236,16,v212
M a[100:103],a[252:255],a[216:219],a[100:103]
buffer_load_dwordx2 v[196:197],v245,s[8:11],s28 offen offset:384
M a[104:107],a[252:255],v[228:231],a[104:107]
ds_read_b128 a[192:195],v248 offset:10240
v_lshlrev_b32 v235,16,v210
M a[104:107],v[216:219],a[196:199],a[104:107]
s_waitcnt lgkmcnt(2)
ds_read_b128 a[232:235],v249 offset:10240
v_fmac_f32 v232,s43,v234
M a[104:107],a[200:203],a[224:227],a[104:107]
s_waitcnt lgkmcnt(2)
v_fmac_f32 v237,4.0,v233
v_fma_f32 v238,-4.0,v234,v236
M a[108:111],a[200:203],a[228:231],a[108:111]
buffer_load_dwordx2 v[198:199],v245,s[8:11],s28 offen offset:768
M a[108:111],v[216:219],a[224:227],a[108:111]
v_fmac_f32 v232,s45,v236
v_fmac_f32 v237,s41,v235
M a[108:111],a[252:255],a[196:199],a[108:111]
v_sub_f32 v236,v236,v234
v_fma_f32 v234,-4.0,v233,v235
M a[112:115],a[252:255],a[224:227],a[112:115]
ds_read_b128 a[240:243],v249 offset:10752
v_sub_f32 v235,v235,v233
M a[112:115],v[216:219],a[228:231],a[112:115]
s_waitcnt lgkmcnt(2)
buffer_load_dwordx2 v[200:201],v245,s[8:11],s28 offen offset:1152
M a[112:115],a[200:203],a[192:195],a[112:115]
s_waitcnt lgkmcnt(1)
ds_read_b128 v[220:223],v248 offset:10752
v_add_f32 v233,v238,v234
M a[116:119],a[200:203],a[232:235],a[116:119]
v_sub_f32 v238,v238,v234
v_fma_f32 v234,2.0,v235,v236
M a[116:119],v[216:219],a[192:195],a[116:119]
v_fmac_f32 v236,-2.0,v235
v_and_b32 v208,s42,v208
M a[116:119],a[252:255],a[228:231],a[116:119]
v_and_b32 v204,s42,v204
v_and_b32 v206,s42,v206
M a[120:123],a[252:255],a[192:195],a[120:123]
v_and_b32 v214,s42,v214
v_and_b32 v212,s42,v212
M a[120:123],v[216:219],a[232:235],a[120:123]
s_waitcnt lgkmcnt(1)
v_and_b32 v210,s42,v210
v_fmac_f32 v204,s43,v208
M a[120:123],a[200:203],a[240:243],a[120:123]
s_waitcnt lgkmcnt(0)
v_fmac_f32 v214,4.0,v206
v_fma_f32 v235,-4.0,v208,v212
M a[124:127],a[200:203],v[220:223],a[124:127]
buffer_load_dwordx4 a[200:203],v250,s[20:23],s46 offen offset:1024 sc1
M a[124:127],v[216:219],a[240:243],a[124:127]
v_fmac_f32 v204,s45,v212
v_fmac_f32 v214,s41,v210
M a[124:127],a[252:255],a[232:235],a[124:127]
s_waitcnt vmcnt(13)
buffer_load_dwordx4 v[216:219],v250,s[20:23],s46 offen offset:2048 sc1
M a[128:131],a[236:239],a[208:211],a[128:131]
s_waitcnt vmcnt(13)
s_add_u32 s47,s73,30720
v_sub_f32 v212,v212,v208
v_fma_f32 v208,-4.0,v206,v210
M a[128:131],a[220:223],a[216:219],a[128:131]
s_waitcnt vmcnt(12)
v_sub_f32 v210,v210,v206
v_add_f32 v206,v235,v208
M a[128:131],a[204:207],v[228:231],a[128:131]
v_sub_f32 v235,v235,v208
v_fma_f32 v208,2.0,v210,v212
M a[132:135],a[204:207],a[196:199],a[132:135]
buffer_load_dwordx4 a[252:255],v250,s[20:23],s47 offen offset:0 sc1
M a[132:135],a[220:223],v[228:231],a[132:135]
v_fmac_f32 v212,-2.0,v210
v_cvt_pk_bf16_f32 v204,v232,v204
M a[132:135],a[236:239],a[216:219],a[132:135]
v_cvt_pk_bf16_f32 v214,v237,v214
v_cvt_pk_bf16_f32 v206,v233,v206
M a[136:139],a[236:239],v[228:231],a[136:139]
v_cvt_pk_bf16_f32 v210,v234,v208
v_cvt_pk_bf16_f32 v208,v238,v235
M a[136:139],a[220:223],a[196:199],a[136:139]
v_cvt_pk_bf16_f32 v212,v236,v212
v_lshlrev_b32 v234,16,v209
M a[136:139],a[204:207],a[224:227],a[136:139]
v_lshlrev_b32 v232,16,v205
v_lshlrev_b32 v233,16,v207
M a[140:143],a[204:207],a[228:231],a[140:143]
v_lshlrev_b32 v237,16,v215
v_lshlrev_b32 v236,16,v213
M a[140:143],a[220:223],a[224:227],a[140:143]
v_lshlrev_b32 v235,16,v211
v_fmac_f32 v232,s43,v234
M a[140:143],a[236:239],a[196:199],a[140:143]
v_fmac_f32 v237,4.0,v233
v_fma_f32 v238,-4.0,v234,v236
M a[144:147],a[236:239],a[224:227],a[144:147]
v_fmac_f32 v232,s45,v236
v_fmac_f32 v237,s41,v235
M a[144:147],a[220:223],a[228:231],a[144:147]
v_sub_f32 v236,v236,v234
v_fma_f32 v234,-4.0,v233,v235
M a[144:147],a[204:207],a[192:195],a[144:147]
v_sub_f32 v235,v235,v233
v_add_f32 v233,v238,v234
M a[148:151],a[204:207],a[232:235],a[148:151]
v_sub_f32 v238,v238,v234
v_fma_f32 v234,2.0,v235,v236
M a[148:151],a[220:223],a[192:195],a[148:151]
v_fmac_f32 v236,-2.0,v235
v_and_b32 v209,s42,v209
M a[148:151],a[236:239],a[228:231],a[148:151]
v_and_b32 v205,s42,v205
v_and_b32 v207,s42,v207
M a[152:155],a[236:239],a[192:195],a[152:155]
v_and_b32 v215,s42,v215
v_and_b32 v213,s42,v213
M a[152:155],a[220:223],a[232:235],a[152:155]
v_and_b32 v211,s42,v211
v_fmac_f32 v205,s43,v209
M a[152:155],a[204:207],a[240:243],a[152:155]
v_fmac_f32 v215,4.0,v207
v_fma_f32 v235,-4.0,v209,v213
M a[156:159],a[204:207],v[220:223],a[156:159]
buffer_load_dwordx4 a[204:207],v250,s[20:23],s47 offen offset:1024 sc1
M a[156:159],a[220:223],a[240:243],a[156:159]
v_fmac_f32 v205,s45,v213
v_fmac_f32 v215,s41,v211
M a[156:159],a[236:239],a[232:235],a[156:159]
s_waitcnt vmcnt(13)
buffer_load_dwordx4 a[220:223],v250,s[20:23],s47 offen offset:2048 sc1
M a[160:163],a[212:215],a[208:211],a[160:163]
s_waitcnt vmcnt(13)
s_add_u32 s48,s73,33792
v_sub_f32 v213,v213,v209
v_fma_f32 v209,-4.0,v207,v211
M a[160:163],a[244:247],a[216:219],a[160:163]
s_waitcnt vmcnt(12)
v_sub_f32 v211,v211,v207
v_add_f32 v207,v235,v209
M a[160:163],a[248:251],v[228:231],a[160:163]
v_sub_f32 v235,v235,v209
v_fma_f32 v209,2.0,v211,v213
M a[164:167],a[248:251],a[196:199],a[164:167]
buffer_load_dwordx4 a[236:239],v250,s[20:23],s48 offen offset:0 sc1
M a[164:167],a[244:247],v[228:231],a[164:167]
v_fmac_f32 v213,-2.0,v211
v_cvt_pk_bf16_f32 v205,v232,v205
M a[164:167],a[212:215],a[216:219],a[164:167]
v_cvt_pk_bf16_f32 v215,v237,v215
v_cvt_pk_bf16_f32 v207,v233,v207
M a[168:171],a[212:215],v[228:231],a[168:171]
v_cvt_pk_bf16_f32 v211,v234,v209
v_cvt_pk_bf16_f32 v209,v238,v235
M a[168:171],a[244:247],a[196:199],a[168:171]
buffer_load_dwordx4 a[208:211],v250,s[20:23],s48 offen offset:1024 sc1
M a[168:171],a[248:251],a[224:227],a[168:171]
v_cvt_pk_bf16_f32 v213,v236,v213
v_fmac_f32 v239,s43,v241
M a[172:175],a[248:251],a[228:231],a[172:175]
v_fmac_f32 v244,4.0,v240
v_fma_f32 v232,-4.0,v241,v243
M a[172:175],a[244:247],a[224:227],a[172:175]
v_fmac_f32 v239,s45,v243
v_fmac_f32 v244,s41,v242
M a[172:175],a[212:215],a[196:199],a[172:175]
buffer_load_dwordx4 a[216:219],v250,s[20:23],s48 offen offset:2048 sc1
M a[176:179],a[212:215],a[224:227],a[176:179]
s_add_u32 s46,s73,36864
v_sub_f32 v243,v243,v241
v_fma_f32 v241,-4.0,v240,v242
M a[176:179],a[244:247],a[228:231],a[176:179]
v_add_u32 v248,0x4400,v248
v_add_u32 v249,0x4400,v249
M a[176:179],a[248:251],a[192:195],a[176:179]
ds_write2st64_b64 v247,v[204:205],v[214:215] offset0:205 offset1:222
M a[180:183],a[248:251],a[232:235],a[180:183]
s_add_u32 s28,s68,7471104
buffer_load_dwordx4 v[228:231],v250,s[20:23],s46 offen offset:0 sc1
M a[180:183],a[244:247],a[192:195],a[180:183]
ds_read_b128 a[196:199],v248 offset:52224
v_sub_f32 v242,v242,v240
M a[180:183],a[212:215],a[228:231],a[180:183]
ds_write2st64_b64 v247,v[206:207],v[208:209] offset0:35 offset1:52
M a[184:187],a[212:215],a[192:195],a[184:187]
buffer_load_dwordx2 v[204:205],v245,s[12:15],s28 offen offset:0
M a[184:187],a[244:247],a[232:235],a[184:187]
ds_read_b128 a[224:227],v249 offset:52224
ds_read_b128 a[228:231],v248 offset:52736
M a[184:187],a[248:251],a[240:243],a[184:187]
ds_write2st64_b64 v247,v[210:211],v[212:213] offset0:69 offset1:86
M a[188:191],a[248:251],v[220:223],a[188:191]
buffer_load_dwordx2 v[214:215],v245,s[16:19],s28 offen offset:1536
M a[188:191],a[244:247],a[240:243],a[188:191]
ds_read_b128 a[192:195],v249 offset:52736
v_add_f32 v240,v232,v241
M a[188:191],a[212:215],a[232:235],a[188:191]
s_waitcnt vmcnt(17) lgkmcnt(5)
v_sub_f32 v232,v232,v241
v_fma_f32 v241,2.0,v242,v243
M v[0:3],v[224:227],a[196:199],v[0:3]
s_waitcnt vmcnt(10) lgkmcnt(3)
ds_read_b128 a[248:251],v248 offset:53248
v_fmac_f32 v243,-2.0,v242
M v[0:3],a[200:203],a[224:227],v[0:3]
s_waitcnt vmcnt(9) lgkmcnt(3)
buffer_load_dwordx2 v[206:207],v245,s[8:11],s28 offen offset:0
M v[0:3],v[216:219],a[228:231],v[0:3]
s_waitcnt lgkmcnt(1)
ds_read_b128 v[220:223],v249 offset:53248
v_cvt_pk_bf16_f32 v233,v239,v244
M v[4:7],v[216:219],a[192:195],v[4:7]
v_cvt_pk_bf16_f32 v234,v240,v232
v_cvt_pk_bf16_f32 v235,v241,v243
M v[4:7],a[200:203],a[228:231],v[4:7]
v_add_u32 v232,104448,v252
M v[4:7],v[224:227],a[224:227],v[4:7]
buffer_load_dwordx2 v[208:209],v245,s[8:11],s28 offen offset:384
M v[8:11],v[224:227],a[228:231],v[8:11]
ds_read_b128 a[240:243],v248 offset:53760
ds_write_b16 v232,v233 offset:0
M v[8:11],a[200:203],a[192:195],v[8:11]
s_waitcnt lgkmcnt(3)
ds_read_b128 a[244:247],v249 offset:53760
ds_write_b16_d16_hi v232,v233 offset:8704
M v[8:11],v[216:219],a[248:251],v[8:11]
s_waitcnt lgkmcnt(4)
ds_write_b16 v252,v234 offset:17408
M v[12:15],v[216:219],v[220:223],v[12:15]
buffer_load_dwordx2 v[210:211],v245,s[8:11],s28 offen offset:768
M v[12:15],a[200:203],a[248:251],v[12:15]
ds_write_b16_d16_hi v252,v234 offset:26112
M v[12:15],v[224:227],a[192:195],v[12:15]
ds_write_b16 v252,v235 offset:34816
M v[16:19],v[224:227],a[248:251],v[16:19]
ds_read_b128 a[212:215],v249 offset:54272
ds_write_b16_d16_hi v252,v235 offset:43520
M v[16:19],a[200:203],v[220:223],v[16:19]
s_waitcnt lgkmcnt(8)
buffer_load_dwordx2 v[212:213],v245,s[8:11],s28 offen offset:1152
M v[16:19],v[216:219],a[240:243],v[16:19]
s_waitcnt lgkmcnt(6)
s_add_u32 s29,s69,6291456
ds_read_b128 a[232:235],v248 offset:54272
v_lshlrev_b32 v234,16,v196
M v[20:23],v[216:219],a[244:247],v[20:23]
v_lshlrev_b32 v232,16,v192
v_lshlrev_b32 v233,16,v194
M v[20:23],a[200:203],a[240:243],v[20:23]
buffer_load_short_d16_hi v239,v246,s[12:15],s29 offen offset:0
M v[20:23],v[224:227],v[220:223],v[20:23]
v_lshlrev_b32 v237,16,v202
v_lshlrev_b32 v236,16,v200
M v[24:27],v[224:227],a[240:243],v[24:27]
buffer_load_short_d16_hi v240,v246,s[8:11],s29 offen offset:0
M v[24:27],a[200:203],a[244:247],v[24:27]
s_waitcnt lgkmcnt(2)
v_lshlrev_b32 v235,16,v198
v_fmac_f32 v232,s43,v234
M v[24:27],v[216:219],a[212:215],v[24:27]
s_waitcnt lgkmcnt(0)
buffer_load_short_d16_hi v241,v246,s[8:11],s29 offen offset:384
M v[28:31],v[216:219],a[232:235],v[28:31]
v_fmac_f32 v237,4.0,v233
v_fma_f32 v238,-4.0,v234,v236
M v[28:31],a[200:203],a[212:215],v[28:31]
buffer_load_dwordx4 v[216:219],v250,s[20:23],s46 offen offset:1024 sc1
M v[28:31],v[224:227],a[244:247],v[28:31]
s_waitcnt vmcnt(16)
v_fmac_f32 v232,s45,v236
v_fmac_f32 v237,s41,v235
M v[32:35],a[252:255],a[196:199],v[32:35]
s_waitcnt vmcnt(15)
v_sub_f32 v236,v236,v234
v_fma_f32 v234,-4.0,v233,v235
M v[32:35],a[204:207],a[224:227],v[32:35]
s_waitcnt vmcnt(14)
v_sub_f32 v235,v235,v233
v_add_f32 v233,v238,v234
M v[32:35],a[220:223],a[228:231],v[32:35]
buffer_load_dwordx4 a[200:203],v250,s[20:23],s46 offen offset:2048 sc1
M v[36:39],a[220:223],a[192:195],v[36:39]
s_add_u32 s47,s73,39936
v_sub_f32 v238,v238,v234
v_fma_f32 v234,2.0,v235,v236
M v[36:39],a[204:207],a[228:231],v[36:39]
v_fmac_f32 v236,-2.0,v235
v_and_b32 v196,s42,v196
M v[36:39],a[252:255],a[224:227],v[36:39]
v_and_b32 v192,s42,v192
v_and_b32 v194,s42,v194
M v[40:43],a[252:255],a[228:231],v[40:43]
buffer_load_dwordx4 v[224:227],v250,s[20:23],s47 offen offset:0 sc1
M v[40:43],a[204:207],a[192:195],v[40:43]
v_and_b32 v202,s42,v202
v_and_b32 v200,s42,v200
M v[40:43],a[220:223],a[248:251],v[40:43]
v_and_b32 v198,s42,v198
v_fmac_f32 v192,s43,v196
M v[44:47],a[220:223],v[220:223],v[44:47]
v_fmac_f32 v202,4.0,v194
v_fma_f32 v235,-4.0,v196,v200
M v[44:47],a[204:207],a[248:251],v[44:47]
buffer_load_short_d16_hi v242,v246,s[8:11],s29 offen offset:768
M v[44:47],a[252:255],a[192:195],v[44:47]
v_fmac_f32 v192,s45,v200
v_fmac_f32 v202,s41,v198
M v[48:51],a[252:255],a[248:251],v[48:51]
buffer_load_short_d16_hi v243,v246,s[8:11],s29 offen offset:1152
M v[48:51],a[204:207],v[220:223],v[48:51]
v_sub_f32 v200,v200,v196
v_fma_f32 v196,-4.0,v194,v198
M v[48:51],a[220:223],a[240:243],v[48:51]
buffer_load_short_d16_hi v244,v246,s[16:19],s29 offen offset:1536
M v[52:55],a[220:223],a[244:247],v[52:55]
v_sub_f32 v198,v198,v194
v_add_f32 v194,v235,v196
M v[52:55],a[204:207],a[240:243],v[52:55]
v_sub_f32 v235,v235,v196
v_fma_f32 v196,2.0,v198,v200
M v[52:55],a[252:255],v[220:223],v[52:55]
v_fmac_f32 v200,-2.0,v198
v_cvt_pk_bf16_f32 v192,v232,v192
M v[56:59],a[252:255],a[240:243],v[56:59]
v_cvt_pk_bf16_f32 v202,v237,v202
v_cvt_pk_bf16_f32 v194,v233,v194
M v[56:59],a[204:207],a[244:247],v[56:59]
v_cvt_pk_bf16_f32 v198,v234,v196
v_cvt_pk_bf16_f32 v196,v238,v235
M v[56:59],a[220:223],a[212:215],v[56:59]
v_cvt_pk_bf16_f32 v200,v236,v200
v_lshlrev_b32 v234,16,v197
M v[60:63],a[220:223],a[232:235],v[60:63]
buffer_load_dwordx4 a[220:223],v250,s[20:23],s47 offen offset:1024 sc1
M v[60:63],a[204:207],a[212:215],v[60:63]
v_lshlrev_b32 v232,16,v193
v_lshlrev_b32 v233,16,v195
M v[60:63],a[252:255],a[244:247],v[60:63]
s_waitcnt vmcnt(19)
buffer_load_dwordx4 a[204:207],v250,s[20:23],s47 offen offset:2048 sc1
M v[64:67],a[236:239],a[196:199],v[64:67]
s_waitcnt vmcnt(19)
s_add_u32 s48,s73,43008
v_lshlrev_b32 v237,16,v203
v_lshlrev_b32 v236,16,v201
M v[64:67],a[208:211],a[224:227],v[64:67]
s_waitcnt vmcnt(18)
v_lshlrev_b32 v235,16,v199
v_fmac_f32 v232,s43,v234
M v[64:67],a[216:219],a[228:231],v[64:67]
v_fmac_f32 v237,4.0,v233
v_fma_f32 v238,-4.0,v234,v236
M v[68:71],a[216:219],a[192:195],v[68:71]
buffer_load_dwordx4 a[252:255],v250,s[20:23],s48 offen offset:0 sc1
M v[68:71],a[208:211],a[228:231],v[68:71]
v_fmac_f32 v232,s45,v236
v_fmac_f32 v237,s41,v235
M v[68:71],a[236:239],a[224:227],v[68:71]
v_sub_f32 v236,v236,v234
v_fma_f32 v234,-4.0,v233,v235
M v[72:75],a[236:239],a[228:231],v[72:75]
v_sub_f32 v235,v235,v233
v_add_f32 v233,v238,v234
M v[72:75],a[208:211],a[192:195],v[72:75]
buffer_load_dwordx4 a[196:199],v250,s[20:23],s48 offen offset:1024 sc1
M v[72:75],a[216:219],a[248:251],v[72:75]
v_sub_f32 v238,v238,v234
v_fma_f32 v234,2.0,v235,v236
M v[76:79],a[216:219],v[220:223],v[76:79]
v_fmac_f32 v236,-2.0,v235
v_and_b32 v197,s42,v197
M v[76:79],a[208:211],a[248:251],v[76:79]
v_and_b32 v193,s42,v193
v_and_b32 v195,s42,v195
M v[76:79],a[236:239],a[192:195],v[76:79]
buffer_load_dwordx4 a[224:227],v250,s[20:23],s48 offen offset:2048 sc1
M v[80:83],a[236:239],a[248:251],v[80:83]
s_add_u32 s46,s74,9216
v_and_b32 v203,s42,v203
v_and_b32 v201,s42,v201
M v[80:83],a[208:211],v[220:223],v[80:83]
v_and_b32 v199,s42,v199
v_fmac_f32 v193,s43,v197
M v[80:83],a[216:219],a[240:243],v[80:83]
v_fmac_f32 v203,4.0,v195
v_fma_f32 v235,-4.0,v197,v201
M v[84:87],a[216:219],a[244:247],v[84:87]
buffer_load_dwordx4 a[228:231],v250,s[20:23],s46 offen offset:0 sc1
M v[84:87],a[208:211],a[240:243],v[84:87]
ds_read_b128 a[192:195],v248 offset:60928
v_fmac_f32 v193,s45,v201
M v[84:87],a[236:239],v[220:223],v[84:87]
ds_read_b128 a[248:251],v249 offset:60928
v_fmac_f32 v203,s41,v199
M v[88:91],a[236:239],a[240:243],v[88:91]
ds_read_b128 v[220:223],v248 offset:61440
v_sub_f32 v201,v201,v197
M v[88:91],a[208:211],a[244:247],v[88:91]
ds_read_b128 a[240:243],v249 offset:61440
v_fma_f32 v197,-4.0,v195,v199
M v[88:91],a[216:219],a[212:215],v[88:91]
v_sub_f32 v199,v199,v195
v_add_f32 v195,v235,v197
M v[92:95],a[216:219],a[232:235],v[92:95]
v_sub_f32 v235,v235,v197
v_fma_f32 v197,2.0,v199,v201
M v[92:95],a[208:211],a[212:215],v[92:95]
v_fmac_f32 v201,-2.0,v199
v_cvt_pk_bf16_f32 v193,v232,v193
M v[92:95],a[236:239],a[244:247],v[92:95]
s_waitcnt vmcnt(21) lgkmcnt(3)
v_cvt_pk_bf16_f32 v203,v237,v203
v_cvt_pk_bf16_f32 v195,v233,v195
M v[96:99],v[228:231],a[192:195],v[96:99]
s_waitcnt vmcnt(11) lgkmcnt(2)
ds_read_b128 a[216:219],v248 offset:61952
v_cvt_pk_bf16_f32 v199,v234,v197
M v[96:99],v[216:219],a[248:251],v[96:99]
s_waitcnt vmcnt(10) lgkmcnt(2)
ds_read_b128 a[232:235],v249 offset:61952
v_cvt_pk_bf16_f32 v197,v238,v235
M v[96:99],a[200:203],v[220:223],v[96:99]
s_waitcnt lgkmcnt(2)
v_cvt_pk_bf16_f32 v201,v236,v201
v_lshlrev_b32 v234,16,v208
M v[100:103],a[200:203],a[240:243],v[100:103]
v_lshlrev_b32 v232,16,v204
v_lshlrev_b32 v233,16,v206
M v[100:103],v[216:219],v[220:223],v[100:103]
v_lshlrev_b32 v237,16,v214
v_lshlrev_b32 v236,16,v212
M v[100:103],v[228:231],a[248:251],v[100:103]
ds_write2st64_b64 v247,v[192:193],v[202:203] offset0:206 offset1:223
M v[104:107],v[228:231],v[220:223],v[104:107]
s_add_u32 s28,s69,6291456
buffer_load_dwordx2 v[192:193],v245,s[12:15],s28 offen offset:0
M v[104:107],v[216:219],a[240:243],v[104:107]
s_waitcnt lgkmcnt(2)
ds_read_b128 a[208:211],v248 offset:62464
ds_read_b128 a[212:215],v249 offset:62464
M v[104:107],a[200:203],a[216:219],v[104:107]
s_waitcnt lgkmcnt(3)
buffer_load_dwordx2 v[202:203],v245,s[16:19],s28 offen offset:1536
M v[108:111],a[200:203],a[232:235],v[108:111]
v_lshlrev_b32 v235,16,v210
v_fmac_f32 v232,s43,v234
M v[108:111],v[216:219],a[216:219],v[108:111]
v_fmac_f32 v237,4.0,v233
v_fma_f32 v238,-4.0,v234,v236
M v[108:111],v[228:231],a[240:243],v[108:111]
ds_write2st64_b64 v247,v[194:195],v[196:197] offset0:36 offset1:53
M v[112:115],v[228:231],a[216:219],v[112:115]
buffer_load_dwordx2 v[194:195],v245,s[8:11],s28 offen offset:0
M v[112:115],v[216:219],a[232:235],v[112:115]
s_waitcnt lgkmcnt(2)
ds_read_b128 a[236:239],v249 offset:62976
ds_read_b128 a[244:247],v248 offset:62976
M v[112:115],a[200:203],a[208:211],v[112:115]
s_waitcnt lgkmcnt(3)
ds_write2st64_b64 v247,v[198:199],v[200:201] offset0:70 offset1:87
M v[116:119],a[200:203],a[212:215],v[116:119]
buffer_load_dwordx2 v[196:197],v245,s[8:11],s28 offen offset:384
M v[116:119],v[216:219],a[208:211],v[116:119]
v_fmac_f32 v232,s45,v236
v_fmac_f32 v237,s41,v235
M v[116:119],v[228:231],a[232:235],v[116:119]
v_sub_f32 v236,v236,v234
v_fma_f32 v234,-4.0,v233,v235
M v[120:123],v[228:231],a[208:211],v[120:123]
v_sub_f32 v235,v235,v233
v_add_f32 v233,v238,v234
M v[120:123],v[216:219],a[212:215],v[120:123]
s_waitcnt lgkmcnt(2)
buffer_load_dwordx2 v[198:199],v245,s[8:11],s28 offen offset:768
M v[120:123],a[200:203],a[236:239],v[120:123]
s_waitcnt lgkmcnt(1)
v_sub_f32 v238,v238,v234
v_fma_f32 v234,2.0,v235,v236
M v[124:127],a[200:203],a[244:247],v[124:127]
v_fmac_f32 v236,-2.0,v235
v_and_b32 v208,s42,v208
M v[124:127],v[216:219],a[236:239],v[124:127]
v_and_b32 v204,s42,v204
v_and_b32 v206,s42,v206
M v[124:127],v[228:231],a[212:215],v[124:127]
s_waitcnt vmcnt(14)
buffer_load_dwordx4 a[200:203],v250,s[20:23],s46 offen offset:1024 sc1
M v[128:131],v[224:227],a[192:195],v[128:131]
s_waitcnt vmcnt(11)
v_and_b32 v214,s42,v214
v_and_b32 v212,s42,v212
M v[128:131],a[220:223],a[248:251],v[128:131]
s_waitcnt vmcnt(10)
v_and_b32 v210,s42,v210
v_fmac_f32 v204,s43,v208
M v[128:131],a[204:207],v[220:223],v[128:131]
v_fmac_f32 v214,4.0,v206
v_fma_f32 v235,-4.0,v208,v212
M v[132:135],a[204:207],a[240:243],v[132:135]
buffer_load_dwordx4 v[216:219],v250,s[20:23],s46 offen offset:2048 sc1
M v[132:135],a[220:223],v[220:223],v[132:135]
s_add_u32 s47,s74,12288
v_fmac_f32 v204,s45,v212
v_fmac_f32 v214,s41,v210
M v[132:135],v[224:227],a[248:251],v[132:135]
v_sub_f32 v212,v212,v208
v_fma_f32 v208,-4.0,v206,v210
M v[136:139],v[224:227],v[220:223],v[136:139]
v_sub_f32 v210,v210,v206
v_add_f32 v206,v235,v208
M v[136:139],a[220:223],a[240:243],v[136:139]
buffer_load_dwordx4 v[228:231],v250,s[20:23],s47 offen offset:0 sc1
M v[136:139],a[204:207],a[216:219],v[136:139]
v_sub_f32 v235,v235,v208
v_fma_f32 v208,2.0,v210,v212
M v[140:143],a[204:207],a[232:235],v[140:143]
v_fmac_f32 v212,-2.0,v210
v_cvt_pk_bf16_f32 v204,v232,v204
M v[140:143],a[220:223],a[216:219],v[140:143]
v_cvt_pk_bf16_f32 v214,v237,v214
v_cvt_pk_bf16_f32 v206,v233,v206
M v[140:143],v[224:227],a[240:243],v[140:143]
buffer_load_dwordx2 v[200:201],v245,s[8:11],s28 offen offset:1152
M v[144:147],v[224:227],a[216:219],v[144:147]
v_cvt_pk_bf16_f32 v210,v234,v208
v_cvt_pk_bf16_f32 v208,v238,v235
M v[144:147],a[220:223],a[232:235],v[144:147]
v_cvt_pk_bf16_f32 v212,v236,v212
v_lshlrev_b32 v234,16,v209
M v[144:147],a[204:207],a[208:211],v[144:147]
v_lshlrev_b32 v232,16,v205
v_lshlrev_b32 v233,16,v207
M v[148:151],a[204:207],a[212:215],v[148:151]
v_lshlrev_b32 v237,16,v215
v_lshlrev_b32 v236,16,v213
M v[148:151],a[220:223],a[208:211],v[148:151]
v_lshlrev_b32 v235,16,v211
v_fmac_f32 v232,s43,v234
M v[148:151],v[224:227],a[232:235],v[148:151]
v_fmac_f32 v237,4.0,v233
v_fma_f32 v238,-4.0,v234,v236
M v[152:155],v[224:227],a[208:211],v[152:155]
v_fmac_f32 v232,s45,v236
v_fmac_f32 v237,s41,v235
M v[152:155],a[220:223],a[212:215],v[152:155]
v_sub_f32 v236,v236,v234
v_fma_f32 v234,-4.0,v233,v235
M v[152:155],a[204:207],a[236:239],v[152:155]
v_sub_f32 v235,v235,v233
v_add_f32 v233,v238,v234
M v[156:159],a[204:207],a[244:247],v[156:159]
buffer_load_dwordx4 a[204:207],v250,s[20:23],s47 offen offset:1024 sc1
v_sub_f32 v238,v238,v234
v_fma_f32 v234,2.0,v235,v236
M v[156:159],a[220:223],a[236:239],v[156:159]
v_fmac_f32 v236,-2.0,v235
v_and_b32 v209,s42,v209
v_and_b32 v205,s42,v205
v_and_b32 v207,s42,v207
M v[156:159],v[224:227],a[212:215],v[156:159]
s_waitcnt vmcnt(13)
buffer_load_dwordx4 a[220:223],v250,s[20:23],s47 offen offset:2048 sc1
v_and_b32 v215,s42,v215
v_and_b32 v213,s42,v213
v_and_b32 v211,s42,v211
v_fmac_f32 v205,s43,v209
M v[160:163],a[252:255],a[192:195],v[160:163]
s_waitcnt vmcnt(13)
s_add_u32 s48,s74,15360
v_fmac_f32 v215,4.0,v207
v_fma_f32 v235,-4.0,v209,v213
v_fmac_f32 v205,s45,v213
v_fmac_f32 v215,s41,v211
M v[160:163],a[196:199],a[248:251],v[160:163]
s_waitcnt vmcnt(12)
buffer_load_dwordx4 v[224:227],v250,s[20:23],s48 offen offset:0 sc1
v_sub_f32 v213,v213,v209
v_fma_f32 v209,-4.0,v207,v211
v_sub_f32 v211,v211,v207
v_add_f32 v207,v235,v209
M v[160:163],a[224:227],v[220:223],v[160:163]
v_sub_f32 v235,v235,v209
v_fma_f32 v209,2.0,v211,v213
v_fmac_f32 v213,-2.0,v211
v_cvt_pk_bf16_f32 v205,v232,v205
M v[164:167],a[224:227],a[240:243],v[164:167]
buffer_load_dwordx4 a[192:195],v250,s[20:23],s48 offen offset:1024 sc1
v_cvt_pk_bf16_f32 v215,v237,v215
v_cvt_pk_bf16_f32 v207,v233,v207
v_cvt_pk_bf16_f32 v211,v234,v209
v_cvt_pk_bf16_f32 v209,v238,v235
M v[164:167],a[196:199],v[220:223],v[164:167]
v_cvt_pk_bf16_f32 v213,v236,v213
M v[164:167],a[252:255],a[248:251],v[164:167]
ds_write2st64_b64 v247,v[204:205],v[214:215] offset0:207 offset1:224
M v[168:171],a[252:255],v[220:223],v[168:171]
s_add_u32 s28,s69,6684672
buffer_load_dwordx4 a[248:251],v250,s[20:23],s48 offen offset:2048 sc1
M v[168:171],a[196:199],a[240:243],v[168:171]
s_add_u32 s46,s74,18432
M v[168:171],a[224:227],a[216:219],v[168:171]
ds_write2st64_b64 v247,v[206:207],v[208:209] offset0:37 offset1:54
M v[172:175],a[224:227],a[232:235],v[172:175]
buffer_load_dwordx4 v[220:223],v250,s[20:23],s46 offen offset:0 sc1
M v[172:175],a[196:199],a[216:219],v[172:175]
M v[172:175],a[252:255],a[240:243],v[172:175]
ds_write2st64_b64 v247,v[210:211],v[212:213] offset0:71 offset1:88
M v[176:179],a[252:255],a[216:219],v[176:179]
buffer_load_dwordx2 v[204:205],v245,s[12:15],s28 offen offset:0
M v[176:179],a[196:199],a[232:235],v[176:179]
M v[176:179],a[224:227],a[208:211],v[176:179]
s_waitcnt lgkmcnt(0)
s_barrier
M v[180:183],a[224:227],a[212:215],v[180:183]
M v[180:183],a[196:199],a[208:211],v[180:183]
buffer_load_dwordx2 v[214:215],v245,s[16:19],s28 offen offset:1536
M v[180:183],a[252:255],a[232:235],v[180:183]
ds_read_b128 a[240:243],v248 offset:0
ds_read_b128 a[216:219],v249 offset:0
M v[184:187],a[252:255],a[208:211],v[184:187]
s_waitcnt vmcnt(13)
ds_read_b128 a[232:235],v248 offset:512
v_lshlrev_b32 v234,16,v196
M v[184:187],a[196:199],a[212:215],v[184:187]
ds_read_b128 a[208:211],v249 offset:512
v_lshlrev_b32 v232,16,v192
M v[184:187],a[224:227],a[236:239],v[184:187]
buffer_load_dwordx2 v[206:207],v245,s[8:11],s28 offen offset:0
M v[188:191],a[224:227],a[244:247],v[188:191]
v_lshlrev_b32 v233,16,v194
v_lshlrev_b32 v237,16,v202
M v[188:191],a[196:199],a[236:239],v[188:191]
s_waitcnt vmcnt(9)
v_lshlrev_b32 v236,16,v200
v_lshlrev_b32 v235,16,v198
M v[188:191],a[252:255],a[212:215],v[188:191]
s_waitcnt lgkmcnt(3)
v_fmac_f32 v232,s43,v234
v_fmac_f32 v237,4.0,v233
M a[0:3],a[228:231],a[240:243],a[0:3]
s_waitcnt lgkmcnt(2)
buffer_load_dwordx2 v[208:209],v245,s[8:11],s28 offen offset:384
M a[0:3],a[200:203],a[216:219],a[0:3]
s_waitcnt lgkmcnt(1)
ds_read_b128 a[224:227],v248 offset:1024
ds_read_b128 a[244:247],v249 offset:1024
M a[0:3],v[216:219],a[232:235],a[0:3]
s_waitcnt lgkmcnt(2)
v_fma_f32 v238,-4.0,v234,v236
v_fmac_f32 v232,s45,v236
M a[4:7],v[216:219],a[208:211],a[4:7]
v_fmac_f32 v237,s41,v235
v_sub_f32 v236,v236,v234
M a[4:7],a[200:203],a[232:235],a[4:7]
buffer_load_dwordx2 v[210:211],v245,s[8:11],s28 offen offset:768
M a[4:7],a[228:231],a[216:219],a[4:7]
v_fma_f32 v234,-4.0,v233,v235
v_sub_f32 v235,v235,v233
M a[8:11],a[228:231],a[232:235],a[8:11]
ds_read_b128 a[196:199],v248 offset:1536
v_add_f32 v233,v238,v234
M a[8:11],a[200:203],a[208:211],a[8:11]
s_waitcnt lgkmcnt(2)
ds_read_b128 a[236:239],v249 offset:1536
v_sub_f32 v238,v238,v234
M a[8:11],v[216:219],a[224:227],a[8:11]
s_waitcnt lgkmcnt(2)
buffer_load_dwordx2 v[212:213],v245,s[8:11],s28 offen offset:1152
M a[12:15],v[216:219],a[244:247],a[12:15]
v_fma_f32 v234,2.0,v235,v236
v_fmac_f32 v236,-2.0,v235
M a[12:15],a[200:203],a[224:227],a[12:15]
v_and_b32 v196,s42,v196
v_and_b32 v192,s42,v192
M a[12:15],a[228:231],a[208:211],a[12:15]
v_and_b32 v194,s42,v194
v_and_b32 v202,s42,v202
M a[16:19],a[228:231],a[224:227],a[16:19]
ds_read_b128 a[212:215],v249 offset:2048
v_and_b32 v200,s42,v200
M a[16:19],a[200:203],a[244:247],a[16:19]
s_waitcnt lgkmcnt(2)
ds_read_b128 a[252:255],v248 offset:2048
v_and_b32 v198,s42,v198
M a[16:19],v[216:219],a[196:199],a[16:19]
s_waitcnt lgkmcnt(2)
v_fmac_f32 v192,s43,v196
v_fmac_f32 v202,4.0,v194
M a[20:23],v[216:219],a[236:239],a[20:23]
v_fma_f32 v235,-4.0,v196,v200
v_fmac_f32 v192,s45,v200
M a[20:23],a[200:203],a[196:199],a[20:23]
v_fmac_f32 v202,s41,v198
v_sub_f32 v200,v200,v196
M a[20:23],a[228:231],a[244:247],a[20:23]
v_fma_f32 v196,-4.0,v194,v198
v_sub_f32 v198,v198,v194
M a[24:27],a[228:231],a[196:199],a[24:27]
v_add_f32 v194,v235,v196
v_sub_f32 v235,v235,v196
M a[24:27],a[200:203],a[236:239],a[24:27]
s_waitcnt lgkmcnt(1)
v_fma_f32 v196,2.0,v198,v200
v_fmac_f32 v200,-2.0,v198
M a[24:27],v[216:219],a[212:215],a[24:27]
s_waitcnt lgkmcnt(0)
v_cvt_pk_bf16_f32 v192,v232,v192
v_cvt_pk_bf16_f32 v202,v237,v202
M a[28:31],v[216:219],a[252:255],a[28:31]
buffer_load_dwordx4 v[216:219],v250,s[20:23],s46 offen offset:1024 sc1
M a[28:31],a[200:203],a[212:215],a[28:31]
v_cvt_pk_bf16_f32 v194,v233,v194
v_cvt_pk_bf16_f32 v198,v234,v196
M a[28:31],a[228:231],a[236:239],a[28:31]
buffer_load_dwordx4 a[200:203],v250,s[20:23],s46 offen offset:2048 sc1
M a[32:35],v[228:231],a[240:243],a[32:35]
s_waitcnt vmcnt(13)
s_add_u32 s47,s74,21504
v_cvt_pk_bf16_f32 v196,v238,v235
v_cvt_pk_bf16_f32 v200,v236,v200
M a[32:35],a[204:207],a[216:219],a[32:35]
s_waitcnt vmcnt(12)
v_lshlrev_b32 v234,16,v197
v_lshlrev_b32 v232,16,v193
M a[32:35],a[220:223],a[232:235],a[32:35]
v_lshlrev_b32 v233,16,v195
v_lshlrev_b32 v237,16,v203
M a[36:39],a[220:223],a[208:211],a[36:39]
buffer_load_dwordx4 a[228:231],v250,s[20:23],s47 offen offset:0 sc1
M a[36:39],a[204:207],a[232:235],a[36:39]
v_lshlrev_b32 v236,16,v201
v_lshlrev_b32 v235,16,v199
M a[36:39],v[228:231],a[216:219],a[36:39]
v_fmac_f32 v232,s43,v234
v_fmac_f32 v237,4.0,v233
M a[40:43],v[228:231],a[232:235],a[40:43]
v_fma_f32 v238,-4.0,v234,v236
v_fmac_f32 v232,s45,v236
M a[40:43],a[204:207],a[208:211],a[40:43]
v_fmac_f32 v237,s41,v235
v_sub_f32 v236,v236,v234
M a[40:43],a[220:223],a[224:227],a[40:43]
v_fma_f32 v234,-4.0,v233,v235
v_sub_f32 v235,v235,v233
M a[44:47],a[220:223],a[244:247],a[44:47]
v_add_f32 v233,v238,v234
v_sub_f32 v238,v238,v234
M a[44:47],a[204:207],a[224:227],a[44:47]
v_fma_f32 v234,2.0,v235,v236
v_fmac_f32 v236,-2.0,v235
M a[44:47],v[228:231],a[208:211],a[44:47]
v_and_b32 v197,s42,v197
v_and_b32 v193,s42,v193
M a[48:51],v[228:231],a[224:227],a[48:51]
v_and_b32 v195,s42,v195
v_and_b32 v203,s42,v203
M a[48:51],a[204:207],a[244:247],a[48:51]
v_and_b32 v201,s42,v201
v_and_b32 v199,s42,v199
M a[48:51],a[220:223],a[196:199],a[48:51]
v_fmac_f32 v193,s43,v197
v_fmac_f32 v203,4.0,v195
M a[52:55],a[220:223],a[236:239],a[52:55]
v_fma_f32 v235,-4.0,v197,v201
v_fmac_f32 v193,s45,v201
M a[52:55],a[204:207],a[196:199],a[52:55]
v_fmac_f32 v203,s41,v199
v_sub_f32 v201,v201,v197
M a[52:55],v[228:231],a[244:247],a[52:55]
v_fma_f32 v197,-4.0,v195,v199
v_sub_f32 v199,v199,v195
M a[56:59],v[228:231],a[196:199],a[56:59]
v_add_f32 v195,v235,v197
v_sub_f32 v235,v235,v197
M a[56:59],a[204:207],a[236:239],a[56:59]
v_fma_f32 v197,2.0,v199,v201
v_fmac_f32 v201,-2.0,v199
M a[56:59],a[220:223],a[212:215],a[56:59]
v_cvt_pk_bf16_f32 v193,v232,v193
v_cvt_pk_bf16_f32 v203,v237,v203
M a[60:63],a[220:223],a[252:255],a[60:63]
buffer_load_dwordx4 a[220:223],v250,s[20:23],s47 offen offset:1024 sc1
M a[60:63],a[204:207],a[212:215],a[60:63]
v_cvt_pk_bf16_f32 v195,v233,v195
v_cvt_pk_bf16_f32 v199,v234,v197
M a[60:63],v[228:231],a[236:239],a[60:63]
s_waitcnt vmcnt(13)
buffer_load_dwordx4 a[204:207],v250,s[20:23],s47 offen offset:2048 sc1
M a[64:67],v[224:227],a[240:243],a[64:67]
s_waitcnt vmcnt(13)
s_add_u32 s48,s74,24576
v_cvt_pk_bf16_f32 v197,v238,v235
v_cvt_pk_bf16_f32 v201,v236,v201
M a[64:67],a[192:195],a[216:219],a[64:67]
s_waitcnt vmcnt(7)
v_lshlrev_b32 v234,16,v208
v_lshlrev_b32 v232,16,v204
M a[64:67],a[248:251],a[232:235],a[64:67]
ds_write2st64_b64 v247,v[192:193],v[202:203] offset0:238 offset1:255
M a[68:71],a[248:251],a[208:211],a[68:71]
s_add_u32 s28,s69,7077888
buffer_load_dwordx4 v[228:231],v250,s[20:23],s48 offen offset:0 sc1
M a[68:71],a[192:195],a[232:235],a[68:71]
v_lshlrev_b32 v233,16,v206
v_lshlrev_b32 v237,16,v214
M a[68:71],v[224:227],a[216:219],a[68:71]
ds_write2st64_b64 v247,v[194:195],v[196:197] offset0:0 offset1:17
M a[72:75],v[224:227],a[232:235],a[72:75]
buffer_load_dwordx4 a[240:243],v250,s[20:23],s48 offen offset:1024 sc1
M a[72:75],a[192:195],a[208:211],a[72:75]
s_waitcnt vmcnt(7)
v_lshlrev_b32 v236,16,v212
v_lshlrev_b32 v235,16,v210
M a[72:75],a[248:251],a[224:227],a[72:75]
ds_write2st64_b64 v247,v[198:199],v[200:201] offset0:136 offset1:153
M a[76:79],a[248:251],a[244:247],a[76:79]
buffer_load_dwordx4 a[216:219],v250,s[20:23],s48 offen offset:2048 sc1
M a[76:79],a[192:195],a[224:227],a[76:79]
s_add_u32 s46,s74,27648
v_fmac_f32 v232,s43,v234
v_fmac_f32 v237,4.0,v233
M a[76:79],v[224:227],a[208:211],a[76:79]
v_fma_f32 v238,-4.0,v234,v236
v_fmac_f32 v232,s45,v236
M a[80:83],v[224:227],a[224:227],a[80:83]
v_fmac_f32 v237,s41,v235
v_sub_f32 v236,v236,v234
M a[80:83],a[192:195],a[244:247],a[80:83]
buffer_load_dwordx4 a[232:235],v250,s[20:23],s46 offen offset:0 sc1
M a[80:83],a[248:251],a[196:199],a[80:83]
v_fma_f32 v234,-4.0,v233,v235
v_sub_f32 v235,v235,v233
M a[84:87],a[248:251],a[236:239],a[84:87]
v_add_f32 v233,v238,v234
v_sub_f32 v238,v238,v234
M a[84:87],a[192:195],a[196:199],a[84:87]
ds_read_b128 a[208:211],v248 offset:8704
v_fma_f32 v234,2.0,v235,v236
M a[84:87],v[224:227],a[244:247],a[84:87]
buffer_load_dwordx2 v[192:193],v245,s[12:15],s28 offen offset:0
M a[88:91],v[224:227],a[196:199],a[88:91]
ds_read_b128 a[224:227],v249 offset:8704
ds_read_b128 a[244:247],v248 offset:9216
M a[88:91],a[192:195],a[236:239],a[88:91]
ds_read_b128 a[196:199],v249 offset:9216
v_fmac_f32 v236,-2.0,v235
M a[88:91],a[248:251],a[212:215],a[88:91]
v_and_b32 v208,s42,v208
v_and_b32 v204,s42,v204
M a[92:95],a[248:251],a[252:255],a[92:95]
buffer_load_dwordx2 v[202:203],v245,s[16:19],s28 offen offset:1536
M a[92:95],a[192:195],a[212:215],a[92:95]
v_and_b32 v206,s42,v206
v_and_b32 v214,s42,v214
M a[92:95],v[224:227],a[236:239],a[92:95]
s_waitcnt lgkmcnt(3)
v_and_b32 v212,s42,v212
v_and_b32 v210,s42,v210
M a[96:99],v[220:223],a[208:211],a[96:99]
s_waitcnt vmcnt(10) lgkmcnt(2)
ds_read_b128 a[248:251],v248 offset:9728
v_fmac_f32 v204,s43,v208
M a[96:99],v[216:219],a[224:227],a[96:99]
s_waitcnt vmcnt(9) lgkmcnt(2)
buffer_load_dwordx2 v[194:195],v245,s[8:11],s28 offen offset:0
M a[96:99],a[200:203],a[244:247],a[96:99]
s_waitcnt lgkmcnt(1)
ds_read_b128 a[252:255],v249 offset:9728
v_fmac_f32 v214,4.0,v206
M a[100:103],a[200:203],a[196:199],a[100:103]
v_fma_f32 v235,-4.0,v208,v212
v_fmac_f32 v204,s45,v212
M a[100:103],v[216:219],a[244:247],a[100:103]
v_fmac_f32 v214,s41,v210
v_sub_f32 v212,v212,v208
M a[100:103],v[220:223],a[224:227],a[100:103]
buffer_load_dwordx2 v[196:197],v245,s[8:11],s28 offen offset:384
M a[104:107],v[220:223],a[244:247],a[104:107]
ds_read_b128 a[192:195],v248 offset:10240
v_fma_f32 v208,-4.0,v206,v210
M a[104:107],v[216:219],a[196:199],a[104:107]
s_waitcnt lgkmcnt(2)
ds_read_b128 a[212:215],v249 offset:10240
v_sub_f32 v210,v210,v206
M a[104:107],a[200:203],a[248:251],a[104:107]
s_waitcnt lgkmcnt(2)
v_add_f32 v206,v235,v208
v_sub_f32 v235,v235,v208
M a[108:111],a[200:203],a[252:255],a[108:111]
buffer_load_dwordx2 v[198:199],v245,s[8:11],s28 offen offset:768
M a[108:111],v[216:219],a[248:251],a[108:111]
v_fma_f32 v208,2.0,v210,v212
v_fmac_f32 v212,-2.0,v210
M a[108:111],v[220:223],a[196:199],a[108:111]
v_cvt_pk_bf16_f32 v204,v232,v204
v_cvt_pk_bf16_f32 v214,v237,v214
M a[112:115],v[220:223],a[248:251],a[112:115]
ds_read_b128 a[236:239],v249 offset:10752
v_cvt_pk_bf16_f32 v206,v233,v206
M a[112:115],v[216:219],a[252:255],a[112:115]
s_waitcnt lgkmcnt(2)
buffer_load_dwordx2 v[200:201],v245,s[8:11],s28 offen offset:1152
M a[112:115],a[200:203],a[192:195],a[112:115]
s_waitcnt lgkmcnt(1)
ds_read_b128 v[224:227],v248 offset:10752
v_cvt_pk_bf16_f32 v210,v234,v208
M a[116:119],a[200:203],a[212:215],a[116:119]
v_cvt_pk_bf16_f32 v208,v238,v235
v_cvt_pk_bf16_f32 v212,v236,v212
M a[116:119],v[216:219],a[192:195],a[116:119]
v_lshlrev_b32 v234,16,v209
v_lshlrev_b32 v232,16,v205
M a[116:119],v[220:223],a[252:255],a[116:119]
v_lshlrev_b32 v233,16,v207
v_lshlrev_b32 v237,16,v215
M a[120:123],v[220:223],a[192:195],a[120:123]
v_lshlrev_b32 v236,16,v213
v_lshlrev_b32 v235,16,v211
M a[120:123],v[216:219],a[212:215],a[120:123]
s_waitcnt lgkmcnt(1)
v_fmac_f32 v232,s43,v234
v_fmac_f32 v237,4.0,v233
M a[120:123],a[200:203],a[236:239],a[120:123]
s_waitcnt lgkmcnt(0)
v_fma_f32 v238,-4.0,v234,v236
v_fmac_f32 v232,s45,v236
M a[124:127],a[200:203],v[224:227],a[124:127]
buffer_load_dwordx4 a[200:203],v250,s[20:23],s46 offen offset:1024 sc1
M a[124:127],v[216:219],a[236:239],a[124:127]
v_fmac_f32 v237,s41,v235
v_sub_f32 v236,v236,v234
M a[124:127],v[220:223],a[212:215],a[124:127]
s_waitcnt vmcnt(13)
buffer_load_dwordx4 v[216:219],v250,s[20:23],s46 offen offset:2048 sc1
M a[128:131],a[228:231],a[208:211],a[128:131]
s_waitcnt vmcnt(13)
s_add_u32 s47,s74,30720
v_fma_f32 v234,-4.0,v233,v235
v_sub_f32 v235,v235,v233
M a[128:131],a[220:223],a[224:227],a[128:131]
s_waitcnt vmcnt(12)
v_add_f32 v233,v238,v234
v_sub_f32 v238,v238,v234
M a[128:131],a[204:207],a[244:247],a[128:131]
v_fma_f32 v234,2.0,v235,v236
v_fmac_f32 v236,-2.0,v235
M a[132:135],a[204:207],a[196:199],a[132:135]
buffer_load_dwordx4 v[220:223],v250,s[20:23],s47 offen offset:0 sc1
M a[132:135],a[220:223],a[244:247],a[132:135]
v_and_b32 v209,s42,v209
v_and_b32 v205,s42,v205
M a[132:135],a[228:231],a[224:227],a[132:135]
v_and_b32 v207,s42,v207
v_and_b32 v215,s42,v215
M a[136:139],a[228:231],a[244:247],a[136:139]
v_and_b32 v213,s42,v213
v_and_b32 v211,s42,v211
M a[136:139],a[220:223],a[196:199],a[136:139]
v_fmac_f32 v205,s43,v209
v_fmac_f32 v215,4.0,v207
M a[136:139],a[204:207],a[248:251],a[136:139]
v_fma_f32 v235,-4.0,v209,v213
v_fmac_f32 v205,s45,v213
M a[140:143],a[204:207],a[252:255],a[140:143]
v_fmac_f32 v215,s41,v211
v_sub_f32 v213,v213,v209
M a[140:143],a[220:223],a[248:251],a[140:143]
v_fma_f32 v209,-4.0,v207,v211
v_sub_f32 v211,v211,v207
M a[140:143],a[228:231],a[196:199],a[140:143]
v_add_f32 v207,v235,v209
v_sub_f32 v235,v235,v209
M a[144:147],a[228:231],a[248:251],a[144:147]
v_fma_f32 v209,2.0,v211,v213
v_fmac_f32 v213,-2.0,v211
M a[144:147],a[220:223],a[252:255],a[144:147]
v_cvt_pk_bf16_f32 v205,v232,v205
v_cvt_pk_bf16_f32 v215,v237,v215
M a[144:147],a[204:207],a[192:195],a[144:147]
v_cvt_pk_bf16_f32 v207,v233,v207
v_cvt_pk_bf16_f32 v211,v234,v209
M a[148:151],a[204:207],a[212:215],a[148:151]
v_cvt_pk_bf16_f32 v209,v238,v235
v_cvt_pk_bf16_f32 v213,v236,v213
M a[148:151],a[220:223],a[192:195],a[148:151]
v_add_u32 v238,121856,v247
v_fmac_f32 v239,s43,v241
M a[148:151],a[228:231],a[252:255],a[148:151]
ds_write2st64_b64 v238,v[204:205],v[214:215] offset0:1 offset1:18
M a[152:155],a[228:231],a[192:195],a[152:155]
s_add_u32 s28,s69,7471104
buffer_load_dwordx2 v[204:205],v245,s[12:15],s28 offen offset:0
M a[152:155],a[220:223],a[212:215],a[152:155]
v_fmac_f32 v244,4.0,v240
v_fma_f32 v232,-4.0,v241,v243
M a[152:155],a[204:207],a[236:239],a[152:155]
buffer_load_dwordx2 v[214:215],v245,s[16:19],s28 offen offset:1536
M a[156:159],a[204:207],v[224:227],a[156:159]
v_fmac_f32 v239,s45,v243
v_fmac_f32 v244,s41,v242
M a[156:159],a[220:223],a[236:239],a[156:159]
v_sub_f32 v243,v243,v241
v_fma_f32 v241,-4.0,v240,v242
M a[156:159],a[228:231],a[212:215],a[156:159]
s_waitcnt vmcnt(14)
ds_write2st64_b64 v247,v[206:207],v[208:209] offset0:1 offset1:18
M a[160:163],v[228:231],a[208:211],a[160:163]
s_waitcnt vmcnt(13)
buffer_load_dwordx4 a[204:207],v250,s[20:23],s47 offen offset:1024 sc1
M a[160:163],a[240:243],a[224:227],a[160:163]
s_waitcnt vmcnt(13)
v_sub_f32 v242,v242,v240
v_add_f32 v240,v232,v241
M a[160:163],a[216:219],a[244:247],a[160:163]
ds_write2st64_b64 v247,v[210:211],v[212:213] offset0:137 offset1:154
M a[164:167],a[216:219],a[196:199],a[164:167]
buffer_load_dwordx4 a[220:223],v250,s[20:23],s47 offen offset:2048 sc1
M a[164:167],a[240:243],a[244:247],a[164:167]
s_add_u32 s48,s74,33792
v_sub_f32 v232,v232,v241
v_fma_f32 v241,2.0,v242,v243
M a[164:167],v[228:231],a[224:227],a[164:167]
v_fmac_f32 v243,-2.0,v242
v_cvt_pk_bf16_f32 v233,v239,v244
M a[168:171],v[228:231],a[244:247],a[168:171]
v_cvt_pk_bf16_f32 v234,v240,v232
v_cvt_pk_bf16_f32 v235,v241,v243
M a[168:171],a[240:243],a[196:199],a[168:171]
buffer_load_dwordx4 a[228:231],v250,s[20:23],s48 offen offset:0 sc1
M a[168:171],a[216:219],a[248:251],a[168:171]
v_add_u32 v232,121856,v252
M a[172:175],a[216:219],a[252:255],a[172:175]
ds_write_b16 v232,v233 offset:0
M a[172:175],a[240:243],a[248:251],a[172:175]
ds_write_b16_d16_hi v232,v233 offset:8704
M a[172:175],v[228:231],a[196:199],a[172:175]
buffer_load_dwordx4 a[208:211],v250,s[20:23],s48 offen offset:1024 sc1
M a[176:179],v[228:231],a[248:251],a[176:179]
ds_write_b16 v252,v234 offset:0
M a[176:179],a[240:243],a[252:255],a[176:179]
ds_write_b16_d16_hi v252,v234 offset:8704
M a[176:179],a[216:219],a[192:195],a[176:179]
v_add_u32 v232,69632,v252
M a[180:183],a[216:219],a[212:215],a[180:183]
buffer_load_dwordx4 a[224:227],v250,s[20:23],s48 offen offset:2048 sc1
M a[180:183],a[240:243],a[192:195],a[180:183]
s_add_u32 s46,s74,36864
ds_read_b128 a[196:199],v248 offset:17408
ds_write_b16 v232,v235 offset:0
M a[180:183],v[228:231],a[252:255],a[180:183]
ds_read_b128 a[248:251],v249 offset:17408
ds_write_b16_d16_hi v232,v235 offset:8704
M a[184:187],v[228:231],a[192:195],a[184:187]
buffer_load_dwordx4 a[244:247],v250,s[20:23],s46 offen offset:0 sc1
M a[184:187],a[240:243],a[212:215],a[184:187]
ds_read_b128 a[252:255],v248 offset:17920
ds_read_b128 a[192:195],v249 offset:17920
M a[184:187],a[216:219],a[236:239],a[184:187]
s_waitcnt vmcnt(13)
v_lshlrev_b32 v234,16,v196
v_lshlrev_b32 v232,16,v192
M a[188:191],a[216:219],v[224:227],a[188:191]
v_lshlrev_b32 v233,16,v194
v_lshlrev_b32 v237,16,v202
M a[188:191],a[240:243],a[236:239],a[188:191]
buffer_load_dwordx2 v[206:207],v245,s[8:11],s28 offen offset:0
M a[188:191],v[228:231],a[212:215],a[188:191]
s_waitcnt vmcnt(12) lgkmcnt(5)
v_lshlrev_b32 v236,16,v200
v_lshlrev_b32 v235,16,v198
M v[0:3],a[232:235],a[196:199],v[0:3]
s_waitcnt vmcnt(11) lgkmcnt(3)
ds_read_b128 a[216:219],v248 offset:18432
v_fmac_f32 v232,s43,v234
M v[0:3],a[200:203],a[248:251],v[0:3]
s_waitcnt vmcnt(10) lgkmcnt(2)
ds_read_b128 v[224:227],v249 offset:18432
v_fmac_f32 v237,4.0,v233
M v[0:3],v[216:219],a[252:255],v[0:3]
s_waitcnt lgkmcnt(2)
buffer_load_dwordx2 v[208:209],v245,s[8:11],s28 offen offset:384
M v[4:7],v[216:219],a[192:195],v[4:7]
v_fma_f32 v238,-4.0,v234,v236
v_fmac_f32 v232,s45,v236
M v[4:7],a[200:203],a[252:255],v[4:7]
v_fmac_f32 v237,s41,v235
v_sub_f32 v236,v236,v234
M v[4:7],a[232:235],a[248:251],v[4:7]
v_fma_f32 v234,-4.0,v233,v235
v_sub_f32 v235,v235,v233
M v[8:11],a[232:235],a[252:255],v[8:11]
buffer_load_dwordx2 v[210:211],v245,s[8:11],s28 offen offset:768
M v[8:11],a[200:203],a[192:195],v[8:11]
s_waitcnt lgkmcnt(1)
ds_read_b128 a[236:239],v248 offset:18944
ds_read_b128 a[240:243],v249 offset:18944
M v[8:11],v[216:219],a[216:219],v[8:11]
s_waitcnt lgkmcnt(2)
v_add_f32 v233,v238,v234
v_sub_f32 v238,v238,v234
M v[12:15],v[216:219],v[224:227],v[12:15]
v_fma_f32 v234,2.0,v235,v236
v_fmac_f32 v236,-2.0,v235
M v[12:15],a[200:203],a[216:219],v[12:15]
buffer_load_dwordx2 v[212:213],v245,s[8:11],s28 offen offset:1152
M v[12:15],a[232:235],a[192:195],v[12:15]
s_add_u32 s29,s70,6291456
v_and_b32 v196,s42,v196
v_and_b32 v192,s42,v192
M v[16:19],a[232:235],a[216:219],v[16:19]
ds_read_b128 a[212:215],v249 offset:19456
v_and_b32 v194,s42,v194
M v[16:19],a[200:203],v[224:227],v[16:19]
s_waitcnt lgkmcnt(2)
ds_read_b128 v[228:231],v248 offset:19456
v_and_b32 v202,s42,v202
M v[16:19],v[216:219],a[236:239],v[16:19]
s_waitcnt lgkmcnt(2)
buffer_load_short_d16_hi v239,v246,s[12:15],s29 offen offset:0
M v[20:23],v[216:219],a[240:243],v[20:23]
v_and_b32 v200,s42,v200
v_and_b32 v198,s42,v198
M v[20:23],a[200:203],a[236:239],v[20:23]
buffer_load_short_d16_hi v240,v246,s[8:11],s29 offen offset:0
M v[20:23],a[232:235],v[224:227],v[20:23]
v_fmac_f32 v192,s43,v196
v_fmac_f32 v202,4.0,v194
M v[24:27],a[232:235],a[236:239],v[24:27]
buffer_load_short_d16_hi v241,v246,s[8:11],s29 offen offset:384
M v[24:27],a[200:203],a[240:243],v[24:27]
s_waitcnt lgkmcnt(1)
v_fma_f32 v235,-4.0,v196,v200
v_fmac_f32 v192,s45,v200
M v[24:27],v[216:219],a[212:215],v[24:27]
s_waitcnt lgkmcnt(0)
buffer_load_short_d16_hi v242,v246,s[8:11],s29 offen offset:768
M v[28:31],v[216:219],v[228:231],v[28:31]
v_fmac_f32 v202,s41,v198
v_sub_f32 v200,v200,v196
M v[28:31],a[200:203],a[212:215],v[28:31]
buffer_load_short_d16_hi v243,v246,s[8:11],s29 offen offset:1152
M v[28:31],a[232:235],a[240:243],v[28:31]
s_waitcnt vmcnt(17)
v_fma_f32 v196,-4.0,v194,v198
v_sub_f32 v198,v198,v194
M v[32:35],v[220:223],a[196:199],v[32:35]
s_waitcnt vmcnt(14)
buffer_load_short_d16_hi v244,v246,s[16:19],s29 offen offset:1536
M v[32:35],a[204:207],a[248:251],v[32:35]
s_waitcnt vmcnt(14)
v_add_f32 v194,v235,v196
v_sub_f32 v235,v235,v196
M v[32:35],a[220:223],a[252:255],v[32:35]
global_load_dword v216,v250,s[64:65]
M v[36:39],a[220:223],a[192:195],v[36:39]
v_fma_f32 v196,2.0,v198,v200
v_fmac_f32 v200,-2.0,v198
M v[36:39],a[204:207],a[252:255],v[36:39]
buffer_load_dwordx4 v[216:219],v250,s[20:23],s46 offen offset:1024 sc1
M v[36:39],v[220:223],a[248:251],v[36:39]
v_cvt_pk_bf16_f32 v192,v232,v192
v_cvt_pk_bf16_f32 v202,v237,v202
M v[40:43],v[220:223],a[252:255],v[40:43]
v_cvt_pk_bf16_f32 v194,v233,v194
v_cvt_pk_bf16_f32 v198,v234,v196
M v[40:43],a[204:207],a[192:195],v[40:43]
v_cvt_pk_bf16_f32 v196,v238,v235
v_cvt_pk_bf16_f32 v200,v236,v200
M v[40:43],a[220:223],a[216:219],v[40:43]
buffer_load_dwordx4 a[200:203],v250,s[20:23],s46 offen offset:2048 sc1
M v[44:47],a[220:223],v[224:227],v[44:47]
s_add_u32 s47,s74,39936
v_lshlrev_b32 v234,16,v197
v_lshlrev_b32 v232,16,v193
M v[44:47],a[204:207],a[216:219],v[44:47]
v_lshlrev_b32 v233,16,v195
v_lshlrev_b32 v237,16,v203
M v[44:47],v[220:223],a[192:195],v[44:47]
v_lshlrev_b32 v236,16,v201
v_lshlrev_b32 v235,16,v199
M v[48:51],v[220:223],a[216:219],v[48:51]
buffer_load_dwordx4 a[232:235],v250,s[20:23],s47 offen offset:0 sc1
M v[48:51],a[204:207],v[224:227],v[48:51]
v_fmac_f32 v232,s43,v234
v_fmac_f32 v237,4.0,v233
M v[48:51],a[220:223],a[236:239],v[48:51]
v_fma_f32 v238,-4.0,v234,v236
v_fmac_f32 v232,s45,v236
M v[52:55],a[220:223],a[240:243],v[52:55]
v_fmac_f32 v237,s41,v235
v_sub_f32 v236,v236,v234
M v[52:55],a[204:207],a[236:239],v[52:55]
v_fma_f32 v234,-4.0,v233,v235
v_sub_f32 v235,v235,v233
M v[52:55],v[220:223],v[224:227],v[52:55]
v_add_f32 v233,v238,v234
v_sub_f32 v238,v238,v234
M v[56:59],v[220:223],a[236:239],v[56:59]
v_fma_f32 v234,2.0,v235,v236
v_fmac_f32 v236,-2.0,v235
M v[56:59],a[204:207],a[240:243],v[56:59]
v_and_b32 v197,s42,v197
v_and_b32 v193,s42,v193
M v[56:59],a[220:223],a[212:215],v[56:59]
v_and_b32 v195,s42,v195
v_and_b32 v203,s42,v203
M v[60:63],a[220:223],v[228:231],v[60:63]
buffer_load_dwordx4 a[220:223],v250,s[20:23],s47 offen offset:1024 sc1
M v[60:63],a[204:207],a[212:215],v[60:63]
v_and_b32 v201,s42,v201
v_and_b32 v199,s42,v199
M v[60:63],v[220:223],a[240:243],v[60:63]
s_waitcnt vmcnt(18)
buffer_load_dwordx4 a[204:207],v250,s[20:23],s47 offen offset:2048 sc1
M v[64:67],a[228:231],a[196:199],v[64:67]
s_waitcnt vmcnt(18)
s_add_u32 s48,s74,43008
v_fmac_f32 v193,s43,v197
v_fmac_f32 v203,4.0,v195
M v[64:67],a[208:211],a[248:251],v[64:67]
s_waitcnt vmcnt(17)
v_fma_f32 v235,-4.0,v197,v201
v_fmac_f32 v193,s45,v201
M v[64:67],a[224:227],a[252:255],v[64:67]
v_fmac_f32 v203,s41,v199
v_sub_f32 v201,v201,v197
M v[68:71],a[224:227],a[192:195],v[68:71]
buffer_load_dwordx4 v[220:223],v250,s[20:23],s48 offen offset:0 sc1
M v[68:71],a[208:211],a[252:255],v[68:71]
v_fma_f32 v197,-4.0,v195,v199
v_sub_f32 v199,v199,v195
M v[68:71],a[228:231],a[248:251],v[68:71]
v_add_f32 v195,v235,v197
v_sub_f32 v235,v235,v197
M v[72:75],a[228:231],a[252:255],v[72:75]
v_fma_f32 v197,2.0,v199,v201
v_fmac_f32 v201,-2.0,v199
M v[72:75],a[208:211],a[192:195],v[72:75]
buffer_load_dwordx4 a[196:199],v250,s[20:23],s48 offen offset:1024 sc1
M v[72:75],a[224:227],a[216:219],v[72:75]
v_cvt_pk_bf16_f32 v193,v232,v193
v_cvt_pk_bf16_f32 v203,v237,v203
M v[76:79],a[224:227],v[224:227],v[76:79]
v_cvt_pk_bf16_f32 v195,v233,v195
v_cvt_pk_bf16_f32 v199,v234,v197
M v[76:79],a[208:211],a[216:219],v[76:79]
v_cvt_pk_bf16_f32 v197,v238,v235
v_cvt_pk_bf16_f32 v201,v236,v201
M v[76:79],a[228:231],a[192:195],v[76:79]
buffer_load_dwordx4 a[248:251],v250,s[20:23],s48 offen offset:2048 sc1
M v[80:83],a[228:231],a[216:219],v[80:83]
s_waitcnt vmcnt(17)
s_add_u32 s46,s75,9216
v_add_u32 v238,121856,v247
v_lshlrev_b32 v234,16,v208
M v[80:83],a[208:211],v[224:227],v[80:83]
v_lshlrev_b32 v232,16,v204
v_lshlrev_b32 v233,16,v206
M v[80:83],a[224:227],a[236:239],v[80:83]
ds_write2st64_b64 v238,v[192:193],v[202:203] offset0:2 offset1:19
M v[84:87],a[224:227],a[240:243],v[84:87]
s_add_u32 s28,s70,6291456
buffer_load_dwordx4 a[252:255],v250,s[20:23],s46 offen offset:0 sc1
M v[84:87],a[208:211],a[236:239],v[84:87]
ds_read_b128 a[192:195],v248 offset:26112
v_lshlrev_b32 v237,16,v214
M v[84:87],a[228:231],v[224:227],v[84:87]
ds_write2st64_b64 v247,v[194:195],v[196:197] offset0:2 offset1:19
M v[88:91],a[228:231],a[236:239],v[88:91]
buffer_load_dwordx2 v[192:193],v245,s[12:15],s28 offen offset:0
M v[88:91],a[208:211],a[240:243],v[88:91]
ds_read_b128 a[216:219],v249 offset:26112
ds_read_b128 v[224:227],v248 offset:26624
M v[88:91],a[224:227],a[212:215],v[88:91]
ds_write2st64_b64 v247,v[198:199],v[200:201] offset0:138 offset1:155
M v[92:95],a[224:227],v[228:231],v[92:95]
buffer_load_dwordx2 v[202:203],v245,s[16:19],s28 offen offset:1536
M v[92:95],a[208:211],a[212:215],v[92:95]
s_waitcnt vmcnt(18)
ds_read_b128 a[236:239],v249 offset:26624
v_lshlrev_b32 v236,16,v212
M v[92:95],a[228:231],a[240:243],v[92:95]
s_waitcnt lgkmcnt(5)
v_lshlrev_b32 v235,16,v210
v_fmac_f32 v232,s43,v234
M v[96:99],a[244:247],a[192:195],v[96:99]
s_waitcnt vmcnt(10) lgkmcnt(3)
ds_read_b128 a[224:227],v248 offset:27136
v_fmac_f32 v237,4.0,v233
M v[96:99],v[216:219],a[216:219],v[96:99]
s_waitcnt vmcnt(9) lgkmcnt(3)
buffer_load_dwordx2 v[194:195],v245,s[8:11],s28 offen offset:0
M v[96:99],a[200:203],v[224:227],v[96:99]
s_waitcnt lgkmcnt(1)
ds_read_b128 v[228:231],v249 offset:27136
v_fma_f32 v238,-4.0,v234,v236
M v[100:103],a[200:203],a[236:239],v[100:103]
v_fmac_f32 v232,s45,v236
v_fmac_f32 v237,s41,v235
M v[100:103],v[216:219],v[224:227],v[100:103]
v_sub_f32 v236,v236,v234
v_fma_f32 v234,-4.0,v233,v235
M v[100:103],a[244:247],a[216:219],v[100:103]
buffer_load_dwordx2 v[196:197],v245,s[8:11],s28 offen offset:384
M v[104:107],a[244:247],v[224:227],v[104:107]
ds_read_b128 a[208:211],v248 offset:27648
v_sub_f32 v235,v235,v233
M v[104:107],v[216:219],a[236:239],v[104:107]
s_waitcnt lgkmcnt(2)
ds_read_b128 a[212:215],v249 offset:27648
v_add_f32 v233,v238,v234
M v[104:107],a[200:203],a[224:227],v[104:107]
s_waitcnt lgkmcnt(2)
v_sub_f32 v238,v238,v234
v_fma_f32 v234,2.0,v235,v236
M v[108:111],a[200:203],v[228:231],v[108:111]
buffer_load_dwordx2 v[198:199],v245,s[8:11],s28 offen offset:768
M v[108:111],v[216:219],a[224:227],v[108:111]
v_fmac_f32 v236,-2.0,v235
v_and_b32 v208,s42,v208
M v[108:111],a[244:247],a[236:239],v[108:111]
v_and_b32 v204,s42,v204
v_and_b32 v206,s42,v206
M v[112:115],a[244:247],a[224:227],v[112:115]
ds_read_b128 a[228:231],v249 offset:28160
v_and_b32 v214,s42,v214
M v[112:115],v[216:219],v[228:231],v[112:115]
s_waitcnt lgkmcnt(2)
buffer_load_dwordx2 v[200:201],v245,s[8:11],s28 offen offset:1152
M v[112:115],a[200:203],a[208:211],v[112:115]
s_waitcnt lgkmcnt(1)
ds_read_b128 a[240:243],v248 offset:28160
v_and_b32 v212,s42,v212
M v[116:119],a[200:203],a[212:215],v[116:119]
v_and_b32 v210,s42,v210
v_fmac_f32 v204,s43,v208
M v[116:119],v[216:219],a[208:211],v[116:119]
v_fmac_f32 v214,4.0,v206
v_fma_f32 v235,-4.0,v208,v212
M v[116:119],a[244:247],v[228:231],v[116:119]
v_fmac_f32 v204,s45,v212
v_fmac_f32 v214,s41,v210
M v[120:123],a[244:247],a[208:211],v[120:123]
v_sub_f32 v212,v212,v208
v_fma_f32 v208,-4.0,v206,v210
M v[120:123],v[216:219],a[212:215],v[120:123]
s_waitcnt lgkmcnt(1)
v_sub_f32 v210,v210,v206
v_add_f32 v206,v235,v208
M v[120:123],a[200:203],a[228:231],v[120:123]
s_waitcnt lgkmcnt(0)
v_sub_f32 v235,v235,v208
v_fma_f32 v208,2.0,v210,v212
M v[124:127],a[200:203],a[240:243],v[124:127]
buffer_load_dwordx4 a[200:203],v250,s[20:23],s46 offen offset:1024 sc1
M v[124:127],v[216:219],a[228:231],v[124:127]
v_fmac_f32 v212,-2.0,v210
v_cvt_pk_bf16_f32 v204,v232,v204
M v[124:127],a[244:247],a[212:215],v[124:127]
s_waitcnt vmcnt(13)
buffer_load_dwordx4 v[216:219],v250,s[20:23],s46 offen offset:2048 sc1
M v[128:131],a[232:235],a[192:195],v[128:131]
s_waitcnt vmcnt(13)
s_add_u32 s47,s75,12288
v_cvt_pk_bf16_f32 v214,v237,v214
v_cvt_pk_bf16_f32 v206,v233,v206
M v[128:131],a[220:223],a[216:219],v[128:131]
s_waitcnt vmcnt(12)
v_cvt_pk_bf16_f32 v210,v234,v208
v_cvt_pk_bf16_f32 v208,v238,v235
M v[128:131],a[204:207],v[224:227],v[128:131]
v_cvt_pk_bf16_f32 v212,v236,v212
v_lshlrev_b32 v234,16,v209
M v[132:135],a[204:207],a[236:239],v[132:135]
buffer_load_dwordx4 a[244:247],v250,s[20:23],s47 offen offset:0 sc1
M v[132:135],a[220:223],v[224:227],v[132:135]
v_lshlrev_b32 v232,16,v205
v_lshlrev_b32 v233,16,v207
M v[132:135],a[232:235],a[216:219],v[132:135]
v_lshlrev_b32 v237,16,v215
v_lshlrev_b32 v236,16,v213
M v[136:139],a[232:235],v[224:227],v[136:139]
v_lshlrev_b32 v235,16,v211
v_fmac_f32 v232,s43,v234
M v[136:139],a[220:223],a[236:239],v[136:139]
v_fmac_f32 v237,4.0,v233
v_fma_f32 v238,-4.0,v234,v236
M v[136:139],a[204:207],a[224:227],v[136:139]
v_fmac_f32 v232,s45,v236
v_fmac_f32 v237,s41,v235
M v[140:143],a[204:207],v[228:231],v[140:143]
v_sub_f32 v236,v236,v234
v_fma_f32 v234,-4.0,v233,v235
M v[140:143],a[220:223],a[224:227],v[140:143]
v_sub_f32 v235,v235,v233
v_add_f32 v233,v238,v234
M v[140:143],a[232:235],a[236:239],v[140:143]
v_sub_f32 v238,v238,v234
v_fma_f32 v234,2.0,v235,v236
M v[144:147],a[232:235],a[224:227],v[144:147]
v_fmac_f32 v236,-2.0,v235
v_and_b32 v209,s42,v209
M v[144:147],a[220:223],v[228:231],v[144:147]
v_and_b32 v205,s42,v205
v_and_b32 v207,s42,v207
M v[144:147],a[204:207],a[208:211],v[144:147]
v_and_b32 v215,s42,v215
v_and_b32 v213,s42,v213
M v[148:151],a[204:207],a[212:215],v[148:151]
v_and_b32 v211,s42,v211
v_fmac_f32 v205,s43,v209
M v[148:151],a[220:223],a[208:211],v[148:151]
v_fmac_f32 v215,4.0,v207
v_fma_f32 v235,-4.0,v209,v213
M v[148:151],a[232:235],v[228:231],v[148:151]
v_fmac_f32 v205,s45,v213
v_fmac_f32 v215,s41,v211
M v[152:155],a[232:235],a[208:211],v[152:155]
v_sub_f32 v213,v213,v209
v_fma_f32 v209,-4.0,v207,v211
M v[152:155],a[220:223],a[212:215],v[152:155]
v_sub_f32 v211,v211,v207
v_add_f32 v207,v235,v209
M v[152:155],a[204:207],a[228:231],v[152:155]
v_sub_f32 v235,v235,v209
v_fma_f32 v209,2.0,v211,v213
M v[156:159],a[204:207],a[240:243],v[156:159]
buffer_load_dwordx4 a[204:207],v250,s[20:23],s47 offen offset:1024 sc1
M v[156:159],a[220:223],a[228:231],v[156:159]
v_fmac_f32 v213,-2.0,v211
v_cvt_pk_bf16_f32 v205,v232,v205
M v[156:159],a[232:235],a[212:215],v[156:159]
s_waitcnt vmcnt(13)
buffer_load_dwordx4 a[220:223],v250,s[20:23],s47 offen offset:2048 sc1
M v[160:163],v[220:223],a[192:195],v[160:163]
s_waitcnt vmcnt(13)
s_add_u32 s48,s75,15360
v_cvt_pk_bf16_f32 v215,v237,v215
v_cvt_pk_bf16_f32 v207,v233,v207
M v[160:163],a[196:199],a[216:219],v[160:163]
s_waitcnt vmcnt(12)
v_cvt_pk_bf16_f32 v211,v234,v209
v_cvt_pk_bf16_f32 v209,v238,v235
M v[160:163],a[248:251],v[224:227],v[160:163]
v_cvt_pk_bf16_f32 v213,v236,v213
v_add_u32 v238,121856,v247
M v[164:167],a[248:251],a[236:239],v[164:167]
buffer_load_dwordx4 a[232:235],v250,s[20:23],s48 offen offset:0 sc1
M v[164:167],a[196:199],v[224:227],v[164:167]
M v[164:167],v[220:223],a[216:219],v[164:167]
ds_write2st64_b64 v238,v[204:205],v[214:215] offset0:3 offset1:20
M v[168:171],v[220:223],v[224:227],v[168:171]
s_add_u32 s28,s70,6684672
M v[168:171],a[196:199],a[236:239],v[168:171]
buffer_load_dwordx4 a[192:195],v250,s[20:23],s48 offen offset:1024 sc1
M v[168:171],a[248:251],a[224:227],v[168:171]
ds_write2st64_b64 v247,v[206:207],v[208:209] offset0:3 offset1:20
M v[172:175],a[248:251],v[228:231],v[172:175]
M v[172:175],a[196:199],a[224:227],v[172:175]
buffer_load_dwordx4 a[216:219],v250,s[20:23],s48 offen offset:2048 sc1
M v[172:175],v[220:223],a[236:239],v[172:175]
s_add_u32 s46,s75,18432
ds_write2st64_b64 v247,v[210:211],v[212:213] offset0:139 offset1:156
M v[176:179],v[220:223],a[224:227],v[176:179]
M v[176:179],a[196:199],v[228:231],v[176:179]
buffer_load_dwordx4 v[224:227],v250,s[20:23],s46 offen offset:0 sc1
M v[176:179],a[248:251],a[208:211],v[176:179]
s_waitcnt lgkmcnt(0)
s_barrier
v_add_u32 v248,0xffffbc00,v248
M v[180:183],a[248:251],a[212:215],v[180:183]
v_add_u32 v249,0xffffbc00,v249
M v[180:183],a[196:199],a[208:211],v[180:183]
ds_read_b128 a[236:239],v248 offset:0
M v[180:183],v[220:223],v[228:231],v[180:183]
buffer_load_dwordx2 v[204:205],v245,s[12:15],s28 offen offset:0
M v[184:187],v[220:223],a[208:211],v[184:187]
ds_read_b128 a[224:227],v249 offset:0
ds_read_b128 v[228:231],v248 offset:512
M v[184:187],a[196:199],a[212:215],v[184:187]
ds_read_b128 a[208:211],v249 offset:512
M v[184:187],a[248:251],a[228:231],v[184:187]
M v[188:191],a[248:251],a[240:243],v[188:191]
buffer_load_dwordx2 v[214:215],v245,s[16:19],s28 offen offset:1536
M v[188:191],a[196:199],a[228:231],v[188:191]
M v[188:191],v[220:223],a[212:215],v[188:191]
s_waitcnt vmcnt(17) lgkmcnt(3)
M a[0:3],a[252:255],a[236:239],a[0:3]
s_waitcnt vmcnt(10) lgkmcnt(2)
ds_read_b128 a[240:243],v248 offset:1024
M a[0:3],a[200:203],a[224:227],a[0:3]
s_waitcnt vmcnt(9) lgkmcnt(2)
buffer_load_dwordx2 v[206:207],v245,s[8:11],s28 offen offset:0
M a[0:3],v[216:219],v[228:231],a[0:3]
s_waitcnt lgkmcnt(1)
ds_read_b128 a[248:251],v249 offset:1024
v_lshlrev_b32 v234,16,v196
M a[4:7],v[216:219],a[208:211],a[4:7]
v_lshlrev_b32 v232,16,v192
v_lshlrev_b32 v233,16,v194
M a[4:7],a[200:203],v[228:231],a[4:7]
v_lshlrev_b32 v237,16,v202
v_lshlrev_b32 v236,16,v200
M a[4:7],a[252:255],a[224:227],a[4:7]
buffer_load_dwordx2 v[208:209],v245,s[8:11],s28 offen offset:384
M a[8:11],a[252:255],v[228:231],a[8:11]
ds_read_b128 a[196:199],v248 offset:1536
v_lshlrev_b32 v235,16,v198
M a[8:11],a[200:203],a[208:211],a[8:11]
s_waitcnt lgkmcnt(2)
ds_read_b128 a[228:231],v249 offset:1536
v_fmac_f32 v232,s43,v234
M a[8:11],v[216:219],a[240:243],a[8:11]
s_waitcnt lgkmcnt(2)
v_fmac_f32 v237,4.0,v233
v_fma_f32 v238,-4.0,v234,v236
M a[12:15],v[216:219],a[248:251],a[12:15]
buffer_load_dwordx2 v[210:211],v245,s[8:11],s28 offen offset:768
M a[12:15],a[200:203],a[240:243],a[12:15]
v_fmac_f32 v232,s45,v236
v_fmac_f32 v237,s41,v235
M a[12:15],a[252:255],a[208:211],a[12:15]
v_sub_f32 v236,v236,v234
v_fma_f32 v234,-4.0,v233,v235
M a[16:19],a[252:255],a[240:243],a[16:19]
ds_read_b128 a[212:215],v249 offset:2048
v_sub_f32 v235,v235,v233
M a[16:19],a[200:203],a[248:251],a[16:19]
s_waitcnt lgkmcnt(2)
buffer_load_dwordx2 v[212:213],v245,s[8:11],s28 offen offset:1152
M a[16:19],v[216:219],a[196:199],a[16:19]
s_waitcnt lgkmcnt(1)
ds_read_b128 v[220:223],v248 offset:2048
v_add_f32 v233,v238,v234
M a[20:23],v[216:219],a[228:231],a[20:23]
v_sub_f32 v238,v238,v234
v_fma_f32 v234,2.0,v235,v236
M a[20:23],a[200:203],a[196:199],a[20:23]
v_fmac_f32 v236,-2.0,v235
v_and_b32 v196,s42,v196
M a[20:23],a[252:255],a[248:251],a[20:23]
v_and_b32 v192,s42,v192
v_and_b32 v194,s42,v194
M a[24:27],a[252:255],a[196:199],a[24:27]
v_and_b32 v202,s42,v202
v_and_b32 v200,s42,v200
M a[24:27],a[200:203],a[228:231],a[24:27]
s_waitcnt lgkmcnt(1)
v_and_b32 v198,s42,v198
v_fmac_f32 v192,s43,v196
M a[24:27],v[216:219],a[212:215],a[24:27]
s_waitcnt lgkmcnt(0)
v_fmac_f32 v202,4.0,v194
v_fma_f32 v235,-4.0,v196,v200
M a[28:31],v[216:219],v[220:223],a[28:31]
buffer_load_dwordx4 v[216:219],v250,s[20:23],s46 offen offset:1024 sc1
M a[28:31],a[200:203],a[212:215],a[28:31]
v_fmac_f32 v192,s45,v200
v_fmac_f32 v202,s41,v198
M a[28:31],a[252:255],a[228:231],a[28:31]
s_waitcnt vmcnt(13)
buffer_load_dwordx4 a[200:203],v250,s[20:23],s46 offen offset:2048 sc1
M a[32:35],a[244:247],a[236:239],a[32:35]
s_waitcnt vmcnt(13)
s_add_u32 s47,s75,21504
v_sub_f32 v200,v200,v196
v_fma_f32 v196,-4.0,v194,v198
M a[32:35],a[204:207],a[224:227],a[32:35]
s_waitcnt vmcnt(12)
v_sub_f32 v198,v198,v194
v_add_f32 v194,v235,v196
M a[32:35],a[220:223],v[228:231],a[32:35]
v_sub_f32 v235,v235,v196
v_fma_f32 v196,2.0,v198,v200
M a[36:39],a[220:223],a[208:211],a[36:39]
buffer_load_dwordx4 a[252:255],v250,s[20:23],s47 offen offset:0 sc1
M a[36:39],a[204:207],v[228:231],a[36:39]
v_fmac_f32 v200,-2.0,v198
v_cvt_pk_bf16_f32 v192,v232,v192
M a[36:39],a[244:247],a[224:227],a[36:39]
v_cvt_pk_bf16_f32 v202,v237,v202
v_cvt_pk_bf16_f32 v194,v233,v194
M a[40:43],a[244:247],v[228:231],a[40:43]
v_cvt_pk_bf16_f32 v198,v234,v196
v_cvt_pk_bf16_f32 v196,v238,v235
M a[40:43],a[204:207],a[208:211],a[40:43]
v_cvt_pk_bf16_f32 v200,v236,v200
v_lshlrev_b32 v234,16,v197
M a[40:43],a[220:223],a[240:243],a[40:43]
v_lshlrev_b32 v232,16,v193
v_lshlrev_b32 v233,16,v195
M a[44:47],a[220:223],a[248:251],a[44:47]
v_lshlrev_b32 v237,16,v203
v_lshlrev_b32 v236,16,v201
M a[44:47],a[204:207],a[240:243],a[44:47]
v_lshlrev_b32 v235,16,v199
v_fmac_f32 v232,s43,v234
M a[44:47],a[244:247],a[208:211],a[44:47]
v_fmac_f32 v237,4.0,v233
v_fma_f32 v238,-4.0,v234,v236
M a[48:51],a[244:247],a[240:243],a[48:51]
v_fmac_f32 v232,s45,v236
v_fmac_f32 v237,s41,v235
M a[48:51],a[204:207],a[248:251],a[48:51]
v_sub_f32 v236,v236,v234
v_fma_f32 v234,-4.0,v233,v235
M a[48:51],a[220:223],a[196:199],a[48:51]
v_sub_f32 v235,v235,v233
v_add_f32 v233,v238,v234
M a[52:55],a[220:223],a[228:231],a[52:55]
v_sub_f32 v238,v238,v234
v_fma_f32 v234,2.0,v235,v236
M a[52:55],a[204:207],a[196:199],a[52:55]
v_fmac_f32 v236,-2.0,v235
v_and_b32 v197,s42,v197
M a[52:55],a[244:247],a[248:251],a[52:55]
v_and_b32 v193,s42,v193
v_and_b32 v195,s42,v195
M a[56:59],a[244:247],a[196:199],a[56:59]
v_and_b32 v203,s42,v203
v_and_b32 v201,s42,v201
M a[56:59],a[204:207],a[228:231],a[56:59]
v_and_b32 v199,s42,v199
v_fmac_f32 v193,s43,v197
M a[56:59],a[220:223],a[212:215],a[56:59]
v_fmac_f32 v203,4.0,v195
v_fma_f32 v235,-4.0,v197,v201
M a[60:63],a[220:223],v[220:223],a[60:63]
buffer_load_dwordx4 a[220:223],v250,s[20:23],s47 offen offset:1024 sc1
M a[60:63],a[204:207],a[212:215],a[60:63]
v_fmac_f32 v193,s45,v201
v_fmac_f32 v203,s41,v199
M a[60:63],a[244:247],a[228:231],a[60:63]
s_waitcnt vmcnt(13)
buffer_load_dwordx4 a[204:207],v250,s[20:23],s47 offen offset:2048 sc1
M a[64:67],a[232:235],a[236:239],a[64:67]
s_waitcnt vmcnt(13)
s_add_u32 s48,s75,24576
v_sub_f32 v201,v201,v197
v_fma_f32 v197,-4.0,v195,v199
M a[64:67],a[192:195],a[224:227],a[64:67]
s_waitcnt vmcnt(12)
v_sub_f32 v199,v199,v195
v_add_f32 v195,v235,v197
M a[64:67],a[216:219],v[228:231],a[64:67]
v_sub_f32 v235,v235,v197
v_fma_f32 v197,2.0,v199,v201
M a[68:71],a[216:219],a[208:211],a[68:71]
buffer_load_dwordx4 a[244:247],v250,s[20:23],s48 offen offset:0 sc1
M a[68:71],a[192:195],v[228:231],a[68:71]
v_fmac_f32 v201,-2.0,v199
v_cvt_pk_bf16_f32 v193,v232,v193
M a[68:71],a[232:235],a[224:227],a[68:71]
v_cvt_pk_bf16_f32 v203,v237,v203
v_cvt_pk_bf16_f32 v195,v233,v195
M a[72:75],a[232:235],v[228:231],a[72:75]
v_cvt_pk_bf16_f32 v199,v234,v197
v_cvt_pk_bf16_f32 v197,v238,v235
M a[72:75],a[192:195],a[208:211],a[72:75]
buffer_load_dwordx4 a[236:239],v250,s[20:23],s48 offen offset:1024 sc1
M a[72:75],a[216:219],a[240:243],a[72:75]
v_cvt_pk_bf16_f32 v201,v236,v201
v_add_u32 v238,139264,v247
M a[76:79],a[216:219],a[248:251],a[76:79]
M a[76:79],a[192:195],a[240:243],a[76:79]
M a[76:79],a[232:235],a[208:211],a[76:79]
buffer_load_dwordx4 a[224:227],v250,s[20:23],s48 offen offset:2048 sc1
M a[80:83],a[232:235],a[240:243],a[80:83]
s_add_u32 s46,s75,27648
M a[80:83],a[192:195],a[248:251],a[80:83]
M a[80:83],a[216:219],a[196:199],a[80:83]
ds_write2st64_b64 v238,v[192:193],v[202:203] offset0:0 offset1:17
M a[84:87],a[216:219],a[228:231],a[84:87]
s_add_u32 s28,s70,7077888
buffer_load_dwordx4 v[228:231],v250,s[20:23],s46 offen offset:0 sc1
M a[84:87],a[192:195],a[196:199],a[84:87]
ds_read_b128 a[208:211],v248 offset:8704
M a[84:87],a[232:235],a[248:251],a[84:87]
ds_write2st64_b64 v247,v[194:195],v[196:197] offset0:34 offset1:51
M a[88:91],a[232:235],a[196:199],a[88:91]
buffer_load_dwordx2 v[192:193],v245,s[12:15],s28 offen offset:0
M a[88:91],a[192:195],a[228:231],a[88:91]
ds_read_b128 a[240:243],v249 offset:8704
ds_read_b128 a[248:251],v248 offset:9216
M a[88:91],a[216:219],a[212:215],a[88:91]
ds_write2st64_b64 v247,v[198:199],v[200:201] offset0:68 offset1:85
M a[92:95],a[216:219],v[220:223],a[92:95]
buffer_load_dwordx2 v[202:203],v245,s[16:19],s28 offen offset:1536
M a[92:95],a[192:195],a[212:215],a[92:95]
ds_read_b128 a[196:199],v249 offset:9216
M a[92:95],a[232:235],a[228:231],a[92:95]
s_waitcnt vmcnt(17) lgkmcnt(5)
M a[96:99],v[224:227],a[208:211],a[96:99]
s_waitcnt vmcnt(10) lgkmcnt(3)
ds_read_b128 a[216:219],v248 offset:9728
M a[96:99],v[216:219],a[240:243],a[96:99]
s_waitcnt vmcnt(9) lgkmcnt(3)
buffer_load_dwordx2 v[194:195],v245,s[8:11],s28 offen offset:0
M a[96:99],a[200:203],a[248:251],a[96:99]
s_waitcnt lgkmcnt(1)
ds_read_b128 v[220:223],v249 offset:9728
v_lshlrev_b32 v234,16,v208
M a[100:103],a[200:203],a[196:199],a[100:103]
v_lshlrev_b32 v232,16,v204
v_lshlrev_b32 v233,16,v206
M a[100:103],v[216:219],a[248:251],a[100:103]
v_lshlrev_b32 v237,16,v214
v_lshlrev_b32 v236,16,v212
M a[100:103],v[224:227],a[240:243],a[100:103]
buffer_load_dwordx2 v[196:197],v245,s[8:11],s28 offen offset:384
M a[104:107],v[224:227],a[248:251],a[104:107]
ds_read_b128 a[192:195],v248 offset:10240
v_lshlrev_b32 v235,16,v210
M a[104:107],v[216:219],a[196:199],a[104:107]
s_waitcnt lgkmcnt(2)
ds_read_b128 a[212:215],v249 offset:10240
v_fmac_f32 v232,s43,v234
M a[104:107],a[200:203],a[216:219],a[104:107]
s_waitcnt lgkmcnt(2)
v_fmac_f32 v237,4.0,v233
v_fma_f32 v238,-4.0,v234,v236
M a[108:111],a[200:203],v[220:223],a[108:111]
buffer_load_dwordx2 v[198:199],v245,s[8:11],s28 offen offset:768
M a[108:111],v[216:219],a[216:219],a[108:111]
v_fmac_f32 v232,s45,v236
v_fmac_f32 v237,s41,v235
M a[108:111],v[224:227],a[196:199],a[108:111]
v_sub_f32 v236,v236,v234
v_fma_f32 v234,-4.0,v233,v235
M a[112:115],v[224:227],a[216:219],a[112:115]
ds_read_b128 a[228:231],v249 offset:10752
v_sub_f32 v235,v235,v233
M a[112:115],v[216:219],v[220:223],a[112:115]
s_waitcnt lgkmcnt(2)
buffer_load_dwordx2 v[200:201],v245,s[8:11],s28 offen offset:1152
M a[112:115],a[200:203],a[192:195],a[112:115]
s_waitcnt lgkmcnt(1)
ds_read_b128 a[232:235],v248 offset:10752
v_add_f32 v233,v238,v234
M a[116:119],a[200:203],a[212:215],a[116:119]
v_sub_f32 v238,v238,v234
v_fma_f32 v234,2.0,v235,v236
M a[116:119],v[216:219],a[192:195],a[116:119]
v_fmac_f32 v236,-2.0,v235
v_and_b32 v208,s42,v208
M a[116:119],v[224:227],v[220:223],a[116:119]
v_and_b32 v204,s42,v204
v_and_b32 v206,s42,v206
M a[120:123],v[224:227],a[192:195],a[120:123]
v_and_b32 v214,s42,v214
v_and_b32 v212,s42,v212
M a[120:123],v[216:219],a[212:215],a[120:123]
s_waitcnt lgkmcnt(1)
v_and_b32 v210,s42,v210
v_fmac_f32 v204,s43,v208
M a[120:123],a[200:203],a[228:231],a[120:123]
s_waitcnt lgkmcnt(0)
v_fmac_f32 v214,4.0,v206
v_fma_f32 v235,-4.0,v208,v212
M a[124:127],a[200:203],a[232:235],a[124:127]
buffer_load_dwordx4 a[200:203],v250,s[20:23],s46 offen offset:1024 sc1
M a[124:127],v[216:219],a[228:231],a[124:127]
v_fmac_f32 v204,s45,v212
v_fmac_f32 v214,s41,v210
M a[124:127],v[224:227],a[212:215],a[124:127]
s_waitcnt vmcnt(13)
buffer_load_dwordx4 v[216:219],v250,s[20:23],s46 offen offset:2048 sc1
M a[128:131],a[252:255],a[208:211],a[128:131]
s_waitcnt vmcnt(13)
s_add_u32 s47,s75,30720
v_sub_f32 v212,v212,v208
v_fma_f32 v208,-4.0,v206,v210
M a[128:131],a[220:223],a[240:243],a[128:131]
s_waitcnt vmcnt(12)
v_sub_f32 v210,v210,v206
v_add_f32 v206,v235,v208
M a[128:131],a[204:207],a[248:251],a[128:131]
v_sub_f32 v235,v235,v208
v_fma_f32 v208,2.0,v210,v212
M a[132:135],a[204:207],a[196:199],a[132:135]
buffer_load_dwordx4 v[224:227],v250,s[20:23],s47 offen offset:0 sc1
M a[132:135],a[220:223],a[248:251],a[132:135]
v_fmac_f32 v212,-2.0,v210
v_cvt_pk_bf16_f32 v204,v232,v204
M a[132:135],a[252:255],a[240:243],a[132:135]
v_cvt_pk_bf16_f32 v214,v237,v214
v_cvt_pk_bf16_f32 v206,v233,v206
M a[136:139],a[252:255],a[248:251],a[136:139]
v_cvt_pk_bf16_f32 v210,v234,v208
v_cvt_pk_bf16_f32 v208,v238,v235
M a[136:139],a[220:223],a[196:199],a[136:139]
v_cvt_pk_bf16_f32 v212,v236,v212
v_lshlrev_b32 v234,16,v209
M a[136:139],a[204:207],a[216:219],a[136:139]
v_lshlrev_b32 v232,16,v205
v_lshlrev_b32 v233,16,v207
M a[140:143],a[204:207],v[220:223],a[140:143]
v_lshlrev_b32 v237,16,v215
v_lshlrev_b32 v236,16,v213
M a[140:143],a[220:223],a[216:219],a[140:143]
v_lshlrev_b32 v235,16,v211
v_fmac_f32 v232,s43,v234
M a[140:143],a[252:255],a[196:199],a[140:143]
v_fmac_f32 v237,4.0,v233
v_fma_f32 v238,-4.0,v234,v236
M a[144:147],a[252:255],a[216:219],a[144:147]
v_fmac_f32 v232,s45,v236
v_fmac_f32 v237,s41,v235
M a[144:147],a[220:223],v[220:223],a[144:147]
v_sub_f32 v236,v236,v234
v_fma_f32 v234,-4.0,v233,v235
M a[144:147],a[204:207],a[192:195],a[144:147]
v_sub_f32 v235,v235,v233
v_add_f32 v233,v238,v234
M a[148:151],a[204:207],a[212:215],a[148:151]
v_sub_f32 v238,v238,v234
v_fma_f32 v234,2.0,v235,v236
M a[148:151],a[220:223],a[192:195],a[148:151]
v_fmac_f32 v236,-2.0,v235
v_and_b32 v209,s42,v209
M a[148:151],a[252:255],v[220:223],a[148:151]
v_and_b32 v205,s42,v205
v_and_b32 v207,s42,v207
M a[152:155],a[252:255],a[192:195],a[152:155]
v_and_b32 v215,s42,v215
v_and_b32 v213,s42,v213
M a[152:155],a[220:223],a[212:215],a[152:155]
v_and_b32 v211,s42,v211
v_fmac_f32 v205,s43,v209
M a[152:155],a[204:207],a[228:231],a[152:155]
v_fmac_f32 v215,4.0,v207
v_fma_f32 v235,-4.0,v209,v213
M a[156:159],a[204:207],a[232:235],a[156:159]
buffer_load_dwordx4 a[204:207],v250,s[20:23],s47 offen offset:1024 sc1
M a[156:159],a[220:223],a[228:231],a[156:159]
v_fmac_f32 v205,s45,v213
v_fmac_f32 v215,s41,v211
M a[156:159],a[252:255],a[212:215],a[156:159]
s_waitcnt vmcnt(13)
buffer_load_dwordx4 a[220:223],v250,s[20:23],s47 offen offset:2048 sc1
M a[160:163],a[244:247],a[208:211],a[160:163]
s_waitcnt vmcnt(13)
s_add_u32 s48,s75,33792
v_sub_f32 v213,v213,v209
v_fma_f32 v209,-4.0,v207,v211
M a[160:163],a[236:239],a[240:243],a[160:163]
s_waitcnt vmcnt(12)
v_sub_f32 v211,v211,v207
v_add_f32 v207,v235,v209
M a[160:163],a[224:227],a[248:251],a[160:163]
v_sub_f32 v235,v235,v209
v_fma_f32 v209,2.0,v211,v213
M a[164:167],a[224:227],a[196:199],a[164:167]
buffer_load_dwordx4 a[252:255],v250,s[20:23],s48 offen offset:0 sc1
M a[164:167],a[236:239],a[248:251],a[164:167]
v_fmac_f32 v213,-2.0,v211
v_cvt_pk_bf16_f32 v205,v232,v205
M a[164:167],a[244:247],a[240:243],a[164:167]
v_cvt_pk_bf16_f32 v215,v237,v215
v_cvt_pk_bf16_f32 v207,v233,v207
M a[168:171],a[244:247],a[248:251],a[168:171]
v_cvt_pk_bf16_f32 v211,v234,v209
v_cvt_pk_bf16_f32 v209,v238,v235
M a[168:171],a[236:239],a[196:199],a[168:171]
buffer_load_dwordx4 a[208:211],v250,s[20:23],s48 offen offset:1024 sc1
M a[168:171],a[224:227],a[216:219],a[168:171]
v_cvt_pk_bf16_f32 v213,v236,v213
v_add_u32 v238,139264,v247
M a[172:175],a[224:227],v[220:223],a[172:175]
v_fmac_f32 v239,s43,v241
v_fmac_f32 v244,4.0,v240
M a[172:175],a[236:239],a[216:219],a[172:175]
v_fma_f32 v232,-4.0,v241,v243
v_fmac_f32 v239,s45,v243
M a[172:175],a[244:247],a[196:199],a[172:175]
buffer_load_dwordx4 a[240:243],v250,s[20:23],s48 offen offset:2048 sc1
M a[176:179],a[244:247],a[216:219],a[176:179]
s_add_u32 s46,s75,36864
v_fmac_f32 v244,s41,v242
v_sub_f32 v243,v243,v241
M a[176:179],a[236:239],v[220:223],a[176:179]
v_add_u32 v248,0x4400,v248
v_add_u32 v249,0x4400,v249
M a[176:179],a[224:227],a[192:195],a[176:179]
ds_write2st64_b64 v238,v[204:205],v[214:215] offset0:1 offset1:18
M a[180:183],a[224:227],a[212:215],a[180:183]
s_add_u32 s28,s70,7471104
buffer_load_dwordx4 a[248:251],v250,s[20:23],s46 offen offset:0 sc1
M a[180:183],a[236:239],a[192:195],a[180:183]
ds_read_b128 a[196:199],v248 offset:52224
v_fma_f32 v241,-4.0,v240,v242
M a[180:183],a[244:247],v[220:223],a[180:183]
ds_write2st64_b64 v247,v[206:207],v[208:209] offset0:35 offset1:52
M a[184:187],a[244:247],a[192:195],a[184:187]
buffer_load_dwordx2 v[204:205],v245,s[12:15],s28 offen offset:0
M a[184:187],a[236:239],a[212:215],a[184:187]
ds_read_b128 a[216:219],v249 offset:52224
ds_read_b128 v[220:223],v248 offset:52736
M a[184:187],a[224:227],a[228:231],a[184:187]
ds_write2st64_b64 v247,v[210:211],v[212:213] offset0:69 offset1:86
M a[188:191],a[224:227],a[232:235],a[188:191]
buffer_load_dwordx2 v[214:215],v245,s[16:19],s28 offen offset:1536
M a[188:191],a[236:239],a[228:231],a[188:191]
ds_read_b128 a[192:195],v249 offset:52736
v_sub_f32 v242,v242,v240
M a[188:191],a[244:247],a[212:215],a[188:191]
s_waitcnt vmcnt(17) lgkmcnt(5)
v_add_f32 v240,v232,v241
v_sub_f32 v232,v232,v241
M v[0:3],v[228:231],a[196:199],v[0:3]
s_waitcnt vmcnt(10) lgkmcnt(3)
ds_read_b128 a[224:227],v248 offset:53248
v_fma_f32 v241,2.0,v242,v243
M v[0:3],a[200:203],a[216:219],v[0:3]
s_waitcnt vmcnt(9) lgkmcnt(3)
buffer_load_dwordx2 v[206:207],v245,s[8:11],s28 offen offset:0
M v[0:3],v[216:219],v[220:223],v[0:3]
s_waitcnt lgkmcnt(1)
ds_read_b128 a[232:235],v249 offset:53248
v_fmac_f32 v243,-2.0,v242
M v[4:7],v[216:219],a[192:195],v[4:7]
v_cvt_pk_bf16_f32 v233,v239,v244
v_cvt_pk_bf16_f32 v234,v240,v232
M v[4:7],a[200:203],v[220:223],v[4:7]
v_cvt_pk_bf16_f32 v235,v241,v243
v_add_u32 v232,139264,v252
M v[4:7],v[228:231],a[216:219],v[4:7]
buffer_load_dwordx2 v[208:209],v245,s[8:11],s28 offen offset:384
M v[8:11],v[228:231],v[220:223],v[8:11]
ds_read_b128 a[228:231],v248 offset:53760
ds_write_b16 v232,v233 offset:0
M v[8:11],a[200:203],a[192:195],v[8:11]
s_waitcnt lgkmcnt(3)
ds_read_b128 a[236:239],v249 offset:53760
ds_write_b16_d16_hi v232,v233 offset:8704
M v[8:11],v[216:219],a[224:227],v[8:11]
s_waitcnt lgkmcnt(4)
ds_write_b16 v252,v234 offset:17408
M v[12:15],v[216:219],a[232:235],v[12:15]
buffer_load_dwordx2 v[210:211],v245,s[8:11],s28 offen offset:768
M v[12:15],a[200:203],a[224:227],v[12:15]
ds_write_b16_d16_hi v252,v234 offset:26112
M v[12:15],v[228:231],a[192:195],v[12:15]
ds_write_b16 v252,v235 offset:34816
M v[16:19],v[228:231],a[224:227],v[16:19]
ds_read_b128 a[212:215],v249 offset:54272
ds_write_b16_d16_hi v252,v235 offset:43520
M v[16:19],a[200:203],a[232:235],v[16:19]
s_waitcnt lgkmcnt(8)
buffer_load_dwordx2 v[212:213],v245,s[8:11],s28 offen offset:1152
M v[16:19],v[216:219],a[228:231],v[16:19]
s_waitcnt lgkmcnt(6)
s_add_u32 s29,s71,6291456
ds_read_b128 a[244:247],v248 offset:54272
v_lshlrev_b32 v234,16,v196
M v[20:23],v[216:219],a[236:239],v[20:23]
v_lshlrev_b32 v232,16,v192
v_lshlrev_b32 v233,16,v194
M v[20:23],a[200:203],a[228:231],v[20:23]
buffer_load_short_d16_hi v239,v246,s[12:15],s29 offen offset:0
M v[20:23],v[228:231],a[232:235],v[20:23]
v_lshlrev_b32 v237,16,v202
v_lshlrev_b32 v236,16,v200
M v[24:27],v[228:231],a[228:231],v[24:27]
buffer_load_short_d16_hi v240,v246,s[8:11],s29 offen offset:0
M v[24:27],a[200:203],a[236:239],v[24:27]
s_waitcnt lgkmcnt(2)
v_lshlrev_b32 v235,16,v198
v_fmac_f32 v232,s43,v234
M v[24:27],v[216:219],a[212:215],v[24:27]
s_waitcnt lgkmcnt(0)
buffer_load_short_d16_hi v241,v246,s[8:11],s29 offen offset:384
M v[28:31],v[216:219],a[244:247],v[28:31]
v_fmac_f32 v237,4.0,v233
v_fma_f32 v238,-4.0,v234,v236
M v[28:31],a[200:203],a[212:215],v[28:31]
buffer_load_dwordx4 v[216:219],v250,s[20:23],s46 offen offset:1024 sc1
M v[28:31],v[228:231],a[236:239],v[28:31]
s_waitcnt vmcnt(16)
v_fmac_f32 v232,s45,v236
v_fmac_f32 v237,s41,v235
M v[32:35],v[224:227],a[196:199],v[32:35]
s_waitcnt vmcnt(15)
v_sub_f32 v236,v236,v234
v_fma_f32 v234,-4.0,v233,v235
M v[32:35],a[204:207],a[216:219],v[32:35]
s_waitcnt vmcnt(14)
v_sub_f32 v235,v235,v233
v_add_f32 v233,v238,v234
M v[32:35],a[220:223],v[220:223],v[32:35]
buffer_load_dwordx4 a[200:203],v250,s[20:23],s46 offen offset:2048 sc1
M v[36:39],a[220:223],a[192:195],v[36:39]
s_add_u32 s47,s75,39936
v_sub_f32 v238,v238,v234
v_fma_f32 v234,2.0,v235,v236
M v[36:39],a[204:207],v[220:223],v[36:39]
v_fmac_f32 v236,-2.0,v235
v_and_b32 v196,s42,v196
M v[36:39],v[224:227],a[216:219],v[36:39]
v_and_b32 v192,s42,v192
v_and_b32 v194,s42,v194
M v[40:43],v[224:227],v[220:223],v[40:43]
buffer_load_dwordx4 v[228:231],v250,s[20:23],s47 offen offset:0 sc1
M v[40:43],a[204:207],a[192:195],v[40:43]
v_and_b32 v202,s42,v202
v_and_b32 v200,s42,v200
M v[40:43],a[220:223],a[224:227],v[40:43]
v_and_b32 v198,s42,v198
v_fmac_f32 v192,s43,v196
M v[44:47],a[220:223],a[232:235],v[44:47]
v_fmac_f32 v202,4.0,v194
v_fma_f32 v235,-4.0,v196,v200
M v[44:47],a[204:207],a[224:227],v[44:47]
buffer_load_short_d16_hi v242,v246,s[8:11],s29 offen offset:768
M v[44:47],v[224:227],a[192:195],v[44:47]
v_fmac_f32 v192,s45,v200
v_fmac_f32 v202,s41,v198
M v[48:51],v[224:227],a[224:227],v[48:51]
buffer_load_short_d16_hi v243,v246,s[8:11],s29 offen offset:1152
M v[48:51],a[204:207],a[232:235],v[48:51]
v_sub_f32 v200,v200,v196
v_fma_f32 v196,-4.0,v194,v198
M v[48:51],a[220:223],a[228:231],v[48:51]
buffer_load_short_d16_hi v244,v246,s[16:19],s29 offen offset:1536
M v[52:55],a[220:223],a[236:239],v[52:55]
v_sub_f32 v198,v198,v194
v_add_f32 v194,v235,v196
M v[52:55],a[204:207],a[228:231],v[52:55]
v_sub_f32 v235,v235,v196
v_fma_f32 v196,2.0,v198,v200
M v[52:55],v[224:227],a[232:235],v[52:55]
v_fmac_f32 v200,-2.0,v198
v_cvt_pk_bf16_f32 v192,v232,v192
M v[56:59],v[224:227],a[228:231],v[56:59]
v_cvt_pk_bf16_f32 v202,v237,v202
v_cvt_pk_bf16_f32 v194,v233,v194
M v[56:59],a[204:207],a[236:239],v[56:59]
v_cvt_pk_bf16_f32 v198,v234,v196
v_cvt_pk_bf16_f32 v196,v238,v235
M v[56:59],a[220:223],a[212:215],v[56:59]
v_cvt_pk_bf16_f32 v200,v236,v200
v_lshlrev_b32 v234,16,v197
M v[60:63],a[220:223],a[244:247],v[60:63]
buffer_load_dwordx4 a[220:223],v250,s[20:23],s47 offen offset:1024 sc1
M v[60:63],a[204:207],a[212:215],v[60:63]
v_lshlrev_b32 v232,16,v193
v_lshlrev_b32 v233,16,v195
M v[60:63],v[224:227],a[236:239],v[60:63]
s_waitcnt vmcnt(19)
buffer_load_dwordx4 a[204:207],v250,s[20:23],s47 offen offset:2048 sc1
M v[64:67],a[252:255],a[196:199],v[64:67]
s_waitcnt vmcnt(19)
s_add_u32 s48,s75,43008
v_lshlrev_b32 v237,16,v203
v_lshlrev_b32 v236,16,v201
M v[64:67],a[208:211],a[216:219],v[64:67]
s_waitcnt vmcnt(18)
v_lshlrev_b32 v235,16,v199
v_fmac_f32 v232,s43,v234
M v[64:67],a[240:243],v[220:223],v[64:67]
v_fmac_f32 v237,4.0,v233
v_fma_f32 v238,-4.0,v234,v236
M v[68:71],a[240:243],a[192:195],v[68:71]
buffer_load_dwordx4 v[224:227],v250,s[20:23],s48 offen offset:0 sc1
M v[68:71],a[208:211],v[220:223],v[68:71]
v_fmac_f32 v232,s45,v236
v_fmac_f32 v237,s41,v235
M v[68:71],a[252:255],a[216:219],v[68:71]
v_sub_f32 v236,v236,v234
v_fma_f32 v234,-4.0,v233,v235
M v[72:75],a[252:255],v[220:223],v[72:75]
v_sub_f32 v235,v235,v233
v_add_f32 v233,v238,v234
M v[72:75],a[208:211],a[192:195],v[72:75]
buffer_load_dwordx4 a[196:199],v250,s[20:23],s48 offen offset:1024 sc1
M v[72:75],a[240:243],a[224:227],v[72:75]
v_sub_f32 v238,v238,v234
v_fma_f32 v234,2.0,v235,v236
M v[76:79],a[240:243],a[232:235],v[76:79]
v_fmac_f32 v236,-2.0,v235
v_and_b32 v197,s42,v197
M v[76:79],a[208:211],a[224:227],v[76:79]
v_and_b32 v193,s42,v193
v_and_b32 v195,s42,v195
M v[76:79],a[252:255],a[192:195],v[76:79]
buffer_load_dwordx4 a[216:219],v250,s[20:23],s48 offen offset:2048 sc1
M v[80:83],a[252:255],a[224:227],v[80:83]
s_add_u32 s46,s76,9216
v_and_b32 v203,s42,v203
v_and_b32 v201,s42,v201
M v[80:83],a[208:211],a[232:235],v[80:83]
v_and_b32 v199,s42,v199
v_fmac_f32 v193,s43,v197
M v[80:83],a[240:243],a[228:231],v[80:83]
v_fmac_f32 v203,4.0,v195
v_fma_f32 v235,-4.0,v197,v201
M v[84:87],a[240:243],a[236:239],v[84:87]
buffer_load_dwordx4 v[220:223],v250,s[20:23],s46 offen offset:0 sc1
M v[84:87],a[208:211],a[228:231],v[84:87]
ds_read_b128 a[192:195],v248 offset:60928
v_fmac_f32 v193,s45,v201
M v[84:87],a[252:255],a[232:235],v[84:87]
ds_read_b128 a[224:227],v249 offset:60928
v_fmac_f32 v203,s41,v199
M v[88:91],a[252:255],a[228:231],v[88:91]
ds_read_b128 a[232:235],v248 offset:61440
v_sub_f32 v201,v201,v197
M v[88:91],a[208:211],a[236:239],v[88:91]
ds_read_b128 a[228:231],v249 offset:61440
v_fma_f32 v197,-4.0,v195,v199
M v[88:91],a[240:243],a[212:215],v[88:91]
v_sub_f32 v199,v199,v195
v_add_f32 v195,v235,v197
M v[92:95],a[240:243],a[244:247],v[92:95]
v_sub_f32 v235,v235,v197
v_fma_f32 v197,2.0,v199,v201
M v[92:95],a[208:211],a[212:215],v[92:95]
v_fmac_f32 v201,-2.0,v199
v_cvt_pk_bf16_f32 v193,v232,v193
M v[92:95],a[252:255],a[236:239],v[92:95]
s_waitcnt vmcnt(21) lgkmcnt(3)
v_cvt_pk_bf16_f32 v203,v237,v203
v_cvt_pk_bf16_f32 v195,v233,v195
M v[96:99],a[248:251],a[192:195],v[96:99]
s_waitcnt vmcnt(11) lgkmcnt(2)
ds_read_b128 a[240:243],v248 offset:61952
v_cvt_pk_bf16_f32 v199,v234,v197
M v[96:99],v[216:219],a[224:227],v[96:99]
s_waitcnt vmcnt(10) lgkmcnt(2)
ds_read_b128 a[244:247],v249 offset:61952
v_cvt_pk_bf16_f32 v197,v238,v235
M v[96:99],a[200:203],a[232:235],v[96:99]
s_waitcnt lgkmcnt(2)
v_cvt_pk_bf16_f32 v201,v236,v201
v_add_u32 v238,139264,v247
M v[100:103],a[200:203],a[228:231],v[100:103]
v_lshlrev_b32 v234,16,v208
v_lshlrev_b32 v232,16,v204
M v[100:103],v[216:219],a[232:235],v[100:103]
v_lshlrev_b32 v233,16,v206
v_lshlrev_b32 v237,16,v214
M v[100:103],a[248:251],a[224:227],v[100:103]
ds_write2st64_b64 v238,v[192:193],v[202:203] offset0:2 offset1:19
M v[104:107],a[248:251],a[232:235],v[104:107]
s_add_u32 s28,s71,6291456
buffer_load_dwordx2 v[192:193],v245,s[12:15],s28 offen offset:0
M v[104:107],v[216:219],a[228:231],v[104:107]
s_waitcnt lgkmcnt(2)
ds_read_b128 a[208:211],v248 offset:62464
ds_read_b128 a[212:215],v249 offset:62464
M v[104:107],a[200:203],a[240:243],v[104:107]
s_waitcnt lgkmcnt(3)
buffer_load_dwordx2 v[202:203],v245,s[16:19],s28 offen offset:1536
M v[108:111],a[200:203],a[244:247],v[108:111]
v_lshlrev_b32 v236,16,v212
v_lshlrev_b32 v235,16,v210
M v[108:111],v[216:219],a[240:243],v[108:111]
v_fmac_f32 v232,s43,v234
v_fmac_f32 v237,4.0,v233
M v[108:111],a[248:251],a[228:231],v[108:111]
ds_write2st64_b64 v247,v[194:195],v[196:197] offset0:36 offset1:53
M v[112:115],a[248:251],a[240:243],v[112:115]
buffer_load_dwordx2 v[194:195],v245,s[8:11],s28 offen offset:0
M v[112:115],v[216:219],a[244:247],v[112:115]
s_waitcnt lgkmcnt(2)
ds_read_b128 a[236:239],v249 offset:62976
ds_read_b128 a[252:255],v248 offset:62976
M v[112:115],a[200:203],a[208:211],v[112:115]
s_waitcnt lgkmcnt(3)
ds_write2st64_b64 v247,v[198:199],v[200:201] offset0:70 offset1:87
M v[116:119],a[200:203],a[212:215],v[116:119]
buffer_load_dwordx2 v[196:197],v245,s[8:11],s28 offen offset:384
M v[116:119],v[216:219],a[208:211],v[116:119]
v_fma_f32 v238,-4.0,v234,v236
v_fmac_f32 v232,s45,v236
M v[116:119],a[248:251],a[244:247],v[116:119]
v_fmac_f32 v237,s41,v235
v_sub_f32 v236,v236,v234
M v[120:123],a[248:251],a[208:211],v[120:123]
v_fma_f32 v234,-4.0,v233,v235
v_sub_f32 v235,v235,v233
M v[120:123],v[216:219],a[212:215],v[120:123]
s_waitcnt lgkmcnt(2)
buffer_load_dwordx2 v[198:199],v245,s[8:11],s28 offen offset:768
M v[120:123],a[200:203],a[236:239],v[120:123]
s_waitcnt lgkmcnt(1)
v_add_f32 v233,v238,v234
v_sub_f32 v238,v238,v234
M v[124:127],a[200:203],a[252:255],v[124:127]
v_fma_f32 v234,2.0,v235,v236
v_fmac_f32 v236,-2.0,v235
M v[124:127],v[216:219],a[236:239],v[124:127]
v_and_b32 v208,s42,v208
v_and_b32 v204,s42,v204
M v[124:127],a[248:251],a[212:215],v[124:127]
s_waitcnt vmcnt(14)
buffer_load_dwordx4 a[200:203],v250,s[20:23],s46 offen offset:1024 sc1
M v[128:131],v[228:231],a[192:195],v[128:131]
s_waitcnt vmcnt(11)
v_and_b32 v206,s42,v206
v_and_b32 v214,s42,v214
M v[128:131],a[220:223],a[224:227],v[128:131]
s_waitcnt vmcnt(10)
v_and_b32 v212,s42,v212
v_and_b32 v210,s42,v210
M v[128:131],a[204:207],a[232:235],v[128:131]
v_fmac_f32 v204,s43,v208
v_fmac_f32 v214,4.0,v206
M v[132:135],a[204:207],a[228:231],v[132:135]
buffer_load_dwordx4 v[216:219],v250,s[20:23],s46 offen offset:2048 sc1
M v[132:135],a[220:223],a[232:235],v[132:135]
s_add_u32 s47,s76,12288
v_fma_f32 v235,-4.0,v208,v212
v_fmac_f32 v204,s45,v212
M v[132:135],v[228:231],a[224:227],v[132:135]
v_fmac_f32 v214,s41,v210
v_sub_f32 v212,v212,v208
M v[136:139],v[228:231],a[232:235],v[136:139]
v_fma_f32 v208,-4.0,v206,v210
v_sub_f32 v210,v210,v206
M v[136:139],a[220:223],a[228:231],v[136:139]
buffer_load_dwordx4 a[248:251],v250,s[20:23],s47 offen offset:0 sc1
M v[136:139],a[204:207],a[240:243],v[136:139]
v_add_f32 v206,v235,v208
v_sub_f32 v235,v235,v208
M v[140:143],a[204:207],a[244:247],v[140:143]
v_fma_f32 v208,2.0,v210,v212
v_fmac_f32 v212,-2.0,v210
M v[140:143],a[220:223],a[240:243],v[140:143]
v_cvt_pk_bf16_f32 v204,v232,v204
v_cvt_pk_bf16_f32 v214,v237,v214
M v[140:143],v[228:231],a[228:231],v[140:143]
buffer_load_dwordx2 v[200:201],v245,s[8:11],s28 offen offset:1152
M v[144:147],v[228:231],a[240:243],v[144:147]
v_cvt_pk_bf16_f32 v206,v233,v206
v_cvt_pk_bf16_f32 v210,v234,v208
M v[144:147],a[220:223],a[244:247],v[144:147]
v_cvt_pk_bf16_f32 v208,v238,v235
v_cvt_pk_bf16_f32 v212,v236,v212
M v[144:147],a[204:207],a[208:211],v[144:147]
v_lshlrev_b32 v234,16,v209
v_lshlrev_b32 v232,16,v205
M v[148:151],a[204:207],a[212:215],v[148:151]
v_lshlrev_b32 v233,16,v207
v_lshlrev_b32 v237,16,v215
M v[148:151],a[220:223],a[208:211],v[148:151]
v_lshlrev_b32 v236,16,v213
v_lshlrev_b32 v235,16,v211
M v[148:151],v[228:231],a[244:247],v[148:151]
v_fmac_f32 v232,s43,v234
v_fmac_f32 v237,4.0,v233
M v[152:155],v[228:231],a[208:211],v[152:155]
v_fma_f32 v238,-4.0,v234,v236
v_fmac_f32 v232,s45,v236
M v[152:155],a[220:223],a[212:215],v[152:155]
v_fmac_f32 v237,s41,v235
v_sub_f32 v236,v236,v234
M v[152:155],a[204:207],a[236:239],v[152:155]
v_fma_f32 v234,-4.0,v233,v235
v_sub_f32 v235,v235,v233
M v[156:159],a[204:207],a[252:255],v[156:159]
buffer_load_dwordx4 a[204:207],v250,s[20:23],s47 offen offset:1024 sc1
v_add_f32 v233,v238,v234
v_sub_f32 v238,v238,v234
v_fma_f32 v234,2.0,v235,v236
v_fmac_f32 v236,-2.0,v235
M v[156:159],a[220:223],a[236:239],v[156:159]
buffer_load_dwordx4 a[220:223],v250,s[20:23],s47 offen offset:2048 sc1
v_and_b32 v209,s42,v209
v_and_b32 v205,s42,v205
v_and_b32 v207,s42,v207
v_and_b32 v215,s42,v215
M v[156:159],v[228:231],a[212:215],v[156:159]
s_waitcnt vmcnt(14)
s_add_u32 s48,s76,15360
v_and_b32 v213,s42,v213
v_and_b32 v211,s42,v211
v_fmac_f32 v205,s43,v209
v_fmac_f32 v215,4.0,v207
M v[160:163],v[224:227],a[192:195],v[160:163]
s_waitcnt vmcnt(13)
v_fma_f32 v235,-4.0,v209,v213
v_fmac_f32 v205,s45,v213
v_fmac_f32 v215,s41,v211
v_sub_f32 v213,v213,v209
M v[160:163],a[196:199],a[224:227],v[160:163]
s_waitcnt vmcnt(12)
buffer_load_dwordx4 v[228:231],v250,s[20:23],s48 offen offset:0 sc1
v_fma_f32 v209,-4.0,v207,v211
v_sub_f32 v211,v211,v207
v_add_f32 v207,v235,v209
v_sub_f32 v235,v235,v209
M v[160:163],a[216:219],a[232:235],v[160:163]
v_fma_f32 v209,2.0,v211,v213
v_fmac_f32 v213,-2.0,v211
v_cvt_pk_bf16_f32 v205,v232,v205
v_cvt_pk_bf16_f32 v215,v237,v215
M v[164:167],a[216:219],a[228:231],v[164:167]
buffer_load_dwordx4 a[192:195],v250,s[20:23],s48 offen offset:1024 sc1
v_cvt_pk_bf16_f32 v207,v233,v207
v_cvt_pk_bf16_f32 v211,v234,v209
v_cvt_pk_bf16_f32 v209,v238,v235
v_cvt_pk_bf16_f32 v213,v236,v213
M v[164:167],a[196:199],a[232:235],v[164:167]
v_add_u32 v238,139264,v247
M v[164:167],v[224:227],a[224:227],v[164:167]
ds_write2st64_b64 v238,v[204:205],v[214:215] offset0:3 offset1:20
M v[168:171],v[224:227],a[232:235],v[168:171]
s_add_u32 s28,s71,6684672
buffer_load_dwordx4 a[224:227],v250,s[20:23],s48 offen offset:2048 sc1
M v[168:171],a[196:199],a[228:231],v[168:171]
s_add_u32 s46,s76,18432
M v[168:171],a[216:219],a[240:243],v[168:171]
ds_write2st64_b64 v247,v[206:207],v[208:209] offset0:37 offset1:54
M v[172:175],a[216:219],a[244:247],v[172:175]
buffer_load_dwordx4 a[232:235],v250,s[20:23],s46 offen offset:0 sc1
M v[172:175],a[196:199],a[240:243],v[172:175]
M v[172:175],v[224:227],a[228:231],v[172:175]
ds_write2st64_b64 v247,v[210:211],v[212:213] offset0:71 offset1:88
M v[176:179],v[224:227],a[240:243],v[176:179]
buffer_load_dwordx2 v[204:205],v245,s[12:15],s28 offen offset:0
M v[176:179],a[196:199],a[244:247],v[176:179]
M v[176:179],a[216:219],a[208:211],v[176:179]
s_waitcnt lgkmcnt(0)
s_barrier
M v[180:183],a[216:219],a[212:215],v[180:183]
M v[180:183],a[196:199],a[208:211],v[180:183]
buffer_load_dwordx2 v[214:215],v245,s[16:19],s28 offen offset:1536
M v[180:183],v[224:227],a[244:247],v[180:183]
ds_read_b128 a[228:231],v248 offset:0
ds_read_b128 a[240:243],v249 offset:0
M v[184:187],v[224:227],a[208:211],v[184:187]
s_waitcnt vmcnt(13)
ds_read_b128 a[244:247],v248 offset:512
v_lshlrev_b32 v234,16,v196
M v[184:187],a[196:199],a[212:215],v[184:187]
ds_read_b128 a[208:211],v249 offset:512
v_lshlrev_b32 v232,16,v192
M v[184:187],a[216:219],a[236:239],v[184:187]
buffer_load_dwordx2 v[206:207],v245,s[8:11],s28 offen offset:0
M v[188:191],a[216:219],a[252:255],v[188:191]
v_lshlrev_b32 v233,16,v194
v_lshlrev_b32 v237,16,v202
M v[188:191],a[196:199],a[236:239],v[188:191]
s_waitcnt vmcnt(9)
v_lshlrev_b32 v236,16,v200
v_lshlrev_b32 v235,16,v198
M v[188:191],v[224:227],a[212:215],v[188:191]
s_waitcnt lgkmcnt(3)
v_fmac_f32 v232,s43,v234
v_fmac_f32 v237,4.0,v233
M a[0:3],v[220:223],a[228:231],a[0:3]
s_waitcnt lgkmcnt(2)
buffer_load_dwordx2 v[208:209],v245,s[8:11],s28 offen offset:384
M a[0:3],a[200:203],a[240:243],a[0:3]
s_waitcnt lgkmcnt(1)
ds_read_b128 a[216:219],v248 offset:1024
ds_read_b128 a[252:255],v249 offset:1024
M a[0:3],v[216:219],a[244:247],a[0:3]
s_waitcnt lgkmcnt(2)
v_fma_f32 v238,-4.0,v234,v236
v_fmac_f32 v232,s45,v236
M a[4:7],v[216:219],a[208:211],a[4:7]
v_fmac_f32 v237,s41,v235
v_sub_f32 v236,v236,v234
M a[4:7],a[200:203],a[244:247],a[4:7]
buffer_load_dwordx2 v[210:211],v245,s[8:11],s28 offen offset:768
M a[4:7],v[220:223],a[240:243],a[4:7]
v_fma_f32 v234,-4.0,v233,v235
v_sub_f32 v235,v235,v233
M a[8:11],v[220:223],a[244:247],a[8:11]
ds_read_b128 a[196:199],v248 offset:1536
v_add_f32 v233,v238,v234
M a[8:11],a[200:203],a[208:211],a[8:11]
s_waitcnt lgkmcnt(2)
ds_read_b128 a[236:239],v249 offset:1536
v_sub_f32 v238,v238,v234
M a[8:11],v[216:219],a[216:219],a[8:11]
s_waitcnt lgkmcnt(2)
buffer_load_dwordx2 v[212:213],v245,s[8:11],s28 offen offset:1152
M a[12:15],v[216:219],a[252:255],a[12:15]
v_fma_f32 v234,2.0,v235,v236
v_fmac_f32 v236,-2.0,v235
M a[12:15],a[200:203],a[216:219],a[12:15]
v_and_b32 v196,s42,v196
v_and_b32 v192,s42,v192
M a[12:15],v[220:223],a[208:211],a[12:15]
v_and_b32 v194,s42,v194
v_and_b32 v202,s42,v202
M a[16:19],v[220:223],a[216:219],a[16:19]
ds_read_b128 a[212:215],v249 offset:2048
v_and_b32 v200,s42,v200
M a[16:19],a[200:203],a[252:255],a[16:19]
s_waitcnt lgkmcnt(2)
ds_read_b128 v[224:227],v248 offset:2048
v_and_b32 v198,s42,v198
M a[16:19],v[216:219],a[196:199],a[16:19]
s_waitcnt lgkmcnt(2)
v_fmac_f32 v192,s43,v196
v_fmac_f32 v202,4.0,v194
M a[20:23],v[216:219],a[236:239],a[20:23]
v_fma_f32 v235,-4.0,v196,v200
v_fmac_f32 v192,s45,v200
M a[20:23],a[200:203],a[196:199],a[20:23]
v_fmac_f32 v202,s41,v198
v_sub_f32 v200,v200,v196
M a[20:23],v[220:223],a[252:255],a[20:23]
v_fma_f32 v196,-4.0,v194,v198
v_sub_f32 v198,v198,v194
M a[24:27],v[220:223],a[196:199],a[24:27]
v_add_f32 v194,v235,v196
v_sub_f32 v235,v235,v196
M a[24:27],a[200:203],a[236:239],a[24:27]
s_waitcnt lgkmcnt(1)
v_fma_f32 v196,2.0,v198,v200
v_fmac_f32 v200,-2.0,v198
M a[24:27],v[216:219],a[212:215],a[24:27]
s_waitcnt lgkmcnt(0)
v_cvt_pk_bf16_f32 v192,v232,v192
v_cvt_pk_bf16_f32 v202,v237,v202
M a[28:31],v[216:219],v[224:227],a[28:31]
buffer_load_dwordx4 v[216:219],v250,s[20:23],s46 offen offset:1024 sc1
M a[28:31],a[200:203],a[212:215],a[28:31]
v_cvt_pk_bf16_f32 v194,v233,v194
v_cvt_pk_bf16_f32 v198,v234,v196
M a[28:31],v[220:223],a[236:239],a[28:31]
buffer_load_dwordx4 a[200:203],v250,s[20:23],s46 offen offset:2048 sc1
M a[32:35],a[248:251],a[228:231],a[32:35]
s_waitcnt vmcnt(13)
s_add_u32 s47,s76,21504
v_cvt_pk_bf16_f32 v196,v238,v235
v_cvt_pk_bf16_f32 v200,v236,v200
M a[32:35],a[204:207],a[240:243],a[32:35]
s_waitcnt vmcnt(12)
v_lshlrev_b32 v234,16,v197
v_lshlrev_b32 v232,16,v193
M a[32:35],a[220:223],a[244:247],a[32:35]
v_lshlrev_b32 v233,16,v195
v_lshlrev_b32 v237,16,v203
M a[36:39],a[220:223],a[208:211],a[36:39]
buffer_load_dwordx4 v[220:223],v250,s[20:23],s47 offen offset:0 sc1
M a[36:39],a[204:207],a[244:247],a[36:39]
v_lshlrev_b32 v236,16,v201
v_lshlrev_b32 v235,16,v199
M a[36:39],a[248:251],a[240:243],a[36:39]
v_fmac_f32 v232,s43,v234
v_fmac_f32 v237,4.0,v233
M a[40:43],a[248:251],a[244:247],a[40:43]
v_fma_f32 v238,-4.0,v234,v236
v_fmac_f32 v232,s45,v236
M a[40:43],a[204:207],a[208:211],a[40:43]
v_fmac_f32 v237,s41,v235
v_sub_f32 v236,v236,v234
M a[40:43],a[220:223],a[216:219],a[40:43]
v_fma_f32 v234,-4.0,v233,v235
v_sub_f32 v235,v235,v233
M a[44:47],a[220:223],a[252:255],a[44:47]
v_add_f32 v233,v238,v234
v_sub_f32 v238,v238,v234
M a[44:47],a[204:207],a[216:219],a[44:47]
v_fma_f32 v234,2.0,v235,v236
v_fmac_f32 v236,-2.0,v235
M a[44:47],a[248:251],a[208:211],a[44:47]
v_and_b32 v197,s42,v197
v_and_b32 v193,s42,v193
M a[48:51],a[248:251],a[216:219],a[48:51]
v_and_b32 v195,s42,v195
v_and_b32 v203,s42,v203
M a[48:51],a[204:207],a[252:255],a[48:51]
v_and_b32 v201,s42,v201
v_and_b32 v199,s42,v199
M a[48:51],a[220:223],a[196:199],a[48:51]
v_fmac_f32 v193,s43,v197
v_fmac_f32 v203,4.0,v195
M a[52:55],a[220:223],a[236:239],a[52:55]
v_fma_f32 v235,-4.0,v197,v201
v_fmac_f32 v193,s45,v201
M a[52:55],a[204:207],a[196:199],a[52:55]
v_fmac_f32 v203,s41,v199
v_sub_f32 v201,v201,v197
M a[52:55],a[248:251],a[252:255],a[52:55]
v_fma_f32 v197,-4.0,v195,v199
v_sub_f32 v199,v199,v195
M a[56:59],a[248:251],a[196:199],a[56:59]
v_add_f32 v195,v235,v197
v_sub_f32 v235,v235,v197
M a[56:59],a[204:207],a[236:239],a[56:59]
v_fma_f32 v197,2.0,v199,v201
v_fmac_f32 v201,-2.0,v199
M a[56:59],a[220:223],a[212:215],a[56:59]
v_cvt_pk_bf16_f32 v193,v232,v193
v_cvt_pk_bf16_f32 v203,v237,v203
M a[60:63],a[220:223],v[224:227],a[60:63]
buffer_load_dwordx4 a[220:223],v250,s[20:23],s47 offen offset:1024 sc1
M a[60:63],a[204:207],a[212:215],a[60:63]
v_cvt_pk_bf16_f32 v195,v233,v195
v_cvt_pk_bf16_f32 v199,v234,v197
M a[60:63],a[248:251],a[236:239],a[60:63]
s_waitcnt vmcnt(13)
buffer_load_dwordx4 a[204:207],v250,s[20:23],s47 offen offset:2048 sc1
M a[64:67],v[228:231],a[228:231],a[64:67]
s_waitcnt vmcnt(13)
s_add_u32 s48,s76,24576
v_cvt_pk_bf16_f32 v197,v238,v235
v_cvt_pk_bf16_f32 v201,v236,v201
M a[64:67],a[192:195],a[240:243],a[64:67]
s_waitcnt vmcnt(7)
v_lshlrev_b32 v234,16,v208
v_lshlrev_b32 v232,16,v204
M a[64:67],a[224:227],a[244:247],a[64:67]
ds_write2st64_b64 v247,v[192:193],v[202:203] offset0:136 offset1:153
M a[68:71],a[224:227],a[208:211],a[68:71]
s_add_u32 s28,s71,7077888
buffer_load_dwordx4 a[248:251],v250,s[20:23],s48 offen offset:0 sc1
M a[68:71],a[192:195],a[244:247],a[68:71]
v_lshlrev_b32 v233,16,v206
v_lshlrev_b32 v237,16,v214
M a[68:71],v[228:231],a[240:243],a[68:71]
ds_write2st64_b64 v247,v[194:195],v[196:197] offset0:0 offset1:17
M a[72:75],v[228:231],a[244:247],a[72:75]
buffer_load_dwordx4 a[228:231],v250,s[20:23],s48 offen offset:1024 sc1
M a[72:75],a[192:195],a[208:211],a[72:75]
s_waitcnt vmcnt(7)
v_lshlrev_b32 v236,16,v212
v_lshlrev_b32 v235,16,v210
M a[72:75],a[224:227],a[216:219],a[72:75]
v_fmac_f32 v232,s43,v234
v_fmac_f32 v237,4.0,v233
M a[76:79],a[224:227],a[252:255],a[76:79]
v_fma_f32 v238,-4.0,v234,v236
v_fmac_f32 v232,s45,v236
M a[76:79],a[192:195],a[216:219],a[76:79]
buffer_load_dwordx4 a[240:243],v250,s[20:23],s48 offen offset:2048 sc1
M a[76:79],v[228:231],a[208:211],a[76:79]
s_add_u32 s46,s76,27648
v_fmac_f32 v237,s41,v235
v_sub_f32 v236,v236,v234
M a[80:83],v[228:231],a[216:219],a[80:83]
v_fma_f32 v234,-4.0,v233,v235
v_sub_f32 v235,v235,v233
M a[80:83],a[192:195],a[252:255],a[80:83]
v_add_f32 v233,v238,v234
v_sub_f32 v238,v238,v234
M a[80:83],a[224:227],a[196:199],a[80:83]
buffer_load_dwordx4 a[244:247],v250,s[20:23],s46 offen offset:0 sc1
M a[84:87],a[224:227],a[236:239],a[84:87]
v_fma_f32 v234,2.0,v235,v236
v_fmac_f32 v236,-2.0,v235
M a[84:87],a[192:195],a[196:199],a[84:87]
ds_read_b128 a[208:211],v248 offset:8704
v_and_b32 v208,s42,v208
M a[84:87],v[228:231],a[252:255],a[84:87]
ds_read_b128 a[216:219],v249 offset:8704
v_and_b32 v204,s42,v204
M a[88:91],v[228:231],a[196:199],a[88:91]
buffer_load_dwordx2 v[192:193],v245,s[12:15],s28 offen offset:0
M a[88:91],a[192:195],a[236:239],a[88:91]
ds_read_b128 a[252:255],v248 offset:9216
ds_read_b128 a[196:199],v249 offset:9216
M a[88:91],a[224:227],a[212:215],a[88:91]
v_and_b32 v206,s42,v206
v_and_b32 v214,s42,v214
M a[92:95],a[224:227],v[224:227],a[92:95]
v_and_b32 v212,s42,v212
v_and_b32 v210,s42,v210
M a[92:95],a[192:195],a[212:215],a[92:95]
buffer_load_dwordx2 v[202:203],v245,s[16:19],s28 offen offset:1536
M a[92:95],v[228:231],a[236:239],a[92:95]
s_waitcnt lgkmcnt(3)
v_fmac_f32 v204,s43,v208
v_fmac_f32 v214,4.0,v206
M a[96:99],a[232:235],a[208:211],a[96:99]
s_waitcnt vmcnt(10) lgkmcnt(2)
ds_read_b128 a[224:227],v248 offset:9728
v_fma_f32 v235,-4.0,v208,v212
M a[96:99],v[216:219],a[216:219],a[96:99]
s_waitcnt vmcnt(9) lgkmcnt(2)
ds_read_b128 v[224:227],v249 offset:9728
v_fmac_f32 v204,s45,v212
M a[96:99],a[200:203],a[252:255],a[96:99]
s_waitcnt lgkmcnt(2)
buffer_load_dwordx2 v[194:195],v245,s[8:11],s28 offen offset:0
M a[100:103],a[200:203],a[196:199],a[100:103]
v_fmac_f32 v214,s41,v210
v_sub_f32 v212,v212,v208
M a[100:103],v[216:219],a[252:255],a[100:103]
v_fma_f32 v208,-4.0,v206,v210
v_sub_f32 v210,v210,v206
M a[100:103],a[232:235],a[216:219],a[100:103]
v_add_f32 v206,v235,v208
v_sub_f32 v235,v235,v208
M a[104:107],a[232:235],a[252:255],a[104:107]
buffer_load_dwordx2 v[196:197],v245,s[8:11],s28 offen offset:384
M a[104:107],v[216:219],a[196:199],a[104:107]
s_waitcnt lgkmcnt(1)
ds_read_b128 a[192:195],v248 offset:10240
ds_read_b128 a[212:215],v249 offset:10240
M a[104:107],a[200:203],a[224:227],a[104:107]
s_waitcnt lgkmcnt(2)
v_fma_f32 v208,2.0,v210,v212
v_fmac_f32 v212,-2.0,v210
M a[108:111],a[200:203],v[224:227],a[108:111]
v_cvt_pk_bf16_f32 v204,v232,v204
v_cvt_pk_bf16_f32 v214,v237,v214
M a[108:111],v[216:219],a[224:227],a[108:111]
v_cvt_pk_bf16_f32 v206,v233,v206
v_cvt_pk_bf16_f32 v210,v234,v208
M a[108:111],a[232:235],a[196:199],a[108:111]
v_cvt_pk_bf16_f32 v208,v238,v235
v_cvt_pk_bf16_f32 v212,v236,v212
M a[112:115],a[232:235],a[224:227],a[112:115]
ds_read_b128 a[236:239],v249 offset:10752
v_lshlrev_b32 v234,16,v209
M a[112:115],v[216:219],v[224:227],a[112:115]
s_waitcnt lgkmcnt(2)
ds_read_b128 v[228:231],v248 offset:10752
v_lshlrev_b32 v232,16,v205
M a[112:115],a[200:203],a[192:195],a[112:115]
s_waitcnt lgkmcnt(2)
v_lshlrev_b32 v233,16,v207
v_lshlrev_b32 v237,16,v215
M a[116:119],a[200:203],a[212:215],a[116:119]
v_lshlrev_b32 v236,16,v213
v_lshlrev_b32 v235,16,v211
M a[116:119],v[216:219],a[192:195],a[116:119]
v_fmac_f32 v232,s43,v234
v_fmac_f32 v237,4.0,v233
M a[116:119],a[232:235],v[224:227],a[116:119]
v_fma_f32 v238,-4.0,v234,v236
v_fmac_f32 v232,s45,v236
M a[120:123],a[232:235],a[192:195],a[120:123]
v_fmac_f32 v237,s41,v235
v_sub_f32 v236,v236,v234
M a[120:123],v[216:219],a[212:215],a[120:123]
s_waitcnt lgkmcnt(1)
v_fma_f32 v234,-4.0,v233,v235
v_sub_f32 v235,v235,v233
M a[120:123],a[200:203],a[236:239],a[120:123]
s_waitcnt lgkmcnt(0)
v_add_f32 v233,v238,v234
v_sub_f32 v238,v238,v234
M a[124:127],a[200:203],v[228:231],a[124:127]
buffer_load_dwordx4 a[200:203],v250,s[20:23],s46 offen offset:1024 sc1
M a[124:127],v[216:219],a[236:239],a[124:127]
v_fma_f32 v234,2.0,v235,v236
v_fmac_f32 v236,-2.0,v235
M a[124:127],a[232:235],a[212:215],a[124:127]
s_waitcnt vmcnt(11)
buffer_load_dwordx4 v[216:219],v250,s[20:23],s46 offen offset:2048 sc1
M a[128:131],v[220:223],a[208:211],a[128:131]
s_waitcnt vmcnt(11)
s_add_u32 s47,s76,30720
v_and_b32 v209,s42,v209
v_and_b32 v205,s42,v205
M a[128:131],a[220:223],a[216:219],a[128:131]
s_waitcnt vmcnt(10)
v_and_b32 v207,s42,v207
v_and_b32 v215,s42,v215
M a[128:131],a[204:207],a[252:255],a[128:131]
v_and_b32 v213,s42,v213
v_and_b32 v211,s42,v211
M a[132:135],a[204:207],a[196:199],a[132:135]
buffer_load_dwordx4 a[232:235],v250,s[20:23],s47 offen offset:0 sc1
M a[132:135],a[220:223],a[252:255],a[132:135]
v_fmac_f32 v205,s43,v209
v_fmac_f32 v215,4.0,v207
M a[132:135],v[220:223],a[216:219],a[132:135]
v_fma_f32 v235,-4.0,v209,v213
v_fmac_f32 v205,s45,v213
M a[136:139],v[220:223],a[252:255],a[136:139]
s_barrier
v_fmac_f32 v215,s41,v211
M a[136:139],a[220:223],a[196:199],a[136:139]
v_sub_f32 v213,v213,v209
v_fma_f32 v209,-4.0,v207,v211
M a[136:139],a[204:207],a[224:227],a[136:139]
ds_write2st64_b64 v247,v[198:199],v[200:201] offset0:34 offset1:51
M a[140:143],a[204:207],v[224:227],a[140:143]
buffer_load_dwordx2 v[198:199],v245,s[8:11],s28 offen offset:768
M a[140:143],a[220:223],a[224:227],a[140:143]
v_sub_f32 v211,v211,v207
v_add_f32 v207,v235,v209
M a[140:143],v[220:223],a[196:199],a[140:143]
buffer_load_dwordx2 v[200:201],v245,s[8:11],s28 offen offset:1152
M a[144:147],v[220:223],a[224:227],a[144:147]
v_sub_f32 v235,v235,v209
v_fma_f32 v209,2.0,v211,v213
M a[144:147],a[220:223],v[224:227],a[144:147]
v_fmac_f32 v213,-2.0,v211
v_cvt_pk_bf16_f32 v205,v232,v205
M a[144:147],a[204:207],a[192:195],a[144:147]
v_cvt_pk_bf16_f32 v215,v237,v215
v_cvt_pk_bf16_f32 v207,v233,v207
M a[148:151],a[204:207],a[212:215],a[148:151]
v_cvt_pk_bf16_f32 v211,v234,v209
v_cvt_pk_bf16_f32 v209,v238,v235
M a[148:151],a[220:223],a[192:195],a[148:151]
v_cvt_pk_bf16_f32 v213,v236,v213
v_fmac_f32 v239,s43,v241
M a[148:151],v[220:223],v[224:227],a[148:151]
ds_write2st64_b64 v247,v[204:205],v[214:215] offset0:137 offset1:154
M a[152:155],v[220:223],a[192:195],a[152:155]
s_add_u32 s28,s71,7471104
buffer_load_dwordx2 v[204:205],v245,s[12:15],s28 offen offset:0
M a[152:155],a[220:223],a[212:215],a[152:155]
v_fmac_f32 v244,4.0,v240
v_fma_f32 v232,-4.0,v241,v243
M a[152:155],a[204:207],a[236:239],a[152:155]
buffer_load_dwordx2 v[214:215],v245,s[16:19],s28 offen offset:1536
M a[156:159],a[204:207],v[228:231],a[156:159]
v_fmac_f32 v239,s45,v243
v_fmac_f32 v244,s41,v242
M a[156:159],a[220:223],a[236:239],a[156:159]
v_sub_f32 v243,v243,v241
v_fma_f32 v241,-4.0,v240,v242
M a[156:159],v[220:223],a[212:215],a[156:159]
s_waitcnt vmcnt(14)
ds_write2st64_b64 v247,v[206:207],v[208:209] offset0:1 offset1:18
M a[160:163],a[248:251],a[208:211],a[160:163]
s_waitcnt vmcnt(13)
buffer_load_dwordx4 a[204:207],v250,s[20:23],s47 offen offset:1024 sc1
M a[160:163],a[228:231],a[216:219],a[160:163]
s_waitcnt vmcnt(13)
v_sub_f32 v242,v242,v240
v_add_f32 v240,v232,v241
M a[160:163],a[240:243],a[252:255],a[160:163]
ds_write2st64_b64 v247,v[210:211],v[212:213] offset0:35 offset1:52
M a[164:167],a[240:243],a[196:199],a[164:167]
buffer_load_dwordx4 a[220:223],v250,s[20:23],s47 offen offset:2048 sc1
M a[164:167],a[228:231],a[252:255],a[164:167]
s_add_u32 s48,s76,33792
v_sub_f32 v232,v232,v241
v_fma_f32 v241,2.0,v242,v243
M a[164:167],a[248:251],a[216:219],a[164:167]
v_fmac_f32 v243,-2.0,v242
v_cvt_pk_bf16_f32 v233,v239,v244
M a[168:171],a[248:251],a[252:255],a[168:171]
v_cvt_pk_bf16_f32 v234,v240,v232
v_cvt_pk_bf16_f32 v235,v241,v243
M a[168:171],a[228:231],a[196:199],a[168:171]
buffer_load_dwordx4 v[220:223],v250,s[20:23],s48 offen offset:0 sc1
M a[168:171],a[240:243],a[224:227],a[168:171]
v_add_u32 v232,69632,v252
M a[172:175],a[240:243],v[224:227],a[172:175]
ds_write_b16 v232,v233 offset:0
M a[172:175],a[228:231],a[224:227],a[172:175]
ds_write_b16_d16_hi v232,v233 offset:8704
M a[172:175],a[248:251],a[196:199],a[172:175]
buffer_load_dwordx4 a[208:211],v250,s[20:23],s48 offen offset:1024 sc1
M a[176:179],a[248:251],a[224:227],a[176:179]
ds_write_b16 v252,v234 offset:0
M a[176:179],a[228:231],v[224:227],a[176:179]
ds_write_b16_d16_hi v252,v234 offset:8704
M a[176:179],a[240:243],a[192:195],a[176:179]
ds_write_b16 v252,v235 offset:17408
M a[180:183],a[240:243],a[212:215],a[180:183]
buffer_load_dwordx4 a[216:219],v250,s[20:23],s48 offen offset:2048 sc1
M a[180:183],a[228:231],a[192:195],a[180:183]
s_add_u32 s46,s76,36864
ds_read_b128 a[196:199],v248 offset:17408
ds_write_b16_d16_hi v252,v235 offset:26112
M a[180:183],a[248:251],v[224:227],a[180:183]
s_waitcnt vmcnt(12)
ds_read_b128 a[224:227],v249 offset:17408
v_lshlrev_b32 v234,16,v196
M a[184:187],a[248:251],a[192:195],a[184:187]
ds_read_b128 v[224:227],v248 offset:17920
v_lshlrev_b32 v232,16,v192
M a[184:187],a[228:231],a[212:215],a[184:187]
buffer_load_dwordx4 a[252:255],v250,s[20:23],s46 offen offset:0 sc1
M a[184:187],a[240:243],a[236:239],a[184:187]
ds_read_b128 a[192:195],v249 offset:17920
v_lshlrev_b32 v233,16,v194
M a[188:191],a[240:243],v[228:231],a[188:191]
s_waitcnt vmcnt(8)
v_lshlrev_b32 v237,16,v202
v_lshlrev_b32 v236,16,v200
M a[188:191],a[228:231],a[236:239],a[188:191]
v_lshlrev_b32 v235,16,v198
v_fmac_f32 v232,s43,v234
M a[188:191],a[248:251],a[212:215],a[188:191]
s_waitcnt lgkmcnt(4)
buffer_load_dwordx2 v[206:207],v245,s[8:11],s28 offen offset:0
M v[0:3],a[244:247],a[196:199],v[0:3]
s_waitcnt lgkmcnt(2)
ds_read_b128 a[240:243],v248 offset:18432
v_fmac_f32 v237,4.0,v233
M v[0:3],a[200:203],a[224:227],v[0:3]
s_waitcnt lgkmcnt(2)
ds_read_b128 v[228:231],v249 offset:18432
v_fma_f32 v238,-4.0,v234,v236
M v[0:3],v[216:219],v[224:227],v[0:3]
s_waitcnt lgkmcnt(2)
v_fmac_f32 v232,s45,v236
v_fmac_f32 v237,s41,v235
M v[4:7],v[216:219],a[192:195],v[4:7]
buffer_load_dwordx2 v[208:209],v245,s[8:11],s28 offen offset:384
M v[4:7],a[200:203],v[224:227],v[4:7]
v_sub_f32 v236,v236,v234
v_fma_f32 v234,-4.0,v233,v235
M v[4:7],a[244:247],a[224:227],v[4:7]
v_sub_f32 v235,v235,v233
v_add_f32 v233,v238,v234
M v[8:11],a[244:247],v[224:227],v[8:11]
ds_read_b128 a[228:231],v248 offset:18944
v_sub_f32 v238,v238,v234
M v[8:11],a[200:203],a[192:195],v[8:11]
s_waitcnt lgkmcnt(2)
buffer_load_dwordx2 v[210:211],v245,s[8:11],s28 offen offset:768
M v[8:11],v[216:219],a[240:243],v[8:11]
s_waitcnt lgkmcnt(1)
ds_read_b128 a[236:239],v249 offset:18944
v_fma_f32 v234,2.0,v235,v236
M v[12:15],v[216:219],v[228:231],v[12:15]
v_fmac_f32 v236,-2.0,v235
v_and_b32 v196,s42,v196
M v[12:15],a[200:203],a[240:243],v[12:15]
v_and_b32 v192,s42,v192
v_and_b32 v194,s42,v194
M v[12:15],a[244:247],a[192:195],v[12:15]
buffer_load_dwordx2 v[212:213],v245,s[8:11],s28 offen offset:1152
M v[16:19],a[244:247],a[240:243],v[16:19]
ds_read_b128 a[212:215],v249 offset:19456
v_and_b32 v202,s42,v202
M v[16:19],a[200:203],v[228:231],v[16:19]
s_waitcnt lgkmcnt(2)
ds_read_b128 a[248:251],v248 offset:19456
v_and_b32 v200,s42,v200
M v[16:19],v[216:219],a[228:231],v[16:19]
s_waitcnt lgkmcnt(2)
v_and_b32 v198,s42,v198
v_fmac_f32 v192,s43,v196
M v[20:23],v[216:219],a[236:239],v[20:23]
v_fmac_f32 v202,4.0,v194
v_fma_f32 v235,-4.0,v196,v200
M v[20:23],a[200:203],a[228:231],v[20:23]
v_fmac_f32 v192,s45,v200
v_fmac_f32 v202,s41,v198
M v[20:23],a[244:247],v[228:231],v[20:23]
v_sub_f32 v200,v200,v196
v_fma_f32 v196,-4.0,v194,v198
M v[24:27],a[244:247],a[228:231],v[24:27]
v_sub_f32 v198,v198,v194
v_add_f32 v194,v235,v196
M v[24:27],a[200:203],a[236:239],v[24:27]
s_waitcnt lgkmcnt(1)
v_sub_f32 v235,v235,v196
v_fma_f32 v196,2.0,v198,v200
M v[24:27],v[216:219],a[212:215],v[24:27]
s_waitcnt lgkmcnt(0)
v_fmac_f32 v200,-2.0,v198
v_cvt_pk_bf16_f32 v192,v232,v192
M v[28:31],v[216:219],a[248:251],v[28:31]
global_load_dword v216,v250,s[64:65]
M v[28:31],a[200:203],a[212:215],v[28:31]
buffer_load_dwordx4 v[216:219],v250,s[20:23],s46 offen offset:1024 sc1
M v[28:31],a[244:247],a[236:239],v[28:31]
v_cvt_pk_bf16_f32 v202,v237,v202
v_cvt_pk_bf16_f32 v194,v233,v194
M v[32:35],a[232:235],a[196:199],v[32:35]
s_waitcnt vmcnt(11)
v_cvt_pk_bf16_f32 v198,v234,v196
v_cvt_pk_bf16_f32 v196,v238,v235
M v[32:35],a[204:207],a[224:227],v[32:35]
s_waitcnt vmcnt(10)
buffer_load_dwordx4 a[200:203],v250,s[20:23],s46 offen offset:2048 sc1
M v[32:35],a[220:223],v[224:227],v[32:35]
s_add_u32 s47,s76,39936
v_cvt_pk_bf16_f32 v200,v236,v200
v_lshlrev_b32 v234,16,v197
M v[36:39],a[220:223],a[192:195],v[36:39]
v_lshlrev_b32 v232,16,v193
v_lshlrev_b32 v233,16,v195
M v[36:39],a[204:207],v[224:227],v[36:39]
v_lshlrev_b32 v237,16,v203
v_lshlrev_b32 v236,16,v201
M v[36:39],a[232:235],a[224:227],v[36:39]
buffer_load_dwordx4 a[244:247],v250,s[20:23],s47 offen offset:0 sc1
M v[40:43],a[232:235],v[224:227],v[40:43]
v_lshlrev_b32 v235,16,v199
v_fmac_f32 v232,s43,v234
M v[40:43],a[204:207],a[192:195],v[40:43]
v_fmac_f32 v237,4.0,v233
v_fma_f32 v238,-4.0,v234,v236
M v[40:43],a[220:223],a[240:243],v[40:43]
v_fmac_f32 v232,s45,v236
v_fmac_f32 v237,s41,v235
M v[44:47],a[220:223],v[228:231],v[44:47]
v_sub_f32 v236,v236,v234
v_fma_f32 v234,-4.0,v233,v235
M v[44:47],a[204:207],a[240:243],v[44:47]
v_sub_f32 v235,v235,v233
v_add_f32 v233,v238,v234
M v[44:47],a[232:235],a[192:195],v[44:47]
v_sub_f32 v238,v238,v234
v_fma_f32 v234,2.0,v235,v236
M v[48:51],a[232:235],a[240:243],v[48:51]
v_fmac_f32 v236,-2.0,v235
v_and_b32 v197,s42,v197
M v[48:51],a[204:207],v[228:231],v[48:51]
v_and_b32 v193,s42,v193
v_and_b32 v195,s42,v195
M v[48:51],a[220:223],a[228:231],v[48:51]
v_and_b32 v203,s42,v203
v_and_b32 v201,s42,v201
M v[52:55],a[220:223],a[236:239],v[52:55]
v_and_b32 v199,s42,v199
v_fmac_f32 v193,s43,v197
M v[52:55],a[204:207],a[228:231],v[52:55]
v_fmac_f32 v203,4.0,v195
v_fma_f32 v235,-4.0,v197,v201
M v[52:55],a[232:235],v[228:231],v[52:55]
v_fmac_f32 v193,s45,v201
v_fmac_f32 v203,s41,v199
M v[56:59],a[232:235],a[228:231],v[56:59]
v_sub_f32 v201,v201,v197
v_fma_f32 v197,-4.0,v195,v199
M v[56:59],a[204:207],a[236:239],v[56:59]
v_sub_f32 v199,v199,v195
v_add_f32 v195,v235,v197
M v[56:59],a[220:223],a[212:215],v[56:59]
v_sub_f32 v235,v235,v197
v_fma_f32 v197,2.0,v199,v201
M v[60:63],a[220:223],a[248:251],v[60:63]
buffer_load_dwordx4 a[220:223],v250,s[20:23],s47 offen offset:1024 sc1
M v[60:63],a[204:207],a[212:215],v[60:63]
v_fmac_f32 v201,-2.0,v199
v_cvt_pk_bf16_f32 v193,v232,v193
M v[60:63],a[232:235],a[236:239],v[60:63]
s_waitcnt vmcnt(12)
buffer_load_dwordx4 a[204:207],v250,s[20:23],s47 offen offset:2048 sc1
M v[64:67],v[220:223],a[196:199],v[64:67]
s_waitcnt vmcnt(12)
s_add_u32 s48,s76,43008
v_cvt_pk_bf16_f32 v203,v237,v203
v_cvt_pk_bf16_f32 v195,v233,v195
M v[64:67],a[208:211],a[224:227],v[64:67]
s_waitcnt vmcnt(11)
v_cvt_pk_bf16_f32 v199,v234,v197
v_cvt_pk_bf16_f32 v197,v238,v235
M v[64:67],a[216:219],v[224:227],v[64:67]
s_waitcnt vmcnt(8)
v_cvt_pk_bf16_f32 v201,v236,v201
v_lshlrev_b32 v234,16,v208
M v[68:71],a[216:219],a[192:195],v[68:71]
buffer_load_dwordx4 a[232:235],v250,s[20:23],s48 offen offset:0 sc1
M v[68:71],a[208:211],v[224:227],v[68:71]
v_lshlrev_b32 v232,16,v204
v_lshlrev_b32 v233,16,v206
M v[68:71],v[220:223],a[224:227],v[68:71]
ds_write2st64_b64 v247,v[192:193],v[202:203] offset0:138 offset1:155
M v[72:75],v[220:223],v[224:227],v[72:75]
s_waitcnt vmcnt(7)
v_lshlrev_b32 v237,16,v214
v_lshlrev_b32 v236,16,v212
M v[72:75],a[208:211],a[192:195],v[72:75]
buffer_load_dwordx4 a[196:199],v250,s[20:23],s48 offen offset:1024 sc1
M v[72:75],a[216:219],a[240:243],v[72:75]
ds_write2st64_b64 v247,v[194:195],v[196:197] offset0:2 offset1:19
M v[76:79],a[216:219],v[228:231],v[76:79]
v_lshlrev_b32 v235,16,v210
v_fmac_f32 v232,s43,v234
M v[76:79],a[208:211],a[240:243],v[76:79]
buffer_load_dwordx4 a[224:227],v250,s[20:23],s48 offen offset:2048 sc1
M v[76:79],v[220:223],a[192:195],v[76:79]
s_add_u32 s46,s77,9216
ds_write2st64_b64 v247,v[198:199],v[200:201] offset0:36 offset1:53
M v[80:83],v[220:223],a[240:243],v[80:83]
v_fmac_f32 v237,4.0,v233
v_fma_f32 v238,-4.0,v234,v236
M v[80:83],a[208:211],v[228:231],v[80:83]
buffer_load_dwordx4 v[224:227],v250,s[20:23],s46 offen offset:0 sc1
M v[80:83],a[216:219],a[228:231],v[80:83]
v_fmac_f32 v232,s45,v236
v_fmac_f32 v237,s41,v235
M v[84:87],a[216:219],a[236:239],v[84:87]
v_sub_f32 v236,v236,v234
v_fma_f32 v234,-4.0,v233,v235
M v[84:87],a[208:211],a[228:231],v[84:87]
ds_read_b128 a[192:195],v248 offset:26112
v_sub_f32 v235,v235,v233
M v[84:87],v[220:223],v[228:231],v[84:87]
ds_read_b128 a[240:243],v249 offset:26112
v_add_f32 v233,v238,v234
M v[88:91],v[220:223],a[228:231],v[88:91]
ds_read_b128 v[228:231],v248 offset:26624
v_sub_f32 v238,v238,v234
M v[88:91],a[208:211],a[236:239],v[88:91]
ds_read_b128 a[228:231],v249 offset:26624
v_fma_f32 v234,2.0,v235,v236
M v[88:91],a[216:219],a[212:215],v[88:91]
v_fmac_f32 v236,-2.0,v235
v_and_b32 v208,s42,v208
M v[92:95],a[216:219],a[248:251],v[92:95]
v_and_b32 v204,s42,v204
v_and_b32 v206,s42,v206
M v[92:95],a[208:211],a[212:215],v[92:95]
v_and_b32 v214,s42,v214
v_and_b32 v212,s42,v212
M v[92:95],v[220:223],a[236:239],v[92:95]
s_waitcnt lgkmcnt(3)
v_and_b32 v210,s42,v210
v_fmac_f32 v204,s43,v208
M v[96:99],a[252:255],a[192:195],v[96:99]
s_waitcnt vmcnt(8) lgkmcnt(2)
ds_read_b128 a[216:219],v248 offset:27136
v_fmac_f32 v214,4.0,v206
M v[96:99],v[216:219],a[240:243],v[96:99]
s_waitcnt vmcnt(7) lgkmcnt(2)
ds_read_b128 a[248:251],v249 offset:27136
v_fma_f32 v235,-4.0,v208,v212
M v[96:99],a[200:203],v[228:231],v[96:99]
s_waitcnt lgkmcnt(2)
v_fmac_f32 v204,s45,v212
v_fmac_f32 v214,s41,v210
M v[100:103],a[200:203],a[228:231],v[100:103]
v_sub_f32 v212,v212,v208
v_fma_f32 v208,-4.0,v206,v210
M v[100:103],v[216:219],v[228:231],v[100:103]
v_sub_f32 v210,v210,v206
v_add_f32 v206,v235,v208
M v[100:103],a[252:255],a[240:243],v[100:103]
v_sub_f32 v235,v235,v208
v_fma_f32 v208,2.0,v210,v212
M v[104:107],a[252:255],v[228:231],v[104:107]
ds_read_b128 a[208:211],v248 offset:27648
v_fmac_f32 v212,-2.0,v210
M v[104:107],v[216:219],a[228:231],v[104:107]
s_waitcnt lgkmcnt(2)
ds_read_b128 a[212:215],v249 offset:27648
v_cvt_pk_bf16_f32 v204,v232,v204
M v[104:107],a[200:203],a[216:219],v[104:107]
s_waitcnt lgkmcnt(2)
v_cvt_pk_bf16_f32 v214,v237,v214
v_cvt_pk_bf16_f32 v206,v233,v206
M v[108:111],a[200:203],a[248:251],v[108:111]
v_cvt_pk_bf16_f32 v210,v234,v208
v_cvt_pk_bf16_f32 v208,v238,v235
M v[108:111],v[216:219],a[216:219],v[108:111]
v_cvt_pk_bf16_f32 v212,v236,v212
v_lshlrev_b32 v234,16,v209
M v[108:111],a[252:255],a[228:231],v[108:111]
v_lshlrev_b32 v232,16,v205
v_lshlrev_b32 v233,16,v207
M v[112:115],a[252:255],a[216:219],v[112:115]
ds_read_b128 a[236:239],v249 offset:28160
v_lshlrev_b32 v237,16,v215
M v[112:115],v[216:219],a[248:251],v[112:115]
s_waitcnt lgkmcnt(2)
ds_read_b128 v[220:223],v248 offset:28160
v_lshlrev_b32 v236,16,v213
M v[112:115],a[200:203],a[208:211],v[112:115]
s_waitcnt lgkmcnt(2)
v_lshlrev_b32 v235,16,v211
v_fmac_f32 v232,s43,v234
M v[116:119],a[200:203],a[212:215],v[116:119]
v_fmac_f32 v237,4.0,v233
v_fma_f32 v238,-4.0,v234,v236
M v[116:119],v[216:219],a[208:211],v[116:119]
v_fmac_f32 v232,s45,v236
v_fmac_f32 v237,s41,v235
M v[116:119],a[252:255],a[248:251],v[116:119]
v_sub_f32 v236,v236,v234
v_fma_f32 v234,-4.0,v233,v235
M v[120:123],a[252:255],a[208:211],v[120:123]
v_sub_f32 v235,v235,v233
v_add_f32 v233,v238,v234
M v[120:123],v[216:219],a[212:215],v[120:123]
s_waitcnt lgkmcnt(1)
v_sub_f32 v238,v238,v234
v_fma_f32 v234,2.0,v235,v236
M v[120:123],a[200:203],a[236:239],v[120:123]
s_waitcnt lgkmcnt(0)
v_fmac_f32 v236,-2.0,v235
v_and_b32 v209,s42,v209
M v[124:127],a[200:203],v[220:223],v[124:127]
buffer_load_dwordx4 a[200:203],v250,s[20:23],s46 offen offset:1024 sc1
M v[124:127],v[216:219],a[236:239],v[124:127]
v_and_b32 v205,s42,v205
v_and_b32 v207,s42,v207
M v[124:127],a[252:255],a[212:215],v[124:127]
s_waitcnt vmcnt(7)
buffer_load_dwordx4 v[216:219],v250,s[20:23],s46 offen offset:2048 sc1
M v[128:131],a[244:247],a[192:195],v[128:131]
s_waitcnt vmcnt(7)
s_add_u32 s46,s77,18432
v_and_b32 v215,s42,v215
v_and_b32 v213,s42,v213
M v[128:131],a[220:223],a[240:243],v[128:131]
s_waitcnt vmcnt(6)
v_and_b32 v211,s42,v211
v_fmac_f32 v205,s43,v209
M v[128:131],a[204:207],v[228:231],v[128:131]
v_fmac_f32 v215,4.0,v207
v_fma_f32 v235,-4.0,v209,v213
M v[132:135],a[204:207],a[228:231],v[132:135]
buffer_load_dwordx4 a[252:255],v250,s[20:23],s46 offen offset:0 sc1
M v[132:135],a[220:223],v[228:231],v[132:135]
v_fmac_f32 v205,s45,v213
v_fmac_f32 v215,s41,v211
M v[132:135],a[244:247],a[240:243],v[132:135]
v_sub_f32 v213,v213,v209
v_fma_f32 v209,-4.0,v207,v211
M v[136:139],a[244:247],v[228:231],v[136:139]
v_sub_f32 v211,v211,v207
v_add_f32 v207,v235,v209
M v[136:139],a[220:223],a[228:231],v[136:139]
v_sub_f32 v235,v235,v209
v_fma_f32 v209,2.0,v211,v213
M v[136:139],a[204:207],a[216:219],v[136:139]
v_fmac_f32 v213,-2.0,v211
v_cvt_pk_bf16_f32 v205,v232,v205
M v[140:143],a[204:207],a[248:251],v[140:143]
v_cvt_pk_bf16_f32 v215,v237,v215
v_cvt_pk_bf16_f32 v207,v233,v207
M v[140:143],a[220:223],a[216:219],v[140:143]
v_cvt_pk_bf16_f32 v211,v234,v209
v_cvt_pk_bf16_f32 v209,v238,v235
M v[140:143],a[244:247],a[228:231],v[140:143]
v_cvt_pk_bf16_f32 v213,v236,v213
M v[144:147],a[244:247],a[216:219],v[144:147]
M v[144:147],a[220:223],a[248:251],v[144:147]
M v[144:147],a[204:207],a[208:211],v[144:147]
ds_write2st64_b64 v247,v[204:205],v[214:215] offset0:139 offset1:156
M v[148:151],a[204:207],a[212:215],v[148:151]
M v[148:151],a[220:223],a[208:211],v[148:151]
M v[148:151],a[244:247],a[248:251],v[148:151]
ds_write2st64_b64 v247,v[206:207],v[208:209] offset0:3 offset1:20
M v[152:155],a[244:247],a[208:211],v[152:155]
M v[152:155],a[220:223],a[212:215],v[152:155]
M v[152:155],a[204:207],a[236:239],v[152:155]
ds_write2st64_b64 v247,v[210:211],v[212:213] offset0:37 offset1:54
M v[156:159],a[204:207],v[220:223],v[156:159]
buffer_load_dwordx4 a[204:207],v250,s[20:23],s46 offen offset:1024 sc1
M v[156:159],a[220:223],a[236:239],v[156:159]
M v[156:159],a[244:247],a[212:215],v[156:159]
s_waitcnt vmcnt(7)
buffer_load_dwordx4 a[220:223],v250,s[20:23],s46 offen offset:2048 sc1
M v[160:163],a[232:235],a[192:195],v[160:163]
s_waitcnt vmcnt(7)
s_add_u32 s46,s77,27648
M v[160:163],a[196:199],a[240:243],v[160:163]
s_waitcnt vmcnt(6)
M v[160:163],a[224:227],v[228:231],v[160:163]
M v[164:167],a[224:227],a[228:231],v[164:167]
buffer_load_dwordx4 a[244:247],v250,s[20:23],s46 offen offset:0 sc1
M v[164:167],a[196:199],v[228:231],v[164:167]
M v[164:167],a[232:235],a[240:243],v[164:167]
M v[168:171],a[232:235],v[228:231],v[168:171]
M v[168:171],a[196:199],a[228:231],v[168:171]
buffer_load_dwordx4 a[192:195],v250,s[20:23],s46 offen offset:1024 sc1
M v[168:171],a[224:227],a[216:219],v[168:171]
M v[172:175],a[224:227],a[248:251],v[172:175]
M v[172:175],a[196:199],a[216:219],v[172:175]
M v[172:175],a[232:235],a[228:231],v[172:175]
buffer_load_dwordx4 a[240:243],v250,s[20:23],s46 offen offset:2048 sc1
M v[176:179],a[232:235],a[216:219],v[176:179]
s_add_u32 s46,s77,36864
M v[176:179],a[196:199],a[248:251],v[176:179]
v_add_u32 v248,0xffffbc00,v248
v_add_u32 v249,0xffffbc00,v249
M v[176:179],a[224:227],a[208:211],v[176:179]
s_waitcnt lgkmcnt(0)
s_barrier
M v[180:183],a[224:227],a[212:215],v[180:183]
buffer_load_dwordx4 v[228:231],v250,s[20:23],s46 offen offset:0 sc1
M v[180:183],a[196:199],a[208:211],v[180:183]
ds_read_b128 a[228:231],v248 offset:0
M v[180:183],a[232:235],a[248:251],v[180:183]
ds_read_b128 a[216:219],v249 offset:0
M v[184:187],a[232:235],a[208:211],v[184:187]
ds_read_b128 a[248:251],v248 offset:512
M v[184:187],a[196:199],a[212:215],v[184:187]
ds_read_b128 a[208:211],v249 offset:512
M v[184:187],a[224:227],a[236:239],v[184:187]
M v[188:191],a[224:227],v[220:223],v[188:191]
buffer_load_dwordx4 a[224:227],v250,s[20:23],s46 offen offset:1024 sc1
M v[188:191],a[196:199],a[236:239],v[188:191]
M v[188:191],a[232:235],a[212:215],v[188:191]
s_waitcnt vmcnt(10) lgkmcnt(3)
buffer_load_dwordx4 v[220:223],v250,s[20:23],s46 offen offset:2048 sc1
M a[0:3],v[224:227],a[228:231],a[0:3]
s_waitcnt vmcnt(10) lgkmcnt(2)
s_add_u32 s47,s77,12288
ds_read_b128 a[236:239],v248 offset:1024
M a[0:3],a[200:203],a[216:219],a[0:3]
s_waitcnt vmcnt(9) lgkmcnt(2)
ds_read_b128 a[212:215],v249 offset:1024
M a[0:3],v[216:219],a[248:251],a[0:3]
s_waitcnt lgkmcnt(2)
M a[4:7],v[216:219],a[208:211],a[4:7]
buffer_load_dwordx4 a[196:199],v250,s[20:23],s47 offen offset:0 sc1
M a[4:7],a[200:203],a[248:251],a[4:7]
M a[4:7],v[224:227],a[216:219],a[4:7]
M a[8:11],v[224:227],a[248:251],a[8:11]
ds_read_b128 a[232:235],v248 offset:1536
M a[8:11],a[200:203],a[208:211],a[8:11]
s_waitcnt lgkmcnt(2)
ds_read_b128 a[228:231],v249 offset:1536
M a[8:11],v[216:219],a[236:239],a[8:11]
s_waitcnt lgkmcnt(2)
M a[12:15],v[216:219],a[212:215],a[12:15]
M a[12:15],a[200:203],a[236:239],a[12:15]
M a[12:15],v[224:227],a[208:211],a[12:15]
M a[16:19],v[224:227],a[236:239],a[16:19]
ds_read_b128 a[216:219],v249 offset:2048
M a[16:19],a[200:203],a[212:215],a[16:19]
s_waitcnt lgkmcnt(2)
ds_read_b128 a[248:251],v248 offset:2048
M a[16:19],v[216:219],a[232:235],a[16:19]
s_waitcnt lgkmcnt(2)
M a[20:23],v[216:219],a[228:231],a[20:23]
M a[20:23],a[200:203],a[232:235],a[20:23]
ds_read_b128 a[208:211],v248 offset:8704
M a[20:23],v[224:227],a[212:215],a[20:23]
ds_read_b128 a[236:239],v249 offset:8704
M a[24:27],v[224:227],a[232:235],a[24:27]
ds_read_b128 a[212:215],v248 offset:9216
M a[24:27],a[200:203],a[228:231],a[24:27]
s_waitcnt lgkmcnt(4)
ds_read_b128 a[232:235],v249 offset:9216
M a[24:27],v[216:219],a[216:219],a[24:27]
s_waitcnt lgkmcnt(4)
M a[28:31],v[216:219],a[248:251],a[28:31]
buffer_load_dwordx4 a[248:251],v250,s[20:23],s47 offen offset:1024 sc1
M a[28:31],a[200:203],a[216:219],a[28:31]
M a[28:31],v[224:227],a[228:231],a[28:31]
s_waitcnt vmcnt(10) lgkmcnt(3)
buffer_load_dwordx4 v[216:219],v250,s[20:23],s47 offen offset:2048 sc1
M a[96:99],a[252:255],a[208:211],a[96:99]
s_waitcnt vmcnt(10) lgkmcnt(2)
s_add_u32 s48,s77,15360
ds_read_b128 a[216:219],v248 offset:9728
M a[96:99],a[204:207],a[236:239],a[96:99]
s_waitcnt vmcnt(9) lgkmcnt(2)
ds_read_b128 a[228:231],v249 offset:9728
M a[96:99],a[220:223],a[212:215],a[96:99]
s_waitcnt lgkmcnt(2)
M a[100:103],a[220:223],a[232:235],a[100:103]
buffer_load_dwordx4 a[200:203],v250,s[20:23],s48 offen offset:0 sc1
M a[100:103],a[204:207],a[212:215],a[100:103]
M a[100:103],a[252:255],a[236:239],a[100:103]
M a[104:107],a[252:255],a[212:215],a[104:107]
ds_read_b128 v[224:227],v248 offset:10240
M a[104:107],a[204:207],a[232:235],a[104:107]
s_waitcnt lgkmcnt(2)
ds_read_b128 a[208:211],v249 offset:10240
M a[104:107],a[220:223],a[216:219],a[104:107]
s_waitcnt lgkmcnt(2)
M a[108:111],a[220:223],a[228:231],a[108:111]
M a[108:111],a[204:207],a[216:219],a[108:111]
M a[108:111],a[252:255],a[232:235],a[108:111]
M a[112:115],a[252:255],a[216:219],a[112:115]
ds_read_b128 a[236:239],v249 offset:10752
M a[112:115],a[204:207],a[228:231],a[112:115]
s_waitcnt lgkmcnt(2)
ds_read_b128 a[212:215],v248 offset:10752
M a[112:115],a[220:223],v[224:227],a[112:115]
s_waitcnt lgkmcnt(2)
M a[116:119],a[220:223],a[208:211],a[116:119]
M a[116:119],a[204:207],v[224:227],a[116:119]
ds_read_b128 a[232:235],v248 offset:17408
M a[116:119],a[252:255],a[228:231],a[116:119]
ds_read_b128 a[216:219],v249 offset:17408
M a[120:123],a[252:255],v[224:227],a[120:123]
ds_read_b128 a[228:231],v248 offset:17920
M a[120:123],a[204:207],a[208:211],a[120:123]
s_waitcnt lgkmcnt(4)
ds_read_b128 v[224:227],v249 offset:17920
M a[120:123],a[220:223],a[236:239],a[120:123]
s_waitcnt lgkmcnt(4)
M a[124:127],a[220:223],a[212:215],a[124:127]
buffer_load_dwordx4 a[212:215],v250,s[20:23],s48 offen offset:1024 sc1
M a[124:127],a[204:207],a[236:239],a[124:127]
M a[124:127],a[252:255],a[208:211],a[124:127]
s_waitcnt vmcnt(10) lgkmcnt(3)
buffer_load_dwordx4 a[220:223],v250,s[20:23],s48 offen offset:2048 sc1
M v[0:3],a[244:247],a[232:235],v[0:3]
s_waitcnt vmcnt(10) lgkmcnt(2)
s_add_u32 s47,s77,21504
ds_read_b128 a[236:239],v248 offset:18432
M v[0:3],a[192:195],a[216:219],v[0:3]
s_waitcnt vmcnt(9) lgkmcnt(2)
ds_read_b128 a[208:211],v249 offset:18432
M v[0:3],a[240:243],a[228:231],v[0:3]
s_waitcnt lgkmcnt(2)
M v[4:7],a[240:243],v[224:227],v[4:7]
buffer_load_dwordx4 a[204:207],v250,s[20:23],s47 offen offset:0 sc1
M v[4:7],a[192:195],a[228:231],v[4:7]
M v[4:7],a[244:247],a[216:219],v[4:7]
M v[8:11],a[244:247],a[228:231],v[8:11]
ds_read_b128 a[252:255],v248 offset:18944
M v[8:11],a[192:195],v[224:227],v[8:11]
s_waitcnt lgkmcnt(2)
ds_read_b128 a[232:235],v249 offset:18944
M v[8:11],a[240:243],a[236:239],v[8:11]
s_waitcnt lgkmcnt(2)
M v[12:15],a[240:243],a[208:211],v[12:15]
M v[12:15],a[192:195],a[236:239],v[12:15]
M v[12:15],a[244:247],v[224:227],v[12:15]
M v[16:19],a[244:247],a[236:239],v[16:19]
ds_read_b128 a[216:219],v249 offset:19456
M v[16:19],a[192:195],a[208:211],v[16:19]
s_waitcnt lgkmcnt(2)
ds_read_b128 a[228:231],v248 offset:19456
M v[16:19],a[240:243],a[252:255],v[16:19]
s_waitcnt lgkmcnt(2)
M v[20:23],a[240:243],a[232:235],v[20:23]
M v[20:23],a[192:195],a[252:255],v[20:23]
ds_read_b128 v[224:227],v248 offset:26112
M v[20:23],a[244:247],a[208:211],v[20:23]
ds_read_b128 a[236:239],v249 offset:26112
M v[24:27],a[244:247],a[252:255],v[24:27]
ds_read_b128 a[208:211],v248 offset:26624
M v[24:27],a[192:195],a[232:235],v[24:27]
s_waitcnt lgkmcnt(4)
ds_read_b128 a[252:255],v249 offset:26624
M v[24:27],a[240:243],a[216:219],v[24:27]
s_waitcnt lgkmcnt(4)
M v[28:31],a[240:243],a[228:231],v[28:31]
buffer_load_dwordx4 a[228:231],v250,s[20:23],s47 offen offset:1024 sc1
M v[28:31],a[192:195],a[216:219],v[28:31]
M v[28:31],a[244:247],a[232:235],v[28:31]
s_waitcnt vmcnt(10) lgkmcnt(3)
buffer_load_dwordx4 a[240:243],v250,s[20:23],s47 offen offset:2048 sc1
M v[96:99],v[228:231],v[224:227],v[96:99]
s_waitcnt vmcnt(10) lgkmcnt(2)
s_add_u32 s48,s77,24576
ds_read_b128 a[216:219],v248 offset:27136
M v[96:99],a[224:227],a[236:239],v[96:99]
s_waitcnt vmcnt(9) lgkmcnt(2)
ds_read_b128 a[232:235],v249 offset:27136
M v[96:99],v[220:223],a[208:211],v[96:99]
s_waitcnt lgkmcnt(2)
M v[100:103],v[220:223],a[252:255],v[100:103]
buffer_load_dwordx4 a[192:195],v250,s[20:23],s48 offen offset:0 sc1
M v[100:103],a[224:227],a[208:211],v[100:103]
M v[100:103],v[228:231],a[236:239],v[100:103]
v_accvgpr_read_b32 v238,a0
v_accvgpr_read_b32 v232,a96
M v[104:107],v[228:231],a[208:211],v[104:107]
ds_read_b128 a[244:247],v248 offset:27648
v_add_f32 v234,v238,v232
M v[104:107],a[224:227],a[252:255],v[104:107]
s_waitcnt lgkmcnt(2)
ds_read_b128 v[224:227],v249 offset:27648
v_sub_f32 v238,v238,v232
M v[104:107],v[220:223],a[216:219],v[104:107]
s_waitcnt lgkmcnt(2)
v_add_f32 v232,v0,v96
v_sub_f32 v96,v0,v96
M v[108:111],v[220:223],a[232:235],v[108:111]
v_add_f32 v0,v234,v232
v_fmac_f32 v234,4.0,v232
M v[108:111],a[224:227],a[216:219],v[108:111]
v_fma_f32 v232,2.0,v96,v238
v_fma_f32 v96,s40,v96,v238
M v[108:111],v[228:231],a[252:255],v[108:111]
v_accvgpr_read_b32 v238,a1
v_accvgpr_read_b32 v237,a97
M v[112:115],v[228:231],a[216:219],v[112:115]
ds_read_b128 a[236:239],v249 offset:28160
v_add_f32 v236,v238,v237
M v[112:115],a[224:227],a[232:235],v[112:115]
s_waitcnt lgkmcnt(2)
ds_read_b128 a[208:211],v248 offset:28160
v_sub_f32 v238,v238,v237
M v[112:115],v[220:223],a[244:247],v[112:115]
s_waitcnt lgkmcnt(2)
v_add_f32 v237,v1,v97
v_sub_f32 v97,v1,v97
M v[116:119],v[220:223],v[224:227],v[116:119]
v_add_f32 v1,v236,v237
v_fmac_f32 v236,4.0,v237
M v[116:119],a[224:227],a[244:247],v[116:119]
ds_read_b128 a[252:255],v248 offset:0
v_fma_f32 v237,2.0,v97,v238
M v[116:119],v[228:231],a[232:235],v[116:119]
ds_read_b128 a[216:219],v249 offset:0
v_fma_f32 v97,s40,v97,v238
M v[120:123],v[228:231],a[244:247],v[120:123]
ds_read_b128 a[232:235],v248 offset:512
v_cvt_pk_bf16_f32 v232,v232,v237
M v[120:123],a[224:227],v[224:227],v[120:123]
s_waitcnt lgkmcnt(4)
ds_read_b128 a[244:247],v249 offset:512
v_cvt_pk_bf16_f32 v234,v234,v236
M v[120:123],v[220:223],a[236:239],v[120:123]
s_waitcnt lgkmcnt(4)
v_accvgpr_read_b32 v238,a2
v_accvgpr_read_b32 v233,a98
M v[124:127],v[220:223],a[208:211],v[124:127]
buffer_load_dwordx4 a[208:211],v250,s[20:23],s48 offen offset:1024 sc1
M v[124:127],a[224:227],a[236:239],v[124:127]
v_add_f32 v235,v238,v233
v_sub_f32 v238,v238,v233
M v[124:127],v[228:231],v[224:227],v[124:127]
s_waitcnt vmcnt(10) lgkmcnt(3)
v_add_f32 v233,v2,v98
v_sub_f32 v98,v2,v98
M a[32:35],a[196:199],a[252:255],a[32:35]
s_waitcnt vmcnt(9) lgkmcnt(2)
ds_read_b128 v[220:223],v248 offset:1024
v_add_f32 v2,v235,v233
M a[32:35],a[248:251],a[216:219],a[32:35]
s_waitcnt vmcnt(8) lgkmcnt(2)
ds_read_b128 a[224:227],v249 offset:1024
v_fmac_f32 v235,4.0,v233
M a[32:35],v[216:219],a[232:235],a[32:35]
s_waitcnt lgkmcnt(2)
v_fma_f32 v233,2.0,v98,v238
v_fma_f32 v98,s40,v98,v238
M a[36:39],v[216:219],a[244:247],a[36:39]
v_accvgpr_read_b32 v238,a3
v_accvgpr_read_b32 v237,a99
M a[36:39],a[248:251],a[232:235],a[36:39]
v_add_f32 v236,v238,v237
v_sub_f32 v238,v238,v237
M a[36:39],a[196:199],a[216:219],a[36:39]
v_add_f32 v237,v3,v99
v_sub_f32 v99,v3,v99
M a[40:43],a[196:199],a[232:235],a[40:43]
ds_read_b128 a[96:99],v248 offset:1536
v_add_f32 v3,v236,v237
M a[40:43],a[248:251],a[244:247],a[40:43]
s_waitcnt lgkmcnt(2)
ds_read_b128 a[236:239],v249 offset:1536
v_fmac_f32 v236,4.0,v237
M a[40:43],v[216:219],v[220:223],a[40:43]
s_waitcnt lgkmcnt(2)
v_fma_f32 v237,2.0,v99,v238
v_fma_f32 v99,s40,v99,v238
M a[44:47],v[216:219],a[224:227],a[44:47]
v_cvt_pk_bf16_f32 v233,v233,v237
v_cvt_pk_bf16_f32 v235,v235,v236
M a[44:47],a[248:251],v[220:223],a[44:47]
ds_write2st64_b64 v254,v[232:233],v[234:235] offset0:68 offset1:72
M a[44:47],a[196:199],a[244:247],a[44:47]
v_accvgpr_read_b32 v238,a4
v_accvgpr_read_b32 v232,a100
M a[48:51],a[196:199],v[220:223],a[48:51]
ds_read_b128 v[224:227],v249 offset:2048
v_add_f32 v234,v238,v232
M a[48:51],a[248:251],a[224:227],a[48:51]
s_waitcnt lgkmcnt(3)
ds_read_b128 v[228:231],v248 offset:2048
v_sub_f32 v238,v238,v232
M a[48:51],v[216:219],a[96:99],a[48:51]
s_waitcnt lgkmcnt(3)
v_add_f32 v232,v4,v100
v_sub_f32 v100,v4,v100
M a[52:55],v[216:219],a[236:239],a[52:55]
v_add_f32 v4,v234,v232
v_fmac_f32 v234,4.0,v232
M a[52:55],a[248:251],a[96:99],a[52:55]
v_fma_f32 v232,2.0,v100,v238
v_fma_f32 v100,s40,v100,v238
M a[52:55],a[196:199],a[224:227],a[52:55]
v_accvgpr_read_b32 v238,a5
v_accvgpr_read_b32 v237,a101
M a[56:59],a[196:199],a[96:99],a[56:59]
v_add_f32 v236,v238,v237
v_sub_f32 v238,v238,v237
M a[56:59],a[248:251],a[236:239],a[56:59]
s_waitcnt lgkmcnt(1)
v_add_f32 v237,v5,v101
v_sub_f32 v101,v5,v101
M a[56:59],v[216:219],v[224:227],a[56:59]
s_waitcnt lgkmcnt(0)
v_add_f32 v5,v236,v237
v_fmac_f32 v236,4.0,v237
M a[60:63],v[216:219],v[228:231],a[60:63]
buffer_load_dwordx4 v[216:219],v250,s[20:23],s48 offen offset:2048 sc1
M a[60:63],a[248:251],v[224:227],a[60:63]
s_add_u32 s47,s77,30720
v_fma_f32 v237,2.0,v101,v238
v_fma_f32 v101,s40,v101,v238
M a[60:63],a[196:199],a[236:239],a[60:63]
s_waitcnt vmcnt(8)
buffer_load_dwordx4 a[248:251],v250,s[20:23],s47 offen offset:0 sc1
M a[64:67],a[200:203],a[252:255],a[64:67]
s_waitcnt vmcnt(8)
v_cvt_pk_bf16_f32 v232,v232,v237
v_cvt_pk_bf16_f32 v234,v234,v236
M a[64:67],a[212:215],a[216:219],a[64:67]
s_waitcnt vmcnt(7)
v_accvgpr_read_b32 v238,a6
v_accvgpr_read_b32 v233,a102
M a[64:67],a[220:223],a[232:235],a[64:67]
v_add_f32 v235,v238,v233
v_sub_f32 v238,v238,v233
M a[68:71],a[220:223],a[244:247],a[68:71]
buffer_load_dwordx4 a[196:199],v250,s[20:23],s47 offen offset:1024 sc1
M a[68:71],a[212:215],a[232:235],a[68:71]
v_add_f32 v233,v6,v102
v_sub_f32 v102,v6,v102
M a[68:71],a[200:203],a[216:219],a[68:71]
v_add_f32 v6,v235,v233
v_fmac_f32 v235,4.0,v233
M a[72:75],a[200:203],a[232:235],a[72:75]
v_fma_f32 v233,2.0,v102,v238
v_fma_f32 v102,s40,v102,v238
M a[72:75],a[212:215],a[244:247],a[72:75]
buffer_load_dwordx4 a[252:255],v250,s[20:23],s47 offen offset:2048 sc1
M a[72:75],a[220:223],v[220:223],a[72:75]
s_add_u32 s48,s77,33792
v_accvgpr_read_b32 v238,a7
v_accvgpr_read_b32 v237,a103
M a[76:79],a[220:223],a[224:227],a[76:79]
v_add_f32 v236,v238,v237
v_sub_f32 v238,v238,v237
M a[76:79],a[212:215],v[220:223],a[76:79]
v_add_f32 v237,v7,v103
v_sub_f32 v103,v7,v103
M a[76:79],a[200:203],a[244:247],a[76:79]
buffer_load_dwordx4 a[216:219],v250,s[20:23],s48 offen offset:0 sc1
M a[80:83],a[200:203],v[220:223],a[80:83]
v_add_f32 v7,v236,v237
v_fmac_f32 v236,4.0,v237
M a[80:83],a[212:215],a[224:227],a[80:83]
v_fma_f32 v237,2.0,v103,v238
v_fma_f32 v103,s40,v103,v238
M a[80:83],a[220:223],a[96:99],a[80:83]
v_cvt_pk_bf16_f32 v233,v233,v237
v_cvt_pk_bf16_f32 v235,v235,v236
M a[84:87],a[220:223],a[236:239],a[84:87]
buffer_load_dwordx4 a[232:235],v250,s[20:23],s48 offen offset:1024 sc1
M a[84:87],a[212:215],a[96:99],a[84:87]
ds_read_b128 a[244:247],v248 offset:8704
ds_write2st64_b64 v254,v[232:233],v[234:235] offset0:76 offset1:80
M a[84:87],a[200:203],a[224:227],a[84:87]
ds_read_b128 v[220:223],v249 offset:8704
v_accvgpr_read_b32 v238,a8
M a[88:91],a[200:203],a[96:99],a[88:91]
buffer_load_dwordx4 a[100:103],v250,s[20:23],s48 offen offset:2048 sc1
M a[88:91],a[212:215],a[236:239],a[88:91]
ds_read_b128 a[96:99],v248 offset:9216
ds_read_b128 a[224:227],v249 offset:9216
M a[88:91],a[220:223],v[224:227],a[88:91]
v_accvgpr_read_b32 v232,a104
v_add_f32 v234,v238,v232
M a[92:95],a[220:223],v[228:231],a[92:95]
v_sub_f32 v238,v238,v232
v_add_f32 v232,v8,v104
M a[92:95],a[212:215],v[224:227],a[92:95]
v_sub_f32 v104,v8,v104
M a[92:95],a[200:203],a[236:239],a[92:95]
s_waitcnt vmcnt(11) lgkmcnt(3)
s_barrier
ds_read_b128 a[0:3],v250 offset:34816
M a[128:131],a[204:207],a[244:247],a[128:131]
s_waitcnt vmcnt(10) lgkmcnt(3)
ds_read_b128 a[4:7],v250 offset:38912
ds_read_b128 a[220:223],v248 offset:9728
M a[128:131],a[228:231],v[220:223],a[128:131]
s_waitcnt vmcnt(9) lgkmcnt(4)
ds_read_b128 v[228:231],v249 offset:9728
v_add_f32 v8,v234,v232
M a[128:131],a[240:243],a[96:99],a[128:131]
s_waitcnt lgkmcnt(4)
v_fmac_f32 v234,4.0,v232
v_fma_f32 v232,2.0,v104,v238
M a[132:135],a[240:243],a[224:227],a[132:135]
v_fma_f32 v104,s40,v104,v238
v_accvgpr_read_b32 v238,a9
M a[132:135],a[228:231],a[96:99],a[132:135]
v_accvgpr_read_b32 v237,a105
v_add_f32 v236,v238,v237
M a[132:135],a[204:207],v[220:223],a[132:135]
v_sub_f32 v238,v238,v237
v_add_f32 v237,v9,v105
M a[136:139],a[204:207],a[96:99],a[136:139]
s_add_u32 s34,s32,6291456
ds_read_b128 a[212:215],v248 offset:10240
v_sub_f32 v105,v9,v105
M a[136:139],a[228:231],a[224:227],a[136:139]
s_waitcnt lgkmcnt(2)
ds_read_b128 v[224:227],v249 offset:10240
v_add_f32 v9,v236,v237
M a[136:139],a[240:243],a[220:223],a[136:139]
s_waitcnt lgkmcnt(2)
buffer_store_dwordx4 a[0:3],v253,s[24:27],s34 offen offset:384 nt
M a[140:143],a[240:243],v[228:231],a[140:143]
v_fmac_f32 v236,4.0,v237
v_fma_f32 v237,2.0,v105,v238
M a[140:143],a[228:231],a[220:223],a[140:143]
v_fma_f32 v105,s40,v105,v238
v_cvt_pk_bf16_f32 v232,v232,v237
M a[140:143],a[204:207],a[224:227],a[140:143]
v_cvt_pk_bf16_f32 v234,v234,v236
v_accvgpr_read_b32 v238,a10
M a[144:147],a[204:207],a[220:223],a[144:147]
ds_read_b128 a[200:203],v249 offset:10752
v_accvgpr_read_b32 v233,a106
M a[144:147],a[228:231],v[228:231],a[144:147]
s_waitcnt lgkmcnt(2)
ds_read_b128 a[236:239],v248 offset:10752
v_add_f32 v235,v238,v233
M a[144:147],a[240:243],a[212:215],a[144:147]
s_waitcnt lgkmcnt(2)
v_sub_f32 v238,v238,v233
v_add_f32 v233,v10,v106
M a[148:151],a[240:243],v[224:227],a[148:151]
s_add_u32 s47,s77,39936
v_sub_f32 v106,v10,v106
v_add_f32 v10,v235,v233
M a[148:151],a[228:231],a[212:215],a[148:151]
v_fmac_f32 v235,4.0,v233
v_fma_f32 v233,2.0,v106,v238
M a[148:151],a[204:207],v[228:231],a[148:151]
v_fma_f32 v106,s40,v106,v238
v_accvgpr_read_b32 v238,a11
M a[152:155],a[204:207],a[212:215],a[152:155]
v_accvgpr_read_b32 v237,a107
v_add_f32 v236,v238,v237
M a[152:155],a[228:231],v[224:227],a[152:155]
s_waitcnt lgkmcnt(1)
v_sub_f32 v238,v238,v237
v_add_f32 v237,v11,v107
M a[152:155],a[240:243],a[200:203],a[152:155]
s_waitcnt lgkmcnt(0)
v_sub_f32 v107,v11,v107
v_add_f32 v11,v236,v237
M a[156:159],a[240:243],a[236:239],a[156:159]
buffer_load_dwordx4 a[104:107],v250,s[20:23],s47 offen offset:0 sc1
M a[156:159],a[228:231],a[200:203],a[156:159]
v_fmac_f32 v236,4.0,v237
v_fma_f32 v237,2.0,v107,v238
M a[156:159],a[204:207],v[224:227],a[156:159]
s_waitcnt vmcnt(10)
buffer_load_dwordx4 a[240:243],v250,s[20:23],s47 offen offset:1024 sc1
M a[160:163],a[192:195],a[244:247],a[160:163]
s_waitcnt vmcnt(10)
v_fma_f32 v107,s40,v107,v238
v_cvt_pk_bf16_f32 v233,v233,v237
M a[160:163],a[208:211],v[220:223],a[160:163]
s_waitcnt vmcnt(9)
v_cvt_pk_bf16_f32 v235,v235,v236
M a[160:163],v[216:219],a[96:99],a[160:163]
ds_write2st64_b64 v254,v[232:233],v[234:235] offset0:85 offset1:89
M a[164:167],v[216:219],a[224:227],a[164:167]
buffer_load_dwordx4 a[228:231],v250,s[20:23],s47 offen offset:2048 sc1
M a[164:167],a[208:211],a[96:99],a[164:167]
s_add_u32 s48,s77,43008
s_add_u32 s34,s32,6488064
v_accvgpr_read_b32 v204,a12
M a[164:167],a[192:195],v[220:223],a[164:167]
v_accvgpr_read_b32 v208,a108
v_accvgpr_read_b32 v205,a13
M a[168:171],a[192:195],a[96:99],a[168:171]
v_accvgpr_read_b32 v209,a109
v_accvgpr_read_b32 v206,a14
M a[168:171],a[208:211],a[224:227],a[168:171]
buffer_load_dwordx4 a[204:207],v250,s[20:23],s48 offen offset:0 sc1
M a[168:171],v[216:219],a[220:223],a[168:171]
v_accvgpr_read_b32 v210,a110
v_accvgpr_read_b32 v207,a15
v_accvgpr_read_b32 v211,a111
v_pk_add_f32 v[212:213],v[204:205],v[208:209]
v_pk_add_f32 v[214:215],v[206:207],v[210:211]
v_pk_add_f32 v[204:205],v[204:205],v[208:209] neg_lo:[0,1] neg_hi:[0,1]
v_pk_add_f32 v[206:207],v[206:207],v[210:211] neg_lo:[0,1] neg_hi:[0,1]
v_pk_add_f32 v[208:209],v[12:13],v[108:109]
v_pk_add_f32 v[210:211],v[14:15],v[110:111]
v_pk_add_f32 v[108:109],v[12:13],v[108:109] neg_lo:[0,1] neg_hi:[0,1]
v_pk_add_f32 v[110:111],v[14:15],v[110:111] neg_lo:[0,1] neg_hi:[0,1]
v_pk_add_f32 v[12:13],v[212:213],v[208:209]
v_pk_add_f32 v[14:15],v[214:215],v[210:211]
v_pk_fma_f32 v[212:213],v[208:209],4.0,v[212:213] op_sel_hi:[1,0,1]
v_pk_fma_f32 v[214:215],v[210:211],4.0,v[214:215] op_sel_hi:[1,0,1]
v_pk_fma_f32 v[208:209],v[108:109],2.0,v[204:205] op_sel_hi:[1,0,1]
v_pk_fma_f32 v[210:211],v[110:111],2.0,v[206:207] op_sel_hi:[1,0,1]
v_pk_fma_f32 v[108:109],v[108:109],s[40:41],v[204:205] op_sel_hi:[1,0,1]
v_pk_fma_f32 v[110:111],v[110:111],s[40:41],v[206:207] op_sel_hi:[1,0,1]
M a[172:175],v[216:219],v[228:231],a[172:175]
buffer_load_dwordx4 a[244:247],v250,s[20:23],s48 offen offset:1024 sc1
M a[172:175],a[208:211],a[220:223],a[172:175]
v_cvt_pk_bf16_f32 v208,v208,v209
v_cvt_pk_bf16_f32 v209,v210,v211
M a[172:175],a[192:195],a[224:227],a[172:175]
buffer_load_dwordx4 v[220:223],v250,s[20:23],s48 offen offset:2048 sc1
M a[176:179],a[192:195],a[220:223],a[176:179]
s_add_u32 s46,s72,0
v_cvt_pk_bf16_f32 v212,v212,v213
v_cvt_pk_bf16_f32 v213,v214,v215
M a[176:179],a[208:211],v[228:231],a[176:179]
ds_write2st64_b64 v254,v[208:209],v[212:213] offset0:93 offset1:97
M a[176:179],v[216:219],a[212:215],a[176:179]
v_accvgpr_read_b32 v238,a16
v_accvgpr_read_b32 v232,a112
M a[180:183],v[216:219],v[224:227],a[180:183]
buffer_load_dwordx4 a[96:99],v250,s[20:23],s46 offen offset:0 sc1
M a[180:183],a[208:211],a[212:215],a[180:183]
ds_read_b128 a[224:227],v248 offset:17408
v_add_f32 v234,v238,v232
M a[180:183],a[192:195],v[228:231],a[180:183]
ds_read_b128 a[220:223],v249 offset:17408
v_sub_f32 v238,v238,v232
M a[184:187],a[192:195],a[212:215],a[184:187]
ds_read_b128 v[228:231],v248 offset:17920
v_add_f32 v232,v16,v112
M a[184:187],a[208:211],v[224:227],a[184:187]
buffer_load_dwordx4 a[108:111],v250,s[20:23],s46 offen offset:1024 sc1
M a[184:187],v[216:219],a[200:203],a[184:187]
ds_read_b128 a[212:215],v249 offset:17920
v_sub_f32 v112,v16,v112
M a[188:191],v[216:219],a[236:239],a[188:191]
s_waitcnt lgkmcnt(4)
s_barrier
ds_read_b128 a[8:11],v250 offset:43520
M a[188:191],a[208:211],a[200:203],a[188:191]
ds_read_b128 a[12:15],v250 offset:47616
v_add_f32 v16,v234,v232
M a[188:191],a[192:195],v[224:227],a[188:191]
s_waitcnt vmcnt(14) lgkmcnt(5)
buffer_store_dwordx4 a[4:7],v253,s[24:27],s34 offen offset:384 nt
M v[32:35],a[248:251],a[224:227],v[32:35]
s_waitcnt vmcnt(14) lgkmcnt(4)
ds_read_b128 a[236:239],v248 offset:18432
v_fmac_f32 v234,4.0,v232
M v[32:35],a[196:199],a[220:223],v[32:35]
s_waitcnt vmcnt(13) lgkmcnt(4)
ds_read_b128 v[216:219],v249 offset:18432
v_fma_f32 v232,2.0,v112,v238
M v[32:35],a[252:255],v[228:231],v[32:35]
s_waitcnt lgkmcnt(3)
s_add_u32 s34,s32,6684672
buffer_store_dwordx4 a[8:11],v253,s[24:27],s34 offen offset:384 nt
M v[36:39],a[252:255],a[212:215],v[36:39]
v_fma_f32 v112,s40,v112,v238
v_accvgpr_read_b32 v238,a17
M v[36:39],a[196:199],v[228:231],v[36:39]
v_accvgpr_read_b32 v237,a113
v_add_f32 v236,v238,v237
M v[36:39],a[248:251],a[220:223],v[36:39]
v_sub_f32 v238,v238,v237
v_add_f32 v237,v17,v113
M v[40:43],a[248:251],v[228:231],v[40:43]
ds_read_b128 a[200:203],v248 offset:18944
v_sub_f32 v113,v17,v113
M v[40:43],a[196:199],a[212:215],v[40:43]
s_waitcnt lgkmcnt(2)
ds_read_b128 a[208:211],v249 offset:18944
v_add_f32 v17,v236,v237
M v[40:43],a[252:255],a[236:239],v[40:43]
s_waitcnt lgkmcnt(2)
v_fmac_f32 v236,4.0,v237
v_fma_f32 v237,2.0,v113,v238
M v[44:47],a[252:255],v[216:219],v[44:47]
v_fma_f32 v113,s40,v113,v238
v_cvt_pk_bf16_f32 v232,v232,v237
M v[44:47],a[196:199],a[236:239],v[44:47]
v_cvt_pk_bf16_f32 v234,v234,v236
v_accvgpr_read_b32 v238,a18
M v[44:47],a[248:251],a[212:215],v[44:47]
v_accvgpr_read_b32 v233,a114
v_add_f32 v235,v238,v233
M v[48:51],a[248:251],a[236:239],v[48:51]
ds_read_b128 a[192:195],v249 offset:19456
v_sub_f32 v238,v238,v233
M v[48:51],a[196:199],v[216:219],v[48:51]
s_waitcnt lgkmcnt(2)
ds_read_b128 v[224:227],v248 offset:19456
v_add_f32 v233,v18,v114
M v[48:51],a[252:255],a[200:203],v[48:51]
s_waitcnt lgkmcnt(2)
v_sub_f32 v114,v18,v114
v_add_f32 v18,v235,v233
M v[52:55],a[252:255],a[208:211],v[52:55]
v_fmac_f32 v235,4.0,v233
v_fma_f32 v233,2.0,v114,v238
M v[52:55],a[196:199],a[200:203],v[52:55]
v_fma_f32 v114,s40,v114,v238
v_accvgpr_read_b32 v238,a19
M v[52:55],a[248:251],v[216:219],v[52:55]
v_accvgpr_read_b32 v237,a115
v_add_f32 v236,v238,v237
M v[56:59],a[248:251],a[200:203],v[56:59]
v_sub_f32 v238,v238,v237
v_add_f32 v237,v19,v115
M v[56:59],a[196:199],a[208:211],v[56:59]
s_waitcnt lgkmcnt(1)
v_sub_f32 v115,v19,v115
v_add_f32 v19,v236,v237
M v[56:59],a[252:255],a[192:195],v[56:59]
s_waitcnt lgkmcnt(0)
v_fmac_f32 v236,4.0,v237
v_fma_f32 v237,2.0,v115,v238
M v[60:63],a[252:255],v[224:227],v[60:63]
buffer_load_dwordx4 a[112:115],v250,s[20:23],s46 offen offset:2048 sc1
M v[60:63],a[196:199],a[192:195],v[60:63]
s_add_u32 s46,s73,0
v_fma_f32 v115,s40,v115,v238
v_cvt_pk_bf16_f32 v233,v233,v237
M v[60:63],a[248:251],a[208:211],v[60:63]
s_waitcnt vmcnt(14)
buffer_load_dwordx4 a[252:255],v250,s[20:23],s46 offen offset:0 sc1
M v[64:67],a[216:219],a[224:227],v[64:67]
s_waitcnt vmcnt(14)
s_add_u32 s34,s32,6881280
v_cvt_pk_bf16_f32 v235,v235,v236
M v[64:67],a[232:235],a[220:223],v[64:67]
s_waitcnt vmcnt(13)
ds_write2st64_b64 v254,v[232:233],v[234:235] offset0:68 offset1:72
M v[64:67],a[100:103],v[228:231],v[64:67]
v_accvgpr_read_b32 v238,a20
v_accvgpr_read_b32 v232,a116
M v[68:71],a[100:103],a[212:215],v[68:71]
buffer_load_dwordx4 a[196:199],v250,s[20:23],s46 offen offset:1024 sc1
M v[68:71],a[232:235],v[228:231],v[68:71]
v_add_f32 v234,v238,v232
v_sub_f32 v238,v238,v232
M v[68:71],a[216:219],a[220:223],v[68:71]
v_add_f32 v232,v20,v116
v_sub_f32 v116,v20,v116
M v[72:75],a[216:219],v[228:231],v[72:75]
v_add_f32 v20,v234,v232
v_fmac_f32 v234,4.0,v232
M v[72:75],a[232:235],a[212:215],v[72:75]
buffer_load_dwordx4 a[248:251],v250,s[20:23],s46 offen offset:2048 sc1
M v[72:75],a[100:103],a[236:239],v[72:75]
s_add_u32 s46,s74,0
v_fma_f32 v232,2.0,v116,v238
v_fma_f32 v116,s40,v116,v238
M v[76:79],a[100:103],v[216:219],v[76:79]
v_accvgpr_read_b32 v238,a21
v_accvgpr_read_b32 v237,a117
M v[76:79],a[232:235],a[236:239],v[76:79]
v_add_f32 v236,v238,v237
v_sub_f32 v238,v238,v237
M v[76:79],a[216:219],a[212:215],v[76:79]
buffer_store_dwordx4 a[12:15],v253,s[24:27],s34 offen offset:384 nt
M v[80:83],a[216:219],a[236:239],v[80:83]
v_add_f32 v237,v21,v117
v_sub_f32 v117,v21,v117
M v[80:83],a[232:235],v[216:219],v[80:83]
v_add_f32 v21,v236,v237
v_fmac_f32 v236,4.0,v237
M v[80:83],a[100:103],a[200:203],v[80:83]
buffer_load_dwordx4 a[224:227],v250,s[20:23],s46 offen offset:0 sc1
M v[84:87],a[100:103],a[208:211],v[84:87]
v_fma_f32 v237,2.0,v117,v238
v_fma_f32 v117,s40,v117,v238
M v[84:87],a[232:235],a[200:203],v[84:87]
ds_read_b128 a[212:215],v248 offset:26112
v_cvt_pk_bf16_f32 v232,v232,v237
M v[84:87],a[216:219],v[216:219],v[84:87]
ds_read_b128 a[236:239],v249 offset:26112
v_cvt_pk_bf16_f32 v234,v234,v236
M v[88:91],a[216:219],a[200:203],v[88:91]
buffer_load_dwordx4 a[220:223],v250,s[20:23],s46 offen offset:1024 sc1
M v[88:91],a[232:235],a[208:211],v[88:91]
ds_read_b128 v[216:219],v248 offset:26624
ds_read_b128 a[200:203],v249 offset:26624
M v[88:91],a[100:103],a[192:195],v[88:91]
v_accvgpr_read_b32 v238,a22
v_accvgpr_read_b32 v233,a118
M v[92:95],a[100:103],v[224:227],v[92:95]
v_add_f32 v235,v238,v233
v_sub_f32 v238,v238,v233
M v[92:95],a[232:235],a[192:195],v[92:95]
buffer_load_dwordx4 v[228:231],v250,s[20:23],s46 offen offset:2048 sc1
M v[92:95],a[216:219],a[208:211],v[92:95]
s_waitcnt vmcnt(17) lgkmcnt(3)
v_add_f32 v233,v22,v118
v_sub_f32 v118,v22,v118
M v[128:131],a[104:107],a[212:215],v[128:131]
s_waitcnt vmcnt(16) lgkmcnt(2)
ds_read_b128 a[100:103],v248 offset:27136
v_add_f32 v22,v235,v233
M v[128:131],a[240:243],a[236:239],v[128:131]
s_waitcnt vmcnt(15) lgkmcnt(2)
ds_read_b128 v[224:227],v249 offset:27136
v_fmac_f32 v235,4.0,v233
M v[128:131],a[228:231],v[216:219],v[128:131]
s_waitcnt lgkmcnt(2)
v_fma_f32 v233,2.0,v118,v238
v_fma_f32 v118,s40,v118,v238
M v[132:135],a[228:231],a[200:203],v[132:135]
v_accvgpr_read_b32 v238,a23
v_accvgpr_read_b32 v237,a119
M v[132:135],a[240:243],v[216:219],v[132:135]
v_add_f32 v236,v238,v237
v_sub_f32 v238,v238,v237
M v[132:135],a[104:107],a[236:239],v[132:135]
v_add_f32 v237,v23,v119
v_sub_f32 v119,v23,v119
M v[136:139],a[104:107],v[216:219],v[136:139]
ds_read_b128 a[116:119],v248 offset:27648
v_add_f32 v23,v236,v237
M v[136:139],a[240:243],a[200:203],v[136:139]
s_waitcnt lgkmcnt(2)
ds_read_b128 a[192:195],v249 offset:27648
v_fmac_f32 v236,4.0,v237
M v[136:139],a[228:231],a[100:103],v[136:139]
s_waitcnt lgkmcnt(2)
s_add_u32 s46,s75,0
v_fma_f32 v237,2.0,v119,v238
v_fma_f32 v119,s40,v119,v238
M v[140:143],a[228:231],v[224:227],v[140:143]
v_cvt_pk_bf16_f32 v233,v233,v237
v_cvt_pk_bf16_f32 v235,v235,v236
M v[140:143],a[240:243],a[100:103],v[140:143]
ds_write2st64_b64 v254,v[232:233],v[234:235] offset0:76 offset1:80
M v[140:143],a[104:107],a[200:203],v[140:143]
v_accvgpr_read_b32 v238,a24
v_accvgpr_read_b32 v232,a120
M v[144:147],a[104:107],a[100:103],v[144:147]
ds_read_b128 a[232:235],v249 offset:28160
v_add_f32 v234,v238,v232
M v[144:147],a[240:243],v[224:227],v[144:147]
s_waitcnt lgkmcnt(3)
ds_read_b128 a[208:211],v248 offset:28160
v_sub_f32 v238,v238,v232
M v[144:147],a[228:231],a[116:119],v[144:147]
s_waitcnt lgkmcnt(3)
buffer_load_dwordx4 a[216:219],v250,s[20:23],s46 offen offset:0 sc1
M v[148:151],a[228:231],a[192:195],v[148:151]
v_add_f32 v232,v24,v120
v_sub_f32 v120,v24,v120
M v[148:151],a[240:243],a[116:119],v[148:151]
s_waitcnt lgkmcnt(2)
s_barrier
ds_read_b128 a[16:19],v250 offset:34816
M v[148:151],a[104:107],v[224:227],v[148:151]
ds_read_b128 a[20:23],v250 offset:38912
v_add_f32 v24,v234,v232
M v[152:155],a[104:107],a[116:119],v[152:155]
v_fmac_f32 v234,4.0,v232
v_fma_f32 v232,2.0,v120,v238
M v[152:155],a[240:243],a[192:195],v[152:155]
s_waitcnt lgkmcnt(3)
v_fma_f32 v120,s40,v120,v238
v_accvgpr_read_b32 v238,a25
M v[152:155],a[228:231],a[232:235],v[152:155]
s_waitcnt lgkmcnt(2)
v_accvgpr_read_b32 v237,a121
v_add_f32 v236,v238,v237
M v[156:159],a[228:231],a[208:211],v[156:159]
s_add_u32 s34,s32,7077888
buffer_load_dwordx4 a[228:231],v250,s[20:23],s46 offen offset:1024 sc1
M v[156:159],a[240:243],a[232:235],v[156:159]
v_sub_f32 v238,v238,v237
v_add_f32 v237,v25,v121
M v[156:159],a[104:107],a[192:195],v[156:159]
s_waitcnt vmcnt(16) lgkmcnt(1)
buffer_store_dwordx4 a[16:19],v253,s[24:27],s34 offen offset:384 nt
M v[160:163],a[204:207],a[212:215],v[160:163]
s_waitcnt vmcnt(16)
s_add_u32 s34,s32,7274496
v_sub_f32 v121,v25,v121
v_add_f32 v25,v236,v237
M v[160:163],a[244:247],a[236:239],v[160:163]
s_waitcnt vmcnt(15)
v_fmac_f32 v236,4.0,v237
v_fma_f32 v237,2.0,v121,v238
M v[160:163],v[220:223],v[216:219],v[160:163]
s_waitcnt lgkmcnt(0)
buffer_store_dwordx4 a[20:23],v253,s[24:27],s34 offen offset:384 nt
M v[164:167],v[220:223],a[200:203],v[164:167]
v_fma_f32 v121,s40,v121,v238
v_cvt_pk_bf16_f32 v232,v232,v237
M v[164:167],a[244:247],v[216:219],v[164:167]
v_cvt_pk_bf16_f32 v234,v234,v236
v_accvgpr_read_b32 v238,a26
M v[164:167],a[204:207],a[236:239],v[164:167]
buffer_load_dwordx4 a[240:243],v250,s[20:23],s46 offen offset:2048 sc1
M v[168:171],a[204:207],v[216:219],v[168:171]
s_add_u32 s46,s76,0
v_accvgpr_read_b32 v233,a122
v_add_f32 v235,v238,v233
M v[168:171],a[244:247],a[200:203],v[168:171]
v_sub_f32 v238,v238,v233
v_add_f32 v233,v26,v122
M v[168:171],v[220:223],a[100:103],v[168:171]
s_barrier
v_sub_f32 v122,v26,v122
M v[172:175],v[220:223],v[224:227],v[172:175]
buffer_load_dwordx4 a[104:107],v250,s[20:23],s46 offen offset:0 sc1
M v[172:175],a[244:247],a[100:103],v[172:175]
v_add_f32 v26,v235,v233
v_fmac_f32 v235,4.0,v233
M v[172:175],a[204:207],a[200:203],v[172:175]
v_fma_f32 v233,2.0,v122,v238
v_fma_f32 v122,s40,v122,v238
M v[176:179],a[204:207],a[100:103],v[176:179]
v_accvgpr_read_b32 v238,a27
v_accvgpr_read_b32 v237,a123
M v[176:179],a[244:247],v[224:227],v[176:179]
buffer_load_dwordx4 a[212:215],v250,s[20:23],s46 offen offset:1024 sc1
M v[176:179],v[220:223],a[116:119],v[176:179]
v_add_f32 v236,v238,v237
v_sub_f32 v238,v238,v237
M v[180:183],v[220:223],a[192:195],v[180:183]
v_add_f32 v237,v27,v123
v_sub_f32 v123,v27,v123
M v[180:183],a[244:247],a[116:119],v[180:183]
ds_read_b128 a[100:103],v248 offset:52224
v_add_f32 v27,v236,v237
M v[180:183],a[204:207],v[224:227],v[180:183]
buffer_load_dwordx4 a[236:239],v250,s[20:23],s46 offen offset:2048 sc1
M v[184:187],a[204:207],a[116:119],v[184:187]
s_add_u32 s46,s77,0
ds_read_b128 a[120:123],v249 offset:52224
ds_read_b128 a[116:119],v248 offset:52736
M v[184:187],a[244:247],a[192:195],v[184:187]
ds_read_b128 a[200:203],v249 offset:52736
v_fmac_f32 v236,4.0,v237
M v[184:187],v[220:223],a[232:235],v[184:187]
v_fma_f32 v237,2.0,v123,v238
v_fma_f32 v123,s40,v123,v238
M v[188:191],v[220:223],a[208:211],v[188:191]
buffer_load_dwordx4 v[216:219],v250,s[20:23],s46 offen offset:0 sc1
M v[188:191],a[244:247],a[232:235],v[188:191]
v_cvt_pk_bf16_f32 v233,v233,v237
v_cvt_pk_bf16_f32 v235,v235,v236
M v[188:191],a[204:207],a[192:195],v[188:191]
s_waitcnt vmcnt(20) lgkmcnt(3)
ds_write2st64_b64 v254,v[232:233],v[234:235] offset0:85 offset1:89
M v[0:3],a[96:99],a[100:103],v[0:3]
s_waitcnt vmcnt(19) lgkmcnt(3)
ds_read_b128 a[100:103],v248 offset:53248
v_accvgpr_read_b32 v204,a28
M v[0:3],a[108:111],a[120:123],v[0:3]
s_waitcnt vmcnt(16) lgkmcnt(3)
buffer_load_dwordx4 v[224:227],v250,s[20:23],s46 offen offset:1024 sc1
M v[0:3],a[112:115],a[116:119],v[0:3]
s_waitcnt lgkmcnt(2)
ds_read_b128 a[192:195],v249 offset:53248
v_accvgpr_read_b32 v208,a124
M v[4:7],a[112:115],a[200:203],v[4:7]
v_accvgpr_read_b32 v205,a29
v_accvgpr_read_b32 v209,a125
M v[4:7],a[108:111],a[116:119],v[4:7]
v_accvgpr_read_b32 v206,a30
v_accvgpr_read_b32 v210,a126
v_accvgpr_read_b32 v207,a31
v_accvgpr_read_b32 v211,a127
v_pk_add_f32 v[212:213],v[204:205],v[208:209]
v_pk_add_f32 v[214:215],v[206:207],v[210:211]
v_pk_add_f32 v[204:205],v[204:205],v[208:209] neg_lo:[0,1] neg_hi:[0,1]
v_pk_add_f32 v[206:207],v[206:207],v[210:211] neg_lo:[0,1] neg_hi:[0,1]
v_pk_add_f32 v[208:209],v[28:29],v[124:125]
v_pk_add_f32 v[210:211],v[30:31],v[126:127]
v_pk_add_f32 v[124:125],v[28:29],v[124:125] neg_lo:[0,1] neg_hi:[0,1]
v_pk_add_f32 v[126:127],v[30:31],v[126:127] neg_lo:[0,1] neg_hi:[0,1]
v_pk_add_f32 v[28:29],v[212:213],v[208:209]
v_pk_add_f32 v[30:31],v[214:215],v[210:211]
v_pk_fma_f32 v[212:213],v[208:209],4.0,v[212:213] op_sel_hi:[1,0,1]
v_pk_fma_f32 v[214:215],v[210:211],4.0,v[214:215] op_sel_hi:[1,0,1]
v_pk_fma_f32 v[208:209],v[124:125],2.0,v[204:205] op_sel_hi:[1,0,1]
v_pk_fma_f32 v[210:211],v[126:127],2.0,v[206:207] op_sel_hi:[1,0,1]
v_pk_fma_f32 v[124:125],v[124:125],s[40:41],v[204:205] op_sel_hi:[1,0,1]
v_pk_fma_f32 v[126:127],v[126:127],s[40:41],v[206:207] op_sel_hi:[1,0,1]
M v[4:7],a[96:99],a[120:123],v[4:7]
buffer_load_dwordx4 a[208:211],v250,s[20:23],s46 offen offset:2048 sc1
M v[8:11],a[96:99],a[116:119],v[8:11]
s_add_u32 s46,s72,46080
ds_read_b128 a[120:123],v248 offset:53760
v_cvt_pk_bf16_f32 v208,v208,v209
M v[8:11],a[108:111],a[200:203],v[8:11]
s_waitcnt lgkmcnt(2)
buffer_load_dwordx4 v[220:223],v250,s[20:23],s46 offen offset:0 sc1
M v[8:11],a[112:115],a[100:103],v[8:11]
s_waitcnt lgkmcnt(1)
ds_read_b128 a[124:127],v249 offset:53760
v_cvt_pk_bf16_f32 v209,v210,v211
M v[12:15],a[112:115],a[192:195],v[12:15]
v_cvt_pk_bf16_f32 v212,v212,v213
v_cvt_pk_bf16_f32 v213,v214,v215
M v[12:15],a[108:111],a[100:103],v[12:15]
ds_write2st64_b64 v254,v[208:209],v[212:213] offset0:93 offset1:97
M v[12:15],a[96:99],a[200:203],v[12:15]
buffer_load_dwordx4 a[232:235],v250,s[20:23],s46 offen offset:1024 sc1
M v[16:19],a[96:99],a[100:103],v[16:19]
ds_read_b128 a[116:119],v249 offset:54272
v_accvgpr_read_b32 v238,a32
M v[16:19],a[108:111],a[192:195],v[16:19]
s_waitcnt lgkmcnt(3)
ds_read_b128 a[100:103],v248 offset:54272
v_add_u32 v248,0x15400,v248
M v[16:19],a[112:115],a[120:123],v[16:19]
s_waitcnt lgkmcnt(3)
v_add_u32 v249,0x15400,v249
v_accvgpr_read_b32 v232,a128
M v[20:23],a[112:115],a[124:127],v[20:23]
buffer_load_dwordx4 a[244:247],v250,s[20:23],s46 offen offset:2048 sc1
M v[20:23],a[108:111],a[120:123],v[20:23]
s_add_u32 s47,s72,49152
ds_read_b128 a[204:207],v248 offset:0
v_add_f32 v234,v238,v232
M v[20:23],a[96:99],a[192:195],v[20:23]
ds_read_b128 a[200:203],v249 offset:0
v_sub_f32 v238,v238,v232
M v[24:27],a[96:99],a[120:123],v[24:27]
ds_read_b128 a[120:123],v248 offset:512
v_add_f32 v232,v32,v128
M v[24:27],a[108:111],a[124:127],v[24:27]
s_waitcnt lgkmcnt(4)
ds_read_b128 a[192:195],v249 offset:512
v_sub_f32 v128,v32,v128
M v[24:27],a[112:115],a[116:119],v[24:27]
s_waitcnt lgkmcnt(4)
s_barrier
ds_read_b128 a[24:27],v250 offset:43520
M v[28:31],a[112:115],a[100:103],v[28:31]
ds_read_b128 a[28:31],v250 offset:47616
v_add_f32 v32,v234,v232
M v[28:31],a[108:111],a[116:119],v[28:31]
buffer_load_dwordx4 a[100:103],v250,s[20:23],s47 offen offset:0 sc1
M v[28:31],a[96:99],a[124:127],v[28:31]
s_waitcnt vmcnt(21) lgkmcnt(5)
v_fmac_f32 v234,4.0,v232
v_fma_f32 v232,2.0,v128,v238
M v[0:3],a[252:255],a[204:207],v[0:3]
s_waitcnt vmcnt(20) lgkmcnt(4)
buffer_load_dwordx4 a[112:115],v250,s[20:23],s47 offen offset:1024 sc1
M v[0:3],a[196:199],a[200:203],v[0:3]
s_waitcnt vmcnt(20) lgkmcnt(3)
s_add_u32 s34,s32,7471104
ds_read_b128 a[116:119],v248 offset:1024
ds_read_b128 a[96:99],v249 offset:1024
M v[0:3],a[248:251],a[120:123],v[0:3]
s_waitcnt lgkmcnt(4)
v_fma_f32 v128,s40,v128,v238
v_accvgpr_read_b32 v238,a33
M v[4:7],a[248:251],a[192:195],v[4:7]
v_accvgpr_read_b32 v237,a129
v_add_f32 v236,v238,v237
M v[4:7],a[196:199],a[120:123],v[4:7]
buffer_load_dwordx4 a[108:111],v250,s[20:23],s47 offen offset:2048 sc1
M v[4:7],a[252:255],a[200:203],v[4:7]
v_sub_f32 v238,v238,v237
v_add_f32 v237,v33,v129
M v[8:11],a[252:255],a[120:123],v[8:11]
ds_read_b128 a[124:127],v248 offset:1536
v_sub_f32 v129,v33,v129
M v[8:11],a[196:199],a[192:195],v[8:11]
s_waitcnt lgkmcnt(2)
ds_read_b128 a[120:123],v249 offset:1536
v_add_f32 v33,v236,v237
M v[8:11],a[248:251],a[116:119],v[8:11]
s_waitcnt lgkmcnt(2)
buffer_store_dwordx4 a[24:27],v253,s[24:27],s34 offen offset:384 nt
M v[12:15],a[248:251],a[96:99],v[12:15]
s_add_u32 s34,s32,7667712
v_fmac_f32 v236,4.0,v237
v_fma_f32 v237,2.0,v129,v238
M v[12:15],a[196:199],a[116:119],v[12:15]
v_fma_f32 v129,s40,v129,v238
v_cvt_pk_bf16_f32 v232,v232,v237
M v[12:15],a[252:255],a[192:195],v[12:15]
buffer_store_dwordx4 a[28:31],v253,s[24:27],s34 offen offset:384 nt
M v[16:19],a[252:255],a[116:119],v[16:19]
ds_read_b128 a[116:119],v249 offset:2048
v_cvt_pk_bf16_f32 v234,v234,v236
M v[16:19],a[196:199],a[96:99],v[16:19]
s_waitcnt lgkmcnt(2)
ds_read_b128 a[204:207],v248 offset:2048
v_accvgpr_read_b32 v238,a34
M v[16:19],a[248:251],a[124:127],v[16:19]
s_waitcnt lgkmcnt(2)
v_accvgpr_read_b32 v233,a130
v_add_f32 v235,v238,v233
M v[20:23],a[248:251],a[120:123],v[20:23]
s_add_u32 s46,s73,46080
v_sub_f32 v238,v238,v233
v_add_f32 v233,v34,v130
M v[20:23],a[196:199],a[124:127],v[20:23]
ds_read_b128 a[200:203],v248 offset:17408
v_sub_f32 v130,v34,v130
M v[20:23],a[252:255],a[96:99],v[20:23]
ds_read_b128 a[96:99],v249 offset:17408
v_add_f32 v34,v235,v233
M v[24:27],a[252:255],a[124:127],v[24:27]
ds_read_b128 a[124:127],v248 offset:17920
v_fmac_f32 v235,4.0,v233
M v[24:27],a[196:199],a[120:123],v[24:27]
s_waitcnt lgkmcnt(4)
ds_read_b128 a[192:195],v249 offset:17920
v_fma_f32 v233,2.0,v130,v238
M v[24:27],a[248:251],a[116:119],v[24:27]
s_waitcnt lgkmcnt(4)
v_fma_f32 v130,s40,v130,v238
v_accvgpr_read_b32 v238,a35
M v[28:31],a[248:251],a[204:207],v[28:31]
v_accvgpr_read_b32 v237,a131
v_add_f32 v236,v238,v237
M v[28:31],a[196:199],a[116:119],v[28:31]
buffer_load_dwordx4 a[128:131],v250,s[20:23],s46 offen offset:0 sc1
M v[28:31],a[252:255],a[120:123],v[28:31]
s_waitcnt vmcnt(22) lgkmcnt(3)
v_sub_f32 v238,v238,v237
v_add_f32 v237,v35,v131
M v[0:3],a[224:227],a[200:203],v[0:3]
s_waitcnt vmcnt(21) lgkmcnt(2)
buffer_load_dwordx4 a[204:207],v250,s[20:23],s46 offen offset:1024 sc1
M v[0:3],a[220:223],a[96:99],v[0:3]
s_waitcnt vmcnt(21) lgkmcnt(1)
ds_read_b128 a[120:123],v248 offset:18432
ds_read_b128 a[248:251],v249 offset:18432
M v[0:3],v[228:231],a[124:127],v[0:3]
s_waitcnt lgkmcnt(2)
v_sub_f32 v131,v35,v131
v_add_f32 v35,v236,v237
M v[4:7],v[228:231],a[192:195],v[4:7]
v_fmac_f32 v236,4.0,v237
v_fma_f32 v237,2.0,v131,v238
M v[4:7],a[220:223],a[124:127],v[4:7]
buffer_load_dwordx4 a[116:119],v250,s[20:23],s46 offen offset:2048 sc1
M v[4:7],a[224:227],a[96:99],v[4:7]
v_fma_f32 v131,s40,v131,v238
v_cvt_pk_bf16_f32 v233,v233,v237
M v[8:11],a[224:227],a[124:127],v[8:11]
ds_read_b128 a[96:99],v248 offset:18944
v_cvt_pk_bf16_f32 v235,v235,v236
M v[8:11],a[220:223],a[192:195],v[8:11]
s_waitcnt lgkmcnt(2)
ds_read_b128 a[124:127],v249 offset:18944
ds_write2st64_b64 v254,v[232:233],v[234:235] offset0:34 offset1:38
M v[8:11],v[228:231],a[120:123],v[8:11]
s_waitcnt lgkmcnt(3)
v_accvgpr_read_b32 v204,a36
v_accvgpr_read_b32 v208,a132
M v[12:15],v[228:231],a[248:251],v[12:15]
v_accvgpr_read_b32 v205,a37
v_accvgpr_read_b32 v209,a133
M v[12:15],a[220:223],a[120:123],v[12:15]
v_accvgpr_read_b32 v206,a38
v_accvgpr_read_b32 v210,a134
v_accvgpr_read_b32 v207,a39
v_accvgpr_read_b32 v211,a135
v_pk_add_f32 v[212:213],v[204:205],v[208:209]
v_pk_add_f32 v[214:215],v[206:207],v[210:211]
v_pk_add_f32 v[204:205],v[204:205],v[208:209] neg_lo:[0,1] neg_hi:[0,1]
v_pk_add_f32 v[206:207],v[206:207],v[210:211] neg_lo:[0,1] neg_hi:[0,1]
v_pk_add_f32 v[208:209],v[36:37],v[132:133]
v_pk_add_f32 v[210:211],v[38:39],v[134:135]
v_pk_add_f32 v[132:133],v[36:37],v[132:133] neg_lo:[0,1] neg_hi:[0,1]
v_pk_add_f32 v[134:135],v[38:39],v[134:135] neg_lo:[0,1] neg_hi:[0,1]
v_pk_add_f32 v[36:37],v[212:213],v[208:209]
v_pk_add_f32 v[38:39],v[214:215],v[210:211]
v_pk_fma_f32 v[212:213],v[208:209],4.0,v[212:213] op_sel_hi:[1,0,1]
v_pk_fma_f32 v[214:215],v[210:211],4.0,v[214:215] op_sel_hi:[1,0,1]
v_pk_fma_f32 v[208:209],v[132:133],2.0,v[204:205] op_sel_hi:[1,0,1]
v_pk_fma_f32 v[210:211],v[134:135],2.0,v[206:207] op_sel_hi:[1,0,1]
v_pk_fma_f32 v[132:133],v[132:133],s[40:41],v[204:205] op_sel_hi:[1,0,1]
v_pk_fma_f32 v[134:135],v[134:135],s[40:41],v[206:207] op_sel_hi:[1,0,1]
M v[12:15],a[224:227],a[192:195],v[12:15]
v_cvt_pk_bf16_f32 v208,v208,v209
v_cvt_pk_bf16_f32 v209,v210,v211
M v[16:19],a[224:227],a[120:123],v[16:19]
s_add_u32 s47,s73,49152
ds_read_b128 a[132:135],v249 offset:19456
v_cvt_pk_bf16_f32 v212,v212,v213
M v[16:19],a[220:223],a[248:251],v[16:19]
s_waitcnt lgkmcnt(3)
ds_read_b128 a[120:123],v248 offset:19456
v_cvt_pk_bf16_f32 v213,v214,v215
M v[16:19],v[228:231],a[96:99],v[16:19]
s_waitcnt lgkmcnt(3)
ds_write2st64_b64 v254,v[208:209],v[212:213] offset0:42 offset1:46
M v[20:23],v[228:231],a[124:127],v[20:23]
v_accvgpr_read_b32 v204,a40
v_accvgpr_read_b32 v208,a136
M v[20:23],a[220:223],a[96:99],v[20:23]
ds_read_b128 a[196:199],v248 offset:34816
v_accvgpr_read_b32 v205,a41
M v[20:23],a[224:227],a[248:251],v[20:23]
ds_read_b128 a[252:255],v249 offset:34816
v_accvgpr_read_b32 v209,a137
M v[24:27],a[224:227],a[96:99],v[24:27]
buffer_load_dwordx4 a[96:99],v250,s[20:23],s47 offen offset:0 sc1
M v[24:27],a[220:223],a[124:127],v[24:27]
s_waitcnt lgkmcnt(4)
ds_read_b128 a[200:203],v248 offset:35328
ds_read_b128 a[192:195],v249 offset:35328
M v[24:27],v[228:231],a[132:135],v[24:27]
s_waitcnt lgkmcnt(5)
v_accvgpr_read_b32 v206,a42
v_accvgpr_read_b32 v210,a138
v_accvgpr_read_b32 v207,a43
v_accvgpr_read_b32 v211,a139
v_pk_add_f32 v[212:213],v[204:205],v[208:209]
v_pk_add_f32 v[214:215],v[206:207],v[210:211]
v_pk_add_f32 v[204:205],v[204:205],v[208:209] neg_lo:[0,1] neg_hi:[0,1]
v_pk_add_f32 v[206:207],v[206:207],v[210:211] neg_lo:[0,1] neg_hi:[0,1]
v_pk_add_f32 v[208:209],v[40:41],v[136:137]
v_pk_add_f32 v[210:211],v[42:43],v[138:139]
v_pk_add_f32 v[136:137],v[40:41],v[136:137] neg_lo:[0,1] neg_hi:[0,1]
v_pk_add_f32 v[138:139],v[42:43],v[138:139] neg_lo:[0,1] neg_hi:[0,1]
v_pk_add_f32 v[40:41],v[212:213],v[208:209]
v_pk_add_f32 v[42:43],v[214:215],v[210:211]
v_pk_fma_f32 v[212:213],v[208:209],4.0,v[212:213] op_sel_hi:[1,0,1]
v_pk_fma_f32 v[214:215],v[210:211],4.0,v[214:215] op_sel_hi:[1,0,1]
v_pk_fma_f32 v[208:209],v[136:137],2.0,v[204:205] op_sel_hi:[1,0,1]
v_pk_fma_f32 v[210:211],v[138:139],2.0,v[206:207] op_sel_hi:[1,0,1]
v_pk_fma_f32 v[136:137],v[136:137],s[40:41],v[204:205] op_sel_hi:[1,0,1]
v_pk_fma_f32 v[138:139],v[138:139],s[40:41],v[206:207] op_sel_hi:[1,0,1]
M v[28:31],v[228:231],a[120:123],v[28:31]
buffer_load_dwordx4 a[136:139],v250,s[20:23],s47 offen offset:1024 sc1
M v[28:31],a[220:223],a[132:135],v[28:31]
v_cvt_pk_bf16_f32 v208,v208,v209
v_cvt_pk_bf16_f32 v209,v210,v211
M v[28:31],a[224:227],a[124:127],v[28:31]
s_waitcnt vmcnt(23) lgkmcnt(3)
buffer_load_dwordx4 a[120:123],v250,s[20:23],s47 offen offset:2048 sc1
M v[0:3],a[216:219],a[196:199],v[0:3]
s_waitcnt vmcnt(23) lgkmcnt(2)
ds_read_b128 a[132:135],v248 offset:35840
v_cvt_pk_bf16_f32 v212,v212,v213
M v[0:3],a[228:231],a[252:255],v[0:3]
s_waitcnt vmcnt(20) lgkmcnt(2)
ds_read_b128 a[124:127],v249 offset:35840
v_cvt_pk_bf16_f32 v213,v214,v215
M v[0:3],a[240:243],a[200:203],v[0:3]
s_waitcnt lgkmcnt(2)
ds_write2st64_b64 v254,v[208:209],v[212:213] offset0:51 offset1:55
M v[4:7],a[240:243],a[192:195],v[4:7]
v_accvgpr_read_b32 v204,a44
v_accvgpr_read_b32 v208,a140
M v[4:7],a[228:231],a[200:203],v[4:7]
v_accvgpr_read_b32 v205,a45
v_accvgpr_read_b32 v209,a141
M v[4:7],a[216:219],a[252:255],v[4:7]
v_accvgpr_read_b32 v206,a46
v_accvgpr_read_b32 v210,a142
v_accvgpr_read_b32 v207,a47
v_accvgpr_read_b32 v211,a143
v_pk_add_f32 v[212:213],v[204:205],v[208:209]
v_pk_add_f32 v[214:215],v[206:207],v[210:211]
v_pk_add_f32 v[204:205],v[204:205],v[208:209] neg_lo:[0,1] neg_hi:[0,1]
v_pk_add_f32 v[206:207],v[206:207],v[210:211] neg_lo:[0,1] neg_hi:[0,1]
v_pk_add_f32 v[208:209],v[44:45],v[140:141]
v_pk_add_f32 v[210:211],v[46:47],v[142:143]
v_pk_add_f32 v[140:141],v[44:45],v[140:141] neg_lo:[0,1] neg_hi:[0,1]
v_pk_add_f32 v[142:143],v[46:47],v[142:143] neg_lo:[0,1] neg_hi:[0,1]
v_pk_add_f32 v[44:45],v[212:213],v[208:209]
v_pk_add_f32 v[46:47],v[214:215],v[210:211]
v_pk_fma_f32 v[212:213],v[208:209],4.0,v[212:213] op_sel_hi:[1,0,1]
v_pk_fma_f32 v[214:215],v[210:211],4.0,v[214:215] op_sel_hi:[1,0,1]
v_pk_fma_f32 v[208:209],v[140:141],2.0,v[204:205] op_sel_hi:[1,0,1]
v_pk_fma_f32 v[210:211],v[142:143],2.0,v[206:207] op_sel_hi:[1,0,1]
v_pk_fma_f32 v[140:141],v[140:141],s[40:41],v[204:205] op_sel_hi:[1,0,1]
v_pk_fma_f32 v[142:143],v[142:143],s[40:41],v[206:207] op_sel_hi:[1,0,1]
M v[8:11],a[216:219],a[200:203],v[8:11]
ds_read_b128 a[248:251],v248 offset:36352
v_cvt_pk_bf16_f32 v208,v208,v209
M v[8:11],a[228:231],a[192:195],v[8:11]
s_waitcnt lgkmcnt(3)
ds_read_b128 v[228:231],v249 offset:36352
v_cvt_pk_bf16_f32 v209,v210,v211
M v[8:11],a[240:243],a[132:135],v[8:11]
s_waitcnt lgkmcnt(3)
v_cvt_pk_bf16_f32 v212,v212,v213
v_cvt_pk_bf16_f32 v213,v214,v215
M v[12:15],a[240:243],a[124:127],v[12:15]
ds_write2st64_b64 v254,v[208:209],v[212:213] offset0:59 offset1:63
M v[12:15],a[228:231],a[132:135],v[12:15]
v_accvgpr_read_b32 v238,a48
v_accvgpr_read_b32 v232,a144
M v[12:15],a[216:219],a[192:195],v[12:15]
v_add_f32 v234,v238,v232
v_sub_f32 v238,v238,v232
M v[16:19],a[216:219],a[132:135],v[16:19]
s_add_u32 s46,s74,46080
ds_read_b128 a[140:143],v249 offset:36864
v_add_f32 v232,v48,v144
M v[16:19],a[228:231],a[124:127],v[16:19]
s_waitcnt lgkmcnt(3)
ds_read_b128 a[132:135],v248 offset:36864
v_sub_f32 v144,v48,v144
M v[16:19],a[240:243],a[248:251],v[16:19]
s_waitcnt lgkmcnt(2)
s_barrier
ds_read_b128 a[32:35],v250 offset:17408
M v[20:23],a[240:243],v[228:231],v[20:23]
ds_read_b128 a[36:39],v250 offset:21504
ds_read_b128 a[40:43],v250 offset:26112
M v[20:23],a[228:231],a[248:251],v[20:23]
ds_read_b128 a[44:47],v250 offset:30208
ds_read_b128 a[220:223],v248 offset:52224
M v[20:23],a[216:219],a[124:127],v[20:23]
ds_read_b128 a[124:127],v249 offset:52224
v_add_f32 v48,v234,v232
M v[24:27],a[216:219],a[248:251],v[24:27]
buffer_load_dwordx4 a[224:227],v250,s[20:23],s46 offen offset:0 sc1
M v[24:27],a[228:231],v[228:231],v[24:27]
s_waitcnt lgkmcnt(7)
s_add_u32 s34,s32,6291456
ds_read_b128 a[196:199],v248 offset:52736
ds_read_b128 a[200:203],v249 offset:52736
M v[24:27],a[240:243],a[140:143],v[24:27]
s_waitcnt lgkmcnt(7)
buffer_store_dwordx4 a[32:35],v253,s[24:27],s34 offen offset:512 nt
M v[28:31],a[240:243],a[132:135],v[28:31]
s_add_u32 s34,s32,6488064
v_fmac_f32 v234,4.0,v232
v_fma_f32 v232,2.0,v144,v238
M v[28:31],a[228:231],a[140:143],v[28:31]
v_fma_f32 v144,s40,v144,v238
v_accvgpr_read_b32 v238,a49
M v[28:31],a[216:219],v[228:231],v[28:31]
s_waitcnt vmcnt(21) lgkmcnt(3)
buffer_store_dwordx4 a[36:39],v253,s[24:27],s34 offen offset:512 nt
M v[0:3],a[104:107],a[220:223],v[0:3]
s_waitcnt vmcnt(21) lgkmcnt(2)
s_add_u32 s34,s32,6684672
ds_read_b128 a[132:135],v248 offset:53248
v_accvgpr_read_b32 v237,a145
M v[0:3],a[212:215],a[124:127],v[0:3]
s_waitcnt vmcnt(20) lgkmcnt(2)
ds_read_b128 a[140:143],v249 offset:53248
v_add_f32 v236,v238,v237
M v[0:3],a[236:239],a[196:199],v[0:3]
s_waitcnt lgkmcnt(2)
buffer_store_dwordx4 a[40:43],v253,s[24:27],s34 offen offset:512 nt
M v[4:7],a[236:239],a[200:203],v[4:7]
v_sub_f32 v238,v238,v237
v_add_f32 v237,v49,v145
M v[4:7],a[212:215],a[196:199],v[4:7]
v_sub_f32 v145,v49,v145
v_add_f32 v49,v236,v237
M v[4:7],a[104:107],a[124:127],v[4:7]
buffer_load_dwordx4 a[252:255],v250,s[20:23],s46 offen offset:1024 sc1
M v[8:11],a[104:107],a[196:199],v[8:11]
ds_read_b128 a[124:127],v248 offset:53760
v_fmac_f32 v236,4.0,v237
M v[8:11],a[212:215],a[200:203],v[8:11]
s_waitcnt lgkmcnt(2)
ds_read_b128 a[248:251],v249 offset:53760
v_fma_f32 v237,2.0,v145,v238
M v[8:11],a[236:239],a[132:135],v[8:11]
s_waitcnt lgkmcnt(2)
v_fma_f32 v145,s40,v145,v238
v_cvt_pk_bf16_f32 v232,v232,v237
M v[12:15],a[236:239],a[140:143],v[12:15]
s_add_u32 s34,s32,6881280
buffer_load_dwordx4 a[192:195],v250,s[20:23],s46 offen offset:2048 sc1
M v[12:15],a[212:215],a[132:135],v[12:15]
v_cvt_pk_bf16_f32 v234,v234,v236
v_accvgpr_read_b32 v238,a50
M v[12:15],a[104:107],a[200:203],v[12:15]
v_accvgpr_read_b32 v233,a146
v_add_f32 v235,v238,v233
M v[16:19],a[104:107],a[132:135],v[16:19]
s_add_u32 s47,s74,49152
ds_read_b128 a[132:135],v249 offset:54272
v_sub_f32 v238,v238,v233
M v[16:19],a[212:215],a[140:143],v[16:19]
s_waitcnt lgkmcnt(2)
ds_read_b128 a[240:243],v248 offset:54272
v_add_u32 v248,0xffff9a00,v248
M v[16:19],a[236:239],a[124:127],v[16:19]
s_waitcnt lgkmcnt(2)
buffer_store_dwordx4 a[44:47],v253,s[24:27],s34 offen offset:512 nt
M v[20:23],a[236:239],a[248:251],v[20:23]
v_add_u32 v249,0xffff9a00,v249
v_add_f32 v233,v50,v146
M v[20:23],a[212:215],a[124:127],v[20:23]
ds_read_b128 a[228:231],v248 offset:8704
v_sub_f32 v146,v50,v146
M v[20:23],a[104:107],a[140:143],v[20:23]
ds_read_b128 a[140:143],v249 offset:8704
v_add_f32 v50,v235,v233
M v[24:27],a[104:107],a[124:127],v[24:27]
buffer_load_dwordx4 a[124:127],v250,s[20:23],s47 offen offset:0 sc1
M v[24:27],a[212:215],a[248:251],v[24:27]
s_waitcnt lgkmcnt(3)
ds_read_b128 a[216:219],v248 offset:9216
ds_read_b128 a[220:223],v249 offset:9216
M v[24:27],a[236:239],a[132:135],v[24:27]
s_waitcnt lgkmcnt(4)
buffer_load_dwordx4 v[228:231],v250,s[20:23],s47 offen offset:1024 sc1
M v[28:31],a[236:239],a[240:243],v[28:31]
v_fmac_f32 v235,4.0,v233
v_fma_f32 v233,2.0,v146,v238
M v[28:31],a[212:215],a[132:135],v[28:31]
v_fma_f32 v146,s40,v146,v238
v_accvgpr_read_b32 v238,a51
M v[28:31],a[104:107],a[248:251],v[28:31]
s_waitcnt vmcnt(25) lgkmcnt(3)
v_accvgpr_read_b32 v237,a147
v_add_f32 v236,v238,v237
M v[0:3],v[216:219],a[228:231],v[0:3]
s_waitcnt vmcnt(24) lgkmcnt(2)
buffer_load_dwordx4 a[196:199],v250,s[20:23],s47 offen offset:2048 sc1
M v[0:3],v[224:227],a[140:143],v[0:3]
s_waitcnt vmcnt(24) lgkmcnt(1)
ds_read_b128 a[132:135],v248 offset:9728
ds_read_b128 a[104:107],v249 offset:9728
M v[0:3],a[208:211],a[216:219],v[0:3]
s_waitcnt lgkmcnt(2)
v_sub_f32 v238,v238,v237
v_add_f32 v237,v51,v147
M v[4:7],a[208:211],a[220:223],v[4:7]
v_sub_f32 v147,v51,v147
v_add_f32 v51,v236,v237
M v[4:7],v[224:227],a[216:219],v[4:7]
v_fmac_f32 v236,4.0,v237
v_fma_f32 v237,2.0,v147,v238
M v[4:7],v[216:219],a[140:143],v[4:7]
v_fma_f32 v147,s40,v147,v238
v_cvt_pk_bf16_f32 v233,v233,v237
M v[8:11],v[216:219],a[216:219],v[8:11]
ds_read_b128 a[144:147],v248 offset:10240
v_cvt_pk_bf16_f32 v235,v235,v236
M v[8:11],v[224:227],a[220:223],v[8:11]
s_waitcnt lgkmcnt(2)
ds_read_b128 a[140:143],v249 offset:10240
ds_write2st64_b64 v254,v[232:233],v[234:235] offset0:17 offset1:21
M v[8:11],a[208:211],a[132:135],v[8:11]
s_waitcnt lgkmcnt(3)
v_accvgpr_read_b32 v204,a52
v_accvgpr_read_b32 v208,a148
M v[12:15],a[208:211],a[104:107],v[12:15]
v_accvgpr_read_b32 v205,a53
v_accvgpr_read_b32 v209,a149
M v[12:15],v[224:227],a[132:135],v[12:15]
v_accvgpr_read_b32 v206,a54
v_accvgpr_read_b32 v210,a150
v_accvgpr_read_b32 v207,a55
v_accvgpr_read_b32 v211,a151
v_pk_add_f32 v[212:213],v[204:205],v[208:209]
v_pk_add_f32 v[214:215],v[206:207],v[210:211]
v_pk_add_f32 v[204:205],v[204:205],v[208:209] neg_lo:[0,1] neg_hi:[0,1]
v_pk_add_f32 v[206:207],v[206:207],v[210:211] neg_lo:[0,1] neg_hi:[0,1]
v_pk_add_f32 v[208:209],v[52:53],v[148:149]
v_pk_add_f32 v[210:211],v[54:55],v[150:151]
v_pk_add_f32 v[148:149],v[52:53],v[148:149] neg_lo:[0,1] neg_hi:[0,1]
v_pk_add_f32 v[150:151],v[54:55],v[150:151] neg_lo:[0,1] neg_hi:[0,1]
v_pk_add_f32 v[52:53],v[212:213],v[208:209]
v_pk_add_f32 v[54:55],v[214:215],v[210:211]
v_pk_fma_f32 v[212:213],v[208:209],4.0,v[212:213] op_sel_hi:[1,0,1]
v_pk_fma_f32 v[214:215],v[210:211],4.0,v[214:215] op_sel_hi:[1,0,1]
v_pk_fma_f32 v[208:209],v[148:149],2.0,v[204:205] op_sel_hi:[1,0,1]
v_pk_fma_f32 v[210:211],v[150:151],2.0,v[206:207] op_sel_hi:[1,0,1]
v_pk_fma_f32 v[148:149],v[148:149],s[40:41],v[204:205] op_sel_hi:[1,0,1]
v_pk_fma_f32 v[150:151],v[150:151],s[40:41],v[206:207] op_sel_hi:[1,0,1]
M v[12:15],v[216:219],a[220:223],v[12:15]
v_cvt_pk_bf16_f32 v208,v208,v209
v_cvt_pk_bf16_f32 v209,v210,v211
M v[16:19],v[216:219],a[132:135],v[16:19]
s_add_u32 s46,s75,46080
ds_read_b128 a[132:135],v249 offset:10752
v_cvt_pk_bf16_f32 v212,v212,v213
M v[16:19],v[224:227],a[104:107],v[16:19]
s_waitcnt lgkmcnt(3)
ds_read_b128 a[200:203],v248 offset:10752
v_cvt_pk_bf16_f32 v213,v214,v215
M v[16:19],a[208:211],a[144:147],v[16:19]
s_waitcnt lgkmcnt(3)
ds_write2st64_b64 v254,v[208:209],v[212:213] offset0:25 offset1:29
M v[20:23],a[208:211],a[140:143],v[20:23]
v_accvgpr_read_b32 v204,a56
v_accvgpr_read_b32 v208,a152
M v[20:23],v[224:227],a[144:147],v[20:23]
ds_read_b128 a[148:151],v248 offset:0
v_accvgpr_read_b32 v205,a57
M v[20:23],v[216:219],a[104:107],v[20:23]
ds_read_b128 a[104:107],v249 offset:0
v_accvgpr_read_b32 v209,a153
M v[24:27],v[216:219],a[144:147],v[24:27]
buffer_load_dwordx4 a[144:147],v250,s[20:23],s46 offen offset:0 sc1
M v[24:27],v[224:227],a[140:143],v[24:27]
s_waitcnt lgkmcnt(4)
ds_read_b128 a[236:239],v248 offset:512
ds_read_b128 a[212:215],v249 offset:512
M v[24:27],a[208:211],a[132:135],v[24:27]
s_waitcnt lgkmcnt(5)
buffer_load_dwordx4 a[240:243],v250,s[20:23],s46 offen offset:1024 sc1
M v[28:31],a[208:211],a[200:203],v[28:31]
v_accvgpr_read_b32 v206,a58
v_accvgpr_read_b32 v210,a154
v_accvgpr_read_b32 v207,a59
v_accvgpr_read_b32 v211,a155
v_pk_add_f32 v[212:213],v[204:205],v[208:209]
v_pk_add_f32 v[214:215],v[206:207],v[210:211]
v_pk_add_f32 v[204:205],v[204:205],v[208:209] neg_lo:[0,1] neg_hi:[0,1]
v_pk_add_f32 v[206:207],v[206:207],v[210:211] neg_lo:[0,1] neg_hi:[0,1]
v_pk_add_f32 v[208:209],v[56:57],v[152:153]
v_pk_add_f32 v[210:211],v[58:59],v[154:155]
v_pk_add_f32 v[152:153],v[56:57],v[152:153] neg_lo:[0,1] neg_hi:[0,1]
v_pk_add_f32 v[154:155],v[58:59],v[154:155] neg_lo:[0,1] neg_hi:[0,1]
v_pk_add_f32 v[56:57],v[212:213],v[208:209]
v_pk_add_f32 v[58:59],v[214:215],v[210:211]
v_pk_fma_f32 v[212:213],v[208:209],4.0,v[212:213] op_sel_hi:[1,0,1]
v_pk_fma_f32 v[214:215],v[210:211],4.0,v[214:215] op_sel_hi:[1,0,1]
v_pk_fma_f32 v[208:209],v[152:153],2.0,v[204:205] op_sel_hi:[1,0,1]
v_pk_fma_f32 v[210:211],v[154:155],2.0,v[206:207] op_sel_hi:[1,0,1]
v_pk_fma_f32 v[152:153],v[152:153],s[40:41],v[204:205] op_sel_hi:[1,0,1]
v_pk_fma_f32 v[154:155],v[154:155],s[40:41],v[206:207] op_sel_hi:[1,0,1]
M v[28:31],v[224:227],a[132:135],v[28:31]
buffer_load_dwordx4 a[248:251],v250,s[20:23],s46 offen offset:2048 sc1
M v[28:31],v[216:219],a[140:143],v[28:31]
s_waitcnt vmcnt(26) lgkmcnt(3)
v_cvt_pk_bf16_f32 v208,v208,v209
v_cvt_pk_bf16_f32 v209,v210,v211
M v[96:99],v[220:223],a[148:151],v[96:99]
s_waitcnt vmcnt(25) lgkmcnt(2)
ds_read_b128 a[132:135],v248 offset:1024
v_cvt_pk_bf16_f32 v212,v212,v213
M v[96:99],a[232:235],a[104:107],v[96:99]
s_waitcnt vmcnt(24) lgkmcnt(2)
ds_read_b128 a[140:143],v249 offset:1024
v_cvt_pk_bf16_f32 v213,v214,v215
M v[96:99],a[244:247],a[236:239],v[96:99]
s_waitcnt lgkmcnt(2)
ds_write2st64_b64 v254,v[208:209],v[212:213] offset0:68 offset1:72
M v[100:103],a[244:247],a[212:215],v[100:103]
v_accvgpr_read_b32 v204,a60
v_accvgpr_read_b32 v208,a156
M v[100:103],a[232:235],a[236:239],v[100:103]
v_accvgpr_read_b32 v205,a61
v_accvgpr_read_b32 v209,a157
M v[100:103],v[220:223],a[104:107],v[100:103]
v_accvgpr_read_b32 v206,a62
v_accvgpr_read_b32 v210,a158
v_accvgpr_read_b32 v207,a63
v_accvgpr_read_b32 v211,a159
v_pk_add_f32 v[212:213],v[204:205],v[208:209]
v_pk_add_f32 v[214:215],v[206:207],v[210:211]
v_pk_add_f32 v[204:205],v[204:205],v[208:209] neg_lo:[0,1] neg_hi:[0,1]
v_pk_add_f32 v[206:207],v[206:207],v[210:211] neg_lo:[0,1] neg_hi:[0,1]
v_pk_add_f32 v[208:209],v[60:61],v[156:157]
v_pk_add_f32 v[210:211],v[62:63],v[158:159]
v_pk_add_f32 v[156:157],v[60:61],v[156:157] neg_lo:[0,1] neg_hi:[0,1]
v_pk_add_f32 v[158:159],v[62:63],v[158:159] neg_lo:[0,1] neg_hi:[0,1]
v_pk_add_f32 v[60:61],v[212:213],v[208:209]
v_pk_add_f32 v[62:63],v[214:215],v[210:211]
v_pk_fma_f32 v[212:213],v[208:209],4.0,v[212:213] op_sel_hi:[1,0,1]
v_pk_fma_f32 v[214:215],v[210:211],4.0,v[214:215] op_sel_hi:[1,0,1]
v_pk_fma_f32 v[208:209],v[156:157],2.0,v[204:205] op_sel_hi:[1,0,1]
v_pk_fma_f32 v[210:211],v[158:159],2.0,v[206:207] op_sel_hi:[1,0,1]
v_pk_fma_f32 v[156:157],v[156:157],s[40:41],v[204:205] op_sel_hi:[1,0,1]
v_pk_fma_f32 v[158:159],v[158:159],s[40:41],v[206:207] op_sel_hi:[1,0,1]
M v[104:107],v[220:223],a[236:239],v[104:107]
ds_read_b128 a[152:155],v248 offset:1536
v_cvt_pk_bf16_f32 v208,v208,v209
M v[104:107],a[232:235],a[212:215],v[104:107]
s_waitcnt lgkmcnt(3)
ds_read_b128 a[228:231],v249 offset:1536
v_cvt_pk_bf16_f32 v209,v210,v211
M v[104:107],a[244:247],a[132:135],v[104:107]
s_waitcnt lgkmcnt(3)
v_cvt_pk_bf16_f32 v212,v212,v213
v_cvt_pk_bf16_f32 v213,v214,v215
M v[108:111],a[244:247],a[140:143],v[108:111]
ds_write2st64_b64 v254,v[208:209],v[212:213] offset0:76 offset1:80
M v[108:111],a[232:235],a[132:135],v[108:111]
v_cvt_pk_bf16_f32 v0,v0,v1
v_cvt_pk_bf16_f32 v1,v2,v3
M v[108:111],v[220:223],a[212:215],v[108:111]
v_cvt_pk_bf16_f32 v4,v4,v5
v_cvt_pk_bf16_f32 v5,v6,v7
M v[112:115],v[220:223],a[132:135],v[112:115]
s_waitcnt lgkmcnt(0)
s_barrier
ds_read_b128 a[48:51],v250 offset:8704
M v[112:115],a[232:235],a[140:143],v[112:115]
ds_read_b128 a[52:55],v250 offset:12800
ds_read_b128 a[56:59],v250 offset:34816
M v[112:115],a[244:247],a[152:155],v[112:115]
ds_read_b128 a[60:63],v250 offset:38912
ds_read_b128 a[156:159],v249 offset:2048
M v[116:119],a[244:247],a[228:231],v[116:119]
ds_read_b128 a[216:219],v248 offset:2048
ds_write2st64_b64 v254,v[0:1],v[4:5] offset0:34 offset1:38
M v[116:119],a[232:235],a[152:155],v[116:119]
v_cvt_pk_bf16_f32 v8,v8,v9
v_cvt_pk_bf16_f32 v9,v10,v11
M v[116:119],v[220:223],a[140:143],v[116:119]
s_waitcnt lgkmcnt(6)
s_add_u32 s34,s32,7077888
buffer_store_dwordx4 a[48:51],v253,s[24:27],s34 offen offset:512 nt
M v[120:123],v[220:223],a[152:155],v[120:123]
s_add_u32 s34,s32,7274496
global_load_dword a220,v250,s[64:65]
M v[120:123],a[232:235],a[228:231],v[120:123]
s_waitcnt lgkmcnt(2)
s_add_u32 s47,s75,49152
v_cvt_pk_bf16_f32 v12,v12,v13
v_cvt_pk_bf16_f32 v13,v14,v15
M v[120:123],a[244:247],a[156:159],v[120:123]
s_waitcnt lgkmcnt(1)
buffer_store_dwordx4 a[52:55],v253,s[24:27],s34 offen offset:512 nt
M v[124:127],a[244:247],a[216:219],v[124:127]
ds_write2st64_b64 v254,v[8:9],v[12:13] offset0:42 offset1:46
M v[124:127],a[232:235],a[156:159],v[124:127]
v_cvt_pk_bf16_f32 v16,v16,v17
v_cvt_pk_bf16_f32 v17,v18,v19
M v[124:127],v[220:223],a[228:231],v[124:127]
s_waitcnt vmcnt(26)
buffer_load_dwordx4 a[220:223],v250,s[20:23],s47 offen offset:0 sc1
M v[128:131],a[100:103],a[148:151],v[128:131]
s_waitcnt vmcnt(26)
v_cvt_pk_bf16_f32 v20,v20,v21
v_cvt_pk_bf16_f32 v21,v22,v23
M v[128:131],a[112:115],a[104:107],v[128:131]
s_waitcnt vmcnt(25)
ds_write2st64_b64 v254,v[16:17],v[20:21] offset0:51 offset1:55
M v[128:131],a[108:111],a[236:239],v[128:131]
buffer_load_dwordx4 a[200:203],v250,s[20:23],s47 offen offset:1024 sc1
M v[132:135],a[108:111],a[212:215],v[132:135]
s_add_u32 s34,s32,7471104
v_cvt_pk_bf16_f32 v24,v24,v25
v_cvt_pk_bf16_f32 v25,v26,v27
M v[132:135],a[112:115],a[236:239],v[132:135]
v_cvt_pk_bf16_f32 v28,v28,v29
v_cvt_pk_bf16_f32 v29,v30,v31
M v[132:135],a[100:103],a[104:107],v[132:135]
ds_write2st64_b64 v254,v[24:25],v[28:29] offset0:59 offset1:63
M v[136:139],a[100:103],a[236:239],v[136:139]
buffer_load_dwordx4 a[208:211],v250,s[20:23],s47 offen offset:2048 sc1
M v[136:139],a[112:115],a[212:215],v[136:139]
v_accvgpr_read_b32 v238,a64
v_accvgpr_read_b32 v232,a160
M v[136:139],a[108:111],a[132:135],v[136:139]
v_add_f32 v234,v238,v232
v_sub_f32 v238,v238,v232
M v[140:143],a[108:111],a[140:143],v[140:143]
v_add_f32 v232,v64,v160
v_sub_f32 v160,v64,v160
M v[140:143],a[112:115],a[132:135],v[140:143]
v_add_f32 v64,v234,v232
v_fmac_f32 v234,4.0,v232
M v[140:143],a[100:103],a[212:215],v[140:143]
buffer_store_dwordx4 a[56:59],v253,s[24:27],s34 offen offset:512 nt
M v[144:147],a[100:103],a[132:135],v[144:147]
s_add_u32 s46,s76,46080
v_fma_f32 v232,2.0,v160,v238
v_fma_f32 v160,s40,v160,v238
M v[144:147],a[112:115],a[140:143],v[144:147]
v_accvgpr_read_b32 v238,a65
v_accvgpr_read_b32 v237,a161
M v[144:147],a[108:111],a[152:155],v[144:147]
v_add_f32 v236,v238,v237
v_sub_f32 v238,v238,v237
M v[148:151],a[108:111],a[228:231],v[148:151]
v_add_f32 v237,v65,v161
v_sub_f32 v161,v65,v161
M v[148:151],a[112:115],a[152:155],v[148:151]
ds_read_b128 a[148:151],v248 offset:34816
v_add_f32 v65,v236,v237
M v[148:151],a[100:103],a[140:143],v[148:151]
ds_read_b128 a[104:107],v249 offset:34816
v_fmac_f32 v236,4.0,v237
M v[152:155],a[100:103],a[152:155],v[152:155]
buffer_load_dwordx4 a[132:135],v250,s[20:23],s46 offen offset:0 sc1
M v[152:155],a[112:115],a[228:231],v[152:155]
ds_read_b128 a[140:143],v248 offset:35328
ds_read_b128 v[224:227],v249 offset:35328
M v[152:155],a[108:111],a[156:159],v[152:155]
buffer_load_dwordx4 a[152:155],v250,s[20:23],s46 offen offset:1024 sc1
M v[156:159],a[108:111],a[216:219],v[156:159]
v_fma_f32 v237,2.0,v161,v238
v_fma_f32 v161,s40,v161,v238
M v[156:159],a[112:115],a[156:159],v[156:159]
v_cvt_pk_bf16_f32 v232,v232,v237
v_cvt_pk_bf16_f32 v234,v234,v236
M v[156:159],a[100:103],a[228:231],v[156:159]
s_waitcnt vmcnt(27) lgkmcnt(3)
v_accvgpr_read_b32 v238,a66
v_accvgpr_read_b32 v233,a162
M v[96:99],a[128:131],a[148:151],v[96:99]
s_waitcnt vmcnt(26) lgkmcnt(2)
buffer_load_dwordx4 v[216:219],v250,s[20:23],s46 offen offset:2048 sc1
M v[96:99],a[204:207],a[104:107],v[96:99]
s_waitcnt vmcnt(26) lgkmcnt(1)
s_add_u32 s34,s32,7667712
ds_read_b128 a[108:111],v248 offset:35840
ds_read_b128 a[112:115],v249 offset:35840
M v[96:99],a[116:119],a[140:143],v[96:99]
s_waitcnt lgkmcnt(2)
v_add_f32 v235,v238,v233
v_sub_f32 v238,v238,v233
M v[100:103],a[116:119],v[224:227],v[100:103]
v_add_f32 v233,v66,v162
v_sub_f32 v162,v66,v162
M v[100:103],a[204:207],a[140:143],v[100:103]
v_add_f32 v66,v235,v233
v_fmac_f32 v235,4.0,v233
M v[100:103],a[128:131],a[104:107],v[100:103]
buffer_store_dwordx4 a[60:63],v253,s[24:27],s34 offen offset:512 nt
M v[104:107],a[128:131],a[140:143],v[104:107]
ds_read_b128 a[156:159],v248 offset:36352
v_fma_f32 v233,2.0,v162,v238
M v[104:107],a[204:207],v[224:227],v[104:107]
s_waitcnt lgkmcnt(2)
ds_read_b128 a[100:103],v249 offset:36352
v_fma_f32 v162,s40,v162,v238
M v[104:107],a[116:119],a[108:111],v[104:107]
s_waitcnt lgkmcnt(2)
v_accvgpr_read_b32 v238,a67
v_accvgpr_read_b32 v237,a163
M v[108:111],a[116:119],a[112:115],v[108:111]
v_add_f32 v236,v238,v237
v_sub_f32 v238,v238,v237
M v[108:111],a[204:207],a[108:111],v[108:111]
v_add_f32 v237,v67,v163
v_sub_f32 v163,v67,v163
M v[108:111],a[128:131],v[224:227],v[108:111]
v_add_f32 v67,v236,v237
v_fmac_f32 v236,4.0,v237
M v[112:115],a[128:131],a[108:111],v[112:115]
s_add_u32 s47,s76,49152
ds_read_b128 a[160:163],v249 offset:36864
v_fma_f32 v237,2.0,v163,v238
M v[112:115],a[204:207],a[112:115],v[112:115]
s_waitcnt lgkmcnt(2)
ds_read_b128 a[244:247],v248 offset:36864
v_fma_f32 v163,s40,v163,v238
M v[112:115],a[116:119],a[156:159],v[112:115]
s_waitcnt lgkmcnt(2)
v_cvt_pk_bf16_f32 v233,v233,v237
v_cvt_pk_bf16_f32 v235,v235,v236
M v[116:119],a[116:119],a[100:103],v[116:119]
ds_write2st64_b64 v254,v[232:233],v[234:235] offset0:0 offset1:4
M v[116:119],a[204:207],a[156:159],v[116:119]
v_accvgpr_read_b32 v238,a68
v_accvgpr_read_b32 v232,a164
M v[116:119],a[128:131],a[112:115],v[116:119]
v_add_f32 v234,v238,v232
v_sub_f32 v238,v238,v232
M v[120:123],a[128:131],a[156:159],v[120:123]
buffer_load_dwordx4 a[232:235],v250,s[20:23],s47 offen offset:0 sc1
M v[120:123],a[204:207],a[100:103],v[120:123]
s_waitcnt lgkmcnt(2)
v_add_f32 v232,v68,v164
v_sub_f32 v164,v68,v164
M v[120:123],a[116:119],a[160:163],v[120:123]
s_waitcnt lgkmcnt(1)
buffer_load_dwordx4 v[220:223],v250,s[20:23],s47 offen offset:1024 sc1
M v[124:127],a[116:119],a[244:247],v[124:127]
v_add_f32 v68,v234,v232
v_fmac_f32 v234,4.0,v232
M v[124:127],a[204:207],a[160:163],v[124:127]
v_fma_f32 v232,2.0,v164,v238
v_fma_f32 v164,s40,v164,v238
M v[124:127],a[128:131],a[100:103],v[124:127]
s_waitcnt vmcnt(28)
v_accvgpr_read_b32 v238,a69
v_accvgpr_read_b32 v237,a165
M v[128:131],a[96:99],a[148:151],v[128:131]
s_waitcnt vmcnt(27)
buffer_load_dwordx4 a[236:239],v250,s[20:23],s47 offen offset:2048 sc1
M v[128:131],a[136:139],a[104:107],v[128:131]
s_waitcnt vmcnt(27)
v_add_f32 v236,v238,v237
v_sub_f32 v238,v238,v237
M v[128:131],a[120:123],a[140:143],v[128:131]
v_add_f32 v237,v69,v165
v_sub_f32 v165,v69,v165
M v[132:135],a[120:123],v[224:227],v[132:135]
v_add_f32 v69,v236,v237
v_fmac_f32 v236,4.0,v237
M v[132:135],a[136:139],a[140:143],v[132:135]
v_fma_f32 v237,2.0,v165,v238
v_fma_f32 v165,s40,v165,v238
M v[132:135],a[96:99],a[104:107],v[132:135]
v_cvt_pk_bf16_f32 v232,v232,v237
v_cvt_pk_bf16_f32 v234,v234,v236
M v[136:139],a[96:99],a[140:143],v[136:139]
v_accvgpr_read_b32 v238,a70
v_accvgpr_read_b32 v233,a166
M v[136:139],a[136:139],v[224:227],v[136:139]
v_add_f32 v235,v238,v233
v_sub_f32 v238,v238,v233
M v[136:139],a[120:123],a[108:111],v[136:139]
v_add_f32 v233,v70,v166
v_sub_f32 v166,v70,v166
M v[140:143],a[120:123],a[112:115],v[140:143]
v_add_f32 v70,v235,v233
v_fmac_f32 v235,4.0,v233
M v[140:143],a[136:139],a[108:111],v[140:143]
v_fma_f32 v233,2.0,v166,v238
v_fma_f32 v166,s40,v166,v238
M v[140:143],a[96:99],v[224:227],v[140:143]
v_accvgpr_read_b32 v238,a71
v_accvgpr_read_b32 v237,a167
M v[144:147],a[96:99],a[108:111],v[144:147]
s_add_u32 s46,s77,46080
v_add_f32 v236,v238,v237
v_sub_f32 v238,v238,v237
M v[144:147],a[136:139],a[112:115],v[144:147]
v_add_f32 v237,v71,v167
v_sub_f32 v167,v71,v167
M v[144:147],a[120:123],a[156:159],v[144:147]
v_add_f32 v71,v236,v237
v_fmac_f32 v236,4.0,v237
M v[148:151],a[120:123],a[100:103],v[148:151]
v_fma_f32 v237,2.0,v167,v238
v_fma_f32 v167,s40,v167,v238
M v[148:151],a[136:139],a[156:159],v[148:151]
ds_read_b128 a[116:119],v248 offset:52224
v_cvt_pk_bf16_f32 v233,v233,v237
M v[148:151],a[96:99],a[112:115],v[148:151]
ds_read_b128 a[128:131],v249 offset:52224
v_cvt_pk_bf16_f32 v235,v235,v236
M v[152:155],a[96:99],a[156:159],v[152:155]
buffer_load_dwordx4 a[148:151],v250,s[20:23],s46 offen offset:0 sc1
M v[152:155],a[136:139],a[100:103],v[152:155]
ds_read_b128 a[104:107],v248 offset:52736
ds_read_b128 a[108:111],v249 offset:52736
M v[152:155],a[120:123],a[160:163],v[152:155]
buffer_load_dwordx4 a[140:143],v250,s[20:23],s46 offen offset:1024 sc1
M v[156:159],a[120:123],a[244:247],v[156:159]
ds_write2st64_b64 v254,v[232:233],v[234:235] offset0:8 offset1:12
M v[156:159],a[136:139],a[160:163],v[156:159]
v_accvgpr_read_b32 v238,a72
v_accvgpr_read_b32 v232,a168
M v[156:159],a[96:99],a[100:103],v[156:159]
s_waitcnt vmcnt(28) lgkmcnt(4)
v_add_f32 v234,v238,v232
v_sub_f32 v238,v238,v232
M v[96:99],a[224:227],a[116:119],v[96:99]
s_waitcnt vmcnt(24) lgkmcnt(3)
buffer_load_dwordx4 a[164:167],v250,s[20:23],s46 offen offset:2048 sc1
M v[96:99],a[252:255],a[128:131],v[96:99]
s_waitcnt vmcnt(24) lgkmcnt(2)
ds_read_b128 a[112:115],v248 offset:53248
ds_read_b128 a[156:159],v249 offset:53248
M v[96:99],a[192:195],a[104:107],v[96:99]
s_waitcnt lgkmcnt(3)
v_add_f32 v232,v72,v168
v_sub_f32 v168,v72,v168
M v[100:103],a[192:195],a[108:111],v[100:103]
s_waitcnt lgkmcnt(2)
s_barrier
ds_read_b128 v[0:3],v250 offset:17408
M v[100:103],a[252:255],a[104:107],v[100:103]
ds_read_b128 v[8:11],v250 offset:21504
ds_read_b128 v[16:19],v250 offset:26112
M v[100:103],a[224:227],a[128:131],v[100:103]
ds_read_b128 v[24:27],v250 offset:30208
ds_read_b128 a[64:67],v250 offset:0
M v[104:107],a[224:227],a[104:107],v[104:107]
ds_read_b128 a[68:71],v250 offset:4096
ds_read_b128 a[120:123],v248 offset:53760
M v[104:107],a[252:255],a[108:111],v[104:107]
s_waitcnt lgkmcnt(8)
ds_read_b128 a[136:139],v249 offset:53760
v_add_f32 v72,v234,v232
M v[104:107],a[192:195],a[112:115],v[104:107]
s_waitcnt lgkmcnt(7)
s_add_u32 s34,s33,6291456
buffer_store_dwordx4 v[0:3],v253,s[24:27],s34 offen offset:0 nt
M v[108:111],a[192:195],a[156:159],v[108:111]
s_add_u32 s34,s33,6684672
v_fmac_f32 v234,4.0,v232
v_fma_f32 v232,2.0,v168,v238
M v[108:111],a[252:255],a[112:115],v[108:111]
v_fma_f32 v168,s40,v168,v238
v_accvgpr_read_b32 v238,a73
M v[108:111],a[224:227],a[108:111],v[108:111]
s_waitcnt lgkmcnt(6)
buffer_store_dwordx4 v[8:11],v253,s[24:27],s34 offen offset:0 nt
M v[112:115],a[224:227],a[112:115],v[112:115]
s_add_u32 s47,s77,49152
ds_read_b128 a[160:163],v249 offset:54272
v_accvgpr_read_b32 v237,a169
M v[112:115],a[252:255],a[156:159],v[112:115]
s_waitcnt lgkmcnt(2)
ds_read_b128 a[96:99],v248 offset:54272
v_add_f32 v236,v238,v237
M v[112:115],a[192:195],a[120:123],v[112:115]
s_waitcnt lgkmcnt(2)
v_sub_f32 v238,v238,v237
v_add_f32 v237,v73,v169
M v[116:119],a[192:195],a[136:139],v[116:119]
v_sub_f32 v169,v73,v169
v_add_f32 v73,v236,v237
M v[116:119],a[252:255],a[120:123],v[116:119]
v_fmac_f32 v236,4.0,v237
v_fma_f32 v237,2.0,v169,v238
M v[116:119],a[224:227],a[156:159],v[116:119]
v_fma_f32 v169,s40,v169,v238
v_cvt_pk_bf16_f32 v232,v232,v237
M v[120:123],a[224:227],a[120:123],v[120:123]
buffer_load_dwordx4 a[100:103],v250,s[20:23],s47 offen offset:0 sc1
M v[120:123],a[252:255],a[136:139],v[120:123]
s_waitcnt lgkmcnt(1)
s_add_u32 s34,s33,7077888
v_cvt_pk_bf16_f32 v234,v234,v236
v_accvgpr_read_b32 v238,a74
M v[120:123],a[192:195],a[160:163],v[120:123]
s_waitcnt lgkmcnt(0)
buffer_load_dwordx4 a[212:215],v250,s[20:23],s47 offen offset:1024 sc1
M v[124:127],a[192:195],a[96:99],v[124:127]
v_accvgpr_read_b32 v233,a170
v_add_f32 v235,v238,v233
M v[124:127],a[252:255],a[160:163],v[124:127]
v_sub_f32 v238,v238,v233
v_add_f32 v233,v74,v170
M v[124:127],a[224:227],a[136:139],v[124:127]
s_waitcnt vmcnt(26)
v_sub_f32 v170,v74,v170
v_add_f32 v74,v235,v233
M v[128:131],a[124:127],a[116:119],v[128:131]
s_waitcnt vmcnt(25)
buffer_load_dwordx4 a[216:219],v250,s[20:23],s47 offen offset:2048 sc1
M v[128:131],v[228:231],a[128:131],v[128:131]
s_waitcnt vmcnt(25)
v_fmac_f32 v235,4.0,v233
v_fma_f32 v233,2.0,v170,v238
M v[128:131],a[196:199],a[104:107],v[128:131]
v_fma_f32 v170,s40,v170,v238
v_accvgpr_read_b32 v238,a75
M v[132:135],a[196:199],a[108:111],v[132:135]
v_accvgpr_read_b32 v237,a171
v_add_f32 v236,v238,v237
M v[132:135],v[228:231],a[104:107],v[132:135]
v_sub_f32 v238,v238,v237
v_add_f32 v237,v75,v171
M v[132:135],a[124:127],a[128:131],v[132:135]
buffer_store_dwordx4 v[16:19],v253,s[24:27],s34 offen offset:0 nt
M v[136:139],a[124:127],a[104:107],v[136:139]
v_sub_f32 v171,v75,v171
v_add_f32 v75,v236,v237
M v[136:139],v[228:231],a[108:111],v[136:139]
v_fmac_f32 v236,4.0,v237
v_fma_f32 v237,2.0,v171,v238
M v[136:139],a[196:199],a[112:115],v[136:139]
v_fma_f32 v171,s40,v171,v238
v_cvt_pk_bf16_f32 v233,v233,v237
M v[140:143],a[196:199],a[156:159],v[140:143]
v_cvt_pk_bf16_f32 v235,v235,v236
M v[140:143],v[228:231],a[112:115],v[140:143]
ds_write2st64_b64 v254,v[232:233],v[234:235] offset0:17 offset1:21
M v[140:143],a[124:127],a[108:111],v[140:143]
v_accvgpr_read_b32 v238,a76
v_accvgpr_read_b32 v232,a172
M v[144:147],a[124:127],a[112:115],v[144:147]
s_add_u32 s47,s72,3072
v_add_f32 v234,v238,v232
v_sub_f32 v238,v238,v232
M v[144:147],v[228:231],a[156:159],v[144:147]
v_add_u32 v248,0x11000,v248
v_add_u32 v249,0x11000,v249
M v[144:147],a[196:199],a[120:123],v[144:147]
v_add_f32 v232,v76,v172
v_sub_f32 v172,v76,v172
M v[148:151],a[196:199],a[136:139],v[148:151]
v_add_f32 v76,v234,v232
v_fmac_f32 v234,4.0,v232
M v[148:151],v[228:231],a[120:123],v[148:151]
ds_read_b128 a[116:119],v248 offset:0
v_fma_f32 v232,2.0,v172,v238
M v[148:151],a[124:127],a[156:159],v[148:151]
s_add_u32 s34,s33,7471104
buffer_store_dwordx4 v[24:27],v253,s[24:27],s34 offen offset:0 nt
M v[152:155],a[124:127],a[120:123],v[152:155]
buffer_load_dwordx4 a[104:107],v250,s[20:23],s47 offen offset:0 sc1
M v[152:155],v[228:231],a[136:139],v[152:155]
ds_read_b128 a[128:131],v249 offset:0
ds_read_b128 a[168:171],v248 offset:512
M v[152:155],a[196:199],a[160:163],v[152:155]
ds_read_b128 a[112:115],v249 offset:512
v_fma_f32 v172,s40,v172,v238
M v[156:159],a[196:199],a[96:99],v[156:159]
v_accvgpr_read_b32 v238,a77
v_accvgpr_read_b32 v237,a173
M v[156:159],v[228:231],a[160:163],v[156:159]
buffer_load_dwordx4 a[108:111],v250,s[20:23],s47 offen offset:1024 sc1
M v[156:159],a[124:127],a[136:139],v[156:159]
s_waitcnt vmcnt(28) lgkmcnt(3)
v_add_f32 v236,v238,v237
v_sub_f32 v238,v238,v237
M v[96:99],a[144:147],a[116:119],v[96:99]
s_waitcnt vmcnt(27) lgkmcnt(2)
ds_read_b128 a[120:123],v248 offset:1024
v_add_f32 v237,v77,v173
M v[96:99],a[240:243],a[128:131],v[96:99]
s_waitcnt vmcnt(26) lgkmcnt(2)
ds_read_b128 a[96:99],v249 offset:1024
v_sub_f32 v173,v77,v173
M v[96:99],a[248:251],a[168:171],v[96:99]
s_waitcnt lgkmcnt(2)
buffer_load_dwordx4 a[156:159],v250,s[20:23],s47 offen offset:2048 sc1
M v[100:103],a[248:251],a[112:115],v[100:103]
v_add_f32 v77,v236,v237
v_fmac_f32 v236,4.0,v237
M v[100:103],a[240:243],a[168:171],v[100:103]
v_fma_f32 v237,2.0,v173,v238
v_fma_f32 v173,s40,v173,v238
M v[100:103],a[144:147],a[128:131],v[100:103]
v_cvt_pk_bf16_f32 v232,v232,v237
v_cvt_pk_bf16_f32 v234,v234,v236
M v[104:107],a[144:147],a[168:171],v[104:107]
ds_read_b128 a[160:163],v248 offset:1536
v_accvgpr_read_b32 v238,a78
M v[104:107],a[240:243],a[112:115],v[104:107]
s_waitcnt lgkmcnt(2)
ds_read_b128 a[124:127],v249 offset:1536
v_accvgpr_read_b32 v233,a174
M v[104:107],a[248:251],a[120:123],v[104:107]
s_waitcnt lgkmcnt(2)
v_add_f32 v235,v238,v233
v_sub_f32 v238,v238,v233
M v[108:111],a[248:251],a[96:99],v[108:111]
v_add_f32 v233,v78,v174
v_sub_f32 v174,v78,v174
M v[108:111],a[240:243],a[120:123],v[108:111]
v_add_f32 v78,v235,v233
v_fmac_f32 v235,4.0,v233
M v[108:111],a[144:147],a[112:115],v[108:111]
v_fma_f32 v233,2.0,v174,v238
v_fma_f32 v174,s40,v174,v238
M v[112:115],a[144:147],a[120:123],v[112:115]
s_add_u32 s48,s72,6144
ds_read_b128 a[136:139],v249 offset:2048
v_accvgpr_read_b32 v238,a79
M v[112:115],a[240:243],a[96:99],v[112:115]
s_waitcnt lgkmcnt(2)
ds_read_b128 a[228:231],v248 offset:2048
v_accvgpr_read_b32 v237,a175
M v[112:115],a[248:251],a[160:163],v[112:115]
s_waitcnt lgkmcnt(2)
v_add_f32 v236,v238,v237
v_sub_f32 v238,v238,v237
M v[116:119],a[248:251],a[124:127],v[116:119]
s_add_u32 s34,s32,6291456
v_add_f32 v237,v79,v175
v_sub_f32 v175,v79,v175
M v[116:119],a[240:243],a[160:163],v[116:119]
v_add_f32 v79,v236,v237
v_fmac_f32 v236,4.0,v237
M v[116:119],a[144:147],a[96:99],v[116:119]
buffer_store_dwordx4 a[64:67],v253,s[24:27],s34 offen offset:640 nt
M v[120:123],a[144:147],a[160:163],v[120:123]
buffer_load_dwordx4 a[172:175],v250,s[20:23],s48 offen offset:0 sc1
M v[120:123],a[240:243],a[124:127],v[120:123]
s_waitcnt lgkmcnt(1)
v_fma_f32 v237,2.0,v175,v238
v_fma_f32 v175,s40,v175,v238
M v[120:123],a[248:251],a[136:139],v[120:123]
s_waitcnt lgkmcnt(0)
v_cvt_pk_bf16_f32 v233,v233,v237
v_cvt_pk_bf16_f32 v235,v235,v236
M v[124:127],a[248:251],a[228:231],v[124:127]
ds_write2st64_b64 v254,v[232:233],v[234:235] offset0:25 offset1:29
M v[124:127],a[240:243],a[136:139],v[124:127]
buffer_load_dwordx4 a[204:207],v250,s[20:23],s48 offen offset:1024 sc1
M v[124:127],a[144:147],a[124:127],v[124:127]
s_waitcnt vmcnt(26)
v_accvgpr_read_b32 v238,a80
v_accvgpr_read_b32 v232,a176
M v[128:131],a[220:223],a[116:119],v[128:131]
s_waitcnt vmcnt(25)
v_add_f32 v234,v238,v232
v_sub_f32 v238,v238,v232
M v[128:131],a[200:203],a[128:131],v[128:131]
s_waitcnt vmcnt(24)
v_add_f32 v232,v80,v176
v_sub_f32 v176,v80,v176
M v[128:131],a[208:211],a[168:171],v[128:131]
buffer_load_dwordx4 v[224:227],v250,s[20:23],s48 offen offset:2048 sc1
M v[132:135],a[208:211],a[112:115],v[132:135]
v_add_f32 v80,v234,v232
v_fmac_f32 v234,4.0,v232
M v[132:135],a[200:203],a[168:171],v[132:135]
v_fma_f32 v232,2.0,v176,v238
v_fma_f32 v176,s40,v176,v238
M v[132:135],a[220:223],a[128:131],v[132:135]
v_accvgpr_read_b32 v238,a81
v_accvgpr_read_b32 v237,a177
M v[136:139],a[220:223],a[168:171],v[136:139]
v_add_f32 v236,v238,v237
v_sub_f32 v238,v238,v237
M v[136:139],a[200:203],a[112:115],v[136:139]
v_add_f32 v237,v81,v177
v_sub_f32 v177,v81,v177
M v[136:139],a[208:211],a[120:123],v[136:139]
v_add_f32 v81,v236,v237
v_fmac_f32 v236,4.0,v237
M v[140:143],a[208:211],a[96:99],v[140:143]
v_fma_f32 v237,2.0,v177,v238
v_fma_f32 v177,s40,v177,v238
M v[140:143],a[200:203],a[120:123],v[140:143]
v_cvt_pk_bf16_f32 v232,v232,v237
v_cvt_pk_bf16_f32 v234,v234,v236
M v[140:143],a[220:223],a[112:115],v[140:143]
v_accvgpr_read_b32 v238,a82
v_accvgpr_read_b32 v233,a178
M v[144:147],a[220:223],a[120:123],v[144:147]
s_add_u32 s47,s73,3072
v_add_f32 v235,v238,v233
v_sub_f32 v238,v238,v233
M v[144:147],a[200:203],a[96:99],v[144:147]
s_add_u32 s34,s32,6488064
v_add_f32 v233,v82,v178
v_sub_f32 v178,v82,v178
M v[144:147],a[208:211],a[160:163],v[144:147]
buffer_store_dwordx4 a[68:71],v253,s[24:27],s34 offen offset:640 nt
M v[148:151],a[208:211],a[124:127],v[148:151]
v_add_f32 v82,v235,v233
v_fmac_f32 v235,4.0,v233
M v[148:151],a[200:203],a[160:163],v[148:151]
ds_read_b128 a[144:147],v248 offset:17408
v_fma_f32 v233,2.0,v178,v238
M v[148:151],a[220:223],a[96:99],v[148:151]
ds_read_b128 a[116:119],v249 offset:17408
v_fma_f32 v178,s40,v178,v238
M v[152:155],a[220:223],a[160:163],v[152:155]
buffer_load_dwordx4 a[128:131],v250,s[20:23],s47 offen offset:0 sc1
M v[152:155],a[200:203],a[124:127],v[152:155]
ds_read_b128 a[168:171],v248 offset:17920
ds_read_b128 a[120:123],v249 offset:17920
M v[152:155],a[208:211],a[136:139],v[152:155]
buffer_load_dwordx4 a[112:115],v250,s[20:23],s47 offen offset:1024 sc1
M v[156:159],a[208:211],a[228:231],v[156:159]
v_accvgpr_read_b32 v238,a83
v_accvgpr_read_b32 v237,a179
M v[156:159],a[200:203],a[136:139],v[156:159]
v_add_f32 v236,v238,v237
v_sub_f32 v238,v238,v237
M v[156:159],a[220:223],a[124:127],v[156:159]
s_waitcnt vmcnt(26) lgkmcnt(3)
v_add_f32 v237,v83,v179
v_sub_f32 v179,v83,v179
M v[96:99],a[132:135],a[144:147],v[96:99]
s_waitcnt vmcnt(25) lgkmcnt(2)
buffer_load_dwordx4 a[96:99],v250,s[20:23],s47 offen offset:2048 sc1
M v[96:99],a[152:155],a[116:119],v[96:99]
s_waitcnt vmcnt(25) lgkmcnt(1)
ds_read_b128 a[160:163],v248 offset:18432
ds_read_b128 a[136:139],v249 offset:18432
M v[96:99],v[216:219],a[168:171],v[96:99]
s_waitcnt lgkmcnt(2)
v_add_f32 v83,v236,v237
v_fmac_f32 v236,4.0,v237
M v[100:103],v[216:219],a[120:123],v[100:103]
v_fma_f32 v237,2.0,v179,v238
v_fma_f32 v179,s40,v179,v238
M v[100:103],a[152:155],a[168:171],v[100:103]
v_cvt_pk_bf16_f32 v233,v233,v237
v_cvt_pk_bf16_f32 v235,v235,v236
M v[100:103],a[132:135],a[116:119],v[100:103]
ds_write2st64_b64 v254,v[232:233],v[234:235] offset0:68 offset1:72
M v[104:107],a[132:135],a[168:171],v[104:107]
ds_read_b128 a[124:127],v248 offset:18944
v_accvgpr_read_b32 v238,a84
M v[104:107],a[152:155],a[120:123],v[104:107]
s_waitcnt lgkmcnt(3)
ds_read_b128 a[176:179],v249 offset:18944
v_accvgpr_read_b32 v232,a180
M v[104:107],v[216:219],a[160:163],v[104:107]
s_waitcnt lgkmcnt(3)
v_add_f32 v234,v238,v232
v_sub_f32 v238,v238,v232
M v[108:111],v[216:219],a[136:139],v[108:111]
v_add_f32 v232,v84,v180
v_sub_f32 v180,v84,v180
M v[108:111],a[152:155],a[160:163],v[108:111]
v_add_f32 v84,v234,v232
v_fmac_f32 v234,4.0,v232
M v[108:111],a[132:135],a[120:123],v[108:111]
v_fma_f32 v232,2.0,v180,v238
v_fma_f32 v180,s40,v180,v238
M v[112:115],a[132:135],a[160:163],v[112:115]
s_add_u32 s48,s73,6144
ds_read_b128 a[244:247],v249 offset:19456
v_accvgpr_read_b32 v238,a85
M v[112:115],a[152:155],a[136:139],v[112:115]
s_waitcnt lgkmcnt(2)
ds_read_b128 a[192:195],v248 offset:19456
v_accvgpr_read_b32 v237,a181
M v[112:115],v[216:219],a[124:127],v[112:115]
s_waitcnt lgkmcnt(2)
v_add_f32 v236,v238,v237
v_sub_f32 v238,v238,v237
M v[116:119],v[216:219],a[176:179],v[116:119]
v_add_f32 v237,v85,v181
v_sub_f32 v181,v85,v181
M v[116:119],a[152:155],a[124:127],v[116:119]
v_add_f32 v85,v236,v237
v_fmac_f32 v236,4.0,v237
M v[116:119],a[132:135],a[136:139],v[116:119]
v_fma_f32 v237,2.0,v181,v238
v_fma_f32 v181,s40,v181,v238
M v[120:123],a[132:135],a[124:127],v[120:123]
buffer_load_dwordx4 a[252:255],v250,s[20:23],s48 offen offset:0 sc1
M v[120:123],a[152:155],a[176:179],v[120:123]
s_waitcnt lgkmcnt(1)
v_cvt_pk_bf16_f32 v232,v232,v237
v_cvt_pk_bf16_f32 v234,v234,v236
M v[120:123],v[216:219],a[244:247],v[120:123]
s_waitcnt lgkmcnt(0)
buffer_load_dwordx4 a[224:227],v250,s[20:23],s48 offen offset:1024 sc1
M v[124:127],v[216:219],a[192:195],v[124:127]
v_accvgpr_read_b32 v238,a86
v_accvgpr_read_b32 v233,a182
M v[124:127],a[152:155],a[244:247],v[124:127]
v_add_f32 v235,v238,v233
v_sub_f32 v238,v238,v233
M v[124:127],a[132:135],a[176:179],v[124:127]
s_waitcnt vmcnt(25)
v_add_f32 v233,v86,v182
v_sub_f32 v182,v86,v182
M v[128:131],a[232:235],a[144:147],v[128:131]
s_waitcnt vmcnt(24)
buffer_load_dwordx4 a[196:199],v250,s[20:23],s48 offen offset:2048 sc1
M v[128:131],v[220:223],a[116:119],v[128:131]
s_waitcnt vmcnt(24)
v_add_f32 v86,v235,v233
v_fmac_f32 v235,4.0,v233
M v[128:131],a[236:239],a[168:171],v[128:131]
v_fma_f32 v233,2.0,v182,v238
v_fma_f32 v182,s40,v182,v238
M v[132:135],a[236:239],a[120:123],v[132:135]
v_accvgpr_read_b32 v238,a87
v_accvgpr_read_b32 v237,a183
M v[132:135],v[220:223],a[168:171],v[132:135]
v_add_f32 v236,v238,v237
v_sub_f32 v238,v238,v237
M v[132:135],a[232:235],a[116:119],v[132:135]
v_add_f32 v237,v87,v183
v_sub_f32 v183,v87,v183
M v[136:139],a[232:235],a[168:171],v[136:139]
v_add_f32 v87,v236,v237
v_fmac_f32 v236,4.0,v237
M v[136:139],v[220:223],a[120:123],v[136:139]
v_fma_f32 v237,2.0,v183,v238
v_fma_f32 v183,s40,v183,v238
M v[136:139],a[236:239],a[160:163],v[136:139]
v_cvt_pk_bf16_f32 v233,v233,v237
v_cvt_pk_bf16_f32 v235,v235,v236
M v[140:143],a[236:239],a[136:139],v[140:143]
ds_write2st64_b64 v254,v[232:233],v[234:235] offset0:76 offset1:80
M v[140:143],v[220:223],a[160:163],v[140:143]
v_accvgpr_read_b32 v238,a88
v_accvgpr_read_b32 v232,a184
M v[140:143],a[232:235],a[120:123],v[140:143]
v_add_f32 v234,v238,v232
v_sub_f32 v238,v238,v232
M v[144:147],a[232:235],a[160:163],v[144:147]
s_add_u32 s47,s74,3072
v_add_f32 v232,v88,v184
v_sub_f32 v184,v88,v184
M v[144:147],v[220:223],a[136:139],v[144:147]
v_add_u32 v248,0xfffece00,v248
v_add_u32 v249,0xfffece00,v249
M v[144:147],a[236:239],a[124:127],v[144:147]
v_add_f32 v88,v234,v232
v_fmac_f32 v234,4.0,v232
M v[148:151],a[236:239],a[176:179],v[148:151]
v_fma_f32 v232,2.0,v184,v238
v_fma_f32 v184,s40,v184,v238
M v[148:151],v[220:223],a[124:127],v[148:151]
ds_read_b128 a[152:155],v248 offset:26112
v_accvgpr_read_b32 v238,a89
M v[148:151],a[232:235],a[136:139],v[148:151]
ds_read_b128 a[132:135],v249 offset:26112
v_accvgpr_read_b32 v237,a185
M v[152:155],a[232:235],a[124:127],v[152:155]
buffer_load_dwordx4 a[144:147],v250,s[20:23],s47 offen offset:0 sc1
M v[152:155],v[220:223],a[176:179],v[152:155]
ds_read_b128 a[116:119],v248 offset:26624
ds_read_b128 a[180:183],v249 offset:26624
M v[152:155],a[236:239],a[244:247],v[152:155]
buffer_load_dwordx4 a[168:171],v250,s[20:23],s47 offen offset:1024 sc1
M v[156:159],a[236:239],a[192:195],v[156:159]
v_add_f32 v236,v238,v237
v_sub_f32 v238,v238,v237
M v[156:159],v[220:223],a[244:247],v[156:159]
v_add_f32 v237,v89,v185
v_sub_f32 v185,v89,v185
M v[156:159],a[232:235],a[176:179],v[156:159]
s_waitcnt vmcnt(25) lgkmcnt(3)
v_add_f32 v89,v236,v237
v_fmac_f32 v236,4.0,v237
M v[96:99],a[148:151],a[152:155],v[96:99]
s_waitcnt vmcnt(24) lgkmcnt(2)
buffer_load_dwordx4 a[120:123],v250,s[20:23],s47 offen offset:2048 sc1
M v[96:99],a[140:143],a[132:135],v[96:99]
s_waitcnt vmcnt(24) lgkmcnt(1)
ds_read_b128 a[160:163],v248 offset:27136
ds_read_b128 a[136:139],v249 offset:27136
M v[96:99],a[164:167],a[116:119],v[96:99]
s_waitcnt lgkmcnt(2)
v_fma_f32 v237,2.0,v185,v238
v_fma_f32 v185,s40,v185,v238
M v[100:103],a[164:167],a[180:183],v[100:103]
v_cvt_pk_bf16_f32 v232,v232,v237
v_cvt_pk_bf16_f32 v234,v234,v236
M v[100:103],a[140:143],a[116:119],v[100:103]
v_accvgpr_read_b32 v238,a90
v_accvgpr_read_b32 v233,a186
M v[100:103],a[148:151],a[132:135],v[100:103]
v_add_f32 v235,v238,v233
v_sub_f32 v238,v238,v233
M v[104:107],a[148:151],a[116:119],v[104:107]
ds_read_b128 a[124:127],v248 offset:27648
v_add_f32 v233,v90,v186
M v[104:107],a[140:143],a[180:183],v[104:107]
s_waitcnt lgkmcnt(2)
ds_read_b128 a[176:179],v249 offset:27648
v_sub_f32 v186,v90,v186
M v[104:107],a[164:167],a[160:163],v[104:107]
s_waitcnt lgkmcnt(2)
v_add_f32 v90,v235,v233
v_fmac_f32 v235,4.0,v233
M v[108:111],a[164:167],a[136:139],v[108:111]
v_fma_f32 v233,2.0,v186,v238
v_fma_f32 v186,s40,v186,v238
M v[108:111],a[140:143],a[160:163],v[108:111]
v_accvgpr_read_b32 v238,a91
v_accvgpr_read_b32 v237,a187
M v[108:111],a[148:151],a[180:183],v[108:111]
v_add_f32 v236,v238,v237
v_sub_f32 v238,v238,v237
M v[112:115],a[148:151],a[160:163],v[112:115]
s_add_u32 s48,s74,6144
ds_read_b128 v[228:231],v249 offset:28160
v_add_f32 v237,v91,v187
M v[112:115],a[140:143],a[136:139],v[112:115]
s_waitcnt lgkmcnt(2)
ds_read_b128 a[248:251],v248 offset:28160
v_sub_f32 v187,v91,v187
M v[112:115],a[164:167],a[124:127],v[112:115]
s_waitcnt lgkmcnt(2)
v_add_f32 v91,v236,v237
v_fmac_f32 v236,4.0,v237
M v[116:119],a[164:167],a[176:179],v[116:119]
v_fma_f32 v237,2.0,v187,v238
v_fma_f32 v187,s40,v187,v238
M v[116:119],a[140:143],a[124:127],v[116:119]
v_cvt_pk_bf16_f32 v233,v233,v237
v_cvt_pk_bf16_f32 v235,v235,v236
M v[116:119],a[148:151],a[136:139],v[116:119]
ds_write2st64_b64 v254,v[232:233],v[234:235] offset0:85 offset1:89
M v[120:123],a[148:151],a[124:127],v[120:123]
buffer_load_dwordx4 a[184:187],v250,s[20:23],s48 offen offset:0 sc1
M v[120:123],a[140:143],a[176:179],v[120:123]
s_waitcnt lgkmcnt(2)
v_accvgpr_read_b32 v238,a92
v_accvgpr_read_b32 v232,a188
M v[120:123],a[164:167],v[228:231],v[120:123]
s_waitcnt lgkmcnt(1)
buffer_load_dwordx4 a[240:243],v250,s[20:23],s48 offen offset:1024 sc1
M v[124:127],a[164:167],a[248:251],v[124:127]
v_add_f32 v234,v238,v232
v_sub_f32 v238,v238,v232
M v[124:127],a[140:143],v[228:231],v[124:127]
v_add_f32 v232,v92,v188
v_sub_f32 v188,v92,v188
M v[124:127],a[148:151],a[176:179],v[124:127]
s_waitcnt vmcnt(23)
v_add_f32 v92,v234,v232
v_fmac_f32 v234,4.0,v232
M v[128:131],a[100:103],a[152:155],v[128:131]
s_waitcnt vmcnt(22)
buffer_load_dwordx4 a[208:211],v250,s[20:23],s48 offen offset:2048 sc1
M v[128:131],a[212:215],a[132:135],v[128:131]
s_waitcnt vmcnt(22)
v_fma_f32 v232,2.0,v188,v238
v_fma_f32 v188,s40,v188,v238
M v[128:131],a[216:219],a[116:119],v[128:131]
v_accvgpr_read_b32 v238,a93
v_accvgpr_read_b32 v237,a189
M v[132:135],a[216:219],a[180:183],v[132:135]
v_add_f32 v236,v238,v237
v_sub_f32 v238,v238,v237
M v[132:135],a[212:215],a[116:119],v[132:135]
v_add_f32 v237,v93,v189
v_sub_f32 v189,v93,v189
M v[132:135],a[100:103],a[132:135],v[132:135]
v_add_f32 v93,v236,v237
v_fmac_f32 v236,4.0,v237
M v[136:139],a[100:103],a[116:119],v[136:139]
v_fma_f32 v237,2.0,v189,v238
v_fma_f32 v189,s40,v189,v238
M v[136:139],a[212:215],a[180:183],v[136:139]
v_cvt_pk_bf16_f32 v232,v232,v237
v_cvt_pk_bf16_f32 v234,v234,v236
M v[136:139],a[216:219],a[160:163],v[136:139]
v_accvgpr_read_b32 v238,a94
v_accvgpr_read_b32 v233,a190
M v[140:143],a[216:219],a[136:139],v[140:143]
v_add_f32 v235,v238,v233
v_sub_f32 v238,v238,v233
M v[140:143],a[212:215],a[160:163],v[140:143]
v_add_f32 v233,v94,v190
v_sub_f32 v190,v94,v190
M v[140:143],a[100:103],a[180:183],v[140:143]
v_add_f32 v94,v235,v233
v_fmac_f32 v235,4.0,v233
M v[144:147],a[100:103],a[160:163],v[144:147]
s_add_u32 s47,s75,3072
v_fma_f32 v233,2.0,v190,v238
v_fma_f32 v190,s40,v190,v238
M v[144:147],a[212:215],a[136:139],v[144:147]
v_accvgpr_read_b32 v238,a95
v_accvgpr_read_b32 v237,a191
M v[144:147],a[216:219],a[124:127],v[144:147]
v_add_f32 v236,v238,v237
v_sub_f32 v238,v238,v237
M v[148:151],a[216:219],a[176:179],v[148:151]
v_add_f32 v237,v95,v191
v_sub_f32 v191,v95,v191
M v[148:151],a[212:215],a[124:127],v[148:151]
ds_read_b128 a[164:167],v248 offset:0
v_add_f32 v95,v236,v237
M v[148:151],a[100:103],a[136:139],v[148:151]
ds_read_b128 a[140:143],v249 offset:0
v_fmac_f32 v236,4.0,v237
M v[152:155],a[100:103],a[124:127],v[152:155]
buffer_load_dwordx4 a[148:151],v250,s[20:23],s47 offen offset:0 sc1
M v[152:155],a[212:215],a[176:179],v[152:155]
ds_read_b128 a[152:155],v248 offset:512
ds_read_b128 a[116:119],v249 offset:512
M v[152:155],a[216:219],v[228:231],v[152:155]
buffer_load_dwordx4 a[132:135],v250,s[20:23],s47 offen offset:1024 sc1
M v[156:159],a[216:219],a[248:251],v[156:159]
v_fma_f32 v237,2.0,v191,v238
v_fma_f32 v191,s40,v191,v238
M v[156:159],a[212:215],v[228:231],v[156:159]
v_cvt_pk_bf16_f32 v233,v233,v237
v_cvt_pk_bf16_f32 v235,v235,v236
M v[156:159],a[100:103],a[176:179],v[156:159]
s_waitcnt vmcnt(21) lgkmcnt(3)
ds_write2st64_b64 v254,v[232:233],v[234:235] offset0:93 offset1:97
M v[32:35],a[104:107],a[164:167],v[32:35]
s_waitcnt vmcnt(20) lgkmcnt(3)
buffer_load_dwordx4 a[180:183],v250,s[20:23],s47 offen offset:2048 sc1
M v[32:35],a[108:111],a[140:143],v[32:35]
s_waitcnt vmcnt(20) lgkmcnt(2)
ds_read_b128 a[160:163],v248 offset:1024
ds_read_b128 a[136:139],v249 offset:1024
M v[32:35],a[156:159],a[152:155],v[32:35]
s_waitcnt lgkmcnt(3)
v_cvt_pk_bf16_f32 v96,v96,v97
v_cvt_pk_bf16_f32 v97,v98,v99
M v[36:39],a[156:159],a[116:119],v[36:39]
v_cvt_pk_bf16_f32 v100,v100,v101
v_cvt_pk_bf16_f32 v101,v102,v103
M v[36:39],a[108:111],a[152:155],v[36:39]
s_waitcnt lgkmcnt(2)
s_barrier
ds_read_b128 a[72:75],v250 offset:8704
M v[36:39],a[104:107],a[140:143],v[36:39]
ds_read_b128 a[76:79],v250 offset:12800
ds_read_b128 a[80:83],v250 offset:34816
M v[40:43],a[104:107],a[152:155],v[40:43]
ds_read_b128 a[84:87],v250 offset:38912
ds_read_b128 a[88:91],v250 offset:43520
M v[40:43],a[108:111],a[116:119],v[40:43]
s_waitcnt lgkmcnt(6)
ds_read_b128 a[92:95],v250 offset:47616
ds_read_b128 a[124:127],v248 offset:1536
M v[40:43],a[156:159],a[160:163],v[40:43]
s_waitcnt lgkmcnt(7)
ds_read_b128 a[188:191],v249 offset:1536
ds_write2st64_b64 v254,v[96:97],v[100:101] offset0:34 offset1:38
M v[44:47],a[156:159],a[136:139],v[44:47]
s_add_u32 s34,s32,6684672
v_cvt_pk_bf16_f32 v104,v104,v105
v_cvt_pk_bf16_f32 v105,v106,v107
M v[44:47],a[108:111],a[160:163],v[44:47]
v_cvt_pk_bf16_f32 v108,v108,v109
v_cvt_pk_bf16_f32 v109,v110,v111
M v[44:47],a[104:107],a[116:119],v[44:47]
s_waitcnt lgkmcnt(8)
buffer_store_dwordx4 a[72:75],v253,s[24:27],s34 offen offset:640 nt
M v[48:51],a[104:107],a[160:163],v[48:51]
s_add_u32 s34,s32,6881280
ds_read_b128 a[100:103],v249 offset:2048
ds_write2st64_b64 v254,v[104:105],v[108:109] offset0:42 offset1:46
M v[48:51],a[108:111],a[136:139],v[48:51]
s_waitcnt lgkmcnt(4)
s_add_u32 s48,s75,6144
ds_read_b128 a[176:179],v248 offset:2048
v_cvt_pk_bf16_f32 v112,v112,v113
M v[48:51],a[156:159],a[124:127],v[48:51]
s_waitcnt lgkmcnt(4)
buffer_store_dwordx4 a[76:79],v253,s[24:27],s34 offen offset:640 nt
M v[52:55],a[156:159],a[188:191],v[52:55]
s_add_u32 s34,s32,7077888
v_cvt_pk_bf16_f32 v113,v114,v115
v_cvt_pk_bf16_f32 v116,v116,v117
M v[52:55],a[108:111],a[124:127],v[52:55]
v_cvt_pk_bf16_f32 v117,v118,v119
M v[52:55],a[104:107],a[136:139],v[52:55]
buffer_store_dwordx4 a[80:83],v253,s[24:27],s34 offen offset:640 nt
M v[56:59],a[104:107],a[124:127],v[56:59]
s_add_u32 s34,s32,7274496
buffer_load_dwordx4 a[228:231],v250,s[20:23],s48 offen offset:0 sc1
M v[56:59],a[108:111],a[188:191],v[56:59]
s_waitcnt lgkmcnt(2)
ds_write2st64_b64 v254,v[112:113],v[116:117] offset0:51 offset1:55
M v[56:59],a[156:159],a[100:103],v[56:59]
s_waitcnt lgkmcnt(1)
v_cvt_pk_bf16_f32 v120,v120,v121
v_cvt_pk_bf16_f32 v121,v122,v123
M v[60:63],a[156:159],a[176:179],v[60:63]
v_cvt_pk_bf16_f32 v124,v124,v125
v_cvt_pk_bf16_f32 v125,v126,v127
M v[60:63],a[108:111],a[100:103],v[60:63]
buffer_load_dwordx4 a[200:203],v250,s[20:23],s48 offen offset:1024 sc1
M v[60:63],a[104:107],a[188:191],v[60:63]
s_waitcnt vmcnt(23)
ds_write2st64_b64 v254,v[120:121],v[124:125] offset0:59 offset1:63
M v[64:67],a[172:175],a[164:167],v[64:67]
s_waitcnt vmcnt(22)
v_cvt_pk_bf16_f32 v128,v128,v129
v_cvt_pk_bf16_f32 v129,v130,v131
M v[64:67],a[204:207],a[140:143],v[64:67]
s_waitcnt vmcnt(21)
buffer_load_dwordx4 a[220:223],v250,s[20:23],s48 offen offset:2048 sc1
M v[64:67],v[224:227],a[152:155],v[64:67]
v_cvt_pk_bf16_f32 v132,v132,v133
v_cvt_pk_bf16_f32 v133,v134,v135
M v[68:71],v[224:227],a[116:119],v[68:71]
s_waitcnt lgkmcnt(0)
s_barrier
ds_read_b128 v[96:99],v250 offset:17408
M v[68:71],a[204:207],a[152:155],v[68:71]
ds_read_b128 v[104:107],v250 offset:21504
ds_read_b128 v[112:115],v250 offset:26112
M v[68:71],a[172:175],a[140:143],v[68:71]
ds_read_b128 v[120:123],v250 offset:30208
buffer_store_dwordx4 a[84:87],v253,s[24:27],s34 offen offset:640 nt
M v[72:75],a[172:175],a[152:155],v[72:75]
s_add_u32 s34,s32,7471104
ds_write2st64_b64 v254,v[128:129],v[132:133] offset0:17 offset1:21
M v[72:75],a[204:207],a[116:119],v[72:75]
v_cvt_pk_bf16_f32 v136,v136,v137
v_cvt_pk_bf16_f32 v137,v138,v139
M v[72:75],v[224:227],a[160:163],v[72:75]
buffer_store_dwordx4 a[88:91],v253,s[24:27],s34 offen offset:640 nt
M v[76:79],v[224:227],a[136:139],v[76:79]
s_add_u32 s34,s32,7667712
v_cvt_pk_bf16_f32 v140,v140,v141
v_cvt_pk_bf16_f32 v141,v142,v143
M v[76:79],a[204:207],a[160:163],v[76:79]
ds_write2st64_b64 v254,v[136:137],v[140:141] offset0:25 offset1:29
M v[76:79],a[172:175],a[116:119],v[76:79]
buffer_store_dwordx4 a[92:95],v253,s[24:27],s34 offen offset:640 nt
M v[80:83],a[172:175],a[160:163],v[80:83]
s_add_u32 s47,s76,3072
v_cvt_pk_bf16_f32 v144,v144,v145
v_cvt_pk_bf16_f32 v145,v146,v147
M v[80:83],a[204:207],a[136:139],v[80:83]
v_cvt_pk_bf16_f32 v148,v148,v149
v_cvt_pk_bf16_f32 v149,v150,v151
M v[80:83],v[224:227],a[124:127],v[80:83]
ds_write2st64_b64 v254,v[144:145],v[148:149] offset0:68 offset1:72
M v[84:87],v[224:227],a[188:191],v[84:87]
v_cvt_pk_bf16_f32 v152,v152,v153
v_cvt_pk_bf16_f32 v153,v154,v155
M v[84:87],a[204:207],a[124:127],v[84:87]
ds_read_b128 a[156:159],v248 offset:34816
v_cvt_pk_bf16_f32 v156,v156,v157
M v[84:87],a[172:175],a[136:139],v[84:87]
ds_read_b128 a[108:111],v249 offset:34816
v_cvt_pk_bf16_f32 v157,v158,v159
M v[88:91],a[172:175],a[124:127],v[88:91]
buffer_load_dwordx4 a[104:107],v250,s[20:23],s47 offen offset:0 sc1
M v[88:91],a[204:207],a[188:191],v[88:91]
ds_read_b128 a[164:167],v248 offset:35328
ds_read_b128 a[152:155],v249 offset:35328
M v[88:91],v[224:227],a[100:103],v[88:91]
buffer_load_dwordx4 a[140:143],v250,s[20:23],s47 offen offset:1024 sc1
M v[92:95],v[224:227],a[176:179],v[92:95]
ds_write2st64_b64 v254,v[152:153],v[156:157] offset0:76 offset1:80
M v[92:95],a[204:207],a[100:103],v[92:95]
M v[92:95],a[172:175],a[188:191],v[92:95]
s_waitcnt vmcnt(25) lgkmcnt(4)
M v[32:35],a[128:131],a[156:159],v[32:35]
s_waitcnt vmcnt(24) lgkmcnt(3)
s_add_u32 s34,s33,6291456
buffer_load_dwordx4 a[116:119],v250,s[20:23],s47 offen offset:2048 sc1
M v[32:35],a[112:115],a[108:111],v[32:35]
s_waitcnt vmcnt(24) lgkmcnt(0)
s_barrier
ds_read_b128 v[128:131],v250 offset:8704
M v[32:35],a[96:99],a[164:167],v[32:35]
ds_read_b128 v[136:139],v250 offset:12800
ds_read_b128 v[144:147],v250 offset:34816
M v[36:39],a[96:99],a[152:155],v[36:39]
ds_read_b128 v[152:155],v250 offset:38912
ds_read_b128 a[160:163],v248 offset:35840
M v[36:39],a[112:115],a[164:167],v[36:39]
ds_read_b128 a[136:139],v249 offset:35840
M v[36:39],a[128:131],a[108:111],v[36:39]
buffer_store_dwordx4 v[96:99],v253,s[24:27],s34 offen offset:1152 nt
M v[40:43],a[128:131],a[164:167],v[40:43]
ds_read_b128 a[124:127],v248 offset:36352
M v[40:43],a[112:115],a[152:155],v[40:43]
s_waitcnt lgkmcnt(2)
s_barrier
ds_read_b128 a[176:179],v249 offset:36352
M v[40:43],a[96:99],a[160:163],v[40:43]
s_waitcnt lgkmcnt(2)
M v[44:47],a[96:99],a[136:139],v[44:47]
M v[44:47],a[112:115],a[160:163],v[44:47]
M v[44:47],a[128:131],a[152:155],v[44:47]
M v[48:51],a[128:131],a[160:163],v[48:51]
s_add_u32 s48,s76,6144
ds_read_b128 a[100:103],v249 offset:36864
M v[48:51],a[112:115],a[136:139],v[48:51]
s_waitcnt lgkmcnt(2)
ds_read_b128 a[172:175],v248 offset:36864
M v[48:51],a[96:99],a[124:127],v[48:51]
s_waitcnt lgkmcnt(2)
M v[52:55],a[96:99],a[176:179],v[52:55]
M v[52:55],a[112:115],a[124:127],v[52:55]
M v[52:55],a[128:131],a[136:139],v[52:55]
M v[56:59],a[128:131],a[124:127],v[56:59]
buffer_load_dwordx4 a[188:191],v250,s[20:23],s48 offen offset:0 sc1
M v[56:59],a[112:115],a[176:179],v[56:59]
s_waitcnt lgkmcnt(1)
M v[56:59],a[96:99],a[100:103],v[56:59]
s_waitcnt lgkmcnt(0)
buffer_load_dwordx4 v[216:219],v250,s[20:23],s48 offen offset:1024 sc1
M v[60:63],a[96:99],a[172:175],v[60:63]
M v[60:63],a[112:115],a[100:103],v[60:63]
s_add_u32 s34,s33,6684672
M v[60:63],a[128:131],a[176:179],v[60:63]
s_waitcnt vmcnt(26)
M v[64:67],a[252:255],a[156:159],v[64:67]
s_waitcnt vmcnt(25)
buffer_load_dwordx4 a[192:195],v250,s[20:23],s48 offen offset:2048 sc1
M v[64:67],a[224:227],a[108:111],v[64:67]
s_waitcnt vmcnt(25)
M v[64:67],a[196:199],a[164:167],v[64:67]
M v[68:71],a[196:199],a[152:155],v[68:71]
M v[68:71],a[224:227],a[164:167],v[68:71]
M v[68:71],a[252:255],a[108:111],v[68:71]
buffer_store_dwordx4 v[104:107],v253,s[24:27],s34 offen offset:1152 nt
M v[72:75],a[252:255],a[164:167],v[72:75]
M v[72:75],a[224:227],a[152:155],v[72:75]
M v[72:75],a[196:199],a[160:163],v[72:75]
M v[76:79],a[196:199],a[136:139],v[76:79]
M v[76:79],a[224:227],a[160:163],v[76:79]
M v[76:79],a[252:255],a[152:155],v[76:79]
M v[80:83],a[252:255],a[160:163],v[80:83]
s_add_u32 s47,s77,3072
M v[80:83],a[224:227],a[136:139],v[80:83]
M v[80:83],a[196:199],a[124:127],v[80:83]
M v[84:87],a[196:199],a[176:179],v[84:87]
M v[84:87],a[224:227],a[124:127],v[84:87]
ds_read_b128 a[96:99],v248 offset:52224
M v[84:87],a[252:255],a[136:139],v[84:87]
ds_read_b128 a[112:115],v249 offset:52224
M v[88:91],a[252:255],a[124:127],v[88:91]
buffer_load_dwordx4 a[128:131],v250,s[20:23],s47 offen offset:0 sc1
M v[88:91],a[224:227],a[176:179],v[88:91]
ds_read_b128 a[156:159],v248 offset:52736
ds_read_b128 a[164:167],v249 offset:52736
M v[88:91],a[196:199],a[100:103],v[88:91]
s_add_u32 s34,s33,7077888
buffer_load_dwordx4 a[108:111],v250,s[20:23],s47 offen offset:1024 sc1
M v[92:95],a[196:199],a[172:175],v[92:95]
M v[92:95],a[224:227],a[100:103],v[92:95]
M v[92:95],a[252:255],a[176:179],v[92:95]
s_waitcnt vmcnt(27) lgkmcnt(3)
M v[32:35],a[144:147],a[96:99],v[32:35]
s_waitcnt vmcnt(26) lgkmcnt(2)
buffer_load_dwordx4 a[152:155],v250,s[20:23],s47 offen offset:2048 sc1
M v[32:35],a[168:171],a[112:115],v[32:35]
s_waitcnt vmcnt(26) lgkmcnt(1)
ds_read_b128 a[160:163],v248 offset:53248
ds_read_b128 a[136:139],v249 offset:53248
M v[32:35],a[120:123],a[156:159],v[32:35]
s_waitcnt lgkmcnt(2)
M v[36:39],a[120:123],a[164:167],v[36:39]
M v[36:39],a[168:171],a[156:159],v[36:39]
M v[36:39],a[144:147],a[112:115],v[36:39]
buffer_store_dwordx4 v[112:115],v253,s[24:27],s34 offen offset:1152 nt
M v[40:43],a[144:147],a[156:159],v[40:43]
ds_read_b128 a[124:127],v248 offset:53760
M v[40:43],a[168:171],a[164:167],v[40:43]
s_waitcnt lgkmcnt(2)
ds_read_b128 a[172:175],v249 offset:53760
M v[40:43],a[120:123],a[160:163],v[40:43]
s_waitcnt lgkmcnt(2)
M v[44:47],a[120:123],a[136:139],v[44:47]
M v[44:47],a[168:171],a[160:163],v[44:47]
M v[44:47],a[144:147],a[164:167],v[44:47]
M v[48:51],a[144:147],a[160:163],v[48:51]
s_add_u32 s48,s77,6144
ds_read_b128 a[100:103],v249 offset:54272
M v[48:51],a[168:171],a[136:139],v[48:51]
s_waitcnt lgkmcnt(2)
ds_read_b128 a[176:179],v248 offset:54272
M v[48:51],a[120:123],a[124:127],v[48:51]
s_waitcnt lgkmcnt(2)
M v[52:55],a[120:123],a[172:175],v[52:55]
M v[52:55],a[168:171],a[124:127],v[52:55]
M v[52:55],a[144:147],a[136:139],v[52:55]
M v[56:59],a[144:147],a[124:127],v[56:59]
s_add_u32 s34,s33,7471104
buffer_load_dwordx4 a[236:239],v250,s[20:23],s48 offen offset:0 sc1
M v[56:59],a[168:171],a[172:175],v[56:59]
s_waitcnt lgkmcnt(1)
M v[56:59],a[120:123],a[100:103],v[56:59]
s_waitcnt lgkmcnt(0)
buffer_store_dwordx4 v[120:123],v253,s[24:27],s34 offen offset:1152 nt
M v[60:63],a[120:123],a[176:179],v[60:63]
M v[60:63],a[168:171],a[100:103],v[60:63]
M v[60:63],a[144:147],a[172:175],v[60:63]
s_waitcnt vmcnt(28)
buffer_load_dwordx4 a[244:247],v250,s[20:23],s48 offen offset:1024 sc1
M v[64:67],a[184:187],a[96:99],v[64:67]
s_waitcnt vmcnt(28)
M v[64:67],a[240:243],a[112:115],v[64:67]
s_waitcnt vmcnt(27)
M v[64:67],a[208:211],a[156:159],v[64:67]
M v[68:71],a[208:211],a[164:167],v[68:71]
buffer_load_dwordx4 v[220:223],v250,s[20:23],s48 offen offset:2048 sc1
M v[68:71],a[240:243],a[156:159],v[68:71]
M v[68:71],a[184:187],a[112:115],v[68:71]
M v[72:75],a[184:187],a[156:159],v[72:75]
M v[72:75],a[240:243],a[164:167],v[72:75]
M v[72:75],a[208:211],a[160:163],v[72:75]
M v[76:79],a[208:211],a[136:139],v[76:79]
M v[76:79],a[240:243],a[160:163],v[76:79]
M v[76:79],a[184:187],a[164:167],v[76:79]
M v[80:83],a[184:187],a[160:163],v[80:83]
s_add_u32 s48,s72,52224
M v[80:83],a[240:243],a[136:139],v[80:83]
v_add_u32 v248,0x11000,v248
v_add_u32 v249,0x11000,v249
M v[80:83],a[208:211],a[124:127],v[80:83]
M v[84:87],a[208:211],a[172:175],v[84:87]
M v[84:87],a[240:243],a[124:127],v[84:87]
s_add_u32 s34,s33,6291456
ds_read_b128 a[120:123],v248 offset:0
M v[84:87],a[184:187],a[136:139],v[84:87]
buffer_store_dwordx4 v[128:131],v253,s[24:27],s34 offen offset:1280 nt
M v[88:91],a[184:187],a[124:127],v[88:91]
buffer_load_dwordx4 a[144:147],v250,s[20:23],s48 offen offset:0 sc1
M v[88:91],a[240:243],a[172:175],v[88:91]
ds_read_b128 a[168:171],v249 offset:0
ds_read_b128 a[96:99],v248 offset:512
M v[88:91],a[208:211],a[100:103],v[88:91]
ds_read_b128 a[156:159],v249 offset:512
M v[92:95],a[208:211],a[176:179],v[92:95]
M v[92:95],a[240:243],a[100:103],v[92:95]
buffer_load_dwordx4 a[112:115],v250,s[20:23],s48 offen offset:1024 sc1
M v[92:95],a[184:187],a[172:175],v[92:95]
s_waitcnt vmcnt(30) lgkmcnt(3)
M v[32:35],a[148:151],a[120:123],v[32:35]
s_waitcnt vmcnt(29) lgkmcnt(2)
ds_read_b128 a[160:163],v248 offset:1024
M v[32:35],a[132:135],a[168:171],v[32:35]
s_waitcnt vmcnt(28) lgkmcnt(2)
ds_read_b128 a[136:139],v249 offset:1024
M v[32:35],a[180:183],a[96:99],v[32:35]
s_waitcnt lgkmcnt(2)
buffer_load_dwordx4 a[164:167],v250,s[20:23],s48 offen offset:2048 sc1
M v[36:39],a[180:183],a[156:159],v[36:39]
M v[36:39],a[132:135],a[96:99],v[36:39]
M v[36:39],a[148:151],a[168:171],v[36:39]
M v[40:43],a[148:151],a[96:99],v[40:43]
ds_read_b128 a[124:127],v248 offset:1536
M v[40:43],a[132:135],a[156:159],v[40:43]
s_waitcnt lgkmcnt(2)
ds_read_b128 a[176:179],v249 offset:1536
M v[40:43],a[180:183],a[160:163],v[40:43]
s_waitcnt lgkmcnt(2)
M v[44:47],a[180:183],a[136:139],v[44:47]
M v[44:47],a[132:135],a[160:163],v[44:47]
M v[44:47],a[148:151],a[156:159],v[44:47]
M v[48:51],a[148:151],a[160:163],v[48:51]
s_add_u32 s48,s73,52224
ds_read_b128 a[100:103],v249 offset:2048
M v[48:51],a[132:135],a[136:139],v[48:51]
s_waitcnt lgkmcnt(2)
ds_read_b128 a[172:175],v248 offset:2048
M v[48:51],a[180:183],a[124:127],v[48:51]
s_waitcnt lgkmcnt(2)
M v[52:55],a[180:183],a[176:179],v[52:55]
s_add_u32 s34,s33,6684672
M v[52:55],a[132:135],a[124:127],v[52:55]
M v[52:55],a[148:151],a[136:139],v[52:55]
buffer_store_dwordx4 v[136:139],v253,s[24:27],s34 offen offset:1280 nt
M v[56:59],a[148:151],a[124:127],v[56:59]
buffer_load_dwordx4 a[184:187],v250,s[20:23],s48 offen offset:0 sc1
M v[56:59],a[132:135],a[176:179],v[56:59]
s_waitcnt lgkmcnt(1)
M v[56:59],a[180:183],a[100:103],v[56:59]
s_waitcnt lgkmcnt(0)
M v[60:63],a[180:183],a[172:175],v[60:63]
M v[60:63],a[132:135],a[100:103],v[60:63]
buffer_load_dwordx4 a[232:235],v250,s[20:23],s48 offen offset:1024 sc1
M v[60:63],a[148:151],a[176:179],v[60:63]
s_waitcnt vmcnt(28)
M v[64:67],a[228:231],a[120:123],v[64:67]
s_waitcnt vmcnt(27)
M v[64:67],a[200:203],a[168:171],v[64:67]
s_waitcnt vmcnt(26)
M v[64:67],a[220:223],a[96:99],v[64:67]
buffer_load_dwordx4 a[216:219],v250,s[20:23],s48 offen offset:2048 sc1
M v[68:71],a[220:223],a[156:159],v[68:71]
M v[68:71],a[200:203],a[96:99],v[68:71]
M v[68:71],a[228:231],a[168:171],v[68:71]
M v[72:75],a[228:231],a[96:99],v[72:75]
M v[72:75],a[200:203],a[156:159],v[72:75]
M v[72:75],a[220:223],a[160:163],v[72:75]
M v[76:79],a[220:223],a[136:139],v[76:79]
M v[76:79],a[200:203],a[160:163],v[76:79]
M v[76:79],a[228:231],a[156:159],v[76:79]
M v[80:83],a[228:231],a[160:163],v[80:83]
s_add_u32 s48,s74,52224
M v[80:83],a[200:203],a[136:139],v[80:83]
s_add_u32 s34,s33,7077888
M v[80:83],a[220:223],a[124:127],v[80:83]
buffer_store_dwordx4 v[144:147],v253,s[24:27],s34 offen offset:1280 nt
M v[84:87],a[220:223],a[176:179],v[84:87]
M v[84:87],a[200:203],a[124:127],v[84:87]
ds_read_b128 a[180:183],v248 offset:17408
M v[84:87],a[228:231],a[136:139],v[84:87]
ds_read_b128 a[132:135],v249 offset:17408
M v[88:91],a[228:231],a[124:127],v[88:91]
buffer_load_dwordx4 a[148:151],v250,s[20:23],s48 offen offset:0 sc1
M v[88:91],a[200:203],a[176:179],v[88:91]
ds_read_b128 a[120:123],v248 offset:17920
ds_read_b128 a[96:99],v249 offset:17920
M v[88:91],a[220:223],a[100:103],v[88:91]
buffer_load_dwordx4 a[168:171],v250,s[20:23],s48 offen offset:1024 sc1
M v[92:95],a[220:223],a[172:175],v[92:95]
M v[92:95],a[200:203],a[100:103],v[92:95]
M v[92:95],a[228:231],a[176:179],v[92:95]
s_waitcnt vmcnt(26) lgkmcnt(3)
M v[32:35],a[104:107],a[180:183],v[32:35]
s_waitcnt vmcnt(25) lgkmcnt(2)
buffer_load_dwordx4 a[156:159],v250,s[20:23],s48 offen offset:2048 sc1
M v[32:35],a[140:143],a[132:135],v[32:35]
s_waitcnt vmcnt(25) lgkmcnt(1)
ds_read_b128 a[160:163],v248 offset:18432
ds_read_b128 a[136:139],v249 offset:18432
M v[32:35],a[116:119],a[120:123],v[32:35]
s_waitcnt lgkmcnt(2)
M v[36:39],a[116:119],a[96:99],v[36:39]
M v[36:39],a[140:143],a[120:123],v[36:39]
M v[36:39],a[104:107],a[132:135],v[36:39]
M v[40:43],a[104:107],a[120:123],v[40:43]
ds_read_b128 a[124:127],v248 offset:18944
M v[40:43],a[140:143],a[96:99],v[40:43]
s_waitcnt lgkmcnt(2)
ds_read_b128 a[172:175],v249 offset:18944
M v[40:43],a[116:119],a[160:163],v[40:43]
s_waitcnt lgkmcnt(2)
M v[44:47],a[116:119],a[136:139],v[44:47]
M v[44:47],a[140:143],a[160:163],v[44:47]
M v[44:47],a[104:107],a[96:99],v[44:47]
s_add_u32 s34,s33,7471104
buffer_store_dwordx4 v[152:155],v253,s[24:27],s34 offen offset:1280 nt
M v[48:51],a[104:107],a[160:163],v[48:51]
s_add_u32 s48,s75,52224
ds_read_b128 a[100:103],v249 offset:19456
M v[48:51],a[140:143],a[136:139],v[48:51]
s_waitcnt lgkmcnt(2)
ds_read_b128 a[176:179],v248 offset:19456
M v[48:51],a[116:119],a[124:127],v[48:51]
s_waitcnt lgkmcnt(2)
M v[52:55],a[116:119],a[172:175],v[52:55]
M v[52:55],a[140:143],a[124:127],v[52:55]
M v[52:55],a[104:107],a[136:139],v[52:55]
M v[56:59],a[104:107],a[124:127],v[56:59]
buffer_load_dwordx4 a[248:251],v250,s[20:23],s48 offen offset:0 sc1
M v[56:59],a[140:143],a[172:175],v[56:59]
s_waitcnt lgkmcnt(1)
M v[56:59],a[116:119],a[100:103],v[56:59]
s_waitcnt lgkmcnt(0)
buffer_load_dwordx4 a[212:215],v250,s[20:23],s48 offen offset:1024 sc1
M v[60:63],a[116:119],a[176:179],v[60:63]
M v[60:63],a[140:143],a[100:103],v[60:63]
M v[60:63],a[104:107],a[172:175],v[60:63]
s_waitcnt vmcnt(26)
M v[64:67],a[188:191],a[180:183],v[64:67]
s_waitcnt vmcnt(25)
buffer_load_dwordx4 v[228:231],v250,s[20:23],s48 offen offset:2048 sc1
M v[64:67],v[216:219],a[132:135],v[64:67]
s_waitcnt vmcnt(25)
M v[64:67],a[192:195],a[120:123],v[64:67]
M v[68:71],a[192:195],a[96:99],v[68:71]
M v[68:71],v[216:219],a[120:123],v[68:71]
M v[68:71],a[188:191],a[132:135],v[68:71]
M v[72:75],a[188:191],a[120:123],v[72:75]
M v[72:75],v[216:219],a[96:99],v[72:75]
M v[72:75],a[192:195],a[160:163],v[72:75]
M v[76:79],a[192:195],a[136:139],v[76:79]
M v[76:79],v[216:219],a[160:163],v[76:79]
M v[76:79],a[188:191],a[96:99],v[76:79]
M v[80:83],a[188:191],a[160:163],v[80:83]
s_add_u32 s48,s76,52224
M v[80:83],v[216:219],a[136:139],v[80:83]
v_add_u32 v248,0xffff1200,v248
v_add_u32 v249,0xffff1200,v249
M v[80:83],a[192:195],a[124:127],v[80:83]
M v[84:87],a[192:195],a[172:175],v[84:87]
M v[84:87],v[216:219],a[124:127],v[84:87]
ds_read_b128 a[116:119],v248 offset:8704
M v[84:87],a[188:191],a[136:139],v[84:87]
ds_read_b128 a[140:143],v249 offset:8704
M v[88:91],a[188:191],a[124:127],v[88:91]
buffer_load_dwordx4 a[104:107],v250,s[20:23],s48 offen offset:0 sc1
M v[88:91],v[216:219],a[172:175],v[88:91]
ds_read_b128 a[180:183],v248 offset:9216
ds_read_b128 a[120:123],v249 offset:9216
M v[88:91],a[192:195],a[100:103],v[88:91]
buffer_load_dwordx4 a[132:135],v250,s[20:23],s48 offen offset:1024 sc1
M v[92:95],a[192:195],a[176:179],v[92:95]
M v[92:95],v[216:219],a[100:103],v[92:95]
M v[92:95],a[188:191],a[172:175],v[92:95]
s_waitcnt vmcnt(25) lgkmcnt(3)
M v[32:35],a[128:131],a[116:119],v[32:35]
s_waitcnt vmcnt(24) lgkmcnt(2)
buffer_load_dwordx4 a[96:99],v250,s[20:23],s48 offen offset:2048 sc1
M v[32:35],a[108:111],a[140:143],v[32:35]
s_waitcnt vmcnt(24) lgkmcnt(1)
ds_read_b128 a[160:163],v248 offset:9728
ds_read_b128 a[136:139],v249 offset:9728
M v[32:35],a[152:155],a[180:183],v[32:35]
s_waitcnt lgkmcnt(2)
M v[36:39],a[152:155],a[120:123],v[36:39]
M v[36:39],a[108:111],a[180:183],v[36:39]
M v[36:39],a[128:131],a[140:143],v[36:39]
s_nop 3
v_cvt_pk_bf16_f32 v32,v32,v33
v_cvt_pk_bf16_f32 v33,v34,v35
M v[40:43],a[128:131],a[180:183],v[40:43]
ds_read_b128 a[124:127],v248 offset:10240
M v[40:43],a[108:111],a[120:123],v[40:43]
s_waitcnt lgkmcnt(2)
ds_read_b128 a[176:179],v249 offset:10240
M v[40:43],a[152:155],a[160:163],v[40:43]
s_waitcnt lgkmcnt(2)
v_cvt_pk_bf16_f32 v36,v36,v37
v_cvt_pk_bf16_f32 v37,v38,v39
M v[44:47],a[152:155],a[136:139],v[44:47]
ds_write2st64_b64 v254,v[32:33],v[36:37] offset0:34 offset1:38
M v[44:47],a[108:111],a[160:163],v[44:47]
M v[44:47],a[128:131],a[120:123],v[44:47]
s_nop 0
v_cvt_pk_bf16_f32 v40,v40,v41
v_cvt_pk_bf16_f32 v41,v42,v43
M v[48:51],a[128:131],a[160:163],v[48:51]
s_add_u32 s48,s77,52224
ds_read_b128 a[100:103],v249 offset:10752
M v[48:51],a[108:111],a[136:139],v[48:51]
s_waitcnt lgkmcnt(3)
ds_read_b128 a[172:175],v248 offset:10752
M v[48:51],a[152:155],a[124:127],v[48:51]
s_waitcnt lgkmcnt(3)
v_cvt_pk_bf16_f32 v44,v44,v45
v_cvt_pk_bf16_f32 v45,v46,v47
M v[52:55],a[152:155],a[176:179],v[52:55]
ds_write2st64_b64 v254,v[40:41],v[44:45] offset0:42 offset1:46
M v[52:55],a[108:111],a[124:127],v[52:55]
M v[52:55],a[128:131],a[136:139],v[52:55]
s_nop 0
v_cvt_pk_bf16_f32 v48,v48,v49
v_cvt_pk_bf16_f32 v49,v50,v51
M v[56:59],a[128:131],a[124:127],v[56:59]
buffer_load_dwordx4 a[188:191],v250,s[20:23],s48 offen offset:0 sc1
M v[56:59],a[108:111],a[176:179],v[56:59]
s_waitcnt lgkmcnt(2)
M v[56:59],a[152:155],a[100:103],v[56:59]
s_waitcnt lgkmcnt(1)
buffer_load_dwordx4 v[224:227],v250,s[20:23],s48 offen offset:1024 sc1
M v[60:63],a[152:155],a[172:175],v[60:63]
v_cvt_pk_bf16_f32 v52,v52,v53
v_cvt_pk_bf16_f32 v53,v54,v55
M v[60:63],a[108:111],a[100:103],v[60:63]
ds_write2st64_b64 v254,v[48:49],v[52:53] offset0:51 offset1:55
M v[60:63],a[128:131],a[176:179],v[60:63]
s_waitcnt vmcnt(24)
v_cvt_pk_bf16_f32 v56,v56,v57
v_cvt_pk_bf16_f32 v57,v58,v59
M v[64:67],a[236:239],a[116:119],v[64:67]
s_waitcnt vmcnt(22)
buffer_load_dwordx4 a[204:207],v250,s[20:23],s48 offen offset:2048 sc1
M v[64:67],a[244:247],a[140:143],v[64:67]
s_waitcnt vmcnt(22)
M v[64:67],v[220:223],a[180:183],v[64:67]
v_cvt_pk_bf16_f32 v60,v60,v61
v_cvt_pk_bf16_f32 v61,v62,v63
M v[68:71],v[220:223],a[120:123],v[68:71]
ds_write2st64_b64 v254,v[56:57],v[60:61] offset0:59 offset1:63
M v[68:71],a[244:247],a[180:183],v[68:71]
M v[68:71],a[236:239],a[140:143],v[68:71]
s_nop 1
v_cvt_pk_bf16_f32 v64,v64,v65
v_cvt_pk_bf16_f32 v65,v66,v67
M v[72:75],a[236:239],a[180:183],v[72:75]
M v[72:75],a[244:247],a[120:123],v[72:75]
M v[72:75],v[220:223],a[160:163],v[72:75]
s_nop 0
v_cvt_pk_bf16_f32 v68,v68,v69
v_cvt_pk_bf16_f32 v69,v70,v71
M v[76:79],v[220:223],a[136:139],v[76:79]
ds_write2st64_b64 v254,v[64:65],v[68:69] offset0:0 offset1:4
M v[76:79],a[244:247],a[160:163],v[76:79]
M v[76:79],a[236:239],a[120:123],v[76:79]
s_nop 0
v_cvt_pk_bf16_f32 v72,v72,v73
v_cvt_pk_bf16_f32 v73,v74,v75
M v[80:83],a[236:239],a[160:163],v[80:83]
M v[80:83],a[244:247],a[136:139],v[80:83]
M v[80:83],v[220:223],a[124:127],v[80:83]
s_nop 1
v_cvt_pk_bf16_f32 v76,v76,v77
v_cvt_pk_bf16_f32 v77,v78,v79
M v[84:87],v[220:223],a[176:179],v[84:87]
ds_write2st64_b64 v254,v[72:73],v[76:77] offset0:8 offset1:12
M v[84:87],a[244:247],a[124:127],v[84:87]
ds_read_b128 a[152:155],v248 offset:0
M v[84:87],a[236:239],a[136:139],v[84:87]
ds_read_b128 a[108:111],v249 offset:0
v_cvt_pk_bf16_f32 v80,v80,v81
M v[88:91],a[236:239],a[124:127],v[88:91]
ds_read_b128 a[128:131],v248 offset:512
v_cvt_pk_bf16_f32 v81,v82,v83
M v[88:91],a[244:247],a[176:179],v[88:91]
ds_read_b128 a[116:119],v249 offset:512
M v[88:91],v[220:223],a[100:103],v[88:91]
v_cvt_pk_bf16_f32 v84,v84,v85
v_cvt_pk_bf16_f32 v85,v86,v87
M v[92:95],v[220:223],a[172:175],v[92:95]
ds_write2st64_b64 v254,v[80:81],v[84:85] offset0:17 offset1:21
M v[92:95],a[244:247],a[100:103],v[92:95]
M v[92:95],a[236:239],a[176:179],v[92:95]
s_waitcnt vmcnt(20) lgkmcnt(4)
s_nop 0
v_cvt_pk_bf16_f32 v88,v88,v89
v_cvt_pk_bf16_f32 v89,v90,v91
M v[160:163],a[144:147],a[152:155],v[160:163]
s_waitcnt vmcnt(19) lgkmcnt(3)
ds_read_b128 a[140:143],v248 offset:1024
M v[160:163],a[112:115],a[108:111],v[160:163]
s_waitcnt vmcnt(18) lgkmcnt(3)
ds_read_b128 a[180:183],v249 offset:1024
M v[160:163],a[164:167],a[128:131],v[160:163]
s_waitcnt lgkmcnt(3)
v_cvt_pk_bf16_f32 v92,v92,v93
v_cvt_pk_bf16_f32 v93,v94,v95
M v[164:167],a[164:167],a[116:119],v[164:167]
ds_write2st64_b64 v254,v[88:89],v[92:93] offset0:25 offset1:29
M v[164:167],a[112:115],a[128:131],v[164:167]
M v[164:167],a[144:147],a[108:111],v[164:167]
M v[168:171],a[144:147],a[128:131],v[168:171]
s_waitcnt lgkmcnt(0)
s_barrier
ds_read_b128 v[32:35],v250 offset:17408
M v[168:171],a[112:115],a[116:119],v[168:171]
ds_read_b128 v[40:43],v250 offset:21504
ds_read_b128 v[48:51],v250 offset:26112
M v[168:171],a[164:167],a[140:143],v[168:171]
ds_read_b128 v[56:59],v250 offset:30208
ds_read_b128 v[64:67],v250 offset:0
M v[172:175],a[164:167],a[180:183],v[172:175]
ds_read_b128 v[72:75],v250 offset:4096
ds_read_b128 v[80:83],v250 offset:8704
ds_read_b128 a[120:123],v248 offset:1536
M v[172:175],a[112:115],a[140:143],v[172:175]
ds_read_b128 v[88:91],v250 offset:12800
ds_read_b128 a[160:163],v249 offset:1536
M v[172:175],a[144:147],a[116:119],v[172:175]
s_waitcnt lgkmcnt(9)
s_add_u32 s34,s33,6291456
buffer_store_dwordx4 v[32:35],v253,s[24:27],s34 offen offset:128 nt
M v[176:179],a[144:147],a[140:143],v[176:179]
s_add_u32 s34,s33,6684672
ds_read_b128 a[136:139],v249 offset:2048
M v[176:179],a[112:115],a[180:183],v[176:179]
s_waitcnt lgkmcnt(3)
ds_read_b128 a[124:127],v248 offset:2048
M v[176:179],a[164:167],a[120:123],v[176:179]
s_waitcnt lgkmcnt(2)
buffer_store_dwordx4 v[40:43],v253,s[24:27],s34 offen offset:128 nt
M v[180:183],a[164:167],a[160:163],v[180:183]
s_add_u32 s34,s33,7077888
M v[180:183],a[112:115],a[120:123],v[180:183]
ds_read_b128 a[172:175],v248 offset:34816
M v[180:183],a[144:147],a[180:183],v[180:183]
buffer_store_dwordx4 v[48:51],v253,s[24:27],s34 offen offset:128 nt
M v[184:187],a[144:147],a[120:123],v[184:187]
s_add_u32 s34,s33,7471104
ds_read_b128 a[100:103],v249 offset:34816
ds_read_b128 a[176:179],v248 offset:35328
M v[184:187],a[112:115],a[160:163],v[184:187]
s_waitcnt lgkmcnt(4)
ds_read_b128 a[152:155],v249 offset:35328
M v[184:187],a[164:167],a[136:139],v[184:187]
s_waitcnt lgkmcnt(4)
buffer_store_dwordx4 v[56:59],v253,s[24:27],s34 offen offset:128 nt
M v[188:191],a[164:167],a[124:127],v[188:191]
M v[188:191],a[112:115],a[136:139],v[188:191]
M v[188:191],a[144:147],a[160:163],v[188:191]
s_waitcnt vmcnt(20) lgkmcnt(3)
M v[160:163],a[184:187],a[172:175],v[160:163]
s_waitcnt vmcnt(19) lgkmcnt(2)
ds_read_b128 a[108:111],v248 offset:35840
M v[160:163],a[232:235],a[100:103],v[160:163]
s_waitcnt vmcnt(18) lgkmcnt(2)
s_add_u32 s34,s33,6291456
ds_read_b128 a[128:131],v249 offset:35840
M v[160:163],a[216:219],a[176:179],v[160:163]
s_waitcnt lgkmcnt(2)
buffer_store_dwordx4 v[64:67],v253,s[24:27],s34 offen offset:256 nt
M v[164:167],a[216:219],a[152:155],v[164:167]
M v[164:167],a[232:235],a[176:179],v[164:167]
M v[164:167],a[184:187],a[100:103],v[164:167]
M v[168:171],a[184:187],a[176:179],v[168:171]
ds_read_b128 a[116:119],v248 offset:36352
M v[168:171],a[232:235],a[152:155],v[168:171]
s_waitcnt lgkmcnt(2)
ds_read_b128 a[140:143],v249 offset:36352
M v[168:171],a[216:219],a[108:111],v[168:171]
s_waitcnt lgkmcnt(2)
M v[172:175],a[216:219],a[128:131],v[172:175]
M v[172:175],a[232:235],a[108:111],v[172:175]
M v[172:175],a[184:187],a[152:155],v[172:175]
M v[176:179],a[184:187],a[108:111],v[176:179]
ds_read_b128 a[180:183],v249 offset:36864
M v[176:179],a[232:235],a[128:131],v[176:179]
s_waitcnt lgkmcnt(2)
ds_read_b128 a[120:123],v248 offset:36864
M v[176:179],a[216:219],a[116:119],v[176:179]
s_waitcnt lgkmcnt(2)
M v[180:183],a[216:219],a[140:143],v[180:183]
M v[180:183],a[232:235],a[116:119],v[180:183]
ds_read_b128 a[124:127],v248 offset:52224
M v[180:183],a[184:187],a[128:131],v[180:183]
ds_read_b128 a[164:167],v249 offset:52224
M v[184:187],a[184:187],a[116:119],v[184:187]
ds_read_b128 a[112:115],v248 offset:52736
M v[184:187],a[232:235],a[140:143],v[184:187]
s_waitcnt lgkmcnt(4)
ds_read_b128 a[136:139],v249 offset:52736
M v[184:187],a[216:219],a[180:183],v[184:187]
s_waitcnt lgkmcnt(4)
M v[188:191],a[216:219],a[120:123],v[188:191]
M v[188:191],a[232:235],a[180:183],v[188:191]
M v[188:191],a[184:187],a[140:143],v[188:191]
s_waitcnt vmcnt(17) lgkmcnt(3)
s_add_u32 s34,s33,6684672
buffer_store_dwordx4 v[72:75],v253,s[24:27],s34 offen offset:256 nt
M v[160:163],a[148:151],a[124:127],v[160:163]
s_waitcnt vmcnt(17) lgkmcnt(2)
ds_read_b128 a[144:147],v248 offset:53248
M v[160:163],a[168:171],a[164:167],v[160:163]
s_waitcnt vmcnt(16) lgkmcnt(2)
ds_read_b128 a[160:163],v249 offset:53248
M v[160:163],a[156:159],a[112:115],v[160:163]
s_waitcnt lgkmcnt(2)
M v[164:167],a[156:159],a[136:139],v[164:167]
M v[164:167],a[168:171],a[112:115],v[164:167]
M v[164:167],a[148:151],a[164:167],v[164:167]
M v[168:171],a[148:151],a[112:115],v[168:171]
ds_read_b128 a[172:175],v248 offset:53760
M v[168:171],a[168:171],a[136:139],v[168:171]
s_waitcnt lgkmcnt(2)
ds_read_b128 a[100:103],v249 offset:53760
M v[168:171],a[156:159],a[144:147],v[168:171]
s_waitcnt lgkmcnt(2)
M v[172:175],a[156:159],a[160:163],v[172:175]
M v[172:175],a[168:171],a[144:147],v[172:175]
M v[172:175],a[148:151],a[136:139],v[172:175]
M v[176:179],a[148:151],a[144:147],v[176:179]
ds_read_b128 a[176:179],v249 offset:54272
M v[176:179],a[168:171],a[160:163],v[176:179]
s_waitcnt lgkmcnt(2)
ds_read_b128 a[152:155],v248 offset:54272
v_add_u32 v248,0x11000,v248
M v[176:179],a[156:159],a[172:175],v[176:179]
s_waitcnt lgkmcnt(2)
v_add_u32 v249,0x11000,v249
M v[180:183],a[156:159],a[100:103],v[180:183]
M v[180:183],a[168:171],a[172:175],v[180:183]
ds_read_b128 a[108:111],v248 offset:0
M v[180:183],a[148:151],a[160:163],v[180:183]
ds_read_b128 a[128:131],v249 offset:0
M v[184:187],a[148:151],a[172:175],v[184:187]
ds_read_b128 a[116:119],v248 offset:512
M v[184:187],a[168:171],a[100:103],v[184:187]
s_waitcnt lgkmcnt(4)
ds_read_b128 a[120:123],v249 offset:512
M v[184:187],a[156:159],a[176:179],v[184:187]
s_waitcnt lgkmcnt(4)
M v[188:191],a[156:159],a[152:155],v[188:191]
s_add_u32 s34,s33,7077888
M v[188:191],a[168:171],a[176:179],v[188:191]
M v[188:191],a[148:151],a[100:103],v[188:191]
s_waitcnt vmcnt(14) lgkmcnt(3)
buffer_store_dwordx4 v[80:83],v253,s[24:27],s34 offen offset:256 nt
M v[160:163],a[248:251],a[108:111],v[160:163]
s_waitcnt vmcnt(14) lgkmcnt(2)
ds_read_b128 a[180:183],v248 offset:1024
M v[160:163],a[212:215],a[128:131],v[160:163]
s_waitcnt vmcnt(13) lgkmcnt(2)
ds_read_b128 a[140:143],v249 offset:1024
M v[160:163],v[228:231],a[116:119],v[160:163]
s_waitcnt lgkmcnt(2)
M v[164:167],v[228:231],a[120:123],v[164:167]
M v[164:167],a[212:215],a[116:119],v[164:167]
M v[164:167],a[248:251],a[128:131],v[164:167]
M v[168:171],a[248:251],a[116:119],v[168:171]
ds_read_b128 a[184:187],v248 offset:1536
M v[168:171],a[212:215],a[120:123],v[168:171]
s_waitcnt lgkmcnt(2)
ds_read_b128 a[124:127],v249 offset:1536
M v[168:171],v[228:231],a[180:183],v[168:171]
s_waitcnt lgkmcnt(2)
M v[172:175],v[228:231],a[140:143],v[172:175]
M v[172:175],a[212:215],a[180:183],v[172:175]
M v[172:175],a[248:251],a[120:123],v[172:175]
M v[176:179],a[248:251],a[180:183],v[176:179]
ds_read_b128 a[164:167],v249 offset:2048
M v[176:179],a[212:215],a[140:143],v[176:179]
s_waitcnt lgkmcnt(2)
ds_read_b128 a[112:115],v248 offset:2048
M v[176:179],v[228:231],a[184:187],v[176:179]
s_waitcnt lgkmcnt(2)
M v[180:183],v[228:231],a[124:127],v[180:183]
M v[180:183],a[212:215],a[184:187],v[180:183]
ds_read_b128 a[136:139],v248 offset:17408
M v[180:183],a[248:251],a[140:143],v[180:183]
ds_read_b128 a[144:147],v249 offset:17408
M v[184:187],a[248:251],a[184:187],v[184:187]
ds_read_b128 a[160:163],v248 offset:17920
M v[184:187],a[212:215],a[124:127],v[184:187]
s_waitcnt lgkmcnt(4)
s_add_u32 s34,s33,7471104
ds_read_b128 a[172:175],v249 offset:17920
M v[184:187],v[228:231],a[164:167],v[184:187]
s_waitcnt lgkmcnt(4)
buffer_store_dwordx4 v[88:91],v253,s[24:27],s34 offen offset:256 nt
M v[188:191],v[228:231],a[112:115],v[188:191]
M v[188:191],a[212:215],a[164:167],v[188:191]
M v[188:191],a[248:251],a[124:127],v[188:191]
s_waitcnt vmcnt(13) lgkmcnt(3)
M v[160:163],a[104:107],a[136:139],v[160:163]
s_waitcnt vmcnt(12) lgkmcnt(2)
ds_read_b128 a[152:155],v248 offset:18432
M v[160:163],a[132:135],a[144:147],v[160:163]
s_waitcnt vmcnt(11) lgkmcnt(2)
ds_read_b128 a[156:159],v249 offset:18432
M v[160:163],a[96:99],a[160:163],v[160:163]
s_waitcnt lgkmcnt(2)
M v[164:167],a[96:99],a[172:175],v[164:167]
M v[164:167],a[132:135],a[160:163],v[164:167]
M v[164:167],a[104:107],a[144:147],v[164:167]
M v[168:171],a[104:107],a[160:163],v[168:171]
ds_read_b128 a[168:171],v248 offset:18944
M v[168:171],a[132:135],a[172:175],v[168:171]
s_waitcnt lgkmcnt(2)
ds_read_b128 a[176:179],v249 offset:18944
M v[168:171],a[96:99],a[152:155],v[168:171]
s_waitcnt lgkmcnt(2)
M v[172:175],a[96:99],a[156:159],v[172:175]
M v[172:175],a[132:135],a[152:155],v[172:175]
M v[172:175],a[104:107],a[172:175],v[172:175]
M v[176:179],a[104:107],a[152:155],v[176:179]
ds_read_b128 a[100:103],v249 offset:19456
M v[176:179],a[132:135],a[156:159],v[176:179]
s_waitcnt lgkmcnt(2)
ds_read_b128 a[148:151],v248 offset:19456
v_add_u32 v248,0xffff3400,v248
M v[176:179],a[96:99],a[168:171],v[176:179]
s_waitcnt lgkmcnt(2)
v_add_u32 v249,0xffff3400,v249
M v[180:183],a[96:99],a[176:179],v[180:183]
M v[180:183],a[132:135],a[168:171],v[180:183]
ds_read_b128 a[108:111],v248 offset:0
M v[180:183],a[104:107],a[156:159],v[180:183]
ds_read_b128 a[128:131],v249 offset:0
M v[184:187],a[104:107],a[168:171],v[184:187]
ds_read_b128 a[116:119],v248 offset:512
M v[184:187],a[132:135],a[176:179],v[184:187]
s_waitcnt lgkmcnt(4)
ds_read_b128 a[120:123],v249 offset:512
M v[184:187],a[96:99],a[100:103],v[184:187]
s_waitcnt lgkmcnt(4)
M v[188:191],a[96:99],a[148:151],v[188:191]
M v[188:191],a[132:135],a[100:103],v[188:191]
M v[188:191],a[104:107],a[176:179],v[188:191]
s_waitcnt vmcnt(10) lgkmcnt(3)
M v[160:163],a[188:191],a[108:111],v[160:163]
s_waitcnt vmcnt(9) lgkmcnt(2)
ds_read_b128 a[180:183],v248 offset:1024
M v[160:163],v[224:227],a[128:131],v[160:163]
s_waitcnt vmcnt(8) lgkmcnt(2)
ds_read_b128 a[140:143],v249 offset:1024
M v[160:163],a[204:207],a[116:119],v[160:163]
s_waitcnt lgkmcnt(2)
M v[164:167],a[204:207],a[120:123],v[164:167]
M v[164:167],v[224:227],a[116:119],v[164:167]
M v[164:167],a[188:191],a[128:131],v[164:167]
s_nop 3
v_cvt_pk_bf16_f32 v160,v160,v161
v_cvt_pk_bf16_f32 v161,v162,v163
M v[168:171],a[188:191],a[116:119],v[168:171]
ds_read_b128 a[184:187],v248 offset:1536
M v[168:171],v[224:227],a[120:123],v[168:171]
s_waitcnt lgkmcnt(2)
ds_read_b128 a[112:115],v249 offset:1536
M v[168:171],a[204:207],a[180:183],v[168:171]
s_waitcnt lgkmcnt(2)
v_cvt_pk_bf16_f32 v164,v164,v165
v_cvt_pk_bf16_f32 v165,v166,v167
M v[172:175],a[204:207],a[140:143],v[172:175]
ds_write2st64_b64 v254,v[160:161],v[164:165] offset0:68 offset1:72
M v[172:175],v[224:227],a[180:183],v[172:175]
M v[172:175],a[188:191],a[120:123],v[172:175]
s_nop 0
v_cvt_pk_bf16_f32 v168,v168,v169
v_cvt_pk_bf16_f32 v169,v170,v171
M v[176:179],a[188:191],a[180:183],v[176:179]
ds_read_b128 a[164:167],v249 offset:2048
M v[176:179],v[224:227],a[140:143],v[176:179]
s_waitcnt lgkmcnt(3)
ds_read_b128 a[124:127],v248 offset:2048
M v[176:179],a[204:207],a[184:187],v[176:179]
s_waitcnt lgkmcnt(3)
v_cvt_pk_bf16_f32 v172,v172,v173
v_cvt_pk_bf16_f32 v173,v174,v175
M v[180:183],a[204:207],a[112:115],v[180:183]
ds_write2st64_b64 v254,v[168:169],v[172:173] offset0:76 offset1:80
M v[180:183],v[224:227],a[184:187],v[180:183]
M v[180:183],a[188:191],a[140:143],v[180:183]
s_nop 0
v_cvt_pk_bf16_f32 v176,v176,v177
v_cvt_pk_bf16_f32 v177,v178,v179
M v[184:187],a[188:191],a[184:187],v[184:187]
M v[184:187],v[224:227],a[112:115],v[184:187]
s_waitcnt lgkmcnt(2)
M v[184:187],a[204:207],a[164:167],v[184:187]
s_waitcnt lgkmcnt(1)
v_cvt_pk_bf16_f32 v180,v180,v181
v_cvt_pk_bf16_f32 v181,v182,v183
M v[188:191],a[204:207],a[124:127],v[188:191]
ds_write2st64_b64 v254,v[176:177],v[180:181] offset0:85 offset1:89
M v[188:191],v[224:227],a[164:167],v[188:191]
M v[188:191],a[188:191],a[112:115],v[188:191]
s_nop 0
v_cvt_pk_bf16_f32 v184,v184,v185
v_cvt_pk_bf16_f32 v185,v186,v187
s_nop 4
v_cvt_pk_bf16_f32 v188,v188,v189
v_cvt_pk_bf16_f32 v189,v190,v191
ds_write2st64_b64 v254,v[184:185],v[188:189] offset0:93 offset1:97
s_waitcnt lgkmcnt(0)
s_barrier
ds_read_b128 v[160:163],v250 offset:34816
ds_read_b128 v[168:171],v250 offset:38912
ds_read_b128 v[176:179],v250 offset:43520
ds_read_b128 v[184:187],v250 offset:47616
s_add_u32 s34,s33,6291456
s_waitcnt lgkmcnt(3)
buffer_store_dwordx4 v[160:163],v253,s[24:27],s34 offen offset:1408 nt
s_add_u32 s34,s33,6684672
s_waitcnt lgkmcnt(2)
buffer_store_dwordx4 v[168:171],v253,s[24:27],s34 offen offset:1408 nt
s_add_u32 s34,s33,7077888
s_waitcnt lgkmcnt(1)
buffer_store_dwordx4 v[176:179],v253,s[24:27],s34 offen offset:1408 nt
s_add_u32 s34,s33,7471104
s_waitcnt lgkmcnt(0)
buffer_store_dwordx4 v[184:187],v253,s[24:27],s34 offen offset:1408 nt
s_endpgm
L_code_end:
L_fallback:
s_mov_b32 s84,0
L_itemF:
s_and_b32 s85,s84,3
s_lshr_b32 s86,s84,2
s_mul_hi_u32 s87,s86,0x55555556
s_mul_i32 s88,s87,3
s_sub_u32 s86,s86,s88
s_mul_hi_u32 s88,s87,0x2aaaaaab
s_mul_i32 s89,s88,6
s_sub_u32 s87,s87,s89
s_mul_i32 s89,s86,221184
s_mul_i32 s90,s87,12288
s_add_u32 s89,s89,s90
s_mul_i32 s90,s85,3072
s_add_u32 s89,s89,s90
s_lshl_b32 s90,s88,7
s_add_u32 s89,s89,s90
s_add_u32 s90,s89,73728
s_add_u32 s91,s90,73728
v_lshlrev_b32 v149,1,v164
buffer_load_short_d16_hi v68,v149,s[36:39],s89 offen offset:0
buffer_load_short_d16_hi v69,v149,s[36:39],s89 offen offset:384
buffer_load_short_d16_hi v70,v149,s[36:39],s89 offen offset:768
buffer_load_short_d16_hi v71,v149,s[36:39],s89 offen offset:1152
buffer_load_short_d16_hi v72,v149,s[36:39],s89 offen offset:1536
buffer_load_short_d16_hi v73,v149,s[36:39],s89 offen offset:1920
buffer_load_short_d16_hi v74,v149,s[36:39],s89 offen offset:2304
buffer_load_short_d16_hi v75,v149,s[36:39],s89 offen offset:2688
buffer_load_short_d16_hi v76,v149,s[36:39],s90 offen offset:0
buffer_load_short_d16_hi v77,v149,s[36:39],s90 offen offset:384
buffer_load_short_d16_hi v78,v149,s[36:39],s90 offen offset:768
buffer_load_short_d16_hi v79,v149,s[36:39],s90 offen offset:1152
buffer_load_short_d16_hi v80,v149,s[36:39],s90 offen offset:1536
buffer_load_short_d16_hi v81,v149,s[36:39],s90 offen offset:1920
buffer_load_short_d16_hi v82,v149,s[36:39],s90 offen offset:2304
buffer_load_short_d16_hi v83,v149,s[36:39],s90 offen offset:2688
buffer_load_short_d16_hi v84,v149,s[36:39],s91 offen offset:0
buffer_load_short_d16_hi v85,v149,s[36:39],s91 offen offset:384
buffer_load_short_d16_hi v86,v149,s[36:39],s91 offen offset:768
buffer_load_short_d16_hi v87,v149,s[36:39],s91 offen offset:1152
buffer_load_short_d16_hi v88,v149,s[36:39],s91 offen offset:1536
buffer_load_short_d16_hi v89,v149,s[36:39],s91 offen offset:1920
buffer_load_short_d16_hi v90,v149,s[36:39],s91 offen offset:2304
buffer_load_short_d16_hi v91,v149,s[36:39],s91 offen offset:2688
s_and_b32 s92,s85,1
s_lshl_b32 s92,s92,2
s_lshr_b32 s85,s85,1
s_lshl_b32 s85,s85,2
v_bfe_u32 v148,v164,2,2
v_or_b32 v148,s92,v148
v_and_b32 v151,3,v164
v_or_b32 v151,s85,v151
v_xor_b32 v151,v151,v148
v_lshrrev_b32 v150,4,v164
v_mul_u32_u24 v150,331776,v150
v_lshl_add_u32 v150,v148,7,v150
v_lshl_add_u32 v150,v151,4,v150
s_mul_i32 s87,s87,55296
s_mul_i32 s88,s88,3072
s_add_u32 s87,s87,s88
s_lshl_b32 s86,s86,10
s_add_u32 s87,s87,s86
s_mov_b32 s85,0xbe2aaaab
s_mov_b32 s86,0x3d2aaaab
s_mov_b32 s88,0x3e2aaaab
s_mov_b32 s92,0x3daaaaab
s_waitcnt vmcnt(0)
v_add_f32 v148,v68,v84
v_add_f32 v92,v148,v76
v_sub_f32 v100,v148,v76
v_mul_f32 v92,s85,v92
v_mul_f32 v100,s85,v100
v_mul_f32 v148,s86,v68
v_fmac_f32 v148,s88,v84
v_fma_f32 v108,s92,v76,v148
v_fma_f32 v116,-s92,v76,v148
v_add_f32 v148,v69,v85
v_add_f32 v93,v148,v77
v_sub_f32 v101,v148,v77
v_mul_f32 v93,s85,v93
v_mul_f32 v101,s85,v101
v_mul_f32 v148,s86,v69
v_fmac_f32 v148,s88,v85
v_fma_f32 v109,s92,v77,v148
v_fma_f32 v117,-s92,v77,v148
v_add_f32 v148,v70,v86
v_add_f32 v94,v148,v78
v_sub_f32 v102,v148,v78
v_mul_f32 v94,s85,v94
v_mul_f32 v102,s85,v102
v_mul_f32 v148,s86,v70
v_fmac_f32 v148,s88,v86
v_fma_f32 v110,s92,v78,v148
v_fma_f32 v118,-s92,v78,v148
v_add_f32 v148,v71,v87
v_add_f32 v95,v148,v79
v_sub_f32 v103,v148,v79
v_mul_f32 v95,s85,v95
v_mul_f32 v103,s85,v103
v_mul_f32 v148,s86,v71
v_fmac_f32 v148,s88,v87
v_fma_f32 v111,s92,v79,v148
v_fma_f32 v119,-s92,v79,v148
v_add_f32 v148,v72,v88
v_add_f32 v96,v148,v80
v_sub_f32 v104,v148,v80
v_mul_f32 v96,s85,v96
v_mul_f32 v104,s85,v104
v_mul_f32 v148,s86,v72
v_fmac_f32 v148,s88,v88
v_fma_f32 v112,s92,v80,v148
v_fma_f32 v120,-s92,v80,v148
v_add_f32 v148,v73,v89
v_add_f32 v97,v148,v81
v_sub_f32 v105,v148,v81
v_mul_f32 v97,s85,v97
v_mul_f32 v105,s85,v105
v_mul_f32 v148,s86,v73
v_fmac_f32 v148,s88,v89
v_fma_f32 v113,s92,v81,v148
v_fma_f32 v121,-s92,v81,v148
v_add_f32 v148,v74,v90
v_add_f32 v98,v148,v82
v_sub_f32 v106,v148,v82
v_mul_f32 v98,s85,v98
v_mul_f32 v106,s85,v106
v_mul_f32 v148,s86,v74
v_fmac_f32 v148,s88,v90
v_fma_f32 v114,s92,v82,v148
v_fma_f32 v122,-s92,v82,v148
v_add_f32 v148,v75,v91
v_add_f32 v99,v148,v83
v_sub_f32 v107,v148,v83
v_mul_f32 v99,s85,v99
v_mul_f32 v107,s85,v107
v_mul_f32 v148,s86,v75
v_fmac_f32 v148,s88,v91
v_fma_f32 v115,s92,v83,v148
v_fma_f32 v123,-s92,v83,v148
v_cvt_pk_bf16_f32 v124,v68,v69
v_cvt_pk_bf16_f32 v125,v70,v71
v_cvt_pk_bf16_f32 v126,v72,v73
v_cvt_pk_bf16_f32 v127,v74,v75
s_add_u32 s89,s87,0
buffer_store_dwordx4 v[124:127],v150,s[20:23],s89 offen sc1
v_cvt_pk_bf16_f32 v144,v84,v85
v_cvt_pk_bf16_f32 v145,v86,v87
v_cvt_pk_bf16_f32 v146,v88,v89
v_cvt_pk_bf16_f32 v147,v90,v91
s_add_u32 s89,s87,46080
buffer_store_dwordx4 v[144:147],v150,s[20:23],s89 offen sc1
v_cvt_pk_bf16_f32 v128,v92,v93
v_cvt_pk_bf16_f32 v129,v94,v95
v_cvt_pk_bf16_f32 v130,v96,v97
v_cvt_pk_bf16_f32 v131,v98,v99
s_add_u32 s89,s87,9216
buffer_store_dwordx4 v[128:131],v150,s[20:23],s89 offen sc1
v_cvt_pk_bf16_f32 v132,v100,v101
v_cvt_pk_bf16_f32 v133,v102,v103
v_cvt_pk_bf16_f32 v134,v104,v105
v_cvt_pk_bf16_f32 v135,v106,v107
s_add_u32 s89,s87,18432
buffer_store_dwordx4 v[132:135],v150,s[20:23],s89 offen sc1
v_cvt_pk_bf16_f32 v136,v108,v109
v_cvt_pk_bf16_f32 v137,v110,v111
v_cvt_pk_bf16_f32 v138,v112,v113
v_cvt_pk_bf16_f32 v139,v114,v115
s_add_u32 s89,s87,27648
buffer_store_dwordx4 v[136:139],v150,s[20:23],s89 offen sc1
v_cvt_pk_bf16_f32 v140,v116,v117
v_cvt_pk_bf16_f32 v141,v118,v119
v_cvt_pk_bf16_f32 v142,v120,v121
v_cvt_pk_bf16_f32 v143,v122,v123
s_add_u32 s89,s87,36864
buffer_store_dwordx4 v[140:143],v150,s[20:23],s89 offen sc1
s_waitcnt vmcnt(0)
s_add_u32 s84,s84,1
s_cmp_lt_u32 s84,216
s_cbranch_scc1 L_itemF
s_branch L_uready
.section .rodata,"a"
.p2align 6
.amdhsa_kernel standalone__winograd__vision_kernel
  .amdhsa_next_free_vgpr 512
  .amdhsa_next_free_sgpr 96
  .amdhsa_accum_offset 256
  .amdhsa_group_segment_fixed_size 0
  .amdhsa_kernarg_size 40
  .amdhsa_user_sgpr_count 2
  .amdhsa_user_sgpr_kernarg_segment_ptr 1
  .amdhsa_system_sgpr_workgroup_id_x 1
  .amdhsa_float_denorm_mode_32 3
.end_amdhsa_kernel
```

```asm
; @launch grid=(256,1,1) block=(256,1,1) lds=156672
.amdgcn_target "amdgcn-amd-amdhsa--gfx950"
.macro M d,a,b,c
v_mfma_f32_16x16x32_bf16 \d,\a,\b,\c
.endm
.text
.globl standalone__winograd__vision_kernel
.p2align 8
.type standalone__winograd__vision_kernel,@function
standalone__winograd__vision_kernel:
s_cmp_ge_u32 s2,256
s_cbranch_scc0 L_go
s_endpgm
L_go:
s_load_dwordx4 s[4:7],s[0:1],0
s_load_dwordx4 s[24:27],s[0:1],16
s_load_dwordx2 s[20:21],s[0:1],32
v_lshlrev_b32 v165,4,v0
s_getpc_b64 s[64:65]
L_pc:
s_lshr_b32 s58,s2,3
s_lshl_b32 s58,s58,12
s_min_u32 s58,s58,L_code_end-L_pc-4096
s_add_u32 s64,s64,s58
s_addc_u32 s65,s65,0
global_load_dword v167,v165,s[64:65]
v_lshrrev_b32 v160,6,v0
v_and_b32 v164,63,v0
v_readfirstlane_b32 s50,v160
v_bfe_u32 v160,v164,3,2
v_bfe_u32 v161,v164,2,1
v_lshl_add_u32 v161,v160,3,v161
v_lshrrev_b32 v162,5,v164
v_xor_b32 v162,v162,v160
v_and_b32 v162,1,v162
v_and_b32 v163,3,v164
v_lshl_add_u32 v162,v162,2,v163
v_mul_u32_u24 v245,196608,v161
v_lshl_add_u32 v245,v162,3,v245
s_and_b32 s54,s2,7
s_lshr_b32 s55,s2,3
s_lshl_b32 s49,s54,6
s_lshl_b32 s55,s55,4
s_lshl_b32 s56,s50,2
s_add_u32 s56,s56,s55
s_mul_i32 s30,s56,384
s_mul_i32 s57,s49,196608
s_add_u32 s30,s30,s57
s_mul_i32 s44,s50,330752
s_mov_b32 s58,0
s_add_u32 s59,s58,0
s_lshl_b32 s84,s59,6
s_add_u32 s66,s30,s84
s_mul_i32 s84,s59,55296
s_add_u32 s72,s44,s84
s_add_u32 s59,s58,1
s_lshl_b32 s84,s59,6
s_add_u32 s67,s30,s84
s_mul_i32 s84,s59,55296
s_add_u32 s73,s44,s84
s_add_u32 s59,s58,2
s_lshl_b32 s84,s59,6
s_add_u32 s68,s30,s84
s_mul_i32 s84,s59,55296
s_add_u32 s74,s44,s84
s_add_u32 s59,s58,3
s_lshl_b32 s84,s59,6
s_add_u32 s69,s30,s84
s_mul_i32 s84,s59,55296
s_add_u32 s75,s44,s84
s_add_u32 s59,s58,4
s_lshl_b32 s84,s59,6
s_add_u32 s70,s30,s84
s_mul_i32 s84,s59,55296
s_add_u32 s76,s44,s84
s_add_u32 s59,s58,5
s_cmp_eq_u32 s59,6
s_cselect_b32 s59,0,s59
s_lshl_b32 s84,s59,6
s_add_u32 s71,s30,s84
s_mul_i32 s84,s59,55296
s_add_u32 s77,s44,s84
s_cmp_eq_u32 s49,0
s_cselect_b32 s58,1,0
v_cmp_gt_u32 vcc,s58,v161
v_lshrrev_b32 v163,5,v164
v_add_u32 v163,32,v163
v_mul_u32_u24 v246,196608,v163
v_bfrev_b32 v163,1
v_cndmask_b32 v251,v245,v163,vcc
v_lshl_add_u32 v168,v162,3,v245
v_cndmask_b32 v169,v168,v163,vcc
v_and_b32 v163,31,v164
v_lshlrev_b32 v163,1,v163
v_lshl_add_u32 v170,v163,1,v246
v_add_u32 v246,v246,v163
v_mov_b32 v166,1
s_mov_b32 s38,663552
s_mov_b32 s39,0x20000
s_mov_b32 s62,0
s_mov_b32 s63,0x20000
s_mov_b32 s22,1327104
s_mov_b32 s23,0x20000
s_waitcnt lgkmcnt(0)
s_and_b32 s21,s21,0xffff
s_mov_b32 s36,s6
s_and_b32 s37,s7,0xffff
s_mov_b32 s60,s26
s_and_b32 s61,s27,0xffff
s_mov_b32 s52,s26
s_mov_b32 s53,s27
s_cmp_lt_u32 s2,54
s_cbranch_scc0 L_noitem
s_lshl_b32 s84,s2,2
s_add_u32 s84,s84,s50
L_itemP:
s_and_b32 s85,s84,3
s_lshr_b32 s86,s84,2
s_mul_hi_u32 s87,s86,0x55555556
s_mul_i32 s88,s87,3
s_sub_u32 s86,s86,s88
s_mul_hi_u32 s88,s87,0x2aaaaaab
s_mul_i32 s89,s88,6
s_sub_u32 s87,s87,s89
s_mul_i32 s89,s86,221184
s_mul_i32 s90,s87,12288
s_add_u32 s89,s89,s90
s_mul_i32 s90,s85,3072
s_add_u32 s89,s89,s90
s_lshl_b32 s90,s88,7
s_add_u32 s89,s89,s90
s_add_u32 s90,s89,73728
s_add_u32 s91,s90,73728
v_lshlrev_b32 v149,1,v164
buffer_load_short_d16_hi v68,v149,s[36:39],s89 offen offset:0
buffer_load_short_d16_hi v69,v149,s[36:39],s89 offen offset:384
buffer_load_short_d16_hi v70,v149,s[36:39],s89 offen offset:768
buffer_load_short_d16_hi v71,v149,s[36:39],s89 offen offset:1152
buffer_load_short_d16_hi v72,v149,s[36:39],s89 offen offset:1536
buffer_load_short_d16_hi v73,v149,s[36:39],s89 offen offset:1920
buffer_load_short_d16_hi v74,v149,s[36:39],s89 offen offset:2304
buffer_load_short_d16_hi v75,v149,s[36:39],s89 offen offset:2688
buffer_load_short_d16_hi v76,v149,s[36:39],s90 offen offset:0
buffer_load_short_d16_hi v77,v149,s[36:39],s90 offen offset:384
buffer_load_short_d16_hi v78,v149,s[36:39],s90 offen offset:768
buffer_load_short_d16_hi v79,v149,s[36:39],s90 offen offset:1152
buffer_load_short_d16_hi v80,v149,s[36:39],s90 offen offset:1536
buffer_load_short_d16_hi v81,v149,s[36:39],s90 offen offset:1920
buffer_load_short_d16_hi v82,v149,s[36:39],s90 offen offset:2304
buffer_load_short_d16_hi v83,v149,s[36:39],s90 offen offset:2688
buffer_load_short_d16_hi v84,v149,s[36:39],s91 offen offset:0
buffer_load_short_d16_hi v85,v149,s[36:39],s91 offen offset:384
buffer_load_short_d16_hi v86,v149,s[36:39],s91 offen offset:768
buffer_load_short_d16_hi v87,v149,s[36:39],s91 offen offset:1152
buffer_load_short_d16_hi v88,v149,s[36:39],s91 offen offset:1536
buffer_load_short_d16_hi v89,v149,s[36:39],s91 offen offset:1920
buffer_load_short_d16_hi v90,v149,s[36:39],s91 offen offset:2304
buffer_load_short_d16_hi v91,v149,s[36:39],s91 offen offset:2688
s_and_b32 s92,s85,1
s_lshl_b32 s92,s92,2
s_lshr_b32 s85,s85,1
s_lshl_b32 s85,s85,2
v_bfe_u32 v148,v164,2,2
v_or_b32 v148,s92,v148
v_and_b32 v151,3,v164
v_or_b32 v151,s85,v151
v_xor_b32 v151,v151,v148
v_lshrrev_b32 v150,4,v164
v_mul_u32_u24 v150,331776,v150
v_lshl_add_u32 v150,v148,7,v150
v_lshl_add_u32 v150,v151,4,v150
s_mul_i32 s87,s87,55296
s_mul_i32 s88,s88,3072
s_add_u32 s87,s87,s88
s_lshl_b32 s86,s86,10
s_add_u32 s87,s87,s86
s_mov_b32 s85,0xbe2aaaab
s_mov_b32 s86,0x3d2aaaab
s_mov_b32 s88,0x3e2aaaab
s_mov_b32 s92,0x3daaaaab
s_waitcnt vmcnt(0)
v_add_f32 v148,v68,v84
v_add_f32 v92,v148,v76
v_sub_f32 v100,v148,v76
v_mul_f32 v92,s85,v92
v_mul_f32 v100,s85,v100
v_mul_f32 v148,s86,v68
v_fmac_f32 v148,s88,v84
v_fma_f32 v108,s92,v76,v148
v_fma_f32 v116,-s92,v76,v148
v_add_f32 v148,v69,v85
v_add_f32 v93,v148,v77
v_sub_f32 v101,v148,v77
v_mul_f32 v93,s85,v93
v_mul_f32 v101,s85,v101
v_mul_f32 v148,s86,v69
v_fmac_f32 v148,s88,v85
v_fma_f32 v109,s92,v77,v148
v_fma_f32 v117,-s92,v77,v148
v_add_f32 v148,v70,v86
v_add_f32 v94,v148,v78
v_sub_f32 v102,v148,v78
v_mul_f32 v94,s85,v94
v_mul_f32 v102,s85,v102
v_mul_f32 v148,s86,v70
v_fmac_f32 v148,s88,v86
v_fma_f32 v110,s92,v78,v148
v_fma_f32 v118,-s92,v78,v148
v_add_f32 v148,v71,v87
v_add_f32 v95,v148,v79
v_sub_f32 v103,v148,v79
v_mul_f32 v95,s85,v95
v_mul_f32 v103,s85,v103
v_mul_f32 v148,s86,v71
v_fmac_f32 v148,s88,v87
v_fma_f32 v111,s92,v79,v148
v_fma_f32 v119,-s92,v79,v148
v_add_f32 v148,v72,v88
v_add_f32 v96,v148,v80
v_sub_f32 v104,v148,v80
v_mul_f32 v96,s85,v96
v_mul_f32 v104,s85,v104
v_mul_f32 v148,s86,v72
v_fmac_f32 v148,s88,v88
v_fma_f32 v112,s92,v80,v148
v_fma_f32 v120,-s92,v80,v148
v_add_f32 v148,v73,v89
v_add_f32 v97,v148,v81
v_sub_f32 v105,v148,v81
v_mul_f32 v97,s85,v97
v_mul_f32 v105,s85,v105
v_mul_f32 v148,s86,v73
v_fmac_f32 v148,s88,v89
v_fma_f32 v113,s92,v81,v148
v_fma_f32 v121,-s92,v81,v148
v_add_f32 v148,v74,v90
v_add_f32 v98,v148,v82
v_sub_f32 v106,v148,v82
v_mul_f32 v98,s85,v98
v_mul_f32 v106,s85,v106
v_mul_f32 v148,s86,v74
v_fmac_f32 v148,s88,v90
v_fma_f32 v114,s92,v82,v148
v_fma_f32 v122,-s92,v82,v148
v_add_f32 v148,v75,v91
v_add_f32 v99,v148,v83
v_sub_f32 v107,v148,v83
v_mul_f32 v99,s85,v99
v_mul_f32 v107,s85,v107
v_mul_f32 v148,s86,v75
v_fmac_f32 v148,s88,v91
v_fma_f32 v115,s92,v83,v148
v_fma_f32 v123,-s92,v83,v148
v_cvt_pk_bf16_f32 v124,v68,v69
v_cvt_pk_bf16_f32 v125,v70,v71
v_cvt_pk_bf16_f32 v126,v72,v73
v_cvt_pk_bf16_f32 v127,v74,v75
s_add_u32 s89,s87,0
buffer_store_dwordx4 v[124:127],v150,s[20:23],s89 offen sc1
v_cvt_pk_bf16_f32 v144,v84,v85
v_cvt_pk_bf16_f32 v145,v86,v87
v_cvt_pk_bf16_f32 v146,v88,v89
v_cvt_pk_bf16_f32 v147,v90,v91
s_add_u32 s89,s87,46080
buffer_store_dwordx4 v[144:147],v150,s[20:23],s89 offen sc1
v_cvt_pk_bf16_f32 v128,v92,v93
v_cvt_pk_bf16_f32 v129,v94,v95
v_cvt_pk_bf16_f32 v130,v96,v97
v_cvt_pk_bf16_f32 v131,v98,v99
s_add_u32 s89,s87,9216
buffer_store_dwordx4 v[128:131],v150,s[20:23],s89 offen sc1
v_cvt_pk_bf16_f32 v132,v100,v101
v_cvt_pk_bf16_f32 v133,v102,v103
v_cvt_pk_bf16_f32 v134,v104,v105
v_cvt_pk_bf16_f32 v135,v106,v107
s_add_u32 s89,s87,18432
buffer_store_dwordx4 v[132:135],v150,s[20:23],s89 offen sc1
v_cvt_pk_bf16_f32 v136,v108,v109
v_cvt_pk_bf16_f32 v137,v110,v111
v_cvt_pk_bf16_f32 v138,v112,v113
v_cvt_pk_bf16_f32 v139,v114,v115
s_add_u32 s89,s87,27648
buffer_store_dwordx4 v[136:139],v150,s[20:23],s89 offen sc1
v_cvt_pk_bf16_f32 v140,v116,v117
v_cvt_pk_bf16_f32 v141,v118,v119
v_cvt_pk_bf16_f32 v142,v120,v121
v_cvt_pk_bf16_f32 v143,v122,v123
s_add_u32 s89,s87,36864
buffer_store_dwordx4 v[140:143],v150,s[20:23],s89 offen sc1
s_waitcnt vmcnt(0)
s_barrier
s_cmp_eq_u32 s50,0
s_cselect_b32 s62,256,0
L_noitem:
s_and_b32 s84,s2,1
s_lshl_b32 s59,s84,6
s_lshl_b32 s84,s84,2
s_mov_b64 exec,1
buffer_atomic_add v166,off,s[60:63],s59 sc0 sc1
s_mov_b64 exec,-1
s_and_b32 s5,s5,0xffff
s_sub_u32 s8,s4,196608
s_subb_u32 s9,s5,0
s_mov_b32 s10,100859904
s_mov_b32 s11,0x20000
s_sub_u32 s12,s4,196992
s_subb_u32 s13,s5,0
s_cmp_eq_u32 s56,0
s_cselect_b32 s14,0,100860288
s_mov_b32 s15,0x20000
s_mov_b32 s16,s8
s_mov_b32 s17,s9
s_cmp_eq_u32 s56,508
s_cselect_b32 s18,0,100859904
s_mov_b32 s19,0x20000
s_add_u32 s28,s30,0
buffer_load_dwordx4 v[8:11],v169,s[8:11],s28 offen offset:384
buffer_load_dwordx4 v[0:3],v169,s[12:15],s28 offen offset:0
buffer_load_dwordx4 v[4:7],v169,s[8:11],s28 offen offset:0
buffer_load_dwordx4 v[20:23],v169,s[16:19],s28 offen offset:1536
buffer_load_dwordx4 v[16:19],v169,s[8:11],s28 offen offset:1152
buffer_load_dwordx4 v[12:15],v169,s[8:11],s28 offen offset:768
s_mov_b64 exec,1
s_waitcnt vmcnt(6)
v_cmp_eq_u32 vcc,26,v166
v_mov_b32 v165,1
s_nop 2
s_and_b64 exec,exec,vcc
s_cselect_b32 s62,s62,0
s_mov_b64 exec,1
buffer_store_dword v165,off,s[60:63],s84 offset:128 sc1
s_mov_b64 exec,-1
s_add_u32 s28,s30,393216
buffer_load_dwordx4 v[32:35],v168,s[8:11],s28 offen offset:384
buffer_load_dwordx4 v[24:27],v168,s[12:15],s28 offen offset:0
buffer_load_dwordx4 v[28:31],v168,s[8:11],s28 offen offset:0
buffer_load_dwordx4 v[44:47],v168,s[16:19],s28 offen offset:1536
buffer_load_dwordx4 v[40:43],v168,s[8:11],s28 offen offset:1152
buffer_load_dwordx4 v[36:39],v168,s[8:11],s28 offen offset:768
v_bfe_u32 v165,v164,2,3
v_lshrrev_b32 v159,5,v164
v_and_b32 v163,3,v164
v_lshl_add_u32 v159,v159,2,v163
v_xor_b32 v163,v159,v165
v_lshlrev_b32 v163,4,v163
v_lshl_add_u32 v163,v165,7,v163
v_lshl_add_u32 v250,s50,10,v163
s_and_b32 s25,s25,0xffff
s_mov_b32 s26,100663296
s_mov_b32 s27,0x20000
s_mov_b32 s41,0xc0a00000
s_mov_b32 s40,0x41000000
s_mov_b32 s42,0xffff0000
s_mov_b32 s43,0xbfa00000
s_mov_b32 s45,0x3e800000
s_mul_i32 s58,s55,384
s_add_u32 s58,s57,s58
s_lshr_b32 s59,s50,1
s_mul_i32 s32,s59,384
s_mul_i32 s33,s59,196608
s_add_u32 s32,s32,s58
s_add_u32 s33,s33,s58
s_lshl_b32 s58,s59,5
s_lshl_b32 s59,s50,7
v_lshlrev_b32 v247,11,v160
v_xor_b32 v163,v160,v161
v_and_b32 v163,1,v163
v_lshl_add_u32 v247,v163,6,v247
v_lshlrev_b32 v163,3,v162
v_xor_b32 v163,s58,v163
v_add3_u32 v247,v247,v163,s59
v_and_b32 v171,0xffffffc0,v247
v_and_b32 v163,3,v162
v_lshlrev_b32 v163,4,v163
v_xor_b32 v163,s58,v163
v_add_u32 v171,v171,v163
v_lshrrev_b32 v163,2,v162
v_mul_u32_u24 v163,17408,v163
v_mad_u32_u24 v172,v163,5,v171
v_lshl_add_u32 v171,v163,1,v171
v_and_b32 v163,15,v164
v_lshlrev_b32 v163,2,v163
v_xor_b32 v163,s58,v163
v_lshrrev_b32 v173,5,v164
v_lshl_add_u32 v173,v173,6,v163
v_add_u32 v173,s59,v173
v_add_u32 v173,8192,v173
v_bfe_u32 v163,v164,4,1
v_mul_u32_u24 v163,17408,v163
v_mad_u32_u24 v174,v163,5,v173
v_lshl_add_u32 v173,v163,1,v173
v_lshrrev_b32 v160,5,v164
v_lshlrev_b32 v160,6,v160
v_and_b32 v161,63,v246
v_xor_b32 v161,s58,v161
v_add3_u32 v252,v160,v161,s59
v_add_u32 v252,8192,v252
v_bfe_u32 v160,v164,2,2
v_and_b32 v161,3,v164
v_lshrrev_b32 v162,4,v164
v_lshlrev_b32 v248,11,v160
v_lshl_add_u32 v248,v161,7,v248
v_and_b32 v163,1,v160
v_lshl_add_u32 v248,v163,6,v248
v_and_b32 v163,2,v161
v_xor_b32 v163,v163,v162
v_lshl_add_u32 v248,v163,4,v248
v_xor_b32 v249,64,v248
v_lshrrev_b32 v160,1,v162
v_lshl_add_u32 v160,s50,1,v160
v_and_b32 v161,7,v164
v_xor_b32 v160,v160,v161
v_and_b32 v163,15,v164
v_lshlrev_b32 v254,7,v163
v_lshl_add_u32 v254,v160,4,v254
v_and_b32 v163,1,v162
v_lshl_add_u32 v254,v163,3,v254
v_bfe_u32 v160,v250,7,4
v_lshrrev_b32 v162,2,v160
v_mul_u32_u24 v253,1572864,v162
v_and_b32 v162,3,v160
v_mul_u32_u24 v162,1536,v162
v_lshl_add_u32 v160,v159,4,v162
v_add_u32 v253,v253,v160
s_waitcnt vmcnt(12)
v_lshlrev_b32 v180,16,v8
v_and_b32 v181,s42,v8
s_waitcnt vmcnt(11)
v_lshlrev_b32 v176,16,v0
v_and_b32 v177,s42,v0
s_waitcnt vmcnt(10)
v_lshlrev_b32 v178,16,v4
v_and_b32 v179,s42,v4
s_add_u32 s28,s30,786432
buffer_load_dwordx4 v[56:59],v168,s[8:11],s28 offen offset:384
s_waitcnt vmcnt(10)
v_lshlrev_b32 v186,16,v20
v_and_b32 v187,s42,v20
s_waitcnt vmcnt(9)
v_lshlrev_b32 v184,16,v16
v_and_b32 v185,s42,v16
s_waitcnt vmcnt(8)
v_lshlrev_b32 v182,16,v12
v_and_b32 v183,s42,v12
v_pk_fma_f32 v[176:177],v[180:181],s[42:43],v[176:177] op_sel:[0,1,0] op_sel_hi:[1,1,1]
v_pk_fma_f32 v[186:187],v[178:179],4.0,v[186:187] op_sel_hi:[1,0,1]
v_pk_fma_f32 v[188:189],v[180:181],-4.0,v[184:185] op_sel_hi:[1,0,1]
v_pk_fma_f32 v[176:177],v[184:185],s[44:45],v[176:177] op_sel:[0,1,0] op_sel_hi:[1,1,1]
v_pk_fma_f32 v[186:187],v[182:183],s[40:41],v[186:187] op_sel:[0,1,0] op_sel_hi:[1,1,1]
v_pk_add_f32 v[184:185],v[184:185],v[180:181] neg_lo:[0,1] neg_hi:[0,1]
buffer_load_dwordx4 v[48:51],v168,s[12:15],s28 offen offset:0
v_pk_fma_f32 v[180:181],v[178:179],-4.0,v[182:183] op_sel_hi:[1,0,1]
v_pk_add_f32 v[182:183],v[182:183],v[178:179] neg_lo:[0,1] neg_hi:[0,1]
v_pk_add_f32 v[178:179],v[188:189],v[180:181]
v_pk_add_f32 v[188:189],v[188:189],v[180:181] neg_lo:[0,1] neg_hi:[0,1]
v_pk_fma_f32 v[180:181],v[182:183],2.0,v[184:185] op_sel_hi:[1,0,1]
v_pk_fma_f32 v[184:185],v[182:183],-2.0,v[184:185] op_sel_hi:[1,0,1]
v_cvt_pk_bf16_f32 v0,v176,v177
v_cvt_pk_bf16_f32 v4,v178,v179
v_cvt_pk_bf16_f32 v8,v188,v189
v_cvt_pk_bf16_f32 v12,v180,v181
v_cvt_pk_bf16_f32 v16,v184,v185
v_cvt_pk_bf16_f32 v20,v186,v187
buffer_load_dwordx4 v[52:55],v168,s[8:11],s28 offen offset:0
v_lshlrev_b32 v180,16,v9
v_and_b32 v181,s42,v9
v_lshlrev_b32 v176,16,v1
v_and_b32 v177,s42,v1
v_lshlrev_b32 v178,16,v5
v_and_b32 v179,s42,v5
v_lshlrev_b32 v186,16,v21
v_and_b32 v187,s42,v21
v_lshlrev_b32 v184,16,v17
v_and_b32 v185,s42,v17
v_lshlrev_b32 v182,16,v13
v_and_b32 v183,s42,v13
buffer_load_dwordx4 v[68:71],v168,s[16:19],s28 offen offset:1536
v_pk_fma_f32 v[176:177],v[180:181],s[42:43],v[176:177] op_sel:[0,1,0] op_sel_hi:[1,1,1]
v_pk_fma_f32 v[186:187],v[178:179],4.0,v[186:187] op_sel_hi:[1,0,1]
v_pk_fma_f32 v[188:189],v[180:181],-4.0,v[184:185] op_sel_hi:[1,0,1]
v_pk_fma_f32 v[176:177],v[184:185],s[44:45],v[176:177] op_sel:[0,1,0] op_sel_hi:[1,1,1]
v_pk_fma_f32 v[186:187],v[182:183],s[40:41],v[186:187] op_sel:[0,1,0] op_sel_hi:[1,1,1]
v_pk_add_f32 v[184:185],v[184:185],v[180:181] neg_lo:[0,1] neg_hi:[0,1]
v_pk_fma_f32 v[180:181],v[178:179],-4.0,v[182:183] op_sel_hi:[1,0,1]
v_pk_add_f32 v[182:183],v[182:183],v[178:179] neg_lo:[0,1] neg_hi:[0,1]
v_pk_add_f32 v[178:179],v[188:189],v[180:181]
v_pk_add_f32 v[188:189],v[188:189],v[180:181] neg_lo:[0,1] neg_hi:[0,1]
v_pk_fma_f32 v[180:181],v[182:183],2.0,v[184:185] op_sel_hi:[1,0,1]
v_pk_fma_f32 v[184:185],v[182:183],-2.0,v[184:185] op_sel_hi:[1,0,1]
buffer_load_dwordx4 v[64:67],v168,s[8:11],s28 offen offset:1152
v_cvt_pk_bf16_f32 v1,v176,v177
v_cvt_pk_bf16_f32 v5,v178,v179
v_cvt_pk_bf16_f32 v9,v188,v189
v_cvt_pk_bf16_f32 v13,v180,v181
v_cvt_pk_bf16_f32 v17,v184,v185
v_cvt_pk_bf16_f32 v21,v186,v187
v_lshlrev_b32 v180,16,v10
v_and_b32 v181,s42,v10
v_lshlrev_b32 v176,16,v2
v_and_b32 v177,s42,v2
v_lshlrev_b32 v178,16,v6
v_and_b32 v179,s42,v6
buffer_load_dwordx4 v[60:63],v168,s[8:11],s28 offen offset:768
v_lshlrev_b32 v186,16,v22
v_and_b32 v187,s42,v22
v_lshlrev_b32 v184,16,v18
v_and_b32 v185,s42,v18
v_lshlrev_b32 v182,16,v14
v_and_b32 v183,s42,v14
v_pk_fma_f32 v[176:177],v[180:181],s[42:43],v[176:177] op_sel:[0,1,0] op_sel_hi:[1,1,1]
v_pk_fma_f32 v[186:187],v[178:179],4.0,v[186:187] op_sel_hi:[1,0,1]
v_pk_fma_f32 v[188:189],v[180:181],-4.0,v[184:185] op_sel_hi:[1,0,1]
v_pk_fma_f32 v[176:177],v[184:185],s[44:45],v[176:177] op_sel:[0,1,0] op_sel_hi:[1,1,1]
v_pk_fma_f32 v[186:187],v[182:183],s[40:41],v[186:187] op_sel:[0,1,0] op_sel_hi:[1,1,1]
v_pk_add_f32 v[184:185],v[184:185],v[180:181] neg_lo:[0,1] neg_hi:[0,1]
s_add_u32 s28,s30,1179648
buffer_load_dwordx4 v[80:83],v168,s[8:11],s28 offen offset:384
v_pk_fma_f32 v[180:181],v[178:179],-4.0,v[182:183] op_sel_hi:[1,0,1]
v_pk_add_f32 v[182:183],v[182:183],v[178:179] neg_lo:[0,1] neg_hi:[0,1]
v_pk_add_f32 v[178:179],v[188:189],v[180:181]
v_pk_add_f32 v[188:189],v[188:189],v[180:181] neg_lo:[0,1] neg_hi:[0,1]
v_pk_fma_f32 v[180:181],v[182:183],2.0,v[184:185] op_sel_hi:[1,0,1]
v_pk_fma_f32 v[184:185],v[182:183],-2.0,v[184:185] op_sel_hi:[1,0,1]
v_cvt_pk_bf16_f32 v2,v176,v177
v_cvt_pk_bf16_f32 v6,v178,v179
v_cvt_pk_bf16_f32 v10,v188,v189
v_cvt_pk_bf16_f32 v14,v180,v181
v_cvt_pk_bf16_f32 v18,v184,v185
v_cvt_pk_bf16_f32 v22,v186,v187
buffer_load_dwordx4 v[72:75],v168,s[12:15],s28 offen offset:0
v_lshlrev_b32 v180,16,v11
v_and_b32 v181,s42,v11
v_lshlrev_b32 v176,16,v3
v_and_b32 v177,s42,v3
v_lshlrev_b32 v178,16,v7
v_and_b32 v179,s42,v7
v_lshlrev_b32 v186,16,v23
v_and_b32 v187,s42,v23
v_lshlrev_b32 v184,16,v19
v_and_b32 v185,s42,v19
v_lshlrev_b32 v182,16,v15
v_and_b32 v183,s42,v15
buffer_load_dwordx4 v[76:79],v168,s[8:11],s28 offen offset:0
v_pk_fma_f32 v[176:177],v[180:181],s[42:43],v[176:177] op_sel:[0,1,0] op_sel_hi:[1,1,1]
v_pk_fma_f32 v[186:187],v[178:179],4.0,v[186:187] op_sel_hi:[1,0,1]
v_pk_fma_f32 v[188:189],v[180:181],-4.0,v[184:185] op_sel_hi:[1,0,1]
v_pk_fma_f32 v[176:177],v[184:185],s[44:45],v[176:177] op_sel:[0,1,0] op_sel_hi:[1,1,1]
v_pk_fma_f32 v[186:187],v[182:183],s[40:41],v[186:187] op_sel:[0,1,0] op_sel_hi:[1,1,1]
v_pk_add_f32 v[184:185],v[184:185],v[180:181] neg_lo:[0,1] neg_hi:[0,1]
v_pk_fma_f32 v[180:181],v[178:179],-4.0,v[182:183] op_sel_hi:[1,0,1]
v_pk_add_f32 v[182:183],v[182:183],v[178:179] neg_lo:[0,1] neg_hi:[0,1]
v_pk_add_f32 v[178:179],v[188:189],v[180:181]
v_pk_add_f32 v[188:189],v[188:189],v[180:181] neg_lo:[0,1] neg_hi:[0,1]
v_pk_fma_f32 v[180:181],v[182:183],2.0,v[184:185] op_sel_hi:[1,0,1]
v_pk_fma_f32 v[184:185],v[182:183],-2.0,v[184:185] op_sel_hi:[1,0,1]
buffer_load_dwordx4 v[92:95],v168,s[16:19],s28 offen offset:1536
v_cvt_pk_bf16_f32 v3,v176,v177
v_cvt_pk_bf16_f32 v7,v178,v179
v_cvt_pk_bf16_f32 v11,v188,v189
v_cvt_pk_bf16_f32 v15,v180,v181
v_cvt_pk_bf16_f32 v19,v184,v185
v_cvt_pk_bf16_f32 v23,v186,v187
ds_write_b128 v172,v[0:3] offset:0
ds_write_b128 v171,v[4:7] offset:17408
ds_write_b128 v171,v[8:11] offset:26112
ds_write_b128 v171,v[12:15] offset:34816
ds_write_b128 v171,v[16:19] offset:43520
ds_write_b128 v172,v[20:23] offset:8704
buffer_load_dwordx4 v[88:91],v168,s[8:11],s28 offen offset:1152
s_waitcnt vmcnt(16)
v_lshlrev_b32 v180,16,v32
v_and_b32 v181,s42,v32
s_waitcnt vmcnt(15)
v_lshlrev_b32 v176,16,v24
v_and_b32 v177,s42,v24
s_waitcnt vmcnt(14)
v_lshlrev_b32 v178,16,v28
v_and_b32 v179,s42,v28
buffer_load_dwordx4 v[84:87],v168,s[8:11],s28 offen offset:768
s_waitcnt vmcnt(14)
v_lshlrev_b32 v186,16,v44
v_and_b32 v187,s42,v44
s_waitcnt vmcnt(13)
v_lshlrev_b32 v184,16,v40
v_and_b32 v185,s42,v40
s_waitcnt vmcnt(12)
v_lshlrev_b32 v182,16,v36
v_and_b32 v183,s42,v36
v_pk_fma_f32 v[176:177],v[180:181],s[42:43],v[176:177] op_sel:[0,1,0] op_sel_hi:[1,1,1]
v_pk_fma_f32 v[186:187],v[178:179],4.0,v[186:187] op_sel_hi:[1,0,1]
v_pk_fma_f32 v[188:189],v[180:181],-4.0,v[184:185] op_sel_hi:[1,0,1]
v_pk_fma_f32 v[176:177],v[184:185],s[44:45],v[176:177] op_sel:[0,1,0] op_sel_hi:[1,1,1]
v_pk_fma_f32 v[186:187],v[182:183],s[40:41],v[186:187] op_sel:[0,1,0] op_sel_hi:[1,1,1]
v_pk_add_f32 v[184:185],v[184:185],v[180:181] neg_lo:[0,1] neg_hi:[0,1]
buffer_load_dword v96,v170,s[12:15],s30 offen offset:0
v_pk_fma_f32 v[180:181],v[178:179],-4.0,v[182:183] op_sel_hi:[1,0,1]
v_pk_add_f32 v[182:183],v[182:183],v[178:179] neg_lo:[0,1] neg_hi:[0,1]
v_pk_add_f32 v[178:179],v[188:189],v[180:181]
v_pk_add_f32 v[188:189],v[188:189],v[180:181] neg_lo:[0,1] neg_hi:[0,1]
v_pk_fma_f32 v[180:181],v[182:183],2.0,v[184:185] op_sel_hi:[1,0,1]
v_pk_fma_f32 v[184:185],v[182:183],-2.0,v[184:185] op_sel_hi:[1,0,1]
v_cvt_pk_bf16_f32 v24,v176,v177
v_cvt_pk_bf16_f32 v28,v178,v179
v_cvt_pk_bf16_f32 v32,v188,v189
v_cvt_pk_bf16_f32 v36,v180,v181
v_cvt_pk_bf16_f32 v40,v184,v185
v_cvt_pk_bf16_f32 v44,v186,v187
buffer_load_dword v97,v170,s[8:11],s30 offen offset:0
v_lshlrev_b32 v180,16,v33
v_and_b32 v181,s42,v33
v_lshlrev_b32 v176,16,v25
v_and_b32 v177,s42,v25
v_lshlrev_b32 v178,16,v29
v_and_b32 v179,s42,v29
v_lshlrev_b32 v186,16,v45
v_and_b32 v187,s42,v45
v_lshlrev_b32 v184,16,v41
v_and_b32 v185,s42,v41
v_lshlrev_b32 v182,16,v37
v_and_b32 v183,s42,v37
buffer_load_dword v98,v170,s[8:11],s30 offen offset:384
v_pk_fma_f32 v[176:177],v[180:181],s[42:43],v[176:177] op_sel:[0,1,0] op_sel_hi:[1,1,1]
v_pk_fma_f32 v[186:187],v[178:179],4.0,v[186:187] op_sel_hi:[1,0,1]
v_pk_fma_f32 v[188:189],v[180:181],-4.0,v[184:185] op_sel_hi:[1,0,1]
v_pk_fma_f32 v[176:177],v[184:185],s[44:45],v[176:177] op_sel:[0,1,0] op_sel_hi:[1,1,1]
v_pk_fma_f32 v[186:187],v[182:183],s[40:41],v[186:187] op_sel:[0,1,0] op_sel_hi:[1,1,1]
v_pk_add_f32 v[184:185],v[184:185],v[180:181] neg_lo:[0,1] neg_hi:[0,1]
v_pk_fma_f32 v[180:181],v[178:179],-4.0,v[182:183] op_sel_hi:[1,0,1]
v_pk_add_f32 v[182:183],v[182:183],v[178:179] neg_lo:[0,1] neg_hi:[0,1]
v_pk_add_f32 v[178:179],v[188:189],v[180:181]
v_pk_add_f32 v[188:189],v[188:189],v[180:181] neg_lo:[0,1] neg_hi:[0,1]
v_pk_fma_f32 v[180:181],v[182:183],2.0,v[184:185] op_sel_hi:[1,0,1]
v_pk_fma_f32 v[184:185],v[182:183],-2.0,v[184:185] op_sel_hi:[1,0,1]
buffer_load_dword v99,v170,s[8:11],s30 offen offset:768
v_cvt_pk_bf16_f32 v25,v176,v177
v_cvt_pk_bf16_f32 v29,v178,v179
v_cvt_pk_bf16_f32 v33,v188,v189
v_cvt_pk_bf16_f32 v37,v180,v181
v_cvt_pk_bf16_f32 v41,v184,v185
v_cvt_pk_bf16_f32 v45,v186,v187
v_lshlrev_b32 v180,16,v34
v_and_b32 v181,s42,v34
v_lshlrev_b32 v176,16,v26
v_and_b32 v177,s42,v26
v_lshlrev_b32 v178,16,v30
v_and_b32 v179,s42,v30
buffer_load_dword v100,v170,s[8:11],s30 offen offset:1152
v_lshlrev_b32 v186,16,v46
v_and_b32 v187,s42,v46
v_lshlrev_b32 v184,16,v42
v_and_b32 v185,s42,v42
v_lshlrev_b32 v182,16,v38
v_and_b32 v183,s42,v38
v_pk_fma_f32 v[176:177],v[180:181],s[42:43],v[176:177] op_sel:[0,1,0] op_sel_hi:[1,1,1]
v_pk_fma_f32 v[186:187],v[178:179],4.0,v[186:187] op_sel_hi:[1,0,1]
v_pk_fma_f32 v[188:189],v[180:181],-4.0,v[184:185] op_sel_hi:[1,0,1]
v_pk_fma_f32 v[176:177],v[184:185],s[44:45],v[176:177] op_sel:[0,1,0] op_sel_hi:[1,1,1]
v_pk_fma_f32 v[186:187],v[182:183],s[40:41],v[186:187] op_sel:[0,1,0] op_sel_hi:[1,1,1]
v_pk_add_f32 v[184:185],v[184:185],v[180:181] neg_lo:[0,1] neg_hi:[0,1]
buffer_load_dword v101,v170,s[16:19],s30 offen offset:1536
v_pk_fma_f32 v[180:181],v[178:179],-4.0,v[182:183] op_sel_hi:[1,0,1]
v_pk_add_f32 v[182:183],v[182:183],v[178:179] neg_lo:[0,1] neg_hi:[0,1]
v_pk_add_f32 v[178:179],v[188:189],v[180:181]
v_pk_add_f32 v[188:189],v[188:189],v[180:181] neg_lo:[0,1] neg_hi:[0,1]
v_pk_fma_f32 v[180:181],v[182:183],2.0,v[184:185] op_sel_hi:[1,0,1]
v_pk_fma_f32 v[184:185],v[182:183],-2.0,v[184:185] op_sel_hi:[1,0,1]
v_cvt_pk_bf16_f32 v26,v176,v177
v_cvt_pk_bf16_f32 v30,v178,v179
v_cvt_pk_bf16_f32 v34,v188,v189
v_cvt_pk_bf16_f32 v38,v180,v181
v_cvt_pk_bf16_f32 v42,v184,v185
v_cvt_pk_bf16_f32 v46,v186,v187
v_lshlrev_b32 v180,16,v35
v_and_b32 v181,s42,v35
v_lshlrev_b32 v176,16,v27
v_and_b32 v177,s42,v27
v_lshlrev_b32 v178,16,v31
v_and_b32 v179,s42,v31
v_lshlrev_b32 v186,16,v47
v_and_b32 v187,s42,v47
v_lshlrev_b32 v184,16,v43
v_and_b32 v185,s42,v43
v_lshlrev_b32 v182,16,v39
v_and_b32 v183,s42,v39
v_pk_fma_f32 v[176:177],v[180:181],s[42:43],v[176:177] op_sel:[0,1,0] op_sel_hi:[1,1,1]
v_pk_fma_f32 v[186:187],v[178:179],4.0,v[186:187] op_sel_hi:[1,0,1]
v_pk_fma_f32 v[188:189],v[180:181],-4.0,v[184:185] op_sel_hi:[1,0,1]
v_pk_fma_f32 v[176:177],v[184:185],s[44:45],v[176:177] op_sel:[0,1,0] op_sel_hi:[1,1,1]
v_pk_fma_f32 v[186:187],v[182:183],s[40:41],v[186:187] op_sel:[0,1,0] op_sel_hi:[1,1,1]
v_pk_add_f32 v[184:185],v[184:185],v[180:181] neg_lo:[0,1] neg_hi:[0,1]
v_pk_fma_f32 v[180:181],v[178:179],-4.0,v[182:183] op_sel_hi:[1,0,1]
v_pk_add_f32 v[182:183],v[182:183],v[178:179] neg_lo:[0,1] neg_hi:[0,1]
v_pk_add_f32 v[178:179],v[188:189],v[180:181]
v_pk_add_f32 v[188:189],v[188:189],v[180:181] neg_lo:[0,1] neg_hi:[0,1]
v_pk_fma_f32 v[180:181],v[182:183],2.0,v[184:185] op_sel_hi:[1,0,1]
v_pk_fma_f32 v[184:185],v[182:183],-2.0,v[184:185] op_sel_hi:[1,0,1]
v_cvt_pk_bf16_f32 v27,v176,v177
v_cvt_pk_bf16_f32 v31,v178,v179
v_cvt_pk_bf16_f32 v35,v188,v189
v_cvt_pk_bf16_f32 v39,v180,v181
v_cvt_pk_bf16_f32 v43,v184,v185
v_cvt_pk_bf16_f32 v47,v186,v187
ds_write_b128 v172,v[24:27] offset:512
ds_write_b128 v171,v[28:31] offset:17920
ds_write_b128 v171,v[32:35] offset:26624
ds_write_b128 v171,v[36:39] offset:35328
ds_write_b128 v171,v[40:43] offset:44032
ds_write_b128 v172,v[44:47] offset:9216
s_waitcnt vmcnt(17)
v_lshlrev_b32 v180,16,v56
v_and_b32 v181,s42,v56
s_waitcnt vmcnt(16)
v_lshlrev_b32 v176,16,v48
v_and_b32 v177,s42,v48
s_waitcnt vmcnt(15)
v_lshlrev_b32 v178,16,v52
v_and_b32 v179,s42,v52
s_waitcnt vmcnt(14)
v_lshlrev_b32 v186,16,v68
v_and_b32 v187,s42,v68
s_waitcnt vmcnt(13)
v_lshlrev_b32 v184,16,v64
v_and_b32 v185,s42,v64
s_waitcnt vmcnt(12)
v_lshlrev_b32 v182,16,v60
v_and_b32 v183,s42,v60
v_pk_fma_f32 v[176:177],v[180:181],s[42:43],v[176:177] op_sel:[0,1,0] op_sel_hi:[1,1,1]
v_pk_fma_f32 v[186:187],v[178:179],4.0,v[186:187] op_sel_hi:[1,0,1]
v_pk_fma_f32 v[188:189],v[180:181],-4.0,v[184:185] op_sel_hi:[1,0,1]
v_pk_fma_f32 v[176:177],v[184:185],s[44:45],v[176:177] op_sel:[0,1,0] op_sel_hi:[1,1,1]
v_pk_fma_f32 v[186:187],v[182:183],s[40:41],v[186:187] op_sel:[0,1,0] op_sel_hi:[1,1,1]
v_pk_add_f32 v[184:185],v[184:185],v[180:181] neg_lo:[0,1] neg_hi:[0,1]
v_pk_fma_f32 v[180:181],v[178:179],-4.0,v[182:183] op_sel_hi:[1,0,1]
v_pk_add_f32 v[182:183],v[182:183],v[178:179] neg_lo:[0,1] neg_hi:[0,1]
v_pk_add_f32 v[178:179],v[188:189],v[180:181]
v_pk_add_f32 v[188:189],v[188:189],v[180:181] neg_lo:[0,1] neg_hi:[0,1]
v_pk_fma_f32 v[180:181],v[182:183],2.0,v[184:185] op_sel_hi:[1,0,1]
v_pk_fma_f32 v[184:185],v[182:183],-2.0,v[184:185] op_sel_hi:[1,0,1]
v_cvt_pk_bf16_f32 v48,v176,v177
v_cvt_pk_bf16_f32 v52,v178,v179
v_cvt_pk_bf16_f32 v56,v188,v189
v_cvt_pk_bf16_f32 v60,v180,v181
v_cvt_pk_bf16_f32 v64,v184,v185
v_cvt_pk_bf16_f32 v68,v186,v187
v_lshlrev_b32 v180,16,v57
v_and_b32 v181,s42,v57
v_lshlrev_b32 v176,16,v49
v_and_b32 v177,s42,v49
v_lshlrev_b32 v178,16,v53
v_and_b32 v179,s42,v53
v_lshlrev_b32 v186,16,v69
v_and_b32 v187,s42,v69
v_lshlrev_b32 v184,16,v65
v_and_b32 v185,s42,v65
v_lshlrev_b32 v182,16,v61
v_and_b32 v183,s42,v61
v_pk_fma_f32 v[176:177],v[180:181],s[42:43],v[176:177] op_sel:[0,1,0] op_sel_hi:[1,1,1]
v_pk_fma_f32 v[186:187],v[178:179],4.0,v[186:187] op_sel_hi:[1,0,1]
v_pk_fma_f32 v[188:189],v[180:181],-4.0,v[184:185] op_sel_hi:[1,0,1]
v_pk_fma_f32 v[176:177],v[184:185],s[44:45],v[176:177] op_sel:[0,1,0] op_sel_hi:[1,1,1]
v_pk_fma_f32 v[186:187],v[182:183],s[40:41],v[186:187] op_sel:[0,1,0] op_sel_hi:[1,1,1]
v_pk_add_f32 v[184:185],v[184:185],v[180:181] neg_lo:[0,1] neg_hi:[0,1]
v_pk_fma_f32 v[180:181],v[178:179],-4.0,v[182:183] op_sel_hi:[1,0,1]
v_pk_add_f32 v[182:183],v[182:183],v[178:179] neg_lo:[0,1] neg_hi:[0,1]
v_pk_add_f32 v[178:179],v[188:189],v[180:181]
v_pk_add_f32 v[188:189],v[188:189],v[180:181] neg_lo:[0,1] neg_hi:[0,1]
v_pk_fma_f32 v[180:181],v[182:183],2.0,v[184:185] op_sel_hi:[1,0,1]
v_pk_fma_f32 v[184:185],v[182:183],-2.0,v[184:185] op_sel_hi:[1,0,1]
v_cvt_pk_bf16_f32 v49,v176,v177
v_cvt_pk_bf16_f32 v53,v178,v179
v_cvt_pk_bf16_f32 v57,v188,v189
v_cvt_pk_bf16_f32 v61,v180,v181
v_cvt_pk_bf16_f32 v65,v184,v185
v_cvt_pk_bf16_f32 v69,v186,v187
v_lshlrev_b32 v180,16,v58
v_and_b32 v181,s42,v58
v_lshlrev_b32 v176,16,v50
v_and_b32 v177,s42,v50
v_lshlrev_b32 v178,16,v54
v_and_b32 v179,s42,v54
v_lshlrev_b32 v186,16,v70
v_and_b32 v187,s42,v70
v_lshlrev_b32 v184,16,v66
v_and_b32 v185,s42,v66
v_lshlrev_b32 v182,16,v62
v_and_b32 v183,s42,v62
v_pk_fma_f32 v[176:177],v[180:181],s[42:43],v[176:177] op_sel:[0,1,0] op_sel_hi:[1,1,1]
v_pk_fma_f32 v[186:187],v[178:179],4.0,v[186:187] op_sel_hi:[1,0,1]
v_pk_fma_f32 v[188:189],v[180:181],-4.0,v[184:185] op_sel_hi:[1,0,1]
v_pk_fma_f32 v[176:177],v[184:185],s[44:45],v[176:177] op_sel:[0,1,0] op_sel_hi:[1,1,1]
v_pk_fma_f32 v[186:187],v[182:183],s[40:41],v[186:187] op_sel:[0,1,0] op_sel_hi:[1,1,1]
v_pk_add_f32 v[184:185],v[184:185],v[180:181] neg_lo:[0,1] neg_hi:[0,1]
v_pk_fma_f32 v[180:181],v[178:179],-4.0,v[182:183] op_sel_hi:[1,0,1]
v_pk_add_f32 v[182:183],v[182:183],v[178:179] neg_lo:[0,1] neg_hi:[0,1]
v_pk_add_f32 v[178:179],v[188:189],v[180:181]
v_pk_add_f32 v[188:189],v[188:189],v[180:181] neg_lo:[0,1] neg_hi:[0,1]
v_pk_fma_f32 v[180:181],v[182:183],2.0,v[184:185] op_sel_hi:[1,0,1]
v_pk_fma_f32 v[184:185],v[182:183],-2.0,v[184:185] op_sel_hi:[1,0,1]
v_cvt_pk_bf16_f32 v50,v176,v177
v_cvt_pk_bf16_f32 v54,v178,v179
v_cvt_pk_bf16_f32 v58,v188,v189
v_cvt_pk_bf16_f32 v62,v180,v181
v_cvt_pk_bf16_f32 v66,v184,v185
v_cvt_pk_bf16_f32 v70,v186,v187
v_lshlrev_b32 v180,16,v59
v_and_b32 v181,s42,v59
v_lshlrev_b32 v176,16,v51
v_and_b32 v177,s42,v51
v_lshlrev_b32 v178,16,v55
v_and_b32 v179,s42,v55
v_lshlrev_b32 v186,16,v71
v_and_b32 v187,s42,v71
v_lshlrev_b32 v184,16,v67
v_and_b32 v185,s42,v67
v_lshlrev_b32 v182,16,v63
v_and_b32 v183,s42,v63
v_pk_fma_f32 v[176:177],v[180:181],s[42:43],v[176:177] op_sel:[0,1,0] op_sel_hi:[1,1,1]
v_pk_fma_f32 v[186:187],v[178:179],4.0,v[186:187] op_sel_hi:[1,0,1]
v_pk_fma_f32 v[188:189],v[180:181],-4.0,v[184:185] op_sel_hi:[1,0,1]
v_pk_fma_f32 v[176:177],v[184:185],s[44:45],v[176:177] op_sel:[0,1,0] op_sel_hi:[1,1,1]
v_pk_fma_f32 v[186:187],v[182:183],s[40:41],v[186:187] op_sel:[0,1,0] op_sel_hi:[1,1,1]
v_pk_add_f32 v[184:185],v[184:185],v[180:181] neg_lo:[0,1] neg_hi:[0,1]
v_pk_fma_f32 v[180:181],v[178:179],-4.0,v[182:183] op_sel_hi:[1,0,1]
v_pk_add_f32 v[182:183],v[182:183],v[178:179] neg_lo:[0,1] neg_hi:[0,1]
v_pk_add_f32 v[178:179],v[188:189],v[180:181]
v_pk_add_f32 v[188:189],v[188:189],v[180:181] neg_lo:[0,1] neg_hi:[0,1]
v_pk_fma_f32 v[180:181],v[182:183],2.0,v[184:185] op_sel_hi:[1,0,1]
v_pk_fma_f32 v[184:185],v[182:183],-2.0,v[184:185] op_sel_hi:[1,0,1]
v_cvt_pk_bf16_f32 v51,v176,v177
v_cvt_pk_bf16_f32 v55,v178,v179
v_cvt_pk_bf16_f32 v59,v188,v189
v_cvt_pk_bf16_f32 v63,v180,v181
v_cvt_pk_bf16_f32 v67,v184,v185
v_cvt_pk_bf16_f32 v71,v186,v187
ds_write_b128 v172,v[48:51] offset:1024
ds_write_b128 v171,v[52:55] offset:18432
ds_write_b128 v171,v[56:59] offset:27136
ds_write_b128 v171,v[60:63] offset:35840
ds_write_b128 v171,v[64:67] offset:44544
ds_write_b128 v172,v[68:71] offset:9728
s_waitcnt vmcnt(11)
v_lshlrev_b32 v180,16,v80
v_and_b32 v181,s42,v80
s_waitcnt vmcnt(10)
v_lshlrev_b32 v176,16,v72
v_and_b32 v177,s42,v72
s_waitcnt vmcnt(9)
v_lshlrev_b32 v178,16,v76
v_and_b32 v179,s42,v76
s_waitcnt vmcnt(8)
v_lshlrev_b32 v186,16,v92
v_and_b32 v187,s42,v92
s_waitcnt vmcnt(7)
v_lshlrev_b32 v184,16,v88
v_and_b32 v185,s42,v88
s_waitcnt vmcnt(6)
v_lshlrev_b32 v182,16,v84
v_and_b32 v183,s42,v84
v_pk_fma_f32 v[176:177],v[180:181],s[42:43],v[176:177] op_sel:[0,1,0] op_sel_hi:[1,1,1]
v_pk_fma_f32 v[186:187],v[178:179],4.0,v[186:187] op_sel_hi:[1,0,1]
v_pk_fma_f32 v[188:189],v[180:181],-4.0,v[184:185] op_sel_hi:[1,0,1]
v_pk_fma_f32 v[176:177],v[184:185],s[44:45],v[176:177] op_sel:[0,1,0] op_sel_hi:[1,1,1]
v_pk_fma_f32 v[186:187],v[182:183],s[40:41],v[186:187] op_sel:[0,1,0] op_sel_hi:[1,1,1]
v_pk_add_f32 v[184:185],v[184:185],v[180:181] neg_lo:[0,1] neg_hi:[0,1]
v_pk_fma_f32 v[180:181],v[178:179],-4.0,v[182:183] op_sel_hi:[1,0,1]
v_pk_add_f32 v[182:183],v[182:183],v[178:179] neg_lo:[0,1] neg_hi:[0,1]
v_pk_add_f32 v[178:179],v[188:189],v[180:181]
v_pk_add_f32 v[188:189],v[188:189],v[180:181] neg_lo:[0,1] neg_hi:[0,1]
v_pk_fma_f32 v[180:181],v[182:183],2.0,v[184:185] op_sel_hi:[1,0,1]
v_pk_fma_f32 v[184:185],v[182:183],-2.0,v[184:185] op_sel_hi:[1,0,1]
v_cvt_pk_bf16_f32 v72,v176,v177
v_cvt_pk_bf16_f32 v76,v178,v179
v_cvt_pk_bf16_f32 v80,v188,v189
v_cvt_pk_bf16_f32 v84,v180,v181
v_cvt_pk_bf16_f32 v88,v184,v185
v_cvt_pk_bf16_f32 v92,v186,v187
v_lshlrev_b32 v180,16,v81
v_and_b32 v181,s42,v81
v_lshlrev_b32 v176,16,v73
v_and_b32 v177,s42,v73
v_lshlrev_b32 v178,16,v77
v_and_b32 v179,s42,v77
v_lshlrev_b32 v186,16,v93
v_and_b32 v187,s42,v93
v_lshlrev_b32 v184,16,v89
v_and_b32 v185,s42,v89
v_lshlrev_b32 v182,16,v85
v_and_b32 v183,s42,v85
v_pk_fma_f32 v[176:177],v[180:181],s[42:43],v[176:177] op_sel:[0,1,0] op_sel_hi:[1,1,1]
v_pk_fma_f32 v[186:187],v[178:179],4.0,v[186:187] op_sel_hi:[1,0,1]
v_pk_fma_f32 v[188:189],v[180:181],-4.0,v[184:185] op_sel_hi:[1,0,1]
v_pk_fma_f32 v[176:177],v[184:185],s[44:45],v[176:177] op_sel:[0,1,0] op_sel_hi:[1,1,1]
v_pk_fma_f32 v[186:187],v[182:183],s[40:41],v[186:187] op_sel:[0,1,0] op_sel_hi:[1,1,1]
v_pk_add_f32 v[184:185],v[184:185],v[180:181] neg_lo:[0,1] neg_hi:[0,1]
v_pk_fma_f32 v[180:181],v[178:179],-4.0,v[182:183] op_sel_hi:[1,0,1]
v_pk_add_f32 v[182:183],v[182:183],v[178:179] neg_lo:[0,1] neg_hi:[0,1]
v_pk_add_f32 v[178:179],v[188:189],v[180:181]
v_pk_add_f32 v[188:189],v[188:189],v[180:181] neg_lo:[0,1] neg_hi:[0,1]
v_pk_fma_f32 v[180:181],v[182:183],2.0,v[184:185] op_sel_hi:[1,0,1]
v_pk_fma_f32 v[184:185],v[182:183],-2.0,v[184:185] op_sel_hi:[1,0,1]
v_cvt_pk_bf16_f32 v73,v176,v177
v_cvt_pk_bf16_f32 v77,v178,v179
v_cvt_pk_bf16_f32 v81,v188,v189
v_cvt_pk_bf16_f32 v85,v180,v181
v_cvt_pk_bf16_f32 v89,v184,v185
v_cvt_pk_bf16_f32 v93,v186,v187
v_lshlrev_b32 v180,16,v82
v_and_b32 v181,s42,v82
v_lshlrev_b32 v176,16,v74
v_and_b32 v177,s42,v74
v_lshlrev_b32 v178,16,v78
v_and_b32 v179,s42,v78
v_lshlrev_b32 v186,16,v94
v_and_b32 v187,s42,v94
v_lshlrev_b32 v184,16,v90
v_and_b32 v185,s42,v90
v_lshlrev_b32 v182,16,v86
v_and_b32 v183,s42,v86
v_pk_fma_f32 v[176:177],v[180:181],s[42:43],v[176:177] op_sel:[0,1,0] op_sel_hi:[1,1,1]
v_pk_fma_f32 v[186:187],v[178:179],4.0,v[186:187] op_sel_hi:[1,0,1]
v_pk_fma_f32 v[188:189],v[180:181],-4.0,v[184:185] op_sel_hi:[1,0,1]
v_pk_fma_f32 v[176:177],v[184:185],s[44:45],v[176:177] op_sel:[0,1,0] op_sel_hi:[1,1,1]
v_pk_fma_f32 v[186:187],v[182:183],s[40:41],v[186:187] op_sel:[0,1,0] op_sel_hi:[1,1,1]
v_pk_add_f32 v[184:185],v[184:185],v[180:181] neg_lo:[0,1] neg_hi:[0,1]
v_pk_fma_f32 v[180:181],v[178:179],-4.0,v[182:183] op_sel_hi:[1,0,1]
v_pk_add_f32 v[182:183],v[182:183],v[178:179] neg_lo:[0,1] neg_hi:[0,1]
v_pk_add_f32 v[178:179],v[188:189],v[180:181]
v_pk_add_f32 v[188:189],v[188:189],v[180:181] neg_lo:[0,1] neg_hi:[0,1]
v_pk_fma_f32 v[180:181],v[182:183],2.0,v[184:185] op_sel_hi:[1,0,1]
v_pk_fma_f32 v[184:185],v[182:183],-2.0,v[184:185] op_sel_hi:[1,0,1]
v_cvt_pk_bf16_f32 v74,v176,v177
v_cvt_pk_bf16_f32 v78,v178,v179
v_cvt_pk_bf16_f32 v82,v188,v189
v_cvt_pk_bf16_f32 v86,v180,v181
v_cvt_pk_bf16_f32 v90,v184,v185
v_cvt_pk_bf16_f32 v94,v186,v187
v_lshlrev_b32 v180,16,v83
v_and_b32 v181,s42,v83
v_lshlrev_b32 v176,16,v75
v_and_b32 v177,s42,v75
v_lshlrev_b32 v178,16,v79
v_and_b32 v179,s42,v79
v_lshlrev_b32 v186,16,v95
v_and_b32 v187,s42,v95
v_lshlrev_b32 v184,16,v91
v_and_b32 v185,s42,v91
v_lshlrev_b32 v182,16,v87
v_and_b32 v183,s42,v87
v_pk_fma_f32 v[176:177],v[180:181],s[42:43],v[176:177] op_sel:[0,1,0] op_sel_hi:[1,1,1]
v_pk_fma_f32 v[186:187],v[178:179],4.0,v[186:187] op_sel_hi:[1,0,1]
v_pk_fma_f32 v[188:189],v[180:181],-4.0,v[184:185] op_sel_hi:[1,0,1]
v_pk_fma_f32 v[176:177],v[184:185],s[44:45],v[176:177] op_sel:[0,1,0] op_sel_hi:[1,1,1]
v_pk_fma_f32 v[186:187],v[182:183],s[40:41],v[186:187] op_sel:[0,1,0] op_sel_hi:[1,1,1]
v_pk_add_f32 v[184:185],v[184:185],v[180:181] neg_lo:[0,1] neg_hi:[0,1]
v_pk_fma_f32 v[180:181],v[178:179],-4.0,v[182:183] op_sel_hi:[1,0,1]
v_pk_add_f32 v[182:183],v[182:183],v[178:179] neg_lo:[0,1] neg_hi:[0,1]
v_pk_add_f32 v[178:179],v[188:189],v[180:181]
v_pk_add_f32 v[188:189],v[188:189],v[180:181] neg_lo:[0,1] neg_hi:[0,1]
v_pk_fma_f32 v[180:181],v[182:183],2.0,v[184:185] op_sel_hi:[1,0,1]
v_pk_fma_f32 v[184:185],v[182:183],-2.0,v[184:185] op_sel_hi:[1,0,1]
v_cvt_pk_bf16_f32 v75,v176,v177
v_cvt_pk_bf16_f32 v79,v178,v179
v_cvt_pk_bf16_f32 v83,v188,v189
v_cvt_pk_bf16_f32 v87,v180,v181
v_cvt_pk_bf16_f32 v91,v184,v185
v_cvt_pk_bf16_f32 v95,v186,v187
ds_write_b128 v172,v[72:75] offset:1536
ds_write_b128 v171,v[76:79] offset:18944
ds_write_b128 v171,v[80:83] offset:27648
ds_write_b128 v171,v[84:87] offset:36352
ds_write_b128 v171,v[88:91] offset:45056
ds_write_b128 v172,v[92:95] offset:10240
s_waitcnt vmcnt(3)
v_lshlrev_b32 v180,16,v98
v_and_b32 v181,s42,v98
v_lshlrev_b32 v176,16,v96
v_and_b32 v177,s42,v96
v_lshlrev_b32 v178,16,v97
v_and_b32 v179,s42,v97
s_waitcnt vmcnt(0)
v_lshlrev_b32 v186,16,v101
v_and_b32 v187,s42,v101
v_lshlrev_b32 v184,16,v100
v_and_b32 v185,s42,v100
v_lshlrev_b32 v182,16,v99
v_and_b32 v183,s42,v99
v_pk_fma_f32 v[176:177],v[180:181],s[42:43],v[176:177] op_sel:[0,1,0] op_sel_hi:[1,1,1]
v_pk_fma_f32 v[186:187],v[178:179],4.0,v[186:187] op_sel_hi:[1,0,1]
v_pk_fma_f32 v[188:189],v[180:181],-4.0,v[184:185] op_sel_hi:[1,0,1]
v_pk_fma_f32 v[176:177],v[184:185],s[44:45],v[176:177] op_sel:[0,1,0] op_sel_hi:[1,1,1]
v_pk_fma_f32 v[186:187],v[182:183],s[40:41],v[186:187] op_sel:[0,1,0] op_sel_hi:[1,1,1]
v_pk_add_f32 v[184:185],v[184:185],v[180:181] neg_lo:[0,1] neg_hi:[0,1]
v_pk_fma_f32 v[180:181],v[178:179],-4.0,v[182:183] op_sel_hi:[1,0,1]
v_pk_add_f32 v[182:183],v[182:183],v[178:179] neg_lo:[0,1] neg_hi:[0,1]
v_pk_add_f32 v[178:179],v[188:189],v[180:181]
v_pk_add_f32 v[188:189],v[188:189],v[180:181] neg_lo:[0,1] neg_hi:[0,1]
v_pk_fma_f32 v[180:181],v[182:183],2.0,v[184:185] op_sel_hi:[1,0,1]
v_pk_fma_f32 v[184:185],v[182:183],-2.0,v[184:185] op_sel_hi:[1,0,1]
v_cvt_pk_bf16_f32 v96,v176,v177
v_cvt_pk_bf16_f32 v97,v178,v179
v_cvt_pk_bf16_f32 v98,v188,v189
v_cvt_pk_bf16_f32 v99,v180,v181
v_cvt_pk_bf16_f32 v100,v184,v185
v_cvt_pk_bf16_f32 v101,v186,v187
ds_write_b32 v174,v96 offset:0
ds_write_b32 v173,v97 offset:17408
ds_write_b32 v173,v98 offset:26112
ds_write_b32 v173,v99 offset:34816
ds_write_b32 v173,v100 offset:43520
ds_write_b32 v174,v101 offset:8704
s_waitcnt lgkmcnt(0)
s_barrier
ds_read_b128 a[192:195],v248 offset:17408
ds_read_b128 a[196:199],v249 offset:17408
ds_read_b128 a[200:203],v248 offset:17920
ds_read_b128 a[204:207],v249 offset:17920
v_and_b32 v165,1,v164
v_lshlrev_b32 v165,2,v165
s_mov_b32 s84,0
L_poll:
global_load_dword v166,v165,s[52:53] offset:128 sc1
s_add_u32 s84,s84,1
s_waitcnt vmcnt(0)
v_cmp_eq_u32 vcc,0,v166
s_cmp_gt_u32 s84,0x4000
s_cbranch_scc1 L_fallback
s_cbranch_vccnz L_poll
L_uready:
s_add_u32 s46,s72,9216
buffer_load_dwordx4 a[96:99],v250,s[20:23],s46 offen offset:0 sc1
buffer_load_dwordx4 a[100:103],v250,s[20:23],s46 offen offset:1024 sc1
buffer_load_dwordx4 a[104:107],v250,s[20:23],s46 offen offset:2048 sc1
s_add_u32 s47,s72,12288
buffer_load_dwordx4 a[108:111],v250,s[20:23],s47 offen offset:0 sc1
buffer_load_dwordx4 a[112:115],v250,s[20:23],s47 offen offset:1024 sc1
buffer_load_dwordx4 a[116:119],v250,s[20:23],s47 offen offset:2048 sc1
s_add_u32 s48,s72,15360
buffer_load_dwordx4 a[120:123],v250,s[20:23],s48 offen offset:0 sc1
buffer_load_dwordx4 a[124:127],v250,s[20:23],s48 offen offset:1024 sc1
buffer_load_dwordx4 a[128:131],v250,s[20:23],s48 offen offset:2048 sc1
s_getpc_b64 s[62:63]
L_pc2:
s_sub_u32 s62,s62,L_pc2-L_pc
s_subb_u32 s63,s63,0
s_lshr_b32 s61,s2,3
s_waitcnt vmcnt(8) lgkmcnt(3)
M a[0:3],a[96:99],a[192:195],0
s_waitcnt vmcnt(7) lgkmcnt(2)
s_add_u32 s46,s72,18432
buffer_load_dwordx4 a[132:135],v250,s[20:23],s46 offen offset:0 sc1
M a[0:3],a[100:103],a[196:199],a[0:3]
s_waitcnt vmcnt(7) lgkmcnt(1)
ds_read_b128 a[208:211],v248 offset:18432
ds_read_b128 a[212:215],v249 offset:18432
M a[0:3],a[104:107],a[200:203],a[0:3]
s_waitcnt lgkmcnt(2)
buffer_load_dwordx4 a[136:139],v250,s[20:23],s46 offen offset:1024 sc1
M a[4:7],a[104:107],a[204:207],0
M a[4:7],a[100:103],a[200:203],a[4:7]
M a[4:7],a[96:99],a[196:199],a[4:7]
M a[8:11],a[96:99],a[200:203],0
buffer_load_dwordx4 a[140:143],v250,s[20:23],s46 offen offset:2048 sc1
M a[8:11],a[100:103],a[204:207],a[8:11]
s_waitcnt lgkmcnt(1)
s_add_u32 s47,s72,21504
ds_read_b128 a[216:219],v248 offset:18944
ds_read_b128 a[220:223],v249 offset:18944
M a[8:11],a[104:107],a[208:211],a[8:11]
s_waitcnt lgkmcnt(2)
M a[12:15],a[104:107],a[212:215],0
M a[12:15],a[100:103],a[208:211],a[12:15]
buffer_load_dwordx4 a[164:167],v250,s[20:23],s47 offen offset:0 sc1
M a[12:15],a[96:99],a[204:207],a[12:15]
M a[16:19],a[96:99],a[208:211],0
ds_read_b128 a[224:227],v249 offset:19456
M a[16:19],a[100:103],a[212:215],a[16:19]
s_waitcnt lgkmcnt(2)
ds_read_b128 a[228:231],v248 offset:19456
M a[16:19],a[104:107],a[216:219],a[16:19]
s_waitcnt lgkmcnt(2)
buffer_load_dwordx4 a[160:163],v250,s[20:23],s47 offen offset:1024 sc1
M a[20:23],a[104:107],a[220:223],0
M a[20:23],a[100:103],a[216:219],a[20:23]
M a[20:23],a[96:99],a[212:215],a[20:23]
M a[24:27],a[96:99],a[216:219],0
buffer_load_dwordx4 a[168:171],v250,s[20:23],s47 offen offset:2048 sc1
M a[24:27],a[100:103],a[220:223],a[24:27]
s_waitcnt lgkmcnt(1)
s_add_u32 s48,s72,24576
M a[24:27],a[104:107],a[224:227],a[24:27]
s_waitcnt lgkmcnt(0)
M a[28:31],a[104:107],a[228:231],0
M a[28:31],a[100:103],a[224:227],a[28:31]
buffer_load_dwordx4 v[4:7],v250,s[20:23],s48 offen offset:0 sc1
M a[28:31],a[96:99],a[220:223],a[28:31]
s_waitcnt vmcnt(12)
M a[32:35],a[108:111],a[192:195],0
s_waitcnt vmcnt(11)
M a[32:35],a[112:115],a[196:199],a[32:35]
s_waitcnt vmcnt(10)
M a[32:35],a[116:119],a[200:203],a[32:35]
buffer_load_dwordx4 v[0:3],v250,s[20:23],s48 offen offset:1024 sc1
M a[36:39],a[116:119],a[204:207],0
M a[36:39],a[112:115],a[200:203],a[36:39]
M a[36:39],a[108:111],a[196:199],a[36:39]
M a[40:43],a[108:111],a[200:203],0
buffer_load_dwordx4 v[8:11],v250,s[20:23],s48 offen offset:2048 sc1
M a[40:43],a[112:115],a[204:207],a[40:43]
s_add_u32 s46,s72,27648
M a[40:43],a[116:119],a[208:211],a[40:43]
M a[44:47],a[116:119],a[212:215],0
M a[44:47],a[112:115],a[208:211],a[44:47]
buffer_load_dwordx4 v[36:39],v250,s[20:23],s46 offen offset:0 sc1
M a[44:47],a[108:111],a[204:207],a[44:47]
M a[48:51],a[108:111],a[208:211],0
M a[48:51],a[112:115],a[212:215],a[48:51]
M a[48:51],a[116:119],a[216:219],a[48:51]
buffer_load_dwordx4 v[32:35],v250,s[20:23],s46 offen offset:1024 sc1
M a[52:55],a[116:119],a[220:223],0
M a[52:55],a[112:115],a[216:219],a[52:55]
M a[52:55],a[108:111],a[212:215],a[52:55]
M a[56:59],a[108:111],a[216:219],0
buffer_load_dwordx4 v[40:43],v250,s[20:23],s46 offen offset:2048 sc1
M a[56:59],a[112:115],a[220:223],a[56:59]
s_add_u32 s47,s72,30720
M a[56:59],a[116:119],a[224:227],a[56:59]
M a[60:63],a[116:119],a[228:231],0
M a[60:63],a[112:115],a[224:227],a[60:63]
buffer_load_dwordx4 v[68:71],v250,s[20:23],s47 offen offset:0 sc1
M a[60:63],a[108:111],a[220:223],a[60:63]
s_waitcnt vmcnt(15)
M a[64:67],a[120:123],a[192:195],0
s_waitcnt vmcnt(14)
M a[64:67],a[124:127],a[196:199],a[64:67]
s_waitcnt vmcnt(13)
M a[64:67],a[128:131],a[200:203],a[64:67]
buffer_load_dwordx4 v[64:67],v250,s[20:23],s47 offen offset:1024 sc1
M a[68:71],a[128:131],a[204:207],0
M a[68:71],a[124:127],a[200:203],a[68:71]
M a[68:71],a[120:123],a[196:199],a[68:71]
M a[72:75],a[120:123],a[200:203],0
buffer_load_dwordx4 v[72:75],v250,s[20:23],s47 offen offset:2048 sc1
M a[72:75],a[124:127],a[204:207],a[72:75]
s_add_u32 s48,s72,33792
M a[72:75],a[128:131],a[208:211],a[72:75]
M a[76:79],a[128:131],a[212:215],0
M a[76:79],a[124:127],a[208:211],a[76:79]
buffer_load_dwordx4 v[100:103],v250,s[20:23],s48 offen offset:0 sc1
M a[76:79],a[120:123],a[204:207],a[76:79]
M a[80:83],a[120:123],a[208:211],0
M a[80:83],a[124:127],a[212:215],a[80:83]
M a[80:83],a[128:131],a[216:219],a[80:83]
buffer_load_dwordx4 v[96:99],v250,s[20:23],s48 offen offset:1024 sc1
M a[84:87],a[128:131],a[220:223],0
M a[84:87],a[124:127],a[216:219],a[84:87]
ds_read_b128 a[232:235],v248 offset:26112
M a[84:87],a[120:123],a[212:215],a[84:87]
ds_read_b128 a[236:239],v249 offset:26112
M a[88:91],a[120:123],a[216:219],0
buffer_load_dwordx4 v[104:107],v250,s[20:23],s48 offen offset:2048 sc1
M a[88:91],a[124:127],a[220:223],a[88:91]
s_add_u32 s46,s72,36864
ds_read_b128 a[240:243],v248 offset:26624
ds_read_b128 a[244:247],v249 offset:26624
M a[88:91],a[128:131],a[224:227],a[88:91]
M a[92:95],a[128:131],a[228:231],0
M a[92:95],a[124:127],a[224:227],a[92:95]
s_add_u32 s28,s68,0
buffer_load_dwordx4 v[132:135],v250,s[20:23],s46 offen offset:0 sc1
M a[92:95],a[120:123],a[220:223],a[92:95]
s_waitcnt vmcnt(18) lgkmcnt(3)
M a[96:99],a[132:135],a[232:235],0
s_waitcnt vmcnt(17) lgkmcnt(2)
ds_read_b128 a[248:251],v248 offset:27136
M a[96:99],a[136:139],a[236:239],a[96:99]
s_waitcnt vmcnt(16) lgkmcnt(2)
ds_read_b128 a[252:255],v249 offset:27136
M a[96:99],a[140:143],a[240:243],a[96:99]
s_waitcnt lgkmcnt(2)
buffer_load_dwordx4 v[128:131],v250,s[20:23],s46 offen offset:1024 sc1
M a[100:103],a[140:143],a[244:247],0
M a[100:103],a[136:139],a[240:243],a[100:103]
M a[100:103],a[132:135],a[236:239],a[100:103]
M a[104:107],a[132:135],a[240:243],0
buffer_load_dwordx4 v[136:139],v250,s[20:23],s46 offen offset:2048 sc1
M a[104:107],a[136:139],a[244:247],a[104:107]
s_waitcnt lgkmcnt(1)
ds_read_b128 v[216:219],v248 offset:27648
ds_read_b128 v[220:223],v249 offset:27648
M a[104:107],a[140:143],a[248:251],a[104:107]
s_waitcnt lgkmcnt(2)
M a[108:111],a[140:143],a[252:255],0
M a[108:111],a[136:139],a[248:251],a[108:111]
buffer_load_dwordx2 v[192:193],v251,s[12:15],s28 offen offset:0
M a[108:111],a[132:135],a[244:247],a[108:111]
M a[112:115],a[132:135],a[248:251],0
ds_read_b128 v[224:227],v249 offset:28160
M a[112:115],a[136:139],a[252:255],a[112:115]
s_waitcnt lgkmcnt(2)
ds_read_b128 v[228:231],v248 offset:28160
M a[112:115],a[140:143],v[216:219],a[112:115]
s_waitcnt lgkmcnt(2)
buffer_load_dwordx2 v[202:203],v251,s[16:19],s28 offen offset:1536
M a[116:119],a[140:143],v[220:223],0
M a[116:119],a[136:139],v[216:219],a[116:119]
M a[116:119],a[132:135],a[252:255],a[116:119]
M a[120:123],a[132:135],v[216:219],0
buffer_load_dwordx2 v[194:195],v251,s[8:11],s28 offen offset:0
M a[120:123],a[136:139],v[220:223],a[120:123]
s_waitcnt lgkmcnt(1)
M a[120:123],a[140:143],v[224:227],a[120:123]
s_waitcnt lgkmcnt(0)
M a[124:127],a[140:143],v[228:231],0
M a[124:127],a[136:139],v[224:227],a[124:127]
buffer_load_dwordx2 v[196:197],v251,s[8:11],s28 offen offset:384
M a[124:127],a[132:135],v[220:223],a[124:127]
s_waitcnt vmcnt(21)
M a[128:131],a[164:167],a[232:235],0
s_waitcnt vmcnt(20)
M a[128:131],a[160:163],a[236:239],a[128:131]
s_waitcnt vmcnt(19)
M a[128:131],a[168:171],a[240:243],a[128:131]
buffer_load_dwordx2 v[198:199],v251,s[8:11],s28 offen offset:768
M a[132:135],a[168:171],a[244:247],0
M a[132:135],a[160:163],a[240:243],a[132:135]
M a[132:135],a[164:167],a[236:239],a[132:135]
M a[136:139],a[164:167],a[240:243],0
buffer_load_dwordx2 v[200:201],v251,s[8:11],s28 offen offset:1152
M a[136:139],a[160:163],a[244:247],a[136:139]
M a[136:139],a[168:171],a[248:251],a[136:139]
M a[140:143],a[168:171],a[252:255],0
M a[140:143],a[160:163],a[248:251],a[140:143]
M a[140:143],a[164:167],a[244:247],a[140:143]
M a[144:147],a[164:167],a[248:251],0
M a[144:147],a[160:163],a[252:255],a[144:147]
M a[144:147],a[168:171],v[216:219],a[144:147]
M a[148:151],a[168:171],v[220:223],0
M a[148:151],a[160:163],v[216:219],a[148:151]
M a[148:151],a[164:167],a[252:255],a[148:151]
M a[152:155],a[164:167],v[216:219],0
M a[152:155],a[160:163],v[220:223],a[152:155]
M a[152:155],a[168:171],v[224:227],a[152:155]
M a[156:159],a[168:171],v[228:231],0
M a[156:159],a[160:163],v[224:227],a[156:159]
s_add_u32 s47,s72,39936
M a[156:159],a[164:167],v[220:223],a[156:159]
s_waitcnt vmcnt(20)
M a[160:163],v[4:7],a[232:235],0
s_waitcnt vmcnt(19)
M a[160:163],v[0:3],a[236:239],a[160:163]
s_waitcnt vmcnt(18)
M a[160:163],v[8:11],a[240:243],a[160:163]
M a[164:167],v[8:11],a[244:247],0
M a[164:167],v[0:3],a[240:243],a[164:167]
buffer_load_dwordx4 v[164:167],v250,s[20:23],s47 offen offset:0 sc1
M a[164:167],v[4:7],a[236:239],a[164:167]
M a[168:171],v[4:7],a[240:243],0
buffer_load_dwordx4 v[160:163],v250,s[20:23],s47 offen offset:1024 sc1
M a[168:171],v[0:3],a[244:247],a[168:171]
M a[168:171],v[8:11],a[248:251],a[168:171]
M a[172:175],v[8:11],a[252:255],0
M a[172:175],v[0:3],a[248:251],a[172:175]
buffer_load_dwordx4 v[168:171],v250,s[20:23],s47 offen offset:2048 sc1
M a[172:175],v[4:7],a[244:247],a[172:175]
s_add_u32 s48,s72,43008
M a[176:179],v[4:7],a[248:251],0
M a[176:179],v[0:3],a[252:255],a[176:179]
M a[176:179],v[8:11],v[216:219],a[176:179]
buffer_load_dwordx4 a[192:195],v250,s[20:23],s48 offen offset:0 sc1
M a[180:183],v[8:11],v[220:223],0
M a[180:183],v[0:3],v[216:219],a[180:183]
ds_read_b128 a[204:207],v248 offset:34816
M a[180:183],v[4:7],a[252:255],a[180:183]
ds_read_b128 a[208:211],v249 offset:34816
M a[184:187],v[4:7],v[216:219],0
buffer_load_dwordx4 a[196:199],v250,s[20:23],s48 offen offset:1024 sc1
M a[184:187],v[0:3],v[220:223],a[184:187]
ds_read_b128 a[216:219],v248 offset:35328
ds_read_b128 a[228:231],v249 offset:35328
M a[184:187],v[8:11],v[224:227],a[184:187]
M a[188:191],v[8:11],v[228:231],0
M a[188:191],v[0:3],v[224:227],a[188:191]
buffer_load_dwordx4 a[200:203],v250,s[20:23],s48 offen offset:2048 sc1
M a[188:191],v[4:7],v[220:223],a[188:191]
s_waitcnt vmcnt(23) lgkmcnt(3)
s_add_u32 s46,s73,9216
M v[0:3],v[36:39],a[204:207],0
s_waitcnt vmcnt(22) lgkmcnt(2)
ds_read_b128 a[224:227],v248 offset:35840
M v[0:3],v[32:35],a[208:211],v[0:3]
s_waitcnt vmcnt(21) lgkmcnt(2)
ds_read_b128 a[220:223],v249 offset:35840
M v[0:3],v[40:43],a[216:219],v[0:3]
s_waitcnt lgkmcnt(2)
buffer_load_dwordx4 a[212:215],v250,s[20:23],s46 offen offset:0 sc1
M v[4:7],v[40:43],a[228:231],0
M v[4:7],v[32:35],a[216:219],v[4:7]
M v[4:7],v[36:39],a[208:211],v[4:7]
M v[8:11],v[36:39],a[216:219],0
ds_read_b128 a[232:235],v248 offset:36352
M v[8:11],v[32:35],a[228:231],v[8:11]
s_waitcnt lgkmcnt(2)
ds_read_b128 a[236:239],v249 offset:36352
M v[8:11],v[40:43],a[224:227],v[8:11]
s_waitcnt lgkmcnt(2)
M v[12:15],v[40:43],a[220:223],0
M v[12:15],v[32:35],a[224:227],v[12:15]
M v[12:15],v[36:39],a[228:231],v[12:15]
s_add_u32 s28,s68,393216
buffer_load_dwordx2 v[204:205],v245,s[12:15],s28 offen offset:0
M v[16:19],v[36:39],a[224:227],0
ds_read_b128 a[240:243],v249 offset:36864
M v[16:19],v[32:35],a[220:223],v[16:19]
s_waitcnt lgkmcnt(2)
buffer_load_dwordx2 v[214:215],v245,s[16:19],s28 offen offset:1536
M v[16:19],v[40:43],a[232:235],v[16:19]
s_waitcnt lgkmcnt(1)
ds_read_b128 a[244:247],v248 offset:36864
M v[20:23],v[40:43],a[236:239],0
M v[20:23],v[32:35],a[232:235],v[20:23]
M v[20:23],v[36:39],a[220:223],v[20:23]
buffer_load_dwordx2 v[206:207],v245,s[8:11],s28 offen offset:0
M v[24:27],v[36:39],a[232:235],0
M v[24:27],v[32:35],a[236:239],v[24:27]
s_waitcnt lgkmcnt(1)
M v[24:27],v[40:43],a[240:243],v[24:27]
s_waitcnt lgkmcnt(0)
M v[28:31],v[40:43],a[244:247],0
buffer_load_dwordx2 v[208:209],v245,s[8:11],s28 offen offset:384
M v[28:31],v[32:35],a[240:243],v[28:31]
M v[28:31],v[36:39],a[236:239],v[28:31]
s_waitcnt vmcnt(25)
M v[32:35],v[68:71],a[204:207],0
s_waitcnt vmcnt(24)
M v[32:35],v[64:67],a[208:211],v[32:35]
s_waitcnt vmcnt(23)
buffer_load_dwordx2 v[210:211],v245,s[8:11],s28 offen offset:768
M v[32:35],v[72:75],a[216:219],v[32:35]
M v[36:39],v[72:75],a[228:231],0
M v[36:39],v[64:67],a[216:219],v[36:39]
M v[36:39],v[68:71],a[208:211],v[36:39]
buffer_load_dwordx2 v[212:213],v245,s[8:11],s28 offen offset:1152
M v[40:43],v[68:71],a[216:219],0
s_add_u32 s29,s68,0
M v[40:43],v[64:67],a[228:231],v[40:43]
M v[40:43],v[72:75],a[224:227],v[40:43]
M v[44:47],v[72:75],a[220:223],0
buffer_load_short_d16_hi v239,v246,s[12:15],s29 offen offset:0
M v[44:47],v[64:67],a[224:227],v[44:47]
M v[44:47],v[68:71],a[228:231],v[44:47]
buffer_load_short_d16_hi v240,v246,s[8:11],s29 offen offset:0
M v[48:51],v[68:71],a[224:227],0
M v[48:51],v[64:67],a[220:223],v[48:51]
buffer_load_short_d16_hi v241,v246,s[8:11],s29 offen offset:384
M v[48:51],v[72:75],a[232:235],v[48:51]
M v[52:55],v[72:75],a[236:239],0
buffer_load_short_d16_hi v242,v246,s[8:11],s29 offen offset:768
M v[52:55],v[64:67],a[232:235],v[52:55]
M v[52:55],v[68:71],a[220:223],v[52:55]
buffer_load_short_d16_hi v243,v246,s[8:11],s29 offen offset:1152
M v[56:59],v[68:71],a[232:235],0
M v[56:59],v[64:67],a[236:239],v[56:59]
buffer_load_short_d16_hi v244,v246,s[16:19],s29 offen offset:1536
M v[56:59],v[72:75],a[240:243],v[56:59]
M v[60:63],v[72:75],a[244:247],0
M v[60:63],v[64:67],a[240:243],v[60:63]
M v[60:63],v[68:71],a[236:239],v[60:63]
s_waitcnt vmcnt(30)
M v[64:67],v[100:103],a[204:207],0
s_waitcnt vmcnt(29)
M v[64:67],v[96:99],a[208:211],v[64:67]
s_waitcnt vmcnt(28)
M v[64:67],v[104:107],a[216:219],v[64:67]
M v[68:71],v[104:107],a[228:231],0
M v[68:71],v[96:99],a[216:219],v[68:71]
M v[68:71],v[100:103],a[208:211],v[68:71]
M v[72:75],v[100:103],a[216:219],0
M v[72:75],v[96:99],a[228:231],v[72:75]
M v[72:75],v[104:107],a[224:227],v[72:75]
M v[76:79],v[104:107],a[220:223],0
M v[76:79],v[96:99],a[224:227],v[76:79]
M v[76:79],v[100:103],a[228:231],v[76:79]
M v[80:83],v[100:103],a[224:227],0
M v[80:83],v[96:99],a[220:223],v[80:83]
M v[80:83],v[104:107],a[232:235],v[80:83]
M v[84:87],v[104:107],a[236:239],0
M v[84:87],v[96:99],a[232:235],v[84:87]
ds_read_b128 a[248:251],v248 offset:43520
M v[84:87],v[100:103],a[220:223],v[84:87]
ds_read_b128 a[252:255],v249 offset:43520
M v[88:91],v[100:103],a[232:235],0
ds_read_b128 v[216:219],v248 offset:44032
M v[88:91],v[96:99],a[236:239],v[88:91]
ds_read_b128 v[228:231],v249 offset:44032
M v[88:91],v[104:107],a[240:243],v[88:91]
M v[92:95],v[104:107],a[244:247],0
M v[92:95],v[96:99],a[240:243],v[92:95]
M v[92:95],v[100:103],a[236:239],v[92:95]
s_waitcnt vmcnt(27) lgkmcnt(3)
M v[96:99],v[132:135],a[248:251],0
s_waitcnt vmcnt(26) lgkmcnt(2)
ds_read_b128 v[224:227],v248 offset:44544
M v[96:99],v[128:131],a[252:255],v[96:99]
s_waitcnt vmcnt(25) lgkmcnt(2)
ds_read_b128 v[220:223],v249 offset:44544
M v[96:99],v[136:139],v[216:219],v[96:99]
s_waitcnt lgkmcnt(2)
M v[100:103],v[136:139],v[228:231],0
M v[100:103],v[128:131],v[216:219],v[100:103]
M v[100:103],v[132:135],a[252:255],v[100:103]
M v[104:107],v[132:135],v[216:219],0
ds_read_b128 a[204:207],v248 offset:45056
M v[104:107],v[128:131],v[228:231],v[104:107]
s_waitcnt lgkmcnt(2)
ds_read_b128 a[208:211],v249 offset:45056
M v[104:107],v[136:139],v[224:227],v[104:107]
s_waitcnt lgkmcnt(2)
M v[108:111],v[136:139],v[220:223],0
s_waitcnt vmcnt(21)
v_lshlrev_b32 v234,16,v196
v_lshlrev_b32 v232,16,v192
M v[108:111],v[128:131],v[224:227],v[108:111]
v_lshlrev_b32 v233,16,v194
v_lshlrev_b32 v237,16,v202
M v[108:111],v[132:135],v[228:231],v[108:111]
s_waitcnt vmcnt(19)
v_lshlrev_b32 v236,16,v200
v_lshlrev_b32 v235,16,v198
M v[112:115],v[132:135],v[224:227],0
ds_read_b128 a[216:219],v249 offset:45568
v_fmac_f32 v232,s43,v234
M v[112:115],v[128:131],v[220:223],v[112:115]
s_waitcnt lgkmcnt(2)
ds_read_b128 a[228:231],v248 offset:45568
v_fmac_f32 v237,4.0,v233
M v[112:115],v[136:139],a[204:207],v[112:115]
s_waitcnt lgkmcnt(2)
v_fma_f32 v238,-4.0,v234,v236
v_fmac_f32 v232,s45,v236
M v[116:119],v[136:139],a[208:211],0
v_fmac_f32 v237,s41,v235
v_sub_f32 v236,v236,v234
M v[116:119],v[128:131],a[204:207],v[116:119]
v_fma_f32 v234,-4.0,v233,v235
v_sub_f32 v235,v235,v233
M v[116:119],v[132:135],v[220:223],v[116:119]
v_add_f32 v233,v238,v234
v_sub_f32 v238,v238,v234
M v[120:123],v[132:135],a[204:207],0
v_fma_f32 v234,2.0,v235,v236
v_fmac_f32 v236,-2.0,v235
M v[120:123],v[128:131],a[208:211],v[120:123]
s_waitcnt lgkmcnt(1)
v_and_b32 v196,s42,v196
v_and_b32 v192,s42,v192
M v[120:123],v[136:139],a[216:219],v[120:123]
s_waitcnt lgkmcnt(0)
v_and_b32 v194,s42,v194
v_and_b32 v202,s42,v202
M v[124:127],v[136:139],a[228:231],0
buffer_load_dwordx4 a[224:227],v250,s[20:23],s46 offen offset:1024 sc1
M v[124:127],v[128:131],a[216:219],v[124:127]
v_and_b32 v200,s42,v200
v_and_b32 v198,s42,v198
M v[124:127],v[132:135],a[208:211],v[124:127]
s_waitcnt vmcnt(19)
buffer_load_dwordx4 a[220:223],v250,s[20:23],s46 offen offset:2048 sc1
M v[128:131],v[164:167],a[248:251],0
s_waitcnt vmcnt(19)
s_add_u32 s47,s73,12288
v_fmac_f32 v192,s43,v196
v_fmac_f32 v202,4.0,v194
M v[128:131],v[160:163],a[252:255],v[128:131]
s_waitcnt vmcnt(18)
v_fma_f32 v235,-4.0,v196,v200
v_fmac_f32 v192,s45,v200
M v[128:131],v[168:171],v[216:219],v[128:131]
v_fmac_f32 v202,s41,v198
v_sub_f32 v200,v200,v196
M v[132:135],v[168:171],v[228:231],0
buffer_load_dwordx4 a[232:235],v250,s[20:23],s47 offen offset:0 sc1
M v[132:135],v[160:163],v[216:219],v[132:135]
v_fma_f32 v196,-4.0,v194,v198
v_sub_f32 v198,v198,v194
M v[132:135],v[164:167],a[252:255],v[132:135]
v_add_f32 v194,v235,v196
v_sub_f32 v235,v235,v196
M v[136:139],v[164:167],v[216:219],0
v_fma_f32 v196,2.0,v198,v200
v_fmac_f32 v200,-2.0,v198
M v[136:139],v[160:163],v[228:231],v[136:139]
v_cvt_pk_bf16_f32 v192,v232,v192
v_cvt_pk_bf16_f32 v202,v237,v202
M v[136:139],v[168:171],v[224:227],v[136:139]
v_cvt_pk_bf16_f32 v194,v233,v194
v_cvt_pk_bf16_f32 v198,v234,v196
M v[140:143],v[168:171],v[220:223],0
v_cvt_pk_bf16_f32 v196,v238,v235
v_cvt_pk_bf16_f32 v200,v236,v200
M v[140:143],v[160:163],v[224:227],v[140:143]
v_lshlrev_b32 v234,16,v197
v_lshlrev_b32 v232,16,v193
M v[140:143],v[164:167],v[228:231],v[140:143]
v_lshlrev_b32 v233,16,v195
v_lshlrev_b32 v237,16,v203
M v[144:147],v[164:167],v[224:227],0
v_lshlrev_b32 v236,16,v201
v_lshlrev_b32 v235,16,v199
M v[144:147],v[160:163],v[220:223],v[144:147]
v_fmac_f32 v232,s43,v234
v_fmac_f32 v237,4.0,v233
M v[144:147],v[168:171],a[204:207],v[144:147]
v_fma_f32 v238,-4.0,v234,v236
v_fmac_f32 v232,s45,v236
M v[148:151],v[168:171],a[208:211],0
v_fmac_f32 v237,s41,v235
v_sub_f32 v236,v236,v234
M v[148:151],v[160:163],a[204:207],v[148:151]
v_fma_f32 v234,-4.0,v233,v235
v_sub_f32 v235,v235,v233
M v[148:151],v[164:167],v[220:223],v[148:151]
v_add_f32 v233,v238,v234
v_sub_f32 v238,v238,v234
M v[152:155],v[164:167],a[204:207],0
v_fma_f32 v234,2.0,v235,v236
v_fmac_f32 v236,-2.0,v235
M v[152:155],v[160:163],a[208:211],v[152:155]
v_and_b32 v197,s42,v197
v_and_b32 v193,s42,v193
M v[152:155],v[168:171],a[216:219],v[152:155]
v_and_b32 v195,s42,v195
v_and_b32 v203,s42,v203
M v[156:159],v[168:171],a[228:231],0
buffer_load_dwordx4 a[244:247],v250,s[20:23],s47 offen offset:1024 sc1
M v[156:159],v[160:163],a[216:219],v[156:159]
v_and_b32 v201,s42,v201
v_and_b32 v199,s42,v199
M v[156:159],v[164:167],a[208:211],v[156:159]
s_waitcnt vmcnt(19)
buffer_load_dwordx4 a[240:243],v250,s[20:23],s47 offen offset:2048 sc1
M v[160:163],a[192:195],a[248:251],0
s_waitcnt vmcnt(19)
s_add_u32 s48,s73,15360
v_fmac_f32 v193,s43,v197
v_fmac_f32 v203,4.0,v195
M v[160:163],a[196:199],a[252:255],v[160:163]
s_waitcnt vmcnt(18)
v_fma_f32 v235,-4.0,v197,v201
v_fmac_f32 v193,s45,v201
M v[160:163],a[200:203],v[216:219],v[160:163]
v_fmac_f32 v203,s41,v199
v_sub_f32 v201,v201,v197
M v[164:167],a[200:203],v[228:231],0
buffer_load_dwordx4 a[236:239],v250,s[20:23],s48 offen offset:0 sc1
M v[164:167],a[196:199],v[216:219],v[164:167]
v_fma_f32 v197,-4.0,v195,v199
v_sub_f32 v199,v199,v195
M v[164:167],a[192:195],a[252:255],v[164:167]
v_add_f32 v195,v235,v197
v_sub_f32 v235,v235,v197
M v[168:171],a[192:195],v[216:219],0
v_fma_f32 v197,2.0,v199,v201
v_fmac_f32 v201,-2.0,v199
M v[168:171],a[196:199],v[228:231],v[168:171]
buffer_load_dwordx4 a[248:251],v250,s[20:23],s48 offen offset:1024 sc1
M v[168:171],a[200:203],v[224:227],v[168:171]
v_cvt_pk_bf16_f32 v193,v232,v193
v_cvt_pk_bf16_f32 v203,v237,v203
M v[172:175],a[200:203],v[220:223],0
v_cvt_pk_bf16_f32 v195,v233,v195
v_cvt_pk_bf16_f32 v199,v234,v197
M v[172:175],a[196:199],v[224:227],v[172:175]
v_cvt_pk_bf16_f32 v197,v238,v235
v_cvt_pk_bf16_f32 v201,v236,v201
M v[172:175],a[192:195],v[228:231],v[172:175]
buffer_load_dwordx4 a[252:255],v250,s[20:23],s48 offen offset:2048 sc1
M v[176:179],a[192:195],v[224:227],0
s_waitcnt vmcnt(16)
s_add_u32 s46,s73,18432
v_lshlrev_b32 v234,16,v208
v_lshlrev_b32 v232,16,v204
M v[176:179],a[196:199],v[220:223],v[176:179]
v_lshlrev_b32 v233,16,v206
v_lshlrev_b32 v237,16,v214
M v[176:179],a[200:203],a[204:207],v[176:179]
s_waitcnt vmcnt(14)
s_barrier
v_lshlrev_b32 v236,16,v212
M v[180:183],a[200:203],a[208:211],0
buffer_load_dwordx4 v[216:219],v250,s[20:23],s46 offen offset:0 sc1
M v[180:183],a[196:199],a[204:207],v[180:183]
ds_read_b128 v[228:231],v248 offset:52224
v_lshlrev_b32 v235,16,v210
M v[180:183],a[192:195],v[220:223],v[180:183]
ds_write2st64_b64 v247,v[192:193],v[202:203] offset0:204 offset1:221
M v[184:187],a[192:195],a[204:207],0
s_add_u32 s28,s68,786432
ds_read_b128 v[224:227],v249 offset:52224
ds_read_b128 v[220:223],v248 offset:52736
M v[184:187],a[196:199],a[208:211],v[184:187]
buffer_load_dwordx2 v[192:193],v245,s[12:15],s28 offen offset:0
M v[184:187],a[200:203],a[216:219],v[184:187]
ds_write2st64_b64 v247,v[194:195],v[196:197] offset0:34 offset1:51
M v[188:191],a[200:203],a[228:231],0
ds_read_b128 a[204:207],v249 offset:52736
v_fmac_f32 v232,s43,v234
M v[188:191],a[196:199],a[216:219],v[188:191]
buffer_load_dwordx2 v[202:203],v245,s[16:19],s28 offen offset:1536
M v[188:191],a[192:195],a[208:211],v[188:191]
s_waitcnt lgkmcnt(5)
ds_write2st64_b64 v247,v[198:199],v[200:201] offset0:68 offset1:85
M a[0:3],a[212:215],v[228:231],a[0:3]
s_waitcnt vmcnt(10) lgkmcnt(4)
ds_read_b128 a[200:203],v248 offset:53248
v_fmac_f32 v237,4.0,v233
M a[0:3],a[224:227],v[224:227],a[0:3]
s_waitcnt vmcnt(9) lgkmcnt(4)
buffer_load_dwordx2 v[194:195],v245,s[8:11],s28 offen offset:0
M a[0:3],a[220:223],v[220:223],a[0:3]
s_waitcnt lgkmcnt(2)
ds_read_b128 a[228:231],v249 offset:53248
v_fma_f32 v238,-4.0,v234,v236
M a[4:7],a[220:223],a[204:207],a[4:7]
v_fmac_f32 v232,s45,v236
v_fmac_f32 v237,s41,v235
M a[4:7],a[224:227],v[220:223],a[4:7]
v_sub_f32 v236,v236,v234
v_fma_f32 v234,-4.0,v233,v235
M a[4:7],a[212:215],v[224:227],a[4:7]
buffer_load_dwordx2 v[196:197],v245,s[8:11],s28 offen offset:384
M a[8:11],a[212:215],v[220:223],a[8:11]
ds_read_b128 a[196:199],v248 offset:53760
v_sub_f32 v235,v235,v233
M a[8:11],a[224:227],a[204:207],a[8:11]
s_waitcnt lgkmcnt(2)
ds_read_b128 a[216:219],v249 offset:53760
v_add_f32 v233,v238,v234
M a[8:11],a[220:223],a[200:203],a[8:11]
s_waitcnt lgkmcnt(2)
v_sub_f32 v238,v238,v234
v_fma_f32 v234,2.0,v235,v236
M a[12:15],a[220:223],a[228:231],a[12:15]
buffer_load_dwordx2 v[198:199],v245,s[8:11],s28 offen offset:768
M a[12:15],a[224:227],a[200:203],a[12:15]
v_fmac_f32 v236,-2.0,v235
v_and_b32 v208,s42,v208
M a[12:15],a[212:215],a[204:207],a[12:15]
v_and_b32 v204,s42,v204
v_and_b32 v206,s42,v206
M a[16:19],a[212:215],a[200:203],a[16:19]
ds_read_b128 a[192:195],v249 offset:54272
v_and_b32 v214,s42,v214
M a[16:19],a[224:227],a[228:231],a[16:19]
s_waitcnt lgkmcnt(2)
buffer_load_dwordx2 v[200:201],v245,s[8:11],s28 offen offset:1152
M a[16:19],a[220:223],a[196:199],a[16:19]
s_waitcnt lgkmcnt(1)
ds_read_b128 a[208:211],v248 offset:54272
v_and_b32 v212,s42,v212
M a[20:23],a[220:223],a[216:219],a[20:23]
v_and_b32 v210,s42,v210
v_fmac_f32 v204,s43,v208
M a[20:23],a[224:227],a[196:199],a[20:23]
v_fmac_f32 v214,4.0,v206
v_fma_f32 v235,-4.0,v208,v212
M a[20:23],a[212:215],a[228:231],a[20:23]
v_fmac_f32 v204,s45,v212
v_fmac_f32 v214,s41,v210
M a[24:27],a[212:215],a[196:199],a[24:27]
v_sub_f32 v212,v212,v208
v_fma_f32 v208,-4.0,v206,v210
M a[24:27],a[224:227],a[216:219],a[24:27]
s_waitcnt lgkmcnt(1)
v_sub_f32 v210,v210,v206
v_add_f32 v206,v235,v208
M a[24:27],a[220:223],a[192:195],a[24:27]
s_waitcnt lgkmcnt(0)
v_sub_f32 v235,v235,v208
v_fma_f32 v208,2.0,v210,v212
M a[28:31],a[220:223],a[208:211],a[28:31]
buffer_load_dwordx4 a[220:223],v250,s[20:23],s46 offen offset:1024 sc1
M a[28:31],a[224:227],a[192:195],a[28:31]
v_fmac_f32 v212,-2.0,v210
v_cvt_pk_bf16_f32 v204,v232,v204
M a[28:31],a[212:215],a[216:219],a[28:31]
s_waitcnt vmcnt(13)
buffer_load_dwordx4 a[224:227],v250,s[20:23],s46 offen offset:2048 sc1
M a[32:35],a[232:235],v[228:231],a[32:35]
s_waitcnt vmcnt(13)
s_add_u32 s47,s73,21504
v_cvt_pk_bf16_f32 v214,v237,v214
v_cvt_pk_bf16_f32 v206,v233,v206
M a[32:35],a[244:247],v[224:227],a[32:35]
s_waitcnt vmcnt(12)
v_cvt_pk_bf16_f32 v210,v234,v208
v_cvt_pk_bf16_f32 v208,v238,v235
M a[32:35],a[240:243],v[220:223],a[32:35]
v_cvt_pk_bf16_f32 v212,v236,v212
v_lshlrev_b32 v234,16,v209
M a[36:39],a[240:243],a[204:207],a[36:39]
buffer_load_dwordx4 a[212:215],v250,s[20:23],s47 offen offset:0 sc1
M a[36:39],a[244:247],v[220:223],a[36:39]
v_lshlrev_b32 v232,16,v205
v_lshlrev_b32 v233,16,v207
M a[36:39],a[232:235],v[224:227],a[36:39]
v_lshlrev_b32 v237,16,v215
v_lshlrev_b32 v236,16,v213
M a[40:43],a[232:235],v[220:223],a[40:43]
v_lshlrev_b32 v235,16,v211
v_fmac_f32 v232,s43,v234
M a[40:43],a[244:247],a[204:207],a[40:43]
v_fmac_f32 v237,4.0,v233
v_fma_f32 v238,-4.0,v234,v236
M a[40:43],a[240:243],a[200:203],a[40:43]
v_fmac_f32 v232,s45,v236
v_fmac_f32 v237,s41,v235
M a[44:47],a[240:243],a[228:231],a[44:47]
v_sub_f32 v236,v236,v234
v_fma_f32 v234,-4.0,v233,v235
M a[44:47],a[244:247],a[200:203],a[44:47]
v_sub_f32 v235,v235,v233
v_add_f32 v233,v238,v234
M a[44:47],a[232:235],a[204:207],a[44:47]
v_sub_f32 v238,v238,v234
v_fma_f32 v234,2.0,v235,v236
M a[48:51],a[232:235],a[200:203],a[48:51]
v_fmac_f32 v236,-2.0,v235
v_and_b32 v209,s42,v209
M a[48:51],a[244:247],a[228:231],a[48:51]
v_and_b32 v205,s42,v205
v_and_b32 v207,s42,v207
M a[48:51],a[240:243],a[196:199],a[48:51]
v_and_b32 v215,s42,v215
v_and_b32 v213,s42,v213
M a[52:55],a[240:243],a[216:219],a[52:55]
v_and_b32 v211,s42,v211
v_fmac_f32 v205,s43,v209
M a[52:55],a[244:247],a[196:199],a[52:55]
v_fmac_f32 v215,4.0,v207
v_fma_f32 v235,-4.0,v209,v213
M a[52:55],a[232:235],a[228:231],a[52:55]
v_fmac_f32 v205,s45,v213
v_fmac_f32 v215,s41,v211
M a[56:59],a[232:235],a[196:199],a[56:59]
v_sub_f32 v213,v213,v209
v_fma_f32 v209,-4.0,v207,v211
M a[56:59],a[244:247],a[216:219],a[56:59]
v_sub_f32 v211,v211,v207
v_add_f32 v207,v235,v209
M a[56:59],a[240:243],a[192:195],a[56:59]
v_sub_f32 v235,v235,v209
v_fma_f32 v209,2.0,v211,v213
M a[60:63],a[240:243],a[208:211],a[60:63]
buffer_load_dwordx4 a[240:243],v250,s[20:23],s47 offen offset:1024 sc1
M a[60:63],a[244:247],a[192:195],a[60:63]
v_fmac_f32 v213,-2.0,v211
v_cvt_pk_bf16_f32 v205,v232,v205
M a[60:63],a[232:235],a[216:219],a[60:63]
s_waitcnt vmcnt(13)
buffer_load_dwordx4 a[244:247],v250,s[20:23],s47 offen offset:2048 sc1
M a[64:67],a[236:239],v[228:231],a[64:67]
s_waitcnt vmcnt(13)
s_add_u32 s48,s73,24576
v_cvt_pk_bf16_f32 v215,v237,v215
v_cvt_pk_bf16_f32 v207,v233,v207
M a[64:67],a[248:251],v[224:227],a[64:67]
s_waitcnt vmcnt(12)
v_cvt_pk_bf16_f32 v211,v234,v209
v_cvt_pk_bf16_f32 v209,v238,v235
M a[64:67],a[252:255],v[220:223],a[64:67]
v_cvt_pk_bf16_f32 v213,v236,v213
v_fmac_f32 v239,s43,v241
M a[68:71],a[252:255],a[204:207],a[68:71]
buffer_load_dwordx4 a[232:235],v250,s[20:23],s48 offen offset:0 sc1
M a[68:71],a[248:251],v[220:223],a[68:71]
v_fmac_f32 v244,4.0,v240
v_fma_f32 v232,-4.0,v241,v243
M a[68:71],a[236:239],v[224:227],a[68:71]
ds_write2st64_b64 v247,v[204:205],v[214:215] offset0:205 offset1:222
M a[72:75],a[236:239],v[220:223],a[72:75]
s_add_u32 s28,s68,1179648
v_fmac_f32 v239,s45,v243
v_fmac_f32 v244,s41,v242
M a[72:75],a[248:251],a[204:207],a[72:75]
buffer_load_dwordx4 v[228:231],v250,s[20:23],s48 offen offset:1024 sc1
M a[72:75],a[252:255],a[200:203],a[72:75]
ds_write2st64_b64 v247,v[206:207],v[208:209] offset0:35 offset1:52
M a[76:79],a[252:255],a[228:231],a[76:79]
v_sub_f32 v243,v243,v241
v_fma_f32 v241,-4.0,v240,v242
M a[76:79],a[248:251],a[200:203],a[76:79]
buffer_load_dwordx4 v[224:227],v250,s[20:23],s48 offen offset:2048 sc1
M a[76:79],a[236:239],a[204:207],a[76:79]
s_add_u32 s46,s73,27648
ds_write2st64_b64 v247,v[210:211],v[212:213] offset0:69 offset1:86
M a[80:83],a[236:239],a[200:203],a[80:83]
v_sub_f32 v242,v242,v240
v_add_f32 v240,v232,v241
M a[80:83],a[248:251],a[228:231],a[80:83]
buffer_load_dwordx4 v[220:223],v250,s[20:23],s46 offen offset:0 sc1
M a[80:83],a[252:255],a[196:199],a[80:83]
v_sub_f32 v232,v232,v241
v_fma_f32 v241,2.0,v242,v243
M a[84:87],a[252:255],a[216:219],a[84:87]
v_fmac_f32 v243,-2.0,v242
v_cvt_pk_bf16_f32 v233,v239,v244
M a[84:87],a[248:251],a[196:199],a[84:87]
ds_read_b128 a[204:207],v248 offset:60928
v_cvt_pk_bf16_f32 v234,v240,v232
M a[84:87],a[236:239],a[228:231],a[84:87]
buffer_load_dwordx2 v[204:205],v245,s[12:15],s28 offen offset:0
M a[88:91],a[236:239],a[196:199],a[88:91]
ds_read_b128 a[200:203],v249 offset:60928
ds_read_b128 a[228:231],v248 offset:61440
M a[88:91],a[248:251],a[216:219],a[88:91]
ds_read_b128 a[196:199],v249 offset:61440
v_cvt_pk_bf16_f32 v235,v241,v243
M a[88:91],a[252:255],a[192:195],a[88:91]
v_add_u32 v232,104448,v252
M a[92:95],a[252:255],a[208:211],a[92:95]
buffer_load_dwordx2 v[214:215],v245,s[16:19],s28 offen offset:1536
M a[92:95],a[248:251],a[192:195],a[92:95]
ds_write_b16 v232,v233 offset:0
M a[92:95],a[236:239],a[216:219],a[92:95]
s_waitcnt vmcnt(17) lgkmcnt(4)
ds_write_b16_d16_hi v232,v233 offset:8704
M a[96:99],v[216:219],a[204:207],a[96:99]
s_waitcnt vmcnt(10) lgkmcnt(4)
ds_read_b128 a[208:211],v248 offset:61952
ds_write_b16 v252,v234 offset:17408
M a[96:99],a[220:223],a[200:203],a[96:99]
s_waitcnt vmcnt(9) lgkmcnt(5)
buffer_load_dwordx2 v[206:207],v245,s[8:11],s28 offen offset:0
M a[96:99],a[224:227],a[228:231],a[96:99]
s_waitcnt lgkmcnt(4)
ds_read_b128 a[252:255],v249 offset:61952
ds_write_b16_d16_hi v252,v234 offset:26112
M a[100:103],a[224:227],a[196:199],a[100:103]
ds_write_b16 v252,v235 offset:34816
M a[100:103],a[220:223],a[228:231],a[100:103]
ds_write_b16_d16_hi v252,v235 offset:43520
M a[100:103],v[216:219],a[200:203],a[100:103]
buffer_load_dwordx2 v[208:209],v245,s[8:11],s28 offen offset:384
M a[104:107],v[216:219],a[228:231],a[104:107]
ds_read_b128 a[192:195],v248 offset:62464
v_lshlrev_b32 v234,16,v196
M a[104:107],a[220:223],a[196:199],a[104:107]
s_waitcnt lgkmcnt(6)
ds_read_b128 a[248:251],v249 offset:62464
v_lshlrev_b32 v232,16,v192
M a[104:107],a[224:227],a[208:211],a[104:107]
s_waitcnt lgkmcnt(5)
v_lshlrev_b32 v233,16,v194
v_lshlrev_b32 v237,16,v202
M a[108:111],a[224:227],a[252:255],a[108:111]
buffer_load_dwordx2 v[210:211],v245,s[8:11],s28 offen offset:768
M a[108:111],a[220:223],a[208:211],a[108:111]
v_lshlrev_b32 v236,16,v200
v_lshlrev_b32 v235,16,v198
M a[108:111],v[216:219],a[196:199],a[108:111]
v_fmac_f32 v232,s43,v234
v_fmac_f32 v237,4.0,v233
M a[112:115],v[216:219],a[208:211],a[112:115]
ds_read_b128 a[216:219],v249 offset:62976
v_fma_f32 v238,-4.0,v234,v236
M a[112:115],a[220:223],a[252:255],a[112:115]
s_waitcnt lgkmcnt(2)
buffer_load_dwordx2 v[212:213],v245,s[8:11],s28 offen offset:1152
M a[112:115],a[224:227],a[192:195],a[112:115]
s_waitcnt lgkmcnt(1)
s_add_u32 s29,s69,0
ds_read_b128 a[236:239],v248 offset:62976
v_fmac_f32 v232,s45,v236
M a[116:119],a[224:227],a[248:251],a[116:119]
v_fmac_f32 v237,s41,v235
v_sub_f32 v236,v236,v234
M a[116:119],a[220:223],a[192:195],a[116:119]
v_fma_f32 v234,-4.0,v233,v235
v_sub_f32 v235,v235,v233
M a[116:119],v[216:219],a[252:255],a[116:119]
buffer_load_short_d16_hi v239,v246,s[12:15],s29 offen offset:0
M a[120:123],v[216:219],a[192:195],a[120:123]
v_add_f32 v233,v238,v234
v_sub_f32 v238,v238,v234
M a[120:123],a[220:223],a[248:251],a[120:123]
s_waitcnt lgkmcnt(1)
buffer_load_short_d16_hi v240,v246,s[8:11],s29 offen offset:0
M a[120:123],a[224:227],a[216:219],a[120:123]
s_waitcnt lgkmcnt(0)
v_fma_f32 v234,2.0,v235,v236
v_fmac_f32 v236,-2.0,v235
M a[124:127],a[224:227],a[236:239],a[124:127]
buffer_load_dwordx4 a[224:227],v250,s[20:23],s46 offen offset:1024 sc1
M a[124:127],a[220:223],a[216:219],a[124:127]
v_and_b32 v196,s42,v196
v_and_b32 v192,s42,v192
M a[124:127],v[216:219],a[248:251],a[124:127]
s_waitcnt vmcnt(15)
v_and_b32 v194,s42,v194
v_and_b32 v202,s42,v202
M a[128:131],a[212:215],a[204:207],a[128:131]
s_waitcnt vmcnt(14)
v_and_b32 v200,s42,v200
v_and_b32 v198,s42,v198
M a[128:131],a[240:243],a[200:203],a[128:131]
s_waitcnt vmcnt(13)
buffer_load_dwordx4 a[220:223],v250,s[20:23],s46 offen offset:2048 sc1
M a[128:131],a[244:247],a[228:231],a[128:131]
s_add_u32 s47,s73,30720
v_fmac_f32 v192,s43,v196
v_fmac_f32 v202,4.0,v194
M a[132:135],a[244:247],a[196:199],a[132:135]
v_fma_f32 v235,-4.0,v196,v200
v_fmac_f32 v192,s45,v200
M a[132:135],a[240:243],a[228:231],a[132:135]
v_fmac_f32 v202,s41,v198
v_sub_f32 v200,v200,v196
M a[132:135],a[212:215],a[200:203],a[132:135]
buffer_load_dwordx4 v[216:219],v250,s[20:23],s47 offen offset:0 sc1
M a[136:139],a[212:215],a[228:231],a[136:139]
v_fma_f32 v196,-4.0,v194,v198
v_sub_f32 v198,v198,v194
M a[136:139],a[240:243],a[196:199],a[136:139]
v_add_f32 v194,v235,v196
v_sub_f32 v235,v235,v196
M a[136:139],a[244:247],a[208:211],a[136:139]
v_fma_f32 v196,2.0,v198,v200
v_fmac_f32 v200,-2.0,v198
M a[140:143],a[244:247],a[252:255],a[140:143]
buffer_load_short_d16_hi v241,v246,s[8:11],s29 offen offset:384
M a[140:143],a[240:243],a[208:211],a[140:143]
v_cvt_pk_bf16_f32 v192,v232,v192
v_cvt_pk_bf16_f32 v202,v237,v202
M a[140:143],a[212:215],a[196:199],a[140:143]
buffer_load_short_d16_hi v242,v246,s[8:11],s29 offen offset:768
M a[144:147],a[212:215],a[208:211],a[144:147]
v_cvt_pk_bf16_f32 v194,v233,v194
v_cvt_pk_bf16_f32 v198,v234,v196
M a[144:147],a[240:243],a[252:255],a[144:147]
buffer_load_short_d16_hi v243,v246,s[8:11],s29 offen offset:1152
M a[144:147],a[244:247],a[192:195],a[144:147]
v_cvt_pk_bf16_f32 v196,v238,v235
v_cvt_pk_bf16_f32 v200,v236,v200
M a[148:151],a[244:247],a[248:251],a[148:151]
buffer_load_short_d16_hi v244,v246,s[16:19],s29 offen offset:1536
M a[148:151],a[240:243],a[192:195],a[148:151]
v_lshlrev_b32 v234,16,v197
v_lshlrev_b32 v232,16,v193
M a[148:151],a[212:215],a[252:255],a[148:151]
v_lshlrev_b32 v233,16,v195
v_lshlrev_b32 v237,16,v203
M a[152:155],a[212:215],a[192:195],a[152:155]
v_lshlrev_b32 v236,16,v201
v_lshlrev_b32 v235,16,v199
M a[152:155],a[240:243],a[248:251],a[152:155]
v_fmac_f32 v232,s43,v234
v_fmac_f32 v237,4.0,v233
M a[152:155],a[244:247],a[216:219],a[152:155]
v_fma_f32 v238,-4.0,v234,v236
v_fmac_f32 v232,s45,v236
M a[156:159],a[244:247],a[236:239],a[156:159]
buffer_load_dwordx4 a[244:247],v250,s[20:23],s47 offen offset:1024 sc1
M a[156:159],a[240:243],a[216:219],a[156:159]
v_fmac_f32 v237,s41,v235
v_sub_f32 v236,v236,v234
M a[156:159],a[212:215],a[248:251],a[156:159]
s_waitcnt vmcnt(19)
buffer_load_dwordx4 a[240:243],v250,s[20:23],s47 offen offset:2048 sc1
M a[160:163],a[232:235],a[204:207],a[160:163]
s_waitcnt vmcnt(19)
s_add_u32 s48,s73,33792
v_fma_f32 v234,-4.0,v233,v235
v_sub_f32 v235,v235,v233
M a[160:163],v[228:231],a[200:203],a[160:163]
s_waitcnt vmcnt(18)
v_add_f32 v233,v238,v234
v_sub_f32 v238,v238,v234
M a[160:163],v[224:227],a[228:231],a[160:163]
v_fma_f32 v234,2.0,v235,v236
v_fmac_f32 v236,-2.0,v235
M a[164:167],v[224:227],a[196:199],a[164:167]
buffer_load_dwordx4 a[212:215],v250,s[20:23],s48 offen offset:0 sc1
M a[164:167],v[228:231],a[228:231],a[164:167]
v_and_b32 v197,s42,v197
v_and_b32 v193,s42,v193
M a[164:167],a[232:235],a[200:203],a[164:167]
v_and_b32 v195,s42,v195
v_and_b32 v203,s42,v203
M a[168:171],a[232:235],a[228:231],a[168:171]
v_and_b32 v201,s42,v201
v_and_b32 v199,s42,v199
M a[168:171],v[228:231],a[196:199],a[168:171]
buffer_load_dwordx4 a[204:207],v250,s[20:23],s48 offen offset:1024 sc1
M a[168:171],v[224:227],a[208:211],a[168:171]
v_fmac_f32 v193,s43,v197
v_fmac_f32 v203,4.0,v195
M a[172:175],v[224:227],a[252:255],a[172:175]
v_fma_f32 v235,-4.0,v197,v201
v_fmac_f32 v193,s45,v201
M a[172:175],v[228:231],a[208:211],a[172:175]
v_fmac_f32 v203,s41,v199
v_sub_f32 v201,v201,v197
M a[172:175],a[232:235],a[196:199],a[172:175]
buffer_load_dwordx4 a[200:203],v250,s[20:23],s48 offen offset:2048 sc1
M a[176:179],a[232:235],a[208:211],a[176:179]
s_add_u32 s46,s73,36864
v_fma_f32 v197,-4.0,v195,v199
v_sub_f32 v199,v199,v195
M a[176:179],v[228:231],a[252:255],a[176:179]
v_add_u32 v248,0x4400,v248
v_add_u32 v249,0x4400,v249
M a[176:179],v[224:227],a[192:195],a[176:179]
v_add_f32 v195,v235,v197
v_sub_f32 v235,v235,v197
M a[180:183],v[224:227],a[248:251],a[180:183]
buffer_load_dwordx4 a[228:231],v250,s[20:23],s46 offen offset:0 sc1
M a[180:183],v[228:231],a[192:195],a[180:183]
ds_read_b128 a[196:199],v248 offset:52224
v_fma_f32 v197,2.0,v199,v201
M a[180:183],a[232:235],a[252:255],a[180:183]
ds_read_b128 a[208:211],v249 offset:52224
v_fmac_f32 v201,-2.0,v199
M a[184:187],a[232:235],a[192:195],a[184:187]
ds_read_b128 a[252:255],v248 offset:52736
v_cvt_pk_bf16_f32 v193,v232,v193
M a[184:187],v[228:231],a[248:251],a[184:187]
ds_read_b128 a[192:195],v249 offset:52736
v_cvt_pk_bf16_f32 v203,v237,v203
M a[184:187],v[224:227],a[216:219],a[184:187]
v_cvt_pk_bf16_f32 v195,v233,v195
v_cvt_pk_bf16_f32 v199,v234,v197
M a[188:191],v[224:227],a[236:239],a[188:191]
v_cvt_pk_bf16_f32 v197,v238,v235
v_cvt_pk_bf16_f32 v201,v236,v201
M a[188:191],v[228:231],a[216:219],a[188:191]
M a[188:191],a[232:235],a[248:251],a[188:191]
s_waitcnt vmcnt(21) lgkmcnt(3)
ds_write2st64_b64 v247,v[192:193],v[202:203] offset0:206 offset1:223
M v[0:3],v[220:223],a[196:199],v[0:3]
s_waitcnt vmcnt(12) lgkmcnt(3)
s_add_u32 s28,s69,0
buffer_load_dwordx2 v[192:193],v251,s[12:15],s28 offen offset:0
M v[0:3],a[224:227],a[208:211],v[0:3]
s_waitcnt vmcnt(12) lgkmcnt(2)
ds_read_b128 a[236:239],v248 offset:53248
ds_read_b128 v[224:227],v249 offset:53248
M v[0:3],a[220:223],a[252:255],v[0:3]
s_waitcnt lgkmcnt(3)
buffer_load_dwordx2 v[202:203],v251,s[16:19],s28 offen offset:1536
M v[4:7],a[220:223],a[192:195],v[4:7]
v_lshlrev_b32 v234,16,v208
v_lshlrev_b32 v232,16,v204
M v[4:7],a[224:227],a[252:255],v[4:7]
v_lshlrev_b32 v233,16,v206
v_lshlrev_b32 v237,16,v214
M v[4:7],v[220:223],a[208:211],v[4:7]
ds_write2st64_b64 v247,v[194:195],v[196:197] offset0:36 offset1:53
M v[8:11],v[220:223],a[252:255],v[8:11]
buffer_load_dwordx2 v[194:195],v251,s[8:11],s28 offen offset:0
M v[8:11],a[224:227],a[192:195],v[8:11]
s_waitcnt lgkmcnt(2)
ds_read_b128 a[216:219],v248 offset:53760
ds_read_b128 v[228:231],v249 offset:53760
M v[8:11],a[220:223],a[236:239],v[8:11]
s_waitcnt lgkmcnt(3)
ds_write2st64_b64 v247,v[198:199],v[200:201] offset0:70 offset1:87
M v[12:15],a[220:223],v[224:227],v[12:15]
buffer_load_dwordx2 v[196:197],v251,s[8:11],s28 offen offset:384
M v[12:15],a[224:227],a[236:239],v[12:15]
v_lshlrev_b32 v236,16,v212
v_lshlrev_b32 v235,16,v210
M v[12:15],v[220:223],a[192:195],v[12:15]
v_fmac_f32 v232,s43,v234
v_fmac_f32 v237,4.0,v233
M v[16:19],v[220:223],a[236:239],v[16:19]
ds_read_b128 a[232:235],v249 offset:54272
v_fma_f32 v238,-4.0,v234,v236
M v[16:19],a[224:227],v[224:227],v[16:19]
s_waitcnt lgkmcnt(3)
buffer_load_dwordx2 v[198:199],v251,s[8:11],s28 offen offset:768
M v[16:19],a[220:223],a[216:219],v[16:19]
s_waitcnt lgkmcnt(2)
ds_read_b128 a[248:251],v248 offset:54272
v_fmac_f32 v232,s45,v236
M v[20:23],a[220:223],v[228:231],v[20:23]
v_fmac_f32 v237,s41,v235
v_sub_f32 v236,v236,v234
M v[20:23],a[224:227],a[216:219],v[20:23]
v_fma_f32 v234,-4.0,v233,v235
v_sub_f32 v235,v235,v233
M v[20:23],v[220:223],v[224:227],v[20:23]
buffer_load_dwordx2 v[200:201],v251,s[8:11],s28 offen offset:1152
M v[24:27],v[220:223],a[216:219],v[24:27]
v_add_f32 v233,v238,v234
v_sub_f32 v238,v238,v234
M v[24:27],a[224:227],v[228:231],v[24:27]
s_waitcnt lgkmcnt(1)
v_fma_f32 v234,2.0,v235,v236
v_fmac_f32 v236,-2.0,v235
M v[24:27],a[220:223],a[232:235],v[24:27]
s_waitcnt lgkmcnt(0)
v_and_b32 v208,s42,v208
v_and_b32 v204,s42,v204
M v[28:31],a[220:223],a[248:251],v[28:31]
global_load_dword a220,v250,s[64:65]
M v[28:31],a[224:227],a[232:235],v[28:31]
v_and_b32 v206,s42,v206
v_and_b32 v214,s42,v214
M v[28:31],v[220:223],v[228:231],v[28:31]
s_waitcnt vmcnt(17)
buffer_load_dwordx4 a[220:223],v250,s[20:23],s46 offen offset:1024 sc1
M v[32:35],v[216:219],a[196:199],v[32:35]
s_waitcnt vmcnt(13)
v_and_b32 v212,s42,v212
v_and_b32 v210,s42,v210
M v[32:35],a[244:247],a[208:211],v[32:35]
s_waitcnt vmcnt(12)
v_fmac_f32 v204,s43,v208
v_fmac_f32 v214,4.0,v206
M v[32:35],a[240:243],a[252:255],v[32:35]
v_fma_f32 v235,-4.0,v208,v212
v_fmac_f32 v204,s45,v212
M v[36:39],a[240:243],a[192:195],v[36:39]
buffer_load_dwordx4 a[224:227],v250,s[20:23],s46 offen offset:2048 sc1
M v[36:39],a[244:247],a[252:255],v[36:39]
s_add_u32 s47,s73,39936
v_fmac_f32 v214,s41,v210
v_sub_f32 v212,v212,v208
M v[36:39],v[216:219],a[208:211],v[36:39]
v_fma_f32 v208,-4.0,v206,v210
v_sub_f32 v210,v210,v206
M v[40:43],v[216:219],a[252:255],v[40:43]
v_add_f32 v206,v235,v208
v_sub_f32 v235,v235,v208
M v[40:43],a[244:247],a[192:195],v[40:43]
buffer_load_dwordx4 v[220:223],v250,s[20:23],s47 offen offset:0 sc1
M v[40:43],a[240:243],a[236:239],v[40:43]
v_fma_f32 v208,2.0,v210,v212
v_fmac_f32 v212,-2.0,v210
M v[44:47],a[240:243],v[224:227],v[44:47]
v_cvt_pk_bf16_f32 v204,v232,v204
v_cvt_pk_bf16_f32 v214,v237,v214
M v[44:47],a[244:247],a[236:239],v[44:47]
v_cvt_pk_bf16_f32 v206,v233,v206
v_cvt_pk_bf16_f32 v210,v234,v208
M v[44:47],v[216:219],a[192:195],v[44:47]
v_cvt_pk_bf16_f32 v208,v238,v235
v_cvt_pk_bf16_f32 v212,v236,v212
M v[48:51],v[216:219],a[236:239],v[48:51]
v_lshlrev_b32 v234,16,v209
v_lshlrev_b32 v232,16,v205
M v[48:51],a[244:247],v[224:227],v[48:51]
v_lshlrev_b32 v233,16,v207
v_lshlrev_b32 v237,16,v215
M v[48:51],a[240:243],a[216:219],v[48:51]
v_lshlrev_b32 v236,16,v213
v_lshlrev_b32 v235,16,v211
M v[52:55],a[240:243],v[228:231],v[52:55]
v_fmac_f32 v232,s43,v234
v_fmac_f32 v237,4.0,v233
M v[52:55],a[244:247],a[216:219],v[52:55]
v_fma_f32 v238,-4.0,v234,v236
v_fmac_f32 v232,s45,v236
M v[52:55],v[216:219],v[224:227],v[52:55]
v_fmac_f32 v237,s41,v235
v_sub_f32 v236,v236,v234
M v[56:59],v[216:219],a[216:219],v[56:59]
v_fma_f32 v234,-4.0,v233,v235
v_sub_f32 v235,v235,v233
M v[56:59],a[244:247],v[228:231],v[56:59]
v_add_f32 v233,v238,v234
v_sub_f32 v238,v238,v234
M v[56:59],a[240:243],a[232:235],v[56:59]
v_fma_f32 v234,2.0,v235,v236
v_fmac_f32 v236,-2.0,v235
M v[60:63],a[240:243],a[248:251],v[60:63]
buffer_load_dwordx4 a[240:243],v250,s[20:23],s47 offen offset:1024 sc1
M v[60:63],a[244:247],a[232:235],v[60:63]
v_and_b32 v209,s42,v209
v_and_b32 v205,s42,v205
M v[60:63],v[216:219],v[228:231],v[60:63]
s_waitcnt vmcnt(14)
buffer_load_dwordx4 a[244:247],v250,s[20:23],s47 offen offset:2048 sc1
M v[64:67],a[212:215],a[196:199],v[64:67]
s_waitcnt vmcnt(14)
s_add_u32 s48,s73,43008
v_and_b32 v207,s42,v207
v_and_b32 v215,s42,v215
M v[64:67],a[204:207],a[208:211],v[64:67]
s_waitcnt vmcnt(13)
v_and_b32 v213,s42,v213
v_and_b32 v211,s42,v211
M v[64:67],a[200:203],a[252:255],v[64:67]
v_fmac_f32 v205,s43,v209
v_fmac_f32 v215,4.0,v207
M v[68:71],a[200:203],a[192:195],v[68:71]
buffer_load_dwordx4 v[216:219],v250,s[20:23],s48 offen offset:0 sc1
M v[68:71],a[204:207],a[252:255],v[68:71]
v_fma_f32 v235,-4.0,v209,v213
v_fmac_f32 v205,s45,v213
M v[68:71],a[212:215],a[208:211],v[68:71]
v_fmac_f32 v215,s41,v211
v_sub_f32 v213,v213,v209
M v[72:75],a[212:215],a[252:255],v[72:75]
v_fma_f32 v209,-4.0,v207,v211
v_sub_f32 v211,v211,v207
M v[72:75],a[204:207],a[192:195],v[72:75]
buffer_load_dwordx4 a[196:199],v250,s[20:23],s48 offen offset:1024 sc1
M v[72:75],a[200:203],a[236:239],v[72:75]
v_add_f32 v207,v235,v209
v_sub_f32 v235,v235,v209
M v[76:79],a[200:203],v[224:227],v[76:79]
v_fma_f32 v209,2.0,v211,v213
v_fmac_f32 v213,-2.0,v211
M v[76:79],a[204:207],a[236:239],v[76:79]
v_cvt_pk_bf16_f32 v205,v232,v205
v_cvt_pk_bf16_f32 v215,v237,v215
M v[76:79],a[212:215],a[192:195],v[76:79]
buffer_load_dwordx4 a[208:211],v250,s[20:23],s48 offen offset:2048 sc1
M v[80:83],a[212:215],a[236:239],v[80:83]
s_add_u32 s46,s74,9216
v_cvt_pk_bf16_f32 v207,v233,v207
v_cvt_pk_bf16_f32 v211,v234,v209
M v[80:83],a[204:207],v[224:227],v[80:83]
v_cvt_pk_bf16_f32 v209,v238,v235
v_cvt_pk_bf16_f32 v213,v236,v213
M v[80:83],a[200:203],a[216:219],v[80:83]
ds_write2st64_b64 v247,v[204:205],v[214:215] offset0:207 offset1:224
M v[84:87],a[200:203],v[228:231],v[84:87]
s_add_u32 s28,s69,393216
buffer_load_dwordx4 a[252:255],v250,s[20:23],s46 offen offset:0 sc1
M v[84:87],a[204:207],a[216:219],v[84:87]
s_waitcnt vmcnt(12)
ds_read_b128 a[192:195],v248 offset:60928
v_lshlrev_b32 v234,16,v196
M v[84:87],a[212:215],v[224:227],v[84:87]
ds_write2st64_b64 v247,v[206:207],v[208:209] offset0:37 offset1:54
M v[88:91],a[212:215],a[216:219],v[88:91]
buffer_load_dwordx2 v[204:205],v245,s[12:15],s28 offen offset:0
M v[88:91],a[204:207],v[228:231],v[88:91]
ds_read_b128 a[236:239],v249 offset:60928
ds_read_b128 v[224:227],v248 offset:61440
M v[88:91],a[200:203],a[232:235],v[88:91]
ds_write2st64_b64 v247,v[210:211],v[212:213] offset0:71 offset1:88
M v[92:95],a[200:203],a[248:251],v[92:95]
buffer_load_dwordx2 v[214:215],v245,s[16:19],s28 offen offset:1536
M v[92:95],a[204:207],a[232:235],v[92:95]
ds_read_b128 a[216:219],v249 offset:61440
v_lshlrev_b32 v232,16,v192
M v[92:95],a[212:215],v[228:231],v[92:95]
s_waitcnt lgkmcnt(5)
v_lshlrev_b32 v233,16,v194
v_lshlrev_b32 v237,16,v202
M v[96:99],a[228:231],a[192:195],v[96:99]
s_waitcnt vmcnt(10) lgkmcnt(3)
ds_read_b128 a[200:203],v248 offset:61952
v_lshlrev_b32 v236,16,v200
M v[96:99],a[220:223],a[236:239],v[96:99]
s_waitcnt vmcnt(9) lgkmcnt(3)
buffer_load_dwordx2 v[206:207],v245,s[8:11],s28 offen offset:0
M v[96:99],a[224:227],v[224:227],v[96:99]
s_waitcnt lgkmcnt(1)
ds_read_b128 a[248:251],v249 offset:61952
v_lshlrev_b32 v235,16,v198
M v[100:103],a[224:227],a[216:219],v[100:103]
v_fmac_f32 v232,s43,v234
v_fmac_f32 v237,4.0,v233
M v[100:103],a[220:223],v[224:227],v[100:103]
v_fma_f32 v238,-4.0,v234,v236
v_fmac_f32 v232,s45,v236
M v[100:103],a[228:231],a[236:239],v[100:103]
buffer_load_dwordx2 v[208:209],v245,s[8:11],s28 offen offset:384
M v[104:107],a[228:231],v[224:227],v[104:107]
ds_read_b128 a[204:207],v248 offset:62464
v_fmac_f32 v237,s41,v235
M v[104:107],a[220:223],a[216:219],v[104:107]
s_waitcnt lgkmcnt(2)
ds_read_b128 a[232:235],v249 offset:62464
v_sub_f32 v236,v236,v234
M v[104:107],a[224:227],a[200:203],v[104:107]
s_waitcnt lgkmcnt(2)
v_fma_f32 v234,-4.0,v233,v235
v_sub_f32 v235,v235,v233
M v[108:111],a[224:227],a[248:251],v[108:111]
buffer_load_dwordx2 v[210:211],v245,s[8:11],s28 offen offset:768
M v[108:111],a[220:223],a[200:203],v[108:111]
v_add_f32 v233,v238,v234
v_sub_f32 v238,v238,v234
M v[108:111],a[228:231],a[216:219],v[108:111]
v_fma_f32 v234,2.0,v235,v236
v_fmac_f32 v236,-2.0,v235
M v[112:115],a[228:231],a[200:203],v[112:115]
ds_read_b128 a[212:215],v249 offset:62976
v_and_b32 v196,s42,v196
M v[112:115],a[220:223],a[248:251],v[112:115]
s_waitcnt lgkmcnt(2)
buffer_load_dwordx2 v[212:213],v245,s[8:11],s28 offen offset:1152
M v[112:115],a[224:227],a[204:207],v[112:115]
s_waitcnt lgkmcnt(1)
ds_read_b128 v[228:231],v248 offset:62976
v_and_b32 v192,s42,v192
M v[116:119],a[224:227],a[232:235],v[116:119]
v_and_b32 v194,s42,v194
v_and_b32 v202,s42,v202
M v[116:119],a[220:223],a[204:207],v[116:119]
v_and_b32 v200,s42,v200
v_and_b32 v198,s42,v198
M v[116:119],a[228:231],a[248:251],v[116:119]
v_fmac_f32 v192,s43,v196
v_fmac_f32 v202,4.0,v194
M v[120:123],a[228:231],a[204:207],v[120:123]
v_fma_f32 v235,-4.0,v196,v200
v_fmac_f32 v192,s45,v200
M v[120:123],a[220:223],a[232:235],v[120:123]
s_waitcnt lgkmcnt(1)
v_fmac_f32 v202,s41,v198
v_sub_f32 v200,v200,v196
M v[120:123],a[224:227],a[212:215],v[120:123]
s_waitcnt lgkmcnt(0)
v_fma_f32 v196,-4.0,v194,v198
v_sub_f32 v198,v198,v194
M v[124:127],a[224:227],v[228:231],v[124:127]
buffer_load_dwordx4 a[224:227],v250,s[20:23],s46 offen offset:1024 sc1
M v[124:127],a[220:223],a[212:215],v[124:127]
v_add_f32 v194,v235,v196
v_sub_f32 v235,v235,v196
M v[124:127],a[228:231],a[232:235],v[124:127]
s_waitcnt vmcnt(13)
buffer_load_dwordx4 a[220:223],v250,s[20:23],s46 offen offset:2048 sc1
M v[128:131],v[220:223],a[192:195],v[128:131]
s_waitcnt vmcnt(13)
s_add_u32 s47,s74,12288
v_fma_f32 v196,2.0,v198,v200
v_fmac_f32 v200,-2.0,v198
M v[128:131],a[240:243],a[236:239],v[128:131]
s_waitcnt vmcnt(12)
v_cvt_pk_bf16_f32 v192,v232,v192
v_cvt_pk_bf16_f32 v202,v237,v202
M v[128:131],a[244:247],v[224:227],v[128:131]
v_cvt_pk_bf16_f32 v194,v233,v194
v_cvt_pk_bf16_f32 v198,v234,v196
M v[132:135],a[244:247],a[216:219],v[132:135]
buffer_load_dwordx4 a[228:231],v250,s[20:23],s47 offen offset:0 sc1
M v[132:135],a[240:243],v[224:227],v[132:135]
v_cvt_pk_bf16_f32 v196,v238,v235
v_cvt_pk_bf16_f32 v200,v236,v200
M v[132:135],v[220:223],a[236:239],v[132:135]
v_lshlrev_b32 v234,16,v197
v_lshlrev_b32 v232,16,v193
M v[136:139],v[220:223],v[224:227],v[136:139]
v_lshlrev_b32 v233,16,v195
v_lshlrev_b32 v237,16,v203
M v[136:139],a[240:243],a[216:219],v[136:139]
v_lshlrev_b32 v236,16,v201
v_lshlrev_b32 v235,16,v199
M v[136:139],a[244:247],a[200:203],v[136:139]
v_fmac_f32 v232,s43,v234
v_fmac_f32 v237,4.0,v233
M v[140:143],a[244:247],a[248:251],v[140:143]
v_fma_f32 v238,-4.0,v234,v236
v_fmac_f32 v232,s45,v236
M v[140:143],a[240:243],a[200:203],v[140:143]
v_fmac_f32 v237,s41,v235
v_sub_f32 v236,v236,v234
M v[140:143],v[220:223],a[216:219],v[140:143]
v_fma_f32 v234,-4.0,v233,v235
v_sub_f32 v235,v235,v233
M v[144:147],v[220:223],a[200:203],v[144:147]
v_add_f32 v233,v238,v234
v_sub_f32 v238,v238,v234
M v[144:147],a[240:243],a[248:251],v[144:147]
v_fma_f32 v234,2.0,v235,v236
v_fmac_f32 v236,-2.0,v235
M v[144:147],a[244:247],a[204:207],v[144:147]
v_and_b32 v197,s42,v197
v_and_b32 v193,s42,v193
M v[148:151],a[244:247],a[232:235],v[148:151]
v_and_b32 v195,s42,v195
v_and_b32 v203,s42,v203
M v[148:151],a[240:243],a[204:207],v[148:151]
v_and_b32 v201,s42,v201
v_and_b32 v199,s42,v199
M v[148:151],v[220:223],a[248:251],v[148:151]
v_fmac_f32 v193,s43,v197
v_fmac_f32 v203,4.0,v195
M v[152:155],v[220:223],a[204:207],v[152:155]
v_fma_f32 v235,-4.0,v197,v201
v_fmac_f32 v193,s45,v201
M v[152:155],a[240:243],a[232:235],v[152:155]
v_fmac_f32 v203,s41,v199
v_sub_f32 v201,v201,v197
M v[152:155],a[244:247],a[212:215],v[152:155]
v_fma_f32 v197,-4.0,v195,v199
v_sub_f32 v199,v199,v195
M v[156:159],a[244:247],v[228:231],v[156:159]
buffer_load_dwordx4 a[244:247],v250,s[20:23],s47 offen offset:1024 sc1
M v[156:159],a[240:243],a[212:215],v[156:159]
v_add_f32 v195,v235,v197
v_sub_f32 v235,v235,v197
M v[156:159],v[220:223],a[232:235],v[156:159]
s_waitcnt vmcnt(13)
buffer_load_dwordx4 a[240:243],v250,s[20:23],s47 offen offset:2048 sc1
M v[160:163],v[216:219],a[192:195],v[160:163]
s_waitcnt vmcnt(13)
s_add_u32 s48,s74,15360
v_fma_f32 v197,2.0,v199,v201
v_fmac_f32 v201,-2.0,v199
M v[160:163],a[196:199],a[236:239],v[160:163]
s_waitcnt vmcnt(12)
v_cvt_pk_bf16_f32 v193,v232,v193
v_cvt_pk_bf16_f32 v203,v237,v203
M v[160:163],a[208:211],v[224:227],v[160:163]
v_cvt_pk_bf16_f32 v195,v233,v195
v_cvt_pk_bf16_f32 v199,v234,v197
M v[164:167],a[208:211],a[216:219],v[164:167]
buffer_load_dwordx4 v[220:223],v250,s[20:23],s48 offen offset:0 sc1
M v[164:167],a[196:199],v[224:227],v[164:167]
v_cvt_pk_bf16_f32 v197,v238,v235
v_cvt_pk_bf16_f32 v201,v236,v201
M v[164:167],v[216:219],a[236:239],v[164:167]
s_waitcnt vmcnt(8)
v_lshlrev_b32 v234,16,v208
v_lshlrev_b32 v232,16,v204
M v[168:171],v[216:219],v[224:227],v[168:171]
v_lshlrev_b32 v233,16,v206
v_lshlrev_b32 v237,16,v214
M v[168:171],a[196:199],a[216:219],v[168:171]
buffer_load_dwordx4 a[192:195],v250,s[20:23],s48 offen offset:1024 sc1
M v[168:171],a[208:211],a[200:203],v[168:171]
s_waitcnt vmcnt(7)
v_lshlrev_b32 v236,16,v212
v_lshlrev_b32 v235,16,v210
M v[172:175],a[208:211],a[248:251],v[172:175]
v_fmac_f32 v232,s43,v234
v_fmac_f32 v237,4.0,v233
M v[172:175],a[196:199],a[200:203],v[172:175]
v_fma_f32 v238,-4.0,v234,v236
v_fmac_f32 v232,s45,v236
M v[172:175],v[216:219],a[216:219],v[172:175]
buffer_load_dwordx4 a[236:239],v250,s[20:23],s48 offen offset:2048 sc1
M v[176:179],v[216:219],a[200:203],v[176:179]
s_add_u32 s46,s74,18432
v_fmac_f32 v237,s41,v235
v_sub_f32 v236,v236,v234
M v[176:179],a[196:199],a[248:251],v[176:179]
v_fma_f32 v234,-4.0,v233,v235
v_sub_f32 v235,v235,v233
M v[176:179],a[208:211],a[204:207],v[176:179]
s_barrier
v_add_f32 v233,v238,v234
M v[180:183],a[208:211],a[232:235],v[180:183]
buffer_load_dwordx4 v[224:227],v250,s[20:23],s46 offen offset:0 sc1
M v[180:183],a[196:199],a[204:207],v[180:183]
ds_read_b128 a[216:219],v248 offset:0
v_sub_f32 v238,v238,v234
M v[180:183],v[216:219],a[248:251],v[180:183]
ds_write2st64_b64 v247,v[192:193],v[202:203] offset0:238 offset1:255
M v[184:187],v[216:219],a[204:207],v[184:187]
s_add_u32 s28,s69,786432
ds_read_b128 a[200:203],v249 offset:0
ds_read_b128 a[248:251],v248 offset:512
M v[184:187],a[196:199],a[232:235],v[184:187]
buffer_load_dwordx2 v[192:193],v245,s[12:15],s28 offen offset:0
M v[184:187],a[208:211],a[212:215],v[184:187]
ds_write2st64_b64 v247,v[194:195],v[196:197] offset0:102 offset1:119
M v[188:191],a[208:211],v[228:231],v[188:191]
ds_read_b128 a[204:207],v249 offset:512
v_fma_f32 v234,2.0,v235,v236
M v[188:191],a[196:199],a[212:215],v[188:191]
buffer_load_dwordx2 v[202:203],v245,s[16:19],s28 offen offset:1536
M v[188:191],v[216:219],a[232:235],v[188:191]
s_waitcnt lgkmcnt(5)
ds_write2st64_b64 v247,v[198:199],v[200:201] offset0:136 offset1:153
M a[0:3],a[252:255],a[216:219],a[0:3]
s_waitcnt vmcnt(10) lgkmcnt(4)
ds_read_b128 a[208:211],v248 offset:1024
v_fmac_f32 v236,-2.0,v235
M a[0:3],a[224:227],a[200:203],a[0:3]
s_waitcnt vmcnt(9) lgkmcnt(4)
buffer_load_dwordx2 v[194:195],v245,s[8:11],s28 offen offset:0
M a[0:3],a[220:223],a[248:251],a[0:3]
s_waitcnt lgkmcnt(2)
ds_read_b128 v[228:231],v249 offset:1024
v_and_b32 v208,s42,v208
M a[4:7],a[220:223],a[204:207],a[4:7]
v_and_b32 v204,s42,v204
v_and_b32 v206,s42,v206
M a[4:7],a[224:227],a[248:251],a[4:7]
v_and_b32 v214,s42,v214
v_and_b32 v212,s42,v212
M a[4:7],a[252:255],a[200:203],a[4:7]
buffer_load_dwordx2 v[196:197],v245,s[8:11],s28 offen offset:384
M a[8:11],a[252:255],a[248:251],a[8:11]
ds_read_b128 a[196:199],v248 offset:1536
v_and_b32 v210,s42,v210
M a[8:11],a[224:227],a[204:207],a[8:11]
s_waitcnt lgkmcnt(2)
ds_read_b128 a[212:215],v249 offset:1536
v_fmac_f32 v204,s43,v208
M a[8:11],a[220:223],a[208:211],a[8:11]
s_waitcnt lgkmcnt(2)
v_fmac_f32 v214,4.0,v206
v_fma_f32 v235,-4.0,v208,v212
M a[12:15],a[220:223],v[228:231],a[12:15]
buffer_load_dwordx2 v[198:199],v245,s[8:11],s28 offen offset:768
M a[12:15],a[224:227],a[208:211],a[12:15]
v_fmac_f32 v204,s45,v212
v_fmac_f32 v214,s41,v210
M a[12:15],a[252:255],a[204:207],a[12:15]
v_sub_f32 v212,v212,v208
v_fma_f32 v208,-4.0,v206,v210
M a[16:19],a[252:255],a[208:211],a[16:19]
ds_read_b128 a[232:235],v249 offset:2048
v_sub_f32 v210,v210,v206
M a[16:19],a[224:227],v[228:231],a[16:19]
s_waitcnt lgkmcnt(2)
buffer_load_dwordx2 v[200:201],v245,s[8:11],s28 offen offset:1152
M a[16:19],a[220:223],a[196:199],a[16:19]
s_waitcnt lgkmcnt(1)
ds_read_b128 v[216:219],v248 offset:2048
v_add_f32 v206,v235,v208
M a[20:23],a[220:223],a[212:215],a[20:23]
v_sub_f32 v235,v235,v208
v_fma_f32 v208,2.0,v210,v212
M a[20:23],a[224:227],a[196:199],a[20:23]
v_fmac_f32 v212,-2.0,v210
v_cvt_pk_bf16_f32 v204,v232,v204
M a[20:23],a[252:255],v[228:231],a[20:23]
v_cvt_pk_bf16_f32 v214,v237,v214
v_cvt_pk_bf16_f32 v206,v233,v206
M a[24:27],a[252:255],a[196:199],a[24:27]
v_cvt_pk_bf16_f32 v210,v234,v208
v_cvt_pk_bf16_f32 v208,v238,v235
M a[24:27],a[224:227],a[212:215],a[24:27]
s_waitcnt lgkmcnt(1)
v_cvt_pk_bf16_f32 v212,v236,v212
v_lshlrev_b32 v234,16,v209
M a[24:27],a[220:223],a[232:235],a[24:27]
s_waitcnt lgkmcnt(0)
v_lshlrev_b32 v232,16,v205
v_lshlrev_b32 v233,16,v207
M a[28:31],a[220:223],v[216:219],a[28:31]
buffer_load_dwordx4 a[220:223],v250,s[20:23],s46 offen offset:1024 sc1
M a[28:31],a[224:227],a[232:235],a[28:31]
v_lshlrev_b32 v237,16,v215
v_lshlrev_b32 v236,16,v213
M a[28:31],a[252:255],a[212:215],a[28:31]
s_waitcnt vmcnt(13)
buffer_load_dwordx4 a[224:227],v250,s[20:23],s46 offen offset:2048 sc1
M a[32:35],a[228:231],a[216:219],a[32:35]
s_waitcnt vmcnt(13)
s_add_u32 s47,s74,21504
v_lshlrev_b32 v235,16,v211
v_fmac_f32 v232,s43,v234
M a[32:35],a[244:247],a[200:203],a[32:35]
s_waitcnt vmcnt(12)
v_fmac_f32 v237,4.0,v233
v_fma_f32 v238,-4.0,v234,v236
M a[32:35],a[240:243],a[248:251],a[32:35]
v_fmac_f32 v232,s45,v236
v_fmac_f32 v237,s41,v235
M a[36:39],a[240:243],a[204:207],a[36:39]
buffer_load_dwordx4 a[252:255],v250,s[20:23],s47 offen offset:0 sc1
M a[36:39],a[244:247],a[248:251],a[36:39]
v_sub_f32 v236,v236,v234
v_fma_f32 v234,-4.0,v233,v235
M a[36:39],a[228:231],a[200:203],a[36:39]
v_sub_f32 v235,v235,v233
v_add_f32 v233,v238,v234
M a[40:43],a[228:231],a[248:251],a[40:43]
v_sub_f32 v238,v238,v234
v_fma_f32 v234,2.0,v235,v236
M a[40:43],a[244:247],a[204:207],a[40:43]
v_fmac_f32 v236,-2.0,v235
v_and_b32 v209,s42,v209
M a[40:43],a[240:243],a[208:211],a[40:43]
v_and_b32 v205,s42,v205
v_and_b32 v207,s42,v207
M a[44:47],a[240:243],v[228:231],a[44:47]
v_and_b32 v215,s42,v215
v_and_b32 v213,s42,v213
M a[44:47],a[244:247],a[208:211],a[44:47]
v_and_b32 v211,s42,v211
v_fmac_f32 v205,s43,v209
M a[44:47],a[228:231],a[204:207],a[44:47]
v_fmac_f32 v215,4.0,v207
v_fma_f32 v235,-4.0,v209,v213
M a[48:51],a[228:231],a[208:211],a[48:51]
v_fmac_f32 v205,s45,v213
v_fmac_f32 v215,s41,v211
M a[48:51],a[244:247],v[228:231],a[48:51]
v_sub_f32 v213,v213,v209
v_fma_f32 v209,-4.0,v207,v211
M a[48:51],a[240:243],a[196:199],a[48:51]
v_sub_f32 v211,v211,v207
v_add_f32 v207,v235,v209
M a[52:55],a[240:243],a[212:215],a[52:55]
v_sub_f32 v235,v235,v209
v_fma_f32 v209,2.0,v211,v213
M a[52:55],a[244:247],a[196:199],a[52:55]
v_fmac_f32 v213,-2.0,v211
v_cvt_pk_bf16_f32 v205,v232,v205
M a[52:55],a[228:231],v[228:231],a[52:55]
v_cvt_pk_bf16_f32 v215,v237,v215
v_cvt_pk_bf16_f32 v207,v233,v207
M a[56:59],a[228:231],a[196:199],a[56:59]
v_cvt_pk_bf16_f32 v211,v234,v209
v_cvt_pk_bf16_f32 v209,v238,v235
M a[56:59],a[244:247],a[212:215],a[56:59]
v_cvt_pk_bf16_f32 v213,v236,v213
v_add_u32 v238,121856,v247
M a[56:59],a[240:243],a[232:235],a[56:59]
ds_write2st64_b64 v238,v[204:205],v[214:215] offset0:1 offset1:18
M a[60:63],a[240:243],v[216:219],a[60:63]
s_add_u32 s28,s69,1179648
buffer_load_dwordx4 a[240:243],v250,s[20:23],s47 offen offset:1024 sc1
M a[60:63],a[244:247],a[232:235],a[60:63]
v_fmac_f32 v239,s43,v241
v_fmac_f32 v244,4.0,v240
M a[60:63],a[228:231],a[212:215],a[60:63]
s_waitcnt vmcnt(13)
buffer_load_dwordx4 a[244:247],v250,s[20:23],s47 offen offset:2048 sc1
M a[64:67],v[220:223],a[216:219],a[64:67]
s_waitcnt vmcnt(13)
s_add_u32 s48,s74,24576
v_fma_f32 v232,-4.0,v241,v243
v_fmac_f32 v239,s45,v243
M a[64:67],a[192:195],a[200:203],a[64:67]
s_waitcnt vmcnt(12)
v_fmac_f32 v244,s41,v242
v_sub_f32 v243,v243,v241
M a[64:67],a[236:239],a[248:251],a[64:67]
ds_write2st64_b64 v247,v[206:207],v[208:209] offset0:103 offset1:120
M a[68:71],a[236:239],a[204:207],a[68:71]
buffer_load_dwordx4 a[228:231],v250,s[20:23],s48 offen offset:0 sc1
M a[68:71],a[192:195],a[248:251],a[68:71]
v_fma_f32 v241,-4.0,v240,v242
v_sub_f32 v242,v242,v240
M a[68:71],v[220:223],a[200:203],a[68:71]
ds_write2st64_b64 v247,v[210:211],v[212:213] offset0:137 offset1:154
M a[72:75],v[220:223],a[248:251],a[72:75]
buffer_load_dwordx4 a[216:219],v250,s[20:23],s48 offen offset:1024 sc1
M a[72:75],a[192:195],a[204:207],a[72:75]
v_add_f32 v240,v232,v241
v_sub_f32 v232,v232,v241
M a[72:75],a[236:239],a[208:211],a[72:75]
v_fma_f32 v241,2.0,v242,v243
v_fmac_f32 v243,-2.0,v242
M a[76:79],a[236:239],v[228:231],a[76:79]
v_cvt_pk_bf16_f32 v233,v239,v244
v_cvt_pk_bf16_f32 v234,v240,v232
M a[76:79],a[192:195],a[208:211],a[76:79]
buffer_load_dwordx4 a[200:203],v250,s[20:23],s48 offen offset:2048 sc1
M a[76:79],v[220:223],a[204:207],a[76:79]
s_add_u32 s46,s74,27648
v_cvt_pk_bf16_f32 v235,v241,v243
v_add_u32 v232,121856,v252
M a[80:83],v[220:223],a[208:211],a[80:83]
ds_write_b16 v232,v233 offset:0
M a[80:83],a[192:195],v[228:231],a[80:83]
ds_write_b16_d16_hi v232,v233 offset:8704
M a[80:83],a[236:239],a[196:199],a[80:83]
buffer_load_dwordx4 a[248:251],v250,s[20:23],s46 offen offset:0 sc1
M a[84:87],a[236:239],a[212:215],a[84:87]
ds_write_b16 v252,v234 offset:52224
M a[84:87],a[192:195],a[196:199],a[84:87]
ds_read_b128 a[204:207],v248 offset:8704
ds_write_b16_d16_hi v252,v234 offset:60928
M a[84:87],v[220:223],v[228:231],a[84:87]
ds_read_b128 a[208:211],v249 offset:8704
v_add_u32 v232,69632,v252
M a[88:91],v[220:223],a[196:199],a[88:91]
buffer_load_dwordx2 v[204:205],v245,s[12:15],s28 offen offset:0
M a[88:91],a[192:195],a[212:215],a[88:91]
ds_read_b128 v[228:231],v248 offset:9216
ds_read_b128 a[196:199],v249 offset:9216
M a[88:91],a[236:239],a[232:235],a[88:91]
ds_write_b16 v232,v235 offset:0
M a[92:95],a[236:239],v[216:219],a[92:95]
ds_write_b16_d16_hi v232,v235 offset:8704
M a[92:95],a[192:195],a[232:235],a[92:95]
buffer_load_dwordx2 v[214:215],v245,s[16:19],s28 offen offset:1536
M a[92:95],v[220:223],a[212:215],a[92:95]
s_waitcnt vmcnt(13) lgkmcnt(6)
v_lshlrev_b32 v234,16,v196
v_lshlrev_b32 v232,16,v192
M a[96:99],v[224:227],a[204:207],a[96:99]
s_waitcnt vmcnt(10) lgkmcnt(4)
ds_read_b128 a[236:239],v248 offset:9728
v_lshlrev_b32 v233,16,v194
M a[96:99],a[220:223],a[208:211],a[96:99]
s_waitcnt vmcnt(9) lgkmcnt(4)
ds_read_b128 v[216:219],v249 offset:9728
v_lshlrev_b32 v237,16,v202
M a[96:99],a[224:227],v[228:231],a[96:99]
s_waitcnt lgkmcnt(4)
buffer_load_dwordx2 v[206:207],v245,s[8:11],s28 offen offset:0
M a[100:103],a[224:227],a[196:199],a[100:103]
v_lshlrev_b32 v236,16,v200
v_lshlrev_b32 v235,16,v198
M a[100:103],a[220:223],v[228:231],a[100:103]
v_fmac_f32 v232,s43,v234
v_fmac_f32 v237,4.0,v233
M a[100:103],v[224:227],a[208:211],a[100:103]
v_fma_f32 v238,-4.0,v234,v236
v_fmac_f32 v232,s45,v236
M a[104:107],v[224:227],v[228:231],a[104:107]
buffer_load_dwordx2 v[208:209],v245,s[8:11],s28 offen offset:384
M a[104:107],a[220:223],a[196:199],a[104:107]
s_waitcnt lgkmcnt(1)
ds_read_b128 a[192:195],v248 offset:10240
ds_read_b128 a[232:235],v249 offset:10240
M a[104:107],a[224:227],a[236:239],a[104:107]
s_waitcnt lgkmcnt(2)
v_fmac_f32 v237,s41,v235
v_sub_f32 v236,v236,v234
M a[108:111],a[224:227],v[216:219],a[108:111]
v_fma_f32 v234,-4.0,v233,v235
v_sub_f32 v235,v235,v233
M a[108:111],a[220:223],a[236:239],a[108:111]
buffer_load_dwordx2 v[210:211],v245,s[8:11],s28 offen offset:768
M a[108:111],v[224:227],a[196:199],a[108:111]
v_add_f32 v233,v238,v234
v_sub_f32 v238,v238,v234
M a[112:115],v[224:227],a[236:239],a[112:115]
ds_read_b128 a[212:215],v249 offset:10752
v_fma_f32 v234,2.0,v235,v236
M a[112:115],a[220:223],v[216:219],a[112:115]
s_waitcnt lgkmcnt(2)
ds_read_b128 v[220:223],v248 offset:10752
v_fmac_f32 v236,-2.0,v235
M a[112:115],a[224:227],a[192:195],a[112:115]
s_waitcnt lgkmcnt(2)
buffer_load_dwordx2 v[212:213],v245,s[8:11],s28 offen offset:1152
M a[116:119],a[224:227],a[232:235],a[116:119]
s_add_u32 s29,s70,0
v_and_b32 v196,s42,v196
v_and_b32 v192,s42,v192
M a[116:119],a[220:223],a[192:195],a[116:119]
v_and_b32 v194,s42,v194
v_and_b32 v202,s42,v202
M a[116:119],v[224:227],v[216:219],a[116:119]
v_and_b32 v200,s42,v200
v_and_b32 v198,s42,v198
M a[120:123],v[224:227],a[192:195],a[120:123]
buffer_load_short_d16_hi v239,v246,s[12:15],s29 offen offset:0
M a[120:123],a[220:223],a[232:235],a[120:123]
s_waitcnt lgkmcnt(1)
v_fmac_f32 v192,s43,v196
v_fmac_f32 v202,4.0,v194
M a[120:123],a[224:227],a[212:215],a[120:123]
s_waitcnt lgkmcnt(0)
buffer_load_short_d16_hi v240,v246,s[8:11],s29 offen offset:0
M a[124:127],a[224:227],v[220:223],a[124:127]
v_fma_f32 v235,-4.0,v196,v200
v_fmac_f32 v192,s45,v200
M a[124:127],a[220:223],a[212:215],a[124:127]
buffer_load_dwordx4 a[224:227],v250,s[20:23],s46 offen offset:1024 sc1
M a[124:127],v[224:227],a[232:235],a[124:127]
s_waitcnt vmcnt(15)
v_fmac_f32 v202,s41,v198
v_sub_f32 v200,v200,v196
M a[128:131],a[252:255],a[204:207],a[128:131]
s_waitcnt vmcnt(14)
v_fma_f32 v196,-4.0,v194,v198
v_sub_f32 v198,v198,v194
M a[128:131],a[240:243],a[208:211],a[128:131]
s_waitcnt vmcnt(13)
v_add_f32 v194,v235,v196
v_sub_f32 v235,v235,v196
M a[128:131],a[244:247],v[228:231],a[128:131]
buffer_load_dwordx4 a[220:223],v250,s[20:23],s46 offen offset:2048 sc1
M a[132:135],a[244:247],a[196:199],a[132:135]
s_add_u32 s47,s74,30720
v_fma_f32 v196,2.0,v198,v200
v_fmac_f32 v200,-2.0,v198
M a[132:135],a[240:243],v[228:231],a[132:135]
v_cvt_pk_bf16_f32 v192,v232,v192
v_cvt_pk_bf16_f32 v202,v237,v202
M a[132:135],a[252:255],a[208:211],a[132:135]
v_cvt_pk_bf16_f32 v194,v233,v194
v_cvt_pk_bf16_f32 v198,v234,v196
M a[136:139],a[252:255],v[228:231],a[136:139]
buffer_load_dwordx4 v[224:227],v250,s[20:23],s47 offen offset:0 sc1
M a[136:139],a[240:243],a[196:199],a[136:139]
v_cvt_pk_bf16_f32 v196,v238,v235
v_cvt_pk_bf16_f32 v200,v236,v200
M a[136:139],a[244:247],a[236:239],a[136:139]
v_lshlrev_b32 v234,16,v197
v_lshlrev_b32 v232,16,v193
M a[140:143],a[244:247],v[216:219],a[140:143]
v_lshlrev_b32 v233,16,v195
v_lshlrev_b32 v237,16,v203
M a[140:143],a[240:243],a[236:239],a[140:143]
buffer_load_short_d16_hi v241,v246,s[8:11],s29 offen offset:384
M a[140:143],a[252:255],a[196:199],a[140:143]
v_lshlrev_b32 v236,16,v201
v_lshlrev_b32 v235,16,v199
M a[144:147],a[252:255],a[236:239],a[144:147]
buffer_load_short_d16_hi v242,v246,s[8:11],s29 offen offset:768
M a[144:147],a[240:243],v[216:219],a[144:147]
v_fmac_f32 v232,s43,v234
v_fmac_f32 v237,4.0,v233
M a[144:147],a[244:247],a[192:195],a[144:147]
buffer_load_short_d16_hi v243,v246,s[8:11],s29 offen offset:1152
M a[148:151],a[244:247],a[232:235],a[148:151]
v_fma_f32 v238,-4.0,v234,v236
v_fmac_f32 v232,s45,v236
M a[148:151],a[240:243],a[192:195],a[148:151]
buffer_load_short_d16_hi v244,v246,s[16:19],s29 offen offset:1536
M a[148:151],a[252:255],v[216:219],a[148:151]
v_fmac_f32 v237,s41,v235
v_sub_f32 v236,v236,v234
M a[152:155],a[252:255],a[192:195],a[152:155]
v_fma_f32 v234,-4.0,v233,v235
v_sub_f32 v235,v235,v233
M a[152:155],a[240:243],a[232:235],a[152:155]
v_add_f32 v233,v238,v234
v_sub_f32 v238,v238,v234
M a[152:155],a[244:247],a[212:215],a[152:155]
v_fma_f32 v234,2.0,v235,v236
v_fmac_f32 v236,-2.0,v235
M a[156:159],a[244:247],v[220:223],a[156:159]
buffer_load_dwordx4 a[244:247],v250,s[20:23],s47 offen offset:1024 sc1
M a[156:159],a[240:243],a[212:215],a[156:159]
v_and_b32 v197,s42,v197
v_and_b32 v193,s42,v193
M a[156:159],a[252:255],a[232:235],a[156:159]
s_waitcnt vmcnt(19)
buffer_load_dwordx4 a[240:243],v250,s[20:23],s47 offen offset:2048 sc1
M a[160:163],a[228:231],a[204:207],a[160:163]
s_waitcnt vmcnt(19)
s_add_u32 s48,s74,33792
v_and_b32 v195,s42,v195
v_and_b32 v203,s42,v203
M a[160:163],a[216:219],a[208:211],a[160:163]
s_waitcnt vmcnt(18)
v_and_b32 v201,s42,v201
v_and_b32 v199,s42,v199
M a[160:163],a[200:203],v[228:231],a[160:163]
v_fmac_f32 v193,s43,v197
v_fmac_f32 v203,4.0,v195
M a[164:167],a[200:203],a[196:199],a[164:167]
buffer_load_dwordx4 a[252:255],v250,s[20:23],s48 offen offset:0 sc1
M a[164:167],a[216:219],v[228:231],a[164:167]
v_fma_f32 v235,-4.0,v197,v201
v_fmac_f32 v193,s45,v201
M a[164:167],a[228:231],a[208:211],a[164:167]
v_fmac_f32 v203,s41,v199
v_sub_f32 v201,v201,v197
M a[168:171],a[228:231],v[228:231],a[168:171]
v_fma_f32 v197,-4.0,v195,v199
v_sub_f32 v199,v199,v195
M a[168:171],a[216:219],a[196:199],a[168:171]
buffer_load_dwordx4 a[204:207],v250,s[20:23],s48 offen offset:1024 sc1
M a[168:171],a[200:203],a[236:239],a[168:171]
v_add_f32 v195,v235,v197
v_sub_f32 v235,v235,v197
M a[172:175],a[200:203],v[216:219],a[172:175]
v_fma_f32 v197,2.0,v199,v201
v_fmac_f32 v201,-2.0,v199
M a[172:175],a[216:219],a[236:239],a[172:175]
v_cvt_pk_bf16_f32 v193,v232,v193
v_cvt_pk_bf16_f32 v203,v237,v203
M a[172:175],a[228:231],a[196:199],a[172:175]
buffer_load_dwordx4 a[208:211],v250,s[20:23],s48 offen offset:2048 sc1
M a[176:179],a[228:231],a[236:239],a[176:179]
s_add_u32 s46,s74,36864
v_cvt_pk_bf16_f32 v195,v233,v195
v_cvt_pk_bf16_f32 v199,v234,v197
M a[176:179],a[216:219],v[216:219],a[176:179]
v_cvt_pk_bf16_f32 v197,v238,v235
v_cvt_pk_bf16_f32 v201,v236,v201
M a[176:179],a[200:203],a[192:195],a[176:179]
s_waitcnt vmcnt(16)
v_add_u32 v238,121856,v247
v_lshlrev_b32 v234,16,v208
M a[180:183],a[200:203],a[232:235],a[180:183]
buffer_load_dwordx4 v[228:231],v250,s[20:23],s46 offen offset:0 sc1
M a[180:183],a[216:219],a[192:195],a[180:183]
ds_read_b128 a[196:199],v248 offset:17408
v_lshlrev_b32 v232,16,v204
M a[180:183],a[228:231],v[216:219],a[180:183]
ds_write2st64_b64 v238,v[192:193],v[202:203] offset0:2 offset1:19
M a[184:187],a[228:231],a[192:195],a[184:187]
s_add_u32 s28,s70,0
ds_read_b128 a[236:239],v249 offset:17408
ds_read_b128 v[216:219],v248 offset:17920
M a[184:187],a[216:219],a[232:235],a[184:187]
buffer_load_dwordx2 v[192:193],v251,s[12:15],s28 offen offset:0
M a[184:187],a[200:203],a[212:215],a[184:187]
ds_write2st64_b64 v247,v[194:195],v[196:197] offset0:104 offset1:121
M a[188:191],a[200:203],v[220:223],a[188:191]
ds_read_b128 a[192:195],v249 offset:17920
v_lshlrev_b32 v233,16,v206
M a[188:191],a[216:219],a[212:215],a[188:191]
buffer_load_dwordx2 v[202:203],v251,s[16:19],s28 offen offset:1536
M a[188:191],a[228:231],a[232:235],a[188:191]
s_waitcnt lgkmcnt(5)
ds_write2st64_b64 v247,v[198:199],v[200:201] offset0:138 offset1:155
M v[0:3],a[248:251],a[196:199],v[0:3]
s_waitcnt vmcnt(14) lgkmcnt(4)
ds_read_b128 a[200:203],v248 offset:18432
v_lshlrev_b32 v237,16,v214
M v[0:3],a[224:227],a[236:239],v[0:3]
s_waitcnt vmcnt(13) lgkmcnt(4)
buffer_load_dwordx2 v[194:195],v251,s[8:11],s28 offen offset:0
M v[0:3],a[220:223],v[216:219],v[0:3]
s_waitcnt lgkmcnt(2)
ds_read_b128 v[220:223],v249 offset:18432
v_lshlrev_b32 v236,16,v212
M v[4:7],a[220:223],a[192:195],v[4:7]
v_lshlrev_b32 v235,16,v210
v_fmac_f32 v232,s43,v234
M v[4:7],a[224:227],v[216:219],v[4:7]
v_fmac_f32 v237,4.0,v233
v_fma_f32 v238,-4.0,v234,v236
M v[4:7],a[248:251],a[236:239],v[4:7]
buffer_load_dwordx2 v[196:197],v251,s[8:11],s28 offen offset:384
M v[8:11],a[248:251],v[216:219],v[8:11]
ds_read_b128 a[212:215],v248 offset:18944
v_fmac_f32 v232,s45,v236
M v[8:11],a[224:227],a[192:195],v[8:11]
s_waitcnt lgkmcnt(2)
ds_read_b128 a[216:219],v249 offset:18944
v_fmac_f32 v237,s41,v235
M v[8:11],a[220:223],a[200:203],v[8:11]
s_waitcnt lgkmcnt(2)
v_sub_f32 v236,v236,v234
v_fma_f32 v234,-4.0,v233,v235
M v[12:15],a[220:223],v[220:223],v[12:15]
buffer_load_dwordx2 v[198:199],v251,s[8:11],s28 offen offset:768
M v[12:15],a[224:227],a[200:203],v[12:15]
v_sub_f32 v235,v235,v233
v_add_f32 v233,v238,v234
M v[12:15],a[248:251],a[192:195],v[12:15]
v_sub_f32 v238,v238,v234
v_fma_f32 v234,2.0,v235,v236
M v[16:19],a[248:251],a[200:203],v[16:19]
ds_read_b128 a[228:231],v249 offset:19456
v_fmac_f32 v236,-2.0,v235
M v[16:19],a[224:227],v[220:223],v[16:19]
s_waitcnt lgkmcnt(2)
buffer_load_dwordx2 v[200:201],v251,s[8:11],s28 offen offset:1152
M v[16:19],a[220:223],a[212:215],v[16:19]
s_waitcnt lgkmcnt(1)
ds_read_b128 a[232:235],v248 offset:19456
v_and_b32 v208,s42,v208
M v[20:23],a[220:223],a[216:219],v[20:23]
v_and_b32 v204,s42,v204
v_and_b32 v206,s42,v206
M v[20:23],a[224:227],a[212:215],v[20:23]
v_and_b32 v214,s42,v214
v_and_b32 v212,s42,v212
M v[20:23],a[248:251],v[220:223],v[20:23]
v_and_b32 v210,s42,v210
v_fmac_f32 v204,s43,v208
M v[24:27],a[248:251],a[212:215],v[24:27]
v_fmac_f32 v214,4.0,v206
v_fma_f32 v235,-4.0,v208,v212
M v[24:27],a[224:227],a[216:219],v[24:27]
s_waitcnt lgkmcnt(1)
v_fmac_f32 v204,s45,v212
v_fmac_f32 v214,s41,v210
M v[24:27],a[220:223],a[228:231],v[24:27]
s_waitcnt lgkmcnt(0)
v_sub_f32 v212,v212,v208
v_fma_f32 v208,-4.0,v206,v210
M v[28:31],a[220:223],a[232:235],v[28:31]
buffer_load_dwordx4 a[220:223],v250,s[20:23],s46 offen offset:1024 sc1
M v[28:31],a[224:227],a[228:231],v[28:31]
v_sub_f32 v210,v210,v206
v_add_f32 v206,v235,v208
M v[28:31],a[248:251],a[216:219],v[28:31]
s_waitcnt vmcnt(17)
buffer_load_dwordx4 a[224:227],v250,s[20:23],s46 offen offset:2048 sc1
M v[32:35],v[224:227],a[196:199],v[32:35]
s_waitcnt vmcnt(13)
s_add_u32 s47,s74,39936
v_sub_f32 v235,v235,v208
v_fma_f32 v208,2.0,v210,v212
M v[32:35],a[244:247],a[236:239],v[32:35]
s_waitcnt vmcnt(12)
v_fmac_f32 v212,-2.0,v210
v_cvt_pk_bf16_f32 v204,v232,v204
M v[32:35],a[240:243],v[216:219],v[32:35]
v_cvt_pk_bf16_f32 v214,v237,v214
v_cvt_pk_bf16_f32 v206,v233,v206
M v[36:39],a[240:243],a[192:195],v[36:39]
buffer_load_dwordx4 a[248:251],v250,s[20:23],s47 offen offset:0 sc1
M v[36:39],a[244:247],v[216:219],v[36:39]
v_cvt_pk_bf16_f32 v210,v234,v208
v_cvt_pk_bf16_f32 v208,v238,v235
M v[36:39],v[224:227],a[236:239],v[36:39]
v_cvt_pk_bf16_f32 v212,v236,v212
v_lshlrev_b32 v234,16,v209
M v[40:43],v[224:227],v[216:219],v[40:43]
v_lshlrev_b32 v232,16,v205
v_lshlrev_b32 v233,16,v207
M v[40:43],a[244:247],a[192:195],v[40:43]
v_lshlrev_b32 v237,16,v215
v_lshlrev_b32 v236,16,v213
M v[40:43],a[240:243],a[200:203],v[40:43]
v_lshlrev_b32 v235,16,v211
v_fmac_f32 v232,s43,v234
M v[44:47],a[240:243],v[220:223],v[44:47]
v_fmac_f32 v237,4.0,v233
v_fma_f32 v238,-4.0,v234,v236
M v[44:47],a[244:247],a[200:203],v[44:47]
v_fmac_f32 v232,s45,v236
v_fmac_f32 v237,s41,v235
M v[44:47],v[224:227],a[192:195],v[44:47]
v_sub_f32 v236,v236,v234
v_fma_f32 v234,-4.0,v233,v235
M v[48:51],v[224:227],a[200:203],v[48:51]
v_sub_f32 v235,v235,v233
v_add_f32 v233,v238,v234
M v[48:51],a[244:247],v[220:223],v[48:51]
v_sub_f32 v238,v238,v234
v_fma_f32 v234,2.0,v235,v236
M v[48:51],a[240:243],a[212:215],v[48:51]
v_fmac_f32 v236,-2.0,v235
v_and_b32 v209,s42,v209
M v[52:55],a[240:243],a[216:219],v[52:55]
v_and_b32 v205,s42,v205
v_and_b32 v207,s42,v207
M v[52:55],a[244:247],a[212:215],v[52:55]
v_and_b32 v215,s42,v215
v_and_b32 v213,s42,v213
M v[52:55],v[224:227],v[220:223],v[52:55]
v_and_b32 v211,s42,v211
v_fmac_f32 v205,s43,v209
M v[56:59],v[224:227],a[212:215],v[56:59]
v_fmac_f32 v215,4.0,v207
v_fma_f32 v235,-4.0,v209,v213
M v[56:59],a[244:247],a[216:219],v[56:59]
v_fmac_f32 v205,s45,v213
v_fmac_f32 v215,s41,v211
M v[56:59],a[240:243],a[228:231],v[56:59]
v_sub_f32 v213,v213,v209
v_fma_f32 v209,-4.0,v207,v211
M v[60:63],a[240:243],a[232:235],v[60:63]
buffer_load_dwordx4 a[240:243],v250,s[20:23],s47 offen offset:1024 sc1
M v[60:63],a[244:247],a[228:231],v[60:63]
v_sub_f32 v211,v211,v207
v_add_f32 v207,v235,v209
M v[60:63],v[224:227],a[216:219],v[60:63]
s_waitcnt vmcnt(13)
buffer_load_dwordx4 a[244:247],v250,s[20:23],s47 offen offset:2048 sc1
M v[64:67],a[252:255],a[196:199],v[64:67]
s_waitcnt vmcnt(13)
s_add_u32 s48,s74,43008
v_sub_f32 v235,v235,v209
v_fma_f32 v209,2.0,v211,v213
M v[64:67],a[204:207],a[236:239],v[64:67]
s_waitcnt vmcnt(12)
v_fmac_f32 v213,-2.0,v211
v_cvt_pk_bf16_f32 v205,v232,v205
M v[64:67],a[208:211],v[216:219],v[64:67]
v_cvt_pk_bf16_f32 v215,v237,v215
v_cvt_pk_bf16_f32 v207,v233,v207
M v[68:71],a[208:211],a[192:195],v[68:71]
buffer_load_dwordx4 v[224:227],v250,s[20:23],s48 offen offset:0 sc1
M v[68:71],a[204:207],v[216:219],v[68:71]
v_cvt_pk_bf16_f32 v211,v234,v209
v_cvt_pk_bf16_f32 v209,v238,v235
M v[68:71],a[252:255],a[236:239],v[68:71]
v_cvt_pk_bf16_f32 v213,v236,v213
v_add_u32 v238,121856,v247
M v[72:75],a[252:255],v[216:219],v[72:75]
M v[72:75],a[204:207],a[192:195],v[72:75]
buffer_load_dwordx4 a[196:199],v250,s[20:23],s48 offen offset:1024 sc1
M v[72:75],a[208:211],a[200:203],v[72:75]
ds_write2st64_b64 v238,v[204:205],v[214:215] offset0:3 offset1:20
M v[76:79],a[208:211],v[220:223],v[76:79]
s_add_u32 s28,s70,393216
M v[76:79],a[204:207],a[200:203],v[76:79]
M v[76:79],a[252:255],a[192:195],v[76:79]
buffer_load_dwordx4 a[236:239],v250,s[20:23],s48 offen offset:2048 sc1
M v[80:83],a[252:255],a[200:203],v[80:83]
s_add_u32 s46,s75,9216
M v[80:83],a[204:207],v[220:223],v[80:83]
M v[80:83],a[208:211],a[212:215],v[80:83]
ds_write2st64_b64 v247,v[206:207],v[208:209] offset0:105 offset1:122
M v[84:87],a[208:211],a[216:219],v[84:87]
buffer_load_dwordx4 v[216:219],v250,s[20:23],s46 offen offset:0 sc1
M v[84:87],a[204:207],a[212:215],v[84:87]
ds_read_b128 a[192:195],v248 offset:26112
M v[84:87],a[252:255],v[220:223],v[84:87]
ds_write2st64_b64 v247,v[210:211],v[212:213] offset0:139 offset1:156
M v[88:91],a[252:255],a[212:215],v[88:91]
buffer_load_dwordx2 v[204:205],v245,s[12:15],s28 offen offset:0
M v[88:91],a[204:207],a[216:219],v[88:91]
ds_read_b128 a[200:203],v249 offset:26112
ds_read_b128 v[220:223],v248 offset:26624
M v[88:91],a[208:211],a[228:231],v[88:91]
ds_read_b128 a[212:215],v249 offset:26624
M v[92:95],a[208:211],a[232:235],v[92:95]
buffer_load_dwordx2 v[214:215],v245,s[16:19],s28 offen offset:1536
M v[92:95],a[204:207],a[228:231],v[92:95]
M v[92:95],a[252:255],a[216:219],v[92:95]
s_waitcnt vmcnt(17) lgkmcnt(4)
M v[96:99],v[228:231],a[192:195],v[96:99]
s_waitcnt vmcnt(10) lgkmcnt(2)
ds_read_b128 a[208:211],v248 offset:27136
M v[96:99],a[220:223],a[200:203],v[96:99]
s_waitcnt vmcnt(9) lgkmcnt(2)
buffer_load_dwordx2 v[206:207],v245,s[8:11],s28 offen offset:0
M v[96:99],a[224:227],v[220:223],v[96:99]
s_waitcnt lgkmcnt(1)
ds_read_b128 a[232:235],v249 offset:27136
v_lshlrev_b32 v234,16,v196
M v[100:103],a[224:227],a[212:215],v[100:103]
v_lshlrev_b32 v232,16,v192
v_lshlrev_b32 v233,16,v194
M v[100:103],a[220:223],v[220:223],v[100:103]
v_lshlrev_b32 v237,16,v202
v_lshlrev_b32 v236,16,v200
M v[100:103],v[228:231],a[200:203],v[100:103]
buffer_load_dwordx2 v[208:209],v245,s[8:11],s28 offen offset:384
M v[104:107],v[228:231],v[220:223],v[104:107]
ds_read_b128 a[204:207],v248 offset:27648
v_lshlrev_b32 v235,16,v198
M v[104:107],a[220:223],a[212:215],v[104:107]
s_waitcnt lgkmcnt(2)
ds_read_b128 a[228:231],v249 offset:27648
v_fmac_f32 v232,s43,v234
M v[104:107],a[224:227],a[208:211],v[104:107]
s_waitcnt lgkmcnt(2)
v_fmac_f32 v237,4.0,v233
v_fma_f32 v238,-4.0,v234,v236
M v[108:111],a[224:227],a[232:235],v[108:111]
buffer_load_dwordx2 v[210:211],v245,s[8:11],s28 offen offset:768
M v[108:111],a[220:223],a[208:211],v[108:111]
v_fmac_f32 v232,s45,v236
v_fmac_f32 v237,s41,v235
M v[108:111],v[228:231],a[212:215],v[108:111]
v_sub_f32 v236,v236,v234
v_fma_f32 v234,-4.0,v233,v235
M v[112:115],v[228:231],a[208:211],v[112:115]
ds_read_b128 a[216:219],v249 offset:28160
v_sub_f32 v235,v235,v233
M v[112:115],a[220:223],a[232:235],v[112:115]
s_waitcnt lgkmcnt(2)
buffer_load_dwordx2 v[212:213],v245,s[8:11],s28 offen offset:1152
M v[112:115],a[224:227],a[204:207],v[112:115]
s_waitcnt lgkmcnt(1)
ds_read_b128 a[252:255],v248 offset:28160
v_add_f32 v233,v238,v234
M v[116:119],a[224:227],a[228:231],v[116:119]
v_sub_f32 v238,v238,v234
v_fma_f32 v234,2.0,v235,v236
M v[116:119],a[220:223],a[204:207],v[116:119]
v_fmac_f32 v236,-2.0,v235
v_and_b32 v196,s42,v196
M v[116:119],v[228:231],a[232:235],v[116:119]
v_and_b32 v192,s42,v192
v_and_b32 v194,s42,v194
M v[120:123],v[228:231],a[204:207],v[120:123]
v_and_b32 v202,s42,v202
v_and_b32 v200,s42,v200
M v[120:123],a[220:223],a[228:231],v[120:123]
s_waitcnt lgkmcnt(1)
v_and_b32 v198,s42,v198
v_fmac_f32 v192,s43,v196
M v[120:123],a[224:227],a[216:219],v[120:123]
s_waitcnt lgkmcnt(0)
v_fmac_f32 v202,4.0,v194
v_fma_f32 v235,-4.0,v196,v200
M v[124:127],a[224:227],a[252:255],v[124:127]
buffer_load_dwordx4 a[224:227],v250,s[20:23],s46 offen offset:1024 sc1
M v[124:127],a[220:223],a[216:219],v[124:127]
v_fmac_f32 v192,s45,v200
v_fmac_f32 v202,s41,v198
M v[124:127],v[228:231],a[228:231],v[124:127]
s_waitcnt vmcnt(13)
buffer_load_dwordx4 a[220:223],v250,s[20:23],s46 offen offset:2048 sc1
M v[128:131],a[248:251],a[192:195],v[128:131]
s_waitcnt vmcnt(13)
s_add_u32 s47,s75,12288
v_sub_f32 v200,v200,v196
v_fma_f32 v196,-4.0,v194,v198
M v[128:131],a[240:243],a[200:203],v[128:131]
s_waitcnt vmcnt(12)
v_sub_f32 v198,v198,v194
v_add_f32 v194,v235,v196
M v[128:131],a[244:247],v[220:223],v[128:131]
v_sub_f32 v235,v235,v196
v_fma_f32 v196,2.0,v198,v200
M v[132:135],a[244:247],a[212:215],v[132:135]
buffer_load_dwordx4 v[228:231],v250,s[20:23],s47 offen offset:0 sc1
M v[132:135],a[240:243],v[220:223],v[132:135]
v_fmac_f32 v200,-2.0,v198
v_cvt_pk_bf16_f32 v192,v232,v192
M v[132:135],a[248:251],a[200:203],v[132:135]
v_cvt_pk_bf16_f32 v202,v237,v202
v_cvt_pk_bf16_f32 v194,v233,v194
M v[136:139],a[248:251],v[220:223],v[136:139]
v_cvt_pk_bf16_f32 v198,v234,v196
v_cvt_pk_bf16_f32 v196,v238,v235
M v[136:139],a[240:243],a[212:215],v[136:139]
v_cvt_pk_bf16_f32 v200,v236,v200
v_lshlrev_b32 v234,16,v197
M v[136:139],a[244:247],a[208:211],v[136:139]
v_lshlrev_b32 v232,16,v193
v_lshlrev_b32 v233,16,v195
M v[140:143],a[244:247],a[232:235],v[140:143]
v_lshlrev_b32 v237,16,v203
v_lshlrev_b32 v236,16,v201
M v[140:143],a[240:243],a[208:211],v[140:143]
v_lshlrev_b32 v235,16,v199
v_fmac_f32 v232,s43,v234
M v[140:143],a[248:251],a[212:215],v[140:143]
v_fmac_f32 v237,4.0,v233
v_fma_f32 v238,-4.0,v234,v236
M v[144:147],a[248:251],a[208:211],v[144:147]
v_fmac_f32 v232,s45,v236
v_fmac_f32 v237,s41,v235
M v[144:147],a[240:243],a[232:235],v[144:147]
v_sub_f32 v236,v236,v234
v_fma_f32 v234,-4.0,v233,v235
M v[144:147],a[244:247],a[204:207],v[144:147]
v_sub_f32 v235,v235,v233
v_add_f32 v233,v238,v234
M v[148:151],a[244:247],a[228:231],v[148:151]
v_sub_f32 v238,v238,v234
v_fma_f32 v234,2.0,v235,v236
M v[148:151],a[240:243],a[204:207],v[148:151]
v_fmac_f32 v236,-2.0,v235
v_and_b32 v197,s42,v197
M v[148:151],a[248:251],a[232:235],v[148:151]
v_and_b32 v193,s42,v193
v_and_b32 v195,s42,v195
M v[152:155],a[248:251],a[204:207],v[152:155]
v_and_b32 v203,s42,v203
v_and_b32 v201,s42,v201
M v[152:155],a[240:243],a[228:231],v[152:155]
v_and_b32 v199,s42,v199
v_fmac_f32 v193,s43,v197
M v[152:155],a[244:247],a[216:219],v[152:155]
v_fmac_f32 v203,4.0,v195
v_fma_f32 v235,-4.0,v197,v201
M v[156:159],a[244:247],a[252:255],v[156:159]
buffer_load_dwordx4 a[244:247],v250,s[20:23],s47 offen offset:1024 sc1
M v[156:159],a[240:243],a[216:219],v[156:159]
v_fmac_f32 v193,s45,v201
v_fmac_f32 v203,s41,v199
M v[156:159],a[248:251],a[228:231],v[156:159]
s_waitcnt vmcnt(13)
buffer_load_dwordx4 a[240:243],v250,s[20:23],s47 offen offset:2048 sc1
M v[160:163],v[224:227],a[192:195],v[160:163]
s_waitcnt vmcnt(13)
s_add_u32 s48,s75,15360
v_sub_f32 v201,v201,v197
v_fma_f32 v197,-4.0,v195,v199
M v[160:163],a[196:199],a[200:203],v[160:163]
s_waitcnt vmcnt(12)
v_sub_f32 v199,v199,v195
v_add_f32 v195,v235,v197
M v[160:163],a[236:239],v[220:223],v[160:163]
v_sub_f32 v235,v235,v197
v_fma_f32 v197,2.0,v199,v201
M v[164:167],a[236:239],a[212:215],v[164:167]
buffer_load_dwordx4 a[248:251],v250,s[20:23],s48 offen offset:0 sc1
M v[164:167],a[196:199],v[220:223],v[164:167]
v_fmac_f32 v201,-2.0,v199
v_cvt_pk_bf16_f32 v193,v232,v193
M v[164:167],v[224:227],a[200:203],v[164:167]
v_cvt_pk_bf16_f32 v203,v237,v203
v_cvt_pk_bf16_f32 v195,v233,v195
M v[168:171],v[224:227],v[220:223],v[168:171]
v_cvt_pk_bf16_f32 v199,v234,v197
v_cvt_pk_bf16_f32 v197,v238,v235
M v[168:171],a[196:199],a[212:215],v[168:171]
buffer_load_dwordx4 a[192:195],v250,s[20:23],s48 offen offset:1024 sc1
M v[168:171],a[236:239],a[208:211],v[168:171]
v_cvt_pk_bf16_f32 v201,v236,v201
v_add_u32 v238,139264,v247
M v[172:175],a[236:239],a[232:235],v[172:175]
M v[172:175],a[196:199],a[208:211],v[172:175]
M v[172:175],v[224:227],a[212:215],v[172:175]
buffer_load_dwordx4 a[200:203],v250,s[20:23],s48 offen offset:2048 sc1
M v[176:179],v[224:227],a[208:211],v[176:179]
s_add_u32 s46,s75,18432
M v[176:179],a[196:199],a[232:235],v[176:179]
M v[176:179],a[236:239],a[204:207],v[176:179]
s_barrier
ds_write2st64_b64 v238,v[192:193],v[202:203] offset0:0 offset1:17
M v[180:183],a[236:239],a[228:231],v[180:183]
s_add_u32 s28,s70,786432
buffer_load_dwordx4 v[220:223],v250,s[20:23],s46 offen offset:0 sc1
M v[180:183],a[196:199],a[204:207],v[180:183]
ds_read_b128 a[212:215],v248 offset:34816
M v[180:183],v[224:227],a[232:235],v[180:183]
ds_write2st64_b64 v247,v[194:195],v[196:197] offset0:34 offset1:51
M v[184:187],v[224:227],a[204:207],v[184:187]
buffer_load_dwordx2 v[192:193],v245,s[12:15],s28 offen offset:0
M v[184:187],a[196:199],a[228:231],v[184:187]
ds_read_b128 a[208:211],v249 offset:34816
ds_read_b128 a[232:235],v248 offset:35328
M v[184:187],a[236:239],a[216:219],v[184:187]
ds_write2st64_b64 v247,v[198:199],v[200:201] offset0:68 offset1:85
M v[188:191],a[236:239],a[252:255],v[188:191]
buffer_load_dwordx2 v[202:203],v245,s[16:19],s28 offen offset:1536
M v[188:191],a[196:199],a[216:219],v[188:191]
ds_read_b128 a[204:207],v249 offset:35328
M v[188:191],v[224:227],a[228:231],v[188:191]
s_waitcnt vmcnt(17) lgkmcnt(5)
M a[0:3],v[216:219],a[212:215],a[0:3]
s_waitcnt vmcnt(10) lgkmcnt(3)
ds_read_b128 a[236:239],v248 offset:35840
M a[0:3],a[224:227],a[208:211],a[0:3]
s_waitcnt vmcnt(9) lgkmcnt(3)
buffer_load_dwordx2 v[194:195],v245,s[8:11],s28 offen offset:0
M a[0:3],a[220:223],a[232:235],a[0:3]
s_waitcnt lgkmcnt(1)
ds_read_b128 a[252:255],v249 offset:35840
v_lshlrev_b32 v234,16,v208
M a[4:7],a[220:223],a[204:207],a[4:7]
v_lshlrev_b32 v232,16,v204
v_lshlrev_b32 v233,16,v206
M a[4:7],a[224:227],a[232:235],a[4:7]
v_lshlrev_b32 v237,16,v214
v_lshlrev_b32 v236,16,v212
M a[4:7],v[216:219],a[208:211],a[4:7]
buffer_load_dwordx2 v[196:197],v245,s[8:11],s28 offen offset:384
M a[8:11],v[216:219],a[232:235],a[8:11]
ds_read_b128 a[196:199],v248 offset:36352
v_lshlrev_b32 v235,16,v210
M a[8:11],a[224:227],a[204:207],a[8:11]
s_waitcnt lgkmcnt(2)
ds_read_b128 a[216:219],v249 offset:36352
v_fmac_f32 v232,s43,v234
M a[8:11],a[220:223],a[236:239],a[8:11]
s_waitcnt lgkmcnt(2)
v_fmac_f32 v237,4.0,v233
v_fma_f32 v238,-4.0,v234,v236
M a[12:15],a[220:223],a[252:255],a[12:15]
buffer_load_dwordx2 v[198:199],v245,s[8:11],s28 offen offset:768
M a[12:15],a[224:227],a[236:239],a[12:15]
v_fmac_f32 v232,s45,v236
v_fmac_f32 v237,s41,v235
M a[12:15],v[216:219],a[204:207],a[12:15]
v_sub_f32 v236,v236,v234
v_fma_f32 v234,-4.0,v233,v235
M a[16:19],v[216:219],a[236:239],a[16:19]
ds_read_b128 a[228:231],v249 offset:36864
v_sub_f32 v235,v235,v233
M a[16:19],a[224:227],a[252:255],a[16:19]
s_waitcnt lgkmcnt(2)
buffer_load_dwordx2 v[200:201],v245,s[8:11],s28 offen offset:1152
M a[16:19],a[220:223],a[196:199],a[16:19]
s_waitcnt lgkmcnt(1)
ds_read_b128 v[224:227],v248 offset:36864
v_add_f32 v233,v238,v234
M a[20:23],a[220:223],a[216:219],a[20:23]
v_sub_f32 v238,v238,v234
v_fma_f32 v234,2.0,v235,v236
M a[20:23],a[224:227],a[196:199],a[20:23]
v_fmac_f32 v236,-2.0,v235
v_and_b32 v208,s42,v208
M a[20:23],v[216:219],a[252:255],a[20:23]
v_and_b32 v204,s42,v204
v_and_b32 v206,s42,v206
M a[24:27],v[216:219],a[196:199],a[24:27]
v_and_b32 v214,s42,v214
v_and_b32 v212,s42,v212
M a[24:27],a[224:227],a[216:219],a[24:27]
s_waitcnt lgkmcnt(1)
v_and_b32 v210,s42,v210
v_fmac_f32 v204,s43,v208
M a[24:27],a[220:223],a[228:231],a[24:27]
s_waitcnt lgkmcnt(0)
v_fmac_f32 v214,4.0,v206
v_fma_f32 v235,-4.0,v208,v212
M a[28:31],a[220:223],v[224:227],a[28:31]
buffer_load_dwordx4 a[220:223],v250,s[20:23],s46 offen offset:1024 sc1
M a[28:31],a[224:227],a[228:231],a[28:31]
v_fmac_f32 v204,s45,v212
v_fmac_f32 v214,s41,v210
M a[28:31],v[216:219],a[216:219],a[28:31]
s_waitcnt vmcnt(13)
buffer_load_dwordx4 a[224:227],v250,s[20:23],s46 offen offset:2048 sc1
M a[32:35],v[228:231],a[212:215],a[32:35]
s_waitcnt vmcnt(13)
s_add_u32 s47,s75,21504
v_sub_f32 v212,v212,v208
v_fma_f32 v208,-4.0,v206,v210
M a[32:35],a[244:247],a[208:211],a[32:35]
s_waitcnt vmcnt(12)
v_sub_f32 v210,v210,v206
v_add_f32 v206,v235,v208
M a[32:35],a[240:243],a[232:235],a[32:35]
v_sub_f32 v235,v235,v208
v_fma_f32 v208,2.0,v210,v212
M a[36:39],a[240:243],a[204:207],a[36:39]
buffer_load_dwordx4 v[216:219],v250,s[20:23],s47 offen offset:0 sc1
M a[36:39],a[244:247],a[232:235],a[36:39]
v_fmac_f32 v212,-2.0,v210
v_cvt_pk_bf16_f32 v204,v232,v204
M a[36:39],v[228:231],a[208:211],a[36:39]
v_cvt_pk_bf16_f32 v214,v237,v214
v_cvt_pk_bf16_f32 v206,v233,v206
M a[40:43],v[228:231],a[232:235],a[40:43]
v_cvt_pk_bf16_f32 v210,v234,v208
v_cvt_pk_bf16_f32 v208,v238,v235
M a[40:43],a[244:247],a[204:207],a[40:43]
v_cvt_pk_bf16_f32 v212,v236,v212
v_lshlrev_b32 v234,16,v209
M a[40:43],a[240:243],a[236:239],a[40:43]
v_lshlrev_b32 v232,16,v205
v_lshlrev_b32 v233,16,v207
M a[44:47],a[240:243],a[252:255],a[44:47]
v_lshlrev_b32 v237,16,v215
v_lshlrev_b32 v236,16,v213
M a[44:47],a[244:247],a[236:239],a[44:47]
v_lshlrev_b32 v235,16,v211
v_fmac_f32 v232,s43,v234
M a[44:47],v[228:231],a[204:207],a[44:47]
v_fmac_f32 v237,4.0,v233
v_fma_f32 v238,-4.0,v234,v236
M a[48:51],v[228:231],a[236:239],a[48:51]
v_fmac_f32 v232,s45,v236
v_fmac_f32 v237,s41,v235
M a[48:51],a[244:247],a[252:255],a[48:51]
v_sub_f32 v236,v236,v234
v_fma_f32 v234,-4.0,v233,v235
M a[48:51],a[240:243],a[196:199],a[48:51]
v_sub_f32 v235,v235,v233
v_add_f32 v233,v238,v234
M a[52:55],a[240:243],a[216:219],a[52:55]
v_sub_f32 v238,v238,v234
v_fma_f32 v234,2.0,v235,v236
M a[52:55],a[244:247],a[196:199],a[52:55]
v_fmac_f32 v236,-2.0,v235
v_and_b32 v209,s42,v209
M a[52:55],v[228:231],a[252:255],a[52:55]
v_and_b32 v205,s42,v205
v_and_b32 v207,s42,v207
M a[56:59],v[228:231],a[196:199],a[56:59]
v_and_b32 v215,s42,v215
v_and_b32 v213,s42,v213
M a[56:59],a[244:247],a[216:219],a[56:59]
v_and_b32 v211,s42,v211
v_fmac_f32 v205,s43,v209
M a[56:59],a[240:243],a[228:231],a[56:59]
v_fmac_f32 v215,4.0,v207
v_fma_f32 v235,-4.0,v209,v213
M a[60:63],a[240:243],v[224:227],a[60:63]
buffer_load_dwordx4 a[240:243],v250,s[20:23],s47 offen offset:1024 sc1
M a[60:63],a[244:247],a[228:231],a[60:63]
v_fmac_f32 v205,s45,v213
v_fmac_f32 v215,s41,v211
M a[60:63],v[228:231],a[216:219],a[60:63]
s_waitcnt vmcnt(13)
buffer_load_dwordx4 a[244:247],v250,s[20:23],s47 offen offset:2048 sc1
M a[64:67],a[248:251],a[212:215],a[64:67]
s_waitcnt vmcnt(13)
s_add_u32 s48,s75,24576
v_sub_f32 v213,v213,v209
v_fma_f32 v209,-4.0,v207,v211
M a[64:67],a[192:195],a[208:211],a[64:67]
s_waitcnt vmcnt(12)
v_sub_f32 v211,v211,v207
v_add_f32 v207,v235,v209
M a[64:67],a[200:203],a[232:235],a[64:67]
v_sub_f32 v235,v235,v209
v_fma_f32 v209,2.0,v211,v213
M a[68:71],a[200:203],a[204:207],a[68:71]
buffer_load_dwordx4 v[228:231],v250,s[20:23],s48 offen offset:0 sc1
M a[68:71],a[192:195],a[232:235],a[68:71]
v_fmac_f32 v213,-2.0,v211
v_cvt_pk_bf16_f32 v205,v232,v205
M a[68:71],a[248:251],a[208:211],a[68:71]
v_cvt_pk_bf16_f32 v215,v237,v215
v_cvt_pk_bf16_f32 v207,v233,v207
M a[72:75],a[248:251],a[232:235],a[72:75]
v_cvt_pk_bf16_f32 v211,v234,v209
v_cvt_pk_bf16_f32 v209,v238,v235
M a[72:75],a[192:195],a[204:207],a[72:75]
buffer_load_dwordx4 a[212:215],v250,s[20:23],s48 offen offset:1024 sc1
M a[72:75],a[200:203],a[236:239],a[72:75]
v_cvt_pk_bf16_f32 v213,v236,v213
v_add_u32 v238,139264,v247
M a[76:79],a[200:203],a[252:255],a[76:79]
v_fmac_f32 v239,s43,v241
v_fmac_f32 v244,4.0,v240
M a[76:79],a[192:195],a[236:239],a[76:79]
v_fma_f32 v232,-4.0,v241,v243
v_fmac_f32 v239,s45,v243
M a[76:79],a[248:251],a[204:207],a[76:79]
buffer_load_dwordx4 a[208:211],v250,s[20:23],s48 offen offset:2048 sc1
M a[80:83],a[248:251],a[236:239],a[80:83]
s_add_u32 s46,s75,27648
v_fmac_f32 v244,s41,v242
v_sub_f32 v243,v243,v241
M a[80:83],a[192:195],a[252:255],a[80:83]
v_fma_f32 v241,-4.0,v240,v242
v_sub_f32 v242,v242,v240
M a[80:83],a[200:203],a[196:199],a[80:83]
ds_write2st64_b64 v238,v[204:205],v[214:215] offset0:1 offset1:18
M a[84:87],a[200:203],a[216:219],a[84:87]
s_add_u32 s28,s70,1179648
buffer_load_dwordx4 a[232:235],v250,s[20:23],s46 offen offset:0 sc1
M a[84:87],a[192:195],a[196:199],a[84:87]
ds_read_b128 a[204:207],v248 offset:43520
v_add_f32 v240,v232,v241
M a[84:87],a[248:251],a[252:255],a[84:87]
ds_write2st64_b64 v247,v[206:207],v[208:209] offset0:35 offset1:52
M a[88:91],a[248:251],a[196:199],a[88:91]
buffer_load_dwordx2 v[204:205],v245,s[12:15],s28 offen offset:0
M a[88:91],a[192:195],a[216:219],a[88:91]
ds_read_b128 a[236:239],v249 offset:43520
ds_read_b128 a[252:255],v248 offset:44032
M a[88:91],a[200:203],a[228:231],a[88:91]
ds_write2st64_b64 v247,v[210:211],v[212:213] offset0:69 offset1:86
M a[92:95],a[200:203],v[224:227],a[92:95]
buffer_load_dwordx2 v[214:215],v245,s[16:19],s28 offen offset:1536
M a[92:95],a[192:195],a[228:231],a[92:95]
ds_read_b128 a[196:199],v249 offset:44032
v_sub_f32 v232,v232,v241
M a[92:95],a[248:251],a[216:219],a[92:95]
s_waitcnt vmcnt(17) lgkmcnt(5)
v_fma_f32 v241,2.0,v242,v243
v_fmac_f32 v243,-2.0,v242
M a[96:99],v[220:223],a[204:207],a[96:99]
s_waitcnt vmcnt(10) lgkmcnt(3)
ds_read_b128 a[200:203],v248 offset:44544
v_cvt_pk_bf16_f32 v233,v239,v244
M a[96:99],a[220:223],a[236:239],a[96:99]
s_waitcnt vmcnt(9) lgkmcnt(3)
buffer_load_dwordx2 v[206:207],v245,s[8:11],s28 offen offset:0
M a[96:99],a[224:227],a[252:255],a[96:99]
s_waitcnt lgkmcnt(1)
ds_read_b128 v[224:227],v249 offset:44544
v_cvt_pk_bf16_f32 v234,v240,v232
M a[100:103],a[224:227],a[196:199],a[100:103]
v_cvt_pk_bf16_f32 v235,v241,v243
v_add_u32 v232,139264,v252
M a[100:103],a[220:223],a[252:255],a[100:103]
ds_write_b16 v232,v233 offset:0
M a[100:103],v[220:223],a[236:239],a[100:103]
buffer_load_dwordx2 v[208:209],v245,s[8:11],s28 offen offset:384
M a[104:107],v[220:223],a[252:255],a[104:107]
ds_read_b128 a[192:195],v248 offset:45056
ds_write_b16_d16_hi v232,v233 offset:8704
M a[104:107],a[220:223],a[196:199],a[104:107]
s_waitcnt lgkmcnt(4)
ds_read_b128 a[228:231],v249 offset:45056
ds_write_b16 v252,v234 offset:17408
M a[104:107],a[224:227],a[200:203],a[104:107]
s_waitcnt lgkmcnt(5)
ds_write_b16_d16_hi v252,v234 offset:26112
M a[108:111],a[224:227],v[224:227],a[108:111]
buffer_load_dwordx2 v[210:211],v245,s[8:11],s28 offen offset:768
M a[108:111],a[220:223],a[200:203],a[108:111]
ds_write_b16 v252,v235 offset:34816
M a[108:111],v[220:223],a[196:199],a[108:111]
ds_write_b16_d16_hi v252,v235 offset:43520
M a[112:115],v[220:223],a[200:203],a[112:115]
ds_read_b128 a[216:219],v249 offset:45568
v_lshlrev_b32 v234,16,v196
M a[112:115],a[220:223],v[224:227],a[112:115]
s_waitcnt lgkmcnt(7)
buffer_load_dwordx2 v[212:213],v245,s[8:11],s28 offen offset:1152
M a[112:115],a[224:227],a[192:195],a[112:115]
s_waitcnt lgkmcnt(5)
s_add_u32 s29,s71,0
ds_read_b128 a[248:251],v248 offset:45568
v_lshlrev_b32 v232,16,v192
M a[116:119],a[224:227],a[228:231],a[116:119]
v_lshlrev_b32 v233,16,v194
v_lshlrev_b32 v237,16,v202
M a[116:119],a[220:223],a[192:195],a[116:119]
v_lshlrev_b32 v236,16,v200
v_lshlrev_b32 v235,16,v198
M a[116:119],v[220:223],v[224:227],a[116:119]
buffer_load_short_d16_hi v239,v246,s[12:15],s29 offen offset:0
M a[120:123],v[220:223],a[192:195],a[120:123]
v_fmac_f32 v232,s43,v234
v_fmac_f32 v237,4.0,v233
M a[120:123],a[220:223],a[228:231],a[120:123]
s_waitcnt lgkmcnt(1)
buffer_load_short_d16_hi v240,v246,s[8:11],s29 offen offset:0
M a[120:123],a[224:227],a[216:219],a[120:123]
s_waitcnt lgkmcnt(0)
v_fma_f32 v238,-4.0,v234,v236
v_fmac_f32 v232,s45,v236
M a[124:127],a[224:227],a[248:251],a[124:127]
buffer_load_dwordx4 a[224:227],v250,s[20:23],s46 offen offset:1024 sc1
M a[124:127],a[220:223],a[216:219],a[124:127]
v_fmac_f32 v237,s41,v235
v_sub_f32 v236,v236,v234
M a[124:127],v[220:223],a[228:231],a[124:127]
s_waitcnt vmcnt(15)
v_fma_f32 v234,-4.0,v233,v235
v_sub_f32 v235,v235,v233
M a[128:131],v[216:219],a[204:207],a[128:131]
s_waitcnt vmcnt(14)
v_add_f32 v233,v238,v234
v_sub_f32 v238,v238,v234
M a[128:131],a[240:243],a[236:239],a[128:131]
s_waitcnt vmcnt(13)
buffer_load_dwordx4 a[220:223],v250,s[20:23],s46 offen offset:2048 sc1
M a[128:131],a[244:247],a[252:255],a[128:131]
s_add_u32 s47,s75,30720
v_fma_f32 v234,2.0,v235,v236
v_fmac_f32 v236,-2.0,v235
M a[132:135],a[244:247],a[196:199],a[132:135]
v_and_b32 v196,s42,v196
v_and_b32 v192,s42,v192
M a[132:135],a[240:243],a[252:255],a[132:135]
v_and_b32 v194,s42,v194
v_and_b32 v202,s42,v202
M a[132:135],v[216:219],a[236:239],a[132:135]
buffer_load_dwordx4 v[220:223],v250,s[20:23],s47 offen offset:0 sc1
M a[136:139],v[216:219],a[252:255],a[136:139]
v_and_b32 v200,s42,v200
v_and_b32 v198,s42,v198
M a[136:139],a[240:243],a[196:199],a[136:139]
v_fmac_f32 v192,s43,v196
v_fmac_f32 v202,4.0,v194
M a[136:139],a[244:247],a[200:203],a[136:139]
v_fma_f32 v235,-4.0,v196,v200
v_fmac_f32 v192,s45,v200
M a[140:143],a[244:247],v[224:227],a[140:143]
buffer_load_short_d16_hi v241,v246,s[8:11],s29 offen offset:384
M a[140:143],a[240:243],a[200:203],a[140:143]
v_fmac_f32 v202,s41,v198
v_sub_f32 v200,v200,v196
M a[140:143],v[216:219],a[196:199],a[140:143]
buffer_load_short_d16_hi v242,v246,s[8:11],s29 offen offset:768
M a[144:147],v[216:219],a[200:203],a[144:147]
v_fma_f32 v196,-4.0,v194,v198
v_sub_f32 v198,v198,v194
M a[144:147],a[240:243],v[224:227],a[144:147]
buffer_load_short_d16_hi v243,v246,s[8:11],s29 offen offset:1152
M a[144:147],a[244:247],a[192:195],a[144:147]
v_add_f32 v194,v235,v196
v_sub_f32 v235,v235,v196
M a[148:151],a[244:247],a[228:231],a[148:151]
buffer_load_short_d16_hi v244,v246,s[16:19],s29 offen offset:1536
M a[148:151],a[240:243],a[192:195],a[148:151]
v_fma_f32 v196,2.0,v198,v200
v_fmac_f32 v200,-2.0,v198
M a[148:151],v[216:219],v[224:227],a[148:151]
v_cvt_pk_bf16_f32 v192,v232,v192
v_cvt_pk_bf16_f32 v202,v237,v202
M a[152:155],v[216:219],a[192:195],a[152:155]
v_cvt_pk_bf16_f32 v194,v233,v194
v_cvt_pk_bf16_f32 v198,v234,v196
M a[152:155],a[240:243],a[228:231],a[152:155]
v_cvt_pk_bf16_f32 v196,v238,v235
v_cvt_pk_bf16_f32 v200,v236,v200
M a[152:155],a[244:247],a[216:219],a[152:155]
v_lshlrev_b32 v234,16,v197
v_lshlrev_b32 v232,16,v193
M a[156:159],a[244:247],a[248:251],a[156:159]
buffer_load_dwordx4 a[244:247],v250,s[20:23],s47 offen offset:1024 sc1
M a[156:159],a[240:243],a[216:219],a[156:159]
v_lshlrev_b32 v233,16,v195
v_lshlrev_b32 v237,16,v203
M a[156:159],v[216:219],a[228:231],a[156:159]
s_waitcnt vmcnt(19)
buffer_load_dwordx4 a[240:243],v250,s[20:23],s47 offen offset:2048 sc1
M a[160:163],v[228:231],a[204:207],a[160:163]
s_waitcnt vmcnt(19)
s_add_u32 s48,s75,33792
v_lshlrev_b32 v236,16,v201
v_lshlrev_b32 v235,16,v199
M a[160:163],a[212:215],a[236:239],a[160:163]
s_waitcnt vmcnt(18)
v_fmac_f32 v232,s43,v234
v_fmac_f32 v237,4.0,v233
M a[160:163],a[208:211],a[252:255],a[160:163]
v_fma_f32 v238,-4.0,v234,v236
v_fmac_f32 v232,s45,v236
M a[164:167],a[208:211],a[196:199],a[164:167]
buffer_load_dwordx4 v[216:219],v250,s[20:23],s48 offen offset:0 sc1
M a[164:167],a[212:215],a[252:255],a[164:167]
v_fmac_f32 v237,s41,v235
v_sub_f32 v236,v236,v234
M a[164:167],v[228:231],a[236:239],a[164:167]
v_fma_f32 v234,-4.0,v233,v235
v_sub_f32 v235,v235,v233
M a[168:171],v[228:231],a[252:255],a[168:171]
v_add_f32 v233,v238,v234
v_sub_f32 v238,v238,v234
M a[168:171],a[212:215],a[196:199],a[168:171]
buffer_load_dwordx4 a[204:207],v250,s[20:23],s48 offen offset:1024 sc1
M a[168:171],a[208:211],a[200:203],a[168:171]
v_fma_f32 v234,2.0,v235,v236
v_fmac_f32 v236,-2.0,v235
M a[172:175],a[208:211],v[224:227],a[172:175]
v_and_b32 v197,s42,v197
v_and_b32 v193,s42,v193
M a[172:175],a[212:215],a[200:203],a[172:175]
v_and_b32 v195,s42,v195
v_and_b32 v203,s42,v203
M a[172:175],v[228:231],a[196:199],a[172:175]
buffer_load_dwordx4 a[236:239],v250,s[20:23],s48 offen offset:2048 sc1
M a[176:179],v[228:231],a[200:203],a[176:179]
s_add_u32 s46,s75,36864
v_and_b32 v201,s42,v201
v_and_b32 v199,s42,v199
M a[176:179],a[212:215],v[224:227],a[176:179]
v_fmac_f32 v193,s43,v197
v_fmac_f32 v203,4.0,v195
M a[176:179],a[208:211],a[192:195],a[176:179]
v_fma_f32 v235,-4.0,v197,v201
v_fmac_f32 v193,s45,v201
M a[180:183],a[208:211],a[228:231],a[180:183]
buffer_load_dwordx4 a[252:255],v250,s[20:23],s46 offen offset:0 sc1
M a[180:183],a[212:215],a[192:195],a[180:183]
ds_read_b128 a[196:199],v248 offset:52224
v_fmac_f32 v203,s41,v199
M a[180:183],v[228:231],v[224:227],a[180:183]
ds_read_b128 a[200:203],v249 offset:52224
v_sub_f32 v201,v201,v197
M a[184:187],v[228:231],a[192:195],a[184:187]
ds_read_b128 v[224:227],v248 offset:52736
v_fma_f32 v197,-4.0,v195,v199
M a[184:187],a[212:215],a[228:231],a[184:187]
ds_read_b128 a[192:195],v249 offset:52736
v_sub_f32 v199,v199,v195
M a[184:187],a[208:211],a[216:219],a[184:187]
v_add_f32 v195,v235,v197
v_sub_f32 v235,v235,v197
M a[188:191],a[208:211],a[248:251],a[188:191]
v_fma_f32 v197,2.0,v199,v201
v_fmac_f32 v201,-2.0,v199
M a[188:191],a[212:215],a[216:219],a[188:191]
v_cvt_pk_bf16_f32 v193,v232,v193
v_cvt_pk_bf16_f32 v203,v237,v203
M a[188:191],v[228:231],a[228:231],a[188:191]
s_waitcnt vmcnt(21) lgkmcnt(3)
v_cvt_pk_bf16_f32 v195,v233,v195
v_cvt_pk_bf16_f32 v199,v234,v197
M v[0:3],a[232:235],a[196:199],v[0:3]
s_waitcnt vmcnt(12) lgkmcnt(2)
ds_read_b128 a[208:211],v248 offset:53248
v_cvt_pk_bf16_f32 v197,v238,v235
M v[0:3],a[224:227],a[200:203],v[0:3]
s_waitcnt vmcnt(11) lgkmcnt(2)
ds_read_b128 a[248:251],v249 offset:53248
v_cvt_pk_bf16_f32 v201,v236,v201
M v[0:3],a[220:223],v[224:227],v[0:3]
s_waitcnt lgkmcnt(2)
v_add_u32 v238,139264,v247
v_lshlrev_b32 v234,16,v208
M v[4:7],a[220:223],a[192:195],v[4:7]
v_lshlrev_b32 v232,16,v204
v_lshlrev_b32 v233,16,v206
M v[4:7],a[224:227],v[224:227],v[4:7]
v_lshlrev_b32 v237,16,v214
v_lshlrev_b32 v236,16,v212
M v[4:7],a[232:235],a[200:203],v[4:7]
ds_write2st64_b64 v238,v[192:193],v[202:203] offset0:2 offset1:19
M v[8:11],a[232:235],v[224:227],v[8:11]
s_add_u32 s28,s71,0
buffer_load_dwordx2 v[192:193],v251,s[12:15],s28 offen offset:0
M v[8:11],a[224:227],a[192:195],v[8:11]
s_waitcnt lgkmcnt(2)
ds_read_b128 a[212:215],v248 offset:53760
ds_read_b128 a[216:219],v249 offset:53760
M v[8:11],a[220:223],a[208:211],v[8:11]
s_waitcnt lgkmcnt(3)
buffer_load_dwordx2 v[202:203],v251,s[16:19],s28 offen offset:1536
M v[12:15],a[220:223],a[248:251],v[12:15]
v_lshlrev_b32 v235,16,v210
v_fmac_f32 v232,s43,v234
M v[12:15],a[224:227],a[208:211],v[12:15]
v_fmac_f32 v237,4.0,v233
v_fma_f32 v238,-4.0,v234,v236
M v[12:15],a[232:235],a[192:195],v[12:15]
ds_write2st64_b64 v247,v[194:195],v[196:197] offset0:36 offset1:53
M v[16:19],a[232:235],a[208:211],v[16:19]
buffer_load_dwordx2 v[194:195],v251,s[8:11],s28 offen offset:0
M v[16:19],a[224:227],a[248:251],v[16:19]
s_waitcnt lgkmcnt(2)
ds_read_b128 a[228:231],v249 offset:54272
ds_read_b128 v[228:231],v248 offset:54272
M v[16:19],a[220:223],a[212:215],v[16:19]
s_waitcnt lgkmcnt(3)
ds_write2st64_b64 v247,v[198:199],v[200:201] offset0:70 offset1:87
M v[20:23],a[220:223],a[216:219],v[20:23]
buffer_load_dwordx2 v[196:197],v251,s[8:11],s28 offen offset:384
M v[20:23],a[224:227],a[212:215],v[20:23]
v_fmac_f32 v232,s45,v236
v_fmac_f32 v237,s41,v235
M v[20:23],a[232:235],a[248:251],v[20:23]
v_sub_f32 v236,v236,v234
v_fma_f32 v234,-4.0,v233,v235
M v[24:27],a[232:235],a[212:215],v[24:27]
v_sub_f32 v235,v235,v233
v_add_f32 v233,v238,v234
M v[24:27],a[224:227],a[216:219],v[24:27]
s_waitcnt lgkmcnt(2)
buffer_load_dwordx2 v[198:199],v251,s[8:11],s28 offen offset:768
M v[24:27],a[220:223],a[228:231],v[24:27]
s_waitcnt lgkmcnt(1)
v_sub_f32 v238,v238,v234
v_fma_f32 v234,2.0,v235,v236
M v[28:31],a[220:223],v[228:231],v[28:31]
v_fmac_f32 v236,-2.0,v235
v_and_b32 v208,s42,v208
M v[28:31],a[224:227],a[228:231],v[28:31]
v_and_b32 v204,s42,v204
v_and_b32 v206,s42,v206
M v[28:31],a[232:235],a[216:219],v[28:31]
s_waitcnt vmcnt(15)
buffer_load_dwordx2 v[200:201],v251,s[8:11],s28 offen offset:1152
M v[32:35],v[220:223],a[196:199],v[32:35]
s_waitcnt vmcnt(11)
v_and_b32 v214,s42,v214
v_and_b32 v212,s42,v212
M v[32:35],a[244:247],a[200:203],v[32:35]
s_waitcnt vmcnt(10)
v_and_b32 v210,s42,v210
v_fmac_f32 v204,s43,v208
M v[32:35],a[240:243],v[224:227],v[32:35]
v_fmac_f32 v214,4.0,v206
v_fma_f32 v235,-4.0,v208,v212
M v[36:39],a[240:243],a[192:195],v[36:39]
global_load_dword a220,v250,s[64:65]
M v[36:39],a[244:247],v[224:227],v[36:39]
v_fmac_f32 v204,s45,v212
v_fmac_f32 v214,s41,v210
M v[36:39],v[220:223],a[200:203],v[36:39]
buffer_load_dwordx4 a[220:223],v250,s[20:23],s46 offen offset:1024 sc1
M v[40:43],v[220:223],v[224:227],v[40:43]
v_sub_f32 v212,v212,v208
v_fma_f32 v208,-4.0,v206,v210
M v[40:43],a[244:247],a[192:195],v[40:43]
v_sub_f32 v210,v210,v206
v_add_f32 v206,v235,v208
M v[40:43],a[240:243],a[208:211],v[40:43]
v_sub_f32 v235,v235,v208
v_fma_f32 v208,2.0,v210,v212
M v[44:47],a[240:243],a[248:251],v[44:47]
buffer_load_dwordx4 a[224:227],v250,s[20:23],s46 offen offset:2048 sc1
M v[44:47],a[244:247],a[208:211],v[44:47]
s_add_u32 s47,s75,39936
v_fmac_f32 v212,-2.0,v210
v_cvt_pk_bf16_f32 v204,v232,v204
M v[44:47],v[220:223],a[192:195],v[44:47]
v_cvt_pk_bf16_f32 v214,v237,v214
v_cvt_pk_bf16_f32 v206,v233,v206
M v[48:51],v[220:223],a[208:211],v[48:51]
v_cvt_pk_bf16_f32 v210,v234,v208
v_cvt_pk_bf16_f32 v208,v238,v235
M v[48:51],a[244:247],a[248:251],v[48:51]
buffer_load_dwordx4 a[232:235],v250,s[20:23],s47 offen offset:0 sc1
M v[48:51],a[240:243],a[212:215],v[48:51]
v_cvt_pk_bf16_f32 v212,v236,v212
v_lshlrev_b32 v234,16,v209
M v[52:55],a[240:243],a[216:219],v[52:55]
v_lshlrev_b32 v232,16,v205
v_lshlrev_b32 v233,16,v207
M v[52:55],a[244:247],a[212:215],v[52:55]
v_lshlrev_b32 v237,16,v215
v_lshlrev_b32 v236,16,v213
M v[52:55],v[220:223],a[248:251],v[52:55]
v_lshlrev_b32 v235,16,v211
v_fmac_f32 v232,s43,v234
M v[56:59],v[220:223],a[212:215],v[56:59]
v_fmac_f32 v237,4.0,v233
v_fma_f32 v238,-4.0,v234,v236
M v[56:59],a[244:247],a[216:219],v[56:59]
v_fmac_f32 v232,s45,v236
v_fmac_f32 v237,s41,v235
M v[56:59],a[240:243],a[228:231],v[56:59]
v_sub_f32 v236,v236,v234
v_fma_f32 v234,-4.0,v233,v235
M v[60:63],a[240:243],v[228:231],v[60:63]
buffer_load_dwordx4 a[240:243],v250,s[20:23],s47 offen offset:1024 sc1
M v[60:63],a[244:247],a[228:231],v[60:63]
v_sub_f32 v235,v235,v233
v_add_f32 v233,v238,v234
M v[60:63],v[220:223],a[216:219],v[60:63]
s_waitcnt vmcnt(14)
buffer_load_dwordx4 a[244:247],v250,s[20:23],s47 offen offset:2048 sc1
M v[64:67],v[216:219],a[196:199],v[64:67]
s_waitcnt vmcnt(14)
s_add_u32 s48,s75,43008
v_sub_f32 v238,v238,v234
v_fma_f32 v234,2.0,v235,v236
M v[64:67],a[204:207],a[200:203],v[64:67]
s_waitcnt vmcnt(13)
v_fmac_f32 v236,-2.0,v235
v_and_b32 v209,s42,v209
M v[64:67],a[236:239],v[224:227],v[64:67]
v_and_b32 v205,s42,v205
v_and_b32 v207,s42,v207
M v[68:71],a[236:239],a[192:195],v[68:71]
buffer_load_dwordx4 v[220:223],v250,s[20:23],s48 offen offset:0 sc1
M v[68:71],a[204:207],v[224:227],v[68:71]
v_and_b32 v215,s42,v215
v_and_b32 v213,s42,v213
M v[68:71],v[216:219],a[200:203],v[68:71]
v_and_b32 v211,s42,v211
v_fmac_f32 v205,s43,v209
M v[72:75],v[216:219],v[224:227],v[72:75]
v_fmac_f32 v215,4.0,v207
v_fma_f32 v235,-4.0,v209,v213
M v[72:75],a[204:207],a[192:195],v[72:75]
buffer_load_dwordx4 a[196:199],v250,s[20:23],s48 offen offset:1024 sc1
M v[72:75],a[236:239],a[208:211],v[72:75]
v_fmac_f32 v205,s45,v213
v_fmac_f32 v215,s41,v211
M v[76:79],a[236:239],a[248:251],v[76:79]
v_sub_f32 v213,v213,v209
v_fma_f32 v209,-4.0,v207,v211
M v[76:79],a[204:207],a[208:211],v[76:79]
v_sub_f32 v211,v211,v207
v_add_f32 v207,v235,v209
M v[76:79],v[216:219],a[192:195],v[76:79]
buffer_load_dwordx4 a[200:203],v250,s[20:23],s48 offen offset:2048 sc1
M v[80:83],v[216:219],a[208:211],v[80:83]
s_add_u32 s46,s76,9216
v_sub_f32 v235,v235,v209
v_fma_f32 v209,2.0,v211,v213
M v[80:83],a[204:207],a[248:251],v[80:83]
v_fmac_f32 v213,-2.0,v211
v_cvt_pk_bf16_f32 v205,v232,v205
M v[80:83],a[236:239],a[212:215],v[80:83]
v_cvt_pk_bf16_f32 v215,v237,v215
v_cvt_pk_bf16_f32 v207,v233,v207
M v[84:87],a[236:239],a[216:219],v[84:87]
buffer_load_dwordx4 v[224:227],v250,s[20:23],s46 offen offset:0 sc1
M v[84:87],a[204:207],a[212:215],v[84:87]
ds_read_b128 a[192:195],v248 offset:60928
v_cvt_pk_bf16_f32 v211,v234,v209
M v[84:87],v[216:219],a[248:251],v[84:87]
ds_read_b128 a[208:211],v249 offset:60928
v_cvt_pk_bf16_f32 v209,v238,v235
M v[88:91],v[216:219],a[212:215],v[88:91]
ds_read_b128 a[248:251],v248 offset:61440
v_cvt_pk_bf16_f32 v213,v236,v213
M v[88:91],a[204:207],a[216:219],v[88:91]
ds_read_b128 a[212:215],v249 offset:61440
v_add_u32 v238,139264,v247
M v[88:91],a[236:239],a[228:231],v[88:91]
ds_write2st64_b64 v238,v[204:205],v[214:215] offset0:3 offset1:20
M v[92:95],a[236:239],v[228:231],v[92:95]
s_add_u32 s28,s71,393216
buffer_load_dwordx2 v[204:205],v245,s[12:15],s28 offen offset:0
M v[92:95],a[204:207],a[228:231],v[92:95]
s_waitcnt vmcnt(13)
v_lshlrev_b32 v234,16,v196
v_lshlrev_b32 v232,16,v192
M v[92:95],v[216:219],a[216:219],v[92:95]
s_waitcnt lgkmcnt(4)
buffer_load_dwordx2 v[214:215],v245,s[16:19],s28 offen offset:1536
M v[96:99],a[252:255],a[192:195],v[96:99]
s_waitcnt vmcnt(10) lgkmcnt(3)
ds_read_b128 a[236:239],v248 offset:61952
v_lshlrev_b32 v233,16,v194
M v[96:99],a[220:223],a[208:211],v[96:99]
s_waitcnt vmcnt(9) lgkmcnt(3)
ds_read_b128 v[228:231],v249 offset:61952
v_lshlrev_b32 v237,16,v202
M v[96:99],a[224:227],a[248:251],v[96:99]
s_waitcnt lgkmcnt(3)
ds_write2st64_b64 v247,v[206:207],v[208:209] offset0:37 offset1:54
M v[100:103],a[224:227],a[212:215],v[100:103]
buffer_load_dwordx2 v[206:207],v245,s[8:11],s28 offen offset:0
M v[100:103],a[220:223],a[248:251],v[100:103]
v_lshlrev_b32 v236,16,v200
v_lshlrev_b32 v235,16,v198
M v[100:103],a[252:255],a[208:211],v[100:103]
ds_write2st64_b64 v247,v[210:211],v[212:213] offset0:71 offset1:88
M v[104:107],a[252:255],a[248:251],v[104:107]
buffer_load_dwordx2 v[208:209],v245,s[8:11],s28 offen offset:384
M v[104:107],a[220:223],a[212:215],v[104:107]
s_waitcnt lgkmcnt(3)
ds_read_b128 a[204:207],v248 offset:62464
ds_read_b128 a[228:231],v249 offset:62464
M v[104:107],a[224:227],a[236:239],v[104:107]
s_waitcnt lgkmcnt(4)
v_fmac_f32 v232,s43,v234
v_fmac_f32 v237,4.0,v233
M v[108:111],a[224:227],v[228:231],v[108:111]
v_fma_f32 v238,-4.0,v234,v236
v_fmac_f32 v232,s45,v236
M v[108:111],a[220:223],a[236:239],v[108:111]
buffer_load_dwordx2 v[210:211],v245,s[8:11],s28 offen offset:768
M v[108:111],a[252:255],a[212:215],v[108:111]
v_fmac_f32 v237,s41,v235
v_sub_f32 v236,v236,v234
M v[112:115],a[252:255],a[236:239],v[112:115]
ds_read_b128 a[216:219],v249 offset:62976
v_fma_f32 v234,-4.0,v233,v235
M v[112:115],a[220:223],v[228:231],v[112:115]
s_waitcnt lgkmcnt(2)
ds_read_b128 v[216:219],v248 offset:62976
v_sub_f32 v235,v235,v233
M v[112:115],a[224:227],a[204:207],v[112:115]
s_waitcnt lgkmcnt(2)
buffer_load_dwordx2 v[212:213],v245,s[8:11],s28 offen offset:1152
M v[116:119],a[224:227],a[228:231],v[116:119]
v_add_f32 v233,v238,v234
v_sub_f32 v238,v238,v234
M v[116:119],a[220:223],a[204:207],v[116:119]
v_fma_f32 v234,2.0,v235,v236
v_fmac_f32 v236,-2.0,v235
M v[116:119],a[252:255],v[228:231],v[116:119]
v_and_b32 v196,s42,v196
v_and_b32 v192,s42,v192
M v[120:123],a[252:255],a[204:207],v[120:123]
v_and_b32 v194,s42,v194
v_and_b32 v202,s42,v202
M v[120:123],a[220:223],a[228:231],v[120:123]
s_waitcnt lgkmcnt(1)
v_and_b32 v200,s42,v200
v_and_b32 v198,s42,v198
M v[120:123],a[224:227],a[216:219],v[120:123]
s_waitcnt lgkmcnt(0)
v_fmac_f32 v192,s43,v196
v_fmac_f32 v202,4.0,v194
M v[124:127],a[224:227],v[216:219],v[124:127]
buffer_load_dwordx4 a[224:227],v250,s[20:23],s46 offen offset:1024 sc1
M v[124:127],a[220:223],a[216:219],v[124:127]
v_fma_f32 v235,-4.0,v196,v200
v_fmac_f32 v192,s45,v200
M v[124:127],a[252:255],a[228:231],v[124:127]
s_waitcnt vmcnt(13)
buffer_load_dwordx4 a[220:223],v250,s[20:23],s46 offen offset:2048 sc1
M v[128:131],a[232:235],a[192:195],v[128:131]
s_waitcnt vmcnt(13)
s_add_u32 s47,s76,12288
v_fmac_f32 v202,s41,v198
v_sub_f32 v200,v200,v196
M v[128:131],a[240:243],a[208:211],v[128:131]
s_waitcnt vmcnt(12)
v_fma_f32 v196,-4.0,v194,v198
v_sub_f32 v198,v198,v194
M v[128:131],a[244:247],a[248:251],v[128:131]
v_add_f32 v194,v235,v196
v_sub_f32 v235,v235,v196
M v[132:135],a[244:247],a[212:215],v[132:135]
buffer_load_dwordx4 a[252:255],v250,s[20:23],s47 offen offset:0 sc1
M v[132:135],a[240:243],a[248:251],v[132:135]
v_fma_f32 v196,2.0,v198,v200
v_fmac_f32 v200,-2.0,v198
M v[132:135],a[232:235],a[208:211],v[132:135]
v_cvt_pk_bf16_f32 v192,v232,v192
v_cvt_pk_bf16_f32 v202,v237,v202
M v[136:139],a[232:235],a[248:251],v[136:139]
v_cvt_pk_bf16_f32 v194,v233,v194
v_cvt_pk_bf16_f32 v198,v234,v196
M v[136:139],a[240:243],a[212:215],v[136:139]
v_cvt_pk_bf16_f32 v196,v238,v235
v_cvt_pk_bf16_f32 v200,v236,v200
M v[136:139],a[244:247],a[236:239],v[136:139]
v_lshlrev_b32 v234,16,v197
v_lshlrev_b32 v232,16,v193
M v[140:143],a[244:247],v[228:231],v[140:143]
v_lshlrev_b32 v233,16,v195
v_lshlrev_b32 v237,16,v203
M v[140:143],a[240:243],a[236:239],v[140:143]
v_lshlrev_b32 v236,16,v201
v_lshlrev_b32 v235,16,v199
M v[140:143],a[232:235],a[212:215],v[140:143]
v_fmac_f32 v232,s43,v234
v_fmac_f32 v237,4.0,v233
M v[144:147],a[232:235],a[236:239],v[144:147]
v_fma_f32 v238,-4.0,v234,v236
v_fmac_f32 v232,s45,v236
M v[144:147],a[240:243],v[228:231],v[144:147]
v_fmac_f32 v237,s41,v235
v_sub_f32 v236,v236,v234
M v[144:147],a[244:247],a[204:207],v[144:147]
v_fma_f32 v234,-4.0,v233,v235
v_sub_f32 v235,v235,v233
M v[148:151],a[244:247],a[228:231],v[148:151]
v_add_f32 v233,v238,v234
v_sub_f32 v238,v238,v234
M v[148:151],a[240:243],a[204:207],v[148:151]
v_fma_f32 v234,2.0,v235,v236
v_fmac_f32 v236,-2.0,v235
M v[148:151],a[232:235],v[228:231],v[148:151]
v_and_b32 v197,s42,v197
v_and_b32 v193,s42,v193
M v[152:155],a[232:235],a[204:207],v[152:155]
v_and_b32 v195,s42,v195
v_and_b32 v203,s42,v203
M v[152:155],a[240:243],a[228:231],v[152:155]
v_and_b32 v201,s42,v201
v_and_b32 v199,s42,v199
M v[152:155],a[244:247],a[216:219],v[152:155]
v_fmac_f32 v193,s43,v197
v_fmac_f32 v203,4.0,v195
M v[156:159],a[244:247],v[216:219],v[156:159]
buffer_load_dwordx4 a[244:247],v250,s[20:23],s47 offen offset:1024 sc1
M v[156:159],a[240:243],a[216:219],v[156:159]
v_fma_f32 v235,-4.0,v197,v201
v_fmac_f32 v193,s45,v201
M v[156:159],a[232:235],a[228:231],v[156:159]
s_waitcnt vmcnt(13)
buffer_load_dwordx4 a[240:243],v250,s[20:23],s47 offen offset:2048 sc1
M v[160:163],v[220:223],a[192:195],v[160:163]
s_waitcnt vmcnt(13)
s_add_u32 s48,s76,15360
v_fmac_f32 v203,s41,v199
v_sub_f32 v201,v201,v197
M v[160:163],a[196:199],a[208:211],v[160:163]
s_waitcnt vmcnt(12)
v_fma_f32 v197,-4.0,v195,v199
v_sub_f32 v199,v199,v195
M v[160:163],a[200:203],a[248:251],v[160:163]
v_add_f32 v195,v235,v197
v_sub_f32 v235,v235,v197
M v[164:167],a[200:203],a[212:215],v[164:167]
buffer_load_dwordx4 a[232:235],v250,s[20:23],s48 offen offset:0 sc1
M v[164:167],a[196:199],a[248:251],v[164:167]
v_fma_f32 v197,2.0,v199,v201
v_fmac_f32 v201,-2.0,v199
M v[164:167],v[220:223],a[208:211],v[164:167]
v_cvt_pk_bf16_f32 v193,v232,v193
v_cvt_pk_bf16_f32 v203,v237,v203
M v[168:171],v[220:223],a[248:251],v[168:171]
v_cvt_pk_bf16_f32 v195,v233,v195
v_cvt_pk_bf16_f32 v199,v234,v197
M v[168:171],a[196:199],a[212:215],v[168:171]
buffer_load_dwordx4 a[192:195],v250,s[20:23],s48 offen offset:1024 sc1
M v[168:171],a[200:203],a[236:239],v[168:171]
v_cvt_pk_bf16_f32 v197,v238,v235
v_cvt_pk_bf16_f32 v201,v236,v201
M v[172:175],a[200:203],v[228:231],v[172:175]
s_waitcnt vmcnt(9)
v_lshlrev_b32 v234,16,v208
v_lshlrev_b32 v232,16,v204
M v[172:175],a[196:199],a[236:239],v[172:175]
v_lshlrev_b32 v233,16,v206
v_lshlrev_b32 v237,16,v214
M v[172:175],v[220:223],a[212:215],v[172:175]
buffer_load_dwordx4 a[208:211],v250,s[20:23],s48 offen offset:2048 sc1
M v[176:179],v[220:223],a[236:239],v[176:179]
s_waitcnt vmcnt(8)
s_add_u32 s46,s76,18432
v_lshlrev_b32 v236,16,v212
v_lshlrev_b32 v235,16,v210
M v[176:179],a[196:199],v[228:231],v[176:179]
v_fmac_f32 v232,s43,v234
v_fmac_f32 v237,4.0,v233
M v[176:179],a[200:203],a[204:207],v[176:179]
s_barrier
v_fma_f32 v238,-4.0,v234,v236
M v[180:183],a[200:203],a[228:231],v[180:183]
buffer_load_dwordx4 a[248:251],v250,s[20:23],s46 offen offset:0 sc1
M v[180:183],a[196:199],a[204:207],v[180:183]
ds_read_b128 a[212:215],v248 offset:0
v_fmac_f32 v232,s45,v236
M v[180:183],v[220:223],v[228:231],v[180:183]
ds_write2st64_b64 v247,v[192:193],v[202:203] offset0:136 offset1:153
M v[184:187],v[220:223],a[204:207],v[184:187]
s_add_u32 s28,s71,786432
ds_read_b128 a[236:239],v249 offset:0
ds_read_b128 v[228:231],v248 offset:512
M v[184:187],a[196:199],a[228:231],v[184:187]
buffer_load_dwordx2 v[192:193],v245,s[12:15],s28 offen offset:0
M v[184:187],a[200:203],a[216:219],v[184:187]
ds_write2st64_b64 v247,v[194:195],v[196:197] offset0:102 offset1:119
M v[188:191],a[200:203],v[216:219],v[188:191]
ds_read_b128 a[204:207],v249 offset:512
v_fmac_f32 v237,s41,v235
M v[188:191],a[196:199],a[216:219],v[188:191]
buffer_load_dwordx2 v[202:203],v245,s[16:19],s28 offen offset:1536
M v[188:191],v[220:223],a[228:231],v[188:191]
s_waitcnt lgkmcnt(5)
v_sub_f32 v236,v236,v234
v_fma_f32 v234,-4.0,v233,v235
M a[0:3],v[224:227],a[212:215],a[0:3]
s_waitcnt vmcnt(10) lgkmcnt(3)
ds_read_b128 a[200:203],v248 offset:1024
v_sub_f32 v235,v235,v233
M a[0:3],a[224:227],a[236:239],a[0:3]
s_waitcnt vmcnt(9) lgkmcnt(3)
ds_read_b128 v[216:219],v249 offset:1024
v_add_f32 v233,v238,v234
M a[0:3],a[220:223],v[228:231],a[0:3]
s_waitcnt lgkmcnt(2)
buffer_load_dwordx2 v[194:195],v245,s[8:11],s28 offen offset:0
M a[4:7],a[220:223],a[204:207],a[4:7]
v_sub_f32 v238,v238,v234
v_fma_f32 v234,2.0,v235,v236
M a[4:7],a[224:227],v[228:231],a[4:7]
v_fmac_f32 v236,-2.0,v235
v_and_b32 v208,s42,v208
M a[4:7],v[224:227],a[236:239],a[4:7]
v_and_b32 v204,s42,v204
v_and_b32 v206,s42,v206
M a[8:11],v[224:227],v[228:231],a[8:11]
buffer_load_dwordx2 v[196:197],v245,s[8:11],s28 offen offset:384
M a[8:11],a[224:227],a[204:207],a[8:11]
s_waitcnt lgkmcnt(1)
ds_read_b128 a[196:199],v248 offset:1536
ds_read_b128 a[216:219],v249 offset:1536
M a[8:11],a[220:223],a[200:203],a[8:11]
s_waitcnt lgkmcnt(2)
v_and_b32 v214,s42,v214
v_and_b32 v212,s42,v212
M a[12:15],a[220:223],v[216:219],a[12:15]
v_and_b32 v210,s42,v210
v_fmac_f32 v204,s43,v208
M a[12:15],a[224:227],a[200:203],a[12:15]
v_fmac_f32 v214,4.0,v206
v_fma_f32 v235,-4.0,v208,v212
M a[12:15],v[224:227],a[204:207],a[12:15]
v_fmac_f32 v204,s45,v212
v_fmac_f32 v214,s41,v210
M a[16:19],v[224:227],a[200:203],a[16:19]
ds_read_b128 a[228:231],v249 offset:2048
v_sub_f32 v212,v212,v208
M a[16:19],a[224:227],v[216:219],a[16:19]
s_waitcnt lgkmcnt(2)
ds_read_b128 v[220:223],v248 offset:2048
v_fma_f32 v208,-4.0,v206,v210
M a[16:19],a[220:223],a[196:199],a[16:19]
s_waitcnt lgkmcnt(2)
v_sub_f32 v210,v210,v206
v_add_f32 v206,v235,v208
M a[20:23],a[220:223],a[216:219],a[20:23]
v_sub_f32 v235,v235,v208
v_fma_f32 v208,2.0,v210,v212
M a[20:23],a[224:227],a[196:199],a[20:23]
v_fmac_f32 v212,-2.0,v210
v_cvt_pk_bf16_f32 v204,v232,v204
M a[20:23],v[224:227],v[216:219],a[20:23]
v_cvt_pk_bf16_f32 v214,v237,v214
v_cvt_pk_bf16_f32 v206,v233,v206
M a[24:27],v[224:227],a[196:199],a[24:27]
v_cvt_pk_bf16_f32 v210,v234,v208
v_cvt_pk_bf16_f32 v208,v238,v235
M a[24:27],a[224:227],a[216:219],a[24:27]
s_waitcnt lgkmcnt(1)
v_cvt_pk_bf16_f32 v212,v236,v212
v_lshlrev_b32 v234,16,v209
M a[24:27],a[220:223],a[228:231],a[24:27]
s_waitcnt lgkmcnt(0)
v_lshlrev_b32 v232,16,v205
v_lshlrev_b32 v233,16,v207
M a[28:31],a[220:223],v[220:223],a[28:31]
buffer_load_dwordx4 a[220:223],v250,s[20:23],s46 offen offset:1024 sc1
M a[28:31],a[224:227],a[228:231],a[28:31]
v_lshlrev_b32 v237,16,v215
v_lshlrev_b32 v236,16,v213
M a[28:31],v[224:227],a[216:219],a[28:31]
s_waitcnt vmcnt(11)
buffer_load_dwordx4 a[224:227],v250,s[20:23],s46 offen offset:2048 sc1
M a[32:35],a[252:255],a[212:215],a[32:35]
s_waitcnt vmcnt(11)
s_add_u32 s47,s76,21504
v_lshlrev_b32 v235,16,v211
v_fmac_f32 v232,s43,v234
M a[32:35],a[244:247],a[236:239],a[32:35]
s_waitcnt vmcnt(10)
v_fmac_f32 v237,4.0,v233
v_fma_f32 v238,-4.0,v234,v236
M a[32:35],a[240:243],v[228:231],a[32:35]
v_fmac_f32 v232,s45,v236
v_fmac_f32 v237,s41,v235
M a[36:39],a[240:243],a[204:207],a[36:39]
buffer_load_dwordx4 v[224:227],v250,s[20:23],s47 offen offset:0 sc1
M a[36:39],a[244:247],v[228:231],a[36:39]
v_sub_f32 v236,v236,v234
v_fma_f32 v234,-4.0,v233,v235
M a[36:39],a[252:255],a[236:239],a[36:39]
v_sub_f32 v235,v235,v233
v_add_f32 v233,v238,v234
M a[40:43],a[252:255],v[228:231],a[40:43]
v_sub_f32 v238,v238,v234
v_fma_f32 v234,2.0,v235,v236
M a[40:43],a[244:247],a[204:207],a[40:43]
v_fmac_f32 v236,-2.0,v235
v_and_b32 v209,s42,v209
M a[40:43],a[240:243],a[200:203],a[40:43]
v_and_b32 v205,s42,v205
v_and_b32 v207,s42,v207
M a[44:47],a[240:243],v[216:219],a[44:47]
v_and_b32 v215,s42,v215
v_and_b32 v213,s42,v213
M a[44:47],a[244:247],a[200:203],a[44:47]
v_and_b32 v211,s42,v211
v_fmac_f32 v205,s43,v209
M a[44:47],a[252:255],a[204:207],a[44:47]
v_fmac_f32 v215,4.0,v207
v_fma_f32 v235,-4.0,v209,v213
M a[48:51],a[252:255],a[200:203],a[48:51]
v_fmac_f32 v205,s45,v213
v_fmac_f32 v215,s41,v211
M a[48:51],a[244:247],v[216:219],a[48:51]
v_sub_f32 v213,v213,v209
v_fma_f32 v209,-4.0,v207,v211
M a[48:51],a[240:243],a[196:199],a[48:51]
v_sub_f32 v211,v211,v207
v_add_f32 v207,v235,v209
M a[52:55],a[240:243],a[216:219],a[52:55]
v_sub_f32 v235,v235,v209
v_fma_f32 v209,2.0,v211,v213
M a[52:55],a[244:247],a[196:199],a[52:55]
v_fmac_f32 v213,-2.0,v211
v_cvt_pk_bf16_f32 v205,v232,v205
M a[52:55],a[252:255],v[216:219],a[52:55]
v_cvt_pk_bf16_f32 v215,v237,v215
v_cvt_pk_bf16_f32 v207,v233,v207
M a[56:59],a[252:255],a[196:199],a[56:59]
v_cvt_pk_bf16_f32 v211,v234,v209
v_cvt_pk_bf16_f32 v209,v238,v235
M a[56:59],a[244:247],a[216:219],a[56:59]
v_cvt_pk_bf16_f32 v213,v236,v213
v_fmac_f32 v239,s43,v241
M a[56:59],a[240:243],a[228:231],a[56:59]
v_fmac_f32 v244,4.0,v240
v_fma_f32 v232,-4.0,v241,v243
M a[60:63],a[240:243],v[220:223],a[60:63]
buffer_load_dwordx4 a[240:243],v250,s[20:23],s47 offen offset:1024 sc1
M a[60:63],a[244:247],a[228:231],a[60:63]
v_fmac_f32 v239,s45,v243
v_fmac_f32 v244,s41,v242
M a[60:63],a[252:255],a[216:219],a[60:63]
s_waitcnt vmcnt(11)
buffer_load_dwordx4 a[244:247],v250,s[20:23],s47 offen offset:2048 sc1
M a[64:67],a[232:235],a[212:215],a[64:67]
s_waitcnt vmcnt(11)
s_add_u32 s48,s76,24576
v_sub_f32 v243,v243,v241
v_fma_f32 v241,-4.0,v240,v242
M a[64:67],a[192:195],a[236:239],a[64:67]
s_waitcnt vmcnt(10)
v_sub_f32 v242,v242,v240
v_add_f32 v240,v232,v241
M a[64:67],a[208:211],v[228:231],a[64:67]
v_sub_f32 v232,v232,v241
v_fma_f32 v241,2.0,v242,v243
M a[68:71],a[208:211],a[204:207],a[68:71]
buffer_load_dwordx4 a[252:255],v250,s[20:23],s48 offen offset:0 sc1
M a[68:71],a[192:195],v[228:231],a[68:71]
v_fmac_f32 v243,-2.0,v242
v_cvt_pk_bf16_f32 v233,v239,v244
M a[68:71],a[232:235],a[236:239],a[68:71]
v_cvt_pk_bf16_f32 v234,v240,v232
v_cvt_pk_bf16_f32 v235,v241,v243
M a[72:75],a[232:235],v[228:231],a[72:75]
v_add_u32 v232,69632,v252
M a[72:75],a[192:195],a[204:207],a[72:75]
buffer_load_dwordx4 a[212:215],v250,s[20:23],s48 offen offset:1024 sc1
M a[72:75],a[208:211],a[200:203],a[72:75]
ds_write_b16 v232,v233 offset:0
M a[76:79],a[208:211],v[216:219],a[76:79]
ds_write_b16_d16_hi v232,v233 offset:8704
M a[76:79],a[192:195],a[200:203],a[76:79]
ds_write_b16 v252,v234 offset:52224
M a[76:79],a[232:235],a[204:207],a[76:79]
buffer_load_dwordx4 a[236:239],v250,s[20:23],s48 offen offset:2048 sc1
M a[80:83],a[232:235],a[200:203],a[80:83]
s_add_u32 s46,s76,27648
ds_write_b16_d16_hi v252,v234 offset:60928
M a[80:83],a[192:195],v[216:219],a[80:83]
M a[80:83],a[208:211],a[196:199],a[80:83]
M a[84:87],a[208:211],a[216:219],a[84:87]
buffer_load_dwordx4 v[228:231],v250,s[20:23],s46 offen offset:0 sc1
M a[84:87],a[192:195],a[196:199],a[84:87]
ds_read_b128 a[204:207],v248 offset:8704
M a[84:87],a[232:235],v[216:219],a[84:87]
ds_read_b128 a[200:203],v249 offset:8704
M a[88:91],a[232:235],a[196:199],a[88:91]
ds_read_b128 v[216:219],v248 offset:9216
M a[88:91],a[192:195],a[216:219],a[88:91]
ds_read_b128 a[196:199],v249 offset:9216
M a[88:91],a[208:211],a[228:231],a[88:91]
M a[92:95],a[208:211],v[220:223],a[92:95]
M a[92:95],a[192:195],a[228:231],a[92:95]
M a[92:95],a[232:235],a[216:219],a[92:95]
s_waitcnt vmcnt(13) lgkmcnt(3)
M a[96:99],a[248:251],a[204:207],a[96:99]
s_waitcnt vmcnt(8) lgkmcnt(2)
ds_read_b128 a[208:211],v248 offset:9728
M a[96:99],a[220:223],a[200:203],a[96:99]
s_waitcnt vmcnt(7) lgkmcnt(2)
ds_read_b128 v[220:223],v249 offset:9728
M a[96:99],a[224:227],v[216:219],a[96:99]
s_waitcnt lgkmcnt(2)
M a[100:103],a[224:227],a[196:199],a[100:103]
M a[100:103],a[220:223],v[216:219],a[100:103]
M a[100:103],a[248:251],a[200:203],a[100:103]
M a[104:107],a[248:251],v[216:219],a[104:107]
ds_read_b128 a[192:195],v248 offset:10240
M a[104:107],a[220:223],a[196:199],a[104:107]
s_waitcnt lgkmcnt(2)
ds_read_b128 a[228:231],v249 offset:10240
M a[104:107],a[224:227],a[208:211],a[104:107]
s_waitcnt lgkmcnt(2)
M a[108:111],a[224:227],v[220:223],a[108:111]
M a[108:111],a[220:223],a[208:211],a[108:111]
M a[108:111],a[248:251],a[196:199],a[108:111]
M a[112:115],a[248:251],a[208:211],a[112:115]
ds_read_b128 a[216:219],v249 offset:10752
M a[112:115],a[220:223],v[220:223],a[112:115]
s_waitcnt lgkmcnt(2)
ds_read_b128 a[232:235],v248 offset:10752
M a[112:115],a[224:227],a[192:195],a[112:115]
s_waitcnt lgkmcnt(2)
M a[116:119],a[224:227],a[228:231],a[116:119]
M a[116:119],a[220:223],a[192:195],a[116:119]
M a[116:119],a[248:251],v[220:223],a[116:119]
M a[120:123],a[248:251],a[192:195],a[120:123]
M a[120:123],a[220:223],a[228:231],a[120:123]
s_waitcnt lgkmcnt(1)
M a[120:123],a[224:227],a[216:219],a[120:123]
s_waitcnt lgkmcnt(0)
M a[124:127],a[224:227],a[232:235],a[124:127]
buffer_load_dwordx4 a[224:227],v250,s[20:23],s46 offen offset:1024 sc1
M a[124:127],a[220:223],a[216:219],a[124:127]
M a[124:127],a[248:251],a[228:231],a[124:127]
s_waitcnt vmcnt(7)
buffer_load_dwordx4 a[220:223],v250,s[20:23],s46 offen offset:2048 sc1
M a[128:131],v[224:227],a[204:207],a[128:131]
s_waitcnt vmcnt(7)
s_add_u32 s47,s76,30720
M a[128:131],a[240:243],a[200:203],a[128:131]
s_waitcnt vmcnt(6)
M a[128:131],a[244:247],v[216:219],a[128:131]
M a[132:135],a[244:247],a[196:199],a[132:135]
buffer_load_dwordx4 a[248:251],v250,s[20:23],s47 offen offset:0 sc1
M a[132:135],a[240:243],v[216:219],a[132:135]
M a[132:135],v[224:227],a[200:203],a[132:135]
M a[136:139],v[224:227],v[216:219],a[136:139]
s_barrier
ds_write_b16 v252,v235 offset:17408
M a[136:139],a[240:243],a[196:199],a[136:139]
ds_write_b16_d16_hi v252,v235 offset:26112
M a[136:139],a[244:247],a[208:211],a[136:139]
ds_write2st64_b64 v247,v[198:199],v[200:201] offset0:34 offset1:51
M a[140:143],a[244:247],v[220:223],a[140:143]
buffer_load_dwordx2 v[198:199],v245,s[8:11],s28 offen offset:768
M a[140:143],a[240:243],a[208:211],a[140:143]
M a[140:143],v[224:227],a[196:199],a[140:143]
buffer_load_dwordx2 v[200:201],v245,s[8:11],s28 offen offset:1152
M a[144:147],v[224:227],a[208:211],a[144:147]
M a[144:147],a[240:243],v[220:223],a[144:147]
M a[144:147],a[244:247],a[192:195],a[144:147]
ds_write2st64_b64 v247,v[204:205],v[214:215] offset0:137 offset1:154
M a[148:151],a[244:247],a[228:231],a[148:151]
s_add_u32 s28,s71,1179648
buffer_load_dwordx2 v[204:205],v245,s[12:15],s28 offen offset:0
M a[148:151],a[240:243],a[192:195],a[148:151]
M a[148:151],v[224:227],v[220:223],a[148:151]
ds_write2st64_b64 v247,v[206:207],v[208:209] offset0:103 offset1:120
M a[152:155],v[224:227],a[192:195],a[152:155]
buffer_load_dwordx2 v[214:215],v245,s[16:19],s28 offen offset:1536
M a[152:155],a[240:243],a[228:231],a[152:155]
M a[152:155],a[244:247],a[216:219],a[152:155]
ds_write2st64_b64 v247,v[210:211],v[212:213] offset0:35 offset1:52
M a[156:159],a[244:247],a[232:235],a[156:159]
buffer_load_dwordx4 a[244:247],v250,s[20:23],s47 offen offset:1024 sc1
M a[156:159],a[240:243],a[216:219],a[156:159]
M a[156:159],v[224:227],a[228:231],a[156:159]
s_waitcnt vmcnt(11)
M a[160:163],a[252:255],a[204:207],a[160:163]
s_waitcnt vmcnt(10)
M a[160:163],a[212:215],a[200:203],a[160:163]
s_waitcnt vmcnt(9)
buffer_load_dwordx4 a[240:243],v250,s[20:23],s47 offen offset:2048 sc1
M a[160:163],a[236:239],v[216:219],a[160:163]
s_add_u32 s48,s76,33792
M a[164:167],a[236:239],a[196:199],a[164:167]
M a[164:167],a[212:215],v[216:219],a[164:167]
M a[164:167],a[252:255],a[200:203],a[164:167]
buffer_load_dwordx4 v[224:227],v250,s[20:23],s48 offen offset:0 sc1
M a[168:171],a[252:255],v[216:219],a[168:171]
M a[168:171],a[212:215],a[196:199],a[168:171]
M a[168:171],a[236:239],a[208:211],a[168:171]
M a[172:175],a[236:239],v[220:223],a[172:175]
buffer_load_dwordx4 a[204:207],v250,s[20:23],s48 offen offset:1024 sc1
M a[172:175],a[212:215],a[208:211],a[172:175]
M a[172:175],a[252:255],a[196:199],a[172:175]
M a[176:179],a[252:255],a[208:211],a[176:179]
M a[176:179],a[212:215],v[220:223],a[176:179]
buffer_load_dwordx4 a[200:203],v250,s[20:23],s48 offen offset:2048 sc1
M a[176:179],a[236:239],a[192:195],a[176:179]
s_add_u32 s46,s76,36864
M a[180:183],a[236:239],a[228:231],a[180:183]
M a[180:183],a[212:215],a[192:195],a[180:183]
ds_read_b128 a[196:199],v248 offset:17408
M a[180:183],a[252:255],v[220:223],a[180:183]
buffer_load_dwordx4 v[216:219],v250,s[20:23],s46 offen offset:0 sc1
M a[184:187],a[252:255],a[192:195],a[184:187]
ds_read_b128 a[208:211],v249 offset:17408
ds_read_b128 v[220:223],v248 offset:17920
M a[184:187],a[212:215],a[228:231],a[184:187]
ds_read_b128 a[192:195],v249 offset:17920
v_lshlrev_b32 v234,16,v196
M a[184:187],a[236:239],a[216:219],a[184:187]
v_lshlrev_b32 v232,16,v192
v_lshlrev_b32 v233,16,v194
M a[188:191],a[236:239],a[232:235],a[188:191]
buffer_load_dwordx2 v[206:207],v245,s[8:11],s28 offen offset:0
M a[188:191],a[212:215],a[216:219],a[188:191]
s_waitcnt vmcnt(9)
v_lshlrev_b32 v237,16,v202
v_lshlrev_b32 v236,16,v200
M a[188:191],a[252:255],a[228:231],a[188:191]
s_waitcnt lgkmcnt(3)
v_lshlrev_b32 v235,16,v198
v_fmac_f32 v232,s43,v234
M v[0:3],v[228:231],a[196:199],v[0:3]
s_waitcnt lgkmcnt(2)
ds_read_b128 a[232:235],v248 offset:18432
v_fmac_f32 v237,4.0,v233
M v[0:3],a[224:227],a[208:211],v[0:3]
s_waitcnt lgkmcnt(2)
buffer_load_dwordx2 v[208:209],v245,s[8:11],s28 offen offset:384
M v[0:3],a[220:223],v[220:223],v[0:3]
s_waitcnt lgkmcnt(1)
ds_read_b128 a[236:239],v249 offset:18432
v_fma_f32 v238,-4.0,v234,v236
M v[4:7],a[220:223],a[192:195],v[4:7]
v_fmac_f32 v232,s45,v236
v_fmac_f32 v237,s41,v235
M v[4:7],a[224:227],v[220:223],v[4:7]
v_sub_f32 v236,v236,v234
v_fma_f32 v234,-4.0,v233,v235
M v[4:7],v[228:231],a[208:211],v[4:7]
buffer_load_dwordx2 v[210:211],v245,s[8:11],s28 offen offset:768
M v[8:11],v[228:231],v[220:223],v[8:11]
ds_read_b128 a[212:215],v248 offset:18944
v_sub_f32 v235,v235,v233
M v[8:11],a[224:227],a[192:195],v[8:11]
s_waitcnt lgkmcnt(2)
ds_read_b128 a[216:219],v249 offset:18944
v_add_f32 v233,v238,v234
M v[8:11],a[220:223],a[232:235],v[8:11]
s_waitcnt lgkmcnt(2)
v_sub_f32 v238,v238,v234
v_fma_f32 v234,2.0,v235,v236
M v[12:15],a[220:223],a[236:239],v[12:15]
buffer_load_dwordx2 v[212:213],v245,s[8:11],s28 offen offset:1152
M v[12:15],a[224:227],a[232:235],v[12:15]
s_add_u32 s29,s66,6291456
v_fmac_f32 v236,-2.0,v235
v_and_b32 v196,s42,v196
M v[12:15],v[228:231],a[192:195],v[12:15]
v_and_b32 v192,s42,v192
v_and_b32 v194,s42,v194
M v[16:19],v[228:231],a[232:235],v[16:19]
ds_read_b128 a[228:231],v249 offset:19456
v_and_b32 v202,s42,v202
M v[16:19],a[224:227],a[236:239],v[16:19]
s_waitcnt lgkmcnt(2)
buffer_load_short_d16_hi v239,v246,s[12:15],s29 offen offset:0
M v[16:19],a[220:223],a[212:215],v[16:19]
s_waitcnt lgkmcnt(1)
ds_read_b128 a[252:255],v248 offset:19456
v_and_b32 v200,s42,v200
M v[20:23],a[220:223],a[216:219],v[20:23]
buffer_load_short_d16_hi v240,v246,s[8:11],s29 offen offset:0
M v[20:23],a[224:227],a[212:215],v[20:23]
v_and_b32 v198,s42,v198
v_fmac_f32 v192,s43,v196
M v[20:23],v[228:231],a[236:239],v[20:23]
buffer_load_short_d16_hi v241,v246,s[8:11],s29 offen offset:384
M v[24:27],v[228:231],a[212:215],v[24:27]
v_fmac_f32 v202,4.0,v194
v_fma_f32 v235,-4.0,v196,v200
M v[24:27],a[224:227],a[216:219],v[24:27]
s_waitcnt lgkmcnt(1)
buffer_load_short_d16_hi v242,v246,s[8:11],s29 offen offset:768
M v[24:27],a[220:223],a[228:231],v[24:27]
s_waitcnt lgkmcnt(0)
v_fmac_f32 v192,s45,v200
v_fmac_f32 v202,s41,v198
M v[28:31],a[220:223],a[252:255],v[28:31]
buffer_load_dwordx4 a[220:223],v250,s[20:23],s46 offen offset:1024 sc1
M v[28:31],a[224:227],a[228:231],v[28:31]
v_sub_f32 v200,v200,v196
v_fma_f32 v196,-4.0,v194,v198
M v[28:31],v[228:231],a[216:219],v[28:31]
v_sub_f32 v198,v198,v194
v_add_f32 v194,v235,v196
M v[32:35],a[248:251],a[196:199],v[32:35]
s_waitcnt vmcnt(14)
v_sub_f32 v235,v235,v196
v_fma_f32 v196,2.0,v198,v200
M v[32:35],a[244:247],a[208:211],v[32:35]
s_waitcnt vmcnt(13)
buffer_load_dwordx4 a[224:227],v250,s[20:23],s46 offen offset:2048 sc1
M v[32:35],a[240:243],v[220:223],v[32:35]
s_add_u32 s47,s76,39936
v_fmac_f32 v200,-2.0,v198
v_cvt_pk_bf16_f32 v192,v232,v192
M v[36:39],a[240:243],a[192:195],v[36:39]
v_cvt_pk_bf16_f32 v202,v237,v202
v_cvt_pk_bf16_f32 v194,v233,v194
M v[36:39],a[244:247],v[220:223],v[36:39]
v_cvt_pk_bf16_f32 v198,v234,v196
v_cvt_pk_bf16_f32 v196,v238,v235
M v[36:39],a[248:251],a[208:211],v[36:39]
buffer_load_dwordx4 v[228:231],v250,s[20:23],s47 offen offset:0 sc1
M v[40:43],a[248:251],v[220:223],v[40:43]
v_cvt_pk_bf16_f32 v200,v236,v200
v_lshlrev_b32 v234,16,v197
M v[40:43],a[244:247],a[192:195],v[40:43]
v_lshlrev_b32 v232,16,v193
v_lshlrev_b32 v233,16,v195
M v[40:43],a[240:243],a[232:235],v[40:43]
v_lshlrev_b32 v237,16,v203
v_lshlrev_b32 v236,16,v201
M v[44:47],a[240:243],a[236:239],v[44:47]
buffer_load_short_d16_hi v243,v246,s[8:11],s29 offen offset:1152
M v[44:47],a[244:247],a[232:235],v[44:47]
v_lshlrev_b32 v235,16,v199
v_fmac_f32 v232,s43,v234
M v[44:47],a[248:251],a[192:195],v[44:47]
buffer_load_short_d16_hi v244,v246,s[16:19],s29 offen offset:1536
M v[48:51],a[248:251],a[232:235],v[48:51]
v_fmac_f32 v237,4.0,v233
v_fma_f32 v238,-4.0,v234,v236
M v[48:51],a[244:247],a[236:239],v[48:51]
v_fmac_f32 v232,s45,v236
v_fmac_f32 v237,s41,v235
M v[48:51],a[240:243],a[212:215],v[48:51]
v_sub_f32 v236,v236,v234
v_fma_f32 v234,-4.0,v233,v235
M v[52:55],a[240:243],a[216:219],v[52:55]
v_sub_f32 v235,v235,v233
v_add_f32 v233,v238,v234
M v[52:55],a[244:247],a[212:215],v[52:55]
v_sub_f32 v238,v238,v234
v_fma_f32 v234,2.0,v235,v236
M v[52:55],a[248:251],a[236:239],v[52:55]
v_fmac_f32 v236,-2.0,v235
v_and_b32 v197,s42,v197
M v[56:59],a[248:251],a[212:215],v[56:59]
v_and_b32 v193,s42,v193
v_and_b32 v195,s42,v195
M v[56:59],a[244:247],a[216:219],v[56:59]
v_and_b32 v203,s42,v203
v_and_b32 v201,s42,v201
M v[56:59],a[240:243],a[228:231],v[56:59]
v_and_b32 v199,s42,v199
v_fmac_f32 v193,s43,v197
M v[60:63],a[240:243],a[252:255],v[60:63]
buffer_load_dwordx4 a[240:243],v250,s[20:23],s47 offen offset:1024 sc1
M v[60:63],a[244:247],a[228:231],v[60:63]
v_fmac_f32 v203,4.0,v195
v_fma_f32 v235,-4.0,v197,v201
M v[60:63],a[248:251],a[216:219],v[60:63]
s_waitcnt vmcnt(17)
buffer_load_dwordx4 a[244:247],v250,s[20:23],s47 offen offset:2048 sc1
M v[64:67],v[224:227],a[196:199],v[64:67]
s_waitcnt vmcnt(17)
s_add_u32 s48,s76,43008
v_fmac_f32 v193,s45,v201
v_fmac_f32 v203,s41,v199
M v[64:67],a[204:207],a[208:211],v[64:67]
s_waitcnt vmcnt(16)
v_sub_f32 v201,v201,v197
v_fma_f32 v197,-4.0,v195,v199
M v[64:67],a[200:203],v[220:223],v[64:67]
v_sub_f32 v199,v199,v195
v_add_f32 v195,v235,v197
M v[68:71],a[200:203],a[192:195],v[68:71]
buffer_load_dwordx4 a[248:251],v250,s[20:23],s48 offen offset:0 sc1
M v[68:71],a[204:207],v[220:223],v[68:71]
v_sub_f32 v235,v235,v197
v_fma_f32 v197,2.0,v199,v201
M v[68:71],v[224:227],a[208:211],v[68:71]
v_fmac_f32 v201,-2.0,v199
v_cvt_pk_bf16_f32 v193,v232,v193
M v[72:75],v[224:227],v[220:223],v[72:75]
v_cvt_pk_bf16_f32 v203,v237,v203
v_cvt_pk_bf16_f32 v195,v233,v195
M v[72:75],a[204:207],a[192:195],v[72:75]
buffer_load_dwordx4 a[196:199],v250,s[20:23],s48 offen offset:1024 sc1
M v[72:75],a[200:203],a[232:235],v[72:75]
v_cvt_pk_bf16_f32 v199,v234,v197
v_cvt_pk_bf16_f32 v197,v238,v235
M v[76:79],a[200:203],a[236:239],v[76:79]
s_waitcnt vmcnt(15)
v_cvt_pk_bf16_f32 v201,v236,v201
v_lshlrev_b32 v234,16,v208
M v[76:79],a[204:207],a[232:235],v[76:79]
v_lshlrev_b32 v232,16,v204
v_lshlrev_b32 v233,16,v206
M v[76:79],v[224:227],a[192:195],v[76:79]
buffer_load_dwordx4 a[208:211],v250,s[20:23],s48 offen offset:2048 sc1
M v[80:83],v[224:227],a[232:235],v[80:83]
s_waitcnt vmcnt(14)
s_add_u32 s46,s77,9216
v_lshlrev_b32 v237,16,v214
v_lshlrev_b32 v236,16,v212
M v[80:83],a[204:207],a[236:239],v[80:83]
v_lshlrev_b32 v235,16,v210
v_fmac_f32 v232,s43,v234
M v[80:83],a[200:203],a[212:215],v[80:83]
ds_write2st64_b64 v247,v[192:193],v[202:203] offset0:138 offset1:155
M v[84:87],a[200:203],a[216:219],v[84:87]
s_add_u32 s28,s66,6291456
buffer_load_dwordx4 v[220:223],v250,s[20:23],s46 offen offset:0 sc1
M v[84:87],a[204:207],a[212:215],v[84:87]
ds_read_b128 a[192:195],v248 offset:26112
v_fmac_f32 v237,4.0,v233
M v[84:87],v[224:227],a[236:239],v[84:87]
ds_write2st64_b64 v247,v[194:195],v[196:197] offset0:104 offset1:121
M v[88:91],v[224:227],a[212:215],v[88:91]
buffer_load_dwordx2 v[192:193],v245,s[12:15],s28 offen offset:0
M v[88:91],a[204:207],a[216:219],v[88:91]
ds_read_b128 a[232:235],v249 offset:26112
ds_read_b128 a[236:239],v248 offset:26624
M v[88:91],a[200:203],a[228:231],v[88:91]
ds_write2st64_b64 v247,v[198:199],v[200:201] offset0:36 offset1:53
M v[92:95],a[200:203],a[252:255],v[92:95]
buffer_load_dwordx2 v[202:203],v245,s[16:19],s28 offen offset:1536
M v[92:95],a[204:207],a[228:231],v[92:95]
ds_read_b128 a[212:215],v249 offset:26624
v_fma_f32 v238,-4.0,v234,v236
M v[92:95],v[224:227],a[216:219],v[92:95]
s_waitcnt lgkmcnt(5)
v_fmac_f32 v232,s45,v236
v_fmac_f32 v237,s41,v235
M v[96:99],v[216:219],a[192:195],v[96:99]
s_waitcnt vmcnt(12) lgkmcnt(3)
ds_read_b128 a[200:203],v248 offset:27136
v_sub_f32 v236,v236,v234
M v[96:99],a[220:223],a[232:235],v[96:99]
s_waitcnt vmcnt(11) lgkmcnt(3)
buffer_load_dwordx2 v[194:195],v245,s[8:11],s28 offen offset:0
M v[96:99],a[224:227],a[236:239],v[96:99]
s_waitcnt lgkmcnt(1)
ds_read_b128 a[252:255],v249 offset:27136
v_fma_f32 v234,-4.0,v233,v235
M v[100:103],a[224:227],a[212:215],v[100:103]
v_sub_f32 v235,v235,v233
v_add_f32 v233,v238,v234
M v[100:103],a[220:223],a[236:239],v[100:103]
v_sub_f32 v238,v238,v234
v_fma_f32 v234,2.0,v235,v236
M v[100:103],v[216:219],a[232:235],v[100:103]
buffer_load_dwordx2 v[196:197],v245,s[8:11],s28 offen offset:384
M v[104:107],v[216:219],a[236:239],v[104:107]
ds_read_b128 a[204:207],v248 offset:27648
v_fmac_f32 v236,-2.0,v235
M v[104:107],a[220:223],a[212:215],v[104:107]
s_waitcnt lgkmcnt(2)
ds_read_b128 a[228:231],v249 offset:27648
v_and_b32 v208,s42,v208
M v[104:107],a[224:227],a[200:203],v[104:107]
s_waitcnt lgkmcnt(2)
v_and_b32 v204,s42,v204
v_and_b32 v206,s42,v206
M v[108:111],a[224:227],a[252:255],v[108:111]
buffer_load_dwordx2 v[198:199],v245,s[8:11],s28 offen offset:768
M v[108:111],a[220:223],a[200:203],v[108:111]
v_and_b32 v214,s42,v214
v_and_b32 v212,s42,v212
M v[108:111],v[216:219],a[212:215],v[108:111]
v_and_b32 v210,s42,v210
v_fmac_f32 v204,s43,v208
M v[112:115],v[216:219],a[200:203],v[112:115]
ds_read_b128 a[216:219],v249 offset:28160
v_fmac_f32 v214,4.0,v206
M v[112:115],a[220:223],a[252:255],v[112:115]
s_waitcnt lgkmcnt(2)
buffer_load_dwordx2 v[200:201],v245,s[8:11],s28 offen offset:1152
M v[112:115],a[224:227],a[204:207],v[112:115]
s_waitcnt lgkmcnt(1)
ds_read_b128 v[224:227],v248 offset:28160
v_fma_f32 v235,-4.0,v208,v212
M v[116:119],a[224:227],a[228:231],v[116:119]
v_fmac_f32 v204,s45,v212
v_fmac_f32 v214,s41,v210
M v[116:119],a[220:223],a[204:207],v[116:119]
v_sub_f32 v212,v212,v208
v_fma_f32 v208,-4.0,v206,v210
M v[116:119],v[216:219],a[252:255],v[116:119]
v_sub_f32 v210,v210,v206
v_add_f32 v206,v235,v208
M v[120:123],v[216:219],a[204:207],v[120:123]
v_sub_f32 v235,v235,v208
v_fma_f32 v208,2.0,v210,v212
M v[120:123],a[220:223],a[228:231],v[120:123]
s_waitcnt lgkmcnt(1)
v_fmac_f32 v212,-2.0,v210
v_cvt_pk_bf16_f32 v204,v232,v204
M v[120:123],a[224:227],a[216:219],v[120:123]
s_waitcnt lgkmcnt(0)
v_cvt_pk_bf16_f32 v214,v237,v214
v_cvt_pk_bf16_f32 v206,v233,v206
M v[124:127],a[224:227],v[224:227],v[124:127]
buffer_load_dwordx4 a[224:227],v250,s[20:23],s46 offen offset:1024 sc1
M v[124:127],a[220:223],a[216:219],v[124:127]
v_cvt_pk_bf16_f32 v210,v234,v208
v_cvt_pk_bf16_f32 v208,v238,v235
M v[124:127],v[216:219],a[228:231],v[124:127]
s_waitcnt vmcnt(15)
buffer_load_dwordx4 a[220:223],v250,s[20:23],s46 offen offset:2048 sc1
M v[128:131],v[228:231],a[192:195],v[128:131]
s_waitcnt vmcnt(13)
s_add_u32 s46,s77,18432
v_cvt_pk_bf16_f32 v212,v236,v212
v_lshlrev_b32 v234,16,v209
M v[128:131],a[240:243],a[232:235],v[128:131]
s_waitcnt vmcnt(12)
v_lshlrev_b32 v232,16,v205
v_lshlrev_b32 v233,16,v207
M v[128:131],a[244:247],a[236:239],v[128:131]
v_lshlrev_b32 v237,16,v215
v_lshlrev_b32 v236,16,v213
M v[132:135],a[244:247],a[212:215],v[132:135]
buffer_load_dwordx4 v[216:219],v250,s[20:23],s46 offen offset:0 sc1
M v[132:135],a[240:243],a[236:239],v[132:135]
v_lshlrev_b32 v235,16,v211
v_fmac_f32 v232,s43,v234
M v[132:135],v[228:231],a[232:235],v[132:135]
v_fmac_f32 v237,4.0,v233
v_fma_f32 v238,-4.0,v234,v236
M v[136:139],v[228:231],a[236:239],v[136:139]
v_fmac_f32 v232,s45,v236
v_fmac_f32 v237,s41,v235
M v[136:139],a[240:243],a[212:215],v[136:139]
v_sub_f32 v236,v236,v234
v_fma_f32 v234,-4.0,v233,v235
M v[136:139],a[244:247],a[200:203],v[136:139]
v_sub_f32 v235,v235,v233
v_add_f32 v233,v238,v234
M v[140:143],a[244:247],a[252:255],v[140:143]
v_sub_f32 v238,v238,v234
v_fma_f32 v234,2.0,v235,v236
M v[140:143],a[240:243],a[200:203],v[140:143]
v_fmac_f32 v236,-2.0,v235
v_and_b32 v209,s42,v209
M v[140:143],v[228:231],a[212:215],v[140:143]
v_and_b32 v205,s42,v205
v_and_b32 v207,s42,v207
M v[144:147],v[228:231],a[200:203],v[144:147]
v_and_b32 v215,s42,v215
v_and_b32 v213,s42,v213
M v[144:147],a[240:243],a[252:255],v[144:147]
v_and_b32 v211,s42,v211
v_fmac_f32 v205,s43,v209
M v[144:147],a[244:247],a[204:207],v[144:147]
v_fmac_f32 v215,4.0,v207
v_fma_f32 v235,-4.0,v209,v213
M v[148:151],a[244:247],a[228:231],v[148:151]
v_fmac_f32 v205,s45,v213
v_fmac_f32 v215,s41,v211
M v[148:151],a[240:243],a[204:207],v[148:151]
v_sub_f32 v213,v213,v209
v_fma_f32 v209,-4.0,v207,v211
M v[148:151],v[228:231],a[252:255],v[148:151]
v_sub_f32 v211,v211,v207
v_add_f32 v207,v235,v209
M v[152:155],v[228:231],a[204:207],v[152:155]
v_sub_f32 v235,v235,v209
v_fma_f32 v209,2.0,v211,v213
M v[152:155],a[240:243],a[228:231],v[152:155]
v_fmac_f32 v213,-2.0,v211
v_cvt_pk_bf16_f32 v205,v232,v205
M v[152:155],a[244:247],a[216:219],v[152:155]
v_cvt_pk_bf16_f32 v215,v237,v215
v_cvt_pk_bf16_f32 v207,v233,v207
M v[156:159],a[244:247],v[224:227],v[156:159]
buffer_load_dwordx4 a[244:247],v250,s[20:23],s46 offen offset:1024 sc1
M v[156:159],a[240:243],a[216:219],v[156:159]
v_cvt_pk_bf16_f32 v211,v234,v209
v_cvt_pk_bf16_f32 v209,v238,v235
M v[156:159],v[228:231],a[228:231],v[156:159]
s_waitcnt vmcnt(13)
buffer_load_dwordx4 a[240:243],v250,s[20:23],s46 offen offset:2048 sc1
M v[160:163],a[248:251],a[192:195],v[160:163]
s_waitcnt vmcnt(13)
s_add_u32 s46,s77,27648
v_cvt_pk_bf16_f32 v213,v236,v213
M v[160:163],a[196:199],a[232:235],v[160:163]
s_waitcnt vmcnt(12)
M v[160:163],a[208:211],a[236:239],v[160:163]
ds_write2st64_b64 v247,v[204:205],v[214:215] offset0:139 offset1:156
M v[164:167],a[208:211],a[212:215],v[164:167]
buffer_load_dwordx4 v[228:231],v250,s[20:23],s46 offen offset:0 sc1
M v[164:167],a[196:199],a[236:239],v[164:167]
M v[164:167],a[248:251],a[232:235],v[164:167]
ds_write2st64_b64 v247,v[206:207],v[208:209] offset0:105 offset1:122
M v[168:171],a[248:251],a[236:239],v[168:171]
buffer_load_dwordx4 a[192:195],v250,s[20:23],s46 offen offset:1024 sc1
M v[168:171],a[196:199],a[212:215],v[168:171]
M v[168:171],a[208:211],a[200:203],v[168:171]
ds_write2st64_b64 v247,v[210:211],v[212:213] offset0:37 offset1:54
M v[172:175],a[208:211],a[252:255],v[172:175]
buffer_load_dwordx4 a[232:235],v250,s[20:23],s46 offen offset:2048 sc1
M v[172:175],a[196:199],a[200:203],v[172:175]
s_add_u32 s46,s77,36864
M v[172:175],a[248:251],a[212:215],v[172:175]
M v[176:179],a[248:251],a[200:203],v[176:179]
M v[176:179],a[196:199],a[252:255],v[176:179]
buffer_load_dwordx4 a[236:239],v250,s[20:23],s46 offen offset:0 sc1
M v[176:179],a[208:211],a[204:207],v[176:179]
s_waitcnt lgkmcnt(0)
s_barrier
M v[180:183],a[208:211],a[228:231],v[180:183]
M v[180:183],a[196:199],a[204:207],v[180:183]
ds_read_b128 a[212:215],v248 offset:34816
M v[180:183],a[248:251],a[252:255],v[180:183]
ds_read_b128 a[200:203],v249 offset:34816
M v[184:187],a[248:251],a[204:207],v[184:187]
ds_read_b128 a[252:255],v248 offset:35328
M v[184:187],a[196:199],a[228:231],v[184:187]
ds_read_b128 a[204:207],v249 offset:35328
M v[184:187],a[208:211],a[216:219],v[184:187]
M v[188:191],a[208:211],v[224:227],v[188:191]
buffer_load_dwordx4 a[208:211],v250,s[20:23],s46 offen offset:1024 sc1
M v[188:191],a[196:199],a[216:219],v[188:191]
M v[188:191],a[248:251],a[228:231],v[188:191]
s_waitcnt vmcnt(16) lgkmcnt(3)
buffer_load_dwordx4 v[224:227],v250,s[20:23],s46 offen offset:2048 sc1
M a[0:3],v[220:223],a[212:215],a[0:3]
s_waitcnt vmcnt(10) lgkmcnt(2)
s_add_u32 s47,s77,12288
ds_read_b128 a[216:219],v248 offset:35840
M a[0:3],a[224:227],a[200:203],a[0:3]
s_waitcnt vmcnt(9) lgkmcnt(2)
ds_read_b128 a[228:231],v249 offset:35840
v_lshlrev_b32 v234,16,v196
M a[0:3],a[220:223],a[252:255],a[0:3]
s_waitcnt lgkmcnt(2)
v_lshlrev_b32 v232,16,v192
v_lshlrev_b32 v233,16,v194
M a[4:7],a[220:223],a[204:207],a[4:7]
buffer_load_dwordx4 a[196:199],v250,s[20:23],s47 offen offset:0 sc1
M a[4:7],a[224:227],a[252:255],a[4:7]
v_lshlrev_b32 v237,16,v202
v_lshlrev_b32 v236,16,v200
M a[4:7],v[220:223],a[200:203],a[4:7]
v_lshlrev_b32 v235,16,v198
v_fmac_f32 v232,s43,v234
M a[8:11],v[220:223],a[252:255],a[8:11]
ds_read_b128 a[248:251],v248 offset:36352
v_fmac_f32 v237,4.0,v233
M a[8:11],a[224:227],a[204:207],a[8:11]
s_waitcnt lgkmcnt(2)
ds_read_b128 a[212:215],v249 offset:36352
v_fma_f32 v238,-4.0,v234,v236
M a[8:11],a[220:223],a[216:219],a[8:11]
s_waitcnt lgkmcnt(2)
v_fmac_f32 v232,s45,v236
v_fmac_f32 v237,s41,v235
M a[12:15],a[220:223],a[228:231],a[12:15]
v_sub_f32 v236,v236,v234
v_fma_f32 v234,-4.0,v233,v235
M a[12:15],a[224:227],a[216:219],a[12:15]
v_sub_f32 v235,v235,v233
v_add_f32 v233,v238,v234
M a[12:15],v[220:223],a[204:207],a[12:15]
v_sub_f32 v238,v238,v234
v_fma_f32 v234,2.0,v235,v236
M a[16:19],v[220:223],a[216:219],a[16:19]
ds_read_b128 a[200:203],v249 offset:36864
v_fmac_f32 v236,-2.0,v235
M a[16:19],a[224:227],a[228:231],a[16:19]
s_waitcnt lgkmcnt(2)
ds_read_b128 a[252:255],v248 offset:36864
v_and_b32 v196,s42,v196
M a[16:19],a[220:223],a[248:251],a[16:19]
s_waitcnt lgkmcnt(2)
v_and_b32 v192,s42,v192
v_and_b32 v194,s42,v194
M a[20:23],a[220:223],a[212:215],a[20:23]
v_and_b32 v202,s42,v202
v_and_b32 v200,s42,v200
M a[20:23],a[224:227],a[248:251],a[20:23]
ds_read_b128 a[204:207],v248 offset:43520
v_and_b32 v198,s42,v198
M a[20:23],v[220:223],a[228:231],a[20:23]
ds_read_b128 a[216:219],v249 offset:43520
v_fmac_f32 v192,s43,v196
M a[24:27],v[220:223],a[248:251],a[24:27]
ds_read_b128 a[228:231],v248 offset:44032
v_fmac_f32 v202,4.0,v194
M a[24:27],a[224:227],a[212:215],a[24:27]
s_waitcnt lgkmcnt(4)
ds_read_b128 a[248:251],v249 offset:44032
v_fma_f32 v235,-4.0,v196,v200
M a[24:27],a[220:223],a[200:203],a[24:27]
s_waitcnt lgkmcnt(4)
v_fmac_f32 v192,s45,v200
v_fmac_f32 v202,s41,v198
M a[28:31],a[220:223],a[252:255],a[28:31]
buffer_load_dwordx4 a[220:223],v250,s[20:23],s47 offen offset:1024 sc1
M a[28:31],a[224:227],a[200:203],a[28:31]
v_sub_f32 v200,v200,v196
v_fma_f32 v196,-4.0,v194,v198
M a[28:31],v[220:223],a[212:215],a[28:31]
s_waitcnt vmcnt(10) lgkmcnt(3)
buffer_load_dwordx4 a[252:255],v250,s[20:23],s47 offen offset:2048 sc1
M a[96:99],v[216:219],a[204:207],a[96:99]
s_waitcnt vmcnt(10) lgkmcnt(2)
s_add_u32 s48,s77,15360
ds_read_b128 a[224:227],v248 offset:44544
v_sub_f32 v198,v198,v194
M a[96:99],a[244:247],a[216:219],a[96:99]
s_waitcnt vmcnt(9) lgkmcnt(2)
ds_read_b128 a[212:215],v249 offset:44544
v_add_f32 v194,v235,v196
M a[96:99],a[240:243],a[228:231],a[96:99]
s_waitcnt lgkmcnt(2)
v_sub_f32 v235,v235,v196
v_fma_f32 v196,2.0,v198,v200
M a[100:103],a[240:243],a[248:251],a[100:103]
buffer_load_dwordx4 a[200:203],v250,s[20:23],s48 offen offset:0 sc1
M a[100:103],a[244:247],a[228:231],a[100:103]
v_fmac_f32 v200,-2.0,v198
v_cvt_pk_bf16_f32 v192,v232,v192
M a[100:103],v[216:219],a[216:219],a[100:103]
v_cvt_pk_bf16_f32 v202,v237,v202
v_cvt_pk_bf16_f32 v194,v233,v194
M a[104:107],v[216:219],a[228:231],a[104:107]
ds_read_b128 v[220:223],v248 offset:45056
v_cvt_pk_bf16_f32 v198,v234,v196
M a[104:107],a[244:247],a[248:251],a[104:107]
s_waitcnt lgkmcnt(2)
ds_read_b128 a[204:207],v249 offset:45056
v_cvt_pk_bf16_f32 v196,v238,v235
M a[104:107],a[240:243],a[224:227],a[104:107]
s_waitcnt lgkmcnt(2)
v_cvt_pk_bf16_f32 v200,v236,v200
v_lshlrev_b32 v234,16,v197
M a[108:111],a[240:243],a[212:215],a[108:111]
v_lshlrev_b32 v232,16,v193
v_lshlrev_b32 v233,16,v195
M a[108:111],a[244:247],a[224:227],a[108:111]
v_lshlrev_b32 v237,16,v203
v_lshlrev_b32 v236,16,v201
M a[108:111],v[216:219],a[248:251],a[108:111]
v_lshlrev_b32 v235,16,v199
v_fmac_f32 v232,s43,v234
M a[112:115],v[216:219],a[224:227],a[112:115]
ds_read_b128 a[216:219],v249 offset:45568
v_fmac_f32 v237,4.0,v233
M a[112:115],a[244:247],a[212:215],a[112:115]
s_waitcnt lgkmcnt(2)
ds_read_b128 a[228:231],v248 offset:45568
v_and_b32 v255,32,v245
M a[112:115],a[240:243],v[220:223],a[112:115]
s_waitcnt lgkmcnt(2)
v_mul_u32_u24 v255,24,v255
v_and_or_b32 v255,v245,s42,v255
M a[116:119],a[240:243],a[204:207],a[116:119]
v_fma_f32 v238,-4.0,v234,v236
v_fmac_f32 v232,s45,v236
M a[116:119],a[244:247],v[220:223],a[116:119]
ds_read_b128 a[248:251],v248 offset:0
v_fmac_f32 v237,s41,v235
M a[116:119],v[216:219],a[212:215],a[116:119]
s_add_u32 s31,s66,6684672
ds_read_b128 a[224:227],v249 offset:0
v_sub_f32 v236,v236,v234
M a[120:123],v[216:219],v[220:223],a[120:123]
ds_read_b128 a[212:215],v248 offset:512
v_fma_f32 v234,-4.0,v233,v235
M a[120:123],a[244:247],a[204:207],a[120:123]
s_waitcnt lgkmcnt(4)
ds_read_b128 v[220:223],v249 offset:512
v_sub_f32 v235,v235,v233
M a[120:123],a[240:243],a[216:219],a[120:123]
s_waitcnt lgkmcnt(4)
v_add_f32 v233,v238,v234
v_sub_f32 v238,v238,v234
M a[124:127],a[240:243],a[228:231],a[124:127]
buffer_load_dword a228,v255,s[8:11],s31 offen offset:0
M a[124:127],a[244:247],a[216:219],a[124:127]
v_fma_f32 v234,2.0,v235,v236
v_fmac_f32 v236,-2.0,v235
M a[124:127],v[216:219],a[204:207],a[124:127]
s_waitcnt vmcnt(10) lgkmcnt(3)
v_and_b32 v197,s42,v197
v_and_b32 v193,s42,v193
M v[0:3],v[228:231],a[248:251],v[0:3]
s_waitcnt vmcnt(9) lgkmcnt(2)
ds_read_b128 a[240:243],v248 offset:1024
v_and_b32 v195,s42,v195
M v[0:3],a[192:195],a[224:227],v[0:3]
s_waitcnt vmcnt(8) lgkmcnt(2)
buffer_load_dword a228,v255,s[8:11],s31 offen offset:384
M v[0:3],a[232:235],a[212:215],v[0:3]
s_waitcnt lgkmcnt(1)
ds_read_b128 a[216:219],v249 offset:1024
v_and_b32 v203,s42,v203
M v[4:7],a[232:235],v[220:223],v[4:7]
v_and_b32 v201,s42,v201
v_and_b32 v199,s42,v199
M v[4:7],a[192:195],a[212:215],v[4:7]
v_fmac_f32 v193,s43,v197
v_fmac_f32 v203,4.0,v195
M v[4:7],v[228:231],a[224:227],v[4:7]
v_fma_f32 v235,-4.0,v197,v201
v_fmac_f32 v193,s45,v201
M v[8:11],v[228:231],a[212:215],v[8:11]
ds_read_b128 a[244:247],v248 offset:1536
v_fmac_f32 v203,s41,v199
M v[8:11],a[192:195],v[220:223],v[8:11]
s_waitcnt lgkmcnt(2)
ds_read_b128 a[204:207],v249 offset:1536
v_sub_f32 v201,v201,v197
M v[8:11],a[232:235],a[240:243],v[8:11]
s_waitcnt lgkmcnt(2)
v_fma_f32 v197,-4.0,v195,v199
v_sub_f32 v199,v199,v195
M v[12:15],a[232:235],a[216:219],v[12:15]
v_add_f32 v195,v235,v197
v_sub_f32 v235,v235,v197
M v[12:15],a[192:195],a[240:243],v[12:15]
v_fma_f32 v197,2.0,v199,v201
v_fmac_f32 v201,-2.0,v199
M v[12:15],v[228:231],v[220:223],v[12:15]
v_cvt_pk_bf16_f32 v193,v232,v193
v_cvt_pk_bf16_f32 v203,v237,v203
M v[16:19],v[228:231],a[240:243],v[16:19]
ds_read_b128 v[216:219],v249 offset:2048
v_cvt_pk_bf16_f32 v195,v233,v195
M v[16:19],a[192:195],a[216:219],v[16:19]
s_waitcnt lgkmcnt(2)
buffer_load_dwordx4 a[228:231],v250,s[20:23],s48 offen offset:1024 sc1
M v[16:19],a[232:235],a[244:247],v[16:19]
s_waitcnt lgkmcnt(1)
ds_read_b128 a[248:251],v248 offset:2048
v_cvt_pk_bf16_f32 v199,v234,v197
M v[20:23],a[232:235],a[204:207],v[20:23]
buffer_load_dwordx4 a[224:227],v250,s[20:23],s48 offen offset:2048 sc1
M v[20:23],a[192:195],a[244:247],v[20:23]
ds_read_b128 a[212:215],v248 offset:8704
v_cvt_pk_bf16_f32 v197,v238,v235
M v[20:23],v[228:231],a[216:219],v[20:23]
ds_read_b128 v[220:223],v249 offset:8704
v_cvt_pk_bf16_f32 v201,v236,v201
M v[24:27],v[228:231],a[244:247],v[24:27]
ds_read_b128 a[240:243],v248 offset:9216
M v[24:27],a[192:195],a[204:207],v[24:27]
s_waitcnt lgkmcnt(4)
ds_read_b128 a[216:219],v249 offset:9216
M v[24:27],a[232:235],v[216:219],v[24:27]
s_waitcnt lgkmcnt(4)
M v[28:31],a[232:235],a[248:251],v[28:31]
s_add_u32 s47,s77,21504
M v[28:31],a[192:195],v[216:219],v[28:31]
M v[28:31],v[228:231],a[204:207],v[28:31]
s_waitcnt vmcnt(10) lgkmcnt(3)
M v[96:99],a[236:239],a[212:215],v[96:99]
s_waitcnt vmcnt(9) lgkmcnt(2)
ds_read_b128 a[244:247],v248 offset:9728
M v[96:99],a[208:211],v[220:223],v[96:99]
s_waitcnt vmcnt(8) lgkmcnt(2)
ds_read_b128 a[232:235],v249 offset:9728
M v[96:99],v[224:227],a[240:243],v[96:99]
s_waitcnt lgkmcnt(2)
M v[100:103],v[224:227],a[216:219],v[100:103]
buffer_load_dwordx4 a[248:251],v250,s[20:23],s47 offen offset:0 sc1
M v[100:103],a[208:211],a[240:243],v[100:103]
M v[100:103],a[236:239],v[220:223],v[100:103]
buffer_load_dwordx4 a[192:195],v250,s[20:23],s47 offen offset:1024 sc1
M v[104:107],a[236:239],a[240:243],v[104:107]
ds_read_b128 v[228:231],v248 offset:10240
v_accvgpr_read_b32 v238,a0
M v[104:107],a[208:211],a[216:219],v[104:107]
s_waitcnt lgkmcnt(2)
ds_read_b128 a[212:215],v249 offset:10240
v_accvgpr_read_b32 v232,a96
M v[104:107],v[224:227],a[244:247],v[104:107]
s_waitcnt lgkmcnt(2)
v_add_f32 v234,v238,v232
v_sub_f32 v238,v238,v232
M v[108:111],v[224:227],a[232:235],v[108:111]
buffer_load_dwordx4 v[216:219],v250,s[20:23],s47 offen offset:2048 sc1
M v[108:111],a[208:211],a[244:247],v[108:111]
s_add_u32 s48,s77,24576
v_add_f32 v232,v0,v96
v_sub_f32 v96,v0,v96
M v[108:111],a[236:239],a[216:219],v[108:111]
v_add_f32 v0,v234,v232
v_fmac_f32 v234,4.0,v232
M v[112:115],a[236:239],a[244:247],v[112:115]
ds_read_b128 v[220:223],v249 offset:10752
v_fma_f32 v232,2.0,v96,v238
M v[112:115],a[208:211],a[232:235],v[112:115]
s_waitcnt lgkmcnt(2)
buffer_load_dwordx4 a[204:207],v250,s[20:23],s48 offen offset:0 sc1
M v[112:115],v[224:227],v[228:231],v[112:115]
s_waitcnt lgkmcnt(1)
ds_read_b128 a[240:243],v248 offset:10752
v_fma_f32 v96,s40,v96,v238
M v[116:119],v[224:227],a[212:215],v[116:119]
v_accvgpr_read_b32 v238,a1
v_accvgpr_read_b32 v237,a97
M v[116:119],a[208:211],v[228:231],v[116:119]
ds_read_b128 a[216:219],v248 offset:34816
v_add_f32 v236,v238,v237
M v[116:119],a[236:239],a[232:235],v[116:119]
ds_read_b128 a[244:247],v249 offset:34816
v_sub_f32 v238,v238,v237
M v[120:123],a[236:239],v[228:231],v[120:123]
ds_read_b128 a[232:235],v248 offset:35328
v_add_f32 v237,v1,v97
M v[120:123],a[208:211],a[212:215],v[120:123]
s_waitcnt lgkmcnt(4)
ds_read_b128 v[228:231],v249 offset:35328
v_sub_f32 v97,v1,v97
M v[120:123],v[224:227],v[220:223],v[120:123]
s_waitcnt lgkmcnt(4)
v_add_f32 v1,v236,v237
v_fmac_f32 v236,4.0,v237
M v[124:127],v[224:227],a[240:243],v[124:127]
v_fma_f32 v237,2.0,v97,v238
v_fma_f32 v97,s40,v97,v238
M v[124:127],a[208:211],v[220:223],v[124:127]
v_cvt_pk_bf16_f32 v232,v232,v237
v_cvt_pk_bf16_f32 v234,v234,v236
M v[124:127],a[236:239],a[212:215],v[124:127]
s_waitcnt vmcnt(11) lgkmcnt(3)
v_accvgpr_read_b32 v238,a2
v_accvgpr_read_b32 v233,a98
M a[32:35],a[196:199],a[216:219],a[32:35]
s_waitcnt vmcnt(10) lgkmcnt(2)
ds_read_b128 a[240:243],v248 offset:35840
v_add_f32 v235,v238,v233
M a[32:35],a[220:223],a[244:247],a[32:35]
s_waitcnt vmcnt(9) lgkmcnt(2)
ds_read_b128 v[224:227],v249 offset:35840
v_sub_f32 v238,v238,v233
M a[32:35],a[252:255],a[232:235],a[32:35]
s_waitcnt lgkmcnt(2)
v_add_f32 v233,v2,v98
v_sub_f32 v98,v2,v98
M a[36:39],a[252:255],v[228:231],a[36:39]
v_add_f32 v2,v235,v233
v_fmac_f32 v235,4.0,v233
M a[36:39],a[220:223],a[232:235],a[36:39]
v_fma_f32 v233,2.0,v98,v238
v_fma_f32 v98,s40,v98,v238
M a[36:39],a[196:199],a[244:247],a[36:39]
v_accvgpr_read_b32 v238,a3
v_accvgpr_read_b32 v237,a99
M a[40:43],a[196:199],a[232:235],a[40:43]
ds_read_b128 a[96:99],v248 offset:36352
v_add_f32 v236,v238,v237
M a[40:43],a[220:223],v[228:231],a[40:43]
s_waitcnt lgkmcnt(2)
ds_read_b128 a[208:211],v249 offset:36352
v_sub_f32 v238,v238,v237
M a[40:43],a[252:255],a[240:243],a[40:43]
s_waitcnt lgkmcnt(2)
v_add_f32 v237,v3,v99
v_sub_f32 v99,v3,v99
M a[44:47],a[252:255],v[224:227],a[44:47]
v_add_f32 v3,v236,v237
v_fmac_f32 v236,4.0,v237
M a[44:47],a[220:223],a[240:243],a[44:47]
v_fma_f32 v237,2.0,v99,v238
v_fma_f32 v99,s40,v99,v238
M a[44:47],a[196:199],v[228:231],a[44:47]
v_cvt_pk_bf16_f32 v233,v233,v237
v_cvt_pk_bf16_f32 v235,v235,v236
M a[48:51],a[196:199],a[240:243],a[48:51]
ds_read_b128 v[220:223],v249 offset:36864
ds_write2st64_b64 v254,v[232:233],v[234:235] offset0:68 offset1:72
M a[48:51],a[220:223],v[224:227],a[48:51]
s_waitcnt lgkmcnt(3)
ds_read_b128 a[212:215],v248 offset:36864
v_accvgpr_read_b32 v238,a4
M a[48:51],a[252:255],a[96:99],a[48:51]
s_waitcnt lgkmcnt(3)
v_accvgpr_read_b32 v232,a100
v_add_f32 v234,v238,v232
M a[52:55],a[252:255],a[208:211],a[52:55]
buffer_load_dwordx4 a[236:239],v250,s[20:23],s48 offen offset:1024 sc1
M a[52:55],a[220:223],a[96:99],a[52:55]
v_sub_f32 v238,v238,v232
v_add_f32 v232,v4,v100
M a[52:55],a[196:199],v[224:227],a[52:55]
v_sub_f32 v100,v4,v100
v_add_f32 v4,v234,v232
M a[56:59],a[196:199],a[96:99],a[56:59]
v_fmac_f32 v234,4.0,v232
v_fma_f32 v232,2.0,v100,v238
M a[56:59],a[220:223],a[208:211],a[56:59]
s_waitcnt lgkmcnt(2)
v_fma_f32 v100,s40,v100,v238
v_accvgpr_read_b32 v238,a5
M a[56:59],a[252:255],v[220:223],a[56:59]
s_waitcnt lgkmcnt(0)
v_accvgpr_read_b32 v237,a101
v_add_f32 v236,v238,v237
M a[60:63],a[252:255],a[212:215],a[60:63]
buffer_load_dwordx4 a[252:255],v250,s[20:23],s48 offen offset:2048 sc1
M a[60:63],a[220:223],v[220:223],a[60:63]
s_add_u32 s47,s77,30720
v_sub_f32 v238,v238,v237
v_add_f32 v237,v5,v101
M a[60:63],a[196:199],a[208:211],a[60:63]
s_waitcnt vmcnt(10)
buffer_load_dwordx4 a[220:223],v250,s[20:23],s47 offen offset:0 sc1
M a[64:67],a[200:203],a[216:219],a[64:67]
s_waitcnt vmcnt(8)
v_sub_f32 v101,v5,v101
v_add_f32 v5,v236,v237
M a[64:67],a[228:231],a[244:247],a[64:67]
s_waitcnt vmcnt(7)
v_fmac_f32 v236,4.0,v237
v_fma_f32 v237,2.0,v101,v238
M a[64:67],a[224:227],a[232:235],a[64:67]
v_fma_f32 v101,s40,v101,v238
v_cvt_pk_bf16_f32 v232,v232,v237
M a[68:71],a[224:227],v[228:231],a[68:71]
buffer_load_dwordx4 a[196:199],v250,s[20:23],s47 offen offset:1024 sc1
M a[68:71],a[228:231],a[232:235],a[68:71]
v_cvt_pk_bf16_f32 v234,v234,v236
v_accvgpr_read_b32 v238,a6
M a[68:71],a[200:203],a[244:247],a[68:71]
v_accvgpr_read_b32 v233,a102
v_add_f32 v235,v238,v233
M a[72:75],a[200:203],a[232:235],a[72:75]
v_sub_f32 v238,v238,v233
v_add_f32 v233,v6,v102
M a[72:75],a[228:231],v[228:231],a[72:75]
buffer_load_dwordx4 a[216:219],v250,s[20:23],s47 offen offset:2048 sc1
M a[72:75],a[224:227],a[240:243],a[72:75]
s_add_u32 s48,s77,33792
v_sub_f32 v102,v6,v102
v_add_f32 v6,v235,v233
M a[76:79],a[224:227],v[224:227],a[76:79]
v_fmac_f32 v235,4.0,v233
v_fma_f32 v233,2.0,v102,v238
M a[76:79],a[228:231],a[240:243],a[76:79]
v_fma_f32 v102,s40,v102,v238
v_accvgpr_read_b32 v238,a7
M a[76:79],a[200:203],v[228:231],a[76:79]
buffer_load_dwordx4 a[244:247],v250,s[20:23],s48 offen offset:0 sc1
M a[80:83],a[200:203],a[240:243],a[80:83]
v_accvgpr_read_b32 v237,a103
v_add_f32 v236,v238,v237
M a[80:83],a[228:231],v[224:227],a[80:83]
v_sub_f32 v238,v238,v237
v_add_f32 v237,v7,v103
M a[80:83],a[224:227],a[96:99],a[80:83]
v_sub_f32 v103,v7,v103
v_add_f32 v7,v236,v237
M a[84:87],a[224:227],a[208:211],a[84:87]
buffer_load_dwordx4 a[232:235],v250,s[20:23],s48 offen offset:1024 sc1
M a[84:87],a[228:231],a[96:99],a[84:87]
ds_read_b128 a[100:103],v248 offset:43520
v_fmac_f32 v236,4.0,v237
M a[84:87],a[200:203],v[224:227],a[84:87]
s_add_u32 s31,s66,7077888
ds_read_b128 v[228:231],v249 offset:43520
v_fma_f32 v237,2.0,v103,v238
M a[88:91],a[200:203],a[96:99],a[88:91]
ds_read_b128 a[96:99],v248 offset:44032
v_fma_f32 v103,s40,v103,v238
M a[88:91],a[228:231],a[208:211],a[88:91]
ds_read_b128 a[240:243],v249 offset:44032
v_cvt_pk_bf16_f32 v233,v233,v237
M a[88:91],a[224:227],v[220:223],a[88:91]
v_cvt_pk_bf16_f32 v235,v235,v236
M a[92:95],a[224:227],a[212:215],a[92:95]
buffer_load_dword v224,v255,s[8:11],s31 offen offset:0
M a[92:95],a[228:231],v[220:223],a[92:95]
ds_write2st64_b64 v254,v[232:233],v[234:235] offset0:76 offset1:80
M a[92:95],a[200:203],a[208:211],a[92:95]
s_waitcnt vmcnt(11) lgkmcnt(4)
v_accvgpr_read_b32 v238,a8
v_accvgpr_read_b32 v232,a104
M a[128:131],a[248:251],a[100:103],a[128:131]
s_waitcnt vmcnt(10) lgkmcnt(3)
ds_read_b128 a[212:215],v248 offset:44544
v_add_f32 v234,v238,v232
M a[128:131],a[192:195],v[228:231],a[128:131]
s_waitcnt vmcnt(9) lgkmcnt(3)
buffer_load_dword v224,v255,s[8:11],s31 offen offset:384
M a[128:131],v[216:219],a[96:99],a[128:131]
s_waitcnt lgkmcnt(2)
ds_read_b128 a[224:227],v249 offset:44544
v_sub_f32 v238,v238,v232
M a[132:135],v[216:219],a[240:243],a[132:135]
v_add_f32 v232,v8,v104
v_sub_f32 v104,v8,v104
M a[132:135],a[192:195],a[96:99],a[132:135]
s_waitcnt lgkmcnt(2)
s_barrier
ds_read_b128 a[0:3],v250 offset:34816
M a[132:135],a[248:251],v[228:231],a[132:135]
ds_read_b128 a[4:7],v250 offset:38912
v_add_f32 v8,v234,v232
M a[136:139],a[248:251],a[96:99],a[136:139]
ds_read_b128 a[228:231],v248 offset:45056
v_fmac_f32 v234,4.0,v232
M a[136:139],a[192:195],a[240:243],a[136:139]
s_waitcnt lgkmcnt(4)
ds_read_b128 v[220:223],v249 offset:45056
v_fma_f32 v232,2.0,v104,v238
M a[136:139],v[216:219],a[212:215],a[136:139]
s_waitcnt lgkmcnt(4)
v_fma_f32 v104,s40,v104,v238
v_accvgpr_read_b32 v238,a9
M a[140:143],v[216:219],a[224:227],a[140:143]
v_accvgpr_read_b32 v237,a105
v_add_f32 v236,v238,v237
M a[140:143],a[192:195],a[212:215],a[140:143]
v_sub_f32 v238,v238,v237
v_add_f32 v237,v9,v105
M a[140:143],a[248:251],a[240:243],a[140:143]
v_sub_f32 v105,v9,v105
v_add_f32 v9,v236,v237
M a[144:147],a[248:251],a[212:215],a[144:147]
ds_read_b128 a[200:203],v249 offset:45568
v_fmac_f32 v236,4.0,v237
M a[144:147],a[192:195],a[224:227],a[144:147]
s_waitcnt lgkmcnt(2)
ds_read_b128 a[208:211],v248 offset:45568
v_fma_f32 v237,2.0,v105,v238
M a[144:147],v[216:219],a[228:231],a[144:147]
s_waitcnt lgkmcnt(2)
buffer_load_dwordx4 v[224:227],v250,s[20:23],s48 offen offset:2048 sc1
M a[148:151],v[216:219],v[220:223],a[148:151]
v_fma_f32 v105,s40,v105,v238
v_cvt_pk_bf16_f32 v232,v232,v237
M a[148:151],a[192:195],a[228:231],a[148:151]
v_cvt_pk_bf16_f32 v234,v234,v236
v_accvgpr_read_b32 v238,a10
M a[148:151],a[248:251],a[224:227],a[148:151]
v_accvgpr_read_b32 v233,a106
v_add_f32 v235,v238,v233
M a[152:155],a[248:251],a[228:231],a[152:155]
v_sub_f32 v238,v238,v233
v_add_f32 v233,v10,v106
M a[152:155],a[192:195],v[220:223],a[152:155]
s_waitcnt lgkmcnt(1)
v_sub_f32 v106,v10,v106
v_add_f32 v10,v235,v233
M a[152:155],v[216:219],a[200:203],a[152:155]
s_waitcnt lgkmcnt(0)
v_fmac_f32 v235,4.0,v233
v_fma_f32 v233,2.0,v106,v238
M a[156:159],v[216:219],a[208:211],a[156:159]
global_load_dword v216,v250,s[64:65]
M a[156:159],a[192:195],a[200:203],a[156:159]
s_add_u32 s47,s77,39936
v_fma_f32 v106,s40,v106,v238
v_accvgpr_read_b32 v238,a11
M a[156:159],a[248:251],v[220:223],a[156:159]
s_waitcnt vmcnt(11)
v_accvgpr_read_b32 v237,a107
v_add_f32 v236,v238,v237
M a[160:163],a[204:207],a[100:103],a[160:163]
s_waitcnt vmcnt(10)
v_sub_f32 v238,v238,v237
v_add_f32 v237,v11,v107
M a[160:163],a[236:239],v[228:231],a[160:163]
s_waitcnt vmcnt(9)
v_sub_f32 v107,v11,v107
v_add_f32 v11,v236,v237
M a[160:163],a[252:255],a[96:99],a[160:163]
v_fmac_f32 v236,4.0,v237
v_fma_f32 v237,2.0,v107,v238
M a[164:167],a[252:255],a[240:243],a[164:167]
buffer_load_dwordx4 v[216:219],v250,s[20:23],s47 offen offset:0 sc1
M a[164:167],a[236:239],a[96:99],a[164:167]
v_fma_f32 v107,s40,v107,v238
v_cvt_pk_bf16_f32 v233,v233,v237
M a[164:167],a[204:207],v[228:231],a[164:167]
buffer_load_dwordx4 a[100:103],v250,s[20:23],s47 offen offset:1024 sc1
M a[168:171],a[204:207],a[96:99],a[168:171]
v_cvt_pk_bf16_f32 v235,v235,v236
M a[168:171],a[236:239],a[240:243],a[168:171]
ds_write2st64_b64 v254,v[232:233],v[234:235] offset0:85 offset1:89
M a[168:171],a[252:255],a[212:215],a[168:171]
v_accvgpr_read_b32 v204,a12
v_accvgpr_read_b32 v208,a108
M a[172:175],a[252:255],a[224:227],a[172:175]
buffer_load_dwordx4 a[104:107],v250,s[20:23],s47 offen offset:2048 sc1
M a[172:175],a[236:239],a[212:215],a[172:175]
s_add_u32 s48,s77,43008
v_accvgpr_read_b32 v205,a13
v_accvgpr_read_b32 v209,a109
M a[172:175],a[204:207],a[240:243],a[172:175]
v_accvgpr_read_b32 v206,a14
v_accvgpr_read_b32 v210,a110
v_accvgpr_read_b32 v207,a15
v_accvgpr_read_b32 v211,a111
v_pk_add_f32 v[212:213],v[204:205],v[208:209]
v_pk_add_f32 v[214:215],v[206:207],v[210:211]
v_pk_add_f32 v[204:205],v[204:205],v[208:209] neg_lo:[0,1] neg_hi:[0,1]
v_pk_add_f32 v[206:207],v[206:207],v[210:211] neg_lo:[0,1] neg_hi:[0,1]
v_pk_add_f32 v[208:209],v[12:13],v[108:109]
v_pk_add_f32 v[210:211],v[14:15],v[110:111]
v_pk_add_f32 v[108:109],v[12:13],v[108:109] neg_lo:[0,1] neg_hi:[0,1]
v_pk_add_f32 v[110:111],v[14:15],v[110:111] neg_lo:[0,1] neg_hi:[0,1]
v_pk_add_f32 v[12:13],v[212:213],v[208:209]
v_pk_add_f32 v[14:15],v[214:215],v[210:211]
v_pk_fma_f32 v[212:213],v[208:209],4.0,v[212:213] op_sel_hi:[1,0,1]
v_pk_fma_f32 v[214:215],v[210:211],4.0,v[214:215] op_sel_hi:[1,0,1]
v_pk_fma_f32 v[208:209],v[108:109],2.0,v[204:205] op_sel_hi:[1,0,1]
v_pk_fma_f32 v[210:211],v[110:111],2.0,v[206:207] op_sel_hi:[1,0,1]
v_pk_fma_f32 v[108:109],v[108:109],s[40:41],v[204:205] op_sel_hi:[1,0,1]
v_pk_fma_f32 v[110:111],v[110:111],s[40:41],v[206:207] op_sel_hi:[1,0,1]
M a[176:179],a[204:207],a[212:215],a[176:179]
buffer_load_dwordx4 a[192:195],v250,s[20:23],s48 offen offset:0 sc1
M a[176:179],a[236:239],a[224:227],a[176:179]
v_cvt_pk_bf16_f32 v208,v208,v209
v_cvt_pk_bf16_f32 v209,v210,v211
M a[176:179],a[252:255],a[228:231],a[176:179]
buffer_load_dwordx4 a[248:251],v250,s[20:23],s48 offen offset:1024 sc1
M a[180:183],a[252:255],v[220:223],a[180:183]
v_cvt_pk_bf16_f32 v212,v212,v213
v_cvt_pk_bf16_f32 v213,v214,v215
M a[180:183],a[236:239],a[228:231],a[180:183]
ds_read_b128 a[108:111],v248 offset:0
ds_write2st64_b64 v254,v[208:209],v[212:213] offset0:93 offset1:97
M a[180:183],a[204:207],a[224:227],a[180:183]
buffer_load_dwordx4 a[96:99],v250,s[20:23],s48 offen offset:2048 sc1
M a[184:187],a[204:207],a[228:231],a[184:187]
s_add_u32 s46,s72,0
ds_read_b128 a[240:243],v249 offset:0
ds_read_b128 a[212:215],v248 offset:512
M a[184:187],a[236:239],v[220:223],a[184:187]
ds_read_b128 a[224:227],v249 offset:512
v_accvgpr_read_b32 v238,a16
M a[184:187],a[252:255],a[200:203],a[184:187]
v_accvgpr_read_b32 v232,a112
v_add_f32 v234,v238,v232
M a[188:191],a[252:255],a[208:211],a[188:191]
buffer_load_dwordx4 v[228:231],v250,s[20:23],s46 offen offset:0 sc1
M a[188:191],a[236:239],a[200:203],a[188:191]
v_sub_f32 v238,v238,v232
v_add_f32 v232,v16,v112
M a[188:191],a[204:207],v[220:223],a[188:191]
s_waitcnt vmcnt(15) lgkmcnt(4)
v_sub_f32 v112,v16,v112
M v[32:35],a[220:223],a[108:111],v[32:35]
s_waitcnt vmcnt(14) lgkmcnt(2)
s_barrier
ds_read_b128 a[8:11],v250 offset:43520
M v[32:35],a[196:199],a[240:243],v[32:35]
s_waitcnt vmcnt(13) lgkmcnt(2)
ds_read_b128 a[12:15],v250 offset:47616
ds_read_b128 a[208:211],v248 offset:1024
M v[32:35],a[216:219],a[212:215],v[32:35]
s_waitcnt lgkmcnt(3)
buffer_load_dwordx4 a[228:231],v250,s[20:23],s46 offen offset:1024 sc1
M v[36:39],a[216:219],a[224:227],v[36:39]
ds_read_b128 a[252:255],v249 offset:1024
v_add_f32 v16,v234,v232
M v[36:39],a[196:199],a[212:215],v[36:39]
v_fmac_f32 v234,4.0,v232
v_fma_f32 v232,2.0,v112,v238
M v[36:39],a[220:223],a[240:243],v[36:39]
v_fma_f32 v112,s40,v112,v238
v_accvgpr_read_b32 v238,a17
M v[40:43],a[220:223],a[212:215],v[40:43]
ds_read_b128 a[200:203],v248 offset:1536
v_accvgpr_read_b32 v237,a113
M v[40:43],a[196:199],a[224:227],v[40:43]
s_waitcnt lgkmcnt(2)
ds_read_b128 a[236:239],v249 offset:1536
v_add_f32 v236,v238,v237
M v[40:43],a[216:219],a[208:211],v[40:43]
s_waitcnt lgkmcnt(2)
v_sub_f32 v238,v238,v237
v_add_f32 v237,v17,v113
M v[44:47],a[216:219],a[252:255],v[44:47]
v_sub_f32 v113,v17,v113
v_add_f32 v17,v236,v237
M v[44:47],a[196:199],a[208:211],v[44:47]
v_fmac_f32 v236,4.0,v237
v_fma_f32 v237,2.0,v113,v238
M v[44:47],a[220:223],a[224:227],v[44:47]
v_fma_f32 v113,s40,v113,v238
v_cvt_pk_bf16_f32 v232,v232,v237
M v[48:51],a[220:223],a[208:211],v[48:51]
ds_read_b128 a[204:207],v249 offset:2048
v_cvt_pk_bf16_f32 v234,v234,v236
M v[48:51],a[196:199],a[252:255],v[48:51]
s_waitcnt lgkmcnt(2)
ds_read_b128 v[220:223],v248 offset:2048
v_accvgpr_read_b32 v238,a18
M v[48:51],a[216:219],a[200:203],v[48:51]
s_waitcnt lgkmcnt(2)
v_accvgpr_read_b32 v233,a114
v_add_f32 v235,v238,v233
M v[52:55],a[216:219],a[236:239],v[52:55]
v_sub_f32 v238,v238,v233
v_add_f32 v233,v18,v114
M v[52:55],a[196:199],a[200:203],v[52:55]
v_sub_f32 v114,v18,v114
v_add_f32 v18,v235,v233
M v[52:55],a[220:223],a[252:255],v[52:55]
v_fmac_f32 v235,4.0,v233
v_fma_f32 v233,2.0,v114,v238
M v[56:59],a[220:223],a[200:203],v[56:59]
v_fma_f32 v114,s40,v114,v238
v_accvgpr_read_b32 v238,a19
M v[56:59],a[196:199],a[236:239],v[56:59]
s_waitcnt lgkmcnt(1)
v_accvgpr_read_b32 v237,a115
v_add_f32 v236,v238,v237
M v[56:59],a[216:219],a[204:207],v[56:59]
s_waitcnt lgkmcnt(0)
v_sub_f32 v238,v238,v237
v_add_f32 v237,v19,v115
M v[60:63],a[216:219],v[220:223],v[60:63]
buffer_load_dwordx4 a[112:115],v250,s[20:23],s46 offen offset:2048 sc1
M v[60:63],a[196:199],a[204:207],v[60:63]
s_add_u32 s46,s73,0
v_sub_f32 v115,v19,v115
v_add_f32 v19,v236,v237
M v[60:63],a[220:223],a[236:239],v[60:63]
s_waitcnt vmcnt(14)
buffer_load_dwordx4 a[216:219],v250,s[20:23],s46 offen offset:0 sc1
M v[64:67],a[244:247],a[108:111],v[64:67]
s_waitcnt vmcnt(14)
v_fmac_f32 v236,4.0,v237
v_fma_f32 v237,2.0,v115,v238
M v[64:67],a[232:235],a[240:243],v[64:67]
s_waitcnt vmcnt(11)
v_fma_f32 v115,s40,v115,v238
v_cvt_pk_bf16_f32 v233,v233,v237
M v[64:67],v[224:227],a[212:215],v[64:67]
v_cvt_pk_bf16_f32 v235,v235,v236
M v[68:71],v[224:227],a[224:227],v[68:71]
buffer_load_dwordx4 a[196:199],v250,s[20:23],s46 offen offset:1024 sc1
M v[68:71],a[232:235],a[212:215],v[68:71]
ds_write2st64_b64 v254,v[232:233],v[234:235] offset0:68 offset1:72
M v[68:71],a[244:247],a[240:243],v[68:71]
v_accvgpr_read_b32 v238,a20
v_accvgpr_read_b32 v232,a116
M v[72:75],a[244:247],a[212:215],v[72:75]
v_add_f32 v234,v238,v232
v_sub_f32 v238,v238,v232
M v[72:75],a[232:235],a[224:227],v[72:75]
buffer_load_dwordx4 a[108:111],v250,s[20:23],s46 offen offset:2048 sc1
M v[72:75],v[224:227],a[208:211],v[72:75]
s_add_u32 s31,s66,7471104
v_add_f32 v232,v20,v116
v_sub_f32 v116,v20,v116
M v[76:79],v[224:227],a[252:255],v[76:79]
v_add_f32 v20,v234,v232
v_fmac_f32 v234,4.0,v232
M v[76:79],a[232:235],a[208:211],v[76:79]
v_fma_f32 v232,2.0,v116,v238
v_fma_f32 v116,s40,v116,v238
M v[76:79],a[244:247],a[224:227],v[76:79]
buffer_load_dword a220,v255,s[8:11],s31 offen offset:0
M v[80:83],a[244:247],a[208:211],v[80:83]
v_accvgpr_read_b32 v238,a21
v_accvgpr_read_b32 v237,a117
M v[80:83],a[232:235],a[252:255],v[80:83]
v_add_f32 v236,v238,v237
v_sub_f32 v238,v238,v237
M v[80:83],v[224:227],a[200:203],v[80:83]
v_add_f32 v237,v21,v117
v_sub_f32 v117,v21,v117
M v[84:87],v[224:227],a[236:239],v[84:87]
buffer_load_dword a220,v255,s[8:11],s31 offen offset:384
M v[84:87],a[232:235],a[200:203],v[84:87]
ds_read_b128 a[240:243],v248 offset:8704
v_add_f32 v21,v236,v237
M v[84:87],a[244:247],a[252:255],v[84:87]
ds_read_b128 a[212:215],v249 offset:8704
v_fmac_f32 v236,4.0,v237
M v[88:91],a[244:247],a[200:203],v[88:91]
ds_read_b128 a[224:227],v248 offset:9216
v_fma_f32 v237,2.0,v117,v238
M v[88:91],a[232:235],a[236:239],v[88:91]
ds_read_b128 a[208:211],v249 offset:9216
v_fma_f32 v117,s40,v117,v238
M v[88:91],v[224:227],a[204:207],v[88:91]
v_cvt_pk_bf16_f32 v232,v232,v237
v_cvt_pk_bf16_f32 v234,v234,v236
M v[92:95],v[224:227],v[220:223],v[92:95]
v_accvgpr_read_b32 v238,a22
v_accvgpr_read_b32 v233,a118
M v[92:95],a[232:235],a[204:207],v[92:95]
v_add_f32 v235,v238,v233
v_sub_f32 v238,v238,v233
M v[92:95],a[244:247],a[236:239],v[92:95]
s_waitcnt vmcnt(13) lgkmcnt(3)
v_add_f32 v233,v22,v118
v_sub_f32 v118,v22,v118
M v[128:131],v[216:219],a[240:243],v[128:131]
s_waitcnt vmcnt(12) lgkmcnt(2)
ds_read_b128 a[252:255],v248 offset:9728
v_add_f32 v22,v235,v233
M v[128:131],a[100:103],a[212:215],v[128:131]
s_waitcnt vmcnt(11) lgkmcnt(2)
ds_read_b128 a[200:203],v249 offset:9728
v_fmac_f32 v235,4.0,v233
M v[128:131],a[104:107],a[224:227],v[128:131]
s_waitcnt lgkmcnt(2)
v_fma_f32 v233,2.0,v118,v238
v_fma_f32 v118,s40,v118,v238
M v[132:135],a[104:107],a[208:211],v[132:135]
v_accvgpr_read_b32 v238,a23
v_accvgpr_read_b32 v237,a119
M v[132:135],a[100:103],a[224:227],v[132:135]
v_add_f32 v236,v238,v237
v_sub_f32 v238,v238,v237
M v[132:135],v[216:219],a[212:215],v[132:135]
s_add_u32 s46,s74,0
v_add_f32 v237,v23,v119
v_sub_f32 v119,v23,v119
M v[136:139],v[216:219],a[224:227],v[136:139]
ds_read_b128 a[116:119],v248 offset:10240
v_add_f32 v23,v236,v237
M v[136:139],a[100:103],a[208:211],v[136:139]
s_waitcnt lgkmcnt(2)
ds_read_b128 v[220:223],v249 offset:10240
v_fmac_f32 v236,4.0,v237
M v[136:139],a[104:107],a[252:255],v[136:139]
s_waitcnt lgkmcnt(2)
v_fma_f32 v237,2.0,v119,v238
v_fma_f32 v119,s40,v119,v238
M v[140:143],a[104:107],a[200:203],v[140:143]
v_cvt_pk_bf16_f32 v233,v233,v237
v_cvt_pk_bf16_f32 v235,v235,v236
M v[140:143],a[100:103],a[252:255],v[140:143]
ds_write2st64_b64 v254,v[232:233],v[234:235] offset0:76 offset1:80
M v[140:143],v[216:219],a[208:211],v[140:143]
buffer_load_dwordx4 a[220:223],v250,s[20:23],s46 offen offset:0 sc1
M v[144:147],v[216:219],a[252:255],v[144:147]
ds_read_b128 a[232:235],v249 offset:10752
v_accvgpr_read_b32 v238,a24
M v[144:147],a[100:103],a[200:203],v[144:147]
s_waitcnt lgkmcnt(3)
buffer_load_dwordx4 v[224:227],v250,s[20:23],s46 offen offset:1024 sc1
M v[144:147],a[104:107],a[116:119],v[144:147]
s_waitcnt lgkmcnt(2)
ds_read_b128 a[236:239],v248 offset:10752
v_accvgpr_read_b32 v232,a120
M v[148:151],a[104:107],v[220:223],v[148:151]
v_add_f32 v234,v238,v232
v_sub_f32 v238,v238,v232
M v[148:151],a[100:103],a[116:119],v[148:151]
v_add_f32 v232,v24,v120
v_sub_f32 v120,v24,v120
M v[148:151],v[216:219],a[200:203],v[148:151]
s_waitcnt lgkmcnt(2)
s_barrier
ds_read_b128 a[16:19],v250 offset:34816
M v[152:155],v[216:219],a[116:119],v[152:155]
buffer_load_dwordx4 a[204:207],v250,s[20:23],s46 offen offset:2048 sc1
M v[152:155],a[100:103],v[220:223],v[152:155]
s_waitcnt lgkmcnt(2)
s_add_u32 s46,s75,0
ds_read_b128 a[20:23],v250 offset:38912
v_add_f32 v24,v234,v232
M v[152:155],a[104:107],a[232:235],v[152:155]
s_waitcnt lgkmcnt(2)
v_fmac_f32 v234,4.0,v232
v_fma_f32 v232,2.0,v120,v238
M v[156:159],a[104:107],a[236:239],v[156:159]
buffer_load_dwordx4 a[244:247],v250,s[20:23],s46 offen offset:0 sc1
M v[156:159],a[100:103],a[232:235],v[156:159]
v_fma_f32 v120,s40,v120,v238
v_accvgpr_read_b32 v238,a25
M v[156:159],v[216:219],v[220:223],v[156:159]
s_waitcnt vmcnt(14)
v_accvgpr_read_b32 v237,a121
v_add_f32 v236,v238,v237
M v[160:163],a[192:195],a[240:243],v[160:163]
s_waitcnt vmcnt(13)
v_sub_f32 v238,v238,v237
v_add_f32 v237,v25,v121
M v[160:163],a[248:251],a[212:215],v[160:163]
s_waitcnt vmcnt(12)
buffer_load_dwordx4 a[104:107],v250,s[20:23],s46 offen offset:1024 sc1
M v[160:163],a[96:99],a[224:227],v[160:163]
v_sub_f32 v121,v25,v121
v_add_f32 v25,v236,v237
M v[164:167],a[96:99],a[208:211],v[164:167]
v_fmac_f32 v236,4.0,v237
v_fma_f32 v237,2.0,v121,v238
M v[164:167],a[248:251],a[224:227],v[164:167]
v_fma_f32 v121,s40,v121,v238
v_cvt_pk_bf16_f32 v232,v232,v237
M v[164:167],a[192:195],a[212:215],v[164:167]
buffer_load_dwordx4 a[100:103],v250,s[20:23],s46 offen offset:2048 sc1
M v[168:171],a[192:195],a[224:227],v[168:171]
s_add_u32 s46,s76,0
v_cvt_pk_bf16_f32 v234,v234,v236
v_accvgpr_read_b32 v238,a26
M v[168:171],a[248:251],a[208:211],v[168:171]
v_accvgpr_read_b32 v233,a122
v_add_f32 v235,v238,v233
M v[168:171],a[96:99],a[252:255],v[168:171]
s_waitcnt lgkmcnt(0)
s_barrier
v_sub_f32 v238,v238,v233
M v[172:175],a[96:99],a[200:203],v[172:175]
buffer_load_dwordx4 v[216:219],v250,s[20:23],s46 offen offset:0 sc1
M v[172:175],a[248:251],a[252:255],v[172:175]
v_add_f32 v233,v26,v122
v_sub_f32 v122,v26,v122
M v[172:175],a[192:195],a[208:211],v[172:175]
v_add_f32 v26,v235,v233
v_fmac_f32 v235,4.0,v233
M v[176:179],a[192:195],a[252:255],v[176:179]
v_fma_f32 v233,2.0,v122,v238
v_fma_f32 v122,s40,v122,v238
M v[176:179],a[248:251],a[200:203],v[176:179]
buffer_load_dwordx4 a[240:243],v250,s[20:23],s46 offen offset:1024 sc1
M v[176:179],a[96:99],a[116:119],v[176:179]
v_add_u32 v248,0xffffbc00,v248
v_add_u32 v249,0xffffbc00,v249
M v[180:183],a[96:99],v[220:223],v[180:183]
v_accvgpr_read_b32 v238,a27
v_accvgpr_read_b32 v237,a123
M v[180:183],a[248:251],a[116:119],v[180:183]
ds_read_b128 a[208:211],v248 offset:0
v_add_f32 v236,v238,v237
M v[180:183],a[192:195],a[200:203],v[180:183]
buffer_load_dwordx4 a[212:215],v250,s[20:23],s46 offen offset:2048 sc1
M v[184:187],a[192:195],a[116:119],v[184:187]
s_add_u32 s46,s77,0
ds_read_b128 a[252:255],v249 offset:0
ds_read_b128 a[116:119],v248 offset:512
M v[184:187],a[248:251],v[220:223],v[184:187]
ds_read_b128 a[120:123],v249 offset:512
v_sub_f32 v238,v238,v237
M v[184:187],a[96:99],a[232:235],v[184:187]
v_add_f32 v237,v27,v123
v_sub_f32 v123,v27,v123
M v[188:191],a[96:99],a[236:239],v[188:191]
buffer_load_dwordx4 a[224:227],v250,s[20:23],s46 offen offset:0 sc1
M v[188:191],a[248:251],a[232:235],v[188:191]
v_add_f32 v27,v236,v237
v_fmac_f32 v236,4.0,v237
M v[188:191],a[192:195],v[220:223],v[188:191]
s_waitcnt vmcnt(17) lgkmcnt(3)
v_fma_f32 v237,2.0,v123,v238
v_fma_f32 v123,s40,v123,v238
M v[0:3],v[228:231],a[208:211],v[0:3]
s_waitcnt vmcnt(16) lgkmcnt(2)
ds_read_b128 a[248:251],v248 offset:1024
v_cvt_pk_bf16_f32 v233,v233,v237
M v[0:3],a[228:231],a[252:255],v[0:3]
s_waitcnt vmcnt(15) lgkmcnt(2)
buffer_load_dwordx4 a[96:99],v250,s[20:23],s46 offen offset:1024 sc1
M v[0:3],a[112:115],a[116:119],v[0:3]
s_waitcnt lgkmcnt(1)
ds_read_b128 a[192:195],v249 offset:1024
v_cvt_pk_bf16_f32 v235,v235,v236
M v[4:7],a[112:115],a[120:123],v[4:7]
ds_write2st64_b64 v254,v[232:233],v[234:235] offset0:85 offset1:89
M v[4:7],a[228:231],a[116:119],v[4:7]
v_accvgpr_read_b32 v204,a28
v_accvgpr_read_b32 v208,a124
M v[4:7],v[228:231],a[252:255],v[4:7]
buffer_load_dwordx4 a[200:203],v250,s[20:23],s46 offen offset:2048 sc1
M v[8:11],v[228:231],a[116:119],v[8:11]
s_add_u32 s46,s72,46080
ds_read_b128 a[116:119],v248 offset:1536
v_accvgpr_read_b32 v205,a29
M v[8:11],a[228:231],a[120:123],v[8:11]
s_waitcnt lgkmcnt(3)
ds_read_b128 v[220:223],v249 offset:1536
v_accvgpr_read_b32 v209,a125
M v[8:11],a[112:115],a[248:251],v[8:11]
s_waitcnt lgkmcnt(3)
v_accvgpr_read_b32 v206,a30
v_accvgpr_read_b32 v210,a126
v_accvgpr_read_b32 v207,a31
v_accvgpr_read_b32 v211,a127
v_pk_add_f32 v[212:213],v[204:205],v[208:209]
v_pk_add_f32 v[214:215],v[206:207],v[210:211]
v_pk_add_f32 v[204:205],v[204:205],v[208:209] neg_lo:[0,1] neg_hi:[0,1]
v_pk_add_f32 v[206:207],v[206:207],v[210:211] neg_lo:[0,1] neg_hi:[0,1]
v_pk_add_f32 v[208:209],v[28:29],v[124:125]
v_pk_add_f32 v[210:211],v[30:31],v[126:127]
v_pk_add_f32 v[124:125],v[28:29],v[124:125] neg_lo:[0,1] neg_hi:[0,1]
v_pk_add_f32 v[126:127],v[30:31],v[126:127] neg_lo:[0,1] neg_hi:[0,1]
v_pk_add_f32 v[28:29],v[212:213],v[208:209]
v_pk_add_f32 v[30:31],v[214:215],v[210:211]
v_pk_fma_f32 v[212:213],v[208:209],4.0,v[212:213] op_sel_hi:[1,0,1]
v_pk_fma_f32 v[214:215],v[210:211],4.0,v[214:215] op_sel_hi:[1,0,1]
v_pk_fma_f32 v[208:209],v[124:125],2.0,v[204:205] op_sel_hi:[1,0,1]
v_pk_fma_f32 v[210:211],v[126:127],2.0,v[206:207] op_sel_hi:[1,0,1]
v_pk_fma_f32 v[124:125],v[124:125],s[40:41],v[204:205] op_sel_hi:[1,0,1]
v_pk_fma_f32 v[126:127],v[126:127],s[40:41],v[206:207] op_sel_hi:[1,0,1]
M v[12:15],a[112:115],a[192:195],v[12:15]
buffer_load_dwordx4 a[236:239],v250,s[20:23],s46 offen offset:0 sc1
M v[12:15],a[228:231],a[248:251],v[12:15]
v_cvt_pk_bf16_f32 v208,v208,v209
v_cvt_pk_bf16_f32 v209,v210,v211
M v[12:15],v[228:231],a[120:123],v[12:15]
buffer_load_dwordx4 a[232:235],v250,s[20:23],s46 offen offset:1024 sc1
M v[16:19],v[228:231],a[248:251],v[16:19]
ds_read_b128 a[120:123],v249 offset:2048
v_cvt_pk_bf16_f32 v212,v212,v213
M v[16:19],a[228:231],a[192:195],v[16:19]
s_waitcnt lgkmcnt(2)
ds_read_b128 a[124:127],v248 offset:2048
v_add_u32 v248,0x15400,v248
M v[16:19],a[112:115],a[116:119],v[16:19]
s_waitcnt lgkmcnt(2)
v_add_u32 v249,0x15400,v249
v_cvt_pk_bf16_f32 v213,v214,v215
M v[20:23],a[112:115],v[220:223],v[20:23]
ds_write2st64_b64 v254,v[208:209],v[212:213] offset0:93 offset1:97
M v[20:23],a[228:231],a[116:119],v[20:23]
ds_read_b128 a[208:211],v248 offset:0
v_accvgpr_read_b32 v238,a32
M v[20:23],v[228:231],a[192:195],v[20:23]
ds_read_b128 a[252:255],v249 offset:0
v_accvgpr_read_b32 v232,a128
M v[24:27],v[228:231],a[116:119],v[24:27]
ds_read_b128 a[116:119],v248 offset:512
v_add_f32 v234,v238,v232
M v[24:27],a[228:231],v[220:223],v[24:27]
s_waitcnt lgkmcnt(5)
ds_read_b128 a[248:251],v249 offset:512
v_sub_f32 v238,v238,v232
M v[24:27],a[112:115],a[120:123],v[24:27]
s_waitcnt lgkmcnt(5)
buffer_load_dwordx4 a[192:195],v250,s[20:23],s46 offen offset:2048 sc1
M v[28:31],a[112:115],a[124:127],v[28:31]
s_add_u32 s47,s72,49152
v_add_f32 v232,v32,v128
v_sub_f32 v128,v32,v128
M v[28:31],a[228:231],a[120:123],v[28:31]
s_waitcnt lgkmcnt(4)
s_barrier
ds_read_b128 a[24:27],v250 offset:43520
M v[28:31],v[228:231],v[220:223],v[28:31]
s_waitcnt vmcnt(19) lgkmcnt(4)
ds_read_b128 a[28:31],v250 offset:47616
v_add_f32 v32,v234,v232
M v[0:3],a[216:219],a[208:211],v[0:3]
s_waitcnt vmcnt(18) lgkmcnt(4)
buffer_load_dwordx4 a[112:115],v250,s[20:23],s47 offen offset:0 sc1
M v[0:3],a[196:199],a[252:255],v[0:3]
s_waitcnt vmcnt(18) lgkmcnt(3)
ds_read_b128 a[228:231],v248 offset:1024
ds_read_b128 v[220:223],v249 offset:1024
M v[0:3],a[108:111],a[116:119],v[0:3]
s_waitcnt lgkmcnt(4)
buffer_load_dwordx4 a[124:127],v250,s[20:23],s47 offen offset:1024 sc1
M v[4:7],a[108:111],a[248:251],v[4:7]
v_fmac_f32 v234,4.0,v232
v_fma_f32 v232,2.0,v128,v238
M v[4:7],a[196:199],a[116:119],v[4:7]
v_fma_f32 v128,s40,v128,v238
v_accvgpr_read_b32 v238,a33
M v[4:7],a[216:219],a[252:255],v[4:7]
v_accvgpr_read_b32 v237,a129
v_add_f32 v236,v238,v237
M v[8:11],a[216:219],a[116:119],v[8:11]
buffer_load_dwordx4 a[120:123],v250,s[20:23],s47 offen offset:2048 sc1
M v[8:11],a[196:199],a[248:251],v[8:11]
s_waitcnt lgkmcnt(1)
ds_read_b128 a[116:119],v248 offset:1536
ds_read_b128 v[228:231],v249 offset:1536
M v[8:11],a[108:111],a[228:231],v[8:11]
s_waitcnt lgkmcnt(2)
s_add_u32 s34,s32,0
v_sub_f32 v238,v238,v237
v_add_f32 v237,v33,v129
M v[12:15],a[108:111],v[220:223],v[12:15]
v_sub_f32 v129,v33,v129
v_add_f32 v33,v236,v237
M v[12:15],a[196:199],a[228:231],v[12:15]
v_fmac_f32 v236,4.0,v237
v_fma_f32 v237,2.0,v129,v238
M v[12:15],a[216:219],a[248:251],v[12:15]
buffer_store_dwordx4 a[0:3],v253,s[24:27],s34 offen offset:384 nt
M v[16:19],a[216:219],a[228:231],v[16:19]
ds_read_b128 a[208:211],v249 offset:2048
v_fma_f32 v129,s40,v129,v238
M v[16:19],a[196:199],v[220:223],v[16:19]
s_waitcnt lgkmcnt(2)
ds_read_b128 a[252:255],v248 offset:2048
v_cvt_pk_bf16_f32 v232,v232,v237
M v[16:19],a[108:111],a[116:119],v[16:19]
s_waitcnt lgkmcnt(2)
v_cvt_pk_bf16_f32 v234,v234,v236
v_accvgpr_read_b32 v238,a34
M v[20:23],a[108:111],v[228:231],v[20:23]
s_add_u32 s46,s73,46080
v_accvgpr_read_b32 v233,a130
v_add_f32 v235,v238,v233
M v[20:23],a[196:199],a[116:119],v[20:23]
ds_read_b128 a[248:251],v248 offset:17408
v_sub_f32 v238,v238,v233
M v[20:23],a[216:219],v[220:223],v[20:23]
ds_read_b128 a[228:231],v249 offset:17408
v_add_f32 v233,v34,v130
M v[24:27],a[216:219],a[116:119],v[24:27]
ds_read_b128 a[116:119],v248 offset:17920
v_sub_f32 v130,v34,v130
M v[24:27],a[196:199],v[228:231],v[24:27]
s_waitcnt lgkmcnt(4)
ds_read_b128 v[220:223],v249 offset:17920
v_add_f32 v34,v235,v233
M v[24:27],a[108:111],a[208:211],v[24:27]
s_waitcnt lgkmcnt(4)
v_fmac_f32 v235,4.0,v233
v_fma_f32 v233,2.0,v130,v238
M v[28:31],a[108:111],a[252:255],v[28:31]
buffer_load_dwordx4 a[108:111],v250,s[20:23],s46 offen offset:0 sc1
M v[28:31],a[196:199],a[208:211],v[28:31]
v_fma_f32 v130,s40,v130,v238
v_accvgpr_read_b32 v238,a35
M v[28:31],a[216:219],v[228:231],v[28:31]
s_waitcnt vmcnt(19) lgkmcnt(3)
buffer_load_dwordx4 a[252:255],v250,s[20:23],s46 offen offset:1024 sc1
M v[0:3],a[220:223],a[248:251],v[0:3]
s_waitcnt vmcnt(19) lgkmcnt(2)
v_accvgpr_read_b32 v237,a131
v_add_f32 v236,v238,v237
M v[0:3],v[224:227],a[228:231],v[0:3]
s_waitcnt vmcnt(18) lgkmcnt(1)
ds_read_b128 a[128:131],v248 offset:18432
ds_read_b128 a[208:211],v249 offset:18432
M v[0:3],a[204:207],a[116:119],v[0:3]
s_waitcnt lgkmcnt(2)
s_add_u32 s34,s32,196608
v_sub_f32 v238,v238,v237
v_add_f32 v237,v35,v131
M v[4:7],a[204:207],v[220:223],v[4:7]
buffer_load_dwordx4 a[196:199],v250,s[20:23],s46 offen offset:2048 sc1
M v[4:7],v[224:227],a[116:119],v[4:7]
v_sub_f32 v131,v35,v131
v_add_f32 v35,v236,v237
M v[4:7],a[220:223],a[228:231],v[4:7]
v_fmac_f32 v236,4.0,v237
v_fma_f32 v237,2.0,v131,v238
M v[8:11],a[220:223],a[116:119],v[8:11]
ds_read_b128 a[116:119],v248 offset:18944
v_fma_f32 v131,s40,v131,v238
M v[8:11],v[224:227],v[220:223],v[8:11]
s_waitcnt lgkmcnt(2)
ds_read_b128 a[216:219],v249 offset:18944
v_cvt_pk_bf16_f32 v233,v233,v237
M v[8:11],a[204:207],a[128:131],v[8:11]
s_waitcnt lgkmcnt(2)
buffer_store_dwordx4 a[4:7],v253,s[24:27],s34 offen offset:384 nt
M v[12:15],a[204:207],a[208:211],v[12:15]
v_cvt_pk_bf16_f32 v235,v235,v236
M v[12:15],v[224:227],a[128:131],v[12:15]
ds_write2st64_b64 v254,v[232:233],v[234:235] offset0:34 offset1:38
M v[12:15],a[220:223],v[220:223],v[12:15]
v_accvgpr_read_b32 v204,a36
v_accvgpr_read_b32 v208,a132
M v[16:19],a[220:223],a[128:131],v[16:19]
s_add_u32 s47,s73,49152
ds_read_b128 a[128:131],v249 offset:19456
v_accvgpr_read_b32 v205,a37
M v[16:19],v[224:227],a[208:211],v[16:19]
s_waitcnt lgkmcnt(3)
ds_read_b128 v[228:231],v248 offset:19456
v_accvgpr_read_b32 v209,a133
M v[16:19],a[204:207],a[116:119],v[16:19]
s_waitcnt lgkmcnt(3)
v_accvgpr_read_b32 v206,a38
v_accvgpr_read_b32 v210,a134
v_accvgpr_read_b32 v207,a39
v_accvgpr_read_b32 v211,a135
v_pk_add_f32 v[212:213],v[204:205],v[208:209]
v_pk_add_f32 v[214:215],v[206:207],v[210:211]
v_pk_add_f32 v[204:205],v[204:205],v[208:209] neg_lo:[0,1] neg_hi:[0,1]
v_pk_add_f32 v[206:207],v[206:207],v[210:211] neg_lo:[0,1] neg_hi:[0,1]
v_pk_add_f32 v[208:209],v[36:37],v[132:133]
v_pk_add_f32 v[210:211],v[38:39],v[134:135]
v_pk_add_f32 v[132:133],v[36:37],v[132:133] neg_lo:[0,1] neg_hi:[0,1]
v_pk_add_f32 v[134:135],v[38:39],v[134:135] neg_lo:[0,1] neg_hi:[0,1]
v_pk_add_f32 v[36:37],v[212:213],v[208:209]
v_pk_add_f32 v[38:39],v[214:215],v[210:211]
v_pk_fma_f32 v[212:213],v[208:209],4.0,v[212:213] op_sel_hi:[1,0,1]
v_pk_fma_f32 v[214:215],v[210:211],4.0,v[214:215] op_sel_hi:[1,0,1]
v_pk_fma_f32 v[208:209],v[132:133],2.0,v[204:205] op_sel_hi:[1,0,1]
v_pk_fma_f32 v[210:211],v[134:135],2.0,v[206:207] op_sel_hi:[1,0,1]
v_pk_fma_f32 v[132:133],v[132:133],s[40:41],v[204:205] op_sel_hi:[1,0,1]
v_pk_fma_f32 v[134:135],v[134:135],s[40:41],v[206:207] op_sel_hi:[1,0,1]
M v[20:23],a[204:207],a[216:219],v[20:23]
v_cvt_pk_bf16_f32 v208,v208,v209
v_cvt_pk_bf16_f32 v209,v210,v211
M v[20:23],v[224:227],a[116:119],v[20:23]
ds_read_b128 a[132:135],v248 offset:34816
v_cvt_pk_bf16_f32 v212,v212,v213
M v[20:23],a[220:223],a[208:211],v[20:23]
ds_read_b128 a[248:251],v249 offset:34816
v_cvt_pk_bf16_f32 v213,v214,v215
M v[24:27],a[220:223],a[116:119],v[24:27]
buffer_load_dwordx4 a[116:119],v250,s[20:23],s47 offen offset:0 sc1
M v[24:27],v[224:227],a[216:219],v[24:27]
s_waitcnt lgkmcnt(3)
ds_read_b128 a[228:231],v248 offset:35328
ds_read_b128 v[220:223],v249 offset:35328
M v[24:27],a[204:207],a[128:131],v[24:27]
s_waitcnt lgkmcnt(4)
s_add_u32 s34,s32,393216
buffer_store_dwordx4 a[8:11],v253,s[24:27],s34 offen offset:384 nt
M v[28:31],a[204:207],v[228:231],v[28:31]
ds_write2st64_b64 v254,v[208:209],v[212:213] offset0:42 offset1:46
M v[28:31],v[224:227],a[128:131],v[28:31]
v_accvgpr_read_b32 v204,a40
v_accvgpr_read_b32 v208,a136
M v[28:31],a[220:223],a[216:219],v[28:31]
s_waitcnt vmcnt(21) lgkmcnt(4)
buffer_load_dwordx4 a[208:211],v250,s[20:23],s47 offen offset:1024 sc1
M v[0:3],a[244:247],a[132:135],v[0:3]
s_waitcnt vmcnt(21) lgkmcnt(3)
ds_read_b128 a[128:131],v248 offset:35840
v_accvgpr_read_b32 v205,a41
M v[0:3],a[104:107],a[248:251],v[0:3]
s_waitcnt vmcnt(20) lgkmcnt(3)
ds_read_b128 a[132:135],v249 offset:35840
v_accvgpr_read_b32 v209,a137
M v[0:3],a[100:103],a[228:231],v[0:3]
s_waitcnt lgkmcnt(3)
v_accvgpr_read_b32 v206,a42
v_accvgpr_read_b32 v210,a138
v_accvgpr_read_b32 v207,a43
v_accvgpr_read_b32 v211,a139
v_pk_add_f32 v[212:213],v[204:205],v[208:209]
v_pk_add_f32 v[214:215],v[206:207],v[210:211]
v_pk_add_f32 v[204:205],v[204:205],v[208:209] neg_lo:[0,1] neg_hi:[0,1]
v_pk_add_f32 v[206:207],v[206:207],v[210:211] neg_lo:[0,1] neg_hi:[0,1]
v_pk_add_f32 v[208:209],v[40:41],v[136:137]
v_pk_add_f32 v[210:211],v[42:43],v[138:139]
v_pk_add_f32 v[136:137],v[40:41],v[136:137] neg_lo:[0,1] neg_hi:[0,1]
v_pk_add_f32 v[138:139],v[42:43],v[138:139] neg_lo:[0,1] neg_hi:[0,1]
v_pk_add_f32 v[40:41],v[212:213],v[208:209]
v_pk_add_f32 v[42:43],v[214:215],v[210:211]
v_pk_fma_f32 v[212:213],v[208:209],4.0,v[212:213] op_sel_hi:[1,0,1]
v_pk_fma_f32 v[214:215],v[210:211],4.0,v[214:215] op_sel_hi:[1,0,1]
v_pk_fma_f32 v[208:209],v[136:137],2.0,v[204:205] op_sel_hi:[1,0,1]
v_pk_fma_f32 v[210:211],v[138:139],2.0,v[206:207] op_sel_hi:[1,0,1]
v_pk_fma_f32 v[136:137],v[136:137],s[40:41],v[204:205] op_sel_hi:[1,0,1]
v_pk_fma_f32 v[138:139],v[138:139],s[40:41],v[206:207] op_sel_hi:[1,0,1]
M v[4:7],a[100:103],v[220:223],v[4:7]
buffer_load_dwordx4 a[204:207],v250,s[20:23],s47 offen offset:2048 sc1
M v[4:7],a[104:107],a[228:231],v[4:7]
v_cvt_pk_bf16_f32 v208,v208,v209
v_cvt_pk_bf16_f32 v209,v210,v211
M v[4:7],a[244:247],a[248:251],v[4:7]
v_cvt_pk_bf16_f32 v212,v212,v213
v_cvt_pk_bf16_f32 v213,v214,v215
M v[8:11],a[244:247],a[228:231],v[8:11]
ds_read_b128 a[136:139],v248 offset:36352
ds_write2st64_b64 v254,v[208:209],v[212:213] offset0:51 offset1:55
M v[8:11],a[104:107],v[220:223],v[8:11]
s_waitcnt lgkmcnt(3)
ds_read_b128 v[228:231],v249 offset:36352
v_accvgpr_read_b32 v204,a44
M v[8:11],a[100:103],a[128:131],v[8:11]
s_waitcnt lgkmcnt(3)
v_accvgpr_read_b32 v208,a140
v_accvgpr_read_b32 v205,a45
M v[12:15],a[100:103],a[132:135],v[12:15]
v_accvgpr_read_b32 v209,a141
v_accvgpr_read_b32 v206,a46
M v[12:15],a[104:107],a[128:131],v[12:15]
v_accvgpr_read_b32 v210,a142
v_accvgpr_read_b32 v207,a47
v_accvgpr_read_b32 v211,a143
v_pk_add_f32 v[212:213],v[204:205],v[208:209]
v_pk_add_f32 v[214:215],v[206:207],v[210:211]
v_pk_add_f32 v[204:205],v[204:205],v[208:209] neg_lo:[0,1] neg_hi:[0,1]
v_pk_add_f32 v[206:207],v[206:207],v[210:211] neg_lo:[0,1] neg_hi:[0,1]
v_pk_add_f32 v[208:209],v[44:45],v[140:141]
v_pk_add_f32 v[210:211],v[46:47],v[142:143]
v_pk_add_f32 v[140:141],v[44:45],v[140:141] neg_lo:[0,1] neg_hi:[0,1]
v_pk_add_f32 v[142:143],v[46:47],v[142:143] neg_lo:[0,1] neg_hi:[0,1]
v_pk_add_f32 v[44:45],v[212:213],v[208:209]
v_pk_add_f32 v[46:47],v[214:215],v[210:211]
v_pk_fma_f32 v[212:213],v[208:209],4.0,v[212:213] op_sel_hi:[1,0,1]
v_pk_fma_f32 v[214:215],v[210:211],4.0,v[214:215] op_sel_hi:[1,0,1]
v_pk_fma_f32 v[208:209],v[140:141],2.0,v[204:205] op_sel_hi:[1,0,1]
v_pk_fma_f32 v[210:211],v[142:143],2.0,v[206:207] op_sel_hi:[1,0,1]
v_pk_fma_f32 v[140:141],v[140:141],s[40:41],v[204:205] op_sel_hi:[1,0,1]
v_pk_fma_f32 v[142:143],v[142:143],s[40:41],v[206:207] op_sel_hi:[1,0,1]
M v[12:15],a[244:247],v[220:223],v[12:15]
v_cvt_pk_bf16_f32 v208,v208,v209
v_cvt_pk_bf16_f32 v209,v210,v211
M v[16:19],a[244:247],a[128:131],v[16:19]
s_add_u32 s46,s74,46080
ds_read_b128 a[128:131],v249 offset:36864
v_cvt_pk_bf16_f32 v212,v212,v213
M v[16:19],a[104:107],a[132:135],v[16:19]
s_waitcnt lgkmcnt(3)
ds_read_b128 v[224:227],v248 offset:36864
v_cvt_pk_bf16_f32 v213,v214,v215
M v[16:19],a[100:103],a[136:139],v[16:19]
s_waitcnt lgkmcnt(2)
s_add_u32 s34,s32,589824
buffer_store_dwordx4 a[12:15],v253,s[24:27],s34 offen offset:384 nt
M v[20:23],a[100:103],v[228:231],v[20:23]
ds_write2st64_b64 v254,v[208:209],v[212:213] offset0:59 offset1:63
M v[20:23],a[104:107],a[136:139],v[20:23]
ds_read_b128 a[140:143],v248 offset:52224
v_accvgpr_read_b32 v238,a48
M v[20:23],a[244:247],a[132:135],v[20:23]
ds_read_b128 a[132:135],v249 offset:52224
v_accvgpr_read_b32 v232,a144
M v[24:27],a[244:247],a[136:139],v[24:27]
buffer_load_dwordx4 a[136:139],v250,s[20:23],s46 offen offset:0 sc1
M v[24:27],a[104:107],v[228:231],v[24:27]
s_waitcnt lgkmcnt(4)
ds_read_b128 a[216:219],v248 offset:52736
ds_read_b128 a[248:251],v249 offset:52736
M v[24:27],a[100:103],a[128:131],v[24:27]
s_waitcnt lgkmcnt(5)
buffer_load_dwordx4 a[220:223],v250,s[20:23],s46 offen offset:1024 sc1
M v[28:31],a[100:103],v[224:227],v[28:31]
v_add_f32 v234,v238,v232
v_sub_f32 v238,v238,v232
M v[28:31],a[104:107],a[128:131],v[28:31]
v_add_f32 v232,v48,v144
v_sub_f32 v144,v48,v144
M v[28:31],a[244:247],v[228:231],v[28:31]
s_waitcnt vmcnt(23) lgkmcnt(3)
s_barrier
ds_read_b128 a[32:35],v250 offset:17408
M v[0:3],v[216:219],a[140:143],v[0:3]
s_waitcnt vmcnt(22) lgkmcnt(3)
ds_read_b128 a[36:39],v250 offset:21504
ds_read_b128 a[40:43],v250 offset:26112
M v[0:3],a[240:243],a[132:135],v[0:3]
s_waitcnt vmcnt(21) lgkmcnt(4)
ds_read_b128 a[44:47],v250 offset:30208
ds_read_b128 a[100:103],v248 offset:53248
M v[0:3],a[212:215],a[216:219],v[0:3]
s_waitcnt lgkmcnt(5)
buffer_load_dwordx4 a[228:231],v250,s[20:23],s46 offen offset:2048 sc1
M v[4:7],a[212:215],a[248:251],v[4:7]
ds_read_b128 a[104:107],v249 offset:53248
v_add_f32 v48,v234,v232
M v[4:7],a[240:243],a[216:219],v[4:7]
v_fmac_f32 v234,4.0,v232
v_fma_f32 v232,2.0,v144,v238
M v[4:7],v[216:219],a[132:135],v[4:7]
v_fma_f32 v144,s40,v144,v238
v_accvgpr_read_b32 v238,a49
M v[8:11],v[216:219],a[216:219],v[8:11]
ds_read_b128 a[128:131],v248 offset:53760
v_accvgpr_read_b32 v237,a145
M v[8:11],a[240:243],a[248:251],v[8:11]
s_waitcnt lgkmcnt(2)
ds_read_b128 a[132:135],v249 offset:53760
v_add_f32 v236,v238,v237
M v[8:11],a[212:215],a[100:103],v[8:11]
s_waitcnt lgkmcnt(2)
s_add_u32 s34,s32,786432
buffer_store_dwordx4 a[16:19],v253,s[24:27],s34 offen offset:384 nt
M v[12:15],a[212:215],a[104:107],v[12:15]
v_sub_f32 v238,v238,v237
v_add_f32 v237,v49,v145
M v[12:15],a[240:243],a[100:103],v[12:15]
v_sub_f32 v145,v49,v145
v_add_f32 v49,v236,v237
M v[12:15],v[216:219],a[248:251],v[12:15]
v_fmac_f32 v236,4.0,v237
v_fma_f32 v237,2.0,v145,v238
M v[16:19],v[216:219],a[100:103],v[16:19]
s_add_u32 s47,s74,49152
ds_read_b128 a[100:103],v249 offset:54272
v_fma_f32 v145,s40,v145,v238
M v[16:19],a[240:243],a[104:107],v[16:19]
s_waitcnt lgkmcnt(2)
ds_read_b128 a[140:143],v248 offset:54272
v_add_u32 v248,0xfffece00,v248
M v[16:19],a[212:215],a[128:131],v[16:19]
s_waitcnt lgkmcnt(2)
v_add_u32 v249,0xfffece00,v249
v_cvt_pk_bf16_f32 v232,v232,v237
M v[20:23],a[212:215],a[132:135],v[20:23]
v_cvt_pk_bf16_f32 v234,v234,v236
v_accvgpr_read_b32 v238,a50
M v[20:23],a[240:243],a[128:131],v[20:23]
ds_read_b128 v[220:223],v248 offset:60928
v_accvgpr_read_b32 v233,a146
M v[20:23],v[216:219],a[104:107],v[20:23]
ds_read_b128 a[104:107],v249 offset:60928
v_add_f32 v235,v238,v233
M v[24:27],v[216:219],a[128:131],v[24:27]
buffer_load_dwordx4 a[128:131],v250,s[20:23],s47 offen offset:0 sc1
M v[24:27],a[240:243],a[132:135],v[24:27]
s_waitcnt lgkmcnt(3)
ds_read_b128 v[224:227],v248 offset:61440
ds_read_b128 v[228:231],v249 offset:61440
M v[24:27],a[212:215],a[100:103],v[24:27]
s_waitcnt lgkmcnt(4)
buffer_load_dwordx4 a[244:247],v250,s[20:23],s47 offen offset:1024 sc1
M v[28:31],a[212:215],a[140:143],v[28:31]
v_sub_f32 v238,v238,v233
v_add_f32 v233,v50,v146
M v[28:31],a[240:243],a[100:103],v[28:31]
v_sub_f32 v146,v50,v146
v_add_f32 v50,v235,v233
M v[28:31],v[216:219],a[132:135],v[28:31]
s_waitcnt vmcnt(24) lgkmcnt(3)
v_fmac_f32 v235,4.0,v233
v_fma_f32 v233,2.0,v146,v238
M v[0:3],a[224:227],v[220:223],v[0:3]
s_waitcnt vmcnt(23) lgkmcnt(2)
buffer_load_dwordx4 a[216:219],v250,s[20:23],s47 offen offset:2048 sc1
M v[0:3],a[96:99],a[104:107],v[0:3]
s_waitcnt vmcnt(23) lgkmcnt(1)
ds_read_b128 a[100:103],v248 offset:61952
ds_read_b128 a[132:135],v249 offset:61952
M v[0:3],a[200:203],v[224:227],v[0:3]
s_waitcnt lgkmcnt(2)
s_add_u32 s34,s32,983040
v_fma_f32 v146,s40,v146,v238
v_accvgpr_read_b32 v238,a51
M v[4:7],a[200:203],v[228:231],v[4:7]
v_accvgpr_read_b32 v237,a147
v_add_f32 v236,v238,v237
M v[4:7],a[96:99],v[224:227],v[4:7]
v_sub_f32 v238,v238,v237
v_add_f32 v237,v51,v147
M v[4:7],a[224:227],a[104:107],v[4:7]
buffer_store_dwordx4 a[20:23],v253,s[24:27],s34 offen offset:384 nt
M v[8:11],a[224:227],v[224:227],v[8:11]
ds_read_b128 a[104:107],v248 offset:62464
v_sub_f32 v147,v51,v147
M v[8:11],a[96:99],v[228:231],v[8:11]
s_waitcnt lgkmcnt(2)
ds_read_b128 a[140:143],v249 offset:62464
v_add_f32 v51,v236,v237
M v[8:11],a[200:203],a[100:103],v[8:11]
s_waitcnt lgkmcnt(2)
v_fmac_f32 v236,4.0,v237
v_fma_f32 v237,2.0,v147,v238
M v[12:15],a[200:203],a[132:135],v[12:15]
v_fma_f32 v147,s40,v147,v238
v_cvt_pk_bf16_f32 v233,v233,v237
M v[12:15],a[96:99],a[100:103],v[12:15]
v_cvt_pk_bf16_f32 v235,v235,v236
M v[12:15],a[224:227],v[228:231],v[12:15]
ds_write2st64_b64 v254,v[232:233],v[234:235] offset0:119 offset1:123
M v[16:19],a[224:227],a[100:103],v[16:19]
s_add_u32 s46,s75,46080
ds_read_b128 a[100:103],v249 offset:62976
v_accvgpr_read_b32 v204,a52
M v[16:19],a[96:99],a[132:135],v[16:19]
s_waitcnt lgkmcnt(3)
ds_read_b128 a[144:147],v248 offset:62976
v_accvgpr_read_b32 v208,a148
M v[16:19],a[200:203],a[104:107],v[16:19]
s_waitcnt lgkmcnt(3)
v_accvgpr_read_b32 v205,a53
v_accvgpr_read_b32 v209,a149
M v[20:23],a[200:203],a[140:143],v[20:23]
v_accvgpr_read_b32 v206,a54
v_accvgpr_read_b32 v210,a150
v_accvgpr_read_b32 v207,a55
v_accvgpr_read_b32 v211,a151
v_pk_add_f32 v[212:213],v[204:205],v[208:209]
v_pk_add_f32 v[214:215],v[206:207],v[210:211]
v_pk_add_f32 v[204:205],v[204:205],v[208:209] neg_lo:[0,1] neg_hi:[0,1]
v_pk_add_f32 v[206:207],v[206:207],v[210:211] neg_lo:[0,1] neg_hi:[0,1]
v_pk_add_f32 v[208:209],v[52:53],v[148:149]
v_pk_add_f32 v[210:211],v[54:55],v[150:151]
v_pk_add_f32 v[148:149],v[52:53],v[148:149] neg_lo:[0,1] neg_hi:[0,1]
v_pk_add_f32 v[150:151],v[54:55],v[150:151] neg_lo:[0,1] neg_hi:[0,1]
v_pk_add_f32 v[52:53],v[212:213],v[208:209]
v_pk_add_f32 v[54:55],v[214:215],v[210:211]
v_pk_fma_f32 v[212:213],v[208:209],4.0,v[212:213] op_sel_hi:[1,0,1]
v_pk_fma_f32 v[214:215],v[210:211],4.0,v[214:215] op_sel_hi:[1,0,1]
v_pk_fma_f32 v[208:209],v[148:149],2.0,v[204:205] op_sel_hi:[1,0,1]
v_pk_fma_f32 v[210:211],v[150:151],2.0,v[206:207] op_sel_hi:[1,0,1]
v_pk_fma_f32 v[148:149],v[148:149],s[40:41],v[204:205] op_sel_hi:[1,0,1]
v_pk_fma_f32 v[150:151],v[150:151],s[40:41],v[206:207] op_sel_hi:[1,0,1]
M v[20:23],a[96:99],a[104:107],v[20:23]
ds_read_b128 a[248:251],v248 offset:0
v_cvt_pk_bf16_f32 v208,v208,v209
M v[20:23],a[224:227],a[132:135],v[20:23]
ds_read_b128 a[132:135],v249 offset:0
v_cvt_pk_bf16_f32 v209,v210,v211
M v[24:27],a[224:227],a[104:107],v[24:27]
buffer_load_dwordx4 a[104:107],v250,s[20:23],s46 offen offset:0 sc1
M v[24:27],a[96:99],a[140:143],v[24:27]
s_waitcnt lgkmcnt(3)
ds_read_b128 a[148:151],v248 offset:512
ds_read_b128 a[240:243],v249 offset:512
M v[24:27],a[200:203],a[100:103],v[24:27]
s_waitcnt lgkmcnt(4)
s_add_u32 s34,s32,1179648
buffer_load_dwordx4 a[212:215],v250,s[20:23],s46 offen offset:1024 sc1
M v[28:31],a[200:203],a[144:147],v[28:31]
v_cvt_pk_bf16_f32 v212,v212,v213
v_cvt_pk_bf16_f32 v213,v214,v215
M v[28:31],a[96:99],a[100:103],v[28:31]
ds_write2st64_b64 v254,v[208:209],v[212:213] offset0:127 offset1:131
M v[28:31],a[224:227],a[140:143],v[28:31]
s_waitcnt vmcnt(25) lgkmcnt(4)
v_accvgpr_read_b32 v204,a56
v_accvgpr_read_b32 v208,a152
M v[96:99],a[236:239],a[248:251],v[96:99]
s_waitcnt vmcnt(24) lgkmcnt(3)
buffer_load_dwordx4 v[216:219],v250,s[20:23],s46 offen offset:2048 sc1
M v[96:99],a[232:235],a[132:135],v[96:99]
s_waitcnt vmcnt(24) lgkmcnt(2)
ds_read_b128 a[96:99],v248 offset:1024
ds_read_b128 a[100:103],v249 offset:1024
M v[96:99],a[192:195],a[148:151],v[96:99]
s_waitcnt lgkmcnt(3)
v_accvgpr_read_b32 v205,a57
v_accvgpr_read_b32 v209,a153
M v[100:103],a[192:195],a[240:243],v[100:103]
v_accvgpr_read_b32 v206,a58
v_accvgpr_read_b32 v210,a154
v_accvgpr_read_b32 v207,a59
v_accvgpr_read_b32 v211,a155
v_pk_add_f32 v[212:213],v[204:205],v[208:209]
v_pk_add_f32 v[214:215],v[206:207],v[210:211]
v_pk_add_f32 v[204:205],v[204:205],v[208:209] neg_lo:[0,1] neg_hi:[0,1]
v_pk_add_f32 v[206:207],v[206:207],v[210:211] neg_lo:[0,1] neg_hi:[0,1]
v_pk_add_f32 v[208:209],v[56:57],v[152:153]
v_pk_add_f32 v[210:211],v[58:59],v[154:155]
v_pk_add_f32 v[152:153],v[56:57],v[152:153] neg_lo:[0,1] neg_hi:[0,1]
v_pk_add_f32 v[154:155],v[58:59],v[154:155] neg_lo:[0,1] neg_hi:[0,1]
v_pk_add_f32 v[56:57],v[212:213],v[208:209]
v_pk_add_f32 v[58:59],v[214:215],v[210:211]
v_pk_fma_f32 v[212:213],v[208:209],4.0,v[212:213] op_sel_hi:[1,0,1]
v_pk_fma_f32 v[214:215],v[210:211],4.0,v[214:215] op_sel_hi:[1,0,1]
v_pk_fma_f32 v[208:209],v[152:153],2.0,v[204:205] op_sel_hi:[1,0,1]
v_pk_fma_f32 v[210:211],v[154:155],2.0,v[206:207] op_sel_hi:[1,0,1]
v_pk_fma_f32 v[152:153],v[152:153],s[40:41],v[204:205] op_sel_hi:[1,0,1]
v_pk_fma_f32 v[154:155],v[154:155],s[40:41],v[206:207] op_sel_hi:[1,0,1]
M v[100:103],a[232:235],a[148:151],v[100:103]
v_cvt_pk_bf16_f32 v208,v208,v209
v_cvt_pk_bf16_f32 v209,v210,v211
M v[100:103],a[236:239],a[132:135],v[100:103]
buffer_store_dwordx4 a[24:27],v253,s[24:27],s34 offen offset:384 nt
M v[104:107],a[236:239],a[148:151],v[104:107]
ds_read_b128 a[140:143],v248 offset:1536
v_cvt_pk_bf16_f32 v212,v212,v213
M v[104:107],a[232:235],a[240:243],v[104:107]
s_waitcnt lgkmcnt(2)
ds_read_b128 a[144:147],v249 offset:1536
v_cvt_pk_bf16_f32 v213,v214,v215
M v[104:107],a[192:195],a[96:99],v[104:107]
s_waitcnt lgkmcnt(2)
ds_write2st64_b64 v254,v[208:209],v[212:213] offset0:68 offset1:72
M v[108:111],a[192:195],a[100:103],v[108:111]
v_accvgpr_read_b32 v204,a60
v_accvgpr_read_b32 v208,a156
M v[108:111],a[232:235],a[96:99],v[108:111]
v_accvgpr_read_b32 v205,a61
v_accvgpr_read_b32 v209,a157
M v[108:111],a[236:239],a[240:243],v[108:111]
v_accvgpr_read_b32 v206,a62
v_accvgpr_read_b32 v210,a158
v_accvgpr_read_b32 v207,a63
v_accvgpr_read_b32 v211,a159
v_pk_add_f32 v[212:213],v[204:205],v[208:209]
v_pk_add_f32 v[214:215],v[206:207],v[210:211]
v_pk_add_f32 v[204:205],v[204:205],v[208:209] neg_lo:[0,1] neg_hi:[0,1]
v_pk_add_f32 v[206:207],v[206:207],v[210:211] neg_lo:[0,1] neg_hi:[0,1]
v_pk_add_f32 v[208:209],v[60:61],v[156:157]
v_pk_add_f32 v[210:211],v[62:63],v[158:159]
v_pk_add_f32 v[156:157],v[60:61],v[156:157] neg_lo:[0,1] neg_hi:[0,1]
v_pk_add_f32 v[158:159],v[62:63],v[158:159] neg_lo:[0,1] neg_hi:[0,1]
v_pk_add_f32 v[60:61],v[212:213],v[208:209]
v_pk_add_f32 v[62:63],v[214:215],v[210:211]
v_pk_fma_f32 v[212:213],v[208:209],4.0,v[212:213] op_sel_hi:[1,0,1]
v_pk_fma_f32 v[214:215],v[210:211],4.0,v[214:215] op_sel_hi:[1,0,1]
v_pk_fma_f32 v[208:209],v[156:157],2.0,v[204:205] op_sel_hi:[1,0,1]
v_pk_fma_f32 v[210:211],v[158:159],2.0,v[206:207] op_sel_hi:[1,0,1]
v_pk_fma_f32 v[156:157],v[156:157],s[40:41],v[204:205] op_sel_hi:[1,0,1]
v_pk_fma_f32 v[158:159],v[158:159],s[40:41],v[206:207] op_sel_hi:[1,0,1]
M v[112:115],a[236:239],a[96:99],v[112:115]
s_add_u32 s47,s75,49152
ds_read_b128 a[152:155],v249 offset:2048
v_cvt_pk_bf16_f32 v208,v208,v209
M v[112:115],a[232:235],a[100:103],v[112:115]
s_waitcnt lgkmcnt(3)
ds_read_b128 v[220:223],v248 offset:2048
v_cvt_pk_bf16_f32 v209,v210,v211
M v[112:115],a[192:195],a[140:143],v[112:115]
s_waitcnt lgkmcnt(3)
s_add_u32 s34,s32,1376256
buffer_store_dwordx4 a[28:31],v253,s[24:27],s34 offen offset:384 nt
M v[116:119],a[192:195],a[144:147],v[116:119]
v_cvt_pk_bf16_f32 v212,v212,v213
v_cvt_pk_bf16_f32 v213,v214,v215
M v[116:119],a[232:235],a[140:143],v[116:119]
ds_write2st64_b64 v254,v[208:209],v[212:213] offset0:76 offset1:80
M v[116:119],a[236:239],a[100:103],v[116:119]
s_add_u32 s28,s66,6684672
buffer_load_dwordx2 v[204:205],v245,s[12:15],s28 offen offset:0
M v[120:123],a[236:239],a[140:143],v[120:123]
v_cvt_pk_bf16_f32 v0,v0,v1
v_cvt_pk_bf16_f32 v1,v2,v3
M v[120:123],a[232:235],a[144:147],v[120:123]
s_waitcnt lgkmcnt(2)
buffer_load_dwordx2 v[214:215],v245,s[16:19],s28 offen offset:1536
M v[120:123],a[192:195],a[152:155],v[120:123]
s_waitcnt lgkmcnt(1)
v_cvt_pk_bf16_f32 v4,v4,v5
v_cvt_pk_bf16_f32 v5,v6,v7
M v[124:127],a[192:195],v[220:223],v[124:127]
s_waitcnt lgkmcnt(0)
s_barrier
ds_read_b128 a[48:51],v250 offset:60928
M v[124:127],a[232:235],a[152:155],v[124:127]
ds_read_b128 a[52:55],v250 offset:65024
ds_read_b128 a[56:59],v250 offset:34816
M v[124:127],a[236:239],a[144:147],v[124:127]
s_waitcnt vmcnt(27)
buffer_load_dwordx2 v[206:207],v245,s[8:11],s28 offen offset:0
ds_read_b128 a[60:63],v250 offset:38912
M v[128:131],a[112:115],a[248:251],v[128:131]
s_waitcnt vmcnt(27)
ds_write2st64_b64 v254,v[0:1],v[4:5] offset0:34 offset1:38
M v[128:131],a[124:127],a[132:135],v[128:131]
s_waitcnt vmcnt(26)
v_cvt_pk_bf16_f32 v8,v8,v9
v_cvt_pk_bf16_f32 v9,v10,v11
M v[128:131],a[120:123],a[148:151],v[128:131]
buffer_load_dwordx2 v[208:209],v245,s[8:11],s28 offen offset:384
v_cvt_pk_bf16_f32 v12,v12,v13
v_cvt_pk_bf16_f32 v13,v14,v15
M v[132:135],a[120:123],a[240:243],v[132:135]
ds_write2st64_b64 v254,v[8:9],v[12:13] offset0:42 offset1:46
M v[132:135],a[124:127],a[148:151],v[132:135]
v_cvt_pk_bf16_f32 v16,v16,v17
v_cvt_pk_bf16_f32 v17,v18,v19
M v[132:135],a[112:115],a[132:135],v[132:135]
buffer_load_dwordx2 v[210:211],v245,s[8:11],s28 offen offset:768
M v[136:139],a[112:115],a[148:151],v[136:139]
v_cvt_pk_bf16_f32 v20,v20,v21
v_cvt_pk_bf16_f32 v21,v22,v23
M v[136:139],a[124:127],a[240:243],v[136:139]
ds_write2st64_b64 v254,v[16:17],v[20:21] offset0:51 offset1:55
M v[136:139],a[120:123],a[96:99],v[136:139]
s_add_u32 s34,s32,0
buffer_load_dwordx2 v[212:213],v245,s[8:11],s28 offen offset:1152
M v[140:143],a[120:123],a[100:103],v[140:143]
v_cvt_pk_bf16_f32 v24,v24,v25
v_cvt_pk_bf16_f32 v25,v26,v27
M v[140:143],a[124:127],a[96:99],v[140:143]
v_cvt_pk_bf16_f32 v28,v28,v29
v_cvt_pk_bf16_f32 v29,v30,v31
M v[140:143],a[112:115],a[240:243],v[140:143]
ds_write2st64_b64 v254,v[24:25],v[28:29] offset0:59 offset1:63
M v[144:147],a[112:115],a[96:99],v[144:147]
buffer_load_dwordx4 a[156:159],v250,s[20:23],s47 offen offset:0 sc1
M v[144:147],a[124:127],a[100:103],v[144:147]
v_add_u32 v248,0x15400,v248
v_add_u32 v249,0x15400,v249
M v[144:147],a[120:123],a[140:143],v[144:147]
v_accvgpr_read_b32 v238,a64
v_accvgpr_read_b32 v232,a160
v_add_f32 v234,v238,v232
v_sub_f32 v238,v238,v232
M v[148:151],a[120:123],a[144:147],v[148:151]
buffer_load_dwordx4 v[224:227],v250,s[20:23],s47 offen offset:1024 sc1
M v[148:151],a[124:127],a[140:143],v[148:151]
ds_read_b128 a[96:99],v248 offset:0
v_add_f32 v232,v64,v160
M v[148:151],a[112:115],a[100:103],v[148:151]
ds_read_b128 a[100:103],v249 offset:0
v_sub_f32 v160,v64,v160
v_add_f32 v64,v234,v232
v_fmac_f32 v234,4.0,v232
M v[152:155],a[112:115],a[140:143],v[152:155]
ds_read_b128 a[140:143],v248 offset:512
v_fma_f32 v232,2.0,v160,v238
M v[152:155],a[124:127],a[144:147],v[152:155]
buffer_load_dwordx4 v[228:231],v250,s[20:23],s47 offen offset:2048 sc1
M v[152:155],a[120:123],a[152:155],v[152:155]
s_add_u32 s46,s76,46080
ds_read_b128 a[200:203],v249 offset:512
v_fma_f32 v160,s40,v160,v238
v_accvgpr_read_b32 v238,a65
v_accvgpr_read_b32 v237,a161
v_add_f32 v236,v238,v237
M v[156:159],a[120:123],v[220:223],v[156:159]
v_sub_f32 v238,v238,v237
v_add_f32 v237,v65,v161
M v[156:159],a[124:127],a[152:155],v[156:159]
buffer_load_dwordx4 a[132:135],v250,s[20:23],s46 offen offset:0 sc1
M v[156:159],a[112:115],a[144:147],v[156:159]
s_waitcnt vmcnt(31) lgkmcnt(3)
v_sub_f32 v161,v65,v161
v_add_f32 v65,v236,v237
v_fmac_f32 v236,4.0,v237
v_fma_f32 v237,2.0,v161,v238
M v[96:99],a[108:111],a[96:99],v[96:99]
s_waitcnt vmcnt(30) lgkmcnt(2)
ds_read_b128 a[112:115],v248 offset:1024
v_fma_f32 v161,s40,v161,v238
M v[96:99],a[252:255],a[100:103],v[96:99]
s_waitcnt vmcnt(29) lgkmcnt(2)
buffer_load_dwordx4 a[148:151],v250,s[20:23],s46 offen offset:1024 sc1
M v[96:99],a[196:199],a[140:143],v[96:99]
s_waitcnt lgkmcnt(1)
ds_read_b128 a[120:123],v249 offset:1024
v_cvt_pk_bf16_f32 v232,v232,v237
v_cvt_pk_bf16_f32 v234,v234,v236
v_accvgpr_read_b32 v238,a66
v_accvgpr_read_b32 v233,a162
M v[100:103],a[196:199],a[200:203],v[100:103]
v_add_f32 v235,v238,v233
v_sub_f32 v238,v238,v233
M v[100:103],a[252:255],a[140:143],v[100:103]
v_add_f32 v233,v66,v162
v_sub_f32 v162,v66,v162
M v[100:103],a[108:111],a[100:103],v[100:103]
buffer_store_dwordx4 a[32:35],v253,s[24:27],s34 offen offset:512 nt
M v[104:107],a[108:111],a[140:143],v[104:107]
s_add_u32 s34,s32,196608
ds_read_b128 a[124:127],v248 offset:1536
v_add_f32 v66,v235,v233
M v[104:107],a[252:255],a[200:203],v[104:107]
s_waitcnt lgkmcnt(2)
ds_read_b128 a[144:147],v249 offset:1536
v_fmac_f32 v235,4.0,v233
M v[104:107],a[196:199],a[112:115],v[104:107]
s_waitcnt lgkmcnt(2)
buffer_load_dwordx4 a[224:227],v250,s[20:23],s46 offen offset:2048 sc1
v_fma_f32 v233,2.0,v162,v238
M v[108:111],a[196:199],a[120:123],v[108:111]
v_fma_f32 v162,s40,v162,v238
v_accvgpr_read_b32 v238,a67
M v[108:111],a[252:255],a[112:115],v[108:111]
v_accvgpr_read_b32 v237,a163
v_add_f32 v236,v238,v237
M v[108:111],a[108:111],a[200:203],v[108:111]
buffer_store_dwordx4 a[36:39],v253,s[24:27],s34 offen offset:512 nt
M v[112:115],a[108:111],a[112:115],v[112:115]
s_add_u32 s47,s76,49152
ds_read_b128 a[152:155],v249 offset:2048
v_sub_f32 v238,v238,v237
M v[112:115],a[252:255],a[120:123],v[112:115]
s_waitcnt lgkmcnt(2)
ds_read_b128 a[192:195],v248 offset:2048
v_add_f32 v237,v67,v163
M v[112:115],a[196:199],a[124:127],v[112:115]
s_waitcnt lgkmcnt(2)
v_sub_f32 v163,v67,v163
v_add_f32 v67,v236,v237
v_fmac_f32 v236,4.0,v237
M v[116:119],a[196:199],a[144:147],v[116:119]
v_fma_f32 v237,2.0,v163,v238
v_fma_f32 v163,s40,v163,v238
M v[116:119],a[252:255],a[124:127],v[116:119]
v_cvt_pk_bf16_f32 v233,v233,v237
v_cvt_pk_bf16_f32 v235,v235,v236
M v[116:119],a[108:111],a[120:123],v[116:119]
ds_write2st64_b64 v254,v[232:233],v[234:235] offset0:102 offset1:106
M v[120:123],a[108:111],a[124:127],v[120:123]
buffer_load_dwordx4 a[160:163],v250,s[20:23],s47 offen offset:0 sc1
M v[120:123],a[252:255],a[144:147],v[120:123]
s_waitcnt lgkmcnt(2)
v_accvgpr_read_b32 v238,a68
v_accvgpr_read_b32 v232,a164
M v[120:123],a[196:199],a[152:155],v[120:123]
s_waitcnt lgkmcnt(1)
s_add_u32 s34,s32,393216
buffer_load_dwordx4 a[232:235],v250,s[20:23],s47 offen offset:1024 sc1
v_add_f32 v234,v238,v232
v_sub_f32 v238,v238,v232
v_add_f32 v232,v68,v164
M v[124:127],a[196:199],a[192:195],v[124:127]
v_sub_f32 v164,v68,v164
v_add_f32 v68,v234,v232
M v[124:127],a[252:255],a[152:155],v[124:127]
v_fmac_f32 v234,4.0,v232
v_fma_f32 v232,2.0,v164,v238
M v[124:127],a[108:111],a[144:147],v[124:127]
s_waitcnt vmcnt(33)
v_fma_f32 v164,s40,v164,v238
v_accvgpr_read_b32 v238,a69
v_accvgpr_read_b32 v237,a165
v_add_f32 v236,v238,v237
M v[128:131],a[116:119],a[96:99],v[128:131]
s_waitcnt vmcnt(31)
buffer_load_dwordx4 a[236:239],v250,s[20:23],s47 offen offset:2048 sc1
M v[128:131],a[208:211],a[100:103],v[128:131]
s_waitcnt vmcnt(31)
v_sub_f32 v238,v238,v237
v_add_f32 v237,v69,v165
M v[128:131],a[204:207],a[140:143],v[128:131]
v_sub_f32 v165,v69,v165
v_add_f32 v69,v236,v237
v_fmac_f32 v236,4.0,v237
v_fma_f32 v237,2.0,v165,v238
v_fma_f32 v165,s40,v165,v238
M v[132:135],a[204:207],a[200:203],v[132:135]
v_cvt_pk_bf16_f32 v232,v232,v237
v_cvt_pk_bf16_f32 v234,v234,v236
M v[132:135],a[208:211],a[140:143],v[132:135]
v_accvgpr_read_b32 v238,a70
v_accvgpr_read_b32 v233,a166
M v[132:135],a[116:119],a[100:103],v[132:135]
buffer_store_dwordx4 a[40:43],v253,s[24:27],s34 offen offset:512 nt
M v[136:139],a[116:119],a[140:143],v[136:139]
v_add_f32 v235,v238,v233
v_sub_f32 v238,v238,v233
M v[136:139],a[208:211],a[200:203],v[136:139]
v_add_f32 v233,v70,v166
v_sub_f32 v166,v70,v166
M v[136:139],a[204:207],a[112:115],v[136:139]
v_add_f32 v70,v235,v233
v_fmac_f32 v235,4.0,v233
v_fma_f32 v233,2.0,v166,v238
M v[140:143],a[204:207],a[120:123],v[140:143]
v_fma_f32 v166,s40,v166,v238
v_accvgpr_read_b32 v238,a71
M v[140:143],a[208:211],a[112:115],v[140:143]
v_accvgpr_read_b32 v237,a167
v_add_f32 v236,v238,v237
M v[140:143],a[116:119],a[200:203],v[140:143]
v_sub_f32 v238,v238,v237
v_add_f32 v237,v71,v167
v_sub_f32 v167,v71,v167
v_add_f32 v71,v236,v237
v_fmac_f32 v236,4.0,v237
M v[144:147],a[116:119],a[112:115],v[144:147]
s_add_u32 s46,s77,46080
v_fma_f32 v237,2.0,v167,v238
v_fma_f32 v167,s40,v167,v238
M v[144:147],a[208:211],a[120:123],v[144:147]
v_cvt_pk_bf16_f32 v233,v233,v237
v_cvt_pk_bf16_f32 v235,v235,v236
M v[144:147],a[204:207],a[124:127],v[144:147]
s_add_u32 s34,s32,589824
buffer_store_dwordx4 a[44:47],v253,s[24:27],s34 offen offset:512 nt
M v[148:151],a[204:207],a[144:147],v[148:151]
ds_write2st64_b64 v254,v[232:233],v[234:235] offset0:110 offset1:114
M v[148:151],a[208:211],a[124:127],v[148:151]
ds_read_b128 a[96:99],v248 offset:17408
v_accvgpr_read_b32 v238,a72
M v[148:151],a[116:119],a[120:123],v[148:151]
ds_read_b128 a[100:103],v249 offset:17408
v_accvgpr_read_b32 v232,a168
M v[152:155],a[116:119],a[124:127],v[152:155]
buffer_load_dwordx4 a[108:111],v250,s[20:23],s46 offen offset:0 sc1
M v[152:155],a[208:211],a[144:147],v[152:155]
ds_read_b128 a[112:115],v248 offset:17920
ds_read_b128 a[124:127],v249 offset:17920
M v[152:155],a[204:207],a[152:155],v[152:155]
buffer_load_dwordx4 a[120:123],v250,s[20:23],s46 offen offset:1024 sc1
M v[156:159],a[204:207],a[192:195],v[156:159]
v_add_f32 v234,v238,v232
v_sub_f32 v238,v238,v232
M v[156:159],a[208:211],a[152:155],v[156:159]
v_add_f32 v232,v72,v168
v_sub_f32 v168,v72,v168
M v[156:159],a[116:119],a[144:147],v[156:159]
s_waitcnt vmcnt(33) lgkmcnt(3)
s_barrier
ds_read_b128 v[0:3],v250 offset:17408
ds_read_b128 v[8:11],v250 offset:21504
ds_read_b128 v[16:19],v250 offset:26112
ds_read_b128 v[24:27],v250 offset:30208
M v[96:99],a[136:139],a[96:99],v[96:99]
s_waitcnt vmcnt(32) lgkmcnt(6)
ds_read_b128 a[64:67],v250 offset:52224
ds_read_b128 a[68:71],v250 offset:56320
M v[96:99],a[220:223],a[100:103],v[96:99]
s_waitcnt vmcnt(31) lgkmcnt(7)
buffer_load_dwordx4 a[140:143],v250,s[20:23],s46 offen offset:2048 sc1
M v[96:99],a[228:231],a[112:115],v[96:99]
s_waitcnt lgkmcnt(6)
ds_read_b128 a[116:119],v248 offset:18432
ds_read_b128 a[144:147],v249 offset:18432
v_add_f32 v72,v234,v232
v_fmac_f32 v234,4.0,v232
v_fma_f32 v232,2.0,v168,v238
M v[100:103],a[228:231],a[124:127],v[100:103]
v_fma_f32 v168,s40,v168,v238
v_accvgpr_read_b32 v238,a73
M v[100:103],a[220:223],a[112:115],v[100:103]
v_accvgpr_read_b32 v237,a169
v_add_f32 v236,v238,v237
M v[100:103],a[136:139],a[100:103],v[100:103]
v_sub_f32 v238,v238,v237
v_add_f32 v237,v73,v169
v_sub_f32 v169,v73,v169
v_add_f32 v73,v236,v237
M v[104:107],a[136:139],a[112:115],v[104:107]
ds_read_b128 a[152:155],v248 offset:18944
v_fmac_f32 v236,4.0,v237
M v[104:107],a[220:223],a[124:127],v[104:107]
s_waitcnt lgkmcnt(2)
ds_read_b128 a[164:167],v249 offset:18944
v_fma_f32 v237,2.0,v169,v238
M v[104:107],a[228:231],a[116:119],v[104:107]
s_waitcnt lgkmcnt(2)
s_add_u32 s34,s32,786432
buffer_store_dwordx4 a[48:51],v253,s[24:27],s34 offen offset:512 nt
M v[108:111],a[228:231],a[144:147],v[108:111]
v_fma_f32 v169,s40,v169,v238
v_cvt_pk_bf16_f32 v232,v232,v237
M v[108:111],a[220:223],a[116:119],v[108:111]
v_cvt_pk_bf16_f32 v234,v234,v236
v_accvgpr_read_b32 v238,a74
M v[108:111],a[136:139],a[124:127],v[108:111]
v_accvgpr_read_b32 v233,a170
v_add_f32 v235,v238,v233
v_sub_f32 v238,v238,v233
M v[112:115],a[136:139],a[116:119],v[112:115]
s_add_u32 s47,s77,49152
ds_read_b128 a[248:251],v249 offset:19456
v_add_f32 v233,v74,v170
M v[112:115],a[220:223],a[144:147],v[112:115]
s_waitcnt lgkmcnt(2)
ds_read_b128 a[240:243],v248 offset:19456
v_sub_f32 v170,v74,v170
M v[112:115],a[228:231],a[152:155],v[112:115]
s_waitcnt lgkmcnt(2)
v_add_f32 v74,v235,v233
v_fmac_f32 v235,4.0,v233
v_fma_f32 v233,2.0,v170,v238
v_fma_f32 v170,s40,v170,v238
v_accvgpr_read_b32 v238,a75
M v[116:119],a[228:231],a[164:167],v[116:119]
v_accvgpr_read_b32 v237,a171
v_add_f32 v236,v238,v237
M v[116:119],a[220:223],a[152:155],v[116:119]
v_sub_f32 v238,v238,v237
v_add_f32 v237,v75,v171
M v[116:119],a[136:139],a[144:147],v[116:119]
v_sub_f32 v171,v75,v171
v_add_f32 v75,v236,v237
v_fmac_f32 v236,4.0,v237
v_fma_f32 v237,2.0,v171,v238
v_fma_f32 v171,s40,v171,v238
M v[120:123],a[136:139],a[152:155],v[120:123]
buffer_load_dwordx4 v[220:223],v250,s[20:23],s47 offen offset:0 sc1
M v[120:123],a[220:223],a[164:167],v[120:123]
s_waitcnt lgkmcnt(1)
v_cvt_pk_bf16_f32 v233,v233,v237
v_cvt_pk_bf16_f32 v235,v235,v236
M v[120:123],a[228:231],a[248:251],v[120:123]
s_waitcnt lgkmcnt(0)
buffer_load_dwordx4 a[196:199],v250,s[20:23],s47 offen offset:1024 sc1
M v[124:127],a[228:231],a[240:243],v[124:127]
ds_write2st64_b64 v254,v[232:233],v[234:235] offset0:119 offset1:123
M v[124:127],a[220:223],a[248:251],v[124:127]
v_accvgpr_read_b32 v238,a76
v_accvgpr_read_b32 v232,a172
M v[124:127],a[136:139],a[164:167],v[124:127]
s_waitcnt vmcnt(33)
v_add_f32 v234,v238,v232
v_sub_f32 v238,v238,v232
v_add_f32 v232,v76,v172
v_sub_f32 v172,v76,v172
M v[128:131],a[128:131],a[96:99],v[128:131]
s_waitcnt vmcnt(32)
buffer_load_dwordx4 a[252:255],v250,s[20:23],s47 offen offset:2048 sc1
M v[128:131],a[244:247],a[100:103],v[128:131]
s_waitcnt vmcnt(32)
v_add_f32 v76,v234,v232
v_fmac_f32 v234,4.0,v232
M v[128:131],a[216:219],a[112:115],v[128:131]
s_add_u32 s34,s32,983040
v_fma_f32 v232,2.0,v172,v238
v_fma_f32 v172,s40,v172,v238
v_accvgpr_read_b32 v238,a77
v_accvgpr_read_b32 v237,a173
M v[132:135],a[216:219],a[124:127],v[132:135]
v_add_f32 v236,v238,v237
v_sub_f32 v238,v238,v237
M v[132:135],a[244:247],a[112:115],v[132:135]
v_add_f32 v237,v77,v173
v_sub_f32 v173,v77,v173
M v[132:135],a[128:131],a[100:103],v[132:135]
buffer_store_dwordx4 a[52:55],v253,s[24:27],s34 offen offset:512 nt
M v[136:139],a[128:131],a[112:115],v[136:139]
v_add_f32 v77,v236,v237
v_fmac_f32 v236,4.0,v237
M v[136:139],a[244:247],a[124:127],v[136:139]
v_fma_f32 v237,2.0,v173,v238
v_fma_f32 v173,s40,v173,v238
M v[136:139],a[216:219],a[116:119],v[136:139]
v_cvt_pk_bf16_f32 v232,v232,v237
v_cvt_pk_bf16_f32 v234,v234,v236
v_accvgpr_read_b32 v238,a78
v_accvgpr_read_b32 v233,a174
M v[140:143],a[216:219],a[144:147],v[140:143]
v_add_f32 v235,v238,v233
v_sub_f32 v238,v238,v233
M v[140:143],a[244:247],a[116:119],v[140:143]
v_add_f32 v233,v78,v174
v_sub_f32 v174,v78,v174
M v[140:143],a[128:131],a[124:127],v[140:143]
v_add_f32 v78,v235,v233
v_fmac_f32 v235,4.0,v233
v_fma_f32 v233,2.0,v174,v238
v_fma_f32 v174,s40,v174,v238
M v[144:147],a[128:131],a[116:119],v[144:147]
s_add_u32 s47,s72,3072
v_accvgpr_read_b32 v238,a79
v_accvgpr_read_b32 v237,a175
M v[144:147],a[244:247],a[144:147],v[144:147]
v_add_f32 v236,v238,v237
v_sub_f32 v238,v238,v237
M v[144:147],a[216:219],a[152:155],v[144:147]
v_add_f32 v237,v79,v175
v_sub_f32 v175,v79,v175
v_add_f32 v79,v236,v237
v_fmac_f32 v236,4.0,v237
v_fma_f32 v237,2.0,v175,v238
M v[148:151],a[216:219],a[164:167],v[148:151]
v_fma_f32 v175,s40,v175,v238
v_cvt_pk_bf16_f32 v233,v233,v237
M v[148:151],a[244:247],a[152:155],v[148:151]
ds_read_b128 a[96:99],v248 offset:34816
v_cvt_pk_bf16_f32 v235,v235,v236
M v[148:151],a[128:131],a[144:147],v[148:151]
ds_read_b128 a[100:103],v249 offset:34816
ds_write2st64_b64 v254,v[232:233],v[234:235] offset0:127 offset1:131
M v[152:155],a[128:131],a[152:155],v[152:155]
buffer_load_dwordx4 a[112:115],v250,s[20:23],s47 offen offset:0 sc1
M v[152:155],a[244:247],a[164:167],v[152:155]
ds_read_b128 a[116:119],v248 offset:35328
ds_read_b128 a[136:139],v249 offset:35328
M v[152:155],a[216:219],a[248:251],v[152:155]
s_add_u32 s34,s32,1179648
buffer_load_dwordx4 a[124:127],v250,s[20:23],s47 offen offset:1024 sc1
v_accvgpr_read_b32 v238,a80
M v[156:159],a[216:219],a[240:243],v[156:159]
v_accvgpr_read_b32 v232,a176
v_add_f32 v234,v238,v232
M v[156:159],a[244:247],a[248:251],v[156:159]
v_sub_f32 v238,v238,v232
v_add_f32 v232,v80,v176
M v[156:159],a[128:131],a[164:167],v[156:159]
s_waitcnt vmcnt(33) lgkmcnt(4)
v_sub_f32 v176,v80,v176
v_add_f32 v80,v234,v232
v_fmac_f32 v234,4.0,v232
v_fma_f32 v232,2.0,v176,v238
v_fma_f32 v176,s40,v176,v238
M v[96:99],a[104:107],a[96:99],v[96:99]
s_waitcnt vmcnt(32) lgkmcnt(3)
buffer_load_dwordx4 a[144:147],v250,s[20:23],s47 offen offset:2048 sc1
M v[96:99],a[212:215],a[100:103],v[96:99]
s_waitcnt vmcnt(32) lgkmcnt(1)
ds_read_b128 a[128:131],v248 offset:35840
ds_read_b128 a[152:155],v249 offset:35840
M v[96:99],v[216:219],a[116:119],v[96:99]
s_waitcnt lgkmcnt(2)
v_accvgpr_read_b32 v238,a81
v_accvgpr_read_b32 v237,a177
v_add_f32 v236,v238,v237
M v[100:103],v[216:219],a[136:139],v[100:103]
v_sub_f32 v238,v238,v237
v_add_f32 v237,v81,v177
M v[100:103],a[212:215],a[116:119],v[100:103]
v_sub_f32 v177,v81,v177
v_add_f32 v81,v236,v237
M v[100:103],a[104:107],a[100:103],v[100:103]
buffer_store_dwordx4 a[56:59],v253,s[24:27],s34 offen offset:512 nt
M v[104:107],a[104:107],a[116:119],v[104:107]
ds_read_b128 a[164:167],v248 offset:36352
v_fmac_f32 v236,4.0,v237
M v[104:107],a[212:215],a[136:139],v[104:107]
s_waitcnt lgkmcnt(2)
ds_read_b128 a[168:171],v249 offset:36352
v_fma_f32 v237,2.0,v177,v238
M v[104:107],v[216:219],a[128:131],v[104:107]
s_waitcnt lgkmcnt(2)
v_fma_f32 v177,s40,v177,v238
v_cvt_pk_bf16_f32 v232,v232,v237
M v[108:111],v[216:219],a[152:155],v[108:111]
v_cvt_pk_bf16_f32 v234,v234,v236
v_accvgpr_read_b32 v238,a82
M v[108:111],a[212:215],a[128:131],v[108:111]
v_accvgpr_read_b32 v233,a178
v_add_f32 v235,v238,v233
M v[108:111],a[104:107],a[136:139],v[108:111]
v_sub_f32 v238,v238,v233
v_add_f32 v233,v82,v178
M v[112:115],a[104:107],a[128:131],v[112:115]
s_add_u32 s48,s72,6144
ds_read_b128 a[172:175],v249 offset:36864
v_sub_f32 v178,v82,v178
M v[112:115],a[212:215],a[152:155],v[112:115]
s_waitcnt lgkmcnt(2)
ds_read_b128 a[200:203],v248 offset:36864
v_add_f32 v82,v235,v233
M v[112:115],v[216:219],a[164:167],v[112:115]
s_waitcnt lgkmcnt(2)
s_add_u32 s34,s32,1376256
buffer_store_dwordx4 a[60:63],v253,s[24:27],s34 offen offset:512 nt
M v[116:119],v[216:219],a[168:171],v[116:119]
v_fmac_f32 v235,4.0,v233
v_fma_f32 v233,2.0,v178,v238
M v[116:119],a[212:215],a[164:167],v[116:119]
v_fma_f32 v178,s40,v178,v238
v_accvgpr_read_b32 v238,a83
M v[116:119],a[104:107],a[152:155],v[116:119]
v_accvgpr_read_b32 v237,a179
v_add_f32 v236,v238,v237
M v[120:123],a[104:107],a[164:167],v[120:123]
buffer_load_dwordx4 a[192:195],v250,s[20:23],s48 offen offset:0 sc1
M v[120:123],a[212:215],a[168:171],v[120:123]
s_waitcnt lgkmcnt(1)
v_sub_f32 v238,v238,v237
v_add_f32 v237,v83,v179
M v[120:123],v[216:219],a[172:175],v[120:123]
s_waitcnt lgkmcnt(0)
buffer_load_dwordx4 a[204:207],v250,s[20:23],s48 offen offset:1024 sc1
M v[124:127],v[216:219],a[200:203],v[124:127]
v_sub_f32 v179,v83,v179
v_add_f32 v83,v236,v237
M v[124:127],a[212:215],a[172:175],v[124:127]
v_fmac_f32 v236,4.0,v237
v_fma_f32 v237,2.0,v179,v238
M v[124:127],a[104:107],a[168:171],v[124:127]
s_waitcnt vmcnt(27)
v_fma_f32 v179,s40,v179,v238
v_cvt_pk_bf16_f32 v233,v233,v237
M v[128:131],a[156:159],a[96:99],v[128:131]
s_waitcnt vmcnt(26)
buffer_load_dwordx4 a[208:211],v250,s[20:23],s48 offen offset:2048 sc1
M v[128:131],v[224:227],a[100:103],v[128:131]
s_waitcnt vmcnt(26)
v_cvt_pk_bf16_f32 v235,v235,v236
M v[128:131],v[228:231],a[116:119],v[128:131]
ds_write2st64_b64 v254,v[232:233],v[234:235] offset0:68 offset1:72
M v[132:135],v[228:231],a[136:139],v[132:135]
v_accvgpr_read_b32 v238,a84
v_accvgpr_read_b32 v232,a180
M v[132:135],v[224:227],a[116:119],v[132:135]
v_add_f32 v234,v238,v232
v_sub_f32 v238,v238,v232
M v[132:135],a[156:159],a[100:103],v[132:135]
v_add_f32 v232,v84,v180
v_sub_f32 v180,v84,v180
M v[136:139],a[156:159],a[116:119],v[136:139]
v_add_f32 v84,v234,v232
v_fmac_f32 v234,4.0,v232
M v[136:139],v[224:227],a[136:139],v[136:139]
v_fma_f32 v232,2.0,v180,v238
v_fma_f32 v180,s40,v180,v238
M v[136:139],v[228:231],a[128:131],v[136:139]
s_add_u32 s34,s33,0
buffer_store_dwordx4 v[0:3],v253,s[24:27],s34 offen offset:0 nt
M v[140:143],v[228:231],a[152:155],v[140:143]
v_accvgpr_read_b32 v238,a85
v_accvgpr_read_b32 v237,a181
M v[140:143],v[224:227],a[128:131],v[140:143]
v_add_f32 v236,v238,v237
v_sub_f32 v238,v238,v237
M v[140:143],a[156:159],a[136:139],v[140:143]
v_add_f32 v237,v85,v181
v_sub_f32 v181,v85,v181
M v[144:147],a[156:159],a[128:131],v[144:147]
s_add_u32 s47,s73,3072
v_add_f32 v85,v236,v237
v_fmac_f32 v236,4.0,v237
M v[144:147],v[224:227],a[152:155],v[144:147]
v_fma_f32 v237,2.0,v181,v238
v_fma_f32 v181,s40,v181,v238
M v[144:147],v[228:231],a[164:167],v[144:147]
v_cvt_pk_bf16_f32 v232,v232,v237
v_cvt_pk_bf16_f32 v234,v234,v236
M v[148:151],v[228:231],a[168:171],v[148:151]
v_accvgpr_read_b32 v238,a86
v_accvgpr_read_b32 v233,a182
M v[148:151],v[224:227],a[164:167],v[148:151]
ds_read_b128 a[96:99],v248 offset:52224
v_add_f32 v235,v238,v233
M v[148:151],a[156:159],a[152:155],v[148:151]
ds_read_b128 a[100:103],v249 offset:52224
v_sub_f32 v238,v238,v233
M v[152:155],a[156:159],a[164:167],v[152:155]
buffer_load_dwordx4 a[104:107],v250,s[20:23],s47 offen offset:0 sc1
M v[152:155],v[224:227],a[168:171],v[152:155]
ds_read_b128 a[116:119],v248 offset:52736
ds_read_b128 a[136:139],v249 offset:52736
M v[152:155],v[228:231],a[172:175],v[152:155]
buffer_load_dwordx4 a[128:131],v250,s[20:23],s47 offen offset:1024 sc1
v_add_f32 v233,v86,v182
M v[156:159],v[228:231],a[200:203],v[156:159]
v_sub_f32 v182,v86,v182
v_add_f32 v86,v235,v233
M v[156:159],v[224:227],a[172:175],v[156:159]
v_fmac_f32 v235,4.0,v233
v_fma_f32 v233,2.0,v182,v238
M v[156:159],a[156:159],a[168:171],v[156:159]
s_waitcnt vmcnt(28) lgkmcnt(3)
v_fma_f32 v182,s40,v182,v238
v_accvgpr_read_b32 v238,a87
v_accvgpr_read_b32 v237,a183
M v[96:99],a[132:135],a[96:99],v[96:99]
s_waitcnt vmcnt(27) lgkmcnt(2)
buffer_load_dwordx4 a[152:155],v250,s[20:23],s47 offen offset:2048 sc1
M v[96:99],a[148:151],a[100:103],v[96:99]
s_waitcnt vmcnt(26) lgkmcnt(1)
ds_read_b128 a[156:159],v248 offset:53248
ds_read_b128 a[164:167],v249 offset:53248
M v[96:99],a[224:227],a[116:119],v[96:99]
s_waitcnt lgkmcnt(2)
s_add_u32 s34,s33,393216
v_add_f32 v236,v238,v237
v_sub_f32 v238,v238,v237
v_add_f32 v237,v87,v183
M v[100:103],a[224:227],a[136:139],v[100:103]
v_sub_f32 v183,v87,v183
v_add_f32 v87,v236,v237
M v[100:103],a[148:151],a[116:119],v[100:103]
v_fmac_f32 v236,4.0,v237
v_fma_f32 v237,2.0,v183,v238
M v[100:103],a[132:135],a[100:103],v[100:103]
buffer_store_dwordx4 v[8:11],v253,s[24:27],s34 offen offset:0 nt
M v[104:107],a[132:135],a[116:119],v[104:107]
ds_read_b128 a[168:171],v248 offset:53760
v_fma_f32 v183,s40,v183,v238
M v[104:107],a[148:151],a[136:139],v[104:107]
s_waitcnt lgkmcnt(2)
ds_read_b128 a[172:175],v249 offset:53760
v_cvt_pk_bf16_f32 v233,v233,v237
M v[104:107],a[224:227],a[156:159],v[104:107]
s_waitcnt lgkmcnt(2)
v_cvt_pk_bf16_f32 v235,v235,v236
M v[108:111],a[224:227],a[164:167],v[108:111]
ds_write2st64_b64 v254,v[232:233],v[234:235] offset0:76 offset1:80
M v[108:111],a[148:151],a[156:159],v[108:111]
v_accvgpr_read_b32 v238,a88
v_accvgpr_read_b32 v232,a184
M v[108:111],a[132:135],a[136:139],v[108:111]
v_add_f32 v234,v238,v232
v_sub_f32 v238,v238,v232
M v[112:115],a[132:135],a[156:159],v[112:115]
s_add_u32 s48,s73,6144
ds_read_b128 a[176:179],v249 offset:54272
v_add_f32 v232,v88,v184
M v[112:115],a[148:151],a[164:167],v[112:115]
s_waitcnt lgkmcnt(3)
ds_read_b128 a[180:183],v248 offset:54272
v_sub_f32 v184,v88,v184
M v[112:115],a[224:227],a[168:171],v[112:115]
s_waitcnt lgkmcnt(3)
v_add_f32 v88,v234,v232
v_fmac_f32 v234,4.0,v232
M v[116:119],a[224:227],a[172:175],v[116:119]
v_fma_f32 v232,2.0,v184,v238
v_fma_f32 v184,s40,v184,v238
M v[116:119],a[148:151],a[168:171],v[116:119]
v_accvgpr_read_b32 v238,a89
v_accvgpr_read_b32 v237,a185
M v[116:119],a[132:135],a[164:167],v[116:119]
v_add_f32 v236,v238,v237
v_sub_f32 v238,v238,v237
M v[120:123],a[132:135],a[168:171],v[120:123]
buffer_load_dwordx4 a[228:231],v250,s[20:23],s48 offen offset:0 sc1
M v[120:123],a[148:151],a[172:175],v[120:123]
s_waitcnt lgkmcnt(1)
v_add_f32 v237,v89,v185
v_sub_f32 v185,v89,v185
M v[120:123],a[224:227],a[176:179],v[120:123]
s_waitcnt lgkmcnt(0)
s_add_u32 s34,s33,786432
buffer_load_dwordx4 a[220:223],v250,s[20:23],s48 offen offset:1024 sc1
M v[124:127],a[224:227],a[180:183],v[124:127]
v_add_f32 v89,v236,v237
v_fmac_f32 v236,4.0,v237
M v[124:127],a[148:151],a[176:179],v[124:127]
v_fma_f32 v237,2.0,v185,v238
v_fma_f32 v185,s40,v185,v238
M v[124:127],a[132:135],a[172:175],v[124:127]
s_waitcnt vmcnt(27)
v_cvt_pk_bf16_f32 v232,v232,v237
v_cvt_pk_bf16_f32 v234,v234,v236
v_accvgpr_read_b32 v238,a90
M v[128:131],a[160:163],a[96:99],v[128:131]
s_waitcnt vmcnt(26)
buffer_load_dwordx4 a[216:219],v250,s[20:23],s48 offen offset:2048 sc1
M v[128:131],a[232:235],a[100:103],v[128:131]
s_waitcnt vmcnt(26)
v_accvgpr_read_b32 v233,a186
v_add_f32 v235,v238,v233
M v[128:131],a[236:239],a[116:119],v[128:131]
v_sub_f32 v238,v238,v233
v_add_f32 v233,v90,v186
v_sub_f32 v186,v90,v186
M v[132:135],a[236:239],a[136:139],v[132:135]
v_add_f32 v90,v235,v233
v_fmac_f32 v235,4.0,v233
M v[132:135],a[232:235],a[116:119],v[132:135]
v_fma_f32 v233,2.0,v186,v238
v_fma_f32 v186,s40,v186,v238
M v[132:135],a[160:163],a[100:103],v[132:135]
buffer_store_dwordx4 v[16:19],v253,s[24:27],s34 offen offset:0 nt
M v[136:139],a[160:163],a[116:119],v[136:139]
v_accvgpr_read_b32 v238,a91
v_accvgpr_read_b32 v237,a187
M v[136:139],a[232:235],a[136:139],v[136:139]
v_add_f32 v236,v238,v237
v_sub_f32 v238,v238,v237
M v[136:139],a[236:239],a[156:159],v[136:139]
v_add_f32 v237,v91,v187
v_sub_f32 v187,v91,v187
M v[140:143],a[236:239],a[164:167],v[140:143]
v_add_f32 v91,v236,v237
v_fmac_f32 v236,4.0,v237
M v[140:143],a[232:235],a[156:159],v[140:143]
v_fma_f32 v237,2.0,v187,v238
v_fma_f32 v187,s40,v187,v238
M v[140:143],a[160:163],a[136:139],v[140:143]
v_cvt_pk_bf16_f32 v233,v233,v237
v_cvt_pk_bf16_f32 v235,v235,v236
M v[144:147],a[160:163],a[156:159],v[144:147]
s_add_u32 s47,s74,3072
ds_write2st64_b64 v254,v[232:233],v[234:235] offset0:85 offset1:89
M v[144:147],a[232:235],a[164:167],v[144:147]
v_add_u32 v248,0xffffbc00,v248
v_add_u32 v249,0xffffbc00,v249
M v[144:147],a[236:239],a[168:171],v[144:147]
s_add_u32 s34,s33,1179648
buffer_store_dwordx4 v[24:27],v253,s[24:27],s34 offen offset:0 nt
M v[148:151],a[236:239],a[172:175],v[148:151]
v_accvgpr_read_b32 v238,a92
v_accvgpr_read_b32 v232,a188
M v[148:151],a[232:235],a[168:171],v[148:151]
ds_read_b128 a[96:99],v248 offset:0
v_add_f32 v234,v238,v232
M v[148:151],a[160:163],a[164:167],v[148:151]
ds_read_b128 a[100:103],v249 offset:0
v_sub_f32 v238,v238,v232
M v[152:155],a[160:163],a[168:171],v[152:155]
buffer_load_dwordx4 a[116:119],v250,s[20:23],s47 offen offset:0 sc1
M v[152:155],a[232:235],a[172:175],v[152:155]
ds_read_b128 a[132:135],v248 offset:512
ds_read_b128 a[148:151],v249 offset:512
M v[152:155],a[236:239],a[176:179],v[152:155]
buffer_load_dwordx4 a[136:139],v250,s[20:23],s47 offen offset:1024 sc1
M v[156:159],a[236:239],a[180:183],v[156:159]
v_add_f32 v232,v92,v188
v_sub_f32 v188,v92,v188
M v[156:159],a[232:235],a[176:179],v[156:159]
v_add_f32 v92,v234,v232
v_fmac_f32 v234,4.0,v232
M v[156:159],a[160:163],a[172:175],v[156:159]
s_waitcnt vmcnt(27) lgkmcnt(3)
v_fma_f32 v232,2.0,v188,v238
v_fma_f32 v188,s40,v188,v238
M v[96:99],a[108:111],a[96:99],v[96:99]
s_waitcnt vmcnt(26) lgkmcnt(2)
buffer_load_dwordx4 a[156:159],v250,s[20:23],s47 offen offset:2048 sc1
M v[96:99],a[120:123],a[100:103],v[96:99]
s_waitcnt vmcnt(26) lgkmcnt(1)
ds_read_b128 a[160:163],v248 offset:1024
ds_read_b128 a[164:167],v249 offset:1024
M v[96:99],a[140:143],a[132:135],v[96:99]
s_waitcnt lgkmcnt(2)
v_accvgpr_read_b32 v238,a93
v_accvgpr_read_b32 v237,a189
M v[100:103],a[140:143],a[148:151],v[100:103]
v_add_f32 v236,v238,v237
v_sub_f32 v238,v238,v237
M v[100:103],a[120:123],a[132:135],v[100:103]
v_add_f32 v237,v93,v189
v_sub_f32 v189,v93,v189
M v[100:103],a[108:111],a[100:103],v[100:103]
v_add_f32 v93,v236,v237
v_fmac_f32 v236,4.0,v237
M v[104:107],a[108:111],a[132:135],v[104:107]
ds_read_b128 a[168:171],v248 offset:1536
v_fma_f32 v237,2.0,v189,v238
M v[104:107],a[120:123],a[148:151],v[104:107]
s_waitcnt lgkmcnt(2)
ds_read_b128 a[172:175],v249 offset:1536
v_fma_f32 v189,s40,v189,v238
M v[104:107],a[140:143],a[160:163],v[104:107]
s_waitcnt lgkmcnt(2)
s_add_u32 s34,s32,0
buffer_store_dwordx4 a[64:67],v253,s[24:27],s34 offen offset:640 nt
M v[108:111],a[140:143],a[164:167],v[108:111]
v_cvt_pk_bf16_f32 v232,v232,v237
v_cvt_pk_bf16_f32 v234,v234,v236
M v[108:111],a[120:123],a[160:163],v[108:111]
v_accvgpr_read_b32 v238,a94
v_accvgpr_read_b32 v233,a190
M v[108:111],a[108:111],a[148:151],v[108:111]
v_add_f32 v235,v238,v233
v_sub_f32 v238,v238,v233
M v[112:115],a[108:111],a[160:163],v[112:115]
s_add_u32 s48,s74,6144
ds_read_b128 a[176:179],v249 offset:2048
v_add_f32 v233,v94,v190
M v[112:115],a[120:123],a[164:167],v[112:115]
s_waitcnt lgkmcnt(2)
ds_read_b128 a[180:183],v248 offset:2048
v_sub_f32 v190,v94,v190
M v[112:115],a[140:143],a[168:171],v[112:115]
s_waitcnt lgkmcnt(2)
v_add_f32 v94,v235,v233
v_fmac_f32 v235,4.0,v233
M v[116:119],a[140:143],a[172:175],v[116:119]
v_fma_f32 v233,2.0,v190,v238
v_fma_f32 v190,s40,v190,v238
M v[116:119],a[120:123],a[168:171],v[116:119]
v_accvgpr_read_b32 v238,a95
v_accvgpr_read_b32 v237,a191
M v[116:119],a[108:111],a[164:167],v[116:119]
v_add_f32 v236,v238,v237
v_sub_f32 v238,v238,v237
M v[120:123],a[108:111],a[168:171],v[120:123]
buffer_load_dwordx4 a[184:187],v250,s[20:23],s48 offen offset:0 sc1
M v[120:123],a[120:123],a[172:175],v[120:123]
s_waitcnt lgkmcnt(1)
v_add_f32 v237,v95,v191
v_sub_f32 v191,v95,v191
M v[120:123],a[140:143],a[176:179],v[120:123]
s_waitcnt lgkmcnt(0)
buffer_load_dwordx4 a[240:243],v250,s[20:23],s48 offen offset:1024 sc1
v_add_f32 v95,v236,v237
M v[124:127],a[140:143],a[180:183],v[124:127]
v_fmac_f32 v236,4.0,v237
v_fma_f32 v237,2.0,v191,v238
M v[124:127],a[120:123],a[176:179],v[124:127]
v_fma_f32 v191,s40,v191,v238
v_cvt_pk_bf16_f32 v233,v233,v237
M v[124:127],a[108:111],a[172:175],v[124:127]
s_waitcnt vmcnt(27)
v_cvt_pk_bf16_f32 v235,v235,v236
M v[128:131],v[220:223],a[96:99],v[128:131]
s_waitcnt vmcnt(26)
buffer_load_dwordx4 a[244:247],v250,s[20:23],s48 offen offset:2048 sc1
M v[128:131],a[196:199],a[100:103],v[128:131]
s_waitcnt vmcnt(26)
ds_write2st64_b64 v254,v[232:233],v[234:235] offset0:93 offset1:97
M v[128:131],a[252:255],a[132:135],v[128:131]
s_add_u32 s34,s32,196608
v_cvt_pk_bf16_f32 v96,v96,v97
v_cvt_pk_bf16_f32 v97,v98,v99
M v[132:135],a[252:255],a[148:151],v[132:135]
v_cvt_pk_bf16_f32 v100,v100,v101
v_cvt_pk_bf16_f32 v101,v102,v103
M v[132:135],a[196:199],a[132:135],v[132:135]
s_waitcnt lgkmcnt(0)
s_barrier
ds_read_b128 a[72:75],v250 offset:60928
M v[132:135],v[220:223],a[100:103],v[132:135]
ds_read_b128 a[76:79],v250 offset:65024
ds_read_b128 a[80:83],v250 offset:34816
M v[136:139],v[220:223],a[132:135],v[136:139]
ds_read_b128 a[84:87],v250 offset:38912
ds_read_b128 a[88:91],v250 offset:43520
M v[136:139],a[196:199],a[148:151],v[136:139]
ds_read_b128 a[92:95],v250 offset:47616
v_add_u32 v4,69632,v250
M v[136:139],a[252:255],a[160:163],v[136:139]
buffer_store_dwordx4 a[68:71],v253,s[24:27],s34 offen offset:640 nt
M v[140:143],a[252:255],a[164:167],v[140:143]
ds_write2st64_b64 v254,v[96:97],v[100:101] offset0:34 offset1:38
M v[140:143],a[196:199],a[160:163],v[140:143]
v_cvt_pk_bf16_f32 v104,v104,v105
v_cvt_pk_bf16_f32 v105,v106,v107
M v[140:143],v[220:223],a[148:151],v[140:143]
v_cvt_pk_bf16_f32 v108,v108,v109
v_cvt_pk_bf16_f32 v109,v110,v111
M v[144:147],v[220:223],a[160:163],v[144:147]
s_add_u32 s47,s75,3072
ds_write2st64_b64 v254,v[104:105],v[108:109] offset0:42 offset1:46
M v[144:147],a[196:199],a[164:167],v[144:147]
v_add_u32 v248,0xfffece00,v248
v_add_u32 v249,0xfffece00,v249
M v[144:147],a[252:255],a[168:171],v[144:147]
v_cvt_pk_bf16_f32 v112,v112,v113
v_cvt_pk_bf16_f32 v113,v114,v115
M v[148:151],a[252:255],a[172:175],v[148:151]
v_cvt_pk_bf16_f32 v116,v116,v117
v_cvt_pk_bf16_f32 v117,v118,v119
M v[148:151],a[196:199],a[168:171],v[148:151]
ds_read_b128 a[96:99],v248 offset:0
ds_write2st64_b64 v254,v[112:113],v[116:117] offset0:51 offset1:55
M v[148:151],v[220:223],a[164:167],v[148:151]
ds_read_b128 a[100:103],v249 offset:0
v_cvt_pk_bf16_f32 v120,v120,v121
M v[152:155],v[220:223],a[168:171],v[152:155]
buffer_load_dwordx4 a[108:111],v250,s[20:23],s47 offen offset:0 sc1
M v[152:155],a[196:199],a[172:175],v[152:155]
ds_read_b128 a[120:123],v248 offset:512
ds_read_b128 a[140:143],v249 offset:512
M v[152:155],a[252:255],a[176:179],v[152:155]
s_add_u32 s34,s32,393216
buffer_load_dwordx4 a[132:135],v250,s[20:23],s47 offen offset:1024 sc1
M v[156:159],a[252:255],a[180:183],v[156:159]
v_cvt_pk_bf16_f32 v121,v122,v123
v_cvt_pk_bf16_f32 v124,v124,v125
M v[156:159],a[196:199],a[176:179],v[156:159]
v_cvt_pk_bf16_f32 v125,v126,v127
M v[156:159],v[220:223],a[172:175],v[156:159]
s_waitcnt vmcnt(27) lgkmcnt(4)
ds_write2st64_b64 v254,v[120:121],v[124:125] offset0:59 offset1:63
M v[32:35],a[112:115],a[96:99],v[32:35]
s_waitcnt vmcnt(26) lgkmcnt(3)
buffer_load_dwordx4 a[148:151],v250,s[20:23],s47 offen offset:2048 sc1
M v[32:35],a[124:127],a[100:103],v[32:35]
s_waitcnt vmcnt(26) lgkmcnt(2)
ds_read_b128 a[160:163],v248 offset:1024
ds_read_b128 a[164:167],v249 offset:1024
M v[32:35],a[144:147],a[120:123],v[32:35]
s_waitcnt lgkmcnt(3)
v_cvt_pk_bf16_f32 v128,v128,v129
v_cvt_pk_bf16_f32 v129,v130,v131
M v[36:39],a[144:147],a[140:143],v[36:39]
v_cvt_pk_bf16_f32 v132,v132,v133
v_cvt_pk_bf16_f32 v133,v134,v135
M v[36:39],a[124:127],a[120:123],v[36:39]
s_waitcnt lgkmcnt(2)
s_barrier
ds_read_b128 v[96:99],v250 offset:17408
M v[36:39],a[112:115],a[100:103],v[36:39]
ds_read_b128 v[104:107],v250 offset:21504
ds_read_b128 v[112:115],v250 offset:26112
M v[40:43],a[112:115],a[120:123],v[40:43]
ds_read_b128 v[120:123],v250 offset:30208
ds_read_b128 a[168:171],v248 offset:1536
M v[40:43],a[124:127],a[140:143],v[40:43]
s_waitcnt lgkmcnt(6)
ds_read_b128 a[172:175],v249 offset:1536
ds_write2st64_b64 v254,v[128:129],v[132:133] offset0:119 offset1:123
M v[40:43],a[144:147],a[160:163],v[40:43]
s_waitcnt lgkmcnt(7)
buffer_store_dwordx4 a[72:75],v253,s[24:27],s34 offen offset:640 nt
M v[44:47],a[144:147],a[164:167],v[44:47]
v_cvt_pk_bf16_f32 v136,v136,v137
v_cvt_pk_bf16_f32 v137,v138,v139
M v[44:47],a[124:127],a[160:163],v[44:47]
v_cvt_pk_bf16_f32 v140,v140,v141
v_cvt_pk_bf16_f32 v141,v142,v143
M v[44:47],a[112:115],a[140:143],v[44:47]
ds_write2st64_b64 v254,v[136:137],v[140:141] offset0:127 offset1:131
M v[48:51],a[112:115],a[160:163],v[48:51]
ds_read_b128 a[176:179],v249 offset:2048
v_cvt_pk_bf16_f32 v144,v144,v145
M v[48:51],a[124:127],a[164:167],v[48:51]
s_waitcnt lgkmcnt(4)
ds_read_b128 a[180:183],v248 offset:2048
v_cvt_pk_bf16_f32 v145,v146,v147
M v[48:51],a[144:147],a[168:171],v[48:51]
s_waitcnt lgkmcnt(4)
s_add_u32 s34,s32,589824
buffer_store_dwordx4 a[76:79],v253,s[24:27],s34 offen offset:640 nt
M v[52:55],a[144:147],a[172:175],v[52:55]
v_cvt_pk_bf16_f32 v148,v148,v149
v_cvt_pk_bf16_f32 v149,v150,v151
M v[52:55],a[124:127],a[168:171],v[52:55]
ds_write2st64_b64 v254,v[144:145],v[148:149] offset0:68 offset1:72
M v[52:55],a[112:115],a[164:167],v[52:55]
v_cvt_pk_bf16_f32 v152,v152,v153
v_cvt_pk_bf16_f32 v153,v154,v155
M v[56:59],a[112:115],a[168:171],v[56:59]
global_load_dword a188,v250,s[64:65]
M v[56:59],a[124:127],a[172:175],v[56:59]
s_waitcnt lgkmcnt(2)
s_add_u32 s48,s75,6144
buffer_load_dwordx4 a[188:191],v250,s[20:23],s48 offen offset:0 sc1
M v[56:59],a[144:147],a[176:179],v[56:59]
s_waitcnt lgkmcnt(1)
v_cvt_pk_bf16_f32 v156,v156,v157
v_cvt_pk_bf16_f32 v157,v158,v159
M v[60:63],a[144:147],a[180:183],v[60:63]
ds_write2st64_b64 v254,v[152:153],v[156:157] offset0:76 offset1:80
M v[60:63],a[124:127],a[176:179],v[60:63]
buffer_load_dwordx4 a[248:251],v250,s[20:23],s48 offen offset:1024 sc1
M v[60:63],a[112:115],a[172:175],v[60:63]
s_waitcnt vmcnt(28)
v_lshlrev_b32 v234,16,v208
v_lshlrev_b32 v232,16,v204
M v[64:67],a[192:195],a[96:99],v[64:67]
s_waitcnt vmcnt(27)
v_lshlrev_b32 v233,16,v206
v_lshlrev_b32 v237,16,v214
M v[64:67],a[204:207],a[100:103],v[64:67]
s_waitcnt vmcnt(26)
v_lshlrev_b32 v236,16,v212
v_lshlrev_b32 v235,16,v210
M v[64:67],a[208:211],a[120:123],v[64:67]
s_waitcnt lgkmcnt(0)
s_barrier
ds_read_b128 v[128:131],v250 offset:60928
M v[68:71],a[208:211],a[140:143],v[68:71]
ds_read_b128 v[136:139],v250 offset:65024
ds_read_b128 v[144:147],v250 offset:34816
M v[68:71],a[204:207],a[120:123],v[68:71]
ds_read_b128 v[152:155],v250 offset:38912
v_fmac_f32 v232,s43,v234
M v[68:71],a[192:195],a[100:103],v[68:71]
buffer_load_dwordx4 v[216:219],v250,s[20:23],s48 offen offset:2048 sc1
M v[72:75],a[192:195],a[120:123],v[72:75]
v_fmac_f32 v237,4.0,v233
v_fma_f32 v238,-4.0,v234,v236
M v[72:75],a[204:207],a[140:143],v[72:75]
v_fmac_f32 v232,s45,v236
v_fmac_f32 v237,s41,v235
M v[72:75],a[208:211],a[160:163],v[72:75]
s_add_u32 s34,s32,786432
buffer_store_dwordx4 a[80:83],v253,s[24:27],s34 offen offset:640 nt
M v[76:79],a[208:211],a[164:167],v[76:79]
v_sub_f32 v236,v236,v234
v_fma_f32 v234,-4.0,v233,v235
M v[76:79],a[204:207],a[160:163],v[76:79]
v_sub_f32 v235,v235,v233
v_add_f32 v233,v238,v234
M v[76:79],a[192:195],a[140:143],v[76:79]
v_sub_f32 v238,v238,v234
v_fma_f32 v234,2.0,v235,v236
M v[80:83],a[192:195],a[160:163],v[80:83]
s_add_u32 s47,s76,3072
v_fmac_f32 v236,-2.0,v235
v_and_b32 v208,s42,v208
M v[80:83],a[204:207],a[164:167],v[80:83]
v_add_u32 v248,0x15400,v248
v_add_u32 v249,0x15400,v249
M v[80:83],a[208:211],a[168:171],v[80:83]
v_and_b32 v204,s42,v204
v_and_b32 v206,s42,v206
M v[84:87],a[208:211],a[172:175],v[84:87]
v_and_b32 v214,s42,v214
v_and_b32 v212,s42,v212
M v[84:87],a[204:207],a[168:171],v[84:87]
ds_read_b128 a[96:99],v248 offset:0
v_and_b32 v210,s42,v210
M v[84:87],a[192:195],a[164:167],v[84:87]
ds_read_b128 a[100:103],v249 offset:0
v_fmac_f32 v204,s43,v208
M v[88:91],a[192:195],a[168:171],v[88:91]
buffer_load_dwordx4 a[112:115],v250,s[20:23],s47 offen offset:0 sc1
M v[88:91],a[204:207],a[172:175],v[88:91]
ds_read_b128 a[120:123],v248 offset:512
ds_read_b128 a[140:143],v249 offset:512
M v[88:91],a[208:211],a[176:179],v[88:91]
buffer_load_dwordx4 a[124:127],v250,s[20:23],s47 offen offset:1024 sc1
M v[92:95],a[208:211],a[180:183],v[92:95]
v_fmac_f32 v214,4.0,v206
v_fma_f32 v235,-4.0,v208,v212
M v[92:95],a[204:207],a[176:179],v[92:95]
v_fmac_f32 v204,s45,v212
v_fmac_f32 v214,s41,v210
M v[92:95],a[192:195],a[172:175],v[92:95]
s_waitcnt vmcnt(28) lgkmcnt(3)
v_sub_f32 v212,v212,v208
v_fma_f32 v208,-4.0,v206,v210
M v[32:35],a[104:107],a[96:99],v[32:35]
s_waitcnt vmcnt(27) lgkmcnt(2)
buffer_load_dwordx4 a[144:147],v250,s[20:23],s47 offen offset:2048 sc1
M v[32:35],a[128:131],a[100:103],v[32:35]
s_waitcnt vmcnt(27) lgkmcnt(1)
ds_read_b128 a[160:163],v248 offset:1024
ds_read_b128 a[164:167],v249 offset:1024
M v[32:35],a[152:155],a[120:123],v[32:35]
s_waitcnt lgkmcnt(2)
s_add_u32 s34,s32,983040
v_sub_f32 v210,v210,v206
v_add_f32 v206,v235,v208
M v[36:39],a[152:155],a[140:143],v[36:39]
v_sub_f32 v235,v235,v208
v_fma_f32 v208,2.0,v210,v212
M v[36:39],a[128:131],a[120:123],v[36:39]
v_fmac_f32 v212,-2.0,v210
v_cvt_pk_bf16_f32 v204,v232,v204
M v[36:39],a[104:107],a[100:103],v[36:39]
buffer_store_dwordx4 a[84:87],v253,s[24:27],s34 offen offset:640 nt
M v[40:43],a[104:107],a[120:123],v[40:43]
ds_read_b128 a[168:171],v248 offset:1536
v_cvt_pk_bf16_f32 v214,v237,v214
M v[40:43],a[128:131],a[140:143],v[40:43]
s_waitcnt lgkmcnt(2)
ds_read_b128 a[172:175],v249 offset:1536
v_cvt_pk_bf16_f32 v206,v233,v206
M v[40:43],a[152:155],a[160:163],v[40:43]
s_waitcnt lgkmcnt(2)
v_cvt_pk_bf16_f32 v210,v234,v208
v_cvt_pk_bf16_f32 v208,v238,v235
M v[44:47],a[152:155],a[164:167],v[44:47]
v_cvt_pk_bf16_f32 v212,v236,v212
v_lshlrev_b32 v234,16,v209
M v[44:47],a[128:131],a[160:163],v[44:47]
v_lshlrev_b32 v232,16,v205
v_lshlrev_b32 v233,16,v207
M v[44:47],a[104:107],a[140:143],v[44:47]
v_lshlrev_b32 v237,16,v215
v_lshlrev_b32 v236,16,v213
M v[48:51],a[104:107],a[160:163],v[48:51]
s_add_u32 s48,s76,6144
ds_read_b128 a[176:179],v249 offset:2048
v_lshlrev_b32 v235,16,v211
M v[48:51],a[128:131],a[164:167],v[48:51]
s_waitcnt lgkmcnt(2)
ds_read_b128 a[180:183],v248 offset:2048
v_fmac_f32 v232,s43,v234
M v[48:51],a[152:155],a[168:171],v[48:51]
s_waitcnt lgkmcnt(2)
v_fmac_f32 v237,4.0,v233
v_fma_f32 v238,-4.0,v234,v236
M v[52:55],a[152:155],a[172:175],v[52:55]
v_fmac_f32 v232,s45,v236
v_fmac_f32 v237,s41,v235
M v[52:55],a[128:131],a[168:171],v[52:55]
v_sub_f32 v236,v236,v234
v_fma_f32 v234,-4.0,v233,v235
M v[52:55],a[104:107],a[164:167],v[52:55]
v_sub_f32 v235,v235,v233
v_add_f32 v233,v238,v234
M v[56:59],a[104:107],a[168:171],v[56:59]
buffer_load_dwordx4 a[212:215],v250,s[20:23],s48 offen offset:0 sc1
M v[56:59],a[128:131],a[172:175],v[56:59]
s_waitcnt lgkmcnt(1)
v_sub_f32 v238,v238,v234
v_fma_f32 v234,2.0,v235,v236
M v[56:59],a[152:155],a[176:179],v[56:59]
s_waitcnt lgkmcnt(0)
s_add_u32 s34,s32,1179648
buffer_load_dwordx4 a[200:203],v250,s[20:23],s48 offen offset:1024 sc1
M v[60:63],a[152:155],a[180:183],v[60:63]
v_fmac_f32 v236,-2.0,v235
v_and_b32 v209,s42,v209
M v[60:63],a[128:131],a[176:179],v[60:63]
v_and_b32 v205,s42,v205
v_and_b32 v207,s42,v207
M v[60:63],a[104:107],a[172:175],v[60:63]
s_waitcnt vmcnt(28)
v_and_b32 v215,s42,v215
v_and_b32 v213,s42,v213
M v[64:67],a[228:231],a[96:99],v[64:67]
s_waitcnt vmcnt(27)
buffer_load_dwordx4 v[228:231],v250,s[20:23],s48 offen offset:2048 sc1
M v[64:67],a[220:223],a[100:103],v[64:67]
s_waitcnt vmcnt(27)
v_and_b32 v211,s42,v211
v_fmac_f32 v205,s43,v209
M v[64:67],a[216:219],a[120:123],v[64:67]
v_fmac_f32 v215,4.0,v207
v_fma_f32 v235,-4.0,v209,v213
M v[68:71],a[216:219],a[140:143],v[68:71]
v_fmac_f32 v205,s45,v213
v_fmac_f32 v215,s41,v211
M v[68:71],a[220:223],a[120:123],v[68:71]
v_sub_f32 v213,v213,v209
v_fma_f32 v209,-4.0,v207,v211
M v[68:71],a[228:231],a[100:103],v[68:71]
buffer_store_dwordx4 a[88:91],v253,s[24:27],s34 offen offset:640 nt
M v[72:75],a[228:231],a[120:123],v[72:75]
v_sub_f32 v211,v211,v207
v_add_f32 v207,v235,v209
M v[72:75],a[220:223],a[140:143],v[72:75]
v_sub_f32 v235,v235,v209
v_fma_f32 v209,2.0,v211,v213
M v[72:75],a[216:219],a[160:163],v[72:75]
v_fmac_f32 v213,-2.0,v211
v_cvt_pk_bf16_f32 v205,v232,v205
M v[76:79],a[216:219],a[164:167],v[76:79]
v_cvt_pk_bf16_f32 v215,v237,v215
v_cvt_pk_bf16_f32 v207,v233,v207
M v[76:79],a[220:223],a[160:163],v[76:79]
v_cvt_pk_bf16_f32 v211,v234,v209
v_cvt_pk_bf16_f32 v209,v238,v235
M v[76:79],a[228:231],a[140:143],v[76:79]
v_cvt_pk_bf16_f32 v213,v236,v213
M v[80:83],a[228:231],a[160:163],v[80:83]
s_add_u32 s47,s77,3072
M v[80:83],a[220:223],a[164:167],v[80:83]
s_barrier
v_fmac_f32 v239,s43,v241
M v[80:83],a[216:219],a[168:171],v[80:83]
s_add_u32 s34,s32,1376256
ds_write2st64_b64 v247,v[192:193],v[202:203] offset0:102 offset1:119
M v[84:87],a[216:219],a[172:175],v[84:87]
s_add_u32 s28,s66,7077888
buffer_load_dwordx2 v[192:193],v245,s[12:15],s28 offen offset:0
M v[84:87],a[220:223],a[168:171],v[84:87]
ds_read_b128 a[96:99],v248 offset:17408
v_fmac_f32 v244,4.0,v240
M v[84:87],a[228:231],a[164:167],v[84:87]
buffer_load_dwordx2 v[202:203],v245,s[16:19],s28 offen offset:1536
M v[88:91],a[228:231],a[168:171],v[88:91]
ds_read_b128 a[100:103],v249 offset:17408
ds_read_b128 a[120:123],v248 offset:17920
M v[88:91],a[220:223],a[172:175],v[88:91]
ds_read_b128 a[140:143],v249 offset:17920
v_fma_f32 v232,-4.0,v241,v243
M v[88:91],a[216:219],a[176:179],v[88:91]
ds_write2st64_b64 v247,v[194:195],v[196:197] offset0:34 offset1:51
M v[92:95],a[216:219],a[180:183],v[92:95]
buffer_load_dwordx2 v[194:195],v245,s[8:11],s28 offen offset:0
M v[92:95],a[220:223],a[176:179],v[92:95]
v_fmac_f32 v239,s45,v243
v_fmac_f32 v244,s41,v242
M v[92:95],a[228:231],a[172:175],v[92:95]
s_waitcnt vmcnt(28) lgkmcnt(4)
ds_write2st64_b64 v247,v[198:199],v[200:201] offset0:68 offset1:85
M v[32:35],a[116:119],a[96:99],v[32:35]
s_waitcnt vmcnt(27) lgkmcnt(4)
buffer_load_dwordx2 v[196:197],v245,s[8:11],s28 offen offset:384
M v[32:35],a[136:139],a[100:103],v[32:35]
s_waitcnt vmcnt(27) lgkmcnt(3)
ds_read_b128 a[160:163],v248 offset:18432
ds_read_b128 a[164:167],v249 offset:18432
M v[32:35],a[156:159],a[120:123],v[32:35]
s_waitcnt lgkmcnt(4)
ds_write2st64_b64 v247,v[204:205],v[214:215] offset0:103 offset1:120
M v[36:39],a[156:159],a[140:143],v[36:39]
buffer_load_dwordx2 v[198:199],v245,s[8:11],s28 offen offset:768
M v[36:39],a[136:139],a[120:123],v[36:39]
v_sub_f32 v243,v243,v241
v_fma_f32 v241,-4.0,v240,v242
M v[36:39],a[116:119],a[100:103],v[36:39]
ds_write2st64_b64 v247,v[206:207],v[208:209] offset0:35 offset1:52
M v[40:43],a[116:119],a[120:123],v[40:43]
buffer_load_dwordx2 v[200:201],v245,s[8:11],s28 offen offset:1152
M v[40:43],a[136:139],a[140:143],v[40:43]
s_waitcnt lgkmcnt(3)
s_add_u32 s28,s66,7471104
ds_read_b128 a[168:171],v248 offset:18944
ds_read_b128 a[172:175],v249 offset:18944
M v[40:43],a[156:159],a[160:163],v[40:43]
s_waitcnt lgkmcnt(4)
ds_write2st64_b64 v247,v[210:211],v[212:213] offset0:69 offset1:86
M v[44:47],a[156:159],a[164:167],v[44:47]
v_sub_f32 v242,v242,v240
v_add_f32 v240,v232,v241
M v[44:47],a[136:139],a[160:163],v[44:47]
buffer_load_dwordx2 v[204:205],v245,s[12:15],s28 offen offset:0
M v[44:47],a[116:119],a[140:143],v[44:47]
v_sub_f32 v232,v232,v241
v_fma_f32 v241,2.0,v242,v243
M v[48:51],a[116:119],a[160:163],v[48:51]
ds_read_b128 a[176:179],v249 offset:19456
v_fmac_f32 v243,-2.0,v242
M v[48:51],a[136:139],a[164:167],v[48:51]
s_waitcnt lgkmcnt(3)
ds_read_b128 a[180:183],v248 offset:19456
v_cvt_pk_bf16_f32 v233,v239,v244
M v[48:51],a[156:159],a[168:171],v[48:51]
s_waitcnt lgkmcnt(3)
buffer_load_dwordx2 v[214:215],v245,s[16:19],s28 offen offset:1536
M v[52:55],a[156:159],a[172:175],v[52:55]
v_cvt_pk_bf16_f32 v234,v240,v232
v_cvt_pk_bf16_f32 v235,v241,v243
M v[52:55],a[136:139],a[168:171],v[52:55]
ds_write_b16 v252,v233 offset:52224
M v[52:55],a[116:119],a[164:167],v[52:55]
ds_write_b16_d16_hi v252,v233 offset:60928
M v[56:59],a[116:119],a[168:171],v[56:59]
buffer_load_dwordx2 v[206:207],v245,s[8:11],s28 offen offset:0
M v[56:59],a[136:139],a[172:175],v[56:59]
s_waitcnt lgkmcnt(3)
ds_write_b16 v252,v234 offset:17408
M v[56:59],a[156:159],a[176:179],v[56:59]
s_waitcnt lgkmcnt(3)
ds_write_b16_d16_hi v252,v234 offset:26112
M v[60:63],a[156:159],a[180:183],v[60:63]
ds_write_b16 v252,v235 offset:34816
M v[60:63],a[136:139],a[176:179],v[60:63]
buffer_load_dwordx2 v[208:209],v245,s[8:11],s28 offen offset:384
M v[60:63],a[116:119],a[172:175],v[60:63]
s_waitcnt vmcnt(31)
ds_write_b16_d16_hi v252,v235 offset:43520
M v[64:67],a[184:187],a[96:99],v[64:67]
s_waitcnt vmcnt(30)
M v[64:67],a[240:243],a[100:103],v[64:67]
s_waitcnt vmcnt(29)
M v[64:67],a[244:247],a[120:123],v[64:67]
buffer_load_dwordx2 v[210:211],v245,s[8:11],s28 offen offset:768
M v[68:71],a[244:247],a[140:143],v[68:71]
M v[68:71],a[240:243],a[120:123],v[68:71]
M v[68:71],a[184:187],a[100:103],v[68:71]
M v[72:75],a[184:187],a[120:123],v[72:75]
buffer_load_dwordx2 v[212:213],v245,s[8:11],s28 offen offset:1152
M v[72:75],a[240:243],a[140:143],v[72:75]
s_add_u32 s29,s67,6291456
M v[72:75],a[244:247],a[160:163],v[72:75]
M v[76:79],a[244:247],a[164:167],v[76:79]
M v[76:79],a[240:243],a[160:163],v[76:79]
buffer_load_short_d16_hi v239,v246,s[12:15],s29 offen offset:0
M v[76:79],a[184:187],a[140:143],v[76:79]
M v[80:83],a[184:187],a[160:163],v[80:83]
buffer_load_short_d16_hi v240,v246,s[8:11],s29 offen offset:0
M v[80:83],a[240:243],a[164:167],v[80:83]
s_waitcnt vmcnt(10)
v_lshlrev_b32 v234,16,v196
v_lshlrev_b32 v232,16,v192
M v[80:83],a[244:247],a[168:171],v[80:83]
buffer_load_short_d16_hi v241,v246,s[8:11],s29 offen offset:384
M v[84:87],a[244:247],a[172:175],v[84:87]
v_lshlrev_b32 v233,16,v194
v_lshlrev_b32 v237,16,v202
M v[84:87],a[240:243],a[168:171],v[84:87]
buffer_load_short_d16_hi v242,v246,s[8:11],s29 offen offset:768
M v[84:87],a[184:187],a[164:167],v[84:87]
ds_read_b128 a[96:99],v248 offset:34816
ds_read_b128 a[100:103],v249 offset:34816
M v[88:91],a[184:187],a[168:171],v[88:91]
buffer_load_short_d16_hi v243,v246,s[8:11],s29 offen offset:1152
M v[88:91],a[240:243],a[172:175],v[88:91]
ds_read_b128 a[120:123],v248 offset:35328
ds_read_b128 a[140:143],v249 offset:35328
M v[88:91],a[244:247],a[176:179],v[88:91]
buffer_load_short_d16_hi v244,v246,s[16:19],s29 offen offset:1536
M v[92:95],a[244:247],a[180:183],v[92:95]
s_waitcnt vmcnt(12)
v_lshlrev_b32 v236,16,v200
v_lshlrev_b32 v235,16,v198
M v[92:95],a[240:243],a[176:179],v[92:95]
buffer_load_dwordx4 a[104:107],v250,s[20:23],s47 offen offset:0 sc1
M v[92:95],a[184:187],a[172:175],v[92:95]
s_waitcnt lgkmcnt(3)
v_fmac_f32 v232,s43,v234
v_fmac_f32 v237,4.0,v233
M v[32:35],a[108:111],a[96:99],v[32:35]
s_waitcnt lgkmcnt(2)
ds_read_b128 a[160:163],v248 offset:35840
v_fma_f32 v238,-4.0,v234,v236
M v[32:35],a[132:135],a[100:103],v[32:35]
s_waitcnt lgkmcnt(2)
ds_read_b128 a[164:167],v249 offset:35840
v_fmac_f32 v232,s45,v236
M v[32:35],a[148:151],a[120:123],v[32:35]
s_waitcnt lgkmcnt(2)
buffer_store_dwordx4 a[92:95],v253,s[24:27],s34 offen offset:640 nt
M v[36:39],a[148:151],a[140:143],v[36:39]
s_add_u32 s34,s33,0
v_fmac_f32 v237,s41,v235
v_sub_f32 v236,v236,v234
M v[36:39],a[132:135],a[120:123],v[36:39]
v_fma_f32 v234,-4.0,v233,v235
v_sub_f32 v235,v235,v233
M v[36:39],a[108:111],a[100:103],v[36:39]
buffer_load_dwordx4 a[128:131],v250,s[20:23],s47 offen offset:1024 sc1
M v[40:43],a[108:111],a[120:123],v[40:43]
ds_read_b128 a[168:171],v248 offset:36352
v_add_f32 v233,v238,v234
M v[40:43],a[132:135],a[140:143],v[40:43]
s_waitcnt lgkmcnt(2)
ds_read_b128 a[172:175],v249 offset:36352
v_sub_f32 v238,v238,v234
M v[40:43],a[148:151],a[160:163],v[40:43]
s_waitcnt lgkmcnt(2)
v_fma_f32 v234,2.0,v235,v236
v_fmac_f32 v236,-2.0,v235
M v[44:47],a[148:151],a[164:167],v[44:47]
buffer_load_dwordx4 a[152:155],v250,s[20:23],s47 offen offset:2048 sc1
M v[44:47],a[132:135],a[160:163],v[44:47]
s_add_u32 s48,s77,6144
v_and_b32 v196,s42,v196
v_and_b32 v192,s42,v192
M v[44:47],a[108:111],a[140:143],v[44:47]
v_and_b32 v194,s42,v194
v_and_b32 v202,s42,v202
M v[48:51],a[108:111],a[160:163],v[48:51]
ds_read_b128 a[176:179],v249 offset:36864
v_and_b32 v200,s42,v200
M v[48:51],a[132:135],a[164:167],v[48:51]
s_waitcnt lgkmcnt(2)
buffer_load_dwordx4 v[224:227],v250,s[20:23],s48 offen offset:0 sc1
M v[48:51],a[148:151],a[168:171],v[48:51]
s_waitcnt lgkmcnt(1)
ds_read_b128 a[180:183],v248 offset:36864
v_and_b32 v198,s42,v198
M v[52:55],a[148:151],a[172:175],v[52:55]
v_fmac_f32 v192,s43,v196
v_fmac_f32 v202,4.0,v194
M v[52:55],a[132:135],a[168:171],v[52:55]
v_fma_f32 v235,-4.0,v196,v200
v_fmac_f32 v192,s45,v200
M v[52:55],a[108:111],a[164:167],v[52:55]
buffer_store_dwordx4 v[96:99],v253,s[24:27],s34 offen offset:1152 nt
M v[56:59],a[108:111],a[168:171],v[56:59]
s_add_u32 s34,s33,393216
v_fmac_f32 v202,s41,v198
v_sub_f32 v200,v200,v196
M v[56:59],a[132:135],a[172:175],v[56:59]
s_waitcnt lgkmcnt(1)
v_fma_f32 v196,-4.0,v194,v198
v_sub_f32 v198,v198,v194
M v[56:59],a[148:151],a[176:179],v[56:59]
s_waitcnt lgkmcnt(0)
buffer_load_dwordx4 a[224:227],v250,s[20:23],s48 offen offset:1024 sc1
M v[60:63],a[148:151],a[180:183],v[60:63]
v_add_f32 v194,v235,v196
v_sub_f32 v235,v235,v196
M v[60:63],a[132:135],a[176:179],v[60:63]
v_fma_f32 v196,2.0,v198,v200
v_fmac_f32 v200,-2.0,v198
M v[60:63],a[108:111],a[172:175],v[60:63]
v_cvt_pk_bf16_f32 v192,v232,v192
v_cvt_pk_bf16_f32 v202,v237,v202
M v[64:67],a[188:191],a[96:99],v[64:67]
buffer_load_dwordx4 a[236:239],v250,s[20:23],s48 offen offset:2048 sc1
M v[64:67],a[248:251],a[100:103],v[64:67]
s_add_u32 s48,s72,52224
v_cvt_pk_bf16_f32 v194,v233,v194
v_cvt_pk_bf16_f32 v198,v234,v196
M v[64:67],v[216:219],a[120:123],v[64:67]
v_cvt_pk_bf16_f32 v196,v238,v235
v_cvt_pk_bf16_f32 v200,v236,v200
M v[68:71],v[216:219],a[140:143],v[68:71]
v_lshlrev_b32 v234,16,v197
v_lshlrev_b32 v232,16,v193
M v[68:71],a[248:251],a[120:123],v[68:71]
buffer_load_dwordx4 a[116:119],v250,s[20:23],s48 offen offset:0 sc1
M v[68:71],a[188:191],a[100:103],v[68:71]
v_lshlrev_b32 v233,16,v195
v_lshlrev_b32 v237,16,v203
M v[72:75],a[188:191],a[120:123],v[72:75]
v_lshlrev_b32 v236,16,v201
v_lshlrev_b32 v235,16,v199
M v[72:75],a[248:251],a[140:143],v[72:75]
v_fmac_f32 v232,s43,v234
v_fmac_f32 v237,4.0,v233
M v[72:75],v[216:219],a[160:163],v[72:75]
buffer_store_dwordx4 v[104:107],v253,s[24:27],s34 offen offset:1152 nt
M v[76:79],v[216:219],a[164:167],v[76:79]
s_add_u32 s34,s33,786432
v_fma_f32 v238,-4.0,v234,v236
v_fmac_f32 v232,s45,v236
M v[76:79],a[248:251],a[160:163],v[76:79]
v_fmac_f32 v237,s41,v235
v_sub_f32 v236,v236,v234
M v[76:79],a[188:191],a[140:143],v[76:79]
buffer_load_dwordx4 a[136:139],v250,s[20:23],s48 offen offset:1024 sc1
M v[80:83],a[188:191],a[160:163],v[80:83]
v_fma_f32 v234,-4.0,v233,v235
v_sub_f32 v235,v235,v233
M v[80:83],a[248:251],a[164:167],v[80:83]
v_add_f32 v233,v238,v234
v_sub_f32 v238,v238,v234
M v[80:83],v[216:219],a[168:171],v[80:83]
v_fma_f32 v234,2.0,v235,v236
v_fmac_f32 v236,-2.0,v235
M v[84:87],v[216:219],a[172:175],v[84:87]
buffer_load_dwordx4 a[156:159],v250,s[20:23],s48 offen offset:2048 sc1
M v[84:87],a[248:251],a[168:171],v[84:87]
s_add_u32 s48,s73,52224
ds_read_b128 a[96:99],v248 offset:52224
v_and_b32 v197,s42,v197
M v[84:87],a[188:191],a[164:167],v[84:87]
ds_read_b128 a[100:103],v249 offset:52224
v_and_b32 v193,s42,v193
M v[88:91],a[188:191],a[168:171],v[88:91]
ds_read_b128 a[120:123],v248 offset:52736
v_and_b32 v195,s42,v195
M v[88:91],a[248:251],a[172:175],v[88:91]
buffer_load_dwordx4 a[184:187],v250,s[20:23],s48 offen offset:0 sc1
M v[88:91],v[216:219],a[176:179],v[88:91]
ds_read_b128 a[140:143],v249 offset:52736
v_and_b32 v203,s42,v203
M v[92:95],v[216:219],a[180:183],v[92:95]
v_and_b32 v201,s42,v201
v_and_b32 v199,s42,v199
M v[92:95],a[248:251],a[176:179],v[92:95]
v_fmac_f32 v193,s43,v197
v_fmac_f32 v203,4.0,v195
M v[92:95],a[188:191],a[172:175],v[92:95]
s_waitcnt lgkmcnt(3)
buffer_store_dwordx4 v[112:115],v253,s[24:27],s34 offen offset:1152 nt
M v[32:35],a[112:115],a[96:99],v[32:35]
s_waitcnt lgkmcnt(2)
s_add_u32 s34,s33,1179648
ds_read_b128 a[160:163],v248 offset:53248
v_fma_f32 v235,-4.0,v197,v201
M v[32:35],a[124:127],a[100:103],v[32:35]
s_waitcnt lgkmcnt(2)
ds_read_b128 a[164:167],v249 offset:53248
v_fmac_f32 v193,s45,v201
M v[32:35],a[144:147],a[120:123],v[32:35]
s_waitcnt lgkmcnt(2)
buffer_store_dwordx4 v[120:123],v253,s[24:27],s34 offen offset:1152 nt
M v[36:39],a[144:147],a[140:143],v[36:39]
s_add_u32 s34,s33,0
v_fmac_f32 v203,s41,v199
v_sub_f32 v201,v201,v197
M v[36:39],a[124:127],a[120:123],v[36:39]
v_fma_f32 v197,-4.0,v195,v199
v_sub_f32 v199,v199,v195
M v[36:39],a[112:115],a[100:103],v[36:39]
buffer_load_dwordx4 a[232:235],v250,s[20:23],s48 offen offset:1024 sc1
M v[40:43],a[112:115],a[120:123],v[40:43]
ds_read_b128 a[168:171],v248 offset:53760
v_add_f32 v195,v235,v197
M v[40:43],a[124:127],a[140:143],v[40:43]
s_waitcnt lgkmcnt(2)
ds_read_b128 a[172:175],v249 offset:53760
v_sub_f32 v235,v235,v197
M v[40:43],a[144:147],a[160:163],v[40:43]
s_waitcnt lgkmcnt(2)
v_fma_f32 v197,2.0,v199,v201
v_fmac_f32 v201,-2.0,v199
M v[44:47],a[144:147],a[164:167],v[44:47]
buffer_load_dwordx4 a[252:255],v250,s[20:23],s48 offen offset:2048 sc1
M v[44:47],a[124:127],a[160:163],v[44:47]
s_add_u32 s48,s74,52224
v_cvt_pk_bf16_f32 v193,v232,v193
v_cvt_pk_bf16_f32 v203,v237,v203
M v[44:47],a[112:115],a[140:143],v[44:47]
v_cvt_pk_bf16_f32 v195,v233,v195
v_cvt_pk_bf16_f32 v199,v234,v197
M v[48:51],a[112:115],a[160:163],v[48:51]
ds_read_b128 a[176:179],v249 offset:54272
v_cvt_pk_bf16_f32 v197,v238,v235
M v[48:51],a[124:127],a[164:167],v[48:51]
s_waitcnt lgkmcnt(2)
buffer_load_dwordx4 a[108:111],v250,s[20:23],s48 offen offset:0 sc1
M v[48:51],a[144:147],a[168:171],v[48:51]
s_waitcnt lgkmcnt(1)
ds_read_b128 a[180:183],v248 offset:54272
v_cvt_pk_bf16_f32 v201,v236,v201
M v[52:55],a[144:147],a[172:175],v[52:55]
s_waitcnt vmcnt(26)
v_lshlrev_b32 v234,16,v208
v_lshlrev_b32 v232,16,v204
M v[52:55],a[124:127],a[168:171],v[52:55]
v_lshlrev_b32 v233,16,v206
v_lshlrev_b32 v237,16,v214
M v[52:55],a[112:115],a[164:167],v[52:55]
ds_write2st64_b64 v247,v[192:193],v[202:203] offset0:104 offset1:121
M v[56:59],a[112:115],a[168:171],v[56:59]
s_add_u32 s28,s67,6291456
buffer_load_dwordx2 v[192:193],v245,s[12:15],s28 offen offset:0
M v[56:59],a[124:127],a[172:175],v[56:59]
s_waitcnt vmcnt(25) lgkmcnt(2)
v_lshlrev_b32 v236,16,v212
v_lshlrev_b32 v235,16,v210
M v[56:59],a[144:147],a[176:179],v[56:59]
s_waitcnt lgkmcnt(1)
buffer_load_dwordx2 v[202:203],v245,s[16:19],s28 offen offset:1536
M v[60:63],a[144:147],a[180:183],v[60:63]
v_fmac_f32 v232,s43,v234
v_fmac_f32 v237,4.0,v233
M v[60:63],a[124:127],a[176:179],v[60:63]
v_fma_f32 v238,-4.0,v234,v236
v_fmac_f32 v232,s45,v236
M v[60:63],a[112:115],a[172:175],v[60:63]
ds_write2st64_b64 v247,v[194:195],v[196:197] offset0:36 offset1:53
M v[64:67],a[212:215],a[96:99],v[64:67]
buffer_load_dwordx2 v[194:195],v245,s[8:11],s28 offen offset:0
M v[64:67],a[200:203],a[100:103],v[64:67]
v_fmac_f32 v237,s41,v235
v_sub_f32 v236,v236,v234
M v[64:67],v[228:231],a[120:123],v[64:67]
ds_write2st64_b64 v247,v[198:199],v[200:201] offset0:70 offset1:87
M v[68:71],v[228:231],a[140:143],v[68:71]
buffer_load_dwordx2 v[196:197],v245,s[8:11],s28 offen offset:384
M v[68:71],a[200:203],a[120:123],v[68:71]
v_fma_f32 v234,-4.0,v233,v235
v_sub_f32 v235,v235,v233
M v[68:71],a[212:215],a[100:103],v[68:71]
v_add_f32 v233,v238,v234
v_sub_f32 v238,v238,v234
M v[72:75],a[212:215],a[120:123],v[72:75]
v_fma_f32 v234,2.0,v235,v236
v_fmac_f32 v236,-2.0,v235
M v[72:75],a[200:203],a[140:143],v[72:75]
buffer_load_dwordx2 v[198:199],v245,s[8:11],s28 offen offset:768
M v[72:75],v[228:231],a[160:163],v[72:75]
v_and_b32 v208,s42,v208
v_and_b32 v204,s42,v204
M v[76:79],v[228:231],a[164:167],v[76:79]
v_and_b32 v206,s42,v206
v_and_b32 v214,s42,v214
M v[76:79],a[200:203],a[160:163],v[76:79]
v_and_b32 v212,s42,v212
v_and_b32 v210,s42,v210
M v[76:79],a[212:215],a[140:143],v[76:79]
buffer_load_dwordx2 v[200:201],v245,s[8:11],s28 offen offset:1152
M v[80:83],a[212:215],a[160:163],v[80:83]
v_fmac_f32 v204,s43,v208
v_fmac_f32 v214,4.0,v206
M v[80:83],a[200:203],a[164:167],v[80:83]
v_add_u32 v248,0xfffece00,v248
v_add_u32 v249,0xfffece00,v249
M v[80:83],v[228:231],a[168:171],v[80:83]
v_fma_f32 v235,-4.0,v208,v212
v_fmac_f32 v204,s45,v212
M v[84:87],v[228:231],a[172:175],v[84:87]
buffer_load_dwordx4 a[132:135],v250,s[20:23],s48 offen offset:1024 sc1
M v[84:87],a[200:203],a[168:171],v[84:87]
ds_read_b128 a[96:99],v248 offset:60928
v_fmac_f32 v214,s41,v210
M v[84:87],a[212:215],a[164:167],v[84:87]
ds_read_b128 a[100:103],v249 offset:60928
v_sub_f32 v212,v212,v208
M v[88:91],a[212:215],a[168:171],v[88:91]
ds_read_b128 a[120:123],v248 offset:61440
v_fma_f32 v208,-4.0,v206,v210
M v[88:91],a[200:203],a[172:175],v[88:91]
buffer_load_dwordx4 a[148:151],v250,s[20:23],s48 offen offset:2048 sc1
M v[88:91],v[228:231],a[176:179],v[88:91]
s_add_u32 s48,s75,52224
ds_read_b128 a[140:143],v249 offset:61440
v_sub_f32 v210,v210,v206
M v[92:95],v[228:231],a[180:183],v[92:95]
v_add_f32 v206,v235,v208
v_sub_f32 v235,v235,v208
M v[92:95],a[200:203],a[176:179],v[92:95]
v_fma_f32 v208,2.0,v210,v212
v_fmac_f32 v212,-2.0,v210
M v[92:95],a[212:215],a[172:175],v[92:95]
s_waitcnt vmcnt(25) lgkmcnt(3)
buffer_store_dwordx4 v[128:131],v253,s[24:27],s34 offen offset:1280 nt
M v[32:35],a[104:107],a[96:99],v[32:35]
s_waitcnt vmcnt(24) lgkmcnt(2)
s_add_u32 s34,s33,393216
ds_read_b128 a[160:163],v248 offset:61952
v_cvt_pk_bf16_f32 v204,v232,v204
M v[32:35],a[128:131],a[100:103],v[32:35]
s_waitcnt vmcnt(23) lgkmcnt(2)
ds_read_b128 a[164:167],v249 offset:61952
v_cvt_pk_bf16_f32 v214,v237,v214
M v[32:35],a[152:155],a[120:123],v[32:35]
s_waitcnt lgkmcnt(2)
buffer_store_dwordx4 v[136:139],v253,s[24:27],s34 offen offset:1280 nt
M v[36:39],a[152:155],a[140:143],v[36:39]
s_add_u32 s34,s33,786432
v_cvt_pk_bf16_f32 v206,v233,v206
v_cvt_pk_bf16_f32 v210,v234,v208
M v[36:39],a[128:131],a[120:123],v[36:39]
v_cvt_pk_bf16_f32 v208,v238,v235
v_cvt_pk_bf16_f32 v212,v236,v212
M v[36:39],a[104:107],a[100:103],v[36:39]
buffer_load_dwordx4 a[188:191],v250,s[20:23],s48 offen offset:0 sc1
M v[40:43],a[104:107],a[120:123],v[40:43]
ds_read_b128 a[168:171],v248 offset:62464
v_lshlrev_b32 v234,16,v209
M v[40:43],a[128:131],a[140:143],v[40:43]
s_waitcnt lgkmcnt(2)
ds_read_b128 a[172:175],v249 offset:62464
v_lshlrev_b32 v232,16,v205
M v[40:43],a[152:155],a[160:163],v[40:43]
s_waitcnt lgkmcnt(2)
v_lshlrev_b32 v233,16,v207
v_lshlrev_b32 v237,16,v215
M v[44:47],a[152:155],a[164:167],v[44:47]
buffer_load_dwordx4 a[196:199],v250,s[20:23],s48 offen offset:1024 sc1
M v[44:47],a[128:131],a[160:163],v[44:47]
v_lshlrev_b32 v236,16,v213
v_lshlrev_b32 v235,16,v211
M v[44:47],a[104:107],a[140:143],v[44:47]
v_fmac_f32 v232,s43,v234
v_fmac_f32 v237,4.0,v233
M v[48:51],a[104:107],a[160:163],v[48:51]
ds_read_b128 a[176:179],v249 offset:62976
v_fma_f32 v238,-4.0,v234,v236
M v[48:51],a[128:131],a[164:167],v[48:51]
s_waitcnt lgkmcnt(2)
buffer_load_dwordx4 v[220:223],v250,s[20:23],s48 offen offset:2048 sc1
M v[48:51],a[152:155],a[168:171],v[48:51]
s_waitcnt lgkmcnt(1)
s_add_u32 s48,s76,52224
ds_read_b128 a[180:183],v248 offset:62976
v_fmac_f32 v232,s45,v236
M v[52:55],a[152:155],a[172:175],v[52:55]
v_fmac_f32 v237,s41,v235
v_sub_f32 v236,v236,v234
M v[52:55],a[128:131],a[168:171],v[52:55]
v_fma_f32 v234,-4.0,v233,v235
v_sub_f32 v235,v235,v233
M v[52:55],a[104:107],a[164:167],v[52:55]
buffer_store_dwordx4 v[144:147],v253,s[24:27],s34 offen offset:1280 nt
M v[56:59],a[104:107],a[168:171],v[56:59]
s_add_u32 s34,s33,1179648
v_add_f32 v233,v238,v234
v_sub_f32 v238,v238,v234
M v[56:59],a[128:131],a[172:175],v[56:59]
s_waitcnt lgkmcnt(1)
v_fma_f32 v234,2.0,v235,v236
v_fmac_f32 v236,-2.0,v235
M v[56:59],a[152:155],a[176:179],v[56:59]
s_waitcnt lgkmcnt(0)
buffer_store_dwordx4 v[152:155],v253,s[24:27],s34 offen offset:1280 nt
M v[60:63],a[152:155],a[180:183],v[60:63]
v_and_b32 v209,s42,v209
v_and_b32 v205,s42,v205
M v[60:63],a[128:131],a[176:179],v[60:63]
v_and_b32 v207,s42,v207
v_and_b32 v215,s42,v215
M v[60:63],a[104:107],a[172:175],v[60:63]
s_waitcnt vmcnt(28)
buffer_load_dwordx4 a[112:115],v250,s[20:23],s48 offen offset:0 sc1
M v[64:67],v[224:227],a[96:99],v[64:67]
s_waitcnt vmcnt(27)
v_and_b32 v213,s42,v213
v_and_b32 v211,s42,v211
M v[64:67],a[224:227],a[100:103],v[64:67]
s_waitcnt vmcnt(26)
v_fmac_f32 v205,s43,v209
v_fmac_f32 v215,4.0,v207
M v[64:67],a[236:239],a[120:123],v[64:67]
v_fma_f32 v235,-4.0,v209,v213
v_fmac_f32 v205,s45,v213
M v[68:71],a[236:239],a[140:143],v[68:71]
buffer_load_dwordx4 a[124:127],v250,s[20:23],s48 offen offset:1024 sc1
M v[68:71],a[224:227],a[120:123],v[68:71]
v_fmac_f32 v215,s41,v211
v_sub_f32 v213,v213,v209
M v[68:71],v[224:227],a[100:103],v[68:71]
v_fma_f32 v209,-4.0,v207,v211
v_sub_f32 v211,v211,v207
M v[72:75],v[224:227],a[120:123],v[72:75]
v_add_f32 v207,v235,v209
v_sub_f32 v235,v235,v209
M v[72:75],a[224:227],a[140:143],v[72:75]
buffer_load_dwordx4 a[144:147],v250,s[20:23],s48 offen offset:2048 sc1
M v[72:75],a[236:239],a[160:163],v[72:75]
s_add_u32 s48,s77,52224
v_fma_f32 v209,2.0,v211,v213
v_fmac_f32 v213,-2.0,v211
M v[76:79],a[236:239],a[164:167],v[76:79]
v_cvt_pk_bf16_f32 v205,v232,v205
v_cvt_pk_bf16_f32 v215,v237,v215
M v[76:79],a[224:227],a[160:163],v[76:79]
v_cvt_pk_bf16_f32 v207,v233,v207
v_cvt_pk_bf16_f32 v211,v234,v209
M v[76:79],v[224:227],a[140:143],v[76:79]
buffer_load_dwordx4 a[208:211],v250,s[20:23],s48 offen offset:0 sc1
M v[80:83],v[224:227],a[160:163],v[80:83]
v_cvt_pk_bf16_f32 v209,v238,v235
v_cvt_pk_bf16_f32 v213,v236,v213
M v[80:83],a[224:227],a[164:167],v[80:83]
s_barrier
v_cvt_pk_bf16_f32 v32,v32,v33
M v[80:83],a[236:239],a[168:171],v[80:83]
ds_write2st64_b64 v247,v[204:205],v[214:215] offset0:105 offset1:122
M v[84:87],a[236:239],a[172:175],v[84:87]
s_add_u32 s28,s67,6684672
buffer_load_dwordx2 v[204:205],v245,s[12:15],s28 offen offset:0
M v[84:87],a[224:227],a[168:171],v[84:87]
ds_read_b128 a[96:99],v248 offset:0
v_cvt_pk_bf16_f32 v33,v34,v35
M v[84:87],v[224:227],a[164:167],v[84:87]
ds_write2st64_b64 v247,v[206:207],v[208:209] offset0:37 offset1:54
M v[88:91],v[224:227],a[168:171],v[88:91]
buffer_load_dwordx2 v[214:215],v245,s[16:19],s28 offen offset:1536
M v[88:91],a[224:227],a[172:175],v[88:91]
ds_read_b128 a[100:103],v249 offset:0
ds_read_b128 a[120:123],v248 offset:512
M v[88:91],a[236:239],a[176:179],v[88:91]
ds_write2st64_b64 v247,v[210:211],v[212:213] offset0:71 offset1:88
M v[92:95],a[236:239],a[180:183],v[92:95]
buffer_load_dwordx2 v[206:207],v245,s[8:11],s28 offen offset:0
M v[92:95],a[224:227],a[176:179],v[92:95]
ds_read_b128 a[140:143],v249 offset:512
v_cvt_pk_bf16_f32 v36,v36,v37
M v[92:95],v[224:227],a[172:175],v[92:95]
s_waitcnt vmcnt(31) lgkmcnt(5)
v_cvt_pk_bf16_f32 v37,v38,v39
M v[160:163],a[116:119],a[96:99],v[160:163]
s_waitcnt vmcnt(29) lgkmcnt(3)
ds_read_b128 a[96:99],v248 offset:1024
ds_write2st64_b64 v254,v[32:33],v[36:37] offset0:0 offset1:4
M v[160:163],a[136:139],a[100:103],v[160:163]
s_waitcnt vmcnt(28) lgkmcnt(4)
buffer_load_dwordx2 v[208:209],v245,s[8:11],s28 offen offset:384
M v[160:163],a[156:159],a[120:123],v[160:163]
s_waitcnt lgkmcnt(2)
ds_read_b128 a[160:163],v249 offset:1024
v_cvt_pk_bf16_f32 v40,v40,v41
M v[164:167],a[156:159],a[140:143],v[164:167]
v_cvt_pk_bf16_f32 v41,v42,v43
v_cvt_pk_bf16_f32 v44,v44,v45
M v[164:167],a[136:139],a[120:123],v[164:167]
buffer_load_dwordx2 v[210:211],v245,s[8:11],s28 offen offset:768
M v[164:167],a[116:119],a[100:103],v[164:167]
v_cvt_pk_bf16_f32 v45,v46,v47
M v[168:171],a[116:119],a[120:123],v[168:171]
ds_read_b128 a[100:103],v248 offset:1536
ds_write2st64_b64 v254,v[40:41],v[44:45] offset0:8 offset1:12
M v[168:171],a[136:139],a[140:143],v[168:171]
s_waitcnt lgkmcnt(4)
buffer_load_dwordx2 v[212:213],v245,s[8:11],s28 offen offset:1152
M v[168:171],a[156:159],a[96:99],v[168:171]
s_waitcnt lgkmcnt(2)
ds_read_b128 a[120:123],v249 offset:1536
v_cvt_pk_bf16_f32 v48,v48,v49
M v[172:175],a[156:159],a[160:163],v[172:175]
v_cvt_pk_bf16_f32 v49,v50,v51
v_cvt_pk_bf16_f32 v52,v52,v53
M v[172:175],a[136:139],a[96:99],v[172:175]
v_cvt_pk_bf16_f32 v53,v54,v55
M v[172:175],a[116:119],a[140:143],v[172:175]
buffer_load_dwordx4 a[204:207],v250,s[20:23],s48 offen offset:1024 sc1
M v[176:179],a[116:119],a[96:99],v[176:179]
ds_read_b128 a[96:99],v249 offset:2048
ds_write2st64_b64 v254,v[48:49],v[52:53] offset0:136 offset1:140
M v[176:179],a[136:139],a[160:163],v[176:179]
s_waitcnt lgkmcnt(4)
ds_read_b128 a[140:143],v248 offset:2048
v_add_u32 v248,0x15400,v248
M v[176:179],a[156:159],a[100:103],v[176:179]
s_waitcnt lgkmcnt(3)
buffer_load_dwordx4 a[192:195],v250,s[20:23],s48 offen offset:2048 sc1
M v[180:183],a[156:159],a[120:123],v[180:183]
s_add_u32 s46,s72,9216
v_add_u32 v249,0x15400,v249
v_cvt_pk_bf16_f32 v56,v56,v57
M v[180:183],a[136:139],a[100:103],v[180:183]
ds_read_b128 a[164:167],v248 offset:0
v_cvt_pk_bf16_f32 v57,v58,v59
M v[180:183],a[116:119],a[160:163],v[180:183]
ds_read_b128 a[160:163],v249 offset:0
v_cvt_pk_bf16_f32 v60,v60,v61
M v[184:187],a[116:119],a[100:103],v[184:187]
buffer_load_dwordx4 a[104:107],v250,s[20:23],s46 offen offset:0 sc1
M v[184:187],a[136:139],a[120:123],v[184:187]
s_waitcnt lgkmcnt(4)
ds_read_b128 a[168:171],v248 offset:512
ds_read_b128 a[176:179],v249 offset:512
M v[184:187],a[156:159],a[96:99],v[184:187]
s_waitcnt lgkmcnt(4)
v_cvt_pk_bf16_f32 v61,v62,v63
M v[188:191],a[156:159],a[140:143],v[188:191]
ds_write2st64_b64 v254,v[56:57],v[60:61] offset0:144 offset1:148
M v[188:191],a[136:139],a[96:99],v[188:191]
buffer_load_dwordx4 a[128:131],v250,s[20:23],s46 offen offset:1024 sc1
M v[188:191],a[116:119],a[120:123],v[188:191]
s_waitcnt vmcnt(34) lgkmcnt(4)
v_cvt_pk_bf16_f32 v64,v64,v65
v_cvt_pk_bf16_f32 v65,v66,v67
M v[160:163],a[184:187],a[164:167],v[160:163]
s_waitcnt vmcnt(31) lgkmcnt(3)
ds_read_b128 a[96:99],v248 offset:1024
v_cvt_pk_bf16_f32 v68,v68,v69
M v[160:163],a[232:235],a[160:163],v[160:163]
s_waitcnt vmcnt(30) lgkmcnt(3)
buffer_load_dwordx4 a[152:155],v250,s[20:23],s46 offen offset:2048 sc1
M v[160:163],a[252:255],a[168:171],v[160:163]
s_waitcnt lgkmcnt(2)
s_add_u32 s47,s72,12288
ds_read_b128 a[116:119],v249 offset:1024
v_cvt_pk_bf16_f32 v69,v70,v71
M v[164:167],a[252:255],a[176:179],v[164:167]
ds_write2st64_b64 v254,v[64:65],v[68:69] offset0:170 offset1:174
M v[164:167],a[232:235],a[168:171],v[164:167]
buffer_load_dwordx4 a[100:103],v250,s[20:23],s47 offen offset:0 sc1
M v[164:167],a[184:187],a[160:163],v[164:167]
v_cvt_pk_bf16_f32 v72,v72,v73
v_cvt_pk_bf16_f32 v73,v74,v75
M v[168:171],a[184:187],a[168:171],v[168:171]
ds_read_b128 a[120:123],v248 offset:1536
v_cvt_pk_bf16_f32 v76,v76,v77
M v[168:171],a[232:235],a[176:179],v[168:171]
s_waitcnt lgkmcnt(3)
ds_read_b128 a[136:139],v249 offset:1536
v_cvt_pk_bf16_f32 v77,v78,v79
M v[168:171],a[252:255],a[96:99],v[168:171]
s_waitcnt lgkmcnt(3)
buffer_load_dwordx4 a[172:175],v250,s[20:23],s47 offen offset:1024 sc1
M v[172:175],a[252:255],a[116:119],v[172:175]
ds_write2st64_b64 v254,v[72:73],v[76:77] offset0:178 offset1:182
M v[172:175],a[232:235],a[96:99],v[172:175]
v_cvt_pk_bf16_f32 v80,v80,v81
v_cvt_pk_bf16_f32 v81,v82,v83
M v[172:175],a[184:187],a[176:179],v[172:175]
buffer_load_dwordx4 a[180:183],v250,s[20:23],s47 offen offset:2048 sc1
M v[176:179],a[184:187],a[96:99],v[176:179]
s_add_u32 s48,s72,15360
ds_read_b128 a[96:99],v249 offset:2048
v_cvt_pk_bf16_f32 v84,v84,v85
M v[176:179],a[232:235],a[116:119],v[176:179]
s_waitcnt lgkmcnt(3)
ds_read_b128 a[140:143],v248 offset:2048
v_cvt_pk_bf16_f32 v85,v86,v87
M v[176:179],a[252:255],a[120:123],v[176:179]
s_waitcnt lgkmcnt(3)
ds_write2st64_b64 v254,v[80:81],v[84:85] offset0:204 offset1:208
M v[180:183],a[252:255],a[136:139],v[180:183]
v_cvt_pk_bf16_f32 v88,v88,v89
v_cvt_pk_bf16_f32 v89,v90,v91
M v[180:183],a[232:235],a[120:123],v[180:183]
ds_read_b128 a[156:159],v248 offset:17408
v_cvt_pk_bf16_f32 v92,v92,v93
M v[180:183],a[184:187],a[116:119],v[180:183]
ds_read_b128 a[116:119],v249 offset:17408
v_cvt_pk_bf16_f32 v93,v94,v95
M v[184:187],a[184:187],a[120:123],v[184:187]
buffer_load_dwordx4 a[120:123],v250,s[20:23],s48 offen offset:0 sc1
M v[184:187],a[232:235],a[136:139],v[184:187]
s_waitcnt lgkmcnt(4)
ds_read_b128 a[160:163],v248 offset:17920
ds_read_b128 a[168:171],v249 offset:17920
M v[184:187],a[252:255],a[96:99],v[184:187]
s_waitcnt lgkmcnt(5)
buffer_load_dwordx4 a[164:167],v250,s[20:23],s48 offen offset:1024 sc1
M v[188:191],a[252:255],a[140:143],v[188:191]
ds_write2st64_b64 v254,v[88:89],v[92:93] offset0:212 offset1:216
M v[188:191],a[232:235],a[96:99],v[188:191]
M v[188:191],a[184:187],a[136:139],v[188:191]
s_waitcnt vmcnt(35) lgkmcnt(4)
M v[160:163],a[108:111],a[156:159],v[160:163]
s_waitcnt vmcnt(28) lgkmcnt(0)
s_barrier
ds_read_b128 v[32:35],v250 offset:0
M v[160:163],a[132:135],a[116:119],v[160:163]
s_waitcnt vmcnt(27)
ds_read_b128 v[40:43],v250 offset:4096
ds_read_b128 v[48:51],v4 offset:0
M v[160:163],a[148:151],a[160:163],v[160:163]
ds_read_b128 v[56:59],v4 offset:4096
ds_read_b128 v[64:67],v4 offset:17408
M v[164:167],a[148:151],a[168:171],v[164:167]
ds_read_b128 v[72:75],v4 offset:21504
ds_read_b128 v[80:83],v4 offset:34816
ds_read_b128 a[96:99],v248 offset:18432
M v[164:167],a[132:135],a[160:163],v[164:167]
ds_read_b128 v[88:91],v4 offset:38912
ds_read_b128 a[136:139],v249 offset:18432
M v[164:167],a[108:111],a[116:119],v[164:167]
s_waitcnt lgkmcnt(9)
s_add_u32 s34,s33,0
buffer_store_dwordx4 v[32:35],v253,s[24:27],s34 offen offset:128 nt
M v[168:171],a[108:111],a[160:163],v[168:171]
s_add_u32 s34,s33,393216
buffer_load_dwordx4 a[176:179],v250,s[20:23],s48 offen offset:2048 sc1
M v[168:171],a[132:135],a[168:171],v[168:171]
s_waitcnt lgkmcnt(2)
ds_read_b128 a[116:119],v248 offset:18944
ds_read_b128 a[140:143],v249 offset:18944
M v[168:171],a[148:151],a[96:99],v[168:171]
s_waitcnt lgkmcnt(2)
M v[172:175],a[148:151],a[136:139],v[172:175]
M v[172:175],a[132:135],a[96:99],v[172:175]
M v[172:175],a[108:111],a[168:171],v[172:175]
buffer_store_dwordx4 v[40:43],v253,s[24:27],s34 offen offset:128 nt
M v[176:179],a[108:111],a[96:99],v[176:179]
s_add_u32 s34,s33,786432
ds_read_b128 a[96:99],v249 offset:19456
s_add_u32 s46,s72,18432
M v[176:179],a[132:135],a[136:139],v[176:179]
s_waitcnt lgkmcnt(2)
ds_read_b128 a[156:159],v248 offset:19456
M v[176:179],a[148:151],a[116:119],v[176:179]
s_waitcnt lgkmcnt(2)
buffer_store_dwordx4 v[48:51],v253,s[24:27],s34 offen offset:128 nt
M v[180:183],a[148:151],a[140:143],v[180:183]
s_add_u32 s34,s33,1179648
M v[180:183],a[132:135],a[116:119],v[180:183]
ds_read_b128 a[160:163],v248 offset:34816
M v[180:183],a[108:111],a[136:139],v[180:183]
buffer_store_dwordx4 v[56:59],v253,s[24:27],s34 offen offset:128 nt
M v[184:187],a[108:111],a[116:119],v[184:187]
s_add_u32 s34,s33,0
ds_read_b128 a[136:139],v249 offset:34816
ds_read_b128 a[116:119],v248 offset:35328
M v[184:187],a[132:135],a[140:143],v[184:187]
s_waitcnt lgkmcnt(4)
buffer_load_dwordx4 a[168:171],v250,s[20:23],s46 offen offset:0 sc1
M v[184:187],a[148:151],a[96:99],v[184:187]
s_waitcnt lgkmcnt(3)
ds_read_b128 a[216:219],v249 offset:35328
M v[188:191],a[148:151],a[156:159],v[188:191]
M v[188:191],a[132:135],a[96:99],v[188:191]
M v[188:191],a[108:111],a[140:143],v[188:191]
s_waitcnt vmcnt(30) lgkmcnt(3)
buffer_store_dwordx4 v[64:67],v253,s[24:27],s34 offen offset:256 nt
M v[160:163],a[188:191],a[160:163],v[160:163]
s_waitcnt vmcnt(30) lgkmcnt(2)
s_add_u32 s34,s33,393216
ds_read_b128 a[96:99],v248 offset:35840
M v[160:163],a[196:199],a[136:139],v[160:163]
s_waitcnt vmcnt(29) lgkmcnt(2)
ds_read_b128 a[108:111],v249 offset:35840
M v[160:163],v[220:223],a[116:119],v[160:163]
s_waitcnt lgkmcnt(2)
buffer_store_dwordx4 v[72:75],v253,s[24:27],s34 offen offset:256 nt
M v[164:167],v[220:223],a[216:219],v[164:167]
s_add_u32 s34,s33,786432
M v[164:167],a[196:199],a[116:119],v[164:167]
M v[164:167],a[188:191],a[136:139],v[164:167]
buffer_load_dwordx4 a[184:187],v250,s[20:23],s46 offen offset:1024 sc1
M v[168:171],a[188:191],a[116:119],v[168:171]
ds_read_b128 a[116:119],v248 offset:36352
M v[168:171],a[196:199],a[216:219],v[168:171]
s_waitcnt lgkmcnt(2)
ds_read_b128 a[132:135],v249 offset:36352
M v[168:171],v[220:223],a[96:99],v[168:171]
s_waitcnt lgkmcnt(2)
M v[172:175],v[220:223],a[108:111],v[172:175]
buffer_load_dwordx4 a[220:223],v250,s[20:23],s46 offen offset:2048 sc1
M v[172:175],a[196:199],a[96:99],v[172:175]
M v[172:175],a[188:191],a[216:219],v[172:175]
M v[176:179],a[188:191],a[96:99],v[176:179]
s_add_u32 s47,s72,21504
ds_read_b128 a[96:99],v249 offset:36864
M v[176:179],a[196:199],a[108:111],v[176:179]
s_waitcnt lgkmcnt(2)
ds_read_b128 a[136:139],v248 offset:36864
M v[176:179],v[220:223],a[116:119],v[176:179]
s_waitcnt lgkmcnt(2)
buffer_store_dwordx4 v[80:83],v253,s[24:27],s34 offen offset:256 nt
M v[180:183],v[220:223],a[132:135],v[180:183]
s_add_u32 s34,s33,1179648
M v[180:183],a[196:199],a[116:119],v[180:183]
ds_read_b128 a[140:143],v248 offset:52224
M v[180:183],a[188:191],a[108:111],v[180:183]
buffer_store_dwordx4 v[88:91],v253,s[24:27],s34 offen offset:256 nt
M v[184:187],a[188:191],a[116:119],v[184:187]
ds_read_b128 a[108:111],v249 offset:52224
ds_read_b128 a[116:119],v248 offset:52736
M v[184:187],a[196:199],a[132:135],v[184:187]
s_waitcnt lgkmcnt(4)
buffer_load_dwordx4 a[228:231],v250,s[20:23],s47 offen offset:0 sc1
M v[184:187],v[220:223],a[96:99],v[184:187]
s_waitcnt lgkmcnt(3)
ds_read_b128 a[148:151],v249 offset:52736
M v[188:191],v[220:223],a[136:139],v[188:191]
M v[188:191],a[196:199],a[96:99],v[188:191]
M v[188:191],a[188:191],a[132:135],v[188:191]
s_waitcnt vmcnt(32) lgkmcnt(3)
buffer_load_dwordx4 a[160:163],v250,s[20:23],s47 offen offset:1024 sc1
M v[160:163],a[112:115],a[140:143],v[160:163]
s_waitcnt vmcnt(32) lgkmcnt(2)
ds_read_b128 a[96:99],v248 offset:53248
M v[160:163],a[124:127],a[108:111],v[160:163]
s_waitcnt vmcnt(31) lgkmcnt(2)
ds_read_b128 a[132:135],v249 offset:53248
M v[160:163],a[144:147],a[116:119],v[160:163]
s_waitcnt lgkmcnt(2)
M v[164:167],a[144:147],a[148:151],v[164:167]
buffer_load_dwordx4 a[244:247],v250,s[20:23],s47 offen offset:2048 sc1
M v[164:167],a[124:127],a[116:119],v[164:167]
M v[164:167],a[112:115],a[108:111],v[164:167]
M v[168:171],a[112:115],a[116:119],v[168:171]
ds_read_b128 a[108:111],v248 offset:53760
M v[168:171],a[124:127],a[148:151],v[168:171]
s_waitcnt lgkmcnt(2)
ds_read_b128 a[116:119],v249 offset:53760
M v[168:171],a[144:147],a[96:99],v[168:171]
s_waitcnt lgkmcnt(2)
M v[172:175],a[144:147],a[132:135],v[172:175]
M v[172:175],a[124:127],a[96:99],v[172:175]
M v[172:175],a[112:115],a[148:151],v[172:175]
M v[176:179],a[112:115],a[96:99],v[176:179]
s_add_u32 s48,s72,24576
ds_read_b128 a[96:99],v249 offset:54272
M v[176:179],a[124:127],a[132:135],v[176:179]
s_waitcnt lgkmcnt(2)
ds_read_b128 a[136:139],v248 offset:54272
v_add_u32 v248,0xfffece00,v248
M v[176:179],a[144:147],a[108:111],v[176:179]
s_waitcnt lgkmcnt(2)
v_add_u32 v249,0xfffece00,v249
M v[180:183],a[144:147],a[116:119],v[180:183]
M v[180:183],a[124:127],a[108:111],v[180:183]
ds_read_b128 a[140:143],v248 offset:60928
M v[180:183],a[112:115],a[132:135],v[180:183]
ds_read_b128 a[132:135],v249 offset:60928
M v[184:187],a[112:115],a[108:111],v[184:187]
buffer_load_dwordx4 a[240:243],v250,s[20:23],s48 offen offset:0 sc1
M v[184:187],a[124:127],a[116:119],v[184:187]
s_waitcnt lgkmcnt(3)
ds_read_b128 a[108:111],v248 offset:61440
ds_read_b128 a[148:151],v249 offset:61440
M v[184:187],a[144:147],a[96:99],v[184:187]
s_waitcnt lgkmcnt(4)
buffer_load_dwordx4 v[216:219],v250,s[20:23],s48 offen offset:1024 sc1
M v[188:191],a[144:147],a[136:139],v[188:191]
M v[188:191],a[124:127],a[96:99],v[188:191]
M v[188:191],a[112:115],a[116:119],v[188:191]
s_waitcnt vmcnt(33) lgkmcnt(3)
M v[160:163],a[208:211],a[140:143],v[160:163]
s_waitcnt vmcnt(26) lgkmcnt(2)
buffer_load_dwordx4 a[248:251],v250,s[20:23],s48 offen offset:2048 sc1
M v[160:163],a[204:207],a[132:135],v[160:163]
s_waitcnt vmcnt(26) lgkmcnt(1)
ds_read_b128 a[96:99],v248 offset:61952
ds_read_b128 a[112:115],v249 offset:61952
M v[160:163],a[192:195],a[108:111],v[160:163]
s_waitcnt lgkmcnt(2)
M v[164:167],a[192:195],a[148:151],v[164:167]
M v[164:167],a[204:207],a[108:111],v[164:167]
M v[164:167],a[208:211],a[132:135],v[164:167]
s_nop 3
v_cvt_pk_bf16_f32 v160,v160,v161
v_cvt_pk_bf16_f32 v161,v162,v163
M v[168:171],a[208:211],a[108:111],v[168:171]
ds_read_b128 a[108:111],v248 offset:62464
M v[168:171],a[204:207],a[148:151],v[168:171]
s_waitcnt lgkmcnt(2)
ds_read_b128 a[116:119],v249 offset:62464
M v[168:171],a[192:195],a[96:99],v[168:171]
s_waitcnt lgkmcnt(2)
v_cvt_pk_bf16_f32 v164,v164,v165
v_cvt_pk_bf16_f32 v165,v166,v167
M v[172:175],a[192:195],a[112:115],v[172:175]
M v[172:175],a[204:207],a[96:99],v[172:175]
ds_read_b128 a[124:127],v249 offset:62976
ds_read_b128 a[132:135],v248 offset:62976
M v[172:175],a[208:211],a[148:151],v[172:175]
M v[176:179],a[208:211],a[96:99],v[176:179]
s_add_u32 s46,s72,27648
M v[176:179],a[204:207],a[112:115],v[176:179]
s_waitcnt lgkmcnt(3)
M v[176:179],a[192:195],a[108:111],v[176:179]
s_waitcnt lgkmcnt(0)
s_barrier
ds_write2st64_b64 v254,v[160:161],v[164:165] offset0:221 offset1:225
M v[180:183],a[192:195],a[116:119],v[180:183]
v_cvt_pk_bf16_f32 v168,v168,v169
v_cvt_pk_bf16_f32 v169,v170,v171
M v[180:183],a[204:207],a[108:111],v[180:183]
ds_read_b128 a[96:99],v248 offset:0
v_cvt_pk_bf16_f32 v172,v172,v173
M v[180:183],a[208:211],a[112:115],v[180:183]
ds_read_b128 a[112:115],v249 offset:0
v_cvt_pk_bf16_f32 v173,v174,v175
M v[184:187],a[208:211],a[108:111],v[184:187]
buffer_load_dwordx4 v[228:231],v250,s[20:23],s46 offen offset:0 sc1
M v[184:187],a[204:207],a[116:119],v[184:187]
ds_read_b128 a[108:111],v248 offset:512
ds_read_b128 a[136:139],v249 offset:512
M v[184:187],a[192:195],a[124:127],v[184:187]
ds_write2st64_b64 v254,v[168:169],v[172:173] offset0:229 offset1:233
M v[188:191],a[192:195],a[132:135],v[188:191]
v_cvt_pk_bf16_f32 v176,v176,v177
v_cvt_pk_bf16_f32 v177,v178,v179
M v[188:191],a[204:207],a[124:127],v[188:191]
v_cvt_pk_bf16_f32 v180,v180,v181
v_cvt_pk_bf16_f32 v181,v182,v183
M v[188:191],a[208:211],a[116:119],v[188:191]
s_waitcnt vmcnt(26) lgkmcnt(4)
ds_write2st64_b64 v254,v[176:177],v[180:181] offset0:238 offset1:242
M a[0:3],a[104:107],a[96:99],0
s_waitcnt vmcnt(25) lgkmcnt(4)
ds_read_b128 a[116:119],v248 offset:1024
v_cvt_pk_bf16_f32 v184,v184,v185
M a[0:3],a[128:131],a[112:115],a[0:3]
s_waitcnt vmcnt(24) lgkmcnt(4)
ds_read_b128 a[124:127],v249 offset:1024
v_cvt_pk_bf16_f32 v185,v186,v187
M a[0:3],a[152:155],a[108:111],a[0:3]
s_waitcnt lgkmcnt(4)
v_cvt_pk_bf16_f32 v188,v188,v189
v_cvt_pk_bf16_f32 v189,v190,v191
M a[4:7],a[152:155],a[136:139],0
ds_write2st64_b64 v254,v[184:185],v[188:189] offset0:246 offset1:250
M a[4:7],a[128:131],a[108:111],a[4:7]
v_lshlrev_b32 v234,16,v196
v_lshlrev_b32 v232,16,v192
M a[4:7],a[104:107],a[112:115],a[4:7]
v_lshlrev_b32 v233,16,v194
v_lshlrev_b32 v237,16,v202
M a[8:11],a[104:107],a[108:111],0
ds_read_b128 a[132:135],v248 offset:1536
v_lshlrev_b32 v236,16,v200
M a[8:11],a[128:131],a[136:139],a[8:11]
s_waitcnt lgkmcnt(3)
ds_read_b128 a[140:143],v249 offset:1536
v_lshlrev_b32 v235,16,v198
M a[8:11],a[152:155],a[116:119],a[8:11]
s_waitcnt lgkmcnt(2)
s_barrier
ds_read_b128 v[160:163],v4 offset:43520
M a[12:15],a[152:155],a[124:127],0
ds_read_b128 v[168:171],v4 offset:47616
ds_read_b128 v[176:179],v4 offset:52224
M a[12:15],a[128:131],a[116:119],a[12:15]
ds_read_b128 v[184:187],v4 offset:56320
v_fmac_f32 v232,s43,v234
M a[12:15],a[104:107],a[136:139],a[12:15]
v_fmac_f32 v237,4.0,v233
v_fma_f32 v238,-4.0,v234,v236
M a[16:19],a[104:107],a[116:119],0
ds_read_b128 a[144:147],v249 offset:2048
v_fmac_f32 v232,s45,v236
M a[16:19],a[128:131],a[124:127],a[16:19]
s_waitcnt lgkmcnt(6)
s_add_u32 s34,s33,0
ds_read_b128 a[148:151],v248 offset:2048
v_fmac_f32 v237,s41,v235
M a[16:19],a[152:155],a[132:135],a[16:19]
s_waitcnt lgkmcnt(5)
buffer_store_dwordx4 v[160:163],v253,s[24:27],s34 offen offset:1408 nt
M a[20:23],a[152:155],a[140:143],0
s_add_u32 s34,s33,393216
v_sub_f32 v236,v236,v234
v_fma_f32 v234,-4.0,v233,v235
M a[20:23],a[128:131],a[132:135],a[20:23]
v_sub_f32 v235,v235,v233
v_add_f32 v233,v238,v234
M a[20:23],a[104:107],a[124:127],a[20:23]
s_waitcnt lgkmcnt(4)
buffer_store_dwordx4 v[168:171],v253,s[24:27],s34 offen offset:1408 nt
M a[24:27],a[104:107],a[132:135],0
s_add_u32 s34,s33,786432
v_sub_f32 v238,v238,v234
v_fma_f32 v234,2.0,v235,v236
M a[24:27],a[128:131],a[140:143],a[24:27]
s_waitcnt lgkmcnt(1)
v_fmac_f32 v236,-2.0,v235
v_and_b32 v196,s42,v196
M a[24:27],a[152:155],a[144:147],a[24:27]
s_waitcnt lgkmcnt(0)
buffer_store_dwordx4 v[176:179],v253,s[24:27],s34 offen offset:1408 nt
M a[28:31],a[152:155],a[148:151],0
s_add_u32 s34,s33,1179648
v_and_b32 v192,s42,v192
v_and_b32 v194,s42,v194
M a[28:31],a[128:131],a[144:147],a[28:31]
v_and_b32 v202,s42,v202
v_and_b32 v200,s42,v200
M a[28:31],a[104:107],a[140:143],a[28:31]
s_waitcnt vmcnt(26)
buffer_store_dwordx4 v[184:187],v253,s[24:27],s34 offen offset:1408 nt
M a[32:35],a[100:103],a[96:99],0
s_waitcnt vmcnt(26)
v_and_b32 v198,s42,v198
v_fmac_f32 v192,s43,v196
M a[32:35],a[172:175],a[112:115],a[32:35]
s_waitcnt vmcnt(25)
v_fmac_f32 v202,4.0,v194
v_fma_f32 v235,-4.0,v196,v200
M a[32:35],a[180:183],a[108:111],a[32:35]
v_fmac_f32 v192,s45,v200
v_fmac_f32 v202,s41,v198
M a[36:39],a[180:183],a[136:139],0
v_sub_f32 v200,v200,v196
v_fma_f32 v196,-4.0,v194,v198
M a[36:39],a[172:175],a[108:111],a[36:39]
v_sub_f32 v198,v198,v194
v_add_f32 v194,v235,v196
M a[36:39],a[100:103],a[112:115],a[36:39]
v_sub_f32 v235,v235,v196
v_fma_f32 v196,2.0,v198,v200
M a[40:43],a[100:103],a[108:111],0
v_fmac_f32 v200,-2.0,v198
v_cvt_pk_bf16_f32 v192,v232,v192
M a[40:43],a[172:175],a[136:139],a[40:43]
v_cvt_pk_bf16_f32 v202,v237,v202
v_cvt_pk_bf16_f32 v194,v233,v194
M a[40:43],a[180:183],a[116:119],a[40:43]
v_cvt_pk_bf16_f32 v198,v234,v196
v_cvt_pk_bf16_f32 v196,v238,v235
M a[44:47],a[180:183],a[124:127],0
v_cvt_pk_bf16_f32 v200,v236,v200
v_lshlrev_b32 v234,16,v197
M a[44:47],a[172:175],a[116:119],a[44:47]
v_lshlrev_b32 v232,16,v193
v_lshlrev_b32 v233,16,v195
M a[44:47],a[100:103],a[136:139],a[44:47]
v_lshlrev_b32 v237,16,v203
v_lshlrev_b32 v236,16,v201
M a[48:51],a[100:103],a[116:119],0
v_lshlrev_b32 v235,16,v199
v_fmac_f32 v232,s43,v234
M a[48:51],a[172:175],a[124:127],a[48:51]
v_fmac_f32 v237,4.0,v233
v_fma_f32 v238,-4.0,v234,v236
M a[48:51],a[180:183],a[132:135],a[48:51]
v_fmac_f32 v232,s45,v236
v_fmac_f32 v237,s41,v235
M a[52:55],a[180:183],a[140:143],0
v_sub_f32 v236,v236,v234
v_fma_f32 v234,-4.0,v233,v235
M a[52:55],a[172:175],a[132:135],a[52:55]
v_sub_f32 v235,v235,v233
v_add_f32 v233,v238,v234
M a[52:55],a[100:103],a[124:127],a[52:55]
v_sub_f32 v238,v238,v234
v_fma_f32 v234,2.0,v235,v236
M a[56:59],a[100:103],a[132:135],0
v_fmac_f32 v236,-2.0,v235
v_and_b32 v197,s42,v197
M a[56:59],a[172:175],a[140:143],a[56:59]
v_and_b32 v193,s42,v193
v_and_b32 v195,s42,v195
M a[56:59],a[180:183],a[144:147],a[56:59]
v_and_b32 v203,s42,v203
v_and_b32 v201,s42,v201
M a[60:63],a[180:183],a[148:151],0
v_and_b32 v199,s42,v199
v_fmac_f32 v193,s43,v197
M a[60:63],a[172:175],a[144:147],a[60:63]
v_fmac_f32 v203,4.0,v195
v_fma_f32 v235,-4.0,v197,v201
M a[60:63],a[100:103],a[140:143],a[60:63]
s_waitcnt vmcnt(24)
v_fmac_f32 v193,s45,v201
v_fmac_f32 v203,s41,v199
M a[64:67],a[120:123],a[96:99],0
s_waitcnt vmcnt(23)
v_sub_f32 v201,v201,v197
v_fma_f32 v197,-4.0,v195,v199
M a[64:67],a[164:167],a[112:115],a[64:67]
s_waitcnt vmcnt(21)
v_sub_f32 v199,v199,v195
v_add_f32 v195,v235,v197
M a[64:67],a[176:179],a[108:111],a[64:67]
v_sub_f32 v235,v235,v197
v_fma_f32 v197,2.0,v199,v201
M a[68:71],a[176:179],a[136:139],0
v_fmac_f32 v201,-2.0,v199
v_cvt_pk_bf16_f32 v193,v232,v193
M a[68:71],a[164:167],a[108:111],a[68:71]
v_cvt_pk_bf16_f32 v203,v237,v203
v_cvt_pk_bf16_f32 v195,v233,v195
M a[68:71],a[120:123],a[112:115],a[68:71]
v_cvt_pk_bf16_f32 v199,v234,v197
v_cvt_pk_bf16_f32 v197,v238,v235
M a[72:75],a[120:123],a[108:111],0
v_cvt_pk_bf16_f32 v201,v236,v201
v_lshlrev_b32 v234,16,v208
M a[72:75],a[164:167],a[136:139],a[72:75]
v_lshlrev_b32 v232,16,v204
v_lshlrev_b32 v233,16,v206
M a[72:75],a[176:179],a[116:119],a[72:75]
ds_write2st64_b64 v247,v[192:193],v[202:203] offset0:170 offset1:187
M a[76:79],a[176:179],a[124:127],0
s_add_u32 s28,s67,7077888
buffer_load_dwordx2 v[192:193],v245,s[12:15],s28 offen offset:0
M a[76:79],a[164:167],a[116:119],a[76:79]
v_lshlrev_b32 v237,16,v214
v_lshlrev_b32 v236,16,v212
M a[76:79],a[120:123],a[136:139],a[76:79]
buffer_load_dwordx2 v[202:203],v245,s[16:19],s28 offen offset:1536
M a[80:83],a[120:123],a[116:119],0
v_lshlrev_b32 v235,16,v210
v_fmac_f32 v232,s43,v234
M a[80:83],a[164:167],a[124:127],a[80:83]
v_fmac_f32 v237,4.0,v233
v_fma_f32 v238,-4.0,v234,v236
M a[80:83],a[176:179],a[132:135],a[80:83]
ds_write2st64_b64 v247,v[194:195],v[196:197] offset0:0 offset1:17
M a[84:87],a[176:179],a[140:143],0
buffer_load_dwordx2 v[194:195],v245,s[8:11],s28 offen offset:0
M a[84:87],a[164:167],a[132:135],a[84:87]
ds_read_b128 a[172:175],v248 offset:8704
v_fmac_f32 v232,s45,v236
M a[84:87],a[120:123],a[124:127],a[84:87]
ds_write2st64_b64 v247,v[198:199],v[200:201] offset0:136 offset1:153
M a[88:91],a[120:123],a[132:135],0
buffer_load_dwordx2 v[196:197],v245,s[8:11],s28 offen offset:384
M a[88:91],a[164:167],a[140:143],a[88:91]
ds_read_b128 a[180:183],v249 offset:8704
ds_read_b128 a[188:191],v248 offset:9216
M a[88:91],a[176:179],a[144:147],a[88:91]
ds_read_b128 a[200:203],v249 offset:9216
v_fmac_f32 v237,s41,v235
M a[92:95],a[176:179],a[148:151],0
v_sub_f32 v236,v236,v234
v_fma_f32 v234,-4.0,v233,v235
M a[92:95],a[164:167],a[144:147],a[92:95]
buffer_load_dwordx2 v[198:199],v245,s[8:11],s28 offen offset:768
M a[92:95],a[120:123],a[140:143],a[92:95]
s_waitcnt vmcnt(22) lgkmcnt(4)
v_sub_f32 v235,v235,v233
v_add_f32 v233,v238,v234
M a[96:99],a[168:171],a[172:175],0
s_waitcnt vmcnt(19) lgkmcnt(2)
ds_read_b128 a[212:215],v248 offset:9728
v_sub_f32 v238,v238,v234
M a[96:99],a[184:187],a[180:183],a[96:99]
s_waitcnt vmcnt(18) lgkmcnt(2)
ds_read_b128 a[236:239],v249 offset:9728
v_fma_f32 v234,2.0,v235,v236
M a[96:99],a[220:223],a[188:191],a[96:99]
s_waitcnt lgkmcnt(2)
buffer_load_dwordx2 v[200:201],v245,s[8:11],s28 offen offset:1152
M a[100:103],a[220:223],a[200:203],0
v_fmac_f32 v236,-2.0,v235
v_and_b32 v208,s42,v208
M a[100:103],a[184:187],a[188:191],a[100:103]
v_and_b32 v204,s42,v204
v_and_b32 v206,s42,v206
M a[100:103],a[168:171],a[180:183],a[100:103]
v_and_b32 v214,s42,v214
v_and_b32 v212,s42,v212
M a[104:107],a[168:171],a[188:191],0
ds_read_b128 a[224:227],v248 offset:10240
v_and_b32 v210,s42,v210
M a[104:107],a[184:187],a[200:203],a[104:107]
s_waitcnt lgkmcnt(2)
ds_read_b128 v[224:227],v249 offset:10240
v_fmac_f32 v204,s43,v208
M a[104:107],a[220:223],a[212:215],a[104:107]
s_waitcnt lgkmcnt(2)
v_fmac_f32 v214,4.0,v206
v_fma_f32 v235,-4.0,v208,v212
M a[108:111],a[220:223],a[236:239],0
v_fmac_f32 v204,s45,v212
v_fmac_f32 v214,s41,v210
M a[108:111],a[184:187],a[212:215],a[108:111]
v_sub_f32 v212,v212,v208
v_fma_f32 v208,-4.0,v206,v210
M a[108:111],a[168:171],a[200:203],a[108:111]
v_sub_f32 v210,v210,v206
v_add_f32 v206,v235,v208
M a[112:115],a[168:171],a[212:215],0
ds_read_b128 a[252:255],v249 offset:10752
v_sub_f32 v235,v235,v208
M a[112:115],a[184:187],a[236:239],a[112:115]
s_waitcnt lgkmcnt(2)
ds_read_b128 a[232:235],v248 offset:10752
v_fma_f32 v208,2.0,v210,v212
M a[112:115],a[220:223],a[224:227],a[112:115]
s_waitcnt lgkmcnt(2)
v_fmac_f32 v212,-2.0,v210
v_cvt_pk_bf16_f32 v204,v232,v204
M a[116:119],a[220:223],v[224:227],0
v_cvt_pk_bf16_f32 v214,v237,v214
v_cvt_pk_bf16_f32 v206,v233,v206
M a[116:119],a[184:187],a[224:227],a[116:119]
v_cvt_pk_bf16_f32 v210,v234,v208
v_cvt_pk_bf16_f32 v208,v238,v235
M a[116:119],a[168:171],a[236:239],a[116:119]
v_cvt_pk_bf16_f32 v212,v236,v212
v_lshlrev_b32 v234,16,v209
M a[120:123],a[168:171],a[224:227],0
v_lshlrev_b32 v232,16,v205
v_lshlrev_b32 v233,16,v207
M a[120:123],a[184:187],v[224:227],a[120:123]
s_waitcnt lgkmcnt(1)
v_lshlrev_b32 v237,16,v215
v_lshlrev_b32 v236,16,v213
M a[120:123],a[220:223],a[252:255],a[120:123]
s_waitcnt lgkmcnt(0)
v_lshlrev_b32 v235,16,v211
v_fmac_f32 v232,s43,v234
M a[124:127],a[220:223],a[232:235],0
buffer_load_dwordx4 a[216:219],v250,s[20:23],s46 offen offset:1024 sc1
M a[124:127],a[184:187],a[252:255],a[124:127]
v_fmac_f32 v237,4.0,v233
v_fma_f32 v238,-4.0,v234,v236
M a[124:127],a[168:171],v[224:227],a[124:127]
s_waitcnt vmcnt(17)
buffer_load_dwordx4 v[220:223],v250,s[20:23],s46 offen offset:2048 sc1
M a[128:131],a[228:231],a[172:175],0
s_waitcnt vmcnt(17)
s_add_u32 s47,s72,30720
v_fmac_f32 v232,s45,v236
v_fmac_f32 v237,s41,v235
M a[128:131],a[160:163],a[180:183],a[128:131]
s_waitcnt vmcnt(16)
v_sub_f32 v236,v236,v234
v_fma_f32 v234,-4.0,v233,v235
M a[128:131],a[244:247],a[188:191],a[128:131]
v_sub_f32 v235,v235,v233
v_add_f32 v233,v238,v234
M a[132:135],a[244:247],a[200:203],0
buffer_load_dwordx4 a[196:199],v250,s[20:23],s47 offen offset:0 sc1
M a[132:135],a[160:163],a[188:191],a[132:135]
v_sub_f32 v238,v238,v234
v_fma_f32 v234,2.0,v235,v236
M a[132:135],a[228:231],a[180:183],a[132:135]
v_fmac_f32 v236,-2.0,v235
v_and_b32 v209,s42,v209
M a[136:139],a[228:231],a[188:191],0
v_and_b32 v205,s42,v205
v_and_b32 v207,s42,v207
M a[136:139],a[160:163],a[200:203],a[136:139]
v_and_b32 v215,s42,v215
v_and_b32 v213,s42,v213
M a[136:139],a[244:247],a[212:215],a[136:139]
v_and_b32 v211,s42,v211
v_fmac_f32 v205,s43,v209
M a[140:143],a[244:247],a[236:239],0
v_fmac_f32 v215,4.0,v207
v_fma_f32 v235,-4.0,v209,v213
M a[140:143],a[160:163],a[212:215],a[140:143]
v_fmac_f32 v205,s45,v213
v_fmac_f32 v215,s41,v211
M a[140:143],a[228:231],a[200:203],a[140:143]
v_sub_f32 v213,v213,v209
v_fma_f32 v209,-4.0,v207,v211
M a[144:147],a[228:231],a[212:215],0
v_sub_f32 v211,v211,v207
v_add_f32 v207,v235,v209
M a[144:147],a[160:163],a[236:239],a[144:147]
v_sub_f32 v235,v235,v209
v_fma_f32 v209,2.0,v211,v213
M a[144:147],a[244:247],a[224:227],a[144:147]
v_fmac_f32 v213,-2.0,v211
v_cvt_pk_bf16_f32 v205,v232,v205
M a[148:151],a[244:247],v[224:227],0
v_cvt_pk_bf16_f32 v215,v237,v215
v_cvt_pk_bf16_f32 v207,v233,v207
M a[148:151],a[160:163],a[224:227],a[148:151]
v_cvt_pk_bf16_f32 v211,v234,v209
v_cvt_pk_bf16_f32 v209,v238,v235
M a[148:151],a[228:231],a[236:239],a[148:151]
v_cvt_pk_bf16_f32 v213,v236,v213
v_fmac_f32 v239,s43,v241
M a[152:155],a[228:231],a[224:227],0
v_fmac_f32 v244,4.0,v240
v_fma_f32 v232,-4.0,v241,v243
M a[152:155],a[160:163],v[224:227],a[152:155]
v_fmac_f32 v239,s45,v243
v_fmac_f32 v244,s41,v242
M a[152:155],a[244:247],a[252:255],a[152:155]
ds_write2st64_b64 v247,v[204:205],v[214:215] offset0:171 offset1:188
M a[156:159],a[244:247],a[232:235],0
s_add_u32 s28,s67,7471104
buffer_load_dwordx4 a[192:195],v250,s[20:23],s47 offen offset:1024 sc1
M a[156:159],a[160:163],a[252:255],a[156:159]
v_sub_f32 v243,v243,v241
v_fma_f32 v241,-4.0,v240,v242
M a[156:159],a[228:231],v[224:227],a[156:159]
s_waitcnt vmcnt(17)
buffer_load_dwordx4 a[204:207],v250,s[20:23],s47 offen offset:2048 sc1
M a[160:163],a[240:243],a[172:175],0
s_waitcnt vmcnt(17)
s_add_u32 s48,s72,33792
v_sub_f32 v242,v242,v240
v_add_f32 v240,v232,v241
M a[160:163],v[216:219],a[180:183],a[160:163]
s_waitcnt vmcnt(16)
v_sub_f32 v232,v232,v241
v_fma_f32 v241,2.0,v242,v243
M a[160:163],a[248:251],a[188:191],a[160:163]
ds_write2st64_b64 v247,v[206:207],v[208:209] offset0:1 offset1:18
M a[164:167],a[248:251],a[200:203],0
buffer_load_dwordx4 a[208:211],v250,s[20:23],s48 offen offset:0 sc1
M a[164:167],v[216:219],a[188:191],a[164:167]
v_fmac_f32 v243,-2.0,v242
v_cvt_pk_bf16_f32 v233,v239,v244
M a[164:167],a[240:243],a[180:183],a[164:167]
ds_write2st64_b64 v247,v[210:211],v[212:213] offset0:137 offset1:154
M a[168:171],a[240:243],a[188:191],0
buffer_load_dwordx4 a[220:223],v250,s[20:23],s48 offen offset:1024 sc1
M a[168:171],v[216:219],a[200:203],a[168:171]
v_cvt_pk_bf16_f32 v234,v240,v232
v_cvt_pk_bf16_f32 v235,v241,v243
M a[168:171],a[248:251],a[212:215],a[168:171]
v_add_u32 v232,87040,v252
M a[172:175],a[248:251],a[236:239],0
ds_write_b16 v232,v233 offset:0
M a[172:175],v[216:219],a[212:215],a[172:175]
buffer_load_dwordx4 a[244:247],v250,s[20:23],s48 offen offset:2048 sc1
M a[172:175],a[240:243],a[200:203],a[172:175]
s_add_u32 s46,s72,36864
ds_write_b16_d16_hi v232,v233 offset:8704
M a[176:179],a[240:243],a[212:215],0
ds_write_b16 v252,v234 offset:0
M a[176:179],v[216:219],a[236:239],a[176:179]
ds_write_b16_d16_hi v252,v234 offset:8704
M a[176:179],a[248:251],a[224:227],a[176:179]
buffer_load_dwordx4 a[228:231],v250,s[20:23],s46 offen offset:0 sc1
M a[180:183],a[248:251],v[224:227],0
v_add_u32 v232,69632,v252
M a[180:183],v[216:219],a[224:227],a[180:183]
ds_read_b128 a[200:203],v248 offset:17408
ds_write_b16 v232,v235 offset:0
M a[180:183],a[240:243],a[236:239],a[180:183]
ds_read_b128 a[212:215],v249 offset:17408
ds_write_b16_d16_hi v232,v235 offset:8704
M a[184:187],a[240:243],a[224:227],0
buffer_load_dwordx2 v[204:205],v245,s[12:15],s28 offen offset:0
M a[184:187],v[216:219],v[224:227],a[184:187]
ds_read_b128 a[236:239],v248 offset:17920
ds_read_b128 a[224:227],v249 offset:17920
M a[184:187],a[248:251],a[252:255],a[184:187]
s_waitcnt vmcnt(12)
v_lshlrev_b32 v234,16,v196
v_lshlrev_b32 v232,16,v192
M a[188:191],a[248:251],a[232:235],0
buffer_load_dwordx2 v[214:215],v245,s[16:19],s28 offen offset:1536
M a[188:191],v[216:219],a[252:255],a[188:191]
v_lshlrev_b32 v233,16,v194
v_lshlrev_b32 v237,16,v202
M a[188:191],a[240:243],v[224:227],a[188:191]
s_waitcnt vmcnt(11) lgkmcnt(5)
v_lshlrev_b32 v236,16,v200
v_lshlrev_b32 v235,16,v198
M v[0:3],v[228:231],a[200:203],0
s_waitcnt vmcnt(10) lgkmcnt(3)
ds_read_b128 a[232:235],v248 offset:18432
v_fmac_f32 v232,s43,v234
M v[0:3],a[216:219],a[212:215],v[0:3]
s_waitcnt vmcnt(9) lgkmcnt(2)
buffer_load_dwordx2 v[206:207],v245,s[8:11],s28 offen offset:0
M v[0:3],v[220:223],a[236:239],v[0:3]
s_waitcnt lgkmcnt(1)
ds_read_b128 a[248:251],v249 offset:18432
v_fmac_f32 v237,4.0,v233
M v[4:7],v[220:223],a[224:227],0
v_fma_f32 v238,-4.0,v234,v236
v_fmac_f32 v232,s45,v236
M v[4:7],a[216:219],a[236:239],v[4:7]
v_fmac_f32 v237,s41,v235
v_sub_f32 v236,v236,v234
M v[4:7],v[228:231],a[212:215],v[4:7]
buffer_load_dwordx2 v[208:209],v245,s[8:11],s28 offen offset:384
M v[8:11],v[228:231],a[236:239],0
ds_read_b128 a[252:255],v248 offset:18944
v_fma_f32 v234,-4.0,v233,v235
M v[8:11],a[216:219],a[224:227],v[8:11]
s_waitcnt lgkmcnt(2)
ds_read_b128 v[216:219],v249 offset:18944
v_sub_f32 v235,v235,v233
M v[8:11],v[220:223],a[232:235],v[8:11]
s_waitcnt lgkmcnt(2)
v_add_f32 v233,v238,v234
v_sub_f32 v238,v238,v234
M v[12:15],v[220:223],a[248:251],0
buffer_load_dwordx2 v[210:211],v245,s[8:11],s28 offen offset:768
M v[12:15],a[216:219],a[232:235],v[12:15]
v_fma_f32 v234,2.0,v235,v236
v_fmac_f32 v236,-2.0,v235
M v[12:15],v[228:231],a[224:227],v[12:15]
v_and_b32 v196,s42,v196
v_and_b32 v192,s42,v192
M v[16:19],v[228:231],a[232:235],0
ds_read_b128 a[240:243],v249 offset:19456
v_and_b32 v194,s42,v194
M v[16:19],a[216:219],a[248:251],v[16:19]
s_waitcnt lgkmcnt(2)
buffer_load_dwordx2 v[212:213],v245,s[8:11],s28 offen offset:1152
M v[16:19],v[220:223],a[252:255],v[16:19]
s_waitcnt lgkmcnt(1)
s_add_u32 s29,s68,6291456
ds_read_b128 v[224:227],v248 offset:19456
v_and_b32 v202,s42,v202
M v[20:23],v[220:223],v[216:219],0
v_and_b32 v200,s42,v200
v_and_b32 v198,s42,v198
M v[20:23],a[216:219],a[252:255],v[20:23]
v_fmac_f32 v192,s43,v196
v_fmac_f32 v202,4.0,v194
M v[20:23],v[228:231],a[248:251],v[20:23]
buffer_load_short_d16_hi v239,v246,s[12:15],s29 offen offset:0
M v[24:27],v[228:231],a[252:255],0
v_fma_f32 v235,-4.0,v196,v200
v_fmac_f32 v192,s45,v200
M v[24:27],a[216:219],v[216:219],v[24:27]
s_waitcnt lgkmcnt(1)
buffer_load_short_d16_hi v240,v246,s[8:11],s29 offen offset:0
M v[24:27],v[220:223],a[240:243],v[24:27]
s_waitcnt lgkmcnt(0)
v_fmac_f32 v202,s41,v198
v_sub_f32 v200,v200,v196
M v[28:31],v[220:223],v[224:227],0
buffer_load_short_d16_hi v241,v246,s[8:11],s29 offen offset:384
M v[28:31],a[216:219],a[240:243],v[28:31]
v_fma_f32 v196,-4.0,v194,v198
v_sub_f32 v198,v198,v194
M v[28:31],v[228:231],v[216:219],v[28:31]
s_waitcnt vmcnt(15)
buffer_load_short_d16_hi v242,v246,s[8:11],s29 offen offset:768
M v[32:35],a[196:199],a[200:203],0
s_waitcnt vmcnt(15)
v_add_f32 v194,v235,v196
v_sub_f32 v235,v235,v196
M v[32:35],a[192:195],a[212:215],v[32:35]
s_waitcnt vmcnt(14)
buffer_load_short_d16_hi v243,v246,s[8:11],s29 offen offset:1152
M v[32:35],a[204:207],a[236:239],v[32:35]
v_fma_f32 v196,2.0,v198,v200
v_fmac_f32 v200,-2.0,v198
M v[36:39],a[204:207],a[224:227],0
buffer_load_short_d16_hi v244,v246,s[16:19],s29 offen offset:1536
M v[36:39],a[192:195],a[236:239],v[36:39]
v_cvt_pk_bf16_f32 v192,v232,v192
v_cvt_pk_bf16_f32 v202,v237,v202
M v[36:39],a[196:199],a[212:215],v[36:39]
global_load_dword v220,v250,s[64:65]
M v[40:43],a[196:199],a[236:239],0
v_cvt_pk_bf16_f32 v194,v233,v194
v_cvt_pk_bf16_f32 v198,v234,v196
M v[40:43],a[192:195],a[224:227],v[40:43]
buffer_load_dwordx4 v[220:223],v250,s[20:23],s46 offen offset:1024 sc1
M v[40:43],a[204:207],a[232:235],v[40:43]
v_cvt_pk_bf16_f32 v196,v238,v235
v_cvt_pk_bf16_f32 v200,v236,v200
M v[44:47],a[204:207],a[248:251],0
v_lshlrev_b32 v234,16,v197
v_lshlrev_b32 v232,16,v193
M v[44:47],a[192:195],a[232:235],v[44:47]
buffer_load_dwordx4 a[216:219],v250,s[20:23],s46 offen offset:2048 sc1
M v[44:47],a[196:199],a[224:227],v[44:47]
s_add_u32 s47,s72,39936
v_lshlrev_b32 v233,16,v195
v_lshlrev_b32 v237,16,v203
M v[48:51],a[196:199],a[232:235],0
v_lshlrev_b32 v236,16,v201
v_lshlrev_b32 v235,16,v199
M v[48:51],a[192:195],a[248:251],v[48:51]
v_fmac_f32 v232,s43,v234
v_fmac_f32 v237,4.0,v233
M v[48:51],a[204:207],a[252:255],v[48:51]
v_fma_f32 v238,-4.0,v234,v236
v_fmac_f32 v232,s45,v236
M v[52:55],a[204:207],v[216:219],0
buffer_load_dwordx4 v[228:231],v250,s[20:23],s47 offen offset:0 sc1
M v[52:55],a[192:195],a[252:255],v[52:55]
v_fmac_f32 v237,s41,v235
v_sub_f32 v236,v236,v234
M v[52:55],a[196:199],a[248:251],v[52:55]
v_fma_f32 v234,-4.0,v233,v235
v_sub_f32 v235,v235,v233
M v[56:59],a[196:199],a[252:255],0
v_add_f32 v233,v238,v234
v_sub_f32 v238,v238,v234
M v[56:59],a[192:195],v[216:219],v[56:59]
v_fma_f32 v234,2.0,v235,v236
v_fmac_f32 v236,-2.0,v235
M v[56:59],a[204:207],a[240:243],v[56:59]
v_and_b32 v197,s42,v197
v_and_b32 v193,s42,v193
M v[60:63],a[204:207],v[224:227],0
buffer_load_dwordx4 a[204:207],v250,s[20:23],s47 offen offset:1024 sc1
M v[60:63],a[192:195],a[240:243],v[60:63]
v_and_b32 v195,s42,v195
v_and_b32 v203,s42,v203
M v[60:63],a[196:199],v[216:219],v[60:63]
s_waitcnt vmcnt(20)
buffer_load_dwordx4 a[192:195],v250,s[20:23],s47 offen offset:2048 sc1
M v[64:67],a[208:211],a[200:203],0
s_waitcnt vmcnt(20)
s_add_u32 s48,s72,43008
v_and_b32 v201,s42,v201
v_and_b32 v199,s42,v199
M v[64:67],a[220:223],a[212:215],v[64:67]
s_waitcnt vmcnt(19)
v_fmac_f32 v193,s43,v197
v_fmac_f32 v203,4.0,v195
M v[64:67],a[244:247],a[236:239],v[64:67]
v_fma_f32 v235,-4.0,v197,v201
v_fmac_f32 v193,s45,v201
M v[68:71],a[244:247],a[224:227],0
buffer_load_dwordx4 a[196:199],v250,s[20:23],s48 offen offset:0 sc1
M v[68:71],a[220:223],a[236:239],v[68:71]
v_fmac_f32 v203,s41,v199
v_sub_f32 v201,v201,v197
M v[68:71],a[208:211],a[212:215],v[68:71]
v_fma_f32 v197,-4.0,v195,v199
v_sub_f32 v199,v199,v195
M v[72:75],a[208:211],a[236:239],0
v_add_f32 v195,v235,v197
v_sub_f32 v235,v235,v197
M v[72:75],a[220:223],a[224:227],v[72:75]
buffer_load_dwordx4 a[200:203],v250,s[20:23],s48 offen offset:1024 sc1
M v[72:75],a[244:247],a[232:235],v[72:75]
v_fma_f32 v197,2.0,v199,v201
v_fmac_f32 v201,-2.0,v199
M v[76:79],a[244:247],a[248:251],0
v_cvt_pk_bf16_f32 v193,v232,v193
v_cvt_pk_bf16_f32 v203,v237,v203
M v[76:79],a[220:223],a[232:235],v[76:79]
v_cvt_pk_bf16_f32 v195,v233,v195
v_cvt_pk_bf16_f32 v199,v234,v197
M v[76:79],a[208:211],a[224:227],v[76:79]
buffer_load_dwordx4 a[212:215],v250,s[20:23],s48 offen offset:2048 sc1
M v[80:83],a[208:211],a[232:235],0
s_add_u32 s46,s73,9216
v_cvt_pk_bf16_f32 v197,v238,v235
v_cvt_pk_bf16_f32 v201,v236,v201
M v[80:83],a[220:223],a[248:251],v[80:83]
s_waitcnt vmcnt(17)
v_lshlrev_b32 v234,16,v208
v_lshlrev_b32 v232,16,v204
M v[80:83],a[244:247],a[252:255],v[80:83]
ds_write2st64_b64 v247,v[192:193],v[202:203] offset0:172 offset1:189
M v[84:87],a[244:247],v[216:219],0
s_add_u32 s28,s68,6291456
buffer_load_dwordx4 a[236:239],v250,s[20:23],s46 offen offset:0 sc1
M v[84:87],a[220:223],a[252:255],v[84:87]
ds_read_b128 a[224:227],v248 offset:26112
v_lshlrev_b32 v233,16,v206
M v[84:87],a[208:211],a[248:251],v[84:87]
ds_write2st64_b64 v247,v[194:195],v[196:197] offset0:2 offset1:19
M v[88:91],a[208:211],a[252:255],0
buffer_load_dwordx2 v[192:193],v245,s[12:15],s28 offen offset:0
M v[88:91],a[220:223],v[216:219],v[88:91]
ds_read_b128 a[232:235],v249 offset:26112
ds_read_b128 a[248:251],v248 offset:26624
M v[88:91],a[244:247],a[240:243],v[88:91]
ds_write2st64_b64 v247,v[198:199],v[200:201] offset0:138 offset1:155
M v[92:95],a[244:247],v[224:227],0
buffer_load_dwordx2 v[202:203],v245,s[16:19],s28 offen offset:1536
M v[92:95],a[220:223],a[240:243],v[92:95]
ds_read_b128 a[252:255],v249 offset:26624
v_lshlrev_b32 v237,16,v214
M v[92:95],a[208:211],v[216:219],v[92:95]
s_waitcnt vmcnt(18) lgkmcnt(5)
v_lshlrev_b32 v236,16,v212
v_lshlrev_b32 v235,16,v210
M v[96:99],a[228:231],a[224:227],0
s_waitcnt vmcnt(10) lgkmcnt(3)
ds_read_b128 a[244:247],v248 offset:27136
v_fmac_f32 v232,s43,v234
M v[96:99],v[220:223],a[232:235],v[96:99]
s_waitcnt vmcnt(9) lgkmcnt(3)
buffer_load_dwordx2 v[194:195],v245,s[8:11],s28 offen offset:0
M v[96:99],a[216:219],a[248:251],v[96:99]
s_waitcnt lgkmcnt(1)
ds_read_b128 v[224:227],v249 offset:27136
v_fmac_f32 v237,4.0,v233
M v[100:103],a[216:219],a[252:255],0
v_fma_f32 v238,-4.0,v234,v236
v_fmac_f32 v232,s45,v236
M v[100:103],v[220:223],a[248:251],v[100:103]
v_fmac_f32 v237,s41,v235
v_sub_f32 v236,v236,v234
M v[100:103],a[228:231],a[232:235],v[100:103]
buffer_load_dwordx2 v[196:197],v245,s[8:11],s28 offen offset:384
M v[104:107],a[228:231],a[248:251],0
ds_read_b128 a[220:223],v248 offset:27648
v_fma_f32 v234,-4.0,v233,v235
M v[104:107],v[220:223],a[252:255],v[104:107]
s_waitcnt lgkmcnt(2)
ds_read_b128 a[240:243],v249 offset:27648
v_sub_f32 v235,v235,v233
M v[104:107],a[216:219],a[244:247],v[104:107]
s_waitcnt lgkmcnt(2)
v_add_f32 v233,v238,v234
v_sub_f32 v238,v238,v234
M v[108:111],a[216:219],v[224:227],0
buffer_load_dwordx2 v[198:199],v245,s[8:11],s28 offen offset:768
M v[108:111],v[220:223],a[244:247],v[108:111]
v_fma_f32 v234,2.0,v235,v236
v_fmac_f32 v236,-2.0,v235
M v[108:111],a[228:231],a[252:255],v[108:111]
v_and_b32 v208,s42,v208
v_and_b32 v204,s42,v204
M v[112:115],a[228:231],a[244:247],0
ds_read_b128 a[208:211],v249 offset:28160
v_and_b32 v206,s42,v206
M v[112:115],v[220:223],v[224:227],v[112:115]
s_waitcnt lgkmcnt(2)
buffer_load_dwordx2 v[200:201],v245,s[8:11],s28 offen offset:1152
M v[112:115],a[216:219],a[220:223],v[112:115]
s_waitcnt lgkmcnt(1)
ds_read_b128 v[216:219],v248 offset:28160
v_and_b32 v214,s42,v214
M v[116:119],a[216:219],a[240:243],0
v_and_b32 v212,s42,v212
v_and_b32 v210,s42,v210
M v[116:119],v[220:223],a[220:223],v[116:119]
v_fmac_f32 v204,s43,v208
v_fmac_f32 v214,4.0,v206
M v[116:119],a[228:231],v[224:227],v[116:119]
v_fma_f32 v235,-4.0,v208,v212
v_fmac_f32 v204,s45,v212
M v[120:123],a[228:231],a[220:223],0
v_fmac_f32 v214,s41,v210
v_sub_f32 v212,v212,v208
M v[120:123],v[220:223],a[240:243],v[120:123]
s_waitcnt lgkmcnt(1)
v_fma_f32 v208,-4.0,v206,v210
v_sub_f32 v210,v210,v206
M v[120:123],a[216:219],a[208:211],v[120:123]
s_waitcnt lgkmcnt(0)
v_add_f32 v206,v235,v208
v_sub_f32 v235,v235,v208
M v[124:127],a[216:219],v[216:219],0
buffer_load_dwordx4 a[216:219],v250,s[20:23],s46 offen offset:1024 sc1
M v[124:127],v[220:223],a[208:211],v[124:127]
v_fma_f32 v208,2.0,v210,v212
v_fmac_f32 v212,-2.0,v210
M v[124:127],a[228:231],a[240:243],v[124:127]
s_waitcnt vmcnt(13)
buffer_load_dwordx4 v[220:223],v250,s[20:23],s46 offen offset:2048 sc1
M v[128:131],v[228:231],a[224:227],0
s_waitcnt vmcnt(13)
s_add_u32 s47,s73,12288
v_cvt_pk_bf16_f32 v204,v232,v204
v_cvt_pk_bf16_f32 v214,v237,v214
M v[128:131],a[204:207],a[232:235],v[128:131]
s_waitcnt vmcnt(12)
v_cvt_pk_bf16_f32 v206,v233,v206
v_cvt_pk_bf16_f32 v210,v234,v208
M v[128:131],a[192:195],a[248:251],v[128:131]
v_cvt_pk_bf16_f32 v208,v238,v235
v_cvt_pk_bf16_f32 v212,v236,v212
M v[132:135],a[192:195],a[252:255],0
buffer_load_dwordx4 a[228:231],v250,s[20:23],s47 offen offset:0 sc1
M v[132:135],a[204:207],a[248:251],v[132:135]
v_lshlrev_b32 v234,16,v209
v_lshlrev_b32 v232,16,v205
M v[132:135],v[228:231],a[232:235],v[132:135]
v_lshlrev_b32 v233,16,v207
v_lshlrev_b32 v237,16,v215
M v[136:139],v[228:231],a[248:251],0
v_lshlrev_b32 v236,16,v213
v_lshlrev_b32 v235,16,v211
M v[136:139],a[204:207],a[252:255],v[136:139]
v_fmac_f32 v232,s43,v234
v_fmac_f32 v237,4.0,v233
M v[136:139],a[192:195],a[244:247],v[136:139]
v_fma_f32 v238,-4.0,v234,v236
v_fmac_f32 v232,s45,v236
M v[140:143],a[192:195],v[224:227],0
v_fmac_f32 v237,s41,v235
v_sub_f32 v236,v236,v234
M v[140:143],a[204:207],a[244:247],v[140:143]
v_fma_f32 v234,-4.0,v233,v235
v_sub_f32 v235,v235,v233
M v[140:143],v[228:231],a[252:255],v[140:143]
v_add_f32 v233,v238,v234
v_sub_f32 v238,v238,v234
M v[144:147],v[228:231],a[244:247],0
v_fma_f32 v234,2.0,v235,v236
v_fmac_f32 v236,-2.0,v235
M v[144:147],a[204:207],v[224:227],v[144:147]
v_and_b32 v209,s42,v209
v_and_b32 v205,s42,v205
M v[144:147],a[192:195],a[220:223],v[144:147]
v_and_b32 v207,s42,v207
v_and_b32 v215,s42,v215
M v[148:151],a[192:195],a[240:243],0
v_and_b32 v213,s42,v213
v_and_b32 v211,s42,v211
M v[148:151],a[204:207],a[220:223],v[148:151]
v_fmac_f32 v205,s43,v209
v_fmac_f32 v215,4.0,v207
M v[148:151],v[228:231],v[224:227],v[148:151]
v_fma_f32 v235,-4.0,v209,v213
v_fmac_f32 v205,s45,v213
M v[152:155],v[228:231],a[220:223],0
v_fmac_f32 v215,s41,v211
v_sub_f32 v213,v213,v209
M v[152:155],a[204:207],a[240:243],v[152:155]
v_fma_f32 v209,-4.0,v207,v211
v_sub_f32 v211,v211,v207
M v[152:155],a[192:195],a[208:211],v[152:155]
v_add_f32 v207,v235,v209
v_sub_f32 v235,v235,v209
M v[156:159],a[192:195],v[216:219],0
buffer_load_dwordx4 a[192:195],v250,s[20:23],s47 offen offset:1024 sc1
M v[156:159],a[204:207],a[208:211],v[156:159]
v_fma_f32 v209,2.0,v211,v213
v_fmac_f32 v213,-2.0,v211
M v[156:159],v[228:231],a[240:243],v[156:159]
s_waitcnt vmcnt(13)
buffer_load_dwordx4 a[204:207],v250,s[20:23],s47 offen offset:2048 sc1
M v[160:163],a[196:199],a[224:227],0
s_waitcnt vmcnt(13)
s_add_u32 s48,s73,15360
v_cvt_pk_bf16_f32 v205,v232,v205
v_cvt_pk_bf16_f32 v215,v237,v215
M v[160:163],a[200:203],a[232:235],v[160:163]
s_waitcnt vmcnt(12)
v_cvt_pk_bf16_f32 v207,v233,v207
v_cvt_pk_bf16_f32 v211,v234,v209
M v[160:163],a[212:215],a[248:251],v[160:163]
v_cvt_pk_bf16_f32 v209,v238,v235
v_cvt_pk_bf16_f32 v213,v236,v213
M v[164:167],a[212:215],a[252:255],0
buffer_load_dwordx4 v[228:231],v250,s[20:23],s48 offen offset:0 sc1
M v[164:167],a[200:203],a[248:251],v[164:167]
M v[164:167],a[196:199],a[232:235],v[164:167]
ds_write2st64_b64 v247,v[204:205],v[214:215] offset0:173 offset1:190
M v[168:171],a[196:199],a[248:251],0
s_add_u32 s28,s68,6684672
M v[168:171],a[200:203],a[252:255],v[168:171]
buffer_load_dwordx4 a[224:227],v250,s[20:23],s48 offen offset:1024 sc1
M v[168:171],a[212:215],a[244:247],v[168:171]
ds_write2st64_b64 v247,v[206:207],v[208:209] offset0:3 offset1:20
M v[172:175],a[212:215],v[224:227],0
M v[172:175],a[200:203],a[244:247],v[172:175]
buffer_load_dwordx4 a[232:235],v250,s[20:23],s48 offen offset:2048 sc1
M v[172:175],a[196:199],a[252:255],v[172:175]
s_add_u32 s46,s73,18432
ds_write2st64_b64 v247,v[210:211],v[212:213] offset0:139 offset1:156
M v[176:179],a[196:199],a[244:247],0
M v[176:179],a[200:203],v[224:227],v[176:179]
buffer_load_dwordx4 a[248:251],v250,s[20:23],s46 offen offset:0 sc1
M v[176:179],a[212:215],a[220:223],v[176:179]
s_waitcnt lgkmcnt(0)
s_barrier
v_add_u32 v248,0xffffbc00,v248
M v[180:183],a[212:215],a[240:243],0
v_add_u32 v249,0xffffbc00,v249
M v[180:183],a[200:203],a[220:223],v[180:183]
ds_read_b128 a[252:255],v248 offset:0
M v[180:183],a[196:199],v[224:227],v[180:183]
buffer_load_dwordx2 v[204:205],v245,s[12:15],s28 offen offset:0
M v[184:187],a[196:199],a[220:223],0
ds_read_b128 a[244:247],v249 offset:0
ds_read_b128 v[224:227],v248 offset:512
M v[184:187],a[200:203],a[240:243],v[184:187]
ds_read_b128 a[220:223],v249 offset:512
M v[184:187],a[212:215],a[208:211],v[184:187]
M v[188:191],a[212:215],v[216:219],0
buffer_load_dwordx2 v[214:215],v245,s[16:19],s28 offen offset:1536
M v[188:191],a[200:203],a[208:211],v[188:191]
M v[188:191],a[196:199],a[240:243],v[188:191]
s_waitcnt vmcnt(17) lgkmcnt(3)
M a[0:3],a[236:239],a[252:255],a[0:3]
s_waitcnt vmcnt(10) lgkmcnt(2)
ds_read_b128 a[212:215],v248 offset:1024
M a[0:3],a[216:219],a[244:247],a[0:3]
s_waitcnt vmcnt(9) lgkmcnt(2)
buffer_load_dwordx2 v[206:207],v245,s[8:11],s28 offen offset:0
M a[0:3],v[220:223],v[224:227],a[0:3]
s_waitcnt lgkmcnt(1)
ds_read_b128 v[216:219],v249 offset:1024
v_lshlrev_b32 v234,16,v196
M a[4:7],v[220:223],a[220:223],a[4:7]
v_lshlrev_b32 v232,16,v192
v_lshlrev_b32 v233,16,v194
M a[4:7],a[216:219],v[224:227],a[4:7]
v_lshlrev_b32 v237,16,v202
v_lshlrev_b32 v236,16,v200
M a[4:7],a[236:239],a[244:247],a[4:7]
buffer_load_dwordx2 v[208:209],v245,s[8:11],s28 offen offset:384
M a[8:11],a[236:239],v[224:227],a[8:11]
ds_read_b128 a[200:203],v248 offset:1536
v_lshlrev_b32 v235,16,v198
M a[8:11],a[216:219],a[220:223],a[8:11]
s_waitcnt lgkmcnt(2)
ds_read_b128 a[208:211],v249 offset:1536
v_fmac_f32 v232,s43,v234
M a[8:11],v[220:223],a[212:215],a[8:11]
s_waitcnt lgkmcnt(2)
v_fmac_f32 v237,4.0,v233
v_fma_f32 v238,-4.0,v234,v236
M a[12:15],v[220:223],v[216:219],a[12:15]
buffer_load_dwordx2 v[210:211],v245,s[8:11],s28 offen offset:768
M a[12:15],a[216:219],a[212:215],a[12:15]
v_fmac_f32 v232,s45,v236
v_fmac_f32 v237,s41,v235
M a[12:15],a[236:239],a[220:223],a[12:15]
v_sub_f32 v236,v236,v234
v_fma_f32 v234,-4.0,v233,v235
M a[16:19],a[236:239],a[212:215],a[16:19]
ds_read_b128 a[196:199],v249 offset:2048
v_sub_f32 v235,v235,v233
M a[16:19],a[216:219],v[216:219],a[16:19]
s_waitcnt lgkmcnt(2)
buffer_load_dwordx2 v[212:213],v245,s[8:11],s28 offen offset:1152
M a[16:19],v[220:223],a[200:203],a[16:19]
s_waitcnt lgkmcnt(1)
ds_read_b128 a[240:243],v248 offset:2048
v_add_f32 v233,v238,v234
M a[20:23],v[220:223],a[208:211],a[20:23]
v_sub_f32 v238,v238,v234
v_fma_f32 v234,2.0,v235,v236
M a[20:23],a[216:219],a[200:203],a[20:23]
v_fmac_f32 v236,-2.0,v235
v_and_b32 v196,s42,v196
M a[20:23],a[236:239],v[216:219],a[20:23]
v_and_b32 v192,s42,v192
v_and_b32 v194,s42,v194
M a[24:27],a[236:239],a[200:203],a[24:27]
v_and_b32 v202,s42,v202
v_and_b32 v200,s42,v200
M a[24:27],a[216:219],a[208:211],a[24:27]
s_waitcnt lgkmcnt(1)
v_and_b32 v198,s42,v198
v_fmac_f32 v192,s43,v196
M a[24:27],v[220:223],a[196:199],a[24:27]
s_waitcnt lgkmcnt(0)
v_fmac_f32 v202,4.0,v194
v_fma_f32 v235,-4.0,v196,v200
M a[28:31],v[220:223],a[240:243],a[28:31]
buffer_load_dwordx4 v[220:223],v250,s[20:23],s46 offen offset:1024 sc1
M a[28:31],a[216:219],a[196:199],a[28:31]
v_fmac_f32 v192,s45,v200
v_fmac_f32 v202,s41,v198
M a[28:31],a[236:239],a[208:211],a[28:31]
s_waitcnt vmcnt(13)
buffer_load_dwordx4 a[216:219],v250,s[20:23],s46 offen offset:2048 sc1
M a[32:35],a[228:231],a[252:255],a[32:35]
s_waitcnt vmcnt(13)
s_add_u32 s47,s73,21504
v_sub_f32 v200,v200,v196
v_fma_f32 v196,-4.0,v194,v198
M a[32:35],a[192:195],a[244:247],a[32:35]
s_waitcnt vmcnt(12)
v_sub_f32 v198,v198,v194
v_add_f32 v194,v235,v196
M a[32:35],a[204:207],v[224:227],a[32:35]
v_sub_f32 v235,v235,v196
v_fma_f32 v196,2.0,v198,v200
M a[36:39],a[204:207],a[220:223],a[36:39]
buffer_load_dwordx4 a[236:239],v250,s[20:23],s47 offen offset:0 sc1
M a[36:39],a[192:195],v[224:227],a[36:39]
v_fmac_f32 v200,-2.0,v198
v_cvt_pk_bf16_f32 v192,v232,v192
M a[36:39],a[228:231],a[244:247],a[36:39]
v_cvt_pk_bf16_f32 v202,v237,v202
v_cvt_pk_bf16_f32 v194,v233,v194
M a[40:43],a[228:231],v[224:227],a[40:43]
v_cvt_pk_bf16_f32 v198,v234,v196
v_cvt_pk_bf16_f32 v196,v238,v235
M a[40:43],a[192:195],a[220:223],a[40:43]
v_cvt_pk_bf16_f32 v200,v236,v200
v_lshlrev_b32 v234,16,v197
M a[40:43],a[204:207],a[212:215],a[40:43]
v_lshlrev_b32 v232,16,v193
v_lshlrev_b32 v233,16,v195
M a[44:47],a[204:207],v[216:219],a[44:47]
v_lshlrev_b32 v237,16,v203
v_lshlrev_b32 v236,16,v201
M a[44:47],a[192:195],a[212:215],a[44:47]
v_lshlrev_b32 v235,16,v199
v_fmac_f32 v232,s43,v234
M a[44:47],a[228:231],a[220:223],a[44:47]
v_fmac_f32 v237,4.0,v233
v_fma_f32 v238,-4.0,v234,v236
M a[48:51],a[228:231],a[212:215],a[48:51]
v_fmac_f32 v232,s45,v236
v_fmac_f32 v237,s41,v235
M a[48:51],a[192:195],v[216:219],a[48:51]
v_sub_f32 v236,v236,v234
v_fma_f32 v234,-4.0,v233,v235
M a[48:51],a[204:207],a[200:203],a[48:51]
v_sub_f32 v235,v235,v233
v_add_f32 v233,v238,v234
M a[52:55],a[204:207],a[208:211],a[52:55]
v_sub_f32 v238,v238,v234
v_fma_f32 v234,2.0,v235,v236
M a[52:55],a[192:195],a[200:203],a[52:55]
v_fmac_f32 v236,-2.0,v235
v_and_b32 v197,s42,v197
M a[52:55],a[228:231],v[216:219],a[52:55]
v_and_b32 v193,s42,v193
v_and_b32 v195,s42,v195
M a[56:59],a[228:231],a[200:203],a[56:59]
v_and_b32 v203,s42,v203
v_and_b32 v201,s42,v201
M a[56:59],a[192:195],a[208:211],a[56:59]
v_and_b32 v199,s42,v199
v_fmac_f32 v193,s43,v197
M a[56:59],a[204:207],a[196:199],a[56:59]
v_fmac_f32 v203,4.0,v195
v_fma_f32 v235,-4.0,v197,v201
M a[60:63],a[204:207],a[240:243],a[60:63]
buffer_load_dwordx4 a[204:207],v250,s[20:23],s47 offen offset:1024 sc1
M a[60:63],a[192:195],a[196:199],a[60:63]
v_fmac_f32 v193,s45,v201
v_fmac_f32 v203,s41,v199
M a[60:63],a[228:231],a[208:211],a[60:63]
s_waitcnt vmcnt(13)
buffer_load_dwordx4 a[192:195],v250,s[20:23],s47 offen offset:2048 sc1
M a[64:67],v[228:231],a[252:255],a[64:67]
s_waitcnt vmcnt(13)
s_add_u32 s48,s73,24576
v_sub_f32 v201,v201,v197
v_fma_f32 v197,-4.0,v195,v199
M a[64:67],a[224:227],a[244:247],a[64:67]
s_waitcnt vmcnt(12)
v_sub_f32 v199,v199,v195
v_add_f32 v195,v235,v197
M a[64:67],a[232:235],v[224:227],a[64:67]
v_sub_f32 v235,v235,v197
v_fma_f32 v197,2.0,v199,v201
M a[68:71],a[232:235],a[220:223],a[68:71]
buffer_load_dwordx4 a[228:231],v250,s[20:23],s48 offen offset:0 sc1
M a[68:71],a[224:227],v[224:227],a[68:71]
v_fmac_f32 v201,-2.0,v199
v_cvt_pk_bf16_f32 v193,v232,v193
M a[68:71],v[228:231],a[244:247],a[68:71]
v_cvt_pk_bf16_f32 v203,v237,v203
v_cvt_pk_bf16_f32 v195,v233,v195
M a[72:75],v[228:231],v[224:227],a[72:75]
v_cvt_pk_bf16_f32 v199,v234,v197
v_cvt_pk_bf16_f32 v197,v238,v235
M a[72:75],a[224:227],a[220:223],a[72:75]
buffer_load_dwordx4 a[252:255],v250,s[20:23],s48 offen offset:1024 sc1
M a[72:75],a[232:235],a[212:215],a[72:75]
v_cvt_pk_bf16_f32 v201,v236,v201
M a[76:79],a[232:235],v[216:219],a[76:79]
M a[76:79],a[224:227],a[212:215],a[76:79]
M a[76:79],v[228:231],a[220:223],a[76:79]
buffer_load_dwordx4 a[244:247],v250,s[20:23],s48 offen offset:2048 sc1
M a[80:83],v[228:231],a[212:215],a[80:83]
s_add_u32 s46,s73,27648
M a[80:83],a[224:227],v[216:219],a[80:83]
M a[80:83],a[232:235],a[200:203],a[80:83]
ds_write2st64_b64 v247,v[192:193],v[202:203] offset0:204 offset1:221
M a[84:87],a[232:235],a[208:211],a[84:87]
s_add_u32 s28,s68,7077888
buffer_load_dwordx4 v[224:227],v250,s[20:23],s46 offen offset:0 sc1
M a[84:87],a[224:227],a[200:203],a[84:87]
ds_read_b128 a[220:223],v248 offset:8704
M a[84:87],v[228:231],v[216:219],a[84:87]
ds_write2st64_b64 v247,v[194:195],v[196:197] offset0:34 offset1:51
M a[88:91],v[228:231],a[200:203],a[88:91]
buffer_load_dwordx2 v[192:193],v245,s[12:15],s28 offen offset:0
M a[88:91],a[224:227],a[208:211],a[88:91]
ds_read_b128 a[212:215],v249 offset:8704
ds_read_b128 v[216:219],v248 offset:9216
M a[88:91],a[232:235],a[196:199],a[88:91]
ds_write2st64_b64 v247,v[198:199],v[200:201] offset0:68 offset1:85
M a[92:95],a[232:235],a[240:243],a[92:95]
buffer_load_dwordx2 v[202:203],v245,s[16:19],s28 offen offset:1536
M a[92:95],a[224:227],a[196:199],a[92:95]
ds_read_b128 a[200:203],v249 offset:9216
M a[92:95],v[228:231],a[208:211],a[92:95]
s_waitcnt vmcnt(17) lgkmcnt(5)
M a[96:99],a[248:251],a[220:223],a[96:99]
s_waitcnt vmcnt(10) lgkmcnt(3)
ds_read_b128 a[232:235],v248 offset:9728
M a[96:99],v[220:223],a[212:215],a[96:99]
s_waitcnt vmcnt(9) lgkmcnt(3)
buffer_load_dwordx2 v[194:195],v245,s[8:11],s28 offen offset:0
M a[96:99],a[216:219],v[216:219],a[96:99]
s_waitcnt lgkmcnt(1)
ds_read_b128 a[240:243],v249 offset:9728
v_lshlrev_b32 v234,16,v208
M a[100:103],a[216:219],a[200:203],a[100:103]
v_lshlrev_b32 v232,16,v204
v_lshlrev_b32 v233,16,v206
M a[100:103],v[220:223],v[216:219],a[100:103]
v_lshlrev_b32 v237,16,v214
v_lshlrev_b32 v236,16,v212
M a[100:103],a[248:251],a[212:215],a[100:103]
buffer_load_dwordx2 v[196:197],v245,s[8:11],s28 offen offset:384
M a[104:107],a[248:251],v[216:219],a[104:107]
ds_read_b128 a[196:199],v248 offset:10240
v_lshlrev_b32 v235,16,v210
M a[104:107],v[220:223],a[200:203],a[104:107]
s_waitcnt lgkmcnt(2)
ds_read_b128 a[224:227],v249 offset:10240
v_fmac_f32 v232,s43,v234
M a[104:107],a[216:219],a[232:235],a[104:107]
s_waitcnt lgkmcnt(2)
v_fmac_f32 v237,4.0,v233
v_fma_f32 v238,-4.0,v234,v236
M a[108:111],a[216:219],a[240:243],a[108:111]
buffer_load_dwordx2 v[198:199],v245,s[8:11],s28 offen offset:768
M a[108:111],v[220:223],a[232:235],a[108:111]
v_fmac_f32 v232,s45,v236
v_fmac_f32 v237,s41,v235
M a[108:111],a[248:251],a[200:203],a[108:111]
v_sub_f32 v236,v236,v234
v_fma_f32 v234,-4.0,v233,v235
M a[112:115],a[248:251],a[232:235],a[112:115]
ds_read_b128 a[208:211],v249 offset:10752
v_sub_f32 v235,v235,v233
M a[112:115],v[220:223],a[240:243],a[112:115]
s_waitcnt lgkmcnt(2)
buffer_load_dwordx2 v[200:201],v245,s[8:11],s28 offen offset:1152
M a[112:115],a[216:219],a[196:199],a[112:115]
s_waitcnt lgkmcnt(1)
ds_read_b128 v[228:231],v248 offset:10752
v_add_f32 v233,v238,v234
M a[116:119],a[216:219],a[224:227],a[116:119]
v_sub_f32 v238,v238,v234
v_fma_f32 v234,2.0,v235,v236
M a[116:119],v[220:223],a[196:199],a[116:119]
v_fmac_f32 v236,-2.0,v235
v_and_b32 v208,s42,v208
M a[116:119],a[248:251],a[240:243],a[116:119]
v_and_b32 v204,s42,v204
v_and_b32 v206,s42,v206
M a[120:123],a[248:251],a[196:199],a[120:123]
v_and_b32 v214,s42,v214
v_and_b32 v212,s42,v212
M a[120:123],v[220:223],a[224:227],a[120:123]
s_waitcnt lgkmcnt(1)
v_and_b32 v210,s42,v210
v_fmac_f32 v204,s43,v208
M a[120:123],a[216:219],a[208:211],a[120:123]
s_waitcnt lgkmcnt(0)
v_fmac_f32 v214,4.0,v206
v_fma_f32 v235,-4.0,v208,v212
M a[124:127],a[216:219],v[228:231],a[124:127]
buffer_load_dwordx4 a[216:219],v250,s[20:23],s46 offen offset:1024 sc1
M a[124:127],v[220:223],a[208:211],a[124:127]
v_fmac_f32 v204,s45,v212
v_fmac_f32 v214,s41,v210
M a[124:127],a[248:251],a[224:227],a[124:127]
s_waitcnt vmcnt(13)
buffer_load_dwordx4 v[220:223],v250,s[20:23],s46 offen offset:2048 sc1
M a[128:131],a[236:239],a[220:223],a[128:131]
s_waitcnt vmcnt(13)
s_add_u32 s47,s73,30720
v_sub_f32 v212,v212,v208
v_fma_f32 v208,-4.0,v206,v210
M a[128:131],a[204:207],a[212:215],a[128:131]
s_waitcnt vmcnt(12)
v_sub_f32 v210,v210,v206
v_add_f32 v206,v235,v208
M a[128:131],a[192:195],v[216:219],a[128:131]
v_sub_f32 v235,v235,v208
v_fma_f32 v208,2.0,v210,v212
M a[132:135],a[192:195],a[200:203],a[132:135]
buffer_load_dwordx4 a[248:251],v250,s[20:23],s47 offen offset:0 sc1
M a[132:135],a[204:207],v[216:219],a[132:135]
v_fmac_f32 v212,-2.0,v210
v_cvt_pk_bf16_f32 v204,v232,v204
M a[132:135],a[236:239],a[212:215],a[132:135]
v_cvt_pk_bf16_f32 v214,v237,v214
v_cvt_pk_bf16_f32 v206,v233,v206
M a[136:139],a[236:239],v[216:219],a[136:139]
v_cvt_pk_bf16_f32 v210,v234,v208
v_cvt_pk_bf16_f32 v208,v238,v235
M a[136:139],a[204:207],a[200:203],a[136:139]
v_cvt_pk_bf16_f32 v212,v236,v212
v_lshlrev_b32 v234,16,v209
M a[136:139],a[192:195],a[232:235],a[136:139]
v_lshlrev_b32 v232,16,v205
v_lshlrev_b32 v233,16,v207
M a[140:143],a[192:195],a[240:243],a[140:143]
v_lshlrev_b32 v237,16,v215
v_lshlrev_b32 v236,16,v213
M a[140:143],a[204:207],a[232:235],a[140:143]
v_lshlrev_b32 v235,16,v211
v_fmac_f32 v232,s43,v234
M a[140:143],a[236:239],a[200:203],a[140:143]
v_fmac_f32 v237,4.0,v233
v_fma_f32 v238,-4.0,v234,v236
M a[144:147],a[236:239],a[232:235],a[144:147]
v_fmac_f32 v232,s45,v236
v_fmac_f32 v237,s41,v235
M a[144:147],a[204:207],a[240:243],a[144:147]
v_sub_f32 v236,v236,v234
v_fma_f32 v234,-4.0,v233,v235
M a[144:147],a[192:195],a[196:199],a[144:147]
v_sub_f32 v235,v235,v233
v_add_f32 v233,v238,v234
M a[148:151],a[192:195],a[224:227],a[148:151]
v_sub_f32 v238,v238,v234
v_fma_f32 v234,2.0,v235,v236
M a[148:151],a[204:207],a[196:199],a[148:151]
v_fmac_f32 v236,-2.0,v235
v_and_b32 v209,s42,v209
M a[148:151],a[236:239],a[240:243],a[148:151]
v_and_b32 v205,s42,v205
v_and_b32 v207,s42,v207
M a[152:155],a[236:239],a[196:199],a[152:155]
v_and_b32 v215,s42,v215
v_and_b32 v213,s42,v213
M a[152:155],a[204:207],a[224:227],a[152:155]
v_and_b32 v211,s42,v211
v_fmac_f32 v205,s43,v209
M a[152:155],a[192:195],a[208:211],a[152:155]
v_fmac_f32 v215,4.0,v207
v_fma_f32 v235,-4.0,v209,v213
M a[156:159],a[192:195],v[228:231],a[156:159]
buffer_load_dwordx4 a[192:195],v250,s[20:23],s47 offen offset:1024 sc1
M a[156:159],a[204:207],a[208:211],a[156:159]
v_fmac_f32 v205,s45,v213
v_fmac_f32 v215,s41,v211
M a[156:159],a[236:239],a[224:227],a[156:159]
s_waitcnt vmcnt(13)
buffer_load_dwordx4 a[204:207],v250,s[20:23],s47 offen offset:2048 sc1
M a[160:163],a[228:231],a[220:223],a[160:163]
s_waitcnt vmcnt(13)
s_add_u32 s48,s73,33792
v_sub_f32 v213,v213,v209
v_fma_f32 v209,-4.0,v207,v211
M a[160:163],a[252:255],a[212:215],a[160:163]
s_waitcnt vmcnt(12)
v_sub_f32 v211,v211,v207
v_add_f32 v207,v235,v209
M a[160:163],a[244:247],v[216:219],a[160:163]
v_sub_f32 v235,v235,v209
v_fma_f32 v209,2.0,v211,v213
M a[164:167],a[244:247],a[200:203],a[164:167]
buffer_load_dwordx4 a[236:239],v250,s[20:23],s48 offen offset:0 sc1
M a[164:167],a[252:255],v[216:219],a[164:167]
v_fmac_f32 v213,-2.0,v211
v_cvt_pk_bf16_f32 v205,v232,v205
M a[164:167],a[228:231],a[212:215],a[164:167]
v_cvt_pk_bf16_f32 v215,v237,v215
v_cvt_pk_bf16_f32 v207,v233,v207
M a[168:171],a[228:231],v[216:219],a[168:171]
v_cvt_pk_bf16_f32 v211,v234,v209
v_cvt_pk_bf16_f32 v209,v238,v235
M a[168:171],a[252:255],a[200:203],a[168:171]
buffer_load_dwordx4 a[220:223],v250,s[20:23],s48 offen offset:1024 sc1
M a[168:171],a[244:247],a[232:235],a[168:171]
v_cvt_pk_bf16_f32 v213,v236,v213
v_fmac_f32 v239,s43,v241
M a[172:175],a[244:247],a[240:243],a[172:175]
v_fmac_f32 v244,4.0,v240
v_fma_f32 v232,-4.0,v241,v243
M a[172:175],a[252:255],a[232:235],a[172:175]
v_fmac_f32 v239,s45,v243
v_fmac_f32 v244,s41,v242
M a[172:175],a[228:231],a[200:203],a[172:175]
buffer_load_dwordx4 a[212:215],v250,s[20:23],s48 offen offset:2048 sc1
M a[176:179],a[228:231],a[232:235],a[176:179]
s_add_u32 s46,s73,36864
v_sub_f32 v243,v243,v241
v_fma_f32 v241,-4.0,v240,v242
M a[176:179],a[252:255],a[240:243],a[176:179]
v_add_u32 v248,0x4400,v248
v_add_u32 v249,0x4400,v249
M a[176:179],a[244:247],a[196:199],a[176:179]
ds_write2st64_b64 v247,v[204:205],v[214:215] offset0:205 offset1:222
M a[180:183],a[244:247],a[224:227],a[180:183]
s_add_u32 s28,s68,7471104
buffer_load_dwordx4 v[216:219],v250,s[20:23],s46 offen offset:0 sc1
M a[180:183],a[252:255],a[196:199],a[180:183]
ds_read_b128 a[200:203],v248 offset:52224
v_sub_f32 v242,v242,v240
M a[180:183],a[228:231],a[240:243],a[180:183]
ds_write2st64_b64 v247,v[206:207],v[208:209] offset0:35 offset1:52
M a[184:187],a[228:231],a[196:199],a[184:187]
buffer_load_dwordx2 v[204:205],v245,s[12:15],s28 offen offset:0
M a[184:187],a[252:255],a[224:227],a[184:187]
ds_read_b128 a[232:235],v249 offset:52224
ds_read_b128 a[240:243],v248 offset:52736
M a[184:187],a[244:247],a[208:211],a[184:187]
ds_write2st64_b64 v247,v[210:211],v[212:213] offset0:69 offset1:86
M a[188:191],a[244:247],v[228:231],a[188:191]
buffer_load_dwordx2 v[214:215],v245,s[16:19],s28 offen offset:1536
M a[188:191],a[252:255],a[208:211],a[188:191]
ds_read_b128 a[196:199],v249 offset:52736
v_add_f32 v240,v232,v241
M a[188:191],a[228:231],a[224:227],a[188:191]
s_waitcnt vmcnt(17) lgkmcnt(5)
v_sub_f32 v232,v232,v241
v_fma_f32 v241,2.0,v242,v243
M v[0:3],v[224:227],a[200:203],v[0:3]
s_waitcnt vmcnt(10) lgkmcnt(3)
ds_read_b128 a[244:247],v248 offset:53248
v_fmac_f32 v243,-2.0,v242
M v[0:3],a[216:219],a[232:235],v[0:3]
s_waitcnt vmcnt(9) lgkmcnt(3)
buffer_load_dwordx2 v[206:207],v245,s[8:11],s28 offen offset:0
M v[0:3],v[220:223],a[240:243],v[0:3]
s_waitcnt lgkmcnt(1)
ds_read_b128 v[228:231],v249 offset:53248
v_cvt_pk_bf16_f32 v233,v239,v244
M v[4:7],v[220:223],a[196:199],v[4:7]
v_cvt_pk_bf16_f32 v234,v240,v232
v_cvt_pk_bf16_f32 v235,v241,v243
M v[4:7],a[216:219],a[240:243],v[4:7]
v_add_u32 v232,104448,v252
M v[4:7],v[224:227],a[232:235],v[4:7]
buffer_load_dwordx2 v[208:209],v245,s[8:11],s28 offen offset:384
M v[8:11],v[224:227],a[240:243],v[8:11]
ds_read_b128 a[208:211],v248 offset:53760
ds_write_b16 v232,v233 offset:0
M v[8:11],a[216:219],a[196:199],v[8:11]
s_waitcnt lgkmcnt(3)
ds_read_b128 a[252:255],v249 offset:53760
ds_write_b16_d16_hi v232,v233 offset:8704
M v[8:11],v[220:223],a[244:247],v[8:11]
s_waitcnt lgkmcnt(4)
ds_write_b16 v252,v234 offset:17408
M v[12:15],v[220:223],v[228:231],v[12:15]
buffer_load_dwordx2 v[210:211],v245,s[8:11],s28 offen offset:768
M v[12:15],a[216:219],a[244:247],v[12:15]
ds_write_b16_d16_hi v252,v234 offset:26112
M v[12:15],v[224:227],a[196:199],v[12:15]
ds_write_b16 v252,v235 offset:34816
M v[16:19],v[224:227],a[244:247],v[16:19]
ds_read_b128 a[224:227],v249 offset:54272
ds_write_b16_d16_hi v252,v235 offset:43520
M v[16:19],a[216:219],v[228:231],v[16:19]
s_waitcnt lgkmcnt(8)
buffer_load_dwordx2 v[212:213],v245,s[8:11],s28 offen offset:1152
M v[16:19],v[220:223],a[208:211],v[16:19]
s_waitcnt lgkmcnt(6)
s_add_u32 s29,s69,6291456
ds_read_b128 a[228:231],v248 offset:54272
v_lshlrev_b32 v234,16,v196
M v[20:23],v[220:223],a[252:255],v[20:23]
v_lshlrev_b32 v232,16,v192
v_lshlrev_b32 v233,16,v194
M v[20:23],a[216:219],a[208:211],v[20:23]
buffer_load_short_d16_hi v239,v246,s[12:15],s29 offen offset:0
M v[20:23],v[224:227],v[228:231],v[20:23]
v_lshlrev_b32 v237,16,v202
v_lshlrev_b32 v236,16,v200
M v[24:27],v[224:227],a[208:211],v[24:27]
buffer_load_short_d16_hi v240,v246,s[8:11],s29 offen offset:0
M v[24:27],a[216:219],a[252:255],v[24:27]
s_waitcnt lgkmcnt(2)
v_lshlrev_b32 v235,16,v198
v_fmac_f32 v232,s43,v234
M v[24:27],v[220:223],a[224:227],v[24:27]
s_waitcnt lgkmcnt(0)
buffer_load_short_d16_hi v241,v246,s[8:11],s29 offen offset:384
M v[28:31],v[220:223],a[228:231],v[28:31]
v_fmac_f32 v237,4.0,v233
v_fma_f32 v238,-4.0,v234,v236
M v[28:31],a[216:219],a[224:227],v[28:31]
buffer_load_dwordx4 v[220:223],v250,s[20:23],s46 offen offset:1024 sc1
M v[28:31],v[224:227],a[252:255],v[28:31]
s_waitcnt vmcnt(16)
v_fmac_f32 v232,s45,v236
v_fmac_f32 v237,s41,v235
M v[32:35],a[248:251],a[200:203],v[32:35]
s_waitcnt vmcnt(15)
v_sub_f32 v236,v236,v234
v_fma_f32 v234,-4.0,v233,v235
M v[32:35],a[192:195],a[232:235],v[32:35]
s_waitcnt vmcnt(14)
v_sub_f32 v235,v235,v233
v_add_f32 v233,v238,v234
M v[32:35],a[204:207],a[240:243],v[32:35]
buffer_load_dwordx4 a[216:219],v250,s[20:23],s46 offen offset:2048 sc1
M v[36:39],a[204:207],a[196:199],v[36:39]
s_add_u32 s47,s73,39936
v_sub_f32 v238,v238,v234
v_fma_f32 v234,2.0,v235,v236
M v[36:39],a[192:195],a[240:243],v[36:39]
v_fmac_f32 v236,-2.0,v235
v_and_b32 v196,s42,v196
M v[36:39],a[248:251],a[232:235],v[36:39]
v_and_b32 v192,s42,v192
v_and_b32 v194,s42,v194
M v[40:43],a[248:251],a[240:243],v[40:43]
buffer_load_dwordx4 v[224:227],v250,s[20:23],s47 offen offset:0 sc1
M v[40:43],a[192:195],a[196:199],v[40:43]
v_and_b32 v202,s42,v202
v_and_b32 v200,s42,v200
M v[40:43],a[204:207],a[244:247],v[40:43]
v_and_b32 v198,s42,v198
v_fmac_f32 v192,s43,v196
M v[44:47],a[204:207],v[228:231],v[44:47]
v_fmac_f32 v202,4.0,v194
v_fma_f32 v235,-4.0,v196,v200
M v[44:47],a[192:195],a[244:247],v[44:47]
buffer_load_short_d16_hi v242,v246,s[8:11],s29 offen offset:768
M v[44:47],a[248:251],a[196:199],v[44:47]
v_fmac_f32 v192,s45,v200
v_fmac_f32 v202,s41,v198
M v[48:51],a[248:251],a[244:247],v[48:51]
buffer_load_short_d16_hi v243,v246,s[8:11],s29 offen offset:1152
M v[48:51],a[192:195],v[228:231],v[48:51]
v_sub_f32 v200,v200,v196
v_fma_f32 v196,-4.0,v194,v198
M v[48:51],a[204:207],a[208:211],v[48:51]
buffer_load_short_d16_hi v244,v246,s[16:19],s29 offen offset:1536
M v[52:55],a[204:207],a[252:255],v[52:55]
v_sub_f32 v198,v198,v194
v_add_f32 v194,v235,v196
M v[52:55],a[192:195],a[208:211],v[52:55]
v_sub_f32 v235,v235,v196
v_fma_f32 v196,2.0,v198,v200
M v[52:55],a[248:251],v[228:231],v[52:55]
v_fmac_f32 v200,-2.0,v198
v_cvt_pk_bf16_f32 v192,v232,v192
M v[56:59],a[248:251],a[208:211],v[56:59]
v_cvt_pk_bf16_f32 v202,v237,v202
v_cvt_pk_bf16_f32 v194,v233,v194
M v[56:59],a[192:195],a[252:255],v[56:59]
v_cvt_pk_bf16_f32 v198,v234,v196
v_cvt_pk_bf16_f32 v196,v238,v235
M v[56:59],a[204:207],a[224:227],v[56:59]
v_cvt_pk_bf16_f32 v200,v236,v200
v_lshlrev_b32 v234,16,v197
M v[60:63],a[204:207],a[228:231],v[60:63]
buffer_load_dwordx4 a[204:207],v250,s[20:23],s47 offen offset:1024 sc1
M v[60:63],a[192:195],a[224:227],v[60:63]
v_lshlrev_b32 v232,16,v193
v_lshlrev_b32 v233,16,v195
M v[60:63],a[248:251],a[252:255],v[60:63]
s_waitcnt vmcnt(19)
buffer_load_dwordx4 a[192:195],v250,s[20:23],s47 offen offset:2048 sc1
M v[64:67],a[236:239],a[200:203],v[64:67]
s_waitcnt vmcnt(19)
s_add_u32 s48,s73,43008
v_lshlrev_b32 v237,16,v203
v_lshlrev_b32 v236,16,v201
M v[64:67],a[220:223],a[232:235],v[64:67]
s_waitcnt vmcnt(18)
v_lshlrev_b32 v235,16,v199
v_fmac_f32 v232,s43,v234
M v[64:67],a[212:215],a[240:243],v[64:67]
v_fmac_f32 v237,4.0,v233
v_fma_f32 v238,-4.0,v234,v236
M v[68:71],a[212:215],a[196:199],v[68:71]
buffer_load_dwordx4 a[248:251],v250,s[20:23],s48 offen offset:0 sc1
M v[68:71],a[220:223],a[240:243],v[68:71]
v_fmac_f32 v232,s45,v236
v_fmac_f32 v237,s41,v235
M v[68:71],a[236:239],a[232:235],v[68:71]
v_sub_f32 v236,v236,v234
v_fma_f32 v234,-4.0,v233,v235
M v[72:75],a[236:239],a[240:243],v[72:75]
v_sub_f32 v235,v235,v233
v_add_f32 v233,v238,v234
M v[72:75],a[220:223],a[196:199],v[72:75]
buffer_load_dwordx4 a[200:203],v250,s[20:23],s48 offen offset:1024 sc1
M v[72:75],a[212:215],a[244:247],v[72:75]
v_sub_f32 v238,v238,v234
v_fma_f32 v234,2.0,v235,v236
M v[76:79],a[212:215],v[228:231],v[76:79]
v_fmac_f32 v236,-2.0,v235
v_and_b32 v197,s42,v197
M v[76:79],a[220:223],a[244:247],v[76:79]
v_and_b32 v193,s42,v193
v_and_b32 v195,s42,v195
M v[76:79],a[236:239],a[196:199],v[76:79]
buffer_load_dwordx4 a[232:235],v250,s[20:23],s48 offen offset:2048 sc1
M v[80:83],a[236:239],a[244:247],v[80:83]
s_add_u32 s46,s74,9216
v_and_b32 v203,s42,v203
v_and_b32 v201,s42,v201
M v[80:83],a[220:223],v[228:231],v[80:83]
v_and_b32 v199,s42,v199
v_fmac_f32 v193,s43,v197
M v[80:83],a[212:215],a[208:211],v[80:83]
v_fmac_f32 v203,4.0,v195
v_fma_f32 v235,-4.0,v197,v201
M v[84:87],a[212:215],a[252:255],v[84:87]
buffer_load_dwordx4 a[240:243],v250,s[20:23],s46 offen offset:0 sc1
M v[84:87],a[220:223],a[208:211],v[84:87]
ds_read_b128 a[196:199],v248 offset:60928
v_fmac_f32 v193,s45,v201
M v[84:87],a[236:239],v[228:231],v[84:87]
ds_read_b128 a[244:247],v249 offset:60928
v_fmac_f32 v203,s41,v199
M v[88:91],a[236:239],a[208:211],v[88:91]
ds_read_b128 v[228:231],v248 offset:61440
v_sub_f32 v201,v201,v197
M v[88:91],a[220:223],a[252:255],v[88:91]
ds_read_b128 a[208:211],v249 offset:61440
v_fma_f32 v197,-4.0,v195,v199
M v[88:91],a[212:215],a[224:227],v[88:91]
v_sub_f32 v199,v199,v195
v_add_f32 v195,v235,v197
M v[92:95],a[212:215],a[228:231],v[92:95]
v_sub_f32 v235,v235,v197
v_fma_f32 v197,2.0,v199,v201
M v[92:95],a[220:223],a[224:227],v[92:95]
v_fmac_f32 v201,-2.0,v199
v_cvt_pk_bf16_f32 v193,v232,v193
M v[92:95],a[236:239],a[252:255],v[92:95]
s_waitcnt vmcnt(21) lgkmcnt(3)
v_cvt_pk_bf16_f32 v203,v237,v203
v_cvt_pk_bf16_f32 v195,v233,v195
M v[96:99],v[216:219],a[196:199],v[96:99]
s_waitcnt vmcnt(11) lgkmcnt(2)
ds_read_b128 a[212:215],v248 offset:61952
v_cvt_pk_bf16_f32 v199,v234,v197
M v[96:99],v[220:223],a[244:247],v[96:99]
s_waitcnt vmcnt(10) lgkmcnt(2)
ds_read_b128 a[228:231],v249 offset:61952
v_cvt_pk_bf16_f32 v197,v238,v235
M v[96:99],a[216:219],v[228:231],v[96:99]
s_waitcnt lgkmcnt(2)
v_cvt_pk_bf16_f32 v201,v236,v201
v_lshlrev_b32 v234,16,v208
M v[100:103],a[216:219],a[208:211],v[100:103]
v_lshlrev_b32 v232,16,v204
v_lshlrev_b32 v233,16,v206
M v[100:103],v[220:223],v[228:231],v[100:103]
v_lshlrev_b32 v237,16,v214
v_lshlrev_b32 v236,16,v212
M v[100:103],v[216:219],a[244:247],v[100:103]
ds_write2st64_b64 v247,v[192:193],v[202:203] offset0:206 offset1:223
M v[104:107],v[216:219],v[228:231],v[104:107]
s_add_u32 s28,s69,6291456
buffer_load_dwordx2 v[192:193],v245,s[12:15],s28 offen offset:0
M v[104:107],v[220:223],a[208:211],v[104:107]
s_waitcnt lgkmcnt(2)
ds_read_b128 a[220:223],v248 offset:62464
ds_read_b128 a[224:227],v249 offset:62464
M v[104:107],a[216:219],a[212:215],v[104:107]
s_waitcnt lgkmcnt(3)
buffer_load_dwordx2 v[202:203],v245,s[16:19],s28 offen offset:1536
M v[108:111],a[216:219],a[228:231],v[108:111]
v_lshlrev_b32 v235,16,v210
v_fmac_f32 v232,s43,v234
M v[108:111],v[220:223],a[212:215],v[108:111]
v_fmac_f32 v237,4.0,v233
v_fma_f32 v238,-4.0,v234,v236
M v[108:111],v[216:219],a[208:211],v[108:111]
ds_write2st64_b64 v247,v[194:195],v[196:197] offset0:36 offset1:53
M v[112:115],v[216:219],a[212:215],v[112:115]
buffer_load_dwordx2 v[194:195],v245,s[8:11],s28 offen offset:0
M v[112:115],v[220:223],a[228:231],v[112:115]
s_waitcnt lgkmcnt(2)
ds_read_b128 a[236:239],v249 offset:62976
ds_read_b128 a[252:255],v248 offset:62976
M v[112:115],a[216:219],a[220:223],v[112:115]
s_waitcnt lgkmcnt(3)
ds_write2st64_b64 v247,v[198:199],v[200:201] offset0:70 offset1:87
M v[116:119],a[216:219],a[224:227],v[116:119]
buffer_load_dwordx2 v[196:197],v245,s[8:11],s28 offen offset:384
M v[116:119],v[220:223],a[220:223],v[116:119]
v_fmac_f32 v232,s45,v236
v_fmac_f32 v237,s41,v235
M v[116:119],v[216:219],a[228:231],v[116:119]
v_sub_f32 v236,v236,v234
v_fma_f32 v234,-4.0,v233,v235
M v[120:123],v[216:219],a[220:223],v[120:123]
v_sub_f32 v235,v235,v233
v_add_f32 v233,v238,v234
M v[120:123],v[220:223],a[224:227],v[120:123]
s_waitcnt lgkmcnt(2)
buffer_load_dwordx2 v[198:199],v245,s[8:11],s28 offen offset:768
M v[120:123],a[216:219],a[236:239],v[120:123]
s_waitcnt lgkmcnt(1)
v_sub_f32 v238,v238,v234
v_fma_f32 v234,2.0,v235,v236
M v[124:127],a[216:219],a[252:255],v[124:127]
v_fmac_f32 v236,-2.0,v235
v_and_b32 v208,s42,v208
M v[124:127],v[220:223],a[236:239],v[124:127]
v_and_b32 v204,s42,v204
v_and_b32 v206,s42,v206
M v[124:127],v[216:219],a[224:227],v[124:127]
s_waitcnt vmcnt(14)
buffer_load_dwordx4 a[216:219],v250,s[20:23],s46 offen offset:1024 sc1
M v[128:131],v[224:227],a[196:199],v[128:131]
s_waitcnt vmcnt(11)
v_and_b32 v214,s42,v214
v_and_b32 v212,s42,v212
M v[128:131],a[204:207],a[244:247],v[128:131]
s_waitcnt vmcnt(10)
v_and_b32 v210,s42,v210
v_fmac_f32 v204,s43,v208
M v[128:131],a[192:195],v[228:231],v[128:131]
v_fmac_f32 v214,4.0,v206
v_fma_f32 v235,-4.0,v208,v212
M v[132:135],a[192:195],a[208:211],v[132:135]
buffer_load_dwordx4 v[220:223],v250,s[20:23],s46 offen offset:2048 sc1
M v[132:135],a[204:207],v[228:231],v[132:135]
s_add_u32 s47,s74,12288
v_fmac_f32 v204,s45,v212
v_fmac_f32 v214,s41,v210
M v[132:135],v[224:227],a[244:247],v[132:135]
v_sub_f32 v212,v212,v208
v_fma_f32 v208,-4.0,v206,v210
M v[136:139],v[224:227],v[228:231],v[136:139]
v_sub_f32 v210,v210,v206
v_add_f32 v206,v235,v208
M v[136:139],a[204:207],a[208:211],v[136:139]
buffer_load_dwordx4 v[216:219],v250,s[20:23],s47 offen offset:0 sc1
M v[136:139],a[192:195],a[212:215],v[136:139]
v_sub_f32 v235,v235,v208
v_fma_f32 v208,2.0,v210,v212
M v[140:143],a[192:195],a[228:231],v[140:143]
v_fmac_f32 v212,-2.0,v210
v_cvt_pk_bf16_f32 v204,v232,v204
M v[140:143],a[204:207],a[212:215],v[140:143]
v_cvt_pk_bf16_f32 v214,v237,v214
v_cvt_pk_bf16_f32 v206,v233,v206
M v[140:143],v[224:227],a[208:211],v[140:143]
buffer_load_dwordx2 v[200:201],v245,s[8:11],s28 offen offset:1152
M v[144:147],v[224:227],a[212:215],v[144:147]
v_cvt_pk_bf16_f32 v210,v234,v208
v_cvt_pk_bf16_f32 v208,v238,v235
M v[144:147],a[204:207],a[228:231],v[144:147]
v_cvt_pk_bf16_f32 v212,v236,v212
v_lshlrev_b32 v234,16,v209
M v[144:147],a[192:195],a[220:223],v[144:147]
v_lshlrev_b32 v232,16,v205
v_lshlrev_b32 v233,16,v207
M v[148:151],a[192:195],a[224:227],v[148:151]
v_lshlrev_b32 v237,16,v215
v_lshlrev_b32 v236,16,v213
M v[148:151],a[204:207],a[220:223],v[148:151]
v_lshlrev_b32 v235,16,v211
v_fmac_f32 v232,s43,v234
M v[148:151],v[224:227],a[228:231],v[148:151]
v_fmac_f32 v237,4.0,v233
v_fma_f32 v238,-4.0,v234,v236
M v[152:155],v[224:227],a[220:223],v[152:155]
v_fmac_f32 v232,s45,v236
v_fmac_f32 v237,s41,v235
M v[152:155],a[204:207],a[224:227],v[152:155]
v_sub_f32 v236,v236,v234
v_fma_f32 v234,-4.0,v233,v235
M v[152:155],a[192:195],a[236:239],v[152:155]
v_sub_f32 v235,v235,v233
v_add_f32 v233,v238,v234
M v[156:159],a[192:195],a[252:255],v[156:159]
buffer_load_dwordx4 a[192:195],v250,s[20:23],s47 offen offset:1024 sc1
v_sub_f32 v238,v238,v234
v_fma_f32 v234,2.0,v235,v236
M v[156:159],a[204:207],a[236:239],v[156:159]
v_fmac_f32 v236,-2.0,v235
v_and_b32 v209,s42,v209
v_and_b32 v205,s42,v205
v_and_b32 v207,s42,v207
M v[156:159],v[224:227],a[224:227],v[156:159]
s_waitcnt vmcnt(13)
buffer_load_dwordx4 a[204:207],v250,s[20:23],s47 offen offset:2048 sc1
v_and_b32 v215,s42,v215
v_and_b32 v213,s42,v213
v_and_b32 v211,s42,v211
v_fmac_f32 v205,s43,v209
M v[160:163],a[248:251],a[196:199],v[160:163]
s_waitcnt vmcnt(13)
s_add_u32 s48,s74,15360
v_fmac_f32 v215,4.0,v207
v_fma_f32 v235,-4.0,v209,v213
v_fmac_f32 v205,s45,v213
v_fmac_f32 v215,s41,v211
M v[160:163],a[200:203],a[244:247],v[160:163]
s_waitcnt vmcnt(12)
buffer_load_dwordx4 v[224:227],v250,s[20:23],s48 offen offset:0 sc1
v_sub_f32 v213,v213,v209
v_fma_f32 v209,-4.0,v207,v211
v_sub_f32 v211,v211,v207
v_add_f32 v207,v235,v209
M v[160:163],a[232:235],v[228:231],v[160:163]
v_sub_f32 v235,v235,v209
v_fma_f32 v209,2.0,v211,v213
v_fmac_f32 v213,-2.0,v211
v_cvt_pk_bf16_f32 v205,v232,v205
M v[164:167],a[232:235],a[208:211],v[164:167]
buffer_load_dwordx4 a[196:199],v250,s[20:23],s48 offen offset:1024 sc1
v_cvt_pk_bf16_f32 v215,v237,v215
v_cvt_pk_bf16_f32 v207,v233,v207
v_cvt_pk_bf16_f32 v211,v234,v209
v_cvt_pk_bf16_f32 v209,v238,v235
M v[164:167],a[200:203],v[228:231],v[164:167]
v_cvt_pk_bf16_f32 v213,v236,v213
M v[164:167],a[248:251],a[244:247],v[164:167]
ds_write2st64_b64 v247,v[204:205],v[214:215] offset0:207 offset1:224
M v[168:171],a[248:251],v[228:231],v[168:171]
s_add_u32 s28,s69,6684672
buffer_load_dwordx4 a[244:247],v250,s[20:23],s48 offen offset:2048 sc1
M v[168:171],a[200:203],a[208:211],v[168:171]
s_add_u32 s46,s74,18432
M v[168:171],a[232:235],a[212:215],v[168:171]
ds_write2st64_b64 v247,v[206:207],v[208:209] offset0:37 offset1:54
M v[172:175],a[232:235],a[228:231],v[172:175]
buffer_load_dwordx4 v[228:231],v250,s[20:23],s46 offen offset:0 sc1
M v[172:175],a[200:203],a[212:215],v[172:175]
M v[172:175],a[248:251],a[208:211],v[172:175]
ds_write2st64_b64 v247,v[210:211],v[212:213] offset0:71 offset1:88
M v[176:179],a[248:251],a[212:215],v[176:179]
buffer_load_dwordx2 v[204:205],v245,s[12:15],s28 offen offset:0
M v[176:179],a[200:203],a[228:231],v[176:179]
M v[176:179],a[232:235],a[220:223],v[176:179]
s_waitcnt lgkmcnt(0)
s_barrier
M v[180:183],a[232:235],a[224:227],v[180:183]
M v[180:183],a[200:203],a[220:223],v[180:183]
buffer_load_dwordx2 v[214:215],v245,s[16:19],s28 offen offset:1536
M v[180:183],a[248:251],a[228:231],v[180:183]
ds_read_b128 a[208:211],v248 offset:0
ds_read_b128 a[212:215],v249 offset:0
M v[184:187],a[248:251],a[220:223],v[184:187]
s_waitcnt vmcnt(13)
ds_read_b128 a[228:231],v248 offset:512
v_lshlrev_b32 v234,16,v196
M v[184:187],a[200:203],a[224:227],v[184:187]
ds_read_b128 a[220:223],v249 offset:512
v_lshlrev_b32 v232,16,v192
M v[184:187],a[232:235],a[236:239],v[184:187]
buffer_load_dwordx2 v[206:207],v245,s[8:11],s28 offen offset:0
M v[188:191],a[232:235],a[252:255],v[188:191]
v_lshlrev_b32 v233,16,v194
v_lshlrev_b32 v237,16,v202
M v[188:191],a[200:203],a[236:239],v[188:191]
s_waitcnt vmcnt(9)
v_lshlrev_b32 v236,16,v200
v_lshlrev_b32 v235,16,v198
M v[188:191],a[248:251],a[224:227],v[188:191]
s_waitcnt lgkmcnt(3)
v_fmac_f32 v232,s43,v234
v_fmac_f32 v237,4.0,v233
M a[0:3],a[240:243],a[208:211],a[0:3]
s_waitcnt lgkmcnt(2)
buffer_load_dwordx2 v[208:209],v245,s[8:11],s28 offen offset:384
M a[0:3],a[216:219],a[212:215],a[0:3]
s_waitcnt lgkmcnt(1)
ds_read_b128 a[232:235],v248 offset:1024
ds_read_b128 a[252:255],v249 offset:1024
M a[0:3],v[220:223],a[228:231],a[0:3]
s_waitcnt lgkmcnt(2)
v_fma_f32 v238,-4.0,v234,v236
v_fmac_f32 v232,s45,v236
M a[4:7],v[220:223],a[220:223],a[4:7]
v_fmac_f32 v237,s41,v235
v_sub_f32 v236,v236,v234
M a[4:7],a[216:219],a[228:231],a[4:7]
buffer_load_dwordx2 v[210:211],v245,s[8:11],s28 offen offset:768
M a[4:7],a[240:243],a[212:215],a[4:7]
v_fma_f32 v234,-4.0,v233,v235
v_sub_f32 v235,v235,v233
M a[8:11],a[240:243],a[228:231],a[8:11]
ds_read_b128 a[200:203],v248 offset:1536
v_add_f32 v233,v238,v234
M a[8:11],a[216:219],a[220:223],a[8:11]
s_waitcnt lgkmcnt(2)
ds_read_b128 a[236:239],v249 offset:1536
v_sub_f32 v238,v238,v234
M a[8:11],v[220:223],a[232:235],a[8:11]
s_waitcnt lgkmcnt(2)
buffer_load_dwordx2 v[212:213],v245,s[8:11],s28 offen offset:1152
M a[12:15],v[220:223],a[252:255],a[12:15]
v_fma_f32 v234,2.0,v235,v236
v_fmac_f32 v236,-2.0,v235
M a[12:15],a[216:219],a[232:235],a[12:15]
v_and_b32 v196,s42,v196
v_and_b32 v192,s42,v192
M a[12:15],a[240:243],a[220:223],a[12:15]
v_and_b32 v194,s42,v194
v_and_b32 v202,s42,v202
M a[16:19],a[240:243],a[232:235],a[16:19]
ds_read_b128 a[224:227],v249 offset:2048
v_and_b32 v200,s42,v200
M a[16:19],a[216:219],a[252:255],a[16:19]
s_waitcnt lgkmcnt(2)
ds_read_b128 a[248:251],v248 offset:2048
v_and_b32 v198,s42,v198
M a[16:19],v[220:223],a[200:203],a[16:19]
s_waitcnt lgkmcnt(2)
v_fmac_f32 v192,s43,v196
v_fmac_f32 v202,4.0,v194
M a[20:23],v[220:223],a[236:239],a[20:23]
v_fma_f32 v235,-4.0,v196,v200
v_fmac_f32 v192,s45,v200
M a[20:23],a[216:219],a[200:203],a[20:23]
v_fmac_f32 v202,s41,v198
v_sub_f32 v200,v200,v196
M a[20:23],a[240:243],a[252:255],a[20:23]
v_fma_f32 v196,-4.0,v194,v198
v_sub_f32 v198,v198,v194
M a[24:27],a[240:243],a[200:203],a[24:27]
v_add_f32 v194,v235,v196
v_sub_f32 v235,v235,v196
M a[24:27],a[216:219],a[236:239],a[24:27]
s_waitcnt lgkmcnt(1)
v_fma_f32 v196,2.0,v198,v200
v_fmac_f32 v200,-2.0,v198
M a[24:27],v[220:223],a[224:227],a[24:27]
s_waitcnt lgkmcnt(0)
v_cvt_pk_bf16_f32 v192,v232,v192
v_cvt_pk_bf16_f32 v202,v237,v202
M a[28:31],v[220:223],a[248:251],a[28:31]
buffer_load_dwordx4 v[220:223],v250,s[20:23],s46 offen offset:1024 sc1
M a[28:31],a[216:219],a[224:227],a[28:31]
v_cvt_pk_bf16_f32 v194,v233,v194
v_cvt_pk_bf16_f32 v198,v234,v196
M a[28:31],a[240:243],a[236:239],a[28:31]
buffer_load_dwordx4 a[216:219],v250,s[20:23],s46 offen offset:2048 sc1
M a[32:35],v[216:219],a[208:211],a[32:35]
s_waitcnt vmcnt(13)
s_add_u32 s47,s74,21504
v_cvt_pk_bf16_f32 v196,v238,v235
v_cvt_pk_bf16_f32 v200,v236,v200
M a[32:35],a[192:195],a[212:215],a[32:35]
s_waitcnt vmcnt(12)
v_lshlrev_b32 v234,16,v197
v_lshlrev_b32 v232,16,v193
M a[32:35],a[204:207],a[228:231],a[32:35]
v_lshlrev_b32 v233,16,v195
v_lshlrev_b32 v237,16,v203
M a[36:39],a[204:207],a[220:223],a[36:39]
buffer_load_dwordx4 a[240:243],v250,s[20:23],s47 offen offset:0 sc1
M a[36:39],a[192:195],a[228:231],a[36:39]
v_lshlrev_b32 v236,16,v201
v_lshlrev_b32 v235,16,v199
M a[36:39],v[216:219],a[212:215],a[36:39]
v_fmac_f32 v232,s43,v234
v_fmac_f32 v237,4.0,v233
M a[40:43],v[216:219],a[228:231],a[40:43]
v_fma_f32 v238,-4.0,v234,v236
v_fmac_f32 v232,s45,v236
M a[40:43],a[192:195],a[220:223],a[40:43]
v_fmac_f32 v237,s41,v235
v_sub_f32 v236,v236,v234
M a[40:43],a[204:207],a[232:235],a[40:43]
v_fma_f32 v234,-4.0,v233,v235
v_sub_f32 v235,v235,v233
M a[44:47],a[204:207],a[252:255],a[44:47]
v_add_f32 v233,v238,v234
v_sub_f32 v238,v238,v234
M a[44:47],a[192:195],a[232:235],a[44:47]
v_fma_f32 v234,2.0,v235,v236
v_fmac_f32 v236,-2.0,v235
M a[44:47],v[216:219],a[220:223],a[44:47]
v_and_b32 v197,s42,v197
v_and_b32 v193,s42,v193
M a[48:51],v[216:219],a[232:235],a[48:51]
v_and_b32 v195,s42,v195
v_and_b32 v203,s42,v203
M a[48:51],a[192:195],a[252:255],a[48:51]
v_and_b32 v201,s42,v201
v_and_b32 v199,s42,v199
M a[48:51],a[204:207],a[200:203],a[48:51]
v_fmac_f32 v193,s43,v197
v_fmac_f32 v203,4.0,v195
M a[52:55],a[204:207],a[236:239],a[52:55]
v_fma_f32 v235,-4.0,v197,v201
v_fmac_f32 v193,s45,v201
M a[52:55],a[192:195],a[200:203],a[52:55]
v_fmac_f32 v203,s41,v199
v_sub_f32 v201,v201,v197
M a[52:55],v[216:219],a[252:255],a[52:55]
v_fma_f32 v197,-4.0,v195,v199
v_sub_f32 v199,v199,v195
M a[56:59],v[216:219],a[200:203],a[56:59]
v_add_f32 v195,v235,v197
v_sub_f32 v235,v235,v197
M a[56:59],a[192:195],a[236:239],a[56:59]
v_fma_f32 v197,2.0,v199,v201
v_fmac_f32 v201,-2.0,v199
M a[56:59],a[204:207],a[224:227],a[56:59]
v_cvt_pk_bf16_f32 v193,v232,v193
v_cvt_pk_bf16_f32 v203,v237,v203
M a[60:63],a[204:207],a[248:251],a[60:63]
buffer_load_dwordx4 a[204:207],v250,s[20:23],s47 offen offset:1024 sc1
M a[60:63],a[192:195],a[224:227],a[60:63]
v_cvt_pk_bf16_f32 v195,v233,v195
v_cvt_pk_bf16_f32 v199,v234,v197
M a[60:63],v[216:219],a[236:239],a[60:63]
s_waitcnt vmcnt(13)
buffer_load_dwordx4 a[192:195],v250,s[20:23],s47 offen offset:2048 sc1
M a[64:67],v[224:227],a[208:211],a[64:67]
s_waitcnt vmcnt(13)
s_add_u32 s48,s74,24576
v_cvt_pk_bf16_f32 v197,v238,v235
v_cvt_pk_bf16_f32 v201,v236,v201
M a[64:67],a[196:199],a[212:215],a[64:67]
s_waitcnt vmcnt(7)
v_lshlrev_b32 v234,16,v208
v_lshlrev_b32 v232,16,v204
M a[64:67],a[244:247],a[228:231],a[64:67]
ds_write2st64_b64 v247,v[192:193],v[202:203] offset0:238 offset1:255
M a[68:71],a[244:247],a[220:223],a[68:71]
s_add_u32 s28,s69,7077888
buffer_load_dwordx4 v[216:219],v250,s[20:23],s48 offen offset:0 sc1
M a[68:71],a[196:199],a[228:231],a[68:71]
v_lshlrev_b32 v233,16,v206
v_lshlrev_b32 v237,16,v214
M a[68:71],v[224:227],a[212:215],a[68:71]
ds_write2st64_b64 v247,v[194:195],v[196:197] offset0:0 offset1:17
M a[72:75],v[224:227],a[228:231],a[72:75]
buffer_load_dwordx4 a[208:211],v250,s[20:23],s48 offen offset:1024 sc1
M a[72:75],a[196:199],a[220:223],a[72:75]
s_waitcnt vmcnt(7)
v_lshlrev_b32 v236,16,v212
v_lshlrev_b32 v235,16,v210
M a[72:75],a[244:247],a[232:235],a[72:75]
ds_write2st64_b64 v247,v[198:199],v[200:201] offset0:136 offset1:153
M a[76:79],a[244:247],a[252:255],a[76:79]
buffer_load_dwordx4 a[212:215],v250,s[20:23],s48 offen offset:2048 sc1
M a[76:79],a[196:199],a[232:235],a[76:79]
s_add_u32 s46,s74,27648
v_fmac_f32 v232,s43,v234
v_fmac_f32 v237,4.0,v233
M a[76:79],v[224:227],a[220:223],a[76:79]
v_fma_f32 v238,-4.0,v234,v236
v_fmac_f32 v232,s45,v236
M a[80:83],v[224:227],a[232:235],a[80:83]
v_fmac_f32 v237,s41,v235
v_sub_f32 v236,v236,v234
M a[80:83],a[196:199],a[252:255],a[80:83]
buffer_load_dwordx4 a[228:231],v250,s[20:23],s46 offen offset:0 sc1
M a[80:83],a[244:247],a[200:203],a[80:83]
v_fma_f32 v234,-4.0,v233,v235
v_sub_f32 v235,v235,v233
M a[84:87],a[244:247],a[236:239],a[84:87]
v_add_f32 v233,v238,v234
v_sub_f32 v238,v238,v234
M a[84:87],a[196:199],a[200:203],a[84:87]
ds_read_b128 a[220:223],v248 offset:8704
v_fma_f32 v234,2.0,v235,v236
M a[84:87],v[224:227],a[252:255],a[84:87]
buffer_load_dwordx2 v[192:193],v245,s[12:15],s28 offen offset:0
M a[88:91],v[224:227],a[200:203],a[88:91]
ds_read_b128 a[232:235],v249 offset:8704
ds_read_b128 a[252:255],v248 offset:9216
M a[88:91],a[196:199],a[236:239],a[88:91]
ds_read_b128 a[200:203],v249 offset:9216
v_fmac_f32 v236,-2.0,v235
M a[88:91],a[244:247],a[224:227],a[88:91]
v_and_b32 v208,s42,v208
v_and_b32 v204,s42,v204
M a[92:95],a[244:247],a[248:251],a[92:95]
buffer_load_dwordx2 v[202:203],v245,s[16:19],s28 offen offset:1536
M a[92:95],a[196:199],a[224:227],a[92:95]
v_and_b32 v206,s42,v206
v_and_b32 v214,s42,v214
M a[92:95],v[224:227],a[236:239],a[92:95]
s_waitcnt lgkmcnt(3)
v_and_b32 v212,s42,v212
v_and_b32 v210,s42,v210
M a[96:99],v[228:231],a[220:223],a[96:99]
s_waitcnt vmcnt(10) lgkmcnt(2)
ds_read_b128 a[244:247],v248 offset:9728
v_fmac_f32 v204,s43,v208
M a[96:99],v[220:223],a[232:235],a[96:99]
s_waitcnt vmcnt(9) lgkmcnt(2)
buffer_load_dwordx2 v[194:195],v245,s[8:11],s28 offen offset:0
M a[96:99],a[216:219],a[252:255],a[96:99]
s_waitcnt lgkmcnt(1)
ds_read_b128 a[248:251],v249 offset:9728
v_fmac_f32 v214,4.0,v206
M a[100:103],a[216:219],a[200:203],a[100:103]
v_fma_f32 v235,-4.0,v208,v212
v_fmac_f32 v204,s45,v212
M a[100:103],v[220:223],a[252:255],a[100:103]
v_fmac_f32 v214,s41,v210
v_sub_f32 v212,v212,v208
M a[100:103],v[228:231],a[232:235],a[100:103]
buffer_load_dwordx2 v[196:197],v245,s[8:11],s28 offen offset:384
M a[104:107],v[228:231],a[252:255],a[104:107]
ds_read_b128 a[196:199],v248 offset:10240
v_fma_f32 v208,-4.0,v206,v210
M a[104:107],v[220:223],a[200:203],a[104:107]
s_waitcnt lgkmcnt(2)
ds_read_b128 a[224:227],v249 offset:10240
v_sub_f32 v210,v210,v206
M a[104:107],a[216:219],a[244:247],a[104:107]
s_waitcnt lgkmcnt(2)
v_add_f32 v206,v235,v208
v_sub_f32 v235,v235,v208
M a[108:111],a[216:219],a[248:251],a[108:111]
buffer_load_dwordx2 v[198:199],v245,s[8:11],s28 offen offset:768
M a[108:111],v[220:223],a[244:247],a[108:111]
v_fma_f32 v208,2.0,v210,v212
v_fmac_f32 v212,-2.0,v210
M a[108:111],v[228:231],a[200:203],a[108:111]
v_cvt_pk_bf16_f32 v204,v232,v204
v_cvt_pk_bf16_f32 v214,v237,v214
M a[112:115],v[228:231],a[244:247],a[112:115]
ds_read_b128 a[236:239],v249 offset:10752
v_cvt_pk_bf16_f32 v206,v233,v206
M a[112:115],v[220:223],a[248:251],a[112:115]
s_waitcnt lgkmcnt(2)
buffer_load_dwordx2 v[200:201],v245,s[8:11],s28 offen offset:1152
M a[112:115],a[216:219],a[196:199],a[112:115]
s_waitcnt lgkmcnt(1)
ds_read_b128 v[224:227],v248 offset:10752
v_cvt_pk_bf16_f32 v210,v234,v208
M a[116:119],a[216:219],a[224:227],a[116:119]
v_cvt_pk_bf16_f32 v208,v238,v235
v_cvt_pk_bf16_f32 v212,v236,v212
M a[116:119],v[220:223],a[196:199],a[116:119]
v_lshlrev_b32 v234,16,v209
v_lshlrev_b32 v232,16,v205
M a[116:119],v[228:231],a[248:251],a[116:119]
v_lshlrev_b32 v233,16,v207
v_lshlrev_b32 v237,16,v215
M a[120:123],v[228:231],a[196:199],a[120:123]
v_lshlrev_b32 v236,16,v213
v_lshlrev_b32 v235,16,v211
M a[120:123],v[220:223],a[224:227],a[120:123]
s_waitcnt lgkmcnt(1)
v_fmac_f32 v232,s43,v234
v_fmac_f32 v237,4.0,v233
M a[120:123],a[216:219],a[236:239],a[120:123]
s_waitcnt lgkmcnt(0)
v_fma_f32 v238,-4.0,v234,v236
v_fmac_f32 v232,s45,v236
M a[124:127],a[216:219],v[224:227],a[124:127]
buffer_load_dwordx4 a[216:219],v250,s[20:23],s46 offen offset:1024 sc1
M a[124:127],v[220:223],a[236:239],a[124:127]
v_fmac_f32 v237,s41,v235
v_sub_f32 v236,v236,v234
M a[124:127],v[228:231],a[224:227],a[124:127]
s_waitcnt vmcnt(13)
buffer_load_dwordx4 v[220:223],v250,s[20:23],s46 offen offset:2048 sc1
M a[128:131],a[240:243],a[220:223],a[128:131]
s_waitcnt vmcnt(13)
s_add_u32 s47,s74,30720
v_fma_f32 v234,-4.0,v233,v235
v_sub_f32 v235,v235,v233
M a[128:131],a[204:207],a[232:235],a[128:131]
s_waitcnt vmcnt(12)
v_add_f32 v233,v238,v234
v_sub_f32 v238,v238,v234
M a[128:131],a[192:195],a[252:255],a[128:131]
v_fma_f32 v234,2.0,v235,v236
v_fmac_f32 v236,-2.0,v235
M a[132:135],a[192:195],a[200:203],a[132:135]
buffer_load_dwordx4 v[228:231],v250,s[20:23],s47 offen offset:0 sc1
M a[132:135],a[204:207],a[252:255],a[132:135]
v_and_b32 v209,s42,v209
v_and_b32 v205,s42,v205
M a[132:135],a[240:243],a[232:235],a[132:135]
v_and_b32 v207,s42,v207
v_and_b32 v215,s42,v215
M a[136:139],a[240:243],a[252:255],a[136:139]
v_and_b32 v213,s42,v213
v_and_b32 v211,s42,v211
M a[136:139],a[204:207],a[200:203],a[136:139]
v_fmac_f32 v205,s43,v209
v_fmac_f32 v215,4.0,v207
M a[136:139],a[192:195],a[244:247],a[136:139]
v_fma_f32 v235,-4.0,v209,v213
v_fmac_f32 v205,s45,v213
M a[140:143],a[192:195],a[248:251],a[140:143]
v_fmac_f32 v215,s41,v211
v_sub_f32 v213,v213,v209
M a[140:143],a[204:207],a[244:247],a[140:143]
v_fma_f32 v209,-4.0,v207,v211
v_sub_f32 v211,v211,v207
M a[140:143],a[240:243],a[200:203],a[140:143]
v_add_f32 v207,v235,v209
v_sub_f32 v235,v235,v209
M a[144:147],a[240:243],a[244:247],a[144:147]
v_fma_f32 v209,2.0,v211,v213
v_fmac_f32 v213,-2.0,v211
M a[144:147],a[204:207],a[248:251],a[144:147]
v_cvt_pk_bf16_f32 v205,v232,v205
v_cvt_pk_bf16_f32 v215,v237,v215
M a[144:147],a[192:195],a[196:199],a[144:147]
v_cvt_pk_bf16_f32 v207,v233,v207
v_cvt_pk_bf16_f32 v211,v234,v209
M a[148:151],a[192:195],a[224:227],a[148:151]
v_cvt_pk_bf16_f32 v209,v238,v235
v_cvt_pk_bf16_f32 v213,v236,v213
M a[148:151],a[204:207],a[196:199],a[148:151]
v_add_u32 v238,121856,v247
v_fmac_f32 v239,s43,v241
M a[148:151],a[240:243],a[248:251],a[148:151]
ds_write2st64_b64 v238,v[204:205],v[214:215] offset0:1 offset1:18
M a[152:155],a[240:243],a[196:199],a[152:155]
s_add_u32 s28,s69,7471104
buffer_load_dwordx2 v[204:205],v245,s[12:15],s28 offen offset:0
M a[152:155],a[204:207],a[224:227],a[152:155]
v_fmac_f32 v244,4.0,v240
v_fma_f32 v232,-4.0,v241,v243
M a[152:155],a[192:195],a[236:239],a[152:155]
buffer_load_dwordx2 v[214:215],v245,s[16:19],s28 offen offset:1536
M a[156:159],a[192:195],v[224:227],a[156:159]
v_fmac_f32 v239,s45,v243
v_fmac_f32 v244,s41,v242
M a[156:159],a[204:207],a[236:239],a[156:159]
v_sub_f32 v243,v243,v241
v_fma_f32 v241,-4.0,v240,v242
M a[156:159],a[240:243],a[224:227],a[156:159]
s_waitcnt vmcnt(14)
ds_write2st64_b64 v247,v[206:207],v[208:209] offset0:1 offset1:18
M a[160:163],v[216:219],a[220:223],a[160:163]
s_waitcnt vmcnt(13)
buffer_load_dwordx4 a[192:195],v250,s[20:23],s47 offen offset:1024 sc1
M a[160:163],a[208:211],a[232:235],a[160:163]
s_waitcnt vmcnt(13)
v_sub_f32 v242,v242,v240
v_add_f32 v240,v232,v241
M a[160:163],a[212:215],a[252:255],a[160:163]
ds_write2st64_b64 v247,v[210:211],v[212:213] offset0:137 offset1:154
M a[164:167],a[212:215],a[200:203],a[164:167]
buffer_load_dwordx4 a[204:207],v250,s[20:23],s47 offen offset:2048 sc1
M a[164:167],a[208:211],a[252:255],a[164:167]
s_add_u32 s48,s74,33792
v_sub_f32 v232,v232,v241
v_fma_f32 v241,2.0,v242,v243
M a[164:167],v[216:219],a[232:235],a[164:167]
v_fmac_f32 v243,-2.0,v242
v_cvt_pk_bf16_f32 v233,v239,v244
M a[168:171],v[216:219],a[252:255],a[168:171]
v_cvt_pk_bf16_f32 v234,v240,v232
v_cvt_pk_bf16_f32 v235,v241,v243
M a[168:171],a[208:211],a[200:203],a[168:171]
buffer_load_dwordx4 a[240:243],v250,s[20:23],s48 offen offset:0 sc1
M a[168:171],a[212:215],a[244:247],a[168:171]
v_add_u32 v232,121856,v252
M a[172:175],a[212:215],a[248:251],a[172:175]
ds_write_b16 v232,v233 offset:0
M a[172:175],a[208:211],a[244:247],a[172:175]
ds_write_b16_d16_hi v232,v233 offset:8704
M a[172:175],v[216:219],a[200:203],a[172:175]
buffer_load_dwordx4 a[220:223],v250,s[20:23],s48 offen offset:1024 sc1
M a[176:179],v[216:219],a[244:247],a[176:179]
ds_write_b16 v252,v234 offset:0
M a[176:179],a[208:211],a[248:251],a[176:179]
ds_write_b16_d16_hi v252,v234 offset:8704
M a[176:179],a[212:215],a[196:199],a[176:179]
v_add_u32 v232,69632,v252
M a[180:183],a[212:215],a[224:227],a[180:183]
buffer_load_dwordx4 a[232:235],v250,s[20:23],s48 offen offset:2048 sc1
M a[180:183],a[208:211],a[196:199],a[180:183]
s_add_u32 s46,s74,36864
ds_read_b128 a[200:203],v248 offset:17408
ds_write_b16 v232,v235 offset:0
M a[180:183],v[216:219],a[248:251],a[180:183]
ds_read_b128 a[244:247],v249 offset:17408
ds_write_b16_d16_hi v232,v235 offset:8704
M a[184:187],v[216:219],a[196:199],a[184:187]
buffer_load_dwordx4 a[252:255],v250,s[20:23],s46 offen offset:0 sc1
M a[184:187],a[208:211],a[224:227],a[184:187]
ds_read_b128 a[248:251],v248 offset:17920
ds_read_b128 a[196:199],v249 offset:17920
M a[184:187],a[212:215],a[236:239],a[184:187]
s_waitcnt vmcnt(13)
v_lshlrev_b32 v234,16,v196
v_lshlrev_b32 v232,16,v192
M a[188:191],a[212:215],v[224:227],a[188:191]
v_lshlrev_b32 v233,16,v194
v_lshlrev_b32 v237,16,v202
M a[188:191],a[208:211],a[236:239],a[188:191]
buffer_load_dwordx2 v[206:207],v245,s[8:11],s28 offen offset:0
M a[188:191],v[216:219],a[224:227],a[188:191]
s_waitcnt vmcnt(12) lgkmcnt(5)
v_lshlrev_b32 v236,16,v200
v_lshlrev_b32 v235,16,v198
M v[0:3],a[228:231],a[200:203],v[0:3]
s_waitcnt vmcnt(11) lgkmcnt(3)
ds_read_b128 a[212:215],v248 offset:18432
v_fmac_f32 v232,s43,v234
M v[0:3],a[216:219],a[244:247],v[0:3]
s_waitcnt vmcnt(10) lgkmcnt(2)
ds_read_b128 v[224:227],v249 offset:18432
v_fmac_f32 v237,4.0,v233
M v[0:3],v[220:223],a[248:251],v[0:3]
s_waitcnt lgkmcnt(2)
buffer_load_dwordx2 v[208:209],v245,s[8:11],s28 offen offset:384
M v[4:7],v[220:223],a[196:199],v[4:7]
v_fma_f32 v238,-4.0,v234,v236
v_fmac_f32 v232,s45,v236
M v[4:7],a[216:219],a[248:251],v[4:7]
v_fmac_f32 v237,s41,v235
v_sub_f32 v236,v236,v234
M v[4:7],a[228:231],a[244:247],v[4:7]
v_fma_f32 v234,-4.0,v233,v235
v_sub_f32 v235,v235,v233
M v[8:11],a[228:231],a[248:251],v[8:11]
buffer_load_dwordx2 v[210:211],v245,s[8:11],s28 offen offset:768
M v[8:11],a[216:219],a[196:199],v[8:11]
s_waitcnt lgkmcnt(1)
ds_read_b128 a[208:211],v248 offset:18944
ds_read_b128 a[236:239],v249 offset:18944
M v[8:11],v[220:223],a[212:215],v[8:11]
s_waitcnt lgkmcnt(2)
v_add_f32 v233,v238,v234
v_sub_f32 v238,v238,v234
M v[12:15],v[220:223],v[224:227],v[12:15]
v_fma_f32 v234,2.0,v235,v236
v_fmac_f32 v236,-2.0,v235
M v[12:15],a[216:219],a[212:215],v[12:15]
buffer_load_dwordx2 v[212:213],v245,s[8:11],s28 offen offset:1152
M v[12:15],a[228:231],a[196:199],v[12:15]
s_add_u32 s29,s70,6291456
v_and_b32 v196,s42,v196
v_and_b32 v192,s42,v192
M v[16:19],a[228:231],a[212:215],v[16:19]
ds_read_b128 a[224:227],v249 offset:19456
v_and_b32 v194,s42,v194
M v[16:19],a[216:219],v[224:227],v[16:19]
s_waitcnt lgkmcnt(2)
ds_read_b128 v[216:219],v248 offset:19456
v_and_b32 v202,s42,v202
M v[16:19],v[220:223],a[208:211],v[16:19]
s_waitcnt lgkmcnt(2)
buffer_load_short_d16_hi v239,v246,s[12:15],s29 offen offset:0
M v[20:23],v[220:223],a[236:239],v[20:23]
v_and_b32 v200,s42,v200
v_and_b32 v198,s42,v198
M v[20:23],a[216:219],a[208:211],v[20:23]
buffer_load_short_d16_hi v240,v246,s[8:11],s29 offen offset:0
M v[20:23],a[228:231],v[224:227],v[20:23]
v_fmac_f32 v192,s43,v196
v_fmac_f32 v202,4.0,v194
M v[24:27],a[228:231],a[208:211],v[24:27]
buffer_load_short_d16_hi v241,v246,s[8:11],s29 offen offset:384
M v[24:27],a[216:219],a[236:239],v[24:27]
s_waitcnt lgkmcnt(1)
v_fma_f32 v235,-4.0,v196,v200
v_fmac_f32 v192,s45,v200
M v[24:27],v[220:223],a[224:227],v[24:27]
s_waitcnt lgkmcnt(0)
buffer_load_short_d16_hi v242,v246,s[8:11],s29 offen offset:768
M v[28:31],v[220:223],v[216:219],v[28:31]
v_fmac_f32 v202,s41,v198
v_sub_f32 v200,v200,v196
M v[28:31],a[216:219],a[224:227],v[28:31]
buffer_load_short_d16_hi v243,v246,s[8:11],s29 offen offset:1152
M v[28:31],a[228:231],a[236:239],v[28:31]
s_waitcnt vmcnt(17)
v_fma_f32 v196,-4.0,v194,v198
v_sub_f32 v198,v198,v194
M v[32:35],v[228:231],a[200:203],v[32:35]
s_waitcnt vmcnt(14)
buffer_load_short_d16_hi v244,v246,s[16:19],s29 offen offset:1536
M v[32:35],a[192:195],a[244:247],v[32:35]
s_waitcnt vmcnt(14)
v_add_f32 v194,v235,v196
v_sub_f32 v235,v235,v196
M v[32:35],a[204:207],a[248:251],v[32:35]
global_load_dword v220,v250,s[64:65]
M v[36:39],a[204:207],a[196:199],v[36:39]
v_fma_f32 v196,2.0,v198,v200
v_fmac_f32 v200,-2.0,v198
M v[36:39],a[192:195],a[248:251],v[36:39]
buffer_load_dwordx4 v[220:223],v250,s[20:23],s46 offen offset:1024 sc1
M v[36:39],v[228:231],a[244:247],v[36:39]
v_cvt_pk_bf16_f32 v192,v232,v192
v_cvt_pk_bf16_f32 v202,v237,v202
M v[40:43],v[228:231],a[248:251],v[40:43]
v_cvt_pk_bf16_f32 v194,v233,v194
v_cvt_pk_bf16_f32 v198,v234,v196
M v[40:43],a[192:195],a[196:199],v[40:43]
v_cvt_pk_bf16_f32 v196,v238,v235
v_cvt_pk_bf16_f32 v200,v236,v200
M v[40:43],a[204:207],a[212:215],v[40:43]
buffer_load_dwordx4 a[216:219],v250,s[20:23],s46 offen offset:2048 sc1
M v[44:47],a[204:207],v[224:227],v[44:47]
s_add_u32 s47,s74,39936
v_lshlrev_b32 v234,16,v197
v_lshlrev_b32 v232,16,v193
M v[44:47],a[192:195],a[212:215],v[44:47]
v_lshlrev_b32 v233,16,v195
v_lshlrev_b32 v237,16,v203
M v[44:47],v[228:231],a[196:199],v[44:47]
v_lshlrev_b32 v236,16,v201
v_lshlrev_b32 v235,16,v199
M v[48:51],v[228:231],a[212:215],v[48:51]
buffer_load_dwordx4 a[228:231],v250,s[20:23],s47 offen offset:0 sc1
M v[48:51],a[192:195],v[224:227],v[48:51]
v_fmac_f32 v232,s43,v234
v_fmac_f32 v237,4.0,v233
M v[48:51],a[204:207],a[208:211],v[48:51]
v_fma_f32 v238,-4.0,v234,v236
v_fmac_f32 v232,s45,v236
M v[52:55],a[204:207],a[236:239],v[52:55]
v_fmac_f32 v237,s41,v235
v_sub_f32 v236,v236,v234
M v[52:55],a[192:195],a[208:211],v[52:55]
v_fma_f32 v234,-4.0,v233,v235
v_sub_f32 v235,v235,v233
M v[52:55],v[228:231],v[224:227],v[52:55]
v_add_f32 v233,v238,v234
v_sub_f32 v238,v238,v234
M v[56:59],v[228:231],a[208:211],v[56:59]
v_fma_f32 v234,2.0,v235,v236
v_fmac_f32 v236,-2.0,v235
M v[56:59],a[192:195],a[236:239],v[56:59]
v_and_b32 v197,s42,v197
v_and_b32 v193,s42,v193
M v[56:59],a[204:207],a[224:227],v[56:59]
v_and_b32 v195,s42,v195
v_and_b32 v203,s42,v203
M v[60:63],a[204:207],v[216:219],v[60:63]
buffer_load_dwordx4 a[204:207],v250,s[20:23],s47 offen offset:1024 sc1
M v[60:63],a[192:195],a[224:227],v[60:63]
v_and_b32 v201,s42,v201
v_and_b32 v199,s42,v199
M v[60:63],v[228:231],a[236:239],v[60:63]
s_waitcnt vmcnt(18)
buffer_load_dwordx4 a[192:195],v250,s[20:23],s47 offen offset:2048 sc1
M v[64:67],a[240:243],a[200:203],v[64:67]
s_waitcnt vmcnt(18)
s_add_u32 s48,s74,43008
v_fmac_f32 v193,s43,v197
v_fmac_f32 v203,4.0,v195
M v[64:67],a[220:223],a[244:247],v[64:67]
s_waitcnt vmcnt(17)
v_fma_f32 v235,-4.0,v197,v201
v_fmac_f32 v193,s45,v201
M v[64:67],a[232:235],a[248:251],v[64:67]
v_fmac_f32 v203,s41,v199
v_sub_f32 v201,v201,v197
M v[68:71],a[232:235],a[196:199],v[68:71]
buffer_load_dwordx4 v[228:231],v250,s[20:23],s48 offen offset:0 sc1
M v[68:71],a[220:223],a[248:251],v[68:71]
v_fma_f32 v197,-4.0,v195,v199
v_sub_f32 v199,v199,v195
M v[68:71],a[240:243],a[244:247],v[68:71]
v_add_f32 v195,v235,v197
v_sub_f32 v235,v235,v197
M v[72:75],a[240:243],a[248:251],v[72:75]
v_fma_f32 v197,2.0,v199,v201
v_fmac_f32 v201,-2.0,v199
M v[72:75],a[220:223],a[196:199],v[72:75]
buffer_load_dwordx4 a[200:203],v250,s[20:23],s48 offen offset:1024 sc1
M v[72:75],a[232:235],a[212:215],v[72:75]
v_cvt_pk_bf16_f32 v193,v232,v193
v_cvt_pk_bf16_f32 v203,v237,v203
M v[76:79],a[232:235],v[224:227],v[76:79]
v_cvt_pk_bf16_f32 v195,v233,v195
v_cvt_pk_bf16_f32 v199,v234,v197
M v[76:79],a[220:223],a[212:215],v[76:79]
v_cvt_pk_bf16_f32 v197,v238,v235
v_cvt_pk_bf16_f32 v201,v236,v201
M v[76:79],a[240:243],a[196:199],v[76:79]
buffer_load_dwordx4 a[244:247],v250,s[20:23],s48 offen offset:2048 sc1
M v[80:83],a[240:243],a[212:215],v[80:83]
s_waitcnt vmcnt(17)
s_add_u32 s46,s75,9216
v_add_u32 v238,121856,v247
v_lshlrev_b32 v234,16,v208
M v[80:83],a[220:223],v[224:227],v[80:83]
v_lshlrev_b32 v232,16,v204
v_lshlrev_b32 v233,16,v206
M v[80:83],a[232:235],a[208:211],v[80:83]
ds_write2st64_b64 v238,v[192:193],v[202:203] offset0:2 offset1:19
M v[84:87],a[232:235],a[236:239],v[84:87]
s_add_u32 s28,s70,6291456
buffer_load_dwordx4 a[248:251],v250,s[20:23],s46 offen offset:0 sc1
M v[84:87],a[220:223],a[208:211],v[84:87]
ds_read_b128 a[196:199],v248 offset:26112
v_lshlrev_b32 v237,16,v214
M v[84:87],a[240:243],v[224:227],v[84:87]
ds_write2st64_b64 v247,v[194:195],v[196:197] offset0:2 offset1:19
M v[88:91],a[240:243],a[208:211],v[88:91]
buffer_load_dwordx2 v[192:193],v245,s[12:15],s28 offen offset:0
M v[88:91],a[220:223],a[236:239],v[88:91]
ds_read_b128 a[212:215],v249 offset:26112
ds_read_b128 v[224:227],v248 offset:26624
M v[88:91],a[232:235],a[224:227],v[88:91]
ds_write2st64_b64 v247,v[198:199],v[200:201] offset0:138 offset1:155
M v[92:95],a[232:235],v[216:219],v[92:95]
buffer_load_dwordx2 v[202:203],v245,s[16:19],s28 offen offset:1536
M v[92:95],a[220:223],a[224:227],v[92:95]
s_waitcnt vmcnt(18)
ds_read_b128 a[208:211],v249 offset:26624
v_lshlrev_b32 v236,16,v212
M v[92:95],a[240:243],a[236:239],v[92:95]
s_waitcnt lgkmcnt(5)
v_lshlrev_b32 v235,16,v210
v_fmac_f32 v232,s43,v234
M v[96:99],a[252:255],a[196:199],v[96:99]
s_waitcnt vmcnt(10) lgkmcnt(3)
ds_read_b128 a[232:235],v248 offset:27136
v_fmac_f32 v237,4.0,v233
M v[96:99],v[220:223],a[212:215],v[96:99]
s_waitcnt vmcnt(9) lgkmcnt(3)
buffer_load_dwordx2 v[194:195],v245,s[8:11],s28 offen offset:0
M v[96:99],a[216:219],v[224:227],v[96:99]
s_waitcnt lgkmcnt(1)
ds_read_b128 v[216:219],v249 offset:27136
v_fma_f32 v238,-4.0,v234,v236
M v[100:103],a[216:219],a[208:211],v[100:103]
v_fmac_f32 v232,s45,v236
v_fmac_f32 v237,s41,v235
M v[100:103],v[220:223],v[224:227],v[100:103]
v_sub_f32 v236,v236,v234
v_fma_f32 v234,-4.0,v233,v235
M v[100:103],a[252:255],a[212:215],v[100:103]
buffer_load_dwordx2 v[196:197],v245,s[8:11],s28 offen offset:384
M v[104:107],a[252:255],v[224:227],v[104:107]
ds_read_b128 a[220:223],v248 offset:27648
v_sub_f32 v235,v235,v233
M v[104:107],v[220:223],a[208:211],v[104:107]
s_waitcnt lgkmcnt(2)
ds_read_b128 a[224:227],v249 offset:27648
v_add_f32 v233,v238,v234
M v[104:107],a[216:219],a[232:235],v[104:107]
s_waitcnt lgkmcnt(2)
v_sub_f32 v238,v238,v234
v_fma_f32 v234,2.0,v235,v236
M v[108:111],a[216:219],v[216:219],v[108:111]
buffer_load_dwordx2 v[198:199],v245,s[8:11],s28 offen offset:768
M v[108:111],v[220:223],a[232:235],v[108:111]
v_fmac_f32 v236,-2.0,v235
v_and_b32 v208,s42,v208
M v[108:111],a[252:255],a[208:211],v[108:111]
v_and_b32 v204,s42,v204
v_and_b32 v206,s42,v206
M v[112:115],a[252:255],a[232:235],v[112:115]
ds_read_b128 a[236:239],v249 offset:28160
v_and_b32 v214,s42,v214
M v[112:115],v[220:223],v[216:219],v[112:115]
s_waitcnt lgkmcnt(2)
buffer_load_dwordx2 v[200:201],v245,s[8:11],s28 offen offset:1152
M v[112:115],a[216:219],a[220:223],v[112:115]
s_waitcnt lgkmcnt(1)
ds_read_b128 a[240:243],v248 offset:28160
v_and_b32 v212,s42,v212
M v[116:119],a[216:219],a[224:227],v[116:119]
v_and_b32 v210,s42,v210
v_fmac_f32 v204,s43,v208
M v[116:119],v[220:223],a[220:223],v[116:119]
v_fmac_f32 v214,4.0,v206
v_fma_f32 v235,-4.0,v208,v212
M v[116:119],a[252:255],v[216:219],v[116:119]
v_fmac_f32 v204,s45,v212
v_fmac_f32 v214,s41,v210
M v[120:123],a[252:255],a[220:223],v[120:123]
v_sub_f32 v212,v212,v208
v_fma_f32 v208,-4.0,v206,v210
M v[120:123],v[220:223],a[224:227],v[120:123]
s_waitcnt lgkmcnt(1)
v_sub_f32 v210,v210,v206
v_add_f32 v206,v235,v208
M v[120:123],a[216:219],a[236:239],v[120:123]
s_waitcnt lgkmcnt(0)
v_sub_f32 v235,v235,v208
v_fma_f32 v208,2.0,v210,v212
M v[124:127],a[216:219],a[240:243],v[124:127]
buffer_load_dwordx4 a[216:219],v250,s[20:23],s46 offen offset:1024 sc1
M v[124:127],v[220:223],a[236:239],v[124:127]
v_fmac_f32 v212,-2.0,v210
v_cvt_pk_bf16_f32 v204,v232,v204
M v[124:127],a[252:255],a[224:227],v[124:127]
s_waitcnt vmcnt(13)
buffer_load_dwordx4 v[220:223],v250,s[20:23],s46 offen offset:2048 sc1
M v[128:131],a[228:231],a[196:199],v[128:131]
s_waitcnt vmcnt(13)
s_add_u32 s47,s75,12288
v_cvt_pk_bf16_f32 v214,v237,v214
v_cvt_pk_bf16_f32 v206,v233,v206
M v[128:131],a[204:207],a[212:215],v[128:131]
s_waitcnt vmcnt(12)
v_cvt_pk_bf16_f32 v210,v234,v208
v_cvt_pk_bf16_f32 v208,v238,v235
M v[128:131],a[192:195],v[224:227],v[128:131]
v_cvt_pk_bf16_f32 v212,v236,v212
v_lshlrev_b32 v234,16,v209
M v[132:135],a[192:195],a[208:211],v[132:135]
buffer_load_dwordx4 a[252:255],v250,s[20:23],s47 offen offset:0 sc1
M v[132:135],a[204:207],v[224:227],v[132:135]
v_lshlrev_b32 v232,16,v205
v_lshlrev_b32 v233,16,v207
M v[132:135],a[228:231],a[212:215],v[132:135]
v_lshlrev_b32 v237,16,v215
v_lshlrev_b32 v236,16,v213
M v[136:139],a[228:231],v[224:227],v[136:139]
v_lshlrev_b32 v235,16,v211
v_fmac_f32 v232,s43,v234
M v[136:139],a[204:207],a[208:211],v[136:139]
v_fmac_f32 v237,4.0,v233
v_fma_f32 v238,-4.0,v234,v236
M v[136:139],a[192:195],a[232:235],v[136:139]
v_fmac_f32 v232,s45,v236
v_fmac_f32 v237,s41,v235
M v[140:143],a[192:195],v[216:219],v[140:143]
v_sub_f32 v236,v236,v234
v_fma_f32 v234,-4.0,v233,v235
M v[140:143],a[204:207],a[232:235],v[140:143]
v_sub_f32 v235,v235,v233
v_add_f32 v233,v238,v234
M v[140:143],a[228:231],a[208:211],v[140:143]
v_sub_f32 v238,v238,v234
v_fma_f32 v234,2.0,v235,v236
M v[144:147],a[228:231],a[232:235],v[144:147]
v_fmac_f32 v236,-2.0,v235
v_and_b32 v209,s42,v209
M v[144:147],a[204:207],v[216:219],v[144:147]
v_and_b32 v205,s42,v205
v_and_b32 v207,s42,v207
M v[144:147],a[192:195],a[220:223],v[144:147]
v_and_b32 v215,s42,v215
v_and_b32 v213,s42,v213
M v[148:151],a[192:195],a[224:227],v[148:151]
v_and_b32 v211,s42,v211
v_fmac_f32 v205,s43,v209
M v[148:151],a[204:207],a[220:223],v[148:151]
v_fmac_f32 v215,4.0,v207
v_fma_f32 v235,-4.0,v209,v213
M v[148:151],a[228:231],v[216:219],v[148:151]
v_fmac_f32 v205,s45,v213
v_fmac_f32 v215,s41,v211
M v[152:155],a[228:231],a[220:223],v[152:155]
v_sub_f32 v213,v213,v209
v_fma_f32 v209,-4.0,v207,v211
M v[152:155],a[204:207],a[224:227],v[152:155]
v_sub_f32 v211,v211,v207
v_add_f32 v207,v235,v209
M v[152:155],a[192:195],a[236:239],v[152:155]
v_sub_f32 v235,v235,v209
v_fma_f32 v209,2.0,v211,v213
M v[156:159],a[192:195],a[240:243],v[156:159]
buffer_load_dwordx4 a[192:195],v250,s[20:23],s47 offen offset:1024 sc1
M v[156:159],a[204:207],a[236:239],v[156:159]
v_fmac_f32 v213,-2.0,v211
v_cvt_pk_bf16_f32 v205,v232,v205
M v[156:159],a[228:231],a[224:227],v[156:159]
s_waitcnt vmcnt(13)
buffer_load_dwordx4 a[204:207],v250,s[20:23],s47 offen offset:2048 sc1
M v[160:163],v[228:231],a[196:199],v[160:163]
s_waitcnt vmcnt(13)
s_add_u32 s48,s75,15360
v_cvt_pk_bf16_f32 v215,v237,v215
v_cvt_pk_bf16_f32 v207,v233,v207
M v[160:163],a[200:203],a[212:215],v[160:163]
s_waitcnt vmcnt(12)
v_cvt_pk_bf16_f32 v211,v234,v209
v_cvt_pk_bf16_f32 v209,v238,v235
M v[160:163],a[244:247],v[224:227],v[160:163]
v_cvt_pk_bf16_f32 v213,v236,v213
v_add_u32 v238,121856,v247
M v[164:167],a[244:247],a[208:211],v[164:167]
buffer_load_dwordx4 a[228:231],v250,s[20:23],s48 offen offset:0 sc1
M v[164:167],a[200:203],v[224:227],v[164:167]
M v[164:167],v[228:231],a[212:215],v[164:167]
ds_write2st64_b64 v238,v[204:205],v[214:215] offset0:3 offset1:20
M v[168:171],v[228:231],v[224:227],v[168:171]
s_add_u32 s28,s70,6684672
M v[168:171],a[200:203],a[208:211],v[168:171]
buffer_load_dwordx4 a[196:199],v250,s[20:23],s48 offen offset:1024 sc1
M v[168:171],a[244:247],a[232:235],v[168:171]
ds_write2st64_b64 v247,v[206:207],v[208:209] offset0:3 offset1:20
M v[172:175],a[244:247],v[216:219],v[172:175]
M v[172:175],a[200:203],a[232:235],v[172:175]
buffer_load_dwordx4 a[212:215],v250,s[20:23],s48 offen offset:2048 sc1
M v[172:175],v[228:231],a[208:211],v[172:175]
s_add_u32 s46,s75,18432
ds_write2st64_b64 v247,v[210:211],v[212:213] offset0:139 offset1:156
M v[176:179],v[228:231],a[232:235],v[176:179]
M v[176:179],a[200:203],v[216:219],v[176:179]
buffer_load_dwordx4 v[224:227],v250,s[20:23],s46 offen offset:0 sc1
M v[176:179],a[244:247],a[220:223],v[176:179]
s_waitcnt lgkmcnt(0)
s_barrier
v_add_u32 v248,0xffffbc00,v248
M v[180:183],a[244:247],a[224:227],v[180:183]
v_add_u32 v249,0xffffbc00,v249
M v[180:183],a[200:203],a[220:223],v[180:183]
ds_read_b128 a[208:211],v248 offset:0
M v[180:183],v[228:231],v[216:219],v[180:183]
buffer_load_dwordx2 v[204:205],v245,s[12:15],s28 offen offset:0
M v[184:187],v[228:231],a[220:223],v[184:187]
ds_read_b128 a[232:235],v249 offset:0
ds_read_b128 v[216:219],v248 offset:512
M v[184:187],a[200:203],a[224:227],v[184:187]
ds_read_b128 a[220:223],v249 offset:512
M v[184:187],a[244:247],a[236:239],v[184:187]
M v[188:191],a[244:247],a[240:243],v[188:191]
buffer_load_dwordx2 v[214:215],v245,s[16:19],s28 offen offset:1536
M v[188:191],a[200:203],a[236:239],v[188:191]
M v[188:191],v[228:231],a[224:227],v[188:191]
s_waitcnt vmcnt(17) lgkmcnt(3)
M a[0:3],a[248:251],a[208:211],a[0:3]
s_waitcnt vmcnt(10) lgkmcnt(2)
ds_read_b128 a[240:243],v248 offset:1024
M a[0:3],a[216:219],a[232:235],a[0:3]
s_waitcnt vmcnt(9) lgkmcnt(2)
buffer_load_dwordx2 v[206:207],v245,s[8:11],s28 offen offset:0
M a[0:3],v[220:223],v[216:219],a[0:3]
s_waitcnt lgkmcnt(1)
ds_read_b128 a[244:247],v249 offset:1024
v_lshlrev_b32 v234,16,v196
M a[4:7],v[220:223],a[220:223],a[4:7]
v_lshlrev_b32 v232,16,v192
v_lshlrev_b32 v233,16,v194
M a[4:7],a[216:219],v[216:219],a[4:7]
v_lshlrev_b32 v237,16,v202
v_lshlrev_b32 v236,16,v200
M a[4:7],a[248:251],a[232:235],a[4:7]
buffer_load_dwordx2 v[208:209],v245,s[8:11],s28 offen offset:384
M a[8:11],a[248:251],v[216:219],a[8:11]
ds_read_b128 a[200:203],v248 offset:1536
v_lshlrev_b32 v235,16,v198
M a[8:11],a[216:219],a[220:223],a[8:11]
s_waitcnt lgkmcnt(2)
ds_read_b128 a[236:239],v249 offset:1536
v_fmac_f32 v232,s43,v234
M a[8:11],v[220:223],a[240:243],a[8:11]
s_waitcnt lgkmcnt(2)
v_fmac_f32 v237,4.0,v233
v_fma_f32 v238,-4.0,v234,v236
M a[12:15],v[220:223],a[244:247],a[12:15]
buffer_load_dwordx2 v[210:211],v245,s[8:11],s28 offen offset:768
M a[12:15],a[216:219],a[240:243],a[12:15]
v_fmac_f32 v232,s45,v236
v_fmac_f32 v237,s41,v235
M a[12:15],a[248:251],a[220:223],a[12:15]
v_sub_f32 v236,v236,v234
v_fma_f32 v234,-4.0,v233,v235
M a[16:19],a[248:251],a[240:243],a[16:19]
ds_read_b128 a[224:227],v249 offset:2048
v_sub_f32 v235,v235,v233
M a[16:19],a[216:219],a[244:247],a[16:19]
s_waitcnt lgkmcnt(2)
buffer_load_dwordx2 v[212:213],v245,s[8:11],s28 offen offset:1152
M a[16:19],v[220:223],a[200:203],a[16:19]
s_waitcnt lgkmcnt(1)
ds_read_b128 v[228:231],v248 offset:2048
v_add_f32 v233,v238,v234
M a[20:23],v[220:223],a[236:239],a[20:23]
v_sub_f32 v238,v238,v234
v_fma_f32 v234,2.0,v235,v236
M a[20:23],a[216:219],a[200:203],a[20:23]
v_fmac_f32 v236,-2.0,v235
v_and_b32 v196,s42,v196
M a[20:23],a[248:251],a[244:247],a[20:23]
v_and_b32 v192,s42,v192
v_and_b32 v194,s42,v194
M a[24:27],a[248:251],a[200:203],a[24:27]
v_and_b32 v202,s42,v202
v_and_b32 v200,s42,v200
M a[24:27],a[216:219],a[236:239],a[24:27]
s_waitcnt lgkmcnt(1)
v_and_b32 v198,s42,v198
v_fmac_f32 v192,s43,v196
M a[24:27],v[220:223],a[224:227],a[24:27]
s_waitcnt lgkmcnt(0)
v_fmac_f32 v202,4.0,v194
v_fma_f32 v235,-4.0,v196,v200
M a[28:31],v[220:223],v[228:231],a[28:31]
buffer_load_dwordx4 v[220:223],v250,s[20:23],s46 offen offset:1024 sc1
M a[28:31],a[216:219],a[224:227],a[28:31]
v_fmac_f32 v192,s45,v200
v_fmac_f32 v202,s41,v198
M a[28:31],a[248:251],a[236:239],a[28:31]
s_waitcnt vmcnt(13)
buffer_load_dwordx4 a[216:219],v250,s[20:23],s46 offen offset:2048 sc1
M a[32:35],a[252:255],a[208:211],a[32:35]
s_waitcnt vmcnt(13)
s_add_u32 s47,s75,21504
v_sub_f32 v200,v200,v196
v_fma_f32 v196,-4.0,v194,v198
M a[32:35],a[192:195],a[232:235],a[32:35]
s_waitcnt vmcnt(12)
v_sub_f32 v198,v198,v194
v_add_f32 v194,v235,v196
M a[32:35],a[204:207],v[216:219],a[32:35]
v_sub_f32 v235,v235,v196
v_fma_f32 v196,2.0,v198,v200
M a[36:39],a[204:207],a[220:223],a[36:39]
buffer_load_dwordx4 a[248:251],v250,s[20:23],s47 offen offset:0 sc1
M a[36:39],a[192:195],v[216:219],a[36:39]
v_fmac_f32 v200,-2.0,v198
v_cvt_pk_bf16_f32 v192,v232,v192
M a[36:39],a[252:255],a[232:235],a[36:39]
v_cvt_pk_bf16_f32 v202,v237,v202
v_cvt_pk_bf16_f32 v194,v233,v194
M a[40:43],a[252:255],v[216:219],a[40:43]
v_cvt_pk_bf16_f32 v198,v234,v196
v_cvt_pk_bf16_f32 v196,v238,v235
M a[40:43],a[192:195],a[220:223],a[40:43]
v_cvt_pk_bf16_f32 v200,v236,v200
v_lshlrev_b32 v234,16,v197
M a[40:43],a[204:207],a[240:243],a[40:43]
v_lshlrev_b32 v232,16,v193
v_lshlrev_b32 v233,16,v195
M a[44:47],a[204:207],a[244:247],a[44:47]
v_lshlrev_b32 v237,16,v203
v_lshlrev_b32 v236,16,v201
M a[44:47],a[192:195],a[240:243],a[44:47]
v_lshlrev_b32 v235,16,v199
v_fmac_f32 v232,s43,v234
M a[44:47],a[252:255],a[220:223],a[44:47]
v_fmac_f32 v237,4.0,v233
v_fma_f32 v238,-4.0,v234,v236
M a[48:51],a[252:255],a[240:243],a[48:51]
v_fmac_f32 v232,s45,v236
v_fmac_f32 v237,s41,v235
M a[48:51],a[192:195],a[244:247],a[48:51]
v_sub_f32 v236,v236,v234
v_fma_f32 v234,-4.0,v233,v235
M a[48:51],a[204:207],a[200:203],a[48:51]
v_sub_f32 v235,v235,v233
v_add_f32 v233,v238,v234
M a[52:55],a[204:207],a[236:239],a[52:55]
v_sub_f32 v238,v238,v234
v_fma_f32 v234,2.0,v235,v236
M a[52:55],a[192:195],a[200:203],a[52:55]
v_fmac_f32 v236,-2.0,v235
v_and_b32 v197,s42,v197
M a[52:55],a[252:255],a[244:247],a[52:55]
v_and_b32 v193,s42,v193
v_and_b32 v195,s42,v195
M a[56:59],a[252:255],a[200:203],a[56:59]
v_and_b32 v203,s42,v203
v_and_b32 v201,s42,v201
M a[56:59],a[192:195],a[236:239],a[56:59]
v_and_b32 v199,s42,v199
v_fmac_f32 v193,s43,v197
M a[56:59],a[204:207],a[224:227],a[56:59]
v_fmac_f32 v203,4.0,v195
v_fma_f32 v235,-4.0,v197,v201
M a[60:63],a[204:207],v[228:231],a[60:63]
buffer_load_dwordx4 a[204:207],v250,s[20:23],s47 offen offset:1024 sc1
M a[60:63],a[192:195],a[224:227],a[60:63]
v_fmac_f32 v193,s45,v201
v_fmac_f32 v203,s41,v199
M a[60:63],a[252:255],a[236:239],a[60:63]
s_waitcnt vmcnt(13)
buffer_load_dwordx4 a[192:195],v250,s[20:23],s47 offen offset:2048 sc1
M a[64:67],a[228:231],a[208:211],a[64:67]
s_waitcnt vmcnt(13)
s_add_u32 s48,s75,24576
v_sub_f32 v201,v201,v197
v_fma_f32 v197,-4.0,v195,v199
M a[64:67],a[196:199],a[232:235],a[64:67]
s_waitcnt vmcnt(12)
v_sub_f32 v199,v199,v195
v_add_f32 v195,v235,v197
M a[64:67],a[212:215],v[216:219],a[64:67]
v_sub_f32 v235,v235,v197
v_fma_f32 v197,2.0,v199,v201
M a[68:71],a[212:215],a[220:223],a[68:71]
buffer_load_dwordx4 a[252:255],v250,s[20:23],s48 offen offset:0 sc1
M a[68:71],a[196:199],v[216:219],a[68:71]
v_fmac_f32 v201,-2.0,v199
v_cvt_pk_bf16_f32 v193,v232,v193
M a[68:71],a[228:231],a[232:235],a[68:71]
v_cvt_pk_bf16_f32 v203,v237,v203
v_cvt_pk_bf16_f32 v195,v233,v195
M a[72:75],a[228:231],v[216:219],a[72:75]
v_cvt_pk_bf16_f32 v199,v234,v197
v_cvt_pk_bf16_f32 v197,v238,v235
M a[72:75],a[196:199],a[220:223],a[72:75]
buffer_load_dwordx4 a[208:211],v250,s[20:23],s48 offen offset:1024 sc1
M a[72:75],a[212:215],a[240:243],a[72:75]
v_cvt_pk_bf16_f32 v201,v236,v201
v_add_u32 v238,139264,v247
M a[76:79],a[212:215],a[244:247],a[76:79]
M a[76:79],a[196:199],a[240:243],a[76:79]
M a[76:79],a[228:231],a[220:223],a[76:79]
buffer_load_dwordx4 a[232:235],v250,s[20:23],s48 offen offset:2048 sc1
M a[80:83],a[228:231],a[240:243],a[80:83]
s_add_u32 s46,s75,27648
M a[80:83],a[196:199],a[244:247],a[80:83]
M a[80:83],a[212:215],a[200:203],a[80:83]
ds_write2st64_b64 v238,v[192:193],v[202:203] offset0:0 offset1:17
M a[84:87],a[212:215],a[236:239],a[84:87]
s_add_u32 s28,s70,7077888
buffer_load_dwordx4 v[216:219],v250,s[20:23],s46 offen offset:0 sc1
M a[84:87],a[196:199],a[200:203],a[84:87]
ds_read_b128 a[220:223],v248 offset:8704
M a[84:87],a[228:231],a[244:247],a[84:87]
ds_write2st64_b64 v247,v[194:195],v[196:197] offset0:34 offset1:51
M a[88:91],a[228:231],a[200:203],a[88:91]
buffer_load_dwordx2 v[192:193],v245,s[12:15],s28 offen offset:0
M a[88:91],a[196:199],a[236:239],a[88:91]
ds_read_b128 a[240:243],v249 offset:8704
ds_read_b128 a[244:247],v248 offset:9216
M a[88:91],a[212:215],a[224:227],a[88:91]
ds_write2st64_b64 v247,v[198:199],v[200:201] offset0:68 offset1:85
M a[92:95],a[212:215],v[228:231],a[92:95]
buffer_load_dwordx2 v[202:203],v245,s[16:19],s28 offen offset:1536
M a[92:95],a[196:199],a[224:227],a[92:95]
ds_read_b128 a[200:203],v249 offset:9216
M a[92:95],a[228:231],a[236:239],a[92:95]
s_waitcnt vmcnt(17) lgkmcnt(5)
M a[96:99],v[224:227],a[220:223],a[96:99]
s_waitcnt vmcnt(10) lgkmcnt(3)
ds_read_b128 a[212:215],v248 offset:9728
M a[96:99],v[220:223],a[240:243],a[96:99]
s_waitcnt vmcnt(9) lgkmcnt(3)
buffer_load_dwordx2 v[194:195],v245,s[8:11],s28 offen offset:0
M a[96:99],a[216:219],a[244:247],a[96:99]
s_waitcnt lgkmcnt(1)
ds_read_b128 v[228:231],v249 offset:9728
v_lshlrev_b32 v234,16,v208
M a[100:103],a[216:219],a[200:203],a[100:103]
v_lshlrev_b32 v232,16,v204
v_lshlrev_b32 v233,16,v206
M a[100:103],v[220:223],a[244:247],a[100:103]
v_lshlrev_b32 v237,16,v214
v_lshlrev_b32 v236,16,v212
M a[100:103],v[224:227],a[240:243],a[100:103]
buffer_load_dwordx2 v[196:197],v245,s[8:11],s28 offen offset:384
M a[104:107],v[224:227],a[244:247],a[104:107]
ds_read_b128 a[196:199],v248 offset:10240
v_lshlrev_b32 v235,16,v210
M a[104:107],v[220:223],a[200:203],a[104:107]
s_waitcnt lgkmcnt(2)
ds_read_b128 a[224:227],v249 offset:10240
v_fmac_f32 v232,s43,v234
M a[104:107],a[216:219],a[212:215],a[104:107]
s_waitcnt lgkmcnt(2)
v_fmac_f32 v237,4.0,v233
v_fma_f32 v238,-4.0,v234,v236
M a[108:111],a[216:219],v[228:231],a[108:111]
buffer_load_dwordx2 v[198:199],v245,s[8:11],s28 offen offset:768
M a[108:111],v[220:223],a[212:215],a[108:111]
v_fmac_f32 v232,s45,v236
v_fmac_f32 v237,s41,v235
M a[108:111],v[224:227],a[200:203],a[108:111]
v_sub_f32 v236,v236,v234
v_fma_f32 v234,-4.0,v233,v235
M a[112:115],v[224:227],a[212:215],a[112:115]
ds_read_b128 a[228:231],v249 offset:10752
v_sub_f32 v235,v235,v233
M a[112:115],v[220:223],v[228:231],a[112:115]
s_waitcnt lgkmcnt(2)
buffer_load_dwordx2 v[200:201],v245,s[8:11],s28 offen offset:1152
M a[112:115],a[216:219],a[196:199],a[112:115]
s_waitcnt lgkmcnt(1)
ds_read_b128 a[236:239],v248 offset:10752
v_add_f32 v233,v238,v234
M a[116:119],a[216:219],a[224:227],a[116:119]
v_sub_f32 v238,v238,v234
v_fma_f32 v234,2.0,v235,v236
M a[116:119],v[220:223],a[196:199],a[116:119]
v_fmac_f32 v236,-2.0,v235
v_and_b32 v208,s42,v208
M a[116:119],v[224:227],v[228:231],a[116:119]
v_and_b32 v204,s42,v204
v_and_b32 v206,s42,v206
M a[120:123],v[224:227],a[196:199],a[120:123]
v_and_b32 v214,s42,v214
v_and_b32 v212,s42,v212
M a[120:123],v[220:223],a[224:227],a[120:123]
s_waitcnt lgkmcnt(1)
v_and_b32 v210,s42,v210
v_fmac_f32 v204,s43,v208
M a[120:123],a[216:219],a[228:231],a[120:123]
s_waitcnt lgkmcnt(0)
v_fmac_f32 v214,4.0,v206
v_fma_f32 v235,-4.0,v208,v212
M a[124:127],a[216:219],a[236:239],a[124:127]
buffer_load_dwordx4 a[216:219],v250,s[20:23],s46 offen offset:1024 sc1
M a[124:127],v[220:223],a[228:231],a[124:127]
v_fmac_f32 v204,s45,v212
v_fmac_f32 v214,s41,v210
M a[124:127],v[224:227],a[224:227],a[124:127]
s_waitcnt vmcnt(13)
buffer_load_dwordx4 v[220:223],v250,s[20:23],s46 offen offset:2048 sc1
M a[128:131],a[248:251],a[220:223],a[128:131]
s_waitcnt vmcnt(13)
s_add_u32 s47,s75,30720
v_sub_f32 v212,v212,v208
v_fma_f32 v208,-4.0,v206,v210
M a[128:131],a[204:207],a[240:243],a[128:131]
s_waitcnt vmcnt(12)
v_sub_f32 v210,v210,v206
v_add_f32 v206,v235,v208
M a[128:131],a[192:195],a[244:247],a[128:131]
v_sub_f32 v235,v235,v208
v_fma_f32 v208,2.0,v210,v212
M a[132:135],a[192:195],a[200:203],a[132:135]
buffer_load_dwordx4 v[224:227],v250,s[20:23],s47 offen offset:0 sc1
M a[132:135],a[204:207],a[244:247],a[132:135]
v_fmac_f32 v212,-2.0,v210
v_cvt_pk_bf16_f32 v204,v232,v204
M a[132:135],a[248:251],a[240:243],a[132:135]
v_cvt_pk_bf16_f32 v214,v237,v214
v_cvt_pk_bf16_f32 v206,v233,v206
M a[136:139],a[248:251],a[244:247],a[136:139]
v_cvt_pk_bf16_f32 v210,v234,v208
v_cvt_pk_bf16_f32 v208,v238,v235
M a[136:139],a[204:207],a[200:203],a[136:139]
v_cvt_pk_bf16_f32 v212,v236,v212
v_lshlrev_b32 v234,16,v209
M a[136:139],a[192:195],a[212:215],a[136:139]
v_lshlrev_b32 v232,16,v205
v_lshlrev_b32 v233,16,v207
M a[140:143],a[192:195],v[228:231],a[140:143]
v_lshlrev_b32 v237,16,v215
v_lshlrev_b32 v236,16,v213
M a[140:143],a[204:207],a[212:215],a[140:143]
v_lshlrev_b32 v235,16,v211
v_fmac_f32 v232,s43,v234
M a[140:143],a[248:251],a[200:203],a[140:143]
v_fmac_f32 v237,4.0,v233
v_fma_f32 v238,-4.0,v234,v236
M a[144:147],a[248:251],a[212:215],a[144:147]
v_fmac_f32 v232,s45,v236
v_fmac_f32 v237,s41,v235
M a[144:147],a[204:207],v[228:231],a[144:147]
v_sub_f32 v236,v236,v234
v_fma_f32 v234,-4.0,v233,v235
M a[144:147],a[192:195],a[196:199],a[144:147]
v_sub_f32 v235,v235,v233
v_add_f32 v233,v238,v234
M a[148:151],a[192:195],a[224:227],a[148:151]
v_sub_f32 v238,v238,v234
v_fma_f32 v234,2.0,v235,v236
M a[148:151],a[204:207],a[196:199],a[148:151]
v_fmac_f32 v236,-2.0,v235
v_and_b32 v209,s42,v209
M a[148:151],a[248:251],v[228:231],a[148:151]
v_and_b32 v205,s42,v205
v_and_b32 v207,s42,v207
M a[152:155],a[248:251],a[196:199],a[152:155]
v_and_b32 v215,s42,v215
v_and_b32 v213,s42,v213
M a[152:155],a[204:207],a[224:227],a[152:155]
v_and_b32 v211,s42,v211
v_fmac_f32 v205,s43,v209
M a[152:155],a[192:195],a[228:231],a[152:155]
v_fmac_f32 v215,4.0,v207
v_fma_f32 v235,-4.0,v209,v213
M a[156:159],a[192:195],a[236:239],a[156:159]
buffer_load_dwordx4 a[192:195],v250,s[20:23],s47 offen offset:1024 sc1
M a[156:159],a[204:207],a[228:231],a[156:159]
v_fmac_f32 v205,s45,v213
v_fmac_f32 v215,s41,v211
M a[156:159],a[248:251],a[224:227],a[156:159]
s_waitcnt vmcnt(13)
buffer_load_dwordx4 a[204:207],v250,s[20:23],s47 offen offset:2048 sc1
M a[160:163],a[252:255],a[220:223],a[160:163]
s_waitcnt vmcnt(13)
s_add_u32 s48,s75,33792
v_sub_f32 v213,v213,v209
v_fma_f32 v209,-4.0,v207,v211
M a[160:163],a[208:211],a[240:243],a[160:163]
s_waitcnt vmcnt(12)
v_sub_f32 v211,v211,v207
v_add_f32 v207,v235,v209
M a[160:163],a[232:235],a[244:247],a[160:163]
v_sub_f32 v235,v235,v209
v_fma_f32 v209,2.0,v211,v213
M a[164:167],a[232:235],a[200:203],a[164:167]
buffer_load_dwordx4 a[248:251],v250,s[20:23],s48 offen offset:0 sc1
M a[164:167],a[208:211],a[244:247],a[164:167]
v_fmac_f32 v213,-2.0,v211
v_cvt_pk_bf16_f32 v205,v232,v205
M a[164:167],a[252:255],a[240:243],a[164:167]
v_cvt_pk_bf16_f32 v215,v237,v215
v_cvt_pk_bf16_f32 v207,v233,v207
M a[168:171],a[252:255],a[244:247],a[168:171]
v_cvt_pk_bf16_f32 v211,v234,v209
v_cvt_pk_bf16_f32 v209,v238,v235
M a[168:171],a[208:211],a[200:203],a[168:171]
buffer_load_dwordx4 a[220:223],v250,s[20:23],s48 offen offset:1024 sc1
M a[168:171],a[232:235],a[212:215],a[168:171]
v_cvt_pk_bf16_f32 v213,v236,v213
v_add_u32 v238,139264,v247
M a[172:175],a[232:235],v[228:231],a[172:175]
v_fmac_f32 v239,s43,v241
v_fmac_f32 v244,4.0,v240
M a[172:175],a[208:211],a[212:215],a[172:175]
v_fma_f32 v232,-4.0,v241,v243
v_fmac_f32 v239,s45,v243
M a[172:175],a[252:255],a[200:203],a[172:175]
buffer_load_dwordx4 a[240:243],v250,s[20:23],s48 offen offset:2048 sc1
M a[176:179],a[252:255],a[212:215],a[176:179]
s_add_u32 s46,s75,36864
v_fmac_f32 v244,s41,v242
v_sub_f32 v243,v243,v241
M a[176:179],a[208:211],v[228:231],a[176:179]
v_add_u32 v248,0x4400,v248
v_add_u32 v249,0x4400,v249
M a[176:179],a[232:235],a[196:199],a[176:179]
ds_write2st64_b64 v238,v[204:205],v[214:215] offset0:1 offset1:18
M a[180:183],a[232:235],a[224:227],a[180:183]
s_add_u32 s28,s70,7471104
buffer_load_dwordx4 a[244:247],v250,s[20:23],s46 offen offset:0 sc1
M a[180:183],a[208:211],a[196:199],a[180:183]
ds_read_b128 a[200:203],v248 offset:52224
v_fma_f32 v241,-4.0,v240,v242
M a[180:183],a[252:255],v[228:231],a[180:183]
ds_write2st64_b64 v247,v[206:207],v[208:209] offset0:35 offset1:52
M a[184:187],a[252:255],a[196:199],a[184:187]
buffer_load_dwordx2 v[204:205],v245,s[12:15],s28 offen offset:0
M a[184:187],a[208:211],a[224:227],a[184:187]
ds_read_b128 a[212:215],v249 offset:52224
ds_read_b128 v[228:231],v248 offset:52736
M a[184:187],a[232:235],a[228:231],a[184:187]
ds_write2st64_b64 v247,v[210:211],v[212:213] offset0:69 offset1:86
M a[188:191],a[232:235],a[236:239],a[188:191]
buffer_load_dwordx2 v[214:215],v245,s[16:19],s28 offen offset:1536
M a[188:191],a[208:211],a[228:231],a[188:191]
ds_read_b128 a[196:199],v249 offset:52736
v_sub_f32 v242,v242,v240
M a[188:191],a[252:255],a[224:227],a[188:191]
s_waitcnt vmcnt(17) lgkmcnt(5)
v_add_f32 v240,v232,v241
v_sub_f32 v232,v232,v241
M v[0:3],v[216:219],a[200:203],v[0:3]
s_waitcnt vmcnt(10) lgkmcnt(3)
ds_read_b128 a[232:235],v248 offset:53248
v_fma_f32 v241,2.0,v242,v243
M v[0:3],a[216:219],a[212:215],v[0:3]
s_waitcnt vmcnt(9) lgkmcnt(3)
buffer_load_dwordx2 v[206:207],v245,s[8:11],s28 offen offset:0
M v[0:3],v[220:223],v[228:231],v[0:3]
s_waitcnt lgkmcnt(1)
ds_read_b128 a[236:239],v249 offset:53248
v_fmac_f32 v243,-2.0,v242
M v[4:7],v[220:223],a[196:199],v[4:7]
v_cvt_pk_bf16_f32 v233,v239,v244
v_cvt_pk_bf16_f32 v234,v240,v232
M v[4:7],a[216:219],v[228:231],v[4:7]
v_cvt_pk_bf16_f32 v235,v241,v243
v_add_u32 v232,139264,v252
M v[4:7],v[216:219],a[212:215],v[4:7]
buffer_load_dwordx2 v[208:209],v245,s[8:11],s28 offen offset:384
M v[8:11],v[216:219],v[228:231],v[8:11]
ds_read_b128 a[208:211],v248 offset:53760
ds_write_b16 v232,v233 offset:0
M v[8:11],a[216:219],a[196:199],v[8:11]
s_waitcnt lgkmcnt(3)
ds_read_b128 a[228:231],v249 offset:53760
ds_write_b16_d16_hi v232,v233 offset:8704
M v[8:11],v[220:223],a[232:235],v[8:11]
s_waitcnt lgkmcnt(4)
ds_write_b16 v252,v234 offset:17408
M v[12:15],v[220:223],a[236:239],v[12:15]
buffer_load_dwordx2 v[210:211],v245,s[8:11],s28 offen offset:768
M v[12:15],a[216:219],a[232:235],v[12:15]
ds_write_b16_d16_hi v252,v234 offset:26112
M v[12:15],v[216:219],a[196:199],v[12:15]
ds_write_b16 v252,v235 offset:34816
M v[16:19],v[216:219],a[232:235],v[16:19]
ds_read_b128 a[224:227],v249 offset:54272
ds_write_b16_d16_hi v252,v235 offset:43520
M v[16:19],a[216:219],a[236:239],v[16:19]
s_waitcnt lgkmcnt(8)
buffer_load_dwordx2 v[212:213],v245,s[8:11],s28 offen offset:1152
M v[16:19],v[220:223],a[208:211],v[16:19]
s_waitcnt lgkmcnt(6)
s_add_u32 s29,s71,6291456
ds_read_b128 a[252:255],v248 offset:54272
v_lshlrev_b32 v234,16,v196
M v[20:23],v[220:223],a[228:231],v[20:23]
v_lshlrev_b32 v232,16,v192
v_lshlrev_b32 v233,16,v194
M v[20:23],a[216:219],a[208:211],v[20:23]
buffer_load_short_d16_hi v239,v246,s[12:15],s29 offen offset:0
M v[20:23],v[216:219],a[236:239],v[20:23]
v_lshlrev_b32 v237,16,v202
v_lshlrev_b32 v236,16,v200
M v[24:27],v[216:219],a[208:211],v[24:27]
buffer_load_short_d16_hi v240,v246,s[8:11],s29 offen offset:0
M v[24:27],a[216:219],a[228:231],v[24:27]
s_waitcnt lgkmcnt(2)
v_lshlrev_b32 v235,16,v198
v_fmac_f32 v232,s43,v234
M v[24:27],v[220:223],a[224:227],v[24:27]
s_waitcnt lgkmcnt(0)
buffer_load_short_d16_hi v241,v246,s[8:11],s29 offen offset:384
M v[28:31],v[220:223],a[252:255],v[28:31]
v_fmac_f32 v237,4.0,v233
v_fma_f32 v238,-4.0,v234,v236
M v[28:31],a[216:219],a[224:227],v[28:31]
buffer_load_dwordx4 v[220:223],v250,s[20:23],s46 offen offset:1024 sc1
M v[28:31],v[216:219],a[228:231],v[28:31]
s_waitcnt vmcnt(16)
v_fmac_f32 v232,s45,v236
v_fmac_f32 v237,s41,v235
M v[32:35],v[224:227],a[200:203],v[32:35]
s_waitcnt vmcnt(15)
v_sub_f32 v236,v236,v234
v_fma_f32 v234,-4.0,v233,v235
M v[32:35],a[192:195],a[212:215],v[32:35]
s_waitcnt vmcnt(14)
v_sub_f32 v235,v235,v233
v_add_f32 v233,v238,v234
M v[32:35],a[204:207],v[228:231],v[32:35]
buffer_load_dwordx4 a[216:219],v250,s[20:23],s46 offen offset:2048 sc1
M v[36:39],a[204:207],a[196:199],v[36:39]
s_add_u32 s47,s75,39936
v_sub_f32 v238,v238,v234
v_fma_f32 v234,2.0,v235,v236
M v[36:39],a[192:195],v[228:231],v[36:39]
v_fmac_f32 v236,-2.0,v235
v_and_b32 v196,s42,v196
M v[36:39],v[224:227],a[212:215],v[36:39]
v_and_b32 v192,s42,v192
v_and_b32 v194,s42,v194
M v[40:43],v[224:227],v[228:231],v[40:43]
buffer_load_dwordx4 v[216:219],v250,s[20:23],s47 offen offset:0 sc1
M v[40:43],a[192:195],a[196:199],v[40:43]
v_and_b32 v202,s42,v202
v_and_b32 v200,s42,v200
M v[40:43],a[204:207],a[232:235],v[40:43]
v_and_b32 v198,s42,v198
v_fmac_f32 v192,s43,v196
M v[44:47],a[204:207],a[236:239],v[44:47]
v_fmac_f32 v202,4.0,v194
v_fma_f32 v235,-4.0,v196,v200
M v[44:47],a[192:195],a[232:235],v[44:47]
buffer_load_short_d16_hi v242,v246,s[8:11],s29 offen offset:768
M v[44:47],v[224:227],a[196:199],v[44:47]
v_fmac_f32 v192,s45,v200
v_fmac_f32 v202,s41,v198
M v[48:51],v[224:227],a[232:235],v[48:51]
buffer_load_short_d16_hi v243,v246,s[8:11],s29 offen offset:1152
M v[48:51],a[192:195],a[236:239],v[48:51]
v_sub_f32 v200,v200,v196
v_fma_f32 v196,-4.0,v194,v198
M v[48:51],a[204:207],a[208:211],v[48:51]
buffer_load_short_d16_hi v244,v246,s[16:19],s29 offen offset:1536
M v[52:55],a[204:207],a[228:231],v[52:55]
v_sub_f32 v198,v198,v194
v_add_f32 v194,v235,v196
M v[52:55],a[192:195],a[208:211],v[52:55]
v_sub_f32 v235,v235,v196
v_fma_f32 v196,2.0,v198,v200
M v[52:55],v[224:227],a[236:239],v[52:55]
v_fmac_f32 v200,-2.0,v198
v_cvt_pk_bf16_f32 v192,v232,v192
M v[56:59],v[224:227],a[208:211],v[56:59]
v_cvt_pk_bf16_f32 v202,v237,v202
v_cvt_pk_bf16_f32 v194,v233,v194
M v[56:59],a[192:195],a[228:231],v[56:59]
v_cvt_pk_bf16_f32 v198,v234,v196
v_cvt_pk_bf16_f32 v196,v238,v235
M v[56:59],a[204:207],a[224:227],v[56:59]
v_cvt_pk_bf16_f32 v200,v236,v200
v_lshlrev_b32 v234,16,v197
M v[60:63],a[204:207],a[252:255],v[60:63]
buffer_load_dwordx4 a[204:207],v250,s[20:23],s47 offen offset:1024 sc1
M v[60:63],a[192:195],a[224:227],v[60:63]
v_lshlrev_b32 v232,16,v193
v_lshlrev_b32 v233,16,v195
M v[60:63],v[224:227],a[228:231],v[60:63]
s_waitcnt vmcnt(19)
buffer_load_dwordx4 a[192:195],v250,s[20:23],s47 offen offset:2048 sc1
M v[64:67],a[248:251],a[200:203],v[64:67]
s_waitcnt vmcnt(19)
s_add_u32 s48,s75,43008
v_lshlrev_b32 v237,16,v203
v_lshlrev_b32 v236,16,v201
M v[64:67],a[220:223],a[212:215],v[64:67]
s_waitcnt vmcnt(18)
v_lshlrev_b32 v235,16,v199
v_fmac_f32 v232,s43,v234
M v[64:67],a[240:243],v[228:231],v[64:67]
v_fmac_f32 v237,4.0,v233
v_fma_f32 v238,-4.0,v234,v236
M v[68:71],a[240:243],a[196:199],v[68:71]
buffer_load_dwordx4 v[224:227],v250,s[20:23],s48 offen offset:0 sc1
M v[68:71],a[220:223],v[228:231],v[68:71]
v_fmac_f32 v232,s45,v236
v_fmac_f32 v237,s41,v235
M v[68:71],a[248:251],a[212:215],v[68:71]
v_sub_f32 v236,v236,v234
v_fma_f32 v234,-4.0,v233,v235
M v[72:75],a[248:251],v[228:231],v[72:75]
v_sub_f32 v235,v235,v233
v_add_f32 v233,v238,v234
M v[72:75],a[220:223],a[196:199],v[72:75]
buffer_load_dwordx4 a[200:203],v250,s[20:23],s48 offen offset:1024 sc1
M v[72:75],a[240:243],a[232:235],v[72:75]
v_sub_f32 v238,v238,v234
v_fma_f32 v234,2.0,v235,v236
M v[76:79],a[240:243],a[236:239],v[76:79]
v_fmac_f32 v236,-2.0,v235
v_and_b32 v197,s42,v197
M v[76:79],a[220:223],a[232:235],v[76:79]
v_and_b32 v193,s42,v193
v_and_b32 v195,s42,v195
M v[76:79],a[248:251],a[196:199],v[76:79]
buffer_load_dwordx4 a[212:215],v250,s[20:23],s48 offen offset:2048 sc1
M v[80:83],a[248:251],a[232:235],v[80:83]
s_add_u32 s46,s76,9216
v_and_b32 v203,s42,v203
v_and_b32 v201,s42,v201
M v[80:83],a[220:223],a[236:239],v[80:83]
v_and_b32 v199,s42,v199
v_fmac_f32 v193,s43,v197
M v[80:83],a[240:243],a[208:211],v[80:83]
v_fmac_f32 v203,4.0,v195
v_fma_f32 v235,-4.0,v197,v201
M v[84:87],a[240:243],a[228:231],v[84:87]
buffer_load_dwordx4 v[228:231],v250,s[20:23],s46 offen offset:0 sc1
M v[84:87],a[220:223],a[208:211],v[84:87]
ds_read_b128 a[196:199],v248 offset:60928
v_fmac_f32 v193,s45,v201
M v[84:87],a[248:251],a[236:239],v[84:87]
ds_read_b128 a[232:235],v249 offset:60928
v_fmac_f32 v203,s41,v199
M v[88:91],a[248:251],a[208:211],v[88:91]
ds_read_b128 a[236:239],v248 offset:61440
v_sub_f32 v201,v201,v197
M v[88:91],a[220:223],a[228:231],v[88:91]
ds_read_b128 a[208:211],v249 offset:61440
v_fma_f32 v197,-4.0,v195,v199
M v[88:91],a[240:243],a[224:227],v[88:91]
v_sub_f32 v199,v199,v195
v_add_f32 v195,v235,v197
M v[92:95],a[240:243],a[252:255],v[92:95]
v_sub_f32 v235,v235,v197
v_fma_f32 v197,2.0,v199,v201
M v[92:95],a[220:223],a[224:227],v[92:95]
v_fmac_f32 v201,-2.0,v199
v_cvt_pk_bf16_f32 v193,v232,v193
M v[92:95],a[248:251],a[228:231],v[92:95]
s_waitcnt vmcnt(21) lgkmcnt(3)
v_cvt_pk_bf16_f32 v203,v237,v203
v_cvt_pk_bf16_f32 v195,v233,v195
M v[96:99],a[244:247],a[196:199],v[96:99]
s_waitcnt vmcnt(11) lgkmcnt(2)
ds_read_b128 a[240:243],v248 offset:61952
v_cvt_pk_bf16_f32 v199,v234,v197
M v[96:99],v[220:223],a[232:235],v[96:99]
s_waitcnt vmcnt(10) lgkmcnt(2)
ds_read_b128 a[252:255],v249 offset:61952
v_cvt_pk_bf16_f32 v197,v238,v235
M v[96:99],a[216:219],a[236:239],v[96:99]
s_waitcnt lgkmcnt(2)
v_cvt_pk_bf16_f32 v201,v236,v201
v_add_u32 v238,139264,v247
M v[100:103],a[216:219],a[208:211],v[100:103]
v_lshlrev_b32 v234,16,v208
v_lshlrev_b32 v232,16,v204
M v[100:103],v[220:223],a[236:239],v[100:103]
v_lshlrev_b32 v233,16,v206
v_lshlrev_b32 v237,16,v214
M v[100:103],a[244:247],a[232:235],v[100:103]
ds_write2st64_b64 v238,v[192:193],v[202:203] offset0:2 offset1:19
M v[104:107],a[244:247],a[236:239],v[104:107]
s_add_u32 s28,s71,6291456
buffer_load_dwordx2 v[192:193],v245,s[12:15],s28 offen offset:0
M v[104:107],v[220:223],a[208:211],v[104:107]
s_waitcnt lgkmcnt(2)
ds_read_b128 a[220:223],v248 offset:62464
ds_read_b128 a[224:227],v249 offset:62464
M v[104:107],a[216:219],a[240:243],v[104:107]
s_waitcnt lgkmcnt(3)
buffer_load_dwordx2 v[202:203],v245,s[16:19],s28 offen offset:1536
M v[108:111],a[216:219],a[252:255],v[108:111]
v_lshlrev_b32 v236,16,v212
v_lshlrev_b32 v235,16,v210
M v[108:111],v[220:223],a[240:243],v[108:111]
v_fmac_f32 v232,s43,v234
v_fmac_f32 v237,4.0,v233
M v[108:111],a[244:247],a[208:211],v[108:111]
ds_write2st64_b64 v247,v[194:195],v[196:197] offset0:36 offset1:53
M v[112:115],a[244:247],a[240:243],v[112:115]
buffer_load_dwordx2 v[194:195],v245,s[8:11],s28 offen offset:0
M v[112:115],v[220:223],a[252:255],v[112:115]
s_waitcnt lgkmcnt(2)
ds_read_b128 a[228:231],v249 offset:62976
ds_read_b128 a[248:251],v248 offset:62976
M v[112:115],a[216:219],a[220:223],v[112:115]
s_waitcnt lgkmcnt(3)
ds_write2st64_b64 v247,v[198:199],v[200:201] offset0:70 offset1:87
M v[116:119],a[216:219],a[224:227],v[116:119]
buffer_load_dwordx2 v[196:197],v245,s[8:11],s28 offen offset:384
M v[116:119],v[220:223],a[220:223],v[116:119]
v_fma_f32 v238,-4.0,v234,v236
v_fmac_f32 v232,s45,v236
M v[116:119],a[244:247],a[252:255],v[116:119]
v_fmac_f32 v237,s41,v235
v_sub_f32 v236,v236,v234
M v[120:123],a[244:247],a[220:223],v[120:123]
v_fma_f32 v234,-4.0,v233,v235
v_sub_f32 v235,v235,v233
M v[120:123],v[220:223],a[224:227],v[120:123]
s_waitcnt lgkmcnt(2)
buffer_load_dwordx2 v[198:199],v245,s[8:11],s28 offen offset:768
M v[120:123],a[216:219],a[228:231],v[120:123]
s_waitcnt lgkmcnt(1)
v_add_f32 v233,v238,v234
v_sub_f32 v238,v238,v234
M v[124:127],a[216:219],a[248:251],v[124:127]
v_fma_f32 v234,2.0,v235,v236
v_fmac_f32 v236,-2.0,v235
M v[124:127],v[220:223],a[228:231],v[124:127]
v_and_b32 v208,s42,v208
v_and_b32 v204,s42,v204
M v[124:127],a[244:247],a[224:227],v[124:127]
s_waitcnt vmcnt(14)
buffer_load_dwordx4 a[216:219],v250,s[20:23],s46 offen offset:1024 sc1
M v[128:131],v[216:219],a[196:199],v[128:131]
s_waitcnt vmcnt(11)
v_and_b32 v206,s42,v206
v_and_b32 v214,s42,v214
M v[128:131],a[204:207],a[232:235],v[128:131]
s_waitcnt vmcnt(10)
v_and_b32 v212,s42,v212
v_and_b32 v210,s42,v210
M v[128:131],a[192:195],a[236:239],v[128:131]
v_fmac_f32 v204,s43,v208
v_fmac_f32 v214,4.0,v206
M v[132:135],a[192:195],a[208:211],v[132:135]
buffer_load_dwordx4 v[220:223],v250,s[20:23],s46 offen offset:2048 sc1
M v[132:135],a[204:207],a[236:239],v[132:135]
s_add_u32 s47,s76,12288
v_fma_f32 v235,-4.0,v208,v212
v_fmac_f32 v204,s45,v212
M v[132:135],v[216:219],a[232:235],v[132:135]
v_fmac_f32 v214,s41,v210
v_sub_f32 v212,v212,v208
M v[136:139],v[216:219],a[236:239],v[136:139]
v_fma_f32 v208,-4.0,v206,v210
v_sub_f32 v210,v210,v206
M v[136:139],a[204:207],a[208:211],v[136:139]
buffer_load_dwordx4 a[244:247],v250,s[20:23],s47 offen offset:0 sc1
M v[136:139],a[192:195],a[240:243],v[136:139]
v_add_f32 v206,v235,v208
v_sub_f32 v235,v235,v208
M v[140:143],a[192:195],a[252:255],v[140:143]
v_fma_f32 v208,2.0,v210,v212
v_fmac_f32 v212,-2.0,v210
M v[140:143],a[204:207],a[240:243],v[140:143]
v_cvt_pk_bf16_f32 v204,v232,v204
v_cvt_pk_bf16_f32 v214,v237,v214
M v[140:143],v[216:219],a[208:211],v[140:143]
buffer_load_dwordx2 v[200:201],v245,s[8:11],s28 offen offset:1152
M v[144:147],v[216:219],a[240:243],v[144:147]
v_cvt_pk_bf16_f32 v206,v233,v206
v_cvt_pk_bf16_f32 v210,v234,v208
M v[144:147],a[204:207],a[252:255],v[144:147]
v_cvt_pk_bf16_f32 v208,v238,v235
v_cvt_pk_bf16_f32 v212,v236,v212
M v[144:147],a[192:195],a[220:223],v[144:147]
v_lshlrev_b32 v234,16,v209
v_lshlrev_b32 v232,16,v205
M v[148:151],a[192:195],a[224:227],v[148:151]
v_lshlrev_b32 v233,16,v207
v_lshlrev_b32 v237,16,v215
M v[148:151],a[204:207],a[220:223],v[148:151]
v_lshlrev_b32 v236,16,v213
v_lshlrev_b32 v235,16,v211
M v[148:151],v[216:219],a[252:255],v[148:151]
v_fmac_f32 v232,s43,v234
v_fmac_f32 v237,4.0,v233
M v[152:155],v[216:219],a[220:223],v[152:155]
v_fma_f32 v238,-4.0,v234,v236
v_fmac_f32 v232,s45,v236
M v[152:155],a[204:207],a[224:227],v[152:155]
v_fmac_f32 v237,s41,v235
v_sub_f32 v236,v236,v234
M v[152:155],a[192:195],a[228:231],v[152:155]
v_fma_f32 v234,-4.0,v233,v235
v_sub_f32 v235,v235,v233
M v[156:159],a[192:195],a[248:251],v[156:159]
buffer_load_dwordx4 a[192:195],v250,s[20:23],s47 offen offset:1024 sc1
v_add_f32 v233,v238,v234
v_sub_f32 v238,v238,v234
v_fma_f32 v234,2.0,v235,v236
v_fmac_f32 v236,-2.0,v235
M v[156:159],a[204:207],a[228:231],v[156:159]
buffer_load_dwordx4 a[204:207],v250,s[20:23],s47 offen offset:2048 sc1
v_and_b32 v209,s42,v209
v_and_b32 v205,s42,v205
v_and_b32 v207,s42,v207
v_and_b32 v215,s42,v215
M v[156:159],v[216:219],a[224:227],v[156:159]
s_waitcnt vmcnt(14)
s_add_u32 s48,s76,15360
v_and_b32 v213,s42,v213
v_and_b32 v211,s42,v211
v_fmac_f32 v205,s43,v209
v_fmac_f32 v215,4.0,v207
M v[160:163],v[224:227],a[196:199],v[160:163]
s_waitcnt vmcnt(13)
v_fma_f32 v235,-4.0,v209,v213
v_fmac_f32 v205,s45,v213
v_fmac_f32 v215,s41,v211
v_sub_f32 v213,v213,v209
M v[160:163],a[200:203],a[232:235],v[160:163]
s_waitcnt vmcnt(12)
buffer_load_dwordx4 v[216:219],v250,s[20:23],s48 offen offset:0 sc1
v_fma_f32 v209,-4.0,v207,v211
v_sub_f32 v211,v211,v207
v_add_f32 v207,v235,v209
v_sub_f32 v235,v235,v209
M v[160:163],a[212:215],a[236:239],v[160:163]
v_fma_f32 v209,2.0,v211,v213
v_fmac_f32 v213,-2.0,v211
v_cvt_pk_bf16_f32 v205,v232,v205
v_cvt_pk_bf16_f32 v215,v237,v215
M v[164:167],a[212:215],a[208:211],v[164:167]
buffer_load_dwordx4 a[196:199],v250,s[20:23],s48 offen offset:1024 sc1
v_cvt_pk_bf16_f32 v207,v233,v207
v_cvt_pk_bf16_f32 v211,v234,v209
v_cvt_pk_bf16_f32 v209,v238,v235
v_cvt_pk_bf16_f32 v213,v236,v213
M v[164:167],a[200:203],a[236:239],v[164:167]
v_add_u32 v238,139264,v247
M v[164:167],v[224:227],a[232:235],v[164:167]
ds_write2st64_b64 v238,v[204:205],v[214:215] offset0:3 offset1:20
M v[168:171],v[224:227],a[236:239],v[168:171]
s_add_u32 s28,s71,6684672
buffer_load_dwordx4 a[232:235],v250,s[20:23],s48 offen offset:2048 sc1
M v[168:171],a[200:203],a[208:211],v[168:171]
s_add_u32 s46,s76,18432
M v[168:171],a[212:215],a[240:243],v[168:171]
ds_write2st64_b64 v247,v[206:207],v[208:209] offset0:37 offset1:54
M v[172:175],a[212:215],a[252:255],v[172:175]
buffer_load_dwordx4 a[236:239],v250,s[20:23],s46 offen offset:0 sc1
M v[172:175],a[200:203],a[240:243],v[172:175]
M v[172:175],v[224:227],a[208:211],v[172:175]
ds_write2st64_b64 v247,v[210:211],v[212:213] offset0:71 offset1:88
M v[176:179],v[224:227],a[240:243],v[176:179]
buffer_load_dwordx2 v[204:205],v245,s[12:15],s28 offen offset:0
M v[176:179],a[200:203],a[252:255],v[176:179]
M v[176:179],a[212:215],a[220:223],v[176:179]
s_waitcnt lgkmcnt(0)
s_barrier
M v[180:183],a[212:215],a[224:227],v[180:183]
M v[180:183],a[200:203],a[220:223],v[180:183]
buffer_load_dwordx2 v[214:215],v245,s[16:19],s28 offen offset:1536
M v[180:183],v[224:227],a[252:255],v[180:183]
ds_read_b128 a[208:211],v248 offset:0
ds_read_b128 a[240:243],v249 offset:0
M v[184:187],v[224:227],a[220:223],v[184:187]
s_waitcnt vmcnt(13)
ds_read_b128 a[252:255],v248 offset:512
v_lshlrev_b32 v234,16,v196
M v[184:187],a[200:203],a[224:227],v[184:187]
ds_read_b128 a[220:223],v249 offset:512
v_lshlrev_b32 v232,16,v192
M v[184:187],a[212:215],a[228:231],v[184:187]
buffer_load_dwordx2 v[206:207],v245,s[8:11],s28 offen offset:0
M v[188:191],a[212:215],a[248:251],v[188:191]
v_lshlrev_b32 v233,16,v194
v_lshlrev_b32 v237,16,v202
M v[188:191],a[200:203],a[228:231],v[188:191]
s_waitcnt vmcnt(9)
v_lshlrev_b32 v236,16,v200
v_lshlrev_b32 v235,16,v198
M v[188:191],v[224:227],a[224:227],v[188:191]
s_waitcnt lgkmcnt(3)
v_fmac_f32 v232,s43,v234
v_fmac_f32 v237,4.0,v233
M a[0:3],v[228:231],a[208:211],a[0:3]
s_waitcnt lgkmcnt(2)
buffer_load_dwordx2 v[208:209],v245,s[8:11],s28 offen offset:384
M a[0:3],a[216:219],a[240:243],a[0:3]
s_waitcnt lgkmcnt(1)
ds_read_b128 a[212:215],v248 offset:1024
ds_read_b128 a[248:251],v249 offset:1024
M a[0:3],v[220:223],a[252:255],a[0:3]
s_waitcnt lgkmcnt(2)
v_fma_f32 v238,-4.0,v234,v236
v_fmac_f32 v232,s45,v236
M a[4:7],v[220:223],a[220:223],a[4:7]
v_fmac_f32 v237,s41,v235
v_sub_f32 v236,v236,v234
M a[4:7],a[216:219],a[252:255],a[4:7]
buffer_load_dwordx2 v[210:211],v245,s[8:11],s28 offen offset:768
M a[4:7],v[228:231],a[240:243],a[4:7]
v_fma_f32 v234,-4.0,v233,v235
v_sub_f32 v235,v235,v233
M a[8:11],v[228:231],a[252:255],a[8:11]
ds_read_b128 a[200:203],v248 offset:1536
v_add_f32 v233,v238,v234
M a[8:11],a[216:219],a[220:223],a[8:11]
s_waitcnt lgkmcnt(2)
ds_read_b128 a[228:231],v249 offset:1536
v_sub_f32 v238,v238,v234
M a[8:11],v[220:223],a[212:215],a[8:11]
s_waitcnt lgkmcnt(2)
buffer_load_dwordx2 v[212:213],v245,s[8:11],s28 offen offset:1152
M a[12:15],v[220:223],a[248:251],a[12:15]
v_fma_f32 v234,2.0,v235,v236
v_fmac_f32 v236,-2.0,v235
M a[12:15],a[216:219],a[212:215],a[12:15]
v_and_b32 v196,s42,v196
v_and_b32 v192,s42,v192
M a[12:15],v[228:231],a[220:223],a[12:15]
v_and_b32 v194,s42,v194
v_and_b32 v202,s42,v202
M a[16:19],v[228:231],a[212:215],a[16:19]
ds_read_b128 a[224:227],v249 offset:2048
v_and_b32 v200,s42,v200
M a[16:19],a[216:219],a[248:251],a[16:19]
s_waitcnt lgkmcnt(2)
ds_read_b128 v[224:227],v248 offset:2048
v_and_b32 v198,s42,v198
M a[16:19],v[220:223],a[200:203],a[16:19]
s_waitcnt lgkmcnt(2)
v_fmac_f32 v192,s43,v196
v_fmac_f32 v202,4.0,v194
M a[20:23],v[220:223],a[228:231],a[20:23]
v_fma_f32 v235,-4.0,v196,v200
v_fmac_f32 v192,s45,v200
M a[20:23],a[216:219],a[200:203],a[20:23]
v_fmac_f32 v202,s41,v198
v_sub_f32 v200,v200,v196
M a[20:23],v[228:231],a[248:251],a[20:23]
v_fma_f32 v196,-4.0,v194,v198
v_sub_f32 v198,v198,v194
M a[24:27],v[228:231],a[200:203],a[24:27]
v_add_f32 v194,v235,v196
v_sub_f32 v235,v235,v196
M a[24:27],a[216:219],a[228:231],a[24:27]
s_waitcnt lgkmcnt(1)
v_fma_f32 v196,2.0,v198,v200
v_fmac_f32 v200,-2.0,v198
M a[24:27],v[220:223],a[224:227],a[24:27]
s_waitcnt lgkmcnt(0)
v_cvt_pk_bf16_f32 v192,v232,v192
v_cvt_pk_bf16_f32 v202,v237,v202
M a[28:31],v[220:223],v[224:227],a[28:31]
buffer_load_dwordx4 v[220:223],v250,s[20:23],s46 offen offset:1024 sc1
M a[28:31],a[216:219],a[224:227],a[28:31]
v_cvt_pk_bf16_f32 v194,v233,v194
v_cvt_pk_bf16_f32 v198,v234,v196
M a[28:31],v[228:231],a[228:231],a[28:31]
buffer_load_dwordx4 a[216:219],v250,s[20:23],s46 offen offset:2048 sc1
M a[32:35],a[244:247],a[208:211],a[32:35]
s_waitcnt vmcnt(13)
s_add_u32 s47,s76,21504
v_cvt_pk_bf16_f32 v196,v238,v235
v_cvt_pk_bf16_f32 v200,v236,v200
M a[32:35],a[192:195],a[240:243],a[32:35]
s_waitcnt vmcnt(12)
v_lshlrev_b32 v234,16,v197
v_lshlrev_b32 v232,16,v193
M a[32:35],a[204:207],a[252:255],a[32:35]
v_lshlrev_b32 v233,16,v195
v_lshlrev_b32 v237,16,v203
M a[36:39],a[204:207],a[220:223],a[36:39]
buffer_load_dwordx4 v[228:231],v250,s[20:23],s47 offen offset:0 sc1
M a[36:39],a[192:195],a[252:255],a[36:39]
v_lshlrev_b32 v236,16,v201
v_lshlrev_b32 v235,16,v199
M a[36:39],a[244:247],a[240:243],a[36:39]
v_fmac_f32 v232,s43,v234
v_fmac_f32 v237,4.0,v233
M a[40:43],a[244:247],a[252:255],a[40:43]
v_fma_f32 v238,-4.0,v234,v236
v_fmac_f32 v232,s45,v236
M a[40:43],a[192:195],a[220:223],a[40:43]
v_fmac_f32 v237,s41,v235
v_sub_f32 v236,v236,v234
M a[40:43],a[204:207],a[212:215],a[40:43]
v_fma_f32 v234,-4.0,v233,v235
v_sub_f32 v235,v235,v233
M a[44:47],a[204:207],a[248:251],a[44:47]
v_add_f32 v233,v238,v234
v_sub_f32 v238,v238,v234
M a[44:47],a[192:195],a[212:215],a[44:47]
v_fma_f32 v234,2.0,v235,v236
v_fmac_f32 v236,-2.0,v235
M a[44:47],a[244:247],a[220:223],a[44:47]
v_and_b32 v197,s42,v197
v_and_b32 v193,s42,v193
M a[48:51],a[244:247],a[212:215],a[48:51]
v_and_b32 v195,s42,v195
v_and_b32 v203,s42,v203
M a[48:51],a[192:195],a[248:251],a[48:51]
v_and_b32 v201,s42,v201
v_and_b32 v199,s42,v199
M a[48:51],a[204:207],a[200:203],a[48:51]
v_fmac_f32 v193,s43,v197
v_fmac_f32 v203,4.0,v195
M a[52:55],a[204:207],a[228:231],a[52:55]
v_fma_f32 v235,-4.0,v197,v201
v_fmac_f32 v193,s45,v201
M a[52:55],a[192:195],a[200:203],a[52:55]
v_fmac_f32 v203,s41,v199
v_sub_f32 v201,v201,v197
M a[52:55],a[244:247],a[248:251],a[52:55]
v_fma_f32 v197,-4.0,v195,v199
v_sub_f32 v199,v199,v195
M a[56:59],a[244:247],a[200:203],a[56:59]
v_add_f32 v195,v235,v197
v_sub_f32 v235,v235,v197
M a[56:59],a[192:195],a[228:231],a[56:59]
v_fma_f32 v197,2.0,v199,v201
v_fmac_f32 v201,-2.0,v199
M a[56:59],a[204:207],a[224:227],a[56:59]
v_cvt_pk_bf16_f32 v193,v232,v193
v_cvt_pk_bf16_f32 v203,v237,v203
M a[60:63],a[204:207],v[224:227],a[60:63]
buffer_load_dwordx4 a[204:207],v250,s[20:23],s47 offen offset:1024 sc1
M a[60:63],a[192:195],a[224:227],a[60:63]
v_cvt_pk_bf16_f32 v195,v233,v195
v_cvt_pk_bf16_f32 v199,v234,v197
M a[60:63],a[244:247],a[228:231],a[60:63]
s_waitcnt vmcnt(13)
buffer_load_dwordx4 a[192:195],v250,s[20:23],s47 offen offset:2048 sc1
M a[64:67],v[216:219],a[208:211],a[64:67]
s_waitcnt vmcnt(13)
s_add_u32 s48,s76,24576
v_cvt_pk_bf16_f32 v197,v238,v235
v_cvt_pk_bf16_f32 v201,v236,v201
M a[64:67],a[196:199],a[240:243],a[64:67]
s_waitcnt vmcnt(7)
v_lshlrev_b32 v234,16,v208
v_lshlrev_b32 v232,16,v204
M a[64:67],a[232:235],a[252:255],a[64:67]
ds_write2st64_b64 v247,v[192:193],v[202:203] offset0:136 offset1:153
M a[68:71],a[232:235],a[220:223],a[68:71]
s_add_u32 s28,s71,7077888
buffer_load_dwordx4 a[244:247],v250,s[20:23],s48 offen offset:0 sc1
M a[68:71],a[196:199],a[252:255],a[68:71]
v_lshlrev_b32 v233,16,v206
v_lshlrev_b32 v237,16,v214
M a[68:71],v[216:219],a[240:243],a[68:71]
ds_write2st64_b64 v247,v[194:195],v[196:197] offset0:0 offset1:17
M a[72:75],v[216:219],a[252:255],a[72:75]
buffer_load_dwordx4 a[208:211],v250,s[20:23],s48 offen offset:1024 sc1
M a[72:75],a[196:199],a[220:223],a[72:75]
s_waitcnt vmcnt(7)
v_lshlrev_b32 v236,16,v212
v_lshlrev_b32 v235,16,v210
M a[72:75],a[232:235],a[212:215],a[72:75]
v_fmac_f32 v232,s43,v234
v_fmac_f32 v237,4.0,v233
M a[76:79],a[232:235],a[248:251],a[76:79]
v_fma_f32 v238,-4.0,v234,v236
v_fmac_f32 v232,s45,v236
M a[76:79],a[196:199],a[212:215],a[76:79]
buffer_load_dwordx4 a[240:243],v250,s[20:23],s48 offen offset:2048 sc1
M a[76:79],v[216:219],a[220:223],a[76:79]
s_add_u32 s46,s76,27648
v_fmac_f32 v237,s41,v235
v_sub_f32 v236,v236,v234
M a[80:83],v[216:219],a[212:215],a[80:83]
v_fma_f32 v234,-4.0,v233,v235
v_sub_f32 v235,v235,v233
M a[80:83],a[196:199],a[248:251],a[80:83]
v_add_f32 v233,v238,v234
v_sub_f32 v238,v238,v234
M a[80:83],a[232:235],a[200:203],a[80:83]
buffer_load_dwordx4 a[252:255],v250,s[20:23],s46 offen offset:0 sc1
M a[84:87],a[232:235],a[228:231],a[84:87]
v_fma_f32 v234,2.0,v235,v236
v_fmac_f32 v236,-2.0,v235
M a[84:87],a[196:199],a[200:203],a[84:87]
ds_read_b128 a[220:223],v248 offset:8704
v_and_b32 v208,s42,v208
M a[84:87],v[216:219],a[248:251],a[84:87]
ds_read_b128 a[212:215],v249 offset:8704
v_and_b32 v204,s42,v204
M a[88:91],v[216:219],a[200:203],a[88:91]
buffer_load_dwordx2 v[192:193],v245,s[12:15],s28 offen offset:0
M a[88:91],a[196:199],a[228:231],a[88:91]
ds_read_b128 a[248:251],v248 offset:9216
ds_read_b128 a[200:203],v249 offset:9216
M a[88:91],a[232:235],a[224:227],a[88:91]
v_and_b32 v206,s42,v206
v_and_b32 v214,s42,v214
M a[92:95],a[232:235],v[224:227],a[92:95]
v_and_b32 v212,s42,v212
v_and_b32 v210,s42,v210
M a[92:95],a[196:199],a[224:227],a[92:95]
buffer_load_dwordx2 v[202:203],v245,s[16:19],s28 offen offset:1536
M a[92:95],v[216:219],a[228:231],a[92:95]
s_waitcnt lgkmcnt(3)
v_fmac_f32 v204,s43,v208
v_fmac_f32 v214,4.0,v206
M a[96:99],a[236:239],a[220:223],a[96:99]
s_waitcnt vmcnt(10) lgkmcnt(2)
ds_read_b128 a[232:235],v248 offset:9728
v_fma_f32 v235,-4.0,v208,v212
M a[96:99],v[220:223],a[212:215],a[96:99]
s_waitcnt vmcnt(9) lgkmcnt(2)
ds_read_b128 v[224:227],v249 offset:9728
v_fmac_f32 v204,s45,v212
M a[96:99],a[216:219],a[248:251],a[96:99]
s_waitcnt lgkmcnt(2)
buffer_load_dwordx2 v[194:195],v245,s[8:11],s28 offen offset:0
M a[100:103],a[216:219],a[200:203],a[100:103]
v_fmac_f32 v214,s41,v210
v_sub_f32 v212,v212,v208
M a[100:103],v[220:223],a[248:251],a[100:103]
v_fma_f32 v208,-4.0,v206,v210
v_sub_f32 v210,v210,v206
M a[100:103],a[236:239],a[212:215],a[100:103]
v_add_f32 v206,v235,v208
v_sub_f32 v235,v235,v208
M a[104:107],a[236:239],a[248:251],a[104:107]
buffer_load_dwordx2 v[196:197],v245,s[8:11],s28 offen offset:384
M a[104:107],v[220:223],a[200:203],a[104:107]
s_waitcnt lgkmcnt(1)
ds_read_b128 a[196:199],v248 offset:10240
ds_read_b128 a[224:227],v249 offset:10240
M a[104:107],a[216:219],a[232:235],a[104:107]
s_waitcnt lgkmcnt(2)
v_fma_f32 v208,2.0,v210,v212
v_fmac_f32 v212,-2.0,v210
M a[108:111],a[216:219],v[224:227],a[108:111]
v_cvt_pk_bf16_f32 v204,v232,v204
v_cvt_pk_bf16_f32 v214,v237,v214
M a[108:111],v[220:223],a[232:235],a[108:111]
v_cvt_pk_bf16_f32 v206,v233,v206
v_cvt_pk_bf16_f32 v210,v234,v208
M a[108:111],a[236:239],a[200:203],a[108:111]
v_cvt_pk_bf16_f32 v208,v238,v235
v_cvt_pk_bf16_f32 v212,v236,v212
M a[112:115],a[236:239],a[232:235],a[112:115]
ds_read_b128 a[228:231],v249 offset:10752
v_lshlrev_b32 v234,16,v209
M a[112:115],v[220:223],v[224:227],a[112:115]
s_waitcnt lgkmcnt(2)
ds_read_b128 v[216:219],v248 offset:10752
v_lshlrev_b32 v232,16,v205
M a[112:115],a[216:219],a[196:199],a[112:115]
s_waitcnt lgkmcnt(2)
v_lshlrev_b32 v233,16,v207
v_lshlrev_b32 v237,16,v215
M a[116:119],a[216:219],a[224:227],a[116:119]
v_lshlrev_b32 v236,16,v213
v_lshlrev_b32 v235,16,v211
M a[116:119],v[220:223],a[196:199],a[116:119]
v_fmac_f32 v232,s43,v234
v_fmac_f32 v237,4.0,v233
M a[116:119],a[236:239],v[224:227],a[116:119]
v_fma_f32 v238,-4.0,v234,v236
v_fmac_f32 v232,s45,v236
M a[120:123],a[236:239],a[196:199],a[120:123]
v_fmac_f32 v237,s41,v235
v_sub_f32 v236,v236,v234
M a[120:123],v[220:223],a[224:227],a[120:123]
s_waitcnt lgkmcnt(1)
v_fma_f32 v234,-4.0,v233,v235
v_sub_f32 v235,v235,v233
M a[120:123],a[216:219],a[228:231],a[120:123]
s_waitcnt lgkmcnt(0)
v_add_f32 v233,v238,v234
v_sub_f32 v238,v238,v234
M a[124:127],a[216:219],v[216:219],a[124:127]
buffer_load_dwordx4 a[216:219],v250,s[20:23],s46 offen offset:1024 sc1
M a[124:127],v[220:223],a[228:231],a[124:127]
v_fma_f32 v234,2.0,v235,v236
v_fmac_f32 v236,-2.0,v235
M a[124:127],a[236:239],a[224:227],a[124:127]
s_waitcnt vmcnt(11)
buffer_load_dwordx4 v[220:223],v250,s[20:23],s46 offen offset:2048 sc1
M a[128:131],v[228:231],a[220:223],a[128:131]
s_waitcnt vmcnt(11)
s_add_u32 s47,s76,30720
v_and_b32 v209,s42,v209
v_and_b32 v205,s42,v205
M a[128:131],a[204:207],a[212:215],a[128:131]
s_waitcnt vmcnt(10)
v_and_b32 v207,s42,v207
v_and_b32 v215,s42,v215
M a[128:131],a[192:195],a[248:251],a[128:131]
v_and_b32 v213,s42,v213
v_and_b32 v211,s42,v211
M a[132:135],a[192:195],a[200:203],a[132:135]
buffer_load_dwordx4 a[236:239],v250,s[20:23],s47 offen offset:0 sc1
M a[132:135],a[204:207],a[248:251],a[132:135]
v_fmac_f32 v205,s43,v209
v_fmac_f32 v215,4.0,v207
M a[132:135],v[228:231],a[212:215],a[132:135]
v_fma_f32 v235,-4.0,v209,v213
v_fmac_f32 v205,s45,v213
M a[136:139],v[228:231],a[248:251],a[136:139]
s_barrier
v_fmac_f32 v215,s41,v211
M a[136:139],a[204:207],a[200:203],a[136:139]
v_sub_f32 v213,v213,v209
v_fma_f32 v209,-4.0,v207,v211
M a[136:139],a[192:195],a[232:235],a[136:139]
ds_write2st64_b64 v247,v[198:199],v[200:201] offset0:34 offset1:51
M a[140:143],a[192:195],v[224:227],a[140:143]
buffer_load_dwordx2 v[198:199],v245,s[8:11],s28 offen offset:768
M a[140:143],a[204:207],a[232:235],a[140:143]
v_sub_f32 v211,v211,v207
v_add_f32 v207,v235,v209
M a[140:143],v[228:231],a[200:203],a[140:143]
buffer_load_dwordx2 v[200:201],v245,s[8:11],s28 offen offset:1152
M a[144:147],v[228:231],a[232:235],a[144:147]
v_sub_f32 v235,v235,v209
v_fma_f32 v209,2.0,v211,v213
M a[144:147],a[204:207],v[224:227],a[144:147]
v_fmac_f32 v213,-2.0,v211
v_cvt_pk_bf16_f32 v205,v232,v205
M a[144:147],a[192:195],a[196:199],a[144:147]
v_cvt_pk_bf16_f32 v215,v237,v215
v_cvt_pk_bf16_f32 v207,v233,v207
M a[148:151],a[192:195],a[224:227],a[148:151]
v_cvt_pk_bf16_f32 v211,v234,v209
v_cvt_pk_bf16_f32 v209,v238,v235
M a[148:151],a[204:207],a[196:199],a[148:151]
v_cvt_pk_bf16_f32 v213,v236,v213
v_fmac_f32 v239,s43,v241
M a[148:151],v[228:231],v[224:227],a[148:151]
ds_write2st64_b64 v247,v[204:205],v[214:215] offset0:137 offset1:154
M a[152:155],v[228:231],a[196:199],a[152:155]
s_add_u32 s28,s71,7471104
buffer_load_dwordx2 v[204:205],v245,s[12:15],s28 offen offset:0
M a[152:155],a[204:207],a[224:227],a[152:155]
v_fmac_f32 v244,4.0,v240
v_fma_f32 v232,-4.0,v241,v243
M a[152:155],a[192:195],a[228:231],a[152:155]
buffer_load_dwordx2 v[214:215],v245,s[16:19],s28 offen offset:1536
M a[156:159],a[192:195],v[216:219],a[156:159]
v_fmac_f32 v239,s45,v243
v_fmac_f32 v244,s41,v242
M a[156:159],a[204:207],a[228:231],a[156:159]
v_sub_f32 v243,v243,v241
v_fma_f32 v241,-4.0,v240,v242
M a[156:159],v[228:231],a[224:227],a[156:159]
s_waitcnt vmcnt(14)
ds_write2st64_b64 v247,v[206:207],v[208:209] offset0:1 offset1:18
M a[160:163],a[244:247],a[220:223],a[160:163]
s_waitcnt vmcnt(13)
buffer_load_dwordx4 a[192:195],v250,s[20:23],s47 offen offset:1024 sc1
M a[160:163],a[208:211],a[212:215],a[160:163]
s_waitcnt vmcnt(13)
v_sub_f32 v242,v242,v240
v_add_f32 v240,v232,v241
M a[160:163],a[240:243],a[248:251],a[160:163]
ds_write2st64_b64 v247,v[210:211],v[212:213] offset0:35 offset1:52
M a[164:167],a[240:243],a[200:203],a[164:167]
buffer_load_dwordx4 a[204:207],v250,s[20:23],s47 offen offset:2048 sc1
M a[164:167],a[208:211],a[248:251],a[164:167]
s_add_u32 s48,s76,33792
v_sub_f32 v232,v232,v241
v_fma_f32 v241,2.0,v242,v243
M a[164:167],a[244:247],a[212:215],a[164:167]
v_fmac_f32 v243,-2.0,v242
v_cvt_pk_bf16_f32 v233,v239,v244
M a[168:171],a[244:247],a[248:251],a[168:171]
v_cvt_pk_bf16_f32 v234,v240,v232
v_cvt_pk_bf16_f32 v235,v241,v243
M a[168:171],a[208:211],a[200:203],a[168:171]
buffer_load_dwordx4 v[228:231],v250,s[20:23],s48 offen offset:0 sc1
M a[168:171],a[240:243],a[232:235],a[168:171]
v_add_u32 v232,69632,v252
M a[172:175],a[240:243],v[224:227],a[172:175]
ds_write_b16 v232,v233 offset:0
M a[172:175],a[208:211],a[232:235],a[172:175]
ds_write_b16_d16_hi v232,v233 offset:8704
M a[172:175],a[244:247],a[200:203],a[172:175]
buffer_load_dwordx4 a[220:223],v250,s[20:23],s48 offen offset:1024 sc1
M a[176:179],a[244:247],a[232:235],a[176:179]
ds_write_b16 v252,v234 offset:0
M a[176:179],a[208:211],v[224:227],a[176:179]
ds_write_b16_d16_hi v252,v234 offset:8704
M a[176:179],a[240:243],a[196:199],a[176:179]
ds_write_b16 v252,v235 offset:17408
M a[180:183],a[240:243],a[224:227],a[180:183]
buffer_load_dwordx4 a[212:215],v250,s[20:23],s48 offen offset:2048 sc1
M a[180:183],a[208:211],a[196:199],a[180:183]
s_add_u32 s46,s76,36864
ds_read_b128 a[200:203],v248 offset:17408
ds_write_b16_d16_hi v252,v235 offset:26112
M a[180:183],a[244:247],v[224:227],a[180:183]
s_waitcnt vmcnt(12)
ds_read_b128 a[232:235],v249 offset:17408
v_lshlrev_b32 v234,16,v196
M a[184:187],a[244:247],a[196:199],a[184:187]
ds_read_b128 v[224:227],v248 offset:17920
v_lshlrev_b32 v232,16,v192
M a[184:187],a[208:211],a[224:227],a[184:187]
buffer_load_dwordx4 a[248:251],v250,s[20:23],s46 offen offset:0 sc1
M a[184:187],a[240:243],a[228:231],a[184:187]
ds_read_b128 a[196:199],v249 offset:17920
v_lshlrev_b32 v233,16,v194
M a[188:191],a[240:243],v[216:219],a[188:191]
s_waitcnt vmcnt(8)
v_lshlrev_b32 v237,16,v202
v_lshlrev_b32 v236,16,v200
M a[188:191],a[208:211],a[228:231],a[188:191]
v_lshlrev_b32 v235,16,v198
v_fmac_f32 v232,s43,v234
M a[188:191],a[244:247],a[224:227],a[188:191]
s_waitcnt lgkmcnt(4)
buffer_load_dwordx2 v[206:207],v245,s[8:11],s28 offen offset:0
M v[0:3],a[252:255],a[200:203],v[0:3]
s_waitcnt lgkmcnt(2)
ds_read_b128 a[240:243],v248 offset:18432
v_fmac_f32 v237,4.0,v233
M v[0:3],a[216:219],a[232:235],v[0:3]
s_waitcnt lgkmcnt(2)
ds_read_b128 v[216:219],v249 offset:18432
v_fma_f32 v238,-4.0,v234,v236
M v[0:3],v[220:223],v[224:227],v[0:3]
s_waitcnt lgkmcnt(2)
v_fmac_f32 v232,s45,v236
v_fmac_f32 v237,s41,v235
M v[4:7],v[220:223],a[196:199],v[4:7]
buffer_load_dwordx2 v[208:209],v245,s[8:11],s28 offen offset:384
M v[4:7],a[216:219],v[224:227],v[4:7]
v_sub_f32 v236,v236,v234
v_fma_f32 v234,-4.0,v233,v235
M v[4:7],a[252:255],a[232:235],v[4:7]
v_sub_f32 v235,v235,v233
v_add_f32 v233,v238,v234
M v[8:11],a[252:255],v[224:227],v[8:11]
ds_read_b128 a[208:211],v248 offset:18944
v_sub_f32 v238,v238,v234
M v[8:11],a[216:219],a[196:199],v[8:11]
s_waitcnt lgkmcnt(2)
buffer_load_dwordx2 v[210:211],v245,s[8:11],s28 offen offset:768
M v[8:11],v[220:223],a[240:243],v[8:11]
s_waitcnt lgkmcnt(1)
ds_read_b128 a[228:231],v249 offset:18944
v_fma_f32 v234,2.0,v235,v236
M v[12:15],v[220:223],v[216:219],v[12:15]
v_fmac_f32 v236,-2.0,v235
v_and_b32 v196,s42,v196
M v[12:15],a[216:219],a[240:243],v[12:15]
v_and_b32 v192,s42,v192
v_and_b32 v194,s42,v194
M v[12:15],a[252:255],a[196:199],v[12:15]
buffer_load_dwordx2 v[212:213],v245,s[8:11],s28 offen offset:1152
M v[16:19],a[252:255],a[240:243],v[16:19]
ds_read_b128 a[224:227],v249 offset:19456
v_and_b32 v202,s42,v202
M v[16:19],a[216:219],v[216:219],v[16:19]
s_waitcnt lgkmcnt(2)
ds_read_b128 a[244:247],v248 offset:19456
v_and_b32 v200,s42,v200
M v[16:19],v[220:223],a[208:211],v[16:19]
s_waitcnt lgkmcnt(2)
v_and_b32 v198,s42,v198
v_fmac_f32 v192,s43,v196
M v[20:23],v[220:223],a[228:231],v[20:23]
v_fmac_f32 v202,4.0,v194
v_fma_f32 v235,-4.0,v196,v200
M v[20:23],a[216:219],a[208:211],v[20:23]
v_fmac_f32 v192,s45,v200
v_fmac_f32 v202,s41,v198
M v[20:23],a[252:255],v[216:219],v[20:23]
v_sub_f32 v200,v200,v196
v_fma_f32 v196,-4.0,v194,v198
M v[24:27],a[252:255],a[208:211],v[24:27]
v_sub_f32 v198,v198,v194
v_add_f32 v194,v235,v196
M v[24:27],a[216:219],a[228:231],v[24:27]
s_waitcnt lgkmcnt(1)
v_sub_f32 v235,v235,v196
v_fma_f32 v196,2.0,v198,v200
M v[24:27],v[220:223],a[224:227],v[24:27]
s_waitcnt lgkmcnt(0)
v_fmac_f32 v200,-2.0,v198
v_cvt_pk_bf16_f32 v192,v232,v192
M v[28:31],v[220:223],a[244:247],v[28:31]
global_load_dword v220,v250,s[64:65]
M v[28:31],a[216:219],a[224:227],v[28:31]
buffer_load_dwordx4 v[220:223],v250,s[20:23],s46 offen offset:1024 sc1
M v[28:31],a[252:255],a[228:231],v[28:31]
v_cvt_pk_bf16_f32 v202,v237,v202
v_cvt_pk_bf16_f32 v194,v233,v194
M v[32:35],a[236:239],a[200:203],v[32:35]
s_waitcnt vmcnt(11)
v_cvt_pk_bf16_f32 v198,v234,v196
v_cvt_pk_bf16_f32 v196,v238,v235
M v[32:35],a[192:195],a[232:235],v[32:35]
s_waitcnt vmcnt(10)
buffer_load_dwordx4 a[216:219],v250,s[20:23],s46 offen offset:2048 sc1
M v[32:35],a[204:207],v[224:227],v[32:35]
s_add_u32 s47,s76,39936
v_cvt_pk_bf16_f32 v200,v236,v200
v_lshlrev_b32 v234,16,v197
M v[36:39],a[204:207],a[196:199],v[36:39]
v_lshlrev_b32 v232,16,v193
v_lshlrev_b32 v233,16,v195
M v[36:39],a[192:195],v[224:227],v[36:39]
v_lshlrev_b32 v237,16,v203
v_lshlrev_b32 v236,16,v201
M v[36:39],a[236:239],a[232:235],v[36:39]
buffer_load_dwordx4 a[252:255],v250,s[20:23],s47 offen offset:0 sc1
M v[40:43],a[236:239],v[224:227],v[40:43]
v_lshlrev_b32 v235,16,v199
v_fmac_f32 v232,s43,v234
M v[40:43],a[192:195],a[196:199],v[40:43]
v_fmac_f32 v237,4.0,v233
v_fma_f32 v238,-4.0,v234,v236
M v[40:43],a[204:207],a[240:243],v[40:43]
v_fmac_f32 v232,s45,v236
v_fmac_f32 v237,s41,v235
M v[44:47],a[204:207],v[216:219],v[44:47]
v_sub_f32 v236,v236,v234
v_fma_f32 v234,-4.0,v233,v235
M v[44:47],a[192:195],a[240:243],v[44:47]
v_sub_f32 v235,v235,v233
v_add_f32 v233,v238,v234
M v[44:47],a[236:239],a[196:199],v[44:47]
v_sub_f32 v238,v238,v234
v_fma_f32 v234,2.0,v235,v236
M v[48:51],a[236:239],a[240:243],v[48:51]
v_fmac_f32 v236,-2.0,v235
v_and_b32 v197,s42,v197
M v[48:51],a[192:195],v[216:219],v[48:51]
v_and_b32 v193,s42,v193
v_and_b32 v195,s42,v195
M v[48:51],a[204:207],a[208:211],v[48:51]
v_and_b32 v203,s42,v203
v_and_b32 v201,s42,v201
M v[52:55],a[204:207],a[228:231],v[52:55]
v_and_b32 v199,s42,v199
v_fmac_f32 v193,s43,v197
M v[52:55],a[192:195],a[208:211],v[52:55]
v_fmac_f32 v203,4.0,v195
v_fma_f32 v235,-4.0,v197,v201
M v[52:55],a[236:239],v[216:219],v[52:55]
v_fmac_f32 v193,s45,v201
v_fmac_f32 v203,s41,v199
M v[56:59],a[236:239],a[208:211],v[56:59]
v_sub_f32 v201,v201,v197
v_fma_f32 v197,-4.0,v195,v199
M v[56:59],a[192:195],a[228:231],v[56:59]
v_sub_f32 v199,v199,v195
v_add_f32 v195,v235,v197
M v[56:59],a[204:207],a[224:227],v[56:59]
v_sub_f32 v235,v235,v197
v_fma_f32 v197,2.0,v199,v201
M v[60:63],a[204:207],a[244:247],v[60:63]
buffer_load_dwordx4 a[204:207],v250,s[20:23],s47 offen offset:1024 sc1
M v[60:63],a[192:195],a[224:227],v[60:63]
v_fmac_f32 v201,-2.0,v199
v_cvt_pk_bf16_f32 v193,v232,v193
M v[60:63],a[236:239],a[228:231],v[60:63]
s_waitcnt vmcnt(12)
buffer_load_dwordx4 a[192:195],v250,s[20:23],s47 offen offset:2048 sc1
M v[64:67],v[228:231],a[200:203],v[64:67]
s_waitcnt vmcnt(12)
s_add_u32 s48,s76,43008
v_cvt_pk_bf16_f32 v203,v237,v203
v_cvt_pk_bf16_f32 v195,v233,v195
M v[64:67],a[220:223],a[232:235],v[64:67]
s_waitcnt vmcnt(11)
v_cvt_pk_bf16_f32 v199,v234,v197
v_cvt_pk_bf16_f32 v197,v238,v235
M v[64:67],a[212:215],v[224:227],v[64:67]
s_waitcnt vmcnt(8)
v_cvt_pk_bf16_f32 v201,v236,v201
v_lshlrev_b32 v234,16,v208
M v[68:71],a[212:215],a[196:199],v[68:71]
buffer_load_dwordx4 a[236:239],v250,s[20:23],s48 offen offset:0 sc1
M v[68:71],a[220:223],v[224:227],v[68:71]
v_lshlrev_b32 v232,16,v204
v_lshlrev_b32 v233,16,v206
M v[68:71],v[228:231],a[232:235],v[68:71]
ds_write2st64_b64 v247,v[192:193],v[202:203] offset0:138 offset1:155
M v[72:75],v[228:231],v[224:227],v[72:75]
s_waitcnt vmcnt(7)
v_lshlrev_b32 v237,16,v214
v_lshlrev_b32 v236,16,v212
M v[72:75],a[220:223],a[196:199],v[72:75]
buffer_load_dwordx4 a[200:203],v250,s[20:23],s48 offen offset:1024 sc1
M v[72:75],a[212:215],a[240:243],v[72:75]
ds_write2st64_b64 v247,v[194:195],v[196:197] offset0:2 offset1:19
M v[76:79],a[212:215],v[216:219],v[76:79]
v_lshlrev_b32 v235,16,v210
v_fmac_f32 v232,s43,v234
M v[76:79],a[220:223],a[240:243],v[76:79]
buffer_load_dwordx4 a[232:235],v250,s[20:23],s48 offen offset:2048 sc1
M v[76:79],v[228:231],a[196:199],v[76:79]
s_add_u32 s46,s77,9216
ds_write2st64_b64 v247,v[198:199],v[200:201] offset0:36 offset1:53
M v[80:83],v[228:231],a[240:243],v[80:83]
v_fmac_f32 v237,4.0,v233
v_fma_f32 v238,-4.0,v234,v236
M v[80:83],a[220:223],v[216:219],v[80:83]
buffer_load_dwordx4 v[224:227],v250,s[20:23],s46 offen offset:0 sc1
M v[80:83],a[212:215],a[208:211],v[80:83]
v_fmac_f32 v232,s45,v236
v_fmac_f32 v237,s41,v235
M v[84:87],a[212:215],a[228:231],v[84:87]
v_sub_f32 v236,v236,v234
v_fma_f32 v234,-4.0,v233,v235
M v[84:87],a[220:223],a[208:211],v[84:87]
ds_read_b128 a[196:199],v248 offset:26112
v_sub_f32 v235,v235,v233
M v[84:87],v[228:231],v[216:219],v[84:87]
ds_read_b128 a[240:243],v249 offset:26112
v_add_f32 v233,v238,v234
M v[88:91],v[228:231],a[208:211],v[88:91]
ds_read_b128 v[216:219],v248 offset:26624
v_sub_f32 v238,v238,v234
M v[88:91],a[220:223],a[228:231],v[88:91]
ds_read_b128 a[208:211],v249 offset:26624
v_fma_f32 v234,2.0,v235,v236
M v[88:91],a[212:215],a[224:227],v[88:91]
v_fmac_f32 v236,-2.0,v235
v_and_b32 v208,s42,v208
M v[92:95],a[212:215],a[244:247],v[92:95]
v_and_b32 v204,s42,v204
v_and_b32 v206,s42,v206
M v[92:95],a[220:223],a[224:227],v[92:95]
v_and_b32 v214,s42,v214
v_and_b32 v212,s42,v212
M v[92:95],v[228:231],a[228:231],v[92:95]
s_waitcnt lgkmcnt(3)
v_and_b32 v210,s42,v210
v_fmac_f32 v204,s43,v208
M v[96:99],a[248:251],a[196:199],v[96:99]
s_waitcnt vmcnt(8) lgkmcnt(2)
ds_read_b128 a[212:215],v248 offset:27136
v_fmac_f32 v214,4.0,v206
M v[96:99],v[220:223],a[240:243],v[96:99]
s_waitcnt vmcnt(7) lgkmcnt(2)
ds_read_b128 a[244:247],v249 offset:27136
v_fma_f32 v235,-4.0,v208,v212
M v[96:99],a[216:219],v[216:219],v[96:99]
s_waitcnt lgkmcnt(2)
v_fmac_f32 v204,s45,v212
v_fmac_f32 v214,s41,v210
M v[100:103],a[216:219],a[208:211],v[100:103]
v_sub_f32 v212,v212,v208
v_fma_f32 v208,-4.0,v206,v210
M v[100:103],v[220:223],v[216:219],v[100:103]
v_sub_f32 v210,v210,v206
v_add_f32 v206,v235,v208
M v[100:103],a[248:251],a[240:243],v[100:103]
v_sub_f32 v235,v235,v208
v_fma_f32 v208,2.0,v210,v212
M v[104:107],a[248:251],v[216:219],v[104:107]
ds_read_b128 a[220:223],v248 offset:27648
v_fmac_f32 v212,-2.0,v210
M v[104:107],v[220:223],a[208:211],v[104:107]
s_waitcnt lgkmcnt(2)
ds_read_b128 a[224:227],v249 offset:27648
v_cvt_pk_bf16_f32 v204,v232,v204
M v[104:107],a[216:219],a[212:215],v[104:107]
s_waitcnt lgkmcnt(2)
v_cvt_pk_bf16_f32 v214,v237,v214
v_cvt_pk_bf16_f32 v206,v233,v206
M v[108:111],a[216:219],a[244:247],v[108:111]
v_cvt_pk_bf16_f32 v210,v234,v208
v_cvt_pk_bf16_f32 v208,v238,v235
M v[108:111],v[220:223],a[212:215],v[108:111]
v_cvt_pk_bf16_f32 v212,v236,v212
v_lshlrev_b32 v234,16,v209
M v[108:111],a[248:251],a[208:211],v[108:111]
v_lshlrev_b32 v232,16,v205
v_lshlrev_b32 v233,16,v207
M v[112:115],a[248:251],a[212:215],v[112:115]
ds_read_b128 a[228:231],v249 offset:28160
v_lshlrev_b32 v237,16,v215
M v[112:115],v[220:223],a[244:247],v[112:115]
s_waitcnt lgkmcnt(2)
ds_read_b128 v[228:231],v248 offset:28160
v_lshlrev_b32 v236,16,v213
M v[112:115],a[216:219],a[220:223],v[112:115]
s_waitcnt lgkmcnt(2)
v_lshlrev_b32 v235,16,v211
v_fmac_f32 v232,s43,v234
M v[116:119],a[216:219],a[224:227],v[116:119]
v_fmac_f32 v237,4.0,v233
v_fma_f32 v238,-4.0,v234,v236
M v[116:119],v[220:223],a[220:223],v[116:119]
v_fmac_f32 v232,s45,v236
v_fmac_f32 v237,s41,v235
M v[116:119],a[248:251],a[244:247],v[116:119]
v_sub_f32 v236,v236,v234
v_fma_f32 v234,-4.0,v233,v235
M v[120:123],a[248:251],a[220:223],v[120:123]
v_sub_f32 v235,v235,v233
v_add_f32 v233,v238,v234
M v[120:123],v[220:223],a[224:227],v[120:123]
s_waitcnt lgkmcnt(1)
v_sub_f32 v238,v238,v234
v_fma_f32 v234,2.0,v235,v236
M v[120:123],a[216:219],a[228:231],v[120:123]
s_waitcnt lgkmcnt(0)
v_fmac_f32 v236,-2.0,v235
v_and_b32 v209,s42,v209
M v[124:127],a[216:219],v[228:231],v[124:127]
buffer_load_dwordx4 a[216:219],v250,s[20:23],s46 offen offset:1024 sc1
M v[124:127],v[220:223],a[228:231],v[124:127]
v_and_b32 v205,s42,v205
v_and_b32 v207,s42,v207
M v[124:127],a[248:251],a[224:227],v[124:127]
s_waitcnt vmcnt(7)
buffer_load_dwordx4 v[220:223],v250,s[20:23],s46 offen offset:2048 sc1
M v[128:131],a[252:255],a[196:199],v[128:131]
s_waitcnt vmcnt(7)
s_add_u32 s46,s77,18432
v_and_b32 v215,s42,v215
v_and_b32 v213,s42,v213
M v[128:131],a[204:207],a[240:243],v[128:131]
s_waitcnt vmcnt(6)
v_and_b32 v211,s42,v211
v_fmac_f32 v205,s43,v209
M v[128:131],a[192:195],v[216:219],v[128:131]
v_fmac_f32 v215,4.0,v207
v_fma_f32 v235,-4.0,v209,v213
M v[132:135],a[192:195],a[208:211],v[132:135]
buffer_load_dwordx4 a[248:251],v250,s[20:23],s46 offen offset:0 sc1
M v[132:135],a[204:207],v[216:219],v[132:135]
v_fmac_f32 v205,s45,v213
v_fmac_f32 v215,s41,v211
M v[132:135],a[252:255],a[240:243],v[132:135]
v_sub_f32 v213,v213,v209
v_fma_f32 v209,-4.0,v207,v211
M v[136:139],a[252:255],v[216:219],v[136:139]
v_sub_f32 v211,v211,v207
v_add_f32 v207,v235,v209
M v[136:139],a[204:207],a[208:211],v[136:139]
v_sub_f32 v235,v235,v209
v_fma_f32 v209,2.0,v211,v213
M v[136:139],a[192:195],a[212:215],v[136:139]
v_fmac_f32 v213,-2.0,v211
v_cvt_pk_bf16_f32 v205,v232,v205
M v[140:143],a[192:195],a[244:247],v[140:143]
v_cvt_pk_bf16_f32 v215,v237,v215
v_cvt_pk_bf16_f32 v207,v233,v207
M v[140:143],a[204:207],a[212:215],v[140:143]
v_cvt_pk_bf16_f32 v211,v234,v209
v_cvt_pk_bf16_f32 v209,v238,v235
M v[140:143],a[252:255],a[208:211],v[140:143]
v_cvt_pk_bf16_f32 v213,v236,v213
M v[144:147],a[252:255],a[212:215],v[144:147]
M v[144:147],a[204:207],a[244:247],v[144:147]
M v[144:147],a[192:195],a[220:223],v[144:147]
ds_write2st64_b64 v247,v[204:205],v[214:215] offset0:139 offset1:156
M v[148:151],a[192:195],a[224:227],v[148:151]
M v[148:151],a[204:207],a[220:223],v[148:151]
M v[148:151],a[252:255],a[244:247],v[148:151]
ds_write2st64_b64 v247,v[206:207],v[208:209] offset0:3 offset1:20
M v[152:155],a[252:255],a[220:223],v[152:155]
M v[152:155],a[204:207],a[224:227],v[152:155]
M v[152:155],a[192:195],a[228:231],v[152:155]
ds_write2st64_b64 v247,v[210:211],v[212:213] offset0:37 offset1:54
M v[156:159],a[192:195],v[228:231],v[156:159]
buffer_load_dwordx4 a[192:195],v250,s[20:23],s46 offen offset:1024 sc1
M v[156:159],a[204:207],a[228:231],v[156:159]
M v[156:159],a[252:255],a[224:227],v[156:159]
s_waitcnt vmcnt(7)
buffer_load_dwordx4 a[204:207],v250,s[20:23],s46 offen offset:2048 sc1
M v[160:163],a[236:239],a[196:199],v[160:163]
s_waitcnt vmcnt(7)
s_add_u32 s46,s77,27648
M v[160:163],a[200:203],a[240:243],v[160:163]
s_waitcnt vmcnt(6)
M v[160:163],a[232:235],v[216:219],v[160:163]
M v[164:167],a[232:235],a[208:211],v[164:167]
buffer_load_dwordx4 a[252:255],v250,s[20:23],s46 offen offset:0 sc1
M v[164:167],a[200:203],v[216:219],v[164:167]
M v[164:167],a[236:239],a[240:243],v[164:167]
M v[168:171],a[236:239],v[216:219],v[168:171]
M v[168:171],a[200:203],a[208:211],v[168:171]
buffer_load_dwordx4 a[196:199],v250,s[20:23],s46 offen offset:1024 sc1
M v[168:171],a[232:235],a[212:215],v[168:171]
M v[172:175],a[232:235],a[244:247],v[172:175]
M v[172:175],a[200:203],a[212:215],v[172:175]
M v[172:175],a[236:239],a[208:211],v[172:175]
buffer_load_dwordx4 a[240:243],v250,s[20:23],s46 offen offset:2048 sc1
M v[176:179],a[236:239],a[212:215],v[176:179]
s_add_u32 s46,s77,36864
M v[176:179],a[200:203],a[244:247],v[176:179]
v_add_u32 v248,0xffffbc00,v248
v_add_u32 v249,0xffffbc00,v249
M v[176:179],a[232:235],a[220:223],v[176:179]
s_waitcnt lgkmcnt(0)
s_barrier
M v[180:183],a[232:235],a[224:227],v[180:183]
buffer_load_dwordx4 v[216:219],v250,s[20:23],s46 offen offset:0 sc1
M v[180:183],a[200:203],a[220:223],v[180:183]
ds_read_b128 a[208:211],v248 offset:0
M v[180:183],a[236:239],a[244:247],v[180:183]
ds_read_b128 a[212:215],v249 offset:0
M v[184:187],a[236:239],a[220:223],v[184:187]
ds_read_b128 a[244:247],v248 offset:512
M v[184:187],a[200:203],a[224:227],v[184:187]
ds_read_b128 a[220:223],v249 offset:512
M v[184:187],a[232:235],a[228:231],v[184:187]
M v[188:191],a[232:235],v[228:231],v[188:191]
buffer_load_dwordx4 a[232:235],v250,s[20:23],s46 offen offset:1024 sc1
M v[188:191],a[200:203],a[228:231],v[188:191]
M v[188:191],a[236:239],a[224:227],v[188:191]
s_waitcnt vmcnt(10) lgkmcnt(3)
buffer_load_dwordx4 v[228:231],v250,s[20:23],s46 offen offset:2048 sc1
M a[0:3],v[224:227],a[208:211],a[0:3]
s_waitcnt vmcnt(10) lgkmcnt(2)
s_add_u32 s47,s77,12288
ds_read_b128 a[228:231],v248 offset:1024
M a[0:3],a[216:219],a[212:215],a[0:3]
s_waitcnt vmcnt(9) lgkmcnt(2)
ds_read_b128 a[224:227],v249 offset:1024
M a[0:3],v[220:223],a[244:247],a[0:3]
s_waitcnt lgkmcnt(2)
M a[4:7],v[220:223],a[220:223],a[4:7]
buffer_load_dwordx4 a[200:203],v250,s[20:23],s47 offen offset:0 sc1
M a[4:7],a[216:219],a[244:247],a[4:7]
M a[4:7],v[224:227],a[212:215],a[4:7]
M a[8:11],v[224:227],a[244:247],a[8:11]
ds_read_b128 a[236:239],v248 offset:1536
M a[8:11],a[216:219],a[220:223],a[8:11]
s_waitcnt lgkmcnt(2)
ds_read_b128 a[208:211],v249 offset:1536
M a[8:11],v[220:223],a[228:231],a[8:11]
s_waitcnt lgkmcnt(2)
M a[12:15],v[220:223],a[224:227],a[12:15]
M a[12:15],a[216:219],a[228:231],a[12:15]
M a[12:15],v[224:227],a[220:223],a[12:15]
M a[16:19],v[224:227],a[228:231],a[16:19]
ds_read_b128 a[212:215],v249 offset:2048
M a[16:19],a[216:219],a[224:227],a[16:19]
s_waitcnt lgkmcnt(2)
ds_read_b128 a[244:247],v248 offset:2048
M a[16:19],v[220:223],a[236:239],a[16:19]
s_waitcnt lgkmcnt(2)
M a[20:23],v[220:223],a[208:211],a[20:23]
M a[20:23],a[216:219],a[236:239],a[20:23]
ds_read_b128 a[220:223],v248 offset:8704
M a[20:23],v[224:227],a[224:227],a[20:23]
ds_read_b128 a[228:231],v249 offset:8704
M a[24:27],v[224:227],a[236:239],a[24:27]
ds_read_b128 a[224:227],v248 offset:9216
M a[24:27],a[216:219],a[208:211],a[24:27]
s_waitcnt lgkmcnt(4)
ds_read_b128 a[236:239],v249 offset:9216
M a[24:27],v[220:223],a[212:215],a[24:27]
s_waitcnt lgkmcnt(4)
M a[28:31],v[220:223],a[244:247],a[28:31]
buffer_load_dwordx4 a[244:247],v250,s[20:23],s47 offen offset:1024 sc1
M a[28:31],a[216:219],a[212:215],a[28:31]
M a[28:31],v[224:227],a[208:211],a[28:31]
s_waitcnt vmcnt(10) lgkmcnt(3)
buffer_load_dwordx4 v[220:223],v250,s[20:23],s47 offen offset:2048 sc1
M a[96:99],a[248:251],a[220:223],a[96:99]
s_waitcnt vmcnt(10) lgkmcnt(2)
s_add_u32 s48,s77,15360
ds_read_b128 a[216:219],v248 offset:9728
M a[96:99],a[192:195],a[228:231],a[96:99]
s_waitcnt vmcnt(9) lgkmcnt(2)
ds_read_b128 a[208:211],v249 offset:9728
M a[96:99],a[204:207],a[224:227],a[96:99]
s_waitcnt lgkmcnt(2)
M a[100:103],a[204:207],a[236:239],a[100:103]
buffer_load_dwordx4 a[212:215],v250,s[20:23],s48 offen offset:0 sc1
M a[100:103],a[192:195],a[224:227],a[100:103]
M a[100:103],a[248:251],a[228:231],a[100:103]
M a[104:107],a[248:251],a[224:227],a[104:107]
ds_read_b128 v[224:227],v248 offset:10240
M a[104:107],a[192:195],a[236:239],a[104:107]
s_waitcnt lgkmcnt(2)
ds_read_b128 a[220:223],v249 offset:10240
M a[104:107],a[204:207],a[216:219],a[104:107]
s_waitcnt lgkmcnt(2)
M a[108:111],a[204:207],a[208:211],a[108:111]
M a[108:111],a[192:195],a[216:219],a[108:111]
M a[108:111],a[248:251],a[236:239],a[108:111]
M a[112:115],a[248:251],a[216:219],a[112:115]
ds_read_b128 a[228:231],v249 offset:10752
M a[112:115],a[192:195],a[208:211],a[112:115]
s_waitcnt lgkmcnt(2)
ds_read_b128 a[224:227],v248 offset:10752
M a[112:115],a[204:207],v[224:227],a[112:115]
s_waitcnt lgkmcnt(2)
M a[116:119],a[204:207],a[220:223],a[116:119]
M a[116:119],a[192:195],v[224:227],a[116:119]
ds_read_b128 a[236:239],v248 offset:17408
M a[116:119],a[248:251],a[208:211],a[116:119]
ds_read_b128 a[216:219],v249 offset:17408
M a[120:123],a[248:251],v[224:227],a[120:123]
ds_read_b128 a[208:211],v248 offset:17920
M a[120:123],a[192:195],a[220:223],a[120:123]
s_waitcnt lgkmcnt(4)
ds_read_b128 v[224:227],v249 offset:17920
M a[120:123],a[204:207],a[228:231],a[120:123]
s_waitcnt lgkmcnt(4)
M a[124:127],a[204:207],a[224:227],a[124:127]
buffer_load_dwordx4 a[204:207],v250,s[20:23],s48 offen offset:1024 sc1
M a[124:127],a[192:195],a[228:231],a[124:127]
M a[124:127],a[248:251],a[220:223],a[124:127]
s_waitcnt vmcnt(10) lgkmcnt(3)
buffer_load_dwordx4 a[224:227],v250,s[20:23],s48 offen offset:2048 sc1
M v[0:3],a[252:255],a[236:239],v[0:3]
s_waitcnt vmcnt(10) lgkmcnt(2)
s_add_u32 s47,s77,21504
ds_read_b128 a[228:231],v248 offset:18432
M v[0:3],a[196:199],a[216:219],v[0:3]
s_waitcnt vmcnt(9) lgkmcnt(2)
ds_read_b128 a[220:223],v249 offset:18432
M v[0:3],a[240:243],a[208:211],v[0:3]
s_waitcnt lgkmcnt(2)
M v[4:7],a[240:243],v[224:227],v[4:7]
buffer_load_dwordx4 a[192:195],v250,s[20:23],s47 offen offset:0 sc1
M v[4:7],a[196:199],a[208:211],v[4:7]
M v[4:7],a[252:255],a[216:219],v[4:7]
M v[8:11],a[252:255],a[208:211],v[8:11]
ds_read_b128 a[248:251],v248 offset:18944
M v[8:11],a[196:199],v[224:227],v[8:11]
s_waitcnt lgkmcnt(2)
ds_read_b128 a[236:239],v249 offset:18944
M v[8:11],a[240:243],a[228:231],v[8:11]
s_waitcnt lgkmcnt(2)
M v[12:15],a[240:243],a[220:223],v[12:15]
M v[12:15],a[196:199],a[228:231],v[12:15]
M v[12:15],a[252:255],v[224:227],v[12:15]
M v[16:19],a[252:255],a[228:231],v[16:19]
ds_read_b128 a[216:219],v249 offset:19456
M v[16:19],a[196:199],a[220:223],v[16:19]
s_waitcnt lgkmcnt(2)
ds_read_b128 a[208:211],v248 offset:19456
M v[16:19],a[240:243],a[248:251],v[16:19]
s_waitcnt lgkmcnt(2)
M v[20:23],a[240:243],a[236:239],v[20:23]
M v[20:23],a[196:199],a[248:251],v[20:23]
ds_read_b128 v[224:227],v248 offset:26112
M v[20:23],a[252:255],a[220:223],v[20:23]
ds_read_b128 a[228:231],v249 offset:26112
M v[24:27],a[252:255],a[248:251],v[24:27]
ds_read_b128 a[220:223],v248 offset:26624
M v[24:27],a[196:199],a[236:239],v[24:27]
s_waitcnt lgkmcnt(4)
ds_read_b128 a[248:251],v249 offset:26624
M v[24:27],a[240:243],a[216:219],v[24:27]
s_waitcnt lgkmcnt(4)
M v[28:31],a[240:243],a[208:211],v[28:31]
buffer_load_dwordx4 a[208:211],v250,s[20:23],s47 offen offset:1024 sc1
M v[28:31],a[196:199],a[216:219],v[28:31]
M v[28:31],a[252:255],a[236:239],v[28:31]
s_waitcnt vmcnt(10) lgkmcnt(3)
buffer_load_dwordx4 a[240:243],v250,s[20:23],s47 offen offset:2048 sc1
M v[96:99],v[216:219],v[224:227],v[96:99]
s_waitcnt vmcnt(10) lgkmcnt(2)
s_add_u32 s48,s77,24576
ds_read_b128 a[216:219],v248 offset:27136
M v[96:99],a[232:235],a[228:231],v[96:99]
s_waitcnt vmcnt(9) lgkmcnt(2)
ds_read_b128 a[236:239],v249 offset:27136
M v[96:99],v[228:231],a[220:223],v[96:99]
s_waitcnt lgkmcnt(2)
M v[100:103],v[228:231],a[248:251],v[100:103]
buffer_load_dwordx4 a[196:199],v250,s[20:23],s48 offen offset:0 sc1
M v[100:103],a[232:235],a[220:223],v[100:103]
M v[100:103],v[216:219],a[228:231],v[100:103]
v_accvgpr_read_b32 v238,a0
v_accvgpr_read_b32 v232,a96
M v[104:107],v[216:219],a[220:223],v[104:107]
ds_read_b128 a[252:255],v248 offset:27648
v_add_f32 v234,v238,v232
M v[104:107],a[232:235],a[248:251],v[104:107]
s_waitcnt lgkmcnt(2)
ds_read_b128 v[224:227],v249 offset:27648
v_sub_f32 v238,v238,v232
M v[104:107],v[228:231],a[216:219],v[104:107]
s_waitcnt lgkmcnt(2)
v_add_f32 v232,v0,v96
v_sub_f32 v96,v0,v96
M v[108:111],v[228:231],a[236:239],v[108:111]
v_add_f32 v0,v234,v232
v_fmac_f32 v234,4.0,v232
M v[108:111],a[232:235],a[216:219],v[108:111]
v_fma_f32 v232,2.0,v96,v238
v_fma_f32 v96,s40,v96,v238
M v[108:111],v[216:219],a[248:251],v[108:111]
v_accvgpr_read_b32 v238,a1
v_accvgpr_read_b32 v237,a97
M v[112:115],v[216:219],a[216:219],v[112:115]
ds_read_b128 a[228:231],v249 offset:28160
v_add_f32 v236,v238,v237
M v[112:115],a[232:235],a[236:239],v[112:115]
s_waitcnt lgkmcnt(2)
ds_read_b128 a[220:223],v248 offset:28160
v_sub_f32 v238,v238,v237
M v[112:115],v[228:231],a[252:255],v[112:115]
s_waitcnt lgkmcnt(2)
v_add_f32 v237,v1,v97
v_sub_f32 v97,v1,v97
M v[116:119],v[228:231],v[224:227],v[116:119]
v_add_f32 v1,v236,v237
v_fmac_f32 v236,4.0,v237
M v[116:119],a[232:235],a[252:255],v[116:119]
ds_read_b128 a[248:251],v248 offset:0
v_fma_f32 v237,2.0,v97,v238
M v[116:119],v[216:219],a[236:239],v[116:119]
ds_read_b128 a[216:219],v249 offset:0
v_fma_f32 v97,s40,v97,v238
M v[120:123],v[216:219],a[252:255],v[120:123]
ds_read_b128 a[236:239],v248 offset:512
v_cvt_pk_bf16_f32 v232,v232,v237
M v[120:123],a[232:235],v[224:227],v[120:123]
s_waitcnt lgkmcnt(4)
ds_read_b128 a[252:255],v249 offset:512
v_cvt_pk_bf16_f32 v234,v234,v236
M v[120:123],v[228:231],a[228:231],v[120:123]
s_waitcnt lgkmcnt(4)
v_accvgpr_read_b32 v238,a2
v_accvgpr_read_b32 v233,a98
M v[124:127],v[228:231],a[220:223],v[124:127]
buffer_load_dwordx4 a[220:223],v250,s[20:23],s48 offen offset:1024 sc1
M v[124:127],a[232:235],a[228:231],v[124:127]
v_add_f32 v235,v238,v233
v_sub_f32 v238,v238,v233
M v[124:127],v[216:219],v[224:227],v[124:127]
s_waitcnt vmcnt(10) lgkmcnt(3)
v_add_f32 v233,v2,v98
v_sub_f32 v98,v2,v98
M a[32:35],a[200:203],a[248:251],a[32:35]
s_waitcnt vmcnt(9) lgkmcnt(2)
ds_read_b128 v[228:231],v248 offset:1024
v_add_f32 v2,v235,v233
M a[32:35],a[244:247],a[216:219],a[32:35]
s_waitcnt vmcnt(8) lgkmcnt(2)
ds_read_b128 a[228:231],v249 offset:1024
v_fmac_f32 v235,4.0,v233
M a[32:35],v[220:223],a[236:239],a[32:35]
s_waitcnt lgkmcnt(2)
v_fma_f32 v233,2.0,v98,v238
v_fma_f32 v98,s40,v98,v238
M a[36:39],v[220:223],a[252:255],a[36:39]
v_accvgpr_read_b32 v238,a3
v_accvgpr_read_b32 v237,a99
M a[36:39],a[244:247],a[236:239],a[36:39]
v_add_f32 v236,v238,v237
v_sub_f32 v238,v238,v237
M a[36:39],a[200:203],a[216:219],a[36:39]
v_add_f32 v237,v3,v99
v_sub_f32 v99,v3,v99
M a[40:43],a[200:203],a[236:239],a[40:43]
ds_read_b128 a[96:99],v248 offset:1536
v_add_f32 v3,v236,v237
M a[40:43],a[244:247],a[252:255],a[40:43]
s_waitcnt lgkmcnt(2)
ds_read_b128 a[232:235],v249 offset:1536
v_fmac_f32 v236,4.0,v237
M a[40:43],v[220:223],v[228:231],a[40:43]
s_waitcnt lgkmcnt(2)
v_fma_f32 v237,2.0,v99,v238
v_fma_f32 v99,s40,v99,v238
M a[44:47],v[220:223],a[228:231],a[44:47]
v_cvt_pk_bf16_f32 v233,v233,v237
v_cvt_pk_bf16_f32 v235,v235,v236
M a[44:47],a[244:247],v[228:231],a[44:47]
ds_write2st64_b64 v254,v[232:233],v[234:235] offset0:68 offset1:72
M a[44:47],a[200:203],a[252:255],a[44:47]
v_accvgpr_read_b32 v238,a4
v_accvgpr_read_b32 v232,a100
M a[48:51],a[200:203],v[228:231],a[48:51]
ds_read_b128 v[216:219],v249 offset:2048
v_add_f32 v234,v238,v232
M a[48:51],a[244:247],a[228:231],a[48:51]
s_waitcnt lgkmcnt(3)
ds_read_b128 v[224:227],v248 offset:2048
v_sub_f32 v238,v238,v232
M a[48:51],v[220:223],a[96:99],a[48:51]
s_waitcnt lgkmcnt(3)
v_add_f32 v232,v4,v100
v_sub_f32 v100,v4,v100
M a[52:55],v[220:223],a[232:235],a[52:55]
v_add_f32 v4,v234,v232
v_fmac_f32 v234,4.0,v232
M a[52:55],a[244:247],a[96:99],a[52:55]
v_fma_f32 v232,2.0,v100,v238
v_fma_f32 v100,s40,v100,v238
M a[52:55],a[200:203],a[228:231],a[52:55]
v_accvgpr_read_b32 v238,a5
v_accvgpr_read_b32 v237,a101
M a[56:59],a[200:203],a[96:99],a[56:59]
v_add_f32 v236,v238,v237
v_sub_f32 v238,v238,v237
M a[56:59],a[244:247],a[232:235],a[56:59]
s_waitcnt lgkmcnt(1)
v_add_f32 v237,v5,v101
v_sub_f32 v101,v5,v101
M a[56:59],v[220:223],v[216:219],a[56:59]
s_waitcnt lgkmcnt(0)
v_add_f32 v5,v236,v237
v_fmac_f32 v236,4.0,v237
M a[60:63],v[220:223],v[224:227],a[60:63]
buffer_load_dwordx4 v[220:223],v250,s[20:23],s48 offen offset:2048 sc1
M a[60:63],a[244:247],v[216:219],a[60:63]
s_add_u32 s47,s77,30720
v_fma_f32 v237,2.0,v101,v238
v_fma_f32 v101,s40,v101,v238
M a[60:63],a[200:203],a[232:235],a[60:63]
s_waitcnt vmcnt(8)
buffer_load_dwordx4 a[244:247],v250,s[20:23],s47 offen offset:0 sc1
M a[64:67],a[212:215],a[248:251],a[64:67]
s_waitcnt vmcnt(8)
v_cvt_pk_bf16_f32 v232,v232,v237
v_cvt_pk_bf16_f32 v234,v234,v236
M a[64:67],a[204:207],a[216:219],a[64:67]
s_waitcnt vmcnt(7)
v_accvgpr_read_b32 v238,a6
v_accvgpr_read_b32 v233,a102
M a[64:67],a[224:227],a[236:239],a[64:67]
v_add_f32 v235,v238,v233
v_sub_f32 v238,v238,v233
M a[68:71],a[224:227],a[252:255],a[68:71]
buffer_load_dwordx4 a[200:203],v250,s[20:23],s47 offen offset:1024 sc1
M a[68:71],a[204:207],a[236:239],a[68:71]
v_add_f32 v233,v6,v102
v_sub_f32 v102,v6,v102
M a[68:71],a[212:215],a[216:219],a[68:71]
v_add_f32 v6,v235,v233
v_fmac_f32 v235,4.0,v233
M a[72:75],a[212:215],a[236:239],a[72:75]
v_fma_f32 v233,2.0,v102,v238
v_fma_f32 v102,s40,v102,v238
M a[72:75],a[204:207],a[252:255],a[72:75]
buffer_load_dwordx4 a[248:251],v250,s[20:23],s47 offen offset:2048 sc1
M a[72:75],a[224:227],v[228:231],a[72:75]
s_add_u32 s48,s77,33792
v_accvgpr_read_b32 v238,a7
v_accvgpr_read_b32 v237,a103
M a[76:79],a[224:227],a[228:231],a[76:79]
v_add_f32 v236,v238,v237
v_sub_f32 v238,v238,v237
M a[76:79],a[204:207],v[228:231],a[76:79]
v_add_f32 v237,v7,v103
v_sub_f32 v103,v7,v103
M a[76:79],a[212:215],a[252:255],a[76:79]
buffer_load_dwordx4 a[216:219],v250,s[20:23],s48 offen offset:0 sc1
M a[80:83],a[212:215],v[228:231],a[80:83]
v_add_f32 v7,v236,v237
v_fmac_f32 v236,4.0,v237
M a[80:83],a[204:207],a[228:231],a[80:83]
v_fma_f32 v237,2.0,v103,v238
v_fma_f32 v103,s40,v103,v238
M a[80:83],a[224:227],a[96:99],a[80:83]
v_cvt_pk_bf16_f32 v233,v233,v237
v_cvt_pk_bf16_f32 v235,v235,v236
M a[84:87],a[224:227],a[232:235],a[84:87]
buffer_load_dwordx4 a[236:239],v250,s[20:23],s48 offen offset:1024 sc1
M a[84:87],a[204:207],a[96:99],a[84:87]
ds_read_b128 a[252:255],v248 offset:8704
ds_write2st64_b64 v254,v[232:233],v[234:235] offset0:76 offset1:80
M a[84:87],a[212:215],a[228:231],a[84:87]
ds_read_b128 v[228:231],v249 offset:8704
v_accvgpr_read_b32 v238,a8
M a[88:91],a[212:215],a[96:99],a[88:91]
buffer_load_dwordx4 a[100:103],v250,s[20:23],s48 offen offset:2048 sc1
M a[88:91],a[204:207],a[232:235],a[88:91]
ds_read_b128 a[96:99],v248 offset:9216
ds_read_b128 a[228:231],v249 offset:9216
M a[88:91],a[224:227],v[216:219],a[88:91]
v_accvgpr_read_b32 v232,a104
v_add_f32 v234,v238,v232
M a[92:95],a[224:227],v[224:227],a[92:95]
v_sub_f32 v238,v238,v232
v_add_f32 v232,v8,v104
M a[92:95],a[204:207],v[216:219],a[92:95]
v_sub_f32 v104,v8,v104
M a[92:95],a[212:215],a[232:235],a[92:95]
s_waitcnt vmcnt(11) lgkmcnt(3)
s_barrier
ds_read_b128 a[0:3],v250 offset:34816
M a[128:131],a[192:195],a[252:255],a[128:131]
s_waitcnt vmcnt(10) lgkmcnt(3)
ds_read_b128 a[4:7],v250 offset:38912
ds_read_b128 a[224:227],v248 offset:9728
M a[128:131],a[208:211],v[228:231],a[128:131]
s_waitcnt vmcnt(9) lgkmcnt(4)
ds_read_b128 v[224:227],v249 offset:9728
v_add_f32 v8,v234,v232
M a[128:131],a[240:243],a[96:99],a[128:131]
s_waitcnt lgkmcnt(4)
v_fmac_f32 v234,4.0,v232
v_fma_f32 v232,2.0,v104,v238
M a[132:135],a[240:243],a[228:231],a[132:135]
v_fma_f32 v104,s40,v104,v238
v_accvgpr_read_b32 v238,a9
M a[132:135],a[208:211],a[96:99],a[132:135]
v_accvgpr_read_b32 v237,a105
v_add_f32 v236,v238,v237
M a[132:135],a[192:195],v[228:231],a[132:135]
v_sub_f32 v238,v238,v237
v_add_f32 v237,v9,v105
M a[136:139],a[192:195],a[96:99],a[136:139]
s_add_u32 s34,s32,6291456
ds_read_b128 a[204:207],v248 offset:10240
v_sub_f32 v105,v9,v105
M a[136:139],a[208:211],a[228:231],a[136:139]
s_waitcnt lgkmcnt(2)
ds_read_b128 v[216:219],v249 offset:10240
v_add_f32 v9,v236,v237
M a[136:139],a[240:243],a[224:227],a[136:139]
s_waitcnt lgkmcnt(2)
buffer_store_dwordx4 a[0:3],v253,s[24:27],s34 offen offset:384 nt
M a[140:143],a[240:243],v[224:227],a[140:143]
v_fmac_f32 v236,4.0,v237
v_fma_f32 v237,2.0,v105,v238
M a[140:143],a[208:211],a[224:227],a[140:143]
v_fma_f32 v105,s40,v105,v238
v_cvt_pk_bf16_f32 v232,v232,v237
M a[140:143],a[192:195],a[228:231],a[140:143]
v_cvt_pk_bf16_f32 v234,v234,v236
v_accvgpr_read_b32 v238,a10
M a[144:147],a[192:195],a[224:227],a[144:147]
ds_read_b128 a[212:215],v249 offset:10752
v_accvgpr_read_b32 v233,a106
M a[144:147],a[208:211],v[224:227],a[144:147]
s_waitcnt lgkmcnt(2)
ds_read_b128 a[232:235],v248 offset:10752
v_add_f32 v235,v238,v233
M a[144:147],a[240:243],a[204:207],a[144:147]
s_waitcnt lgkmcnt(2)
v_sub_f32 v238,v238,v233
v_add_f32 v233,v10,v106
M a[148:151],a[240:243],v[216:219],a[148:151]
s_add_u32 s47,s77,39936
v_sub_f32 v106,v10,v106
v_add_f32 v10,v235,v233
M a[148:151],a[208:211],a[204:207],a[148:151]
v_fmac_f32 v235,4.0,v233
v_fma_f32 v233,2.0,v106,v238
M a[148:151],a[192:195],v[224:227],a[148:151]
v_fma_f32 v106,s40,v106,v238
v_accvgpr_read_b32 v238,a11
M a[152:155],a[192:195],a[204:207],a[152:155]
v_accvgpr_read_b32 v237,a107
v_add_f32 v236,v238,v237
M a[152:155],a[208:211],v[216:219],a[152:155]
s_waitcnt lgkmcnt(1)
v_sub_f32 v238,v238,v237
v_add_f32 v237,v11,v107
M a[152:155],a[240:243],a[212:215],a[152:155]
s_waitcnt lgkmcnt(0)
v_sub_f32 v107,v11,v107
v_add_f32 v11,v236,v237
M a[156:159],a[240:243],a[232:235],a[156:159]
buffer_load_dwordx4 a[104:107],v250,s[20:23],s47 offen offset:0 sc1
M a[156:159],a[208:211],a[212:215],a[156:159]
v_fmac_f32 v236,4.0,v237
v_fma_f32 v237,2.0,v107,v238
M a[156:159],a[192:195],v[216:219],a[156:159]
s_waitcnt vmcnt(10)
buffer_load_dwordx4 a[240:243],v250,s[20:23],s47 offen offset:1024 sc1
M a[160:163],a[196:199],a[252:255],a[160:163]
s_waitcnt vmcnt(10)
v_fma_f32 v107,s40,v107,v238
v_cvt_pk_bf16_f32 v233,v233,v237
M a[160:163],a[220:223],v[228:231],a[160:163]
s_waitcnt vmcnt(9)
v_cvt_pk_bf16_f32 v235,v235,v236
M a[160:163],v[220:223],a[96:99],a[160:163]
ds_write2st64_b64 v254,v[232:233],v[234:235] offset0:85 offset1:89
M a[164:167],v[220:223],a[228:231],a[164:167]
buffer_load_dwordx4 a[208:211],v250,s[20:23],s47 offen offset:2048 sc1
M a[164:167],a[220:223],a[96:99],a[164:167]
s_add_u32 s48,s77,43008
s_add_u32 s34,s32,6488064
v_accvgpr_read_b32 v204,a12
M a[164:167],a[196:199],v[228:231],a[164:167]
v_accvgpr_read_b32 v208,a108
v_accvgpr_read_b32 v205,a13
M a[168:171],a[196:199],a[96:99],a[168:171]
v_accvgpr_read_b32 v209,a109
v_accvgpr_read_b32 v206,a14
M a[168:171],a[220:223],a[228:231],a[168:171]
buffer_load_dwordx4 a[192:195],v250,s[20:23],s48 offen offset:0 sc1
M a[168:171],v[220:223],a[224:227],a[168:171]
v_accvgpr_read_b32 v210,a110
v_accvgpr_read_b32 v207,a15
v_accvgpr_read_b32 v211,a111
v_pk_add_f32 v[212:213],v[204:205],v[208:209]
v_pk_add_f32 v[214:215],v[206:207],v[210:211]
v_pk_add_f32 v[204:205],v[204:205],v[208:209] neg_lo:[0,1] neg_hi:[0,1]
v_pk_add_f32 v[206:207],v[206:207],v[210:211] neg_lo:[0,1] neg_hi:[0,1]
v_pk_add_f32 v[208:209],v[12:13],v[108:109]
v_pk_add_f32 v[210:211],v[14:15],v[110:111]
v_pk_add_f32 v[108:109],v[12:13],v[108:109] neg_lo:[0,1] neg_hi:[0,1]
v_pk_add_f32 v[110:111],v[14:15],v[110:111] neg_lo:[0,1] neg_hi:[0,1]
v_pk_add_f32 v[12:13],v[212:213],v[208:209]
v_pk_add_f32 v[14:15],v[214:215],v[210:211]
v_pk_fma_f32 v[212:213],v[208:209],4.0,v[212:213] op_sel_hi:[1,0,1]
v_pk_fma_f32 v[214:215],v[210:211],4.0,v[214:215] op_sel_hi:[1,0,1]
v_pk_fma_f32 v[208:209],v[108:109],2.0,v[204:205] op_sel_hi:[1,0,1]
v_pk_fma_f32 v[210:211],v[110:111],2.0,v[206:207] op_sel_hi:[1,0,1]
v_pk_fma_f32 v[108:109],v[108:109],s[40:41],v[204:205] op_sel_hi:[1,0,1]
v_pk_fma_f32 v[110:111],v[110:111],s[40:41],v[206:207] op_sel_hi:[1,0,1]
M a[172:175],v[220:223],v[224:227],a[172:175]
buffer_load_dwordx4 a[252:255],v250,s[20:23],s48 offen offset:1024 sc1
M a[172:175],a[220:223],a[224:227],a[172:175]
v_cvt_pk_bf16_f32 v208,v208,v209
v_cvt_pk_bf16_f32 v209,v210,v211
M a[172:175],a[196:199],a[228:231],a[172:175]
buffer_load_dwordx4 v[228:231],v250,s[20:23],s48 offen offset:2048 sc1
M a[176:179],a[196:199],a[224:227],a[176:179]
s_add_u32 s46,s72,0
v_cvt_pk_bf16_f32 v212,v212,v213
v_cvt_pk_bf16_f32 v213,v214,v215
M a[176:179],a[220:223],v[224:227],a[176:179]
ds_write2st64_b64 v254,v[208:209],v[212:213] offset0:93 offset1:97
M a[176:179],v[220:223],a[204:207],a[176:179]
v_accvgpr_read_b32 v238,a16
v_accvgpr_read_b32 v232,a112
M a[180:183],v[220:223],v[216:219],a[180:183]
buffer_load_dwordx4 a[96:99],v250,s[20:23],s46 offen offset:0 sc1
M a[180:183],a[220:223],a[204:207],a[180:183]
ds_read_b128 a[228:231],v248 offset:17408
v_add_f32 v234,v238,v232
M a[180:183],a[196:199],v[224:227],a[180:183]
ds_read_b128 a[224:227],v249 offset:17408
v_sub_f32 v238,v238,v232
M a[184:187],a[196:199],a[204:207],a[184:187]
ds_read_b128 v[224:227],v248 offset:17920
v_add_f32 v232,v16,v112
M a[184:187],a[220:223],v[216:219],a[184:187]
buffer_load_dwordx4 a[108:111],v250,s[20:23],s46 offen offset:1024 sc1
M a[184:187],v[220:223],a[212:215],a[184:187]
ds_read_b128 a[204:207],v249 offset:17920
v_sub_f32 v112,v16,v112
M a[188:191],v[220:223],a[232:235],a[188:191]
s_waitcnt lgkmcnt(4)
s_barrier
ds_read_b128 a[8:11],v250 offset:43520
M a[188:191],a[220:223],a[212:215],a[188:191]
ds_read_b128 a[12:15],v250 offset:47616
v_add_f32 v16,v234,v232
M a[188:191],a[196:199],v[216:219],a[188:191]
s_waitcnt vmcnt(14) lgkmcnt(5)
buffer_store_dwordx4 a[4:7],v253,s[24:27],s34 offen offset:384 nt
M v[32:35],a[244:247],a[228:231],v[32:35]
s_waitcnt vmcnt(14) lgkmcnt(4)
ds_read_b128 a[232:235],v248 offset:18432
v_fmac_f32 v234,4.0,v232
M v[32:35],a[200:203],a[224:227],v[32:35]
s_waitcnt vmcnt(13) lgkmcnt(4)
ds_read_b128 v[220:223],v249 offset:18432
v_fma_f32 v232,2.0,v112,v238
M v[32:35],a[248:251],v[224:227],v[32:35]
s_waitcnt lgkmcnt(3)
s_add_u32 s34,s32,6684672
buffer_store_dwordx4 a[8:11],v253,s[24:27],s34 offen offset:384 nt
M v[36:39],a[248:251],a[204:207],v[36:39]
v_fma_f32 v112,s40,v112,v238
v_accvgpr_read_b32 v238,a17
M v[36:39],a[200:203],v[224:227],v[36:39]
v_accvgpr_read_b32 v237,a113
v_add_f32 v236,v238,v237
M v[36:39],a[244:247],a[224:227],v[36:39]
v_sub_f32 v238,v238,v237
v_add_f32 v237,v17,v113
M v[40:43],a[244:247],v[224:227],v[40:43]
ds_read_b128 a[212:215],v248 offset:18944
v_sub_f32 v113,v17,v113
M v[40:43],a[200:203],a[204:207],v[40:43]
s_waitcnt lgkmcnt(2)
ds_read_b128 a[220:223],v249 offset:18944
v_add_f32 v17,v236,v237
M v[40:43],a[248:251],a[232:235],v[40:43]
s_waitcnt lgkmcnt(2)
v_fmac_f32 v236,4.0,v237
v_fma_f32 v237,2.0,v113,v238
M v[44:47],a[248:251],v[220:223],v[44:47]
v_fma_f32 v113,s40,v113,v238
v_cvt_pk_bf16_f32 v232,v232,v237
M v[44:47],a[200:203],a[232:235],v[44:47]
v_cvt_pk_bf16_f32 v234,v234,v236
v_accvgpr_read_b32 v238,a18
M v[44:47],a[244:247],a[204:207],v[44:47]
v_accvgpr_read_b32 v233,a114
v_add_f32 v235,v238,v233
M v[48:51],a[244:247],a[232:235],v[48:51]
ds_read_b128 a[196:199],v249 offset:19456
v_sub_f32 v238,v238,v233
M v[48:51],a[200:203],v[220:223],v[48:51]
s_waitcnt lgkmcnt(2)
ds_read_b128 v[216:219],v248 offset:19456
v_add_f32 v233,v18,v114
M v[48:51],a[248:251],a[212:215],v[48:51]
s_waitcnt lgkmcnt(2)
v_sub_f32 v114,v18,v114
v_add_f32 v18,v235,v233
M v[52:55],a[248:251],a[220:223],v[52:55]
v_fmac_f32 v235,4.0,v233
v_fma_f32 v233,2.0,v114,v238
M v[52:55],a[200:203],a[212:215],v[52:55]
v_fma_f32 v114,s40,v114,v238
v_accvgpr_read_b32 v238,a19
M v[52:55],a[244:247],v[220:223],v[52:55]
v_accvgpr_read_b32 v237,a115
v_add_f32 v236,v238,v237
M v[56:59],a[244:247],a[212:215],v[56:59]
v_sub_f32 v238,v238,v237
v_add_f32 v237,v19,v115
M v[56:59],a[200:203],a[220:223],v[56:59]
s_waitcnt lgkmcnt(1)
v_sub_f32 v115,v19,v115
v_add_f32 v19,v236,v237
M v[56:59],a[248:251],a[196:199],v[56:59]
s_waitcnt lgkmcnt(0)
v_fmac_f32 v236,4.0,v237
v_fma_f32 v237,2.0,v115,v238
M v[60:63],a[248:251],v[216:219],v[60:63]
buffer_load_dwordx4 a[112:115],v250,s[20:23],s46 offen offset:2048 sc1
M v[60:63],a[200:203],a[196:199],v[60:63]
s_add_u32 s46,s73,0
v_fma_f32 v115,s40,v115,v238
v_cvt_pk_bf16_f32 v233,v233,v237
M v[60:63],a[244:247],a[220:223],v[60:63]
s_waitcnt vmcnt(14)
buffer_load_dwordx4 a[248:251],v250,s[20:23],s46 offen offset:0 sc1
M v[64:67],a[216:219],a[228:231],v[64:67]
s_waitcnt vmcnt(14)
s_add_u32 s34,s32,6881280
v_cvt_pk_bf16_f32 v235,v235,v236
M v[64:67],a[236:239],a[224:227],v[64:67]
s_waitcnt vmcnt(13)
ds_write2st64_b64 v254,v[232:233],v[234:235] offset0:68 offset1:72
M v[64:67],a[100:103],v[224:227],v[64:67]
v_accvgpr_read_b32 v238,a20
v_accvgpr_read_b32 v232,a116
M v[68:71],a[100:103],a[204:207],v[68:71]
buffer_load_dwordx4 a[200:203],v250,s[20:23],s46 offen offset:1024 sc1
M v[68:71],a[236:239],v[224:227],v[68:71]
v_add_f32 v234,v238,v232
v_sub_f32 v238,v238,v232
M v[68:71],a[216:219],a[224:227],v[68:71]
v_add_f32 v232,v20,v116
v_sub_f32 v116,v20,v116
M v[72:75],a[216:219],v[224:227],v[72:75]
v_add_f32 v20,v234,v232
v_fmac_f32 v234,4.0,v232
M v[72:75],a[236:239],a[204:207],v[72:75]
buffer_load_dwordx4 a[244:247],v250,s[20:23],s46 offen offset:2048 sc1
M v[72:75],a[100:103],a[232:235],v[72:75]
s_add_u32 s46,s74,0
v_fma_f32 v232,2.0,v116,v238
v_fma_f32 v116,s40,v116,v238
M v[76:79],a[100:103],v[220:223],v[76:79]
v_accvgpr_read_b32 v238,a21
v_accvgpr_read_b32 v237,a117
M v[76:79],a[236:239],a[232:235],v[76:79]
v_add_f32 v236,v238,v237
v_sub_f32 v238,v238,v237
M v[76:79],a[216:219],a[204:207],v[76:79]
buffer_store_dwordx4 a[12:15],v253,s[24:27],s34 offen offset:384 nt
M v[80:83],a[216:219],a[232:235],v[80:83]
v_add_f32 v237,v21,v117
v_sub_f32 v117,v21,v117
M v[80:83],a[236:239],v[220:223],v[80:83]
v_add_f32 v21,v236,v237
v_fmac_f32 v236,4.0,v237
M v[80:83],a[100:103],a[212:215],v[80:83]
buffer_load_dwordx4 a[228:231],v250,s[20:23],s46 offen offset:0 sc1
M v[84:87],a[100:103],a[220:223],v[84:87]
v_fma_f32 v237,2.0,v117,v238
v_fma_f32 v117,s40,v117,v238
M v[84:87],a[236:239],a[212:215],v[84:87]
ds_read_b128 a[204:207],v248 offset:26112
v_cvt_pk_bf16_f32 v232,v232,v237
M v[84:87],a[216:219],v[220:223],v[84:87]
ds_read_b128 a[232:235],v249 offset:26112
v_cvt_pk_bf16_f32 v234,v234,v236
M v[88:91],a[216:219],a[212:215],v[88:91]
buffer_load_dwordx4 a[224:227],v250,s[20:23],s46 offen offset:1024 sc1
M v[88:91],a[236:239],a[220:223],v[88:91]
ds_read_b128 v[220:223],v248 offset:26624
ds_read_b128 a[212:215],v249 offset:26624
M v[88:91],a[100:103],a[196:199],v[88:91]
v_accvgpr_read_b32 v238,a22
v_accvgpr_read_b32 v233,a118
M v[92:95],a[100:103],v[216:219],v[92:95]
v_add_f32 v235,v238,v233
v_sub_f32 v238,v238,v233
M v[92:95],a[236:239],a[196:199],v[92:95]
buffer_load_dwordx4 v[224:227],v250,s[20:23],s46 offen offset:2048 sc1
M v[92:95],a[216:219],a[220:223],v[92:95]
s_waitcnt vmcnt(17) lgkmcnt(3)
v_add_f32 v233,v22,v118
v_sub_f32 v118,v22,v118
M v[128:131],a[104:107],a[204:207],v[128:131]
s_waitcnt vmcnt(16) lgkmcnt(2)
ds_read_b128 a[100:103],v248 offset:27136
v_add_f32 v22,v235,v233
M v[128:131],a[240:243],a[232:235],v[128:131]
s_waitcnt vmcnt(15) lgkmcnt(2)
ds_read_b128 v[216:219],v249 offset:27136
v_fmac_f32 v235,4.0,v233
M v[128:131],a[208:211],v[220:223],v[128:131]
s_waitcnt lgkmcnt(2)
v_fma_f32 v233,2.0,v118,v238
v_fma_f32 v118,s40,v118,v238
M v[132:135],a[208:211],a[212:215],v[132:135]
v_accvgpr_read_b32 v238,a23
v_accvgpr_read_b32 v237,a119
M v[132:135],a[240:243],v[220:223],v[132:135]
v_add_f32 v236,v238,v237
v_sub_f32 v238,v238,v237
M v[132:135],a[104:107],a[232:235],v[132:135]
v_add_f32 v237,v23,v119
v_sub_f32 v119,v23,v119
M v[136:139],a[104:107],v[220:223],v[136:139]
ds_read_b128 a[116:119],v248 offset:27648
v_add_f32 v23,v236,v237
M v[136:139],a[240:243],a[212:215],v[136:139]
s_waitcnt lgkmcnt(2)
ds_read_b128 a[196:199],v249 offset:27648
v_fmac_f32 v236,4.0,v237
M v[136:139],a[208:211],a[100:103],v[136:139]
s_waitcnt lgkmcnt(2)
s_add_u32 s46,s75,0
v_fma_f32 v237,2.0,v119,v238
v_fma_f32 v119,s40,v119,v238
M v[140:143],a[208:211],v[216:219],v[140:143]
v_cvt_pk_bf16_f32 v233,v233,v237
v_cvt_pk_bf16_f32 v235,v235,v236
M v[140:143],a[240:243],a[100:103],v[140:143]
ds_write2st64_b64 v254,v[232:233],v[234:235] offset0:76 offset1:80
M v[140:143],a[104:107],a[212:215],v[140:143]
v_accvgpr_read_b32 v238,a24
v_accvgpr_read_b32 v232,a120
M v[144:147],a[104:107],a[100:103],v[144:147]
ds_read_b128 a[236:239],v249 offset:28160
v_add_f32 v234,v238,v232
M v[144:147],a[240:243],v[216:219],v[144:147]
s_waitcnt lgkmcnt(3)
ds_read_b128 a[216:219],v248 offset:28160
v_sub_f32 v238,v238,v232
M v[144:147],a[208:211],a[116:119],v[144:147]
s_waitcnt lgkmcnt(3)
buffer_load_dwordx4 a[220:223],v250,s[20:23],s46 offen offset:0 sc1
M v[148:151],a[208:211],a[196:199],v[148:151]
v_add_f32 v232,v24,v120
v_sub_f32 v120,v24,v120
M v[148:151],a[240:243],a[116:119],v[148:151]
s_waitcnt lgkmcnt(2)
s_barrier
ds_read_b128 a[16:19],v250 offset:34816
M v[148:151],a[104:107],v[216:219],v[148:151]
ds_read_b128 a[20:23],v250 offset:38912
v_add_f32 v24,v234,v232
M v[152:155],a[104:107],a[116:119],v[152:155]
v_fmac_f32 v234,4.0,v232
v_fma_f32 v232,2.0,v120,v238
M v[152:155],a[240:243],a[196:199],v[152:155]
s_waitcnt lgkmcnt(3)
v_fma_f32 v120,s40,v120,v238
v_accvgpr_read_b32 v238,a25
M v[152:155],a[208:211],a[236:239],v[152:155]
s_waitcnt lgkmcnt(2)
v_accvgpr_read_b32 v237,a121
v_add_f32 v236,v238,v237
M v[156:159],a[208:211],a[216:219],v[156:159]
s_add_u32 s34,s32,7077888
buffer_load_dwordx4 a[208:211],v250,s[20:23],s46 offen offset:1024 sc1
M v[156:159],a[240:243],a[236:239],v[156:159]
v_sub_f32 v238,v238,v237
v_add_f32 v237,v25,v121
M v[156:159],a[104:107],a[196:199],v[156:159]
s_waitcnt vmcnt(16) lgkmcnt(1)
buffer_store_dwordx4 a[16:19],v253,s[24:27],s34 offen offset:384 nt
M v[160:163],a[192:195],a[204:207],v[160:163]
s_waitcnt vmcnt(16)
s_add_u32 s34,s32,7274496
v_sub_f32 v121,v25,v121
v_add_f32 v25,v236,v237
M v[160:163],a[252:255],a[232:235],v[160:163]
s_waitcnt vmcnt(15)
v_fmac_f32 v236,4.0,v237
v_fma_f32 v237,2.0,v121,v238
M v[160:163],v[228:231],v[220:223],v[160:163]
s_waitcnt lgkmcnt(0)
buffer_store_dwordx4 a[20:23],v253,s[24:27],s34 offen offset:384 nt
M v[164:167],v[228:231],a[212:215],v[164:167]
v_fma_f32 v121,s40,v121,v238
v_cvt_pk_bf16_f32 v232,v232,v237
M v[164:167],a[252:255],v[220:223],v[164:167]
v_cvt_pk_bf16_f32 v234,v234,v236
v_accvgpr_read_b32 v238,a26
M v[164:167],a[192:195],a[232:235],v[164:167]
buffer_load_dwordx4 a[240:243],v250,s[20:23],s46 offen offset:2048 sc1
M v[168:171],a[192:195],v[220:223],v[168:171]
s_add_u32 s46,s76,0
v_accvgpr_read_b32 v233,a122
v_add_f32 v235,v238,v233
M v[168:171],a[252:255],a[212:215],v[168:171]
v_sub_f32 v238,v238,v233
v_add_f32 v233,v26,v122
M v[168:171],v[228:231],a[100:103],v[168:171]
s_barrier
v_sub_f32 v122,v26,v122
M v[172:175],v[228:231],v[216:219],v[172:175]
buffer_load_dwordx4 a[104:107],v250,s[20:23],s46 offen offset:0 sc1
M v[172:175],a[252:255],a[100:103],v[172:175]
v_add_f32 v26,v235,v233
v_fmac_f32 v235,4.0,v233
M v[172:175],a[192:195],a[212:215],v[172:175]
v_fma_f32 v233,2.0,v122,v238
v_fma_f32 v122,s40,v122,v238
M v[176:179],a[192:195],a[100:103],v[176:179]
v_accvgpr_read_b32 v238,a27
v_accvgpr_read_b32 v237,a123
M v[176:179],a[252:255],v[216:219],v[176:179]
buffer_load_dwordx4 a[204:207],v250,s[20:23],s46 offen offset:1024 sc1
M v[176:179],v[228:231],a[116:119],v[176:179]
v_add_f32 v236,v238,v237
v_sub_f32 v238,v238,v237
M v[180:183],v[228:231],a[196:199],v[180:183]
v_add_f32 v237,v27,v123
v_sub_f32 v123,v27,v123
M v[180:183],a[252:255],a[116:119],v[180:183]
ds_read_b128 a[100:103],v248 offset:52224
v_add_f32 v27,v236,v237
M v[180:183],a[192:195],v[216:219],v[180:183]
buffer_load_dwordx4 a[232:235],v250,s[20:23],s46 offen offset:2048 sc1
M v[184:187],a[192:195],a[116:119],v[184:187]
s_add_u32 s46,s77,0
ds_read_b128 a[120:123],v249 offset:52224
ds_read_b128 a[116:119],v248 offset:52736
M v[184:187],a[252:255],a[196:199],v[184:187]
ds_read_b128 a[212:215],v249 offset:52736
v_fmac_f32 v236,4.0,v237
M v[184:187],v[228:231],a[236:239],v[184:187]
v_fma_f32 v237,2.0,v123,v238
v_fma_f32 v123,s40,v123,v238
M v[188:191],v[228:231],a[216:219],v[188:191]
buffer_load_dwordx4 v[220:223],v250,s[20:23],s46 offen offset:0 sc1
M v[188:191],a[252:255],a[236:239],v[188:191]
v_cvt_pk_bf16_f32 v233,v233,v237
v_cvt_pk_bf16_f32 v235,v235,v236
M v[188:191],a[192:195],a[196:199],v[188:191]
s_waitcnt vmcnt(20) lgkmcnt(3)
ds_write2st64_b64 v254,v[232:233],v[234:235] offset0:85 offset1:89
M v[0:3],a[96:99],a[100:103],v[0:3]
s_waitcnt vmcnt(19) lgkmcnt(3)
ds_read_b128 a[100:103],v248 offset:53248
v_accvgpr_read_b32 v204,a28
M v[0:3],a[108:111],a[120:123],v[0:3]
s_waitcnt vmcnt(16) lgkmcnt(3)
buffer_load_dwordx4 v[216:219],v250,s[20:23],s46 offen offset:1024 sc1
M v[0:3],a[112:115],a[116:119],v[0:3]
s_waitcnt lgkmcnt(2)
ds_read_b128 a[192:195],v249 offset:53248
v_accvgpr_read_b32 v208,a124
M v[4:7],a[112:115],a[212:215],v[4:7]
v_accvgpr_read_b32 v205,a29
v_accvgpr_read_b32 v209,a125
M v[4:7],a[108:111],a[116:119],v[4:7]
v_accvgpr_read_b32 v206,a30
v_accvgpr_read_b32 v210,a126
v_accvgpr_read_b32 v207,a31
v_accvgpr_read_b32 v211,a127
v_pk_add_f32 v[212:213],v[204:205],v[208:209]
v_pk_add_f32 v[214:215],v[206:207],v[210:211]
v_pk_add_f32 v[204:205],v[204:205],v[208:209] neg_lo:[0,1] neg_hi:[0,1]
v_pk_add_f32 v[206:207],v[206:207],v[210:211] neg_lo:[0,1] neg_hi:[0,1]
v_pk_add_f32 v[208:209],v[28:29],v[124:125]
v_pk_add_f32 v[210:211],v[30:31],v[126:127]
v_pk_add_f32 v[124:125],v[28:29],v[124:125] neg_lo:[0,1] neg_hi:[0,1]
v_pk_add_f32 v[126:127],v[30:31],v[126:127] neg_lo:[0,1] neg_hi:[0,1]
v_pk_add_f32 v[28:29],v[212:213],v[208:209]
v_pk_add_f32 v[30:31],v[214:215],v[210:211]
v_pk_fma_f32 v[212:213],v[208:209],4.0,v[212:213] op_sel_hi:[1,0,1]
v_pk_fma_f32 v[214:215],v[210:211],4.0,v[214:215] op_sel_hi:[1,0,1]
v_pk_fma_f32 v[208:209],v[124:125],2.0,v[204:205] op_sel_hi:[1,0,1]
v_pk_fma_f32 v[210:211],v[126:127],2.0,v[206:207] op_sel_hi:[1,0,1]
v_pk_fma_f32 v[124:125],v[124:125],s[40:41],v[204:205] op_sel_hi:[1,0,1]
v_pk_fma_f32 v[126:127],v[126:127],s[40:41],v[206:207] op_sel_hi:[1,0,1]
M v[4:7],a[96:99],a[120:123],v[4:7]
buffer_load_dwordx4 a[216:219],v250,s[20:23],s46 offen offset:2048 sc1
M v[8:11],a[96:99],a[116:119],v[8:11]
s_add_u32 s46,s72,46080
ds_read_b128 a[120:123],v248 offset:53760
v_cvt_pk_bf16_f32 v208,v208,v209
M v[8:11],a[108:111],a[212:215],v[8:11]
s_waitcnt lgkmcnt(2)
buffer_load_dwordx4 v[228:231],v250,s[20:23],s46 offen offset:0 sc1
M v[8:11],a[112:115],a[100:103],v[8:11]
s_waitcnt lgkmcnt(1)
ds_read_b128 a[124:127],v249 offset:53760
v_cvt_pk_bf16_f32 v209,v210,v211
M v[12:15],a[112:115],a[192:195],v[12:15]
v_cvt_pk_bf16_f32 v212,v212,v213
v_cvt_pk_bf16_f32 v213,v214,v215
M v[12:15],a[108:111],a[100:103],v[12:15]
ds_write2st64_b64 v254,v[208:209],v[212:213] offset0:93 offset1:97
M v[12:15],a[96:99],a[212:215],v[12:15]
buffer_load_dwordx4 a[236:239],v250,s[20:23],s46 offen offset:1024 sc1
M v[16:19],a[96:99],a[100:103],v[16:19]
ds_read_b128 a[116:119],v249 offset:54272
v_accvgpr_read_b32 v238,a32
M v[16:19],a[108:111],a[192:195],v[16:19]
s_waitcnt lgkmcnt(3)
ds_read_b128 a[100:103],v248 offset:54272
v_add_u32 v248,0x15400,v248
M v[16:19],a[112:115],a[120:123],v[16:19]
s_waitcnt lgkmcnt(3)
v_add_u32 v249,0x15400,v249
v_accvgpr_read_b32 v232,a128
M v[20:23],a[112:115],a[124:127],v[20:23]
buffer_load_dwordx4 a[252:255],v250,s[20:23],s46 offen offset:2048 sc1
M v[20:23],a[108:111],a[120:123],v[20:23]
s_add_u32 s47,s72,49152
ds_read_b128 a[196:199],v248 offset:0
v_add_f32 v234,v238,v232
M v[20:23],a[96:99],a[192:195],v[20:23]
ds_read_b128 a[212:215],v249 offset:0
v_sub_f32 v238,v238,v232
M v[24:27],a[96:99],a[120:123],v[24:27]
ds_read_b128 a[120:123],v248 offset:512
v_add_f32 v232,v32,v128
M v[24:27],a[108:111],a[124:127],v[24:27]
s_waitcnt lgkmcnt(4)
ds_read_b128 a[192:195],v249 offset:512
v_sub_f32 v128,v32,v128
M v[24:27],a[112:115],a[116:119],v[24:27]
s_waitcnt lgkmcnt(4)
s_barrier
ds_read_b128 a[24:27],v250 offset:43520
M v[28:31],a[112:115],a[100:103],v[28:31]
ds_read_b128 a[28:31],v250 offset:47616
v_add_f32 v32,v234,v232
M v[28:31],a[108:111],a[116:119],v[28:31]
buffer_load_dwordx4 a[100:103],v250,s[20:23],s47 offen offset:0 sc1
M v[28:31],a[96:99],a[124:127],v[28:31]
s_waitcnt vmcnt(21) lgkmcnt(5)
v_fmac_f32 v234,4.0,v232
v_fma_f32 v232,2.0,v128,v238
M v[0:3],a[248:251],a[196:199],v[0:3]
s_waitcnt vmcnt(20) lgkmcnt(4)
buffer_load_dwordx4 a[112:115],v250,s[20:23],s47 offen offset:1024 sc1
M v[0:3],a[200:203],a[212:215],v[0:3]
s_waitcnt vmcnt(20) lgkmcnt(3)
s_add_u32 s34,s32,7471104
ds_read_b128 a[116:119],v248 offset:1024
ds_read_b128 a[96:99],v249 offset:1024
M v[0:3],a[244:247],a[120:123],v[0:3]
s_waitcnt lgkmcnt(4)
v_fma_f32 v128,s40,v128,v238
v_accvgpr_read_b32 v238,a33
M v[4:7],a[244:247],a[192:195],v[4:7]
v_accvgpr_read_b32 v237,a129
v_add_f32 v236,v238,v237
M v[4:7],a[200:203],a[120:123],v[4:7]
buffer_load_dwordx4 a[108:111],v250,s[20:23],s47 offen offset:2048 sc1
M v[4:7],a[248:251],a[212:215],v[4:7]
v_sub_f32 v238,v238,v237
v_add_f32 v237,v33,v129
M v[8:11],a[248:251],a[120:123],v[8:11]
ds_read_b128 a[124:127],v248 offset:1536
v_sub_f32 v129,v33,v129
M v[8:11],a[200:203],a[192:195],v[8:11]
s_waitcnt lgkmcnt(2)
ds_read_b128 a[120:123],v249 offset:1536
v_add_f32 v33,v236,v237
M v[8:11],a[244:247],a[116:119],v[8:11]
s_waitcnt lgkmcnt(2)
buffer_store_dwordx4 a[24:27],v253,s[24:27],s34 offen offset:384 nt
M v[12:15],a[244:247],a[96:99],v[12:15]
s_add_u32 s34,s32,7667712
v_fmac_f32 v236,4.0,v237
v_fma_f32 v237,2.0,v129,v238
M v[12:15],a[200:203],a[116:119],v[12:15]
v_fma_f32 v129,s40,v129,v238
v_cvt_pk_bf16_f32 v232,v232,v237
M v[12:15],a[248:251],a[192:195],v[12:15]
buffer_store_dwordx4 a[28:31],v253,s[24:27],s34 offen offset:384 nt
M v[16:19],a[248:251],a[116:119],v[16:19]
ds_read_b128 a[116:119],v249 offset:2048
v_cvt_pk_bf16_f32 v234,v234,v236
M v[16:19],a[200:203],a[96:99],v[16:19]
s_waitcnt lgkmcnt(2)
ds_read_b128 a[196:199],v248 offset:2048
v_accvgpr_read_b32 v238,a34
M v[16:19],a[244:247],a[124:127],v[16:19]
s_waitcnt lgkmcnt(2)
v_accvgpr_read_b32 v233,a130
v_add_f32 v235,v238,v233
M v[20:23],a[244:247],a[120:123],v[20:23]
s_add_u32 s46,s73,46080
v_sub_f32 v238,v238,v233
v_add_f32 v233,v34,v130
M v[20:23],a[200:203],a[124:127],v[20:23]
ds_read_b128 a[212:215],v248 offset:17408
v_sub_f32 v130,v34,v130
M v[20:23],a[248:251],a[96:99],v[20:23]
ds_read_b128 a[96:99],v249 offset:17408
v_add_f32 v34,v235,v233
M v[24:27],a[248:251],a[124:127],v[24:27]
ds_read_b128 a[124:127],v248 offset:17920
v_fmac_f32 v235,4.0,v233
M v[24:27],a[200:203],a[120:123],v[24:27]
s_waitcnt lgkmcnt(4)
ds_read_b128 a[192:195],v249 offset:17920
v_fma_f32 v233,2.0,v130,v238
M v[24:27],a[244:247],a[116:119],v[24:27]
s_waitcnt lgkmcnt(4)
v_fma_f32 v130,s40,v130,v238
v_accvgpr_read_b32 v238,a35
M v[28:31],a[244:247],a[196:199],v[28:31]
v_accvgpr_read_b32 v237,a131
v_add_f32 v236,v238,v237
M v[28:31],a[200:203],a[116:119],v[28:31]
buffer_load_dwordx4 a[128:131],v250,s[20:23],s46 offen offset:0 sc1
M v[28:31],a[248:251],a[120:123],v[28:31]
s_waitcnt vmcnt(22) lgkmcnt(3)
v_sub_f32 v238,v238,v237
v_add_f32 v237,v35,v131
M v[0:3],a[228:231],a[212:215],v[0:3]
s_waitcnt vmcnt(21) lgkmcnt(2)
buffer_load_dwordx4 a[196:199],v250,s[20:23],s46 offen offset:1024 sc1
M v[0:3],a[224:227],a[96:99],v[0:3]
s_waitcnt vmcnt(21) lgkmcnt(1)
ds_read_b128 a[120:123],v248 offset:18432
ds_read_b128 a[244:247],v249 offset:18432
M v[0:3],v[224:227],a[124:127],v[0:3]
s_waitcnt lgkmcnt(2)
v_sub_f32 v131,v35,v131
v_add_f32 v35,v236,v237
M v[4:7],v[224:227],a[192:195],v[4:7]
v_fmac_f32 v236,4.0,v237
v_fma_f32 v237,2.0,v131,v238
M v[4:7],a[224:227],a[124:127],v[4:7]
buffer_load_dwordx4 a[116:119],v250,s[20:23],s46 offen offset:2048 sc1
M v[4:7],a[228:231],a[96:99],v[4:7]
v_fma_f32 v131,s40,v131,v238
v_cvt_pk_bf16_f32 v233,v233,v237
M v[8:11],a[228:231],a[124:127],v[8:11]
ds_read_b128 a[96:99],v248 offset:18944
v_cvt_pk_bf16_f32 v235,v235,v236
M v[8:11],a[224:227],a[192:195],v[8:11]
s_waitcnt lgkmcnt(2)
ds_read_b128 a[124:127],v249 offset:18944
ds_write2st64_b64 v254,v[232:233],v[234:235] offset0:34 offset1:38
M v[8:11],v[224:227],a[120:123],v[8:11]
s_waitcnt lgkmcnt(3)
v_accvgpr_read_b32 v204,a36
v_accvgpr_read_b32 v208,a132
M v[12:15],v[224:227],a[244:247],v[12:15]
v_accvgpr_read_b32 v205,a37
v_accvgpr_read_b32 v209,a133
M v[12:15],a[224:227],a[120:123],v[12:15]
v_accvgpr_read_b32 v206,a38
v_accvgpr_read_b32 v210,a134
v_accvgpr_read_b32 v207,a39
v_accvgpr_read_b32 v211,a135
v_pk_add_f32 v[212:213],v[204:205],v[208:209]
v_pk_add_f32 v[214:215],v[206:207],v[210:211]
v_pk_add_f32 v[204:205],v[204:205],v[208:209] neg_lo:[0,1] neg_hi:[0,1]
v_pk_add_f32 v[206:207],v[206:207],v[210:211] neg_lo:[0,1] neg_hi:[0,1]
v_pk_add_f32 v[208:209],v[36:37],v[132:133]
v_pk_add_f32 v[210:211],v[38:39],v[134:135]
v_pk_add_f32 v[132:133],v[36:37],v[132:133] neg_lo:[0,1] neg_hi:[0,1]
v_pk_add_f32 v[134:135],v[38:39],v[134:135] neg_lo:[0,1] neg_hi:[0,1]
v_pk_add_f32 v[36:37],v[212:213],v[208:209]
v_pk_add_f32 v[38:39],v[214:215],v[210:211]
v_pk_fma_f32 v[212:213],v[208:209],4.0,v[212:213] op_sel_hi:[1,0,1]
v_pk_fma_f32 v[214:215],v[210:211],4.0,v[214:215] op_sel_hi:[1,0,1]
v_pk_fma_f32 v[208:209],v[132:133],2.0,v[204:205] op_sel_hi:[1,0,1]
v_pk_fma_f32 v[210:211],v[134:135],2.0,v[206:207] op_sel_hi:[1,0,1]
v_pk_fma_f32 v[132:133],v[132:133],s[40:41],v[204:205] op_sel_hi:[1,0,1]
v_pk_fma_f32 v[134:135],v[134:135],s[40:41],v[206:207] op_sel_hi:[1,0,1]
M v[12:15],a[228:231],a[192:195],v[12:15]
v_cvt_pk_bf16_f32 v208,v208,v209
v_cvt_pk_bf16_f32 v209,v210,v211
M v[16:19],a[228:231],a[120:123],v[16:19]
s_add_u32 s47,s73,49152
ds_read_b128 a[132:135],v249 offset:19456
v_cvt_pk_bf16_f32 v212,v212,v213
M v[16:19],a[224:227],a[244:247],v[16:19]
s_waitcnt lgkmcnt(3)
ds_read_b128 a[120:123],v248 offset:19456
v_cvt_pk_bf16_f32 v213,v214,v215
M v[16:19],v[224:227],a[96:99],v[16:19]
s_waitcnt lgkmcnt(3)
ds_write2st64_b64 v254,v[208:209],v[212:213] offset0:42 offset1:46
M v[20:23],v[224:227],a[124:127],v[20:23]
v_accvgpr_read_b32 v204,a40
v_accvgpr_read_b32 v208,a136
M v[20:23],a[224:227],a[96:99],v[20:23]
ds_read_b128 a[200:203],v248 offset:34816
v_accvgpr_read_b32 v205,a41
M v[20:23],a[228:231],a[244:247],v[20:23]
ds_read_b128 a[248:251],v249 offset:34816
v_accvgpr_read_b32 v209,a137
M v[24:27],a[228:231],a[96:99],v[24:27]
buffer_load_dwordx4 a[96:99],v250,s[20:23],s47 offen offset:0 sc1
M v[24:27],a[224:227],a[124:127],v[24:27]
s_waitcnt lgkmcnt(4)
ds_read_b128 a[212:215],v248 offset:35328
ds_read_b128 a[192:195],v249 offset:35328
M v[24:27],v[224:227],a[132:135],v[24:27]
s_waitcnt lgkmcnt(5)
v_accvgpr_read_b32 v206,a42
v_accvgpr_read_b32 v210,a138
v_accvgpr_read_b32 v207,a43
v_accvgpr_read_b32 v211,a139
v_pk_add_f32 v[212:213],v[204:205],v[208:209]
v_pk_add_f32 v[214:215],v[206:207],v[210:211]
v_pk_add_f32 v[204:205],v[204:205],v[208:209] neg_lo:[0,1] neg_hi:[0,1]
v_pk_add_f32 v[206:207],v[206:207],v[210:211] neg_lo:[0,1] neg_hi:[0,1]
v_pk_add_f32 v[208:209],v[40:41],v[136:137]
v_pk_add_f32 v[210:211],v[42:43],v[138:139]
v_pk_add_f32 v[136:137],v[40:41],v[136:137] neg_lo:[0,1] neg_hi:[0,1]
v_pk_add_f32 v[138:139],v[42:43],v[138:139] neg_lo:[0,1] neg_hi:[0,1]
v_pk_add_f32 v[40:41],v[212:213],v[208:209]
v_pk_add_f32 v[42:43],v[214:215],v[210:211]
v_pk_fma_f32 v[212:213],v[208:209],4.0,v[212:213] op_sel_hi:[1,0,1]
v_pk_fma_f32 v[214:215],v[210:211],4.0,v[214:215] op_sel_hi:[1,0,1]
v_pk_fma_f32 v[208:209],v[136:137],2.0,v[204:205] op_sel_hi:[1,0,1]
v_pk_fma_f32 v[210:211],v[138:139],2.0,v[206:207] op_sel_hi:[1,0,1]
v_pk_fma_f32 v[136:137],v[136:137],s[40:41],v[204:205] op_sel_hi:[1,0,1]
v_pk_fma_f32 v[138:139],v[138:139],s[40:41],v[206:207] op_sel_hi:[1,0,1]
M v[28:31],v[224:227],a[120:123],v[28:31]
buffer_load_dwordx4 a[136:139],v250,s[20:23],s47 offen offset:1024 sc1
M v[28:31],a[224:227],a[132:135],v[28:31]
v_cvt_pk_bf16_f32 v208,v208,v209
v_cvt_pk_bf16_f32 v209,v210,v211
M v[28:31],a[228:231],a[124:127],v[28:31]
s_waitcnt vmcnt(23) lgkmcnt(3)
buffer_load_dwordx4 a[120:123],v250,s[20:23],s47 offen offset:2048 sc1
M v[0:3],a[220:223],a[200:203],v[0:3]
s_waitcnt vmcnt(23) lgkmcnt(2)
ds_read_b128 a[132:135],v248 offset:35840
v_cvt_pk_bf16_f32 v212,v212,v213
M v[0:3],a[208:211],a[248:251],v[0:3]
s_waitcnt vmcnt(20) lgkmcnt(2)
ds_read_b128 a[124:127],v249 offset:35840
v_cvt_pk_bf16_f32 v213,v214,v215
M v[0:3],a[240:243],a[212:215],v[0:3]
s_waitcnt lgkmcnt(2)
ds_write2st64_b64 v254,v[208:209],v[212:213] offset0:51 offset1:55
M v[4:7],a[240:243],a[192:195],v[4:7]
v_accvgpr_read_b32 v204,a44
v_accvgpr_read_b32 v208,a140
M v[4:7],a[208:211],a[212:215],v[4:7]
v_accvgpr_read_b32 v205,a45
v_accvgpr_read_b32 v209,a141
M v[4:7],a[220:223],a[248:251],v[4:7]
v_accvgpr_read_b32 v206,a46
v_accvgpr_read_b32 v210,a142
v_accvgpr_read_b32 v207,a47
v_accvgpr_read_b32 v211,a143
v_pk_add_f32 v[212:213],v[204:205],v[208:209]
v_pk_add_f32 v[214:215],v[206:207],v[210:211]
v_pk_add_f32 v[204:205],v[204:205],v[208:209] neg_lo:[0,1] neg_hi:[0,1]
v_pk_add_f32 v[206:207],v[206:207],v[210:211] neg_lo:[0,1] neg_hi:[0,1]
v_pk_add_f32 v[208:209],v[44:45],v[140:141]
v_pk_add_f32 v[210:211],v[46:47],v[142:143]
v_pk_add_f32 v[140:141],v[44:45],v[140:141] neg_lo:[0,1] neg_hi:[0,1]
v_pk_add_f32 v[142:143],v[46:47],v[142:143] neg_lo:[0,1] neg_hi:[0,1]
v_pk_add_f32 v[44:45],v[212:213],v[208:209]
v_pk_add_f32 v[46:47],v[214:215],v[210:211]
v_pk_fma_f32 v[212:213],v[208:209],4.0,v[212:213] op_sel_hi:[1,0,1]
v_pk_fma_f32 v[214:215],v[210:211],4.0,v[214:215] op_sel_hi:[1,0,1]
v_pk_fma_f32 v[208:209],v[140:141],2.0,v[204:205] op_sel_hi:[1,0,1]
v_pk_fma_f32 v[210:211],v[142:143],2.0,v[206:207] op_sel_hi:[1,0,1]
v_pk_fma_f32 v[140:141],v[140:141],s[40:41],v[204:205] op_sel_hi:[1,0,1]
v_pk_fma_f32 v[142:143],v[142:143],s[40:41],v[206:207] op_sel_hi:[1,0,1]
M v[8:11],a[220:223],a[212:215],v[8:11]
ds_read_b128 a[244:247],v248 offset:36352
v_cvt_pk_bf16_f32 v208,v208,v209
M v[8:11],a[208:211],a[192:195],v[8:11]
s_waitcnt lgkmcnt(3)
ds_read_b128 v[224:227],v249 offset:36352
v_cvt_pk_bf16_f32 v209,v210,v211
M v[8:11],a[240:243],a[132:135],v[8:11]
s_waitcnt lgkmcnt(3)
v_cvt_pk_bf16_f32 v212,v212,v213
v_cvt_pk_bf16_f32 v213,v214,v215
M v[12:15],a[240:243],a[124:127],v[12:15]
ds_write2st64_b64 v254,v[208:209],v[212:213] offset0:59 offset1:63
M v[12:15],a[208:211],a[132:135],v[12:15]
v_accvgpr_read_b32 v238,a48
v_accvgpr_read_b32 v232,a144
M v[12:15],a[220:223],a[192:195],v[12:15]
v_add_f32 v234,v238,v232
v_sub_f32 v238,v238,v232
M v[16:19],a[220:223],a[132:135],v[16:19]
s_add_u32 s46,s74,46080
ds_read_b128 a[140:143],v249 offset:36864
v_add_f32 v232,v48,v144
M v[16:19],a[208:211],a[124:127],v[16:19]
s_waitcnt lgkmcnt(3)
ds_read_b128 a[132:135],v248 offset:36864
v_sub_f32 v144,v48,v144
M v[16:19],a[240:243],a[244:247],v[16:19]
s_waitcnt lgkmcnt(2)
s_barrier
ds_read_b128 a[32:35],v250 offset:17408
M v[20:23],a[240:243],v[224:227],v[20:23]
ds_read_b128 a[36:39],v250 offset:21504
ds_read_b128 a[40:43],v250 offset:26112
M v[20:23],a[208:211],a[244:247],v[20:23]
ds_read_b128 a[44:47],v250 offset:30208
ds_read_b128 a[224:227],v248 offset:52224
M v[20:23],a[220:223],a[124:127],v[20:23]
ds_read_b128 a[124:127],v249 offset:52224
v_add_f32 v48,v234,v232
M v[24:27],a[220:223],a[244:247],v[24:27]
buffer_load_dwordx4 a[228:231],v250,s[20:23],s46 offen offset:0 sc1
M v[24:27],a[208:211],v[224:227],v[24:27]
s_waitcnt lgkmcnt(7)
s_add_u32 s34,s32,6291456
ds_read_b128 a[200:203],v248 offset:52736
ds_read_b128 a[212:215],v249 offset:52736
M v[24:27],a[240:243],a[140:143],v[24:27]
s_waitcnt lgkmcnt(7)
buffer_store_dwordx4 a[32:35],v253,s[24:27],s34 offen offset:512 nt
M v[28:31],a[240:243],a[132:135],v[28:31]
s_add_u32 s34,s32,6488064
v_fmac_f32 v234,4.0,v232
v_fma_f32 v232,2.0,v144,v238
M v[28:31],a[208:211],a[140:143],v[28:31]
v_fma_f32 v144,s40,v144,v238
v_accvgpr_read_b32 v238,a49
M v[28:31],a[220:223],v[224:227],v[28:31]
s_waitcnt vmcnt(21) lgkmcnt(3)
buffer_store_dwordx4 a[36:39],v253,s[24:27],s34 offen offset:512 nt
M v[0:3],a[104:107],a[224:227],v[0:3]
s_waitcnt vmcnt(21) lgkmcnt(2)
s_add_u32 s34,s32,6684672
ds_read_b128 a[132:135],v248 offset:53248
v_accvgpr_read_b32 v237,a145
M v[0:3],a[204:207],a[124:127],v[0:3]
s_waitcnt vmcnt(20) lgkmcnt(2)
ds_read_b128 a[140:143],v249 offset:53248
v_add_f32 v236,v238,v237
M v[0:3],a[232:235],a[200:203],v[0:3]
s_waitcnt lgkmcnt(2)
buffer_store_dwordx4 a[40:43],v253,s[24:27],s34 offen offset:512 nt
M v[4:7],a[232:235],a[212:215],v[4:7]
v_sub_f32 v238,v238,v237
v_add_f32 v237,v49,v145
M v[4:7],a[204:207],a[200:203],v[4:7]
v_sub_f32 v145,v49,v145
v_add_f32 v49,v236,v237
M v[4:7],a[104:107],a[124:127],v[4:7]
buffer_load_dwordx4 a[248:251],v250,s[20:23],s46 offen offset:1024 sc1
M v[8:11],a[104:107],a[200:203],v[8:11]
ds_read_b128 a[124:127],v248 offset:53760
v_fmac_f32 v236,4.0,v237
M v[8:11],a[204:207],a[212:215],v[8:11]
s_waitcnt lgkmcnt(2)
ds_read_b128 a[244:247],v249 offset:53760
v_fma_f32 v237,2.0,v145,v238
M v[8:11],a[232:235],a[132:135],v[8:11]
s_waitcnt lgkmcnt(2)
v_fma_f32 v145,s40,v145,v238
v_cvt_pk_bf16_f32 v232,v232,v237
M v[12:15],a[232:235],a[140:143],v[12:15]
s_add_u32 s34,s32,6881280
buffer_load_dwordx4 a[192:195],v250,s[20:23],s46 offen offset:2048 sc1
M v[12:15],a[204:207],a[132:135],v[12:15]
v_cvt_pk_bf16_f32 v234,v234,v236
v_accvgpr_read_b32 v238,a50
M v[12:15],a[104:107],a[212:215],v[12:15]
v_accvgpr_read_b32 v233,a146
v_add_f32 v235,v238,v233
M v[16:19],a[104:107],a[132:135],v[16:19]
s_add_u32 s47,s74,49152
ds_read_b128 a[132:135],v249 offset:54272
v_sub_f32 v238,v238,v233
M v[16:19],a[204:207],a[140:143],v[16:19]
s_waitcnt lgkmcnt(2)
ds_read_b128 a[240:243],v248 offset:54272
v_add_u32 v248,0xffff9a00,v248
M v[16:19],a[232:235],a[124:127],v[16:19]
s_waitcnt lgkmcnt(2)
buffer_store_dwordx4 a[44:47],v253,s[24:27],s34 offen offset:512 nt
M v[20:23],a[232:235],a[244:247],v[20:23]
v_add_u32 v249,0xffff9a00,v249
v_add_f32 v233,v50,v146
M v[20:23],a[204:207],a[124:127],v[20:23]
ds_read_b128 a[208:211],v248 offset:8704
v_sub_f32 v146,v50,v146
M v[20:23],a[104:107],a[140:143],v[20:23]
ds_read_b128 a[140:143],v249 offset:8704
v_add_f32 v50,v235,v233
M v[24:27],a[104:107],a[124:127],v[24:27]
buffer_load_dwordx4 a[124:127],v250,s[20:23],s47 offen offset:0 sc1
M v[24:27],a[204:207],a[244:247],v[24:27]
s_waitcnt lgkmcnt(3)
ds_read_b128 a[220:223],v248 offset:9216
ds_read_b128 a[224:227],v249 offset:9216
M v[24:27],a[232:235],a[132:135],v[24:27]
s_waitcnt lgkmcnt(4)
buffer_load_dwordx4 v[224:227],v250,s[20:23],s47 offen offset:1024 sc1
M v[28:31],a[232:235],a[240:243],v[28:31]
v_fmac_f32 v235,4.0,v233
v_fma_f32 v233,2.0,v146,v238
M v[28:31],a[204:207],a[132:135],v[28:31]
v_fma_f32 v146,s40,v146,v238
v_accvgpr_read_b32 v238,a51
M v[28:31],a[104:107],a[244:247],v[28:31]
s_waitcnt vmcnt(25) lgkmcnt(3)
v_accvgpr_read_b32 v237,a147
v_add_f32 v236,v238,v237
M v[0:3],v[220:223],a[208:211],v[0:3]
s_waitcnt vmcnt(24) lgkmcnt(2)
buffer_load_dwordx4 a[200:203],v250,s[20:23],s47 offen offset:2048 sc1
M v[0:3],v[216:219],a[140:143],v[0:3]
s_waitcnt vmcnt(24) lgkmcnt(1)
ds_read_b128 a[132:135],v248 offset:9728
ds_read_b128 a[104:107],v249 offset:9728
M v[0:3],a[216:219],a[220:223],v[0:3]
s_waitcnt lgkmcnt(2)
v_sub_f32 v238,v238,v237
v_add_f32 v237,v51,v147
M v[4:7],a[216:219],a[224:227],v[4:7]
v_sub_f32 v147,v51,v147
v_add_f32 v51,v236,v237
M v[4:7],v[216:219],a[220:223],v[4:7]
v_fmac_f32 v236,4.0,v237
v_fma_f32 v237,2.0,v147,v238
M v[4:7],v[220:223],a[140:143],v[4:7]
v_fma_f32 v147,s40,v147,v238
v_cvt_pk_bf16_f32 v233,v233,v237
M v[8:11],v[220:223],a[220:223],v[8:11]
ds_read_b128 a[144:147],v248 offset:10240
v_cvt_pk_bf16_f32 v235,v235,v236
M v[8:11],v[216:219],a[224:227],v[8:11]
s_waitcnt lgkmcnt(2)
ds_read_b128 a[140:143],v249 offset:10240
ds_write2st64_b64 v254,v[232:233],v[234:235] offset0:17 offset1:21
M v[8:11],a[216:219],a[132:135],v[8:11]
s_waitcnt lgkmcnt(3)
v_accvgpr_read_b32 v204,a52
v_accvgpr_read_b32 v208,a148
M v[12:15],a[216:219],a[104:107],v[12:15]
v_accvgpr_read_b32 v205,a53
v_accvgpr_read_b32 v209,a149
M v[12:15],v[216:219],a[132:135],v[12:15]
v_accvgpr_read_b32 v206,a54
v_accvgpr_read_b32 v210,a150
v_accvgpr_read_b32 v207,a55
v_accvgpr_read_b32 v211,a151
v_pk_add_f32 v[212:213],v[204:205],v[208:209]
v_pk_add_f32 v[214:215],v[206:207],v[210:211]
v_pk_add_f32 v[204:205],v[204:205],v[208:209] neg_lo:[0,1] neg_hi:[0,1]
v_pk_add_f32 v[206:207],v[206:207],v[210:211] neg_lo:[0,1] neg_hi:[0,1]
v_pk_add_f32 v[208:209],v[52:53],v[148:149]
v_pk_add_f32 v[210:211],v[54:55],v[150:151]
v_pk_add_f32 v[148:149],v[52:53],v[148:149] neg_lo:[0,1] neg_hi:[0,1]
v_pk_add_f32 v[150:151],v[54:55],v[150:151] neg_lo:[0,1] neg_hi:[0,1]
v_pk_add_f32 v[52:53],v[212:213],v[208:209]
v_pk_add_f32 v[54:55],v[214:215],v[210:211]
v_pk_fma_f32 v[212:213],v[208:209],4.0,v[212:213] op_sel_hi:[1,0,1]
v_pk_fma_f32 v[214:215],v[210:211],4.0,v[214:215] op_sel_hi:[1,0,1]
v_pk_fma_f32 v[208:209],v[148:149],2.0,v[204:205] op_sel_hi:[1,0,1]
v_pk_fma_f32 v[210:211],v[150:151],2.0,v[206:207] op_sel_hi:[1,0,1]
v_pk_fma_f32 v[148:149],v[148:149],s[40:41],v[204:205] op_sel_hi:[1,0,1]
v_pk_fma_f32 v[150:151],v[150:151],s[40:41],v[206:207] op_sel_hi:[1,0,1]
M v[12:15],v[220:223],a[224:227],v[12:15]
v_cvt_pk_bf16_f32 v208,v208,v209
v_cvt_pk_bf16_f32 v209,v210,v211
M v[16:19],v[220:223],a[132:135],v[16:19]
s_add_u32 s46,s75,46080
ds_read_b128 a[132:135],v249 offset:10752
v_cvt_pk_bf16_f32 v212,v212,v213
M v[16:19],v[216:219],a[104:107],v[16:19]
s_waitcnt lgkmcnt(3)
ds_read_b128 a[212:215],v248 offset:10752
v_cvt_pk_bf16_f32 v213,v214,v215
M v[16:19],a[216:219],a[144:147],v[16:19]
s_waitcnt lgkmcnt(3)
ds_write2st64_b64 v254,v[208:209],v[212:213] offset0:25 offset1:29
M v[20:23],a[216:219],a[140:143],v[20:23]
v_accvgpr_read_b32 v204,a56
v_accvgpr_read_b32 v208,a152
M v[20:23],v[216:219],a[144:147],v[20:23]
ds_read_b128 a[148:151],v248 offset:0
v_accvgpr_read_b32 v205,a57
M v[20:23],v[220:223],a[104:107],v[20:23]
ds_read_b128 a[104:107],v249 offset:0
v_accvgpr_read_b32 v209,a153
M v[24:27],v[220:223],a[144:147],v[24:27]
buffer_load_dwordx4 a[144:147],v250,s[20:23],s46 offen offset:0 sc1
M v[24:27],v[216:219],a[140:143],v[24:27]
s_waitcnt lgkmcnt(4)
ds_read_b128 a[232:235],v248 offset:512
ds_read_b128 a[204:207],v249 offset:512
M v[24:27],a[216:219],a[132:135],v[24:27]
s_waitcnt lgkmcnt(5)
buffer_load_dwordx4 a[240:243],v250,s[20:23],s46 offen offset:1024 sc1
M v[28:31],a[216:219],a[212:215],v[28:31]
v_accvgpr_read_b32 v206,a58
v_accvgpr_read_b32 v210,a154
v_accvgpr_read_b32 v207,a59
v_accvgpr_read_b32 v211,a155
v_pk_add_f32 v[212:213],v[204:205],v[208:209]
v_pk_add_f32 v[214:215],v[206:207],v[210:211]
v_pk_add_f32 v[204:205],v[204:205],v[208:209] neg_lo:[0,1] neg_hi:[0,1]
v_pk_add_f32 v[206:207],v[206:207],v[210:211] neg_lo:[0,1] neg_hi:[0,1]
v_pk_add_f32 v[208:209],v[56:57],v[152:153]
v_pk_add_f32 v[210:211],v[58:59],v[154:155]
v_pk_add_f32 v[152:153],v[56:57],v[152:153] neg_lo:[0,1] neg_hi:[0,1]
v_pk_add_f32 v[154:155],v[58:59],v[154:155] neg_lo:[0,1] neg_hi:[0,1]
v_pk_add_f32 v[56:57],v[212:213],v[208:209]
v_pk_add_f32 v[58:59],v[214:215],v[210:211]
v_pk_fma_f32 v[212:213],v[208:209],4.0,v[212:213] op_sel_hi:[1,0,1]
v_pk_fma_f32 v[214:215],v[210:211],4.0,v[214:215] op_sel_hi:[1,0,1]
v_pk_fma_f32 v[208:209],v[152:153],2.0,v[204:205] op_sel_hi:[1,0,1]
v_pk_fma_f32 v[210:211],v[154:155],2.0,v[206:207] op_sel_hi:[1,0,1]
v_pk_fma_f32 v[152:153],v[152:153],s[40:41],v[204:205] op_sel_hi:[1,0,1]
v_pk_fma_f32 v[154:155],v[154:155],s[40:41],v[206:207] op_sel_hi:[1,0,1]
M v[28:31],v[216:219],a[132:135],v[28:31]
buffer_load_dwordx4 a[244:247],v250,s[20:23],s46 offen offset:2048 sc1
M v[28:31],v[220:223],a[140:143],v[28:31]
s_waitcnt vmcnt(26) lgkmcnt(3)
v_cvt_pk_bf16_f32 v208,v208,v209
v_cvt_pk_bf16_f32 v209,v210,v211
M v[96:99],v[228:231],a[148:151],v[96:99]
s_waitcnt vmcnt(25) lgkmcnt(2)
ds_read_b128 a[132:135],v248 offset:1024
v_cvt_pk_bf16_f32 v212,v212,v213
M v[96:99],a[236:239],a[104:107],v[96:99]
s_waitcnt vmcnt(24) lgkmcnt(2)
ds_read_b128 a[140:143],v249 offset:1024
v_cvt_pk_bf16_f32 v213,v214,v215
M v[96:99],a[252:255],a[232:235],v[96:99]
s_waitcnt lgkmcnt(2)
ds_write2st64_b64 v254,v[208:209],v[212:213] offset0:68 offset1:72
M v[100:103],a[252:255],a[204:207],v[100:103]
v_accvgpr_read_b32 v204,a60
v_accvgpr_read_b32 v208,a156
M v[100:103],a[236:239],a[232:235],v[100:103]
v_accvgpr_read_b32 v205,a61
v_accvgpr_read_b32 v209,a157
M v[100:103],v[228:231],a[104:107],v[100:103]
v_accvgpr_read_b32 v206,a62
v_accvgpr_read_b32 v210,a158
v_accvgpr_read_b32 v207,a63
v_accvgpr_read_b32 v211,a159
v_pk_add_f32 v[212:213],v[204:205],v[208:209]
v_pk_add_f32 v[214:215],v[206:207],v[210:211]
v_pk_add_f32 v[204:205],v[204:205],v[208:209] neg_lo:[0,1] neg_hi:[0,1]
v_pk_add_f32 v[206:207],v[206:207],v[210:211] neg_lo:[0,1] neg_hi:[0,1]
v_pk_add_f32 v[208:209],v[60:61],v[156:157]
v_pk_add_f32 v[210:211],v[62:63],v[158:159]
v_pk_add_f32 v[156:157],v[60:61],v[156:157] neg_lo:[0,1] neg_hi:[0,1]
v_pk_add_f32 v[158:159],v[62:63],v[158:159] neg_lo:[0,1] neg_hi:[0,1]
v_pk_add_f32 v[60:61],v[212:213],v[208:209]
v_pk_add_f32 v[62:63],v[214:215],v[210:211]
v_pk_fma_f32 v[212:213],v[208:209],4.0,v[212:213] op_sel_hi:[1,0,1]
v_pk_fma_f32 v[214:215],v[210:211],4.0,v[214:215] op_sel_hi:[1,0,1]
v_pk_fma_f32 v[208:209],v[156:157],2.0,v[204:205] op_sel_hi:[1,0,1]
v_pk_fma_f32 v[210:211],v[158:159],2.0,v[206:207] op_sel_hi:[1,0,1]
v_pk_fma_f32 v[156:157],v[156:157],s[40:41],v[204:205] op_sel_hi:[1,0,1]
v_pk_fma_f32 v[158:159],v[158:159],s[40:41],v[206:207] op_sel_hi:[1,0,1]
M v[104:107],v[228:231],a[232:235],v[104:107]
ds_read_b128 a[152:155],v248 offset:1536
v_cvt_pk_bf16_f32 v208,v208,v209
M v[104:107],a[236:239],a[204:207],v[104:107]
s_waitcnt lgkmcnt(3)
ds_read_b128 a[208:211],v249 offset:1536
v_cvt_pk_bf16_f32 v209,v210,v211
M v[104:107],a[252:255],a[132:135],v[104:107]
s_waitcnt lgkmcnt(3)
v_cvt_pk_bf16_f32 v212,v212,v213
v_cvt_pk_bf16_f32 v213,v214,v215
M v[108:111],a[252:255],a[140:143],v[108:111]
ds_write2st64_b64 v254,v[208:209],v[212:213] offset0:76 offset1:80
M v[108:111],a[236:239],a[132:135],v[108:111]
v_cvt_pk_bf16_f32 v0,v0,v1
v_cvt_pk_bf16_f32 v1,v2,v3
M v[108:111],v[228:231],a[204:207],v[108:111]
v_cvt_pk_bf16_f32 v4,v4,v5
v_cvt_pk_bf16_f32 v5,v6,v7
M v[112:115],v[228:231],a[132:135],v[112:115]
s_waitcnt lgkmcnt(0)
s_barrier
ds_read_b128 a[48:51],v250 offset:8704
M v[112:115],a[236:239],a[140:143],v[112:115]
ds_read_b128 a[52:55],v250 offset:12800
ds_read_b128 a[56:59],v250 offset:34816
M v[112:115],a[252:255],a[152:155],v[112:115]
ds_read_b128 a[60:63],v250 offset:38912
ds_read_b128 a[156:159],v249 offset:2048
M v[116:119],a[252:255],a[208:211],v[116:119]
ds_read_b128 a[220:223],v248 offset:2048
ds_write2st64_b64 v254,v[0:1],v[4:5] offset0:34 offset1:38
M v[116:119],a[236:239],a[152:155],v[116:119]
v_cvt_pk_bf16_f32 v8,v8,v9
v_cvt_pk_bf16_f32 v9,v10,v11
M v[116:119],v[228:231],a[140:143],v[116:119]
s_waitcnt lgkmcnt(6)
s_add_u32 s34,s32,7077888
buffer_store_dwordx4 a[48:51],v253,s[24:27],s34 offen offset:512 nt
M v[120:123],v[228:231],a[152:155],v[120:123]
s_add_u32 s34,s32,7274496
global_load_dword a224,v250,s[64:65]
M v[120:123],a[236:239],a[208:211],v[120:123]
s_waitcnt lgkmcnt(2)
s_add_u32 s47,s75,49152
v_cvt_pk_bf16_f32 v12,v12,v13
v_cvt_pk_bf16_f32 v13,v14,v15
M v[120:123],a[252:255],a[156:159],v[120:123]
s_waitcnt lgkmcnt(1)
buffer_store_dwordx4 a[52:55],v253,s[24:27],s34 offen offset:512 nt
M v[124:127],a[252:255],a[220:223],v[124:127]
ds_write2st64_b64 v254,v[8:9],v[12:13] offset0:42 offset1:46
M v[124:127],a[236:239],a[156:159],v[124:127]
v_cvt_pk_bf16_f32 v16,v16,v17
v_cvt_pk_bf16_f32 v17,v18,v19
M v[124:127],v[228:231],a[208:211],v[124:127]
s_waitcnt vmcnt(26)
buffer_load_dwordx4 a[224:227],v250,s[20:23],s47 offen offset:0 sc1
M v[128:131],a[100:103],a[148:151],v[128:131]
s_waitcnt vmcnt(26)
v_cvt_pk_bf16_f32 v20,v20,v21
v_cvt_pk_bf16_f32 v21,v22,v23
M v[128:131],a[112:115],a[104:107],v[128:131]
s_waitcnt vmcnt(25)
ds_write2st64_b64 v254,v[16:17],v[20:21] offset0:51 offset1:55
M v[128:131],a[108:111],a[232:235],v[128:131]
buffer_load_dwordx4 a[212:215],v250,s[20:23],s47 offen offset:1024 sc1
M v[132:135],a[108:111],a[204:207],v[132:135]
s_add_u32 s34,s32,7471104
v_cvt_pk_bf16_f32 v24,v24,v25
v_cvt_pk_bf16_f32 v25,v26,v27
M v[132:135],a[112:115],a[232:235],v[132:135]
v_cvt_pk_bf16_f32 v28,v28,v29
v_cvt_pk_bf16_f32 v29,v30,v31
M v[132:135],a[100:103],a[104:107],v[132:135]
ds_write2st64_b64 v254,v[24:25],v[28:29] offset0:59 offset1:63
M v[136:139],a[100:103],a[232:235],v[136:139]
buffer_load_dwordx4 a[216:219],v250,s[20:23],s47 offen offset:2048 sc1
M v[136:139],a[112:115],a[204:207],v[136:139]
v_accvgpr_read_b32 v238,a64
v_accvgpr_read_b32 v232,a160
M v[136:139],a[108:111],a[132:135],v[136:139]
v_add_f32 v234,v238,v232
v_sub_f32 v238,v238,v232
M v[140:143],a[108:111],a[140:143],v[140:143]
v_add_f32 v232,v64,v160
v_sub_f32 v160,v64,v160
M v[140:143],a[112:115],a[132:135],v[140:143]
v_add_f32 v64,v234,v232
v_fmac_f32 v234,4.0,v232
M v[140:143],a[100:103],a[204:207],v[140:143]
buffer_store_dwordx4 a[56:59],v253,s[24:27],s34 offen offset:512 nt
M v[144:147],a[100:103],a[132:135],v[144:147]
s_add_u32 s46,s76,46080
v_fma_f32 v232,2.0,v160,v238
v_fma_f32 v160,s40,v160,v238
M v[144:147],a[112:115],a[140:143],v[144:147]
v_accvgpr_read_b32 v238,a65
v_accvgpr_read_b32 v237,a161
M v[144:147],a[108:111],a[152:155],v[144:147]
v_add_f32 v236,v238,v237
v_sub_f32 v238,v238,v237
M v[148:151],a[108:111],a[208:211],v[148:151]
v_add_f32 v237,v65,v161
v_sub_f32 v161,v65,v161
M v[148:151],a[112:115],a[152:155],v[148:151]
ds_read_b128 a[148:151],v248 offset:34816
v_add_f32 v65,v236,v237
M v[148:151],a[100:103],a[140:143],v[148:151]
ds_read_b128 a[104:107],v249 offset:34816
v_fmac_f32 v236,4.0,v237
M v[152:155],a[100:103],a[152:155],v[152:155]
buffer_load_dwordx4 a[132:135],v250,s[20:23],s46 offen offset:0 sc1
M v[152:155],a[112:115],a[208:211],v[152:155]
ds_read_b128 a[140:143],v248 offset:35328
ds_read_b128 v[216:219],v249 offset:35328
M v[152:155],a[108:111],a[156:159],v[152:155]
buffer_load_dwordx4 a[152:155],v250,s[20:23],s46 offen offset:1024 sc1
M v[156:159],a[108:111],a[220:223],v[156:159]
v_fma_f32 v237,2.0,v161,v238
v_fma_f32 v161,s40,v161,v238
M v[156:159],a[112:115],a[156:159],v[156:159]
v_cvt_pk_bf16_f32 v232,v232,v237
v_cvt_pk_bf16_f32 v234,v234,v236
M v[156:159],a[100:103],a[208:211],v[156:159]
s_waitcnt vmcnt(27) lgkmcnt(3)
v_accvgpr_read_b32 v238,a66
v_accvgpr_read_b32 v233,a162
M v[96:99],a[128:131],a[148:151],v[96:99]
s_waitcnt vmcnt(26) lgkmcnt(2)
buffer_load_dwordx4 v[220:223],v250,s[20:23],s46 offen offset:2048 sc1
M v[96:99],a[196:199],a[104:107],v[96:99]
s_waitcnt vmcnt(26) lgkmcnt(1)
s_add_u32 s34,s32,7667712
ds_read_b128 a[108:111],v248 offset:35840
ds_read_b128 a[112:115],v249 offset:35840
M v[96:99],a[116:119],a[140:143],v[96:99]
s_waitcnt lgkmcnt(2)
v_add_f32 v235,v238,v233
v_sub_f32 v238,v238,v233
M v[100:103],a[116:119],v[216:219],v[100:103]
v_add_f32 v233,v66,v162
v_sub_f32 v162,v66,v162
M v[100:103],a[196:199],a[140:143],v[100:103]
v_add_f32 v66,v235,v233
v_fmac_f32 v235,4.0,v233
M v[100:103],a[128:131],a[104:107],v[100:103]
buffer_store_dwordx4 a[60:63],v253,s[24:27],s34 offen offset:512 nt
M v[104:107],a[128:131],a[140:143],v[104:107]
ds_read_b128 a[156:159],v248 offset:36352
v_fma_f32 v233,2.0,v162,v238
M v[104:107],a[196:199],v[216:219],v[104:107]
s_waitcnt lgkmcnt(2)
ds_read_b128 a[100:103],v249 offset:36352
v_fma_f32 v162,s40,v162,v238
M v[104:107],a[116:119],a[108:111],v[104:107]
s_waitcnt lgkmcnt(2)
v_accvgpr_read_b32 v238,a67
v_accvgpr_read_b32 v237,a163
M v[108:111],a[116:119],a[112:115],v[108:111]
v_add_f32 v236,v238,v237
v_sub_f32 v238,v238,v237
M v[108:111],a[196:199],a[108:111],v[108:111]
v_add_f32 v237,v67,v163
v_sub_f32 v163,v67,v163
M v[108:111],a[128:131],v[216:219],v[108:111]
v_add_f32 v67,v236,v237
v_fmac_f32 v236,4.0,v237
M v[112:115],a[128:131],a[108:111],v[112:115]
s_add_u32 s47,s76,49152
ds_read_b128 a[160:163],v249 offset:36864
v_fma_f32 v237,2.0,v163,v238
M v[112:115],a[196:199],a[112:115],v[112:115]
s_waitcnt lgkmcnt(2)
ds_read_b128 a[252:255],v248 offset:36864
v_fma_f32 v163,s40,v163,v238
M v[112:115],a[116:119],a[156:159],v[112:115]
s_waitcnt lgkmcnt(2)
v_cvt_pk_bf16_f32 v233,v233,v237
v_cvt_pk_bf16_f32 v235,v235,v236
M v[116:119],a[116:119],a[100:103],v[116:119]
ds_write2st64_b64 v254,v[232:233],v[234:235] offset0:0 offset1:4
M v[116:119],a[196:199],a[156:159],v[116:119]
v_accvgpr_read_b32 v238,a68
v_accvgpr_read_b32 v232,a164
M v[116:119],a[128:131],a[112:115],v[116:119]
v_add_f32 v234,v238,v232
v_sub_f32 v238,v238,v232
M v[120:123],a[128:131],a[156:159],v[120:123]
buffer_load_dwordx4 a[236:239],v250,s[20:23],s47 offen offset:0 sc1
M v[120:123],a[196:199],a[100:103],v[120:123]
s_waitcnt lgkmcnt(2)
v_add_f32 v232,v68,v164
v_sub_f32 v164,v68,v164
M v[120:123],a[116:119],a[160:163],v[120:123]
s_waitcnt lgkmcnt(1)
buffer_load_dwordx4 v[228:231],v250,s[20:23],s47 offen offset:1024 sc1
M v[124:127],a[116:119],a[252:255],v[124:127]
v_add_f32 v68,v234,v232
v_fmac_f32 v234,4.0,v232
M v[124:127],a[196:199],a[160:163],v[124:127]
v_fma_f32 v232,2.0,v164,v238
v_fma_f32 v164,s40,v164,v238
M v[124:127],a[128:131],a[100:103],v[124:127]
s_waitcnt vmcnt(28)
v_accvgpr_read_b32 v238,a69
v_accvgpr_read_b32 v237,a165
M v[128:131],a[96:99],a[148:151],v[128:131]
s_waitcnt vmcnt(27)
buffer_load_dwordx4 a[232:235],v250,s[20:23],s47 offen offset:2048 sc1
M v[128:131],a[136:139],a[104:107],v[128:131]
s_waitcnt vmcnt(27)
v_add_f32 v236,v238,v237
v_sub_f32 v238,v238,v237
M v[128:131],a[120:123],a[140:143],v[128:131]
v_add_f32 v237,v69,v165
v_sub_f32 v165,v69,v165
M v[132:135],a[120:123],v[216:219],v[132:135]
v_add_f32 v69,v236,v237
v_fmac_f32 v236,4.0,v237
M v[132:135],a[136:139],a[140:143],v[132:135]
v_fma_f32 v237,2.0,v165,v238
v_fma_f32 v165,s40,v165,v238
M v[132:135],a[96:99],a[104:107],v[132:135]
v_cvt_pk_bf16_f32 v232,v232,v237
v_cvt_pk_bf16_f32 v234,v234,v236
M v[136:139],a[96:99],a[140:143],v[136:139]
v_accvgpr_read_b32 v238,a70
v_accvgpr_read_b32 v233,a166
M v[136:139],a[136:139],v[216:219],v[136:139]
v_add_f32 v235,v238,v233
v_sub_f32 v238,v238,v233
M v[136:139],a[120:123],a[108:111],v[136:139]
v_add_f32 v233,v70,v166
v_sub_f32 v166,v70,v166
M v[140:143],a[120:123],a[112:115],v[140:143]
v_add_f32 v70,v235,v233
v_fmac_f32 v235,4.0,v233
M v[140:143],a[136:139],a[108:111],v[140:143]
v_fma_f32 v233,2.0,v166,v238
v_fma_f32 v166,s40,v166,v238
M v[140:143],a[96:99],v[216:219],v[140:143]
v_accvgpr_read_b32 v238,a71
v_accvgpr_read_b32 v237,a167
M v[144:147],a[96:99],a[108:111],v[144:147]
s_add_u32 s46,s77,46080
v_add_f32 v236,v238,v237
v_sub_f32 v238,v238,v237
M v[144:147],a[136:139],a[112:115],v[144:147]
v_add_f32 v237,v71,v167
v_sub_f32 v167,v71,v167
M v[144:147],a[120:123],a[156:159],v[144:147]
v_add_f32 v71,v236,v237
v_fmac_f32 v236,4.0,v237
M v[148:151],a[120:123],a[100:103],v[148:151]
v_fma_f32 v237,2.0,v167,v238
v_fma_f32 v167,s40,v167,v238
M v[148:151],a[136:139],a[156:159],v[148:151]
ds_read_b128 a[116:119],v248 offset:52224
v_cvt_pk_bf16_f32 v233,v233,v237
M v[148:151],a[96:99],a[112:115],v[148:151]
ds_read_b128 a[128:131],v249 offset:52224
v_cvt_pk_bf16_f32 v235,v235,v236
M v[152:155],a[96:99],a[156:159],v[152:155]
buffer_load_dwordx4 a[148:151],v250,s[20:23],s46 offen offset:0 sc1
M v[152:155],a[136:139],a[100:103],v[152:155]
ds_read_b128 a[104:107],v248 offset:52736
ds_read_b128 a[108:111],v249 offset:52736
M v[152:155],a[120:123],a[160:163],v[152:155]
buffer_load_dwordx4 a[140:143],v250,s[20:23],s46 offen offset:1024 sc1
M v[156:159],a[120:123],a[252:255],v[156:159]
ds_write2st64_b64 v254,v[232:233],v[234:235] offset0:8 offset1:12
M v[156:159],a[136:139],a[160:163],v[156:159]
v_accvgpr_read_b32 v238,a72
v_accvgpr_read_b32 v232,a168
M v[156:159],a[96:99],a[100:103],v[156:159]
s_waitcnt vmcnt(28) lgkmcnt(4)
v_add_f32 v234,v238,v232
v_sub_f32 v238,v238,v232
M v[96:99],a[228:231],a[116:119],v[96:99]
s_waitcnt vmcnt(24) lgkmcnt(3)
buffer_load_dwordx4 a[164:167],v250,s[20:23],s46 offen offset:2048 sc1
M v[96:99],a[248:251],a[128:131],v[96:99]
s_waitcnt vmcnt(24) lgkmcnt(2)
ds_read_b128 a[112:115],v248 offset:53248
ds_read_b128 a[156:159],v249 offset:53248
M v[96:99],a[192:195],a[104:107],v[96:99]
s_waitcnt lgkmcnt(3)
v_add_f32 v232,v72,v168
v_sub_f32 v168,v72,v168
M v[100:103],a[192:195],a[108:111],v[100:103]
s_waitcnt lgkmcnt(2)
s_barrier
ds_read_b128 v[0:3],v250 offset:17408
M v[100:103],a[248:251],a[104:107],v[100:103]
ds_read_b128 v[8:11],v250 offset:21504
ds_read_b128 v[16:19],v250 offset:26112
M v[100:103],a[228:231],a[128:131],v[100:103]
ds_read_b128 v[24:27],v250 offset:30208
ds_read_b128 a[64:67],v250 offset:0
M v[104:107],a[228:231],a[104:107],v[104:107]
ds_read_b128 a[68:71],v250 offset:4096
ds_read_b128 a[120:123],v248 offset:53760
M v[104:107],a[248:251],a[108:111],v[104:107]
s_waitcnt lgkmcnt(8)
ds_read_b128 a[136:139],v249 offset:53760
v_add_f32 v72,v234,v232
M v[104:107],a[192:195],a[112:115],v[104:107]
s_waitcnt lgkmcnt(7)
s_add_u32 s34,s33,6291456
buffer_store_dwordx4 v[0:3],v253,s[24:27],s34 offen offset:0 nt
M v[108:111],a[192:195],a[156:159],v[108:111]
s_add_u32 s34,s33,6684672
v_fmac_f32 v234,4.0,v232
v_fma_f32 v232,2.0,v168,v238
M v[108:111],a[248:251],a[112:115],v[108:111]
v_fma_f32 v168,s40,v168,v238
v_accvgpr_read_b32 v238,a73
M v[108:111],a[228:231],a[108:111],v[108:111]
s_waitcnt lgkmcnt(6)
buffer_store_dwordx4 v[8:11],v253,s[24:27],s34 offen offset:0 nt
M v[112:115],a[228:231],a[112:115],v[112:115]
s_add_u32 s47,s77,49152
ds_read_b128 a[160:163],v249 offset:54272
v_accvgpr_read_b32 v237,a169
M v[112:115],a[248:251],a[156:159],v[112:115]
s_waitcnt lgkmcnt(2)
ds_read_b128 a[96:99],v248 offset:54272
v_add_f32 v236,v238,v237
M v[112:115],a[192:195],a[120:123],v[112:115]
s_waitcnt lgkmcnt(2)
v_sub_f32 v238,v238,v237
v_add_f32 v237,v73,v169
M v[116:119],a[192:195],a[136:139],v[116:119]
v_sub_f32 v169,v73,v169
v_add_f32 v73,v236,v237
M v[116:119],a[248:251],a[120:123],v[116:119]
v_fmac_f32 v236,4.0,v237
v_fma_f32 v237,2.0,v169,v238
M v[116:119],a[228:231],a[156:159],v[116:119]
v_fma_f32 v169,s40,v169,v238
v_cvt_pk_bf16_f32 v232,v232,v237
M v[120:123],a[228:231],a[120:123],v[120:123]
buffer_load_dwordx4 a[100:103],v250,s[20:23],s47 offen offset:0 sc1
M v[120:123],a[248:251],a[136:139],v[120:123]
s_waitcnt lgkmcnt(1)
s_add_u32 s34,s33,7077888
v_cvt_pk_bf16_f32 v234,v234,v236
v_accvgpr_read_b32 v238,a74
M v[120:123],a[192:195],a[160:163],v[120:123]
s_waitcnt lgkmcnt(0)
buffer_load_dwordx4 a[204:207],v250,s[20:23],s47 offen offset:1024 sc1
M v[124:127],a[192:195],a[96:99],v[124:127]
v_accvgpr_read_b32 v233,a170
v_add_f32 v235,v238,v233
M v[124:127],a[248:251],a[160:163],v[124:127]
v_sub_f32 v238,v238,v233
v_add_f32 v233,v74,v170
M v[124:127],a[228:231],a[136:139],v[124:127]
s_waitcnt vmcnt(26)
v_sub_f32 v170,v74,v170
v_add_f32 v74,v235,v233
M v[128:131],a[124:127],a[116:119],v[128:131]
s_waitcnt vmcnt(25)
buffer_load_dwordx4 a[220:223],v250,s[20:23],s47 offen offset:2048 sc1
M v[128:131],v[224:227],a[128:131],v[128:131]
s_waitcnt vmcnt(25)
v_fmac_f32 v235,4.0,v233
v_fma_f32 v233,2.0,v170,v238
M v[128:131],a[200:203],a[104:107],v[128:131]
v_fma_f32 v170,s40,v170,v238
v_accvgpr_read_b32 v238,a75
M v[132:135],a[200:203],a[108:111],v[132:135]
v_accvgpr_read_b32 v237,a171
v_add_f32 v236,v238,v237
M v[132:135],v[224:227],a[104:107],v[132:135]
v_sub_f32 v238,v238,v237
v_add_f32 v237,v75,v171
M v[132:135],a[124:127],a[128:131],v[132:135]
buffer_store_dwordx4 v[16:19],v253,s[24:27],s34 offen offset:0 nt
M v[136:139],a[124:127],a[104:107],v[136:139]
v_sub_f32 v171,v75,v171
v_add_f32 v75,v236,v237
M v[136:139],v[224:227],a[108:111],v[136:139]
v_fmac_f32 v236,4.0,v237
v_fma_f32 v237,2.0,v171,v238
M v[136:139],a[200:203],a[112:115],v[136:139]
v_fma_f32 v171,s40,v171,v238
v_cvt_pk_bf16_f32 v233,v233,v237
M v[140:143],a[200:203],a[156:159],v[140:143]
v_cvt_pk_bf16_f32 v235,v235,v236
M v[140:143],v[224:227],a[112:115],v[140:143]
ds_write2st64_b64 v254,v[232:233],v[234:235] offset0:17 offset1:21
M v[140:143],a[124:127],a[108:111],v[140:143]
v_accvgpr_read_b32 v238,a76
v_accvgpr_read_b32 v232,a172
M v[144:147],a[124:127],a[112:115],v[144:147]
s_add_u32 s47,s72,3072
v_add_f32 v234,v238,v232
v_sub_f32 v238,v238,v232
M v[144:147],v[224:227],a[156:159],v[144:147]
v_add_u32 v248,0x11000,v248
v_add_u32 v249,0x11000,v249
M v[144:147],a[200:203],a[120:123],v[144:147]
v_add_f32 v232,v76,v172
v_sub_f32 v172,v76,v172
M v[148:151],a[200:203],a[136:139],v[148:151]
v_add_f32 v76,v234,v232
v_fmac_f32 v234,4.0,v232
M v[148:151],v[224:227],a[120:123],v[148:151]
ds_read_b128 a[116:119],v248 offset:0
v_fma_f32 v232,2.0,v172,v238
M v[148:151],a[124:127],a[156:159],v[148:151]
s_add_u32 s34,s33,7471104
buffer_store_dwordx4 v[24:27],v253,s[24:27],s34 offen offset:0 nt
M v[152:155],a[124:127],a[120:123],v[152:155]
buffer_load_dwordx4 a[104:107],v250,s[20:23],s47 offen offset:0 sc1
M v[152:155],v[224:227],a[136:139],v[152:155]
ds_read_b128 a[128:131],v249 offset:0
ds_read_b128 a[168:171],v248 offset:512
M v[152:155],a[200:203],a[160:163],v[152:155]
ds_read_b128 a[112:115],v249 offset:512
v_fma_f32 v172,s40,v172,v238
M v[156:159],a[200:203],a[96:99],v[156:159]
v_accvgpr_read_b32 v238,a77
v_accvgpr_read_b32 v237,a173
M v[156:159],v[224:227],a[160:163],v[156:159]
buffer_load_dwordx4 a[108:111],v250,s[20:23],s47 offen offset:1024 sc1
M v[156:159],a[124:127],a[136:139],v[156:159]
s_waitcnt vmcnt(28) lgkmcnt(3)
v_add_f32 v236,v238,v237
v_sub_f32 v238,v238,v237
M v[96:99],a[144:147],a[116:119],v[96:99]
s_waitcnt vmcnt(27) lgkmcnt(2)
ds_read_b128 a[120:123],v248 offset:1024
v_add_f32 v237,v77,v173
M v[96:99],a[240:243],a[128:131],v[96:99]
s_waitcnt vmcnt(26) lgkmcnt(2)
ds_read_b128 a[96:99],v249 offset:1024
v_sub_f32 v173,v77,v173
M v[96:99],a[244:247],a[168:171],v[96:99]
s_waitcnt lgkmcnt(2)
buffer_load_dwordx4 a[156:159],v250,s[20:23],s47 offen offset:2048 sc1
M v[100:103],a[244:247],a[112:115],v[100:103]
v_add_f32 v77,v236,v237
v_fmac_f32 v236,4.0,v237
M v[100:103],a[240:243],a[168:171],v[100:103]
v_fma_f32 v237,2.0,v173,v238
v_fma_f32 v173,s40,v173,v238
M v[100:103],a[144:147],a[128:131],v[100:103]
v_cvt_pk_bf16_f32 v232,v232,v237
v_cvt_pk_bf16_f32 v234,v234,v236
M v[104:107],a[144:147],a[168:171],v[104:107]
ds_read_b128 a[160:163],v248 offset:1536
v_accvgpr_read_b32 v238,a78
M v[104:107],a[240:243],a[112:115],v[104:107]
s_waitcnt lgkmcnt(2)
ds_read_b128 a[124:127],v249 offset:1536
v_accvgpr_read_b32 v233,a174
M v[104:107],a[244:247],a[120:123],v[104:107]
s_waitcnt lgkmcnt(2)
v_add_f32 v235,v238,v233
v_sub_f32 v238,v238,v233
M v[108:111],a[244:247],a[96:99],v[108:111]
v_add_f32 v233,v78,v174
v_sub_f32 v174,v78,v174
M v[108:111],a[240:243],a[120:123],v[108:111]
v_add_f32 v78,v235,v233
v_fmac_f32 v235,4.0,v233
M v[108:111],a[144:147],a[112:115],v[108:111]
v_fma_f32 v233,2.0,v174,v238
v_fma_f32 v174,s40,v174,v238
M v[112:115],a[144:147],a[120:123],v[112:115]
s_add_u32 s48,s72,6144
ds_read_b128 a[136:139],v249 offset:2048
v_accvgpr_read_b32 v238,a79
M v[112:115],a[240:243],a[96:99],v[112:115]
s_waitcnt lgkmcnt(2)
ds_read_b128 a[208:211],v248 offset:2048
v_accvgpr_read_b32 v237,a175
M v[112:115],a[244:247],a[160:163],v[112:115]
s_waitcnt lgkmcnt(2)
v_add_f32 v236,v238,v237
v_sub_f32 v238,v238,v237
M v[116:119],a[244:247],a[124:127],v[116:119]
s_add_u32 s34,s32,6291456
v_add_f32 v237,v79,v175
v_sub_f32 v175,v79,v175
M v[116:119],a[240:243],a[160:163],v[116:119]
v_add_f32 v79,v236,v237
v_fmac_f32 v236,4.0,v237
M v[116:119],a[144:147],a[96:99],v[116:119]
buffer_store_dwordx4 a[64:67],v253,s[24:27],s34 offen offset:640 nt
M v[120:123],a[144:147],a[160:163],v[120:123]
buffer_load_dwordx4 a[172:175],v250,s[20:23],s48 offen offset:0 sc1
M v[120:123],a[240:243],a[124:127],v[120:123]
s_waitcnt lgkmcnt(1)
v_fma_f32 v237,2.0,v175,v238
v_fma_f32 v175,s40,v175,v238
M v[120:123],a[244:247],a[136:139],v[120:123]
s_waitcnt lgkmcnt(0)
v_cvt_pk_bf16_f32 v233,v233,v237
v_cvt_pk_bf16_f32 v235,v235,v236
M v[124:127],a[244:247],a[208:211],v[124:127]
ds_write2st64_b64 v254,v[232:233],v[234:235] offset0:25 offset1:29
M v[124:127],a[240:243],a[136:139],v[124:127]
buffer_load_dwordx4 a[196:199],v250,s[20:23],s48 offen offset:1024 sc1
M v[124:127],a[144:147],a[124:127],v[124:127]
s_waitcnt vmcnt(26)
v_accvgpr_read_b32 v238,a80
v_accvgpr_read_b32 v232,a176
M v[128:131],a[224:227],a[116:119],v[128:131]
s_waitcnt vmcnt(25)
v_add_f32 v234,v238,v232
v_sub_f32 v238,v238,v232
M v[128:131],a[212:215],a[128:131],v[128:131]
s_waitcnt vmcnt(24)
v_add_f32 v232,v80,v176
v_sub_f32 v176,v80,v176
M v[128:131],a[216:219],a[168:171],v[128:131]
buffer_load_dwordx4 v[216:219],v250,s[20:23],s48 offen offset:2048 sc1
M v[132:135],a[216:219],a[112:115],v[132:135]
v_add_f32 v80,v234,v232
v_fmac_f32 v234,4.0,v232
M v[132:135],a[212:215],a[168:171],v[132:135]
v_fma_f32 v232,2.0,v176,v238
v_fma_f32 v176,s40,v176,v238
M v[132:135],a[224:227],a[128:131],v[132:135]
v_accvgpr_read_b32 v238,a81
v_accvgpr_read_b32 v237,a177
M v[136:139],a[224:227],a[168:171],v[136:139]
v_add_f32 v236,v238,v237
v_sub_f32 v238,v238,v237
M v[136:139],a[212:215],a[112:115],v[136:139]
v_add_f32 v237,v81,v177
v_sub_f32 v177,v81,v177
M v[136:139],a[216:219],a[120:123],v[136:139]
v_add_f32 v81,v236,v237
v_fmac_f32 v236,4.0,v237
M v[140:143],a[216:219],a[96:99],v[140:143]
v_fma_f32 v237,2.0,v177,v238
v_fma_f32 v177,s40,v177,v238
M v[140:143],a[212:215],a[120:123],v[140:143]
v_cvt_pk_bf16_f32 v232,v232,v237
v_cvt_pk_bf16_f32 v234,v234,v236
M v[140:143],a[224:227],a[112:115],v[140:143]
v_accvgpr_read_b32 v238,a82
v_accvgpr_read_b32 v233,a178
M v[144:147],a[224:227],a[120:123],v[144:147]
s_add_u32 s47,s73,3072
v_add_f32 v235,v238,v233
v_sub_f32 v238,v238,v233
M v[144:147],a[212:215],a[96:99],v[144:147]
s_add_u32 s34,s32,6488064
v_add_f32 v233,v82,v178
v_sub_f32 v178,v82,v178
M v[144:147],a[216:219],a[160:163],v[144:147]
buffer_store_dwordx4 a[68:71],v253,s[24:27],s34 offen offset:640 nt
M v[148:151],a[216:219],a[124:127],v[148:151]
v_add_f32 v82,v235,v233
v_fmac_f32 v235,4.0,v233
M v[148:151],a[212:215],a[160:163],v[148:151]
ds_read_b128 a[144:147],v248 offset:17408
v_fma_f32 v233,2.0,v178,v238
M v[148:151],a[224:227],a[96:99],v[148:151]
ds_read_b128 a[116:119],v249 offset:17408
v_fma_f32 v178,s40,v178,v238
M v[152:155],a[224:227],a[160:163],v[152:155]
buffer_load_dwordx4 a[128:131],v250,s[20:23],s47 offen offset:0 sc1
M v[152:155],a[212:215],a[124:127],v[152:155]
ds_read_b128 a[168:171],v248 offset:17920
ds_read_b128 a[120:123],v249 offset:17920
M v[152:155],a[216:219],a[136:139],v[152:155]
buffer_load_dwordx4 a[112:115],v250,s[20:23],s47 offen offset:1024 sc1
M v[156:159],a[216:219],a[208:211],v[156:159]
v_accvgpr_read_b32 v238,a83
v_accvgpr_read_b32 v237,a179
M v[156:159],a[212:215],a[136:139],v[156:159]
v_add_f32 v236,v238,v237
v_sub_f32 v238,v238,v237
M v[156:159],a[224:227],a[124:127],v[156:159]
s_waitcnt vmcnt(26) lgkmcnt(3)
v_add_f32 v237,v83,v179
v_sub_f32 v179,v83,v179
M v[96:99],a[132:135],a[144:147],v[96:99]
s_waitcnt vmcnt(25) lgkmcnt(2)
buffer_load_dwordx4 a[96:99],v250,s[20:23],s47 offen offset:2048 sc1
M v[96:99],a[152:155],a[116:119],v[96:99]
s_waitcnt vmcnt(25) lgkmcnt(1)
ds_read_b128 a[160:163],v248 offset:18432
ds_read_b128 a[136:139],v249 offset:18432
M v[96:99],v[220:223],a[168:171],v[96:99]
s_waitcnt lgkmcnt(2)
v_add_f32 v83,v236,v237
v_fmac_f32 v236,4.0,v237
M v[100:103],v[220:223],a[120:123],v[100:103]
v_fma_f32 v237,2.0,v179,v238
v_fma_f32 v179,s40,v179,v238
M v[100:103],a[152:155],a[168:171],v[100:103]
v_cvt_pk_bf16_f32 v233,v233,v237
v_cvt_pk_bf16_f32 v235,v235,v236
M v[100:103],a[132:135],a[116:119],v[100:103]
ds_write2st64_b64 v254,v[232:233],v[234:235] offset0:68 offset1:72
M v[104:107],a[132:135],a[168:171],v[104:107]
ds_read_b128 a[124:127],v248 offset:18944
v_accvgpr_read_b32 v238,a84
M v[104:107],a[152:155],a[120:123],v[104:107]
s_waitcnt lgkmcnt(3)
ds_read_b128 a[176:179],v249 offset:18944
v_accvgpr_read_b32 v232,a180
M v[104:107],v[220:223],a[160:163],v[104:107]
s_waitcnt lgkmcnt(3)
v_add_f32 v234,v238,v232
v_sub_f32 v238,v238,v232
M v[108:111],v[220:223],a[136:139],v[108:111]
v_add_f32 v232,v84,v180
v_sub_f32 v180,v84,v180
M v[108:111],a[152:155],a[160:163],v[108:111]
v_add_f32 v84,v234,v232
v_fmac_f32 v234,4.0,v232
M v[108:111],a[132:135],a[120:123],v[108:111]
v_fma_f32 v232,2.0,v180,v238
v_fma_f32 v180,s40,v180,v238
M v[112:115],a[132:135],a[160:163],v[112:115]
s_add_u32 s48,s73,6144
ds_read_b128 a[252:255],v249 offset:19456
v_accvgpr_read_b32 v238,a85
M v[112:115],a[152:155],a[136:139],v[112:115]
s_waitcnt lgkmcnt(2)
ds_read_b128 a[192:195],v248 offset:19456
v_accvgpr_read_b32 v237,a181
M v[112:115],v[220:223],a[124:127],v[112:115]
s_waitcnt lgkmcnt(2)
v_add_f32 v236,v238,v237
v_sub_f32 v238,v238,v237
M v[116:119],v[220:223],a[176:179],v[116:119]
v_add_f32 v237,v85,v181
v_sub_f32 v181,v85,v181
M v[116:119],a[152:155],a[124:127],v[116:119]
v_add_f32 v85,v236,v237
v_fmac_f32 v236,4.0,v237
M v[116:119],a[132:135],a[136:139],v[116:119]
v_fma_f32 v237,2.0,v181,v238
v_fma_f32 v181,s40,v181,v238
M v[120:123],a[132:135],a[124:127],v[120:123]
buffer_load_dwordx4 a[248:251],v250,s[20:23],s48 offen offset:0 sc1
M v[120:123],a[152:155],a[176:179],v[120:123]
s_waitcnt lgkmcnt(1)
v_cvt_pk_bf16_f32 v232,v232,v237
v_cvt_pk_bf16_f32 v234,v234,v236
M v[120:123],v[220:223],a[252:255],v[120:123]
s_waitcnt lgkmcnt(0)
buffer_load_dwordx4 a[228:231],v250,s[20:23],s48 offen offset:1024 sc1
M v[124:127],v[220:223],a[192:195],v[124:127]
v_accvgpr_read_b32 v238,a86
v_accvgpr_read_b32 v233,a182
M v[124:127],a[152:155],a[252:255],v[124:127]
v_add_f32 v235,v238,v233
v_sub_f32 v238,v238,v233
M v[124:127],a[132:135],a[176:179],v[124:127]
s_waitcnt vmcnt(25)
v_add_f32 v233,v86,v182
v_sub_f32 v182,v86,v182
M v[128:131],a[236:239],a[144:147],v[128:131]
s_waitcnt vmcnt(24)
buffer_load_dwordx4 a[200:203],v250,s[20:23],s48 offen offset:2048 sc1
M v[128:131],v[228:231],a[116:119],v[128:131]
s_waitcnt vmcnt(24)
v_add_f32 v86,v235,v233
v_fmac_f32 v235,4.0,v233
M v[128:131],a[232:235],a[168:171],v[128:131]
v_fma_f32 v233,2.0,v182,v238
v_fma_f32 v182,s40,v182,v238
M v[132:135],a[232:235],a[120:123],v[132:135]
v_accvgpr_read_b32 v238,a87
v_accvgpr_read_b32 v237,a183
M v[132:135],v[228:231],a[168:171],v[132:135]
v_add_f32 v236,v238,v237
v_sub_f32 v238,v238,v237
M v[132:135],a[236:239],a[116:119],v[132:135]
v_add_f32 v237,v87,v183
v_sub_f32 v183,v87,v183
M v[136:139],a[236:239],a[168:171],v[136:139]
v_add_f32 v87,v236,v237
v_fmac_f32 v236,4.0,v237
M v[136:139],v[228:231],a[120:123],v[136:139]
v_fma_f32 v237,2.0,v183,v238
v_fma_f32 v183,s40,v183,v238
M v[136:139],a[232:235],a[160:163],v[136:139]
v_cvt_pk_bf16_f32 v233,v233,v237
v_cvt_pk_bf16_f32 v235,v235,v236
M v[140:143],a[232:235],a[136:139],v[140:143]
ds_write2st64_b64 v254,v[232:233],v[234:235] offset0:76 offset1:80
M v[140:143],v[228:231],a[160:163],v[140:143]
v_accvgpr_read_b32 v238,a88
v_accvgpr_read_b32 v232,a184
M v[140:143],a[236:239],a[120:123],v[140:143]
v_add_f32 v234,v238,v232
v_sub_f32 v238,v238,v232
M v[144:147],a[236:239],a[160:163],v[144:147]
s_add_u32 s47,s74,3072
v_add_f32 v232,v88,v184
v_sub_f32 v184,v88,v184
M v[144:147],v[228:231],a[136:139],v[144:147]
v_add_u32 v248,0xfffece00,v248
v_add_u32 v249,0xfffece00,v249
M v[144:147],a[232:235],a[124:127],v[144:147]
v_add_f32 v88,v234,v232
v_fmac_f32 v234,4.0,v232
M v[148:151],a[232:235],a[176:179],v[148:151]
v_fma_f32 v232,2.0,v184,v238
v_fma_f32 v184,s40,v184,v238
M v[148:151],v[228:231],a[124:127],v[148:151]
ds_read_b128 a[152:155],v248 offset:26112
v_accvgpr_read_b32 v238,a89
M v[148:151],a[236:239],a[136:139],v[148:151]
ds_read_b128 a[132:135],v249 offset:26112
v_accvgpr_read_b32 v237,a185
M v[152:155],a[236:239],a[124:127],v[152:155]
buffer_load_dwordx4 a[144:147],v250,s[20:23],s47 offen offset:0 sc1
M v[152:155],v[228:231],a[176:179],v[152:155]
ds_read_b128 a[116:119],v248 offset:26624
ds_read_b128 a[180:183],v249 offset:26624
M v[152:155],a[232:235],a[252:255],v[152:155]
buffer_load_dwordx4 a[168:171],v250,s[20:23],s47 offen offset:1024 sc1
M v[156:159],a[232:235],a[192:195],v[156:159]
v_add_f32 v236,v238,v237
v_sub_f32 v238,v238,v237
M v[156:159],v[228:231],a[252:255],v[156:159]
v_add_f32 v237,v89,v185
v_sub_f32 v185,v89,v185
M v[156:159],a[236:239],a[176:179],v[156:159]
s_waitcnt vmcnt(25) lgkmcnt(3)
v_add_f32 v89,v236,v237
v_fmac_f32 v236,4.0,v237
M v[96:99],a[148:151],a[152:155],v[96:99]
s_waitcnt vmcnt(24) lgkmcnt(2)
buffer_load_dwordx4 a[120:123],v250,s[20:23],s47 offen offset:2048 sc1
M v[96:99],a[140:143],a[132:135],v[96:99]
s_waitcnt vmcnt(24) lgkmcnt(1)
ds_read_b128 a[160:163],v248 offset:27136
ds_read_b128 a[136:139],v249 offset:27136
M v[96:99],a[164:167],a[116:119],v[96:99]
s_waitcnt lgkmcnt(2)
v_fma_f32 v237,2.0,v185,v238
v_fma_f32 v185,s40,v185,v238
M v[100:103],a[164:167],a[180:183],v[100:103]
v_cvt_pk_bf16_f32 v232,v232,v237
v_cvt_pk_bf16_f32 v234,v234,v236
M v[100:103],a[140:143],a[116:119],v[100:103]
v_accvgpr_read_b32 v238,a90
v_accvgpr_read_b32 v233,a186
M v[100:103],a[148:151],a[132:135],v[100:103]
v_add_f32 v235,v238,v233
v_sub_f32 v238,v238,v233
M v[104:107],a[148:151],a[116:119],v[104:107]
ds_read_b128 a[124:127],v248 offset:27648
v_add_f32 v233,v90,v186
M v[104:107],a[140:143],a[180:183],v[104:107]
s_waitcnt lgkmcnt(2)
ds_read_b128 a[176:179],v249 offset:27648
v_sub_f32 v186,v90,v186
M v[104:107],a[164:167],a[160:163],v[104:107]
s_waitcnt lgkmcnt(2)
v_add_f32 v90,v235,v233
v_fmac_f32 v235,4.0,v233
M v[108:111],a[164:167],a[136:139],v[108:111]
v_fma_f32 v233,2.0,v186,v238
v_fma_f32 v186,s40,v186,v238
M v[108:111],a[140:143],a[160:163],v[108:111]
v_accvgpr_read_b32 v238,a91
v_accvgpr_read_b32 v237,a187
M v[108:111],a[148:151],a[180:183],v[108:111]
v_add_f32 v236,v238,v237
v_sub_f32 v238,v238,v237
M v[112:115],a[148:151],a[160:163],v[112:115]
s_add_u32 s48,s74,6144
ds_read_b128 v[224:227],v249 offset:28160
v_add_f32 v237,v91,v187
M v[112:115],a[140:143],a[136:139],v[112:115]
s_waitcnt lgkmcnt(2)
ds_read_b128 a[244:247],v248 offset:28160
v_sub_f32 v187,v91,v187
M v[112:115],a[164:167],a[124:127],v[112:115]
s_waitcnt lgkmcnt(2)
v_add_f32 v91,v236,v237
v_fmac_f32 v236,4.0,v237
M v[116:119],a[164:167],a[176:179],v[116:119]
v_fma_f32 v237,2.0,v187,v238
v_fma_f32 v187,s40,v187,v238
M v[116:119],a[140:143],a[124:127],v[116:119]
v_cvt_pk_bf16_f32 v233,v233,v237
v_cvt_pk_bf16_f32 v235,v235,v236
M v[116:119],a[148:151],a[136:139],v[116:119]
ds_write2st64_b64 v254,v[232:233],v[234:235] offset0:85 offset1:89
M v[120:123],a[148:151],a[124:127],v[120:123]
buffer_load_dwordx4 a[184:187],v250,s[20:23],s48 offen offset:0 sc1
M v[120:123],a[140:143],a[176:179],v[120:123]
s_waitcnt lgkmcnt(2)
v_accvgpr_read_b32 v238,a92
v_accvgpr_read_b32 v232,a188
M v[120:123],a[164:167],v[224:227],v[120:123]
s_waitcnt lgkmcnt(1)
buffer_load_dwordx4 a[240:243],v250,s[20:23],s48 offen offset:1024 sc1
M v[124:127],a[164:167],a[244:247],v[124:127]
v_add_f32 v234,v238,v232
v_sub_f32 v238,v238,v232
M v[124:127],a[140:143],v[224:227],v[124:127]
v_add_f32 v232,v92,v188
v_sub_f32 v188,v92,v188
M v[124:127],a[148:151],a[176:179],v[124:127]
s_waitcnt vmcnt(23)
v_add_f32 v92,v234,v232
v_fmac_f32 v234,4.0,v232
M v[128:131],a[100:103],a[152:155],v[128:131]
s_waitcnt vmcnt(22)
buffer_load_dwordx4 a[208:211],v250,s[20:23],s48 offen offset:2048 sc1
M v[128:131],a[204:207],a[132:135],v[128:131]
s_waitcnt vmcnt(22)
v_fma_f32 v232,2.0,v188,v238
v_fma_f32 v188,s40,v188,v238
M v[128:131],a[220:223],a[116:119],v[128:131]
v_accvgpr_read_b32 v238,a93
v_accvgpr_read_b32 v237,a189
M v[132:135],a[220:223],a[180:183],v[132:135]
v_add_f32 v236,v238,v237
v_sub_f32 v238,v238,v237
M v[132:135],a[204:207],a[116:119],v[132:135]
v_add_f32 v237,v93,v189
v_sub_f32 v189,v93,v189
M v[132:135],a[100:103],a[132:135],v[132:135]
v_add_f32 v93,v236,v237
v_fmac_f32 v236,4.0,v237
M v[136:139],a[100:103],a[116:119],v[136:139]
v_fma_f32 v237,2.0,v189,v238
v_fma_f32 v189,s40,v189,v238
M v[136:139],a[204:207],a[180:183],v[136:139]
v_cvt_pk_bf16_f32 v232,v232,v237
v_cvt_pk_bf16_f32 v234,v234,v236
M v[136:139],a[220:223],a[160:163],v[136:139]
v_accvgpr_read_b32 v238,a94
v_accvgpr_read_b32 v233,a190
M v[140:143],a[220:223],a[136:139],v[140:143]
v_add_f32 v235,v238,v233
v_sub_f32 v238,v238,v233
M v[140:143],a[204:207],a[160:163],v[140:143]
v_add_f32 v233,v94,v190
v_sub_f32 v190,v94,v190
M v[140:143],a[100:103],a[180:183],v[140:143]
v_add_f32 v94,v235,v233
v_fmac_f32 v235,4.0,v233
M v[144:147],a[100:103],a[160:163],v[144:147]
s_add_u32 s47,s75,3072
v_fma_f32 v233,2.0,v190,v238
v_fma_f32 v190,s40,v190,v238
M v[144:147],a[204:207],a[136:139],v[144:147]
v_accvgpr_read_b32 v238,a95
v_accvgpr_read_b32 v237,a191
M v[144:147],a[220:223],a[124:127],v[144:147]
v_add_f32 v236,v238,v237
v_sub_f32 v238,v238,v237
M v[148:151],a[220:223],a[176:179],v[148:151]
v_add_f32 v237,v95,v191
v_sub_f32 v191,v95,v191
M v[148:151],a[204:207],a[124:127],v[148:151]
ds_read_b128 a[164:167],v248 offset:0
v_add_f32 v95,v236,v237
M v[148:151],a[100:103],a[136:139],v[148:151]
ds_read_b128 a[140:143],v249 offset:0
v_fmac_f32 v236,4.0,v237
M v[152:155],a[100:103],a[124:127],v[152:155]
buffer_load_dwordx4 a[148:151],v250,s[20:23],s47 offen offset:0 sc1
M v[152:155],a[204:207],a[176:179],v[152:155]
ds_read_b128 a[152:155],v248 offset:512
ds_read_b128 a[116:119],v249 offset:512
M v[152:155],a[220:223],v[224:227],v[152:155]
buffer_load_dwordx4 a[132:135],v250,s[20:23],s47 offen offset:1024 sc1
M v[156:159],a[220:223],a[244:247],v[156:159]
v_fma_f32 v237,2.0,v191,v238
v_fma_f32 v191,s40,v191,v238
M v[156:159],a[204:207],v[224:227],v[156:159]
v_cvt_pk_bf16_f32 v233,v233,v237
v_cvt_pk_bf16_f32 v235,v235,v236
M v[156:159],a[100:103],a[176:179],v[156:159]
s_waitcnt vmcnt(21) lgkmcnt(3)
ds_write2st64_b64 v254,v[232:233],v[234:235] offset0:93 offset1:97
M v[32:35],a[104:107],a[164:167],v[32:35]
s_waitcnt vmcnt(20) lgkmcnt(3)
buffer_load_dwordx4 a[180:183],v250,s[20:23],s47 offen offset:2048 sc1
M v[32:35],a[108:111],a[140:143],v[32:35]
s_waitcnt vmcnt(20) lgkmcnt(2)
ds_read_b128 a[160:163],v248 offset:1024
ds_read_b128 a[136:139],v249 offset:1024
M v[32:35],a[156:159],a[152:155],v[32:35]
s_waitcnt lgkmcnt(3)
v_cvt_pk_bf16_f32 v96,v96,v97
v_cvt_pk_bf16_f32 v97,v98,v99
M v[36:39],a[156:159],a[116:119],v[36:39]
v_cvt_pk_bf16_f32 v100,v100,v101
v_cvt_pk_bf16_f32 v101,v102,v103
M v[36:39],a[108:111],a[152:155],v[36:39]
s_waitcnt lgkmcnt(2)
s_barrier
ds_read_b128 a[72:75],v250 offset:8704
M v[36:39],a[104:107],a[140:143],v[36:39]
ds_read_b128 a[76:79],v250 offset:12800
ds_read_b128 a[80:83],v250 offset:34816
M v[40:43],a[104:107],a[152:155],v[40:43]
ds_read_b128 a[84:87],v250 offset:38912
ds_read_b128 a[88:91],v250 offset:43520
M v[40:43],a[108:111],a[116:119],v[40:43]
s_waitcnt lgkmcnt(6)
ds_read_b128 a[92:95],v250 offset:47616
ds_read_b128 a[124:127],v248 offset:1536
M v[40:43],a[156:159],a[160:163],v[40:43]
s_waitcnt lgkmcnt(7)
ds_read_b128 a[188:191],v249 offset:1536
ds_write2st64_b64 v254,v[96:97],v[100:101] offset0:34 offset1:38
M v[44:47],a[156:159],a[136:139],v[44:47]
s_add_u32 s34,s32,6684672
v_cvt_pk_bf16_f32 v104,v104,v105
v_cvt_pk_bf16_f32 v105,v106,v107
M v[44:47],a[108:111],a[160:163],v[44:47]
v_cvt_pk_bf16_f32 v108,v108,v109
v_cvt_pk_bf16_f32 v109,v110,v111
M v[44:47],a[104:107],a[116:119],v[44:47]
s_waitcnt lgkmcnt(8)
buffer_store_dwordx4 a[72:75],v253,s[24:27],s34 offen offset:640 nt
M v[48:51],a[104:107],a[160:163],v[48:51]
s_add_u32 s34,s32,6881280
ds_read_b128 a[100:103],v249 offset:2048
ds_write2st64_b64 v254,v[104:105],v[108:109] offset0:42 offset1:46
M v[48:51],a[108:111],a[136:139],v[48:51]
s_waitcnt lgkmcnt(4)
s_add_u32 s48,s75,6144
ds_read_b128 a[176:179],v248 offset:2048
v_cvt_pk_bf16_f32 v112,v112,v113
M v[48:51],a[156:159],a[124:127],v[48:51]
s_waitcnt lgkmcnt(4)
buffer_store_dwordx4 a[76:79],v253,s[24:27],s34 offen offset:640 nt
M v[52:55],a[156:159],a[188:191],v[52:55]
s_add_u32 s34,s32,7077888
v_cvt_pk_bf16_f32 v113,v114,v115
v_cvt_pk_bf16_f32 v116,v116,v117
M v[52:55],a[108:111],a[124:127],v[52:55]
v_cvt_pk_bf16_f32 v117,v118,v119
M v[52:55],a[104:107],a[136:139],v[52:55]
buffer_store_dwordx4 a[80:83],v253,s[24:27],s34 offen offset:640 nt
M v[56:59],a[104:107],a[124:127],v[56:59]
s_add_u32 s34,s32,7274496
buffer_load_dwordx4 a[216:219],v250,s[20:23],s48 offen offset:0 sc1
M v[56:59],a[108:111],a[188:191],v[56:59]
s_waitcnt lgkmcnt(2)
ds_write2st64_b64 v254,v[112:113],v[116:117] offset0:51 offset1:55
M v[56:59],a[156:159],a[100:103],v[56:59]
s_waitcnt lgkmcnt(1)
v_cvt_pk_bf16_f32 v120,v120,v121
v_cvt_pk_bf16_f32 v121,v122,v123
M v[60:63],a[156:159],a[176:179],v[60:63]
v_cvt_pk_bf16_f32 v124,v124,v125
v_cvt_pk_bf16_f32 v125,v126,v127
M v[60:63],a[108:111],a[100:103],v[60:63]
buffer_load_dwordx4 a[212:215],v250,s[20:23],s48 offen offset:1024 sc1
M v[60:63],a[104:107],a[188:191],v[60:63]
s_waitcnt vmcnt(23)
ds_write2st64_b64 v254,v[120:121],v[124:125] offset0:59 offset1:63
M v[64:67],a[172:175],a[164:167],v[64:67]
s_waitcnt vmcnt(22)
v_cvt_pk_bf16_f32 v128,v128,v129
v_cvt_pk_bf16_f32 v129,v130,v131
M v[64:67],a[196:199],a[140:143],v[64:67]
s_waitcnt vmcnt(21)
buffer_load_dwordx4 a[224:227],v250,s[20:23],s48 offen offset:2048 sc1
M v[64:67],v[216:219],a[152:155],v[64:67]
v_cvt_pk_bf16_f32 v132,v132,v133
v_cvt_pk_bf16_f32 v133,v134,v135
M v[68:71],v[216:219],a[116:119],v[68:71]
s_waitcnt lgkmcnt(0)
s_barrier
ds_read_b128 v[96:99],v250 offset:17408
M v[68:71],a[196:199],a[152:155],v[68:71]
ds_read_b128 v[104:107],v250 offset:21504
ds_read_b128 v[112:115],v250 offset:26112
M v[68:71],a[172:175],a[140:143],v[68:71]
ds_read_b128 v[120:123],v250 offset:30208
buffer_store_dwordx4 a[84:87],v253,s[24:27],s34 offen offset:640 nt
M v[72:75],a[172:175],a[152:155],v[72:75]
s_add_u32 s34,s32,7471104
ds_write2st64_b64 v254,v[128:129],v[132:133] offset0:17 offset1:21
M v[72:75],a[196:199],a[116:119],v[72:75]
v_cvt_pk_bf16_f32 v136,v136,v137
v_cvt_pk_bf16_f32 v137,v138,v139
M v[72:75],v[216:219],a[160:163],v[72:75]
buffer_store_dwordx4 a[88:91],v253,s[24:27],s34 offen offset:640 nt
M v[76:79],v[216:219],a[136:139],v[76:79]
s_add_u32 s34,s32,7667712
v_cvt_pk_bf16_f32 v140,v140,v141
v_cvt_pk_bf16_f32 v141,v142,v143
M v[76:79],a[196:199],a[160:163],v[76:79]
ds_write2st64_b64 v254,v[136:137],v[140:141] offset0:25 offset1:29
M v[76:79],a[172:175],a[116:119],v[76:79]
buffer_store_dwordx4 a[92:95],v253,s[24:27],s34 offen offset:640 nt
M v[80:83],a[172:175],a[160:163],v[80:83]
s_add_u32 s47,s76,3072
v_cvt_pk_bf16_f32 v144,v144,v145
v_cvt_pk_bf16_f32 v145,v146,v147
M v[80:83],a[196:199],a[136:139],v[80:83]
v_cvt_pk_bf16_f32 v148,v148,v149
v_cvt_pk_bf16_f32 v149,v150,v151
M v[80:83],v[216:219],a[124:127],v[80:83]
ds_write2st64_b64 v254,v[144:145],v[148:149] offset0:68 offset1:72
M v[84:87],v[216:219],a[188:191],v[84:87]
v_cvt_pk_bf16_f32 v152,v152,v153
v_cvt_pk_bf16_f32 v153,v154,v155
M v[84:87],a[196:199],a[124:127],v[84:87]
ds_read_b128 a[156:159],v248 offset:34816
v_cvt_pk_bf16_f32 v156,v156,v157
M v[84:87],a[172:175],a[136:139],v[84:87]
ds_read_b128 a[108:111],v249 offset:34816
v_cvt_pk_bf16_f32 v157,v158,v159
M v[88:91],a[172:175],a[124:127],v[88:91]
buffer_load_dwordx4 a[104:107],v250,s[20:23],s47 offen offset:0 sc1
M v[88:91],a[196:199],a[188:191],v[88:91]
ds_read_b128 a[164:167],v248 offset:35328
ds_read_b128 a[152:155],v249 offset:35328
M v[88:91],v[216:219],a[100:103],v[88:91]
buffer_load_dwordx4 a[140:143],v250,s[20:23],s47 offen offset:1024 sc1
M v[92:95],v[216:219],a[176:179],v[92:95]
ds_write2st64_b64 v254,v[152:153],v[156:157] offset0:76 offset1:80
M v[92:95],a[196:199],a[100:103],v[92:95]
M v[92:95],a[172:175],a[188:191],v[92:95]
s_waitcnt vmcnt(25) lgkmcnt(4)
M v[32:35],a[128:131],a[156:159],v[32:35]
s_waitcnt vmcnt(24) lgkmcnt(3)
s_add_u32 s34,s33,6291456
buffer_load_dwordx4 a[116:119],v250,s[20:23],s47 offen offset:2048 sc1
M v[32:35],a[112:115],a[108:111],v[32:35]
s_waitcnt vmcnt(24) lgkmcnt(0)
s_barrier
ds_read_b128 v[128:131],v250 offset:8704
M v[32:35],a[96:99],a[164:167],v[32:35]
ds_read_b128 v[136:139],v250 offset:12800
ds_read_b128 v[144:147],v250 offset:34816
M v[36:39],a[96:99],a[152:155],v[36:39]
ds_read_b128 v[152:155],v250 offset:38912
ds_read_b128 a[160:163],v248 offset:35840
M v[36:39],a[112:115],a[164:167],v[36:39]
ds_read_b128 a[136:139],v249 offset:35840
M v[36:39],a[128:131],a[108:111],v[36:39]
buffer_store_dwordx4 v[96:99],v253,s[24:27],s34 offen offset:1152 nt
M v[40:43],a[128:131],a[164:167],v[40:43]
ds_read_b128 a[124:127],v248 offset:36352
M v[40:43],a[112:115],a[152:155],v[40:43]
s_waitcnt lgkmcnt(2)
s_barrier
ds_read_b128 a[176:179],v249 offset:36352
M v[40:43],a[96:99],a[160:163],v[40:43]
s_waitcnt lgkmcnt(2)
M v[44:47],a[96:99],a[136:139],v[44:47]
M v[44:47],a[112:115],a[160:163],v[44:47]
M v[44:47],a[128:131],a[152:155],v[44:47]
M v[48:51],a[128:131],a[160:163],v[48:51]
s_add_u32 s48,s76,6144
ds_read_b128 a[100:103],v249 offset:36864
M v[48:51],a[112:115],a[136:139],v[48:51]
s_waitcnt lgkmcnt(2)
ds_read_b128 a[172:175],v248 offset:36864
M v[48:51],a[96:99],a[124:127],v[48:51]
s_waitcnt lgkmcnt(2)
M v[52:55],a[96:99],a[176:179],v[52:55]
M v[52:55],a[112:115],a[124:127],v[52:55]
M v[52:55],a[128:131],a[136:139],v[52:55]
M v[56:59],a[128:131],a[124:127],v[56:59]
buffer_load_dwordx4 a[188:191],v250,s[20:23],s48 offen offset:0 sc1
M v[56:59],a[112:115],a[176:179],v[56:59]
s_waitcnt lgkmcnt(1)
M v[56:59],a[96:99],a[100:103],v[56:59]
s_waitcnt lgkmcnt(0)
buffer_load_dwordx4 v[220:223],v250,s[20:23],s48 offen offset:1024 sc1
M v[60:63],a[96:99],a[172:175],v[60:63]
M v[60:63],a[112:115],a[100:103],v[60:63]
s_add_u32 s34,s33,6684672
M v[60:63],a[128:131],a[176:179],v[60:63]
s_waitcnt vmcnt(26)
M v[64:67],a[248:251],a[156:159],v[64:67]
s_waitcnt vmcnt(25)
buffer_load_dwordx4 a[192:195],v250,s[20:23],s48 offen offset:2048 sc1
M v[64:67],a[228:231],a[108:111],v[64:67]
s_waitcnt vmcnt(25)
M v[64:67],a[200:203],a[164:167],v[64:67]
M v[68:71],a[200:203],a[152:155],v[68:71]
M v[68:71],a[228:231],a[164:167],v[68:71]
M v[68:71],a[248:251],a[108:111],v[68:71]
buffer_store_dwordx4 v[104:107],v253,s[24:27],s34 offen offset:1152 nt
M v[72:75],a[248:251],a[164:167],v[72:75]
M v[72:75],a[228:231],a[152:155],v[72:75]
M v[72:75],a[200:203],a[160:163],v[72:75]
M v[76:79],a[200:203],a[136:139],v[76:79]
M v[76:79],a[228:231],a[160:163],v[76:79]
M v[76:79],a[248:251],a[152:155],v[76:79]
M v[80:83],a[248:251],a[160:163],v[80:83]
s_add_u32 s47,s77,3072
M v[80:83],a[228:231],a[136:139],v[80:83]
M v[80:83],a[200:203],a[124:127],v[80:83]
M v[84:87],a[200:203],a[176:179],v[84:87]
M v[84:87],a[228:231],a[124:127],v[84:87]
ds_read_b128 a[96:99],v248 offset:52224
M v[84:87],a[248:251],a[136:139],v[84:87]
ds_read_b128 a[112:115],v249 offset:52224
M v[88:91],a[248:251],a[124:127],v[88:91]
buffer_load_dwordx4 a[128:131],v250,s[20:23],s47 offen offset:0 sc1
M v[88:91],a[228:231],a[176:179],v[88:91]
ds_read_b128 a[156:159],v248 offset:52736
ds_read_b128 a[164:167],v249 offset:52736
M v[88:91],a[200:203],a[100:103],v[88:91]
s_add_u32 s34,s33,7077888
buffer_load_dwordx4 a[108:111],v250,s[20:23],s47 offen offset:1024 sc1
M v[92:95],a[200:203],a[172:175],v[92:95]
M v[92:95],a[228:231],a[100:103],v[92:95]
M v[92:95],a[248:251],a[176:179],v[92:95]
s_waitcnt vmcnt(27) lgkmcnt(3)
M v[32:35],a[144:147],a[96:99],v[32:35]
s_waitcnt vmcnt(26) lgkmcnt(2)
buffer_load_dwordx4 a[152:155],v250,s[20:23],s47 offen offset:2048 sc1
M v[32:35],a[168:171],a[112:115],v[32:35]
s_waitcnt vmcnt(26) lgkmcnt(1)
ds_read_b128 a[160:163],v248 offset:53248
ds_read_b128 a[136:139],v249 offset:53248
M v[32:35],a[120:123],a[156:159],v[32:35]
s_waitcnt lgkmcnt(2)
M v[36:39],a[120:123],a[164:167],v[36:39]
M v[36:39],a[168:171],a[156:159],v[36:39]
M v[36:39],a[144:147],a[112:115],v[36:39]
buffer_store_dwordx4 v[112:115],v253,s[24:27],s34 offen offset:1152 nt
M v[40:43],a[144:147],a[156:159],v[40:43]
ds_read_b128 a[124:127],v248 offset:53760
M v[40:43],a[168:171],a[164:167],v[40:43]
s_waitcnt lgkmcnt(2)
ds_read_b128 a[172:175],v249 offset:53760
M v[40:43],a[120:123],a[160:163],v[40:43]
s_waitcnt lgkmcnt(2)
M v[44:47],a[120:123],a[136:139],v[44:47]
M v[44:47],a[168:171],a[160:163],v[44:47]
M v[44:47],a[144:147],a[164:167],v[44:47]
M v[48:51],a[144:147],a[160:163],v[48:51]
s_add_u32 s48,s77,6144
ds_read_b128 a[100:103],v249 offset:54272
M v[48:51],a[168:171],a[136:139],v[48:51]
s_waitcnt lgkmcnt(2)
ds_read_b128 a[176:179],v248 offset:54272
M v[48:51],a[120:123],a[124:127],v[48:51]
s_waitcnt lgkmcnt(2)
M v[52:55],a[120:123],a[172:175],v[52:55]
M v[52:55],a[168:171],a[124:127],v[52:55]
M v[52:55],a[144:147],a[136:139],v[52:55]
M v[56:59],a[144:147],a[124:127],v[56:59]
s_add_u32 s34,s33,7471104
buffer_load_dwordx4 a[232:235],v250,s[20:23],s48 offen offset:0 sc1
M v[56:59],a[168:171],a[172:175],v[56:59]
s_waitcnt lgkmcnt(1)
M v[56:59],a[120:123],a[100:103],v[56:59]
s_waitcnt lgkmcnt(0)
buffer_store_dwordx4 v[120:123],v253,s[24:27],s34 offen offset:1152 nt
M v[60:63],a[120:123],a[176:179],v[60:63]
M v[60:63],a[168:171],a[100:103],v[60:63]
M v[60:63],a[144:147],a[172:175],v[60:63]
s_waitcnt vmcnt(28)
buffer_load_dwordx4 a[252:255],v250,s[20:23],s48 offen offset:1024 sc1
M v[64:67],a[184:187],a[96:99],v[64:67]
s_waitcnt vmcnt(28)
M v[64:67],a[240:243],a[112:115],v[64:67]
s_waitcnt vmcnt(27)
M v[64:67],a[208:211],a[156:159],v[64:67]
M v[68:71],a[208:211],a[164:167],v[68:71]
buffer_load_dwordx4 v[228:231],v250,s[20:23],s48 offen offset:2048 sc1
M v[68:71],a[240:243],a[156:159],v[68:71]
M v[68:71],a[184:187],a[112:115],v[68:71]
M v[72:75],a[184:187],a[156:159],v[72:75]
M v[72:75],a[240:243],a[164:167],v[72:75]
M v[72:75],a[208:211],a[160:163],v[72:75]
M v[76:79],a[208:211],a[136:139],v[76:79]
M v[76:79],a[240:243],a[160:163],v[76:79]
M v[76:79],a[184:187],a[164:167],v[76:79]
M v[80:83],a[184:187],a[160:163],v[80:83]
s_add_u32 s48,s72,52224
M v[80:83],a[240:243],a[136:139],v[80:83]
v_add_u32 v248,0x11000,v248
v_add_u32 v249,0x11000,v249
M v[80:83],a[208:211],a[124:127],v[80:83]
M v[84:87],a[208:211],a[172:175],v[84:87]
M v[84:87],a[240:243],a[124:127],v[84:87]
s_add_u32 s34,s33,6291456
ds_read_b128 a[120:123],v248 offset:0
M v[84:87],a[184:187],a[136:139],v[84:87]
buffer_store_dwordx4 v[128:131],v253,s[24:27],s34 offen offset:1280 nt
M v[88:91],a[184:187],a[124:127],v[88:91]
buffer_load_dwordx4 a[144:147],v250,s[20:23],s48 offen offset:0 sc1
M v[88:91],a[240:243],a[172:175],v[88:91]
ds_read_b128 a[168:171],v249 offset:0
ds_read_b128 a[96:99],v248 offset:512
M v[88:91],a[208:211],a[100:103],v[88:91]
ds_read_b128 a[156:159],v249 offset:512
M v[92:95],a[208:211],a[176:179],v[92:95]
M v[92:95],a[240:243],a[100:103],v[92:95]
buffer_load_dwordx4 a[112:115],v250,s[20:23],s48 offen offset:1024 sc1
M v[92:95],a[184:187],a[172:175],v[92:95]
s_waitcnt vmcnt(30) lgkmcnt(3)
M v[32:35],a[148:151],a[120:123],v[32:35]
s_waitcnt vmcnt(29) lgkmcnt(2)
ds_read_b128 a[160:163],v248 offset:1024
M v[32:35],a[132:135],a[168:171],v[32:35]
s_waitcnt vmcnt(28) lgkmcnt(2)
ds_read_b128 a[136:139],v249 offset:1024
M v[32:35],a[180:183],a[96:99],v[32:35]
s_waitcnt lgkmcnt(2)
buffer_load_dwordx4 a[164:167],v250,s[20:23],s48 offen offset:2048 sc1
M v[36:39],a[180:183],a[156:159],v[36:39]
M v[36:39],a[132:135],a[96:99],v[36:39]
M v[36:39],a[148:151],a[168:171],v[36:39]
M v[40:43],a[148:151],a[96:99],v[40:43]
ds_read_b128 a[124:127],v248 offset:1536
M v[40:43],a[132:135],a[156:159],v[40:43]
s_waitcnt lgkmcnt(2)
ds_read_b128 a[176:179],v249 offset:1536
M v[40:43],a[180:183],a[160:163],v[40:43]
s_waitcnt lgkmcnt(2)
M v[44:47],a[180:183],a[136:139],v[44:47]
M v[44:47],a[132:135],a[160:163],v[44:47]
M v[44:47],a[148:151],a[156:159],v[44:47]
M v[48:51],a[148:151],a[160:163],v[48:51]
s_add_u32 s48,s73,52224
ds_read_b128 a[100:103],v249 offset:2048
M v[48:51],a[132:135],a[136:139],v[48:51]
s_waitcnt lgkmcnt(2)
ds_read_b128 a[172:175],v248 offset:2048
M v[48:51],a[180:183],a[124:127],v[48:51]
s_waitcnt lgkmcnt(2)
M v[52:55],a[180:183],a[176:179],v[52:55]
s_add_u32 s34,s33,6684672
M v[52:55],a[132:135],a[124:127],v[52:55]
M v[52:55],a[148:151],a[136:139],v[52:55]
buffer_store_dwordx4 v[136:139],v253,s[24:27],s34 offen offset:1280 nt
M v[56:59],a[148:151],a[124:127],v[56:59]
buffer_load_dwordx4 a[184:187],v250,s[20:23],s48 offen offset:0 sc1
M v[56:59],a[132:135],a[176:179],v[56:59]
s_waitcnt lgkmcnt(1)
M v[56:59],a[180:183],a[100:103],v[56:59]
s_waitcnt lgkmcnt(0)
M v[60:63],a[180:183],a[172:175],v[60:63]
M v[60:63],a[132:135],a[100:103],v[60:63]
buffer_load_dwordx4 a[236:239],v250,s[20:23],s48 offen offset:1024 sc1
M v[60:63],a[148:151],a[176:179],v[60:63]
s_waitcnt vmcnt(28)
M v[64:67],a[216:219],a[120:123],v[64:67]
s_waitcnt vmcnt(27)
M v[64:67],a[212:215],a[168:171],v[64:67]
s_waitcnt vmcnt(26)
M v[64:67],a[224:227],a[96:99],v[64:67]
buffer_load_dwordx4 a[220:223],v250,s[20:23],s48 offen offset:2048 sc1
M v[68:71],a[224:227],a[156:159],v[68:71]
M v[68:71],a[212:215],a[96:99],v[68:71]
M v[68:71],a[216:219],a[168:171],v[68:71]
M v[72:75],a[216:219],a[96:99],v[72:75]
M v[72:75],a[212:215],a[156:159],v[72:75]
M v[72:75],a[224:227],a[160:163],v[72:75]
M v[76:79],a[224:227],a[136:139],v[76:79]
M v[76:79],a[212:215],a[160:163],v[76:79]
M v[76:79],a[216:219],a[156:159],v[76:79]
M v[80:83],a[216:219],a[160:163],v[80:83]
s_add_u32 s48,s74,52224
M v[80:83],a[212:215],a[136:139],v[80:83]
s_add_u32 s34,s33,7077888
M v[80:83],a[224:227],a[124:127],v[80:83]
buffer_store_dwordx4 v[144:147],v253,s[24:27],s34 offen offset:1280 nt
M v[84:87],a[224:227],a[176:179],v[84:87]
M v[84:87],a[212:215],a[124:127],v[84:87]
ds_read_b128 a[180:183],v248 offset:17408
M v[84:87],a[216:219],a[136:139],v[84:87]
ds_read_b128 a[132:135],v249 offset:17408
M v[88:91],a[216:219],a[124:127],v[88:91]
buffer_load_dwordx4 a[148:151],v250,s[20:23],s48 offen offset:0 sc1
M v[88:91],a[212:215],a[176:179],v[88:91]
ds_read_b128 a[120:123],v248 offset:17920
ds_read_b128 a[96:99],v249 offset:17920
M v[88:91],a[224:227],a[100:103],v[88:91]
buffer_load_dwordx4 a[168:171],v250,s[20:23],s48 offen offset:1024 sc1
M v[92:95],a[224:227],a[172:175],v[92:95]
M v[92:95],a[212:215],a[100:103],v[92:95]
M v[92:95],a[216:219],a[176:179],v[92:95]
s_waitcnt vmcnt(26) lgkmcnt(3)
M v[32:35],a[104:107],a[180:183],v[32:35]
s_waitcnt vmcnt(25) lgkmcnt(2)
buffer_load_dwordx4 a[156:159],v250,s[20:23],s48 offen offset:2048 sc1
M v[32:35],a[140:143],a[132:135],v[32:35]
s_waitcnt vmcnt(25) lgkmcnt(1)
ds_read_b128 a[160:163],v248 offset:18432
ds_read_b128 a[136:139],v249 offset:18432
M v[32:35],a[116:119],a[120:123],v[32:35]
s_waitcnt lgkmcnt(2)
M v[36:39],a[116:119],a[96:99],v[36:39]
M v[36:39],a[140:143],a[120:123],v[36:39]
M v[36:39],a[104:107],a[132:135],v[36:39]
M v[40:43],a[104:107],a[120:123],v[40:43]
ds_read_b128 a[124:127],v248 offset:18944
M v[40:43],a[140:143],a[96:99],v[40:43]
s_waitcnt lgkmcnt(2)
ds_read_b128 a[172:175],v249 offset:18944
M v[40:43],a[116:119],a[160:163],v[40:43]
s_waitcnt lgkmcnt(2)
M v[44:47],a[116:119],a[136:139],v[44:47]
M v[44:47],a[140:143],a[160:163],v[44:47]
M v[44:47],a[104:107],a[96:99],v[44:47]
s_add_u32 s34,s33,7471104
buffer_store_dwordx4 v[152:155],v253,s[24:27],s34 offen offset:1280 nt
M v[48:51],a[104:107],a[160:163],v[48:51]
s_add_u32 s48,s75,52224
ds_read_b128 a[100:103],v249 offset:19456
M v[48:51],a[140:143],a[136:139],v[48:51]
s_waitcnt lgkmcnt(2)
ds_read_b128 a[176:179],v248 offset:19456
M v[48:51],a[116:119],a[124:127],v[48:51]
s_waitcnt lgkmcnt(2)
M v[52:55],a[116:119],a[172:175],v[52:55]
M v[52:55],a[140:143],a[124:127],v[52:55]
M v[52:55],a[104:107],a[136:139],v[52:55]
M v[56:59],a[104:107],a[124:127],v[56:59]
buffer_load_dwordx4 a[244:247],v250,s[20:23],s48 offen offset:0 sc1
M v[56:59],a[140:143],a[172:175],v[56:59]
s_waitcnt lgkmcnt(1)
M v[56:59],a[116:119],a[100:103],v[56:59]
s_waitcnt lgkmcnt(0)
buffer_load_dwordx4 a[204:207],v250,s[20:23],s48 offen offset:1024 sc1
M v[60:63],a[116:119],a[176:179],v[60:63]
M v[60:63],a[140:143],a[100:103],v[60:63]
M v[60:63],a[104:107],a[172:175],v[60:63]
s_waitcnt vmcnt(26)
M v[64:67],a[188:191],a[180:183],v[64:67]
s_waitcnt vmcnt(25)
buffer_load_dwordx4 v[224:227],v250,s[20:23],s48 offen offset:2048 sc1
M v[64:67],v[220:223],a[132:135],v[64:67]
s_waitcnt vmcnt(25)
M v[64:67],a[192:195],a[120:123],v[64:67]
M v[68:71],a[192:195],a[96:99],v[68:71]
M v[68:71],v[220:223],a[120:123],v[68:71]
M v[68:71],a[188:191],a[132:135],v[68:71]
M v[72:75],a[188:191],a[120:123],v[72:75]
M v[72:75],v[220:223],a[96:99],v[72:75]
M v[72:75],a[192:195],a[160:163],v[72:75]
M v[76:79],a[192:195],a[136:139],v[76:79]
M v[76:79],v[220:223],a[160:163],v[76:79]
M v[76:79],a[188:191],a[96:99],v[76:79]
M v[80:83],a[188:191],a[160:163],v[80:83]
s_add_u32 s48,s76,52224
M v[80:83],v[220:223],a[136:139],v[80:83]
v_add_u32 v248,0xffff1200,v248
v_add_u32 v249,0xffff1200,v249
M v[80:83],a[192:195],a[124:127],v[80:83]
M v[84:87],a[192:195],a[172:175],v[84:87]
M v[84:87],v[220:223],a[124:127],v[84:87]
ds_read_b128 a[116:119],v248 offset:8704
M v[84:87],a[188:191],a[136:139],v[84:87]
ds_read_b128 a[140:143],v249 offset:8704
M v[88:91],a[188:191],a[124:127],v[88:91]
buffer_load_dwordx4 a[104:107],v250,s[20:23],s48 offen offset:0 sc1
M v[88:91],v[220:223],a[172:175],v[88:91]
ds_read_b128 a[180:183],v248 offset:9216
ds_read_b128 a[120:123],v249 offset:9216
M v[88:91],a[192:195],a[100:103],v[88:91]
buffer_load_dwordx4 a[132:135],v250,s[20:23],s48 offen offset:1024 sc1
M v[92:95],a[192:195],a[176:179],v[92:95]
M v[92:95],v[220:223],a[100:103],v[92:95]
M v[92:95],a[188:191],a[172:175],v[92:95]
s_waitcnt vmcnt(25) lgkmcnt(3)
M v[32:35],a[128:131],a[116:119],v[32:35]
s_waitcnt vmcnt(24) lgkmcnt(2)
buffer_load_dwordx4 a[96:99],v250,s[20:23],s48 offen offset:2048 sc1
M v[32:35],a[108:111],a[140:143],v[32:35]
s_waitcnt vmcnt(24) lgkmcnt(1)
ds_read_b128 a[160:163],v248 offset:9728
ds_read_b128 a[136:139],v249 offset:9728
M v[32:35],a[152:155],a[180:183],v[32:35]
s_waitcnt lgkmcnt(2)
M v[36:39],a[152:155],a[120:123],v[36:39]
M v[36:39],a[108:111],a[180:183],v[36:39]
M v[36:39],a[128:131],a[140:143],v[36:39]
s_nop 3
v_cvt_pk_bf16_f32 v32,v32,v33
v_cvt_pk_bf16_f32 v33,v34,v35
M v[40:43],a[128:131],a[180:183],v[40:43]
ds_read_b128 a[124:127],v248 offset:10240
M v[40:43],a[108:111],a[120:123],v[40:43]
s_waitcnt lgkmcnt(2)
ds_read_b128 a[176:179],v249 offset:10240
M v[40:43],a[152:155],a[160:163],v[40:43]
s_waitcnt lgkmcnt(2)
v_cvt_pk_bf16_f32 v36,v36,v37
v_cvt_pk_bf16_f32 v37,v38,v39
M v[44:47],a[152:155],a[136:139],v[44:47]
ds_write2st64_b64 v254,v[32:33],v[36:37] offset0:34 offset1:38
M v[44:47],a[108:111],a[160:163],v[44:47]
M v[44:47],a[128:131],a[120:123],v[44:47]
s_nop 0
v_cvt_pk_bf16_f32 v40,v40,v41
v_cvt_pk_bf16_f32 v41,v42,v43
M v[48:51],a[128:131],a[160:163],v[48:51]
s_add_u32 s48,s77,52224
ds_read_b128 a[100:103],v249 offset:10752
M v[48:51],a[108:111],a[136:139],v[48:51]
s_waitcnt lgkmcnt(3)
ds_read_b128 a[172:175],v248 offset:10752
M v[48:51],a[152:155],a[124:127],v[48:51]
s_waitcnt lgkmcnt(3)
v_cvt_pk_bf16_f32 v44,v44,v45
v_cvt_pk_bf16_f32 v45,v46,v47
M v[52:55],a[152:155],a[176:179],v[52:55]
ds_write2st64_b64 v254,v[40:41],v[44:45] offset0:42 offset1:46
M v[52:55],a[108:111],a[124:127],v[52:55]
M v[52:55],a[128:131],a[136:139],v[52:55]
s_nop 0
v_cvt_pk_bf16_f32 v48,v48,v49
v_cvt_pk_bf16_f32 v49,v50,v51
M v[56:59],a[128:131],a[124:127],v[56:59]
buffer_load_dwordx4 a[188:191],v250,s[20:23],s48 offen offset:0 sc1
M v[56:59],a[108:111],a[176:179],v[56:59]
s_waitcnt lgkmcnt(2)
M v[56:59],a[152:155],a[100:103],v[56:59]
s_waitcnt lgkmcnt(1)
buffer_load_dwordx4 v[216:219],v250,s[20:23],s48 offen offset:1024 sc1
M v[60:63],a[152:155],a[172:175],v[60:63]
v_cvt_pk_bf16_f32 v52,v52,v53
v_cvt_pk_bf16_f32 v53,v54,v55
M v[60:63],a[108:111],a[100:103],v[60:63]
ds_write2st64_b64 v254,v[48:49],v[52:53] offset0:51 offset1:55
M v[60:63],a[128:131],a[176:179],v[60:63]
s_waitcnt vmcnt(24)
v_cvt_pk_bf16_f32 v56,v56,v57
v_cvt_pk_bf16_f32 v57,v58,v59
M v[64:67],a[232:235],a[116:119],v[64:67]
s_waitcnt vmcnt(22)
buffer_load_dwordx4 a[196:199],v250,s[20:23],s48 offen offset:2048 sc1
M v[64:67],a[252:255],a[140:143],v[64:67]
s_waitcnt vmcnt(22)
M v[64:67],v[228:231],a[180:183],v[64:67]
v_cvt_pk_bf16_f32 v60,v60,v61
v_cvt_pk_bf16_f32 v61,v62,v63
M v[68:71],v[228:231],a[120:123],v[68:71]
ds_write2st64_b64 v254,v[56:57],v[60:61] offset0:59 offset1:63
M v[68:71],a[252:255],a[180:183],v[68:71]
M v[68:71],a[232:235],a[140:143],v[68:71]
s_nop 1
v_cvt_pk_bf16_f32 v64,v64,v65
v_cvt_pk_bf16_f32 v65,v66,v67
M v[72:75],a[232:235],a[180:183],v[72:75]
M v[72:75],a[252:255],a[120:123],v[72:75]
M v[72:75],v[228:231],a[160:163],v[72:75]
s_nop 0
v_cvt_pk_bf16_f32 v68,v68,v69
v_cvt_pk_bf16_f32 v69,v70,v71
M v[76:79],v[228:231],a[136:139],v[76:79]
ds_write2st64_b64 v254,v[64:65],v[68:69] offset0:0 offset1:4
M v[76:79],a[252:255],a[160:163],v[76:79]
M v[76:79],a[232:235],a[120:123],v[76:79]
s_nop 0
v_cvt_pk_bf16_f32 v72,v72,v73
v_cvt_pk_bf16_f32 v73,v74,v75
M v[80:83],a[232:235],a[160:163],v[80:83]
M v[80:83],a[252:255],a[136:139],v[80:83]
M v[80:83],v[228:231],a[124:127],v[80:83]
s_nop 1
v_cvt_pk_bf16_f32 v76,v76,v77
v_cvt_pk_bf16_f32 v77,v78,v79
M v[84:87],v[228:231],a[176:179],v[84:87]
ds_write2st64_b64 v254,v[72:73],v[76:77] offset0:8 offset1:12
M v[84:87],a[252:255],a[124:127],v[84:87]
ds_read_b128 a[152:155],v248 offset:0
M v[84:87],a[232:235],a[136:139],v[84:87]
ds_read_b128 a[108:111],v249 offset:0
v_cvt_pk_bf16_f32 v80,v80,v81
M v[88:91],a[232:235],a[124:127],v[88:91]
ds_read_b128 a[128:131],v248 offset:512
v_cvt_pk_bf16_f32 v81,v82,v83
M v[88:91],a[252:255],a[176:179],v[88:91]
ds_read_b128 a[116:119],v249 offset:512
M v[88:91],v[228:231],a[100:103],v[88:91]
v_cvt_pk_bf16_f32 v84,v84,v85
v_cvt_pk_bf16_f32 v85,v86,v87
M v[92:95],v[228:231],a[172:175],v[92:95]
ds_write2st64_b64 v254,v[80:81],v[84:85] offset0:17 offset1:21
M v[92:95],a[252:255],a[100:103],v[92:95]
M v[92:95],a[232:235],a[176:179],v[92:95]
s_waitcnt vmcnt(20) lgkmcnt(4)
s_nop 0
v_cvt_pk_bf16_f32 v88,v88,v89
v_cvt_pk_bf16_f32 v89,v90,v91
M v[160:163],a[144:147],a[152:155],v[160:163]
s_waitcnt vmcnt(19) lgkmcnt(3)
ds_read_b128 a[140:143],v248 offset:1024
M v[160:163],a[112:115],a[108:111],v[160:163]
s_waitcnt vmcnt(18) lgkmcnt(3)
ds_read_b128 a[180:183],v249 offset:1024
M v[160:163],a[164:167],a[128:131],v[160:163]
s_waitcnt lgkmcnt(3)
v_cvt_pk_bf16_f32 v92,v92,v93
v_cvt_pk_bf16_f32 v93,v94,v95
M v[164:167],a[164:167],a[116:119],v[164:167]
ds_write2st64_b64 v254,v[88:89],v[92:93] offset0:25 offset1:29
M v[164:167],a[112:115],a[128:131],v[164:167]
M v[164:167],a[144:147],a[108:111],v[164:167]
M v[168:171],a[144:147],a[128:131],v[168:171]
s_waitcnt lgkmcnt(0)
s_barrier
ds_read_b128 v[32:35],v250 offset:17408
M v[168:171],a[112:115],a[116:119],v[168:171]
ds_read_b128 v[40:43],v250 offset:21504
ds_read_b128 v[48:51],v250 offset:26112
M v[168:171],a[164:167],a[140:143],v[168:171]
ds_read_b128 v[56:59],v250 offset:30208
ds_read_b128 v[64:67],v250 offset:0
M v[172:175],a[164:167],a[180:183],v[172:175]
ds_read_b128 v[72:75],v250 offset:4096
ds_read_b128 v[80:83],v250 offset:8704
ds_read_b128 a[120:123],v248 offset:1536
M v[172:175],a[112:115],a[140:143],v[172:175]
ds_read_b128 v[88:91],v250 offset:12800
ds_read_b128 a[160:163],v249 offset:1536
M v[172:175],a[144:147],a[116:119],v[172:175]
s_waitcnt lgkmcnt(9)
s_add_u32 s34,s33,6291456
buffer_store_dwordx4 v[32:35],v253,s[24:27],s34 offen offset:128 nt
M v[176:179],a[144:147],a[140:143],v[176:179]
s_add_u32 s34,s33,6684672
ds_read_b128 a[136:139],v249 offset:2048
M v[176:179],a[112:115],a[180:183],v[176:179]
s_waitcnt lgkmcnt(3)
ds_read_b128 a[124:127],v248 offset:2048
M v[176:179],a[164:167],a[120:123],v[176:179]
s_waitcnt lgkmcnt(2)
buffer_store_dwordx4 v[40:43],v253,s[24:27],s34 offen offset:128 nt
M v[180:183],a[164:167],a[160:163],v[180:183]
s_add_u32 s34,s33,7077888
M v[180:183],a[112:115],a[120:123],v[180:183]
ds_read_b128 a[172:175],v248 offset:34816
M v[180:183],a[144:147],a[180:183],v[180:183]
buffer_store_dwordx4 v[48:51],v253,s[24:27],s34 offen offset:128 nt
M v[184:187],a[144:147],a[120:123],v[184:187]
s_add_u32 s34,s33,7471104
ds_read_b128 a[100:103],v249 offset:34816
ds_read_b128 a[176:179],v248 offset:35328
M v[184:187],a[112:115],a[160:163],v[184:187]
s_waitcnt lgkmcnt(4)
ds_read_b128 a[152:155],v249 offset:35328
M v[184:187],a[164:167],a[136:139],v[184:187]
s_waitcnt lgkmcnt(4)
buffer_store_dwordx4 v[56:59],v253,s[24:27],s34 offen offset:128 nt
M v[188:191],a[164:167],a[124:127],v[188:191]
M v[188:191],a[112:115],a[136:139],v[188:191]
M v[188:191],a[144:147],a[160:163],v[188:191]
s_waitcnt vmcnt(20) lgkmcnt(3)
M v[160:163],a[184:187],a[172:175],v[160:163]
s_waitcnt vmcnt(19) lgkmcnt(2)
ds_read_b128 a[108:111],v248 offset:35840
M v[160:163],a[236:239],a[100:103],v[160:163]
s_waitcnt vmcnt(18) lgkmcnt(2)
s_add_u32 s34,s33,6291456
ds_read_b128 a[128:131],v249 offset:35840
M v[160:163],a[220:223],a[176:179],v[160:163]
s_waitcnt lgkmcnt(2)
buffer_store_dwordx4 v[64:67],v253,s[24:27],s34 offen offset:256 nt
M v[164:167],a[220:223],a[152:155],v[164:167]
M v[164:167],a[236:239],a[176:179],v[164:167]
M v[164:167],a[184:187],a[100:103],v[164:167]
M v[168:171],a[184:187],a[176:179],v[168:171]
ds_read_b128 a[116:119],v248 offset:36352
M v[168:171],a[236:239],a[152:155],v[168:171]
s_waitcnt lgkmcnt(2)
ds_read_b128 a[140:143],v249 offset:36352
M v[168:171],a[220:223],a[108:111],v[168:171]
s_waitcnt lgkmcnt(2)
M v[172:175],a[220:223],a[128:131],v[172:175]
M v[172:175],a[236:239],a[108:111],v[172:175]
M v[172:175],a[184:187],a[152:155],v[172:175]
M v[176:179],a[184:187],a[108:111],v[176:179]
ds_read_b128 a[180:183],v249 offset:36864
M v[176:179],a[236:239],a[128:131],v[176:179]
s_waitcnt lgkmcnt(2)
ds_read_b128 a[120:123],v248 offset:36864
M v[176:179],a[220:223],a[116:119],v[176:179]
s_waitcnt lgkmcnt(2)
M v[180:183],a[220:223],a[140:143],v[180:183]
M v[180:183],a[236:239],a[116:119],v[180:183]
ds_read_b128 a[124:127],v248 offset:52224
M v[180:183],a[184:187],a[128:131],v[180:183]
ds_read_b128 a[164:167],v249 offset:52224
M v[184:187],a[184:187],a[116:119],v[184:187]
ds_read_b128 a[112:115],v248 offset:52736
M v[184:187],a[236:239],a[140:143],v[184:187]
s_waitcnt lgkmcnt(4)
ds_read_b128 a[136:139],v249 offset:52736
M v[184:187],a[220:223],a[180:183],v[184:187]
s_waitcnt lgkmcnt(4)
M v[188:191],a[220:223],a[120:123],v[188:191]
M v[188:191],a[236:239],a[180:183],v[188:191]
M v[188:191],a[184:187],a[140:143],v[188:191]
s_waitcnt vmcnt(17) lgkmcnt(3)
s_add_u32 s34,s33,6684672
buffer_store_dwordx4 v[72:75],v253,s[24:27],s34 offen offset:256 nt
M v[160:163],a[148:151],a[124:127],v[160:163]
s_waitcnt vmcnt(17) lgkmcnt(2)
ds_read_b128 a[144:147],v248 offset:53248
M v[160:163],a[168:171],a[164:167],v[160:163]
s_waitcnt vmcnt(16) lgkmcnt(2)
ds_read_b128 a[160:163],v249 offset:53248
M v[160:163],a[156:159],a[112:115],v[160:163]
s_waitcnt lgkmcnt(2)
M v[164:167],a[156:159],a[136:139],v[164:167]
M v[164:167],a[168:171],a[112:115],v[164:167]
M v[164:167],a[148:151],a[164:167],v[164:167]
M v[168:171],a[148:151],a[112:115],v[168:171]
ds_read_b128 a[172:175],v248 offset:53760
M v[168:171],a[168:171],a[136:139],v[168:171]
s_waitcnt lgkmcnt(2)
ds_read_b128 a[100:103],v249 offset:53760
M v[168:171],a[156:159],a[144:147],v[168:171]
s_waitcnt lgkmcnt(2)
M v[172:175],a[156:159],a[160:163],v[172:175]
M v[172:175],a[168:171],a[144:147],v[172:175]
M v[172:175],a[148:151],a[136:139],v[172:175]
M v[176:179],a[148:151],a[144:147],v[176:179]
ds_read_b128 a[176:179],v249 offset:54272
M v[176:179],a[168:171],a[160:163],v[176:179]
s_waitcnt lgkmcnt(2)
ds_read_b128 a[152:155],v248 offset:54272
v_add_u32 v248,0x11000,v248
M v[176:179],a[156:159],a[172:175],v[176:179]
s_waitcnt lgkmcnt(2)
v_add_u32 v249,0x11000,v249
M v[180:183],a[156:159],a[100:103],v[180:183]
M v[180:183],a[168:171],a[172:175],v[180:183]
ds_read_b128 a[108:111],v248 offset:0
M v[180:183],a[148:151],a[160:163],v[180:183]
ds_read_b128 a[128:131],v249 offset:0
M v[184:187],a[148:151],a[172:175],v[184:187]
ds_read_b128 a[116:119],v248 offset:512
M v[184:187],a[168:171],a[100:103],v[184:187]
s_waitcnt lgkmcnt(4)
ds_read_b128 a[120:123],v249 offset:512
M v[184:187],a[156:159],a[176:179],v[184:187]
s_waitcnt lgkmcnt(4)
M v[188:191],a[156:159],a[152:155],v[188:191]
s_add_u32 s34,s33,7077888
M v[188:191],a[168:171],a[176:179],v[188:191]
M v[188:191],a[148:151],a[100:103],v[188:191]
s_waitcnt vmcnt(14) lgkmcnt(3)
buffer_store_dwordx4 v[80:83],v253,s[24:27],s34 offen offset:256 nt
M v[160:163],a[244:247],a[108:111],v[160:163]
s_waitcnt vmcnt(14) lgkmcnt(2)
ds_read_b128 a[180:183],v248 offset:1024
M v[160:163],a[204:207],a[128:131],v[160:163]
s_waitcnt vmcnt(13) lgkmcnt(2)
ds_read_b128 a[140:143],v249 offset:1024
M v[160:163],v[224:227],a[116:119],v[160:163]
s_waitcnt lgkmcnt(2)
M v[164:167],v[224:227],a[120:123],v[164:167]
M v[164:167],a[204:207],a[116:119],v[164:167]
M v[164:167],a[244:247],a[128:131],v[164:167]
M v[168:171],a[244:247],a[116:119],v[168:171]
ds_read_b128 a[184:187],v248 offset:1536
M v[168:171],a[204:207],a[120:123],v[168:171]
s_waitcnt lgkmcnt(2)
ds_read_b128 a[124:127],v249 offset:1536
M v[168:171],v[224:227],a[180:183],v[168:171]
s_waitcnt lgkmcnt(2)
M v[172:175],v[224:227],a[140:143],v[172:175]
M v[172:175],a[204:207],a[180:183],v[172:175]
M v[172:175],a[244:247],a[120:123],v[172:175]
M v[176:179],a[244:247],a[180:183],v[176:179]
ds_read_b128 a[164:167],v249 offset:2048
M v[176:179],a[204:207],a[140:143],v[176:179]
s_waitcnt lgkmcnt(2)
ds_read_b128 a[112:115],v248 offset:2048
M v[176:179],v[224:227],a[184:187],v[176:179]
s_waitcnt lgkmcnt(2)
M v[180:183],v[224:227],a[124:127],v[180:183]
M v[180:183],a[204:207],a[184:187],v[180:183]
ds_read_b128 a[136:139],v248 offset:17408
M v[180:183],a[244:247],a[140:143],v[180:183]
ds_read_b128 a[144:147],v249 offset:17408
M v[184:187],a[244:247],a[184:187],v[184:187]
ds_read_b128 a[160:163],v248 offset:17920
M v[184:187],a[204:207],a[124:127],v[184:187]
s_waitcnt lgkmcnt(4)
s_add_u32 s34,s33,7471104
ds_read_b128 a[172:175],v249 offset:17920
M v[184:187],v[224:227],a[164:167],v[184:187]
s_waitcnt lgkmcnt(4)
buffer_store_dwordx4 v[88:91],v253,s[24:27],s34 offen offset:256 nt
M v[188:191],v[224:227],a[112:115],v[188:191]
M v[188:191],a[204:207],a[164:167],v[188:191]
M v[188:191],a[244:247],a[124:127],v[188:191]
s_waitcnt vmcnt(13) lgkmcnt(3)
M v[160:163],a[104:107],a[136:139],v[160:163]
s_waitcnt vmcnt(12) lgkmcnt(2)
ds_read_b128 a[152:155],v248 offset:18432
M v[160:163],a[132:135],a[144:147],v[160:163]
s_waitcnt vmcnt(11) lgkmcnt(2)
ds_read_b128 a[156:159],v249 offset:18432
M v[160:163],a[96:99],a[160:163],v[160:163]
s_waitcnt lgkmcnt(2)
M v[164:167],a[96:99],a[172:175],v[164:167]
M v[164:167],a[132:135],a[160:163],v[164:167]
M v[164:167],a[104:107],a[144:147],v[164:167]
M v[168:171],a[104:107],a[160:163],v[168:171]
ds_read_b128 a[168:171],v248 offset:18944
M v[168:171],a[132:135],a[172:175],v[168:171]
s_waitcnt lgkmcnt(2)
ds_read_b128 a[176:179],v249 offset:18944
M v[168:171],a[96:99],a[152:155],v[168:171]
s_waitcnt lgkmcnt(2)
M v[172:175],a[96:99],a[156:159],v[172:175]
M v[172:175],a[132:135],a[152:155],v[172:175]
M v[172:175],a[104:107],a[172:175],v[172:175]
M v[176:179],a[104:107],a[152:155],v[176:179]
ds_read_b128 a[100:103],v249 offset:19456
M v[176:179],a[132:135],a[156:159],v[176:179]
s_waitcnt lgkmcnt(2)
ds_read_b128 a[148:151],v248 offset:19456
v_add_u32 v248,0xffff3400,v248
M v[176:179],a[96:99],a[168:171],v[176:179]
s_waitcnt lgkmcnt(2)
v_add_u32 v249,0xffff3400,v249
M v[180:183],a[96:99],a[176:179],v[180:183]
M v[180:183],a[132:135],a[168:171],v[180:183]
ds_read_b128 a[108:111],v248 offset:0
M v[180:183],a[104:107],a[156:159],v[180:183]
ds_read_b128 a[128:131],v249 offset:0
M v[184:187],a[104:107],a[168:171],v[184:187]
ds_read_b128 a[116:119],v248 offset:512
M v[184:187],a[132:135],a[176:179],v[184:187]
s_waitcnt lgkmcnt(4)
ds_read_b128 a[120:123],v249 offset:512
M v[184:187],a[96:99],a[100:103],v[184:187]
s_waitcnt lgkmcnt(4)
M v[188:191],a[96:99],a[148:151],v[188:191]
M v[188:191],a[132:135],a[100:103],v[188:191]
M v[188:191],a[104:107],a[176:179],v[188:191]
s_waitcnt vmcnt(10) lgkmcnt(3)
M v[160:163],a[188:191],a[108:111],v[160:163]
s_waitcnt vmcnt(9) lgkmcnt(2)
ds_read_b128 a[180:183],v248 offset:1024
M v[160:163],v[216:219],a[128:131],v[160:163]
s_waitcnt vmcnt(8) lgkmcnt(2)
ds_read_b128 a[140:143],v249 offset:1024
M v[160:163],a[196:199],a[116:119],v[160:163]
s_waitcnt lgkmcnt(2)
M v[164:167],a[196:199],a[120:123],v[164:167]
M v[164:167],v[216:219],a[116:119],v[164:167]
M v[164:167],a[188:191],a[128:131],v[164:167]
s_nop 3
v_cvt_pk_bf16_f32 v160,v160,v161
v_cvt_pk_bf16_f32 v161,v162,v163
M v[168:171],a[188:191],a[116:119],v[168:171]
ds_read_b128 a[184:187],v248 offset:1536
M v[168:171],v[216:219],a[120:123],v[168:171]
s_waitcnt lgkmcnt(2)
ds_read_b128 a[112:115],v249 offset:1536
M v[168:171],a[196:199],a[180:183],v[168:171]
s_waitcnt lgkmcnt(2)
v_cvt_pk_bf16_f32 v164,v164,v165
v_cvt_pk_bf16_f32 v165,v166,v167
M v[172:175],a[196:199],a[140:143],v[172:175]
ds_write2st64_b64 v254,v[160:161],v[164:165] offset0:68 offset1:72
M v[172:175],v[216:219],a[180:183],v[172:175]
M v[172:175],a[188:191],a[120:123],v[172:175]
s_nop 0
v_cvt_pk_bf16_f32 v168,v168,v169
v_cvt_pk_bf16_f32 v169,v170,v171
M v[176:179],a[188:191],a[180:183],v[176:179]
ds_read_b128 a[164:167],v249 offset:2048
M v[176:179],v[216:219],a[140:143],v[176:179]
s_waitcnt lgkmcnt(3)
ds_read_b128 a[124:127],v248 offset:2048
M v[176:179],a[196:199],a[184:187],v[176:179]
s_waitcnt lgkmcnt(3)
v_cvt_pk_bf16_f32 v172,v172,v173
v_cvt_pk_bf16_f32 v173,v174,v175
M v[180:183],a[196:199],a[112:115],v[180:183]
ds_write2st64_b64 v254,v[168:169],v[172:173] offset0:76 offset1:80
M v[180:183],v[216:219],a[184:187],v[180:183]
M v[180:183],a[188:191],a[140:143],v[180:183]
s_nop 0
v_cvt_pk_bf16_f32 v176,v176,v177
v_cvt_pk_bf16_f32 v177,v178,v179
M v[184:187],a[188:191],a[184:187],v[184:187]
M v[184:187],v[216:219],a[112:115],v[184:187]
s_waitcnt lgkmcnt(2)
M v[184:187],a[196:199],a[164:167],v[184:187]
s_waitcnt lgkmcnt(1)
v_cvt_pk_bf16_f32 v180,v180,v181
v_cvt_pk_bf16_f32 v181,v182,v183
M v[188:191],a[196:199],a[124:127],v[188:191]
ds_write2st64_b64 v254,v[176:177],v[180:181] offset0:85 offset1:89
M v[188:191],v[216:219],a[164:167],v[188:191]
M v[188:191],a[188:191],a[112:115],v[188:191]
s_nop 0
v_cvt_pk_bf16_f32 v184,v184,v185
v_cvt_pk_bf16_f32 v185,v186,v187
s_nop 4
v_cvt_pk_bf16_f32 v188,v188,v189
v_cvt_pk_bf16_f32 v189,v190,v191
ds_write2st64_b64 v254,v[184:185],v[188:189] offset0:93 offset1:97
s_waitcnt lgkmcnt(0)
s_barrier
ds_read_b128 v[160:163],v250 offset:34816
ds_read_b128 v[168:171],v250 offset:38912
ds_read_b128 v[176:179],v250 offset:43520
ds_read_b128 v[184:187],v250 offset:47616
s_add_u32 s34,s33,6291456
s_waitcnt lgkmcnt(3)
buffer_store_dwordx4 v[160:163],v253,s[24:27],s34 offen offset:1408 nt
s_add_u32 s34,s33,6684672
s_waitcnt lgkmcnt(2)
buffer_store_dwordx4 v[168:171],v253,s[24:27],s34 offen offset:1408 nt
s_add_u32 s34,s33,7077888
s_waitcnt lgkmcnt(1)
buffer_store_dwordx4 v[176:179],v253,s[24:27],s34 offen offset:1408 nt
s_add_u32 s34,s33,7471104
s_waitcnt lgkmcnt(0)
buffer_store_dwordx4 v[184:187],v253,s[24:27],s34 offen offset:1408 nt
s_endpgm
L_code_end:
L_fallback:
s_mov_b32 s84,0
L_itemF:
s_and_b32 s85,s84,3
s_lshr_b32 s86,s84,2
s_mul_hi_u32 s87,s86,0x55555556
s_mul_i32 s88,s87,3
s_sub_u32 s86,s86,s88
s_mul_hi_u32 s88,s87,0x2aaaaaab
s_mul_i32 s89,s88,6
s_sub_u32 s87,s87,s89
s_mul_i32 s89,s86,221184
s_mul_i32 s90,s87,12288
s_add_u32 s89,s89,s90
s_mul_i32 s90,s85,3072
s_add_u32 s89,s89,s90
s_lshl_b32 s90,s88,7
s_add_u32 s89,s89,s90
s_add_u32 s90,s89,73728
s_add_u32 s91,s90,73728
v_lshlrev_b32 v149,1,v164
buffer_load_short_d16_hi v68,v149,s[36:39],s89 offen offset:0
buffer_load_short_d16_hi v69,v149,s[36:39],s89 offen offset:384
buffer_load_short_d16_hi v70,v149,s[36:39],s89 offen offset:768
buffer_load_short_d16_hi v71,v149,s[36:39],s89 offen offset:1152
buffer_load_short_d16_hi v72,v149,s[36:39],s89 offen offset:1536
buffer_load_short_d16_hi v73,v149,s[36:39],s89 offen offset:1920
buffer_load_short_d16_hi v74,v149,s[36:39],s89 offen offset:2304
buffer_load_short_d16_hi v75,v149,s[36:39],s89 offen offset:2688
buffer_load_short_d16_hi v76,v149,s[36:39],s90 offen offset:0
buffer_load_short_d16_hi v77,v149,s[36:39],s90 offen offset:384
buffer_load_short_d16_hi v78,v149,s[36:39],s90 offen offset:768
buffer_load_short_d16_hi v79,v149,s[36:39],s90 offen offset:1152
buffer_load_short_d16_hi v80,v149,s[36:39],s90 offen offset:1536
buffer_load_short_d16_hi v81,v149,s[36:39],s90 offen offset:1920
buffer_load_short_d16_hi v82,v149,s[36:39],s90 offen offset:2304
buffer_load_short_d16_hi v83,v149,s[36:39],s90 offen offset:2688
buffer_load_short_d16_hi v84,v149,s[36:39],s91 offen offset:0
buffer_load_short_d16_hi v85,v149,s[36:39],s91 offen offset:384
buffer_load_short_d16_hi v86,v149,s[36:39],s91 offen offset:768
buffer_load_short_d16_hi v87,v149,s[36:39],s91 offen offset:1152
buffer_load_short_d16_hi v88,v149,s[36:39],s91 offen offset:1536
buffer_load_short_d16_hi v89,v149,s[36:39],s91 offen offset:1920
buffer_load_short_d16_hi v90,v149,s[36:39],s91 offen offset:2304
buffer_load_short_d16_hi v91,v149,s[36:39],s91 offen offset:2688
s_and_b32 s92,s85,1
s_lshl_b32 s92,s92,2
s_lshr_b32 s85,s85,1
s_lshl_b32 s85,s85,2
v_bfe_u32 v148,v164,2,2
v_or_b32 v148,s92,v148
v_and_b32 v151,3,v164
v_or_b32 v151,s85,v151
v_xor_b32 v151,v151,v148
v_lshrrev_b32 v150,4,v164
v_mul_u32_u24 v150,331776,v150
v_lshl_add_u32 v150,v148,7,v150
v_lshl_add_u32 v150,v151,4,v150
s_mul_i32 s87,s87,55296
s_mul_i32 s88,s88,3072
s_add_u32 s87,s87,s88
s_lshl_b32 s86,s86,10
s_add_u32 s87,s87,s86
s_mov_b32 s85,0xbe2aaaab
s_mov_b32 s86,0x3d2aaaab
s_mov_b32 s88,0x3e2aaaab
s_mov_b32 s92,0x3daaaaab
s_waitcnt vmcnt(0)
v_add_f32 v148,v68,v84
v_add_f32 v92,v148,v76
v_sub_f32 v100,v148,v76
v_mul_f32 v92,s85,v92
v_mul_f32 v100,s85,v100
v_mul_f32 v148,s86,v68
v_fmac_f32 v148,s88,v84
v_fma_f32 v108,s92,v76,v148
v_fma_f32 v116,-s92,v76,v148
v_add_f32 v148,v69,v85
v_add_f32 v93,v148,v77
v_sub_f32 v101,v148,v77
v_mul_f32 v93,s85,v93
v_mul_f32 v101,s85,v101
v_mul_f32 v148,s86,v69
v_fmac_f32 v148,s88,v85
v_fma_f32 v109,s92,v77,v148
v_fma_f32 v117,-s92,v77,v148
v_add_f32 v148,v70,v86
v_add_f32 v94,v148,v78
v_sub_f32 v102,v148,v78
v_mul_f32 v94,s85,v94
v_mul_f32 v102,s85,v102
v_mul_f32 v148,s86,v70
v_fmac_f32 v148,s88,v86
v_fma_f32 v110,s92,v78,v148
v_fma_f32 v118,-s92,v78,v148
v_add_f32 v148,v71,v87
v_add_f32 v95,v148,v79
v_sub_f32 v103,v148,v79
v_mul_f32 v95,s85,v95
v_mul_f32 v103,s85,v103
v_mul_f32 v148,s86,v71
v_fmac_f32 v148,s88,v87
v_fma_f32 v111,s92,v79,v148
v_fma_f32 v119,-s92,v79,v148
v_add_f32 v148,v72,v88
v_add_f32 v96,v148,v80
v_sub_f32 v104,v148,v80
v_mul_f32 v96,s85,v96
v_mul_f32 v104,s85,v104
v_mul_f32 v148,s86,v72
v_fmac_f32 v148,s88,v88
v_fma_f32 v112,s92,v80,v148
v_fma_f32 v120,-s92,v80,v148
v_add_f32 v148,v73,v89
v_add_f32 v97,v148,v81
v_sub_f32 v105,v148,v81
v_mul_f32 v97,s85,v97
v_mul_f32 v105,s85,v105
v_mul_f32 v148,s86,v73
v_fmac_f32 v148,s88,v89
v_fma_f32 v113,s92,v81,v148
v_fma_f32 v121,-s92,v81,v148
v_add_f32 v148,v74,v90
v_add_f32 v98,v148,v82
v_sub_f32 v106,v148,v82
v_mul_f32 v98,s85,v98
v_mul_f32 v106,s85,v106
v_mul_f32 v148,s86,v74
v_fmac_f32 v148,s88,v90
v_fma_f32 v114,s92,v82,v148
v_fma_f32 v122,-s92,v82,v148
v_add_f32 v148,v75,v91
v_add_f32 v99,v148,v83
v_sub_f32 v107,v148,v83
v_mul_f32 v99,s85,v99
v_mul_f32 v107,s85,v107
v_mul_f32 v148,s86,v75
v_fmac_f32 v148,s88,v91
v_fma_f32 v115,s92,v83,v148
v_fma_f32 v123,-s92,v83,v148
v_cvt_pk_bf16_f32 v124,v68,v69
v_cvt_pk_bf16_f32 v125,v70,v71
v_cvt_pk_bf16_f32 v126,v72,v73
v_cvt_pk_bf16_f32 v127,v74,v75
s_add_u32 s89,s87,0
buffer_store_dwordx4 v[124:127],v150,s[20:23],s89 offen sc1
v_cvt_pk_bf16_f32 v144,v84,v85
v_cvt_pk_bf16_f32 v145,v86,v87
v_cvt_pk_bf16_f32 v146,v88,v89
v_cvt_pk_bf16_f32 v147,v90,v91
s_add_u32 s89,s87,46080
buffer_store_dwordx4 v[144:147],v150,s[20:23],s89 offen sc1
v_cvt_pk_bf16_f32 v128,v92,v93
v_cvt_pk_bf16_f32 v129,v94,v95
v_cvt_pk_bf16_f32 v130,v96,v97
v_cvt_pk_bf16_f32 v131,v98,v99
s_add_u32 s89,s87,9216
buffer_store_dwordx4 v[128:131],v150,s[20:23],s89 offen sc1
v_cvt_pk_bf16_f32 v132,v100,v101
v_cvt_pk_bf16_f32 v133,v102,v103
v_cvt_pk_bf16_f32 v134,v104,v105
v_cvt_pk_bf16_f32 v135,v106,v107
s_add_u32 s89,s87,18432
buffer_store_dwordx4 v[132:135],v150,s[20:23],s89 offen sc1
v_cvt_pk_bf16_f32 v136,v108,v109
v_cvt_pk_bf16_f32 v137,v110,v111
v_cvt_pk_bf16_f32 v138,v112,v113
v_cvt_pk_bf16_f32 v139,v114,v115
s_add_u32 s89,s87,27648
buffer_store_dwordx4 v[136:139],v150,s[20:23],s89 offen sc1
v_cvt_pk_bf16_f32 v140,v116,v117
v_cvt_pk_bf16_f32 v141,v118,v119
v_cvt_pk_bf16_f32 v142,v120,v121
v_cvt_pk_bf16_f32 v143,v122,v123
s_add_u32 s89,s87,36864
buffer_store_dwordx4 v[140:143],v150,s[20:23],s89 offen sc1
s_waitcnt vmcnt(0)
s_add_u32 s84,s84,1
s_cmp_lt_u32 s84,216
s_cbranch_scc1 L_itemF
s_branch L_uready
.section .rodata,"a"
.p2align 6
.amdhsa_kernel standalone__winograd__vision_kernel
  .amdhsa_next_free_vgpr 512
  .amdhsa_next_free_sgpr 96
  .amdhsa_accum_offset 256
  .amdhsa_group_segment_fixed_size 0
  .amdhsa_kernarg_size 40
  .amdhsa_user_sgpr_count 2
  .amdhsa_user_sgpr_kernarg_segment_ptr 1
  .amdhsa_system_sgpr_workgroup_id_x 1
  .amdhsa_float_denorm_mode_32 3
.end_amdhsa_kernel
```

```asm
; @launch grid=(256,1,1) block=(256,1,1) lds=156672
.amdgcn_target "amdgcn-amd-amdhsa--gfx950"
.macro M d,a,b,c
v_mfma_f32_16x16x32_bf16 \d,\a,\b,\c
.endm
.text
.globl standalone__winograd__vision_kernel
.p2align 8
.type standalone__winograd__vision_kernel,@function
standalone__winograd__vision_kernel:
s_cmp_ge_u32 s2,256
s_cbranch_scc0 L_go
s_endpgm
L_go:
s_load_dwordx4 s[4:7],s[0:1],0
s_load_dwordx4 s[24:27],s[0:1],16
s_load_dwordx2 s[20:21],s[0:1],32
v_lshlrev_b32 v165,4,v0
s_getpc_b64 s[64:65]
L_pc:
s_lshr_b32 s58,s2,3
s_lshl_b32 s58,s58,12
s_min_u32 s58,s58,L_code_end-L_pc-4096
s_add_u32 s64,s64,s58
s_addc_u32 s65,s65,0
global_load_dword v167,v165,s[64:65]
v_lshrrev_b32 v160,6,v0
v_and_b32 v164,63,v0
v_readfirstlane_b32 s50,v160
v_bfe_u32 v160,v164,3,2
v_bfe_u32 v161,v164,2,1
v_lshl_add_u32 v161,v160,3,v161
v_lshrrev_b32 v162,5,v164
v_xor_b32 v162,v162,v160
v_and_b32 v162,1,v162
v_and_b32 v163,3,v164
v_lshl_add_u32 v162,v162,2,v163
v_mul_u32_u24 v245,196608,v161
v_lshl_add_u32 v245,v162,3,v245
s_and_b32 s54,s2,7
s_lshr_b32 s55,s2,3
s_lshl_b32 s49,s54,6
s_lshl_b32 s55,s55,4
s_lshl_b32 s56,s50,2
s_add_u32 s56,s56,s55
s_mul_i32 s30,s56,384
s_mul_i32 s57,s49,196608
s_add_u32 s30,s30,s57
s_mul_i32 s44,s50,330752
s_mov_b32 s58,0
s_add_u32 s59,s58,0
s_lshl_b32 s84,s59,6
s_add_u32 s66,s30,s84
s_mul_i32 s84,s59,55296
s_add_u32 s72,s44,s84
s_add_u32 s59,s58,1
s_lshl_b32 s84,s59,6
s_add_u32 s67,s30,s84
s_mul_i32 s84,s59,55296
s_add_u32 s73,s44,s84
s_add_u32 s59,s58,2
s_lshl_b32 s84,s59,6
s_add_u32 s68,s30,s84
s_mul_i32 s84,s59,55296
s_add_u32 s74,s44,s84
s_add_u32 s59,s58,3
s_lshl_b32 s84,s59,6
s_add_u32 s69,s30,s84
s_mul_i32 s84,s59,55296
s_add_u32 s75,s44,s84
s_add_u32 s59,s58,4
s_lshl_b32 s84,s59,6
s_add_u32 s70,s30,s84
s_mul_i32 s84,s59,55296
s_add_u32 s76,s44,s84
s_add_u32 s59,s58,5
s_cmp_eq_u32 s59,6
s_cselect_b32 s59,0,s59
s_lshl_b32 s84,s59,6
s_add_u32 s71,s30,s84
s_mul_i32 s84,s59,55296
s_add_u32 s77,s44,s84
s_cmp_eq_u32 s49,0
s_cselect_b32 s58,1,0
v_cmp_gt_u32 vcc,s58,v161
v_lshrrev_b32 v163,5,v164
v_add_u32 v163,32,v163
v_mul_u32_u24 v246,196608,v163
v_bfrev_b32 v163,1
v_cndmask_b32 v251,v245,v163,vcc
v_lshl_add_u32 v168,v162,3,v245
v_cndmask_b32 v169,v168,v163,vcc
v_and_b32 v163,31,v164
v_lshlrev_b32 v163,1,v163
v_lshl_add_u32 v170,v163,1,v246
v_add_u32 v246,v246,v163
v_mov_b32 v166,1
s_mov_b32 s38,663552
s_mov_b32 s39,0x20000
s_mov_b32 s62,0
s_mov_b32 s63,0x20000
s_mov_b32 s22,1327104
s_mov_b32 s23,0x20000
s_waitcnt lgkmcnt(0)
s_and_b32 s21,s21,0xffff
s_mov_b32 s36,s6
s_and_b32 s37,s7,0xffff
s_mov_b32 s60,s26
s_and_b32 s61,s27,0xffff
s_mov_b32 s52,s26
s_mov_b32 s53,s27
s_cmp_lt_u32 s2,54
s_cbranch_scc0 L_noitem
s_lshl_b32 s84,s2,2
s_add_u32 s84,s84,s50
L_itemP:
s_and_b32 s85,s84,3
s_lshr_b32 s86,s84,2
s_mul_hi_u32 s87,s86,0x55555556
s_mul_i32 s88,s87,3
s_sub_u32 s86,s86,s88
s_mul_hi_u32 s88,s87,0x2aaaaaab
s_mul_i32 s89,s88,6
s_sub_u32 s87,s87,s89
s_mul_i32 s89,s86,221184
s_mul_i32 s90,s87,12288
s_add_u32 s89,s89,s90
s_mul_i32 s90,s85,3072
s_add_u32 s89,s89,s90
s_lshl_b32 s90,s88,7
s_add_u32 s89,s89,s90
s_add_u32 s90,s89,73728
s_add_u32 s91,s90,73728
v_lshlrev_b32 v149,1,v164
buffer_load_short_d16_hi v68,v149,s[36:39],s89 offen offset:0
buffer_load_short_d16_hi v69,v149,s[36:39],s89 offen offset:384
buffer_load_short_d16_hi v70,v149,s[36:39],s89 offen offset:768
buffer_load_short_d16_hi v71,v149,s[36:39],s89 offen offset:1152
buffer_load_short_d16_hi v72,v149,s[36:39],s89 offen offset:1536
buffer_load_short_d16_hi v73,v149,s[36:39],s89 offen offset:1920
buffer_load_short_d16_hi v74,v149,s[36:39],s89 offen offset:2304
buffer_load_short_d16_hi v75,v149,s[36:39],s89 offen offset:2688
buffer_load_short_d16_hi v76,v149,s[36:39],s90 offen offset:0
buffer_load_short_d16_hi v77,v149,s[36:39],s90 offen offset:384
buffer_load_short_d16_hi v78,v149,s[36:39],s90 offen offset:768
buffer_load_short_d16_hi v79,v149,s[36:39],s90 offen offset:1152
buffer_load_short_d16_hi v80,v149,s[36:39],s90 offen offset:1536
buffer_load_short_d16_hi v81,v149,s[36:39],s90 offen offset:1920
buffer_load_short_d16_hi v82,v149,s[36:39],s90 offen offset:2304
buffer_load_short_d16_hi v83,v149,s[36:39],s90 offen offset:2688
buffer_load_short_d16_hi v84,v149,s[36:39],s91 offen offset:0
buffer_load_short_d16_hi v85,v149,s[36:39],s91 offen offset:384
buffer_load_short_d16_hi v86,v149,s[36:39],s91 offen offset:768
buffer_load_short_d16_hi v87,v149,s[36:39],s91 offen offset:1152
buffer_load_short_d16_hi v88,v149,s[36:39],s91 offen offset:1536
buffer_load_short_d16_hi v89,v149,s[36:39],s91 offen offset:1920
buffer_load_short_d16_hi v90,v149,s[36:39],s91 offen offset:2304
buffer_load_short_d16_hi v91,v149,s[36:39],s91 offen offset:2688
s_and_b32 s92,s85,1
s_lshl_b32 s92,s92,2
s_lshr_b32 s85,s85,1
s_lshl_b32 s85,s85,2
v_bfe_u32 v148,v164,2,2
v_or_b32 v148,s92,v148
v_and_b32 v151,3,v164
v_or_b32 v151,s85,v151
v_xor_b32 v151,v151,v148
v_lshrrev_b32 v150,4,v164
v_mul_u32_u24 v150,331776,v150
v_lshl_add_u32 v150,v148,7,v150
v_lshl_add_u32 v150,v151,4,v150
s_mul_i32 s87,s87,55296
s_mul_i32 s88,s88,3072
s_add_u32 s87,s87,s88
s_lshl_b32 s86,s86,10
s_add_u32 s87,s87,s86
s_mov_b32 s85,0xbe2aaaab
s_mov_b32 s86,0x3d2aaaab
s_mov_b32 s88,0x3e2aaaab
s_mov_b32 s92,0x3daaaaab
s_waitcnt vmcnt(0)
v_add_f32 v148,v68,v84
v_add_f32 v92,v148,v76
v_sub_f32 v100,v148,v76
v_mul_f32 v92,s85,v92
v_mul_f32 v100,s85,v100
v_mul_f32 v148,s86,v68
v_fmac_f32 v148,s88,v84
v_fma_f32 v108,s92,v76,v148
v_fma_f32 v116,-s92,v76,v148
v_add_f32 v148,v69,v85
v_add_f32 v93,v148,v77
v_sub_f32 v101,v148,v77
v_mul_f32 v93,s85,v93
v_mul_f32 v101,s85,v101
v_mul_f32 v148,s86,v69
v_fmac_f32 v148,s88,v85
v_fma_f32 v109,s92,v77,v148
v_fma_f32 v117,-s92,v77,v148
v_add_f32 v148,v70,v86
v_add_f32 v94,v148,v78
v_sub_f32 v102,v148,v78
v_mul_f32 v94,s85,v94
v_mul_f32 v102,s85,v102
v_mul_f32 v148,s86,v70
v_fmac_f32 v148,s88,v86
v_fma_f32 v110,s92,v78,v148
v_fma_f32 v118,-s92,v78,v148
v_add_f32 v148,v71,v87
v_add_f32 v95,v148,v79
v_sub_f32 v103,v148,v79
v_mul_f32 v95,s85,v95
v_mul_f32 v103,s85,v103
v_mul_f32 v148,s86,v71
v_fmac_f32 v148,s88,v87
v_fma_f32 v111,s92,v79,v148
v_fma_f32 v119,-s92,v79,v148
v_add_f32 v148,v72,v88
v_add_f32 v96,v148,v80
v_sub_f32 v104,v148,v80
v_mul_f32 v96,s85,v96
v_mul_f32 v104,s85,v104
v_mul_f32 v148,s86,v72
v_fmac_f32 v148,s88,v88
v_fma_f32 v112,s92,v80,v148
v_fma_f32 v120,-s92,v80,v148
v_add_f32 v148,v73,v89
v_add_f32 v97,v148,v81
v_sub_f32 v105,v148,v81
v_mul_f32 v97,s85,v97
v_mul_f32 v105,s85,v105
v_mul_f32 v148,s86,v73
v_fmac_f32 v148,s88,v89
v_fma_f32 v113,s92,v81,v148
v_fma_f32 v121,-s92,v81,v148
v_add_f32 v148,v74,v90
v_add_f32 v98,v148,v82
v_sub_f32 v106,v148,v82
v_mul_f32 v98,s85,v98
v_mul_f32 v106,s85,v106
v_mul_f32 v148,s86,v74
v_fmac_f32 v148,s88,v90
v_fma_f32 v114,s92,v82,v148
v_fma_f32 v122,-s92,v82,v148
v_add_f32 v148,v75,v91
v_add_f32 v99,v148,v83
v_sub_f32 v107,v148,v83
v_mul_f32 v99,s85,v99
v_mul_f32 v107,s85,v107
v_mul_f32 v148,s86,v75
v_fmac_f32 v148,s88,v91
v_fma_f32 v115,s92,v83,v148
v_fma_f32 v123,-s92,v83,v148
v_cvt_pk_bf16_f32 v124,v68,v69
v_cvt_pk_bf16_f32 v125,v70,v71
v_cvt_pk_bf16_f32 v126,v72,v73
v_cvt_pk_bf16_f32 v127,v74,v75
s_add_u32 s89,s87,0
buffer_store_dwordx4 v[124:127],v150,s[20:23],s89 offen sc1
v_cvt_pk_bf16_f32 v144,v84,v85
v_cvt_pk_bf16_f32 v145,v86,v87
v_cvt_pk_bf16_f32 v146,v88,v89
v_cvt_pk_bf16_f32 v147,v90,v91
s_add_u32 s89,s87,46080
buffer_store_dwordx4 v[144:147],v150,s[20:23],s89 offen sc1
v_cvt_pk_bf16_f32 v128,v92,v93
v_cvt_pk_bf16_f32 v129,v94,v95
v_cvt_pk_bf16_f32 v130,v96,v97
v_cvt_pk_bf16_f32 v131,v98,v99
s_add_u32 s89,s87,9216
buffer_store_dwordx4 v[128:131],v150,s[20:23],s89 offen sc1
v_cvt_pk_bf16_f32 v132,v100,v101
v_cvt_pk_bf16_f32 v133,v102,v103
v_cvt_pk_bf16_f32 v134,v104,v105
v_cvt_pk_bf16_f32 v135,v106,v107
s_add_u32 s89,s87,18432
buffer_store_dwordx4 v[132:135],v150,s[20:23],s89 offen sc1
v_cvt_pk_bf16_f32 v136,v108,v109
v_cvt_pk_bf16_f32 v137,v110,v111
v_cvt_pk_bf16_f32 v138,v112,v113
v_cvt_pk_bf16_f32 v139,v114,v115
s_add_u32 s89,s87,27648
buffer_store_dwordx4 v[136:139],v150,s[20:23],s89 offen sc1
v_cvt_pk_bf16_f32 v140,v116,v117
v_cvt_pk_bf16_f32 v141,v118,v119
v_cvt_pk_bf16_f32 v142,v120,v121
v_cvt_pk_bf16_f32 v143,v122,v123
s_add_u32 s89,s87,36864
buffer_store_dwordx4 v[140:143],v150,s[20:23],s89 offen sc1
s_waitcnt vmcnt(0)
s_barrier
s_cmp_eq_u32 s50,0
s_cselect_b32 s62,256,0
L_noitem:
s_and_b32 s84,s2,1
s_lshl_b32 s59,s84,6
s_lshl_b32 s84,s84,2
s_mov_b64 exec,1
buffer_atomic_add v166,off,s[60:63],s59 sc0 sc1
s_mov_b64 exec,-1
s_and_b32 s5,s5,0xffff
s_sub_u32 s8,s4,196608
s_subb_u32 s9,s5,0
s_mov_b32 s10,100859904
s_mov_b32 s11,0x20000
s_sub_u32 s12,s4,196992
s_subb_u32 s13,s5,0
s_cmp_eq_u32 s56,0
s_cselect_b32 s14,0,100860288
s_mov_b32 s15,0x20000
s_mov_b32 s16,s8
s_mov_b32 s17,s9
s_cmp_eq_u32 s56,508
s_cselect_b32 s18,0,100859904
s_mov_b32 s19,0x20000
s_add_u32 s28,s30,0
buffer_load_dwordx4 v[8:11],v169,s[8:11],s28 offen offset:384
buffer_load_dwordx4 v[0:3],v169,s[12:15],s28 offen offset:0
buffer_load_dwordx4 v[4:7],v169,s[8:11],s28 offen offset:0
buffer_load_dwordx4 v[20:23],v169,s[16:19],s28 offen offset:1536
buffer_load_dwordx4 v[16:19],v169,s[8:11],s28 offen offset:1152
buffer_load_dwordx4 v[12:15],v169,s[8:11],s28 offen offset:768
s_mov_b64 exec,1
s_waitcnt vmcnt(6)
v_cmp_eq_u32 vcc,26,v166
v_mov_b32 v165,1
s_nop 2
s_and_b64 exec,exec,vcc
s_cselect_b32 s62,s62,0
s_mov_b64 exec,1
buffer_store_dword v165,off,s[60:63],s84 offset:128 sc1
s_mov_b64 exec,-1
s_add_u32 s28,s30,393216
buffer_load_dwordx4 v[32:35],v168,s[8:11],s28 offen offset:384
buffer_load_dwordx4 v[24:27],v168,s[12:15],s28 offen offset:0
buffer_load_dwordx4 v[28:31],v168,s[8:11],s28 offen offset:0
buffer_load_dwordx4 v[44:47],v168,s[16:19],s28 offen offset:1536
buffer_load_dwordx4 v[40:43],v168,s[8:11],s28 offen offset:1152
buffer_load_dwordx4 v[36:39],v168,s[8:11],s28 offen offset:768
v_bfe_u32 v165,v164,2,3
v_lshrrev_b32 v159,5,v164
v_and_b32 v163,3,v164
v_lshl_add_u32 v159,v159,2,v163
v_xor_b32 v163,v159,v165
v_lshlrev_b32 v163,4,v163
v_lshl_add_u32 v163,v165,7,v163
v_lshl_add_u32 v250,s50,10,v163
s_and_b32 s25,s25,0xffff
s_mov_b32 s26,100663296
s_mov_b32 s27,0x20000
s_mov_b32 s41,0xc0a00000
s_mov_b32 s40,0x41000000
s_mov_b32 s42,0xffff0000
s_mov_b32 s43,0xbfa00000
s_mov_b32 s45,0x3e800000
s_mul_i32 s58,s55,384
s_add_u32 s58,s57,s58
s_lshr_b32 s59,s50,1
s_mul_i32 s32,s59,384
s_mul_i32 s33,s59,196608
s_add_u32 s32,s32,s58
s_add_u32 s33,s33,s58
s_lshl_b32 s58,s59,5
s_lshl_b32 s59,s50,7
v_lshlrev_b32 v247,11,v160
v_xor_b32 v163,v160,v161
v_and_b32 v163,1,v163
v_lshl_add_u32 v247,v163,6,v247
v_lshlrev_b32 v163,3,v162
v_xor_b32 v163,s58,v163
v_add3_u32 v247,v247,v163,s59
v_and_b32 v171,0xffffffc0,v247
v_and_b32 v163,3,v162
v_lshlrev_b32 v163,4,v163
v_xor_b32 v163,s58,v163
v_add_u32 v171,v171,v163
v_lshrrev_b32 v163,2,v162
v_mul_u32_u24 v163,17408,v163
v_mad_u32_u24 v172,v163,5,v171
v_lshl_add_u32 v171,v163,1,v171
v_and_b32 v163,15,v164
v_lshlrev_b32 v163,2,v163
v_xor_b32 v163,s58,v163
v_lshrrev_b32 v173,5,v164
v_lshl_add_u32 v173,v173,6,v163
v_add_u32 v173,s59,v173
v_add_u32 v173,8192,v173
v_bfe_u32 v163,v164,4,1
v_mul_u32_u24 v163,17408,v163
v_mad_u32_u24 v174,v163,5,v173
v_lshl_add_u32 v173,v163,1,v173
v_lshrrev_b32 v160,5,v164
v_lshlrev_b32 v160,6,v160
v_and_b32 v161,63,v246
v_xor_b32 v161,s58,v161
v_add3_u32 v252,v160,v161,s59
v_add_u32 v252,8192,v252
v_bfe_u32 v160,v164,2,2
v_and_b32 v161,3,v164
v_lshrrev_b32 v162,4,v164
v_lshlrev_b32 v248,11,v160
v_lshl_add_u32 v248,v161,7,v248
v_and_b32 v163,1,v160
v_lshl_add_u32 v248,v163,6,v248
v_and_b32 v163,2,v161
v_xor_b32 v163,v163,v162
v_lshl_add_u32 v248,v163,4,v248
v_xor_b32 v249,64,v248
v_lshrrev_b32 v160,1,v162
v_lshl_add_u32 v160,s50,1,v160
v_and_b32 v161,7,v164
v_xor_b32 v160,v160,v161
v_and_b32 v163,15,v164
v_lshlrev_b32 v254,7,v163
v_lshl_add_u32 v254,v160,4,v254
v_and_b32 v163,1,v162
v_lshl_add_u32 v254,v163,3,v254
v_bfe_u32 v160,v250,7,4
v_lshrrev_b32 v162,2,v160
v_mul_u32_u24 v253,1572864,v162
v_and_b32 v162,3,v160
v_mul_u32_u24 v162,1536,v162
v_lshl_add_u32 v160,v159,4,v162
v_add_u32 v253,v253,v160
s_waitcnt vmcnt(12)
v_lshlrev_b32 v180,16,v8
v_and_b32 v181,s42,v8
s_waitcnt vmcnt(11)
v_lshlrev_b32 v176,16,v0
v_and_b32 v177,s42,v0
s_waitcnt vmcnt(10)
v_lshlrev_b32 v178,16,v4
v_and_b32 v179,s42,v4
s_add_u32 s28,s30,786432
buffer_load_dwordx4 v[56:59],v168,s[8:11],s28 offen offset:384
s_waitcnt vmcnt(10)
v_lshlrev_b32 v186,16,v20
v_and_b32 v187,s42,v20
s_waitcnt vmcnt(9)
v_lshlrev_b32 v184,16,v16
v_and_b32 v185,s42,v16
s_waitcnt vmcnt(8)
v_lshlrev_b32 v182,16,v12
v_and_b32 v183,s42,v12
v_pk_fma_f32 v[176:177],v[180:181],s[42:43],v[176:177] op_sel:[0,1,0] op_sel_hi:[1,1,1]
v_pk_fma_f32 v[186:187],v[178:179],4.0,v[186:187] op_sel_hi:[1,0,1]
v_pk_fma_f32 v[188:189],v[180:181],-4.0,v[184:185] op_sel_hi:[1,0,1]
v_pk_fma_f32 v[176:177],v[184:185],s[44:45],v[176:177] op_sel:[0,1,0] op_sel_hi:[1,1,1]
v_pk_fma_f32 v[186:187],v[182:183],s[40:41],v[186:187] op_sel:[0,1,0] op_sel_hi:[1,1,1]
v_pk_add_f32 v[184:185],v[184:185],v[180:181] neg_lo:[0,1] neg_hi:[0,1]
buffer_load_dwordx4 v[48:51],v168,s[12:15],s28 offen offset:0
v_pk_fma_f32 v[180:181],v[178:179],-4.0,v[182:183] op_sel_hi:[1,0,1]
v_pk_add_f32 v[182:183],v[182:183],v[178:179] neg_lo:[0,1] neg_hi:[0,1]
v_pk_add_f32 v[178:179],v[188:189],v[180:181]
v_pk_add_f32 v[188:189],v[188:189],v[180:181] neg_lo:[0,1] neg_hi:[0,1]
v_pk_fma_f32 v[180:181],v[182:183],2.0,v[184:185] op_sel_hi:[1,0,1]
v_pk_fma_f32 v[184:185],v[182:183],-2.0,v[184:185] op_sel_hi:[1,0,1]
v_cvt_pk_bf16_f32 v0,v176,v177
v_cvt_pk_bf16_f32 v4,v178,v179
v_cvt_pk_bf16_f32 v8,v188,v189
v_cvt_pk_bf16_f32 v12,v180,v181
v_cvt_pk_bf16_f32 v16,v184,v185
v_cvt_pk_bf16_f32 v20,v186,v187
buffer_load_dwordx4 v[52:55],v168,s[8:11],s28 offen offset:0
v_lshlrev_b32 v180,16,v9
v_and_b32 v181,s42,v9
v_lshlrev_b32 v176,16,v1
v_and_b32 v177,s42,v1
v_lshlrev_b32 v178,16,v5
v_and_b32 v179,s42,v5
v_lshlrev_b32 v186,16,v21
v_and_b32 v187,s42,v21
v_lshlrev_b32 v184,16,v17
v_and_b32 v185,s42,v17
v_lshlrev_b32 v182,16,v13
v_and_b32 v183,s42,v13
buffer_load_dwordx4 v[68:71],v168,s[16:19],s28 offen offset:1536
v_pk_fma_f32 v[176:177],v[180:181],s[42:43],v[176:177] op_sel:[0,1,0] op_sel_hi:[1,1,1]
v_pk_fma_f32 v[186:187],v[178:179],4.0,v[186:187] op_sel_hi:[1,0,1]
v_pk_fma_f32 v[188:189],v[180:181],-4.0,v[184:185] op_sel_hi:[1,0,1]
v_pk_fma_f32 v[176:177],v[184:185],s[44:45],v[176:177] op_sel:[0,1,0] op_sel_hi:[1,1,1]
v_pk_fma_f32 v[186:187],v[182:183],s[40:41],v[186:187] op_sel:[0,1,0] op_sel_hi:[1,1,1]
v_pk_add_f32 v[184:185],v[184:185],v[180:181] neg_lo:[0,1] neg_hi:[0,1]
v_pk_fma_f32 v[180:181],v[178:179],-4.0,v[182:183] op_sel_hi:[1,0,1]
v_pk_add_f32 v[182:183],v[182:183],v[178:179] neg_lo:[0,1] neg_hi:[0,1]
v_pk_add_f32 v[178:179],v[188:189],v[180:181]
v_pk_add_f32 v[188:189],v[188:189],v[180:181] neg_lo:[0,1] neg_hi:[0,1]
v_pk_fma_f32 v[180:181],v[182:183],2.0,v[184:185] op_sel_hi:[1,0,1]
v_pk_fma_f32 v[184:185],v[182:183],-2.0,v[184:185] op_sel_hi:[1,0,1]
buffer_load_dwordx4 v[64:67],v168,s[8:11],s28 offen offset:1152
v_cvt_pk_bf16_f32 v1,v176,v177
v_cvt_pk_bf16_f32 v5,v178,v179
v_cvt_pk_bf16_f32 v9,v188,v189
v_cvt_pk_bf16_f32 v13,v180,v181
v_cvt_pk_bf16_f32 v17,v184,v185
v_cvt_pk_bf16_f32 v21,v186,v187
v_lshlrev_b32 v180,16,v10
v_and_b32 v181,s42,v10
v_lshlrev_b32 v176,16,v2
v_and_b32 v177,s42,v2
v_lshlrev_b32 v178,16,v6
v_and_b32 v179,s42,v6
buffer_load_dwordx4 v[60:63],v168,s[8:11],s28 offen offset:768
v_lshlrev_b32 v186,16,v22
v_and_b32 v187,s42,v22
v_lshlrev_b32 v184,16,v18
v_and_b32 v185,s42,v18
v_lshlrev_b32 v182,16,v14
v_and_b32 v183,s42,v14
v_pk_fma_f32 v[176:177],v[180:181],s[42:43],v[176:177] op_sel:[0,1,0] op_sel_hi:[1,1,1]
v_pk_fma_f32 v[186:187],v[178:179],4.0,v[186:187] op_sel_hi:[1,0,1]
v_pk_fma_f32 v[188:189],v[180:181],-4.0,v[184:185] op_sel_hi:[1,0,1]
v_pk_fma_f32 v[176:177],v[184:185],s[44:45],v[176:177] op_sel:[0,1,0] op_sel_hi:[1,1,1]
v_pk_fma_f32 v[186:187],v[182:183],s[40:41],v[186:187] op_sel:[0,1,0] op_sel_hi:[1,1,1]
v_pk_add_f32 v[184:185],v[184:185],v[180:181] neg_lo:[0,1] neg_hi:[0,1]
s_add_u32 s28,s30,1179648
buffer_load_dwordx4 v[80:83],v168,s[8:11],s28 offen offset:384
v_pk_fma_f32 v[180:181],v[178:179],-4.0,v[182:183] op_sel_hi:[1,0,1]
v_pk_add_f32 v[182:183],v[182:183],v[178:179] neg_lo:[0,1] neg_hi:[0,1]
v_pk_add_f32 v[178:179],v[188:189],v[180:181]
v_pk_add_f32 v[188:189],v[188:189],v[180:181] neg_lo:[0,1] neg_hi:[0,1]
v_pk_fma_f32 v[180:181],v[182:183],2.0,v[184:185] op_sel_hi:[1,0,1]
v_pk_fma_f32 v[184:185],v[182:183],-2.0,v[184:185] op_sel_hi:[1,0,1]
v_cvt_pk_bf16_f32 v2,v176,v177
v_cvt_pk_bf16_f32 v6,v178,v179
v_cvt_pk_bf16_f32 v10,v188,v189
v_cvt_pk_bf16_f32 v14,v180,v181
v_cvt_pk_bf16_f32 v18,v184,v185
v_cvt_pk_bf16_f32 v22,v186,v187
buffer_load_dwordx4 v[72:75],v168,s[12:15],s28 offen offset:0
v_lshlrev_b32 v180,16,v11
v_and_b32 v181,s42,v11
v_lshlrev_b32 v176,16,v3
v_and_b32 v177,s42,v3
v_lshlrev_b32 v178,16,v7
v_and_b32 v179,s42,v7
v_lshlrev_b32 v186,16,v23
v_and_b32 v187,s42,v23
v_lshlrev_b32 v184,16,v19
v_and_b32 v185,s42,v19
v_lshlrev_b32 v182,16,v15
v_and_b32 v183,s42,v15
buffer_load_dwordx4 v[76:79],v168,s[8:11],s28 offen offset:0
v_pk_fma_f32 v[176:177],v[180:181],s[42:43],v[176:177] op_sel:[0,1,0] op_sel_hi:[1,1,1]
v_pk_fma_f32 v[186:187],v[178:179],4.0,v[186:187] op_sel_hi:[1,0,1]
v_pk_fma_f32 v[188:189],v[180:181],-4.0,v[184:185] op_sel_hi:[1,0,1]
v_pk_fma_f32 v[176:177],v[184:185],s[44:45],v[176:177] op_sel:[0,1,0] op_sel_hi:[1,1,1]
v_pk_fma_f32 v[186:187],v[182:183],s[40:41],v[186:187] op_sel:[0,1,0] op_sel_hi:[1,1,1]
v_pk_add_f32 v[184:185],v[184:185],v[180:181] neg_lo:[0,1] neg_hi:[0,1]
v_pk_fma_f32 v[180:181],v[178:179],-4.0,v[182:183] op_sel_hi:[1,0,1]
v_pk_add_f32 v[182:183],v[182:183],v[178:179] neg_lo:[0,1] neg_hi:[0,1]
v_pk_add_f32 v[178:179],v[188:189],v[180:181]
v_pk_add_f32 v[188:189],v[188:189],v[180:181] neg_lo:[0,1] neg_hi:[0,1]
v_pk_fma_f32 v[180:181],v[182:183],2.0,v[184:185] op_sel_hi:[1,0,1]
v_pk_fma_f32 v[184:185],v[182:183],-2.0,v[184:185] op_sel_hi:[1,0,1]
buffer_load_dwordx4 v[92:95],v168,s[16:19],s28 offen offset:1536
v_cvt_pk_bf16_f32 v3,v176,v177
v_cvt_pk_bf16_f32 v7,v178,v179
v_cvt_pk_bf16_f32 v11,v188,v189
v_cvt_pk_bf16_f32 v15,v180,v181
v_cvt_pk_bf16_f32 v19,v184,v185
v_cvt_pk_bf16_f32 v23,v186,v187
ds_write_b128 v172,v[0:3] offset:0
ds_write_b128 v171,v[4:7] offset:17408
ds_write_b128 v171,v[8:11] offset:26112
ds_write_b128 v171,v[12:15] offset:34816
ds_write_b128 v171,v[16:19] offset:43520
ds_write_b128 v172,v[20:23] offset:8704
buffer_load_dwordx4 v[88:91],v168,s[8:11],s28 offen offset:1152
s_waitcnt vmcnt(16)
v_lshlrev_b32 v180,16,v32
v_and_b32 v181,s42,v32
s_waitcnt vmcnt(15)
v_lshlrev_b32 v176,16,v24
v_and_b32 v177,s42,v24
s_waitcnt vmcnt(14)
v_lshlrev_b32 v178,16,v28
v_and_b32 v179,s42,v28
buffer_load_dwordx4 v[84:87],v168,s[8:11],s28 offen offset:768
s_waitcnt vmcnt(14)
v_lshlrev_b32 v186,16,v44
v_and_b32 v187,s42,v44
s_waitcnt vmcnt(13)
v_lshlrev_b32 v184,16,v40
v_and_b32 v185,s42,v40
s_waitcnt vmcnt(12)
v_lshlrev_b32 v182,16,v36
v_and_b32 v183,s42,v36
v_pk_fma_f32 v[176:177],v[180:181],s[42:43],v[176:177] op_sel:[0,1,0] op_sel_hi:[1,1,1]
v_pk_fma_f32 v[186:187],v[178:179],4.0,v[186:187] op_sel_hi:[1,0,1]
v_pk_fma_f32 v[188:189],v[180:181],-4.0,v[184:185] op_sel_hi:[1,0,1]
v_pk_fma_f32 v[176:177],v[184:185],s[44:45],v[176:177] op_sel:[0,1,0] op_sel_hi:[1,1,1]
v_pk_fma_f32 v[186:187],v[182:183],s[40:41],v[186:187] op_sel:[0,1,0] op_sel_hi:[1,1,1]
v_pk_add_f32 v[184:185],v[184:185],v[180:181] neg_lo:[0,1] neg_hi:[0,1]
buffer_load_dword v96,v170,s[12:15],s30 offen offset:0
v_pk_fma_f32 v[180:181],v[178:179],-4.0,v[182:183] op_sel_hi:[1,0,1]
v_pk_add_f32 v[182:183],v[182:183],v[178:179] neg_lo:[0,1] neg_hi:[0,1]
v_pk_add_f32 v[178:179],v[188:189],v[180:181]
v_pk_add_f32 v[188:189],v[188:189],v[180:181] neg_lo:[0,1] neg_hi:[0,1]
v_pk_fma_f32 v[180:181],v[182:183],2.0,v[184:185] op_sel_hi:[1,0,1]
v_pk_fma_f32 v[184:185],v[182:183],-2.0,v[184:185] op_sel_hi:[1,0,1]
v_cvt_pk_bf16_f32 v24,v176,v177
v_cvt_pk_bf16_f32 v28,v178,v179
v_cvt_pk_bf16_f32 v32,v188,v189
v_cvt_pk_bf16_f32 v36,v180,v181
v_cvt_pk_bf16_f32 v40,v184,v185
v_cvt_pk_bf16_f32 v44,v186,v187
buffer_load_dword v97,v170,s[8:11],s30 offen offset:0
v_lshlrev_b32 v180,16,v33
v_and_b32 v181,s42,v33
v_lshlrev_b32 v176,16,v25
v_and_b32 v177,s42,v25
v_lshlrev_b32 v178,16,v29
v_and_b32 v179,s42,v29
v_lshlrev_b32 v186,16,v45
v_and_b32 v187,s42,v45
v_lshlrev_b32 v184,16,v41
v_and_b32 v185,s42,v41
v_lshlrev_b32 v182,16,v37
v_and_b32 v183,s42,v37
buffer_load_dword v98,v170,s[8:11],s30 offen offset:384
v_pk_fma_f32 v[176:177],v[180:181],s[42:43],v[176:177] op_sel:[0,1,0] op_sel_hi:[1,1,1]
v_pk_fma_f32 v[186:187],v[178:179],4.0,v[186:187] op_sel_hi:[1,0,1]
v_pk_fma_f32 v[188:189],v[180:181],-4.0,v[184:185] op_sel_hi:[1,0,1]
v_pk_fma_f32 v[176:177],v[184:185],s[44:45],v[176:177] op_sel:[0,1,0] op_sel_hi:[1,1,1]
v_pk_fma_f32 v[186:187],v[182:183],s[40:41],v[186:187] op_sel:[0,1,0] op_sel_hi:[1,1,1]
v_pk_add_f32 v[184:185],v[184:185],v[180:181] neg_lo:[0,1] neg_hi:[0,1]
v_pk_fma_f32 v[180:181],v[178:179],-4.0,v[182:183] op_sel_hi:[1,0,1]
v_pk_add_f32 v[182:183],v[182:183],v[178:179] neg_lo:[0,1] neg_hi:[0,1]
v_pk_add_f32 v[178:179],v[188:189],v[180:181]
v_pk_add_f32 v[188:189],v[188:189],v[180:181] neg_lo:[0,1] neg_hi:[0,1]
v_pk_fma_f32 v[180:181],v[182:183],2.0,v[184:185] op_sel_hi:[1,0,1]
v_pk_fma_f32 v[184:185],v[182:183],-2.0,v[184:185] op_sel_hi:[1,0,1]
buffer_load_dword v99,v170,s[8:11],s30 offen offset:768
v_cvt_pk_bf16_f32 v25,v176,v177
v_cvt_pk_bf16_f32 v29,v178,v179
v_cvt_pk_bf16_f32 v33,v188,v189
v_cvt_pk_bf16_f32 v37,v180,v181
v_cvt_pk_bf16_f32 v41,v184,v185
v_cvt_pk_bf16_f32 v45,v186,v187
v_lshlrev_b32 v180,16,v34
v_and_b32 v181,s42,v34
v_lshlrev_b32 v176,16,v26
v_and_b32 v177,s42,v26
v_lshlrev_b32 v178,16,v30
v_and_b32 v179,s42,v30
buffer_load_dword v100,v170,s[8:11],s30 offen offset:1152
v_lshlrev_b32 v186,16,v46
v_and_b32 v187,s42,v46
v_lshlrev_b32 v184,16,v42
v_and_b32 v185,s42,v42
v_lshlrev_b32 v182,16,v38
v_and_b32 v183,s42,v38
v_pk_fma_f32 v[176:177],v[180:181],s[42:43],v[176:177] op_sel:[0,1,0] op_sel_hi:[1,1,1]
v_pk_fma_f32 v[186:187],v[178:179],4.0,v[186:187] op_sel_hi:[1,0,1]
v_pk_fma_f32 v[188:189],v[180:181],-4.0,v[184:185] op_sel_hi:[1,0,1]
v_pk_fma_f32 v[176:177],v[184:185],s[44:45],v[176:177] op_sel:[0,1,0] op_sel_hi:[1,1,1]
v_pk_fma_f32 v[186:187],v[182:183],s[40:41],v[186:187] op_sel:[0,1,0] op_sel_hi:[1,1,1]
v_pk_add_f32 v[184:185],v[184:185],v[180:181] neg_lo:[0,1] neg_hi:[0,1]
buffer_load_dword v101,v170,s[16:19],s30 offen offset:1536
v_pk_fma_f32 v[180:181],v[178:179],-4.0,v[182:183] op_sel_hi:[1,0,1]
v_pk_add_f32 v[182:183],v[182:183],v[178:179] neg_lo:[0,1] neg_hi:[0,1]
v_pk_add_f32 v[178:179],v[188:189],v[180:181]
v_pk_add_f32 v[188:189],v[188:189],v[180:181] neg_lo:[0,1] neg_hi:[0,1]
v_pk_fma_f32 v[180:181],v[182:183],2.0,v[184:185] op_sel_hi:[1,0,1]
v_pk_fma_f32 v[184:185],v[182:183],-2.0,v[184:185] op_sel_hi:[1,0,1]
v_cvt_pk_bf16_f32 v26,v176,v177
v_cvt_pk_bf16_f32 v30,v178,v179
v_cvt_pk_bf16_f32 v34,v188,v189
v_cvt_pk_bf16_f32 v38,v180,v181
v_cvt_pk_bf16_f32 v42,v184,v185
v_cvt_pk_bf16_f32 v46,v186,v187
v_lshlrev_b32 v180,16,v35
v_and_b32 v181,s42,v35
v_lshlrev_b32 v176,16,v27
v_and_b32 v177,s42,v27
v_lshlrev_b32 v178,16,v31
v_and_b32 v179,s42,v31
v_lshlrev_b32 v186,16,v47
v_and_b32 v187,s42,v47
v_lshlrev_b32 v184,16,v43
v_and_b32 v185,s42,v43
v_lshlrev_b32 v182,16,v39
v_and_b32 v183,s42,v39
v_pk_fma_f32 v[176:177],v[180:181],s[42:43],v[176:177] op_sel:[0,1,0] op_sel_hi:[1,1,1]
v_pk_fma_f32 v[186:187],v[178:179],4.0,v[186:187] op_sel_hi:[1,0,1]
v_pk_fma_f32 v[188:189],v[180:181],-4.0,v[184:185] op_sel_hi:[1,0,1]
v_pk_fma_f32 v[176:177],v[184:185],s[44:45],v[176:177] op_sel:[0,1,0] op_sel_hi:[1,1,1]
v_pk_fma_f32 v[186:187],v[182:183],s[40:41],v[186:187] op_sel:[0,1,0] op_sel_hi:[1,1,1]
v_pk_add_f32 v[184:185],v[184:185],v[180:181] neg_lo:[0,1] neg_hi:[0,1]
v_pk_fma_f32 v[180:181],v[178:179],-4.0,v[182:183] op_sel_hi:[1,0,1]
v_pk_add_f32 v[182:183],v[182:183],v[178:179] neg_lo:[0,1] neg_hi:[0,1]
v_pk_add_f32 v[178:179],v[188:189],v[180:181]
v_pk_add_f32 v[188:189],v[188:189],v[180:181] neg_lo:[0,1] neg_hi:[0,1]
v_pk_fma_f32 v[180:181],v[182:183],2.0,v[184:185] op_sel_hi:[1,0,1]
v_pk_fma_f32 v[184:185],v[182:183],-2.0,v[184:185] op_sel_hi:[1,0,1]
v_cvt_pk_bf16_f32 v27,v176,v177
v_cvt_pk_bf16_f32 v31,v178,v179
v_cvt_pk_bf16_f32 v35,v188,v189
v_cvt_pk_bf16_f32 v39,v180,v181
v_cvt_pk_bf16_f32 v43,v184,v185
v_cvt_pk_bf16_f32 v47,v186,v187
ds_write_b128 v172,v[24:27] offset:512
ds_write_b128 v171,v[28:31] offset:17920
ds_write_b128 v171,v[32:35] offset:26624
ds_write_b128 v171,v[36:39] offset:35328
ds_write_b128 v171,v[40:43] offset:44032
ds_write_b128 v172,v[44:47] offset:9216
s_waitcnt vmcnt(17)
v_lshlrev_b32 v180,16,v56
v_and_b32 v181,s42,v56
s_waitcnt vmcnt(16)
v_lshlrev_b32 v176,16,v48
v_and_b32 v177,s42,v48
s_waitcnt vmcnt(15)
v_lshlrev_b32 v178,16,v52
v_and_b32 v179,s42,v52
s_waitcnt vmcnt(14)
v_lshlrev_b32 v186,16,v68
v_and_b32 v187,s42,v68
s_waitcnt vmcnt(13)
v_lshlrev_b32 v184,16,v64
v_and_b32 v185,s42,v64
s_waitcnt vmcnt(12)
v_lshlrev_b32 v182,16,v60
v_and_b32 v183,s42,v60
v_pk_fma_f32 v[176:177],v[180:181],s[42:43],v[176:177] op_sel:[0,1,0] op_sel_hi:[1,1,1]
v_pk_fma_f32 v[186:187],v[178:179],4.0,v[186:187] op_sel_hi:[1,0,1]
v_pk_fma_f32 v[188:189],v[180:181],-4.0,v[184:185] op_sel_hi:[1,0,1]
v_pk_fma_f32 v[176:177],v[184:185],s[44:45],v[176:177] op_sel:[0,1,0] op_sel_hi:[1,1,1]
v_pk_fma_f32 v[186:187],v[182:183],s[40:41],v[186:187] op_sel:[0,1,0] op_sel_hi:[1,1,1]
v_pk_add_f32 v[184:185],v[184:185],v[180:181] neg_lo:[0,1] neg_hi:[0,1]
v_pk_fma_f32 v[180:181],v[178:179],-4.0,v[182:183] op_sel_hi:[1,0,1]
v_pk_add_f32 v[182:183],v[182:183],v[178:179] neg_lo:[0,1] neg_hi:[0,1]
v_pk_add_f32 v[178:179],v[188:189],v[180:181]
v_pk_add_f32 v[188:189],v[188:189],v[180:181] neg_lo:[0,1] neg_hi:[0,1]
v_pk_fma_f32 v[180:181],v[182:183],2.0,v[184:185] op_sel_hi:[1,0,1]
v_pk_fma_f32 v[184:185],v[182:183],-2.0,v[184:185] op_sel_hi:[1,0,1]
v_cvt_pk_bf16_f32 v48,v176,v177
v_cvt_pk_bf16_f32 v52,v178,v179
v_cvt_pk_bf16_f32 v56,v188,v189
v_cvt_pk_bf16_f32 v60,v180,v181
v_cvt_pk_bf16_f32 v64,v184,v185
v_cvt_pk_bf16_f32 v68,v186,v187
v_lshlrev_b32 v180,16,v57
v_and_b32 v181,s42,v57
v_lshlrev_b32 v176,16,v49
v_and_b32 v177,s42,v49
v_lshlrev_b32 v178,16,v53
v_and_b32 v179,s42,v53
v_lshlrev_b32 v186,16,v69
v_and_b32 v187,s42,v69
v_lshlrev_b32 v184,16,v65
v_and_b32 v185,s42,v65
v_lshlrev_b32 v182,16,v61
v_and_b32 v183,s42,v61
v_pk_fma_f32 v[176:177],v[180:181],s[42:43],v[176:177] op_sel:[0,1,0] op_sel_hi:[1,1,1]
v_pk_fma_f32 v[186:187],v[178:179],4.0,v[186:187] op_sel_hi:[1,0,1]
v_pk_fma_f32 v[188:189],v[180:181],-4.0,v[184:185] op_sel_hi:[1,0,1]
v_pk_fma_f32 v[176:177],v[184:185],s[44:45],v[176:177] op_sel:[0,1,0] op_sel_hi:[1,1,1]
v_pk_fma_f32 v[186:187],v[182:183],s[40:41],v[186:187] op_sel:[0,1,0] op_sel_hi:[1,1,1]
v_pk_add_f32 v[184:185],v[184:185],v[180:181] neg_lo:[0,1] neg_hi:[0,1]
v_pk_fma_f32 v[180:181],v[178:179],-4.0,v[182:183] op_sel_hi:[1,0,1]
v_pk_add_f32 v[182:183],v[182:183],v[178:179] neg_lo:[0,1] neg_hi:[0,1]
v_pk_add_f32 v[178:179],v[188:189],v[180:181]
v_pk_add_f32 v[188:189],v[188:189],v[180:181] neg_lo:[0,1] neg_hi:[0,1]
v_pk_fma_f32 v[180:181],v[182:183],2.0,v[184:185] op_sel_hi:[1,0,1]
v_pk_fma_f32 v[184:185],v[182:183],-2.0,v[184:185] op_sel_hi:[1,0,1]
v_cvt_pk_bf16_f32 v49,v176,v177
v_cvt_pk_bf16_f32 v53,v178,v179
v_cvt_pk_bf16_f32 v57,v188,v189
v_cvt_pk_bf16_f32 v61,v180,v181
v_cvt_pk_bf16_f32 v65,v184,v185
v_cvt_pk_bf16_f32 v69,v186,v187
v_lshlrev_b32 v180,16,v58
v_and_b32 v181,s42,v58
v_lshlrev_b32 v176,16,v50
v_and_b32 v177,s42,v50
v_lshlrev_b32 v178,16,v54
v_and_b32 v179,s42,v54
v_lshlrev_b32 v186,16,v70
v_and_b32 v187,s42,v70
v_lshlrev_b32 v184,16,v66
v_and_b32 v185,s42,v66
v_lshlrev_b32 v182,16,v62
v_and_b32 v183,s42,v62
v_pk_fma_f32 v[176:177],v[180:181],s[42:43],v[176:177] op_sel:[0,1,0] op_sel_hi:[1,1,1]
v_pk_fma_f32 v[186:187],v[178:179],4.0,v[186:187] op_sel_hi:[1,0,1]
v_pk_fma_f32 v[188:189],v[180:181],-4.0,v[184:185] op_sel_hi:[1,0,1]
v_pk_fma_f32 v[176:177],v[184:185],s[44:45],v[176:177] op_sel:[0,1,0] op_sel_hi:[1,1,1]
v_pk_fma_f32 v[186:187],v[182:183],s[40:41],v[186:187] op_sel:[0,1,0] op_sel_hi:[1,1,1]
v_pk_add_f32 v[184:185],v[184:185],v[180:181] neg_lo:[0,1] neg_hi:[0,1]
v_pk_fma_f32 v[180:181],v[178:179],-4.0,v[182:183] op_sel_hi:[1,0,1]
v_pk_add_f32 v[182:183],v[182:183],v[178:179] neg_lo:[0,1] neg_hi:[0,1]
v_pk_add_f32 v[178:179],v[188:189],v[180:181]
v_pk_add_f32 v[188:189],v[188:189],v[180:181] neg_lo:[0,1] neg_hi:[0,1]
v_pk_fma_f32 v[180:181],v[182:183],2.0,v[184:185] op_sel_hi:[1,0,1]
v_pk_fma_f32 v[184:185],v[182:183],-2.0,v[184:185] op_sel_hi:[1,0,1]
v_cvt_pk_bf16_f32 v50,v176,v177
v_cvt_pk_bf16_f32 v54,v178,v179
v_cvt_pk_bf16_f32 v58,v188,v189
v_cvt_pk_bf16_f32 v62,v180,v181
v_cvt_pk_bf16_f32 v66,v184,v185
v_cvt_pk_bf16_f32 v70,v186,v187
v_lshlrev_b32 v180,16,v59
v_and_b32 v181,s42,v59
v_lshlrev_b32 v176,16,v51
v_and_b32 v177,s42,v51
v_lshlrev_b32 v178,16,v55
v_and_b32 v179,s42,v55
v_lshlrev_b32 v186,16,v71
v_and_b32 v187,s42,v71
v_lshlrev_b32 v184,16,v67
v_and_b32 v185,s42,v67
v_lshlrev_b32 v182,16,v63
v_and_b32 v183,s42,v63
v_pk_fma_f32 v[176:177],v[180:181],s[42:43],v[176:177] op_sel:[0,1,0] op_sel_hi:[1,1,1]
v_pk_fma_f32 v[186:187],v[178:179],4.0,v[186:187] op_sel_hi:[1,0,1]
v_pk_fma_f32 v[188:189],v[180:181],-4.0,v[184:185] op_sel_hi:[1,0,1]
v_pk_fma_f32 v[176:177],v[184:185],s[44:45],v[176:177] op_sel:[0,1,0] op_sel_hi:[1,1,1]
v_pk_fma_f32 v[186:187],v[182:183],s[40:41],v[186:187] op_sel:[0,1,0] op_sel_hi:[1,1,1]
v_pk_add_f32 v[184:185],v[184:185],v[180:181] neg_lo:[0,1] neg_hi:[0,1]
v_pk_fma_f32 v[180:181],v[178:179],-4.0,v[182:183] op_sel_hi:[1,0,1]
v_pk_add_f32 v[182:183],v[182:183],v[178:179] neg_lo:[0,1] neg_hi:[0,1]
v_pk_add_f32 v[178:179],v[188:189],v[180:181]
v_pk_add_f32 v[188:189],v[188:189],v[180:181] neg_lo:[0,1] neg_hi:[0,1]
v_pk_fma_f32 v[180:181],v[182:183],2.0,v[184:185] op_sel_hi:[1,0,1]
v_pk_fma_f32 v[184:185],v[182:183],-2.0,v[184:185] op_sel_hi:[1,0,1]
v_cvt_pk_bf16_f32 v51,v176,v177
v_cvt_pk_bf16_f32 v55,v178,v179
v_cvt_pk_bf16_f32 v59,v188,v189
v_cvt_pk_bf16_f32 v63,v180,v181
v_cvt_pk_bf16_f32 v67,v184,v185
v_cvt_pk_bf16_f32 v71,v186,v187
ds_write_b128 v172,v[48:51] offset:1024
ds_write_b128 v171,v[52:55] offset:18432
ds_write_b128 v171,v[56:59] offset:27136
ds_write_b128 v171,v[60:63] offset:35840
ds_write_b128 v171,v[64:67] offset:44544
ds_write_b128 v172,v[68:71] offset:9728
s_waitcnt vmcnt(11)
v_lshlrev_b32 v180,16,v80
v_and_b32 v181,s42,v80
s_waitcnt vmcnt(10)
v_lshlrev_b32 v176,16,v72
v_and_b32 v177,s42,v72
s_waitcnt vmcnt(9)
v_lshlrev_b32 v178,16,v76
v_and_b32 v179,s42,v76
s_waitcnt vmcnt(8)
v_lshlrev_b32 v186,16,v92
v_and_b32 v187,s42,v92
s_waitcnt vmcnt(7)
v_lshlrev_b32 v184,16,v88
v_and_b32 v185,s42,v88
s_waitcnt vmcnt(6)
v_lshlrev_b32 v182,16,v84
v_and_b32 v183,s42,v84
v_pk_fma_f32 v[176:177],v[180:181],s[42:43],v[176:177] op_sel:[0,1,0] op_sel_hi:[1,1,1]
v_pk_fma_f32 v[186:187],v[178:179],4.0,v[186:187] op_sel_hi:[1,0,1]
v_pk_fma_f32 v[188:189],v[180:181],-4.0,v[184:185] op_sel_hi:[1,0,1]
v_pk_fma_f32 v[176:177],v[184:185],s[44:45],v[176:177] op_sel:[0,1,0] op_sel_hi:[1,1,1]
v_pk_fma_f32 v[186:187],v[182:183],s[40:41],v[186:187] op_sel:[0,1,0] op_sel_hi:[1,1,1]
v_pk_add_f32 v[184:185],v[184:185],v[180:181] neg_lo:[0,1] neg_hi:[0,1]
v_pk_fma_f32 v[180:181],v[178:179],-4.0,v[182:183] op_sel_hi:[1,0,1]
v_pk_add_f32 v[182:183],v[182:183],v[178:179] neg_lo:[0,1] neg_hi:[0,1]
v_pk_add_f32 v[178:179],v[188:189],v[180:181]
v_pk_add_f32 v[188:189],v[188:189],v[180:181] neg_lo:[0,1] neg_hi:[0,1]
v_pk_fma_f32 v[180:181],v[182:183],2.0,v[184:185] op_sel_hi:[1,0,1]
v_pk_fma_f32 v[184:185],v[182:183],-2.0,v[184:185] op_sel_hi:[1,0,1]
v_cvt_pk_bf16_f32 v72,v176,v177
v_cvt_pk_bf16_f32 v76,v178,v179
v_cvt_pk_bf16_f32 v80,v188,v189
v_cvt_pk_bf16_f32 v84,v180,v181
v_cvt_pk_bf16_f32 v88,v184,v185
v_cvt_pk_bf16_f32 v92,v186,v187
v_lshlrev_b32 v180,16,v81
v_and_b32 v181,s42,v81
v_lshlrev_b32 v176,16,v73
v_and_b32 v177,s42,v73
v_lshlrev_b32 v178,16,v77
v_and_b32 v179,s42,v77
v_lshlrev_b32 v186,16,v93
v_and_b32 v187,s42,v93
v_lshlrev_b32 v184,16,v89
v_and_b32 v185,s42,v89
v_lshlrev_b32 v182,16,v85
v_and_b32 v183,s42,v85
v_pk_fma_f32 v[176:177],v[180:181],s[42:43],v[176:177] op_sel:[0,1,0] op_sel_hi:[1,1,1]
v_pk_fma_f32 v[186:187],v[178:179],4.0,v[186:187] op_sel_hi:[1,0,1]
v_pk_fma_f32 v[188:189],v[180:181],-4.0,v[184:185] op_sel_hi:[1,0,1]
v_pk_fma_f32 v[176:177],v[184:185],s[44:45],v[176:177] op_sel:[0,1,0] op_sel_hi:[1,1,1]
v_pk_fma_f32 v[186:187],v[182:183],s[40:41],v[186:187] op_sel:[0,1,0] op_sel_hi:[1,1,1]
v_pk_add_f32 v[184:185],v[184:185],v[180:181] neg_lo:[0,1] neg_hi:[0,1]
v_pk_fma_f32 v[180:181],v[178:179],-4.0,v[182:183] op_sel_hi:[1,0,1]
v_pk_add_f32 v[182:183],v[182:183],v[178:179] neg_lo:[0,1] neg_hi:[0,1]
v_pk_add_f32 v[178:179],v[188:189],v[180:181]
v_pk_add_f32 v[188:189],v[188:189],v[180:181] neg_lo:[0,1] neg_hi:[0,1]
v_pk_fma_f32 v[180:181],v[182:183],2.0,v[184:185] op_sel_hi:[1,0,1]
v_pk_fma_f32 v[184:185],v[182:183],-2.0,v[184:185] op_sel_hi:[1,0,1]
v_cvt_pk_bf16_f32 v73,v176,v177
v_cvt_pk_bf16_f32 v77,v178,v179
v_cvt_pk_bf16_f32 v81,v188,v189
v_cvt_pk_bf16_f32 v85,v180,v181
v_cvt_pk_bf16_f32 v89,v184,v185
v_cvt_pk_bf16_f32 v93,v186,v187
v_lshlrev_b32 v180,16,v82
v_and_b32 v181,s42,v82
v_lshlrev_b32 v176,16,v74
v_and_b32 v177,s42,v74
v_lshlrev_b32 v178,16,v78
v_and_b32 v179,s42,v78
v_lshlrev_b32 v186,16,v94
v_and_b32 v187,s42,v94
v_lshlrev_b32 v184,16,v90
v_and_b32 v185,s42,v90
v_lshlrev_b32 v182,16,v86
v_and_b32 v183,s42,v86
v_pk_fma_f32 v[176:177],v[180:181],s[42:43],v[176:177] op_sel:[0,1,0] op_sel_hi:[1,1,1]
v_pk_fma_f32 v[186:187],v[178:179],4.0,v[186:187] op_sel_hi:[1,0,1]
v_pk_fma_f32 v[188:189],v[180:181],-4.0,v[184:185] op_sel_hi:[1,0,1]
v_pk_fma_f32 v[176:177],v[184:185],s[44:45],v[176:177] op_sel:[0,1,0] op_sel_hi:[1,1,1]
v_pk_fma_f32 v[186:187],v[182:183],s[40:41],v[186:187] op_sel:[0,1,0] op_sel_hi:[1,1,1]
v_pk_add_f32 v[184:185],v[184:185],v[180:181] neg_lo:[0,1] neg_hi:[0,1]
v_pk_fma_f32 v[180:181],v[178:179],-4.0,v[182:183] op_sel_hi:[1,0,1]
v_pk_add_f32 v[182:183],v[182:183],v[178:179] neg_lo:[0,1] neg_hi:[0,1]
v_pk_add_f32 v[178:179],v[188:189],v[180:181]
v_pk_add_f32 v[188:189],v[188:189],v[180:181] neg_lo:[0,1] neg_hi:[0,1]
v_pk_fma_f32 v[180:181],v[182:183],2.0,v[184:185] op_sel_hi:[1,0,1]
v_pk_fma_f32 v[184:185],v[182:183],-2.0,v[184:185] op_sel_hi:[1,0,1]
v_cvt_pk_bf16_f32 v74,v176,v177
v_cvt_pk_bf16_f32 v78,v178,v179
v_cvt_pk_bf16_f32 v82,v188,v189
v_cvt_pk_bf16_f32 v86,v180,v181
v_cvt_pk_bf16_f32 v90,v184,v185
v_cvt_pk_bf16_f32 v94,v186,v187
v_lshlrev_b32 v180,16,v83
v_and_b32 v181,s42,v83
v_lshlrev_b32 v176,16,v75
v_and_b32 v177,s42,v75
v_lshlrev_b32 v178,16,v79
v_and_b32 v179,s42,v79
v_lshlrev_b32 v186,16,v95
v_and_b32 v187,s42,v95
v_lshlrev_b32 v184,16,v91
v_and_b32 v185,s42,v91
v_lshlrev_b32 v182,16,v87
v_and_b32 v183,s42,v87
v_pk_fma_f32 v[176:177],v[180:181],s[42:43],v[176:177] op_sel:[0,1,0] op_sel_hi:[1,1,1]
v_pk_fma_f32 v[186:187],v[178:179],4.0,v[186:187] op_sel_hi:[1,0,1]
v_pk_fma_f32 v[188:189],v[180:181],-4.0,v[184:185] op_sel_hi:[1,0,1]
v_pk_fma_f32 v[176:177],v[184:185],s[44:45],v[176:177] op_sel:[0,1,0] op_sel_hi:[1,1,1]
v_pk_fma_f32 v[186:187],v[182:183],s[40:41],v[186:187] op_sel:[0,1,0] op_sel_hi:[1,1,1]
v_pk_add_f32 v[184:185],v[184:185],v[180:181] neg_lo:[0,1] neg_hi:[0,1]
v_pk_fma_f32 v[180:181],v[178:179],-4.0,v[182:183] op_sel_hi:[1,0,1]
v_pk_add_f32 v[182:183],v[182:183],v[178:179] neg_lo:[0,1] neg_hi:[0,1]
v_pk_add_f32 v[178:179],v[188:189],v[180:181]
v_pk_add_f32 v[188:189],v[188:189],v[180:181] neg_lo:[0,1] neg_hi:[0,1]
v_pk_fma_f32 v[180:181],v[182:183],2.0,v[184:185] op_sel_hi:[1,0,1]
v_pk_fma_f32 v[184:185],v[182:183],-2.0,v[184:185] op_sel_hi:[1,0,1]
v_cvt_pk_bf16_f32 v75,v176,v177
v_cvt_pk_bf16_f32 v79,v178,v179
v_cvt_pk_bf16_f32 v83,v188,v189
v_cvt_pk_bf16_f32 v87,v180,v181
v_cvt_pk_bf16_f32 v91,v184,v185
v_cvt_pk_bf16_f32 v95,v186,v187
ds_write_b128 v172,v[72:75] offset:1536
ds_write_b128 v171,v[76:79] offset:18944
ds_write_b128 v171,v[80:83] offset:27648
ds_write_b128 v171,v[84:87] offset:36352
ds_write_b128 v171,v[88:91] offset:45056
ds_write_b128 v172,v[92:95] offset:10240
s_waitcnt vmcnt(3)
v_lshlrev_b32 v180,16,v98
v_and_b32 v181,s42,v98
v_lshlrev_b32 v176,16,v96
v_and_b32 v177,s42,v96
v_lshlrev_b32 v178,16,v97
v_and_b32 v179,s42,v97
s_waitcnt vmcnt(0)
v_lshlrev_b32 v186,16,v101
v_and_b32 v187,s42,v101
v_lshlrev_b32 v184,16,v100
v_and_b32 v185,s42,v100
v_lshlrev_b32 v182,16,v99
v_and_b32 v183,s42,v99
v_pk_fma_f32 v[176:177],v[180:181],s[42:43],v[176:177] op_sel:[0,1,0] op_sel_hi:[1,1,1]
v_pk_fma_f32 v[186:187],v[178:179],4.0,v[186:187] op_sel_hi:[1,0,1]
v_pk_fma_f32 v[188:189],v[180:181],-4.0,v[184:185] op_sel_hi:[1,0,1]
v_pk_fma_f32 v[176:177],v[184:185],s[44:45],v[176:177] op_sel:[0,1,0] op_sel_hi:[1,1,1]
v_pk_fma_f32 v[186:187],v[182:183],s[40:41],v[186:187] op_sel:[0,1,0] op_sel_hi:[1,1,1]
v_pk_add_f32 v[184:185],v[184:185],v[180:181] neg_lo:[0,1] neg_hi:[0,1]
v_pk_fma_f32 v[180:181],v[178:179],-4.0,v[182:183] op_sel_hi:[1,0,1]
v_pk_add_f32 v[182:183],v[182:183],v[178:179] neg_lo:[0,1] neg_hi:[0,1]
v_pk_add_f32 v[178:179],v[188:189],v[180:181]
v_pk_add_f32 v[188:189],v[188:189],v[180:181] neg_lo:[0,1] neg_hi:[0,1]
v_pk_fma_f32 v[180:181],v[182:183],2.0,v[184:185] op_sel_hi:[1,0,1]
v_pk_fma_f32 v[184:185],v[182:183],-2.0,v[184:185] op_sel_hi:[1,0,1]
v_cvt_pk_bf16_f32 v96,v176,v177
v_cvt_pk_bf16_f32 v97,v178,v179
v_cvt_pk_bf16_f32 v98,v188,v189
v_cvt_pk_bf16_f32 v99,v180,v181
v_cvt_pk_bf16_f32 v100,v184,v185
v_cvt_pk_bf16_f32 v101,v186,v187
ds_write_b32 v174,v96 offset:0
ds_write_b32 v173,v97 offset:17408
ds_write_b32 v173,v98 offset:26112
ds_write_b32 v173,v99 offset:34816
ds_write_b32 v173,v100 offset:43520
ds_write_b32 v174,v101 offset:8704
s_waitcnt lgkmcnt(0)
s_barrier
ds_read_b128 a[192:195],v248 offset:17408
ds_read_b128 a[196:199],v249 offset:17408
ds_read_b128 a[200:203],v248 offset:17920
ds_read_b128 a[204:207],v249 offset:17920
v_and_b32 v165,1,v164
v_lshlrev_b32 v165,2,v165
s_mov_b32 s84,0
L_poll:
global_load_dword v166,v165,s[52:53] offset:128 sc1
s_add_u32 s84,s84,1
s_waitcnt vmcnt(0)
v_cmp_eq_u32 vcc,0,v166
s_cmp_gt_u32 s84,0x4000
s_cbranch_scc1 L_fallback
s_cbranch_vccnz L_poll
L_uready:
s_add_u32 s46,s72,9216
buffer_load_dwordx4 a[96:99],v250,s[20:23],s46 offen offset:0 sc1
buffer_load_dwordx4 a[100:103],v250,s[20:23],s46 offen offset:1024 sc1
buffer_load_dwordx4 a[104:107],v250,s[20:23],s46 offen offset:2048 sc1
s_add_u32 s47,s72,12288
buffer_load_dwordx4 a[108:111],v250,s[20:23],s47 offen offset:0 sc1
buffer_load_dwordx4 a[112:115],v250,s[20:23],s47 offen offset:1024 sc1
buffer_load_dwordx4 a[116:119],v250,s[20:23],s47 offen offset:2048 sc1
s_add_u32 s48,s72,15360
buffer_load_dwordx4 a[120:123],v250,s[20:23],s48 offen offset:0 sc1
buffer_load_dwordx4 a[124:127],v250,s[20:23],s48 offen offset:1024 sc1
buffer_load_dwordx4 a[128:131],v250,s[20:23],s48 offen offset:2048 sc1
s_getpc_b64 s[62:63]
L_pc2:
s_sub_u32 s62,s62,L_pc2-L_pc
s_subb_u32 s63,s63,0
s_lshr_b32 s61,s2,3
s_waitcnt vmcnt(8) lgkmcnt(3)
M a[0:3],a[96:99],a[192:195],0
s_waitcnt vmcnt(7) lgkmcnt(2)
s_add_u32 s46,s72,18432
buffer_load_dwordx4 a[132:135],v250,s[20:23],s46 offen offset:0 sc1
M a[0:3],a[100:103],a[196:199],a[0:3]
s_waitcnt vmcnt(7) lgkmcnt(1)
ds_read_b128 a[208:211],v248 offset:18432
ds_read_b128 a[212:215],v249 offset:18432
M a[0:3],a[104:107],a[200:203],a[0:3]
s_waitcnt lgkmcnt(2)
buffer_load_dwordx4 a[136:139],v250,s[20:23],s46 offen offset:1024 sc1
M a[4:7],a[104:107],a[204:207],0
M a[4:7],a[100:103],a[200:203],a[4:7]
M a[4:7],a[96:99],a[196:199],a[4:7]
M a[8:11],a[96:99],a[200:203],0
buffer_load_dwordx4 a[140:143],v250,s[20:23],s46 offen offset:2048 sc1
M a[8:11],a[100:103],a[204:207],a[8:11]
s_waitcnt lgkmcnt(1)
s_add_u32 s47,s72,21504
ds_read_b128 a[216:219],v248 offset:18944
ds_read_b128 a[220:223],v249 offset:18944
M a[8:11],a[104:107],a[208:211],a[8:11]
s_waitcnt lgkmcnt(2)
M a[12:15],a[104:107],a[212:215],0
M a[12:15],a[100:103],a[208:211],a[12:15]
buffer_load_dwordx4 a[164:167],v250,s[20:23],s47 offen offset:0 sc1
M a[12:15],a[96:99],a[204:207],a[12:15]
M a[16:19],a[96:99],a[208:211],0
ds_read_b128 a[224:227],v249 offset:19456
M a[16:19],a[100:103],a[212:215],a[16:19]
s_waitcnt lgkmcnt(2)
ds_read_b128 a[228:231],v248 offset:19456
M a[16:19],a[104:107],a[216:219],a[16:19]
s_waitcnt lgkmcnt(2)
buffer_load_dwordx4 a[160:163],v250,s[20:23],s47 offen offset:1024 sc1
M a[20:23],a[104:107],a[220:223],0
M a[20:23],a[100:103],a[216:219],a[20:23]
M a[20:23],a[96:99],a[212:215],a[20:23]
M a[24:27],a[96:99],a[216:219],0
buffer_load_dwordx4 a[168:171],v250,s[20:23],s47 offen offset:2048 sc1
M a[24:27],a[100:103],a[220:223],a[24:27]
s_waitcnt lgkmcnt(1)
s_add_u32 s48,s72,24576
M a[24:27],a[104:107],a[224:227],a[24:27]
s_waitcnt lgkmcnt(0)
M a[28:31],a[104:107],a[228:231],0
M a[28:31],a[100:103],a[224:227],a[28:31]
buffer_load_dwordx4 v[4:7],v250,s[20:23],s48 offen offset:0 sc1
M a[28:31],a[96:99],a[220:223],a[28:31]
s_waitcnt vmcnt(12)
M a[32:35],a[108:111],a[192:195],0
s_waitcnt vmcnt(11)
M a[32:35],a[112:115],a[196:199],a[32:35]
s_waitcnt vmcnt(10)
M a[32:35],a[116:119],a[200:203],a[32:35]
buffer_load_dwordx4 v[0:3],v250,s[20:23],s48 offen offset:1024 sc1
M a[36:39],a[116:119],a[204:207],0
M a[36:39],a[112:115],a[200:203],a[36:39]
M a[36:39],a[108:111],a[196:199],a[36:39]
M a[40:43],a[108:111],a[200:203],0
buffer_load_dwordx4 v[8:11],v250,s[20:23],s48 offen offset:2048 sc1
M a[40:43],a[112:115],a[204:207],a[40:43]
s_add_u32 s46,s72,27648
M a[40:43],a[116:119],a[208:211],a[40:43]
M a[44:47],a[116:119],a[212:215],0
M a[44:47],a[112:115],a[208:211],a[44:47]
buffer_load_dwordx4 v[36:39],v250,s[20:23],s46 offen offset:0 sc1
M a[44:47],a[108:111],a[204:207],a[44:47]
M a[48:51],a[108:111],a[208:211],0
M a[48:51],a[112:115],a[212:215],a[48:51]
M a[48:51],a[116:119],a[216:219],a[48:51]
buffer_load_dwordx4 v[32:35],v250,s[20:23],s46 offen offset:1024 sc1
M a[52:55],a[116:119],a[220:223],0
M a[52:55],a[112:115],a[216:219],a[52:55]
M a[52:55],a[108:111],a[212:215],a[52:55]
M a[56:59],a[108:111],a[216:219],0
buffer_load_dwordx4 v[40:43],v250,s[20:23],s46 offen offset:2048 sc1
M a[56:59],a[112:115],a[220:223],a[56:59]
s_add_u32 s47,s72,30720
M a[56:59],a[116:119],a[224:227],a[56:59]
M a[60:63],a[116:119],a[228:231],0
M a[60:63],a[112:115],a[224:227],a[60:63]
buffer_load_dwordx4 v[68:71],v250,s[20:23],s47 offen offset:0 sc1
M a[60:63],a[108:111],a[220:223],a[60:63]
s_waitcnt vmcnt(15)
M a[64:67],a[120:123],a[192:195],0
s_waitcnt vmcnt(14)
M a[64:67],a[124:127],a[196:199],a[64:67]
s_waitcnt vmcnt(13)
M a[64:67],a[128:131],a[200:203],a[64:67]
buffer_load_dwordx4 v[64:67],v250,s[20:23],s47 offen offset:1024 sc1
M a[68:71],a[128:131],a[204:207],0
M a[68:71],a[124:127],a[200:203],a[68:71]
M a[68:71],a[120:123],a[196:199],a[68:71]
M a[72:75],a[120:123],a[200:203],0
buffer_load_dwordx4 v[72:75],v250,s[20:23],s47 offen offset:2048 sc1
M a[72:75],a[124:127],a[204:207],a[72:75]
s_add_u32 s48,s72,33792
M a[72:75],a[128:131],a[208:211],a[72:75]
M a[76:79],a[128:131],a[212:215],0
M a[76:79],a[124:127],a[208:211],a[76:79]
buffer_load_dwordx4 v[100:103],v250,s[20:23],s48 offen offset:0 sc1
M a[76:79],a[120:123],a[204:207],a[76:79]
M a[80:83],a[120:123],a[208:211],0
M a[80:83],a[124:127],a[212:215],a[80:83]
M a[80:83],a[128:131],a[216:219],a[80:83]
buffer_load_dwordx4 v[96:99],v250,s[20:23],s48 offen offset:1024 sc1
M a[84:87],a[128:131],a[220:223],0
M a[84:87],a[124:127],a[216:219],a[84:87]
ds_read_b128 a[232:235],v248 offset:26112
M a[84:87],a[120:123],a[212:215],a[84:87]
ds_read_b128 a[236:239],v249 offset:26112
M a[88:91],a[120:123],a[216:219],0
buffer_load_dwordx4 v[104:107],v250,s[20:23],s48 offen offset:2048 sc1
M a[88:91],a[124:127],a[220:223],a[88:91]
s_add_u32 s46,s72,36864
ds_read_b128 a[240:243],v248 offset:26624
ds_read_b128 a[244:247],v249 offset:26624
M a[88:91],a[128:131],a[224:227],a[88:91]
M a[92:95],a[128:131],a[228:231],0
M a[92:95],a[124:127],a[224:227],a[92:95]
s_add_u32 s28,s68,0
buffer_load_dwordx4 v[132:135],v250,s[20:23],s46 offen offset:0 sc1
M a[92:95],a[120:123],a[220:223],a[92:95]
s_waitcnt vmcnt(18) lgkmcnt(3)
M a[96:99],a[132:135],a[232:235],0
s_waitcnt vmcnt(17) lgkmcnt(2)
ds_read_b128 a[248:251],v248 offset:27136
M a[96:99],a[136:139],a[236:239],a[96:99]
s_waitcnt vmcnt(16) lgkmcnt(2)
ds_read_b128 a[252:255],v249 offset:27136
M a[96:99],a[140:143],a[240:243],a[96:99]
s_waitcnt lgkmcnt(2)
buffer_load_dwordx4 v[128:131],v250,s[20:23],s46 offen offset:1024 sc1
M a[100:103],a[140:143],a[244:247],0
M a[100:103],a[136:139],a[240:243],a[100:103]
M a[100:103],a[132:135],a[236:239],a[100:103]
M a[104:107],a[132:135],a[240:243],0
buffer_load_dwordx4 v[136:139],v250,s[20:23],s46 offen offset:2048 sc1
M a[104:107],a[136:139],a[244:247],a[104:107]
s_waitcnt lgkmcnt(1)
ds_read_b128 v[216:219],v248 offset:27648
ds_read_b128 v[220:223],v249 offset:27648
M a[104:107],a[140:143],a[248:251],a[104:107]
s_waitcnt lgkmcnt(2)
M a[108:111],a[140:143],a[252:255],0
M a[108:111],a[136:139],a[248:251],a[108:111]
buffer_load_dwordx2 v[192:193],v251,s[12:15],s28 offen offset:0
M a[108:111],a[132:135],a[244:247],a[108:111]
M a[112:115],a[132:135],a[248:251],0
ds_read_b128 v[224:227],v249 offset:28160
M a[112:115],a[136:139],a[252:255],a[112:115]
s_waitcnt lgkmcnt(2)
ds_read_b128 v[228:231],v248 offset:28160
M a[112:115],a[140:143],v[216:219],a[112:115]
s_waitcnt lgkmcnt(2)
buffer_load_dwordx2 v[202:203],v251,s[16:19],s28 offen offset:1536
M a[116:119],a[140:143],v[220:223],0
M a[116:119],a[136:139],v[216:219],a[116:119]
M a[116:119],a[132:135],a[252:255],a[116:119]
M a[120:123],a[132:135],v[216:219],0
buffer_load_dwordx2 v[194:195],v251,s[8:11],s28 offen offset:0
M a[120:123],a[136:139],v[220:223],a[120:123]
s_waitcnt lgkmcnt(1)
M a[120:123],a[140:143],v[224:227],a[120:123]
s_waitcnt lgkmcnt(0)
M a[124:127],a[140:143],v[228:231],0
M a[124:127],a[136:139],v[224:227],a[124:127]
buffer_load_dwordx2 v[196:197],v251,s[8:11],s28 offen offset:384
M a[124:127],a[132:135],v[220:223],a[124:127]
s_waitcnt vmcnt(21)
M a[128:131],a[164:167],a[232:235],0
s_waitcnt vmcnt(20)
M a[128:131],a[160:163],a[236:239],a[128:131]
s_waitcnt vmcnt(19)
M a[128:131],a[168:171],a[240:243],a[128:131]
buffer_load_dwordx2 v[198:199],v251,s[8:11],s28 offen offset:768
M a[132:135],a[168:171],a[244:247],0
M a[132:135],a[160:163],a[240:243],a[132:135]
M a[132:135],a[164:167],a[236:239],a[132:135]
M a[136:139],a[164:167],a[240:243],0
buffer_load_dwordx2 v[200:201],v251,s[8:11],s28 offen offset:1152
M a[136:139],a[160:163],a[244:247],a[136:139]
M a[136:139],a[168:171],a[248:251],a[136:139]
M a[140:143],a[168:171],a[252:255],0
M a[140:143],a[160:163],a[248:251],a[140:143]
M a[140:143],a[164:167],a[244:247],a[140:143]
M a[144:147],a[164:167],a[248:251],0
M a[144:147],a[160:163],a[252:255],a[144:147]
M a[144:147],a[168:171],v[216:219],a[144:147]
M a[148:151],a[168:171],v[220:223],0
M a[148:151],a[160:163],v[216:219],a[148:151]
M a[148:151],a[164:167],a[252:255],a[148:151]
M a[152:155],a[164:167],v[216:219],0
M a[152:155],a[160:163],v[220:223],a[152:155]
M a[152:155],a[168:171],v[224:227],a[152:155]
M a[156:159],a[168:171],v[228:231],0
M a[156:159],a[160:163],v[224:227],a[156:159]
s_add_u32 s47,s72,39936
M a[156:159],a[164:167],v[220:223],a[156:159]
s_waitcnt vmcnt(20)
M a[160:163],v[4:7],a[232:235],0
s_waitcnt vmcnt(19)
M a[160:163],v[0:3],a[236:239],a[160:163]
s_waitcnt vmcnt(18)
M a[160:163],v[8:11],a[240:243],a[160:163]
M a[164:167],v[8:11],a[244:247],0
M a[164:167],v[0:3],a[240:243],a[164:167]
buffer_load_dwordx4 v[164:167],v250,s[20:23],s47 offen offset:0 sc1
M a[164:167],v[4:7],a[236:239],a[164:167]
M a[168:171],v[4:7],a[240:243],0
buffer_load_dwordx4 v[160:163],v250,s[20:23],s47 offen offset:1024 sc1
M a[168:171],v[0:3],a[244:247],a[168:171]
M a[168:171],v[8:11],a[248:251],a[168:171]
M a[172:175],v[8:11],a[252:255],0
M a[172:175],v[0:3],a[248:251],a[172:175]
buffer_load_dwordx4 v[168:171],v250,s[20:23],s47 offen offset:2048 sc1
M a[172:175],v[4:7],a[244:247],a[172:175]
s_add_u32 s48,s72,43008
M a[176:179],v[4:7],a[248:251],0
M a[176:179],v[0:3],a[252:255],a[176:179]
M a[176:179],v[8:11],v[216:219],a[176:179]
buffer_load_dwordx4 a[192:195],v250,s[20:23],s48 offen offset:0 sc1
M a[180:183],v[8:11],v[220:223],0
M a[180:183],v[0:3],v[216:219],a[180:183]
ds_read_b128 a[204:207],v248 offset:34816
M a[180:183],v[4:7],a[252:255],a[180:183]
ds_read_b128 a[208:211],v249 offset:34816
M a[184:187],v[4:7],v[216:219],0
buffer_load_dwordx4 a[196:199],v250,s[20:23],s48 offen offset:1024 sc1
M a[184:187],v[0:3],v[220:223],a[184:187]
ds_read_b128 a[216:219],v248 offset:35328
ds_read_b128 a[228:231],v249 offset:35328
M a[184:187],v[8:11],v[224:227],a[184:187]
M a[188:191],v[8:11],v[228:231],0
M a[188:191],v[0:3],v[224:227],a[188:191]
buffer_load_dwordx4 a[200:203],v250,s[20:23],s48 offen offset:2048 sc1
M a[188:191],v[4:7],v[220:223],a[188:191]
s_waitcnt vmcnt(23) lgkmcnt(3)
s_add_u32 s46,s73,9216
M v[0:3],v[36:39],a[204:207],0
s_waitcnt vmcnt(22) lgkmcnt(2)
ds_read_b128 a[224:227],v248 offset:35840
M v[0:3],v[32:35],a[208:211],v[0:3]
s_waitcnt vmcnt(21) lgkmcnt(2)
ds_read_b128 a[220:223],v249 offset:35840
M v[0:3],v[40:43],a[216:219],v[0:3]
s_waitcnt lgkmcnt(2)
buffer_load_dwordx4 a[212:215],v250,s[20:23],s46 offen offset:0 sc1
M v[4:7],v[40:43],a[228:231],0
M v[4:7],v[32:35],a[216:219],v[4:7]
M v[4:7],v[36:39],a[208:211],v[4:7]
M v[8:11],v[36:39],a[216:219],0
ds_read_b128 a[232:235],v248 offset:36352
M v[8:11],v[32:35],a[228:231],v[8:11]
s_waitcnt lgkmcnt(2)
ds_read_b128 a[236:239],v249 offset:36352
M v[8:11],v[40:43],a[224:227],v[8:11]
s_waitcnt lgkmcnt(2)
M v[12:15],v[40:43],a[220:223],0
M v[12:15],v[32:35],a[224:227],v[12:15]
M v[12:15],v[36:39],a[228:231],v[12:15]
s_add_u32 s28,s68,393216
buffer_load_dwordx2 v[204:205],v245,s[12:15],s28 offen offset:0
M v[16:19],v[36:39],a[224:227],0
ds_read_b128 a[240:243],v249 offset:36864
M v[16:19],v[32:35],a[220:223],v[16:19]
s_waitcnt lgkmcnt(2)
buffer_load_dwordx2 v[214:215],v245,s[16:19],s28 offen offset:1536
M v[16:19],v[40:43],a[232:235],v[16:19]
s_waitcnt lgkmcnt(1)
ds_read_b128 a[244:247],v248 offset:36864
M v[20:23],v[40:43],a[236:239],0
M v[20:23],v[32:35],a[232:235],v[20:23]
M v[20:23],v[36:39],a[220:223],v[20:23]
buffer_load_dwordx2 v[206:207],v245,s[8:11],s28 offen offset:0
M v[24:27],v[36:39],a[232:235],0
M v[24:27],v[32:35],a[236:239],v[24:27]
s_waitcnt lgkmcnt(1)
M v[24:27],v[40:43],a[240:243],v[24:27]
s_waitcnt lgkmcnt(0)
M v[28:31],v[40:43],a[244:247],0
buffer_load_dwordx2 v[208:209],v245,s[8:11],s28 offen offset:384
M v[28:31],v[32:35],a[240:243],v[28:31]
M v[28:31],v[36:39],a[236:239],v[28:31]
s_waitcnt vmcnt(25)
M v[32:35],v[68:71],a[204:207],0
s_waitcnt vmcnt(24)
M v[32:35],v[64:67],a[208:211],v[32:35]
s_waitcnt vmcnt(23)
buffer_load_dwordx2 v[210:211],v245,s[8:11],s28 offen offset:768
M v[32:35],v[72:75],a[216:219],v[32:35]
M v[36:39],v[72:75],a[228:231],0
M v[36:39],v[64:67],a[216:219],v[36:39]
M v[36:39],v[68:71],a[208:211],v[36:39]
buffer_load_dwordx2 v[212:213],v245,s[8:11],s28 offen offset:1152
M v[40:43],v[68:71],a[216:219],0
s_add_u32 s29,s68,0
M v[40:43],v[64:67],a[228:231],v[40:43]
M v[40:43],v[72:75],a[224:227],v[40:43]
M v[44:47],v[72:75],a[220:223],0
buffer_load_short_d16_hi v239,v246,s[12:15],s29 offen offset:0
M v[44:47],v[64:67],a[224:227],v[44:47]
M v[44:47],v[68:71],a[228:231],v[44:47]
buffer_load_short_d16_hi v240,v246,s[8:11],s29 offen offset:0
M v[48:51],v[68:71],a[224:227],0
M v[48:51],v[64:67],a[220:223],v[48:51]
buffer_load_short_d16_hi v241,v246,s[8:11],s29 offen offset:384
M v[48:51],v[72:75],a[232:235],v[48:51]
M v[52:55],v[72:75],a[236:239],0
buffer_load_short_d16_hi v242,v246,s[8:11],s29 offen offset:768
M v[52:55],v[64:67],a[232:235],v[52:55]
M v[52:55],v[68:71],a[220:223],v[52:55]
buffer_load_short_d16_hi v243,v246,s[8:11],s29 offen offset:1152
M v[56:59],v[68:71],a[232:235],0
M v[56:59],v[64:67],a[236:239],v[56:59]
buffer_load_short_d16_hi v244,v246,s[16:19],s29 offen offset:1536
M v[56:59],v[72:75],a[240:243],v[56:59]
M v[60:63],v[72:75],a[244:247],0
M v[60:63],v[64:67],a[240:243],v[60:63]
M v[60:63],v[68:71],a[236:239],v[60:63]
s_waitcnt vmcnt(30)
M v[64:67],v[100:103],a[204:207],0
s_waitcnt vmcnt(29)
M v[64:67],v[96:99],a[208:211],v[64:67]
s_waitcnt vmcnt(28)
M v[64:67],v[104:107],a[216:219],v[64:67]
M v[68:71],v[104:107],a[228:231],0
M v[68:71],v[96:99],a[216:219],v[68:71]
M v[68:71],v[100:103],a[208:211],v[68:71]
M v[72:75],v[100:103],a[216:219],0
M v[72:75],v[96:99],a[228:231],v[72:75]
M v[72:75],v[104:107],a[224:227],v[72:75]
M v[76:79],v[104:107],a[220:223],0
M v[76:79],v[96:99],a[224:227],v[76:79]
M v[76:79],v[100:103],a[228:231],v[76:79]
M v[80:83],v[100:103],a[224:227],0
M v[80:83],v[96:99],a[220:223],v[80:83]
M v[80:83],v[104:107],a[232:235],v[80:83]
M v[84:87],v[104:107],a[236:239],0
M v[84:87],v[96:99],a[232:235],v[84:87]
ds_read_b128 a[248:251],v248 offset:43520
M v[84:87],v[100:103],a[220:223],v[84:87]
ds_read_b128 a[252:255],v249 offset:43520
M v[88:91],v[100:103],a[232:235],0
ds_read_b128 v[216:219],v248 offset:44032
M v[88:91],v[96:99],a[236:239],v[88:91]
ds_read_b128 v[228:231],v249 offset:44032
M v[88:91],v[104:107],a[240:243],v[88:91]
M v[92:95],v[104:107],a[244:247],0
M v[92:95],v[96:99],a[240:243],v[92:95]
M v[92:95],v[100:103],a[236:239],v[92:95]
s_waitcnt vmcnt(27) lgkmcnt(3)
M v[96:99],v[132:135],a[248:251],0
s_waitcnt vmcnt(26) lgkmcnt(2)
ds_read_b128 v[224:227],v248 offset:44544
M v[96:99],v[128:131],a[252:255],v[96:99]
s_waitcnt vmcnt(25) lgkmcnt(2)
ds_read_b128 v[220:223],v249 offset:44544
M v[96:99],v[136:139],v[216:219],v[96:99]
s_waitcnt lgkmcnt(2)
M v[100:103],v[136:139],v[228:231],0
M v[100:103],v[128:131],v[216:219],v[100:103]
M v[100:103],v[132:135],a[252:255],v[100:103]
M v[104:107],v[132:135],v[216:219],0
ds_read_b128 a[204:207],v248 offset:45056
M v[104:107],v[128:131],v[228:231],v[104:107]
s_waitcnt lgkmcnt(2)
ds_read_b128 a[208:211],v249 offset:45056
M v[104:107],v[136:139],v[224:227],v[104:107]
s_waitcnt lgkmcnt(2)
M v[108:111],v[136:139],v[220:223],0
s_waitcnt vmcnt(21)
v_lshlrev_b32 v234,16,v196
v_lshlrev_b32 v232,16,v192
M v[108:111],v[128:131],v[224:227],v[108:111]
v_lshlrev_b32 v233,16,v194
v_lshlrev_b32 v237,16,v202
M v[108:111],v[132:135],v[228:231],v[108:111]
s_waitcnt vmcnt(19)
v_lshlrev_b32 v236,16,v200
v_lshlrev_b32 v235,16,v198
M v[112:115],v[132:135],v[224:227],0
ds_read_b128 a[216:219],v249 offset:45568
v_fmac_f32 v232,s43,v234
M v[112:115],v[128:131],v[220:223],v[112:115]
s_waitcnt lgkmcnt(2)
ds_read_b128 a[228:231],v248 offset:45568
v_fmac_f32 v237,4.0,v233
M v[112:115],v[136:139],a[204:207],v[112:115]
s_waitcnt lgkmcnt(2)
v_fma_f32 v238,-4.0,v234,v236
v_fmac_f32 v232,s45,v236
M v[116:119],v[136:139],a[208:211],0
v_fmac_f32 v237,s41,v235
v_sub_f32 v236,v236,v234
M v[116:119],v[128:131],a[204:207],v[116:119]
v_fma_f32 v234,-4.0,v233,v235
v_sub_f32 v235,v235,v233
M v[116:119],v[132:135],v[220:223],v[116:119]
v_add_f32 v233,v238,v234
v_sub_f32 v238,v238,v234
M v[120:123],v[132:135],a[204:207],0
v_fma_f32 v234,2.0,v235,v236
v_fmac_f32 v236,-2.0,v235
M v[120:123],v[128:131],a[208:211],v[120:123]
s_waitcnt lgkmcnt(1)
v_and_b32 v196,s42,v196
v_and_b32 v192,s42,v192
M v[120:123],v[136:139],a[216:219],v[120:123]
s_waitcnt lgkmcnt(0)
v_and_b32 v194,s42,v194
v_and_b32 v202,s42,v202
M v[124:127],v[136:139],a[228:231],0
buffer_load_dwordx4 a[224:227],v250,s[20:23],s46 offen offset:1024 sc1
M v[124:127],v[128:131],a[216:219],v[124:127]
v_and_b32 v200,s42,v200
v_and_b32 v198,s42,v198
M v[124:127],v[132:135],a[208:211],v[124:127]
s_waitcnt vmcnt(19)
buffer_load_dwordx4 a[220:223],v250,s[20:23],s46 offen offset:2048 sc1
M v[128:131],v[164:167],a[248:251],0
s_waitcnt vmcnt(19)
s_add_u32 s47,s73,12288
v_fmac_f32 v192,s43,v196
v_fmac_f32 v202,4.0,v194
M v[128:131],v[160:163],a[252:255],v[128:131]
s_waitcnt vmcnt(18)
v_fma_f32 v235,-4.0,v196,v200
v_fmac_f32 v192,s45,v200
M v[128:131],v[168:171],v[216:219],v[128:131]
v_fmac_f32 v202,s41,v198
v_sub_f32 v200,v200,v196
M v[132:135],v[168:171],v[228:231],0
buffer_load_dwordx4 a[232:235],v250,s[20:23],s47 offen offset:0 sc1
M v[132:135],v[160:163],v[216:219],v[132:135]
v_fma_f32 v196,-4.0,v194,v198
v_sub_f32 v198,v198,v194
M v[132:135],v[164:167],a[252:255],v[132:135]
v_add_f32 v194,v235,v196
v_sub_f32 v235,v235,v196
M v[136:139],v[164:167],v[216:219],0
v_fma_f32 v196,2.0,v198,v200
v_fmac_f32 v200,-2.0,v198
M v[136:139],v[160:163],v[228:231],v[136:139]
v_cvt_pk_bf16_f32 v192,v232,v192
v_cvt_pk_bf16_f32 v202,v237,v202
M v[136:139],v[168:171],v[224:227],v[136:139]
v_cvt_pk_bf16_f32 v194,v233,v194
v_cvt_pk_bf16_f32 v198,v234,v196
M v[140:143],v[168:171],v[220:223],0
v_cvt_pk_bf16_f32 v196,v238,v235
v_cvt_pk_bf16_f32 v200,v236,v200
M v[140:143],v[160:163],v[224:227],v[140:143]
v_lshlrev_b32 v234,16,v197
v_lshlrev_b32 v232,16,v193
M v[140:143],v[164:167],v[228:231],v[140:143]
v_lshlrev_b32 v233,16,v195
v_lshlrev_b32 v237,16,v203
M v[144:147],v[164:167],v[224:227],0
v_lshlrev_b32 v236,16,v201
v_lshlrev_b32 v235,16,v199
M v[144:147],v[160:163],v[220:223],v[144:147]
v_fmac_f32 v232,s43,v234
v_fmac_f32 v237,4.0,v233
M v[144:147],v[168:171],a[204:207],v[144:147]
v_fma_f32 v238,-4.0,v234,v236
v_fmac_f32 v232,s45,v236
M v[148:151],v[168:171],a[208:211],0
v_fmac_f32 v237,s41,v235
v_sub_f32 v236,v236,v234
M v[148:151],v[160:163],a[204:207],v[148:151]
v_fma_f32 v234,-4.0,v233,v235
v_sub_f32 v235,v235,v233
M v[148:151],v[164:167],v[220:223],v[148:151]
v_add_f32 v233,v238,v234
v_sub_f32 v238,v238,v234
M v[152:155],v[164:167],a[204:207],0
v_fma_f32 v234,2.0,v235,v236
v_fmac_f32 v236,-2.0,v235
M v[152:155],v[160:163],a[208:211],v[152:155]
v_and_b32 v197,s42,v197
v_and_b32 v193,s42,v193
M v[152:155],v[168:171],a[216:219],v[152:155]
v_and_b32 v195,s42,v195
v_and_b32 v203,s42,v203
M v[156:159],v[168:171],a[228:231],0
buffer_load_dwordx4 a[244:247],v250,s[20:23],s47 offen offset:1024 sc1
M v[156:159],v[160:163],a[216:219],v[156:159]
v_and_b32 v201,s42,v201
v_and_b32 v199,s42,v199
M v[156:159],v[164:167],a[208:211],v[156:159]
s_waitcnt vmcnt(19)
buffer_load_dwordx4 a[240:243],v250,s[20:23],s47 offen offset:2048 sc1
M v[160:163],a[192:195],a[248:251],0
s_waitcnt vmcnt(19)
s_add_u32 s48,s73,15360
v_fmac_f32 v193,s43,v197
v_fmac_f32 v203,4.0,v195
M v[160:163],a[196:199],a[252:255],v[160:163]
s_waitcnt vmcnt(18)
v_fma_f32 v235,-4.0,v197,v201
v_fmac_f32 v193,s45,v201
M v[160:163],a[200:203],v[216:219],v[160:163]
v_fmac_f32 v203,s41,v199
v_sub_f32 v201,v201,v197
M v[164:167],a[200:203],v[228:231],0
buffer_load_dwordx4 a[236:239],v250,s[20:23],s48 offen offset:0 sc1
M v[164:167],a[196:199],v[216:219],v[164:167]
v_fma_f32 v197,-4.0,v195,v199
v_sub_f32 v199,v199,v195
M v[164:167],a[192:195],a[252:255],v[164:167]
v_add_f32 v195,v235,v197
v_sub_f32 v235,v235,v197
M v[168:171],a[192:195],v[216:219],0
v_fma_f32 v197,2.0,v199,v201
v_fmac_f32 v201,-2.0,v199
M v[168:171],a[196:199],v[228:231],v[168:171]
buffer_load_dwordx4 a[248:251],v250,s[20:23],s48 offen offset:1024 sc1
M v[168:171],a[200:203],v[224:227],v[168:171]
v_cvt_pk_bf16_f32 v193,v232,v193
v_cvt_pk_bf16_f32 v203,v237,v203
M v[172:175],a[200:203],v[220:223],0
v_cvt_pk_bf16_f32 v195,v233,v195
v_cvt_pk_bf16_f32 v199,v234,v197
M v[172:175],a[196:199],v[224:227],v[172:175]
v_cvt_pk_bf16_f32 v197,v238,v235
v_cvt_pk_bf16_f32 v201,v236,v201
M v[172:175],a[192:195],v[228:231],v[172:175]
buffer_load_dwordx4 a[252:255],v250,s[20:23],s48 offen offset:2048 sc1
M v[176:179],a[192:195],v[224:227],0
s_waitcnt vmcnt(16)
s_add_u32 s46,s73,18432
v_lshlrev_b32 v234,16,v208
v_lshlrev_b32 v232,16,v204
M v[176:179],a[196:199],v[220:223],v[176:179]
v_lshlrev_b32 v233,16,v206
v_lshlrev_b32 v237,16,v214
M v[176:179],a[200:203],a[204:207],v[176:179]
s_waitcnt vmcnt(14)
s_barrier
v_lshlrev_b32 v236,16,v212
M v[180:183],a[200:203],a[208:211],0
buffer_load_dwordx4 v[216:219],v250,s[20:23],s46 offen offset:0 sc1
M v[180:183],a[196:199],a[204:207],v[180:183]
ds_read_b128 v[228:231],v248 offset:52224
v_lshlrev_b32 v235,16,v210
M v[180:183],a[192:195],v[220:223],v[180:183]
ds_write2st64_b64 v247,v[192:193],v[202:203] offset0:204 offset1:221
M v[184:187],a[192:195],a[204:207],0
s_add_u32 s28,s68,786432
ds_read_b128 v[224:227],v249 offset:52224
ds_read_b128 v[220:223],v248 offset:52736
M v[184:187],a[196:199],a[208:211],v[184:187]
buffer_load_dwordx2 v[192:193],v245,s[12:15],s28 offen offset:0
M v[184:187],a[200:203],a[216:219],v[184:187]
ds_write2st64_b64 v247,v[194:195],v[196:197] offset0:34 offset1:51
M v[188:191],a[200:203],a[228:231],0
ds_read_b128 a[204:207],v249 offset:52736
v_fmac_f32 v232,s43,v234
M v[188:191],a[196:199],a[216:219],v[188:191]
buffer_load_dwordx2 v[202:203],v245,s[16:19],s28 offen offset:1536
M v[188:191],a[192:195],a[208:211],v[188:191]
s_waitcnt lgkmcnt(5)
ds_write2st64_b64 v247,v[198:199],v[200:201] offset0:68 offset1:85
M a[0:3],a[212:215],v[228:231],a[0:3]
s_waitcnt vmcnt(10) lgkmcnt(4)
ds_read_b128 a[200:203],v248 offset:53248
v_fmac_f32 v237,4.0,v233
M a[0:3],a[224:227],v[224:227],a[0:3]
s_waitcnt vmcnt(9) lgkmcnt(4)
buffer_load_dwordx2 v[194:195],v245,s[8:11],s28 offen offset:0
M a[0:3],a[220:223],v[220:223],a[0:3]
s_waitcnt lgkmcnt(2)
ds_read_b128 a[228:231],v249 offset:53248
v_fma_f32 v238,-4.0,v234,v236
M a[4:7],a[220:223],a[204:207],a[4:7]
v_fmac_f32 v232,s45,v236
v_fmac_f32 v237,s41,v235
M a[4:7],a[224:227],v[220:223],a[4:7]
v_sub_f32 v236,v236,v234
v_fma_f32 v234,-4.0,v233,v235
M a[4:7],a[212:215],v[224:227],a[4:7]
buffer_load_dwordx2 v[196:197],v245,s[8:11],s28 offen offset:384
M a[8:11],a[212:215],v[220:223],a[8:11]
ds_read_b128 a[196:199],v248 offset:53760
v_sub_f32 v235,v235,v233
M a[8:11],a[224:227],a[204:207],a[8:11]
s_waitcnt lgkmcnt(2)
ds_read_b128 a[216:219],v249 offset:53760
v_add_f32 v233,v238,v234
M a[8:11],a[220:223],a[200:203],a[8:11]
s_waitcnt lgkmcnt(2)
v_sub_f32 v238,v238,v234
v_fma_f32 v234,2.0,v235,v236
M a[12:15],a[220:223],a[228:231],a[12:15]
buffer_load_dwordx2 v[198:199],v245,s[8:11],s28 offen offset:768
M a[12:15],a[224:227],a[200:203],a[12:15]
v_fmac_f32 v236,-2.0,v235
v_and_b32 v208,s42,v208
M a[12:15],a[212:215],a[204:207],a[12:15]
v_and_b32 v204,s42,v204
v_and_b32 v206,s42,v206
M a[16:19],a[212:215],a[200:203],a[16:19]
ds_read_b128 a[192:195],v249 offset:54272
v_and_b32 v214,s42,v214
M a[16:19],a[224:227],a[228:231],a[16:19]
s_waitcnt lgkmcnt(2)
buffer_load_dwordx2 v[200:201],v245,s[8:11],s28 offen offset:1152
M a[16:19],a[220:223],a[196:199],a[16:19]
s_waitcnt lgkmcnt(1)
ds_read_b128 a[208:211],v248 offset:54272
v_and_b32 v212,s42,v212
M a[20:23],a[220:223],a[216:219],a[20:23]
v_and_b32 v210,s42,v210
v_fmac_f32 v204,s43,v208
M a[20:23],a[224:227],a[196:199],a[20:23]
v_fmac_f32 v214,4.0,v206
v_fma_f32 v235,-4.0,v208,v212
M a[20:23],a[212:215],a[228:231],a[20:23]
v_fmac_f32 v204,s45,v212
v_fmac_f32 v214,s41,v210
M a[24:27],a[212:215],a[196:199],a[24:27]
v_sub_f32 v212,v212,v208
v_fma_f32 v208,-4.0,v206,v210
M a[24:27],a[224:227],a[216:219],a[24:27]
s_waitcnt lgkmcnt(1)
v_sub_f32 v210,v210,v206
v_add_f32 v206,v235,v208
M a[24:27],a[220:223],a[192:195],a[24:27]
s_waitcnt lgkmcnt(0)
v_sub_f32 v235,v235,v208
v_fma_f32 v208,2.0,v210,v212
M a[28:31],a[220:223],a[208:211],a[28:31]
buffer_load_dwordx4 a[220:223],v250,s[20:23],s46 offen offset:1024 sc1
M a[28:31],a[224:227],a[192:195],a[28:31]
v_fmac_f32 v212,-2.0,v210
v_cvt_pk_bf16_f32 v204,v232,v204
M a[28:31],a[212:215],a[216:219],a[28:31]
s_waitcnt vmcnt(13)
buffer_load_dwordx4 a[224:227],v250,s[20:23],s46 offen offset:2048 sc1
M a[32:35],a[232:235],v[228:231],a[32:35]
s_waitcnt vmcnt(13)
s_add_u32 s47,s73,21504
v_cvt_pk_bf16_f32 v214,v237,v214
v_cvt_pk_bf16_f32 v206,v233,v206
M a[32:35],a[244:247],v[224:227],a[32:35]
s_waitcnt vmcnt(12)
v_cvt_pk_bf16_f32 v210,v234,v208
v_cvt_pk_bf16_f32 v208,v238,v235
M a[32:35],a[240:243],v[220:223],a[32:35]
v_cvt_pk_bf16_f32 v212,v236,v212
v_lshlrev_b32 v234,16,v209
M a[36:39],a[240:243],a[204:207],a[36:39]
buffer_load_dwordx4 a[212:215],v250,s[20:23],s47 offen offset:0 sc1
M a[36:39],a[244:247],v[220:223],a[36:39]
v_lshlrev_b32 v232,16,v205
v_lshlrev_b32 v233,16,v207
M a[36:39],a[232:235],v[224:227],a[36:39]
v_lshlrev_b32 v237,16,v215
v_lshlrev_b32 v236,16,v213
M a[40:43],a[232:235],v[220:223],a[40:43]
v_lshlrev_b32 v235,16,v211
v_fmac_f32 v232,s43,v234
M a[40:43],a[244:247],a[204:207],a[40:43]
v_fmac_f32 v237,4.0,v233
v_fma_f32 v238,-4.0,v234,v236
M a[40:43],a[240:243],a[200:203],a[40:43]
v_fmac_f32 v232,s45,v236
v_fmac_f32 v237,s41,v235
M a[44:47],a[240:243],a[228:231],a[44:47]
v_sub_f32 v236,v236,v234
v_fma_f32 v234,-4.0,v233,v235
M a[44:47],a[244:247],a[200:203],a[44:47]
v_sub_f32 v235,v235,v233
v_add_f32 v233,v238,v234
M a[44:47],a[232:235],a[204:207],a[44:47]
v_sub_f32 v238,v238,v234
v_fma_f32 v234,2.0,v235,v236
M a[48:51],a[232:235],a[200:203],a[48:51]
v_fmac_f32 v236,-2.0,v235
v_and_b32 v209,s42,v209
M a[48:51],a[244:247],a[228:231],a[48:51]
v_and_b32 v205,s42,v205
v_and_b32 v207,s42,v207
M a[48:51],a[240:243],a[196:199],a[48:51]
v_and_b32 v215,s42,v215
v_and_b32 v213,s42,v213
M a[52:55],a[240:243],a[216:219],a[52:55]
v_and_b32 v211,s42,v211
v_fmac_f32 v205,s43,v209
M a[52:55],a[244:247],a[196:199],a[52:55]
v_fmac_f32 v215,4.0,v207
v_fma_f32 v235,-4.0,v209,v213
M a[52:55],a[232:235],a[228:231],a[52:55]
v_fmac_f32 v205,s45,v213
v_fmac_f32 v215,s41,v211
M a[56:59],a[232:235],a[196:199],a[56:59]
v_sub_f32 v213,v213,v209
v_fma_f32 v209,-4.0,v207,v211
M a[56:59],a[244:247],a[216:219],a[56:59]
v_sub_f32 v211,v211,v207
v_add_f32 v207,v235,v209
M a[56:59],a[240:243],a[192:195],a[56:59]
v_sub_f32 v235,v235,v209
v_fma_f32 v209,2.0,v211,v213
M a[60:63],a[240:243],a[208:211],a[60:63]
buffer_load_dwordx4 a[240:243],v250,s[20:23],s47 offen offset:1024 sc1
M a[60:63],a[244:247],a[192:195],a[60:63]
v_fmac_f32 v213,-2.0,v211
v_cvt_pk_bf16_f32 v205,v232,v205
M a[60:63],a[232:235],a[216:219],a[60:63]
s_waitcnt vmcnt(13)
buffer_load_dwordx4 a[244:247],v250,s[20:23],s47 offen offset:2048 sc1
M a[64:67],a[236:239],v[228:231],a[64:67]
s_waitcnt vmcnt(13)
s_add_u32 s48,s73,24576
v_cvt_pk_bf16_f32 v215,v237,v215
v_cvt_pk_bf16_f32 v207,v233,v207
M a[64:67],a[248:251],v[224:227],a[64:67]
s_waitcnt vmcnt(12)
v_cvt_pk_bf16_f32 v211,v234,v209
v_cvt_pk_bf16_f32 v209,v238,v235
M a[64:67],a[252:255],v[220:223],a[64:67]
v_cvt_pk_bf16_f32 v213,v236,v213
v_fmac_f32 v239,s43,v241
M a[68:71],a[252:255],a[204:207],a[68:71]
buffer_load_dwordx4 a[232:235],v250,s[20:23],s48 offen offset:0 sc1
M a[68:71],a[248:251],v[220:223],a[68:71]
v_fmac_f32 v244,4.0,v240
v_fma_f32 v232,-4.0,v241,v243
M a[68:71],a[236:239],v[224:227],a[68:71]
ds_write2st64_b64 v247,v[204:205],v[214:215] offset0:205 offset1:222
M a[72:75],a[236:239],v[220:223],a[72:75]
s_add_u32 s28,s68,1179648
v_fmac_f32 v239,s45,v243
v_fmac_f32 v244,s41,v242
M a[72:75],a[248:251],a[204:207],a[72:75]
buffer_load_dwordx4 v[228:231],v250,s[20:23],s48 offen offset:1024 sc1
M a[72:75],a[252:255],a[200:203],a[72:75]
ds_write2st64_b64 v247,v[206:207],v[208:209] offset0:35 offset1:52
M a[76:79],a[252:255],a[228:231],a[76:79]
v_sub_f32 v243,v243,v241
v_fma_f32 v241,-4.0,v240,v242
M a[76:79],a[248:251],a[200:203],a[76:79]
buffer_load_dwordx4 v[224:227],v250,s[20:23],s48 offen offset:2048 sc1
M a[76:79],a[236:239],a[204:207],a[76:79]
s_add_u32 s46,s73,27648
ds_write2st64_b64 v247,v[210:211],v[212:213] offset0:69 offset1:86
M a[80:83],a[236:239],a[200:203],a[80:83]
v_sub_f32 v242,v242,v240
v_add_f32 v240,v232,v241
M a[80:83],a[248:251],a[228:231],a[80:83]
buffer_load_dwordx4 v[220:223],v250,s[20:23],s46 offen offset:0 sc1
M a[80:83],a[252:255],a[196:199],a[80:83]
v_sub_f32 v232,v232,v241
v_fma_f32 v241,2.0,v242,v243
M a[84:87],a[252:255],a[216:219],a[84:87]
v_fmac_f32 v243,-2.0,v242
v_cvt_pk_bf16_f32 v233,v239,v244
M a[84:87],a[248:251],a[196:199],a[84:87]
ds_read_b128 a[204:207],v248 offset:60928
v_cvt_pk_bf16_f32 v234,v240,v232
M a[84:87],a[236:239],a[228:231],a[84:87]
buffer_load_dwordx2 v[204:205],v245,s[12:15],s28 offen offset:0
M a[88:91],a[236:239],a[196:199],a[88:91]
ds_read_b128 a[200:203],v249 offset:60928
ds_read_b128 a[228:231],v248 offset:61440
M a[88:91],a[248:251],a[216:219],a[88:91]
ds_read_b128 a[196:199],v249 offset:61440
v_cvt_pk_bf16_f32 v235,v241,v243
M a[88:91],a[252:255],a[192:195],a[88:91]
v_add_u32 v232,104448,v252
M a[92:95],a[252:255],a[208:211],a[92:95]
buffer_load_dwordx2 v[214:215],v245,s[16:19],s28 offen offset:1536
M a[92:95],a[248:251],a[192:195],a[92:95]
ds_write_b16 v232,v233 offset:0
M a[92:95],a[236:239],a[216:219],a[92:95]
s_waitcnt vmcnt(17) lgkmcnt(4)
ds_write_b16_d16_hi v232,v233 offset:8704
M a[96:99],v[216:219],a[204:207],a[96:99]
s_waitcnt vmcnt(10) lgkmcnt(4)
ds_read_b128 a[208:211],v248 offset:61952
ds_write_b16 v252,v234 offset:17408
M a[96:99],a[220:223],a[200:203],a[96:99]
s_waitcnt vmcnt(9) lgkmcnt(5)
buffer_load_dwordx2 v[206:207],v245,s[8:11],s28 offen offset:0
M a[96:99],a[224:227],a[228:231],a[96:99]
s_waitcnt lgkmcnt(4)
ds_read_b128 a[252:255],v249 offset:61952
ds_write_b16_d16_hi v252,v234 offset:26112
M a[100:103],a[224:227],a[196:199],a[100:103]
ds_write_b16 v252,v235 offset:34816
M a[100:103],a[220:223],a[228:231],a[100:103]
ds_write_b16_d16_hi v252,v235 offset:43520
M a[100:103],v[216:219],a[200:203],a[100:103]
buffer_load_dwordx2 v[208:209],v245,s[8:11],s28 offen offset:384
M a[104:107],v[216:219],a[228:231],a[104:107]
ds_read_b128 a[192:195],v248 offset:62464
v_lshlrev_b32 v234,16,v196
M a[104:107],a[220:223],a[196:199],a[104:107]
s_waitcnt lgkmcnt(6)
ds_read_b128 a[248:251],v249 offset:62464
v_lshlrev_b32 v232,16,v192
M a[104:107],a[224:227],a[208:211],a[104:107]
s_waitcnt lgkmcnt(5)
v_lshlrev_b32 v233,16,v194
v_lshlrev_b32 v237,16,v202
M a[108:111],a[224:227],a[252:255],a[108:111]
buffer_load_dwordx2 v[210:211],v245,s[8:11],s28 offen offset:768
M a[108:111],a[220:223],a[208:211],a[108:111]
v_lshlrev_b32 v236,16,v200
v_lshlrev_b32 v235,16,v198
M a[108:111],v[216:219],a[196:199],a[108:111]
v_fmac_f32 v232,s43,v234
v_fmac_f32 v237,4.0,v233
M a[112:115],v[216:219],a[208:211],a[112:115]
ds_read_b128 a[216:219],v249 offset:62976
v_fma_f32 v238,-4.0,v234,v236
M a[112:115],a[220:223],a[252:255],a[112:115]
s_waitcnt lgkmcnt(2)
buffer_load_dwordx2 v[212:213],v245,s[8:11],s28 offen offset:1152
M a[112:115],a[224:227],a[192:195],a[112:115]
s_waitcnt lgkmcnt(1)
s_add_u32 s29,s69,0
ds_read_b128 a[236:239],v248 offset:62976
v_fmac_f32 v232,s45,v236
M a[116:119],a[224:227],a[248:251],a[116:119]
v_fmac_f32 v237,s41,v235
v_sub_f32 v236,v236,v234
M a[116:119],a[220:223],a[192:195],a[116:119]
v_fma_f32 v234,-4.0,v233,v235
v_sub_f32 v235,v235,v233
M a[116:119],v[216:219],a[252:255],a[116:119]
buffer_load_short_d16_hi v239,v246,s[12:15],s29 offen offset:0
M a[120:123],v[216:219],a[192:195],a[120:123]
v_add_f32 v233,v238,v234
v_sub_f32 v238,v238,v234
M a[120:123],a[220:223],a[248:251],a[120:123]
s_waitcnt lgkmcnt(1)
buffer_load_short_d16_hi v240,v246,s[8:11],s29 offen offset:0
M a[120:123],a[224:227],a[216:219],a[120:123]
s_waitcnt lgkmcnt(0)
v_fma_f32 v234,2.0,v235,v236
v_fmac_f32 v236,-2.0,v235
M a[124:127],a[224:227],a[236:239],a[124:127]
buffer_load_dwordx4 a[224:227],v250,s[20:23],s46 offen offset:1024 sc1
M a[124:127],a[220:223],a[216:219],a[124:127]
v_and_b32 v196,s42,v196
v_and_b32 v192,s42,v192
M a[124:127],v[216:219],a[248:251],a[124:127]
s_waitcnt vmcnt(15)
v_and_b32 v194,s42,v194
v_and_b32 v202,s42,v202
M a[128:131],a[212:215],a[204:207],a[128:131]
s_waitcnt vmcnt(14)
v_and_b32 v200,s42,v200
v_and_b32 v198,s42,v198
M a[128:131],a[240:243],a[200:203],a[128:131]
s_waitcnt vmcnt(13)
buffer_load_dwordx4 a[220:223],v250,s[20:23],s46 offen offset:2048 sc1
M a[128:131],a[244:247],a[228:231],a[128:131]
s_add_u32 s47,s73,30720
v_fmac_f32 v192,s43,v196
v_fmac_f32 v202,4.0,v194
M a[132:135],a[244:247],a[196:199],a[132:135]
v_fma_f32 v235,-4.0,v196,v200
v_fmac_f32 v192,s45,v200
M a[132:135],a[240:243],a[228:231],a[132:135]
v_fmac_f32 v202,s41,v198
v_sub_f32 v200,v200,v196
M a[132:135],a[212:215],a[200:203],a[132:135]
buffer_load_dwordx4 v[216:219],v250,s[20:23],s47 offen offset:0 sc1
M a[136:139],a[212:215],a[228:231],a[136:139]
v_fma_f32 v196,-4.0,v194,v198
v_sub_f32 v198,v198,v194
M a[136:139],a[240:243],a[196:199],a[136:139]
v_add_f32 v194,v235,v196
v_sub_f32 v235,v235,v196
M a[136:139],a[244:247],a[208:211],a[136:139]
v_fma_f32 v196,2.0,v198,v200
v_fmac_f32 v200,-2.0,v198
M a[140:143],a[244:247],a[252:255],a[140:143]
buffer_load_short_d16_hi v241,v246,s[8:11],s29 offen offset:384
M a[140:143],a[240:243],a[208:211],a[140:143]
v_cvt_pk_bf16_f32 v192,v232,v192
v_cvt_pk_bf16_f32 v202,v237,v202
M a[140:143],a[212:215],a[196:199],a[140:143]
buffer_load_short_d16_hi v242,v246,s[8:11],s29 offen offset:768
M a[144:147],a[212:215],a[208:211],a[144:147]
v_cvt_pk_bf16_f32 v194,v233,v194
v_cvt_pk_bf16_f32 v198,v234,v196
M a[144:147],a[240:243],a[252:255],a[144:147]
buffer_load_short_d16_hi v243,v246,s[8:11],s29 offen offset:1152
M a[144:147],a[244:247],a[192:195],a[144:147]
v_cvt_pk_bf16_f32 v196,v238,v235
v_cvt_pk_bf16_f32 v200,v236,v200
M a[148:151],a[244:247],a[248:251],a[148:151]
buffer_load_short_d16_hi v244,v246,s[16:19],s29 offen offset:1536
M a[148:151],a[240:243],a[192:195],a[148:151]
v_lshlrev_b32 v234,16,v197
v_lshlrev_b32 v232,16,v193
M a[148:151],a[212:215],a[252:255],a[148:151]
v_lshlrev_b32 v233,16,v195
v_lshlrev_b32 v237,16,v203
M a[152:155],a[212:215],a[192:195],a[152:155]
v_lshlrev_b32 v236,16,v201
v_lshlrev_b32 v235,16,v199
M a[152:155],a[240:243],a[248:251],a[152:155]
v_fmac_f32 v232,s43,v234
v_fmac_f32 v237,4.0,v233
M a[152:155],a[244:247],a[216:219],a[152:155]
v_fma_f32 v238,-4.0,v234,v236
v_fmac_f32 v232,s45,v236
M a[156:159],a[244:247],a[236:239],a[156:159]
buffer_load_dwordx4 a[244:247],v250,s[20:23],s47 offen offset:1024 sc1
M a[156:159],a[240:243],a[216:219],a[156:159]
v_fmac_f32 v237,s41,v235
v_sub_f32 v236,v236,v234
M a[156:159],a[212:215],a[248:251],a[156:159]
s_waitcnt vmcnt(19)
buffer_load_dwordx4 a[240:243],v250,s[20:23],s47 offen offset:2048 sc1
M a[160:163],a[232:235],a[204:207],a[160:163]
s_waitcnt vmcnt(19)
s_add_u32 s48,s73,33792
v_fma_f32 v234,-4.0,v233,v235
v_sub_f32 v235,v235,v233
M a[160:163],v[228:231],a[200:203],a[160:163]
s_waitcnt vmcnt(18)
v_add_f32 v233,v238,v234
v_sub_f32 v238,v238,v234
M a[160:163],v[224:227],a[228:231],a[160:163]
v_fma_f32 v234,2.0,v235,v236
v_fmac_f32 v236,-2.0,v235
M a[164:167],v[224:227],a[196:199],a[164:167]
buffer_load_dwordx4 a[212:215],v250,s[20:23],s48 offen offset:0 sc1
M a[164:167],v[228:231],a[228:231],a[164:167]
v_and_b32 v197,s42,v197
v_and_b32 v193,s42,v193
M a[164:167],a[232:235],a[200:203],a[164:167]
v_and_b32 v195,s42,v195
v_and_b32 v203,s42,v203
M a[168:171],a[232:235],a[228:231],a[168:171]
v_and_b32 v201,s42,v201
v_and_b32 v199,s42,v199
M a[168:171],v[228:231],a[196:199],a[168:171]
buffer_load_dwordx4 a[204:207],v250,s[20:23],s48 offen offset:1024 sc1
M a[168:171],v[224:227],a[208:211],a[168:171]
v_fmac_f32 v193,s43,v197
v_fmac_f32 v203,4.0,v195
M a[172:175],v[224:227],a[252:255],a[172:175]
v_fma_f32 v235,-4.0,v197,v201
v_fmac_f32 v193,s45,v201
M a[172:175],v[228:231],a[208:211],a[172:175]
v_fmac_f32 v203,s41,v199
v_sub_f32 v201,v201,v197
M a[172:175],a[232:235],a[196:199],a[172:175]
buffer_load_dwordx4 a[200:203],v250,s[20:23],s48 offen offset:2048 sc1
M a[176:179],a[232:235],a[208:211],a[176:179]
s_add_u32 s46,s73,36864
v_fma_f32 v197,-4.0,v195,v199
v_sub_f32 v199,v199,v195
M a[176:179],v[228:231],a[252:255],a[176:179]
v_add_u32 v248,0x4400,v248
v_add_u32 v249,0x4400,v249
M a[176:179],v[224:227],a[192:195],a[176:179]
v_add_f32 v195,v235,v197
v_sub_f32 v235,v235,v197
M a[180:183],v[224:227],a[248:251],a[180:183]
buffer_load_dwordx4 a[228:231],v250,s[20:23],s46 offen offset:0 sc1
M a[180:183],v[228:231],a[192:195],a[180:183]
ds_read_b128 a[196:199],v248 offset:52224
v_fma_f32 v197,2.0,v199,v201
M a[180:183],a[232:235],a[252:255],a[180:183]
ds_read_b128 a[208:211],v249 offset:52224
v_fmac_f32 v201,-2.0,v199
M a[184:187],a[232:235],a[192:195],a[184:187]
ds_read_b128 a[252:255],v248 offset:52736
v_cvt_pk_bf16_f32 v193,v232,v193
M a[184:187],v[228:231],a[248:251],a[184:187]
ds_read_b128 a[192:195],v249 offset:52736
v_cvt_pk_bf16_f32 v203,v237,v203
M a[184:187],v[224:227],a[216:219],a[184:187]
v_cvt_pk_bf16_f32 v195,v233,v195
v_cvt_pk_bf16_f32 v199,v234,v197
M a[188:191],v[224:227],a[236:239],a[188:191]
v_cvt_pk_bf16_f32 v197,v238,v235
v_cvt_pk_bf16_f32 v201,v236,v201
M a[188:191],v[228:231],a[216:219],a[188:191]
M a[188:191],a[232:235],a[248:251],a[188:191]
s_waitcnt vmcnt(21) lgkmcnt(3)
ds_write2st64_b64 v247,v[192:193],v[202:203] offset0:206 offset1:223
M v[0:3],v[220:223],a[196:199],v[0:3]
s_waitcnt vmcnt(12) lgkmcnt(3)
s_add_u32 s28,s69,0
buffer_load_dwordx2 v[192:193],v251,s[12:15],s28 offen offset:0
M v[0:3],a[224:227],a[208:211],v[0:3]
s_waitcnt vmcnt(12) lgkmcnt(2)
ds_read_b128 a[236:239],v248 offset:53248
ds_read_b128 v[224:227],v249 offset:53248
M v[0:3],a[220:223],a[252:255],v[0:3]
s_waitcnt lgkmcnt(3)
buffer_load_dwordx2 v[202:203],v251,s[16:19],s28 offen offset:1536
M v[4:7],a[220:223],a[192:195],v[4:7]
v_lshlrev_b32 v234,16,v208
v_lshlrev_b32 v232,16,v204
M v[4:7],a[224:227],a[252:255],v[4:7]
v_lshlrev_b32 v233,16,v206
v_lshlrev_b32 v237,16,v214
M v[4:7],v[220:223],a[208:211],v[4:7]
ds_write2st64_b64 v247,v[194:195],v[196:197] offset0:36 offset1:53
M v[8:11],v[220:223],a[252:255],v[8:11]
buffer_load_dwordx2 v[194:195],v251,s[8:11],s28 offen offset:0
M v[8:11],a[224:227],a[192:195],v[8:11]
s_waitcnt lgkmcnt(2)
ds_read_b128 a[216:219],v248 offset:53760
ds_read_b128 v[228:231],v249 offset:53760
M v[8:11],a[220:223],a[236:239],v[8:11]
s_waitcnt lgkmcnt(3)
ds_write2st64_b64 v247,v[198:199],v[200:201] offset0:70 offset1:87
M v[12:15],a[220:223],v[224:227],v[12:15]
buffer_load_dwordx2 v[196:197],v251,s[8:11],s28 offen offset:384
M v[12:15],a[224:227],a[236:239],v[12:15]
v_lshlrev_b32 v236,16,v212
v_lshlrev_b32 v235,16,v210
M v[12:15],v[220:223],a[192:195],v[12:15]
v_fmac_f32 v232,s43,v234
v_fmac_f32 v237,4.0,v233
M v[16:19],v[220:223],a[236:239],v[16:19]
ds_read_b128 a[232:235],v249 offset:54272
v_fma_f32 v238,-4.0,v234,v236
M v[16:19],a[224:227],v[224:227],v[16:19]
s_waitcnt lgkmcnt(3)
buffer_load_dwordx2 v[198:199],v251,s[8:11],s28 offen offset:768
M v[16:19],a[220:223],a[216:219],v[16:19]
s_waitcnt lgkmcnt(2)
ds_read_b128 a[248:251],v248 offset:54272
v_fmac_f32 v232,s45,v236
M v[20:23],a[220:223],v[228:231],v[20:23]
v_fmac_f32 v237,s41,v235
v_sub_f32 v236,v236,v234
M v[20:23],a[224:227],a[216:219],v[20:23]
v_fma_f32 v234,-4.0,v233,v235
v_sub_f32 v235,v235,v233
M v[20:23],v[220:223],v[224:227],v[20:23]
buffer_load_dwordx2 v[200:201],v251,s[8:11],s28 offen offset:1152
M v[24:27],v[220:223],a[216:219],v[24:27]
v_add_f32 v233,v238,v234
v_sub_f32 v238,v238,v234
M v[24:27],a[224:227],v[228:231],v[24:27]
s_waitcnt lgkmcnt(1)
v_fma_f32 v234,2.0,v235,v236
v_fmac_f32 v236,-2.0,v235
M v[24:27],a[220:223],a[232:235],v[24:27]
s_waitcnt lgkmcnt(0)
v_and_b32 v208,s42,v208
v_and_b32 v204,s42,v204
M v[28:31],a[220:223],a[248:251],v[28:31]
global_load_dword a220,v250,s[64:65]
M v[28:31],a[224:227],a[232:235],v[28:31]
v_and_b32 v206,s42,v206
v_and_b32 v214,s42,v214
M v[28:31],v[220:223],v[228:231],v[28:31]
s_waitcnt vmcnt(17)
buffer_load_dwordx4 a[220:223],v250,s[20:23],s46 offen offset:1024 sc1
M v[32:35],v[216:219],a[196:199],v[32:35]
s_waitcnt vmcnt(13)
v_and_b32 v212,s42,v212
v_and_b32 v210,s42,v210
M v[32:35],a[244:247],a[208:211],v[32:35]
s_waitcnt vmcnt(12)
v_fmac_f32 v204,s43,v208
v_fmac_f32 v214,4.0,v206
M v[32:35],a[240:243],a[252:255],v[32:35]
v_fma_f32 v235,-4.0,v208,v212
v_fmac_f32 v204,s45,v212
M v[36:39],a[240:243],a[192:195],v[36:39]
buffer_load_dwordx4 a[224:227],v250,s[20:23],s46 offen offset:2048 sc1
M v[36:39],a[244:247],a[252:255],v[36:39]
s_add_u32 s47,s73,39936
v_fmac_f32 v214,s41,v210
v_sub_f32 v212,v212,v208
M v[36:39],v[216:219],a[208:211],v[36:39]
v_fma_f32 v208,-4.0,v206,v210
v_sub_f32 v210,v210,v206
M v[40:43],v[216:219],a[252:255],v[40:43]
v_add_f32 v206,v235,v208
v_sub_f32 v235,v235,v208
M v[40:43],a[244:247],a[192:195],v[40:43]
buffer_load_dwordx4 v[220:223],v250,s[20:23],s47 offen offset:0 sc1
M v[40:43],a[240:243],a[236:239],v[40:43]
v_fma_f32 v208,2.0,v210,v212
v_fmac_f32 v212,-2.0,v210
M v[44:47],a[240:243],v[224:227],v[44:47]
v_cvt_pk_bf16_f32 v204,v232,v204
v_cvt_pk_bf16_f32 v214,v237,v214
M v[44:47],a[244:247],a[236:239],v[44:47]
v_cvt_pk_bf16_f32 v206,v233,v206
v_cvt_pk_bf16_f32 v210,v234,v208
M v[44:47],v[216:219],a[192:195],v[44:47]
v_cvt_pk_bf16_f32 v208,v238,v235
v_cvt_pk_bf16_f32 v212,v236,v212
M v[48:51],v[216:219],a[236:239],v[48:51]
v_lshlrev_b32 v234,16,v209
v_lshlrev_b32 v232,16,v205
M v[48:51],a[244:247],v[224:227],v[48:51]
v_lshlrev_b32 v233,16,v207
v_lshlrev_b32 v237,16,v215
M v[48:51],a[240:243],a[216:219],v[48:51]
v_lshlrev_b32 v236,16,v213
v_lshlrev_b32 v235,16,v211
M v[52:55],a[240:243],v[228:231],v[52:55]
v_fmac_f32 v232,s43,v234
v_fmac_f32 v237,4.0,v233
M v[52:55],a[244:247],a[216:219],v[52:55]
v_fma_f32 v238,-4.0,v234,v236
v_fmac_f32 v232,s45,v236
M v[52:55],v[216:219],v[224:227],v[52:55]
v_fmac_f32 v237,s41,v235
v_sub_f32 v236,v236,v234
M v[56:59],v[216:219],a[216:219],v[56:59]
v_fma_f32 v234,-4.0,v233,v235
v_sub_f32 v235,v235,v233
M v[56:59],a[244:247],v[228:231],v[56:59]
v_add_f32 v233,v238,v234
v_sub_f32 v238,v238,v234
M v[56:59],a[240:243],a[232:235],v[56:59]
v_fma_f32 v234,2.0,v235,v236
v_fmac_f32 v236,-2.0,v235
M v[60:63],a[240:243],a[248:251],v[60:63]
buffer_load_dwordx4 a[240:243],v250,s[20:23],s47 offen offset:1024 sc1
M v[60:63],a[244:247],a[232:235],v[60:63]
v_and_b32 v209,s42,v209
v_and_b32 v205,s42,v205
M v[60:63],v[216:219],v[228:231],v[60:63]
s_waitcnt vmcnt(14)
buffer_load_dwordx4 a[244:247],v250,s[20:23],s47 offen offset:2048 sc1
M v[64:67],a[212:215],a[196:199],v[64:67]
s_waitcnt vmcnt(14)
s_add_u32 s48,s73,43008
v_and_b32 v207,s42,v207
v_and_b32 v215,s42,v215
M v[64:67],a[204:207],a[208:211],v[64:67]
s_waitcnt vmcnt(13)
v_and_b32 v213,s42,v213
v_and_b32 v211,s42,v211
M v[64:67],a[200:203],a[252:255],v[64:67]
v_fmac_f32 v205,s43,v209
v_fmac_f32 v215,4.0,v207
M v[68:71],a[200:203],a[192:195],v[68:71]
buffer_load_dwordx4 v[216:219],v250,s[20:23],s48 offen offset:0 sc1
M v[68:71],a[204:207],a[252:255],v[68:71]
v_fma_f32 v235,-4.0,v209,v213
v_fmac_f32 v205,s45,v213
M v[68:71],a[212:215],a[208:211],v[68:71]
v_fmac_f32 v215,s41,v211
v_sub_f32 v213,v213,v209
M v[72:75],a[212:215],a[252:255],v[72:75]
v_fma_f32 v209,-4.0,v207,v211
v_sub_f32 v211,v211,v207
M v[72:75],a[204:207],a[192:195],v[72:75]
buffer_load_dwordx4 a[196:199],v250,s[20:23],s48 offen offset:1024 sc1
M v[72:75],a[200:203],a[236:239],v[72:75]
v_add_f32 v207,v235,v209
v_sub_f32 v235,v235,v209
M v[76:79],a[200:203],v[224:227],v[76:79]
v_fma_f32 v209,2.0,v211,v213
v_fmac_f32 v213,-2.0,v211
M v[76:79],a[204:207],a[236:239],v[76:79]
v_cvt_pk_bf16_f32 v205,v232,v205
v_cvt_pk_bf16_f32 v215,v237,v215
M v[76:79],a[212:215],a[192:195],v[76:79]
buffer_load_dwordx4 a[208:211],v250,s[20:23],s48 offen offset:2048 sc1
M v[80:83],a[212:215],a[236:239],v[80:83]
s_add_u32 s46,s74,9216
v_cvt_pk_bf16_f32 v207,v233,v207
v_cvt_pk_bf16_f32 v211,v234,v209
M v[80:83],a[204:207],v[224:227],v[80:83]
v_cvt_pk_bf16_f32 v209,v238,v235
v_cvt_pk_bf16_f32 v213,v236,v213
M v[80:83],a[200:203],a[216:219],v[80:83]
ds_write2st64_b64 v247,v[204:205],v[214:215] offset0:207 offset1:224
M v[84:87],a[200:203],v[228:231],v[84:87]
s_add_u32 s28,s69,393216
buffer_load_dwordx4 a[252:255],v250,s[20:23],s46 offen offset:0 sc1
M v[84:87],a[204:207],a[216:219],v[84:87]
s_waitcnt vmcnt(12)
ds_read_b128 a[192:195],v248 offset:60928
v_lshlrev_b32 v234,16,v196
M v[84:87],a[212:215],v[224:227],v[84:87]
ds_write2st64_b64 v247,v[206:207],v[208:209] offset0:37 offset1:54
M v[88:91],a[212:215],a[216:219],v[88:91]
buffer_load_dwordx2 v[204:205],v245,s[12:15],s28 offen offset:0
M v[88:91],a[204:207],v[228:231],v[88:91]
ds_read_b128 a[236:239],v249 offset:60928
ds_read_b128 v[224:227],v248 offset:61440
M v[88:91],a[200:203],a[232:235],v[88:91]
ds_write2st64_b64 v247,v[210:211],v[212:213] offset0:71 offset1:88
M v[92:95],a[200:203],a[248:251],v[92:95]
buffer_load_dwordx2 v[214:215],v245,s[16:19],s28 offen offset:1536
M v[92:95],a[204:207],a[232:235],v[92:95]
ds_read_b128 a[216:219],v249 offset:61440
v_lshlrev_b32 v232,16,v192
M v[92:95],a[212:215],v[228:231],v[92:95]
s_waitcnt lgkmcnt(5)
v_lshlrev_b32 v233,16,v194
v_lshlrev_b32 v237,16,v202
M v[96:99],a[228:231],a[192:195],v[96:99]
s_waitcnt vmcnt(10) lgkmcnt(3)
ds_read_b128 a[200:203],v248 offset:61952
v_lshlrev_b32 v236,16,v200
M v[96:99],a[220:223],a[236:239],v[96:99]
s_waitcnt vmcnt(9) lgkmcnt(3)
buffer_load_dwordx2 v[206:207],v245,s[8:11],s28 offen offset:0
M v[96:99],a[224:227],v[224:227],v[96:99]
s_waitcnt lgkmcnt(1)
ds_read_b128 a[248:251],v249 offset:61952
v_lshlrev_b32 v235,16,v198
M v[100:103],a[224:227],a[216:219],v[100:103]
v_fmac_f32 v232,s43,v234
v_fmac_f32 v237,4.0,v233
M v[100:103],a[220:223],v[224:227],v[100:103]
v_fma_f32 v238,-4.0,v234,v236
v_fmac_f32 v232,s45,v236
M v[100:103],a[228:231],a[236:239],v[100:103]
buffer_load_dwordx2 v[208:209],v245,s[8:11],s28 offen offset:384
M v[104:107],a[228:231],v[224:227],v[104:107]
ds_read_b128 a[204:207],v248 offset:62464
v_fmac_f32 v237,s41,v235
M v[104:107],a[220:223],a[216:219],v[104:107]
s_waitcnt lgkmcnt(2)
ds_read_b128 a[232:235],v249 offset:62464
v_sub_f32 v236,v236,v234
M v[104:107],a[224:227],a[200:203],v[104:107]
s_waitcnt lgkmcnt(2)
v_fma_f32 v234,-4.0,v233,v235
v_sub_f32 v235,v235,v233
M v[108:111],a[224:227],a[248:251],v[108:111]
buffer_load_dwordx2 v[210:211],v245,s[8:11],s28 offen offset:768
M v[108:111],a[220:223],a[200:203],v[108:111]
v_add_f32 v233,v238,v234
v_sub_f32 v238,v238,v234
M v[108:111],a[228:231],a[216:219],v[108:111]
v_fma_f32 v234,2.0,v235,v236
v_fmac_f32 v236,-2.0,v235
M v[112:115],a[228:231],a[200:203],v[112:115]
ds_read_b128 a[212:215],v249 offset:62976
v_and_b32 v196,s42,v196
M v[112:115],a[220:223],a[248:251],v[112:115]
s_waitcnt lgkmcnt(2)
buffer_load_dwordx2 v[212:213],v245,s[8:11],s28 offen offset:1152
M v[112:115],a[224:227],a[204:207],v[112:115]
s_waitcnt lgkmcnt(1)
ds_read_b128 v[228:231],v248 offset:62976
v_and_b32 v192,s42,v192
M v[116:119],a[224:227],a[232:235],v[116:119]
v_and_b32 v194,s42,v194
v_and_b32 v202,s42,v202
M v[116:119],a[220:223],a[204:207],v[116:119]
v_and_b32 v200,s42,v200
v_and_b32 v198,s42,v198
M v[116:119],a[228:231],a[248:251],v[116:119]
v_fmac_f32 v192,s43,v196
v_fmac_f32 v202,4.0,v194
M v[120:123],a[228:231],a[204:207],v[120:123]
v_fma_f32 v235,-4.0,v196,v200
v_fmac_f32 v192,s45,v200
M v[120:123],a[220:223],a[232:235],v[120:123]
s_waitcnt lgkmcnt(1)
v_fmac_f32 v202,s41,v198
v_sub_f32 v200,v200,v196
M v[120:123],a[224:227],a[212:215],v[120:123]
s_waitcnt lgkmcnt(0)
v_fma_f32 v196,-4.0,v194,v198
v_sub_f32 v198,v198,v194
M v[124:127],a[224:227],v[228:231],v[124:127]
buffer_load_dwordx4 a[224:227],v250,s[20:23],s46 offen offset:1024 sc1
M v[124:127],a[220:223],a[212:215],v[124:127]
v_add_f32 v194,v235,v196
v_sub_f32 v235,v235,v196
M v[124:127],a[228:231],a[232:235],v[124:127]
s_waitcnt vmcnt(13)
buffer_load_dwordx4 a[220:223],v250,s[20:23],s46 offen offset:2048 sc1
M v[128:131],v[220:223],a[192:195],v[128:131]
s_waitcnt vmcnt(13)
s_add_u32 s47,s74,12288
v_fma_f32 v196,2.0,v198,v200
v_fmac_f32 v200,-2.0,v198
M v[128:131],a[240:243],a[236:239],v[128:131]
s_waitcnt vmcnt(12)
v_cvt_pk_bf16_f32 v192,v232,v192
v_cvt_pk_bf16_f32 v202,v237,v202
M v[128:131],a[244:247],v[224:227],v[128:131]
v_cvt_pk_bf16_f32 v194,v233,v194
v_cvt_pk_bf16_f32 v198,v234,v196
M v[132:135],a[244:247],a[216:219],v[132:135]
buffer_load_dwordx4 a[228:231],v250,s[20:23],s47 offen offset:0 sc1
M v[132:135],a[240:243],v[224:227],v[132:135]
v_cvt_pk_bf16_f32 v196,v238,v235
v_cvt_pk_bf16_f32 v200,v236,v200
M v[132:135],v[220:223],a[236:239],v[132:135]
v_lshlrev_b32 v234,16,v197
v_lshlrev_b32 v232,16,v193
M v[136:139],v[220:223],v[224:227],v[136:139]
v_lshlrev_b32 v233,16,v195
v_lshlrev_b32 v237,16,v203
M v[136:139],a[240:243],a[216:219],v[136:139]
v_lshlrev_b32 v236,16,v201
v_lshlrev_b32 v235,16,v199
M v[136:139],a[244:247],a[200:203],v[136:139]
v_fmac_f32 v232,s43,v234
v_fmac_f32 v237,4.0,v233
M v[140:143],a[244:247],a[248:251],v[140:143]
v_fma_f32 v238,-4.0,v234,v236
v_fmac_f32 v232,s45,v236
M v[140:143],a[240:243],a[200:203],v[140:143]
v_fmac_f32 v237,s41,v235
v_sub_f32 v236,v236,v234
M v[140:143],v[220:223],a[216:219],v[140:143]
v_fma_f32 v234,-4.0,v233,v235
v_sub_f32 v235,v235,v233
M v[144:147],v[220:223],a[200:203],v[144:147]
v_add_f32 v233,v238,v234
v_sub_f32 v238,v238,v234
M v[144:147],a[240:243],a[248:251],v[144:147]
v_fma_f32 v234,2.0,v235,v236
v_fmac_f32 v236,-2.0,v235
M v[144:147],a[244:247],a[204:207],v[144:147]
v_and_b32 v197,s42,v197
v_and_b32 v193,s42,v193
M v[148:151],a[244:247],a[232:235],v[148:151]
v_and_b32 v195,s42,v195
v_and_b32 v203,s42,v203
M v[148:151],a[240:243],a[204:207],v[148:151]
v_and_b32 v201,s42,v201
v_and_b32 v199,s42,v199
M v[148:151],v[220:223],a[248:251],v[148:151]
v_fmac_f32 v193,s43,v197
v_fmac_f32 v203,4.0,v195
M v[152:155],v[220:223],a[204:207],v[152:155]
v_fma_f32 v235,-4.0,v197,v201
v_fmac_f32 v193,s45,v201
M v[152:155],a[240:243],a[232:235],v[152:155]
v_fmac_f32 v203,s41,v199
v_sub_f32 v201,v201,v197
M v[152:155],a[244:247],a[212:215],v[152:155]
v_fma_f32 v197,-4.0,v195,v199
v_sub_f32 v199,v199,v195
M v[156:159],a[244:247],v[228:231],v[156:159]
buffer_load_dwordx4 a[244:247],v250,s[20:23],s47 offen offset:1024 sc1
M v[156:159],a[240:243],a[212:215],v[156:159]
v_add_f32 v195,v235,v197
v_sub_f32 v235,v235,v197
M v[156:159],v[220:223],a[232:235],v[156:159]
s_waitcnt vmcnt(13)
buffer_load_dwordx4 a[240:243],v250,s[20:23],s47 offen offset:2048 sc1
M v[160:163],v[216:219],a[192:195],v[160:163]
s_waitcnt vmcnt(13)
s_add_u32 s48,s74,15360
v_fma_f32 v197,2.0,v199,v201
v_fmac_f32 v201,-2.0,v199
M v[160:163],a[196:199],a[236:239],v[160:163]
s_waitcnt vmcnt(12)
v_cvt_pk_bf16_f32 v193,v232,v193
v_cvt_pk_bf16_f32 v203,v237,v203
M v[160:163],a[208:211],v[224:227],v[160:163]
v_cvt_pk_bf16_f32 v195,v233,v195
v_cvt_pk_bf16_f32 v199,v234,v197
M v[164:167],a[208:211],a[216:219],v[164:167]
buffer_load_dwordx4 v[220:223],v250,s[20:23],s48 offen offset:0 sc1
M v[164:167],a[196:199],v[224:227],v[164:167]
v_cvt_pk_bf16_f32 v197,v238,v235
v_cvt_pk_bf16_f32 v201,v236,v201
M v[164:167],v[216:219],a[236:239],v[164:167]
s_waitcnt vmcnt(8)
v_lshlrev_b32 v234,16,v208
v_lshlrev_b32 v232,16,v204
M v[168:171],v[216:219],v[224:227],v[168:171]
v_lshlrev_b32 v233,16,v206
v_lshlrev_b32 v237,16,v214
M v[168:171],a[196:199],a[216:219],v[168:171]
buffer_load_dwordx4 a[192:195],v250,s[20:23],s48 offen offset:1024 sc1
M v[168:171],a[208:211],a[200:203],v[168:171]
s_waitcnt vmcnt(7)
v_lshlrev_b32 v236,16,v212
v_lshlrev_b32 v235,16,v210
M v[172:175],a[208:211],a[248:251],v[172:175]
v_fmac_f32 v232,s43,v234
v_fmac_f32 v237,4.0,v233
M v[172:175],a[196:199],a[200:203],v[172:175]
v_fma_f32 v238,-4.0,v234,v236
v_fmac_f32 v232,s45,v236
M v[172:175],v[216:219],a[216:219],v[172:175]
buffer_load_dwordx4 a[236:239],v250,s[20:23],s48 offen offset:2048 sc1
M v[176:179],v[216:219],a[200:203],v[176:179]
s_add_u32 s46,s74,18432
v_fmac_f32 v237,s41,v235
v_sub_f32 v236,v236,v234
M v[176:179],a[196:199],a[248:251],v[176:179]
v_fma_f32 v234,-4.0,v233,v235
v_sub_f32 v235,v235,v233
M v[176:179],a[208:211],a[204:207],v[176:179]
s_barrier
v_add_f32 v233,v238,v234
M v[180:183],a[208:211],a[232:235],v[180:183]
buffer_load_dwordx4 v[224:227],v250,s[20:23],s46 offen offset:0 sc1
M v[180:183],a[196:199],a[204:207],v[180:183]
ds_read_b128 a[216:219],v248 offset:0
v_sub_f32 v238,v238,v234
M v[180:183],v[216:219],a[248:251],v[180:183]
ds_write2st64_b64 v247,v[192:193],v[202:203] offset0:238 offset1:255
M v[184:187],v[216:219],a[204:207],v[184:187]
s_add_u32 s28,s69,786432
ds_read_b128 a[200:203],v249 offset:0
ds_read_b128 a[248:251],v248 offset:512
M v[184:187],a[196:199],a[232:235],v[184:187]
buffer_load_dwordx2 v[192:193],v245,s[12:15],s28 offen offset:0
M v[184:187],a[208:211],a[212:215],v[184:187]
ds_write2st64_b64 v247,v[194:195],v[196:197] offset0:102 offset1:119
M v[188:191],a[208:211],v[228:231],v[188:191]
ds_read_b128 a[204:207],v249 offset:512
v_fma_f32 v234,2.0,v235,v236
M v[188:191],a[196:199],a[212:215],v[188:191]
buffer_load_dwordx2 v[202:203],v245,s[16:19],s28 offen offset:1536
M v[188:191],v[216:219],a[232:235],v[188:191]
s_waitcnt lgkmcnt(5)
ds_write2st64_b64 v247,v[198:199],v[200:201] offset0:136 offset1:153
M a[0:3],a[252:255],a[216:219],a[0:3]
s_waitcnt vmcnt(10) lgkmcnt(4)
ds_read_b128 a[208:211],v248 offset:1024
v_fmac_f32 v236,-2.0,v235
M a[0:3],a[224:227],a[200:203],a[0:3]
s_waitcnt vmcnt(9) lgkmcnt(4)
buffer_load_dwordx2 v[194:195],v245,s[8:11],s28 offen offset:0
M a[0:3],a[220:223],a[248:251],a[0:3]
s_waitcnt lgkmcnt(2)
ds_read_b128 v[228:231],v249 offset:1024
v_and_b32 v208,s42,v208
M a[4:7],a[220:223],a[204:207],a[4:7]
v_and_b32 v204,s42,v204
v_and_b32 v206,s42,v206
M a[4:7],a[224:227],a[248:251],a[4:7]
v_and_b32 v214,s42,v214
v_and_b32 v212,s42,v212
M a[4:7],a[252:255],a[200:203],a[4:7]
buffer_load_dwordx2 v[196:197],v245,s[8:11],s28 offen offset:384
M a[8:11],a[252:255],a[248:251],a[8:11]
ds_read_b128 a[196:199],v248 offset:1536
v_and_b32 v210,s42,v210
M a[8:11],a[224:227],a[204:207],a[8:11]
s_waitcnt lgkmcnt(2)
ds_read_b128 a[212:215],v249 offset:1536
v_fmac_f32 v204,s43,v208
M a[8:11],a[220:223],a[208:211],a[8:11]
s_waitcnt lgkmcnt(2)
v_fmac_f32 v214,4.0,v206
v_fma_f32 v235,-4.0,v208,v212
M a[12:15],a[220:223],v[228:231],a[12:15]
buffer_load_dwordx2 v[198:199],v245,s[8:11],s28 offen offset:768
M a[12:15],a[224:227],a[208:211],a[12:15]
v_fmac_f32 v204,s45,v212
v_fmac_f32 v214,s41,v210
M a[12:15],a[252:255],a[204:207],a[12:15]
v_sub_f32 v212,v212,v208
v_fma_f32 v208,-4.0,v206,v210
M a[16:19],a[252:255],a[208:211],a[16:19]
ds_read_b128 a[232:235],v249 offset:2048
v_sub_f32 v210,v210,v206
M a[16:19],a[224:227],v[228:231],a[16:19]
s_waitcnt lgkmcnt(2)
buffer_load_dwordx2 v[200:201],v245,s[8:11],s28 offen offset:1152
M a[16:19],a[220:223],a[196:199],a[16:19]
s_waitcnt lgkmcnt(1)
ds_read_b128 v[216:219],v248 offset:2048
v_add_f32 v206,v235,v208
M a[20:23],a[220:223],a[212:215],a[20:23]
v_sub_f32 v235,v235,v208
v_fma_f32 v208,2.0,v210,v212
M a[20:23],a[224:227],a[196:199],a[20:23]
v_fmac_f32 v212,-2.0,v210
v_cvt_pk_bf16_f32 v204,v232,v204
M a[20:23],a[252:255],v[228:231],a[20:23]
v_cvt_pk_bf16_f32 v214,v237,v214
v_cvt_pk_bf16_f32 v206,v233,v206
M a[24:27],a[252:255],a[196:199],a[24:27]
v_cvt_pk_bf16_f32 v210,v234,v208
v_cvt_pk_bf16_f32 v208,v238,v235
M a[24:27],a[224:227],a[212:215],a[24:27]
s_waitcnt lgkmcnt(1)
v_cvt_pk_bf16_f32 v212,v236,v212
v_lshlrev_b32 v234,16,v209
M a[24:27],a[220:223],a[232:235],a[24:27]
s_waitcnt lgkmcnt(0)
v_lshlrev_b32 v232,16,v205
v_lshlrev_b32 v233,16,v207
M a[28:31],a[220:223],v[216:219],a[28:31]
buffer_load_dwordx4 a[220:223],v250,s[20:23],s46 offen offset:1024 sc1
M a[28:31],a[224:227],a[232:235],a[28:31]
v_lshlrev_b32 v237,16,v215
v_lshlrev_b32 v236,16,v213
M a[28:31],a[252:255],a[212:215],a[28:31]
s_waitcnt vmcnt(13)
buffer_load_dwordx4 a[224:227],v250,s[20:23],s46 offen offset:2048 sc1
M a[32:35],a[228:231],a[216:219],a[32:35]
s_waitcnt vmcnt(13)
s_add_u32 s47,s74,21504
v_lshlrev_b32 v235,16,v211
v_fmac_f32 v232,s43,v234
M a[32:35],a[244:247],a[200:203],a[32:35]
s_waitcnt vmcnt(12)
v_fmac_f32 v237,4.0,v233
v_fma_f32 v238,-4.0,v234,v236
M a[32:35],a[240:243],a[248:251],a[32:35]
v_fmac_f32 v232,s45,v236
v_fmac_f32 v237,s41,v235
M a[36:39],a[240:243],a[204:207],a[36:39]
buffer_load_dwordx4 a[252:255],v250,s[20:23],s47 offen offset:0 sc1
M a[36:39],a[244:247],a[248:251],a[36:39]
v_sub_f32 v236,v236,v234
v_fma_f32 v234,-4.0,v233,v235
M a[36:39],a[228:231],a[200:203],a[36:39]
v_sub_f32 v235,v235,v233
v_add_f32 v233,v238,v234
M a[40:43],a[228:231],a[248:251],a[40:43]
v_sub_f32 v238,v238,v234
v_fma_f32 v234,2.0,v235,v236
M a[40:43],a[244:247],a[204:207],a[40:43]
v_fmac_f32 v236,-2.0,v235
v_and_b32 v209,s42,v209
M a[40:43],a[240:243],a[208:211],a[40:43]
v_and_b32 v205,s42,v205
v_and_b32 v207,s42,v207
M a[44:47],a[240:243],v[228:231],a[44:47]
v_and_b32 v215,s42,v215
v_and_b32 v213,s42,v213
M a[44:47],a[244:247],a[208:211],a[44:47]
v_and_b32 v211,s42,v211
v_fmac_f32 v205,s43,v209
M a[44:47],a[228:231],a[204:207],a[44:47]
v_fmac_f32 v215,4.0,v207
v_fma_f32 v235,-4.0,v209,v213
M a[48:51],a[228:231],a[208:211],a[48:51]
v_fmac_f32 v205,s45,v213
v_fmac_f32 v215,s41,v211
M a[48:51],a[244:247],v[228:231],a[48:51]
v_sub_f32 v213,v213,v209
v_fma_f32 v209,-4.0,v207,v211
M a[48:51],a[240:243],a[196:199],a[48:51]
v_sub_f32 v211,v211,v207
v_add_f32 v207,v235,v209
M a[52:55],a[240:243],a[212:215],a[52:55]
v_sub_f32 v235,v235,v209
v_fma_f32 v209,2.0,v211,v213
M a[52:55],a[244:247],a[196:199],a[52:55]
v_fmac_f32 v213,-2.0,v211
v_cvt_pk_bf16_f32 v205,v232,v205
M a[52:55],a[228:231],v[228:231],a[52:55]
v_cvt_pk_bf16_f32 v215,v237,v215
v_cvt_pk_bf16_f32 v207,v233,v207
M a[56:59],a[228:231],a[196:199],a[56:59]
v_cvt_pk_bf16_f32 v211,v234,v209
v_cvt_pk_bf16_f32 v209,v238,v235
M a[56:59],a[244:247],a[212:215],a[56:59]
v_cvt_pk_bf16_f32 v213,v236,v213
v_add_u32 v238,121856,v247
M a[56:59],a[240:243],a[232:235],a[56:59]
ds_write2st64_b64 v238,v[204:205],v[214:215] offset0:1 offset1:18
M a[60:63],a[240:243],v[216:219],a[60:63]
s_add_u32 s28,s69,1179648
buffer_load_dwordx4 a[240:243],v250,s[20:23],s47 offen offset:1024 sc1
M a[60:63],a[244:247],a[232:235],a[60:63]
v_fmac_f32 v239,s43,v241
v_fmac_f32 v244,4.0,v240
M a[60:63],a[228:231],a[212:215],a[60:63]
s_waitcnt vmcnt(13)
buffer_load_dwordx4 a[244:247],v250,s[20:23],s47 offen offset:2048 sc1
M a[64:67],v[220:223],a[216:219],a[64:67]
s_waitcnt vmcnt(13)
s_add_u32 s48,s74,24576
v_fma_f32 v232,-4.0,v241,v243
v_fmac_f32 v239,s45,v243
M a[64:67],a[192:195],a[200:203],a[64:67]
s_waitcnt vmcnt(12)
v_fmac_f32 v244,s41,v242
v_sub_f32 v243,v243,v241
M a[64:67],a[236:239],a[248:251],a[64:67]
ds_write2st64_b64 v247,v[206:207],v[208:209] offset0:103 offset1:120
M a[68:71],a[236:239],a[204:207],a[68:71]
buffer_load_dwordx4 a[228:231],v250,s[20:23],s48 offen offset:0 sc1
M a[68:71],a[192:195],a[248:251],a[68:71]
v_fma_f32 v241,-4.0,v240,v242
v_sub_f32 v242,v242,v240
M a[68:71],v[220:223],a[200:203],a[68:71]
ds_write2st64_b64 v247,v[210:211],v[212:213] offset0:137 offset1:154
M a[72:75],v[220:223],a[248:251],a[72:75]
buffer_load_dwordx4 a[216:219],v250,s[20:23],s48 offen offset:1024 sc1
M a[72:75],a[192:195],a[204:207],a[72:75]
v_add_f32 v240,v232,v241
v_sub_f32 v232,v232,v241
M a[72:75],a[236:239],a[208:211],a[72:75]
v_fma_f32 v241,2.0,v242,v243
v_fmac_f32 v243,-2.0,v242
M a[76:79],a[236:239],v[228:231],a[76:79]
v_cvt_pk_bf16_f32 v233,v239,v244
v_cvt_pk_bf16_f32 v234,v240,v232
M a[76:79],a[192:195],a[208:211],a[76:79]
buffer_load_dwordx4 a[200:203],v250,s[20:23],s48 offen offset:2048 sc1
M a[76:79],v[220:223],a[204:207],a[76:79]
s_add_u32 s46,s74,27648
v_cvt_pk_bf16_f32 v235,v241,v243
v_add_u32 v232,121856,v252
M a[80:83],v[220:223],a[208:211],a[80:83]
ds_write_b16 v232,v233 offset:0
M a[80:83],a[192:195],v[228:231],a[80:83]
ds_write_b16_d16_hi v232,v233 offset:8704
M a[80:83],a[236:239],a[196:199],a[80:83]
buffer_load_dwordx4 a[248:251],v250,s[20:23],s46 offen offset:0 sc1
M a[84:87],a[236:239],a[212:215],a[84:87]
ds_write_b16 v252,v234 offset:52224
M a[84:87],a[192:195],a[196:199],a[84:87]
ds_read_b128 a[204:207],v248 offset:8704
ds_write_b16_d16_hi v252,v234 offset:60928
M a[84:87],v[220:223],v[228:231],a[84:87]
ds_read_b128 a[208:211],v249 offset:8704
v_add_u32 v232,69632,v252
M a[88:91],v[220:223],a[196:199],a[88:91]
buffer_load_dwordx2 v[204:205],v245,s[12:15],s28 offen offset:0
M a[88:91],a[192:195],a[212:215],a[88:91]
ds_read_b128 v[228:231],v248 offset:9216
ds_read_b128 a[196:199],v249 offset:9216
M a[88:91],a[236:239],a[232:235],a[88:91]
ds_write_b16 v232,v235 offset:0
M a[92:95],a[236:239],v[216:219],a[92:95]
ds_write_b16_d16_hi v232,v235 offset:8704
M a[92:95],a[192:195],a[232:235],a[92:95]
buffer_load_dwordx2 v[214:215],v245,s[16:19],s28 offen offset:1536
M a[92:95],v[220:223],a[212:215],a[92:95]
s_waitcnt vmcnt(13) lgkmcnt(6)
v_lshlrev_b32 v234,16,v196
v_lshlrev_b32 v232,16,v192
M a[96:99],v[224:227],a[204:207],a[96:99]
s_waitcnt vmcnt(10) lgkmcnt(4)
ds_read_b128 a[236:239],v248 offset:9728
v_lshlrev_b32 v233,16,v194
M a[96:99],a[220:223],a[208:211],a[96:99]
s_waitcnt vmcnt(9) lgkmcnt(4)
ds_read_b128 v[216:219],v249 offset:9728
v_lshlrev_b32 v237,16,v202
M a[96:99],a[224:227],v[228:231],a[96:99]
s_waitcnt lgkmcnt(4)
buffer_load_dwordx2 v[206:207],v245,s[8:11],s28 offen offset:0
M a[100:103],a[224:227],a[196:199],a[100:103]
v_lshlrev_b32 v236,16,v200
v_lshlrev_b32 v235,16,v198
M a[100:103],a[220:223],v[228:231],a[100:103]
v_fmac_f32 v232,s43,v234
v_fmac_f32 v237,4.0,v233
M a[100:103],v[224:227],a[208:211],a[100:103]
v_fma_f32 v238,-4.0,v234,v236
v_fmac_f32 v232,s45,v236
M a[104:107],v[224:227],v[228:231],a[104:107]
buffer_load_dwordx2 v[208:209],v245,s[8:11],s28 offen offset:384
M a[104:107],a[220:223],a[196:199],a[104:107]
s_waitcnt lgkmcnt(1)
ds_read_b128 a[192:195],v248 offset:10240
ds_read_b128 a[232:235],v249 offset:10240
M a[104:107],a[224:227],a[236:239],a[104:107]
s_waitcnt lgkmcnt(2)
v_fmac_f32 v237,s41,v235
v_sub_f32 v236,v236,v234
M a[108:111],a[224:227],v[216:219],a[108:111]
v_fma_f32 v234,-4.0,v233,v235
v_sub_f32 v235,v235,v233
M a[108:111],a[220:223],a[236:239],a[108:111]
buffer_load_dwordx2 v[210:211],v245,s[8:11],s28 offen offset:768
M a[108:111],v[224:227],a[196:199],a[108:111]
v_add_f32 v233,v238,v234
v_sub_f32 v238,v238,v234
M a[112:115],v[224:227],a[236:239],a[112:115]
ds_read_b128 a[212:215],v249 offset:10752
v_fma_f32 v234,2.0,v235,v236
M a[112:115],a[220:223],v[216:219],a[112:115]
s_waitcnt lgkmcnt(2)
ds_read_b128 v[220:223],v248 offset:10752
v_fmac_f32 v236,-2.0,v235
M a[112:115],a[224:227],a[192:195],a[112:115]
s_waitcnt lgkmcnt(2)
buffer_load_dwordx2 v[212:213],v245,s[8:11],s28 offen offset:1152
M a[116:119],a[224:227],a[232:235],a[116:119]
s_add_u32 s29,s70,0
v_and_b32 v196,s42,v196
v_and_b32 v192,s42,v192
M a[116:119],a[220:223],a[192:195],a[116:119]
v_and_b32 v194,s42,v194
v_and_b32 v202,s42,v202
M a[116:119],v[224:227],v[216:219],a[116:119]
v_and_b32 v200,s42,v200
v_and_b32 v198,s42,v198
M a[120:123],v[224:227],a[192:195],a[120:123]
buffer_load_short_d16_hi v239,v246,s[12:15],s29 offen offset:0
M a[120:123],a[220:223],a[232:235],a[120:123]
s_waitcnt lgkmcnt(1)
v_fmac_f32 v192,s43,v196
v_fmac_f32 v202,4.0,v194
M a[120:123],a[224:227],a[212:215],a[120:123]
s_waitcnt lgkmcnt(0)
buffer_load_short_d16_hi v240,v246,s[8:11],s29 offen offset:0
M a[124:127],a[224:227],v[220:223],a[124:127]
v_fma_f32 v235,-4.0,v196,v200
v_fmac_f32 v192,s45,v200
M a[124:127],a[220:223],a[212:215],a[124:127]
buffer_load_dwordx4 a[224:227],v250,s[20:23],s46 offen offset:1024 sc1
M a[124:127],v[224:227],a[232:235],a[124:127]
s_waitcnt vmcnt(15)
v_fmac_f32 v202,s41,v198
v_sub_f32 v200,v200,v196
M a[128:131],a[252:255],a[204:207],a[128:131]
s_waitcnt vmcnt(14)
v_fma_f32 v196,-4.0,v194,v198
v_sub_f32 v198,v198,v194
M a[128:131],a[240:243],a[208:211],a[128:131]
s_waitcnt vmcnt(13)
v_add_f32 v194,v235,v196
v_sub_f32 v235,v235,v196
M a[128:131],a[244:247],v[228:231],a[128:131]
buffer_load_dwordx4 a[220:223],v250,s[20:23],s46 offen offset:2048 sc1
M a[132:135],a[244:247],a[196:199],a[132:135]
s_add_u32 s47,s74,30720
v_fma_f32 v196,2.0,v198,v200
v_fmac_f32 v200,-2.0,v198
M a[132:135],a[240:243],v[228:231],a[132:135]
v_cvt_pk_bf16_f32 v192,v232,v192
v_cvt_pk_bf16_f32 v202,v237,v202
M a[132:135],a[252:255],a[208:211],a[132:135]
v_cvt_pk_bf16_f32 v194,v233,v194
v_cvt_pk_bf16_f32 v198,v234,v196
M a[136:139],a[252:255],v[228:231],a[136:139]
buffer_load_dwordx4 v[224:227],v250,s[20:23],s47 offen offset:0 sc1
M a[136:139],a[240:243],a[196:199],a[136:139]
v_cvt_pk_bf16_f32 v196,v238,v235
v_cvt_pk_bf16_f32 v200,v236,v200
M a[136:139],a[244:247],a[236:239],a[136:139]
v_lshlrev_b32 v234,16,v197
v_lshlrev_b32 v232,16,v193
M a[140:143],a[244:247],v[216:219],a[140:143]
v_lshlrev_b32 v233,16,v195
v_lshlrev_b32 v237,16,v203
M a[140:143],a[240:243],a[236:239],a[140:143]
buffer_load_short_d16_hi v241,v246,s[8:11],s29 offen offset:384
M a[140:143],a[252:255],a[196:199],a[140:143]
v_lshlrev_b32 v236,16,v201
v_lshlrev_b32 v235,16,v199
M a[144:147],a[252:255],a[236:239],a[144:147]
buffer_load_short_d16_hi v242,v246,s[8:11],s29 offen offset:768
M a[144:147],a[240:243],v[216:219],a[144:147]
v_fmac_f32 v232,s43,v234
v_fmac_f32 v237,4.0,v233
M a[144:147],a[244:247],a[192:195],a[144:147]
buffer_load_short_d16_hi v243,v246,s[8:11],s29 offen offset:1152
M a[148:151],a[244:247],a[232:235],a[148:151]
v_fma_f32 v238,-4.0,v234,v236
v_fmac_f32 v232,s45,v236
M a[148:151],a[240:243],a[192:195],a[148:151]
buffer_load_short_d16_hi v244,v246,s[16:19],s29 offen offset:1536
M a[148:151],a[252:255],v[216:219],a[148:151]
v_fmac_f32 v237,s41,v235
v_sub_f32 v236,v236,v234
M a[152:155],a[252:255],a[192:195],a[152:155]
v_fma_f32 v234,-4.0,v233,v235
v_sub_f32 v235,v235,v233
M a[152:155],a[240:243],a[232:235],a[152:155]
v_add_f32 v233,v238,v234
v_sub_f32 v238,v238,v234
M a[152:155],a[244:247],a[212:215],a[152:155]
v_fma_f32 v234,2.0,v235,v236
v_fmac_f32 v236,-2.0,v235
M a[156:159],a[244:247],v[220:223],a[156:159]
buffer_load_dwordx4 a[244:247],v250,s[20:23],s47 offen offset:1024 sc1
M a[156:159],a[240:243],a[212:215],a[156:159]
v_and_b32 v197,s42,v197
v_and_b32 v193,s42,v193
M a[156:159],a[252:255],a[232:235],a[156:159]
s_waitcnt vmcnt(19)
buffer_load_dwordx4 a[240:243],v250,s[20:23],s47 offen offset:2048 sc1
M a[160:163],a[228:231],a[204:207],a[160:163]
s_waitcnt vmcnt(19)
s_add_u32 s48,s74,33792
v_and_b32 v195,s42,v195
v_and_b32 v203,s42,v203
M a[160:163],a[216:219],a[208:211],a[160:163]
s_waitcnt vmcnt(18)
v_and_b32 v201,s42,v201
v_and_b32 v199,s42,v199
M a[160:163],a[200:203],v[228:231],a[160:163]
v_fmac_f32 v193,s43,v197
v_fmac_f32 v203,4.0,v195
M a[164:167],a[200:203],a[196:199],a[164:167]
buffer_load_dwordx4 a[252:255],v250,s[20:23],s48 offen offset:0 sc1
M a[164:167],a[216:219],v[228:231],a[164:167]
v_fma_f32 v235,-4.0,v197,v201
v_fmac_f32 v193,s45,v201
M a[164:167],a[228:231],a[208:211],a[164:167]
v_fmac_f32 v203,s41,v199
v_sub_f32 v201,v201,v197
M a[168:171],a[228:231],v[228:231],a[168:171]
v_fma_f32 v197,-4.0,v195,v199
v_sub_f32 v199,v199,v195
M a[168:171],a[216:219],a[196:199],a[168:171]
buffer_load_dwordx4 a[204:207],v250,s[20:23],s48 offen offset:1024 sc1
M a[168:171],a[200:203],a[236:239],a[168:171]
v_add_f32 v195,v235,v197
v_sub_f32 v235,v235,v197
M a[172:175],a[200:203],v[216:219],a[172:175]
v_fma_f32 v197,2.0,v199,v201
v_fmac_f32 v201,-2.0,v199
M a[172:175],a[216:219],a[236:239],a[172:175]
v_cvt_pk_bf16_f32 v193,v232,v193
v_cvt_pk_bf16_f32 v203,v237,v203
M a[172:175],a[228:231],a[196:199],a[172:175]
buffer_load_dwordx4 a[208:211],v250,s[20:23],s48 offen offset:2048 sc1
M a[176:179],a[228:231],a[236:239],a[176:179]
s_add_u32 s46,s74,36864
v_cvt_pk_bf16_f32 v195,v233,v195
v_cvt_pk_bf16_f32 v199,v234,v197
M a[176:179],a[216:219],v[216:219],a[176:179]
v_cvt_pk_bf16_f32 v197,v238,v235
v_cvt_pk_bf16_f32 v201,v236,v201
M a[176:179],a[200:203],a[192:195],a[176:179]
s_waitcnt vmcnt(16)
v_add_u32 v238,121856,v247
v_lshlrev_b32 v234,16,v208
M a[180:183],a[200:203],a[232:235],a[180:183]
buffer_load_dwordx4 v[228:231],v250,s[20:23],s46 offen offset:0 sc1
M a[180:183],a[216:219],a[192:195],a[180:183]
ds_read_b128 a[196:199],v248 offset:17408
v_lshlrev_b32 v232,16,v204
M a[180:183],a[228:231],v[216:219],a[180:183]
ds_write2st64_b64 v238,v[192:193],v[202:203] offset0:2 offset1:19
M a[184:187],a[228:231],a[192:195],a[184:187]
s_add_u32 s28,s70,0
ds_read_b128 a[236:239],v249 offset:17408
ds_read_b128 v[216:219],v248 offset:17920
M a[184:187],a[216:219],a[232:235],a[184:187]
buffer_load_dwordx2 v[192:193],v251,s[12:15],s28 offen offset:0
M a[184:187],a[200:203],a[212:215],a[184:187]
ds_write2st64_b64 v247,v[194:195],v[196:197] offset0:104 offset1:121
M a[188:191],a[200:203],v[220:223],a[188:191]
ds_read_b128 a[192:195],v249 offset:17920
v_lshlrev_b32 v233,16,v206
M a[188:191],a[216:219],a[212:215],a[188:191]
buffer_load_dwordx2 v[202:203],v251,s[16:19],s28 offen offset:1536
M a[188:191],a[228:231],a[232:235],a[188:191]
s_waitcnt lgkmcnt(5)
ds_write2st64_b64 v247,v[198:199],v[200:201] offset0:138 offset1:155
M v[0:3],a[248:251],a[196:199],v[0:3]
s_waitcnt vmcnt(14) lgkmcnt(4)
ds_read_b128 a[200:203],v248 offset:18432
v_lshlrev_b32 v237,16,v214
M v[0:3],a[224:227],a[236:239],v[0:3]
s_waitcnt vmcnt(13) lgkmcnt(4)
buffer_load_dwordx2 v[194:195],v251,s[8:11],s28 offen offset:0
M v[0:3],a[220:223],v[216:219],v[0:3]
s_waitcnt lgkmcnt(2)
ds_read_b128 v[220:223],v249 offset:18432
v_lshlrev_b32 v236,16,v212
M v[4:7],a[220:223],a[192:195],v[4:7]
v_lshlrev_b32 v235,16,v210
v_fmac_f32 v232,s43,v234
M v[4:7],a[224:227],v[216:219],v[4:7]
v_fmac_f32 v237,4.0,v233
v_fma_f32 v238,-4.0,v234,v236
M v[4:7],a[248:251],a[236:239],v[4:7]
buffer_load_dwordx2 v[196:197],v251,s[8:11],s28 offen offset:384
M v[8:11],a[248:251],v[216:219],v[8:11]
ds_read_b128 a[212:215],v248 offset:18944
v_fmac_f32 v232,s45,v236
M v[8:11],a[224:227],a[192:195],v[8:11]
s_waitcnt lgkmcnt(2)
ds_read_b128 a[216:219],v249 offset:18944
v_fmac_f32 v237,s41,v235
M v[8:11],a[220:223],a[200:203],v[8:11]
s_waitcnt lgkmcnt(2)
v_sub_f32 v236,v236,v234
v_fma_f32 v234,-4.0,v233,v235
M v[12:15],a[220:223],v[220:223],v[12:15]
buffer_load_dwordx2 v[198:199],v251,s[8:11],s28 offen offset:768
M v[12:15],a[224:227],a[200:203],v[12:15]
v_sub_f32 v235,v235,v233
v_add_f32 v233,v238,v234
M v[12:15],a[248:251],a[192:195],v[12:15]
v_sub_f32 v238,v238,v234
v_fma_f32 v234,2.0,v235,v236
M v[16:19],a[248:251],a[200:203],v[16:19]
ds_read_b128 a[228:231],v249 offset:19456
v_fmac_f32 v236,-2.0,v235
M v[16:19],a[224:227],v[220:223],v[16:19]
s_waitcnt lgkmcnt(2)
buffer_load_dwordx2 v[200:201],v251,s[8:11],s28 offen offset:1152
M v[16:19],a[220:223],a[212:215],v[16:19]
s_waitcnt lgkmcnt(1)
ds_read_b128 a[232:235],v248 offset:19456
v_and_b32 v208,s42,v208
M v[20:23],a[220:223],a[216:219],v[20:23]
v_and_b32 v204,s42,v204
v_and_b32 v206,s42,v206
M v[20:23],a[224:227],a[212:215],v[20:23]
v_and_b32 v214,s42,v214
v_and_b32 v212,s42,v212
M v[20:23],a[248:251],v[220:223],v[20:23]
v_and_b32 v210,s42,v210
v_fmac_f32 v204,s43,v208
M v[24:27],a[248:251],a[212:215],v[24:27]
v_fmac_f32 v214,4.0,v206
v_fma_f32 v235,-4.0,v208,v212
M v[24:27],a[224:227],a[216:219],v[24:27]
s_waitcnt lgkmcnt(1)
v_fmac_f32 v204,s45,v212
v_fmac_f32 v214,s41,v210
M v[24:27],a[220:223],a[228:231],v[24:27]
s_waitcnt lgkmcnt(0)
v_sub_f32 v212,v212,v208
v_fma_f32 v208,-4.0,v206,v210
M v[28:31],a[220:223],a[232:235],v[28:31]
buffer_load_dwordx4 a[220:223],v250,s[20:23],s46 offen offset:1024 sc1
M v[28:31],a[224:227],a[228:231],v[28:31]
v_sub_f32 v210,v210,v206
v_add_f32 v206,v235,v208
M v[28:31],a[248:251],a[216:219],v[28:31]
s_waitcnt vmcnt(17)
buffer_load_dwordx4 a[224:227],v250,s[20:23],s46 offen offset:2048 sc1
M v[32:35],v[224:227],a[196:199],v[32:35]
s_waitcnt vmcnt(13)
s_add_u32 s47,s74,39936
v_sub_f32 v235,v235,v208
v_fma_f32 v208,2.0,v210,v212
M v[32:35],a[244:247],a[236:239],v[32:35]
s_waitcnt vmcnt(12)
v_fmac_f32 v212,-2.0,v210
v_cvt_pk_bf16_f32 v204,v232,v204
M v[32:35],a[240:243],v[216:219],v[32:35]
v_cvt_pk_bf16_f32 v214,v237,v214
v_cvt_pk_bf16_f32 v206,v233,v206
M v[36:39],a[240:243],a[192:195],v[36:39]
buffer_load_dwordx4 a[248:251],v250,s[20:23],s47 offen offset:0 sc1
M v[36:39],a[244:247],v[216:219],v[36:39]
v_cvt_pk_bf16_f32 v210,v234,v208
v_cvt_pk_bf16_f32 v208,v238,v235
M v[36:39],v[224:227],a[236:239],v[36:39]
v_cvt_pk_bf16_f32 v212,v236,v212
v_lshlrev_b32 v234,16,v209
M v[40:43],v[224:227],v[216:219],v[40:43]
v_lshlrev_b32 v232,16,v205
v_lshlrev_b32 v233,16,v207
M v[40:43],a[244:247],a[192:195],v[40:43]
v_lshlrev_b32 v237,16,v215
v_lshlrev_b32 v236,16,v213
M v[40:43],a[240:243],a[200:203],v[40:43]
v_lshlrev_b32 v235,16,v211
v_fmac_f32 v232,s43,v234
M v[44:47],a[240:243],v[220:223],v[44:47]
v_fmac_f32 v237,4.0,v233
v_fma_f32 v238,-4.0,v234,v236
M v[44:47],a[244:247],a[200:203],v[44:47]
v_fmac_f32 v232,s45,v236
v_fmac_f32 v237,s41,v235
M v[44:47],v[224:227],a[192:195],v[44:47]
v_sub_f32 v236,v236,v234
v_fma_f32 v234,-4.0,v233,v235
M v[48:51],v[224:227],a[200:203],v[48:51]
v_sub_f32 v235,v235,v233
v_add_f32 v233,v238,v234
M v[48:51],a[244:247],v[220:223],v[48:51]
v_sub_f32 v238,v238,v234
v_fma_f32 v234,2.0,v235,v236
M v[48:51],a[240:243],a[212:215],v[48:51]
v_fmac_f32 v236,-2.0,v235
v_and_b32 v209,s42,v209
M v[52:55],a[240:243],a[216:219],v[52:55]
v_and_b32 v205,s42,v205
v_and_b32 v207,s42,v207
M v[52:55],a[244:247],a[212:215],v[52:55]
v_and_b32 v215,s42,v215
v_and_b32 v213,s42,v213
M v[52:55],v[224:227],v[220:223],v[52:55]
v_and_b32 v211,s42,v211
v_fmac_f32 v205,s43,v209
M v[56:59],v[224:227],a[212:215],v[56:59]
v_fmac_f32 v215,4.0,v207
v_fma_f32 v235,-4.0,v209,v213
M v[56:59],a[244:247],a[216:219],v[56:59]
v_fmac_f32 v205,s45,v213
v_fmac_f32 v215,s41,v211
M v[56:59],a[240:243],a[228:231],v[56:59]
v_sub_f32 v213,v213,v209
v_fma_f32 v209,-4.0,v207,v211
M v[60:63],a[240:243],a[232:235],v[60:63]
buffer_load_dwordx4 a[240:243],v250,s[20:23],s47 offen offset:1024 sc1
M v[60:63],a[244:247],a[228:231],v[60:63]
v_sub_f32 v211,v211,v207
v_add_f32 v207,v235,v209
M v[60:63],v[224:227],a[216:219],v[60:63]
s_waitcnt vmcnt(13)
buffer_load_dwordx4 a[244:247],v250,s[20:23],s47 offen offset:2048 sc1
M v[64:67],a[252:255],a[196:199],v[64:67]
s_waitcnt vmcnt(13)
s_add_u32 s48,s74,43008
v_sub_f32 v235,v235,v209
v_fma_f32 v209,2.0,v211,v213
M v[64:67],a[204:207],a[236:239],v[64:67]
s_waitcnt vmcnt(12)
v_fmac_f32 v213,-2.0,v211
v_cvt_pk_bf16_f32 v205,v232,v205
M v[64:67],a[208:211],v[216:219],v[64:67]
v_cvt_pk_bf16_f32 v215,v237,v215
v_cvt_pk_bf16_f32 v207,v233,v207
M v[68:71],a[208:211],a[192:195],v[68:71]
buffer_load_dwordx4 v[224:227],v250,s[20:23],s48 offen offset:0 sc1
M v[68:71],a[204:207],v[216:219],v[68:71]
v_cvt_pk_bf16_f32 v211,v234,v209
v_cvt_pk_bf16_f32 v209,v238,v235
M v[68:71],a[252:255],a[236:239],v[68:71]
v_cvt_pk_bf16_f32 v213,v236,v213
v_add_u32 v238,121856,v247
M v[72:75],a[252:255],v[216:219],v[72:75]
M v[72:75],a[204:207],a[192:195],v[72:75]
buffer_load_dwordx4 a[196:199],v250,s[20:23],s48 offen offset:1024 sc1
M v[72:75],a[208:211],a[200:203],v[72:75]
ds_write2st64_b64 v238,v[204:205],v[214:215] offset0:3 offset1:20
M v[76:79],a[208:211],v[220:223],v[76:79]
s_add_u32 s28,s70,393216
M v[76:79],a[204:207],a[200:203],v[76:79]
M v[76:79],a[252:255],a[192:195],v[76:79]
buffer_load_dwordx4 a[236:239],v250,s[20:23],s48 offen offset:2048 sc1
M v[80:83],a[252:255],a[200:203],v[80:83]
s_add_u32 s46,s75,9216
M v[80:83],a[204:207],v[220:223],v[80:83]
M v[80:83],a[208:211],a[212:215],v[80:83]
ds_write2st64_b64 v247,v[206:207],v[208:209] offset0:105 offset1:122
M v[84:87],a[208:211],a[216:219],v[84:87]
buffer_load_dwordx4 v[216:219],v250,s[20:23],s46 offen offset:0 sc1
M v[84:87],a[204:207],a[212:215],v[84:87]
ds_read_b128 a[192:195],v248 offset:26112
M v[84:87],a[252:255],v[220:223],v[84:87]
ds_write2st64_b64 v247,v[210:211],v[212:213] offset0:139 offset1:156
M v[88:91],a[252:255],a[212:215],v[88:91]
buffer_load_dwordx2 v[204:205],v245,s[12:15],s28 offen offset:0
M v[88:91],a[204:207],a[216:219],v[88:91]
ds_read_b128 a[200:203],v249 offset:26112
ds_read_b128 v[220:223],v248 offset:26624
M v[88:91],a[208:211],a[228:231],v[88:91]
ds_read_b128 a[212:215],v249 offset:26624
M v[92:95],a[208:211],a[232:235],v[92:95]
buffer_load_dwordx2 v[214:215],v245,s[16:19],s28 offen offset:1536
M v[92:95],a[204:207],a[228:231],v[92:95]
M v[92:95],a[252:255],a[216:219],v[92:95]
s_waitcnt vmcnt(17) lgkmcnt(4)
M v[96:99],v[228:231],a[192:195],v[96:99]
s_waitcnt vmcnt(10) lgkmcnt(2)
ds_read_b128 a[208:211],v248 offset:27136
M v[96:99],a[220:223],a[200:203],v[96:99]
s_waitcnt vmcnt(9) lgkmcnt(2)
buffer_load_dwordx2 v[206:207],v245,s[8:11],s28 offen offset:0
M v[96:99],a[224:227],v[220:223],v[96:99]
s_waitcnt lgkmcnt(1)
ds_read_b128 a[232:235],v249 offset:27136
v_lshlrev_b32 v234,16,v196
M v[100:103],a[224:227],a[212:215],v[100:103]
v_lshlrev_b32 v232,16,v192
v_lshlrev_b32 v233,16,v194
M v[100:103],a[220:223],v[220:223],v[100:103]
v_lshlrev_b32 v237,16,v202
v_lshlrev_b32 v236,16,v200
M v[100:103],v[228:231],a[200:203],v[100:103]
buffer_load_dwordx2 v[208:209],v245,s[8:11],s28 offen offset:384
M v[104:107],v[228:231],v[220:223],v[104:107]
ds_read_b128 a[204:207],v248 offset:27648
v_lshlrev_b32 v235,16,v198
M v[104:107],a[220:223],a[212:215],v[104:107]
s_waitcnt lgkmcnt(2)
ds_read_b128 a[228:231],v249 offset:27648
v_fmac_f32 v232,s43,v234
M v[104:107],a[224:227],a[208:211],v[104:107]
s_waitcnt lgkmcnt(2)
v_fmac_f32 v237,4.0,v233
v_fma_f32 v238,-4.0,v234,v236
M v[108:111],a[224:227],a[232:235],v[108:111]
buffer_load_dwordx2 v[210:211],v245,s[8:11],s28 offen offset:768
M v[108:111],a[220:223],a[208:211],v[108:111]
v_fmac_f32 v232,s45,v236
v_fmac_f32 v237,s41,v235
M v[108:111],v[228:231],a[212:215],v[108:111]
v_sub_f32 v236,v236,v234
v_fma_f32 v234,-4.0,v233,v235
M v[112:115],v[228:231],a[208:211],v[112:115]
ds_read_b128 a[216:219],v249 offset:28160
v_sub_f32 v235,v235,v233
M v[112:115],a[220:223],a[232:235],v[112:115]
s_waitcnt lgkmcnt(2)
buffer_load_dwordx2 v[212:213],v245,s[8:11],s28 offen offset:1152
M v[112:115],a[224:227],a[204:207],v[112:115]
s_waitcnt lgkmcnt(1)
ds_read_b128 a[252:255],v248 offset:28160
v_add_f32 v233,v238,v234
M v[116:119],a[224:227],a[228:231],v[116:119]
v_sub_f32 v238,v238,v234
v_fma_f32 v234,2.0,v235,v236
M v[116:119],a[220:223],a[204:207],v[116:119]
v_fmac_f32 v236,-2.0,v235
v_and_b32 v196,s42,v196
M v[116:119],v[228:231],a[232:235],v[116:119]
v_and_b32 v192,s42,v192
v_and_b32 v194,s42,v194
M v[120:123],v[228:231],a[204:207],v[120:123]
v_and_b32 v202,s42,v202
v_and_b32 v200,s42,v200
M v[120:123],a[220:223],a[228:231],v[120:123]
s_waitcnt lgkmcnt(1)
v_and_b32 v198,s42,v198
v_fmac_f32 v192,s43,v196
M v[120:123],a[224:227],a[216:219],v[120:123]
s_waitcnt lgkmcnt(0)
v_fmac_f32 v202,4.0,v194
v_fma_f32 v235,-4.0,v196,v200
M v[124:127],a[224:227],a[252:255],v[124:127]
buffer_load_dwordx4 a[224:227],v250,s[20:23],s46 offen offset:1024 sc1
M v[124:127],a[220:223],a[216:219],v[124:127]
v_fmac_f32 v192,s45,v200
v_fmac_f32 v202,s41,v198
M v[124:127],v[228:231],a[228:231],v[124:127]
s_waitcnt vmcnt(13)
buffer_load_dwordx4 a[220:223],v250,s[20:23],s46 offen offset:2048 sc1
M v[128:131],a[248:251],a[192:195],v[128:131]
s_waitcnt vmcnt(13)
s_add_u32 s47,s75,12288
v_sub_f32 v200,v200,v196
v_fma_f32 v196,-4.0,v194,v198
M v[128:131],a[240:243],a[200:203],v[128:131]
s_waitcnt vmcnt(12)
v_sub_f32 v198,v198,v194
v_add_f32 v194,v235,v196
M v[128:131],a[244:247],v[220:223],v[128:131]
v_sub_f32 v235,v235,v196
v_fma_f32 v196,2.0,v198,v200
M v[132:135],a[244:247],a[212:215],v[132:135]
buffer_load_dwordx4 v[228:231],v250,s[20:23],s47 offen offset:0 sc1
M v[132:135],a[240:243],v[220:223],v[132:135]
v_fmac_f32 v200,-2.0,v198
v_cvt_pk_bf16_f32 v192,v232,v192
M v[132:135],a[248:251],a[200:203],v[132:135]
v_cvt_pk_bf16_f32 v202,v237,v202
v_cvt_pk_bf16_f32 v194,v233,v194
M v[136:139],a[248:251],v[220:223],v[136:139]
v_cvt_pk_bf16_f32 v198,v234,v196
v_cvt_pk_bf16_f32 v196,v238,v235
M v[136:139],a[240:243],a[212:215],v[136:139]
v_cvt_pk_bf16_f32 v200,v236,v200
v_lshlrev_b32 v234,16,v197
M v[136:139],a[244:247],a[208:211],v[136:139]
v_lshlrev_b32 v232,16,v193
v_lshlrev_b32 v233,16,v195
M v[140:143],a[244:247],a[232:235],v[140:143]
v_lshlrev_b32 v237,16,v203
v_lshlrev_b32 v236,16,v201
M v[140:143],a[240:243],a[208:211],v[140:143]
v_lshlrev_b32 v235,16,v199
v_fmac_f32 v232,s43,v234
M v[140:143],a[248:251],a[212:215],v[140:143]
v_fmac_f32 v237,4.0,v233
v_fma_f32 v238,-4.0,v234,v236
M v[144:147],a[248:251],a[208:211],v[144:147]
v_fmac_f32 v232,s45,v236
v_fmac_f32 v237,s41,v235
M v[144:147],a[240:243],a[232:235],v[144:147]
v_sub_f32 v236,v236,v234
v_fma_f32 v234,-4.0,v233,v235
M v[144:147],a[244:247],a[204:207],v[144:147]
v_sub_f32 v235,v235,v233
v_add_f32 v233,v238,v234
M v[148:151],a[244:247],a[228:231],v[148:151]
v_sub_f32 v238,v238,v234
v_fma_f32 v234,2.0,v235,v236
M v[148:151],a[240:243],a[204:207],v[148:151]
v_fmac_f32 v236,-2.0,v235
v_and_b32 v197,s42,v197
M v[148:151],a[248:251],a[232:235],v[148:151]
v_and_b32 v193,s42,v193
v_and_b32 v195,s42,v195
M v[152:155],a[248:251],a[204:207],v[152:155]
v_and_b32 v203,s42,v203
v_and_b32 v201,s42,v201
M v[152:155],a[240:243],a[228:231],v[152:155]
v_and_b32 v199,s42,v199
v_fmac_f32 v193,s43,v197
M v[152:155],a[244:247],a[216:219],v[152:155]
v_fmac_f32 v203,4.0,v195
v_fma_f32 v235,-4.0,v197,v201
M v[156:159],a[244:247],a[252:255],v[156:159]
buffer_load_dwordx4 a[244:247],v250,s[20:23],s47 offen offset:1024 sc1
M v[156:159],a[240:243],a[216:219],v[156:159]
v_fmac_f32 v193,s45,v201
v_fmac_f32 v203,s41,v199
M v[156:159],a[248:251],a[228:231],v[156:159]
s_waitcnt vmcnt(13)
buffer_load_dwordx4 a[240:243],v250,s[20:23],s47 offen offset:2048 sc1
M v[160:163],v[224:227],a[192:195],v[160:163]
s_waitcnt vmcnt(13)
s_add_u32 s48,s75,15360
v_sub_f32 v201,v201,v197
v_fma_f32 v197,-4.0,v195,v199
M v[160:163],a[196:199],a[200:203],v[160:163]
s_waitcnt vmcnt(12)
v_sub_f32 v199,v199,v195
v_add_f32 v195,v235,v197
M v[160:163],a[236:239],v[220:223],v[160:163]
v_sub_f32 v235,v235,v197
v_fma_f32 v197,2.0,v199,v201
M v[164:167],a[236:239],a[212:215],v[164:167]
buffer_load_dwordx4 a[248:251],v250,s[20:23],s48 offen offset:0 sc1
M v[164:167],a[196:199],v[220:223],v[164:167]
v_fmac_f32 v201,-2.0,v199
v_cvt_pk_bf16_f32 v193,v232,v193
M v[164:167],v[224:227],a[200:203],v[164:167]
v_cvt_pk_bf16_f32 v203,v237,v203
v_cvt_pk_bf16_f32 v195,v233,v195
M v[168:171],v[224:227],v[220:223],v[168:171]
v_cvt_pk_bf16_f32 v199,v234,v197
v_cvt_pk_bf16_f32 v197,v238,v235
M v[168:171],a[196:199],a[212:215],v[168:171]
buffer_load_dwordx4 a[192:195],v250,s[20:23],s48 offen offset:1024 sc1
M v[168:171],a[236:239],a[208:211],v[168:171]
v_cvt_pk_bf16_f32 v201,v236,v201
v_add_u32 v238,139264,v247
M v[172:175],a[236:239],a[232:235],v[172:175]
M v[172:175],a[196:199],a[208:211],v[172:175]
M v[172:175],v[224:227],a[212:215],v[172:175]
buffer_load_dwordx4 a[200:203],v250,s[20:23],s48 offen offset:2048 sc1
M v[176:179],v[224:227],a[208:211],v[176:179]
s_add_u32 s46,s75,18432
M v[176:179],a[196:199],a[232:235],v[176:179]
M v[176:179],a[236:239],a[204:207],v[176:179]
s_barrier
ds_write2st64_b64 v238,v[192:193],v[202:203] offset0:0 offset1:17
M v[180:183],a[236:239],a[228:231],v[180:183]
s_add_u32 s28,s70,786432
buffer_load_dwordx4 v[220:223],v250,s[20:23],s46 offen offset:0 sc1
M v[180:183],a[196:199],a[204:207],v[180:183]
ds_read_b128 a[212:215],v248 offset:34816
M v[180:183],v[224:227],a[232:235],v[180:183]
ds_write2st64_b64 v247,v[194:195],v[196:197] offset0:34 offset1:51
M v[184:187],v[224:227],a[204:207],v[184:187]
buffer_load_dwordx2 v[192:193],v245,s[12:15],s28 offen offset:0
M v[184:187],a[196:199],a[228:231],v[184:187]
ds_read_b128 a[208:211],v249 offset:34816
ds_read_b128 a[232:235],v248 offset:35328
M v[184:187],a[236:239],a[216:219],v[184:187]
ds_write2st64_b64 v247,v[198:199],v[200:201] offset0:68 offset1:85
M v[188:191],a[236:239],a[252:255],v[188:191]
buffer_load_dwordx2 v[202:203],v245,s[16:19],s28 offen offset:1536
M v[188:191],a[196:199],a[216:219],v[188:191]
ds_read_b128 a[204:207],v249 offset:35328
M v[188:191],v[224:227],a[228:231],v[188:191]
s_waitcnt vmcnt(17) lgkmcnt(5)
M a[0:3],v[216:219],a[212:215],a[0:3]
s_waitcnt vmcnt(10) lgkmcnt(3)
ds_read_b128 a[236:239],v248 offset:35840
M a[0:3],a[224:227],a[208:211],a[0:3]
s_waitcnt vmcnt(9) lgkmcnt(3)
buffer_load_dwordx2 v[194:195],v245,s[8:11],s28 offen offset:0
M a[0:3],a[220:223],a[232:235],a[0:3]
s_waitcnt lgkmcnt(1)
ds_read_b128 a[252:255],v249 offset:35840
v_lshlrev_b32 v234,16,v208
M a[4:7],a[220:223],a[204:207],a[4:7]
v_lshlrev_b32 v232,16,v204
v_lshlrev_b32 v233,16,v206
M a[4:7],a[224:227],a[232:235],a[4:7]
v_lshlrev_b32 v237,16,v214
v_lshlrev_b32 v236,16,v212
M a[4:7],v[216:219],a[208:211],a[4:7]
buffer_load_dwordx2 v[196:197],v245,s[8:11],s28 offen offset:384
M a[8:11],v[216:219],a[232:235],a[8:11]
ds_read_b128 a[196:199],v248 offset:36352
v_lshlrev_b32 v235,16,v210
M a[8:11],a[224:227],a[204:207],a[8:11]
s_waitcnt lgkmcnt(2)
ds_read_b128 a[216:219],v249 offset:36352
v_fmac_f32 v232,s43,v234
M a[8:11],a[220:223],a[236:239],a[8:11]
s_waitcnt lgkmcnt(2)
v_fmac_f32 v237,4.0,v233
v_fma_f32 v238,-4.0,v234,v236
M a[12:15],a[220:223],a[252:255],a[12:15]
buffer_load_dwordx2 v[198:199],v245,s[8:11],s28 offen offset:768
M a[12:15],a[224:227],a[236:239],a[12:15]
v_fmac_f32 v232,s45,v236
v_fmac_f32 v237,s41,v235
M a[12:15],v[216:219],a[204:207],a[12:15]
v_sub_f32 v236,v236,v234
v_fma_f32 v234,-4.0,v233,v235
M a[16:19],v[216:219],a[236:239],a[16:19]
ds_read_b128 a[228:231],v249 offset:36864
v_sub_f32 v235,v235,v233
M a[16:19],a[224:227],a[252:255],a[16:19]
s_waitcnt lgkmcnt(2)
buffer_load_dwordx2 v[200:201],v245,s[8:11],s28 offen offset:1152
M a[16:19],a[220:223],a[196:199],a[16:19]
s_waitcnt lgkmcnt(1)
ds_read_b128 v[224:227],v248 offset:36864
v_add_f32 v233,v238,v234
M a[20:23],a[220:223],a[216:219],a[20:23]
v_sub_f32 v238,v238,v234
v_fma_f32 v234,2.0,v235,v236
M a[20:23],a[224:227],a[196:199],a[20:23]
v_fmac_f32 v236,-2.0,v235
v_and_b32 v208,s42,v208
M a[20:23],v[216:219],a[252:255],a[20:23]
v_and_b32 v204,s42,v204
v_and_b32 v206,s42,v206
M a[24:27],v[216:219],a[196:199],a[24:27]
v_and_b32 v214,s42,v214
v_and_b32 v212,s42,v212
M a[24:27],a[224:227],a[216:219],a[24:27]
s_waitcnt lgkmcnt(1)
v_and_b32 v210,s42,v210
v_fmac_f32 v204,s43,v208
M a[24:27],a[220:223],a[228:231],a[24:27]
s_waitcnt lgkmcnt(0)
v_fmac_f32 v214,4.0,v206
v_fma_f32 v235,-4.0,v208,v212
M a[28:31],a[220:223],v[224:227],a[28:31]
buffer_load_dwordx4 a[220:223],v250,s[20:23],s46 offen offset:1024 sc1
M a[28:31],a[224:227],a[228:231],a[28:31]
v_fmac_f32 v204,s45,v212
v_fmac_f32 v214,s41,v210
M a[28:31],v[216:219],a[216:219],a[28:31]
s_waitcnt vmcnt(13)
buffer_load_dwordx4 a[224:227],v250,s[20:23],s46 offen offset:2048 sc1
M a[32:35],v[228:231],a[212:215],a[32:35]
s_waitcnt vmcnt(13)
s_add_u32 s47,s75,21504
v_sub_f32 v212,v212,v208
v_fma_f32 v208,-4.0,v206,v210
M a[32:35],a[244:247],a[208:211],a[32:35]
s_waitcnt vmcnt(12)
v_sub_f32 v210,v210,v206
v_add_f32 v206,v235,v208
M a[32:35],a[240:243],a[232:235],a[32:35]
v_sub_f32 v235,v235,v208
v_fma_f32 v208,2.0,v210,v212
M a[36:39],a[240:243],a[204:207],a[36:39]
buffer_load_dwordx4 v[216:219],v250,s[20:23],s47 offen offset:0 sc1
M a[36:39],a[244:247],a[232:235],a[36:39]
v_fmac_f32 v212,-2.0,v210
v_cvt_pk_bf16_f32 v204,v232,v204
M a[36:39],v[228:231],a[208:211],a[36:39]
v_cvt_pk_bf16_f32 v214,v237,v214
v_cvt_pk_bf16_f32 v206,v233,v206
M a[40:43],v[228:231],a[232:235],a[40:43]
v_cvt_pk_bf16_f32 v210,v234,v208
v_cvt_pk_bf16_f32 v208,v238,v235
M a[40:43],a[244:247],a[204:207],a[40:43]
v_cvt_pk_bf16_f32 v212,v236,v212
v_lshlrev_b32 v234,16,v209
M a[40:43],a[240:243],a[236:239],a[40:43]
v_lshlrev_b32 v232,16,v205
v_lshlrev_b32 v233,16,v207
M a[44:47],a[240:243],a[252:255],a[44:47]
v_lshlrev_b32 v237,16,v215
v_lshlrev_b32 v236,16,v213
M a[44:47],a[244:247],a[236:239],a[44:47]
v_lshlrev_b32 v235,16,v211
v_fmac_f32 v232,s43,v234
M a[44:47],v[228:231],a[204:207],a[44:47]
v_fmac_f32 v237,4.0,v233
v_fma_f32 v238,-4.0,v234,v236
M a[48:51],v[228:231],a[236:239],a[48:51]
v_fmac_f32 v232,s45,v236
v_fmac_f32 v237,s41,v235
M a[48:51],a[244:247],a[252:255],a[48:51]
v_sub_f32 v236,v236,v234
v_fma_f32 v234,-4.0,v233,v235
M a[48:51],a[240:243],a[196:199],a[48:51]
v_sub_f32 v235,v235,v233
v_add_f32 v233,v238,v234
M a[52:55],a[240:243],a[216:219],a[52:55]
v_sub_f32 v238,v238,v234
v_fma_f32 v234,2.0,v235,v236
M a[52:55],a[244:247],a[196:199],a[52:55]
v_fmac_f32 v236,-2.0,v235
v_and_b32 v209,s42,v209
M a[52:55],v[228:231],a[252:255],a[52:55]
v_and_b32 v205,s42,v205
v_and_b32 v207,s42,v207
M a[56:59],v[228:231],a[196:199],a[56:59]
v_and_b32 v215,s42,v215
v_and_b32 v213,s42,v213
M a[56:59],a[244:247],a[216:219],a[56:59]
v_and_b32 v211,s42,v211
v_fmac_f32 v205,s43,v209
M a[56:59],a[240:243],a[228:231],a[56:59]
v_fmac_f32 v215,4.0,v207
v_fma_f32 v235,-4.0,v209,v213
M a[60:63],a[240:243],v[224:227],a[60:63]
buffer_load_dwordx4 a[240:243],v250,s[20:23],s47 offen offset:1024 sc1
M a[60:63],a[244:247],a[228:231],a[60:63]
v_fmac_f32 v205,s45,v213
v_fmac_f32 v215,s41,v211
M a[60:63],v[228:231],a[216:219],a[60:63]
s_waitcnt vmcnt(13)
buffer_load_dwordx4 a[244:247],v250,s[20:23],s47 offen offset:2048 sc1
M a[64:67],a[248:251],a[212:215],a[64:67]
s_waitcnt vmcnt(13)
s_add_u32 s48,s75,24576
v_sub_f32 v213,v213,v209
v_fma_f32 v209,-4.0,v207,v211
M a[64:67],a[192:195],a[208:211],a[64:67]
s_waitcnt vmcnt(12)
v_sub_f32 v211,v211,v207
v_add_f32 v207,v235,v209
M a[64:67],a[200:203],a[232:235],a[64:67]
v_sub_f32 v235,v235,v209
v_fma_f32 v209,2.0,v211,v213
M a[68:71],a[200:203],a[204:207],a[68:71]
buffer_load_dwordx4 v[228:231],v250,s[20:23],s48 offen offset:0 sc1
M a[68:71],a[192:195],a[232:235],a[68:71]
v_fmac_f32 v213,-2.0,v211
v_cvt_pk_bf16_f32 v205,v232,v205
M a[68:71],a[248:251],a[208:211],a[68:71]
v_cvt_pk_bf16_f32 v215,v237,v215
v_cvt_pk_bf16_f32 v207,v233,v207
M a[72:75],a[248:251],a[232:235],a[72:75]
v_cvt_pk_bf16_f32 v211,v234,v209
v_cvt_pk_bf16_f32 v209,v238,v235
M a[72:75],a[192:195],a[204:207],a[72:75]
buffer_load_dwordx4 a[212:215],v250,s[20:23],s48 offen offset:1024 sc1
M a[72:75],a[200:203],a[236:239],a[72:75]
v_cvt_pk_bf16_f32 v213,v236,v213
v_add_u32 v238,139264,v247
M a[76:79],a[200:203],a[252:255],a[76:79]
v_fmac_f32 v239,s43,v241
v_fmac_f32 v244,4.0,v240
M a[76:79],a[192:195],a[236:239],a[76:79]
v_fma_f32 v232,-4.0,v241,v243
v_fmac_f32 v239,s45,v243
M a[76:79],a[248:251],a[204:207],a[76:79]
buffer_load_dwordx4 a[208:211],v250,s[20:23],s48 offen offset:2048 sc1
M a[80:83],a[248:251],a[236:239],a[80:83]
s_add_u32 s46,s75,27648
v_fmac_f32 v244,s41,v242
v_sub_f32 v243,v243,v241
M a[80:83],a[192:195],a[252:255],a[80:83]
v_fma_f32 v241,-4.0,v240,v242
v_sub_f32 v242,v242,v240
M a[80:83],a[200:203],a[196:199],a[80:83]
ds_write2st64_b64 v238,v[204:205],v[214:215] offset0:1 offset1:18
M a[84:87],a[200:203],a[216:219],a[84:87]
s_add_u32 s28,s70,1179648
buffer_load_dwordx4 a[232:235],v250,s[20:23],s46 offen offset:0 sc1
M a[84:87],a[192:195],a[196:199],a[84:87]
ds_read_b128 a[204:207],v248 offset:43520
v_add_f32 v240,v232,v241
M a[84:87],a[248:251],a[252:255],a[84:87]
ds_write2st64_b64 v247,v[206:207],v[208:209] offset0:35 offset1:52
M a[88:91],a[248:251],a[196:199],a[88:91]
buffer_load_dwordx2 v[204:205],v245,s[12:15],s28 offen offset:0
M a[88:91],a[192:195],a[216:219],a[88:91]
ds_read_b128 a[236:239],v249 offset:43520
ds_read_b128 a[252:255],v248 offset:44032
M a[88:91],a[200:203],a[228:231],a[88:91]
ds_write2st64_b64 v247,v[210:211],v[212:213] offset0:69 offset1:86
M a[92:95],a[200:203],v[224:227],a[92:95]
buffer_load_dwordx2 v[214:215],v245,s[16:19],s28 offen offset:1536
M a[92:95],a[192:195],a[228:231],a[92:95]
ds_read_b128 a[196:199],v249 offset:44032
v_sub_f32 v232,v232,v241
M a[92:95],a[248:251],a[216:219],a[92:95]
s_waitcnt vmcnt(17) lgkmcnt(5)
v_fma_f32 v241,2.0,v242,v243
v_fmac_f32 v243,-2.0,v242
M a[96:99],v[220:223],a[204:207],a[96:99]
s_waitcnt vmcnt(10) lgkmcnt(3)
ds_read_b128 a[200:203],v248 offset:44544
v_cvt_pk_bf16_f32 v233,v239,v244
M a[96:99],a[220:223],a[236:239],a[96:99]
s_waitcnt vmcnt(9) lgkmcnt(3)
buffer_load_dwordx2 v[206:207],v245,s[8:11],s28 offen offset:0
M a[96:99],a[224:227],a[252:255],a[96:99]
s_waitcnt lgkmcnt(1)
ds_read_b128 v[224:227],v249 offset:44544
v_cvt_pk_bf16_f32 v234,v240,v232
M a[100:103],a[224:227],a[196:199],a[100:103]
v_cvt_pk_bf16_f32 v235,v241,v243
v_add_u32 v232,139264,v252
M a[100:103],a[220:223],a[252:255],a[100:103]
ds_write_b16 v232,v233 offset:0
M a[100:103],v[220:223],a[236:239],a[100:103]
buffer_load_dwordx2 v[208:209],v245,s[8:11],s28 offen offset:384
M a[104:107],v[220:223],a[252:255],a[104:107]
ds_read_b128 a[192:195],v248 offset:45056
ds_write_b16_d16_hi v232,v233 offset:8704
M a[104:107],a[220:223],a[196:199],a[104:107]
s_waitcnt lgkmcnt(4)
ds_read_b128 a[228:231],v249 offset:45056
ds_write_b16 v252,v234 offset:17408
M a[104:107],a[224:227],a[200:203],a[104:107]
s_waitcnt lgkmcnt(5)
ds_write_b16_d16_hi v252,v234 offset:26112
M a[108:111],a[224:227],v[224:227],a[108:111]
buffer_load_dwordx2 v[210:211],v245,s[8:11],s28 offen offset:768
M a[108:111],a[220:223],a[200:203],a[108:111]
ds_write_b16 v252,v235 offset:34816
M a[108:111],v[220:223],a[196:199],a[108:111]
ds_write_b16_d16_hi v252,v235 offset:43520
M a[112:115],v[220:223],a[200:203],a[112:115]
ds_read_b128 a[216:219],v249 offset:45568
v_lshlrev_b32 v234,16,v196
M a[112:115],a[220:223],v[224:227],a[112:115]
s_waitcnt lgkmcnt(7)
buffer_load_dwordx2 v[212:213],v245,s[8:11],s28 offen offset:1152
M a[112:115],a[224:227],a[192:195],a[112:115]
s_waitcnt lgkmcnt(5)
s_add_u32 s29,s71,0
ds_read_b128 a[248:251],v248 offset:45568
v_lshlrev_b32 v232,16,v192
M a[116:119],a[224:227],a[228:231],a[116:119]
v_lshlrev_b32 v233,16,v194
v_lshlrev_b32 v237,16,v202
M a[116:119],a[220:223],a[192:195],a[116:119]
v_lshlrev_b32 v236,16,v200
v_lshlrev_b32 v235,16,v198
M a[116:119],v[220:223],v[224:227],a[116:119]
buffer_load_short_d16_hi v239,v246,s[12:15],s29 offen offset:0
M a[120:123],v[220:223],a[192:195],a[120:123]
v_fmac_f32 v232,s43,v234
v_fmac_f32 v237,4.0,v233
M a[120:123],a[220:223],a[228:231],a[120:123]
s_waitcnt lgkmcnt(1)
buffer_load_short_d16_hi v240,v246,s[8:11],s29 offen offset:0
M a[120:123],a[224:227],a[216:219],a[120:123]
s_waitcnt lgkmcnt(0)
v_fma_f32 v238,-4.0,v234,v236
v_fmac_f32 v232,s45,v236
M a[124:127],a[224:227],a[248:251],a[124:127]
buffer_load_dwordx4 a[224:227],v250,s[20:23],s46 offen offset:1024 sc1
M a[124:127],a[220:223],a[216:219],a[124:127]
v_fmac_f32 v237,s41,v235
v_sub_f32 v236,v236,v234
M a[124:127],v[220:223],a[228:231],a[124:127]
s_waitcnt vmcnt(15)
v_fma_f32 v234,-4.0,v233,v235
v_sub_f32 v235,v235,v233
M a[128:131],v[216:219],a[204:207],a[128:131]
s_waitcnt vmcnt(14)
v_add_f32 v233,v238,v234
v_sub_f32 v238,v238,v234
M a[128:131],a[240:243],a[236:239],a[128:131]
s_waitcnt vmcnt(13)
buffer_load_dwordx4 a[220:223],v250,s[20:23],s46 offen offset:2048 sc1
M a[128:131],a[244:247],a[252:255],a[128:131]
s_add_u32 s47,s75,30720
v_fma_f32 v234,2.0,v235,v236
v_fmac_f32 v236,-2.0,v235
M a[132:135],a[244:247],a[196:199],a[132:135]
v_and_b32 v196,s42,v196
v_and_b32 v192,s42,v192
M a[132:135],a[240:243],a[252:255],a[132:135]
v_and_b32 v194,s42,v194
v_and_b32 v202,s42,v202
M a[132:135],v[216:219],a[236:239],a[132:135]
buffer_load_dwordx4 v[220:223],v250,s[20:23],s47 offen offset:0 sc1
M a[136:139],v[216:219],a[252:255],a[136:139]
v_and_b32 v200,s42,v200
v_and_b32 v198,s42,v198
M a[136:139],a[240:243],a[196:199],a[136:139]
v_fmac_f32 v192,s43,v196
v_fmac_f32 v202,4.0,v194
M a[136:139],a[244:247],a[200:203],a[136:139]
v_fma_f32 v235,-4.0,v196,v200
v_fmac_f32 v192,s45,v200
M a[140:143],a[244:247],v[224:227],a[140:143]
buffer_load_short_d16_hi v241,v246,s[8:11],s29 offen offset:384
M a[140:143],a[240:243],a[200:203],a[140:143]
v_fmac_f32 v202,s41,v198
v_sub_f32 v200,v200,v196
M a[140:143],v[216:219],a[196:199],a[140:143]
buffer_load_short_d16_hi v242,v246,s[8:11],s29 offen offset:768
M a[144:147],v[216:219],a[200:203],a[144:147]
v_fma_f32 v196,-4.0,v194,v198
v_sub_f32 v198,v198,v194
M a[144:147],a[240:243],v[224:227],a[144:147]
buffer_load_short_d16_hi v243,v246,s[8:11],s29 offen offset:1152
M a[144:147],a[244:247],a[192:195],a[144:147]
v_add_f32 v194,v235,v196
v_sub_f32 v235,v235,v196
M a[148:151],a[244:247],a[228:231],a[148:151]
buffer_load_short_d16_hi v244,v246,s[16:19],s29 offen offset:1536
M a[148:151],a[240:243],a[192:195],a[148:151]
v_fma_f32 v196,2.0,v198,v200
v_fmac_f32 v200,-2.0,v198
M a[148:151],v[216:219],v[224:227],a[148:151]
v_cvt_pk_bf16_f32 v192,v232,v192
v_cvt_pk_bf16_f32 v202,v237,v202
M a[152:155],v[216:219],a[192:195],a[152:155]
v_cvt_pk_bf16_f32 v194,v233,v194
v_cvt_pk_bf16_f32 v198,v234,v196
M a[152:155],a[240:243],a[228:231],a[152:155]
v_cvt_pk_bf16_f32 v196,v238,v235
v_cvt_pk_bf16_f32 v200,v236,v200
M a[152:155],a[244:247],a[216:219],a[152:155]
v_lshlrev_b32 v234,16,v197
v_lshlrev_b32 v232,16,v193
M a[156:159],a[244:247],a[248:251],a[156:159]
buffer_load_dwordx4 a[244:247],v250,s[20:23],s47 offen offset:1024 sc1
M a[156:159],a[240:243],a[216:219],a[156:159]
v_lshlrev_b32 v233,16,v195
v_lshlrev_b32 v237,16,v203
M a[156:159],v[216:219],a[228:231],a[156:159]
s_waitcnt vmcnt(19)
buffer_load_dwordx4 a[240:243],v250,s[20:23],s47 offen offset:2048 sc1
M a[160:163],v[228:231],a[204:207],a[160:163]
s_waitcnt vmcnt(19)
s_add_u32 s48,s75,33792
v_lshlrev_b32 v236,16,v201
v_lshlrev_b32 v235,16,v199
M a[160:163],a[212:215],a[236:239],a[160:163]
s_waitcnt vmcnt(18)
v_fmac_f32 v232,s43,v234
v_fmac_f32 v237,4.0,v233
M a[160:163],a[208:211],a[252:255],a[160:163]
v_fma_f32 v238,-4.0,v234,v236
v_fmac_f32 v232,s45,v236
M a[164:167],a[208:211],a[196:199],a[164:167]
buffer_load_dwordx4 v[216:219],v250,s[20:23],s48 offen offset:0 sc1
M a[164:167],a[212:215],a[252:255],a[164:167]
v_fmac_f32 v237,s41,v235
v_sub_f32 v236,v236,v234
M a[164:167],v[228:231],a[236:239],a[164:167]
v_fma_f32 v234,-4.0,v233,v235
v_sub_f32 v235,v235,v233
M a[168:171],v[228:231],a[252:255],a[168:171]
v_add_f32 v233,v238,v234
v_sub_f32 v238,v238,v234
M a[168:171],a[212:215],a[196:199],a[168:171]
buffer_load_dwordx4 a[204:207],v250,s[20:23],s48 offen offset:1024 sc1
M a[168:171],a[208:211],a[200:203],a[168:171]
v_fma_f32 v234,2.0,v235,v236
v_fmac_f32 v236,-2.0,v235
M a[172:175],a[208:211],v[224:227],a[172:175]
v_and_b32 v197,s42,v197
v_and_b32 v193,s42,v193
M a[172:175],a[212:215],a[200:203],a[172:175]
v_and_b32 v195,s42,v195
v_and_b32 v203,s42,v203
M a[172:175],v[228:231],a[196:199],a[172:175]
buffer_load_dwordx4 a[236:239],v250,s[20:23],s48 offen offset:2048 sc1
M a[176:179],v[228:231],a[200:203],a[176:179]
s_add_u32 s46,s75,36864
v_and_b32 v201,s42,v201
v_and_b32 v199,s42,v199
M a[176:179],a[212:215],v[224:227],a[176:179]
v_fmac_f32 v193,s43,v197
v_fmac_f32 v203,4.0,v195
M a[176:179],a[208:211],a[192:195],a[176:179]
v_fma_f32 v235,-4.0,v197,v201
v_fmac_f32 v193,s45,v201
M a[180:183],a[208:211],a[228:231],a[180:183]
buffer_load_dwordx4 a[252:255],v250,s[20:23],s46 offen offset:0 sc1
M a[180:183],a[212:215],a[192:195],a[180:183]
ds_read_b128 a[196:199],v248 offset:52224
v_fmac_f32 v203,s41,v199
M a[180:183],v[228:231],v[224:227],a[180:183]
ds_read_b128 a[200:203],v249 offset:52224
v_sub_f32 v201,v201,v197
M a[184:187],v[228:231],a[192:195],a[184:187]
ds_read_b128 v[224:227],v248 offset:52736
v_fma_f32 v197,-4.0,v195,v199
M a[184:187],a[212:215],a[228:231],a[184:187]
ds_read_b128 a[192:195],v249 offset:52736
v_sub_f32 v199,v199,v195
M a[184:187],a[208:211],a[216:219],a[184:187]
v_add_f32 v195,v235,v197
v_sub_f32 v235,v235,v197
M a[188:191],a[208:211],a[248:251],a[188:191]
v_fma_f32 v197,2.0,v199,v201
v_fmac_f32 v201,-2.0,v199
M a[188:191],a[212:215],a[216:219],a[188:191]
v_cvt_pk_bf16_f32 v193,v232,v193
v_cvt_pk_bf16_f32 v203,v237,v203
M a[188:191],v[228:231],a[228:231],a[188:191]
s_waitcnt vmcnt(21) lgkmcnt(3)
v_cvt_pk_bf16_f32 v195,v233,v195
v_cvt_pk_bf16_f32 v199,v234,v197
M v[0:3],a[232:235],a[196:199],v[0:3]
s_waitcnt vmcnt(12) lgkmcnt(2)
ds_read_b128 a[208:211],v248 offset:53248
v_cvt_pk_bf16_f32 v197,v238,v235
M v[0:3],a[224:227],a[200:203],v[0:3]
s_waitcnt vmcnt(11) lgkmcnt(2)
ds_read_b128 a[248:251],v249 offset:53248
v_cvt_pk_bf16_f32 v201,v236,v201
M v[0:3],a[220:223],v[224:227],v[0:3]
s_waitcnt lgkmcnt(2)
v_add_u32 v238,139264,v247
v_lshlrev_b32 v234,16,v208
M v[4:7],a[220:223],a[192:195],v[4:7]
v_lshlrev_b32 v232,16,v204
v_lshlrev_b32 v233,16,v206
M v[4:7],a[224:227],v[224:227],v[4:7]
v_lshlrev_b32 v237,16,v214
v_lshlrev_b32 v236,16,v212
M v[4:7],a[232:235],a[200:203],v[4:7]
ds_write2st64_b64 v238,v[192:193],v[202:203] offset0:2 offset1:19
M v[8:11],a[232:235],v[224:227],v[8:11]
s_add_u32 s28,s71,0
buffer_load_dwordx2 v[192:193],v251,s[12:15],s28 offen offset:0
M v[8:11],a[224:227],a[192:195],v[8:11]
s_waitcnt lgkmcnt(2)
ds_read_b128 a[212:215],v248 offset:53760
ds_read_b128 a[216:219],v249 offset:53760
M v[8:11],a[220:223],a[208:211],v[8:11]
s_waitcnt lgkmcnt(3)
buffer_load_dwordx2 v[202:203],v251,s[16:19],s28 offen offset:1536
M v[12:15],a[220:223],a[248:251],v[12:15]
v_lshlrev_b32 v235,16,v210
v_fmac_f32 v232,s43,v234
M v[12:15],a[224:227],a[208:211],v[12:15]
v_fmac_f32 v237,4.0,v233
v_fma_f32 v238,-4.0,v234,v236
M v[12:15],a[232:235],a[192:195],v[12:15]
ds_write2st64_b64 v247,v[194:195],v[196:197] offset0:36 offset1:53
M v[16:19],a[232:235],a[208:211],v[16:19]
buffer_load_dwordx2 v[194:195],v251,s[8:11],s28 offen offset:0
M v[16:19],a[224:227],a[248:251],v[16:19]
s_waitcnt lgkmcnt(2)
ds_read_b128 a[228:231],v249 offset:54272
ds_read_b128 v[228:231],v248 offset:54272
M v[16:19],a[220:223],a[212:215],v[16:19]
s_waitcnt lgkmcnt(3)
ds_write2st64_b64 v247,v[198:199],v[200:201] offset0:70 offset1:87
M v[20:23],a[220:223],a[216:219],v[20:23]
buffer_load_dwordx2 v[196:197],v251,s[8:11],s28 offen offset:384
M v[20:23],a[224:227],a[212:215],v[20:23]
v_fmac_f32 v232,s45,v236
v_fmac_f32 v237,s41,v235
M v[20:23],a[232:235],a[248:251],v[20:23]
v_sub_f32 v236,v236,v234
v_fma_f32 v234,-4.0,v233,v235
M v[24:27],a[232:235],a[212:215],v[24:27]
v_sub_f32 v235,v235,v233
v_add_f32 v233,v238,v234
M v[24:27],a[224:227],a[216:219],v[24:27]
s_waitcnt lgkmcnt(2)
buffer_load_dwordx2 v[198:199],v251,s[8:11],s28 offen offset:768
M v[24:27],a[220:223],a[228:231],v[24:27]
s_waitcnt lgkmcnt(1)
v_sub_f32 v238,v238,v234
v_fma_f32 v234,2.0,v235,v236
M v[28:31],a[220:223],v[228:231],v[28:31]
v_fmac_f32 v236,-2.0,v235
v_and_b32 v208,s42,v208
M v[28:31],a[224:227],a[228:231],v[28:31]
v_and_b32 v204,s42,v204
v_and_b32 v206,s42,v206
M v[28:31],a[232:235],a[216:219],v[28:31]
s_waitcnt vmcnt(15)
buffer_load_dwordx2 v[200:201],v251,s[8:11],s28 offen offset:1152
M v[32:35],v[220:223],a[196:199],v[32:35]
s_waitcnt vmcnt(11)
v_and_b32 v214,s42,v214
v_and_b32 v212,s42,v212
M v[32:35],a[244:247],a[200:203],v[32:35]
s_waitcnt vmcnt(10)
v_and_b32 v210,s42,v210
v_fmac_f32 v204,s43,v208
M v[32:35],a[240:243],v[224:227],v[32:35]
v_fmac_f32 v214,4.0,v206
v_fma_f32 v235,-4.0,v208,v212
M v[36:39],a[240:243],a[192:195],v[36:39]
global_load_dword a220,v250,s[64:65]
M v[36:39],a[244:247],v[224:227],v[36:39]
v_fmac_f32 v204,s45,v212
v_fmac_f32 v214,s41,v210
M v[36:39],v[220:223],a[200:203],v[36:39]
buffer_load_dwordx4 a[220:223],v250,s[20:23],s46 offen offset:1024 sc1
M v[40:43],v[220:223],v[224:227],v[40:43]
v_sub_f32 v212,v212,v208
v_fma_f32 v208,-4.0,v206,v210
M v[40:43],a[244:247],a[192:195],v[40:43]
v_sub_f32 v210,v210,v206
v_add_f32 v206,v235,v208
M v[40:43],a[240:243],a[208:211],v[40:43]
v_sub_f32 v235,v235,v208
v_fma_f32 v208,2.0,v210,v212
M v[44:47],a[240:243],a[248:251],v[44:47]
buffer_load_dwordx4 a[224:227],v250,s[20:23],s46 offen offset:2048 sc1
M v[44:47],a[244:247],a[208:211],v[44:47]
s_add_u32 s47,s75,39936
v_fmac_f32 v212,-2.0,v210
v_cvt_pk_bf16_f32 v204,v232,v204
M v[44:47],v[220:223],a[192:195],v[44:47]
v_cvt_pk_bf16_f32 v214,v237,v214
v_cvt_pk_bf16_f32 v206,v233,v206
M v[48:51],v[220:223],a[208:211],v[48:51]
v_cvt_pk_bf16_f32 v210,v234,v208
v_cvt_pk_bf16_f32 v208,v238,v235
M v[48:51],a[244:247],a[248:251],v[48:51]
buffer_load_dwordx4 a[232:235],v250,s[20:23],s47 offen offset:0 sc1
M v[48:51],a[240:243],a[212:215],v[48:51]
v_cvt_pk_bf16_f32 v212,v236,v212
v_lshlrev_b32 v234,16,v209
M v[52:55],a[240:243],a[216:219],v[52:55]
v_lshlrev_b32 v232,16,v205
v_lshlrev_b32 v233,16,v207
M v[52:55],a[244:247],a[212:215],v[52:55]
v_lshlrev_b32 v237,16,v215
v_lshlrev_b32 v236,16,v213
M v[52:55],v[220:223],a[248:251],v[52:55]
v_lshlrev_b32 v235,16,v211
v_fmac_f32 v232,s43,v234
M v[56:59],v[220:223],a[212:215],v[56:59]
v_fmac_f32 v237,4.0,v233
v_fma_f32 v238,-4.0,v234,v236
M v[56:59],a[244:247],a[216:219],v[56:59]
v_fmac_f32 v232,s45,v236
v_fmac_f32 v237,s41,v235
M v[56:59],a[240:243],a[228:231],v[56:59]
v_sub_f32 v236,v236,v234
v_fma_f32 v234,-4.0,v233,v235
M v[60:63],a[240:243],v[228:231],v[60:63]
buffer_load_dwordx4 a[240:243],v250,s[20:23],s47 offen offset:1024 sc1
M v[60:63],a[244:247],a[228:231],v[60:63]
v_sub_f32 v235,v235,v233
v_add_f32 v233,v238,v234
M v[60:63],v[220:223],a[216:219],v[60:63]
s_waitcnt vmcnt(14)
buffer_load_dwordx4 a[244:247],v250,s[20:23],s47 offen offset:2048 sc1
M v[64:67],v[216:219],a[196:199],v[64:67]
s_waitcnt vmcnt(14)
s_add_u32 s48,s75,43008
v_sub_f32 v238,v238,v234
v_fma_f32 v234,2.0,v235,v236
M v[64:67],a[204:207],a[200:203],v[64:67]
s_waitcnt vmcnt(13)
v_fmac_f32 v236,-2.0,v235
v_and_b32 v209,s42,v209
M v[64:67],a[236:239],v[224:227],v[64:67]
v_and_b32 v205,s42,v205
v_and_b32 v207,s42,v207
M v[68:71],a[236:239],a[192:195],v[68:71]
buffer_load_dwordx4 v[220:223],v250,s[20:23],s48 offen offset:0 sc1
M v[68:71],a[204:207],v[224:227],v[68:71]
v_and_b32 v215,s42,v215
v_and_b32 v213,s42,v213
M v[68:71],v[216:219],a[200:203],v[68:71]
v_and_b32 v211,s42,v211
v_fmac_f32 v205,s43,v209
M v[72:75],v[216:219],v[224:227],v[72:75]
v_fmac_f32 v215,4.0,v207
v_fma_f32 v235,-4.0,v209,v213
M v[72:75],a[204:207],a[192:195],v[72:75]
buffer_load_dwordx4 a[196:199],v250,s[20:23],s48 offen offset:1024 sc1
M v[72:75],a[236:239],a[208:211],v[72:75]
v_fmac_f32 v205,s45,v213
v_fmac_f32 v215,s41,v211
M v[76:79],a[236:239],a[248:251],v[76:79]
v_sub_f32 v213,v213,v209
v_fma_f32 v209,-4.0,v207,v211
M v[76:79],a[204:207],a[208:211],v[76:79]
v_sub_f32 v211,v211,v207
v_add_f32 v207,v235,v209
M v[76:79],v[216:219],a[192:195],v[76:79]
buffer_load_dwordx4 a[200:203],v250,s[20:23],s48 offen offset:2048 sc1
M v[80:83],v[216:219],a[208:211],v[80:83]
s_add_u32 s46,s76,9216
v_sub_f32 v235,v235,v209
v_fma_f32 v209,2.0,v211,v213
M v[80:83],a[204:207],a[248:251],v[80:83]
v_fmac_f32 v213,-2.0,v211
v_cvt_pk_bf16_f32 v205,v232,v205
M v[80:83],a[236:239],a[212:215],v[80:83]
v_cvt_pk_bf16_f32 v215,v237,v215
v_cvt_pk_bf16_f32 v207,v233,v207
M v[84:87],a[236:239],a[216:219],v[84:87]
buffer_load_dwordx4 v[224:227],v250,s[20:23],s46 offen offset:0 sc1
M v[84:87],a[204:207],a[212:215],v[84:87]
ds_read_b128 a[192:195],v248 offset:60928
v_cvt_pk_bf16_f32 v211,v234,v209
M v[84:87],v[216:219],a[248:251],v[84:87]
ds_read_b128 a[208:211],v249 offset:60928
v_cvt_pk_bf16_f32 v209,v238,v235
M v[88:91],v[216:219],a[212:215],v[88:91]
ds_read_b128 a[248:251],v248 offset:61440
v_cvt_pk_bf16_f32 v213,v236,v213
M v[88:91],a[204:207],a[216:219],v[88:91]
ds_read_b128 a[212:215],v249 offset:61440
v_add_u32 v238,139264,v247
M v[88:91],a[236:239],a[228:231],v[88:91]
ds_write2st64_b64 v238,v[204:205],v[214:215] offset0:3 offset1:20
M v[92:95],a[236:239],v[228:231],v[92:95]
s_add_u32 s28,s71,393216
buffer_load_dwordx2 v[204:205],v245,s[12:15],s28 offen offset:0
M v[92:95],a[204:207],a[228:231],v[92:95]
s_waitcnt vmcnt(13)
v_lshlrev_b32 v234,16,v196
v_lshlrev_b32 v232,16,v192
M v[92:95],v[216:219],a[216:219],v[92:95]
s_waitcnt lgkmcnt(4)
buffer_load_dwordx2 v[214:215],v245,s[16:19],s28 offen offset:1536
M v[96:99],a[252:255],a[192:195],v[96:99]
s_waitcnt vmcnt(10) lgkmcnt(3)
ds_read_b128 a[236:239],v248 offset:61952
v_lshlrev_b32 v233,16,v194
M v[96:99],a[220:223],a[208:211],v[96:99]
s_waitcnt vmcnt(9) lgkmcnt(3)
ds_read_b128 v[228:231],v249 offset:61952
v_lshlrev_b32 v237,16,v202
M v[96:99],a[224:227],a[248:251],v[96:99]
s_waitcnt lgkmcnt(3)
ds_write2st64_b64 v247,v[206:207],v[208:209] offset0:37 offset1:54
M v[100:103],a[224:227],a[212:215],v[100:103]
buffer_load_dwordx2 v[206:207],v245,s[8:11],s28 offen offset:0
M v[100:103],a[220:223],a[248:251],v[100:103]
v_lshlrev_b32 v236,16,v200
v_lshlrev_b32 v235,16,v198
M v[100:103],a[252:255],a[208:211],v[100:103]
ds_write2st64_b64 v247,v[210:211],v[212:213] offset0:71 offset1:88
M v[104:107],a[252:255],a[248:251],v[104:107]
buffer_load_dwordx2 v[208:209],v245,s[8:11],s28 offen offset:384
M v[104:107],a[220:223],a[212:215],v[104:107]
s_waitcnt lgkmcnt(3)
ds_read_b128 a[204:207],v248 offset:62464
ds_read_b128 a[228:231],v249 offset:62464
M v[104:107],a[224:227],a[236:239],v[104:107]
s_waitcnt lgkmcnt(4)
v_fmac_f32 v232,s43,v234
v_fmac_f32 v237,4.0,v233
M v[108:111],a[224:227],v[228:231],v[108:111]
v_fma_f32 v238,-4.0,v234,v236
v_fmac_f32 v232,s45,v236
M v[108:111],a[220:223],a[236:239],v[108:111]
buffer_load_dwordx2 v[210:211],v245,s[8:11],s28 offen offset:768
M v[108:111],a[252:255],a[212:215],v[108:111]
v_fmac_f32 v237,s41,v235
v_sub_f32 v236,v236,v234
M v[112:115],a[252:255],a[236:239],v[112:115]
ds_read_b128 a[216:219],v249 offset:62976
v_fma_f32 v234,-4.0,v233,v235
M v[112:115],a[220:223],v[228:231],v[112:115]
s_waitcnt lgkmcnt(2)
ds_read_b128 v[216:219],v248 offset:62976
v_sub_f32 v235,v235,v233
M v[112:115],a[224:227],a[204:207],v[112:115]
s_waitcnt lgkmcnt(2)
buffer_load_dwordx2 v[212:213],v245,s[8:11],s28 offen offset:1152
M v[116:119],a[224:227],a[228:231],v[116:119]
v_add_f32 v233,v238,v234
v_sub_f32 v238,v238,v234
M v[116:119],a[220:223],a[204:207],v[116:119]
v_fma_f32 v234,2.0,v235,v236
v_fmac_f32 v236,-2.0,v235
M v[116:119],a[252:255],v[228:231],v[116:119]
v_and_b32 v196,s42,v196
v_and_b32 v192,s42,v192
M v[120:123],a[252:255],a[204:207],v[120:123]
v_and_b32 v194,s42,v194
v_and_b32 v202,s42,v202
M v[120:123],a[220:223],a[228:231],v[120:123]
s_waitcnt lgkmcnt(1)
v_and_b32 v200,s42,v200
v_and_b32 v198,s42,v198
M v[120:123],a[224:227],a[216:219],v[120:123]
s_waitcnt lgkmcnt(0)
v_fmac_f32 v192,s43,v196
v_fmac_f32 v202,4.0,v194
M v[124:127],a[224:227],v[216:219],v[124:127]
buffer_load_dwordx4 a[224:227],v250,s[20:23],s46 offen offset:1024 sc1
M v[124:127],a[220:223],a[216:219],v[124:127]
v_fma_f32 v235,-4.0,v196,v200
v_fmac_f32 v192,s45,v200
M v[124:127],a[252:255],a[228:231],v[124:127]
s_waitcnt vmcnt(13)
buffer_load_dwordx4 a[220:223],v250,s[20:23],s46 offen offset:2048 sc1
M v[128:131],a[232:235],a[192:195],v[128:131]
s_waitcnt vmcnt(13)
s_add_u32 s47,s76,12288
v_fmac_f32 v202,s41,v198
v_sub_f32 v200,v200,v196
M v[128:131],a[240:243],a[208:211],v[128:131]
s_waitcnt vmcnt(12)
v_fma_f32 v196,-4.0,v194,v198
v_sub_f32 v198,v198,v194
M v[128:131],a[244:247],a[248:251],v[128:131]
v_add_f32 v194,v235,v196
v_sub_f32 v235,v235,v196
M v[132:135],a[244:247],a[212:215],v[132:135]
buffer_load_dwordx4 a[252:255],v250,s[20:23],s47 offen offset:0 sc1
M v[132:135],a[240:243],a[248:251],v[132:135]
v_fma_f32 v196,2.0,v198,v200
v_fmac_f32 v200,-2.0,v198
M v[132:135],a[232:235],a[208:211],v[132:135]
v_cvt_pk_bf16_f32 v192,v232,v192
v_cvt_pk_bf16_f32 v202,v237,v202
M v[136:139],a[232:235],a[248:251],v[136:139]
v_cvt_pk_bf16_f32 v194,v233,v194
v_cvt_pk_bf16_f32 v198,v234,v196
M v[136:139],a[240:243],a[212:215],v[136:139]
v_cvt_pk_bf16_f32 v196,v238,v235
v_cvt_pk_bf16_f32 v200,v236,v200
M v[136:139],a[244:247],a[236:239],v[136:139]
v_lshlrev_b32 v234,16,v197
v_lshlrev_b32 v232,16,v193
M v[140:143],a[244:247],v[228:231],v[140:143]
v_lshlrev_b32 v233,16,v195
v_lshlrev_b32 v237,16,v203
M v[140:143],a[240:243],a[236:239],v[140:143]
v_lshlrev_b32 v236,16,v201
v_lshlrev_b32 v235,16,v199
M v[140:143],a[232:235],a[212:215],v[140:143]
v_fmac_f32 v232,s43,v234
v_fmac_f32 v237,4.0,v233
M v[144:147],a[232:235],a[236:239],v[144:147]
v_fma_f32 v238,-4.0,v234,v236
v_fmac_f32 v232,s45,v236
M v[144:147],a[240:243],v[228:231],v[144:147]
v_fmac_f32 v237,s41,v235
v_sub_f32 v236,v236,v234
M v[144:147],a[244:247],a[204:207],v[144:147]
v_fma_f32 v234,-4.0,v233,v235
v_sub_f32 v235,v235,v233
M v[148:151],a[244:247],a[228:231],v[148:151]
v_add_f32 v233,v238,v234
v_sub_f32 v238,v238,v234
M v[148:151],a[240:243],a[204:207],v[148:151]
v_fma_f32 v234,2.0,v235,v236
v_fmac_f32 v236,-2.0,v235
M v[148:151],a[232:235],v[228:231],v[148:151]
v_and_b32 v197,s42,v197
v_and_b32 v193,s42,v193
M v[152:155],a[232:235],a[204:207],v[152:155]
v_and_b32 v195,s42,v195
v_and_b32 v203,s42,v203
M v[152:155],a[240:243],a[228:231],v[152:155]
v_and_b32 v201,s42,v201
v_and_b32 v199,s42,v199
M v[152:155],a[244:247],a[216:219],v[152:155]
v_fmac_f32 v193,s43,v197
v_fmac_f32 v203,4.0,v195
M v[156:159],a[244:247],v[216:219],v[156:159]
buffer_load_dwordx4 a[244:247],v250,s[20:23],s47 offen offset:1024 sc1
M v[156:159],a[240:243],a[216:219],v[156:159]
v_fma_f32 v235,-4.0,v197,v201
v_fmac_f32 v193,s45,v201
M v[156:159],a[232:235],a[228:231],v[156:159]
s_waitcnt vmcnt(13)
buffer_load_dwordx4 a[240:243],v250,s[20:23],s47 offen offset:2048 sc1
M v[160:163],v[220:223],a[192:195],v[160:163]
s_waitcnt vmcnt(13)
s_add_u32 s48,s76,15360
v_fmac_f32 v203,s41,v199
v_sub_f32 v201,v201,v197
M v[160:163],a[196:199],a[208:211],v[160:163]
s_waitcnt vmcnt(12)
v_fma_f32 v197,-4.0,v195,v199
v_sub_f32 v199,v199,v195
M v[160:163],a[200:203],a[248:251],v[160:163]
v_add_f32 v195,v235,v197
v_sub_f32 v235,v235,v197
M v[164:167],a[200:203],a[212:215],v[164:167]
buffer_load_dwordx4 a[232:235],v250,s[20:23],s48 offen offset:0 sc1
M v[164:167],a[196:199],a[248:251],v[164:167]
v_fma_f32 v197,2.0,v199,v201
v_fmac_f32 v201,-2.0,v199
M v[164:167],v[220:223],a[208:211],v[164:167]
v_cvt_pk_bf16_f32 v193,v232,v193
v_cvt_pk_bf16_f32 v203,v237,v203
M v[168:171],v[220:223],a[248:251],v[168:171]
v_cvt_pk_bf16_f32 v195,v233,v195
v_cvt_pk_bf16_f32 v199,v234,v197
M v[168:171],a[196:199],a[212:215],v[168:171]
buffer_load_dwordx4 a[192:195],v250,s[20:23],s48 offen offset:1024 sc1
M v[168:171],a[200:203],a[236:239],v[168:171]
v_cvt_pk_bf16_f32 v197,v238,v235
v_cvt_pk_bf16_f32 v201,v236,v201
M v[172:175],a[200:203],v[228:231],v[172:175]
s_waitcnt vmcnt(9)
v_lshlrev_b32 v234,16,v208
v_lshlrev_b32 v232,16,v204
M v[172:175],a[196:199],a[236:239],v[172:175]
v_lshlrev_b32 v233,16,v206
v_lshlrev_b32 v237,16,v214
M v[172:175],v[220:223],a[212:215],v[172:175]
buffer_load_dwordx4 a[208:211],v250,s[20:23],s48 offen offset:2048 sc1
M v[176:179],v[220:223],a[236:239],v[176:179]
s_waitcnt vmcnt(8)
s_add_u32 s46,s76,18432
v_lshlrev_b32 v236,16,v212
v_lshlrev_b32 v235,16,v210
M v[176:179],a[196:199],v[228:231],v[176:179]
v_fmac_f32 v232,s43,v234
v_fmac_f32 v237,4.0,v233
M v[176:179],a[200:203],a[204:207],v[176:179]
s_barrier
v_fma_f32 v238,-4.0,v234,v236
M v[180:183],a[200:203],a[228:231],v[180:183]
buffer_load_dwordx4 a[248:251],v250,s[20:23],s46 offen offset:0 sc1
M v[180:183],a[196:199],a[204:207],v[180:183]
ds_read_b128 a[212:215],v248 offset:0
v_fmac_f32 v232,s45,v236
M v[180:183],v[220:223],v[228:231],v[180:183]
ds_write2st64_b64 v247,v[192:193],v[202:203] offset0:136 offset1:153
M v[184:187],v[220:223],a[204:207],v[184:187]
s_add_u32 s28,s71,786432
ds_read_b128 a[236:239],v249 offset:0
ds_read_b128 v[228:231],v248 offset:512
M v[184:187],a[196:199],a[228:231],v[184:187]
buffer_load_dwordx2 v[192:193],v245,s[12:15],s28 offen offset:0
M v[184:187],a[200:203],a[216:219],v[184:187]
ds_write2st64_b64 v247,v[194:195],v[196:197] offset0:102 offset1:119
M v[188:191],a[200:203],v[216:219],v[188:191]
ds_read_b128 a[204:207],v249 offset:512
v_fmac_f32 v237,s41,v235
M v[188:191],a[196:199],a[216:219],v[188:191]
buffer_load_dwordx2 v[202:203],v245,s[16:19],s28 offen offset:1536
M v[188:191],v[220:223],a[228:231],v[188:191]
s_waitcnt lgkmcnt(5)
v_sub_f32 v236,v236,v234
v_fma_f32 v234,-4.0,v233,v235
M a[0:3],v[224:227],a[212:215],a[0:3]
s_waitcnt vmcnt(10) lgkmcnt(3)
ds_read_b128 a[200:203],v248 offset:1024
v_sub_f32 v235,v235,v233
M a[0:3],a[224:227],a[236:239],a[0:3]
s_waitcnt vmcnt(9) lgkmcnt(3)
ds_read_b128 v[216:219],v249 offset:1024
v_add_f32 v233,v238,v234
M a[0:3],a[220:223],v[228:231],a[0:3]
s_waitcnt lgkmcnt(2)
buffer_load_dwordx2 v[194:195],v245,s[8:11],s28 offen offset:0
M a[4:7],a[220:223],a[204:207],a[4:7]
v_sub_f32 v238,v238,v234
v_fma_f32 v234,2.0,v235,v236
M a[4:7],a[224:227],v[228:231],a[4:7]
v_fmac_f32 v236,-2.0,v235
v_and_b32 v208,s42,v208
M a[4:7],v[224:227],a[236:239],a[4:7]
v_and_b32 v204,s42,v204
v_and_b32 v206,s42,v206
M a[8:11],v[224:227],v[228:231],a[8:11]
buffer_load_dwordx2 v[196:197],v245,s[8:11],s28 offen offset:384
M a[8:11],a[224:227],a[204:207],a[8:11]
s_waitcnt lgkmcnt(1)
ds_read_b128 a[196:199],v248 offset:1536
ds_read_b128 a[216:219],v249 offset:1536
M a[8:11],a[220:223],a[200:203],a[8:11]
s_waitcnt lgkmcnt(2)
v_and_b32 v214,s42,v214
v_and_b32 v212,s42,v212
M a[12:15],a[220:223],v[216:219],a[12:15]
v_and_b32 v210,s42,v210
v_fmac_f32 v204,s43,v208
M a[12:15],a[224:227],a[200:203],a[12:15]
v_fmac_f32 v214,4.0,v206
v_fma_f32 v235,-4.0,v208,v212
M a[12:15],v[224:227],a[204:207],a[12:15]
v_fmac_f32 v204,s45,v212
v_fmac_f32 v214,s41,v210
M a[16:19],v[224:227],a[200:203],a[16:19]
ds_read_b128 a[228:231],v249 offset:2048
v_sub_f32 v212,v212,v208
M a[16:19],a[224:227],v[216:219],a[16:19]
s_waitcnt lgkmcnt(2)
ds_read_b128 v[220:223],v248 offset:2048
v_fma_f32 v208,-4.0,v206,v210
M a[16:19],a[220:223],a[196:199],a[16:19]
s_waitcnt lgkmcnt(2)
v_sub_f32 v210,v210,v206
v_add_f32 v206,v235,v208
M a[20:23],a[220:223],a[216:219],a[20:23]
v_sub_f32 v235,v235,v208
v_fma_f32 v208,2.0,v210,v212
M a[20:23],a[224:227],a[196:199],a[20:23]
v_fmac_f32 v212,-2.0,v210
v_cvt_pk_bf16_f32 v204,v232,v204
M a[20:23],v[224:227],v[216:219],a[20:23]
v_cvt_pk_bf16_f32 v214,v237,v214
v_cvt_pk_bf16_f32 v206,v233,v206
M a[24:27],v[224:227],a[196:199],a[24:27]
v_cvt_pk_bf16_f32 v210,v234,v208
v_cvt_pk_bf16_f32 v208,v238,v235
M a[24:27],a[224:227],a[216:219],a[24:27]
s_waitcnt lgkmcnt(1)
v_cvt_pk_bf16_f32 v212,v236,v212
v_lshlrev_b32 v234,16,v209
M a[24:27],a[220:223],a[228:231],a[24:27]
s_waitcnt lgkmcnt(0)
v_lshlrev_b32 v232,16,v205
v_lshlrev_b32 v233,16,v207
M a[28:31],a[220:223],v[220:223],a[28:31]
buffer_load_dwordx4 a[220:223],v250,s[20:23],s46 offen offset:1024 sc1
M a[28:31],a[224:227],a[228:231],a[28:31]
v_lshlrev_b32 v237,16,v215
v_lshlrev_b32 v236,16,v213
M a[28:31],v[224:227],a[216:219],a[28:31]
s_waitcnt vmcnt(11)
buffer_load_dwordx4 a[224:227],v250,s[20:23],s46 offen offset:2048 sc1
M a[32:35],a[252:255],a[212:215],a[32:35]
s_waitcnt vmcnt(11)
s_add_u32 s47,s76,21504
v_lshlrev_b32 v235,16,v211
v_fmac_f32 v232,s43,v234
M a[32:35],a[244:247],a[236:239],a[32:35]
s_waitcnt vmcnt(10)
v_fmac_f32 v237,4.0,v233
v_fma_f32 v238,-4.0,v234,v236
M a[32:35],a[240:243],v[228:231],a[32:35]
v_fmac_f32 v232,s45,v236
v_fmac_f32 v237,s41,v235
M a[36:39],a[240:243],a[204:207],a[36:39]
buffer_load_dwordx4 v[224:227],v250,s[20:23],s47 offen offset:0 sc1
M a[36:39],a[244:247],v[228:231],a[36:39]
v_sub_f32 v236,v236,v234
v_fma_f32 v234,-4.0,v233,v235
M a[36:39],a[252:255],a[236:239],a[36:39]
v_sub_f32 v235,v235,v233
v_add_f32 v233,v238,v234
M a[40:43],a[252:255],v[228:231],a[40:43]
v_sub_f32 v238,v238,v234
v_fma_f32 v234,2.0,v235,v236
M a[40:43],a[244:247],a[204:207],a[40:43]
v_fmac_f32 v236,-2.0,v235
v_and_b32 v209,s42,v209
M a[40:43],a[240:243],a[200:203],a[40:43]
v_and_b32 v205,s42,v205
v_and_b32 v207,s42,v207
M a[44:47],a[240:243],v[216:219],a[44:47]
v_and_b32 v215,s42,v215
v_and_b32 v213,s42,v213
M a[44:47],a[244:247],a[200:203],a[44:47]
v_and_b32 v211,s42,v211
v_fmac_f32 v205,s43,v209
M a[44:47],a[252:255],a[204:207],a[44:47]
v_fmac_f32 v215,4.0,v207
v_fma_f32 v235,-4.0,v209,v213
M a[48:51],a[252:255],a[200:203],a[48:51]
v_fmac_f32 v205,s45,v213
v_fmac_f32 v215,s41,v211
M a[48:51],a[244:247],v[216:219],a[48:51]
v_sub_f32 v213,v213,v209
v_fma_f32 v209,-4.0,v207,v211
M a[48:51],a[240:243],a[196:199],a[48:51]
v_sub_f32 v211,v211,v207
v_add_f32 v207,v235,v209
M a[52:55],a[240:243],a[216:219],a[52:55]
v_sub_f32 v235,v235,v209
v_fma_f32 v209,2.0,v211,v213
M a[52:55],a[244:247],a[196:199],a[52:55]
v_fmac_f32 v213,-2.0,v211
v_cvt_pk_bf16_f32 v205,v232,v205
M a[52:55],a[252:255],v[216:219],a[52:55]
v_cvt_pk_bf16_f32 v215,v237,v215
v_cvt_pk_bf16_f32 v207,v233,v207
M a[56:59],a[252:255],a[196:199],a[56:59]
v_cvt_pk_bf16_f32 v211,v234,v209
v_cvt_pk_bf16_f32 v209,v238,v235
M a[56:59],a[244:247],a[216:219],a[56:59]
v_cvt_pk_bf16_f32 v213,v236,v213
v_fmac_f32 v239,s43,v241
M a[56:59],a[240:243],a[228:231],a[56:59]
v_fmac_f32 v244,4.0,v240
v_fma_f32 v232,-4.0,v241,v243
M a[60:63],a[240:243],v[220:223],a[60:63]
buffer_load_dwordx4 a[240:243],v250,s[20:23],s47 offen offset:1024 sc1
M a[60:63],a[244:247],a[228:231],a[60:63]
v_fmac_f32 v239,s45,v243
v_fmac_f32 v244,s41,v242
M a[60:63],a[252:255],a[216:219],a[60:63]
s_waitcnt vmcnt(11)
buffer_load_dwordx4 a[244:247],v250,s[20:23],s47 offen offset:2048 sc1
M a[64:67],a[232:235],a[212:215],a[64:67]
s_waitcnt vmcnt(11)
s_add_u32 s48,s76,24576
v_sub_f32 v243,v243,v241
v_fma_f32 v241,-4.0,v240,v242
M a[64:67],a[192:195],a[236:239],a[64:67]
s_waitcnt vmcnt(10)
v_sub_f32 v242,v242,v240
v_add_f32 v240,v232,v241
M a[64:67],a[208:211],v[228:231],a[64:67]
v_sub_f32 v232,v232,v241
v_fma_f32 v241,2.0,v242,v243
M a[68:71],a[208:211],a[204:207],a[68:71]
buffer_load_dwordx4 a[252:255],v250,s[20:23],s48 offen offset:0 sc1
M a[68:71],a[192:195],v[228:231],a[68:71]
v_fmac_f32 v243,-2.0,v242
v_cvt_pk_bf16_f32 v233,v239,v244
M a[68:71],a[232:235],a[236:239],a[68:71]
v_cvt_pk_bf16_f32 v234,v240,v232
v_cvt_pk_bf16_f32 v235,v241,v243
M a[72:75],a[232:235],v[228:231],a[72:75]
v_add_u32 v232,69632,v252
M a[72:75],a[192:195],a[204:207],a[72:75]
buffer_load_dwordx4 a[212:215],v250,s[20:23],s48 offen offset:1024 sc1
M a[72:75],a[208:211],a[200:203],a[72:75]
ds_write_b16 v232,v233 offset:0
M a[76:79],a[208:211],v[216:219],a[76:79]
ds_write_b16_d16_hi v232,v233 offset:8704
M a[76:79],a[192:195],a[200:203],a[76:79]
ds_write_b16 v252,v234 offset:52224
M a[76:79],a[232:235],a[204:207],a[76:79]
buffer_load_dwordx4 a[236:239],v250,s[20:23],s48 offen offset:2048 sc1
M a[80:83],a[232:235],a[200:203],a[80:83]
s_add_u32 s46,s76,27648
ds_write_b16_d16_hi v252,v234 offset:60928
M a[80:83],a[192:195],v[216:219],a[80:83]
M a[80:83],a[208:211],a[196:199],a[80:83]
M a[84:87],a[208:211],a[216:219],a[84:87]
buffer_load_dwordx4 v[228:231],v250,s[20:23],s46 offen offset:0 sc1
M a[84:87],a[192:195],a[196:199],a[84:87]
ds_read_b128 a[204:207],v248 offset:8704
M a[84:87],a[232:235],v[216:219],a[84:87]
ds_read_b128 a[200:203],v249 offset:8704
M a[88:91],a[232:235],a[196:199],a[88:91]
ds_read_b128 v[216:219],v248 offset:9216
M a[88:91],a[192:195],a[216:219],a[88:91]
ds_read_b128 a[196:199],v249 offset:9216
M a[88:91],a[208:211],a[228:231],a[88:91]
M a[92:95],a[208:211],v[220:223],a[92:95]
M a[92:95],a[192:195],a[228:231],a[92:95]
M a[92:95],a[232:235],a[216:219],a[92:95]
s_waitcnt vmcnt(13) lgkmcnt(3)
M a[96:99],a[248:251],a[204:207],a[96:99]
s_waitcnt vmcnt(8) lgkmcnt(2)
ds_read_b128 a[208:211],v248 offset:9728
M a[96:99],a[220:223],a[200:203],a[96:99]
s_waitcnt vmcnt(7) lgkmcnt(2)
ds_read_b128 v[220:223],v249 offset:9728
M a[96:99],a[224:227],v[216:219],a[96:99]
s_waitcnt lgkmcnt(2)
M a[100:103],a[224:227],a[196:199],a[100:103]
M a[100:103],a[220:223],v[216:219],a[100:103]
M a[100:103],a[248:251],a[200:203],a[100:103]
M a[104:107],a[248:251],v[216:219],a[104:107]
ds_read_b128 a[192:195],v248 offset:10240
M a[104:107],a[220:223],a[196:199],a[104:107]
s_waitcnt lgkmcnt(2)
ds_read_b128 a[228:231],v249 offset:10240
M a[104:107],a[224:227],a[208:211],a[104:107]
s_waitcnt lgkmcnt(2)
M a[108:111],a[224:227],v[220:223],a[108:111]
M a[108:111],a[220:223],a[208:211],a[108:111]
M a[108:111],a[248:251],a[196:199],a[108:111]
M a[112:115],a[248:251],a[208:211],a[112:115]
ds_read_b128 a[216:219],v249 offset:10752
M a[112:115],a[220:223],v[220:223],a[112:115]
s_waitcnt lgkmcnt(2)
ds_read_b128 a[232:235],v248 offset:10752
M a[112:115],a[224:227],a[192:195],a[112:115]
s_waitcnt lgkmcnt(2)
M a[116:119],a[224:227],a[228:231],a[116:119]
M a[116:119],a[220:223],a[192:195],a[116:119]
M a[116:119],a[248:251],v[220:223],a[116:119]
M a[120:123],a[248:251],a[192:195],a[120:123]
M a[120:123],a[220:223],a[228:231],a[120:123]
s_waitcnt lgkmcnt(1)
M a[120:123],a[224:227],a[216:219],a[120:123]
s_waitcnt lgkmcnt(0)
M a[124:127],a[224:227],a[232:235],a[124:127]
buffer_load_dwordx4 a[224:227],v250,s[20:23],s46 offen offset:1024 sc1
M a[124:127],a[220:223],a[216:219],a[124:127]
M a[124:127],a[248:251],a[228:231],a[124:127]
s_waitcnt vmcnt(7)
buffer_load_dwordx4 a[220:223],v250,s[20:23],s46 offen offset:2048 sc1
M a[128:131],v[224:227],a[204:207],a[128:131]
s_waitcnt vmcnt(7)
s_add_u32 s47,s76,30720
M a[128:131],a[240:243],a[200:203],a[128:131]
s_waitcnt vmcnt(6)
M a[128:131],a[244:247],v[216:219],a[128:131]
M a[132:135],a[244:247],a[196:199],a[132:135]
buffer_load_dwordx4 a[248:251],v250,s[20:23],s47 offen offset:0 sc1
M a[132:135],a[240:243],v[216:219],a[132:135]
M a[132:135],v[224:227],a[200:203],a[132:135]
M a[136:139],v[224:227],v[216:219],a[136:139]
s_barrier
ds_write_b16 v252,v235 offset:17408
M a[136:139],a[240:243],a[196:199],a[136:139]
ds_write_b16_d16_hi v252,v235 offset:26112
M a[136:139],a[244:247],a[208:211],a[136:139]
ds_write2st64_b64 v247,v[198:199],v[200:201] offset0:34 offset1:51
M a[140:143],a[244:247],v[220:223],a[140:143]
buffer_load_dwordx2 v[198:199],v245,s[8:11],s28 offen offset:768
M a[140:143],a[240:243],a[208:211],a[140:143]
M a[140:143],v[224:227],a[196:199],a[140:143]
buffer_load_dwordx2 v[200:201],v245,s[8:11],s28 offen offset:1152
M a[144:147],v[224:227],a[208:211],a[144:147]
M a[144:147],a[240:243],v[220:223],a[144:147]
M a[144:147],a[244:247],a[192:195],a[144:147]
ds_write2st64_b64 v247,v[204:205],v[214:215] offset0:137 offset1:154
M a[148:151],a[244:247],a[228:231],a[148:151]
s_add_u32 s28,s71,1179648
buffer_load_dwordx2 v[204:205],v245,s[12:15],s28 offen offset:0
M a[148:151],a[240:243],a[192:195],a[148:151]
M a[148:151],v[224:227],v[220:223],a[148:151]
ds_write2st64_b64 v247,v[206:207],v[208:209] offset0:103 offset1:120
M a[152:155],v[224:227],a[192:195],a[152:155]
buffer_load_dwordx2 v[214:215],v245,s[16:19],s28 offen offset:1536
M a[152:155],a[240:243],a[228:231],a[152:155]
M a[152:155],a[244:247],a[216:219],a[152:155]
ds_write2st64_b64 v247,v[210:211],v[212:213] offset0:35 offset1:52
M a[156:159],a[244:247],a[232:235],a[156:159]
buffer_load_dwordx4 a[244:247],v250,s[20:23],s47 offen offset:1024 sc1
M a[156:159],a[240:243],a[216:219],a[156:159]
M a[156:159],v[224:227],a[228:231],a[156:159]
s_waitcnt vmcnt(11)
M a[160:163],a[252:255],a[204:207],a[160:163]
s_waitcnt vmcnt(10)
M a[160:163],a[212:215],a[200:203],a[160:163]
s_waitcnt vmcnt(9)
buffer_load_dwordx4 a[240:243],v250,s[20:23],s47 offen offset:2048 sc1
M a[160:163],a[236:239],v[216:219],a[160:163]
s_add_u32 s48,s76,33792
M a[164:167],a[236:239],a[196:199],a[164:167]
M a[164:167],a[212:215],v[216:219],a[164:167]
M a[164:167],a[252:255],a[200:203],a[164:167]
buffer_load_dwordx4 v[224:227],v250,s[20:23],s48 offen offset:0 sc1
M a[168:171],a[252:255],v[216:219],a[168:171]
M a[168:171],a[212:215],a[196:199],a[168:171]
M a[168:171],a[236:239],a[208:211],a[168:171]
M a[172:175],a[236:239],v[220:223],a[172:175]
buffer_load_dwordx4 a[204:207],v250,s[20:23],s48 offen offset:1024 sc1
M a[172:175],a[212:215],a[208:211],a[172:175]
M a[172:175],a[252:255],a[196:199],a[172:175]
M a[176:179],a[252:255],a[208:211],a[176:179]
M a[176:179],a[212:215],v[220:223],a[176:179]
buffer_load_dwordx4 a[200:203],v250,s[20:23],s48 offen offset:2048 sc1
M a[176:179],a[236:239],a[192:195],a[176:179]
s_add_u32 s46,s76,36864
M a[180:183],a[236:239],a[228:231],a[180:183]
M a[180:183],a[212:215],a[192:195],a[180:183]
ds_read_b128 a[196:199],v248 offset:17408
M a[180:183],a[252:255],v[220:223],a[180:183]
buffer_load_dwordx4 v[216:219],v250,s[20:23],s46 offen offset:0 sc1
M a[184:187],a[252:255],a[192:195],a[184:187]
ds_read_b128 a[208:211],v249 offset:17408
ds_read_b128 v[220:223],v248 offset:17920
M a[184:187],a[212:215],a[228:231],a[184:187]
ds_read_b128 a[192:195],v249 offset:17920
v_lshlrev_b32 v234,16,v196
M a[184:187],a[236:239],a[216:219],a[184:187]
v_lshlrev_b32 v232,16,v192
v_lshlrev_b32 v233,16,v194
M a[188:191],a[236:239],a[232:235],a[188:191]
buffer_load_dwordx2 v[206:207],v245,s[8:11],s28 offen offset:0
M a[188:191],a[212:215],a[216:219],a[188:191]
s_waitcnt vmcnt(9)
v_lshlrev_b32 v237,16,v202
v_lshlrev_b32 v236,16,v200
M a[188:191],a[252:255],a[228:231],a[188:191]
s_waitcnt lgkmcnt(3)
v_lshlrev_b32 v235,16,v198
v_fmac_f32 v232,s43,v234
M v[0:3],v[228:231],a[196:199],v[0:3]
s_waitcnt lgkmcnt(2)
ds_read_b128 a[232:235],v248 offset:18432
v_fmac_f32 v237,4.0,v233
M v[0:3],a[224:227],a[208:211],v[0:3]
s_waitcnt lgkmcnt(2)
buffer_load_dwordx2 v[208:209],v245,s[8:11],s28 offen offset:384
M v[0:3],a[220:223],v[220:223],v[0:3]
s_waitcnt lgkmcnt(1)
ds_read_b128 a[236:239],v249 offset:18432
v_fma_f32 v238,-4.0,v234,v236
M v[4:7],a[220:223],a[192:195],v[4:7]
v_fmac_f32 v232,s45,v236
v_fmac_f32 v237,s41,v235
M v[4:7],a[224:227],v[220:223],v[4:7]
v_sub_f32 v236,v236,v234
v_fma_f32 v234,-4.0,v233,v235
M v[4:7],v[228:231],a[208:211],v[4:7]
buffer_load_dwordx2 v[210:211],v245,s[8:11],s28 offen offset:768
M v[8:11],v[228:231],v[220:223],v[8:11]
ds_read_b128 a[212:215],v248 offset:18944
v_sub_f32 v235,v235,v233
M v[8:11],a[224:227],a[192:195],v[8:11]
s_waitcnt lgkmcnt(2)
ds_read_b128 a[216:219],v249 offset:18944
v_add_f32 v233,v238,v234
M v[8:11],a[220:223],a[232:235],v[8:11]
s_waitcnt lgkmcnt(2)
v_sub_f32 v238,v238,v234
v_fma_f32 v234,2.0,v235,v236
M v[12:15],a[220:223],a[236:239],v[12:15]
buffer_load_dwordx2 v[212:213],v245,s[8:11],s28 offen offset:1152
M v[12:15],a[224:227],a[232:235],v[12:15]
s_add_u32 s29,s66,6291456
v_fmac_f32 v236,-2.0,v235
v_and_b32 v196,s42,v196
M v[12:15],v[228:231],a[192:195],v[12:15]
v_and_b32 v192,s42,v192
v_and_b32 v194,s42,v194
M v[16:19],v[228:231],a[232:235],v[16:19]
ds_read_b128 a[228:231],v249 offset:19456
v_and_b32 v202,s42,v202
M v[16:19],a[224:227],a[236:239],v[16:19]
s_waitcnt lgkmcnt(2)
buffer_load_short_d16_hi v239,v246,s[12:15],s29 offen offset:0
M v[16:19],a[220:223],a[212:215],v[16:19]
s_waitcnt lgkmcnt(1)
ds_read_b128 a[252:255],v248 offset:19456
v_and_b32 v200,s42,v200
M v[20:23],a[220:223],a[216:219],v[20:23]
buffer_load_short_d16_hi v240,v246,s[8:11],s29 offen offset:0
M v[20:23],a[224:227],a[212:215],v[20:23]
v_and_b32 v198,s42,v198
v_fmac_f32 v192,s43,v196
M v[20:23],v[228:231],a[236:239],v[20:23]
buffer_load_short_d16_hi v241,v246,s[8:11],s29 offen offset:384
M v[24:27],v[228:231],a[212:215],v[24:27]
v_fmac_f32 v202,4.0,v194
v_fma_f32 v235,-4.0,v196,v200
M v[24:27],a[224:227],a[216:219],v[24:27]
s_waitcnt lgkmcnt(1)
buffer_load_short_d16_hi v242,v246,s[8:11],s29 offen offset:768
M v[24:27],a[220:223],a[228:231],v[24:27]
s_waitcnt lgkmcnt(0)
v_fmac_f32 v192,s45,v200
v_fmac_f32 v202,s41,v198
M v[28:31],a[220:223],a[252:255],v[28:31]
buffer_load_dwordx4 a[220:223],v250,s[20:23],s46 offen offset:1024 sc1
M v[28:31],a[224:227],a[228:231],v[28:31]
v_sub_f32 v200,v200,v196
v_fma_f32 v196,-4.0,v194,v198
M v[28:31],v[228:231],a[216:219],v[28:31]
v_sub_f32 v198,v198,v194
v_add_f32 v194,v235,v196
M v[32:35],a[248:251],a[196:199],v[32:35]
s_waitcnt vmcnt(14)
v_sub_f32 v235,v235,v196
v_fma_f32 v196,2.0,v198,v200
M v[32:35],a[244:247],a[208:211],v[32:35]
s_waitcnt vmcnt(13)
buffer_load_dwordx4 a[224:227],v250,s[20:23],s46 offen offset:2048 sc1
M v[32:35],a[240:243],v[220:223],v[32:35]
s_add_u32 s47,s76,39936
v_fmac_f32 v200,-2.0,v198
v_cvt_pk_bf16_f32 v192,v232,v192
M v[36:39],a[240:243],a[192:195],v[36:39]
v_cvt_pk_bf16_f32 v202,v237,v202
v_cvt_pk_bf16_f32 v194,v233,v194
M v[36:39],a[244:247],v[220:223],v[36:39]
v_cvt_pk_bf16_f32 v198,v234,v196
v_cvt_pk_bf16_f32 v196,v238,v235
M v[36:39],a[248:251],a[208:211],v[36:39]
buffer_load_dwordx4 v[228:231],v250,s[20:23],s47 offen offset:0 sc1
M v[40:43],a[248:251],v[220:223],v[40:43]
v_cvt_pk_bf16_f32 v200,v236,v200
v_lshlrev_b32 v234,16,v197
M v[40:43],a[244:247],a[192:195],v[40:43]
v_lshlrev_b32 v232,16,v193
v_lshlrev_b32 v233,16,v195
M v[40:43],a[240:243],a[232:235],v[40:43]
v_lshlrev_b32 v237,16,v203
v_lshlrev_b32 v236,16,v201
M v[44:47],a[240:243],a[236:239],v[44:47]
buffer_load_short_d16_hi v243,v246,s[8:11],s29 offen offset:1152
M v[44:47],a[244:247],a[232:235],v[44:47]
v_lshlrev_b32 v235,16,v199
v_fmac_f32 v232,s43,v234
M v[44:47],a[248:251],a[192:195],v[44:47]
buffer_load_short_d16_hi v244,v246,s[16:19],s29 offen offset:1536
M v[48:51],a[248:251],a[232:235],v[48:51]
v_fmac_f32 v237,4.0,v233
v_fma_f32 v238,-4.0,v234,v236
M v[48:51],a[244:247],a[236:239],v[48:51]
v_fmac_f32 v232,s45,v236
v_fmac_f32 v237,s41,v235
M v[48:51],a[240:243],a[212:215],v[48:51]
v_sub_f32 v236,v236,v234
v_fma_f32 v234,-4.0,v233,v235
M v[52:55],a[240:243],a[216:219],v[52:55]
v_sub_f32 v235,v235,v233
v_add_f32 v233,v238,v234
M v[52:55],a[244:247],a[212:215],v[52:55]
v_sub_f32 v238,v238,v234
v_fma_f32 v234,2.0,v235,v236
M v[52:55],a[248:251],a[236:239],v[52:55]
v_fmac_f32 v236,-2.0,v235
v_and_b32 v197,s42,v197
M v[56:59],a[248:251],a[212:215],v[56:59]
v_and_b32 v193,s42,v193
v_and_b32 v195,s42,v195
M v[56:59],a[244:247],a[216:219],v[56:59]
v_and_b32 v203,s42,v203
v_and_b32 v201,s42,v201
M v[56:59],a[240:243],a[228:231],v[56:59]
v_and_b32 v199,s42,v199
v_fmac_f32 v193,s43,v197
M v[60:63],a[240:243],a[252:255],v[60:63]
buffer_load_dwordx4 a[240:243],v250,s[20:23],s47 offen offset:1024 sc1
M v[60:63],a[244:247],a[228:231],v[60:63]
v_fmac_f32 v203,4.0,v195
v_fma_f32 v235,-4.0,v197,v201
M v[60:63],a[248:251],a[216:219],v[60:63]
s_waitcnt vmcnt(17)
buffer_load_dwordx4 a[244:247],v250,s[20:23],s47 offen offset:2048 sc1
M v[64:67],v[224:227],a[196:199],v[64:67]
s_waitcnt vmcnt(17)
s_add_u32 s48,s76,43008
v_fmac_f32 v193,s45,v201
v_fmac_f32 v203,s41,v199
M v[64:67],a[204:207],a[208:211],v[64:67]
s_waitcnt vmcnt(16)
v_sub_f32 v201,v201,v197
v_fma_f32 v197,-4.0,v195,v199
M v[64:67],a[200:203],v[220:223],v[64:67]
v_sub_f32 v199,v199,v195
v_add_f32 v195,v235,v197
M v[68:71],a[200:203],a[192:195],v[68:71]
buffer_load_dwordx4 a[248:251],v250,s[20:23],s48 offen offset:0 sc1
M v[68:71],a[204:207],v[220:223],v[68:71]
v_sub_f32 v235,v235,v197
v_fma_f32 v197,2.0,v199,v201
M v[68:71],v[224:227],a[208:211],v[68:71]
v_fmac_f32 v201,-2.0,v199
v_cvt_pk_bf16_f32 v193,v232,v193
M v[72:75],v[224:227],v[220:223],v[72:75]
v_cvt_pk_bf16_f32 v203,v237,v203
v_cvt_pk_bf16_f32 v195,v233,v195
M v[72:75],a[204:207],a[192:195],v[72:75]
buffer_load_dwordx4 a[196:199],v250,s[20:23],s48 offen offset:1024 sc1
M v[72:75],a[200:203],a[232:235],v[72:75]
v_cvt_pk_bf16_f32 v199,v234,v197
v_cvt_pk_bf16_f32 v197,v238,v235
M v[76:79],a[200:203],a[236:239],v[76:79]
s_waitcnt vmcnt(15)
v_cvt_pk_bf16_f32 v201,v236,v201
v_lshlrev_b32 v234,16,v208
M v[76:79],a[204:207],a[232:235],v[76:79]
v_lshlrev_b32 v232,16,v204
v_lshlrev_b32 v233,16,v206
M v[76:79],v[224:227],a[192:195],v[76:79]
buffer_load_dwordx4 a[208:211],v250,s[20:23],s48 offen offset:2048 sc1
M v[80:83],v[224:227],a[232:235],v[80:83]
s_waitcnt vmcnt(14)
s_add_u32 s46,s77,9216
v_lshlrev_b32 v237,16,v214
v_lshlrev_b32 v236,16,v212
M v[80:83],a[204:207],a[236:239],v[80:83]
v_lshlrev_b32 v235,16,v210
v_fmac_f32 v232,s43,v234
M v[80:83],a[200:203],a[212:215],v[80:83]
ds_write2st64_b64 v247,v[192:193],v[202:203] offset0:138 offset1:155
M v[84:87],a[200:203],a[216:219],v[84:87]
s_add_u32 s28,s66,6291456
buffer_load_dwordx4 v[220:223],v250,s[20:23],s46 offen offset:0 sc1
M v[84:87],a[204:207],a[212:215],v[84:87]
ds_read_b128 a[192:195],v248 offset:26112
v_fmac_f32 v237,4.0,v233
M v[84:87],v[224:227],a[236:239],v[84:87]
ds_write2st64_b64 v247,v[194:195],v[196:197] offset0:104 offset1:121
M v[88:91],v[224:227],a[212:215],v[88:91]
buffer_load_dwordx2 v[192:193],v245,s[12:15],s28 offen offset:0
M v[88:91],a[204:207],a[216:219],v[88:91]
ds_read_b128 a[232:235],v249 offset:26112
ds_read_b128 a[236:239],v248 offset:26624
M v[88:91],a[200:203],a[228:231],v[88:91]
ds_write2st64_b64 v247,v[198:199],v[200:201] offset0:36 offset1:53
M v[92:95],a[200:203],a[252:255],v[92:95]
buffer_load_dwordx2 v[202:203],v245,s[16:19],s28 offen offset:1536
M v[92:95],a[204:207],a[228:231],v[92:95]
ds_read_b128 a[212:215],v249 offset:26624
v_fma_f32 v238,-4.0,v234,v236
M v[92:95],v[224:227],a[216:219],v[92:95]
s_waitcnt lgkmcnt(5)
v_fmac_f32 v232,s45,v236
v_fmac_f32 v237,s41,v235
M v[96:99],v[216:219],a[192:195],v[96:99]
s_waitcnt vmcnt(12) lgkmcnt(3)
ds_read_b128 a[200:203],v248 offset:27136
v_sub_f32 v236,v236,v234
M v[96:99],a[220:223],a[232:235],v[96:99]
s_waitcnt vmcnt(11) lgkmcnt(3)
buffer_load_dwordx2 v[194:195],v245,s[8:11],s28 offen offset:0
M v[96:99],a[224:227],a[236:239],v[96:99]
s_waitcnt lgkmcnt(1)
ds_read_b128 a[252:255],v249 offset:27136
v_fma_f32 v234,-4.0,v233,v235
M v[100:103],a[224:227],a[212:215],v[100:103]
v_sub_f32 v235,v235,v233
v_add_f32 v233,v238,v234
M v[100:103],a[220:223],a[236:239],v[100:103]
v_sub_f32 v238,v238,v234
v_fma_f32 v234,2.0,v235,v236
M v[100:103],v[216:219],a[232:235],v[100:103]
buffer_load_dwordx2 v[196:197],v245,s[8:11],s28 offen offset:384
M v[104:107],v[216:219],a[236:239],v[104:107]
ds_read_b128 a[204:207],v248 offset:27648
v_fmac_f32 v236,-2.0,v235
M v[104:107],a[220:223],a[212:215],v[104:107]
s_waitcnt lgkmcnt(2)
ds_read_b128 a[228:231],v249 offset:27648
v_and_b32 v208,s42,v208
M v[104:107],a[224:227],a[200:203],v[104:107]
s_waitcnt lgkmcnt(2)
v_and_b32 v204,s42,v204
v_and_b32 v206,s42,v206
M v[108:111],a[224:227],a[252:255],v[108:111]
buffer_load_dwordx2 v[198:199],v245,s[8:11],s28 offen offset:768
M v[108:111],a[220:223],a[200:203],v[108:111]
v_and_b32 v214,s42,v214
v_and_b32 v212,s42,v212
M v[108:111],v[216:219],a[212:215],v[108:111]
v_and_b32 v210,s42,v210
v_fmac_f32 v204,s43,v208
M v[112:115],v[216:219],a[200:203],v[112:115]
ds_read_b128 a[216:219],v249 offset:28160
v_fmac_f32 v214,4.0,v206
M v[112:115],a[220:223],a[252:255],v[112:115]
s_waitcnt lgkmcnt(2)
buffer_load_dwordx2 v[200:201],v245,s[8:11],s28 offen offset:1152
M v[112:115],a[224:227],a[204:207],v[112:115]
s_waitcnt lgkmcnt(1)
ds_read_b128 v[224:227],v248 offset:28160
v_fma_f32 v235,-4.0,v208,v212
M v[116:119],a[224:227],a[228:231],v[116:119]
v_fmac_f32 v204,s45,v212
v_fmac_f32 v214,s41,v210
M v[116:119],a[220:223],a[204:207],v[116:119]
v_sub_f32 v212,v212,v208
v_fma_f32 v208,-4.0,v206,v210
M v[116:119],v[216:219],a[252:255],v[116:119]
v_sub_f32 v210,v210,v206
v_add_f32 v206,v235,v208
M v[120:123],v[216:219],a[204:207],v[120:123]
v_sub_f32 v235,v235,v208
v_fma_f32 v208,2.0,v210,v212
M v[120:123],a[220:223],a[228:231],v[120:123]
s_waitcnt lgkmcnt(1)
v_fmac_f32 v212,-2.0,v210
v_cvt_pk_bf16_f32 v204,v232,v204
M v[120:123],a[224:227],a[216:219],v[120:123]
s_waitcnt lgkmcnt(0)
v_cvt_pk_bf16_f32 v214,v237,v214
v_cvt_pk_bf16_f32 v206,v233,v206
M v[124:127],a[224:227],v[224:227],v[124:127]
buffer_load_dwordx4 a[224:227],v250,s[20:23],s46 offen offset:1024 sc1
M v[124:127],a[220:223],a[216:219],v[124:127]
v_cvt_pk_bf16_f32 v210,v234,v208
v_cvt_pk_bf16_f32 v208,v238,v235
M v[124:127],v[216:219],a[228:231],v[124:127]
s_waitcnt vmcnt(15)
buffer_load_dwordx4 a[220:223],v250,s[20:23],s46 offen offset:2048 sc1
M v[128:131],v[228:231],a[192:195],v[128:131]
s_waitcnt vmcnt(13)
s_add_u32 s46,s77,18432
v_cvt_pk_bf16_f32 v212,v236,v212
v_lshlrev_b32 v234,16,v209
M v[128:131],a[240:243],a[232:235],v[128:131]
s_waitcnt vmcnt(12)
v_lshlrev_b32 v232,16,v205
v_lshlrev_b32 v233,16,v207
M v[128:131],a[244:247],a[236:239],v[128:131]
v_lshlrev_b32 v237,16,v215
v_lshlrev_b32 v236,16,v213
M v[132:135],a[244:247],a[212:215],v[132:135]
buffer_load_dwordx4 v[216:219],v250,s[20:23],s46 offen offset:0 sc1
M v[132:135],a[240:243],a[236:239],v[132:135]
v_lshlrev_b32 v235,16,v211
v_fmac_f32 v232,s43,v234
M v[132:135],v[228:231],a[232:235],v[132:135]
v_fmac_f32 v237,4.0,v233
v_fma_f32 v238,-4.0,v234,v236
M v[136:139],v[228:231],a[236:239],v[136:139]
v_fmac_f32 v232,s45,v236
v_fmac_f32 v237,s41,v235
M v[136:139],a[240:243],a[212:215],v[136:139]
v_sub_f32 v236,v236,v234
v_fma_f32 v234,-4.0,v233,v235
M v[136:139],a[244:247],a[200:203],v[136:139]
v_sub_f32 v235,v235,v233
v_add_f32 v233,v238,v234
M v[140:143],a[244:247],a[252:255],v[140:143]
v_sub_f32 v238,v238,v234
v_fma_f32 v234,2.0,v235,v236
M v[140:143],a[240:243],a[200:203],v[140:143]
v_fmac_f32 v236,-2.0,v235
v_and_b32 v209,s42,v209
M v[140:143],v[228:231],a[212:215],v[140:143]
v_and_b32 v205,s42,v205
v_and_b32 v207,s42,v207
M v[144:147],v[228:231],a[200:203],v[144:147]
v_and_b32 v215,s42,v215
v_and_b32 v213,s42,v213
M v[144:147],a[240:243],a[252:255],v[144:147]
v_and_b32 v211,s42,v211
v_fmac_f32 v205,s43,v209
M v[144:147],a[244:247],a[204:207],v[144:147]
v_fmac_f32 v215,4.0,v207
v_fma_f32 v235,-4.0,v209,v213
M v[148:151],a[244:247],a[228:231],v[148:151]
v_fmac_f32 v205,s45,v213
v_fmac_f32 v215,s41,v211
M v[148:151],a[240:243],a[204:207],v[148:151]
v_sub_f32 v213,v213,v209
v_fma_f32 v209,-4.0,v207,v211
M v[148:151],v[228:231],a[252:255],v[148:151]
v_sub_f32 v211,v211,v207
v_add_f32 v207,v235,v209
M v[152:155],v[228:231],a[204:207],v[152:155]
v_sub_f32 v235,v235,v209
v_fma_f32 v209,2.0,v211,v213
M v[152:155],a[240:243],a[228:231],v[152:155]
v_fmac_f32 v213,-2.0,v211
v_cvt_pk_bf16_f32 v205,v232,v205
M v[152:155],a[244:247],a[216:219],v[152:155]
v_cvt_pk_bf16_f32 v215,v237,v215
v_cvt_pk_bf16_f32 v207,v233,v207
M v[156:159],a[244:247],v[224:227],v[156:159]
buffer_load_dwordx4 a[244:247],v250,s[20:23],s46 offen offset:1024 sc1
M v[156:159],a[240:243],a[216:219],v[156:159]
v_cvt_pk_bf16_f32 v211,v234,v209
v_cvt_pk_bf16_f32 v209,v238,v235
M v[156:159],v[228:231],a[228:231],v[156:159]
s_waitcnt vmcnt(13)
buffer_load_dwordx4 a[240:243],v250,s[20:23],s46 offen offset:2048 sc1
M v[160:163],a[248:251],a[192:195],v[160:163]
s_waitcnt vmcnt(13)
s_add_u32 s46,s77,27648
v_cvt_pk_bf16_f32 v213,v236,v213
M v[160:163],a[196:199],a[232:235],v[160:163]
s_waitcnt vmcnt(12)
M v[160:163],a[208:211],a[236:239],v[160:163]
ds_write2st64_b64 v247,v[204:205],v[214:215] offset0:139 offset1:156
M v[164:167],a[208:211],a[212:215],v[164:167]
buffer_load_dwordx4 v[228:231],v250,s[20:23],s46 offen offset:0 sc1
M v[164:167],a[196:199],a[236:239],v[164:167]
M v[164:167],a[248:251],a[232:235],v[164:167]
ds_write2st64_b64 v247,v[206:207],v[208:209] offset0:105 offset1:122
M v[168:171],a[248:251],a[236:239],v[168:171]
buffer_load_dwordx4 a[192:195],v250,s[20:23],s46 offen offset:1024 sc1
M v[168:171],a[196:199],a[212:215],v[168:171]
M v[168:171],a[208:211],a[200:203],v[168:171]
ds_write2st64_b64 v247,v[210:211],v[212:213] offset0:37 offset1:54
M v[172:175],a[208:211],a[252:255],v[172:175]
buffer_load_dwordx4 a[232:235],v250,s[20:23],s46 offen offset:2048 sc1
M v[172:175],a[196:199],a[200:203],v[172:175]
s_add_u32 s46,s77,36864
M v[172:175],a[248:251],a[212:215],v[172:175]
M v[176:179],a[248:251],a[200:203],v[176:179]
M v[176:179],a[196:199],a[252:255],v[176:179]
buffer_load_dwordx4 a[236:239],v250,s[20:23],s46 offen offset:0 sc1
M v[176:179],a[208:211],a[204:207],v[176:179]
s_waitcnt lgkmcnt(0)
s_barrier
M v[180:183],a[208:211],a[228:231],v[180:183]
s_waitcnt vmcnt(11)
v_lshlrev_b32 v234,16,v196
v_lshlrev_b32 v232,16,v192
M v[180:183],a[196:199],a[204:207],v[180:183]
ds_read_b128 a[212:215],v248 offset:34816
v_lshlrev_b32 v233,16,v194
M v[180:183],a[248:251],a[252:255],v[180:183]
ds_read_b128 a[200:203],v249 offset:34816
v_lshlrev_b32 v237,16,v202
M v[184:187],a[248:251],a[204:207],v[184:187]
s_waitcnt vmcnt(9)
ds_read_b128 a[252:255],v248 offset:35328
v_lshlrev_b32 v236,16,v200
M v[184:187],a[196:199],a[228:231],v[184:187]
ds_read_b128 a[204:207],v249 offset:35328
v_lshlrev_b32 v235,16,v198
M v[184:187],a[208:211],a[216:219],v[184:187]
v_fmac_f32 v232,s43,v234
v_fmac_f32 v237,4.0,v233
M v[188:191],a[208:211],v[224:227],v[188:191]
buffer_load_dwordx4 a[208:211],v250,s[20:23],s46 offen offset:1024 sc1
M v[188:191],a[196:199],a[216:219],v[188:191]
v_fma_f32 v238,-4.0,v234,v236
v_fmac_f32 v232,s45,v236
M v[188:191],a[248:251],a[228:231],v[188:191]
s_waitcnt lgkmcnt(3)
buffer_load_dwordx4 v[224:227],v250,s[20:23],s46 offen offset:2048 sc1
M a[0:3],v[220:223],a[212:215],a[0:3]
s_waitcnt vmcnt(10) lgkmcnt(2)
s_add_u32 s47,s77,12288
ds_read_b128 a[216:219],v248 offset:35840
v_fmac_f32 v237,s41,v235
M a[0:3],a[224:227],a[200:203],a[0:3]
s_waitcnt vmcnt(9) lgkmcnt(2)
ds_read_b128 a[228:231],v249 offset:35840
v_sub_f32 v236,v236,v234
M a[0:3],a[220:223],a[252:255],a[0:3]
s_waitcnt lgkmcnt(2)
v_fma_f32 v234,-4.0,v233,v235
v_sub_f32 v235,v235,v233
M a[4:7],a[220:223],a[204:207],a[4:7]
buffer_load_dwordx4 a[196:199],v250,s[20:23],s47 offen offset:0 sc1
M a[4:7],a[224:227],a[252:255],a[4:7]
v_add_f32 v233,v238,v234
v_sub_f32 v238,v238,v234
M a[4:7],v[220:223],a[200:203],a[4:7]
v_fma_f32 v234,2.0,v235,v236
v_fmac_f32 v236,-2.0,v235
M a[8:11],v[220:223],a[252:255],a[8:11]
ds_read_b128 a[248:251],v248 offset:36352
v_and_b32 v196,s42,v196
M a[8:11],a[224:227],a[204:207],a[8:11]
s_waitcnt lgkmcnt(2)
ds_read_b128 a[212:215],v249 offset:36352
v_and_b32 v192,s42,v192
M a[8:11],a[220:223],a[216:219],a[8:11]
s_waitcnt lgkmcnt(2)
v_and_b32 v194,s42,v194
v_and_b32 v202,s42,v202
M a[12:15],a[220:223],a[228:231],a[12:15]
v_and_b32 v200,s42,v200
v_and_b32 v198,s42,v198
M a[12:15],a[224:227],a[216:219],a[12:15]
v_fmac_f32 v192,s43,v196
v_fmac_f32 v202,4.0,v194
M a[12:15],v[220:223],a[204:207],a[12:15]
v_fma_f32 v235,-4.0,v196,v200
v_fmac_f32 v192,s45,v200
M a[16:19],v[220:223],a[216:219],a[16:19]
ds_read_b128 a[200:203],v249 offset:36864
v_fmac_f32 v202,s41,v198
M a[16:19],a[224:227],a[228:231],a[16:19]
s_waitcnt lgkmcnt(2)
ds_read_b128 a[252:255],v248 offset:36864
v_sub_f32 v200,v200,v196
M a[16:19],a[220:223],a[248:251],a[16:19]
s_waitcnt lgkmcnt(2)
v_fma_f32 v196,-4.0,v194,v198
v_sub_f32 v198,v198,v194
M a[20:23],a[220:223],a[212:215],a[20:23]
v_add_f32 v194,v235,v196
v_sub_f32 v235,v235,v196
M a[20:23],a[224:227],a[248:251],a[20:23]
ds_read_b128 a[204:207],v248 offset:43520
v_fma_f32 v196,2.0,v198,v200
M a[20:23],v[220:223],a[228:231],a[20:23]
ds_read_b128 a[216:219],v249 offset:43520
v_fmac_f32 v200,-2.0,v198
M a[24:27],v[220:223],a[248:251],a[24:27]
ds_read_b128 a[228:231],v248 offset:44032
v_cvt_pk_bf16_f32 v192,v232,v192
M a[24:27],a[224:227],a[212:215],a[24:27]
s_waitcnt lgkmcnt(4)
ds_read_b128 a[248:251],v249 offset:44032
v_cvt_pk_bf16_f32 v202,v237,v202
M a[24:27],a[220:223],a[200:203],a[24:27]
s_waitcnt lgkmcnt(4)
v_cvt_pk_bf16_f32 v194,v233,v194
v_cvt_pk_bf16_f32 v198,v234,v196
M a[28:31],a[220:223],a[252:255],a[28:31]
buffer_load_dwordx4 a[220:223],v250,s[20:23],s47 offen offset:1024 sc1
M a[28:31],a[224:227],a[200:203],a[28:31]
v_cvt_pk_bf16_f32 v196,v238,v235
v_cvt_pk_bf16_f32 v200,v236,v200
M a[28:31],v[220:223],a[212:215],a[28:31]
s_waitcnt vmcnt(10) lgkmcnt(3)
buffer_load_dwordx4 a[252:255],v250,s[20:23],s47 offen offset:2048 sc1
M a[96:99],v[216:219],a[204:207],a[96:99]
s_waitcnt vmcnt(10) lgkmcnt(2)
s_add_u32 s48,s77,15360
ds_read_b128 a[224:227],v248 offset:44544
v_lshlrev_b32 v234,16,v197
M a[96:99],a[244:247],a[216:219],a[96:99]
s_waitcnt vmcnt(9) lgkmcnt(2)
ds_read_b128 a[212:215],v249 offset:44544
v_lshlrev_b32 v232,16,v193
M a[96:99],a[240:243],a[228:231],a[96:99]
s_waitcnt lgkmcnt(2)
v_lshlrev_b32 v233,16,v195
v_lshlrev_b32 v237,16,v203
M a[100:103],a[240:243],a[248:251],a[100:103]
buffer_load_dwordx4 a[200:203],v250,s[20:23],s48 offen offset:0 sc1
M a[100:103],a[244:247],a[228:231],a[100:103]
v_lshlrev_b32 v236,16,v201
v_lshlrev_b32 v235,16,v199
M a[100:103],v[216:219],a[216:219],a[100:103]
v_fmac_f32 v232,s43,v234
v_fmac_f32 v237,4.0,v233
M a[104:107],v[216:219],a[228:231],a[104:107]
ds_read_b128 v[220:223],v248 offset:45056
v_fma_f32 v238,-4.0,v234,v236
M a[104:107],a[244:247],a[248:251],a[104:107]
s_waitcnt lgkmcnt(2)
ds_read_b128 a[204:207],v249 offset:45056
v_fmac_f32 v232,s45,v236
M a[104:107],a[240:243],a[224:227],a[104:107]
s_waitcnt lgkmcnt(2)
v_fmac_f32 v237,s41,v235
v_sub_f32 v236,v236,v234
M a[108:111],a[240:243],a[212:215],a[108:111]
v_fma_f32 v234,-4.0,v233,v235
v_sub_f32 v235,v235,v233
M a[108:111],a[244:247],a[224:227],a[108:111]
v_add_f32 v233,v238,v234
v_sub_f32 v238,v238,v234
M a[108:111],v[216:219],a[248:251],a[108:111]
v_fma_f32 v234,2.0,v235,v236
v_fmac_f32 v236,-2.0,v235
M a[112:115],v[216:219],a[224:227],a[112:115]
ds_read_b128 a[216:219],v249 offset:45568
v_and_b32 v197,s42,v197
M a[112:115],a[244:247],a[212:215],a[112:115]
s_waitcnt lgkmcnt(2)
ds_read_b128 a[228:231],v248 offset:45568
v_and_b32 v255,32,v245
M a[112:115],a[240:243],v[220:223],a[112:115]
s_waitcnt lgkmcnt(2)
v_mul_u32_u24 v255,24,v255
v_and_or_b32 v255,v245,s42,v255
M a[116:119],a[240:243],a[204:207],a[116:119]
v_and_b32 v193,s42,v193
v_and_b32 v195,s42,v195
M a[116:119],a[244:247],v[220:223],a[116:119]
ds_read_b128 a[248:251],v248 offset:0
v_and_b32 v203,s42,v203
M a[116:119],v[216:219],a[212:215],a[116:119]
s_add_u32 s31,s66,6684672
ds_read_b128 a[224:227],v249 offset:0
v_and_b32 v201,s42,v201
M a[120:123],v[216:219],v[220:223],a[120:123]
ds_read_b128 a[212:215],v248 offset:512
v_and_b32 v199,s42,v199
M a[120:123],a[244:247],a[204:207],a[120:123]
s_waitcnt lgkmcnt(4)
ds_read_b128 v[220:223],v249 offset:512
v_fmac_f32 v193,s43,v197
M a[120:123],a[240:243],a[216:219],a[120:123]
s_waitcnt lgkmcnt(4)
v_fmac_f32 v203,4.0,v195
v_fma_f32 v235,-4.0,v197,v201
M a[124:127],a[240:243],a[228:231],a[124:127]
buffer_load_dword a228,v255,s[8:11],s31 offen offset:0
M a[124:127],a[244:247],a[216:219],a[124:127]
v_fmac_f32 v193,s45,v201
v_fmac_f32 v203,s41,v199
M a[124:127],v[216:219],a[204:207],a[124:127]
s_waitcnt vmcnt(10) lgkmcnt(3)
v_sub_f32 v201,v201,v197
v_fma_f32 v197,-4.0,v195,v199
M v[0:3],v[228:231],a[248:251],v[0:3]
s_waitcnt vmcnt(9) lgkmcnt(2)
ds_read_b128 a[240:243],v248 offset:1024
v_sub_f32 v199,v199,v195
M v[0:3],a[192:195],a[224:227],v[0:3]
s_waitcnt vmcnt(8) lgkmcnt(2)
buffer_load_dword a228,v255,s[8:11],s31 offen offset:384
M v[0:3],a[232:235],a[212:215],v[0:3]
s_waitcnt lgkmcnt(1)
ds_read_b128 a[216:219],v249 offset:1024
v_add_f32 v195,v235,v197
M v[4:7],a[232:235],v[220:223],v[4:7]
v_sub_f32 v235,v235,v197
v_fma_f32 v197,2.0,v199,v201
M v[4:7],a[192:195],a[212:215],v[4:7]
v_fmac_f32 v201,-2.0,v199
v_cvt_pk_bf16_f32 v193,v232,v193
M v[4:7],v[228:231],a[224:227],v[4:7]
v_cvt_pk_bf16_f32 v203,v237,v203
v_cvt_pk_bf16_f32 v195,v233,v195
M v[8:11],v[228:231],a[212:215],v[8:11]
ds_read_b128 a[244:247],v248 offset:1536
v_cvt_pk_bf16_f32 v199,v234,v197
M v[8:11],a[192:195],v[220:223],v[8:11]
s_waitcnt lgkmcnt(2)
ds_read_b128 a[204:207],v249 offset:1536
v_cvt_pk_bf16_f32 v197,v238,v235
M v[8:11],a[232:235],a[240:243],v[8:11]
s_waitcnt lgkmcnt(2)
v_cvt_pk_bf16_f32 v201,v236,v201
M v[12:15],a[232:235],a[216:219],v[12:15]
M v[12:15],a[192:195],a[240:243],v[12:15]
M v[12:15],v[228:231],v[220:223],v[12:15]
M v[16:19],v[228:231],a[240:243],v[16:19]
ds_read_b128 v[216:219],v249 offset:2048
M v[16:19],a[192:195],a[216:219],v[16:19]
s_waitcnt lgkmcnt(2)
buffer_load_dwordx4 a[228:231],v250,s[20:23],s48 offen offset:1024 sc1
M v[16:19],a[232:235],a[244:247],v[16:19]
s_waitcnt lgkmcnt(1)
ds_read_b128 a[248:251],v248 offset:2048
M v[20:23],a[232:235],a[204:207],v[20:23]
buffer_load_dwordx4 a[224:227],v250,s[20:23],s48 offen offset:2048 sc1
M v[20:23],a[192:195],a[244:247],v[20:23]
ds_read_b128 a[212:215],v248 offset:8704
M v[20:23],v[228:231],a[216:219],v[20:23]
ds_read_b128 v[220:223],v249 offset:8704
M v[24:27],v[228:231],a[244:247],v[24:27]
ds_read_b128 a[240:243],v248 offset:9216
M v[24:27],a[192:195],a[204:207],v[24:27]
s_waitcnt lgkmcnt(4)
ds_read_b128 a[216:219],v249 offset:9216
M v[24:27],a[232:235],v[216:219],v[24:27]
s_waitcnt lgkmcnt(4)
M v[28:31],a[232:235],a[248:251],v[28:31]
s_add_u32 s47,s77,21504
M v[28:31],a[192:195],v[216:219],v[28:31]
M v[28:31],v[228:231],a[204:207],v[28:31]
s_waitcnt vmcnt(10) lgkmcnt(3)
M v[96:99],a[236:239],a[212:215],v[96:99]
s_waitcnt vmcnt(9) lgkmcnt(2)
ds_read_b128 a[244:247],v248 offset:9728
M v[96:99],a[208:211],v[220:223],v[96:99]
s_waitcnt vmcnt(8) lgkmcnt(2)
ds_read_b128 a[232:235],v249 offset:9728
M v[96:99],v[224:227],a[240:243],v[96:99]
s_waitcnt lgkmcnt(2)
M v[100:103],v[224:227],a[216:219],v[100:103]
buffer_load_dwordx4 a[248:251],v250,s[20:23],s47 offen offset:0 sc1
M v[100:103],a[208:211],a[240:243],v[100:103]
M v[100:103],a[236:239],v[220:223],v[100:103]
buffer_load_dwordx4 a[192:195],v250,s[20:23],s47 offen offset:1024 sc1
M v[104:107],a[236:239],a[240:243],v[104:107]
ds_read_b128 v[228:231],v248 offset:10240
v_accvgpr_read_b32 v238,a0
M v[104:107],a[208:211],a[216:219],v[104:107]
s_waitcnt lgkmcnt(2)
ds_read_b128 a[212:215],v249 offset:10240
v_accvgpr_read_b32 v232,a96
M v[104:107],v[224:227],a[244:247],v[104:107]
s_waitcnt lgkmcnt(2)
v_add_f32 v234,v238,v232
v_sub_f32 v238,v238,v232
M v[108:111],v[224:227],a[232:235],v[108:111]
buffer_load_dwordx4 v[216:219],v250,s[20:23],s47 offen offset:2048 sc1
M v[108:111],a[208:211],a[244:247],v[108:111]
s_add_u32 s48,s77,24576
v_add_f32 v232,v0,v96
v_sub_f32 v96,v0,v96
M v[108:111],a[236:239],a[216:219],v[108:111]
v_add_f32 v0,v234,v232
v_fmac_f32 v234,4.0,v232
M v[112:115],a[236:239],a[244:247],v[112:115]
ds_read_b128 v[220:223],v249 offset:10752
v_fma_f32 v232,2.0,v96,v238
M v[112:115],a[208:211],a[232:235],v[112:115]
s_waitcnt lgkmcnt(2)
buffer_load_dwordx4 a[204:207],v250,s[20:23],s48 offen offset:0 sc1
M v[112:115],v[224:227],v[228:231],v[112:115]
s_waitcnt lgkmcnt(1)
ds_read_b128 a[240:243],v248 offset:10752
v_fma_f32 v96,s40,v96,v238
M v[116:119],v[224:227],a[212:215],v[116:119]
v_accvgpr_read_b32 v238,a1
v_accvgpr_read_b32 v237,a97
M v[116:119],a[208:211],v[228:231],v[116:119]
ds_read_b128 a[216:219],v248 offset:34816
v_add_f32 v236,v238,v237
M v[116:119],a[236:239],a[232:235],v[116:119]
ds_read_b128 a[244:247],v249 offset:34816
v_sub_f32 v238,v238,v237
M v[120:123],a[236:239],v[228:231],v[120:123]
ds_read_b128 a[232:235],v248 offset:35328
v_add_f32 v237,v1,v97
M v[120:123],a[208:211],a[212:215],v[120:123]
s_waitcnt lgkmcnt(4)
ds_read_b128 v[228:231],v249 offset:35328
v_sub_f32 v97,v1,v97
M v[120:123],v[224:227],v[220:223],v[120:123]
s_waitcnt lgkmcnt(4)
v_add_f32 v1,v236,v237
v_fmac_f32 v236,4.0,v237
M v[124:127],v[224:227],a[240:243],v[124:127]
v_fma_f32 v237,2.0,v97,v238
v_fma_f32 v97,s40,v97,v238
M v[124:127],a[208:211],v[220:223],v[124:127]
v_cvt_pk_bf16_f32 v232,v232,v237
v_cvt_pk_bf16_f32 v234,v234,v236
M v[124:127],a[236:239],a[212:215],v[124:127]
s_waitcnt vmcnt(11) lgkmcnt(3)
v_accvgpr_read_b32 v238,a2
v_accvgpr_read_b32 v233,a98
M a[32:35],a[196:199],a[216:219],a[32:35]
s_waitcnt vmcnt(10) lgkmcnt(2)
ds_read_b128 a[240:243],v248 offset:35840
v_add_f32 v235,v238,v233
M a[32:35],a[220:223],a[244:247],a[32:35]
s_waitcnt vmcnt(9) lgkmcnt(2)
ds_read_b128 v[224:227],v249 offset:35840
v_sub_f32 v238,v238,v233
M a[32:35],a[252:255],a[232:235],a[32:35]
s_waitcnt lgkmcnt(2)
v_add_f32 v233,v2,v98
v_sub_f32 v98,v2,v98
M a[36:39],a[252:255],v[228:231],a[36:39]
v_add_f32 v2,v235,v233
v_fmac_f32 v235,4.0,v233
M a[36:39],a[220:223],a[232:235],a[36:39]
v_fma_f32 v233,2.0,v98,v238
v_fma_f32 v98,s40,v98,v238
M a[36:39],a[196:199],a[244:247],a[36:39]
v_accvgpr_read_b32 v238,a3
v_accvgpr_read_b32 v237,a99
M a[40:43],a[196:199],a[232:235],a[40:43]
ds_read_b128 a[96:99],v248 offset:36352
v_add_f32 v236,v238,v237
M a[40:43],a[220:223],v[228:231],a[40:43]
s_waitcnt lgkmcnt(2)
ds_read_b128 a[208:211],v249 offset:36352
v_sub_f32 v238,v238,v237
M a[40:43],a[252:255],a[240:243],a[40:43]
s_waitcnt lgkmcnt(2)
v_add_f32 v237,v3,v99
v_sub_f32 v99,v3,v99
M a[44:47],a[252:255],v[224:227],a[44:47]
v_add_f32 v3,v236,v237
v_fmac_f32 v236,4.0,v237
M a[44:47],a[220:223],a[240:243],a[44:47]
v_fma_f32 v237,2.0,v99,v238
v_fma_f32 v99,s40,v99,v238
M a[44:47],a[196:199],v[228:231],a[44:47]
v_cvt_pk_bf16_f32 v233,v233,v237
v_cvt_pk_bf16_f32 v235,v235,v236
M a[48:51],a[196:199],a[240:243],a[48:51]
ds_read_b128 v[220:223],v249 offset:36864
ds_write2st64_b64 v254,v[232:233],v[234:235] offset0:68 offset1:72
M a[48:51],a[220:223],v[224:227],a[48:51]
s_waitcnt lgkmcnt(3)
ds_read_b128 a[212:215],v248 offset:36864
v_accvgpr_read_b32 v238,a4
M a[48:51],a[252:255],a[96:99],a[48:51]
s_waitcnt lgkmcnt(3)
v_accvgpr_read_b32 v232,a100
v_add_f32 v234,v238,v232
M a[52:55],a[252:255],a[208:211],a[52:55]
buffer_load_dwordx4 a[236:239],v250,s[20:23],s48 offen offset:1024 sc1
M a[52:55],a[220:223],a[96:99],a[52:55]
v_sub_f32 v238,v238,v232
v_add_f32 v232,v4,v100
M a[52:55],a[196:199],v[224:227],a[52:55]
v_sub_f32 v100,v4,v100
v_add_f32 v4,v234,v232
M a[56:59],a[196:199],a[96:99],a[56:59]
v_fmac_f32 v234,4.0,v232
v_fma_f32 v232,2.0,v100,v238
M a[56:59],a[220:223],a[208:211],a[56:59]
s_waitcnt lgkmcnt(2)
v_fma_f32 v100,s40,v100,v238
v_accvgpr_read_b32 v238,a5
M a[56:59],a[252:255],v[220:223],a[56:59]
s_waitcnt lgkmcnt(0)
v_accvgpr_read_b32 v237,a101
v_add_f32 v236,v238,v237
M a[60:63],a[252:255],a[212:215],a[60:63]
buffer_load_dwordx4 a[252:255],v250,s[20:23],s48 offen offset:2048 sc1
M a[60:63],a[220:223],v[220:223],a[60:63]
s_add_u32 s47,s77,30720
v_sub_f32 v238,v238,v237
v_add_f32 v237,v5,v101
M a[60:63],a[196:199],a[208:211],a[60:63]
s_waitcnt vmcnt(10)
buffer_load_dwordx4 a[220:223],v250,s[20:23],s47 offen offset:0 sc1
M a[64:67],a[200:203],a[216:219],a[64:67]
s_waitcnt vmcnt(8)
v_sub_f32 v101,v5,v101
v_add_f32 v5,v236,v237
M a[64:67],a[228:231],a[244:247],a[64:67]
s_waitcnt vmcnt(7)
v_fmac_f32 v236,4.0,v237
v_fma_f32 v237,2.0,v101,v238
M a[64:67],a[224:227],a[232:235],a[64:67]
v_fma_f32 v101,s40,v101,v238
v_cvt_pk_bf16_f32 v232,v232,v237
M a[68:71],a[224:227],v[228:231],a[68:71]
buffer_load_dwordx4 a[196:199],v250,s[20:23],s47 offen offset:1024 sc1
M a[68:71],a[228:231],a[232:235],a[68:71]
v_cvt_pk_bf16_f32 v234,v234,v236
v_accvgpr_read_b32 v238,a6
M a[68:71],a[200:203],a[244:247],a[68:71]
v_accvgpr_read_b32 v233,a102
v_add_f32 v235,v238,v233
M a[72:75],a[200:203],a[232:235],a[72:75]
v_sub_f32 v238,v238,v233
v_add_f32 v233,v6,v102
M a[72:75],a[228:231],v[228:231],a[72:75]
buffer_load_dwordx4 a[216:219],v250,s[20:23],s47 offen offset:2048 sc1
M a[72:75],a[224:227],a[240:243],a[72:75]
s_add_u32 s48,s77,33792
v_sub_f32 v102,v6,v102
v_add_f32 v6,v235,v233
M a[76:79],a[224:227],v[224:227],a[76:79]
v_fmac_f32 v235,4.0,v233
v_fma_f32 v233,2.0,v102,v238
M a[76:79],a[228:231],a[240:243],a[76:79]
v_fma_f32 v102,s40,v102,v238
v_accvgpr_read_b32 v238,a7
M a[76:79],a[200:203],v[228:231],a[76:79]
buffer_load_dwordx4 a[244:247],v250,s[20:23],s48 offen offset:0 sc1
M a[80:83],a[200:203],a[240:243],a[80:83]
v_accvgpr_read_b32 v237,a103
v_add_f32 v236,v238,v237
M a[80:83],a[228:231],v[224:227],a[80:83]
v_sub_f32 v238,v238,v237
v_add_f32 v237,v7,v103
M a[80:83],a[224:227],a[96:99],a[80:83]
v_sub_f32 v103,v7,v103
v_add_f32 v7,v236,v237
M a[84:87],a[224:227],a[208:211],a[84:87]
buffer_load_dwordx4 a[232:235],v250,s[20:23],s48 offen offset:1024 sc1
M a[84:87],a[228:231],a[96:99],a[84:87]
ds_read_b128 a[100:103],v248 offset:43520
v_fmac_f32 v236,4.0,v237
M a[84:87],a[200:203],v[224:227],a[84:87]
s_add_u32 s31,s66,7077888
ds_read_b128 v[228:231],v249 offset:43520
v_fma_f32 v237,2.0,v103,v238
M a[88:91],a[200:203],a[96:99],a[88:91]
ds_read_b128 a[96:99],v248 offset:44032
v_fma_f32 v103,s40,v103,v238
M a[88:91],a[228:231],a[208:211],a[88:91]
ds_read_b128 a[240:243],v249 offset:44032
v_cvt_pk_bf16_f32 v233,v233,v237
M a[88:91],a[224:227],v[220:223],a[88:91]
v_cvt_pk_bf16_f32 v235,v235,v236
M a[92:95],a[224:227],a[212:215],a[92:95]
buffer_load_dword v224,v255,s[8:11],s31 offen offset:0
M a[92:95],a[228:231],v[220:223],a[92:95]
ds_write2st64_b64 v254,v[232:233],v[234:235] offset0:76 offset1:80
M a[92:95],a[200:203],a[208:211],a[92:95]
s_waitcnt vmcnt(11) lgkmcnt(4)
v_accvgpr_read_b32 v238,a8
v_accvgpr_read_b32 v232,a104
M a[128:131],a[248:251],a[100:103],a[128:131]
s_waitcnt vmcnt(10) lgkmcnt(3)
ds_read_b128 a[212:215],v248 offset:44544
v_add_f32 v234,v238,v232
M a[128:131],a[192:195],v[228:231],a[128:131]
s_waitcnt vmcnt(9) lgkmcnt(3)
buffer_load_dword v224,v255,s[8:11],s31 offen offset:384
M a[128:131],v[216:219],a[96:99],a[128:131]
s_waitcnt lgkmcnt(2)
ds_read_b128 a[224:227],v249 offset:44544
v_sub_f32 v238,v238,v232
M a[132:135],v[216:219],a[240:243],a[132:135]
v_add_f32 v232,v8,v104
v_sub_f32 v104,v8,v104
M a[132:135],a[192:195],a[96:99],a[132:135]
v_add_f32 v8,v234,v232
v_fmac_f32 v234,4.0,v232
M a[132:135],a[248:251],v[228:231],a[132:135]
v_fma_f32 v232,2.0,v104,v238
v_fma_f32 v104,s40,v104,v238
M a[136:139],a[248:251],a[96:99],a[136:139]
s_waitcnt lgkmcnt(2)
s_barrier
ds_read_b128 a[0:3],v250 offset:34816
M a[136:139],a[192:195],a[240:243],a[136:139]
s_waitcnt lgkmcnt(2)
ds_read_b128 a[4:7],v250 offset:38912
ds_read_b128 a[228:231],v248 offset:45056
M a[136:139],v[216:219],a[212:215],a[136:139]
s_waitcnt lgkmcnt(3)
ds_read_b128 v[220:223],v249 offset:45056
v_accvgpr_read_b32 v238,a9
M a[140:143],v[216:219],a[224:227],a[140:143]
v_accvgpr_read_b32 v237,a105
v_add_f32 v236,v238,v237
M a[140:143],a[192:195],a[212:215],a[140:143]
v_sub_f32 v238,v238,v237
v_add_f32 v237,v9,v105
M a[140:143],a[248:251],a[240:243],a[140:143]
v_sub_f32 v105,v9,v105
v_add_f32 v9,v236,v237
M a[144:147],a[248:251],a[212:215],a[144:147]
ds_read_b128 a[200:203],v249 offset:45568
v_fmac_f32 v236,4.0,v237
M a[144:147],a[192:195],a[224:227],a[144:147]
s_waitcnt lgkmcnt(2)
ds_read_b128 a[208:211],v248 offset:45568
v_fma_f32 v237,2.0,v105,v238
M a[144:147],v[216:219],a[228:231],a[144:147]
s_waitcnt lgkmcnt(2)
buffer_load_dwordx4 v[224:227],v250,s[20:23],s48 offen offset:2048 sc1
M a[148:151],v[216:219],v[220:223],a[148:151]
v_fma_f32 v105,s40,v105,v238
v_cvt_pk_bf16_f32 v232,v232,v237
M a[148:151],a[192:195],a[228:231],a[148:151]
v_cvt_pk_bf16_f32 v234,v234,v236
v_accvgpr_read_b32 v238,a10
M a[148:151],a[248:251],a[224:227],a[148:151]
v_accvgpr_read_b32 v233,a106
v_add_f32 v235,v238,v233
M a[152:155],a[248:251],a[228:231],a[152:155]
v_sub_f32 v238,v238,v233
v_add_f32 v233,v10,v106
M a[152:155],a[192:195],v[220:223],a[152:155]
s_waitcnt lgkmcnt(1)
v_sub_f32 v106,v10,v106
v_add_f32 v10,v235,v233
M a[152:155],v[216:219],a[200:203],a[152:155]
s_waitcnt lgkmcnt(0)
v_fmac_f32 v235,4.0,v233
v_fma_f32 v233,2.0,v106,v238
M a[156:159],v[216:219],a[208:211],a[156:159]
global_load_dword v216,v250,s[64:65]
M a[156:159],a[192:195],a[200:203],a[156:159]
s_add_u32 s47,s77,39936
v_fma_f32 v106,s40,v106,v238
v_accvgpr_read_b32 v238,a11
M a[156:159],a[248:251],v[220:223],a[156:159]
s_waitcnt vmcnt(11)
v_accvgpr_read_b32 v237,a107
v_add_f32 v236,v238,v237
M a[160:163],a[204:207],a[100:103],a[160:163]
s_waitcnt vmcnt(10)
v_sub_f32 v238,v238,v237
v_add_f32 v237,v11,v107
M a[160:163],a[236:239],v[228:231],a[160:163]
s_waitcnt vmcnt(9)
v_sub_f32 v107,v11,v107
v_add_f32 v11,v236,v237
M a[160:163],a[252:255],a[96:99],a[160:163]
v_fmac_f32 v236,4.0,v237
v_fma_f32 v237,2.0,v107,v238
M a[164:167],a[252:255],a[240:243],a[164:167]
buffer_load_dwordx4 v[216:219],v250,s[20:23],s47 offen offset:0 sc1
M a[164:167],a[236:239],a[96:99],a[164:167]
v_fma_f32 v107,s40,v107,v238
v_cvt_pk_bf16_f32 v233,v233,v237
M a[164:167],a[204:207],v[228:231],a[164:167]
buffer_load_dwordx4 a[100:103],v250,s[20:23],s47 offen offset:1024 sc1
M a[168:171],a[204:207],a[96:99],a[168:171]
v_cvt_pk_bf16_f32 v235,v235,v236
M a[168:171],a[236:239],a[240:243],a[168:171]
ds_write2st64_b64 v254,v[232:233],v[234:235] offset0:85 offset1:89
M a[168:171],a[252:255],a[212:215],a[168:171]
v_accvgpr_read_b32 v204,a12
v_accvgpr_read_b32 v208,a108
M a[172:175],a[252:255],a[224:227],a[172:175]
buffer_load_dwordx4 a[104:107],v250,s[20:23],s47 offen offset:2048 sc1
M a[172:175],a[236:239],a[212:215],a[172:175]
s_add_u32 s48,s77,43008
v_accvgpr_read_b32 v205,a13
v_accvgpr_read_b32 v209,a109
M a[172:175],a[204:207],a[240:243],a[172:175]
v_accvgpr_read_b32 v206,a14
v_accvgpr_read_b32 v210,a110
v_accvgpr_read_b32 v207,a15
v_accvgpr_read_b32 v211,a111
v_pk_add_f32 v[212:213],v[204:205],v[208:209]
v_pk_add_f32 v[214:215],v[206:207],v[210:211]
v_pk_add_f32 v[204:205],v[204:205],v[208:209] neg_lo:[0,1] neg_hi:[0,1]
v_pk_add_f32 v[206:207],v[206:207],v[210:211] neg_lo:[0,1] neg_hi:[0,1]
v_pk_add_f32 v[208:209],v[12:13],v[108:109]
v_pk_add_f32 v[210:211],v[14:15],v[110:111]
v_pk_add_f32 v[108:109],v[12:13],v[108:109] neg_lo:[0,1] neg_hi:[0,1]
v_pk_add_f32 v[110:111],v[14:15],v[110:111] neg_lo:[0,1] neg_hi:[0,1]
v_pk_add_f32 v[12:13],v[212:213],v[208:209]
v_pk_add_f32 v[14:15],v[214:215],v[210:211]
v_pk_fma_f32 v[212:213],v[208:209],4.0,v[212:213] op_sel_hi:[1,0,1]
v_pk_fma_f32 v[214:215],v[210:211],4.0,v[214:215] op_sel_hi:[1,0,1]
v_pk_fma_f32 v[208:209],v[108:109],2.0,v[204:205] op_sel_hi:[1,0,1]
v_pk_fma_f32 v[210:211],v[110:111],2.0,v[206:207] op_sel_hi:[1,0,1]
v_pk_fma_f32 v[108:109],v[108:109],s[40:41],v[204:205] op_sel_hi:[1,0,1]
v_pk_fma_f32 v[110:111],v[110:111],s[40:41],v[206:207] op_sel_hi:[1,0,1]
M a[176:179],a[204:207],a[212:215],a[176:179]
buffer_load_dwordx4 a[192:195],v250,s[20:23],s48 offen offset:0 sc1
M a[176:179],a[236:239],a[224:227],a[176:179]
v_cvt_pk_bf16_f32 v208,v208,v209
v_cvt_pk_bf16_f32 v209,v210,v211
M a[176:179],a[252:255],a[228:231],a[176:179]
buffer_load_dwordx4 a[248:251],v250,s[20:23],s48 offen offset:1024 sc1
M a[180:183],a[252:255],v[220:223],a[180:183]
v_cvt_pk_bf16_f32 v212,v212,v213
v_cvt_pk_bf16_f32 v213,v214,v215
M a[180:183],a[236:239],a[228:231],a[180:183]
ds_read_b128 a[108:111],v248 offset:0
ds_write2st64_b64 v254,v[208:209],v[212:213] offset0:93 offset1:97
M a[180:183],a[204:207],a[224:227],a[180:183]
buffer_load_dwordx4 a[96:99],v250,s[20:23],s48 offen offset:2048 sc1
M a[184:187],a[204:207],a[228:231],a[184:187]
s_add_u32 s46,s72,0
ds_read_b128 a[240:243],v249 offset:0
ds_read_b128 a[212:215],v248 offset:512
M a[184:187],a[236:239],v[220:223],a[184:187]
ds_read_b128 a[224:227],v249 offset:512
v_accvgpr_read_b32 v238,a16
M a[184:187],a[252:255],a[200:203],a[184:187]
v_accvgpr_read_b32 v232,a112
v_add_f32 v234,v238,v232
M a[188:191],a[252:255],a[208:211],a[188:191]
buffer_load_dwordx4 v[228:231],v250,s[20:23],s46 offen offset:0 sc1
M a[188:191],a[236:239],a[200:203],a[188:191]
v_sub_f32 v238,v238,v232
v_add_f32 v232,v16,v112
M a[188:191],a[204:207],v[220:223],a[188:191]
s_waitcnt vmcnt(15) lgkmcnt(4)
v_sub_f32 v112,v16,v112
v_add_f32 v16,v234,v232
M v[32:35],a[220:223],a[108:111],v[32:35]
s_waitcnt vmcnt(14) lgkmcnt(2)
ds_read_b128 a[208:211],v248 offset:1024
v_fmac_f32 v234,4.0,v232
M v[32:35],a[196:199],a[240:243],v[32:35]
s_waitcnt vmcnt(13) lgkmcnt(2)
buffer_load_dwordx4 a[228:231],v250,s[20:23],s46 offen offset:1024 sc1
M v[32:35],a[216:219],a[212:215],v[32:35]
s_waitcnt lgkmcnt(1)
ds_read_b128 a[252:255],v249 offset:1024
v_fma_f32 v232,2.0,v112,v238
M v[36:39],a[216:219],a[224:227],v[36:39]
v_fma_f32 v112,s40,v112,v238
M v[36:39],a[196:199],a[212:215],v[36:39]
s_barrier
ds_read_b128 a[8:11],v250 offset:43520
M v[36:39],a[220:223],a[240:243],v[36:39]
ds_read_b128 a[12:15],v250 offset:47616
v_accvgpr_read_b32 v238,a17
M v[40:43],a[220:223],a[212:215],v[40:43]
ds_read_b128 a[200:203],v248 offset:1536
v_accvgpr_read_b32 v237,a113
M v[40:43],a[196:199],a[224:227],v[40:43]
s_waitcnt lgkmcnt(4)
ds_read_b128 a[236:239],v249 offset:1536
v_add_f32 v236,v238,v237
M v[40:43],a[216:219],a[208:211],v[40:43]
s_waitcnt lgkmcnt(4)
v_sub_f32 v238,v238,v237
v_add_f32 v237,v17,v113
M v[44:47],a[216:219],a[252:255],v[44:47]
v_sub_f32 v113,v17,v113
v_add_f32 v17,v236,v237
M v[44:47],a[196:199],a[208:211],v[44:47]
v_fmac_f32 v236,4.0,v237
v_fma_f32 v237,2.0,v113,v238
M v[44:47],a[220:223],a[224:227],v[44:47]
v_fma_f32 v113,s40,v113,v238
v_cvt_pk_bf16_f32 v232,v232,v237
M v[48:51],a[220:223],a[208:211],v[48:51]
ds_read_b128 a[204:207],v249 offset:2048
v_cvt_pk_bf16_f32 v234,v234,v236
M v[48:51],a[196:199],a[252:255],v[48:51]
s_waitcnt lgkmcnt(2)
ds_read_b128 v[220:223],v248 offset:2048
v_accvgpr_read_b32 v238,a18
M v[48:51],a[216:219],a[200:203],v[48:51]
s_waitcnt lgkmcnt(2)
v_accvgpr_read_b32 v233,a114
v_add_f32 v235,v238,v233
M v[52:55],a[216:219],a[236:239],v[52:55]
v_sub_f32 v238,v238,v233
v_add_f32 v233,v18,v114
M v[52:55],a[196:199],a[200:203],v[52:55]
v_sub_f32 v114,v18,v114
v_add_f32 v18,v235,v233
M v[52:55],a[220:223],a[252:255],v[52:55]
v_fmac_f32 v235,4.0,v233
v_fma_f32 v233,2.0,v114,v238
M v[56:59],a[220:223],a[200:203],v[56:59]
v_fma_f32 v114,s40,v114,v238
v_accvgpr_read_b32 v238,a19
M v[56:59],a[196:199],a[236:239],v[56:59]
s_waitcnt lgkmcnt(1)
v_accvgpr_read_b32 v237,a115
v_add_f32 v236,v238,v237
M v[56:59],a[216:219],a[204:207],v[56:59]
s_waitcnt lgkmcnt(0)
v_sub_f32 v238,v238,v237
v_add_f32 v237,v19,v115
M v[60:63],a[216:219],v[220:223],v[60:63]
buffer_load_dwordx4 a[112:115],v250,s[20:23],s46 offen offset:2048 sc1
M v[60:63],a[196:199],a[204:207],v[60:63]
s_add_u32 s46,s73,0
v_sub_f32 v115,v19,v115
v_add_f32 v19,v236,v237
M v[60:63],a[220:223],a[236:239],v[60:63]
s_waitcnt vmcnt(14)
buffer_load_dwordx4 a[216:219],v250,s[20:23],s46 offen offset:0 sc1
M v[64:67],a[244:247],a[108:111],v[64:67]
s_waitcnt vmcnt(14)
v_fmac_f32 v236,4.0,v237
v_fma_f32 v237,2.0,v115,v238
M v[64:67],a[232:235],a[240:243],v[64:67]
s_waitcnt vmcnt(11)
v_fma_f32 v115,s40,v115,v238
v_cvt_pk_bf16_f32 v233,v233,v237
M v[64:67],v[224:227],a[212:215],v[64:67]
v_cvt_pk_bf16_f32 v235,v235,v236
M v[68:71],v[224:227],a[224:227],v[68:71]
buffer_load_dwordx4 a[196:199],v250,s[20:23],s46 offen offset:1024 sc1
M v[68:71],a[232:235],a[212:215],v[68:71]
ds_write2st64_b64 v254,v[232:233],v[234:235] offset0:68 offset1:72
M v[68:71],a[244:247],a[240:243],v[68:71]
v_accvgpr_read_b32 v238,a20
v_accvgpr_read_b32 v232,a116
M v[72:75],a[244:247],a[212:215],v[72:75]
v_add_f32 v234,v238,v232
v_sub_f32 v238,v238,v232
M v[72:75],a[232:235],a[224:227],v[72:75]
buffer_load_dwordx4 a[108:111],v250,s[20:23],s46 offen offset:2048 sc1
M v[72:75],v[224:227],a[208:211],v[72:75]
s_add_u32 s31,s66,7471104
v_add_f32 v232,v20,v116
v_sub_f32 v116,v20,v116
M v[76:79],v[224:227],a[252:255],v[76:79]
v_add_f32 v20,v234,v232
v_fmac_f32 v234,4.0,v232
M v[76:79],a[232:235],a[208:211],v[76:79]
v_fma_f32 v232,2.0,v116,v238
v_fma_f32 v116,s40,v116,v238
M v[76:79],a[244:247],a[224:227],v[76:79]
buffer_load_dword a220,v255,s[8:11],s31 offen offset:0
M v[80:83],a[244:247],a[208:211],v[80:83]
v_accvgpr_read_b32 v238,a21
v_accvgpr_read_b32 v237,a117
M v[80:83],a[232:235],a[252:255],v[80:83]
v_add_f32 v236,v238,v237
v_sub_f32 v238,v238,v237
M v[80:83],v[224:227],a[200:203],v[80:83]
v_add_f32 v237,v21,v117
v_sub_f32 v117,v21,v117
M v[84:87],v[224:227],a[236:239],v[84:87]
buffer_load_dword a220,v255,s[8:11],s31 offen offset:384
M v[84:87],a[232:235],a[200:203],v[84:87]
ds_read_b128 a[240:243],v248 offset:8704
v_add_f32 v21,v236,v237
M v[84:87],a[244:247],a[252:255],v[84:87]
ds_read_b128 a[212:215],v249 offset:8704
v_fmac_f32 v236,4.0,v237
M v[88:91],a[244:247],a[200:203],v[88:91]
ds_read_b128 a[224:227],v248 offset:9216
v_fma_f32 v237,2.0,v117,v238
M v[88:91],a[232:235],a[236:239],v[88:91]
ds_read_b128 a[208:211],v249 offset:9216
v_fma_f32 v117,s40,v117,v238
M v[88:91],v[224:227],a[204:207],v[88:91]
v_cvt_pk_bf16_f32 v232,v232,v237
v_cvt_pk_bf16_f32 v234,v234,v236
M v[92:95],v[224:227],v[220:223],v[92:95]
v_accvgpr_read_b32 v238,a22
v_accvgpr_read_b32 v233,a118
M v[92:95],a[232:235],a[204:207],v[92:95]
v_add_f32 v235,v238,v233
v_sub_f32 v238,v238,v233
M v[92:95],a[244:247],a[236:239],v[92:95]
s_waitcnt vmcnt(13) lgkmcnt(3)
v_add_f32 v233,v22,v118
v_sub_f32 v118,v22,v118
M v[128:131],v[216:219],a[240:243],v[128:131]
s_waitcnt vmcnt(12) lgkmcnt(2)
ds_read_b128 a[252:255],v248 offset:9728
v_add_f32 v22,v235,v233
M v[128:131],a[100:103],a[212:215],v[128:131]
s_waitcnt vmcnt(11) lgkmcnt(2)
ds_read_b128 a[200:203],v249 offset:9728
v_fmac_f32 v235,4.0,v233
M v[128:131],a[104:107],a[224:227],v[128:131]
s_waitcnt lgkmcnt(2)
v_fma_f32 v233,2.0,v118,v238
v_fma_f32 v118,s40,v118,v238
M v[132:135],a[104:107],a[208:211],v[132:135]
v_accvgpr_read_b32 v238,a23
v_accvgpr_read_b32 v237,a119
M v[132:135],a[100:103],a[224:227],v[132:135]
v_add_f32 v236,v238,v237
v_sub_f32 v238,v238,v237
M v[132:135],v[216:219],a[212:215],v[132:135]
s_add_u32 s46,s74,0
v_add_f32 v237,v23,v119
v_sub_f32 v119,v23,v119
M v[136:139],v[216:219],a[224:227],v[136:139]
ds_read_b128 a[116:119],v248 offset:10240
v_add_f32 v23,v236,v237
M v[136:139],a[100:103],a[208:211],v[136:139]
s_waitcnt lgkmcnt(2)
ds_read_b128 v[220:223],v249 offset:10240
v_fmac_f32 v236,4.0,v237
M v[136:139],a[104:107],a[252:255],v[136:139]
s_waitcnt lgkmcnt(2)
v_fma_f32 v237,2.0,v119,v238
v_fma_f32 v119,s40,v119,v238
M v[140:143],a[104:107],a[200:203],v[140:143]
v_cvt_pk_bf16_f32 v233,v233,v237
v_cvt_pk_bf16_f32 v235,v235,v236
M v[140:143],a[100:103],a[252:255],v[140:143]
ds_write2st64_b64 v254,v[232:233],v[234:235] offset0:76 offset1:80
M v[140:143],v[216:219],a[208:211],v[140:143]
buffer_load_dwordx4 a[220:223],v250,s[20:23],s46 offen offset:0 sc1
M v[144:147],v[216:219],a[252:255],v[144:147]
ds_read_b128 a[232:235],v249 offset:10752
v_accvgpr_read_b32 v238,a24
M v[144:147],a[100:103],a[200:203],v[144:147]
s_waitcnt lgkmcnt(3)
buffer_load_dwordx4 v[224:227],v250,s[20:23],s46 offen offset:1024 sc1
M v[144:147],a[104:107],a[116:119],v[144:147]
s_waitcnt lgkmcnt(2)
ds_read_b128 a[236:239],v248 offset:10752
v_accvgpr_read_b32 v232,a120
M v[148:151],a[104:107],v[220:223],v[148:151]
v_add_f32 v234,v238,v232
v_sub_f32 v238,v238,v232
M v[148:151],a[100:103],a[116:119],v[148:151]
v_add_f32 v232,v24,v120
v_sub_f32 v120,v24,v120
M v[148:151],v[216:219],a[200:203],v[148:151]
buffer_load_dwordx4 a[204:207],v250,s[20:23],s46 offen offset:2048 sc1
M v[152:155],v[216:219],a[116:119],v[152:155]
s_add_u32 s46,s75,0
v_add_f32 v24,v234,v232
v_fmac_f32 v234,4.0,v232
M v[152:155],a[100:103],v[220:223],v[152:155]
s_waitcnt lgkmcnt(1)
v_fma_f32 v232,2.0,v120,v238
v_fma_f32 v120,s40,v120,v238
M v[152:155],a[104:107],a[232:235],v[152:155]
s_waitcnt lgkmcnt(0)
s_barrier
ds_read_b128 a[16:19],v250 offset:34816
M v[156:159],a[104:107],a[236:239],v[156:159]
ds_read_b128 a[20:23],v250 offset:38912
v_accvgpr_read_b32 v238,a25
M v[156:159],a[100:103],a[232:235],v[156:159]
buffer_load_dwordx4 a[244:247],v250,s[20:23],s46 offen offset:0 sc1
M v[156:159],v[216:219],v[220:223],v[156:159]
s_waitcnt vmcnt(14)
v_accvgpr_read_b32 v237,a121
v_add_f32 v236,v238,v237
M v[160:163],a[192:195],a[240:243],v[160:163]
s_waitcnt vmcnt(13)
v_sub_f32 v238,v238,v237
v_add_f32 v237,v25,v121
M v[160:163],a[248:251],a[212:215],v[160:163]
s_waitcnt vmcnt(12)
buffer_load_dwordx4 a[104:107],v250,s[20:23],s46 offen offset:1024 sc1
M v[160:163],a[96:99],a[224:227],v[160:163]
v_sub_f32 v121,v25,v121
v_add_f32 v25,v236,v237
M v[164:167],a[96:99],a[208:211],v[164:167]
v_fmac_f32 v236,4.0,v237
v_fma_f32 v237,2.0,v121,v238
M v[164:167],a[248:251],a[224:227],v[164:167]
v_fma_f32 v121,s40,v121,v238
v_cvt_pk_bf16_f32 v232,v232,v237
M v[164:167],a[192:195],a[212:215],v[164:167]
buffer_load_dwordx4 a[100:103],v250,s[20:23],s46 offen offset:2048 sc1
M v[168:171],a[192:195],a[224:227],v[168:171]
s_add_u32 s46,s76,0
v_cvt_pk_bf16_f32 v234,v234,v236
v_accvgpr_read_b32 v238,a26
M v[168:171],a[248:251],a[208:211],v[168:171]
v_accvgpr_read_b32 v233,a122
v_add_f32 v235,v238,v233
M v[168:171],a[96:99],a[252:255],v[168:171]
v_sub_f32 v238,v238,v233
v_add_f32 v233,v26,v122
M v[172:175],a[96:99],a[200:203],v[172:175]
buffer_load_dwordx4 v[216:219],v250,s[20:23],s46 offen offset:0 sc1
M v[172:175],a[248:251],a[252:255],v[172:175]
v_sub_f32 v122,v26,v122
v_add_f32 v26,v235,v233
M v[172:175],a[192:195],a[208:211],v[172:175]
v_fmac_f32 v235,4.0,v233
v_fma_f32 v233,2.0,v122,v238
M v[176:179],a[192:195],a[252:255],v[176:179]
v_fma_f32 v122,s40,v122,v238
v_accvgpr_read_b32 v238,a27
M v[176:179],a[248:251],a[200:203],v[176:179]
buffer_load_dwordx4 a[240:243],v250,s[20:23],s46 offen offset:1024 sc1
M v[176:179],a[96:99],a[116:119],v[176:179]
v_add_u32 v248,0xffffbc00,v248
v_add_u32 v249,0xffffbc00,v249
M v[180:183],a[96:99],v[220:223],v[180:183]
v_accvgpr_read_b32 v237,a123
v_add_f32 v236,v238,v237
M v[180:183],a[248:251],a[116:119],v[180:183]
ds_read_b128 a[208:211],v248 offset:0
v_sub_f32 v238,v238,v237
M v[180:183],a[192:195],a[200:203],v[180:183]
buffer_load_dwordx4 a[212:215],v250,s[20:23],s46 offen offset:2048 sc1
M v[184:187],a[192:195],a[116:119],v[184:187]
s_add_u32 s46,s77,0
ds_read_b128 a[120:123],v249 offset:0
ds_read_b128 a[116:119],v248 offset:512
M v[184:187],a[248:251],v[220:223],v[184:187]
ds_read_b128 a[252:255],v249 offset:512
v_add_f32 v237,v27,v123
M v[184:187],a[96:99],a[232:235],v[184:187]
v_sub_f32 v123,v27,v123
v_add_f32 v27,v236,v237
M v[188:191],a[96:99],a[236:239],v[188:191]
buffer_load_dwordx4 a[224:227],v250,s[20:23],s46 offen offset:0 sc1
M v[188:191],a[248:251],a[232:235],v[188:191]
v_fmac_f32 v236,4.0,v237
v_fma_f32 v237,2.0,v123,v238
M v[188:191],a[192:195],v[220:223],v[188:191]
s_waitcnt vmcnt(17) lgkmcnt(3)
v_fma_f32 v123,s40,v123,v238
v_cvt_pk_bf16_f32 v233,v233,v237
M v[0:3],v[228:231],a[208:211],v[0:3]
s_waitcnt vmcnt(16) lgkmcnt(2)
ds_read_b128 a[248:251],v248 offset:1024
v_cvt_pk_bf16_f32 v235,v235,v236
M v[0:3],a[228:231],a[120:123],v[0:3]
s_waitcnt vmcnt(15) lgkmcnt(2)
buffer_load_dwordx4 a[96:99],v250,s[20:23],s46 offen offset:1024 sc1
M v[0:3],a[112:115],a[116:119],v[0:3]
s_waitcnt lgkmcnt(1)
ds_read_b128 a[192:195],v249 offset:1024
ds_write2st64_b64 v254,v[232:233],v[234:235] offset0:85 offset1:89
M v[4:7],a[112:115],a[252:255],v[4:7]
v_accvgpr_read_b32 v204,a28
v_accvgpr_read_b32 v208,a124
M v[4:7],a[228:231],a[116:119],v[4:7]
buffer_load_dwordx4 a[200:203],v250,s[20:23],s46 offen offset:2048 sc1
M v[4:7],v[228:231],a[120:123],v[4:7]
s_add_u32 s46,s72,46080
v_accvgpr_read_b32 v205,a29
v_accvgpr_read_b32 v209,a125
M v[8:11],v[228:231],a[116:119],v[8:11]
ds_read_b128 a[116:119],v248 offset:1536
v_accvgpr_read_b32 v206,a30
M v[8:11],a[228:231],a[252:255],v[8:11]
s_waitcnt lgkmcnt(3)
ds_read_b128 a[120:123],v249 offset:1536
v_accvgpr_read_b32 v210,a126
v_accvgpr_read_b32 v207,a31
v_accvgpr_read_b32 v211,a127
v_pk_add_f32 v[212:213],v[204:205],v[208:209]
v_pk_add_f32 v[214:215],v[206:207],v[210:211]
v_pk_add_f32 v[204:205],v[204:205],v[208:209] neg_lo:[0,1] neg_hi:[0,1]
v_pk_add_f32 v[206:207],v[206:207],v[210:211] neg_lo:[0,1] neg_hi:[0,1]
v_pk_add_f32 v[208:209],v[28:29],v[124:125]
v_pk_add_f32 v[210:211],v[30:31],v[126:127]
v_pk_add_f32 v[124:125],v[28:29],v[124:125] neg_lo:[0,1] neg_hi:[0,1]
v_pk_add_f32 v[126:127],v[30:31],v[126:127] neg_lo:[0,1] neg_hi:[0,1]
v_pk_add_f32 v[28:29],v[212:213],v[208:209]
v_pk_add_f32 v[30:31],v[214:215],v[210:211]
v_pk_fma_f32 v[212:213],v[208:209],4.0,v[212:213] op_sel_hi:[1,0,1]
v_pk_fma_f32 v[214:215],v[210:211],4.0,v[214:215] op_sel_hi:[1,0,1]
v_pk_fma_f32 v[208:209],v[124:125],2.0,v[204:205] op_sel_hi:[1,0,1]
v_pk_fma_f32 v[210:211],v[126:127],2.0,v[206:207] op_sel_hi:[1,0,1]
v_pk_fma_f32 v[124:125],v[124:125],s[40:41],v[204:205] op_sel_hi:[1,0,1]
v_pk_fma_f32 v[126:127],v[126:127],s[40:41],v[206:207] op_sel_hi:[1,0,1]
M v[8:11],a[112:115],a[248:251],v[8:11]
s_waitcnt lgkmcnt(3)
buffer_load_dwordx4 a[236:239],v250,s[20:23],s46 offen offset:0 sc1
M v[12:15],a[112:115],a[192:195],v[12:15]
v_cvt_pk_bf16_f32 v208,v208,v209
v_cvt_pk_bf16_f32 v209,v210,v211
M v[12:15],a[228:231],a[248:251],v[12:15]
buffer_load_dwordx4 a[232:235],v250,s[20:23],s46 offen offset:1024 sc1
M v[12:15],v[228:231],a[252:255],v[12:15]
v_cvt_pk_bf16_f32 v212,v212,v213
v_cvt_pk_bf16_f32 v213,v214,v215
M v[16:19],v[228:231],a[248:251],v[16:19]
ds_read_b128 a[124:127],v249 offset:2048
ds_write2st64_b64 v254,v[208:209],v[212:213] offset0:93 offset1:97
M v[16:19],a[228:231],a[192:195],v[16:19]
s_waitcnt lgkmcnt(3)
ds_read_b128 v[220:223],v248 offset:2048
v_add_u32 v248,0x15400,v248
M v[16:19],a[112:115],a[116:119],v[16:19]
s_waitcnt lgkmcnt(3)
v_add_u32 v249,0x15400,v249
v_accvgpr_read_b32 v238,a32
M v[20:23],a[112:115],a[120:123],v[20:23]
v_accvgpr_read_b32 v232,a128
v_add_f32 v234,v238,v232
M v[20:23],a[228:231],a[116:119],v[20:23]
ds_read_b128 a[208:211],v248 offset:0
v_sub_f32 v238,v238,v232
M v[20:23],v[228:231],a[192:195],v[20:23]
ds_read_b128 a[252:255],v249 offset:0
v_add_f32 v232,v32,v128
M v[24:27],v[228:231],a[116:119],v[24:27]
ds_read_b128 a[116:119],v248 offset:512
v_sub_f32 v128,v32,v128
M v[24:27],a[228:231],a[120:123],v[24:27]
s_waitcnt lgkmcnt(5)
ds_read_b128 a[248:251],v249 offset:512
v_add_f32 v32,v234,v232
M v[24:27],a[112:115],a[124:127],v[24:27]
s_waitcnt lgkmcnt(4)
buffer_load_dwordx4 a[192:195],v250,s[20:23],s46 offen offset:2048 sc1
M v[28:31],a[112:115],v[220:223],v[28:31]
s_add_u32 s47,s72,49152
v_fmac_f32 v234,4.0,v232
v_fma_f32 v232,2.0,v128,v238
M v[28:31],a[228:231],a[124:127],v[28:31]
buffer_load_dwordx4 a[112:115],v250,s[20:23],s47 offen offset:0 sc1
M v[28:31],v[228:231],a[120:123],v[28:31]
s_waitcnt vmcnt(20) lgkmcnt(3)
v_fma_f32 v128,s40,v128,v238
M v[0:3],a[216:219],a[208:211],v[0:3]
s_waitcnt vmcnt(19) lgkmcnt(2)
s_barrier
ds_read_b128 a[24:27],v250 offset:43520
M v[0:3],a[196:199],a[252:255],v[0:3]
s_waitcnt vmcnt(18) lgkmcnt(2)
ds_read_b128 a[28:31],v250 offset:47616
ds_read_b128 a[120:123],v248 offset:1024
M v[0:3],a[108:111],a[116:119],v[0:3]
s_waitcnt lgkmcnt(3)
buffer_load_dwordx4 v[220:223],v250,s[20:23],s47 offen offset:1024 sc1
M v[4:7],a[108:111],a[248:251],v[4:7]
ds_read_b128 a[228:231],v249 offset:1024
v_accvgpr_read_b32 v238,a33
M v[4:7],a[196:199],a[116:119],v[4:7]
v_accvgpr_read_b32 v237,a129
v_add_f32 v236,v238,v237
M v[4:7],a[216:219],a[252:255],v[4:7]
v_sub_f32 v238,v238,v237
v_add_f32 v237,v33,v129
M v[8:11],a[216:219],a[116:119],v[8:11]
buffer_load_dwordx4 a[124:127],v250,s[20:23],s47 offen offset:2048 sc1
M v[8:11],a[196:199],a[248:251],v[8:11]
s_waitcnt lgkmcnt(1)
ds_read_b128 a[116:119],v248 offset:1536
ds_read_b128 v[228:231],v249 offset:1536
M v[8:11],a[108:111],a[120:123],v[8:11]
s_waitcnt lgkmcnt(2)
s_add_u32 s34,s32,0
v_sub_f32 v129,v33,v129
v_add_f32 v33,v236,v237
M v[12:15],a[108:111],a[228:231],v[12:15]
v_fmac_f32 v236,4.0,v237
v_fma_f32 v237,2.0,v129,v238
M v[12:15],a[196:199],a[120:123],v[12:15]
v_fma_f32 v129,s40,v129,v238
v_cvt_pk_bf16_f32 v232,v232,v237
M v[12:15],a[216:219],a[248:251],v[12:15]
buffer_store_dwordx4 a[0:3],v253,s[24:27],s34 offen offset:384 nt
M v[16:19],a[216:219],a[120:123],v[16:19]
ds_read_b128 a[120:123],v249 offset:2048
v_cvt_pk_bf16_f32 v234,v234,v236
M v[16:19],a[196:199],a[228:231],v[16:19]
s_waitcnt lgkmcnt(2)
ds_read_b128 a[208:211],v248 offset:2048
v_accvgpr_read_b32 v238,a34
M v[16:19],a[108:111],a[116:119],v[16:19]
s_waitcnt lgkmcnt(2)
v_accvgpr_read_b32 v233,a130
v_add_f32 v235,v238,v233
M v[20:23],a[108:111],v[228:231],v[20:23]
s_add_u32 s46,s73,46080
v_sub_f32 v238,v238,v233
v_add_f32 v233,v34,v130
M v[20:23],a[196:199],a[116:119],v[20:23]
ds_read_b128 a[252:255],v248 offset:17408
v_sub_f32 v130,v34,v130
M v[20:23],a[216:219],a[228:231],v[20:23]
ds_read_b128 a[248:251],v249 offset:17408
v_add_f32 v34,v235,v233
M v[24:27],a[216:219],a[116:119],v[24:27]
ds_read_b128 a[116:119],v248 offset:17920
v_fmac_f32 v235,4.0,v233
M v[24:27],a[196:199],v[228:231],v[24:27]
s_waitcnt lgkmcnt(4)
ds_read_b128 a[228:231],v249 offset:17920
v_fma_f32 v233,2.0,v130,v238
M v[24:27],a[108:111],a[120:123],v[24:27]
s_waitcnt lgkmcnt(4)
v_fma_f32 v130,s40,v130,v238
v_accvgpr_read_b32 v238,a35
M v[28:31],a[108:111],a[208:211],v[28:31]
buffer_load_dwordx4 a[108:111],v250,s[20:23],s46 offen offset:0 sc1
M v[28:31],a[196:199],a[120:123],v[28:31]
v_accvgpr_read_b32 v237,a131
v_add_f32 v236,v238,v237
M v[28:31],a[216:219],v[228:231],v[28:31]
s_waitcnt vmcnt(19) lgkmcnt(3)
buffer_load_dwordx4 a[208:211],v250,s[20:23],s46 offen offset:1024 sc1
M v[0:3],a[220:223],a[252:255],v[0:3]
s_waitcnt vmcnt(19) lgkmcnt(2)
ds_read_b128 a[128:131],v248 offset:18432
v_sub_f32 v238,v238,v237
M v[0:3],v[224:227],a[248:251],v[0:3]
s_waitcnt vmcnt(18) lgkmcnt(2)
ds_read_b128 a[196:199],v249 offset:18432
v_add_f32 v237,v35,v131
M v[0:3],a[204:207],a[116:119],v[0:3]
s_waitcnt lgkmcnt(2)
s_add_u32 s34,s32,196608
v_sub_f32 v131,v35,v131
v_add_f32 v35,v236,v237
M v[4:7],a[204:207],a[228:231],v[4:7]
buffer_load_dwordx4 a[120:123],v250,s[20:23],s46 offen offset:2048 sc1
M v[4:7],v[224:227],a[116:119],v[4:7]
v_fmac_f32 v236,4.0,v237
v_fma_f32 v237,2.0,v131,v238
M v[4:7],a[220:223],a[248:251],v[4:7]
v_fma_f32 v131,s40,v131,v238
v_cvt_pk_bf16_f32 v233,v233,v237
M v[8:11],a[220:223],a[116:119],v[8:11]
ds_read_b128 a[116:119],v248 offset:18944
v_cvt_pk_bf16_f32 v235,v235,v236
M v[8:11],v[224:227],a[228:231],v[8:11]
s_waitcnt lgkmcnt(2)
ds_read_b128 a[216:219],v249 offset:18944
ds_write2st64_b64 v254,v[232:233],v[234:235] offset0:34 offset1:38
M v[8:11],a[204:207],a[128:131],v[8:11]
s_waitcnt lgkmcnt(3)
buffer_store_dwordx4 a[4:7],v253,s[24:27],s34 offen offset:384 nt
M v[12:15],a[204:207],a[196:199],v[12:15]
v_accvgpr_read_b32 v204,a36
v_accvgpr_read_b32 v208,a132
M v[12:15],v[224:227],a[128:131],v[12:15]
v_accvgpr_read_b32 v205,a37
v_accvgpr_read_b32 v209,a133
M v[12:15],a[220:223],a[228:231],v[12:15]
v_accvgpr_read_b32 v206,a38
v_accvgpr_read_b32 v210,a134
v_accvgpr_read_b32 v207,a39
v_accvgpr_read_b32 v211,a135
v_pk_add_f32 v[212:213],v[204:205],v[208:209]
v_pk_add_f32 v[214:215],v[206:207],v[210:211]
v_pk_add_f32 v[204:205],v[204:205],v[208:209] neg_lo:[0,1] neg_hi:[0,1]
v_pk_add_f32 v[206:207],v[206:207],v[210:211] neg_lo:[0,1] neg_hi:[0,1]
v_pk_add_f32 v[208:209],v[36:37],v[132:133]
v_pk_add_f32 v[210:211],v[38:39],v[134:135]
v_pk_add_f32 v[132:133],v[36:37],v[132:133] neg_lo:[0,1] neg_hi:[0,1]
v_pk_add_f32 v[134:135],v[38:39],v[134:135] neg_lo:[0,1] neg_hi:[0,1]
v_pk_add_f32 v[36:37],v[212:213],v[208:209]
v_pk_add_f32 v[38:39],v[214:215],v[210:211]
v_pk_fma_f32 v[212:213],v[208:209],4.0,v[212:213] op_sel_hi:[1,0,1]
v_pk_fma_f32 v[214:215],v[210:211],4.0,v[214:215] op_sel_hi:[1,0,1]
v_pk_fma_f32 v[208:209],v[132:133],2.0,v[204:205] op_sel_hi:[1,0,1]
v_pk_fma_f32 v[210:211],v[134:135],2.0,v[206:207] op_sel_hi:[1,0,1]
v_pk_fma_f32 v[132:133],v[132:133],s[40:41],v[204:205] op_sel_hi:[1,0,1]
v_pk_fma_f32 v[134:135],v[134:135],s[40:41],v[206:207] op_sel_hi:[1,0,1]
M v[16:19],a[220:223],a[128:131],v[16:19]
s_add_u32 s47,s73,49152
ds_read_b128 a[128:131],v249 offset:19456
v_cvt_pk_bf16_f32 v208,v208,v209
M v[16:19],v[224:227],a[196:199],v[16:19]
s_waitcnt lgkmcnt(3)
ds_read_b128 v[228:231],v248 offset:19456
v_cvt_pk_bf16_f32 v209,v210,v211
M v[16:19],a[204:207],a[116:119],v[16:19]
s_waitcnt lgkmcnt(3)
v_cvt_pk_bf16_f32 v212,v212,v213
v_cvt_pk_bf16_f32 v213,v214,v215
M v[20:23],a[204:207],a[216:219],v[20:23]
ds_write2st64_b64 v254,v[208:209],v[212:213] offset0:42 offset1:46
M v[20:23],v[224:227],a[116:119],v[20:23]
ds_read_b128 a[132:135],v248 offset:34816
v_accvgpr_read_b32 v204,a40
M v[20:23],a[220:223],a[196:199],v[20:23]
ds_read_b128 a[252:255],v249 offset:34816
v_accvgpr_read_b32 v208,a136
M v[24:27],a[220:223],a[116:119],v[24:27]
buffer_load_dwordx4 a[116:119],v250,s[20:23],s47 offen offset:0 sc1
M v[24:27],v[224:227],a[216:219],v[24:27]
s_waitcnt lgkmcnt(4)
ds_read_b128 a[248:251],v248 offset:35328
ds_read_b128 a[228:231],v249 offset:35328
M v[24:27],a[204:207],a[128:131],v[24:27]
s_waitcnt lgkmcnt(5)
s_add_u32 s34,s32,393216
buffer_store_dwordx4 a[8:11],v253,s[24:27],s34 offen offset:384 nt
M v[28:31],a[204:207],v[228:231],v[28:31]
v_accvgpr_read_b32 v205,a41
v_accvgpr_read_b32 v209,a137
M v[28:31],v[224:227],a[128:131],v[28:31]
v_accvgpr_read_b32 v206,a42
v_accvgpr_read_b32 v210,a138
v_accvgpr_read_b32 v207,a43
v_accvgpr_read_b32 v211,a139
v_pk_add_f32 v[212:213],v[204:205],v[208:209]
v_pk_add_f32 v[214:215],v[206:207],v[210:211]
v_pk_add_f32 v[204:205],v[204:205],v[208:209] neg_lo:[0,1] neg_hi:[0,1]
v_pk_add_f32 v[206:207],v[206:207],v[210:211] neg_lo:[0,1] neg_hi:[0,1]
v_pk_add_f32 v[208:209],v[40:41],v[136:137]
v_pk_add_f32 v[210:211],v[42:43],v[138:139]
v_pk_add_f32 v[136:137],v[40:41],v[136:137] neg_lo:[0,1] neg_hi:[0,1]
v_pk_add_f32 v[138:139],v[42:43],v[138:139] neg_lo:[0,1] neg_hi:[0,1]
v_pk_add_f32 v[40:41],v[212:213],v[208:209]
v_pk_add_f32 v[42:43],v[214:215],v[210:211]
v_pk_fma_f32 v[212:213],v[208:209],4.0,v[212:213] op_sel_hi:[1,0,1]
v_pk_fma_f32 v[214:215],v[210:211],4.0,v[214:215] op_sel_hi:[1,0,1]
v_pk_fma_f32 v[208:209],v[136:137],2.0,v[204:205] op_sel_hi:[1,0,1]
v_pk_fma_f32 v[210:211],v[138:139],2.0,v[206:207] op_sel_hi:[1,0,1]
v_pk_fma_f32 v[136:137],v[136:137],s[40:41],v[204:205] op_sel_hi:[1,0,1]
v_pk_fma_f32 v[138:139],v[138:139],s[40:41],v[206:207] op_sel_hi:[1,0,1]
M v[28:31],a[220:223],a[216:219],v[28:31]
s_waitcnt vmcnt(21) lgkmcnt(3)
buffer_load_dwordx4 a[196:199],v250,s[20:23],s47 offen offset:1024 sc1
M v[0:3],a[244:247],a[132:135],v[0:3]
s_waitcnt vmcnt(21) lgkmcnt(2)
ds_read_b128 a[128:131],v248 offset:35840
v_cvt_pk_bf16_f32 v208,v208,v209
M v[0:3],a[104:107],a[252:255],v[0:3]
s_waitcnt vmcnt(20) lgkmcnt(2)
buffer_load_dwordx4 a[204:207],v250,s[20:23],s47 offen offset:2048 sc1
M v[0:3],a[100:103],a[248:251],v[0:3]
s_waitcnt lgkmcnt(1)
ds_read_b128 a[132:135],v249 offset:35840
v_cvt_pk_bf16_f32 v209,v210,v211
M v[4:7],a[100:103],a[228:231],v[4:7]
v_cvt_pk_bf16_f32 v212,v212,v213
v_cvt_pk_bf16_f32 v213,v214,v215
M v[4:7],a[104:107],a[248:251],v[4:7]
ds_write2st64_b64 v254,v[208:209],v[212:213] offset0:51 offset1:55
M v[4:7],a[244:247],a[252:255],v[4:7]
v_accvgpr_read_b32 v204,a44
v_accvgpr_read_b32 v208,a140
M v[8:11],a[244:247],a[248:251],v[8:11]
ds_read_b128 a[136:139],v248 offset:36352
v_accvgpr_read_b32 v205,a45
M v[8:11],a[104:107],a[228:231],v[8:11]
s_waitcnt lgkmcnt(3)
ds_read_b128 v[228:231],v249 offset:36352
v_accvgpr_read_b32 v209,a141
M v[8:11],a[100:103],a[128:131],v[8:11]
s_waitcnt lgkmcnt(3)
v_accvgpr_read_b32 v206,a46
v_accvgpr_read_b32 v210,a142
v_accvgpr_read_b32 v207,a47
v_accvgpr_read_b32 v211,a143
v_pk_add_f32 v[212:213],v[204:205],v[208:209]
v_pk_add_f32 v[214:215],v[206:207],v[210:211]
v_pk_add_f32 v[204:205],v[204:205],v[208:209] neg_lo:[0,1] neg_hi:[0,1]
v_pk_add_f32 v[206:207],v[206:207],v[210:211] neg_lo:[0,1] neg_hi:[0,1]
v_pk_add_f32 v[208:209],v[44:45],v[140:141]
v_pk_add_f32 v[210:211],v[46:47],v[142:143]
v_pk_add_f32 v[140:141],v[44:45],v[140:141] neg_lo:[0,1] neg_hi:[0,1]
v_pk_add_f32 v[142:143],v[46:47],v[142:143] neg_lo:[0,1] neg_hi:[0,1]
v_pk_add_f32 v[44:45],v[212:213],v[208:209]
v_pk_add_f32 v[46:47],v[214:215],v[210:211]
v_pk_fma_f32 v[212:213],v[208:209],4.0,v[212:213] op_sel_hi:[1,0,1]
v_pk_fma_f32 v[214:215],v[210:211],4.0,v[214:215] op_sel_hi:[1,0,1]
v_pk_fma_f32 v[208:209],v[140:141],2.0,v[204:205] op_sel_hi:[1,0,1]
v_pk_fma_f32 v[210:211],v[142:143],2.0,v[206:207] op_sel_hi:[1,0,1]
v_pk_fma_f32 v[140:141],v[140:141],s[40:41],v[204:205] op_sel_hi:[1,0,1]
v_pk_fma_f32 v[142:143],v[142:143],s[40:41],v[206:207] op_sel_hi:[1,0,1]
M v[12:15],a[100:103],a[132:135],v[12:15]
v_cvt_pk_bf16_f32 v208,v208,v209
v_cvt_pk_bf16_f32 v209,v210,v211
M v[12:15],a[104:107],a[128:131],v[12:15]
v_cvt_pk_bf16_f32 v212,v212,v213
v_cvt_pk_bf16_f32 v213,v214,v215
M v[12:15],a[244:247],a[228:231],v[12:15]
ds_write2st64_b64 v254,v[208:209],v[212:213] offset0:59 offset1:63
M v[16:19],a[244:247],a[128:131],v[16:19]
s_add_u32 s46,s74,46080
ds_read_b128 a[128:131],v249 offset:36864
v_accvgpr_read_b32 v238,a48
M v[16:19],a[104:107],a[132:135],v[16:19]
s_waitcnt lgkmcnt(3)
ds_read_b128 v[224:227],v248 offset:36864
v_accvgpr_read_b32 v232,a144
M v[16:19],a[100:103],a[136:139],v[16:19]
s_waitcnt lgkmcnt(3)
s_add_u32 s34,s32,589824
buffer_store_dwordx4 a[12:15],v253,s[24:27],s34 offen offset:384 nt
M v[20:23],a[100:103],v[228:231],v[20:23]
v_add_f32 v234,v238,v232
v_sub_f32 v238,v238,v232
M v[20:23],a[104:107],a[136:139],v[20:23]
ds_read_b128 a[140:143],v248 offset:52224
v_add_f32 v232,v48,v144
M v[20:23],a[244:247],a[132:135],v[20:23]
ds_read_b128 a[132:135],v249 offset:52224
v_sub_f32 v144,v48,v144
M v[24:27],a[244:247],a[136:139],v[24:27]
buffer_load_dwordx4 a[136:139],v250,s[20:23],s46 offen offset:0 sc1
M v[24:27],a[104:107],v[228:231],v[24:27]
s_waitcnt lgkmcnt(3)
ds_read_b128 a[216:219],v248 offset:52736
ds_read_b128 a[252:255],v249 offset:52736
M v[24:27],a[100:103],a[128:131],v[24:27]
s_waitcnt lgkmcnt(4)
buffer_load_dwordx4 a[220:223],v250,s[20:23],s46 offen offset:1024 sc1
M v[28:31],a[100:103],v[224:227],v[28:31]
v_add_f32 v48,v234,v232
v_fmac_f32 v234,4.0,v232
M v[28:31],a[104:107],a[128:131],v[28:31]
v_fma_f32 v232,2.0,v144,v238
v_fma_f32 v144,s40,v144,v238
M v[28:31],a[244:247],v[228:231],v[28:31]
s_waitcnt vmcnt(23) lgkmcnt(3)
v_accvgpr_read_b32 v238,a49
v_accvgpr_read_b32 v237,a145
M v[0:3],v[216:219],a[140:143],v[0:3]
s_waitcnt vmcnt(22) lgkmcnt(2)
buffer_load_dwordx4 a[248:251],v250,s[20:23],s46 offen offset:2048 sc1
M v[0:3],a[240:243],a[132:135],v[0:3]
s_waitcnt vmcnt(22) lgkmcnt(1)
ds_read_b128 a[100:103],v248 offset:53248
ds_read_b128 a[104:107],v249 offset:53248
M v[0:3],a[212:215],a[216:219],v[0:3]
s_waitcnt lgkmcnt(2)
v_add_f32 v236,v238,v237
v_sub_f32 v238,v238,v237
M v[4:7],a[212:215],a[252:255],v[4:7]
v_add_f32 v237,v49,v145
v_sub_f32 v145,v49,v145
M v[4:7],a[240:243],a[216:219],v[4:7]
v_add_f32 v49,v236,v237
v_fmac_f32 v236,4.0,v237
M v[4:7],v[216:219],a[132:135],v[4:7]
v_fma_f32 v237,2.0,v145,v238
v_fma_f32 v145,s40,v145,v238
M v[8:11],v[216:219],a[216:219],v[8:11]
ds_read_b128 a[128:131],v248 offset:53760
v_cvt_pk_bf16_f32 v232,v232,v237
M v[8:11],a[240:243],a[252:255],v[8:11]
s_waitcnt lgkmcnt(2)
ds_read_b128 a[132:135],v249 offset:53760
v_cvt_pk_bf16_f32 v234,v234,v236
M v[8:11],a[212:215],a[100:103],v[8:11]
s_waitcnt lgkmcnt(2)
s_add_u32 s34,s32,786432
buffer_store_dwordx4 a[16:19],v253,s[24:27],s34 offen offset:384 nt
M v[12:15],a[212:215],a[104:107],v[12:15]
v_accvgpr_read_b32 v238,a50
v_accvgpr_read_b32 v233,a146
M v[12:15],a[240:243],a[100:103],v[12:15]
v_add_f32 v235,v238,v233
v_sub_f32 v238,v238,v233
M v[12:15],v[216:219],a[252:255],v[12:15]
v_add_f32 v233,v50,v146
v_sub_f32 v146,v50,v146
M v[16:19],v[216:219],a[100:103],v[16:19]
s_add_u32 s47,s74,49152
ds_read_b128 a[100:103],v249 offset:54272
v_add_f32 v50,v235,v233
M v[16:19],a[240:243],a[104:107],v[16:19]
s_waitcnt lgkmcnt(2)
ds_read_b128 a[140:143],v248 offset:54272
v_add_u32 v248,0xfffece00,v248
M v[16:19],a[212:215],a[128:131],v[16:19]
s_waitcnt lgkmcnt(2)
v_add_u32 v249,0xfffece00,v249
v_fmac_f32 v235,4.0,v233
M v[20:23],a[212:215],a[132:135],v[20:23]
v_fma_f32 v233,2.0,v146,v238
v_fma_f32 v146,s40,v146,v238
M v[20:23],a[240:243],a[128:131],v[20:23]
ds_read_b128 a[228:231],v248 offset:60928
v_accvgpr_read_b32 v238,a51
M v[20:23],v[216:219],a[104:107],v[20:23]
ds_read_b128 a[104:107],v249 offset:60928
v_accvgpr_read_b32 v237,a147
M v[24:27],v[216:219],a[128:131],v[24:27]
buffer_load_dwordx4 a[128:131],v250,s[20:23],s47 offen offset:0 sc1
M v[24:27],a[240:243],a[132:135],v[24:27]
s_waitcnt lgkmcnt(3)
ds_read_b128 v[224:227],v248 offset:61440
ds_read_b128 v[228:231],v249 offset:61440
M v[24:27],a[212:215],a[100:103],v[24:27]
s_waitcnt lgkmcnt(4)
buffer_load_dwordx4 a[244:247],v250,s[20:23],s47 offen offset:1024 sc1
M v[28:31],a[212:215],a[140:143],v[28:31]
v_add_f32 v236,v238,v237
v_sub_f32 v238,v238,v237
M v[28:31],a[240:243],a[100:103],v[28:31]
v_add_f32 v237,v51,v147
v_sub_f32 v147,v51,v147
M v[28:31],v[216:219],a[132:135],v[28:31]
s_waitcnt vmcnt(24) lgkmcnt(3)
v_add_f32 v51,v236,v237
v_fmac_f32 v236,4.0,v237
M v[0:3],a[224:227],a[228:231],v[0:3]
s_waitcnt vmcnt(23) lgkmcnt(2)
buffer_load_dwordx4 a[216:219],v250,s[20:23],s47 offen offset:2048 sc1
M v[0:3],a[96:99],a[104:107],v[0:3]
s_waitcnt vmcnt(23) lgkmcnt(1)
ds_read_b128 a[100:103],v248 offset:61952
ds_read_b128 a[132:135],v249 offset:61952
M v[0:3],a[200:203],v[224:227],v[0:3]
s_waitcnt lgkmcnt(2)
s_add_u32 s34,s32,983040
v_fma_f32 v237,2.0,v147,v238
v_fma_f32 v147,s40,v147,v238
M v[4:7],a[200:203],v[228:231],v[4:7]
v_cvt_pk_bf16_f32 v233,v233,v237
v_cvt_pk_bf16_f32 v235,v235,v236
M v[4:7],a[96:99],v[224:227],v[4:7]
ds_write2st64_b64 v254,v[232:233],v[234:235] offset0:102 offset1:106
M v[4:7],a[224:227],a[104:107],v[4:7]
buffer_store_dwordx4 a[20:23],v253,s[24:27],s34 offen offset:384 nt
M v[8:11],a[224:227],v[224:227],v[8:11]
ds_read_b128 a[104:107],v248 offset:62464
v_accvgpr_read_b32 v204,a52
M v[8:11],a[96:99],v[228:231],v[8:11]
s_waitcnt lgkmcnt(3)
ds_read_b128 a[140:143],v249 offset:62464
v_accvgpr_read_b32 v208,a148
M v[8:11],a[200:203],a[100:103],v[8:11]
s_waitcnt lgkmcnt(3)
v_accvgpr_read_b32 v205,a53
v_accvgpr_read_b32 v209,a149
M v[12:15],a[200:203],a[132:135],v[12:15]
v_accvgpr_read_b32 v206,a54
v_accvgpr_read_b32 v210,a150
v_accvgpr_read_b32 v207,a55
v_accvgpr_read_b32 v211,a151
v_pk_add_f32 v[212:213],v[204:205],v[208:209]
v_pk_add_f32 v[214:215],v[206:207],v[210:211]
v_pk_add_f32 v[204:205],v[204:205],v[208:209] neg_lo:[0,1] neg_hi:[0,1]
v_pk_add_f32 v[206:207],v[206:207],v[210:211] neg_lo:[0,1] neg_hi:[0,1]
v_pk_add_f32 v[208:209],v[52:53],v[148:149]
v_pk_add_f32 v[210:211],v[54:55],v[150:151]
v_pk_add_f32 v[148:149],v[52:53],v[148:149] neg_lo:[0,1] neg_hi:[0,1]
v_pk_add_f32 v[150:151],v[54:55],v[150:151] neg_lo:[0,1] neg_hi:[0,1]
v_pk_add_f32 v[52:53],v[212:213],v[208:209]
v_pk_add_f32 v[54:55],v[214:215],v[210:211]
v_pk_fma_f32 v[212:213],v[208:209],4.0,v[212:213] op_sel_hi:[1,0,1]
v_pk_fma_f32 v[214:215],v[210:211],4.0,v[214:215] op_sel_hi:[1,0,1]
v_pk_fma_f32 v[208:209],v[148:149],2.0,v[204:205] op_sel_hi:[1,0,1]
v_pk_fma_f32 v[210:211],v[150:151],2.0,v[206:207] op_sel_hi:[1,0,1]
v_pk_fma_f32 v[148:149],v[148:149],s[40:41],v[204:205] op_sel_hi:[1,0,1]
v_pk_fma_f32 v[150:151],v[150:151],s[40:41],v[206:207] op_sel_hi:[1,0,1]
M v[12:15],a[96:99],a[100:103],v[12:15]
v_cvt_pk_bf16_f32 v208,v208,v209
v_cvt_pk_bf16_f32 v209,v210,v211
M v[12:15],a[224:227],v[228:231],v[12:15]
v_cvt_pk_bf16_f32 v212,v212,v213
v_cvt_pk_bf16_f32 v213,v214,v215
M v[16:19],a[224:227],a[100:103],v[16:19]
s_add_u32 s46,s75,46080
ds_read_b128 a[100:103],v249 offset:62976
ds_write2st64_b64 v254,v[208:209],v[212:213] offset0:110 offset1:114
M v[16:19],a[96:99],a[132:135],v[16:19]
s_waitcnt lgkmcnt(3)
ds_read_b128 a[144:147],v248 offset:62976
v_accvgpr_read_b32 v204,a56
M v[16:19],a[200:203],a[104:107],v[16:19]
s_waitcnt lgkmcnt(3)
v_accvgpr_read_b32 v208,a152
v_accvgpr_read_b32 v205,a57
M v[20:23],a[200:203],a[140:143],v[20:23]
v_accvgpr_read_b32 v209,a153
v_accvgpr_read_b32 v206,a58
M v[20:23],a[96:99],a[104:107],v[20:23]
ds_read_b128 a[148:151],v248 offset:0
v_accvgpr_read_b32 v210,a154
v_accvgpr_read_b32 v207,a59
v_accvgpr_read_b32 v211,a155
v_pk_add_f32 v[212:213],v[204:205],v[208:209]
v_pk_add_f32 v[214:215],v[206:207],v[210:211]
v_pk_add_f32 v[204:205],v[204:205],v[208:209] neg_lo:[0,1] neg_hi:[0,1]
v_pk_add_f32 v[206:207],v[206:207],v[210:211] neg_lo:[0,1] neg_hi:[0,1]
v_pk_add_f32 v[208:209],v[56:57],v[152:153]
v_pk_add_f32 v[210:211],v[58:59],v[154:155]
v_pk_add_f32 v[152:153],v[56:57],v[152:153] neg_lo:[0,1] neg_hi:[0,1]
v_pk_add_f32 v[154:155],v[58:59],v[154:155] neg_lo:[0,1] neg_hi:[0,1]
v_pk_add_f32 v[56:57],v[212:213],v[208:209]
v_pk_add_f32 v[58:59],v[214:215],v[210:211]
v_pk_fma_f32 v[212:213],v[208:209],4.0,v[212:213] op_sel_hi:[1,0,1]
v_pk_fma_f32 v[214:215],v[210:211],4.0,v[214:215] op_sel_hi:[1,0,1]
v_pk_fma_f32 v[208:209],v[152:153],2.0,v[204:205] op_sel_hi:[1,0,1]
v_pk_fma_f32 v[210:211],v[154:155],2.0,v[206:207] op_sel_hi:[1,0,1]
v_pk_fma_f32 v[152:153],v[152:153],s[40:41],v[204:205] op_sel_hi:[1,0,1]
v_pk_fma_f32 v[154:155],v[154:155],s[40:41],v[206:207] op_sel_hi:[1,0,1]
M v[20:23],a[224:227],a[132:135],v[20:23]
ds_read_b128 a[132:135],v249 offset:0
v_cvt_pk_bf16_f32 v208,v208,v209
M v[24:27],a[224:227],a[104:107],v[24:27]
buffer_load_dwordx4 a[104:107],v250,s[20:23],s46 offen offset:0 sc1
M v[24:27],a[96:99],a[140:143],v[24:27]
s_waitcnt lgkmcnt(4)
ds_read_b128 a[252:255],v248 offset:512
ds_read_b128 a[240:243],v249 offset:512
M v[24:27],a[200:203],a[100:103],v[24:27]
s_waitcnt lgkmcnt(4)
s_add_u32 s34,s32,1179648
buffer_load_dwordx4 a[212:215],v250,s[20:23],s46 offen offset:1024 sc1
M v[28:31],a[200:203],a[144:147],v[28:31]
v_cvt_pk_bf16_f32 v209,v210,v211
v_cvt_pk_bf16_f32 v212,v212,v213
M v[28:31],a[96:99],a[100:103],v[28:31]
v_cvt_pk_bf16_f32 v213,v214,v215
M v[28:31],a[224:227],a[140:143],v[28:31]
s_waitcnt vmcnt(25) lgkmcnt(3)
ds_write2st64_b64 v254,v[208:209],v[212:213] offset0:119 offset1:123
M v[96:99],a[236:239],a[148:151],v[96:99]
s_waitcnt vmcnt(24) lgkmcnt(3)
buffer_load_dwordx4 v[216:219],v250,s[20:23],s46 offen offset:2048 sc1
M v[96:99],a[232:235],a[132:135],v[96:99]
s_waitcnt vmcnt(24) lgkmcnt(2)
ds_read_b128 a[96:99],v248 offset:1024
ds_read_b128 a[100:103],v249 offset:1024
M v[96:99],a[192:195],a[252:255],v[96:99]
s_waitcnt lgkmcnt(3)
v_accvgpr_read_b32 v204,a60
v_accvgpr_read_b32 v208,a156
M v[100:103],a[192:195],a[240:243],v[100:103]
v_accvgpr_read_b32 v205,a61
v_accvgpr_read_b32 v209,a157
M v[100:103],a[232:235],a[252:255],v[100:103]
v_accvgpr_read_b32 v206,a62
v_accvgpr_read_b32 v210,a158
v_accvgpr_read_b32 v207,a63
v_accvgpr_read_b32 v211,a159
v_pk_add_f32 v[212:213],v[204:205],v[208:209]
v_pk_add_f32 v[214:215],v[206:207],v[210:211]
v_pk_add_f32 v[204:205],v[204:205],v[208:209] neg_lo:[0,1] neg_hi:[0,1]
v_pk_add_f32 v[206:207],v[206:207],v[210:211] neg_lo:[0,1] neg_hi:[0,1]
v_pk_add_f32 v[208:209],v[60:61],v[156:157]
v_pk_add_f32 v[210:211],v[62:63],v[158:159]
v_pk_add_f32 v[156:157],v[60:61],v[156:157] neg_lo:[0,1] neg_hi:[0,1]
v_pk_add_f32 v[158:159],v[62:63],v[158:159] neg_lo:[0,1] neg_hi:[0,1]
v_pk_add_f32 v[60:61],v[212:213],v[208:209]
v_pk_add_f32 v[62:63],v[214:215],v[210:211]
v_pk_fma_f32 v[212:213],v[208:209],4.0,v[212:213] op_sel_hi:[1,0,1]
v_pk_fma_f32 v[214:215],v[210:211],4.0,v[214:215] op_sel_hi:[1,0,1]
v_pk_fma_f32 v[208:209],v[156:157],2.0,v[204:205] op_sel_hi:[1,0,1]
v_pk_fma_f32 v[210:211],v[158:159],2.0,v[206:207] op_sel_hi:[1,0,1]
v_pk_fma_f32 v[156:157],v[156:157],s[40:41],v[204:205] op_sel_hi:[1,0,1]
v_pk_fma_f32 v[158:159],v[158:159],s[40:41],v[206:207] op_sel_hi:[1,0,1]
M v[100:103],a[236:239],a[132:135],v[100:103]
buffer_store_dwordx4 a[24:27],v253,s[24:27],s34 offen offset:384 nt
M v[104:107],a[236:239],a[252:255],v[104:107]
ds_read_b128 a[140:143],v248 offset:1536
v_cvt_pk_bf16_f32 v208,v208,v209
M v[104:107],a[232:235],a[240:243],v[104:107]
s_waitcnt lgkmcnt(2)
ds_read_b128 a[144:147],v249 offset:1536
v_cvt_pk_bf16_f32 v209,v210,v211
M v[104:107],a[192:195],a[96:99],v[104:107]
s_waitcnt lgkmcnt(2)
v_cvt_pk_bf16_f32 v212,v212,v213
v_cvt_pk_bf16_f32 v213,v214,v215
M v[108:111],a[192:195],a[100:103],v[108:111]
ds_write2st64_b64 v254,v[208:209],v[212:213] offset0:127 offset1:131
M v[108:111],a[232:235],a[96:99],v[108:111]
s_add_u32 s28,s66,6684672
buffer_load_dwordx2 v[204:205],v245,s[12:15],s28 offen offset:0
M v[108:111],a[236:239],a[240:243],v[108:111]
v_cvt_pk_bf16_f32 v0,v0,v1
v_cvt_pk_bf16_f32 v1,v2,v3
M v[112:115],a[236:239],a[96:99],v[112:115]
s_add_u32 s47,s75,49152
buffer_load_dwordx2 v[214:215],v245,s[16:19],s28 offen offset:1536
M v[112:115],a[232:235],a[100:103],v[112:115]
s_waitcnt lgkmcnt(2)
ds_read_b128 a[152:155],v249 offset:2048
ds_read_b128 a[156:159],v248 offset:2048
M v[112:115],a[192:195],a[140:143],v[112:115]
s_waitcnt lgkmcnt(3)
s_add_u32 s34,s32,1376256
v_cvt_pk_bf16_f32 v4,v4,v5
v_cvt_pk_bf16_f32 v5,v6,v7
M v[116:119],a[192:195],a[144:147],v[116:119]
s_waitcnt lgkmcnt(2)
s_barrier
ds_read_b128 a[32:35],v250 offset:17408
M v[116:119],a[232:235],a[140:143],v[116:119]
buffer_load_dwordx2 v[206:207],v245,s[8:11],s28 offen offset:0
M v[116:119],a[236:239],a[100:103],v[116:119]
ds_read_b128 a[36:39],v250 offset:21504
ds_read_b128 a[40:43],v250 offset:26112
M v[120:123],a[236:239],a[140:143],v[120:123]
ds_read_b128 a[44:47],v250 offset:30208
ds_read_b128 a[48:51],v250 offset:52224
M v[120:123],a[232:235],a[144:147],v[120:123]
s_waitcnt lgkmcnt(6)
ds_read_b128 a[52:55],v250 offset:56320
ds_read_b128 a[56:59],v250 offset:60928
M v[120:123],a[192:195],a[152:155],v[120:123]
s_waitcnt lgkmcnt(7)
buffer_load_dwordx2 v[208:209],v245,s[8:11],s28 offen offset:384
M v[124:127],a[192:195],a[156:159],v[124:127]
ds_read_b128 a[60:63],v250 offset:65024
ds_write2st64_b64 v254,v[0:1],v[4:5] offset0:68 offset1:72
M v[124:127],a[232:235],a[152:155],v[124:127]
v_cvt_pk_bf16_f32 v8,v8,v9
v_cvt_pk_bf16_f32 v9,v10,v11
M v[124:127],a[236:239],a[144:147],v[124:127]
s_waitcnt vmcnt(28)
buffer_load_dwordx2 v[210:211],v245,s[8:11],s28 offen offset:768
M v[128:131],a[112:115],a[148:151],v[128:131]
s_waitcnt vmcnt(28)
v_cvt_pk_bf16_f32 v12,v12,v13
v_cvt_pk_bf16_f32 v13,v14,v15
M v[128:131],v[220:223],a[132:135],v[128:131]
s_waitcnt vmcnt(27)
ds_write2st64_b64 v254,v[8:9],v[12:13] offset0:76 offset1:80
M v[128:131],a[124:127],a[252:255],v[128:131]
v_cvt_pk_bf16_f32 v16,v16,v17
v_cvt_pk_bf16_f32 v17,v18,v19
M v[132:135],a[124:127],a[240:243],v[132:135]
buffer_load_dwordx2 v[212:213],v245,s[8:11],s28 offen offset:1152
M v[132:135],v[220:223],a[252:255],v[132:135]
v_cvt_pk_bf16_f32 v20,v20,v21
v_cvt_pk_bf16_f32 v21,v22,v23
M v[132:135],a[112:115],a[132:135],v[132:135]
ds_write2st64_b64 v254,v[16:17],v[20:21] offset0:85 offset1:89
M v[136:139],a[112:115],a[252:255],v[136:139]
buffer_load_dwordx4 a[228:231],v250,s[20:23],s47 offen offset:0 sc1
M v[136:139],v[220:223],a[240:243],v[136:139]
v_cvt_pk_bf16_f32 v24,v24,v25
v_cvt_pk_bf16_f32 v25,v26,v27
M v[136:139],a[124:127],a[96:99],v[136:139]
v_cvt_pk_bf16_f32 v28,v28,v29
v_cvt_pk_bf16_f32 v29,v30,v31
M v[140:143],a[124:127],a[100:103],v[140:143]
ds_write2st64_b64 v254,v[24:25],v[28:29] offset0:93 offset1:97
M v[140:143],v[220:223],a[96:99],v[140:143]
buffer_load_dwordx4 v[224:227],v250,s[20:23],s47 offen offset:1024 sc1
M v[140:143],a[112:115],a[240:243],v[140:143]
v_accvgpr_read_b32 v238,a64
v_accvgpr_read_b32 v232,a160
M v[144:147],a[112:115],a[96:99],v[144:147]
v_add_f32 v234,v238,v232
v_sub_f32 v238,v238,v232
M v[144:147],v[220:223],a[100:103],v[144:147]
buffer_load_dwordx4 v[228:231],v250,s[20:23],s47 offen offset:2048 sc1
M v[144:147],a[124:127],a[140:143],v[144:147]
s_add_u32 s46,s76,46080
v_add_u32 v248,0x15400,v248
v_add_u32 v249,0x15400,v249
M v[148:151],a[124:127],a[144:147],v[148:151]
v_add_f32 v232,v64,v160
v_sub_f32 v160,v64,v160
M v[148:151],v[220:223],a[140:143],v[148:151]
ds_read_b128 a[96:99],v248 offset:0
v_add_f32 v64,v234,v232
M v[148:151],a[112:115],a[100:103],v[148:151]
buffer_store_dwordx4 a[28:31],v253,s[24:27],s34 offen offset:384 nt
M v[152:155],a[112:115],a[140:143],v[152:155]
s_add_u32 s34,s32,0
ds_read_b128 a[100:103],v249 offset:0
ds_read_b128 a[140:143],v248 offset:512
M v[152:155],v[220:223],a[144:147],v[152:155]
ds_read_b128 a[200:203],v249 offset:512
v_fmac_f32 v234,4.0,v232
M v[152:155],a[124:127],a[152:155],v[152:155]
s_waitcnt lgkmcnt(15)
buffer_store_dwordx4 a[32:35],v253,s[24:27],s34 offen offset:512 nt
M v[156:159],a[124:127],a[156:159],v[156:159]
v_fma_f32 v232,2.0,v160,v238
v_fma_f32 v160,s40,v160,v238
M v[156:159],v[220:223],a[152:155],v[156:159]
s_waitcnt lgkmcnt(4)
s_barrier
ds_read_b128 v[0:3],v250 offset:34816
M v[156:159],a[112:115],a[144:147],v[156:159]
s_waitcnt vmcnt(31) lgkmcnt(4)
ds_read_b128 v[8:11],v250 offset:38912
ds_read_b128 v[16:19],v250 offset:43520
M v[96:99],a[108:111],a[96:99],v[96:99]
s_waitcnt vmcnt(30) lgkmcnt(5)
ds_read_b128 v[24:27],v250 offset:47616
ds_read_b128 a[112:115],v248 offset:1024
M v[96:99],a[208:211],a[100:103],v[96:99]
s_waitcnt vmcnt(29) lgkmcnt(6)
buffer_load_dwordx4 a[132:135],v250,s[20:23],s46 offen offset:0 sc1
M v[96:99],a[120:123],a[140:143],v[96:99]
s_waitcnt lgkmcnt(5)
s_add_u32 s34,s32,196608
ds_read_b128 a[124:127],v249 offset:1024
v_accvgpr_read_b32 v238,a65
M v[100:103],a[120:123],a[200:203],v[100:103]
buffer_load_dwordx4 a[148:151],v250,s[20:23],s46 offen offset:1024 sc1
M v[100:103],a[208:211],a[140:143],v[100:103]
v_accvgpr_read_b32 v237,a161
v_add_f32 v236,v238,v237
M v[100:103],a[108:111],a[100:103],v[100:103]
v_sub_f32 v238,v238,v237
v_add_f32 v237,v65,v161
M v[104:107],a[108:111],a[140:143],v[104:107]
ds_read_b128 a[144:147],v248 offset:1536
v_sub_f32 v161,v65,v161
M v[104:107],a[208:211],a[200:203],v[104:107]
s_waitcnt lgkmcnt(2)
buffer_load_dwordx4 a[224:227],v250,s[20:23],s46 offen offset:2048 sc1
M v[104:107],a[120:123],a[112:115],v[104:107]
s_waitcnt lgkmcnt(1)
ds_read_b128 a[152:155],v249 offset:1536
v_add_f32 v65,v236,v237
M v[108:111],a[120:123],a[124:127],v[108:111]
v_fmac_f32 v236,4.0,v237
v_fma_f32 v237,2.0,v161,v238
M v[108:111],a[208:211],a[112:115],v[108:111]
v_fma_f32 v161,s40,v161,v238
v_cvt_pk_bf16_f32 v232,v232,v237
M v[108:111],a[108:111],a[200:203],v[108:111]
buffer_store_dwordx4 a[36:39],v253,s[24:27],s34 offen offset:512 nt
M v[112:115],a[108:111],a[112:115],v[112:115]
s_add_u32 s47,s76,49152
ds_read_b128 a[156:159],v249 offset:2048
v_cvt_pk_bf16_f32 v234,v234,v236
M v[112:115],a[208:211],a[124:127],v[112:115]
s_waitcnt lgkmcnt(2)
ds_read_b128 a[192:195],v248 offset:2048
v_accvgpr_read_b32 v238,a66
M v[112:115],a[120:123],a[144:147],v[112:115]
s_waitcnt lgkmcnt(2)
v_accvgpr_read_b32 v233,a162
v_add_f32 v235,v238,v233
M v[116:119],a[120:123],a[152:155],v[116:119]
v_sub_f32 v238,v238,v233
v_add_f32 v233,v66,v162
M v[116:119],a[208:211],a[144:147],v[116:119]
v_sub_f32 v162,v66,v162
v_add_f32 v66,v235,v233
M v[116:119],a[108:111],a[124:127],v[116:119]
v_fmac_f32 v235,4.0,v233
v_fma_f32 v233,2.0,v162,v238
v_fma_f32 v162,s40,v162,v238
v_accvgpr_read_b32 v238,a67
v_accvgpr_read_b32 v237,a163
M v[120:123],a[108:111],a[144:147],v[120:123]
buffer_load_dwordx4 a[232:235],v250,s[20:23],s47 offen offset:0 sc1
M v[120:123],a[208:211],a[152:155],v[120:123]
s_waitcnt lgkmcnt(1)
v_add_f32 v236,v238,v237
v_sub_f32 v238,v238,v237
M v[120:123],a[120:123],a[156:159],v[120:123]
s_waitcnt lgkmcnt(0)
s_add_u32 s34,s32,393216
buffer_load_dwordx4 a[236:239],v250,s[20:23],s47 offen offset:1024 sc1
v_add_f32 v237,v67,v163
v_sub_f32 v163,v67,v163
v_add_f32 v67,v236,v237
M v[124:127],a[120:123],a[192:195],v[124:127]
v_fmac_f32 v236,4.0,v237
v_fma_f32 v237,2.0,v163,v238
M v[124:127],a[208:211],a[156:159],v[124:127]
v_fma_f32 v163,s40,v163,v238
v_cvt_pk_bf16_f32 v233,v233,v237
M v[124:127],a[108:111],a[152:155],v[124:127]
s_waitcnt vmcnt(33)
v_cvt_pk_bf16_f32 v235,v235,v236
M v[128:131],a[116:119],a[96:99],v[128:131]
s_waitcnt vmcnt(31)
buffer_load_dwordx4 a[252:255],v250,s[20:23],s47 offen offset:2048 sc1
M v[128:131],a[196:199],a[100:103],v[128:131]
s_waitcnt vmcnt(31)
ds_write2st64_b64 v254,v[232:233],v[234:235] offset0:34 offset1:38
M v[128:131],a[204:207],a[140:143],v[128:131]
v_accvgpr_read_b32 v238,a68
v_accvgpr_read_b32 v232,a164
v_add_f32 v234,v238,v232
M v[132:135],a[204:207],a[200:203],v[132:135]
v_sub_f32 v238,v238,v232
v_add_f32 v232,v68,v164
M v[132:135],a[196:199],a[140:143],v[132:135]
v_sub_f32 v164,v68,v164
v_add_f32 v68,v234,v232
M v[132:135],a[116:119],a[100:103],v[132:135]
buffer_store_dwordx4 a[40:43],v253,s[24:27],s34 offen offset:512 nt
M v[136:139],a[116:119],a[140:143],v[136:139]
v_fmac_f32 v234,4.0,v232
v_fma_f32 v232,2.0,v164,v238
M v[136:139],a[196:199],a[200:203],v[136:139]
v_fma_f32 v164,s40,v164,v238
v_accvgpr_read_b32 v238,a69
M v[136:139],a[204:207],a[112:115],v[136:139]
v_accvgpr_read_b32 v237,a165
v_add_f32 v236,v238,v237
v_sub_f32 v238,v238,v237
M v[140:143],a[204:207],a[124:127],v[140:143]
v_add_f32 v237,v69,v165
v_sub_f32 v165,v69,v165
M v[140:143],a[196:199],a[112:115],v[140:143]
v_add_f32 v69,v236,v237
v_fmac_f32 v236,4.0,v237
M v[140:143],a[116:119],a[200:203],v[140:143]
v_fma_f32 v237,2.0,v165,v238
v_fma_f32 v165,s40,v165,v238
v_cvt_pk_bf16_f32 v232,v232,v237
v_cvt_pk_bf16_f32 v234,v234,v236
v_accvgpr_read_b32 v238,a70
M v[144:147],a[116:119],a[112:115],v[144:147]
s_add_u32 s46,s77,46080
v_accvgpr_read_b32 v233,a166
v_add_f32 v235,v238,v233
M v[144:147],a[196:199],a[124:127],v[144:147]
v_sub_f32 v238,v238,v233
v_add_f32 v233,v70,v166
M v[144:147],a[204:207],a[144:147],v[144:147]
s_add_u32 s34,s32,589824
buffer_store_dwordx4 a[44:47],v253,s[24:27],s34 offen offset:512 nt
M v[148:151],a[204:207],a[152:155],v[148:151]
v_sub_f32 v166,v70,v166
v_add_f32 v70,v235,v233
M v[148:151],a[196:199],a[144:147],v[148:151]
ds_read_b128 a[96:99],v248 offset:17408
v_fmac_f32 v235,4.0,v233
M v[148:151],a[116:119],a[124:127],v[148:151]
ds_read_b128 a[100:103],v249 offset:17408
v_fma_f32 v233,2.0,v166,v238
v_fma_f32 v166,s40,v166,v238
M v[152:155],a[116:119],a[144:147],v[152:155]
buffer_load_dwordx4 a[108:111],v250,s[20:23],s46 offen offset:0 sc1
M v[152:155],a[196:199],a[152:155],v[152:155]
ds_read_b128 a[112:115],v248 offset:17920
ds_read_b128 a[124:127],v249 offset:17920
M v[152:155],a[204:207],a[156:159],v[152:155]
buffer_load_dwordx4 a[120:123],v250,s[20:23],s46 offen offset:1024 sc1
v_accvgpr_read_b32 v238,a71
v_accvgpr_read_b32 v237,a167
v_add_f32 v236,v238,v237
M v[156:159],a[204:207],a[192:195],v[156:159]
v_sub_f32 v238,v238,v237
v_add_f32 v237,v71,v167
M v[156:159],a[196:199],a[156:159],v[156:159]
v_sub_f32 v167,v71,v167
v_add_f32 v71,v236,v237
M v[156:159],a[116:119],a[152:155],v[156:159]
s_waitcnt vmcnt(33) lgkmcnt(3)
v_fmac_f32 v236,4.0,v237
v_fma_f32 v237,2.0,v167,v238
v_fma_f32 v167,s40,v167,v238
v_cvt_pk_bf16_f32 v233,v233,v237
M v[96:99],a[136:139],a[96:99],v[96:99]
s_waitcnt vmcnt(32) lgkmcnt(2)
buffer_load_dwordx4 a[140:143],v250,s[20:23],s46 offen offset:2048 sc1
M v[96:99],a[220:223],a[100:103],v[96:99]
s_waitcnt vmcnt(32) lgkmcnt(1)
ds_read_b128 a[116:119],v248 offset:18432
ds_read_b128 a[144:147],v249 offset:18432
M v[96:99],a[248:251],a[112:115],v[96:99]
s_waitcnt lgkmcnt(2)
v_cvt_pk_bf16_f32 v235,v235,v236
M v[100:103],a[248:251],a[124:127],v[100:103]
ds_write2st64_b64 v254,v[232:233],v[234:235] offset0:42 offset1:46
M v[100:103],a[220:223],a[112:115],v[100:103]
v_accvgpr_read_b32 v238,a72
v_accvgpr_read_b32 v232,a168
M v[100:103],a[136:139],a[100:103],v[100:103]
v_add_f32 v234,v238,v232
v_sub_f32 v238,v238,v232
v_add_f32 v232,v72,v168
v_sub_f32 v168,v72,v168
M v[104:107],a[136:139],a[112:115],v[104:107]
ds_read_b128 a[152:155],v248 offset:18944
v_add_f32 v72,v234,v232
M v[104:107],a[220:223],a[124:127],v[104:107]
s_waitcnt lgkmcnt(3)
ds_read_b128 a[156:159],v249 offset:18944
v_fmac_f32 v234,4.0,v232
M v[104:107],a[248:251],a[116:119],v[104:107]
s_waitcnt lgkmcnt(3)
s_add_u32 s34,s32,786432
buffer_store_dwordx4 a[48:51],v253,s[24:27],s34 offen offset:512 nt
M v[108:111],a[248:251],a[144:147],v[108:111]
v_fma_f32 v232,2.0,v168,v238
v_fma_f32 v168,s40,v168,v238
M v[108:111],a[220:223],a[116:119],v[108:111]
v_accvgpr_read_b32 v238,a73
v_accvgpr_read_b32 v237,a169
M v[108:111],a[136:139],a[124:127],v[108:111]
v_add_f32 v236,v238,v237
v_sub_f32 v238,v238,v237
v_add_f32 v237,v73,v169
M v[112:115],a[136:139],a[116:119],v[112:115]
s_add_u32 s47,s77,49152
ds_read_b128 a[160:163],v249 offset:19456
v_sub_f32 v169,v73,v169
M v[112:115],a[220:223],a[144:147],v[112:115]
s_waitcnt lgkmcnt(2)
ds_read_b128 a[164:167],v248 offset:19456
v_add_f32 v73,v236,v237
M v[112:115],a[248:251],a[152:155],v[112:115]
s_waitcnt lgkmcnt(2)
v_fmac_f32 v236,4.0,v237
v_fma_f32 v237,2.0,v169,v238
v_fma_f32 v169,s40,v169,v238
v_cvt_pk_bf16_f32 v232,v232,v237
v_cvt_pk_bf16_f32 v234,v234,v236
M v[116:119],a[248:251],a[156:159],v[116:119]
v_accvgpr_read_b32 v238,a74
v_accvgpr_read_b32 v233,a170
M v[116:119],a[220:223],a[152:155],v[116:119]
v_add_f32 v235,v238,v233
v_sub_f32 v238,v238,v233
M v[116:119],a[136:139],a[144:147],v[116:119]
v_add_f32 v233,v74,v170
v_sub_f32 v170,v74,v170
v_add_f32 v74,v235,v233
v_fmac_f32 v235,4.0,v233
M v[120:123],a[136:139],a[152:155],v[120:123]
buffer_load_dwordx4 a[240:243],v250,s[20:23],s47 offen offset:0 sc1
M v[120:123],a[220:223],a[156:159],v[120:123]
s_waitcnt lgkmcnt(1)
v_fma_f32 v233,2.0,v170,v238
v_fma_f32 v170,s40,v170,v238
M v[120:123],a[248:251],a[160:163],v[120:123]
s_waitcnt lgkmcnt(0)
buffer_load_dwordx4 v[220:223],v250,s[20:23],s47 offen offset:1024 sc1
v_accvgpr_read_b32 v238,a75
v_accvgpr_read_b32 v237,a171
v_add_f32 v236,v238,v237
M v[124:127],a[248:251],a[164:167],v[124:127]
v_sub_f32 v238,v238,v237
v_add_f32 v237,v75,v171
M v[124:127],a[220:223],a[160:163],v[124:127]
v_sub_f32 v171,v75,v171
v_add_f32 v75,v236,v237
M v[124:127],a[136:139],a[156:159],v[124:127]
s_waitcnt vmcnt(33)
v_fmac_f32 v236,4.0,v237
v_fma_f32 v237,2.0,v171,v238
v_fma_f32 v171,s40,v171,v238
v_cvt_pk_bf16_f32 v233,v233,v237
M v[128:131],a[128:131],a[96:99],v[128:131]
s_waitcnt vmcnt(32)
buffer_load_dwordx4 a[208:211],v250,s[20:23],s47 offen offset:2048 sc1
M v[128:131],a[244:247],a[100:103],v[128:131]
s_waitcnt vmcnt(32)
v_cvt_pk_bf16_f32 v235,v235,v236
M v[128:131],a[216:219],a[112:115],v[128:131]
s_add_u32 s34,s32,983040
ds_write2st64_b64 v254,v[232:233],v[234:235] offset0:51 offset1:55
M v[132:135],a[216:219],a[124:127],v[132:135]
v_accvgpr_read_b32 v238,a76
v_accvgpr_read_b32 v232,a172
M v[132:135],a[244:247],a[112:115],v[132:135]
v_add_f32 v234,v238,v232
v_sub_f32 v238,v238,v232
M v[132:135],a[128:131],a[100:103],v[132:135]
buffer_store_dwordx4 a[52:55],v253,s[24:27],s34 offen offset:512 nt
M v[136:139],a[128:131],a[112:115],v[136:139]
v_add_f32 v232,v76,v172
v_sub_f32 v172,v76,v172
M v[136:139],a[244:247],a[124:127],v[136:139]
v_add_f32 v76,v234,v232
v_fmac_f32 v234,4.0,v232
M v[136:139],a[216:219],a[116:119],v[136:139]
v_fma_f32 v232,2.0,v172,v238
v_fma_f32 v172,s40,v172,v238
v_accvgpr_read_b32 v238,a77
M v[140:143],a[216:219],a[144:147],v[140:143]
v_accvgpr_read_b32 v237,a173
v_add_f32 v236,v238,v237
M v[140:143],a[244:247],a[116:119],v[140:143]
v_sub_f32 v238,v238,v237
v_add_f32 v237,v77,v173
M v[140:143],a[128:131],a[124:127],v[140:143]
v_sub_f32 v173,v77,v173
v_add_f32 v77,v236,v237
v_fmac_f32 v236,4.0,v237
v_fma_f32 v237,2.0,v173,v238
v_fma_f32 v173,s40,v173,v238
M v[144:147],a[128:131],a[116:119],v[144:147]
s_add_u32 s47,s72,3072
v_cvt_pk_bf16_f32 v232,v232,v237
v_cvt_pk_bf16_f32 v234,v234,v236
M v[144:147],a[244:247],a[144:147],v[144:147]
v_accvgpr_read_b32 v238,a78
v_accvgpr_read_b32 v233,a174
M v[144:147],a[216:219],a[152:155],v[144:147]
v_add_f32 v235,v238,v233
v_sub_f32 v238,v238,v233
v_add_f32 v233,v78,v174
v_sub_f32 v174,v78,v174
M v[148:151],a[216:219],a[156:159],v[148:151]
v_add_f32 v78,v235,v233
v_fmac_f32 v235,4.0,v233
M v[148:151],a[244:247],a[152:155],v[148:151]
ds_read_b128 a[96:99],v248 offset:34816
v_fma_f32 v233,2.0,v174,v238
M v[148:151],a[128:131],a[144:147],v[148:151]
ds_read_b128 a[100:103],v249 offset:34816
v_fma_f32 v174,s40,v174,v238
v_accvgpr_read_b32 v238,a79
v_accvgpr_read_b32 v237,a175
v_add_f32 v236,v238,v237
M v[152:155],a[128:131],a[152:155],v[152:155]
buffer_load_dwordx4 a[112:115],v250,s[20:23],s47 offen offset:0 sc1
M v[152:155],a[244:247],a[156:159],v[152:155]
ds_read_b128 a[116:119],v248 offset:35328
ds_read_b128 a[136:139],v249 offset:35328
M v[152:155],a[216:219],a[160:163],v[152:155]
s_add_u32 s34,s32,1179648
buffer_load_dwordx4 a[124:127],v250,s[20:23],s47 offen offset:1024 sc1
v_sub_f32 v238,v238,v237
v_add_f32 v237,v79,v175
M v[156:159],a[216:219],a[164:167],v[156:159]
v_sub_f32 v175,v79,v175
v_add_f32 v79,v236,v237
M v[156:159],a[244:247],a[160:163],v[156:159]
v_fmac_f32 v236,4.0,v237
v_fma_f32 v237,2.0,v175,v238
M v[156:159],a[128:131],a[156:159],v[156:159]
s_waitcnt vmcnt(33) lgkmcnt(3)
v_fma_f32 v175,s40,v175,v238
v_cvt_pk_bf16_f32 v233,v233,v237
v_cvt_pk_bf16_f32 v235,v235,v236
M v[96:99],a[104:107],a[96:99],v[96:99]
s_waitcnt vmcnt(32) lgkmcnt(2)
buffer_load_dwordx4 a[144:147],v250,s[20:23],s47 offen offset:2048 sc1
M v[96:99],a[212:215],a[100:103],v[96:99]
s_waitcnt vmcnt(32) lgkmcnt(1)
ds_read_b128 a[128:131],v248 offset:35840
ds_read_b128 a[152:155],v249 offset:35840
M v[96:99],v[216:219],a[116:119],v[96:99]
s_waitcnt lgkmcnt(2)
ds_write2st64_b64 v254,v[232:233],v[234:235] offset0:59 offset1:63
M v[100:103],v[216:219],a[136:139],v[100:103]
v_accvgpr_read_b32 v238,a80
v_accvgpr_read_b32 v232,a176
M v[100:103],a[212:215],a[116:119],v[100:103]
v_add_f32 v234,v238,v232
v_sub_f32 v238,v238,v232
M v[100:103],a[104:107],a[100:103],v[100:103]
buffer_store_dwordx4 a[56:59],v253,s[24:27],s34 offen offset:512 nt
M v[104:107],a[104:107],a[116:119],v[104:107]
ds_read_b128 a[156:159],v248 offset:36352
v_add_f32 v232,v80,v176
M v[104:107],a[212:215],a[136:139],v[104:107]
s_waitcnt lgkmcnt(3)
ds_read_b128 a[160:163],v249 offset:36352
v_sub_f32 v176,v80,v176
M v[104:107],v[216:219],a[128:131],v[104:107]
s_waitcnt lgkmcnt(3)
v_add_f32 v80,v234,v232
v_fmac_f32 v234,4.0,v232
M v[108:111],v[216:219],a[152:155],v[108:111]
v_fma_f32 v232,2.0,v176,v238
v_fma_f32 v176,s40,v176,v238
M v[108:111],a[212:215],a[128:131],v[108:111]
v_accvgpr_read_b32 v238,a81
v_accvgpr_read_b32 v237,a177
M v[108:111],a[104:107],a[136:139],v[108:111]
v_add_f32 v236,v238,v237
v_sub_f32 v238,v238,v237
M v[112:115],a[104:107],a[128:131],v[112:115]
s_add_u32 s48,s72,6144
ds_read_b128 a[164:167],v249 offset:36864
v_add_f32 v237,v81,v177
M v[112:115],a[212:215],a[152:155],v[112:115]
s_waitcnt lgkmcnt(2)
ds_read_b128 a[168:171],v248 offset:36864
v_sub_f32 v177,v81,v177
M v[112:115],v[216:219],a[156:159],v[112:115]
s_waitcnt lgkmcnt(2)
s_add_u32 s34,s32,1376256
buffer_store_dwordx4 a[60:63],v253,s[24:27],s34 offen offset:512 nt
M v[116:119],v[216:219],a[160:163],v[116:119]
v_add_f32 v81,v236,v237
v_fmac_f32 v236,4.0,v237
M v[116:119],a[212:215],a[156:159],v[116:119]
v_fma_f32 v237,2.0,v177,v238
v_fma_f32 v177,s40,v177,v238
M v[116:119],a[104:107],a[152:155],v[116:119]
v_cvt_pk_bf16_f32 v232,v232,v237
v_cvt_pk_bf16_f32 v234,v234,v236
M v[120:123],a[104:107],a[156:159],v[120:123]
buffer_load_dwordx4 a[172:175],v250,s[20:23],s48 offen offset:0 sc1
M v[120:123],a[212:215],a[160:163],v[120:123]
s_waitcnt lgkmcnt(1)
v_accvgpr_read_b32 v238,a82
v_accvgpr_read_b32 v233,a178
M v[120:123],v[216:219],a[164:167],v[120:123]
s_waitcnt lgkmcnt(0)
buffer_load_dwordx4 a[200:203],v250,s[20:23],s48 offen offset:1024 sc1
M v[124:127],v[216:219],a[168:171],v[124:127]
v_add_f32 v235,v238,v233
v_sub_f32 v238,v238,v233
M v[124:127],a[212:215],a[164:167],v[124:127]
v_add_f32 v233,v82,v178
v_sub_f32 v178,v82,v178
M v[124:127],a[104:107],a[160:163],v[124:127]
s_waitcnt vmcnt(28)
v_add_f32 v82,v235,v233
v_fmac_f32 v235,4.0,v233
M v[128:131],a[228:231],a[96:99],v[128:131]
s_waitcnt vmcnt(27)
buffer_load_dwordx4 a[192:195],v250,s[20:23],s48 offen offset:2048 sc1
M v[128:131],v[224:227],a[100:103],v[128:131]
s_waitcnt vmcnt(27)
v_fma_f32 v233,2.0,v178,v238
v_fma_f32 v178,s40,v178,v238
M v[128:131],v[228:231],a[116:119],v[128:131]
v_accvgpr_read_b32 v238,a83
v_accvgpr_read_b32 v237,a179
v_add_f32 v236,v238,v237
v_sub_f32 v238,v238,v237
M v[132:135],v[228:231],a[136:139],v[132:135]
v_add_f32 v237,v83,v179
v_sub_f32 v179,v83,v179
M v[132:135],v[224:227],a[116:119],v[132:135]
v_add_f32 v83,v236,v237
v_fmac_f32 v236,4.0,v237
M v[132:135],a[228:231],a[100:103],v[132:135]
v_fma_f32 v237,2.0,v179,v238
v_fma_f32 v179,s40,v179,v238
v_cvt_pk_bf16_f32 v233,v233,v237
M v[136:139],a[228:231],a[116:119],v[136:139]
v_cvt_pk_bf16_f32 v235,v235,v236
M v[136:139],v[224:227],a[136:139],v[136:139]
ds_write2st64_b64 v254,v[232:233],v[234:235] offset0:102 offset1:106
M v[136:139],v[228:231],a[128:131],v[136:139]
s_add_u32 s34,s33,0
buffer_store_dwordx4 v[0:3],v253,s[24:27],s34 offen offset:0 nt
M v[140:143],v[228:231],a[152:155],v[140:143]
v_accvgpr_read_b32 v238,a84
v_accvgpr_read_b32 v232,a180
M v[140:143],v[224:227],a[128:131],v[140:143]
v_add_f32 v234,v238,v232
v_sub_f32 v238,v238,v232
M v[140:143],a[228:231],a[136:139],v[140:143]
v_add_f32 v232,v84,v180
v_sub_f32 v180,v84,v180
M v[144:147],a[228:231],a[128:131],v[144:147]
s_add_u32 s47,s73,3072
v_add_f32 v84,v234,v232
v_fmac_f32 v234,4.0,v232
M v[144:147],v[224:227],a[152:155],v[144:147]
v_fma_f32 v232,2.0,v180,v238
v_fma_f32 v180,s40,v180,v238
M v[144:147],v[228:231],a[156:159],v[144:147]
v_accvgpr_read_b32 v238,a85
v_accvgpr_read_b32 v237,a181
M v[148:151],v[228:231],a[160:163],v[148:151]
v_add_f32 v236,v238,v237
v_sub_f32 v238,v238,v237
M v[148:151],v[224:227],a[156:159],v[148:151]
ds_read_b128 a[96:99],v248 offset:52224
v_add_f32 v237,v85,v181
M v[148:151],a[228:231],a[152:155],v[148:151]
ds_read_b128 a[100:103],v249 offset:52224
v_sub_f32 v181,v85,v181
M v[152:155],a[228:231],a[156:159],v[152:155]
buffer_load_dwordx4 a[104:107],v250,s[20:23],s47 offen offset:0 sc1
M v[152:155],v[224:227],a[160:163],v[152:155]
ds_read_b128 a[116:119],v248 offset:52736
ds_read_b128 a[136:139],v249 offset:52736
M v[152:155],v[228:231],a[164:167],v[152:155]
buffer_load_dwordx4 a[128:131],v250,s[20:23],s47 offen offset:1024 sc1
M v[156:159],v[228:231],a[168:171],v[156:159]
v_add_f32 v85,v236,v237
v_fmac_f32 v236,4.0,v237
M v[156:159],v[224:227],a[164:167],v[156:159]
v_fma_f32 v237,2.0,v181,v238
v_fma_f32 v181,s40,v181,v238
M v[156:159],a[228:231],a[160:163],v[156:159]
s_waitcnt vmcnt(27) lgkmcnt(3)
v_cvt_pk_bf16_f32 v232,v232,v237
v_cvt_pk_bf16_f32 v234,v234,v236
M v[96:99],a[132:135],a[96:99],v[96:99]
s_waitcnt vmcnt(26) lgkmcnt(2)
buffer_load_dwordx4 a[152:155],v250,s[20:23],s47 offen offset:2048 sc1
M v[96:99],a[148:151],a[100:103],v[96:99]
s_waitcnt vmcnt(26) lgkmcnt(1)
ds_read_b128 a[156:159],v248 offset:53248
ds_read_b128 a[160:163],v249 offset:53248
M v[96:99],a[224:227],a[116:119],v[96:99]
s_waitcnt lgkmcnt(2)
s_add_u32 s34,s33,393216
v_accvgpr_read_b32 v238,a86
v_accvgpr_read_b32 v233,a182
v_add_f32 v235,v238,v233
M v[100:103],a[224:227],a[136:139],v[100:103]
v_sub_f32 v238,v238,v233
v_add_f32 v233,v86,v182
M v[100:103],a[148:151],a[116:119],v[100:103]
v_sub_f32 v182,v86,v182
v_add_f32 v86,v235,v233
M v[100:103],a[132:135],a[100:103],v[100:103]
buffer_store_dwordx4 v[8:11],v253,s[24:27],s34 offen offset:0 nt
M v[104:107],a[132:135],a[116:119],v[104:107]
ds_read_b128 a[164:167],v248 offset:53760
v_fmac_f32 v235,4.0,v233
M v[104:107],a[148:151],a[136:139],v[104:107]
s_waitcnt lgkmcnt(2)
ds_read_b128 a[168:171],v249 offset:53760
v_fma_f32 v233,2.0,v182,v238
M v[104:107],a[224:227],a[156:159],v[104:107]
s_waitcnt lgkmcnt(2)
v_fma_f32 v182,s40,v182,v238
v_accvgpr_read_b32 v238,a87
M v[108:111],a[224:227],a[160:163],v[108:111]
v_accvgpr_read_b32 v237,a183
v_add_f32 v236,v238,v237
M v[108:111],a[148:151],a[156:159],v[108:111]
v_sub_f32 v238,v238,v237
v_add_f32 v237,v87,v183
M v[108:111],a[132:135],a[136:139],v[108:111]
v_sub_f32 v183,v87,v183
v_add_f32 v87,v236,v237
M v[112:115],a[132:135],a[156:159],v[112:115]
s_add_u32 s48,s73,6144
ds_read_b128 a[176:179],v249 offset:54272
v_fmac_f32 v236,4.0,v237
M v[112:115],a[148:151],a[160:163],v[112:115]
s_waitcnt lgkmcnt(2)
ds_read_b128 a[204:207],v248 offset:54272
v_fma_f32 v237,2.0,v183,v238
M v[112:115],a[224:227],a[164:167],v[112:115]
s_waitcnt lgkmcnt(2)
v_fma_f32 v183,s40,v183,v238
v_cvt_pk_bf16_f32 v233,v233,v237
v_cvt_pk_bf16_f32 v235,v235,v236
M v[116:119],a[224:227],a[168:171],v[116:119]
ds_write2st64_b64 v254,v[232:233],v[234:235] offset0:110 offset1:114
M v[116:119],a[148:151],a[164:167],v[116:119]
v_accvgpr_read_b32 v238,a88
v_accvgpr_read_b32 v232,a184
M v[116:119],a[132:135],a[160:163],v[116:119]
v_add_f32 v234,v238,v232
v_sub_f32 v238,v238,v232
M v[120:123],a[132:135],a[164:167],v[120:123]
buffer_load_dwordx4 a[180:183],v250,s[20:23],s48 offen offset:0 sc1
M v[120:123],a[148:151],a[168:171],v[120:123]
s_waitcnt lgkmcnt(2)
v_add_f32 v232,v88,v184
v_sub_f32 v184,v88,v184
M v[120:123],a[224:227],a[176:179],v[120:123]
s_waitcnt lgkmcnt(1)
s_add_u32 s34,s33,786432
buffer_load_dwordx4 a[196:199],v250,s[20:23],s48 offen offset:1024 sc1
M v[124:127],a[224:227],a[204:207],v[124:127]
v_add_f32 v88,v234,v232
v_fmac_f32 v234,4.0,v232
M v[124:127],a[148:151],a[176:179],v[124:127]
v_fma_f32 v232,2.0,v184,v238
v_fma_f32 v184,s40,v184,v238
M v[124:127],a[132:135],a[168:171],v[124:127]
s_waitcnt vmcnt(27)
v_accvgpr_read_b32 v238,a89
v_accvgpr_read_b32 v237,a185
v_add_f32 v236,v238,v237
M v[128:131],a[232:235],a[96:99],v[128:131]
s_waitcnt vmcnt(26)
buffer_load_dwordx4 a[248:251],v250,s[20:23],s48 offen offset:2048 sc1
M v[128:131],a[236:239],a[100:103],v[128:131]
s_waitcnt vmcnt(26)
v_sub_f32 v238,v238,v237
v_add_f32 v237,v89,v185
M v[128:131],a[252:255],a[116:119],v[128:131]
v_sub_f32 v185,v89,v185
v_add_f32 v89,v236,v237
v_fmac_f32 v236,4.0,v237
M v[132:135],a[252:255],a[136:139],v[132:135]
v_fma_f32 v237,2.0,v185,v238
v_fma_f32 v185,s40,v185,v238
M v[132:135],a[236:239],a[116:119],v[132:135]
v_cvt_pk_bf16_f32 v232,v232,v237
v_cvt_pk_bf16_f32 v234,v234,v236
M v[132:135],a[232:235],a[100:103],v[132:135]
buffer_store_dwordx4 v[16:19],v253,s[24:27],s34 offen offset:0 nt
M v[136:139],a[232:235],a[116:119],v[136:139]
v_accvgpr_read_b32 v238,a90
v_accvgpr_read_b32 v233,a186
M v[136:139],a[236:239],a[136:139],v[136:139]
v_add_f32 v235,v238,v233
v_sub_f32 v238,v238,v233
M v[136:139],a[252:255],a[156:159],v[136:139]
v_add_f32 v233,v90,v186
v_sub_f32 v186,v90,v186
M v[140:143],a[252:255],a[160:163],v[140:143]
v_add_f32 v90,v235,v233
v_fmac_f32 v235,4.0,v233
M v[140:143],a[236:239],a[156:159],v[140:143]
v_fma_f32 v233,2.0,v186,v238
v_fma_f32 v186,s40,v186,v238
M v[140:143],a[232:235],a[136:139],v[140:143]
v_accvgpr_read_b32 v238,a91
v_accvgpr_read_b32 v237,a187
M v[144:147],a[232:235],a[156:159],v[144:147]
s_add_u32 s47,s74,3072
v_add_f32 v236,v238,v237
v_sub_f32 v238,v238,v237
M v[144:147],a[236:239],a[160:163],v[144:147]
v_add_u32 v248,0xffffbc00,v248
v_add_u32 v249,0xffffbc00,v249
M v[144:147],a[252:255],a[164:167],v[144:147]
s_add_u32 s34,s33,1179648
buffer_store_dwordx4 v[24:27],v253,s[24:27],s34 offen offset:0 nt
M v[148:151],a[252:255],a[168:171],v[148:151]
v_add_f32 v237,v91,v187
v_sub_f32 v187,v91,v187
M v[148:151],a[236:239],a[164:167],v[148:151]
ds_read_b128 a[96:99],v248 offset:0
v_add_f32 v91,v236,v237
M v[148:151],a[232:235],a[160:163],v[148:151]
ds_read_b128 a[100:103],v249 offset:0
v_fmac_f32 v236,4.0,v237
M v[152:155],a[232:235],a[164:167],v[152:155]
buffer_load_dwordx4 a[116:119],v250,s[20:23],s47 offen offset:0 sc1
M v[152:155],a[236:239],a[168:171],v[152:155]
ds_read_b128 a[132:135],v248 offset:512
ds_read_b128 a[148:151],v249 offset:512
M v[152:155],a[252:255],a[176:179],v[152:155]
buffer_load_dwordx4 a[136:139],v250,s[20:23],s47 offen offset:1024 sc1
M v[156:159],a[252:255],a[204:207],v[156:159]
v_fma_f32 v237,2.0,v187,v238
v_fma_f32 v187,s40,v187,v238
M v[156:159],a[236:239],a[176:179],v[156:159]
v_cvt_pk_bf16_f32 v233,v233,v237
v_cvt_pk_bf16_f32 v235,v235,v236
M v[156:159],a[232:235],a[168:171],v[156:159]
s_waitcnt vmcnt(27) lgkmcnt(3)
ds_write2st64_b64 v254,v[232:233],v[234:235] offset0:119 offset1:123
M v[96:99],a[108:111],a[96:99],v[96:99]
s_waitcnt vmcnt(26) lgkmcnt(3)
buffer_load_dwordx4 a[156:159],v250,s[20:23],s47 offen offset:2048 sc1
M v[96:99],a[120:123],a[100:103],v[96:99]
s_waitcnt vmcnt(26) lgkmcnt(2)
ds_read_b128 a[160:163],v248 offset:1024
ds_read_b128 a[164:167],v249 offset:1024
M v[96:99],a[140:143],a[132:135],v[96:99]
s_waitcnt lgkmcnt(3)
v_accvgpr_read_b32 v238,a92
v_accvgpr_read_b32 v232,a188
M v[100:103],a[140:143],a[148:151],v[100:103]
v_add_f32 v234,v238,v232
v_sub_f32 v238,v238,v232
M v[100:103],a[120:123],a[132:135],v[100:103]
v_add_f32 v232,v92,v188
v_sub_f32 v188,v92,v188
M v[100:103],a[108:111],a[100:103],v[100:103]
v_add_f32 v92,v234,v232
v_fmac_f32 v234,4.0,v232
M v[104:107],a[108:111],a[132:135],v[104:107]
ds_read_b128 a[168:171],v248 offset:1536
v_fma_f32 v232,2.0,v188,v238
M v[104:107],a[120:123],a[148:151],v[104:107]
s_waitcnt lgkmcnt(2)
ds_read_b128 a[176:179],v249 offset:1536
v_fma_f32 v188,s40,v188,v238
M v[104:107],a[140:143],a[160:163],v[104:107]
s_waitcnt lgkmcnt(2)
v_accvgpr_read_b32 v238,a93
v_accvgpr_read_b32 v237,a189
v_add_f32 v236,v238,v237
M v[108:111],a[140:143],a[164:167],v[108:111]
v_sub_f32 v238,v238,v237
v_add_f32 v237,v93,v189
M v[108:111],a[120:123],a[160:163],v[108:111]
v_sub_f32 v189,v93,v189
v_add_f32 v93,v236,v237
M v[108:111],a[108:111],a[148:151],v[108:111]
v_fmac_f32 v236,4.0,v237
v_fma_f32 v237,2.0,v189,v238
v_fma_f32 v189,s40,v189,v238
M v[112:115],a[108:111],a[160:163],v[112:115]
s_add_u32 s48,s74,6144
ds_read_b128 a[184:187],v249 offset:2048
v_cvt_pk_bf16_f32 v232,v232,v237
M v[112:115],a[120:123],a[164:167],v[112:115]
s_waitcnt lgkmcnt(2)
ds_read_b128 a[220:223],v248 offset:2048
v_cvt_pk_bf16_f32 v234,v234,v236
M v[112:115],a[140:143],a[168:171],v[112:115]
s_waitcnt lgkmcnt(2)
v_accvgpr_read_b32 v238,a94
v_accvgpr_read_b32 v233,a190
v_add_f32 v235,v238,v233
M v[116:119],a[140:143],a[176:179],v[116:119]
v_sub_f32 v238,v238,v233
v_add_f32 v233,v94,v190
M v[116:119],a[120:123],a[168:171],v[116:119]
v_sub_f32 v190,v94,v190
v_add_f32 v94,v235,v233
M v[116:119],a[108:111],a[164:167],v[116:119]
v_fmac_f32 v235,4.0,v233
v_fma_f32 v233,2.0,v190,v238
v_fma_f32 v190,s40,v190,v238
M v[120:123],a[108:111],a[168:171],v[120:123]
buffer_load_dwordx4 a[216:219],v250,s[20:23],s48 offen offset:0 sc1
M v[120:123],a[120:123],a[176:179],v[120:123]
s_waitcnt lgkmcnt(1)
v_accvgpr_read_b32 v238,a95
v_accvgpr_read_b32 v237,a191
M v[120:123],a[140:143],a[184:187],v[120:123]
s_waitcnt lgkmcnt(0)
buffer_load_dwordx4 a[244:247],v250,s[20:23],s48 offen offset:1024 sc1
v_add_f32 v236,v238,v237
v_sub_f32 v238,v238,v237
M v[124:127],a[140:143],a[220:223],v[124:127]
v_add_f32 v237,v95,v191
v_sub_f32 v191,v95,v191
M v[124:127],a[120:123],a[184:187],v[124:127]
v_add_f32 v95,v236,v237
v_fmac_f32 v236,4.0,v237
M v[124:127],a[108:111],a[176:179],v[124:127]
s_waitcnt vmcnt(26)
v_fma_f32 v237,2.0,v191,v238
v_fma_f32 v191,s40,v191,v238
v_cvt_pk_bf16_f32 v233,v233,v237
M v[128:131],a[240:243],a[96:99],v[128:131]
s_waitcnt vmcnt(25)
buffer_load_dwordx4 v[216:219],v250,s[20:23],s48 offen offset:2048 sc1
M v[128:131],v[220:223],a[100:103],v[128:131]
s_waitcnt vmcnt(25)
v_cvt_pk_bf16_f32 v235,v235,v236
M v[128:131],a[208:211],a[132:135],v[128:131]
ds_write2st64_b64 v254,v[232:233],v[234:235] offset0:127 offset1:131
M v[132:135],a[208:211],a[148:151],v[132:135]
v_cvt_pk_bf16_f32 v96,v96,v97
v_cvt_pk_bf16_f32 v97,v98,v99
M v[132:135],v[220:223],a[132:135],v[132:135]
v_cvt_pk_bf16_f32 v100,v100,v101
v_cvt_pk_bf16_f32 v101,v102,v103
M v[132:135],a[240:243],a[100:103],v[132:135]
s_waitcnt lgkmcnt(0)
s_barrier
ds_read_b128 a[64:67],v250 offset:17408
M v[136:139],a[240:243],a[132:135],v[136:139]
ds_read_b128 a[68:71],v250 offset:21504
ds_read_b128 a[72:75],v250 offset:26112
M v[136:139],v[220:223],a[148:151],v[136:139]
ds_read_b128 a[76:79],v250 offset:30208
ds_read_b128 a[80:83],v250 offset:52224
M v[136:139],a[208:211],a[160:163],v[136:139]
ds_read_b128 a[84:87],v250 offset:56320
ds_read_b128 a[88:91],v250 offset:60928
M v[140:143],a[208:211],a[164:167],v[140:143]
ds_read_b128 a[92:95],v250 offset:65024
v_add_u32 v4,69632,v250
M v[140:143],v[220:223],a[160:163],v[140:143]
s_add_u32 s34,s32,0
ds_write2st64_b64 v254,v[96:97],v[100:101] offset0:68 offset1:72
M v[140:143],a[240:243],a[148:151],v[140:143]
s_waitcnt lgkmcnt(8)
buffer_store_dwordx4 a[64:67],v253,s[24:27],s34 offen offset:640 nt
M v[144:147],a[240:243],a[160:163],v[144:147]
s_add_u32 s34,s32,196608
s_add_u32 s47,s75,3072
v_cvt_pk_bf16_f32 v104,v104,v105
M v[144:147],v[220:223],a[164:167],v[144:147]
v_add_u32 v248,0xfffece00,v248
v_add_u32 v249,0xfffece00,v249
M v[144:147],a[208:211],a[168:171],v[144:147]
s_waitcnt lgkmcnt(7)
buffer_store_dwordx4 a[68:71],v253,s[24:27],s34 offen offset:640 nt
M v[148:151],a[208:211],a[176:179],v[148:151]
v_cvt_pk_bf16_f32 v105,v106,v107
v_cvt_pk_bf16_f32 v108,v108,v109
M v[148:151],v[220:223],a[168:171],v[148:151]
ds_read_b128 a[96:99],v248 offset:0
v_cvt_pk_bf16_f32 v109,v110,v111
M v[148:151],a[240:243],a[164:167],v[148:151]
ds_read_b128 a[100:103],v249 offset:0
ds_write2st64_b64 v254,v[104:105],v[108:109] offset0:76 offset1:80
M v[152:155],a[240:243],a[168:171],v[152:155]
buffer_load_dwordx4 a[108:111],v250,s[20:23],s47 offen offset:0 sc1
M v[152:155],v[220:223],a[176:179],v[152:155]
ds_read_b128 a[120:123],v248 offset:512
ds_read_b128 a[140:143],v249 offset:512
M v[152:155],a[208:211],a[184:187],v[152:155]
s_add_u32 s34,s32,393216
buffer_load_dwordx4 a[132:135],v250,s[20:23],s47 offen offset:1024 sc1
M v[156:159],a[208:211],a[220:223],v[156:159]
v_cvt_pk_bf16_f32 v112,v112,v113
v_cvt_pk_bf16_f32 v113,v114,v115
M v[156:159],v[220:223],a[184:187],v[156:159]
v_cvt_pk_bf16_f32 v116,v116,v117
v_cvt_pk_bf16_f32 v117,v118,v119
M v[156:159],a[240:243],a[176:179],v[156:159]
s_waitcnt vmcnt(27) lgkmcnt(4)
ds_write2st64_b64 v254,v[112:113],v[116:117] offset0:85 offset1:89
M v[32:35],a[112:115],a[96:99],v[32:35]
s_waitcnt vmcnt(26) lgkmcnt(4)
buffer_load_dwordx4 a[148:151],v250,s[20:23],s47 offen offset:2048 sc1
M v[32:35],a[124:127],a[100:103],v[32:35]
s_waitcnt vmcnt(26) lgkmcnt(2)
ds_read_b128 a[160:163],v248 offset:1024
ds_read_b128 a[164:167],v249 offset:1024
M v[32:35],a[144:147],a[120:123],v[32:35]
s_waitcnt lgkmcnt(3)
v_cvt_pk_bf16_f32 v120,v120,v121
v_cvt_pk_bf16_f32 v121,v122,v123
M v[36:39],a[144:147],a[140:143],v[36:39]
v_cvt_pk_bf16_f32 v124,v124,v125
v_cvt_pk_bf16_f32 v125,v126,v127
M v[36:39],a[124:127],a[120:123],v[36:39]
ds_write2st64_b64 v254,v[120:121],v[124:125] offset0:93 offset1:97
M v[36:39],a[112:115],a[100:103],v[36:39]
buffer_store_dwordx4 a[72:75],v253,s[24:27],s34 offen offset:640 nt
M v[40:43],a[112:115],a[120:123],v[40:43]
ds_read_b128 a[168:171],v248 offset:1536
v_cvt_pk_bf16_f32 v128,v128,v129
M v[40:43],a[124:127],a[140:143],v[40:43]
s_waitcnt lgkmcnt(3)
ds_read_b128 a[176:179],v249 offset:1536
v_cvt_pk_bf16_f32 v129,v130,v131
M v[40:43],a[144:147],a[160:163],v[40:43]
s_waitcnt lgkmcnt(3)
v_cvt_pk_bf16_f32 v132,v132,v133
v_cvt_pk_bf16_f32 v133,v134,v135
M v[44:47],a[144:147],a[164:167],v[44:47]
s_waitcnt lgkmcnt(2)
s_barrier
ds_read_b128 v[96:99],v250 offset:34816
M v[44:47],a[124:127],a[160:163],v[44:47]
ds_read_b128 v[104:107],v250 offset:38912
ds_read_b128 v[112:115],v250 offset:43520
M v[44:47],a[112:115],a[140:143],v[44:47]
ds_read_b128 v[120:123],v250 offset:47616
ds_write2st64_b64 v254,v[128:129],v[132:133] offset0:34 offset1:38
M v[48:51],a[112:115],a[160:163],v[48:51]
ds_read_b128 a[184:187],v249 offset:2048
v_cvt_pk_bf16_f32 v136,v136,v137
M v[48:51],a[124:127],a[164:167],v[48:51]
s_waitcnt lgkmcnt(7)
ds_read_b128 a[188:191],v248 offset:2048
v_cvt_pk_bf16_f32 v137,v138,v139
M v[48:51],a[144:147],a[168:171],v[48:51]
s_waitcnt lgkmcnt(7)
s_add_u32 s34,s32,589824
buffer_store_dwordx4 a[76:79],v253,s[24:27],s34 offen offset:640 nt
M v[52:55],a[144:147],a[176:179],v[52:55]
v_cvt_pk_bf16_f32 v140,v140,v141
v_cvt_pk_bf16_f32 v141,v142,v143
M v[52:55],a[124:127],a[168:171],v[52:55]
ds_write2st64_b64 v254,v[136:137],v[140:141] offset0:42 offset1:46
M v[52:55],a[112:115],a[164:167],v[52:55]
v_cvt_pk_bf16_f32 v144,v144,v145
v_cvt_pk_bf16_f32 v145,v146,v147
M v[56:59],a[112:115],a[168:171],v[56:59]
global_load_dword a212,v250,s[64:65]
M v[56:59],a[124:127],a[176:179],v[56:59]
s_waitcnt lgkmcnt(2)
s_add_u32 s48,s75,6144
buffer_load_dwordx4 a[212:215],v250,s[20:23],s48 offen offset:0 sc1
M v[56:59],a[144:147],a[184:187],v[56:59]
s_waitcnt lgkmcnt(1)
v_cvt_pk_bf16_f32 v148,v148,v149
v_cvt_pk_bf16_f32 v149,v150,v151
M v[60:63],a[144:147],a[188:191],v[60:63]
ds_write2st64_b64 v254,v[144:145],v[148:149] offset0:51 offset1:55
M v[60:63],a[124:127],a[184:187],v[60:63]
buffer_load_dwordx4 v[228:231],v250,s[20:23],s48 offen offset:1024 sc1
M v[60:63],a[112:115],a[176:179],v[60:63]
s_waitcnt vmcnt(28)
v_cvt_pk_bf16_f32 v152,v152,v153
v_cvt_pk_bf16_f32 v153,v154,v155
M v[64:67],a[172:175],a[96:99],v[64:67]
s_waitcnt vmcnt(27)
v_cvt_pk_bf16_f32 v156,v156,v157
v_cvt_pk_bf16_f32 v157,v158,v159
M v[64:67],a[200:203],a[100:103],v[64:67]
s_waitcnt vmcnt(26)
ds_write2st64_b64 v254,v[152:153],v[156:157] offset0:59 offset1:63
M v[64:67],a[192:195],a[120:123],v[64:67]
buffer_load_dwordx4 v[224:227],v250,s[20:23],s48 offen offset:2048 sc1
M v[68:71],a[192:195],a[140:143],v[68:71]
v_lshlrev_b32 v234,16,v208
v_lshlrev_b32 v232,16,v204
M v[68:71],a[200:203],a[120:123],v[68:71]
v_lshlrev_b32 v233,16,v206
v_lshlrev_b32 v237,16,v214
M v[68:71],a[172:175],a[100:103],v[68:71]
v_lshlrev_b32 v236,16,v212
v_lshlrev_b32 v235,16,v210
M v[72:75],a[172:175],a[120:123],v[72:75]
v_fmac_f32 v232,s43,v234
v_fmac_f32 v237,4.0,v233
M v[72:75],a[200:203],a[140:143],v[72:75]
v_fma_f32 v238,-4.0,v234,v236
v_fmac_f32 v232,s45,v236
M v[72:75],a[192:195],a[160:163],v[72:75]
s_add_u32 s34,s32,786432
buffer_store_dwordx4 a[80:83],v253,s[24:27],s34 offen offset:640 nt
M v[76:79],a[192:195],a[164:167],v[76:79]
s_waitcnt lgkmcnt(0)
s_barrier
ds_read_b128 v[128:131],v250 offset:17408
M v[76:79],a[200:203],a[160:163],v[76:79]
ds_read_b128 v[136:139],v250 offset:21504
ds_read_b128 v[144:147],v250 offset:26112
M v[76:79],a[172:175],a[140:143],v[76:79]
ds_read_b128 v[152:155],v250 offset:30208
v_fmac_f32 v237,s41,v235
M v[80:83],a[172:175],a[160:163],v[80:83]
s_add_u32 s47,s76,3072
v_sub_f32 v236,v236,v234
v_fma_f32 v234,-4.0,v233,v235
M v[80:83],a[200:203],a[164:167],v[80:83]
v_add_u32 v248,0x15400,v248
v_add_u32 v249,0x15400,v249
M v[80:83],a[192:195],a[168:171],v[80:83]
v_sub_f32 v235,v235,v233
v_add_f32 v233,v238,v234
M v[84:87],a[192:195],a[176:179],v[84:87]
v_sub_f32 v238,v238,v234
v_fma_f32 v234,2.0,v235,v236
M v[84:87],a[200:203],a[168:171],v[84:87]
ds_read_b128 a[96:99],v248 offset:0
v_fmac_f32 v236,-2.0,v235
M v[84:87],a[172:175],a[164:167],v[84:87]
ds_read_b128 a[100:103],v249 offset:0
v_and_b32 v208,s42,v208
M v[88:91],a[172:175],a[168:171],v[88:91]
buffer_load_dwordx4 a[112:115],v250,s[20:23],s47 offen offset:0 sc1
M v[88:91],a[200:203],a[176:179],v[88:91]
ds_read_b128 a[120:123],v248 offset:512
ds_read_b128 a[140:143],v249 offset:512
M v[88:91],a[192:195],a[184:187],v[88:91]
buffer_load_dwordx4 a[124:127],v250,s[20:23],s47 offen offset:1024 sc1
M v[92:95],a[192:195],a[188:191],v[92:95]
v_and_b32 v204,s42,v204
v_and_b32 v206,s42,v206
M v[92:95],a[200:203],a[184:187],v[92:95]
v_and_b32 v214,s42,v214
v_and_b32 v212,s42,v212
M v[92:95],a[172:175],a[176:179],v[92:95]
s_waitcnt vmcnt(28) lgkmcnt(3)
v_and_b32 v210,s42,v210
v_fmac_f32 v204,s43,v208
M v[32:35],a[104:107],a[96:99],v[32:35]
s_waitcnt vmcnt(27) lgkmcnt(2)
buffer_load_dwordx4 a[144:147],v250,s[20:23],s47 offen offset:2048 sc1
M v[32:35],a[128:131],a[100:103],v[32:35]
s_waitcnt vmcnt(27) lgkmcnt(1)
ds_read_b128 a[160:163],v248 offset:1024
ds_read_b128 a[164:167],v249 offset:1024
M v[32:35],a[152:155],a[120:123],v[32:35]
s_waitcnt lgkmcnt(2)
s_add_u32 s34,s32,983040
v_fmac_f32 v214,4.0,v206
v_fma_f32 v235,-4.0,v208,v212
M v[36:39],a[152:155],a[140:143],v[36:39]
v_fmac_f32 v204,s45,v212
v_fmac_f32 v214,s41,v210
M v[36:39],a[128:131],a[120:123],v[36:39]
v_sub_f32 v212,v212,v208
v_fma_f32 v208,-4.0,v206,v210
M v[36:39],a[104:107],a[100:103],v[36:39]
buffer_store_dwordx4 a[84:87],v253,s[24:27],s34 offen offset:640 nt
M v[40:43],a[104:107],a[120:123],v[40:43]
ds_read_b128 a[168:171],v248 offset:1536
v_sub_f32 v210,v210,v206
M v[40:43],a[128:131],a[140:143],v[40:43]
s_waitcnt lgkmcnt(2)
ds_read_b128 a[172:175],v249 offset:1536
v_add_f32 v206,v235,v208
M v[40:43],a[152:155],a[160:163],v[40:43]
s_waitcnt lgkmcnt(2)
v_sub_f32 v235,v235,v208
v_fma_f32 v208,2.0,v210,v212
M v[44:47],a[152:155],a[164:167],v[44:47]
v_fmac_f32 v212,-2.0,v210
v_cvt_pk_bf16_f32 v204,v232,v204
M v[44:47],a[128:131],a[160:163],v[44:47]
v_cvt_pk_bf16_f32 v214,v237,v214
v_cvt_pk_bf16_f32 v206,v233,v206
M v[44:47],a[104:107],a[140:143],v[44:47]
v_cvt_pk_bf16_f32 v210,v234,v208
v_cvt_pk_bf16_f32 v208,v238,v235
M v[48:51],a[104:107],a[160:163],v[48:51]
s_add_u32 s48,s76,6144
ds_read_b128 a[176:179],v249 offset:2048
v_cvt_pk_bf16_f32 v212,v236,v212
M v[48:51],a[128:131],a[164:167],v[48:51]
s_waitcnt lgkmcnt(2)
ds_read_b128 a[184:187],v248 offset:2048
v_lshlrev_b32 v234,16,v209
M v[48:51],a[152:155],a[168:171],v[48:51]
s_waitcnt lgkmcnt(2)
v_lshlrev_b32 v232,16,v205
v_lshlrev_b32 v233,16,v207
M v[52:55],a[152:155],a[172:175],v[52:55]
v_lshlrev_b32 v237,16,v215
v_lshlrev_b32 v236,16,v213
M v[52:55],a[128:131],a[168:171],v[52:55]
v_lshlrev_b32 v235,16,v211
v_fmac_f32 v232,s43,v234
M v[52:55],a[104:107],a[164:167],v[52:55]
v_fmac_f32 v237,4.0,v233
v_fma_f32 v238,-4.0,v234,v236
M v[56:59],a[104:107],a[168:171],v[56:59]
buffer_load_dwordx4 a[188:191],v250,s[20:23],s48 offen offset:0 sc1
M v[56:59],a[128:131],a[172:175],v[56:59]
s_waitcnt lgkmcnt(1)
v_fmac_f32 v232,s45,v236
v_fmac_f32 v237,s41,v235
M v[56:59],a[152:155],a[176:179],v[56:59]
s_waitcnt lgkmcnt(0)
s_add_u32 s34,s32,1179648
buffer_load_dwordx4 a[228:231],v250,s[20:23],s48 offen offset:1024 sc1
M v[60:63],a[152:155],a[184:187],v[60:63]
v_sub_f32 v236,v236,v234
v_fma_f32 v234,-4.0,v233,v235
M v[60:63],a[128:131],a[176:179],v[60:63]
v_sub_f32 v235,v235,v233
v_add_f32 v233,v238,v234
M v[60:63],a[104:107],a[172:175],v[60:63]
s_waitcnt vmcnt(28)
v_sub_f32 v238,v238,v234
v_fma_f32 v234,2.0,v235,v236
M v[64:67],a[180:183],a[96:99],v[64:67]
s_waitcnt vmcnt(27)
buffer_load_dwordx4 a[224:227],v250,s[20:23],s48 offen offset:2048 sc1
M v[64:67],a[196:199],a[100:103],v[64:67]
s_waitcnt vmcnt(27)
v_fmac_f32 v236,-2.0,v235
v_and_b32 v209,s42,v209
M v[64:67],a[248:251],a[120:123],v[64:67]
v_and_b32 v205,s42,v205
v_and_b32 v207,s42,v207
M v[68:71],a[248:251],a[140:143],v[68:71]
v_and_b32 v215,s42,v215
v_and_b32 v213,s42,v213
M v[68:71],a[196:199],a[120:123],v[68:71]
v_and_b32 v211,s42,v211
v_fmac_f32 v205,s43,v209
M v[68:71],a[180:183],a[100:103],v[68:71]
buffer_store_dwordx4 a[88:91],v253,s[24:27],s34 offen offset:640 nt
M v[72:75],a[180:183],a[120:123],v[72:75]
v_fmac_f32 v215,4.0,v207
v_fma_f32 v235,-4.0,v209,v213
M v[72:75],a[196:199],a[140:143],v[72:75]
v_fmac_f32 v205,s45,v213
v_fmac_f32 v215,s41,v211
M v[72:75],a[248:251],a[160:163],v[72:75]
v_sub_f32 v213,v213,v209
v_fma_f32 v209,-4.0,v207,v211
M v[76:79],a[248:251],a[164:167],v[76:79]
v_sub_f32 v211,v211,v207
v_add_f32 v207,v235,v209
M v[76:79],a[196:199],a[160:163],v[76:79]
v_sub_f32 v235,v235,v209
v_fma_f32 v209,2.0,v211,v213
M v[76:79],a[180:183],a[140:143],v[76:79]
v_fmac_f32 v213,-2.0,v211
v_cvt_pk_bf16_f32 v205,v232,v205
M v[80:83],a[180:183],a[160:163],v[80:83]
s_add_u32 s47,s77,3072
v_cvt_pk_bf16_f32 v215,v237,v215
v_cvt_pk_bf16_f32 v207,v233,v207
M v[80:83],a[196:199],a[164:167],v[80:83]
v_cvt_pk_bf16_f32 v211,v234,v209
v_cvt_pk_bf16_f32 v209,v238,v235
M v[80:83],a[248:251],a[168:171],v[80:83]
s_add_u32 s34,s32,1376256
buffer_store_dwordx4 a[92:95],v253,s[24:27],s34 offen offset:640 nt
M v[84:87],a[248:251],a[172:175],v[84:87]
v_cvt_pk_bf16_f32 v213,v236,v213
M v[84:87],a[196:199],a[168:171],v[84:87]
s_barrier
ds_read_b128 a[96:99],v248 offset:17408
M v[84:87],a[180:183],a[164:167],v[84:87]
ds_write2st64_b64 v247,v[192:193],v[202:203] offset0:102 offset1:119
M v[88:91],a[180:183],a[168:171],v[88:91]
s_add_u32 s28,s66,7077888
buffer_load_dwordx2 v[192:193],v245,s[12:15],s28 offen offset:0
M v[88:91],a[196:199],a[172:175],v[88:91]
ds_read_b128 a[100:103],v249 offset:17408
ds_read_b128 a[120:123],v248 offset:17920
M v[88:91],a[248:251],a[176:179],v[88:91]
buffer_load_dwordx2 v[202:203],v245,s[16:19],s28 offen offset:1536
M v[92:95],a[248:251],a[184:187],v[92:95]
ds_read_b128 a[140:143],v249 offset:17920
v_fmac_f32 v239,s43,v241
M v[92:95],a[196:199],a[176:179],v[92:95]
v_fmac_f32 v244,4.0,v240
v_fma_f32 v232,-4.0,v241,v243
M v[92:95],a[180:183],a[172:175],v[92:95]
s_waitcnt vmcnt(28) lgkmcnt(4)
ds_write2st64_b64 v247,v[194:195],v[196:197] offset0:34 offset1:51
M v[32:35],a[116:119],a[96:99],v[32:35]
s_waitcnt vmcnt(27) lgkmcnt(3)
buffer_load_dwordx2 v[194:195],v245,s[8:11],s28 offen offset:0
M v[32:35],a[136:139],a[100:103],v[32:35]
s_waitcnt vmcnt(27) lgkmcnt(2)
ds_read_b128 a[160:163],v248 offset:18432
ds_read_b128 a[164:167],v249 offset:18432
M v[32:35],a[156:159],a[120:123],v[32:35]
s_waitcnt lgkmcnt(3)
ds_write2st64_b64 v247,v[198:199],v[200:201] offset0:68 offset1:85
M v[36:39],a[156:159],a[140:143],v[36:39]
buffer_load_dwordx2 v[196:197],v245,s[8:11],s28 offen offset:384
M v[36:39],a[136:139],a[120:123],v[36:39]
v_fmac_f32 v239,s45,v243
v_fmac_f32 v244,s41,v242
M v[36:39],a[116:119],a[100:103],v[36:39]
ds_write2st64_b64 v247,v[204:205],v[214:215] offset0:103 offset1:120
M v[40:43],a[116:119],a[120:123],v[40:43]
buffer_load_dwordx2 v[198:199],v245,s[8:11],s28 offen offset:768
M v[40:43],a[136:139],a[140:143],v[40:43]
s_waitcnt lgkmcnt(3)
ds_read_b128 a[168:171],v248 offset:18944
ds_read_b128 a[172:175],v249 offset:18944
M v[40:43],a[156:159],a[160:163],v[40:43]
s_waitcnt lgkmcnt(4)
s_add_u32 s34,s33,0
ds_write2st64_b64 v247,v[206:207],v[208:209] offset0:35 offset1:52
M v[44:47],a[156:159],a[164:167],v[44:47]
buffer_load_dwordx2 v[200:201],v245,s[8:11],s28 offen offset:1152
M v[44:47],a[136:139],a[160:163],v[44:47]
s_add_u32 s28,s66,7471104
v_sub_f32 v243,v243,v241
v_fma_f32 v241,-4.0,v240,v242
M v[44:47],a[116:119],a[140:143],v[44:47]
ds_write2st64_b64 v247,v[210:211],v[212:213] offset0:69 offset1:86
M v[48:51],a[116:119],a[160:163],v[48:51]
ds_read_b128 a[176:179],v249 offset:19456
v_sub_f32 v242,v242,v240
M v[48:51],a[136:139],a[164:167],v[48:51]
s_waitcnt lgkmcnt(4)
buffer_load_dwordx2 v[204:205],v245,s[12:15],s28 offen offset:0
M v[48:51],a[156:159],a[168:171],v[48:51]
s_waitcnt lgkmcnt(3)
ds_read_b128 a[180:183],v248 offset:19456
v_add_f32 v240,v232,v241
M v[52:55],a[156:159],a[172:175],v[52:55]
v_sub_f32 v232,v232,v241
v_fma_f32 v241,2.0,v242,v243
M v[52:55],a[136:139],a[168:171],v[52:55]
v_fmac_f32 v243,-2.0,v242
v_cvt_pk_bf16_f32 v233,v239,v244
M v[52:55],a[116:119],a[164:167],v[52:55]
buffer_load_dwordx2 v[214:215],v245,s[16:19],s28 offen offset:1536
M v[56:59],a[116:119],a[168:171],v[56:59]
v_cvt_pk_bf16_f32 v234,v240,v232
v_cvt_pk_bf16_f32 v235,v241,v243
M v[56:59],a[136:139],a[172:175],v[56:59]
s_waitcnt lgkmcnt(1)
ds_write_b16 v252,v233 offset:52224
M v[56:59],a[156:159],a[176:179],v[56:59]
s_waitcnt lgkmcnt(1)
ds_write_b16_d16_hi v252,v233 offset:60928
M v[60:63],a[156:159],a[180:183],v[60:63]
buffer_load_dwordx2 v[206:207],v245,s[8:11],s28 offen offset:0
M v[60:63],a[136:139],a[176:179],v[60:63]
ds_write_b16 v252,v234 offset:17408
M v[60:63],a[116:119],a[172:175],v[60:63]
s_waitcnt vmcnt(32)
ds_write_b16_d16_hi v252,v234 offset:26112
M v[64:67],a[216:219],a[96:99],v[64:67]
s_waitcnt vmcnt(31)
ds_write_b16 v252,v235 offset:34816
M v[64:67],a[244:247],a[100:103],v[64:67]
s_waitcnt vmcnt(30)
buffer_load_dwordx2 v[208:209],v245,s[8:11],s28 offen offset:384
M v[64:67],v[216:219],a[120:123],v[64:67]
ds_write_b16_d16_hi v252,v235 offset:43520
M v[68:71],v[216:219],a[140:143],v[68:71]
M v[68:71],a[244:247],a[120:123],v[68:71]
M v[68:71],a[216:219],a[100:103],v[68:71]
buffer_load_dwordx2 v[210:211],v245,s[8:11],s28 offen offset:768
M v[72:75],a[216:219],a[120:123],v[72:75]
M v[72:75],a[244:247],a[140:143],v[72:75]
M v[72:75],v[216:219],a[160:163],v[72:75]
M v[76:79],v[216:219],a[164:167],v[76:79]
buffer_load_dwordx2 v[212:213],v245,s[8:11],s28 offen offset:1152
M v[76:79],a[244:247],a[160:163],v[76:79]
s_add_u32 s29,s67,6291456
M v[76:79],a[216:219],a[140:143],v[76:79]
M v[80:83],a[216:219],a[160:163],v[80:83]
M v[80:83],a[244:247],a[164:167],v[80:83]
buffer_load_short_d16_hi v239,v246,s[12:15],s29 offen offset:0
M v[80:83],v[216:219],a[168:171],v[80:83]
M v[84:87],v[216:219],a[172:175],v[84:87]
buffer_load_short_d16_hi v240,v246,s[8:11],s29 offen offset:0
M v[84:87],a[244:247],a[168:171],v[84:87]
ds_read_b128 a[96:99],v248 offset:34816
M v[84:87],a[216:219],a[164:167],v[84:87]
buffer_load_short_d16_hi v241,v246,s[8:11],s29 offen offset:384
M v[88:91],a[216:219],a[168:171],v[88:91]
ds_read_b128 a[100:103],v249 offset:34816
ds_read_b128 a[120:123],v248 offset:35328
M v[88:91],a[244:247],a[172:175],v[88:91]
buffer_load_short_d16_hi v242,v246,s[8:11],s29 offen offset:768
M v[88:91],v[216:219],a[176:179],v[88:91]
ds_read_b128 a[140:143],v249 offset:35328
M v[92:95],v[216:219],a[180:183],v[92:95]
buffer_load_short_d16_hi v243,v246,s[8:11],s29 offen offset:1152
M v[92:95],a[244:247],a[176:179],v[92:95]
M v[92:95],a[216:219],a[172:175],v[92:95]
s_waitcnt vmcnt(35) lgkmcnt(3)
buffer_load_short_d16_hi v244,v246,s[16:19],s29 offen offset:1536
M v[32:35],a[108:111],a[96:99],v[32:35]
s_waitcnt vmcnt(35) lgkmcnt(2)
ds_read_b128 a[160:163],v248 offset:35840
M v[32:35],a[132:135],a[100:103],v[32:35]
s_waitcnt vmcnt(34) lgkmcnt(2)
buffer_load_dwordx4 a[104:107],v250,s[20:23],s47 offen offset:0 sc1
M v[32:35],a[148:151],a[120:123],v[32:35]
s_waitcnt lgkmcnt(1)
ds_read_b128 a[164:167],v249 offset:35840
M v[36:39],a[148:151],a[140:143],v[36:39]
M v[36:39],a[132:135],a[120:123],v[36:39]
M v[36:39],a[108:111],a[100:103],v[36:39]
buffer_load_dwordx4 a[128:131],v250,s[20:23],s47 offen offset:1024 sc1
M v[40:43],a[108:111],a[120:123],v[40:43]
ds_read_b128 a[168:171],v248 offset:36352
M v[40:43],a[132:135],a[140:143],v[40:43]
s_waitcnt lgkmcnt(2)
ds_read_b128 a[172:175],v249 offset:36352
M v[40:43],a[148:151],a[160:163],v[40:43]
s_waitcnt lgkmcnt(2)
M v[44:47],a[148:151],a[164:167],v[44:47]
buffer_load_dwordx4 a[152:155],v250,s[20:23],s47 offen offset:2048 sc1
M v[44:47],a[132:135],a[160:163],v[44:47]
s_add_u32 s48,s77,6144
M v[44:47],a[108:111],a[140:143],v[44:47]
s_waitcnt vmcnt(17)
v_lshlrev_b32 v234,16,v196
v_lshlrev_b32 v232,16,v192
M v[48:51],a[108:111],a[160:163],v[48:51]
ds_read_b128 a[176:179],v249 offset:36864
v_lshlrev_b32 v233,16,v194
M v[48:51],a[132:135],a[164:167],v[48:51]
s_waitcnt lgkmcnt(2)
buffer_load_dwordx4 a[184:187],v250,s[20:23],s48 offen offset:0 sc1
M v[48:51],a[148:151],a[168:171],v[48:51]
s_waitcnt lgkmcnt(1)
ds_read_b128 a[180:183],v248 offset:36864
v_lshlrev_b32 v237,16,v202
M v[52:55],a[148:151],a[172:175],v[52:55]
s_waitcnt vmcnt(16)
v_lshlrev_b32 v236,16,v200
v_lshlrev_b32 v235,16,v198
M v[52:55],a[132:135],a[168:171],v[52:55]
v_fmac_f32 v232,s43,v234
v_fmac_f32 v237,4.0,v233
M v[52:55],a[108:111],a[164:167],v[52:55]
buffer_store_dwordx4 v[96:99],v253,s[24:27],s34 offen offset:1152 nt
M v[56:59],a[108:111],a[168:171],v[56:59]
s_add_u32 s34,s33,393216
v_fma_f32 v238,-4.0,v234,v236
v_fmac_f32 v232,s45,v236
M v[56:59],a[132:135],a[172:175],v[56:59]
s_waitcnt lgkmcnt(1)
v_fmac_f32 v237,s41,v235
v_sub_f32 v236,v236,v234
M v[56:59],a[148:151],a[176:179],v[56:59]
s_waitcnt lgkmcnt(0)
buffer_load_dwordx4 a[204:207],v250,s[20:23],s48 offen offset:1024 sc1
M v[60:63],a[148:151],a[180:183],v[60:63]
v_fma_f32 v234,-4.0,v233,v235
v_sub_f32 v235,v235,v233
M v[60:63],a[132:135],a[176:179],v[60:63]
v_add_f32 v233,v238,v234
v_sub_f32 v238,v238,v234
M v[60:63],a[108:111],a[172:175],v[60:63]
v_fma_f32 v234,2.0,v235,v236
v_fmac_f32 v236,-2.0,v235
M v[64:67],a[212:215],a[96:99],v[64:67]
buffer_load_dwordx4 a[252:255],v250,s[20:23],s48 offen offset:2048 sc1
M v[64:67],v[228:231],a[100:103],v[64:67]
s_add_u32 s48,s72,52224
v_and_b32 v196,s42,v196
v_and_b32 v192,s42,v192
M v[64:67],v[224:227],a[120:123],v[64:67]
v_and_b32 v194,s42,v194
v_and_b32 v202,s42,v202
M v[68:71],v[224:227],a[140:143],v[68:71]
v_and_b32 v200,s42,v200
v_and_b32 v198,s42,v198
M v[68:71],v[228:231],a[120:123],v[68:71]
buffer_load_dwordx4 a[116:119],v250,s[20:23],s48 offen offset:0 sc1
M v[68:71],a[212:215],a[100:103],v[68:71]
v_fmac_f32 v192,s43,v196
v_fmac_f32 v202,4.0,v194
M v[72:75],a[212:215],a[120:123],v[72:75]
v_fma_f32 v235,-4.0,v196,v200
v_fmac_f32 v192,s45,v200
M v[72:75],v[228:231],a[140:143],v[72:75]
v_fmac_f32 v202,s41,v198
v_sub_f32 v200,v200,v196
M v[72:75],v[224:227],a[160:163],v[72:75]
buffer_store_dwordx4 v[104:107],v253,s[24:27],s34 offen offset:1152 nt
M v[76:79],v[224:227],a[164:167],v[76:79]
s_add_u32 s34,s33,786432
v_fma_f32 v196,-4.0,v194,v198
v_sub_f32 v198,v198,v194
M v[76:79],v[228:231],a[160:163],v[76:79]
v_add_f32 v194,v235,v196
v_sub_f32 v235,v235,v196
M v[76:79],a[212:215],a[140:143],v[76:79]
buffer_load_dwordx4 a[136:139],v250,s[20:23],s48 offen offset:1024 sc1
M v[80:83],a[212:215],a[160:163],v[80:83]
v_fma_f32 v196,2.0,v198,v200
v_fmac_f32 v200,-2.0,v198
M v[80:83],v[228:231],a[164:167],v[80:83]
v_cvt_pk_bf16_f32 v192,v232,v192
v_cvt_pk_bf16_f32 v202,v237,v202
M v[80:83],v[224:227],a[168:171],v[80:83]
v_cvt_pk_bf16_f32 v194,v233,v194
v_cvt_pk_bf16_f32 v198,v234,v196
M v[84:87],v[224:227],a[172:175],v[84:87]
buffer_load_dwordx4 a[156:159],v250,s[20:23],s48 offen offset:2048 sc1
M v[84:87],v[228:231],a[168:171],v[84:87]
s_add_u32 s48,s73,52224
ds_read_b128 a[96:99],v248 offset:52224
v_cvt_pk_bf16_f32 v196,v238,v235
M v[84:87],a[212:215],a[164:167],v[84:87]
ds_read_b128 a[100:103],v249 offset:52224
v_cvt_pk_bf16_f32 v200,v236,v200
M v[88:91],a[212:215],a[168:171],v[88:91]
ds_read_b128 a[120:123],v248 offset:52736
v_lshlrev_b32 v234,16,v197
M v[88:91],v[228:231],a[172:175],v[88:91]
buffer_load_dwordx4 a[236:239],v250,s[20:23],s48 offen offset:0 sc1
M v[88:91],v[224:227],a[176:179],v[88:91]
ds_read_b128 a[140:143],v249 offset:52736
v_lshlrev_b32 v232,16,v193
M v[92:95],v[224:227],a[180:183],v[92:95]
v_lshlrev_b32 v233,16,v195
v_lshlrev_b32 v237,16,v203
M v[92:95],v[228:231],a[176:179],v[92:95]
v_lshlrev_b32 v236,16,v201
v_lshlrev_b32 v235,16,v199
M v[92:95],a[212:215],a[172:175],v[92:95]
s_waitcnt lgkmcnt(3)
buffer_store_dwordx4 v[112:115],v253,s[24:27],s34 offen offset:1152 nt
M v[32:35],a[112:115],a[96:99],v[32:35]
s_waitcnt lgkmcnt(2)
s_add_u32 s34,s33,1179648
ds_read_b128 a[160:163],v248 offset:53248
v_fmac_f32 v232,s43,v234
M v[32:35],a[124:127],a[100:103],v[32:35]
s_waitcnt lgkmcnt(2)
ds_read_b128 a[164:167],v249 offset:53248
v_fmac_f32 v237,4.0,v233
M v[32:35],a[144:147],a[120:123],v[32:35]
s_waitcnt lgkmcnt(2)
buffer_store_dwordx4 v[120:123],v253,s[24:27],s34 offen offset:1152 nt
M v[36:39],a[144:147],a[140:143],v[36:39]
s_add_u32 s34,s33,0
v_fma_f32 v238,-4.0,v234,v236
v_fmac_f32 v232,s45,v236
M v[36:39],a[124:127],a[120:123],v[36:39]
v_fmac_f32 v237,s41,v235
v_sub_f32 v236,v236,v234
M v[36:39],a[112:115],a[100:103],v[36:39]
buffer_load_dwordx4 a[232:235],v250,s[20:23],s48 offen offset:1024 sc1
M v[40:43],a[112:115],a[120:123],v[40:43]
ds_read_b128 a[168:171],v248 offset:53760
v_fma_f32 v234,-4.0,v233,v235
M v[40:43],a[124:127],a[140:143],v[40:43]
s_waitcnt lgkmcnt(2)
ds_read_b128 a[172:175],v249 offset:53760
v_sub_f32 v235,v235,v233
M v[40:43],a[144:147],a[160:163],v[40:43]
s_waitcnt lgkmcnt(2)
v_add_f32 v233,v238,v234
v_sub_f32 v238,v238,v234
M v[44:47],a[144:147],a[164:167],v[44:47]
buffer_load_dwordx4 a[208:211],v250,s[20:23],s48 offen offset:2048 sc1
M v[44:47],a[124:127],a[160:163],v[44:47]
s_add_u32 s48,s74,52224
v_fma_f32 v234,2.0,v235,v236
v_fmac_f32 v236,-2.0,v235
M v[44:47],a[112:115],a[140:143],v[44:47]
v_and_b32 v197,s42,v197
v_and_b32 v193,s42,v193
M v[48:51],a[112:115],a[160:163],v[48:51]
ds_read_b128 a[176:179],v249 offset:54272
v_and_b32 v195,s42,v195
M v[48:51],a[124:127],a[164:167],v[48:51]
s_waitcnt lgkmcnt(2)
buffer_load_dwordx4 a[108:111],v250,s[20:23],s48 offen offset:0 sc1
M v[48:51],a[144:147],a[168:171],v[48:51]
s_waitcnt lgkmcnt(1)
ds_read_b128 a[180:183],v248 offset:54272
v_and_b32 v203,s42,v203
M v[52:55],a[144:147],a[172:175],v[52:55]
v_and_b32 v201,s42,v201
v_and_b32 v199,s42,v199
M v[52:55],a[124:127],a[168:171],v[52:55]
v_fmac_f32 v193,s43,v197
v_fmac_f32 v203,4.0,v195
M v[52:55],a[112:115],a[164:167],v[52:55]
buffer_store_dwordx4 v[128:131],v253,s[24:27],s34 offen offset:1280 nt
M v[56:59],a[112:115],a[168:171],v[56:59]
s_add_u32 s34,s33,393216
v_fma_f32 v235,-4.0,v197,v201
v_fmac_f32 v193,s45,v201
M v[56:59],a[124:127],a[172:175],v[56:59]
s_waitcnt lgkmcnt(1)
v_fmac_f32 v203,s41,v199
v_sub_f32 v201,v201,v197
M v[56:59],a[144:147],a[176:179],v[56:59]
s_waitcnt lgkmcnt(0)
buffer_load_dwordx4 a[132:135],v250,s[20:23],s48 offen offset:1024 sc1
M v[60:63],a[144:147],a[180:183],v[60:63]
v_fma_f32 v197,-4.0,v195,v199
v_sub_f32 v199,v199,v195
M v[60:63],a[124:127],a[176:179],v[60:63]
v_add_f32 v195,v235,v197
v_sub_f32 v235,v235,v197
M v[60:63],a[112:115],a[172:175],v[60:63]
v_fma_f32 v197,2.0,v199,v201
v_fmac_f32 v201,-2.0,v199
M v[64:67],a[188:191],a[96:99],v[64:67]
buffer_load_dwordx4 a[148:151],v250,s[20:23],s48 offen offset:2048 sc1
M v[64:67],a[228:231],a[100:103],v[64:67]
s_add_u32 s48,s75,52224
v_cvt_pk_bf16_f32 v193,v232,v193
v_cvt_pk_bf16_f32 v203,v237,v203
M v[64:67],a[224:227],a[120:123],v[64:67]
v_cvt_pk_bf16_f32 v195,v233,v195
v_cvt_pk_bf16_f32 v199,v234,v197
M v[68:71],a[224:227],a[140:143],v[68:71]
v_cvt_pk_bf16_f32 v197,v238,v235
v_cvt_pk_bf16_f32 v201,v236,v201
M v[68:71],a[228:231],a[120:123],v[68:71]
buffer_load_dwordx4 a[220:223],v250,s[20:23],s48 offen offset:0 sc1
M v[68:71],a[188:191],a[100:103],v[68:71]
ds_write2st64_b64 v247,v[192:193],v[202:203] offset0:104 offset1:121
M v[72:75],a[188:191],a[120:123],v[72:75]
s_waitcnt vmcnt(29)
s_add_u32 s28,s67,6291456
v_lshlrev_b32 v234,16,v208
v_lshlrev_b32 v232,16,v204
M v[72:75],a[228:231],a[140:143],v[72:75]
buffer_load_dwordx2 v[192:193],v245,s[12:15],s28 offen offset:0
M v[72:75],a[224:227],a[160:163],v[72:75]
ds_write2st64_b64 v247,v[194:195],v[196:197] offset0:36 offset1:53
M v[76:79],a[224:227],a[164:167],v[76:79]
v_lshlrev_b32 v233,16,v206
v_lshlrev_b32 v237,16,v214
M v[76:79],a[228:231],a[160:163],v[76:79]
buffer_load_dwordx2 v[202:203],v245,s[16:19],s28 offen offset:1536
M v[76:79],a[188:191],a[140:143],v[76:79]
ds_write2st64_b64 v247,v[198:199],v[200:201] offset0:70 offset1:87
M v[80:83],a[188:191],a[160:163],v[80:83]
s_waitcnt vmcnt(29)
v_lshlrev_b32 v236,16,v212
v_lshlrev_b32 v235,16,v210
M v[80:83],a[228:231],a[164:167],v[80:83]
buffer_load_dwordx2 v[194:195],v245,s[8:11],s28 offen offset:0
M v[80:83],a[224:227],a[168:171],v[80:83]
v_add_u32 v248,0xfffece00,v248
v_add_u32 v249,0xfffece00,v249
M v[84:87],a[224:227],a[172:175],v[84:87]
v_fmac_f32 v232,s43,v234
v_fmac_f32 v237,4.0,v233
M v[84:87],a[228:231],a[168:171],v[84:87]
ds_read_b128 a[96:99],v248 offset:60928
v_fma_f32 v238,-4.0,v234,v236
M v[84:87],a[188:191],a[164:167],v[84:87]
buffer_load_dwordx2 v[196:197],v245,s[8:11],s28 offen offset:384
M v[88:91],a[188:191],a[168:171],v[88:91]
ds_read_b128 a[100:103],v249 offset:60928
ds_read_b128 a[120:123],v248 offset:61440
M v[88:91],a[228:231],a[172:175],v[88:91]
ds_read_b128 a[140:143],v249 offset:61440
v_fmac_f32 v232,s45,v236
M v[88:91],a[224:227],a[176:179],v[88:91]
v_fmac_f32 v237,s41,v235
v_sub_f32 v236,v236,v234
M v[92:95],a[224:227],a[180:183],v[92:95]
buffer_load_dwordx2 v[198:199],v245,s[8:11],s28 offen offset:768
M v[92:95],a[228:231],a[176:179],v[92:95]
v_fma_f32 v234,-4.0,v233,v235
v_sub_f32 v235,v235,v233
M v[92:95],a[188:191],a[172:175],v[92:95]
s_waitcnt vmcnt(25) lgkmcnt(3)
v_add_f32 v233,v238,v234
v_sub_f32 v238,v238,v234
M v[32:35],a[104:107],a[96:99],v[32:35]
s_waitcnt vmcnt(24) lgkmcnt(2)
ds_read_b128 a[160:163],v248 offset:61952
v_fma_f32 v234,2.0,v235,v236
M v[32:35],a[128:131],a[100:103],v[32:35]
s_waitcnt vmcnt(23) lgkmcnt(2)
buffer_load_dwordx2 v[200:201],v245,s[8:11],s28 offen offset:1152
M v[32:35],a[152:155],a[120:123],v[32:35]
s_waitcnt lgkmcnt(1)
ds_read_b128 a[164:167],v249 offset:61952
v_fmac_f32 v236,-2.0,v235
M v[36:39],a[152:155],a[140:143],v[36:39]
v_and_b32 v208,s42,v208
v_and_b32 v204,s42,v204
M v[36:39],a[128:131],a[120:123],v[36:39]
v_and_b32 v206,s42,v206
v_and_b32 v214,s42,v214
M v[36:39],a[104:107],a[100:103],v[36:39]
buffer_store_dwordx4 v[136:139],v253,s[24:27],s34 offen offset:1280 nt
M v[40:43],a[104:107],a[120:123],v[40:43]
s_add_u32 s34,s33,786432
ds_read_b128 a[168:171],v248 offset:62464
v_and_b32 v212,s42,v212
M v[40:43],a[128:131],a[140:143],v[40:43]
s_waitcnt lgkmcnt(2)
ds_read_b128 a[172:175],v249 offset:62464
v_and_b32 v210,s42,v210
M v[40:43],a[152:155],a[160:163],v[40:43]
s_waitcnt lgkmcnt(2)
buffer_load_dwordx4 v[220:223],v250,s[20:23],s48 offen offset:1024 sc1
M v[44:47],a[152:155],a[164:167],v[44:47]
v_fmac_f32 v204,s43,v208
v_fmac_f32 v214,4.0,v206
M v[44:47],a[128:131],a[160:163],v[44:47]
v_fma_f32 v235,-4.0,v208,v212
v_fmac_f32 v204,s45,v212
M v[44:47],a[104:107],a[140:143],v[44:47]
v_fmac_f32 v214,s41,v210
v_sub_f32 v212,v212,v208
M v[48:51],a[104:107],a[160:163],v[48:51]
buffer_load_dwordx4 a[240:243],v250,s[20:23],s48 offen offset:2048 sc1
M v[48:51],a[128:131],a[164:167],v[48:51]
s_waitcnt lgkmcnt(1)
s_add_u32 s48,s76,52224
ds_read_b128 a[176:179],v249 offset:62976
ds_read_b128 a[180:183],v248 offset:62976
M v[48:51],a[152:155],a[168:171],v[48:51]
s_waitcnt lgkmcnt(2)
v_fma_f32 v208,-4.0,v206,v210
v_sub_f32 v210,v210,v206
M v[52:55],a[152:155],a[172:175],v[52:55]
v_add_f32 v206,v235,v208
v_sub_f32 v235,v235,v208
M v[52:55],a[128:131],a[168:171],v[52:55]
buffer_load_dwordx4 a[112:115],v250,s[20:23],s48 offen offset:0 sc1
M v[52:55],a[104:107],a[164:167],v[52:55]
v_fma_f32 v208,2.0,v210,v212
v_fmac_f32 v212,-2.0,v210
M v[56:59],a[104:107],a[168:171],v[56:59]
v_cvt_pk_bf16_f32 v204,v232,v204
v_cvt_pk_bf16_f32 v214,v237,v214
M v[56:59],a[128:131],a[172:175],v[56:59]
s_waitcnt lgkmcnt(1)
v_cvt_pk_bf16_f32 v206,v233,v206
v_cvt_pk_bf16_f32 v210,v234,v208
M v[56:59],a[152:155],a[176:179],v[56:59]
s_waitcnt lgkmcnt(0)
buffer_store_dwordx4 v[144:147],v253,s[24:27],s34 offen offset:1280 nt
M v[60:63],a[152:155],a[180:183],v[60:63]
s_add_u32 s34,s33,1179648
v_cvt_pk_bf16_f32 v208,v238,v235
v_cvt_pk_bf16_f32 v212,v236,v212
M v[60:63],a[128:131],a[176:179],v[60:63]
v_lshlrev_b32 v234,16,v209
v_lshlrev_b32 v232,16,v205
M v[60:63],a[104:107],a[172:175],v[60:63]
s_waitcnt vmcnt(28)
buffer_store_dwordx4 v[152:155],v253,s[24:27],s34 offen offset:1280 nt
M v[64:67],a[184:187],a[96:99],v[64:67]
s_waitcnt vmcnt(27)
v_lshlrev_b32 v233,16,v207
v_lshlrev_b32 v237,16,v215
M v[64:67],a[204:207],a[100:103],v[64:67]
s_waitcnt vmcnt(26)
v_lshlrev_b32 v236,16,v213
v_lshlrev_b32 v235,16,v211
M v[64:67],a[252:255],a[120:123],v[64:67]
buffer_load_dwordx4 a[124:127],v250,s[20:23],s48 offen offset:1024 sc1
M v[68:71],a[252:255],a[140:143],v[68:71]
v_fmac_f32 v232,s43,v234
v_fmac_f32 v237,4.0,v233
M v[68:71],a[204:207],a[120:123],v[68:71]
v_fma_f32 v238,-4.0,v234,v236
v_fmac_f32 v232,s45,v236
M v[68:71],a[184:187],a[100:103],v[68:71]
v_fmac_f32 v237,s41,v235
v_sub_f32 v236,v236,v234
M v[72:75],a[184:187],a[120:123],v[72:75]
buffer_load_dwordx4 a[144:147],v250,s[20:23],s48 offen offset:2048 sc1
M v[72:75],a[204:207],a[140:143],v[72:75]
s_add_u32 s48,s77,52224
v_fma_f32 v234,-4.0,v233,v235
v_sub_f32 v235,v235,v233
M v[72:75],a[252:255],a[160:163],v[72:75]
v_add_f32 v233,v238,v234
v_sub_f32 v238,v238,v234
M v[76:79],a[252:255],a[164:167],v[76:79]
v_fma_f32 v234,2.0,v235,v236
v_fmac_f32 v236,-2.0,v235
M v[76:79],a[204:207],a[160:163],v[76:79]
buffer_load_dwordx4 a[188:191],v250,s[20:23],s48 offen offset:0 sc1
M v[76:79],a[184:187],a[140:143],v[76:79]
v_and_b32 v209,s42,v209
v_and_b32 v205,s42,v205
M v[80:83],a[184:187],a[160:163],v[80:83]
v_and_b32 v207,s42,v207
v_and_b32 v215,s42,v215
M v[80:83],a[204:207],a[164:167],v[80:83]
v_and_b32 v213,s42,v213
v_and_b32 v211,s42,v211
M v[80:83],a[252:255],a[168:171],v[80:83]
buffer_load_dwordx4 a[192:195],v250,s[20:23],s48 offen offset:1024 sc1
M v[84:87],a[252:255],a[172:175],v[84:87]
v_fmac_f32 v205,s43,v209
v_fmac_f32 v215,4.0,v207
M v[84:87],a[204:207],a[168:171],v[84:87]
ds_read_b128 a[96:99],v248 offset:0
v_fma_f32 v235,-4.0,v209,v213
M v[84:87],a[184:187],a[164:167],v[84:87]
ds_read_b128 a[100:103],v249 offset:0
v_fmac_f32 v205,s45,v213
M v[88:91],a[184:187],a[168:171],v[88:91]
buffer_load_dwordx4 a[200:203],v250,s[20:23],s48 offen offset:2048 sc1
M v[88:91],a[204:207],a[172:175],v[88:91]
s_add_u32 s46,s72,9216
ds_read_b128 a[120:123],v248 offset:512
ds_read_b128 a[140:143],v249 offset:512
M v[88:91],a[252:255],a[176:179],v[88:91]
v_fmac_f32 v215,s41,v211
v_sub_f32 v213,v213,v209
M v[92:95],a[252:255],a[180:183],v[92:95]
v_fma_f32 v209,-4.0,v207,v211
v_sub_f32 v211,v211,v207
M v[92:95],a[204:207],a[176:179],v[92:95]
buffer_load_dwordx4 a[104:107],v250,s[20:23],s46 offen offset:0 sc1
M v[92:95],a[184:187],a[172:175],v[92:95]
s_waitcnt vmcnt(31) lgkmcnt(3)
v_add_f32 v207,v235,v209
v_sub_f32 v235,v235,v209
M v[160:163],a[116:119],a[96:99],v[160:163]
s_waitcnt vmcnt(29) lgkmcnt(2)
ds_read_b128 a[96:99],v248 offset:1024
v_fma_f32 v209,2.0,v211,v213
M v[160:163],a[136:139],a[100:103],v[160:163]
s_waitcnt vmcnt(28) lgkmcnt(2)
ds_read_b128 a[160:163],v249 offset:1024
v_fmac_f32 v213,-2.0,v211
M v[160:163],a[156:159],a[120:123],v[160:163]
s_waitcnt lgkmcnt(2)
buffer_load_dwordx4 a[128:131],v250,s[20:23],s46 offen offset:1024 sc1
M v[164:167],a[156:159],a[140:143],v[164:167]
v_cvt_pk_bf16_f32 v205,v232,v205
v_cvt_pk_bf16_f32 v215,v237,v215
M v[164:167],a[136:139],a[120:123],v[164:167]
v_cvt_pk_bf16_f32 v207,v233,v207
v_cvt_pk_bf16_f32 v211,v234,v209
M v[164:167],a[116:119],a[100:103],v[164:167]
v_cvt_pk_bf16_f32 v209,v238,v235
v_cvt_pk_bf16_f32 v213,v236,v213
M v[168:171],a[116:119],a[120:123],v[168:171]
s_barrier
ds_read_b128 a[100:103],v248 offset:1536
M v[168:171],a[136:139],a[140:143],v[168:171]
s_waitcnt lgkmcnt(2)
buffer_load_dwordx4 a[152:155],v250,s[20:23],s46 offen offset:2048 sc1
M v[168:171],a[156:159],a[96:99],v[168:171]
s_waitcnt lgkmcnt(1)
ds_write2st64_b64 v247,v[204:205],v[214:215] offset0:105 offset1:122
M v[172:175],a[156:159],a[160:163],v[172:175]
s_add_u32 s28,s67,6684672
ds_read_b128 a[120:123],v249 offset:1536
v_cvt_pk_bf16_f32 v32,v32,v33
M v[172:175],a[136:139],a[96:99],v[172:175]
buffer_load_dwordx2 v[204:205],v245,s[12:15],s28 offen offset:0
M v[172:175],a[116:119],a[140:143],v[172:175]
ds_write2st64_b64 v247,v[206:207],v[208:209] offset0:37 offset1:54
M v[176:179],a[116:119],a[96:99],v[176:179]
s_add_u32 s47,s72,12288
ds_read_b128 a[96:99],v249 offset:2048
v_cvt_pk_bf16_f32 v33,v34,v35
M v[176:179],a[136:139],a[160:163],v[176:179]
s_waitcnt lgkmcnt(4)
buffer_load_dwordx2 v[214:215],v245,s[16:19],s28 offen offset:1536
M v[176:179],a[156:159],a[100:103],v[176:179]
s_waitcnt lgkmcnt(2)
ds_write2st64_b64 v247,v[210:211],v[212:213] offset0:71 offset1:88
M v[180:183],a[156:159],a[120:123],v[180:183]
ds_read_b128 a[140:143],v248 offset:2048
v_add_u32 v248,0x15400,v248
M v[180:183],a[136:139],a[100:103],v[180:183]
buffer_load_dwordx2 v[206:207],v245,s[8:11],s28 offen offset:0
M v[180:183],a[116:119],a[160:163],v[180:183]
v_add_u32 v249,0x15400,v249
v_cvt_pk_bf16_f32 v36,v36,v37
M v[184:187],a[116:119],a[100:103],v[184:187]
ds_read_b128 a[164:167],v248 offset:0
ds_read_b128 a[160:163],v249 offset:0
M v[184:187],a[136:139],a[120:123],v[184:187]
s_waitcnt lgkmcnt(4)
ds_read_b128 a[168:171],v248 offset:512
ds_read_b128 a[176:179],v249 offset:512
M v[184:187],a[156:159],a[96:99],v[184:187]
s_waitcnt lgkmcnt(4)
buffer_load_dwordx2 v[208:209],v245,s[8:11],s28 offen offset:384
M v[188:191],a[156:159],a[140:143],v[188:191]
v_cvt_pk_bf16_f32 v37,v38,v39
M v[188:191],a[136:139],a[96:99],v[188:191]
ds_write2st64_b64 v254,v[32:33],v[36:37] offset0:0 offset1:4
M v[188:191],a[116:119],a[120:123],v[188:191]
s_waitcnt vmcnt(33) lgkmcnt(4)
buffer_load_dwordx2 v[210:211],v245,s[8:11],s28 offen offset:768
M v[160:163],a[236:239],a[164:167],v[160:163]
s_waitcnt vmcnt(31) lgkmcnt(3)
ds_read_b128 a[96:99],v248 offset:1024
v_cvt_pk_bf16_f32 v40,v40,v41
M v[160:163],a[232:235],a[160:163],v[160:163]
s_waitcnt vmcnt(30) lgkmcnt(3)
ds_read_b128 a[116:119],v249 offset:1024
v_cvt_pk_bf16_f32 v41,v42,v43
M v[160:163],a[208:211],a[168:171],v[160:163]
s_waitcnt lgkmcnt(3)
v_cvt_pk_bf16_f32 v44,v44,v45
v_cvt_pk_bf16_f32 v45,v46,v47
M v[164:167],a[208:211],a[176:179],v[164:167]
buffer_load_dwordx2 v[212:213],v245,s[8:11],s28 offen offset:1152
M v[164:167],a[232:235],a[168:171],v[164:167]
ds_write2st64_b64 v254,v[40:41],v[44:45] offset0:8 offset1:12
M v[164:167],a[236:239],a[160:163],v[164:167]
v_cvt_pk_bf16_f32 v48,v48,v49
v_cvt_pk_bf16_f32 v49,v50,v51
M v[168:171],a[236:239],a[168:171],v[168:171]
ds_read_b128 a[120:123],v248 offset:1536
v_cvt_pk_bf16_f32 v52,v52,v53
M v[168:171],a[232:235],a[176:179],v[168:171]
s_waitcnt lgkmcnt(3)
buffer_load_dwordx4 a[100:103],v250,s[20:23],s47 offen offset:0 sc1
M v[168:171],a[208:211],a[96:99],v[168:171]
s_waitcnt lgkmcnt(2)
ds_read_b128 a[136:139],v249 offset:1536
v_cvt_pk_bf16_f32 v53,v54,v55
M v[172:175],a[208:211],a[116:119],v[172:175]
ds_write2st64_b64 v254,v[48:49],v[52:53] offset0:136 offset1:140
M v[172:175],a[232:235],a[96:99],v[172:175]
buffer_load_dwordx4 a[172:175],v250,s[20:23],s47 offen offset:1024 sc1
M v[172:175],a[236:239],a[176:179],v[172:175]
v_cvt_pk_bf16_f32 v56,v56,v57
v_cvt_pk_bf16_f32 v57,v58,v59
M v[176:179],a[236:239],a[96:99],v[176:179]
ds_read_b128 a[96:99],v249 offset:2048
v_cvt_pk_bf16_f32 v60,v60,v61
M v[176:179],a[232:235],a[116:119],v[176:179]
s_waitcnt lgkmcnt(3)
ds_read_b128 a[140:143],v248 offset:2048
v_cvt_pk_bf16_f32 v61,v62,v63
M v[176:179],a[208:211],a[120:123],v[176:179]
s_waitcnt lgkmcnt(3)
buffer_load_dwordx4 a[180:183],v250,s[20:23],s47 offen offset:2048 sc1
M v[180:183],a[208:211],a[136:139],v[180:183]
s_add_u32 s48,s72,15360
ds_write2st64_b64 v254,v[56:57],v[60:61] offset0:144 offset1:148
M v[180:183],a[232:235],a[120:123],v[180:183]
ds_read_b128 a[156:159],v248 offset:17408
v_cvt_pk_bf16_f32 v64,v64,v65
M v[180:183],a[236:239],a[116:119],v[180:183]
ds_read_b128 a[116:119],v249 offset:17408
v_cvt_pk_bf16_f32 v65,v66,v67
M v[184:187],a[236:239],a[120:123],v[184:187]
buffer_load_dwordx4 a[120:123],v250,s[20:23],s48 offen offset:0 sc1
M v[184:187],a[232:235],a[136:139],v[184:187]
s_waitcnt lgkmcnt(4)
ds_read_b128 a[160:163],v248 offset:17920
ds_read_b128 a[168:171],v249 offset:17920
M v[184:187],a[208:211],a[96:99],v[184:187]
s_waitcnt lgkmcnt(5)
v_cvt_pk_bf16_f32 v68,v68,v69
v_cvt_pk_bf16_f32 v69,v70,v71
M v[188:191],a[208:211],a[140:143],v[188:191]
buffer_load_dwordx4 a[164:167],v250,s[20:23],s48 offen offset:1024 sc1
M v[188:191],a[232:235],a[96:99],v[188:191]
ds_write2st64_b64 v254,v[64:65],v[68:69] offset0:170 offset1:174
M v[188:191],a[236:239],a[136:139],v[188:191]
s_waitcnt vmcnt(35) lgkmcnt(4)
v_cvt_pk_bf16_f32 v72,v72,v73
v_cvt_pk_bf16_f32 v73,v74,v75
M v[160:163],a[108:111],a[156:159],v[160:163]
s_waitcnt vmcnt(33) lgkmcnt(3)
buffer_load_dwordx4 a[176:179],v250,s[20:23],s48 offen offset:2048 sc1
M v[160:163],a[132:135],a[116:119],v[160:163]
s_waitcnt vmcnt(33) lgkmcnt(2)
ds_read_b128 a[96:99],v248 offset:18432
ds_read_b128 a[136:139],v249 offset:18432
M v[160:163],a[148:151],a[160:163],v[160:163]
s_waitcnt lgkmcnt(3)
v_cvt_pk_bf16_f32 v76,v76,v77
v_cvt_pk_bf16_f32 v77,v78,v79
M v[164:167],a[148:151],a[168:171],v[164:167]
ds_write2st64_b64 v254,v[72:73],v[76:77] offset0:178 offset1:182
M v[164:167],a[132:135],a[160:163],v[164:167]
v_cvt_pk_bf16_f32 v80,v80,v81
v_cvt_pk_bf16_f32 v81,v82,v83
M v[164:167],a[108:111],a[116:119],v[164:167]
v_cvt_pk_bf16_f32 v84,v84,v85
v_cvt_pk_bf16_f32 v85,v86,v87
M v[168:171],a[108:111],a[160:163],v[168:171]
ds_read_b128 a[116:119],v248 offset:18944
ds_write2st64_b64 v254,v[80:81],v[84:85] offset0:204 offset1:208
M v[168:171],a[132:135],a[168:171],v[168:171]
s_waitcnt lgkmcnt(4)
ds_read_b128 a[140:143],v249 offset:18944
v_cvt_pk_bf16_f32 v88,v88,v89
M v[168:171],a[148:151],a[96:99],v[168:171]
s_waitcnt lgkmcnt(4)
v_cvt_pk_bf16_f32 v89,v90,v91
v_cvt_pk_bf16_f32 v92,v92,v93
M v[172:175],a[148:151],a[136:139],v[172:175]
v_cvt_pk_bf16_f32 v93,v94,v95
M v[172:175],a[132:135],a[96:99],v[172:175]
ds_write2st64_b64 v254,v[88:89],v[92:93] offset0:212 offset1:216
M v[172:175],a[108:111],a[168:171],v[172:175]
M v[176:179],a[108:111],a[96:99],v[176:179]
s_add_u32 s46,s72,18432
ds_read_b128 a[96:99],v249 offset:19456
M v[176:179],a[132:135],a[136:139],v[176:179]
s_waitcnt lgkmcnt(1)
s_barrier
ds_read_b128 v[32:35],v250 offset:0
M v[176:179],a[148:151],a[116:119],v[176:179]
ds_read_b128 v[40:43],v250 offset:4096
ds_read_b128 v[48:51],v4 offset:0
M v[180:183],a[148:151],a[140:143],v[180:183]
ds_read_b128 v[56:59],v4 offset:4096
ds_read_b128 v[64:67],v4 offset:17408
M v[180:183],a[132:135],a[116:119],v[180:183]
ds_read_b128 v[72:75],v4 offset:21504
ds_read_b128 v[80:83],v4 offset:34816
ds_read_b128 a[156:159],v248 offset:19456
M v[180:183],a[108:111],a[136:139],v[180:183]
ds_read_b128 v[88:91],v4 offset:38912
ds_read_b128 a[160:163],v248 offset:34816
M v[184:187],a[108:111],a[116:119],v[184:187]
s_add_u32 s34,s33,0
buffer_load_dwordx4 a[168:171],v250,s[20:23],s46 offen offset:0 sc1
M v[184:187],a[132:135],a[140:143],v[184:187]
s_waitcnt lgkmcnt(10)
ds_read_b128 a[136:139],v249 offset:34816
ds_read_b128 a[116:119],v248 offset:35328
M v[184:187],a[148:151],a[96:99],v[184:187]
s_waitcnt lgkmcnt(4)
buffer_store_dwordx4 v[32:35],v253,s[24:27],s34 offen offset:128 nt
M v[188:191],a[148:151],a[156:159],v[188:191]
s_add_u32 s34,s33,393216
ds_read_b128 a[248:251],v249 offset:35328
M v[188:191],a[132:135],a[96:99],v[188:191]
M v[188:191],a[108:111],a[140:143],v[188:191]
s_waitcnt vmcnt(34) lgkmcnt(3)
buffer_store_dwordx4 v[40:43],v253,s[24:27],s34 offen offset:128 nt
M v[160:163],a[220:223],a[160:163],v[160:163]
s_waitcnt vmcnt(27) lgkmcnt(2)
s_add_u32 s34,s33,786432
ds_read_b128 a[96:99],v248 offset:35840
M v[160:163],v[220:223],a[136:139],v[160:163]
s_waitcnt vmcnt(26) lgkmcnt(2)
ds_read_b128 a[108:111],v249 offset:35840
M v[160:163],a[240:243],a[116:119],v[160:163]
s_waitcnt lgkmcnt(2)
buffer_store_dwordx4 v[48:51],v253,s[24:27],s34 offen offset:128 nt
M v[164:167],a[240:243],a[248:251],v[164:167]
s_add_u32 s34,s33,1179648
M v[164:167],v[220:223],a[116:119],v[164:167]
M v[164:167],a[220:223],a[136:139],v[164:167]
buffer_store_dwordx4 v[56:59],v253,s[24:27],s34 offen offset:128 nt
M v[168:171],a[220:223],a[116:119],v[168:171]
s_add_u32 s34,s33,0
ds_read_b128 a[116:119],v248 offset:36352
M v[168:171],v[220:223],a[248:251],v[168:171]
s_waitcnt lgkmcnt(2)
ds_read_b128 a[132:135],v249 offset:36352
M v[168:171],a[240:243],a[96:99],v[168:171]
s_waitcnt lgkmcnt(2)
buffer_store_dwordx4 v[64:67],v253,s[24:27],s34 offen offset:256 nt
M v[172:175],a[240:243],a[108:111],v[172:175]
s_add_u32 s34,s33,393216
M v[172:175],v[220:223],a[96:99],v[172:175]
M v[172:175],a[220:223],a[248:251],v[172:175]
buffer_store_dwordx4 v[72:75],v253,s[24:27],s34 offen offset:256 nt
M v[176:179],a[220:223],a[96:99],v[176:179]
s_add_u32 s34,s33,786432
ds_read_b128 a[96:99],v249 offset:36864
M v[176:179],v[220:223],a[108:111],v[176:179]
s_waitcnt lgkmcnt(2)
ds_read_b128 a[136:139],v248 offset:36864
M v[176:179],a[240:243],a[116:119],v[176:179]
s_waitcnt lgkmcnt(2)
buffer_load_dwordx4 a[184:187],v250,s[20:23],s46 offen offset:1024 sc1
M v[180:183],a[240:243],a[132:135],v[180:183]
M v[180:183],v[220:223],a[116:119],v[180:183]
ds_read_b128 a[140:143],v248 offset:52224
M v[180:183],a[220:223],a[108:111],v[180:183]
ds_read_b128 a[108:111],v249 offset:52224
M v[184:187],a[220:223],a[116:119],v[184:187]
buffer_load_dwordx4 a[196:199],v250,s[20:23],s46 offen offset:2048 sc1
M v[184:187],v[220:223],a[132:135],v[184:187]
s_waitcnt lgkmcnt(3)
s_add_u32 s47,s72,21504
ds_read_b128 a[116:119],v248 offset:52736
ds_read_b128 a[148:151],v249 offset:52736
M v[184:187],a[240:243],a[96:99],v[184:187]
s_waitcnt lgkmcnt(4)
M v[188:191],a[240:243],a[136:139],v[188:191]
M v[188:191],v[220:223],a[96:99],v[188:191]
buffer_load_dwordx4 v[216:219],v250,s[20:23],s47 offen offset:0 sc1
M v[188:191],a[220:223],a[132:135],v[188:191]
s_waitcnt vmcnt(32) lgkmcnt(3)
M v[160:163],a[112:115],a[140:143],v[160:163]
s_waitcnt vmcnt(29) lgkmcnt(2)
ds_read_b128 a[96:99],v248 offset:53248
M v[160:163],a[124:127],a[108:111],v[160:163]
s_waitcnt vmcnt(28) lgkmcnt(2)
ds_read_b128 a[132:135],v249 offset:53248
M v[160:163],a[144:147],a[116:119],v[160:163]
s_waitcnt lgkmcnt(2)
buffer_store_dwordx4 v[80:83],v253,s[24:27],s34 offen offset:256 nt
M v[164:167],a[144:147],a[148:151],v[164:167]
s_add_u32 s34,s33,1179648
M v[164:167],a[124:127],a[116:119],v[164:167]
M v[164:167],a[112:115],a[108:111],v[164:167]
buffer_store_dwordx4 v[88:91],v253,s[24:27],s34 offen offset:256 nt
M v[168:171],a[112:115],a[116:119],v[168:171]
ds_read_b128 a[108:111],v248 offset:53760
M v[168:171],a[124:127],a[148:151],v[168:171]
s_waitcnt lgkmcnt(2)
ds_read_b128 a[116:119],v249 offset:53760
M v[168:171],a[144:147],a[96:99],v[168:171]
s_waitcnt lgkmcnt(2)
buffer_load_dwordx4 a[160:163],v250,s[20:23],s47 offen offset:1024 sc1
M v[172:175],a[144:147],a[132:135],v[172:175]
M v[172:175],a[124:127],a[96:99],v[172:175]
M v[172:175],a[112:115],a[148:151],v[172:175]
M v[176:179],a[112:115],a[96:99],v[176:179]
buffer_load_dwordx4 a[244:247],v250,s[20:23],s47 offen offset:2048 sc1
M v[176:179],a[124:127],a[132:135],v[176:179]
s_waitcnt lgkmcnt(1)
s_add_u32 s48,s72,24576
ds_read_b128 a[96:99],v249 offset:54272
ds_read_b128 a[136:139],v248 offset:54272
M v[176:179],a[144:147],a[108:111],v[176:179]
s_waitcnt lgkmcnt(2)
v_add_u32 v248,0xfffece00,v248
v_add_u32 v249,0xfffece00,v249
M v[180:183],a[144:147],a[116:119],v[180:183]
M v[180:183],a[124:127],a[108:111],v[180:183]
ds_read_b128 a[140:143],v248 offset:60928
M v[180:183],a[112:115],a[132:135],v[180:183]
ds_read_b128 a[132:135],v249 offset:60928
M v[184:187],a[112:115],a[108:111],v[184:187]
buffer_load_dwordx4 a[216:219],v250,s[20:23],s48 offen offset:0 sc1
M v[184:187],a[124:127],a[116:119],v[184:187]
s_waitcnt lgkmcnt(3)
ds_read_b128 a[108:111],v248 offset:61440
ds_read_b128 a[148:151],v249 offset:61440
M v[184:187],a[144:147],a[96:99],v[184:187]
s_waitcnt lgkmcnt(4)
buffer_load_dwordx4 v[224:227],v250,s[20:23],s48 offen offset:1024 sc1
M v[188:191],a[144:147],a[136:139],v[188:191]
M v[188:191],a[124:127],a[96:99],v[188:191]
M v[188:191],a[112:115],a[116:119],v[188:191]
s_waitcnt vmcnt(33) lgkmcnt(3)
M v[160:163],a[188:191],a[140:143],v[160:163]
s_waitcnt vmcnt(32) lgkmcnt(2)
buffer_load_dwordx4 v[228:231],v250,s[20:23],s48 offen offset:2048 sc1
M v[160:163],a[192:195],a[132:135],v[160:163]
s_waitcnt vmcnt(32) lgkmcnt(1)
ds_read_b128 a[96:99],v248 offset:61952
ds_read_b128 a[112:115],v249 offset:61952
M v[160:163],a[200:203],a[108:111],v[160:163]
s_waitcnt lgkmcnt(2)
M v[164:167],a[200:203],a[148:151],v[164:167]
M v[164:167],a[192:195],a[108:111],v[164:167]
M v[164:167],a[188:191],a[132:135],v[164:167]
s_nop 3
v_cvt_pk_bf16_f32 v160,v160,v161
v_cvt_pk_bf16_f32 v161,v162,v163
M v[168:171],a[188:191],a[108:111],v[168:171]
ds_read_b128 a[108:111],v248 offset:62464
M v[168:171],a[192:195],a[148:151],v[168:171]
s_waitcnt lgkmcnt(2)
ds_read_b128 a[116:119],v249 offset:62464
M v[168:171],a[200:203],a[96:99],v[168:171]
s_waitcnt lgkmcnt(2)
v_cvt_pk_bf16_f32 v164,v164,v165
v_cvt_pk_bf16_f32 v165,v166,v167
M v[172:175],a[200:203],a[112:115],v[172:175]
M v[172:175],a[192:195],a[96:99],v[172:175]
ds_read_b128 a[124:127],v249 offset:62976
ds_read_b128 a[132:135],v248 offset:62976
M v[172:175],a[188:191],a[148:151],v[172:175]
M v[176:179],a[188:191],a[96:99],v[176:179]
s_add_u32 s46,s72,27648
M v[176:179],a[192:195],a[112:115],v[176:179]
s_waitcnt lgkmcnt(3)
M v[176:179],a[200:203],a[108:111],v[176:179]
s_waitcnt lgkmcnt(0)
s_barrier
ds_write2st64_b64 v254,v[160:161],v[164:165] offset0:221 offset1:225
M v[180:183],a[200:203],a[116:119],v[180:183]
v_cvt_pk_bf16_f32 v168,v168,v169
v_cvt_pk_bf16_f32 v169,v170,v171
M v[180:183],a[192:195],a[108:111],v[180:183]
ds_read_b128 a[96:99],v248 offset:0
v_cvt_pk_bf16_f32 v172,v172,v173
M v[180:183],a[188:191],a[112:115],v[180:183]
ds_read_b128 a[112:115],v249 offset:0
v_cvt_pk_bf16_f32 v173,v174,v175
M v[184:187],a[188:191],a[108:111],v[184:187]
buffer_load_dwordx4 a[212:215],v250,s[20:23],s46 offen offset:0 sc1
M v[184:187],a[192:195],a[116:119],v[184:187]
ds_read_b128 a[108:111],v248 offset:512
ds_read_b128 a[136:139],v249 offset:512
M v[184:187],a[200:203],a[124:127],v[184:187]
ds_write2st64_b64 v254,v[168:169],v[172:173] offset0:229 offset1:233
M v[188:191],a[200:203],a[132:135],v[188:191]
v_cvt_pk_bf16_f32 v176,v176,v177
v_cvt_pk_bf16_f32 v177,v178,v179
M v[188:191],a[192:195],a[124:127],v[188:191]
v_cvt_pk_bf16_f32 v180,v180,v181
v_cvt_pk_bf16_f32 v181,v182,v183
M v[188:191],a[188:191],a[116:119],v[188:191]
s_waitcnt vmcnt(32) lgkmcnt(4)
ds_write2st64_b64 v254,v[176:177],v[180:181] offset0:238 offset1:242
M a[0:3],a[104:107],a[96:99],0
s_waitcnt vmcnt(31) lgkmcnt(4)
ds_read_b128 a[116:119],v248 offset:1024
v_cvt_pk_bf16_f32 v184,v184,v185
M a[0:3],a[128:131],a[112:115],a[0:3]
s_waitcnt vmcnt(30) lgkmcnt(4)
ds_read_b128 a[124:127],v249 offset:1024
v_cvt_pk_bf16_f32 v185,v186,v187
M a[0:3],a[152:155],a[108:111],a[0:3]
s_waitcnt lgkmcnt(4)
v_cvt_pk_bf16_f32 v188,v188,v189
v_cvt_pk_bf16_f32 v189,v190,v191
M a[4:7],a[152:155],a[136:139],0
ds_write2st64_b64 v254,v[184:185],v[188:189] offset0:246 offset1:250
M a[4:7],a[128:131],a[108:111],a[4:7]
v_lshlrev_b32 v234,16,v196
v_lshlrev_b32 v232,16,v192
M a[4:7],a[104:107],a[112:115],a[4:7]
v_lshlrev_b32 v233,16,v194
v_lshlrev_b32 v237,16,v202
M a[8:11],a[104:107],a[108:111],0
ds_read_b128 a[132:135],v248 offset:1536
v_lshlrev_b32 v236,16,v200
M a[8:11],a[128:131],a[136:139],a[8:11]
s_waitcnt lgkmcnt(3)
ds_read_b128 a[140:143],v249 offset:1536
v_lshlrev_b32 v235,16,v198
M a[8:11],a[152:155],a[116:119],a[8:11]
s_waitcnt lgkmcnt(3)
v_fmac_f32 v232,s43,v234
v_fmac_f32 v237,4.0,v233
M a[12:15],a[152:155],a[124:127],0
v_fma_f32 v238,-4.0,v234,v236
v_fmac_f32 v232,s45,v236
M a[12:15],a[128:131],a[116:119],a[12:15]
s_waitcnt lgkmcnt(2)
s_barrier
ds_read_b128 v[160:163],v4 offset:43520
M a[12:15],a[104:107],a[136:139],a[12:15]
ds_read_b128 v[168:171],v4 offset:47616
ds_read_b128 v[176:179],v4 offset:52224
M a[16:19],a[104:107],a[116:119],0
ds_read_b128 v[184:187],v4 offset:56320
ds_read_b128 a[144:147],v249 offset:2048
M a[16:19],a[128:131],a[124:127],a[16:19]
s_waitcnt lgkmcnt(6)
ds_read_b128 a[148:151],v248 offset:2048
v_fmac_f32 v237,s41,v235
M a[16:19],a[152:155],a[132:135],a[16:19]
s_waitcnt lgkmcnt(6)
v_sub_f32 v236,v236,v234
v_fma_f32 v234,-4.0,v233,v235
M a[20:23],a[152:155],a[140:143],0
s_add_u32 s34,s33,0
v_sub_f32 v235,v235,v233
v_add_f32 v233,v238,v234
M a[20:23],a[128:131],a[132:135],a[20:23]
v_sub_f32 v238,v238,v234
v_fma_f32 v234,2.0,v235,v236
M a[20:23],a[104:107],a[124:127],a[20:23]
s_waitcnt lgkmcnt(5)
buffer_store_dwordx4 v[160:163],v253,s[24:27],s34 offen offset:1408 nt
M a[24:27],a[104:107],a[132:135],0
s_add_u32 s34,s33,393216
v_fmac_f32 v236,-2.0,v235
v_and_b32 v196,s42,v196
M a[24:27],a[128:131],a[140:143],a[24:27]
s_waitcnt lgkmcnt(1)
v_and_b32 v192,s42,v192
v_and_b32 v194,s42,v194
M a[24:27],a[152:155],a[144:147],a[24:27]
s_waitcnt lgkmcnt(0)
buffer_store_dwordx4 v[168:171],v253,s[24:27],s34 offen offset:1408 nt
M a[28:31],a[152:155],a[148:151],0
s_add_u32 s34,s33,786432
v_and_b32 v202,s42,v202
v_and_b32 v200,s42,v200
M a[28:31],a[128:131],a[144:147],a[28:31]
v_and_b32 v198,s42,v198
v_fmac_f32 v192,s43,v196
M a[28:31],a[104:107],a[140:143],a[28:31]
s_waitcnt vmcnt(25)
buffer_store_dwordx4 v[176:179],v253,s[24:27],s34 offen offset:1408 nt
M a[32:35],a[100:103],a[96:99],0
s_waitcnt vmcnt(25)
s_add_u32 s34,s33,1179648
v_fmac_f32 v202,4.0,v194
v_fma_f32 v235,-4.0,v196,v200
M a[32:35],a[172:175],a[112:115],a[32:35]
s_waitcnt vmcnt(24)
v_fmac_f32 v192,s45,v200
v_fmac_f32 v202,s41,v198
M a[32:35],a[180:183],a[108:111],a[32:35]
buffer_store_dwordx4 v[184:187],v253,s[24:27],s34 offen offset:1408 nt
M a[36:39],a[180:183],a[136:139],0
v_sub_f32 v200,v200,v196
v_fma_f32 v196,-4.0,v194,v198
M a[36:39],a[172:175],a[108:111],a[36:39]
v_sub_f32 v198,v198,v194
v_add_f32 v194,v235,v196
M a[36:39],a[100:103],a[112:115],a[36:39]
v_sub_f32 v235,v235,v196
v_fma_f32 v196,2.0,v198,v200
M a[40:43],a[100:103],a[108:111],0
v_fmac_f32 v200,-2.0,v198
v_cvt_pk_bf16_f32 v192,v232,v192
M a[40:43],a[172:175],a[136:139],a[40:43]
v_cvt_pk_bf16_f32 v202,v237,v202
v_cvt_pk_bf16_f32 v194,v233,v194
M a[40:43],a[180:183],a[116:119],a[40:43]
v_cvt_pk_bf16_f32 v198,v234,v196
v_cvt_pk_bf16_f32 v196,v238,v235
M a[44:47],a[180:183],a[124:127],0
v_cvt_pk_bf16_f32 v200,v236,v200
v_lshlrev_b32 v234,16,v197
M a[44:47],a[172:175],a[116:119],a[44:47]
v_lshlrev_b32 v232,16,v193
v_lshlrev_b32 v233,16,v195
M a[44:47],a[100:103],a[136:139],a[44:47]
v_lshlrev_b32 v237,16,v203
v_lshlrev_b32 v236,16,v201
M a[48:51],a[100:103],a[116:119],0
v_lshlrev_b32 v235,16,v199
v_fmac_f32 v232,s43,v234
M a[48:51],a[172:175],a[124:127],a[48:51]
v_fmac_f32 v237,4.0,v233
v_fma_f32 v238,-4.0,v234,v236
M a[48:51],a[180:183],a[132:135],a[48:51]
v_fmac_f32 v232,s45,v236
v_fmac_f32 v237,s41,v235
M a[52:55],a[180:183],a[140:143],0
v_sub_f32 v236,v236,v234
v_fma_f32 v234,-4.0,v233,v235
M a[52:55],a[172:175],a[132:135],a[52:55]
v_sub_f32 v235,v235,v233
v_add_f32 v233,v238,v234
M a[52:55],a[100:103],a[124:127],a[52:55]
v_sub_f32 v238,v238,v234
v_fma_f32 v234,2.0,v235,v236
M a[56:59],a[100:103],a[132:135],0
v_fmac_f32 v236,-2.0,v235
v_and_b32 v197,s42,v197
M a[56:59],a[172:175],a[140:143],a[56:59]
v_and_b32 v193,s42,v193
v_and_b32 v195,s42,v195
M a[56:59],a[180:183],a[144:147],a[56:59]
v_and_b32 v203,s42,v203
v_and_b32 v201,s42,v201
M a[60:63],a[180:183],a[148:151],0
v_and_b32 v199,s42,v199
v_fmac_f32 v193,s43,v197
M a[60:63],a[172:175],a[144:147],a[60:63]
v_fmac_f32 v203,4.0,v195
v_fma_f32 v235,-4.0,v197,v201
M a[60:63],a[100:103],a[140:143],a[60:63]
s_waitcnt vmcnt(24)
v_fmac_f32 v193,s45,v201
v_fmac_f32 v203,s41,v199
M a[64:67],a[120:123],a[96:99],0
s_waitcnt vmcnt(23)
v_sub_f32 v201,v201,v197
v_fma_f32 v197,-4.0,v195,v199
M a[64:67],a[164:167],a[112:115],a[64:67]
s_waitcnt vmcnt(22)
v_sub_f32 v199,v199,v195
v_add_f32 v195,v235,v197
M a[64:67],a[176:179],a[108:111],a[64:67]
v_sub_f32 v235,v235,v197
v_fma_f32 v197,2.0,v199,v201
M a[68:71],a[176:179],a[136:139],0
v_fmac_f32 v201,-2.0,v199
v_cvt_pk_bf16_f32 v193,v232,v193
M a[68:71],a[164:167],a[108:111],a[68:71]
v_cvt_pk_bf16_f32 v203,v237,v203
v_cvt_pk_bf16_f32 v195,v233,v195
M a[68:71],a[120:123],a[112:115],a[68:71]
v_cvt_pk_bf16_f32 v199,v234,v197
v_cvt_pk_bf16_f32 v197,v238,v235
M a[72:75],a[120:123],a[108:111],0
v_cvt_pk_bf16_f32 v201,v236,v201
v_lshlrev_b32 v234,16,v208
M a[72:75],a[164:167],a[136:139],a[72:75]
v_lshlrev_b32 v232,16,v204
v_lshlrev_b32 v233,16,v206
M a[72:75],a[176:179],a[116:119],a[72:75]
ds_write2st64_b64 v247,v[192:193],v[202:203] offset0:170 offset1:187
M a[76:79],a[176:179],a[124:127],0
s_add_u32 s28,s67,7077888
buffer_load_dwordx2 v[192:193],v245,s[12:15],s28 offen offset:0
M a[76:79],a[164:167],a[116:119],a[76:79]
v_lshlrev_b32 v237,16,v214
v_lshlrev_b32 v236,16,v212
M a[76:79],a[120:123],a[136:139],a[76:79]
buffer_load_dwordx2 v[202:203],v245,s[16:19],s28 offen offset:1536
M a[80:83],a[120:123],a[116:119],0
v_lshlrev_b32 v235,16,v210
v_fmac_f32 v232,s43,v234
M a[80:83],a[164:167],a[124:127],a[80:83]
v_fmac_f32 v237,4.0,v233
v_fma_f32 v238,-4.0,v234,v236
M a[80:83],a[176:179],a[132:135],a[80:83]
ds_write2st64_b64 v247,v[194:195],v[196:197] offset0:0 offset1:17
M a[84:87],a[176:179],a[140:143],0
buffer_load_dwordx2 v[194:195],v245,s[8:11],s28 offen offset:0
M a[84:87],a[164:167],a[132:135],a[84:87]
ds_read_b128 a[172:175],v248 offset:8704
v_fmac_f32 v232,s45,v236
M a[84:87],a[120:123],a[124:127],a[84:87]
ds_write2st64_b64 v247,v[198:199],v[200:201] offset0:136 offset1:153
M a[88:91],a[120:123],a[132:135],0
buffer_load_dwordx2 v[196:197],v245,s[8:11],s28 offen offset:384
M a[88:91],a[164:167],a[140:143],a[88:91]
ds_read_b128 a[180:183],v249 offset:8704
ds_read_b128 a[188:191],v248 offset:9216
M a[88:91],a[176:179],a[144:147],a[88:91]
ds_read_b128 a[224:227],v249 offset:9216
v_fmac_f32 v237,s41,v235
M a[92:95],a[176:179],a[148:151],0
v_sub_f32 v236,v236,v234
v_fma_f32 v234,-4.0,v233,v235
M a[92:95],a[164:167],a[144:147],a[92:95]
buffer_load_dwordx2 v[198:199],v245,s[8:11],s28 offen offset:768
M a[92:95],a[120:123],a[140:143],a[92:95]
s_waitcnt vmcnt(26) lgkmcnt(4)
v_sub_f32 v235,v235,v233
v_add_f32 v233,v238,v234
M a[96:99],a[168:171],a[172:175],0
s_waitcnt vmcnt(19) lgkmcnt(2)
ds_read_b128 a[228:231],v248 offset:9728
v_sub_f32 v238,v238,v234
M a[96:99],a[184:187],a[180:183],a[96:99]
s_waitcnt vmcnt(18) lgkmcnt(2)
ds_read_b128 a[252:255],v249 offset:9728
v_fma_f32 v234,2.0,v235,v236
M a[96:99],a[196:199],a[188:191],a[96:99]
s_waitcnt lgkmcnt(2)
buffer_load_dwordx2 v[200:201],v245,s[8:11],s28 offen offset:1152
M a[100:103],a[196:199],a[224:227],0
v_fmac_f32 v236,-2.0,v235
v_and_b32 v208,s42,v208
M a[100:103],a[184:187],a[188:191],a[100:103]
v_and_b32 v204,s42,v204
v_and_b32 v206,s42,v206
M a[100:103],a[168:171],a[180:183],a[100:103]
v_and_b32 v214,s42,v214
v_and_b32 v212,s42,v212
M a[104:107],a[168:171],a[188:191],0
ds_read_b128 a[204:207],v248 offset:10240
v_and_b32 v210,s42,v210
M a[104:107],a[184:187],a[224:227],a[104:107]
s_waitcnt lgkmcnt(2)
ds_read_b128 a[208:211],v249 offset:10240
v_fmac_f32 v204,s43,v208
M a[104:107],a[196:199],a[228:231],a[104:107]
s_waitcnt lgkmcnt(2)
v_fmac_f32 v214,4.0,v206
v_fma_f32 v235,-4.0,v208,v212
M a[108:111],a[196:199],a[252:255],0
v_fmac_f32 v204,s45,v212
v_fmac_f32 v214,s41,v210
M a[108:111],a[184:187],a[228:231],a[108:111]
v_sub_f32 v212,v212,v208
v_fma_f32 v208,-4.0,v206,v210
M a[108:111],a[168:171],a[224:227],a[108:111]
v_sub_f32 v210,v210,v206
v_add_f32 v206,v235,v208
M a[112:115],a[168:171],a[228:231],0
ds_read_b128 a[232:235],v249 offset:10752
v_sub_f32 v235,v235,v208
M a[112:115],a[184:187],a[252:255],a[112:115]
s_waitcnt lgkmcnt(2)
ds_read_b128 a[236:239],v248 offset:10752
v_fma_f32 v208,2.0,v210,v212
M a[112:115],a[196:199],a[204:207],a[112:115]
s_waitcnt lgkmcnt(2)
v_fmac_f32 v212,-2.0,v210
v_cvt_pk_bf16_f32 v204,v232,v204
M a[116:119],a[196:199],a[208:211],0
v_cvt_pk_bf16_f32 v214,v237,v214
v_cvt_pk_bf16_f32 v206,v233,v206
M a[116:119],a[184:187],a[204:207],a[116:119]
v_cvt_pk_bf16_f32 v210,v234,v208
v_cvt_pk_bf16_f32 v208,v238,v235
M a[116:119],a[168:171],a[252:255],a[116:119]
v_cvt_pk_bf16_f32 v212,v236,v212
v_lshlrev_b32 v234,16,v209
M a[120:123],a[168:171],a[204:207],0
v_lshlrev_b32 v232,16,v205
v_lshlrev_b32 v233,16,v207
M a[120:123],a[184:187],a[208:211],a[120:123]
s_waitcnt lgkmcnt(1)
v_lshlrev_b32 v237,16,v215
v_lshlrev_b32 v236,16,v213
M a[120:123],a[196:199],a[232:235],a[120:123]
s_waitcnt lgkmcnt(0)
v_lshlrev_b32 v235,16,v211
v_fmac_f32 v232,s43,v234
M a[124:127],a[196:199],a[236:239],0
buffer_load_dwordx4 a[248:251],v250,s[20:23],s46 offen offset:1024 sc1
M a[124:127],a[184:187],a[232:235],a[124:127]
v_fmac_f32 v237,4.0,v233
v_fma_f32 v238,-4.0,v234,v236
M a[124:127],a[168:171],a[208:211],a[124:127]
s_waitcnt vmcnt(19)
buffer_load_dwordx4 a[240:243],v250,s[20:23],s46 offen offset:2048 sc1
M a[128:131],v[216:219],a[172:175],0
s_waitcnt vmcnt(17)
s_add_u32 s47,s72,30720
v_fmac_f32 v232,s45,v236
v_fmac_f32 v237,s41,v235
M a[128:131],a[160:163],a[180:183],a[128:131]
s_waitcnt vmcnt(16)
v_sub_f32 v236,v236,v234
v_fma_f32 v234,-4.0,v233,v235
M a[128:131],a[244:247],a[188:191],a[128:131]
v_sub_f32 v235,v235,v233
v_add_f32 v233,v238,v234
M a[132:135],a[244:247],a[224:227],0
buffer_load_dwordx4 v[220:223],v250,s[20:23],s47 offen offset:0 sc1
M a[132:135],a[160:163],a[188:191],a[132:135]
v_sub_f32 v238,v238,v234
v_fma_f32 v234,2.0,v235,v236
M a[132:135],v[216:219],a[180:183],a[132:135]
v_fmac_f32 v236,-2.0,v235
v_and_b32 v209,s42,v209
M a[136:139],v[216:219],a[188:191],0
v_and_b32 v205,s42,v205
v_and_b32 v207,s42,v207
M a[136:139],a[160:163],a[224:227],a[136:139]
v_and_b32 v215,s42,v215
v_and_b32 v213,s42,v213
M a[136:139],a[244:247],a[228:231],a[136:139]
v_and_b32 v211,s42,v211
v_fmac_f32 v205,s43,v209
M a[140:143],a[244:247],a[252:255],0
v_fmac_f32 v215,4.0,v207
v_fma_f32 v235,-4.0,v209,v213
M a[140:143],a[160:163],a[228:231],a[140:143]
v_fmac_f32 v205,s45,v213
v_fmac_f32 v215,s41,v211
M a[140:143],v[216:219],a[224:227],a[140:143]
v_sub_f32 v213,v213,v209
v_fma_f32 v209,-4.0,v207,v211
M a[144:147],v[216:219],a[228:231],0
v_sub_f32 v211,v211,v207
v_add_f32 v207,v235,v209
M a[144:147],a[160:163],a[252:255],a[144:147]
v_sub_f32 v235,v235,v209
v_fma_f32 v209,2.0,v211,v213
M a[144:147],a[244:247],a[204:207],a[144:147]
v_fmac_f32 v213,-2.0,v211
v_cvt_pk_bf16_f32 v205,v232,v205
M a[148:151],a[244:247],a[208:211],0
v_cvt_pk_bf16_f32 v215,v237,v215
v_cvt_pk_bf16_f32 v207,v233,v207
M a[148:151],a[160:163],a[204:207],a[148:151]
v_cvt_pk_bf16_f32 v211,v234,v209
v_cvt_pk_bf16_f32 v209,v238,v235
M a[148:151],v[216:219],a[252:255],a[148:151]
v_cvt_pk_bf16_f32 v213,v236,v213
v_fmac_f32 v239,s43,v241
M a[152:155],v[216:219],a[204:207],0
v_fmac_f32 v244,4.0,v240
v_fma_f32 v232,-4.0,v241,v243
M a[152:155],a[160:163],a[208:211],a[152:155]
v_fmac_f32 v239,s45,v243
v_fmac_f32 v244,s41,v242
M a[152:155],a[244:247],a[232:235],a[152:155]
ds_write2st64_b64 v247,v[204:205],v[214:215] offset0:171 offset1:188
M a[156:159],a[244:247],a[236:239],0
s_add_u32 s28,s67,7471104
buffer_load_dwordx4 a[220:223],v250,s[20:23],s47 offen offset:1024 sc1
M a[156:159],a[160:163],a[232:235],a[156:159]
v_sub_f32 v243,v243,v241
v_fma_f32 v241,-4.0,v240,v242
M a[156:159],v[216:219],a[208:211],a[156:159]
s_waitcnt vmcnt(17)
buffer_load_dwordx4 a[200:203],v250,s[20:23],s47 offen offset:2048 sc1
M a[160:163],a[216:219],a[172:175],0
s_waitcnt vmcnt(17)
s_add_u32 s48,s72,33792
v_sub_f32 v242,v242,v240
v_add_f32 v240,v232,v241
M a[160:163],v[224:227],a[180:183],a[160:163]
s_waitcnt vmcnt(16)
v_sub_f32 v232,v232,v241
v_fma_f32 v241,2.0,v242,v243
M a[160:163],v[228:231],a[188:191],a[160:163]
ds_write2st64_b64 v247,v[206:207],v[208:209] offset0:1 offset1:18
M a[164:167],v[228:231],a[224:227],0
buffer_load_dwordx4 a[192:195],v250,s[20:23],s48 offen offset:0 sc1
M a[164:167],v[224:227],a[188:191],a[164:167]
v_fmac_f32 v243,-2.0,v242
v_cvt_pk_bf16_f32 v233,v239,v244
M a[164:167],a[216:219],a[180:183],a[164:167]
ds_write2st64_b64 v247,v[210:211],v[212:213] offset0:137 offset1:154
M a[168:171],a[216:219],a[188:191],0
buffer_load_dwordx4 a[196:199],v250,s[20:23],s48 offen offset:1024 sc1
M a[168:171],v[224:227],a[224:227],a[168:171]
v_cvt_pk_bf16_f32 v234,v240,v232
v_cvt_pk_bf16_f32 v235,v241,v243
M a[168:171],v[228:231],a[228:231],a[168:171]
v_add_u32 v232,87040,v252
M a[172:175],v[228:231],a[252:255],0
ds_write_b16 v232,v233 offset:0
M a[172:175],v[224:227],a[228:231],a[172:175]
buffer_load_dwordx4 a[244:247],v250,s[20:23],s48 offen offset:2048 sc1
M a[172:175],a[216:219],a[224:227],a[172:175]
s_add_u32 s46,s72,36864
ds_write_b16_d16_hi v232,v233 offset:8704
M a[176:179],a[216:219],a[228:231],0
ds_write_b16 v252,v234 offset:0
M a[176:179],v[224:227],a[252:255],a[176:179]
ds_write_b16_d16_hi v252,v234 offset:8704
M a[176:179],v[228:231],a[204:207],a[176:179]
buffer_load_dwordx4 v[216:219],v250,s[20:23],s46 offen offset:0 sc1
M a[180:183],v[228:231],a[208:211],0
v_add_u32 v232,69632,v252
M a[180:183],v[224:227],a[204:207],a[180:183]
ds_read_b128 a[224:227],v248 offset:17408
ds_write_b16 v232,v235 offset:0
M a[180:183],a[216:219],a[252:255],a[180:183]
ds_read_b128 a[228:231],v249 offset:17408
ds_write_b16_d16_hi v232,v235 offset:8704
M a[184:187],a[216:219],a[204:207],0
buffer_load_dwordx2 v[204:205],v245,s[12:15],s28 offen offset:0
M a[184:187],v[224:227],a[208:211],a[184:187]
ds_read_b128 a[252:255],v248 offset:17920
ds_read_b128 a[204:207],v249 offset:17920
M a[184:187],v[228:231],a[232:235],a[184:187]
s_waitcnt vmcnt(12)
v_lshlrev_b32 v234,16,v196
v_lshlrev_b32 v232,16,v192
M a[188:191],v[228:231],a[236:239],0
buffer_load_dwordx2 v[214:215],v245,s[16:19],s28 offen offset:1536
M a[188:191],v[224:227],a[232:235],a[188:191]
v_lshlrev_b32 v233,16,v194
v_lshlrev_b32 v237,16,v202
M a[188:191],a[216:219],a[208:211],a[188:191]
s_waitcnt vmcnt(11) lgkmcnt(5)
v_lshlrev_b32 v236,16,v200
v_lshlrev_b32 v235,16,v198
M v[0:3],a[212:215],a[224:227],0
s_waitcnt vmcnt(10) lgkmcnt(3)
ds_read_b128 a[236:239],v248 offset:18432
v_fmac_f32 v232,s43,v234
M v[0:3],a[248:251],a[228:231],v[0:3]
s_waitcnt vmcnt(9) lgkmcnt(2)
buffer_load_dwordx2 v[206:207],v245,s[8:11],s28 offen offset:0
M v[0:3],a[240:243],a[252:255],v[0:3]
s_waitcnt lgkmcnt(1)
ds_read_b128 v[228:231],v249 offset:18432
v_fmac_f32 v237,4.0,v233
M v[4:7],a[240:243],a[204:207],0
v_fma_f32 v238,-4.0,v234,v236
v_fmac_f32 v232,s45,v236
M v[4:7],a[248:251],a[252:255],v[4:7]
v_fmac_f32 v237,s41,v235
v_sub_f32 v236,v236,v234
M v[4:7],a[212:215],a[228:231],v[4:7]
buffer_load_dwordx2 v[208:209],v245,s[8:11],s28 offen offset:384
M v[8:11],a[212:215],a[252:255],0
ds_read_b128 a[232:235],v248 offset:18944
v_fma_f32 v234,-4.0,v233,v235
M v[8:11],a[248:251],a[204:207],v[8:11]
s_waitcnt lgkmcnt(2)
ds_read_b128 v[224:227],v249 offset:18944
v_sub_f32 v235,v235,v233
M v[8:11],a[240:243],a[236:239],v[8:11]
s_waitcnt lgkmcnt(2)
v_add_f32 v233,v238,v234
v_sub_f32 v238,v238,v234
M v[12:15],a[240:243],v[228:231],0
buffer_load_dwordx2 v[210:211],v245,s[8:11],s28 offen offset:768
M v[12:15],a[248:251],a[236:239],v[12:15]
v_fma_f32 v234,2.0,v235,v236
v_fmac_f32 v236,-2.0,v235
M v[12:15],a[212:215],a[204:207],v[12:15]
v_and_b32 v196,s42,v196
v_and_b32 v192,s42,v192
M v[16:19],a[212:215],a[236:239],0
ds_read_b128 a[208:211],v249 offset:19456
v_and_b32 v194,s42,v194
M v[16:19],a[248:251],v[228:231],v[16:19]
s_waitcnt lgkmcnt(2)
buffer_load_dwordx2 v[212:213],v245,s[8:11],s28 offen offset:1152
M v[16:19],a[240:243],a[232:235],v[16:19]
s_waitcnt lgkmcnt(1)
s_add_u32 s29,s68,6291456
ds_read_b128 a[216:219],v248 offset:19456
v_and_b32 v202,s42,v202
M v[20:23],a[240:243],v[224:227],0
v_and_b32 v200,s42,v200
v_and_b32 v198,s42,v198
M v[20:23],a[248:251],a[232:235],v[20:23]
v_fmac_f32 v192,s43,v196
v_fmac_f32 v202,4.0,v194
M v[20:23],a[212:215],v[228:231],v[20:23]
buffer_load_short_d16_hi v239,v246,s[12:15],s29 offen offset:0
M v[24:27],a[212:215],a[232:235],0
v_fma_f32 v235,-4.0,v196,v200
v_fmac_f32 v192,s45,v200
M v[24:27],a[248:251],v[224:227],v[24:27]
s_waitcnt lgkmcnt(1)
buffer_load_short_d16_hi v240,v246,s[8:11],s29 offen offset:0
M v[24:27],a[240:243],a[208:211],v[24:27]
s_waitcnt lgkmcnt(0)
v_fmac_f32 v202,s41,v198
v_sub_f32 v200,v200,v196
M v[28:31],a[240:243],a[216:219],0
buffer_load_short_d16_hi v241,v246,s[8:11],s29 offen offset:384
M v[28:31],a[248:251],a[208:211],v[28:31]
v_fma_f32 v196,-4.0,v194,v198
v_sub_f32 v198,v198,v194
M v[28:31],a[212:215],v[224:227],v[28:31]
s_waitcnt vmcnt(15)
buffer_load_short_d16_hi v242,v246,s[8:11],s29 offen offset:768
M v[32:35],v[220:223],a[224:227],0
s_waitcnt vmcnt(15)
v_add_f32 v194,v235,v196
v_sub_f32 v235,v235,v196
M v[32:35],a[220:223],a[228:231],v[32:35]
s_waitcnt vmcnt(14)
buffer_load_short_d16_hi v243,v246,s[8:11],s29 offen offset:1152
M v[32:35],a[200:203],a[252:255],v[32:35]
v_fma_f32 v196,2.0,v198,v200
v_fmac_f32 v200,-2.0,v198
M v[36:39],a[200:203],a[204:207],0
buffer_load_short_d16_hi v244,v246,s[16:19],s29 offen offset:1536
M v[36:39],a[220:223],a[252:255],v[36:39]
v_cvt_pk_bf16_f32 v192,v232,v192
v_cvt_pk_bf16_f32 v202,v237,v202
M v[36:39],v[220:223],a[228:231],v[36:39]
global_load_dword a240,v250,s[64:65]
M v[40:43],v[220:223],a[252:255],0
v_cvt_pk_bf16_f32 v194,v233,v194
v_cvt_pk_bf16_f32 v198,v234,v196
M v[40:43],a[220:223],a[204:207],v[40:43]
buffer_load_dwordx4 a[240:243],v250,s[20:23],s46 offen offset:1024 sc1
M v[40:43],a[200:203],a[236:239],v[40:43]
v_cvt_pk_bf16_f32 v196,v238,v235
v_cvt_pk_bf16_f32 v200,v236,v200
M v[44:47],a[200:203],v[228:231],0
v_lshlrev_b32 v234,16,v197
v_lshlrev_b32 v232,16,v193
M v[44:47],a[220:223],a[236:239],v[44:47]
buffer_load_dwordx4 a[248:251],v250,s[20:23],s46 offen offset:2048 sc1
M v[44:47],v[220:223],a[204:207],v[44:47]
s_add_u32 s47,s72,39936
v_lshlrev_b32 v233,16,v195
v_lshlrev_b32 v237,16,v203
M v[48:51],v[220:223],a[236:239],0
v_lshlrev_b32 v236,16,v201
v_lshlrev_b32 v235,16,v199
M v[48:51],a[220:223],v[228:231],v[48:51]
v_fmac_f32 v232,s43,v234
v_fmac_f32 v237,4.0,v233
M v[48:51],a[200:203],a[232:235],v[48:51]
v_fma_f32 v238,-4.0,v234,v236
v_fmac_f32 v232,s45,v236
M v[52:55],a[200:203],v[224:227],0
buffer_load_dwordx4 a[212:215],v250,s[20:23],s47 offen offset:0 sc1
M v[52:55],a[220:223],a[232:235],v[52:55]
v_fmac_f32 v237,s41,v235
v_sub_f32 v236,v236,v234
M v[52:55],v[220:223],v[228:231],v[52:55]
v_fma_f32 v234,-4.0,v233,v235
v_sub_f32 v235,v235,v233
M v[56:59],v[220:223],a[232:235],0
v_add_f32 v233,v238,v234
v_sub_f32 v238,v238,v234
M v[56:59],a[220:223],v[224:227],v[56:59]
v_fma_f32 v234,2.0,v235,v236
v_fmac_f32 v236,-2.0,v235
M v[56:59],a[200:203],a[208:211],v[56:59]
v_and_b32 v197,s42,v197
v_and_b32 v193,s42,v193
M v[60:63],a[200:203],a[216:219],0
buffer_load_dwordx4 a[200:203],v250,s[20:23],s47 offen offset:1024 sc1
M v[60:63],a[220:223],a[208:211],v[60:63]
v_and_b32 v195,s42,v195
v_and_b32 v203,s42,v203
M v[60:63],v[220:223],v[224:227],v[60:63]
s_waitcnt vmcnt(20)
buffer_load_dwordx4 a[220:223],v250,s[20:23],s47 offen offset:2048 sc1
M v[64:67],a[192:195],a[224:227],0
s_waitcnt vmcnt(20)
s_add_u32 s48,s72,43008
v_and_b32 v201,s42,v201
v_and_b32 v199,s42,v199
M v[64:67],a[196:199],a[228:231],v[64:67]
s_waitcnt vmcnt(19)
v_fmac_f32 v193,s43,v197
v_fmac_f32 v203,4.0,v195
M v[64:67],a[244:247],a[252:255],v[64:67]
v_fma_f32 v235,-4.0,v197,v201
v_fmac_f32 v193,s45,v201
M v[68:71],a[244:247],a[204:207],0
buffer_load_dwordx4 v[220:223],v250,s[20:23],s48 offen offset:0 sc1
M v[68:71],a[196:199],a[252:255],v[68:71]
v_fmac_f32 v203,s41,v199
v_sub_f32 v201,v201,v197
M v[68:71],a[192:195],a[228:231],v[68:71]
v_fma_f32 v197,-4.0,v195,v199
v_sub_f32 v199,v199,v195
M v[72:75],a[192:195],a[252:255],0
v_add_f32 v195,v235,v197
v_sub_f32 v235,v235,v197
M v[72:75],a[196:199],a[204:207],v[72:75]
buffer_load_dwordx4 a[224:227],v250,s[20:23],s48 offen offset:1024 sc1
M v[72:75],a[244:247],a[236:239],v[72:75]
v_fma_f32 v197,2.0,v199,v201
v_fmac_f32 v201,-2.0,v199
M v[76:79],a[244:247],v[228:231],0
v_cvt_pk_bf16_f32 v193,v232,v193
v_cvt_pk_bf16_f32 v203,v237,v203
M v[76:79],a[196:199],a[236:239],v[76:79]
v_cvt_pk_bf16_f32 v195,v233,v195
v_cvt_pk_bf16_f32 v199,v234,v197
M v[76:79],a[192:195],a[204:207],v[76:79]
buffer_load_dwordx4 a[228:231],v250,s[20:23],s48 offen offset:2048 sc1
M v[80:83],a[192:195],a[236:239],0
s_add_u32 s46,s73,9216
v_cvt_pk_bf16_f32 v197,v238,v235
v_cvt_pk_bf16_f32 v201,v236,v201
M v[80:83],a[196:199],v[228:231],v[80:83]
s_waitcnt vmcnt(17)
v_lshlrev_b32 v234,16,v208
v_lshlrev_b32 v232,16,v204
M v[80:83],a[244:247],a[232:235],v[80:83]
ds_write2st64_b64 v247,v[192:193],v[202:203] offset0:172 offset1:189
M v[84:87],a[244:247],v[224:227],0
s_add_u32 s28,s68,6291456
buffer_load_dwordx4 a[252:255],v250,s[20:23],s46 offen offset:0 sc1
M v[84:87],a[196:199],a[232:235],v[84:87]
ds_read_b128 a[204:207],v248 offset:26112
v_lshlrev_b32 v233,16,v206
M v[84:87],a[192:195],v[228:231],v[84:87]
ds_write2st64_b64 v247,v[194:195],v[196:197] offset0:2 offset1:19
M v[88:91],a[192:195],a[232:235],0
buffer_load_dwordx2 v[192:193],v245,s[12:15],s28 offen offset:0
M v[88:91],a[196:199],v[224:227],v[88:91]
ds_read_b128 a[236:239],v249 offset:26112
ds_read_b128 v[228:231],v248 offset:26624
M v[88:91],a[244:247],a[208:211],v[88:91]
ds_write2st64_b64 v247,v[198:199],v[200:201] offset0:138 offset1:155
M v[92:95],a[244:247],a[216:219],0
buffer_load_dwordx2 v[202:203],v245,s[16:19],s28 offen offset:1536
M v[92:95],a[196:199],a[208:211],v[92:95]
ds_read_b128 a[232:235],v249 offset:26624
v_lshlrev_b32 v237,16,v214
M v[92:95],a[192:195],v[224:227],v[92:95]
s_waitcnt vmcnt(18) lgkmcnt(5)
v_lshlrev_b32 v236,16,v212
v_lshlrev_b32 v235,16,v210
M v[96:99],v[216:219],a[204:207],0
s_waitcnt vmcnt(10) lgkmcnt(3)
ds_read_b128 a[216:219],v248 offset:27136
v_fmac_f32 v232,s43,v234
M v[96:99],a[240:243],a[236:239],v[96:99]
s_waitcnt vmcnt(9) lgkmcnt(3)
buffer_load_dwordx2 v[194:195],v245,s[8:11],s28 offen offset:0
M v[96:99],a[248:251],v[228:231],v[96:99]
s_waitcnt lgkmcnt(1)
ds_read_b128 a[244:247],v249 offset:27136
v_fmac_f32 v237,4.0,v233
M v[100:103],a[248:251],a[232:235],0
v_fma_f32 v238,-4.0,v234,v236
v_fmac_f32 v232,s45,v236
M v[100:103],a[240:243],v[228:231],v[100:103]
v_fmac_f32 v237,s41,v235
v_sub_f32 v236,v236,v234
M v[100:103],v[216:219],a[236:239],v[100:103]
buffer_load_dwordx2 v[196:197],v245,s[8:11],s28 offen offset:384
M v[104:107],v[216:219],v[228:231],0
ds_read_b128 a[196:199],v248 offset:27648
v_fma_f32 v234,-4.0,v233,v235
M v[104:107],a[240:243],a[232:235],v[104:107]
s_waitcnt lgkmcnt(2)
ds_read_b128 a[208:211],v249 offset:27648
v_sub_f32 v235,v235,v233
M v[104:107],a[248:251],a[216:219],v[104:107]
s_waitcnt lgkmcnt(2)
v_add_f32 v233,v238,v234
v_sub_f32 v238,v238,v234
M v[108:111],a[248:251],a[244:247],0
buffer_load_dwordx2 v[198:199],v245,s[8:11],s28 offen offset:768
M v[108:111],a[240:243],a[216:219],v[108:111]
v_fma_f32 v234,2.0,v235,v236
v_fmac_f32 v236,-2.0,v235
M v[108:111],v[216:219],a[232:235],v[108:111]
v_and_b32 v208,s42,v208
v_and_b32 v204,s42,v204
M v[112:115],v[216:219],a[216:219],0
ds_read_b128 a[192:195],v249 offset:28160
v_and_b32 v206,s42,v206
M v[112:115],a[240:243],a[244:247],v[112:115]
s_waitcnt lgkmcnt(2)
buffer_load_dwordx2 v[200:201],v245,s[8:11],s28 offen offset:1152
M v[112:115],a[248:251],a[196:199],v[112:115]
s_waitcnt lgkmcnt(1)
ds_read_b128 v[224:227],v248 offset:28160
v_and_b32 v214,s42,v214
M v[116:119],a[248:251],a[208:211],0
v_and_b32 v212,s42,v212
v_and_b32 v210,s42,v210
M v[116:119],a[240:243],a[196:199],v[116:119]
v_fmac_f32 v204,s43,v208
v_fmac_f32 v214,4.0,v206
M v[116:119],v[216:219],a[244:247],v[116:119]
v_fma_f32 v235,-4.0,v208,v212
v_fmac_f32 v204,s45,v212
M v[120:123],v[216:219],a[196:199],0
v_fmac_f32 v214,s41,v210
v_sub_f32 v212,v212,v208
M v[120:123],a[240:243],a[208:211],v[120:123]
s_waitcnt lgkmcnt(1)
v_fma_f32 v208,-4.0,v206,v210
v_sub_f32 v210,v210,v206
M v[120:123],a[248:251],a[192:195],v[120:123]
s_waitcnt lgkmcnt(0)
v_add_f32 v206,v235,v208
v_sub_f32 v235,v235,v208
M v[124:127],a[248:251],v[224:227],0
buffer_load_dwordx4 a[248:251],v250,s[20:23],s46 offen offset:1024 sc1
M v[124:127],a[240:243],a[192:195],v[124:127]
v_fma_f32 v208,2.0,v210,v212
v_fmac_f32 v212,-2.0,v210
M v[124:127],v[216:219],a[208:211],v[124:127]
s_waitcnt vmcnt(13)
buffer_load_dwordx4 a[240:243],v250,s[20:23],s46 offen offset:2048 sc1
M v[128:131],a[212:215],a[204:207],0
s_waitcnt vmcnt(13)
s_add_u32 s47,s73,12288
v_cvt_pk_bf16_f32 v204,v232,v204
v_cvt_pk_bf16_f32 v214,v237,v214
M v[128:131],a[200:203],a[236:239],v[128:131]
s_waitcnt vmcnt(12)
v_cvt_pk_bf16_f32 v206,v233,v206
v_cvt_pk_bf16_f32 v210,v234,v208
M v[128:131],a[220:223],v[228:231],v[128:131]
v_cvt_pk_bf16_f32 v208,v238,v235
v_cvt_pk_bf16_f32 v212,v236,v212
M v[132:135],a[220:223],a[232:235],0
buffer_load_dwordx4 v[216:219],v250,s[20:23],s47 offen offset:0 sc1
M v[132:135],a[200:203],v[228:231],v[132:135]
v_lshlrev_b32 v234,16,v209
v_lshlrev_b32 v232,16,v205
M v[132:135],a[212:215],a[236:239],v[132:135]
v_lshlrev_b32 v233,16,v207
v_lshlrev_b32 v237,16,v215
M v[136:139],a[212:215],v[228:231],0
v_lshlrev_b32 v236,16,v213
v_lshlrev_b32 v235,16,v211
M v[136:139],a[200:203],a[232:235],v[136:139]
v_fmac_f32 v232,s43,v234
v_fmac_f32 v237,4.0,v233
M v[136:139],a[220:223],a[216:219],v[136:139]
v_fma_f32 v238,-4.0,v234,v236
v_fmac_f32 v232,s45,v236
M v[140:143],a[220:223],a[244:247],0
v_fmac_f32 v237,s41,v235
v_sub_f32 v236,v236,v234
M v[140:143],a[200:203],a[216:219],v[140:143]
v_fma_f32 v234,-4.0,v233,v235
v_sub_f32 v235,v235,v233
M v[140:143],a[212:215],a[232:235],v[140:143]
v_add_f32 v233,v238,v234
v_sub_f32 v238,v238,v234
M v[144:147],a[212:215],a[216:219],0
v_fma_f32 v234,2.0,v235,v236
v_fmac_f32 v236,-2.0,v235
M v[144:147],a[200:203],a[244:247],v[144:147]
v_and_b32 v209,s42,v209
v_and_b32 v205,s42,v205
M v[144:147],a[220:223],a[196:199],v[144:147]
v_and_b32 v207,s42,v207
v_and_b32 v215,s42,v215
M v[148:151],a[220:223],a[208:211],0
v_and_b32 v213,s42,v213
v_and_b32 v211,s42,v211
M v[148:151],a[200:203],a[196:199],v[148:151]
v_fmac_f32 v205,s43,v209
v_fmac_f32 v215,4.0,v207
M v[148:151],a[212:215],a[244:247],v[148:151]
v_fma_f32 v235,-4.0,v209,v213
v_fmac_f32 v205,s45,v213
M v[152:155],a[212:215],a[196:199],0
v_fmac_f32 v215,s41,v211
v_sub_f32 v213,v213,v209
M v[152:155],a[200:203],a[208:211],v[152:155]
v_fma_f32 v209,-4.0,v207,v211
v_sub_f32 v211,v211,v207
M v[152:155],a[220:223],a[192:195],v[152:155]
v_add_f32 v207,v235,v209
v_sub_f32 v235,v235,v209
M v[156:159],a[220:223],v[224:227],0
buffer_load_dwordx4 a[220:223],v250,s[20:23],s47 offen offset:1024 sc1
M v[156:159],a[200:203],a[192:195],v[156:159]
v_fma_f32 v209,2.0,v211,v213
v_fmac_f32 v213,-2.0,v211
M v[156:159],a[212:215],a[208:211],v[156:159]
s_waitcnt vmcnt(13)
buffer_load_dwordx4 a[200:203],v250,s[20:23],s47 offen offset:2048 sc1
M v[160:163],v[220:223],a[204:207],0
s_waitcnt vmcnt(13)
s_add_u32 s48,s73,15360
v_cvt_pk_bf16_f32 v205,v232,v205
v_cvt_pk_bf16_f32 v215,v237,v215
M v[160:163],a[224:227],a[236:239],v[160:163]
s_waitcnt vmcnt(12)
v_cvt_pk_bf16_f32 v207,v233,v207
v_cvt_pk_bf16_f32 v211,v234,v209
M v[160:163],a[228:231],v[228:231],v[160:163]
v_cvt_pk_bf16_f32 v209,v238,v235
v_cvt_pk_bf16_f32 v213,v236,v213
M v[164:167],a[228:231],a[232:235],0
buffer_load_dwordx4 a[212:215],v250,s[20:23],s48 offen offset:0 sc1
M v[164:167],a[224:227],v[228:231],v[164:167]
M v[164:167],v[220:223],a[236:239],v[164:167]
ds_write2st64_b64 v247,v[204:205],v[214:215] offset0:173 offset1:190
M v[168:171],v[220:223],v[228:231],0
s_add_u32 s28,s68,6684672
M v[168:171],a[224:227],a[232:235],v[168:171]
buffer_load_dwordx4 a[204:207],v250,s[20:23],s48 offen offset:1024 sc1
M v[168:171],a[228:231],a[216:219],v[168:171]
ds_write2st64_b64 v247,v[206:207],v[208:209] offset0:3 offset1:20
M v[172:175],a[228:231],a[244:247],0
M v[172:175],a[224:227],a[216:219],v[172:175]
buffer_load_dwordx4 a[236:239],v250,s[20:23],s48 offen offset:2048 sc1
M v[172:175],v[220:223],a[232:235],v[172:175]
s_add_u32 s46,s73,18432
ds_write2st64_b64 v247,v[210:211],v[212:213] offset0:139 offset1:156
M v[176:179],v[220:223],a[216:219],0
M v[176:179],a[224:227],a[244:247],v[176:179]
buffer_load_dwordx4 v[228:231],v250,s[20:23],s46 offen offset:0 sc1
M v[176:179],a[228:231],a[196:199],v[176:179]
s_waitcnt lgkmcnt(0)
s_barrier
v_add_u32 v248,0xffffbc00,v248
M v[180:183],a[228:231],a[208:211],0
v_add_u32 v249,0xffffbc00,v249
M v[180:183],a[224:227],a[196:199],v[180:183]
ds_read_b128 a[232:235],v248 offset:0
M v[180:183],v[220:223],a[244:247],v[180:183]
buffer_load_dwordx2 v[204:205],v245,s[12:15],s28 offen offset:0
M v[184:187],v[220:223],a[196:199],0
ds_read_b128 a[216:219],v249 offset:0
ds_read_b128 a[244:247],v248 offset:512
M v[184:187],a[224:227],a[208:211],v[184:187]
ds_read_b128 a[196:199],v249 offset:512
M v[184:187],a[228:231],a[192:195],v[184:187]
M v[188:191],a[228:231],v[224:227],0
buffer_load_dwordx2 v[214:215],v245,s[16:19],s28 offen offset:1536
M v[188:191],a[224:227],a[192:195],v[188:191]
M v[188:191],v[220:223],a[208:211],v[188:191]
s_waitcnt vmcnt(17) lgkmcnt(3)
M a[0:3],a[252:255],a[232:235],a[0:3]
s_waitcnt vmcnt(10) lgkmcnt(2)
ds_read_b128 a[228:231],v248 offset:1024
M a[0:3],a[248:251],a[216:219],a[0:3]
s_waitcnt vmcnt(9) lgkmcnt(2)
buffer_load_dwordx2 v[206:207],v245,s[8:11],s28 offen offset:0
M a[0:3],a[240:243],a[244:247],a[0:3]
s_waitcnt lgkmcnt(1)
ds_read_b128 v[224:227],v249 offset:1024
v_lshlrev_b32 v234,16,v196
M a[4:7],a[240:243],a[196:199],a[4:7]
v_lshlrev_b32 v232,16,v192
v_lshlrev_b32 v233,16,v194
M a[4:7],a[248:251],a[244:247],a[4:7]
v_lshlrev_b32 v237,16,v202
v_lshlrev_b32 v236,16,v200
M a[4:7],a[252:255],a[216:219],a[4:7]
buffer_load_dwordx2 v[208:209],v245,s[8:11],s28 offen offset:384
M a[8:11],a[252:255],a[244:247],a[8:11]
ds_read_b128 a[192:195],v248 offset:1536
v_lshlrev_b32 v235,16,v198
M a[8:11],a[248:251],a[196:199],a[8:11]
s_waitcnt lgkmcnt(2)
ds_read_b128 a[224:227],v249 offset:1536
v_fmac_f32 v232,s43,v234
M a[8:11],a[240:243],a[228:231],a[8:11]
s_waitcnt lgkmcnt(2)
v_fmac_f32 v237,4.0,v233
v_fma_f32 v238,-4.0,v234,v236
M a[12:15],a[240:243],v[224:227],a[12:15]
buffer_load_dwordx2 v[210:211],v245,s[8:11],s28 offen offset:768
M a[12:15],a[248:251],a[228:231],a[12:15]
v_fmac_f32 v232,s45,v236
v_fmac_f32 v237,s41,v235
M a[12:15],a[252:255],a[196:199],a[12:15]
v_sub_f32 v236,v236,v234
v_fma_f32 v234,-4.0,v233,v235
M a[16:19],a[252:255],a[228:231],a[16:19]
ds_read_b128 a[208:211],v249 offset:2048
v_sub_f32 v235,v235,v233
M a[16:19],a[248:251],v[224:227],a[16:19]
s_waitcnt lgkmcnt(2)
buffer_load_dwordx2 v[212:213],v245,s[8:11],s28 offen offset:1152
M a[16:19],a[240:243],a[192:195],a[16:19]
s_waitcnt lgkmcnt(1)
ds_read_b128 v[220:223],v248 offset:2048
v_add_f32 v233,v238,v234
M a[20:23],a[240:243],a[224:227],a[20:23]
v_sub_f32 v238,v238,v234
v_fma_f32 v234,2.0,v235,v236
M a[20:23],a[248:251],a[192:195],a[20:23]
v_fmac_f32 v236,-2.0,v235
v_and_b32 v196,s42,v196
M a[20:23],a[252:255],v[224:227],a[20:23]
v_and_b32 v192,s42,v192
v_and_b32 v194,s42,v194
M a[24:27],a[252:255],a[192:195],a[24:27]
v_and_b32 v202,s42,v202
v_and_b32 v200,s42,v200
M a[24:27],a[248:251],a[224:227],a[24:27]
s_waitcnt lgkmcnt(1)
v_and_b32 v198,s42,v198
v_fmac_f32 v192,s43,v196
M a[24:27],a[240:243],a[208:211],a[24:27]
s_waitcnt lgkmcnt(0)
v_fmac_f32 v202,4.0,v194
v_fma_f32 v235,-4.0,v196,v200
M a[28:31],a[240:243],v[220:223],a[28:31]
buffer_load_dwordx4 a[240:243],v250,s[20:23],s46 offen offset:1024 sc1
M a[28:31],a[248:251],a[208:211],a[28:31]
v_fmac_f32 v192,s45,v200
v_fmac_f32 v202,s41,v198
M a[28:31],a[252:255],a[224:227],a[28:31]
s_waitcnt vmcnt(13)
buffer_load_dwordx4 a[248:251],v250,s[20:23],s46 offen offset:2048 sc1
M a[32:35],v[216:219],a[232:235],a[32:35]
s_waitcnt vmcnt(13)
s_add_u32 s47,s73,21504
v_sub_f32 v200,v200,v196
v_fma_f32 v196,-4.0,v194,v198
M a[32:35],a[220:223],a[216:219],a[32:35]
s_waitcnt vmcnt(12)
v_sub_f32 v198,v198,v194
v_add_f32 v194,v235,v196
M a[32:35],a[200:203],a[244:247],a[32:35]
v_sub_f32 v235,v235,v196
v_fma_f32 v196,2.0,v198,v200
M a[36:39],a[200:203],a[196:199],a[36:39]
buffer_load_dwordx4 a[252:255],v250,s[20:23],s47 offen offset:0 sc1
M a[36:39],a[220:223],a[244:247],a[36:39]
v_fmac_f32 v200,-2.0,v198
v_cvt_pk_bf16_f32 v192,v232,v192
M a[36:39],v[216:219],a[216:219],a[36:39]
v_cvt_pk_bf16_f32 v202,v237,v202
v_cvt_pk_bf16_f32 v194,v233,v194
M a[40:43],v[216:219],a[244:247],a[40:43]
v_cvt_pk_bf16_f32 v198,v234,v196
v_cvt_pk_bf16_f32 v196,v238,v235
M a[40:43],a[220:223],a[196:199],a[40:43]
v_cvt_pk_bf16_f32 v200,v236,v200
v_lshlrev_b32 v234,16,v197
M a[40:43],a[200:203],a[228:231],a[40:43]
v_lshlrev_b32 v232,16,v193
v_lshlrev_b32 v233,16,v195
M a[44:47],a[200:203],v[224:227],a[44:47]
v_lshlrev_b32 v237,16,v203
v_lshlrev_b32 v236,16,v201
M a[44:47],a[220:223],a[228:231],a[44:47]
v_lshlrev_b32 v235,16,v199
v_fmac_f32 v232,s43,v234
M a[44:47],v[216:219],a[196:199],a[44:47]
v_fmac_f32 v237,4.0,v233
v_fma_f32 v238,-4.0,v234,v236
M a[48:51],v[216:219],a[228:231],a[48:51]
v_fmac_f32 v232,s45,v236
v_fmac_f32 v237,s41,v235
M a[48:51],a[220:223],v[224:227],a[48:51]
v_sub_f32 v236,v236,v234
v_fma_f32 v234,-4.0,v233,v235
M a[48:51],a[200:203],a[192:195],a[48:51]
v_sub_f32 v235,v235,v233
v_add_f32 v233,v238,v234
M a[52:55],a[200:203],a[224:227],a[52:55]
v_sub_f32 v238,v238,v234
v_fma_f32 v234,2.0,v235,v236
M a[52:55],a[220:223],a[192:195],a[52:55]
v_fmac_f32 v236,-2.0,v235
v_and_b32 v197,s42,v197
M a[52:55],v[216:219],v[224:227],a[52:55]
v_and_b32 v193,s42,v193
v_and_b32 v195,s42,v195
M a[56:59],v[216:219],a[192:195],a[56:59]
v_and_b32 v203,s42,v203
v_and_b32 v201,s42,v201
M a[56:59],a[220:223],a[224:227],a[56:59]
v_and_b32 v199,s42,v199
v_fmac_f32 v193,s43,v197
M a[56:59],a[200:203],a[208:211],a[56:59]
v_fmac_f32 v203,4.0,v195
v_fma_f32 v235,-4.0,v197,v201
M a[60:63],a[200:203],v[220:223],a[60:63]
buffer_load_dwordx4 a[200:203],v250,s[20:23],s47 offen offset:1024 sc1
M a[60:63],a[220:223],a[208:211],a[60:63]
v_fmac_f32 v193,s45,v201
v_fmac_f32 v203,s41,v199
M a[60:63],v[216:219],a[224:227],a[60:63]
s_waitcnt vmcnt(13)
buffer_load_dwordx4 a[220:223],v250,s[20:23],s47 offen offset:2048 sc1
M a[64:67],a[212:215],a[232:235],a[64:67]
s_waitcnt vmcnt(13)
s_add_u32 s48,s73,24576
v_sub_f32 v201,v201,v197
v_fma_f32 v197,-4.0,v195,v199
M a[64:67],a[204:207],a[216:219],a[64:67]
s_waitcnt vmcnt(12)
v_sub_f32 v199,v199,v195
v_add_f32 v195,v235,v197
M a[64:67],a[236:239],a[244:247],a[64:67]
v_sub_f32 v235,v235,v197
v_fma_f32 v197,2.0,v199,v201
M a[68:71],a[236:239],a[196:199],a[68:71]
buffer_load_dwordx4 v[216:219],v250,s[20:23],s48 offen offset:0 sc1
M a[68:71],a[204:207],a[244:247],a[68:71]
v_fmac_f32 v201,-2.0,v199
v_cvt_pk_bf16_f32 v193,v232,v193
M a[68:71],a[212:215],a[216:219],a[68:71]
v_cvt_pk_bf16_f32 v203,v237,v203
v_cvt_pk_bf16_f32 v195,v233,v195
M a[72:75],a[212:215],a[244:247],a[72:75]
v_cvt_pk_bf16_f32 v199,v234,v197
v_cvt_pk_bf16_f32 v197,v238,v235
M a[72:75],a[204:207],a[196:199],a[72:75]
buffer_load_dwordx4 a[232:235],v250,s[20:23],s48 offen offset:1024 sc1
M a[72:75],a[236:239],a[228:231],a[72:75]
v_cvt_pk_bf16_f32 v201,v236,v201
M a[76:79],a[236:239],v[224:227],a[76:79]
M a[76:79],a[204:207],a[228:231],a[76:79]
M a[76:79],a[212:215],a[196:199],a[76:79]
buffer_load_dwordx4 a[216:219],v250,s[20:23],s48 offen offset:2048 sc1
M a[80:83],a[212:215],a[228:231],a[80:83]
s_add_u32 s46,s73,27648
M a[80:83],a[204:207],v[224:227],a[80:83]
M a[80:83],a[236:239],a[192:195],a[80:83]
ds_write2st64_b64 v247,v[192:193],v[202:203] offset0:204 offset1:221
M a[84:87],a[236:239],a[224:227],a[84:87]
s_add_u32 s28,s68,7077888
buffer_load_dwordx4 a[244:247],v250,s[20:23],s46 offen offset:0 sc1
M a[84:87],a[204:207],a[192:195],a[84:87]
ds_read_b128 a[196:199],v248 offset:8704
M a[84:87],a[212:215],v[224:227],a[84:87]
ds_write2st64_b64 v247,v[194:195],v[196:197] offset0:34 offset1:51
M a[88:91],a[212:215],a[192:195],a[88:91]
buffer_load_dwordx2 v[192:193],v245,s[12:15],s28 offen offset:0
M a[88:91],a[204:207],a[224:227],a[88:91]
ds_read_b128 a[228:231],v249 offset:8704
ds_read_b128 v[224:227],v248 offset:9216
M a[88:91],a[236:239],a[208:211],a[88:91]
ds_write2st64_b64 v247,v[198:199],v[200:201] offset0:68 offset1:85
M a[92:95],a[236:239],v[220:223],a[92:95]
buffer_load_dwordx2 v[202:203],v245,s[16:19],s28 offen offset:1536
M a[92:95],a[204:207],a[208:211],a[92:95]
ds_read_b128 a[192:195],v249 offset:9216
M a[92:95],a[212:215],a[224:227],a[92:95]
s_waitcnt vmcnt(17) lgkmcnt(5)
M a[96:99],v[228:231],a[196:199],a[96:99]
s_waitcnt vmcnt(10) lgkmcnt(3)
ds_read_b128 a[236:239],v248 offset:9728
M a[96:99],a[240:243],a[228:231],a[96:99]
s_waitcnt vmcnt(9) lgkmcnt(3)
buffer_load_dwordx2 v[194:195],v245,s[8:11],s28 offen offset:0
M a[96:99],a[248:251],v[224:227],a[96:99]
s_waitcnt lgkmcnt(1)
ds_read_b128 v[220:223],v249 offset:9728
v_lshlrev_b32 v234,16,v208
M a[100:103],a[248:251],a[192:195],a[100:103]
v_lshlrev_b32 v232,16,v204
v_lshlrev_b32 v233,16,v206
M a[100:103],a[240:243],v[224:227],a[100:103]
v_lshlrev_b32 v237,16,v214
v_lshlrev_b32 v236,16,v212
M a[100:103],v[228:231],a[228:231],a[100:103]
buffer_load_dwordx2 v[196:197],v245,s[8:11],s28 offen offset:384
M a[104:107],v[228:231],v[224:227],a[104:107]
ds_read_b128 a[204:207],v248 offset:10240
v_lshlrev_b32 v235,16,v210
M a[104:107],a[240:243],a[192:195],a[104:107]
s_waitcnt lgkmcnt(2)
ds_read_b128 a[208:211],v249 offset:10240
v_fmac_f32 v232,s43,v234
M a[104:107],a[248:251],a[236:239],a[104:107]
s_waitcnt lgkmcnt(2)
v_fmac_f32 v237,4.0,v233
v_fma_f32 v238,-4.0,v234,v236
M a[108:111],a[248:251],v[220:223],a[108:111]
buffer_load_dwordx2 v[198:199],v245,s[8:11],s28 offen offset:768
M a[108:111],a[240:243],a[236:239],a[108:111]
v_fmac_f32 v232,s45,v236
v_fmac_f32 v237,s41,v235
M a[108:111],v[228:231],a[192:195],a[108:111]
v_sub_f32 v236,v236,v234
v_fma_f32 v234,-4.0,v233,v235
M a[112:115],v[228:231],a[236:239],a[112:115]
ds_read_b128 a[212:215],v249 offset:10752
v_sub_f32 v235,v235,v233
M a[112:115],a[240:243],v[220:223],a[112:115]
s_waitcnt lgkmcnt(2)
buffer_load_dwordx2 v[200:201],v245,s[8:11],s28 offen offset:1152
M a[112:115],a[248:251],a[204:207],a[112:115]
s_waitcnt lgkmcnt(1)
ds_read_b128 a[224:227],v248 offset:10752
v_add_f32 v233,v238,v234
M a[116:119],a[248:251],a[208:211],a[116:119]
v_sub_f32 v238,v238,v234
v_fma_f32 v234,2.0,v235,v236
M a[116:119],a[240:243],a[204:207],a[116:119]
v_fmac_f32 v236,-2.0,v235
v_and_b32 v208,s42,v208
M a[116:119],v[228:231],v[220:223],a[116:119]
v_and_b32 v204,s42,v204
v_and_b32 v206,s42,v206
M a[120:123],v[228:231],a[204:207],a[120:123]
v_and_b32 v214,s42,v214
v_and_b32 v212,s42,v212
M a[120:123],a[240:243],a[208:211],a[120:123]
s_waitcnt lgkmcnt(1)
v_and_b32 v210,s42,v210
v_fmac_f32 v204,s43,v208
M a[120:123],a[248:251],a[212:215],a[120:123]
s_waitcnt lgkmcnt(0)
v_fmac_f32 v214,4.0,v206
v_fma_f32 v235,-4.0,v208,v212
M a[124:127],a[248:251],a[224:227],a[124:127]
buffer_load_dwordx4 a[248:251],v250,s[20:23],s46 offen offset:1024 sc1
M a[124:127],a[240:243],a[212:215],a[124:127]
v_fmac_f32 v204,s45,v212
v_fmac_f32 v214,s41,v210
M a[124:127],v[228:231],a[208:211],a[124:127]
s_waitcnt vmcnt(13)
buffer_load_dwordx4 a[240:243],v250,s[20:23],s46 offen offset:2048 sc1
M a[128:131],a[252:255],a[196:199],a[128:131]
s_waitcnt vmcnt(13)
s_add_u32 s47,s73,30720
v_sub_f32 v212,v212,v208
v_fma_f32 v208,-4.0,v206,v210
M a[128:131],a[200:203],a[228:231],a[128:131]
s_waitcnt vmcnt(12)
v_sub_f32 v210,v210,v206
v_add_f32 v206,v235,v208
M a[128:131],a[220:223],v[224:227],a[128:131]
v_sub_f32 v235,v235,v208
v_fma_f32 v208,2.0,v210,v212
M a[132:135],a[220:223],a[192:195],a[132:135]
buffer_load_dwordx4 v[228:231],v250,s[20:23],s47 offen offset:0 sc1
M a[132:135],a[200:203],v[224:227],a[132:135]
v_fmac_f32 v212,-2.0,v210
v_cvt_pk_bf16_f32 v204,v232,v204
M a[132:135],a[252:255],a[228:231],a[132:135]
v_cvt_pk_bf16_f32 v214,v237,v214
v_cvt_pk_bf16_f32 v206,v233,v206
M a[136:139],a[252:255],v[224:227],a[136:139]
v_cvt_pk_bf16_f32 v210,v234,v208
v_cvt_pk_bf16_f32 v208,v238,v235
M a[136:139],a[200:203],a[192:195],a[136:139]
v_cvt_pk_bf16_f32 v212,v236,v212
v_lshlrev_b32 v234,16,v209
M a[136:139],a[220:223],a[236:239],a[136:139]
v_lshlrev_b32 v232,16,v205
v_lshlrev_b32 v233,16,v207
M a[140:143],a[220:223],v[220:223],a[140:143]
v_lshlrev_b32 v237,16,v215
v_lshlrev_b32 v236,16,v213
M a[140:143],a[200:203],a[236:239],a[140:143]
v_lshlrev_b32 v235,16,v211
v_fmac_f32 v232,s43,v234
M a[140:143],a[252:255],a[192:195],a[140:143]
v_fmac_f32 v237,4.0,v233
v_fma_f32 v238,-4.0,v234,v236
M a[144:147],a[252:255],a[236:239],a[144:147]
v_fmac_f32 v232,s45,v236
v_fmac_f32 v237,s41,v235
M a[144:147],a[200:203],v[220:223],a[144:147]
v_sub_f32 v236,v236,v234
v_fma_f32 v234,-4.0,v233,v235
M a[144:147],a[220:223],a[204:207],a[144:147]
v_sub_f32 v235,v235,v233
v_add_f32 v233,v238,v234
M a[148:151],a[220:223],a[208:211],a[148:151]
v_sub_f32 v238,v238,v234
v_fma_f32 v234,2.0,v235,v236
M a[148:151],a[200:203],a[204:207],a[148:151]
v_fmac_f32 v236,-2.0,v235
v_and_b32 v209,s42,v209
M a[148:151],a[252:255],v[220:223],a[148:151]
v_and_b32 v205,s42,v205
v_and_b32 v207,s42,v207
M a[152:155],a[252:255],a[204:207],a[152:155]
v_and_b32 v215,s42,v215
v_and_b32 v213,s42,v213
M a[152:155],a[200:203],a[208:211],a[152:155]
v_and_b32 v211,s42,v211
v_fmac_f32 v205,s43,v209
M a[152:155],a[220:223],a[212:215],a[152:155]
v_fmac_f32 v215,4.0,v207
v_fma_f32 v235,-4.0,v209,v213
M a[156:159],a[220:223],a[224:227],a[156:159]
buffer_load_dwordx4 a[220:223],v250,s[20:23],s47 offen offset:1024 sc1
M a[156:159],a[200:203],a[212:215],a[156:159]
v_fmac_f32 v205,s45,v213
v_fmac_f32 v215,s41,v211
M a[156:159],a[252:255],a[208:211],a[156:159]
s_waitcnt vmcnt(13)
buffer_load_dwordx4 a[200:203],v250,s[20:23],s47 offen offset:2048 sc1
M a[160:163],v[216:219],a[196:199],a[160:163]
s_waitcnt vmcnt(13)
s_add_u32 s48,s73,33792
v_sub_f32 v213,v213,v209
v_fma_f32 v209,-4.0,v207,v211
M a[160:163],a[232:235],a[228:231],a[160:163]
s_waitcnt vmcnt(12)
v_sub_f32 v211,v211,v207
v_add_f32 v207,v235,v209
M a[160:163],a[216:219],v[224:227],a[160:163]
v_sub_f32 v235,v235,v209
v_fma_f32 v209,2.0,v211,v213
M a[164:167],a[216:219],a[192:195],a[164:167]
buffer_load_dwordx4 a[252:255],v250,s[20:23],s48 offen offset:0 sc1
M a[164:167],a[232:235],v[224:227],a[164:167]
v_fmac_f32 v213,-2.0,v211
v_cvt_pk_bf16_f32 v205,v232,v205
M a[164:167],v[216:219],a[228:231],a[164:167]
v_cvt_pk_bf16_f32 v215,v237,v215
v_cvt_pk_bf16_f32 v207,v233,v207
M a[168:171],v[216:219],v[224:227],a[168:171]
v_cvt_pk_bf16_f32 v211,v234,v209
v_cvt_pk_bf16_f32 v209,v238,v235
M a[168:171],a[232:235],a[192:195],a[168:171]
buffer_load_dwordx4 a[196:199],v250,s[20:23],s48 offen offset:1024 sc1
M a[168:171],a[216:219],a[236:239],a[168:171]
v_cvt_pk_bf16_f32 v213,v236,v213
v_fmac_f32 v239,s43,v241
M a[172:175],a[216:219],v[220:223],a[172:175]
v_fmac_f32 v244,4.0,v240
v_fma_f32 v232,-4.0,v241,v243
M a[172:175],a[232:235],a[236:239],a[172:175]
v_fmac_f32 v239,s45,v243
v_fmac_f32 v244,s41,v242
M a[172:175],v[216:219],a[192:195],a[172:175]
buffer_load_dwordx4 a[228:231],v250,s[20:23],s48 offen offset:2048 sc1
M a[176:179],v[216:219],a[236:239],a[176:179]
s_add_u32 s46,s73,36864
v_sub_f32 v243,v243,v241
v_fma_f32 v241,-4.0,v240,v242
M a[176:179],a[232:235],v[220:223],a[176:179]
v_add_u32 v248,0x4400,v248
v_add_u32 v249,0x4400,v249
M a[176:179],a[216:219],a[204:207],a[176:179]
ds_write2st64_b64 v247,v[204:205],v[214:215] offset0:205 offset1:222
M a[180:183],a[216:219],a[208:211],a[180:183]
s_add_u32 s28,s68,7471104
buffer_load_dwordx4 v[224:227],v250,s[20:23],s46 offen offset:0 sc1
M a[180:183],a[232:235],a[204:207],a[180:183]
ds_read_b128 a[192:195],v248 offset:52224
v_sub_f32 v242,v242,v240
M a[180:183],v[216:219],v[220:223],a[180:183]
ds_write2st64_b64 v247,v[206:207],v[208:209] offset0:35 offset1:52
M a[184:187],v[216:219],a[204:207],a[184:187]
buffer_load_dwordx2 v[204:205],v245,s[12:15],s28 offen offset:0
M a[184:187],a[232:235],a[208:211],a[184:187]
ds_read_b128 a[236:239],v249 offset:52224
ds_read_b128 v[220:223],v248 offset:52736
M a[184:187],a[216:219],a[212:215],a[184:187]
ds_write2st64_b64 v247,v[210:211],v[212:213] offset0:69 offset1:86
M a[188:191],a[216:219],a[224:227],a[188:191]
buffer_load_dwordx2 v[214:215],v245,s[16:19],s28 offen offset:1536
M a[188:191],a[232:235],a[212:215],a[188:191]
ds_read_b128 a[204:207],v249 offset:52736
v_add_f32 v240,v232,v241
M a[188:191],v[216:219],a[208:211],a[188:191]
s_waitcnt vmcnt(17) lgkmcnt(5)
v_sub_f32 v232,v232,v241
v_fma_f32 v241,2.0,v242,v243
M v[0:3],a[244:247],a[192:195],v[0:3]
s_waitcnt vmcnt(10) lgkmcnt(3)
ds_read_b128 a[216:219],v248 offset:53248
v_fmac_f32 v243,-2.0,v242
M v[0:3],a[248:251],a[236:239],v[0:3]
s_waitcnt vmcnt(9) lgkmcnt(3)
buffer_load_dwordx2 v[206:207],v245,s[8:11],s28 offen offset:0
M v[0:3],a[240:243],v[220:223],v[0:3]
s_waitcnt lgkmcnt(1)
ds_read_b128 a[224:227],v249 offset:53248
v_cvt_pk_bf16_f32 v233,v239,v244
M v[4:7],a[240:243],a[204:207],v[4:7]
v_cvt_pk_bf16_f32 v234,v240,v232
v_cvt_pk_bf16_f32 v235,v241,v243
M v[4:7],a[248:251],v[220:223],v[4:7]
v_add_u32 v232,104448,v252
M v[4:7],a[244:247],a[236:239],v[4:7]
buffer_load_dwordx2 v[208:209],v245,s[8:11],s28 offen offset:384
M v[8:11],a[244:247],v[220:223],v[8:11]
ds_read_b128 a[212:215],v248 offset:53760
ds_write_b16 v232,v233 offset:0
M v[8:11],a[248:251],a[204:207],v[8:11]
s_waitcnt lgkmcnt(3)
ds_read_b128 a[232:235],v249 offset:53760
ds_write_b16_d16_hi v232,v233 offset:8704
M v[8:11],a[240:243],a[216:219],v[8:11]
s_waitcnt lgkmcnt(4)
ds_write_b16 v252,v234 offset:17408
M v[12:15],a[240:243],a[224:227],v[12:15]
buffer_load_dwordx2 v[210:211],v245,s[8:11],s28 offen offset:768
M v[12:15],a[248:251],a[216:219],v[12:15]
ds_write_b16_d16_hi v252,v234 offset:26112
M v[12:15],a[244:247],a[204:207],v[12:15]
ds_write_b16 v252,v235 offset:34816
M v[16:19],a[244:247],a[216:219],v[16:19]
ds_read_b128 a[208:211],v249 offset:54272
ds_write_b16_d16_hi v252,v235 offset:43520
M v[16:19],a[248:251],a[224:227],v[16:19]
s_waitcnt lgkmcnt(8)
buffer_load_dwordx2 v[212:213],v245,s[8:11],s28 offen offset:1152
M v[16:19],a[240:243],a[212:215],v[16:19]
s_waitcnt lgkmcnt(6)
s_add_u32 s29,s69,6291456
ds_read_b128 v[216:219],v248 offset:54272
v_lshlrev_b32 v234,16,v196
M v[20:23],a[240:243],a[232:235],v[20:23]
v_lshlrev_b32 v232,16,v192
v_lshlrev_b32 v233,16,v194
M v[20:23],a[248:251],a[212:215],v[20:23]
buffer_load_short_d16_hi v239,v246,s[12:15],s29 offen offset:0
M v[20:23],a[244:247],a[224:227],v[20:23]
v_lshlrev_b32 v237,16,v202
v_lshlrev_b32 v236,16,v200
M v[24:27],a[244:247],a[212:215],v[24:27]
buffer_load_short_d16_hi v240,v246,s[8:11],s29 offen offset:0
M v[24:27],a[248:251],a[232:235],v[24:27]
s_waitcnt lgkmcnt(2)
v_lshlrev_b32 v235,16,v198
v_fmac_f32 v232,s43,v234
M v[24:27],a[240:243],a[208:211],v[24:27]
s_waitcnt lgkmcnt(0)
buffer_load_short_d16_hi v241,v246,s[8:11],s29 offen offset:384
M v[28:31],a[240:243],v[216:219],v[28:31]
v_fmac_f32 v237,4.0,v233
v_fma_f32 v238,-4.0,v234,v236
M v[28:31],a[248:251],a[208:211],v[28:31]
buffer_load_dwordx4 a[240:243],v250,s[20:23],s46 offen offset:1024 sc1
M v[28:31],a[244:247],a[232:235],v[28:31]
s_waitcnt vmcnt(16)
v_fmac_f32 v232,s45,v236
v_fmac_f32 v237,s41,v235
M v[32:35],v[228:231],a[192:195],v[32:35]
s_waitcnt vmcnt(15)
v_sub_f32 v236,v236,v234
v_fma_f32 v234,-4.0,v233,v235
M v[32:35],a[220:223],a[236:239],v[32:35]
s_waitcnt vmcnt(14)
v_sub_f32 v235,v235,v233
v_add_f32 v233,v238,v234
M v[32:35],a[200:203],v[220:223],v[32:35]
buffer_load_dwordx4 a[248:251],v250,s[20:23],s46 offen offset:2048 sc1
M v[36:39],a[200:203],a[204:207],v[36:39]
s_add_u32 s47,s73,39936
v_sub_f32 v238,v238,v234
v_fma_f32 v234,2.0,v235,v236
M v[36:39],a[220:223],v[220:223],v[36:39]
v_fmac_f32 v236,-2.0,v235
v_and_b32 v196,s42,v196
M v[36:39],v[228:231],a[236:239],v[36:39]
v_and_b32 v192,s42,v192
v_and_b32 v194,s42,v194
M v[40:43],v[228:231],v[220:223],v[40:43]
buffer_load_dwordx4 a[244:247],v250,s[20:23],s47 offen offset:0 sc1
M v[40:43],a[220:223],a[204:207],v[40:43]
v_and_b32 v202,s42,v202
v_and_b32 v200,s42,v200
M v[40:43],a[200:203],a[216:219],v[40:43]
v_and_b32 v198,s42,v198
v_fmac_f32 v192,s43,v196
M v[44:47],a[200:203],a[224:227],v[44:47]
v_fmac_f32 v202,4.0,v194
v_fma_f32 v235,-4.0,v196,v200
M v[44:47],a[220:223],a[216:219],v[44:47]
buffer_load_short_d16_hi v242,v246,s[8:11],s29 offen offset:768
M v[44:47],v[228:231],a[204:207],v[44:47]
v_fmac_f32 v192,s45,v200
v_fmac_f32 v202,s41,v198
M v[48:51],v[228:231],a[216:219],v[48:51]
buffer_load_short_d16_hi v243,v246,s[8:11],s29 offen offset:1152
M v[48:51],a[220:223],a[224:227],v[48:51]
v_sub_f32 v200,v200,v196
v_fma_f32 v196,-4.0,v194,v198
M v[48:51],a[200:203],a[212:215],v[48:51]
buffer_load_short_d16_hi v244,v246,s[16:19],s29 offen offset:1536
M v[52:55],a[200:203],a[232:235],v[52:55]
v_sub_f32 v198,v198,v194
v_add_f32 v194,v235,v196
M v[52:55],a[220:223],a[212:215],v[52:55]
v_sub_f32 v235,v235,v196
v_fma_f32 v196,2.0,v198,v200
M v[52:55],v[228:231],a[224:227],v[52:55]
v_fmac_f32 v200,-2.0,v198
v_cvt_pk_bf16_f32 v192,v232,v192
M v[56:59],v[228:231],a[212:215],v[56:59]
v_cvt_pk_bf16_f32 v202,v237,v202
v_cvt_pk_bf16_f32 v194,v233,v194
M v[56:59],a[220:223],a[232:235],v[56:59]
v_cvt_pk_bf16_f32 v198,v234,v196
v_cvt_pk_bf16_f32 v196,v238,v235
M v[56:59],a[200:203],a[208:211],v[56:59]
v_cvt_pk_bf16_f32 v200,v236,v200
v_lshlrev_b32 v234,16,v197
M v[60:63],a[200:203],v[216:219],v[60:63]
buffer_load_dwordx4 a[200:203],v250,s[20:23],s47 offen offset:1024 sc1
M v[60:63],a[220:223],a[208:211],v[60:63]
v_lshlrev_b32 v232,16,v193
v_lshlrev_b32 v233,16,v195
M v[60:63],v[228:231],a[232:235],v[60:63]
s_waitcnt vmcnt(19)
buffer_load_dwordx4 a[220:223],v250,s[20:23],s47 offen offset:2048 sc1
M v[64:67],a[252:255],a[192:195],v[64:67]
s_waitcnt vmcnt(19)
s_add_u32 s48,s73,43008
v_lshlrev_b32 v237,16,v203
v_lshlrev_b32 v236,16,v201
M v[64:67],a[196:199],a[236:239],v[64:67]
s_waitcnt vmcnt(18)
v_lshlrev_b32 v235,16,v199
v_fmac_f32 v232,s43,v234
M v[64:67],a[228:231],v[220:223],v[64:67]
v_fmac_f32 v237,4.0,v233
v_fma_f32 v238,-4.0,v234,v236
M v[68:71],a[228:231],a[204:207],v[68:71]
buffer_load_dwordx4 v[228:231],v250,s[20:23],s48 offen offset:0 sc1
M v[68:71],a[196:199],v[220:223],v[68:71]
v_fmac_f32 v232,s45,v236
v_fmac_f32 v237,s41,v235
M v[68:71],a[252:255],a[236:239],v[68:71]
v_sub_f32 v236,v236,v234
v_fma_f32 v234,-4.0,v233,v235
M v[72:75],a[252:255],v[220:223],v[72:75]
v_sub_f32 v235,v235,v233
v_add_f32 v233,v238,v234
M v[72:75],a[196:199],a[204:207],v[72:75]
buffer_load_dwordx4 a[192:195],v250,s[20:23],s48 offen offset:1024 sc1
M v[72:75],a[228:231],a[216:219],v[72:75]
v_sub_f32 v238,v238,v234
v_fma_f32 v234,2.0,v235,v236
M v[76:79],a[228:231],a[224:227],v[76:79]
v_fmac_f32 v236,-2.0,v235
v_and_b32 v197,s42,v197
M v[76:79],a[196:199],a[216:219],v[76:79]
v_and_b32 v193,s42,v193
v_and_b32 v195,s42,v195
M v[76:79],a[252:255],a[204:207],v[76:79]
buffer_load_dwordx4 a[236:239],v250,s[20:23],s48 offen offset:2048 sc1
M v[80:83],a[252:255],a[216:219],v[80:83]
s_add_u32 s46,s74,9216
v_and_b32 v203,s42,v203
v_and_b32 v201,s42,v201
M v[80:83],a[196:199],a[224:227],v[80:83]
v_and_b32 v199,s42,v199
v_fmac_f32 v193,s43,v197
M v[80:83],a[228:231],a[212:215],v[80:83]
v_fmac_f32 v203,4.0,v195
v_fma_f32 v235,-4.0,v197,v201
M v[84:87],a[228:231],a[232:235],v[84:87]
buffer_load_dwordx4 v[220:223],v250,s[20:23],s46 offen offset:0 sc1
M v[84:87],a[196:199],a[212:215],v[84:87]
ds_read_b128 a[204:207],v248 offset:60928
v_fmac_f32 v193,s45,v201
M v[84:87],a[252:255],a[224:227],v[84:87]
ds_read_b128 a[216:219],v249 offset:60928
v_fmac_f32 v203,s41,v199
M v[88:91],a[252:255],a[212:215],v[88:91]
ds_read_b128 a[224:227],v248 offset:61440
v_sub_f32 v201,v201,v197
M v[88:91],a[196:199],a[232:235],v[88:91]
ds_read_b128 a[212:215],v249 offset:61440
v_fma_f32 v197,-4.0,v195,v199
M v[88:91],a[228:231],a[208:211],v[88:91]
v_sub_f32 v199,v199,v195
v_add_f32 v195,v235,v197
M v[92:95],a[228:231],v[216:219],v[92:95]
v_sub_f32 v235,v235,v197
v_fma_f32 v197,2.0,v199,v201
M v[92:95],a[196:199],a[208:211],v[92:95]
v_fmac_f32 v201,-2.0,v199
v_cvt_pk_bf16_f32 v193,v232,v193
M v[92:95],a[252:255],a[232:235],v[92:95]
s_waitcnt vmcnt(21) lgkmcnt(3)
v_cvt_pk_bf16_f32 v203,v237,v203
v_cvt_pk_bf16_f32 v195,v233,v195
M v[96:99],v[224:227],a[204:207],v[96:99]
s_waitcnt vmcnt(11) lgkmcnt(2)
ds_read_b128 a[228:231],v248 offset:61952
v_cvt_pk_bf16_f32 v199,v234,v197
M v[96:99],a[240:243],a[216:219],v[96:99]
s_waitcnt vmcnt(10) lgkmcnt(2)
ds_read_b128 v[216:219],v249 offset:61952
v_cvt_pk_bf16_f32 v197,v238,v235
M v[96:99],a[248:251],a[224:227],v[96:99]
s_waitcnt lgkmcnt(2)
v_cvt_pk_bf16_f32 v201,v236,v201
v_lshlrev_b32 v234,16,v208
M v[100:103],a[248:251],a[212:215],v[100:103]
v_lshlrev_b32 v232,16,v204
v_lshlrev_b32 v233,16,v206
M v[100:103],a[240:243],a[224:227],v[100:103]
v_lshlrev_b32 v237,16,v214
v_lshlrev_b32 v236,16,v212
M v[100:103],v[224:227],a[216:219],v[100:103]
ds_write2st64_b64 v247,v[192:193],v[202:203] offset0:206 offset1:223
M v[104:107],v[224:227],a[224:227],v[104:107]
s_add_u32 s28,s69,6291456
buffer_load_dwordx2 v[192:193],v245,s[12:15],s28 offen offset:0
M v[104:107],a[240:243],a[212:215],v[104:107]
s_waitcnt lgkmcnt(2)
ds_read_b128 a[196:199],v248 offset:62464
ds_read_b128 a[208:211],v249 offset:62464
M v[104:107],a[248:251],a[228:231],v[104:107]
s_waitcnt lgkmcnt(3)
buffer_load_dwordx2 v[202:203],v245,s[16:19],s28 offen offset:1536
M v[108:111],a[248:251],v[216:219],v[108:111]
v_lshlrev_b32 v235,16,v210
v_fmac_f32 v232,s43,v234
M v[108:111],a[240:243],a[228:231],v[108:111]
v_fmac_f32 v237,4.0,v233
v_fma_f32 v238,-4.0,v234,v236
M v[108:111],v[224:227],a[212:215],v[108:111]
ds_write2st64_b64 v247,v[194:195],v[196:197] offset0:36 offset1:53
M v[112:115],v[224:227],a[228:231],v[112:115]
buffer_load_dwordx2 v[194:195],v245,s[8:11],s28 offen offset:0
M v[112:115],a[240:243],v[216:219],v[112:115]
s_waitcnt lgkmcnt(2)
ds_read_b128 a[232:235],v249 offset:62976
ds_read_b128 a[252:255],v248 offset:62976
M v[112:115],a[248:251],a[196:199],v[112:115]
s_waitcnt lgkmcnt(3)
ds_write2st64_b64 v247,v[198:199],v[200:201] offset0:70 offset1:87
M v[116:119],a[248:251],a[208:211],v[116:119]
buffer_load_dwordx2 v[196:197],v245,s[8:11],s28 offen offset:384
M v[116:119],a[240:243],a[196:199],v[116:119]
v_fmac_f32 v232,s45,v236
v_fmac_f32 v237,s41,v235
M v[116:119],v[224:227],v[216:219],v[116:119]
v_sub_f32 v236,v236,v234
v_fma_f32 v234,-4.0,v233,v235
M v[120:123],v[224:227],a[196:199],v[120:123]
v_sub_f32 v235,v235,v233
v_add_f32 v233,v238,v234
M v[120:123],a[240:243],a[208:211],v[120:123]
s_waitcnt lgkmcnt(2)
buffer_load_dwordx2 v[198:199],v245,s[8:11],s28 offen offset:768
M v[120:123],a[248:251],a[232:235],v[120:123]
s_waitcnt lgkmcnt(1)
v_sub_f32 v238,v238,v234
v_fma_f32 v234,2.0,v235,v236
M v[124:127],a[248:251],a[252:255],v[124:127]
v_fmac_f32 v236,-2.0,v235
v_and_b32 v208,s42,v208
M v[124:127],a[240:243],a[232:235],v[124:127]
v_and_b32 v204,s42,v204
v_and_b32 v206,s42,v206
M v[124:127],v[224:227],a[208:211],v[124:127]
s_waitcnt vmcnt(14)
buffer_load_dwordx4 a[248:251],v250,s[20:23],s46 offen offset:1024 sc1
M v[128:131],a[244:247],a[204:207],v[128:131]
s_waitcnt vmcnt(11)
v_and_b32 v214,s42,v214
v_and_b32 v212,s42,v212
M v[128:131],a[200:203],a[216:219],v[128:131]
s_waitcnt vmcnt(10)
v_and_b32 v210,s42,v210
v_fmac_f32 v204,s43,v208
M v[128:131],a[220:223],a[224:227],v[128:131]
v_fmac_f32 v214,4.0,v206
v_fma_f32 v235,-4.0,v208,v212
M v[132:135],a[220:223],a[212:215],v[132:135]
buffer_load_dwordx4 a[240:243],v250,s[20:23],s46 offen offset:2048 sc1
M v[132:135],a[200:203],a[224:227],v[132:135]
s_add_u32 s47,s74,12288
v_fmac_f32 v204,s45,v212
v_fmac_f32 v214,s41,v210
M v[132:135],a[244:247],a[216:219],v[132:135]
v_sub_f32 v212,v212,v208
v_fma_f32 v208,-4.0,v206,v210
M v[136:139],a[244:247],a[224:227],v[136:139]
v_sub_f32 v210,v210,v206
v_add_f32 v206,v235,v208
M v[136:139],a[200:203],a[212:215],v[136:139]
buffer_load_dwordx4 v[224:227],v250,s[20:23],s47 offen offset:0 sc1
M v[136:139],a[220:223],a[228:231],v[136:139]
v_sub_f32 v235,v235,v208
v_fma_f32 v208,2.0,v210,v212
M v[140:143],a[220:223],v[216:219],v[140:143]
v_fmac_f32 v212,-2.0,v210
v_cvt_pk_bf16_f32 v204,v232,v204
M v[140:143],a[200:203],a[228:231],v[140:143]
v_cvt_pk_bf16_f32 v214,v237,v214
v_cvt_pk_bf16_f32 v206,v233,v206
M v[140:143],a[244:247],a[212:215],v[140:143]
buffer_load_dwordx2 v[200:201],v245,s[8:11],s28 offen offset:1152
M v[144:147],a[244:247],a[228:231],v[144:147]
v_cvt_pk_bf16_f32 v210,v234,v208
v_cvt_pk_bf16_f32 v208,v238,v235
M v[144:147],a[200:203],v[216:219],v[144:147]
v_cvt_pk_bf16_f32 v212,v236,v212
v_lshlrev_b32 v234,16,v209
M v[144:147],a[220:223],a[196:199],v[144:147]
v_lshlrev_b32 v232,16,v205
v_lshlrev_b32 v233,16,v207
M v[148:151],a[220:223],a[208:211],v[148:151]
v_lshlrev_b32 v237,16,v215
v_lshlrev_b32 v236,16,v213
M v[148:151],a[200:203],a[196:199],v[148:151]
v_lshlrev_b32 v235,16,v211
v_fmac_f32 v232,s43,v234
M v[148:151],a[244:247],v[216:219],v[148:151]
v_fmac_f32 v237,4.0,v233
v_fma_f32 v238,-4.0,v234,v236
M v[152:155],a[244:247],a[196:199],v[152:155]
v_fmac_f32 v232,s45,v236
v_fmac_f32 v237,s41,v235
M v[152:155],a[200:203],a[208:211],v[152:155]
v_sub_f32 v236,v236,v234
v_fma_f32 v234,-4.0,v233,v235
M v[152:155],a[220:223],a[232:235],v[152:155]
v_sub_f32 v235,v235,v233
v_add_f32 v233,v238,v234
M v[156:159],a[220:223],a[252:255],v[156:159]
buffer_load_dwordx4 a[220:223],v250,s[20:23],s47 offen offset:1024 sc1
v_sub_f32 v238,v238,v234
v_fma_f32 v234,2.0,v235,v236
M v[156:159],a[200:203],a[232:235],v[156:159]
v_fmac_f32 v236,-2.0,v235
v_and_b32 v209,s42,v209
v_and_b32 v205,s42,v205
v_and_b32 v207,s42,v207
M v[156:159],a[244:247],a[208:211],v[156:159]
s_waitcnt vmcnt(13)
buffer_load_dwordx4 a[200:203],v250,s[20:23],s47 offen offset:2048 sc1
v_and_b32 v215,s42,v215
v_and_b32 v213,s42,v213
v_and_b32 v211,s42,v211
v_fmac_f32 v205,s43,v209
M v[160:163],v[228:231],a[204:207],v[160:163]
s_waitcnt vmcnt(13)
s_add_u32 s48,s74,15360
v_fmac_f32 v215,4.0,v207
v_fma_f32 v235,-4.0,v209,v213
v_fmac_f32 v205,s45,v213
v_fmac_f32 v215,s41,v211
M v[160:163],a[192:195],a[216:219],v[160:163]
s_waitcnt vmcnt(12)
buffer_load_dwordx4 a[244:247],v250,s[20:23],s48 offen offset:0 sc1
v_sub_f32 v213,v213,v209
v_fma_f32 v209,-4.0,v207,v211
v_sub_f32 v211,v211,v207
v_add_f32 v207,v235,v209
M v[160:163],a[236:239],a[224:227],v[160:163]
v_sub_f32 v235,v235,v209
v_fma_f32 v209,2.0,v211,v213
v_fmac_f32 v213,-2.0,v211
v_cvt_pk_bf16_f32 v205,v232,v205
M v[164:167],a[236:239],a[212:215],v[164:167]
buffer_load_dwordx4 a[204:207],v250,s[20:23],s48 offen offset:1024 sc1
v_cvt_pk_bf16_f32 v215,v237,v215
v_cvt_pk_bf16_f32 v207,v233,v207
v_cvt_pk_bf16_f32 v211,v234,v209
v_cvt_pk_bf16_f32 v209,v238,v235
M v[164:167],a[192:195],a[224:227],v[164:167]
v_cvt_pk_bf16_f32 v213,v236,v213
M v[164:167],v[228:231],a[216:219],v[164:167]
ds_write2st64_b64 v247,v[204:205],v[214:215] offset0:207 offset1:224
M v[168:171],v[228:231],a[224:227],v[168:171]
s_add_u32 s28,s69,6684672
buffer_load_dwordx4 a[216:219],v250,s[20:23],s48 offen offset:2048 sc1
M v[168:171],a[192:195],a[212:215],v[168:171]
s_add_u32 s46,s74,18432
M v[168:171],a[236:239],a[228:231],v[168:171]
ds_write2st64_b64 v247,v[206:207],v[208:209] offset0:37 offset1:54
M v[172:175],a[236:239],v[216:219],v[172:175]
buffer_load_dwordx4 a[224:227],v250,s[20:23],s46 offen offset:0 sc1
M v[172:175],a[192:195],a[228:231],v[172:175]
M v[172:175],v[228:231],a[212:215],v[172:175]
ds_write2st64_b64 v247,v[210:211],v[212:213] offset0:71 offset1:88
M v[176:179],v[228:231],a[228:231],v[176:179]
buffer_load_dwordx2 v[204:205],v245,s[12:15],s28 offen offset:0
M v[176:179],a[192:195],v[216:219],v[176:179]
M v[176:179],a[236:239],a[196:199],v[176:179]
s_waitcnt lgkmcnt(0)
s_barrier
M v[180:183],a[236:239],a[208:211],v[180:183]
M v[180:183],a[192:195],a[196:199],v[180:183]
buffer_load_dwordx2 v[214:215],v245,s[16:19],s28 offen offset:1536
M v[180:183],v[228:231],v[216:219],v[180:183]
ds_read_b128 a[212:215],v248 offset:0
ds_read_b128 a[228:231],v249 offset:0
M v[184:187],v[228:231],a[196:199],v[184:187]
s_waitcnt vmcnt(13)
ds_read_b128 v[216:219],v248 offset:512
v_lshlrev_b32 v234,16,v196
M v[184:187],a[192:195],a[208:211],v[184:187]
ds_read_b128 a[196:199],v249 offset:512
v_lshlrev_b32 v232,16,v192
M v[184:187],a[236:239],a[232:235],v[184:187]
buffer_load_dwordx2 v[206:207],v245,s[8:11],s28 offen offset:0
M v[188:191],a[236:239],a[252:255],v[188:191]
v_lshlrev_b32 v233,16,v194
v_lshlrev_b32 v237,16,v202
M v[188:191],a[192:195],a[232:235],v[188:191]
s_waitcnt vmcnt(9)
v_lshlrev_b32 v236,16,v200
v_lshlrev_b32 v235,16,v198
M v[188:191],v[228:231],a[208:211],v[188:191]
s_waitcnt lgkmcnt(3)
v_fmac_f32 v232,s43,v234
v_fmac_f32 v237,4.0,v233
M a[0:3],v[220:223],a[212:215],a[0:3]
s_waitcnt lgkmcnt(2)
buffer_load_dwordx2 v[208:209],v245,s[8:11],s28 offen offset:384
M a[0:3],a[248:251],a[228:231],a[0:3]
s_waitcnt lgkmcnt(1)
ds_read_b128 a[236:239],v248 offset:1024
ds_read_b128 a[252:255],v249 offset:1024
M a[0:3],a[240:243],v[216:219],a[0:3]
s_waitcnt lgkmcnt(2)
v_fma_f32 v238,-4.0,v234,v236
v_fmac_f32 v232,s45,v236
M a[4:7],a[240:243],a[196:199],a[4:7]
v_fmac_f32 v237,s41,v235
v_sub_f32 v236,v236,v234
M a[4:7],a[248:251],v[216:219],a[4:7]
buffer_load_dwordx2 v[210:211],v245,s[8:11],s28 offen offset:768
M a[4:7],v[220:223],a[228:231],a[4:7]
v_fma_f32 v234,-4.0,v233,v235
v_sub_f32 v235,v235,v233
M a[8:11],v[220:223],v[216:219],a[8:11]
ds_read_b128 a[192:195],v248 offset:1536
v_add_f32 v233,v238,v234
M a[8:11],a[248:251],a[196:199],a[8:11]
s_waitcnt lgkmcnt(2)
ds_read_b128 a[232:235],v249 offset:1536
v_sub_f32 v238,v238,v234
M a[8:11],a[240:243],a[236:239],a[8:11]
s_waitcnt lgkmcnt(2)
buffer_load_dwordx2 v[212:213],v245,s[8:11],s28 offen offset:1152
M a[12:15],a[240:243],a[252:255],a[12:15]
v_fma_f32 v234,2.0,v235,v236
v_fmac_f32 v236,-2.0,v235
M a[12:15],a[248:251],a[236:239],a[12:15]
v_and_b32 v196,s42,v196
v_and_b32 v192,s42,v192
M a[12:15],v[220:223],a[196:199],a[12:15]
v_and_b32 v194,s42,v194
v_and_b32 v202,s42,v202
M a[16:19],v[220:223],a[236:239],a[16:19]
ds_read_b128 a[208:211],v249 offset:2048
v_and_b32 v200,s42,v200
M a[16:19],a[248:251],a[252:255],a[16:19]
s_waitcnt lgkmcnt(2)
ds_read_b128 v[228:231],v248 offset:2048
v_and_b32 v198,s42,v198
M a[16:19],a[240:243],a[192:195],a[16:19]
s_waitcnt lgkmcnt(2)
v_fmac_f32 v192,s43,v196
v_fmac_f32 v202,4.0,v194
M a[20:23],a[240:243],a[232:235],a[20:23]
v_fma_f32 v235,-4.0,v196,v200
v_fmac_f32 v192,s45,v200
M a[20:23],a[248:251],a[192:195],a[20:23]
v_fmac_f32 v202,s41,v198
v_sub_f32 v200,v200,v196
M a[20:23],v[220:223],a[252:255],a[20:23]
v_fma_f32 v196,-4.0,v194,v198
v_sub_f32 v198,v198,v194
M a[24:27],v[220:223],a[192:195],a[24:27]
v_add_f32 v194,v235,v196
v_sub_f32 v235,v235,v196
M a[24:27],a[248:251],a[232:235],a[24:27]
s_waitcnt lgkmcnt(1)
v_fma_f32 v196,2.0,v198,v200
v_fmac_f32 v200,-2.0,v198
M a[24:27],a[240:243],a[208:211],a[24:27]
s_waitcnt lgkmcnt(0)
v_cvt_pk_bf16_f32 v192,v232,v192
v_cvt_pk_bf16_f32 v202,v237,v202
M a[28:31],a[240:243],v[228:231],a[28:31]
buffer_load_dwordx4 a[240:243],v250,s[20:23],s46 offen offset:1024 sc1
M a[28:31],a[248:251],a[208:211],a[28:31]
v_cvt_pk_bf16_f32 v194,v233,v194
v_cvt_pk_bf16_f32 v198,v234,v196
M a[28:31],v[220:223],a[232:235],a[28:31]
buffer_load_dwordx4 a[248:251],v250,s[20:23],s46 offen offset:2048 sc1
M a[32:35],v[224:227],a[212:215],a[32:35]
s_waitcnt vmcnt(13)
s_add_u32 s47,s74,21504
v_cvt_pk_bf16_f32 v196,v238,v235
v_cvt_pk_bf16_f32 v200,v236,v200
M a[32:35],a[220:223],a[228:231],a[32:35]
s_waitcnt vmcnt(12)
v_lshlrev_b32 v234,16,v197
v_lshlrev_b32 v232,16,v193
M a[32:35],a[200:203],v[216:219],a[32:35]
v_lshlrev_b32 v233,16,v195
v_lshlrev_b32 v237,16,v203
M a[36:39],a[200:203],a[196:199],a[36:39]
buffer_load_dwordx4 v[220:223],v250,s[20:23],s47 offen offset:0 sc1
M a[36:39],a[220:223],v[216:219],a[36:39]
v_lshlrev_b32 v236,16,v201
v_lshlrev_b32 v235,16,v199
M a[36:39],v[224:227],a[228:231],a[36:39]
v_fmac_f32 v232,s43,v234
v_fmac_f32 v237,4.0,v233
M a[40:43],v[224:227],v[216:219],a[40:43]
v_fma_f32 v238,-4.0,v234,v236
v_fmac_f32 v232,s45,v236
M a[40:43],a[220:223],a[196:199],a[40:43]
v_fmac_f32 v237,s41,v235
v_sub_f32 v236,v236,v234
M a[40:43],a[200:203],a[236:239],a[40:43]
v_fma_f32 v234,-4.0,v233,v235
v_sub_f32 v235,v235,v233
M a[44:47],a[200:203],a[252:255],a[44:47]
v_add_f32 v233,v238,v234
v_sub_f32 v238,v238,v234
M a[44:47],a[220:223],a[236:239],a[44:47]
v_fma_f32 v234,2.0,v235,v236
v_fmac_f32 v236,-2.0,v235
M a[44:47],v[224:227],a[196:199],a[44:47]
v_and_b32 v197,s42,v197
v_and_b32 v193,s42,v193
M a[48:51],v[224:227],a[236:239],a[48:51]
v_and_b32 v195,s42,v195
v_and_b32 v203,s42,v203
M a[48:51],a[220:223],a[252:255],a[48:51]
v_and_b32 v201,s42,v201
v_and_b32 v199,s42,v199
M a[48:51],a[200:203],a[192:195],a[48:51]
v_fmac_f32 v193,s43,v197
v_fmac_f32 v203,4.0,v195
M a[52:55],a[200:203],a[232:235],a[52:55]
v_fma_f32 v235,-4.0,v197,v201
v_fmac_f32 v193,s45,v201
M a[52:55],a[220:223],a[192:195],a[52:55]
v_fmac_f32 v203,s41,v199
v_sub_f32 v201,v201,v197
M a[52:55],v[224:227],a[252:255],a[52:55]
v_fma_f32 v197,-4.0,v195,v199
v_sub_f32 v199,v199,v195
M a[56:59],v[224:227],a[192:195],a[56:59]
v_add_f32 v195,v235,v197
v_sub_f32 v235,v235,v197
M a[56:59],a[220:223],a[232:235],a[56:59]
v_fma_f32 v197,2.0,v199,v201
v_fmac_f32 v201,-2.0,v199
M a[56:59],a[200:203],a[208:211],a[56:59]
v_cvt_pk_bf16_f32 v193,v232,v193
v_cvt_pk_bf16_f32 v203,v237,v203
M a[60:63],a[200:203],v[228:231],a[60:63]
buffer_load_dwordx4 a[200:203],v250,s[20:23],s47 offen offset:1024 sc1
M a[60:63],a[220:223],a[208:211],a[60:63]
v_cvt_pk_bf16_f32 v195,v233,v195
v_cvt_pk_bf16_f32 v199,v234,v197
M a[60:63],v[224:227],a[232:235],a[60:63]
s_waitcnt vmcnt(13)
buffer_load_dwordx4 a[220:223],v250,s[20:23],s47 offen offset:2048 sc1
M a[64:67],a[244:247],a[212:215],a[64:67]
s_waitcnt vmcnt(13)
s_add_u32 s48,s74,24576
v_cvt_pk_bf16_f32 v197,v238,v235
v_cvt_pk_bf16_f32 v201,v236,v201
M a[64:67],a[204:207],a[228:231],a[64:67]
s_waitcnt vmcnt(7)
v_lshlrev_b32 v234,16,v208
v_lshlrev_b32 v232,16,v204
M a[64:67],a[216:219],v[216:219],a[64:67]
ds_write2st64_b64 v247,v[192:193],v[202:203] offset0:238 offset1:255
M a[68:71],a[216:219],a[196:199],a[68:71]
s_add_u32 s28,s69,7077888
buffer_load_dwordx4 v[224:227],v250,s[20:23],s48 offen offset:0 sc1
M a[68:71],a[204:207],v[216:219],a[68:71]
v_lshlrev_b32 v233,16,v206
v_lshlrev_b32 v237,16,v214
M a[68:71],a[244:247],a[228:231],a[68:71]
ds_write2st64_b64 v247,v[194:195],v[196:197] offset0:0 offset1:17
M a[72:75],a[244:247],v[216:219],a[72:75]
buffer_load_dwordx4 a[212:215],v250,s[20:23],s48 offen offset:1024 sc1
M a[72:75],a[204:207],a[196:199],a[72:75]
s_waitcnt vmcnt(7)
v_lshlrev_b32 v236,16,v212
v_lshlrev_b32 v235,16,v210
M a[72:75],a[216:219],a[236:239],a[72:75]
ds_write2st64_b64 v247,v[198:199],v[200:201] offset0:136 offset1:153
M a[76:79],a[216:219],a[252:255],a[76:79]
buffer_load_dwordx4 a[228:231],v250,s[20:23],s48 offen offset:2048 sc1
M a[76:79],a[204:207],a[236:239],a[76:79]
s_add_u32 s46,s74,27648
v_fmac_f32 v232,s43,v234
v_fmac_f32 v237,4.0,v233
M a[76:79],a[244:247],a[196:199],a[76:79]
v_fma_f32 v238,-4.0,v234,v236
v_fmac_f32 v232,s45,v236
M a[80:83],a[244:247],a[236:239],a[80:83]
v_fmac_f32 v237,s41,v235
v_sub_f32 v236,v236,v234
M a[80:83],a[204:207],a[252:255],a[80:83]
buffer_load_dwordx4 v[216:219],v250,s[20:23],s46 offen offset:0 sc1
M a[80:83],a[216:219],a[192:195],a[80:83]
v_fma_f32 v234,-4.0,v233,v235
v_sub_f32 v235,v235,v233
M a[84:87],a[216:219],a[232:235],a[84:87]
v_add_f32 v233,v238,v234
v_sub_f32 v238,v238,v234
M a[84:87],a[204:207],a[192:195],a[84:87]
ds_read_b128 a[196:199],v248 offset:8704
v_fma_f32 v234,2.0,v235,v236
M a[84:87],a[244:247],a[252:255],a[84:87]
buffer_load_dwordx2 v[192:193],v245,s[12:15],s28 offen offset:0
M a[88:91],a[244:247],a[192:195],a[88:91]
ds_read_b128 a[236:239],v249 offset:8704
ds_read_b128 a[252:255],v248 offset:9216
M a[88:91],a[204:207],a[232:235],a[88:91]
ds_read_b128 a[192:195],v249 offset:9216
v_fmac_f32 v236,-2.0,v235
M a[88:91],a[216:219],a[208:211],a[88:91]
v_and_b32 v208,s42,v208
v_and_b32 v204,s42,v204
M a[92:95],a[216:219],v[228:231],a[92:95]
buffer_load_dwordx2 v[202:203],v245,s[16:19],s28 offen offset:1536
M a[92:95],a[204:207],a[208:211],a[92:95]
v_and_b32 v206,s42,v206
v_and_b32 v214,s42,v214
M a[92:95],a[244:247],a[232:235],a[92:95]
s_waitcnt lgkmcnt(3)
v_and_b32 v212,s42,v212
v_and_b32 v210,s42,v210
M a[96:99],a[224:227],a[196:199],a[96:99]
s_waitcnt vmcnt(10) lgkmcnt(2)
ds_read_b128 a[216:219],v248 offset:9728
v_fmac_f32 v204,s43,v208
M a[96:99],a[240:243],a[236:239],a[96:99]
s_waitcnt vmcnt(9) lgkmcnt(2)
buffer_load_dwordx2 v[194:195],v245,s[8:11],s28 offen offset:0
M a[96:99],a[248:251],a[252:255],a[96:99]
s_waitcnt lgkmcnt(1)
ds_read_b128 v[228:231],v249 offset:9728
v_fmac_f32 v214,4.0,v206
M a[100:103],a[248:251],a[192:195],a[100:103]
v_fma_f32 v235,-4.0,v208,v212
v_fmac_f32 v204,s45,v212
M a[100:103],a[240:243],a[252:255],a[100:103]
v_fmac_f32 v214,s41,v210
v_sub_f32 v212,v212,v208
M a[100:103],a[224:227],a[236:239],a[100:103]
buffer_load_dwordx2 v[196:197],v245,s[8:11],s28 offen offset:384
M a[104:107],a[224:227],a[252:255],a[104:107]
ds_read_b128 a[204:207],v248 offset:10240
v_fma_f32 v208,-4.0,v206,v210
M a[104:107],a[240:243],a[192:195],a[104:107]
s_waitcnt lgkmcnt(2)
ds_read_b128 a[208:211],v249 offset:10240
v_sub_f32 v210,v210,v206
M a[104:107],a[248:251],a[216:219],a[104:107]
s_waitcnt lgkmcnt(2)
v_add_f32 v206,v235,v208
v_sub_f32 v235,v235,v208
M a[108:111],a[248:251],v[228:231],a[108:111]
buffer_load_dwordx2 v[198:199],v245,s[8:11],s28 offen offset:768
M a[108:111],a[240:243],a[216:219],a[108:111]
v_fma_f32 v208,2.0,v210,v212
v_fmac_f32 v212,-2.0,v210
M a[108:111],a[224:227],a[192:195],a[108:111]
v_cvt_pk_bf16_f32 v204,v232,v204
v_cvt_pk_bf16_f32 v214,v237,v214
M a[112:115],a[224:227],a[216:219],a[112:115]
ds_read_b128 a[232:235],v249 offset:10752
v_cvt_pk_bf16_f32 v206,v233,v206
M a[112:115],a[240:243],v[228:231],a[112:115]
s_waitcnt lgkmcnt(2)
buffer_load_dwordx2 v[200:201],v245,s[8:11],s28 offen offset:1152
M a[112:115],a[248:251],a[204:207],a[112:115]
s_waitcnt lgkmcnt(1)
ds_read_b128 a[244:247],v248 offset:10752
v_cvt_pk_bf16_f32 v210,v234,v208
M a[116:119],a[248:251],a[208:211],a[116:119]
v_cvt_pk_bf16_f32 v208,v238,v235
v_cvt_pk_bf16_f32 v212,v236,v212
M a[116:119],a[240:243],a[204:207],a[116:119]
v_lshlrev_b32 v234,16,v209
v_lshlrev_b32 v232,16,v205
M a[116:119],a[224:227],v[228:231],a[116:119]
v_lshlrev_b32 v233,16,v207
v_lshlrev_b32 v237,16,v215
M a[120:123],a[224:227],a[204:207],a[120:123]
v_lshlrev_b32 v236,16,v213
v_lshlrev_b32 v235,16,v211
M a[120:123],a[240:243],a[208:211],a[120:123]
s_waitcnt lgkmcnt(1)
v_fmac_f32 v232,s43,v234
v_fmac_f32 v237,4.0,v233
M a[120:123],a[248:251],a[232:235],a[120:123]
s_waitcnt lgkmcnt(0)
v_fma_f32 v238,-4.0,v234,v236
v_fmac_f32 v232,s45,v236
M a[124:127],a[248:251],a[244:247],a[124:127]
buffer_load_dwordx4 a[248:251],v250,s[20:23],s46 offen offset:1024 sc1
M a[124:127],a[240:243],a[232:235],a[124:127]
v_fmac_f32 v237,s41,v235
v_sub_f32 v236,v236,v234
M a[124:127],a[224:227],a[208:211],a[124:127]
s_waitcnt vmcnt(13)
buffer_load_dwordx4 a[240:243],v250,s[20:23],s46 offen offset:2048 sc1
M a[128:131],v[220:223],a[196:199],a[128:131]
s_waitcnt vmcnt(13)
s_add_u32 s47,s74,30720
v_fma_f32 v234,-4.0,v233,v235
v_sub_f32 v235,v235,v233
M a[128:131],a[200:203],a[236:239],a[128:131]
s_waitcnt vmcnt(12)
v_add_f32 v233,v238,v234
v_sub_f32 v238,v238,v234
M a[128:131],a[220:223],a[252:255],a[128:131]
v_fma_f32 v234,2.0,v235,v236
v_fmac_f32 v236,-2.0,v235
M a[132:135],a[220:223],a[192:195],a[132:135]
buffer_load_dwordx4 a[224:227],v250,s[20:23],s47 offen offset:0 sc1
M a[132:135],a[200:203],a[252:255],a[132:135]
v_and_b32 v209,s42,v209
v_and_b32 v205,s42,v205
M a[132:135],v[220:223],a[236:239],a[132:135]
v_and_b32 v207,s42,v207
v_and_b32 v215,s42,v215
M a[136:139],v[220:223],a[252:255],a[136:139]
v_and_b32 v213,s42,v213
v_and_b32 v211,s42,v211
M a[136:139],a[200:203],a[192:195],a[136:139]
v_fmac_f32 v205,s43,v209
v_fmac_f32 v215,4.0,v207
M a[136:139],a[220:223],a[216:219],a[136:139]
v_fma_f32 v235,-4.0,v209,v213
v_fmac_f32 v205,s45,v213
M a[140:143],a[220:223],v[228:231],a[140:143]
v_fmac_f32 v215,s41,v211
v_sub_f32 v213,v213,v209
M a[140:143],a[200:203],a[216:219],a[140:143]
v_fma_f32 v209,-4.0,v207,v211
v_sub_f32 v211,v211,v207
M a[140:143],v[220:223],a[192:195],a[140:143]
v_add_f32 v207,v235,v209
v_sub_f32 v235,v235,v209
M a[144:147],v[220:223],a[216:219],a[144:147]
v_fma_f32 v209,2.0,v211,v213
v_fmac_f32 v213,-2.0,v211
M a[144:147],a[200:203],v[228:231],a[144:147]
v_cvt_pk_bf16_f32 v205,v232,v205
v_cvt_pk_bf16_f32 v215,v237,v215
M a[144:147],a[220:223],a[204:207],a[144:147]
v_cvt_pk_bf16_f32 v207,v233,v207
v_cvt_pk_bf16_f32 v211,v234,v209
M a[148:151],a[220:223],a[208:211],a[148:151]
v_cvt_pk_bf16_f32 v209,v238,v235
v_cvt_pk_bf16_f32 v213,v236,v213
M a[148:151],a[200:203],a[204:207],a[148:151]
v_add_u32 v238,121856,v247
v_fmac_f32 v239,s43,v241
M a[148:151],v[220:223],v[228:231],a[148:151]
ds_write2st64_b64 v238,v[204:205],v[214:215] offset0:1 offset1:18
M a[152:155],v[220:223],a[204:207],a[152:155]
s_add_u32 s28,s69,7471104
buffer_load_dwordx2 v[204:205],v245,s[12:15],s28 offen offset:0
M a[152:155],a[200:203],a[208:211],a[152:155]
v_fmac_f32 v244,4.0,v240
v_fma_f32 v232,-4.0,v241,v243
M a[152:155],a[220:223],a[232:235],a[152:155]
buffer_load_dwordx2 v[214:215],v245,s[16:19],s28 offen offset:1536
M a[156:159],a[220:223],a[244:247],a[156:159]
v_fmac_f32 v239,s45,v243
v_fmac_f32 v244,s41,v242
M a[156:159],a[200:203],a[232:235],a[156:159]
v_sub_f32 v243,v243,v241
v_fma_f32 v241,-4.0,v240,v242
M a[156:159],v[220:223],a[208:211],a[156:159]
s_waitcnt vmcnt(14)
ds_write2st64_b64 v247,v[206:207],v[208:209] offset0:1 offset1:18
M a[160:163],v[224:227],a[196:199],a[160:163]
s_waitcnt vmcnt(13)
buffer_load_dwordx4 a[220:223],v250,s[20:23],s47 offen offset:1024 sc1
M a[160:163],a[212:215],a[236:239],a[160:163]
s_waitcnt vmcnt(13)
v_sub_f32 v242,v242,v240
v_add_f32 v240,v232,v241
M a[160:163],a[228:231],a[252:255],a[160:163]
ds_write2st64_b64 v247,v[210:211],v[212:213] offset0:137 offset1:154
M a[164:167],a[228:231],a[192:195],a[164:167]
buffer_load_dwordx4 a[200:203],v250,s[20:23],s47 offen offset:2048 sc1
M a[164:167],a[212:215],a[252:255],a[164:167]
s_add_u32 s48,s74,33792
v_sub_f32 v232,v232,v241
v_fma_f32 v241,2.0,v242,v243
M a[164:167],v[224:227],a[236:239],a[164:167]
v_fmac_f32 v243,-2.0,v242
v_cvt_pk_bf16_f32 v233,v239,v244
M a[168:171],v[224:227],a[252:255],a[168:171]
v_cvt_pk_bf16_f32 v234,v240,v232
v_cvt_pk_bf16_f32 v235,v241,v243
M a[168:171],a[212:215],a[192:195],a[168:171]
buffer_load_dwordx4 v[220:223],v250,s[20:23],s48 offen offset:0 sc1
M a[168:171],a[228:231],a[216:219],a[168:171]
v_add_u32 v232,121856,v252
M a[172:175],a[228:231],v[228:231],a[172:175]
ds_write_b16 v232,v233 offset:0
M a[172:175],a[212:215],a[216:219],a[172:175]
ds_write_b16_d16_hi v232,v233 offset:8704
M a[172:175],v[224:227],a[192:195],a[172:175]
buffer_load_dwordx4 a[196:199],v250,s[20:23],s48 offen offset:1024 sc1
M a[176:179],v[224:227],a[216:219],a[176:179]
ds_write_b16 v252,v234 offset:0
M a[176:179],a[212:215],v[228:231],a[176:179]
ds_write_b16_d16_hi v252,v234 offset:8704
M a[176:179],a[228:231],a[204:207],a[176:179]
v_add_u32 v232,69632,v252
M a[180:183],a[228:231],a[208:211],a[180:183]
buffer_load_dwordx4 a[236:239],v250,s[20:23],s48 offen offset:2048 sc1
M a[180:183],a[212:215],a[204:207],a[180:183]
s_add_u32 s46,s74,36864
ds_read_b128 a[192:195],v248 offset:17408
ds_write_b16 v232,v235 offset:0
M a[180:183],v[224:227],v[228:231],a[180:183]
ds_read_b128 a[216:219],v249 offset:17408
ds_write_b16_d16_hi v232,v235 offset:8704
M a[184:187],v[224:227],a[204:207],a[184:187]
buffer_load_dwordx4 a[252:255],v250,s[20:23],s46 offen offset:0 sc1
M a[184:187],a[212:215],a[208:211],a[184:187]
ds_read_b128 v[228:231],v248 offset:17920
ds_read_b128 a[204:207],v249 offset:17920
M a[184:187],a[228:231],a[232:235],a[184:187]
s_waitcnt vmcnt(13)
v_lshlrev_b32 v234,16,v196
v_lshlrev_b32 v232,16,v192
M a[188:191],a[228:231],a[244:247],a[188:191]
v_lshlrev_b32 v233,16,v194
v_lshlrev_b32 v237,16,v202
M a[188:191],a[212:215],a[232:235],a[188:191]
buffer_load_dwordx2 v[206:207],v245,s[8:11],s28 offen offset:0
M a[188:191],v[224:227],a[208:211],a[188:191]
s_waitcnt vmcnt(12) lgkmcnt(5)
v_lshlrev_b32 v236,16,v200
v_lshlrev_b32 v235,16,v198
M v[0:3],v[216:219],a[192:195],v[0:3]
s_waitcnt vmcnt(11) lgkmcnt(3)
ds_read_b128 a[228:231],v248 offset:18432
v_fmac_f32 v232,s43,v234
M v[0:3],a[248:251],a[216:219],v[0:3]
s_waitcnt vmcnt(10) lgkmcnt(2)
ds_read_b128 a[244:247],v249 offset:18432
v_fmac_f32 v237,4.0,v233
M v[0:3],a[240:243],v[228:231],v[0:3]
s_waitcnt lgkmcnt(2)
buffer_load_dwordx2 v[208:209],v245,s[8:11],s28 offen offset:384
M v[4:7],a[240:243],a[204:207],v[4:7]
v_fma_f32 v238,-4.0,v234,v236
v_fmac_f32 v232,s45,v236
M v[4:7],a[248:251],v[228:231],v[4:7]
v_fmac_f32 v237,s41,v235
v_sub_f32 v236,v236,v234
M v[4:7],v[216:219],a[216:219],v[4:7]
v_fma_f32 v234,-4.0,v233,v235
v_sub_f32 v235,v235,v233
M v[8:11],v[216:219],v[228:231],v[8:11]
buffer_load_dwordx2 v[210:211],v245,s[8:11],s28 offen offset:768
M v[8:11],a[248:251],a[204:207],v[8:11]
s_waitcnt lgkmcnt(1)
ds_read_b128 a[212:215],v248 offset:18944
ds_read_b128 a[232:235],v249 offset:18944
M v[8:11],a[240:243],a[228:231],v[8:11]
s_waitcnt lgkmcnt(2)
v_add_f32 v233,v238,v234
v_sub_f32 v238,v238,v234
M v[12:15],a[240:243],a[244:247],v[12:15]
v_fma_f32 v234,2.0,v235,v236
v_fmac_f32 v236,-2.0,v235
M v[12:15],a[248:251],a[228:231],v[12:15]
buffer_load_dwordx2 v[212:213],v245,s[8:11],s28 offen offset:1152
M v[12:15],v[216:219],a[204:207],v[12:15]
s_add_u32 s29,s70,6291456
v_and_b32 v196,s42,v196
v_and_b32 v192,s42,v192
M v[16:19],v[216:219],a[228:231],v[16:19]
ds_read_b128 a[208:211],v249 offset:19456
v_and_b32 v194,s42,v194
M v[16:19],a[248:251],a[244:247],v[16:19]
s_waitcnt lgkmcnt(2)
ds_read_b128 v[224:227],v248 offset:19456
v_and_b32 v202,s42,v202
M v[16:19],a[240:243],a[212:215],v[16:19]
s_waitcnt lgkmcnt(2)
buffer_load_short_d16_hi v239,v246,s[12:15],s29 offen offset:0
M v[20:23],a[240:243],a[232:235],v[20:23]
v_and_b32 v200,s42,v200
v_and_b32 v198,s42,v198
M v[20:23],a[248:251],a[212:215],v[20:23]
buffer_load_short_d16_hi v240,v246,s[8:11],s29 offen offset:0
M v[20:23],v[216:219],a[244:247],v[20:23]
v_fmac_f32 v192,s43,v196
v_fmac_f32 v202,4.0,v194
M v[24:27],v[216:219],a[212:215],v[24:27]
buffer_load_short_d16_hi v241,v246,s[8:11],s29 offen offset:384
M v[24:27],a[248:251],a[232:235],v[24:27]
s_waitcnt lgkmcnt(1)
v_fma_f32 v235,-4.0,v196,v200
v_fmac_f32 v192,s45,v200
M v[24:27],a[240:243],a[208:211],v[24:27]
s_waitcnt lgkmcnt(0)
buffer_load_short_d16_hi v242,v246,s[8:11],s29 offen offset:768
M v[28:31],a[240:243],v[224:227],v[28:31]
v_fmac_f32 v202,s41,v198
v_sub_f32 v200,v200,v196
M v[28:31],a[248:251],a[208:211],v[28:31]
buffer_load_short_d16_hi v243,v246,s[8:11],s29 offen offset:1152
M v[28:31],v[216:219],a[232:235],v[28:31]
s_waitcnt vmcnt(17)
v_fma_f32 v196,-4.0,v194,v198
v_sub_f32 v198,v198,v194
M v[32:35],a[224:227],a[192:195],v[32:35]
s_waitcnt vmcnt(14)
buffer_load_short_d16_hi v244,v246,s[16:19],s29 offen offset:1536
M v[32:35],a[220:223],a[216:219],v[32:35]
s_waitcnt vmcnt(14)
v_add_f32 v194,v235,v196
v_sub_f32 v235,v235,v196
M v[32:35],a[200:203],v[228:231],v[32:35]
global_load_dword a240,v250,s[64:65]
M v[36:39],a[200:203],a[204:207],v[36:39]
v_fma_f32 v196,2.0,v198,v200
v_fmac_f32 v200,-2.0,v198
M v[36:39],a[220:223],v[228:231],v[36:39]
buffer_load_dwordx4 a[240:243],v250,s[20:23],s46 offen offset:1024 sc1
M v[36:39],a[224:227],a[216:219],v[36:39]
v_cvt_pk_bf16_f32 v192,v232,v192
v_cvt_pk_bf16_f32 v202,v237,v202
M v[40:43],a[224:227],v[228:231],v[40:43]
v_cvt_pk_bf16_f32 v194,v233,v194
v_cvt_pk_bf16_f32 v198,v234,v196
M v[40:43],a[220:223],a[204:207],v[40:43]
v_cvt_pk_bf16_f32 v196,v238,v235
v_cvt_pk_bf16_f32 v200,v236,v200
M v[40:43],a[200:203],a[228:231],v[40:43]
buffer_load_dwordx4 a[248:251],v250,s[20:23],s46 offen offset:2048 sc1
M v[44:47],a[200:203],a[244:247],v[44:47]
s_add_u32 s47,s74,39936
v_lshlrev_b32 v234,16,v197
v_lshlrev_b32 v232,16,v193
M v[44:47],a[220:223],a[228:231],v[44:47]
v_lshlrev_b32 v233,16,v195
v_lshlrev_b32 v237,16,v203
M v[44:47],a[224:227],a[204:207],v[44:47]
v_lshlrev_b32 v236,16,v201
v_lshlrev_b32 v235,16,v199
M v[48:51],a[224:227],a[228:231],v[48:51]
buffer_load_dwordx4 v[216:219],v250,s[20:23],s47 offen offset:0 sc1
M v[48:51],a[220:223],a[244:247],v[48:51]
v_fmac_f32 v232,s43,v234
v_fmac_f32 v237,4.0,v233
M v[48:51],a[200:203],a[212:215],v[48:51]
v_fma_f32 v238,-4.0,v234,v236
v_fmac_f32 v232,s45,v236
M v[52:55],a[200:203],a[232:235],v[52:55]
v_fmac_f32 v237,s41,v235
v_sub_f32 v236,v236,v234
M v[52:55],a[220:223],a[212:215],v[52:55]
v_fma_f32 v234,-4.0,v233,v235
v_sub_f32 v235,v235,v233
M v[52:55],a[224:227],a[244:247],v[52:55]
v_add_f32 v233,v238,v234
v_sub_f32 v238,v238,v234
M v[56:59],a[224:227],a[212:215],v[56:59]
v_fma_f32 v234,2.0,v235,v236
v_fmac_f32 v236,-2.0,v235
M v[56:59],a[220:223],a[232:235],v[56:59]
v_and_b32 v197,s42,v197
v_and_b32 v193,s42,v193
M v[56:59],a[200:203],a[208:211],v[56:59]
v_and_b32 v195,s42,v195
v_and_b32 v203,s42,v203
M v[60:63],a[200:203],v[224:227],v[60:63]
buffer_load_dwordx4 a[200:203],v250,s[20:23],s47 offen offset:1024 sc1
M v[60:63],a[220:223],a[208:211],v[60:63]
v_and_b32 v201,s42,v201
v_and_b32 v199,s42,v199
M v[60:63],a[224:227],a[232:235],v[60:63]
s_waitcnt vmcnt(18)
buffer_load_dwordx4 a[220:223],v250,s[20:23],s47 offen offset:2048 sc1
M v[64:67],v[220:223],a[192:195],v[64:67]
s_waitcnt vmcnt(18)
s_add_u32 s48,s74,43008
v_fmac_f32 v193,s43,v197
v_fmac_f32 v203,4.0,v195
M v[64:67],a[196:199],a[216:219],v[64:67]
s_waitcnt vmcnt(17)
v_fma_f32 v235,-4.0,v197,v201
v_fmac_f32 v193,s45,v201
M v[64:67],a[236:239],v[228:231],v[64:67]
v_fmac_f32 v203,s41,v199
v_sub_f32 v201,v201,v197
M v[68:71],a[236:239],a[204:207],v[68:71]
buffer_load_dwordx4 a[224:227],v250,s[20:23],s48 offen offset:0 sc1
M v[68:71],a[196:199],v[228:231],v[68:71]
v_fma_f32 v197,-4.0,v195,v199
v_sub_f32 v199,v199,v195
M v[68:71],v[220:223],a[216:219],v[68:71]
v_add_f32 v195,v235,v197
v_sub_f32 v235,v235,v197
M v[72:75],v[220:223],v[228:231],v[72:75]
v_fma_f32 v197,2.0,v199,v201
v_fmac_f32 v201,-2.0,v199
M v[72:75],a[196:199],a[204:207],v[72:75]
buffer_load_dwordx4 a[192:195],v250,s[20:23],s48 offen offset:1024 sc1
M v[72:75],a[236:239],a[228:231],v[72:75]
v_cvt_pk_bf16_f32 v193,v232,v193
v_cvt_pk_bf16_f32 v203,v237,v203
M v[76:79],a[236:239],a[244:247],v[76:79]
v_cvt_pk_bf16_f32 v195,v233,v195
v_cvt_pk_bf16_f32 v199,v234,v197
M v[76:79],a[196:199],a[228:231],v[76:79]
v_cvt_pk_bf16_f32 v197,v238,v235
v_cvt_pk_bf16_f32 v201,v236,v201
M v[76:79],v[220:223],a[204:207],v[76:79]
buffer_load_dwordx4 a[216:219],v250,s[20:23],s48 offen offset:2048 sc1
M v[80:83],v[220:223],a[228:231],v[80:83]
s_waitcnt vmcnt(17)
s_add_u32 s46,s75,9216
v_add_u32 v238,121856,v247
v_lshlrev_b32 v234,16,v208
M v[80:83],a[196:199],a[244:247],v[80:83]
v_lshlrev_b32 v232,16,v204
v_lshlrev_b32 v233,16,v206
M v[80:83],a[236:239],a[212:215],v[80:83]
ds_write2st64_b64 v238,v[192:193],v[202:203] offset0:2 offset1:19
M v[84:87],a[236:239],a[232:235],v[84:87]
s_add_u32 s28,s70,6291456
buffer_load_dwordx4 v[228:231],v250,s[20:23],s46 offen offset:0 sc1
M v[84:87],a[196:199],a[212:215],v[84:87]
ds_read_b128 a[204:207],v248 offset:26112
v_lshlrev_b32 v237,16,v214
M v[84:87],v[220:223],a[244:247],v[84:87]
ds_write2st64_b64 v247,v[194:195],v[196:197] offset0:2 offset1:19
M v[88:91],v[220:223],a[212:215],v[88:91]
buffer_load_dwordx2 v[192:193],v245,s[12:15],s28 offen offset:0
M v[88:91],a[196:199],a[232:235],v[88:91]
ds_read_b128 a[228:231],v249 offset:26112
ds_read_b128 a[244:247],v248 offset:26624
M v[88:91],a[236:239],a[208:211],v[88:91]
ds_write2st64_b64 v247,v[198:199],v[200:201] offset0:138 offset1:155
M v[92:95],a[236:239],v[224:227],v[92:95]
buffer_load_dwordx2 v[202:203],v245,s[16:19],s28 offen offset:1536
M v[92:95],a[196:199],a[208:211],v[92:95]
s_waitcnt vmcnt(18)
ds_read_b128 a[212:215],v249 offset:26624
v_lshlrev_b32 v236,16,v212
M v[92:95],v[220:223],a[232:235],v[92:95]
s_waitcnt lgkmcnt(5)
v_lshlrev_b32 v235,16,v210
v_fmac_f32 v232,s43,v234
M v[96:99],a[252:255],a[204:207],v[96:99]
s_waitcnt vmcnt(10) lgkmcnt(3)
ds_read_b128 a[236:239],v248 offset:27136
v_fmac_f32 v237,4.0,v233
M v[96:99],a[240:243],a[228:231],v[96:99]
s_waitcnt vmcnt(9) lgkmcnt(3)
buffer_load_dwordx2 v[194:195],v245,s[8:11],s28 offen offset:0
M v[96:99],a[248:251],a[244:247],v[96:99]
s_waitcnt lgkmcnt(1)
ds_read_b128 v[224:227],v249 offset:27136
v_fma_f32 v238,-4.0,v234,v236
M v[100:103],a[248:251],a[212:215],v[100:103]
v_fmac_f32 v232,s45,v236
v_fmac_f32 v237,s41,v235
M v[100:103],a[240:243],a[244:247],v[100:103]
v_sub_f32 v236,v236,v234
v_fma_f32 v234,-4.0,v233,v235
M v[100:103],a[252:255],a[228:231],v[100:103]
buffer_load_dwordx2 v[196:197],v245,s[8:11],s28 offen offset:384
M v[104:107],a[252:255],a[244:247],v[104:107]
ds_read_b128 a[196:199],v248 offset:27648
v_sub_f32 v235,v235,v233
M v[104:107],a[240:243],a[212:215],v[104:107]
s_waitcnt lgkmcnt(2)
ds_read_b128 a[208:211],v249 offset:27648
v_add_f32 v233,v238,v234
M v[104:107],a[248:251],a[236:239],v[104:107]
s_waitcnt lgkmcnt(2)
v_sub_f32 v238,v238,v234
v_fma_f32 v234,2.0,v235,v236
M v[108:111],a[248:251],v[224:227],v[108:111]
buffer_load_dwordx2 v[198:199],v245,s[8:11],s28 offen offset:768
M v[108:111],a[240:243],a[236:239],v[108:111]
v_fmac_f32 v236,-2.0,v235
v_and_b32 v208,s42,v208
M v[108:111],a[252:255],a[212:215],v[108:111]
v_and_b32 v204,s42,v204
v_and_b32 v206,s42,v206
M v[112:115],a[252:255],a[236:239],v[112:115]
ds_read_b128 a[232:235],v249 offset:28160
v_and_b32 v214,s42,v214
M v[112:115],a[240:243],v[224:227],v[112:115]
s_waitcnt lgkmcnt(2)
buffer_load_dwordx2 v[200:201],v245,s[8:11],s28 offen offset:1152
M v[112:115],a[248:251],a[196:199],v[112:115]
s_waitcnt lgkmcnt(1)
ds_read_b128 v[220:223],v248 offset:28160
v_and_b32 v212,s42,v212
M v[116:119],a[248:251],a[208:211],v[116:119]
v_and_b32 v210,s42,v210
v_fmac_f32 v204,s43,v208
M v[116:119],a[240:243],a[196:199],v[116:119]
v_fmac_f32 v214,4.0,v206
v_fma_f32 v235,-4.0,v208,v212
M v[116:119],a[252:255],v[224:227],v[116:119]
v_fmac_f32 v204,s45,v212
v_fmac_f32 v214,s41,v210
M v[120:123],a[252:255],a[196:199],v[120:123]
v_sub_f32 v212,v212,v208
v_fma_f32 v208,-4.0,v206,v210
M v[120:123],a[240:243],a[208:211],v[120:123]
s_waitcnt lgkmcnt(1)
v_sub_f32 v210,v210,v206
v_add_f32 v206,v235,v208
M v[120:123],a[248:251],a[232:235],v[120:123]
s_waitcnt lgkmcnt(0)
v_sub_f32 v235,v235,v208
v_fma_f32 v208,2.0,v210,v212
M v[124:127],a[248:251],v[220:223],v[124:127]
buffer_load_dwordx4 a[248:251],v250,s[20:23],s46 offen offset:1024 sc1
M v[124:127],a[240:243],a[232:235],v[124:127]
v_fmac_f32 v212,-2.0,v210
v_cvt_pk_bf16_f32 v204,v232,v204
M v[124:127],a[252:255],a[208:211],v[124:127]
s_waitcnt vmcnt(13)
buffer_load_dwordx4 a[240:243],v250,s[20:23],s46 offen offset:2048 sc1
M v[128:131],v[216:219],a[204:207],v[128:131]
s_waitcnt vmcnt(13)
s_add_u32 s47,s75,12288
v_cvt_pk_bf16_f32 v214,v237,v214
v_cvt_pk_bf16_f32 v206,v233,v206
M v[128:131],a[200:203],a[228:231],v[128:131]
s_waitcnt vmcnt(12)
v_cvt_pk_bf16_f32 v210,v234,v208
v_cvt_pk_bf16_f32 v208,v238,v235
M v[128:131],a[220:223],a[244:247],v[128:131]
v_cvt_pk_bf16_f32 v212,v236,v212
v_lshlrev_b32 v234,16,v209
M v[132:135],a[220:223],a[212:215],v[132:135]
buffer_load_dwordx4 a[252:255],v250,s[20:23],s47 offen offset:0 sc1
M v[132:135],a[200:203],a[244:247],v[132:135]
v_lshlrev_b32 v232,16,v205
v_lshlrev_b32 v233,16,v207
M v[132:135],v[216:219],a[228:231],v[132:135]
v_lshlrev_b32 v237,16,v215
v_lshlrev_b32 v236,16,v213
M v[136:139],v[216:219],a[244:247],v[136:139]
v_lshlrev_b32 v235,16,v211
v_fmac_f32 v232,s43,v234
M v[136:139],a[200:203],a[212:215],v[136:139]
v_fmac_f32 v237,4.0,v233
v_fma_f32 v238,-4.0,v234,v236
M v[136:139],a[220:223],a[236:239],v[136:139]
v_fmac_f32 v232,s45,v236
v_fmac_f32 v237,s41,v235
M v[140:143],a[220:223],v[224:227],v[140:143]
v_sub_f32 v236,v236,v234
v_fma_f32 v234,-4.0,v233,v235
M v[140:143],a[200:203],a[236:239],v[140:143]
v_sub_f32 v235,v235,v233
v_add_f32 v233,v238,v234
M v[140:143],v[216:219],a[212:215],v[140:143]
v_sub_f32 v238,v238,v234
v_fma_f32 v234,2.0,v235,v236
M v[144:147],v[216:219],a[236:239],v[144:147]
v_fmac_f32 v236,-2.0,v235
v_and_b32 v209,s42,v209
M v[144:147],a[200:203],v[224:227],v[144:147]
v_and_b32 v205,s42,v205
v_and_b32 v207,s42,v207
M v[144:147],a[220:223],a[196:199],v[144:147]
v_and_b32 v215,s42,v215
v_and_b32 v213,s42,v213
M v[148:151],a[220:223],a[208:211],v[148:151]
v_and_b32 v211,s42,v211
v_fmac_f32 v205,s43,v209
M v[148:151],a[200:203],a[196:199],v[148:151]
v_fmac_f32 v215,4.0,v207
v_fma_f32 v235,-4.0,v209,v213
M v[148:151],v[216:219],v[224:227],v[148:151]
v_fmac_f32 v205,s45,v213
v_fmac_f32 v215,s41,v211
M v[152:155],v[216:219],a[196:199],v[152:155]
v_sub_f32 v213,v213,v209
v_fma_f32 v209,-4.0,v207,v211
M v[152:155],a[200:203],a[208:211],v[152:155]
v_sub_f32 v211,v211,v207
v_add_f32 v207,v235,v209
M v[152:155],a[220:223],a[232:235],v[152:155]
v_sub_f32 v235,v235,v209
v_fma_f32 v209,2.0,v211,v213
M v[156:159],a[220:223],v[220:223],v[156:159]
buffer_load_dwordx4 a[220:223],v250,s[20:23],s47 offen offset:1024 sc1
M v[156:159],a[200:203],a[232:235],v[156:159]
v_fmac_f32 v213,-2.0,v211
v_cvt_pk_bf16_f32 v205,v232,v205
M v[156:159],v[216:219],a[208:211],v[156:159]
s_waitcnt vmcnt(13)
buffer_load_dwordx4 a[200:203],v250,s[20:23],s47 offen offset:2048 sc1
M v[160:163],a[224:227],a[204:207],v[160:163]
s_waitcnt vmcnt(13)
s_add_u32 s48,s75,15360
v_cvt_pk_bf16_f32 v215,v237,v215
v_cvt_pk_bf16_f32 v207,v233,v207
M v[160:163],a[192:195],a[228:231],v[160:163]
s_waitcnt vmcnt(12)
v_cvt_pk_bf16_f32 v211,v234,v209
v_cvt_pk_bf16_f32 v209,v238,v235
M v[160:163],a[216:219],a[244:247],v[160:163]
v_cvt_pk_bf16_f32 v213,v236,v213
v_add_u32 v238,121856,v247
M v[164:167],a[216:219],a[212:215],v[164:167]
buffer_load_dwordx4 v[216:219],v250,s[20:23],s48 offen offset:0 sc1
M v[164:167],a[192:195],a[244:247],v[164:167]
M v[164:167],a[224:227],a[228:231],v[164:167]
ds_write2st64_b64 v238,v[204:205],v[214:215] offset0:3 offset1:20
M v[168:171],a[224:227],a[244:247],v[168:171]
s_add_u32 s28,s70,6684672
M v[168:171],a[192:195],a[212:215],v[168:171]
buffer_load_dwordx4 a[204:207],v250,s[20:23],s48 offen offset:1024 sc1
M v[168:171],a[216:219],a[236:239],v[168:171]
ds_write2st64_b64 v247,v[206:207],v[208:209] offset0:3 offset1:20
M v[172:175],a[216:219],v[224:227],v[172:175]
M v[172:175],a[192:195],a[236:239],v[172:175]
buffer_load_dwordx4 a[228:231],v250,s[20:23],s48 offen offset:2048 sc1
M v[172:175],a[224:227],a[212:215],v[172:175]
s_add_u32 s46,s75,18432
ds_write2st64_b64 v247,v[210:211],v[212:213] offset0:139 offset1:156
M v[176:179],a[224:227],a[236:239],v[176:179]
M v[176:179],a[192:195],v[224:227],v[176:179]
buffer_load_dwordx4 a[244:247],v250,s[20:23],s46 offen offset:0 sc1
M v[176:179],a[216:219],a[196:199],v[176:179]
s_waitcnt lgkmcnt(0)
s_barrier
v_add_u32 v248,0xffffbc00,v248
M v[180:183],a[216:219],a[208:211],v[180:183]
v_add_u32 v249,0xffffbc00,v249
M v[180:183],a[192:195],a[196:199],v[180:183]
ds_read_b128 a[212:215],v248 offset:0
M v[180:183],a[224:227],v[224:227],v[180:183]
buffer_load_dwordx2 v[204:205],v245,s[12:15],s28 offen offset:0
M v[184:187],a[224:227],a[196:199],v[184:187]
ds_read_b128 a[236:239],v249 offset:0
ds_read_b128 v[224:227],v248 offset:512
M v[184:187],a[192:195],a[208:211],v[184:187]
ds_read_b128 a[196:199],v249 offset:512
M v[184:187],a[216:219],a[232:235],v[184:187]
M v[188:191],a[216:219],v[220:223],v[188:191]
buffer_load_dwordx2 v[214:215],v245,s[16:19],s28 offen offset:1536
M v[188:191],a[192:195],a[232:235],v[188:191]
M v[188:191],a[224:227],a[208:211],v[188:191]
s_waitcnt vmcnt(17) lgkmcnt(3)
M a[0:3],v[228:231],a[212:215],a[0:3]
s_waitcnt vmcnt(10) lgkmcnt(2)
ds_read_b128 a[216:219],v248 offset:1024
M a[0:3],a[248:251],a[236:239],a[0:3]
s_waitcnt vmcnt(9) lgkmcnt(2)
buffer_load_dwordx2 v[206:207],v245,s[8:11],s28 offen offset:0
M a[0:3],a[240:243],v[224:227],a[0:3]
s_waitcnt lgkmcnt(1)
ds_read_b128 v[220:223],v249 offset:1024
v_lshlrev_b32 v234,16,v196
M a[4:7],a[240:243],a[196:199],a[4:7]
v_lshlrev_b32 v232,16,v192
v_lshlrev_b32 v233,16,v194
M a[4:7],a[248:251],v[224:227],a[4:7]
v_lshlrev_b32 v237,16,v202
v_lshlrev_b32 v236,16,v200
M a[4:7],v[228:231],a[236:239],a[4:7]
buffer_load_dwordx2 v[208:209],v245,s[8:11],s28 offen offset:384
M a[8:11],v[228:231],v[224:227],a[8:11]
ds_read_b128 a[192:195],v248 offset:1536
v_lshlrev_b32 v235,16,v198
M a[8:11],a[248:251],a[196:199],a[8:11]
s_waitcnt lgkmcnt(2)
ds_read_b128 a[232:235],v249 offset:1536
v_fmac_f32 v232,s43,v234
M a[8:11],a[240:243],a[216:219],a[8:11]
s_waitcnt lgkmcnt(2)
v_fmac_f32 v237,4.0,v233
v_fma_f32 v238,-4.0,v234,v236
M a[12:15],a[240:243],v[220:223],a[12:15]
buffer_load_dwordx2 v[210:211],v245,s[8:11],s28 offen offset:768
M a[12:15],a[248:251],a[216:219],a[12:15]
v_fmac_f32 v232,s45,v236
v_fmac_f32 v237,s41,v235
M a[12:15],v[228:231],a[196:199],a[12:15]
v_sub_f32 v236,v236,v234
v_fma_f32 v234,-4.0,v233,v235
M a[16:19],v[228:231],a[216:219],a[16:19]
ds_read_b128 a[208:211],v249 offset:2048
v_sub_f32 v235,v235,v233
M a[16:19],a[248:251],v[220:223],a[16:19]
s_waitcnt lgkmcnt(2)
buffer_load_dwordx2 v[212:213],v245,s[8:11],s28 offen offset:1152
M a[16:19],a[240:243],a[192:195],a[16:19]
s_waitcnt lgkmcnt(1)
ds_read_b128 a[224:227],v248 offset:2048
v_add_f32 v233,v238,v234
M a[20:23],a[240:243],a[232:235],a[20:23]
v_sub_f32 v238,v238,v234
v_fma_f32 v234,2.0,v235,v236
M a[20:23],a[248:251],a[192:195],a[20:23]
v_fmac_f32 v236,-2.0,v235
v_and_b32 v196,s42,v196
M a[20:23],v[228:231],v[220:223],a[20:23]
v_and_b32 v192,s42,v192
v_and_b32 v194,s42,v194
M a[24:27],v[228:231],a[192:195],a[24:27]
v_and_b32 v202,s42,v202
v_and_b32 v200,s42,v200
M a[24:27],a[248:251],a[232:235],a[24:27]
s_waitcnt lgkmcnt(1)
v_and_b32 v198,s42,v198
v_fmac_f32 v192,s43,v196
M a[24:27],a[240:243],a[208:211],a[24:27]
s_waitcnt lgkmcnt(0)
v_fmac_f32 v202,4.0,v194
v_fma_f32 v235,-4.0,v196,v200
M a[28:31],a[240:243],a[224:227],a[28:31]
buffer_load_dwordx4 a[240:243],v250,s[20:23],s46 offen offset:1024 sc1
M a[28:31],a[248:251],a[208:211],a[28:31]
v_fmac_f32 v192,s45,v200
v_fmac_f32 v202,s41,v198
M a[28:31],v[228:231],a[232:235],a[28:31]
s_waitcnt vmcnt(13)
buffer_load_dwordx4 a[248:251],v250,s[20:23],s46 offen offset:2048 sc1
M a[32:35],a[252:255],a[212:215],a[32:35]
s_waitcnt vmcnt(13)
s_add_u32 s47,s75,21504
v_sub_f32 v200,v200,v196
v_fma_f32 v196,-4.0,v194,v198
M a[32:35],a[220:223],a[236:239],a[32:35]
s_waitcnt vmcnt(12)
v_sub_f32 v198,v198,v194
v_add_f32 v194,v235,v196
M a[32:35],a[200:203],v[224:227],a[32:35]
v_sub_f32 v235,v235,v196
v_fma_f32 v196,2.0,v198,v200
M a[36:39],a[200:203],a[196:199],a[36:39]
buffer_load_dwordx4 v[228:231],v250,s[20:23],s47 offen offset:0 sc1
M a[36:39],a[220:223],v[224:227],a[36:39]
v_fmac_f32 v200,-2.0,v198
v_cvt_pk_bf16_f32 v192,v232,v192
M a[36:39],a[252:255],a[236:239],a[36:39]
v_cvt_pk_bf16_f32 v202,v237,v202
v_cvt_pk_bf16_f32 v194,v233,v194
M a[40:43],a[252:255],v[224:227],a[40:43]
v_cvt_pk_bf16_f32 v198,v234,v196
v_cvt_pk_bf16_f32 v196,v238,v235
M a[40:43],a[220:223],a[196:199],a[40:43]
v_cvt_pk_bf16_f32 v200,v236,v200
v_lshlrev_b32 v234,16,v197
M a[40:43],a[200:203],a[216:219],a[40:43]
v_lshlrev_b32 v232,16,v193
v_lshlrev_b32 v233,16,v195
M a[44:47],a[200:203],v[220:223],a[44:47]
v_lshlrev_b32 v237,16,v203
v_lshlrev_b32 v236,16,v201
M a[44:47],a[220:223],a[216:219],a[44:47]
v_lshlrev_b32 v235,16,v199
v_fmac_f32 v232,s43,v234
M a[44:47],a[252:255],a[196:199],a[44:47]
v_fmac_f32 v237,4.0,v233
v_fma_f32 v238,-4.0,v234,v236
M a[48:51],a[252:255],a[216:219],a[48:51]
v_fmac_f32 v232,s45,v236
v_fmac_f32 v237,s41,v235
M a[48:51],a[220:223],v[220:223],a[48:51]
v_sub_f32 v236,v236,v234
v_fma_f32 v234,-4.0,v233,v235
M a[48:51],a[200:203],a[192:195],a[48:51]
v_sub_f32 v235,v235,v233
v_add_f32 v233,v238,v234
M a[52:55],a[200:203],a[232:235],a[52:55]
v_sub_f32 v238,v238,v234
v_fma_f32 v234,2.0,v235,v236
M a[52:55],a[220:223],a[192:195],a[52:55]
v_fmac_f32 v236,-2.0,v235
v_and_b32 v197,s42,v197
M a[52:55],a[252:255],v[220:223],a[52:55]
v_and_b32 v193,s42,v193
v_and_b32 v195,s42,v195
M a[56:59],a[252:255],a[192:195],a[56:59]
v_and_b32 v203,s42,v203
v_and_b32 v201,s42,v201
M a[56:59],a[220:223],a[232:235],a[56:59]
v_and_b32 v199,s42,v199
v_fmac_f32 v193,s43,v197
M a[56:59],a[200:203],a[208:211],a[56:59]
v_fmac_f32 v203,4.0,v195
v_fma_f32 v235,-4.0,v197,v201
M a[60:63],a[200:203],a[224:227],a[60:63]
buffer_load_dwordx4 a[200:203],v250,s[20:23],s47 offen offset:1024 sc1
M a[60:63],a[220:223],a[208:211],a[60:63]
v_fmac_f32 v193,s45,v201
v_fmac_f32 v203,s41,v199
M a[60:63],a[252:255],a[232:235],a[60:63]
s_waitcnt vmcnt(13)
buffer_load_dwordx4 a[220:223],v250,s[20:23],s47 offen offset:2048 sc1
M a[64:67],v[216:219],a[212:215],a[64:67]
s_waitcnt vmcnt(13)
s_add_u32 s48,s75,24576
v_sub_f32 v201,v201,v197
v_fma_f32 v197,-4.0,v195,v199
M a[64:67],a[204:207],a[236:239],a[64:67]
s_waitcnt vmcnt(12)
v_sub_f32 v199,v199,v195
v_add_f32 v195,v235,v197
M a[64:67],a[228:231],v[224:227],a[64:67]
v_sub_f32 v235,v235,v197
v_fma_f32 v197,2.0,v199,v201
M a[68:71],a[228:231],a[196:199],a[68:71]
buffer_load_dwordx4 a[252:255],v250,s[20:23],s48 offen offset:0 sc1
M a[68:71],a[204:207],v[224:227],a[68:71]
v_fmac_f32 v201,-2.0,v199
v_cvt_pk_bf16_f32 v193,v232,v193
M a[68:71],v[216:219],a[236:239],a[68:71]
v_cvt_pk_bf16_f32 v203,v237,v203
v_cvt_pk_bf16_f32 v195,v233,v195
M a[72:75],v[216:219],v[224:227],a[72:75]
v_cvt_pk_bf16_f32 v199,v234,v197
v_cvt_pk_bf16_f32 v197,v238,v235
M a[72:75],a[204:207],a[196:199],a[72:75]
buffer_load_dwordx4 a[212:215],v250,s[20:23],s48 offen offset:1024 sc1
M a[72:75],a[228:231],a[216:219],a[72:75]
v_cvt_pk_bf16_f32 v201,v236,v201
v_add_u32 v238,139264,v247
M a[76:79],a[228:231],v[220:223],a[76:79]
M a[76:79],a[204:207],a[216:219],a[76:79]
M a[76:79],v[216:219],a[196:199],a[76:79]
buffer_load_dwordx4 a[236:239],v250,s[20:23],s48 offen offset:2048 sc1
M a[80:83],v[216:219],a[216:219],a[80:83]
s_add_u32 s46,s75,27648
M a[80:83],a[204:207],v[220:223],a[80:83]
M a[80:83],a[228:231],a[192:195],a[80:83]
ds_write2st64_b64 v238,v[192:193],v[202:203] offset0:0 offset1:17
M a[84:87],a[228:231],a[232:235],a[84:87]
s_add_u32 s28,s70,7077888
buffer_load_dwordx4 v[224:227],v250,s[20:23],s46 offen offset:0 sc1
M a[84:87],a[204:207],a[192:195],a[84:87]
ds_read_b128 a[196:199],v248 offset:8704
M a[84:87],v[216:219],v[220:223],a[84:87]
ds_write2st64_b64 v247,v[194:195],v[196:197] offset0:34 offset1:51
M a[88:91],v[216:219],a[192:195],a[88:91]
buffer_load_dwordx2 v[192:193],v245,s[12:15],s28 offen offset:0
M a[88:91],a[204:207],a[232:235],a[88:91]
ds_read_b128 a[216:219],v249 offset:8704
ds_read_b128 v[220:223],v248 offset:9216
M a[88:91],a[228:231],a[208:211],a[88:91]
ds_write2st64_b64 v247,v[198:199],v[200:201] offset0:68 offset1:85
M a[92:95],a[228:231],a[224:227],a[92:95]
buffer_load_dwordx2 v[202:203],v245,s[16:19],s28 offen offset:1536
M a[92:95],a[204:207],a[208:211],a[92:95]
ds_read_b128 a[192:195],v249 offset:9216
M a[92:95],v[216:219],a[232:235],a[92:95]
s_waitcnt vmcnt(17) lgkmcnt(5)
M a[96:99],a[244:247],a[196:199],a[96:99]
s_waitcnt vmcnt(10) lgkmcnt(3)
ds_read_b128 a[224:227],v248 offset:9728
M a[96:99],a[240:243],a[216:219],a[96:99]
s_waitcnt vmcnt(9) lgkmcnt(3)
buffer_load_dwordx2 v[194:195],v245,s[8:11],s28 offen offset:0
M a[96:99],a[248:251],v[220:223],a[96:99]
s_waitcnt lgkmcnt(1)
ds_read_b128 a[228:231],v249 offset:9728
v_lshlrev_b32 v234,16,v208
M a[100:103],a[248:251],a[192:195],a[100:103]
v_lshlrev_b32 v232,16,v204
v_lshlrev_b32 v233,16,v206
M a[100:103],a[240:243],v[220:223],a[100:103]
v_lshlrev_b32 v237,16,v214
v_lshlrev_b32 v236,16,v212
M a[100:103],a[244:247],a[216:219],a[100:103]
buffer_load_dwordx2 v[196:197],v245,s[8:11],s28 offen offset:384
M a[104:107],a[244:247],v[220:223],a[104:107]
ds_read_b128 a[204:207],v248 offset:10240
v_lshlrev_b32 v235,16,v210
M a[104:107],a[240:243],a[192:195],a[104:107]
s_waitcnt lgkmcnt(2)
ds_read_b128 a[208:211],v249 offset:10240
v_fmac_f32 v232,s43,v234
M a[104:107],a[248:251],a[224:227],a[104:107]
s_waitcnt lgkmcnt(2)
v_fmac_f32 v237,4.0,v233
v_fma_f32 v238,-4.0,v234,v236
M a[108:111],a[248:251],a[228:231],a[108:111]
buffer_load_dwordx2 v[198:199],v245,s[8:11],s28 offen offset:768
M a[108:111],a[240:243],a[224:227],a[108:111]
v_fmac_f32 v232,s45,v236
v_fmac_f32 v237,s41,v235
M a[108:111],a[244:247],a[192:195],a[108:111]
v_sub_f32 v236,v236,v234
v_fma_f32 v234,-4.0,v233,v235
M a[112:115],a[244:247],a[224:227],a[112:115]
ds_read_b128 a[232:235],v249 offset:10752
v_sub_f32 v235,v235,v233
M a[112:115],a[240:243],a[228:231],a[112:115]
s_waitcnt lgkmcnt(2)
buffer_load_dwordx2 v[200:201],v245,s[8:11],s28 offen offset:1152
M a[112:115],a[248:251],a[204:207],a[112:115]
s_waitcnt lgkmcnt(1)
ds_read_b128 v[216:219],v248 offset:10752
v_add_f32 v233,v238,v234
M a[116:119],a[248:251],a[208:211],a[116:119]
v_sub_f32 v238,v238,v234
v_fma_f32 v234,2.0,v235,v236
M a[116:119],a[240:243],a[204:207],a[116:119]
v_fmac_f32 v236,-2.0,v235
v_and_b32 v208,s42,v208
M a[116:119],a[244:247],a[228:231],a[116:119]
v_and_b32 v204,s42,v204
v_and_b32 v206,s42,v206
M a[120:123],a[244:247],a[204:207],a[120:123]
v_and_b32 v214,s42,v214
v_and_b32 v212,s42,v212
M a[120:123],a[240:243],a[208:211],a[120:123]
s_waitcnt lgkmcnt(1)
v_and_b32 v210,s42,v210
v_fmac_f32 v204,s43,v208
M a[120:123],a[248:251],a[232:235],a[120:123]
s_waitcnt lgkmcnt(0)
v_fmac_f32 v214,4.0,v206
v_fma_f32 v235,-4.0,v208,v212
M a[124:127],a[248:251],v[216:219],a[124:127]
buffer_load_dwordx4 a[248:251],v250,s[20:23],s46 offen offset:1024 sc1
M a[124:127],a[240:243],a[232:235],a[124:127]
v_fmac_f32 v204,s45,v212
v_fmac_f32 v214,s41,v210
M a[124:127],a[244:247],a[208:211],a[124:127]
s_waitcnt vmcnt(13)
buffer_load_dwordx4 a[240:243],v250,s[20:23],s46 offen offset:2048 sc1
M a[128:131],v[228:231],a[196:199],a[128:131]
s_waitcnt vmcnt(13)
s_add_u32 s47,s75,30720
v_sub_f32 v212,v212,v208
v_fma_f32 v208,-4.0,v206,v210
M a[128:131],a[200:203],a[216:219],a[128:131]
s_waitcnt vmcnt(12)
v_sub_f32 v210,v210,v206
v_add_f32 v206,v235,v208
M a[128:131],a[220:223],v[220:223],a[128:131]
v_sub_f32 v235,v235,v208
v_fma_f32 v208,2.0,v210,v212
M a[132:135],a[220:223],a[192:195],a[132:135]
buffer_load_dwordx4 a[244:247],v250,s[20:23],s47 offen offset:0 sc1
M a[132:135],a[200:203],v[220:223],a[132:135]
v_fmac_f32 v212,-2.0,v210
v_cvt_pk_bf16_f32 v204,v232,v204
M a[132:135],v[228:231],a[216:219],a[132:135]
v_cvt_pk_bf16_f32 v214,v237,v214
v_cvt_pk_bf16_f32 v206,v233,v206
M a[136:139],v[228:231],v[220:223],a[136:139]
v_cvt_pk_bf16_f32 v210,v234,v208
v_cvt_pk_bf16_f32 v208,v238,v235
M a[136:139],a[200:203],a[192:195],a[136:139]
v_cvt_pk_bf16_f32 v212,v236,v212
v_lshlrev_b32 v234,16,v209
M a[136:139],a[220:223],a[224:227],a[136:139]
v_lshlrev_b32 v232,16,v205
v_lshlrev_b32 v233,16,v207
M a[140:143],a[220:223],a[228:231],a[140:143]
v_lshlrev_b32 v237,16,v215
v_lshlrev_b32 v236,16,v213
M a[140:143],a[200:203],a[224:227],a[140:143]
v_lshlrev_b32 v235,16,v211
v_fmac_f32 v232,s43,v234
M a[140:143],v[228:231],a[192:195],a[140:143]
v_fmac_f32 v237,4.0,v233
v_fma_f32 v238,-4.0,v234,v236
M a[144:147],v[228:231],a[224:227],a[144:147]
v_fmac_f32 v232,s45,v236
v_fmac_f32 v237,s41,v235
M a[144:147],a[200:203],a[228:231],a[144:147]
v_sub_f32 v236,v236,v234
v_fma_f32 v234,-4.0,v233,v235
M a[144:147],a[220:223],a[204:207],a[144:147]
v_sub_f32 v235,v235,v233
v_add_f32 v233,v238,v234
M a[148:151],a[220:223],a[208:211],a[148:151]
v_sub_f32 v238,v238,v234
v_fma_f32 v234,2.0,v235,v236
M a[148:151],a[200:203],a[204:207],a[148:151]
v_fmac_f32 v236,-2.0,v235
v_and_b32 v209,s42,v209
M a[148:151],v[228:231],a[228:231],a[148:151]
v_and_b32 v205,s42,v205
v_and_b32 v207,s42,v207
M a[152:155],v[228:231],a[204:207],a[152:155]
v_and_b32 v215,s42,v215
v_and_b32 v213,s42,v213
M a[152:155],a[200:203],a[208:211],a[152:155]
v_and_b32 v211,s42,v211
v_fmac_f32 v205,s43,v209
M a[152:155],a[220:223],a[232:235],a[152:155]
v_fmac_f32 v215,4.0,v207
v_fma_f32 v235,-4.0,v209,v213
M a[156:159],a[220:223],v[216:219],a[156:159]
buffer_load_dwordx4 a[220:223],v250,s[20:23],s47 offen offset:1024 sc1
M a[156:159],a[200:203],a[232:235],a[156:159]
v_fmac_f32 v205,s45,v213
v_fmac_f32 v215,s41,v211
M a[156:159],v[228:231],a[208:211],a[156:159]
s_waitcnt vmcnt(13)
buffer_load_dwordx4 a[200:203],v250,s[20:23],s47 offen offset:2048 sc1
M a[160:163],a[252:255],a[196:199],a[160:163]
s_waitcnt vmcnt(13)
s_add_u32 s48,s75,33792
v_sub_f32 v213,v213,v209
v_fma_f32 v209,-4.0,v207,v211
M a[160:163],a[212:215],a[216:219],a[160:163]
s_waitcnt vmcnt(12)
v_sub_f32 v211,v211,v207
v_add_f32 v207,v235,v209
M a[160:163],a[236:239],v[220:223],a[160:163]
v_sub_f32 v235,v235,v209
v_fma_f32 v209,2.0,v211,v213
M a[164:167],a[236:239],a[192:195],a[164:167]
buffer_load_dwordx4 v[228:231],v250,s[20:23],s48 offen offset:0 sc1
M a[164:167],a[212:215],v[220:223],a[164:167]
v_fmac_f32 v213,-2.0,v211
v_cvt_pk_bf16_f32 v205,v232,v205
M a[164:167],a[252:255],a[216:219],a[164:167]
v_cvt_pk_bf16_f32 v215,v237,v215
v_cvt_pk_bf16_f32 v207,v233,v207
M a[168:171],a[252:255],v[220:223],a[168:171]
v_cvt_pk_bf16_f32 v211,v234,v209
v_cvt_pk_bf16_f32 v209,v238,v235
M a[168:171],a[212:215],a[192:195],a[168:171]
buffer_load_dwordx4 a[196:199],v250,s[20:23],s48 offen offset:1024 sc1
M a[168:171],a[236:239],a[224:227],a[168:171]
v_cvt_pk_bf16_f32 v213,v236,v213
v_add_u32 v238,139264,v247
M a[172:175],a[236:239],a[228:231],a[172:175]
v_fmac_f32 v239,s43,v241
v_fmac_f32 v244,4.0,v240
M a[172:175],a[212:215],a[224:227],a[172:175]
v_fma_f32 v232,-4.0,v241,v243
v_fmac_f32 v239,s45,v243
M a[172:175],a[252:255],a[192:195],a[172:175]
buffer_load_dwordx4 a[216:219],v250,s[20:23],s48 offen offset:2048 sc1
M a[176:179],a[252:255],a[224:227],a[176:179]
s_add_u32 s46,s75,36864
v_fmac_f32 v244,s41,v242
v_sub_f32 v243,v243,v241
M a[176:179],a[212:215],a[228:231],a[176:179]
v_add_u32 v248,0x4400,v248
v_add_u32 v249,0x4400,v249
M a[176:179],a[236:239],a[204:207],a[176:179]
ds_write2st64_b64 v238,v[204:205],v[214:215] offset0:1 offset1:18
M a[180:183],a[236:239],a[208:211],a[180:183]
s_add_u32 s28,s70,7471104
buffer_load_dwordx4 v[220:223],v250,s[20:23],s46 offen offset:0 sc1
M a[180:183],a[212:215],a[204:207],a[180:183]
ds_read_b128 a[192:195],v248 offset:52224
v_fma_f32 v241,-4.0,v240,v242
M a[180:183],a[252:255],a[228:231],a[180:183]
ds_write2st64_b64 v247,v[206:207],v[208:209] offset0:35 offset1:52
M a[184:187],a[252:255],a[204:207],a[184:187]
buffer_load_dwordx2 v[204:205],v245,s[12:15],s28 offen offset:0
M a[184:187],a[212:215],a[208:211],a[184:187]
ds_read_b128 a[224:227],v249 offset:52224
ds_read_b128 a[228:231],v248 offset:52736
M a[184:187],a[236:239],a[232:235],a[184:187]
ds_write2st64_b64 v247,v[210:211],v[212:213] offset0:69 offset1:86
M a[188:191],a[236:239],v[216:219],a[188:191]
buffer_load_dwordx2 v[214:215],v245,s[16:19],s28 offen offset:1536
M a[188:191],a[212:215],a[232:235],a[188:191]
ds_read_b128 a[204:207],v249 offset:52736
v_sub_f32 v242,v242,v240
M a[188:191],a[252:255],a[208:211],a[188:191]
s_waitcnt vmcnt(17) lgkmcnt(5)
v_add_f32 v240,v232,v241
v_sub_f32 v232,v232,v241
M v[0:3],v[224:227],a[192:195],v[0:3]
s_waitcnt vmcnt(10) lgkmcnt(3)
ds_read_b128 a[236:239],v248 offset:53248
v_fma_f32 v241,2.0,v242,v243
M v[0:3],a[248:251],a[224:227],v[0:3]
s_waitcnt vmcnt(9) lgkmcnt(3)
buffer_load_dwordx2 v[206:207],v245,s[8:11],s28 offen offset:0
M v[0:3],a[240:243],a[228:231],v[0:3]
s_waitcnt lgkmcnt(1)
ds_read_b128 v[216:219],v249 offset:53248
v_fmac_f32 v243,-2.0,v242
M v[4:7],a[240:243],a[204:207],v[4:7]
v_cvt_pk_bf16_f32 v233,v239,v244
v_cvt_pk_bf16_f32 v234,v240,v232
M v[4:7],a[248:251],a[228:231],v[4:7]
v_cvt_pk_bf16_f32 v235,v241,v243
v_add_u32 v232,139264,v252
M v[4:7],v[224:227],a[224:227],v[4:7]
buffer_load_dwordx2 v[208:209],v245,s[8:11],s28 offen offset:384
M v[8:11],v[224:227],a[228:231],v[8:11]
ds_read_b128 a[212:215],v248 offset:53760
ds_write_b16 v232,v233 offset:0
M v[8:11],a[248:251],a[204:207],v[8:11]
s_waitcnt lgkmcnt(3)
ds_read_b128 a[232:235],v249 offset:53760
ds_write_b16_d16_hi v232,v233 offset:8704
M v[8:11],a[240:243],a[236:239],v[8:11]
s_waitcnt lgkmcnt(4)
ds_write_b16 v252,v234 offset:17408
M v[12:15],a[240:243],v[216:219],v[12:15]
buffer_load_dwordx2 v[210:211],v245,s[8:11],s28 offen offset:768
M v[12:15],a[248:251],a[236:239],v[12:15]
ds_write_b16_d16_hi v252,v234 offset:26112
M v[12:15],v[224:227],a[204:207],v[12:15]
ds_write_b16 v252,v235 offset:34816
M v[16:19],v[224:227],a[236:239],v[16:19]
ds_read_b128 a[208:211],v249 offset:54272
ds_write_b16_d16_hi v252,v235 offset:43520
M v[16:19],a[248:251],v[216:219],v[16:19]
s_waitcnt lgkmcnt(8)
buffer_load_dwordx2 v[212:213],v245,s[8:11],s28 offen offset:1152
M v[16:19],a[240:243],a[212:215],v[16:19]
s_waitcnt lgkmcnt(6)
s_add_u32 s29,s71,6291456
ds_read_b128 a[252:255],v248 offset:54272
v_lshlrev_b32 v234,16,v196
M v[20:23],a[240:243],a[232:235],v[20:23]
v_lshlrev_b32 v232,16,v192
v_lshlrev_b32 v233,16,v194
M v[20:23],a[248:251],a[212:215],v[20:23]
buffer_load_short_d16_hi v239,v246,s[12:15],s29 offen offset:0
M v[20:23],v[224:227],v[216:219],v[20:23]
v_lshlrev_b32 v237,16,v202
v_lshlrev_b32 v236,16,v200
M v[24:27],v[224:227],a[212:215],v[24:27]
buffer_load_short_d16_hi v240,v246,s[8:11],s29 offen offset:0
M v[24:27],a[248:251],a[232:235],v[24:27]
s_waitcnt lgkmcnt(2)
v_lshlrev_b32 v235,16,v198
v_fmac_f32 v232,s43,v234
M v[24:27],a[240:243],a[208:211],v[24:27]
s_waitcnt lgkmcnt(0)
buffer_load_short_d16_hi v241,v246,s[8:11],s29 offen offset:384
M v[28:31],a[240:243],a[252:255],v[28:31]
v_fmac_f32 v237,4.0,v233
v_fma_f32 v238,-4.0,v234,v236
M v[28:31],a[248:251],a[208:211],v[28:31]
buffer_load_dwordx4 a[240:243],v250,s[20:23],s46 offen offset:1024 sc1
M v[28:31],v[224:227],a[232:235],v[28:31]
s_waitcnt vmcnt(16)
v_fmac_f32 v232,s45,v236
v_fmac_f32 v237,s41,v235
M v[32:35],a[244:247],a[192:195],v[32:35]
s_waitcnt vmcnt(15)
v_sub_f32 v236,v236,v234
v_fma_f32 v234,-4.0,v233,v235
M v[32:35],a[220:223],a[224:227],v[32:35]
s_waitcnt vmcnt(14)
v_sub_f32 v235,v235,v233
v_add_f32 v233,v238,v234
M v[32:35],a[200:203],a[228:231],v[32:35]
buffer_load_dwordx4 a[248:251],v250,s[20:23],s46 offen offset:2048 sc1
M v[36:39],a[200:203],a[204:207],v[36:39]
s_add_u32 s47,s75,39936
v_sub_f32 v238,v238,v234
v_fma_f32 v234,2.0,v235,v236
M v[36:39],a[220:223],a[228:231],v[36:39]
v_fmac_f32 v236,-2.0,v235
v_and_b32 v196,s42,v196
M v[36:39],a[244:247],a[224:227],v[36:39]
v_and_b32 v192,s42,v192
v_and_b32 v194,s42,v194
M v[40:43],a[244:247],a[228:231],v[40:43]
buffer_load_dwordx4 v[224:227],v250,s[20:23],s47 offen offset:0 sc1
M v[40:43],a[220:223],a[204:207],v[40:43]
v_and_b32 v202,s42,v202
v_and_b32 v200,s42,v200
M v[40:43],a[200:203],a[236:239],v[40:43]
v_and_b32 v198,s42,v198
v_fmac_f32 v192,s43,v196
M v[44:47],a[200:203],v[216:219],v[44:47]
v_fmac_f32 v202,4.0,v194
v_fma_f32 v235,-4.0,v196,v200
M v[44:47],a[220:223],a[236:239],v[44:47]
buffer_load_short_d16_hi v242,v246,s[8:11],s29 offen offset:768
M v[44:47],a[244:247],a[204:207],v[44:47]
v_fmac_f32 v192,s45,v200
v_fmac_f32 v202,s41,v198
M v[48:51],a[244:247],a[236:239],v[48:51]
buffer_load_short_d16_hi v243,v246,s[8:11],s29 offen offset:1152
M v[48:51],a[220:223],v[216:219],v[48:51]
v_sub_f32 v200,v200,v196
v_fma_f32 v196,-4.0,v194,v198
M v[48:51],a[200:203],a[212:215],v[48:51]
buffer_load_short_d16_hi v244,v246,s[16:19],s29 offen offset:1536
M v[52:55],a[200:203],a[232:235],v[52:55]
v_sub_f32 v198,v198,v194
v_add_f32 v194,v235,v196
M v[52:55],a[220:223],a[212:215],v[52:55]
v_sub_f32 v235,v235,v196
v_fma_f32 v196,2.0,v198,v200
M v[52:55],a[244:247],v[216:219],v[52:55]
v_fmac_f32 v200,-2.0,v198
v_cvt_pk_bf16_f32 v192,v232,v192
M v[56:59],a[244:247],a[212:215],v[56:59]
v_cvt_pk_bf16_f32 v202,v237,v202
v_cvt_pk_bf16_f32 v194,v233,v194
M v[56:59],a[220:223],a[232:235],v[56:59]
v_cvt_pk_bf16_f32 v198,v234,v196
v_cvt_pk_bf16_f32 v196,v238,v235
M v[56:59],a[200:203],a[208:211],v[56:59]
v_cvt_pk_bf16_f32 v200,v236,v200
v_lshlrev_b32 v234,16,v197
M v[60:63],a[200:203],a[252:255],v[60:63]
buffer_load_dwordx4 a[200:203],v250,s[20:23],s47 offen offset:1024 sc1
M v[60:63],a[220:223],a[208:211],v[60:63]
v_lshlrev_b32 v232,16,v193
v_lshlrev_b32 v233,16,v195
M v[60:63],a[244:247],a[232:235],v[60:63]
s_waitcnt vmcnt(19)
buffer_load_dwordx4 a[220:223],v250,s[20:23],s47 offen offset:2048 sc1
M v[64:67],v[228:231],a[192:195],v[64:67]
s_waitcnt vmcnt(19)
s_add_u32 s48,s75,43008
v_lshlrev_b32 v237,16,v203
v_lshlrev_b32 v236,16,v201
M v[64:67],a[196:199],a[224:227],v[64:67]
s_waitcnt vmcnt(18)
v_lshlrev_b32 v235,16,v199
v_fmac_f32 v232,s43,v234
M v[64:67],a[216:219],a[228:231],v[64:67]
v_fmac_f32 v237,4.0,v233
v_fma_f32 v238,-4.0,v234,v236
M v[68:71],a[216:219],a[204:207],v[68:71]
buffer_load_dwordx4 a[244:247],v250,s[20:23],s48 offen offset:0 sc1
M v[68:71],a[196:199],a[228:231],v[68:71]
v_fmac_f32 v232,s45,v236
v_fmac_f32 v237,s41,v235
M v[68:71],v[228:231],a[224:227],v[68:71]
v_sub_f32 v236,v236,v234
v_fma_f32 v234,-4.0,v233,v235
M v[72:75],v[228:231],a[228:231],v[72:75]
v_sub_f32 v235,v235,v233
v_add_f32 v233,v238,v234
M v[72:75],a[196:199],a[204:207],v[72:75]
buffer_load_dwordx4 a[192:195],v250,s[20:23],s48 offen offset:1024 sc1
M v[72:75],a[216:219],a[236:239],v[72:75]
v_sub_f32 v238,v238,v234
v_fma_f32 v234,2.0,v235,v236
M v[76:79],a[216:219],v[216:219],v[76:79]
v_fmac_f32 v236,-2.0,v235
v_and_b32 v197,s42,v197
M v[76:79],a[196:199],a[236:239],v[76:79]
v_and_b32 v193,s42,v193
v_and_b32 v195,s42,v195
M v[76:79],v[228:231],a[204:207],v[76:79]
buffer_load_dwordx4 a[224:227],v250,s[20:23],s48 offen offset:2048 sc1
M v[80:83],v[228:231],a[236:239],v[80:83]
s_add_u32 s46,s76,9216
v_and_b32 v203,s42,v203
v_and_b32 v201,s42,v201
M v[80:83],a[196:199],v[216:219],v[80:83]
v_and_b32 v199,s42,v199
v_fmac_f32 v193,s43,v197
M v[80:83],a[216:219],a[212:215],v[80:83]
v_fmac_f32 v203,4.0,v195
v_fma_f32 v235,-4.0,v197,v201
M v[84:87],a[216:219],a[232:235],v[84:87]
buffer_load_dwordx4 a[228:231],v250,s[20:23],s46 offen offset:0 sc1
M v[84:87],a[196:199],a[212:215],v[84:87]
ds_read_b128 a[204:207],v248 offset:60928
v_fmac_f32 v193,s45,v201
M v[84:87],v[228:231],v[216:219],v[84:87]
ds_read_b128 a[236:239],v249 offset:60928
v_fmac_f32 v203,s41,v199
M v[88:91],v[228:231],a[212:215],v[88:91]
ds_read_b128 v[216:219],v248 offset:61440
v_sub_f32 v201,v201,v197
M v[88:91],a[196:199],a[232:235],v[88:91]
ds_read_b128 a[212:215],v249 offset:61440
v_fma_f32 v197,-4.0,v195,v199
M v[88:91],a[216:219],a[208:211],v[88:91]
v_sub_f32 v199,v199,v195
v_add_f32 v195,v235,v197
M v[92:95],a[216:219],a[252:255],v[92:95]
v_sub_f32 v235,v235,v197
v_fma_f32 v197,2.0,v199,v201
M v[92:95],a[196:199],a[208:211],v[92:95]
v_fmac_f32 v201,-2.0,v199
v_cvt_pk_bf16_f32 v193,v232,v193
M v[92:95],v[228:231],a[232:235],v[92:95]
s_waitcnt vmcnt(21) lgkmcnt(3)
v_cvt_pk_bf16_f32 v203,v237,v203
v_cvt_pk_bf16_f32 v195,v233,v195
M v[96:99],v[220:223],a[204:207],v[96:99]
s_waitcnt vmcnt(11) lgkmcnt(2)
ds_read_b128 a[216:219],v248 offset:61952
v_cvt_pk_bf16_f32 v199,v234,v197
M v[96:99],a[240:243],a[236:239],v[96:99]
s_waitcnt vmcnt(10) lgkmcnt(2)
ds_read_b128 a[252:255],v249 offset:61952
v_cvt_pk_bf16_f32 v197,v238,v235
M v[96:99],a[248:251],v[216:219],v[96:99]
s_waitcnt lgkmcnt(2)
v_cvt_pk_bf16_f32 v201,v236,v201
v_add_u32 v238,139264,v247
M v[100:103],a[248:251],a[212:215],v[100:103]
v_lshlrev_b32 v234,16,v208
v_lshlrev_b32 v232,16,v204
M v[100:103],a[240:243],v[216:219],v[100:103]
v_lshlrev_b32 v233,16,v206
v_lshlrev_b32 v237,16,v214
M v[100:103],v[220:223],a[236:239],v[100:103]
ds_write2st64_b64 v238,v[192:193],v[202:203] offset0:2 offset1:19
M v[104:107],v[220:223],v[216:219],v[104:107]
s_add_u32 s28,s71,6291456
buffer_load_dwordx2 v[192:193],v245,s[12:15],s28 offen offset:0
M v[104:107],a[240:243],a[212:215],v[104:107]
s_waitcnt lgkmcnt(2)
ds_read_b128 a[196:199],v248 offset:62464
ds_read_b128 a[208:211],v249 offset:62464
M v[104:107],a[248:251],a[216:219],v[104:107]
s_waitcnt lgkmcnt(3)
buffer_load_dwordx2 v[202:203],v245,s[16:19],s28 offen offset:1536
M v[108:111],a[248:251],a[252:255],v[108:111]
v_lshlrev_b32 v236,16,v212
v_lshlrev_b32 v235,16,v210
M v[108:111],a[240:243],a[216:219],v[108:111]
v_fmac_f32 v232,s43,v234
v_fmac_f32 v237,4.0,v233
M v[108:111],v[220:223],a[212:215],v[108:111]
ds_write2st64_b64 v247,v[194:195],v[196:197] offset0:36 offset1:53
M v[112:115],v[220:223],a[216:219],v[112:115]
buffer_load_dwordx2 v[194:195],v245,s[8:11],s28 offen offset:0
M v[112:115],a[240:243],a[252:255],v[112:115]
s_waitcnt lgkmcnt(2)
ds_read_b128 a[232:235],v249 offset:62976
ds_read_b128 v[228:231],v248 offset:62976
M v[112:115],a[248:251],a[196:199],v[112:115]
s_waitcnt lgkmcnt(3)
ds_write2st64_b64 v247,v[198:199],v[200:201] offset0:70 offset1:87
M v[116:119],a[248:251],a[208:211],v[116:119]
buffer_load_dwordx2 v[196:197],v245,s[8:11],s28 offen offset:384
M v[116:119],a[240:243],a[196:199],v[116:119]
v_fma_f32 v238,-4.0,v234,v236
v_fmac_f32 v232,s45,v236
M v[116:119],v[220:223],a[252:255],v[116:119]
v_fmac_f32 v237,s41,v235
v_sub_f32 v236,v236,v234
M v[120:123],v[220:223],a[196:199],v[120:123]
v_fma_f32 v234,-4.0,v233,v235
v_sub_f32 v235,v235,v233
M v[120:123],a[240:243],a[208:211],v[120:123]
s_waitcnt lgkmcnt(2)
buffer_load_dwordx2 v[198:199],v245,s[8:11],s28 offen offset:768
M v[120:123],a[248:251],a[232:235],v[120:123]
s_waitcnt lgkmcnt(1)
v_add_f32 v233,v238,v234
v_sub_f32 v238,v238,v234
M v[124:127],a[248:251],v[228:231],v[124:127]
v_fma_f32 v234,2.0,v235,v236
v_fmac_f32 v236,-2.0,v235
M v[124:127],a[240:243],a[232:235],v[124:127]
v_and_b32 v208,s42,v208
v_and_b32 v204,s42,v204
M v[124:127],v[220:223],a[208:211],v[124:127]
s_waitcnt vmcnt(14)
buffer_load_dwordx4 a[248:251],v250,s[20:23],s46 offen offset:1024 sc1
M v[128:131],v[224:227],a[204:207],v[128:131]
s_waitcnt vmcnt(11)
v_and_b32 v206,s42,v206
v_and_b32 v214,s42,v214
M v[128:131],a[200:203],a[236:239],v[128:131]
s_waitcnt vmcnt(10)
v_and_b32 v212,s42,v212
v_and_b32 v210,s42,v210
M v[128:131],a[220:223],v[216:219],v[128:131]
v_fmac_f32 v204,s43,v208
v_fmac_f32 v214,4.0,v206
M v[132:135],a[220:223],a[212:215],v[132:135]
buffer_load_dwordx4 a[240:243],v250,s[20:23],s46 offen offset:2048 sc1
M v[132:135],a[200:203],v[216:219],v[132:135]
s_add_u32 s47,s76,12288
v_fma_f32 v235,-4.0,v208,v212
v_fmac_f32 v204,s45,v212
M v[132:135],v[224:227],a[236:239],v[132:135]
v_fmac_f32 v214,s41,v210
v_sub_f32 v212,v212,v208
M v[136:139],v[224:227],v[216:219],v[136:139]
v_fma_f32 v208,-4.0,v206,v210
v_sub_f32 v210,v210,v206
M v[136:139],a[200:203],a[212:215],v[136:139]
buffer_load_dwordx4 v[220:223],v250,s[20:23],s47 offen offset:0 sc1
M v[136:139],a[220:223],a[216:219],v[136:139]
v_add_f32 v206,v235,v208
v_sub_f32 v235,v235,v208
M v[140:143],a[220:223],a[252:255],v[140:143]
v_fma_f32 v208,2.0,v210,v212
v_fmac_f32 v212,-2.0,v210
M v[140:143],a[200:203],a[216:219],v[140:143]
v_cvt_pk_bf16_f32 v204,v232,v204
v_cvt_pk_bf16_f32 v214,v237,v214
M v[140:143],v[224:227],a[212:215],v[140:143]
buffer_load_dwordx2 v[200:201],v245,s[8:11],s28 offen offset:1152
M v[144:147],v[224:227],a[216:219],v[144:147]
v_cvt_pk_bf16_f32 v206,v233,v206
v_cvt_pk_bf16_f32 v210,v234,v208
M v[144:147],a[200:203],a[252:255],v[144:147]
v_cvt_pk_bf16_f32 v208,v238,v235
v_cvt_pk_bf16_f32 v212,v236,v212
M v[144:147],a[220:223],a[196:199],v[144:147]
v_lshlrev_b32 v234,16,v209
v_lshlrev_b32 v232,16,v205
M v[148:151],a[220:223],a[208:211],v[148:151]
v_lshlrev_b32 v233,16,v207
v_lshlrev_b32 v237,16,v215
M v[148:151],a[200:203],a[196:199],v[148:151]
v_lshlrev_b32 v236,16,v213
v_lshlrev_b32 v235,16,v211
M v[148:151],v[224:227],a[252:255],v[148:151]
v_fmac_f32 v232,s43,v234
v_fmac_f32 v237,4.0,v233
M v[152:155],v[224:227],a[196:199],v[152:155]
v_fma_f32 v238,-4.0,v234,v236
v_fmac_f32 v232,s45,v236
M v[152:155],a[200:203],a[208:211],v[152:155]
v_fmac_f32 v237,s41,v235
v_sub_f32 v236,v236,v234
M v[152:155],a[220:223],a[232:235],v[152:155]
v_fma_f32 v234,-4.0,v233,v235
v_sub_f32 v235,v235,v233
M v[156:159],a[220:223],v[228:231],v[156:159]
buffer_load_dwordx4 a[220:223],v250,s[20:23],s47 offen offset:1024 sc1
v_add_f32 v233,v238,v234
v_sub_f32 v238,v238,v234
v_fma_f32 v234,2.0,v235,v236
v_fmac_f32 v236,-2.0,v235
M v[156:159],a[200:203],a[232:235],v[156:159]
buffer_load_dwordx4 a[200:203],v250,s[20:23],s47 offen offset:2048 sc1
v_and_b32 v209,s42,v209
v_and_b32 v205,s42,v205
v_and_b32 v207,s42,v207
v_and_b32 v215,s42,v215
M v[156:159],v[224:227],a[208:211],v[156:159]
s_waitcnt vmcnt(14)
s_add_u32 s48,s76,15360
v_and_b32 v213,s42,v213
v_and_b32 v211,s42,v211
v_fmac_f32 v205,s43,v209
v_fmac_f32 v215,4.0,v207
M v[160:163],a[244:247],a[204:207],v[160:163]
s_waitcnt vmcnt(13)
v_fma_f32 v235,-4.0,v209,v213
v_fmac_f32 v205,s45,v213
v_fmac_f32 v215,s41,v211
v_sub_f32 v213,v213,v209
M v[160:163],a[192:195],a[236:239],v[160:163]
s_waitcnt vmcnt(12)
buffer_load_dwordx4 v[224:227],v250,s[20:23],s48 offen offset:0 sc1
v_fma_f32 v209,-4.0,v207,v211
v_sub_f32 v211,v211,v207
v_add_f32 v207,v235,v209
v_sub_f32 v235,v235,v209
M v[160:163],a[224:227],v[216:219],v[160:163]
v_fma_f32 v209,2.0,v211,v213
v_fmac_f32 v213,-2.0,v211
v_cvt_pk_bf16_f32 v205,v232,v205
v_cvt_pk_bf16_f32 v215,v237,v215
M v[164:167],a[224:227],a[212:215],v[164:167]
buffer_load_dwordx4 a[204:207],v250,s[20:23],s48 offen offset:1024 sc1
v_cvt_pk_bf16_f32 v207,v233,v207
v_cvt_pk_bf16_f32 v211,v234,v209
v_cvt_pk_bf16_f32 v209,v238,v235
v_cvt_pk_bf16_f32 v213,v236,v213
M v[164:167],a[192:195],v[216:219],v[164:167]
v_add_u32 v238,139264,v247
M v[164:167],a[244:247],a[236:239],v[164:167]
ds_write2st64_b64 v238,v[204:205],v[214:215] offset0:3 offset1:20
M v[168:171],a[244:247],v[216:219],v[168:171]
s_add_u32 s28,s71,6684672
buffer_load_dwordx4 a[236:239],v250,s[20:23],s48 offen offset:2048 sc1
M v[168:171],a[192:195],a[212:215],v[168:171]
s_add_u32 s46,s76,18432
M v[168:171],a[224:227],a[216:219],v[168:171]
ds_write2st64_b64 v247,v[206:207],v[208:209] offset0:37 offset1:54
M v[172:175],a[224:227],a[252:255],v[172:175]
buffer_load_dwordx4 v[216:219],v250,s[20:23],s46 offen offset:0 sc1
M v[172:175],a[192:195],a[216:219],v[172:175]
M v[172:175],a[244:247],a[212:215],v[172:175]
ds_write2st64_b64 v247,v[210:211],v[212:213] offset0:71 offset1:88
M v[176:179],a[244:247],a[216:219],v[176:179]
buffer_load_dwordx2 v[204:205],v245,s[12:15],s28 offen offset:0
M v[176:179],a[192:195],a[252:255],v[176:179]
M v[176:179],a[224:227],a[196:199],v[176:179]
s_waitcnt lgkmcnt(0)
s_barrier
M v[180:183],a[224:227],a[208:211],v[180:183]
M v[180:183],a[192:195],a[196:199],v[180:183]
buffer_load_dwordx2 v[214:215],v245,s[16:19],s28 offen offset:1536
M v[180:183],a[244:247],a[252:255],v[180:183]
ds_read_b128 a[212:215],v248 offset:0
ds_read_b128 a[216:219],v249 offset:0
M v[184:187],a[244:247],a[196:199],v[184:187]
s_waitcnt vmcnt(13)
ds_read_b128 a[252:255],v248 offset:512
v_lshlrev_b32 v234,16,v196
M v[184:187],a[192:195],a[208:211],v[184:187]
ds_read_b128 a[196:199],v249 offset:512
v_lshlrev_b32 v232,16,v192
M v[184:187],a[224:227],a[232:235],v[184:187]
buffer_load_dwordx2 v[206:207],v245,s[8:11],s28 offen offset:0
M v[188:191],a[224:227],v[228:231],v[188:191]
v_lshlrev_b32 v233,16,v194
v_lshlrev_b32 v237,16,v202
M v[188:191],a[192:195],a[232:235],v[188:191]
s_waitcnt vmcnt(9)
v_lshlrev_b32 v236,16,v200
v_lshlrev_b32 v235,16,v198
M v[188:191],a[244:247],a[208:211],v[188:191]
s_waitcnt lgkmcnt(3)
v_fmac_f32 v232,s43,v234
v_fmac_f32 v237,4.0,v233
M a[0:3],a[228:231],a[212:215],a[0:3]
s_waitcnt lgkmcnt(2)
buffer_load_dwordx2 v[208:209],v245,s[8:11],s28 offen offset:384
M a[0:3],a[248:251],a[216:219],a[0:3]
s_waitcnt lgkmcnt(1)
ds_read_b128 a[224:227],v248 offset:1024
ds_read_b128 v[228:231],v249 offset:1024
M a[0:3],a[240:243],a[252:255],a[0:3]
s_waitcnt lgkmcnt(2)
v_fma_f32 v238,-4.0,v234,v236
v_fmac_f32 v232,s45,v236
M a[4:7],a[240:243],a[196:199],a[4:7]
v_fmac_f32 v237,s41,v235
v_sub_f32 v236,v236,v234
M a[4:7],a[248:251],a[252:255],a[4:7]
buffer_load_dwordx2 v[210:211],v245,s[8:11],s28 offen offset:768
M a[4:7],a[228:231],a[216:219],a[4:7]
v_fma_f32 v234,-4.0,v233,v235
v_sub_f32 v235,v235,v233
M a[8:11],a[228:231],a[252:255],a[8:11]
ds_read_b128 a[192:195],v248 offset:1536
v_add_f32 v233,v238,v234
M a[8:11],a[248:251],a[196:199],a[8:11]
s_waitcnt lgkmcnt(2)
ds_read_b128 a[232:235],v249 offset:1536
v_sub_f32 v238,v238,v234
M a[8:11],a[240:243],a[224:227],a[8:11]
s_waitcnt lgkmcnt(2)
buffer_load_dwordx2 v[212:213],v245,s[8:11],s28 offen offset:1152
M a[12:15],a[240:243],v[228:231],a[12:15]
v_fma_f32 v234,2.0,v235,v236
v_fmac_f32 v236,-2.0,v235
M a[12:15],a[248:251],a[224:227],a[12:15]
v_and_b32 v196,s42,v196
v_and_b32 v192,s42,v192
M a[12:15],a[228:231],a[196:199],a[12:15]
v_and_b32 v194,s42,v194
v_and_b32 v202,s42,v202
M a[16:19],a[228:231],a[224:227],a[16:19]
ds_read_b128 a[208:211],v249 offset:2048
v_and_b32 v200,s42,v200
M a[16:19],a[248:251],v[228:231],a[16:19]
s_waitcnt lgkmcnt(2)
ds_read_b128 a[244:247],v248 offset:2048
v_and_b32 v198,s42,v198
M a[16:19],a[240:243],a[192:195],a[16:19]
s_waitcnt lgkmcnt(2)
v_fmac_f32 v192,s43,v196
v_fmac_f32 v202,4.0,v194
M a[20:23],a[240:243],a[232:235],a[20:23]
v_fma_f32 v235,-4.0,v196,v200
v_fmac_f32 v192,s45,v200
M a[20:23],a[248:251],a[192:195],a[20:23]
v_fmac_f32 v202,s41,v198
v_sub_f32 v200,v200,v196
M a[20:23],a[228:231],v[228:231],a[20:23]
v_fma_f32 v196,-4.0,v194,v198
v_sub_f32 v198,v198,v194
M a[24:27],a[228:231],a[192:195],a[24:27]
v_add_f32 v194,v235,v196
v_sub_f32 v235,v235,v196
M a[24:27],a[248:251],a[232:235],a[24:27]
s_waitcnt lgkmcnt(1)
v_fma_f32 v196,2.0,v198,v200
v_fmac_f32 v200,-2.0,v198
M a[24:27],a[240:243],a[208:211],a[24:27]
s_waitcnt lgkmcnt(0)
v_cvt_pk_bf16_f32 v192,v232,v192
v_cvt_pk_bf16_f32 v202,v237,v202
M a[28:31],a[240:243],a[244:247],a[28:31]
buffer_load_dwordx4 a[240:243],v250,s[20:23],s46 offen offset:1024 sc1
M a[28:31],a[248:251],a[208:211],a[28:31]
v_cvt_pk_bf16_f32 v194,v233,v194
v_cvt_pk_bf16_f32 v198,v234,v196
M a[28:31],a[228:231],a[232:235],a[28:31]
buffer_load_dwordx4 a[248:251],v250,s[20:23],s46 offen offset:2048 sc1
M a[32:35],v[220:223],a[212:215],a[32:35]
s_waitcnt vmcnt(13)
s_add_u32 s47,s76,21504
v_cvt_pk_bf16_f32 v196,v238,v235
v_cvt_pk_bf16_f32 v200,v236,v200
M a[32:35],a[220:223],a[216:219],a[32:35]
s_waitcnt vmcnt(12)
v_lshlrev_b32 v234,16,v197
v_lshlrev_b32 v232,16,v193
M a[32:35],a[200:203],a[252:255],a[32:35]
v_lshlrev_b32 v233,16,v195
v_lshlrev_b32 v237,16,v203
M a[36:39],a[200:203],a[196:199],a[36:39]
buffer_load_dwordx4 a[228:231],v250,s[20:23],s47 offen offset:0 sc1
M a[36:39],a[220:223],a[252:255],a[36:39]
v_lshlrev_b32 v236,16,v201
v_lshlrev_b32 v235,16,v199
M a[36:39],v[220:223],a[216:219],a[36:39]
v_fmac_f32 v232,s43,v234
v_fmac_f32 v237,4.0,v233
M a[40:43],v[220:223],a[252:255],a[40:43]
v_fma_f32 v238,-4.0,v234,v236
v_fmac_f32 v232,s45,v236
M a[40:43],a[220:223],a[196:199],a[40:43]
v_fmac_f32 v237,s41,v235
v_sub_f32 v236,v236,v234
M a[40:43],a[200:203],a[224:227],a[40:43]
v_fma_f32 v234,-4.0,v233,v235
v_sub_f32 v235,v235,v233
M a[44:47],a[200:203],v[228:231],a[44:47]
v_add_f32 v233,v238,v234
v_sub_f32 v238,v238,v234
M a[44:47],a[220:223],a[224:227],a[44:47]
v_fma_f32 v234,2.0,v235,v236
v_fmac_f32 v236,-2.0,v235
M a[44:47],v[220:223],a[196:199],a[44:47]
v_and_b32 v197,s42,v197
v_and_b32 v193,s42,v193
M a[48:51],v[220:223],a[224:227],a[48:51]
v_and_b32 v195,s42,v195
v_and_b32 v203,s42,v203
M a[48:51],a[220:223],v[228:231],a[48:51]
v_and_b32 v201,s42,v201
v_and_b32 v199,s42,v199
M a[48:51],a[200:203],a[192:195],a[48:51]
v_fmac_f32 v193,s43,v197
v_fmac_f32 v203,4.0,v195
M a[52:55],a[200:203],a[232:235],a[52:55]
v_fma_f32 v235,-4.0,v197,v201
v_fmac_f32 v193,s45,v201
M a[52:55],a[220:223],a[192:195],a[52:55]
v_fmac_f32 v203,s41,v199
v_sub_f32 v201,v201,v197
M a[52:55],v[220:223],v[228:231],a[52:55]
v_fma_f32 v197,-4.0,v195,v199
v_sub_f32 v199,v199,v195
M a[56:59],v[220:223],a[192:195],a[56:59]
v_add_f32 v195,v235,v197
v_sub_f32 v235,v235,v197
M a[56:59],a[220:223],a[232:235],a[56:59]
v_fma_f32 v197,2.0,v199,v201
v_fmac_f32 v201,-2.0,v199
M a[56:59],a[200:203],a[208:211],a[56:59]
v_cvt_pk_bf16_f32 v193,v232,v193
v_cvt_pk_bf16_f32 v203,v237,v203
M a[60:63],a[200:203],a[244:247],a[60:63]
buffer_load_dwordx4 a[200:203],v250,s[20:23],s47 offen offset:1024 sc1
M a[60:63],a[220:223],a[208:211],a[60:63]
v_cvt_pk_bf16_f32 v195,v233,v195
v_cvt_pk_bf16_f32 v199,v234,v197
M a[60:63],v[220:223],a[232:235],a[60:63]
s_waitcnt vmcnt(13)
buffer_load_dwordx4 a[220:223],v250,s[20:23],s47 offen offset:2048 sc1
M a[64:67],v[224:227],a[212:215],a[64:67]
s_waitcnt vmcnt(13)
s_add_u32 s48,s76,24576
v_cvt_pk_bf16_f32 v197,v238,v235
v_cvt_pk_bf16_f32 v201,v236,v201
M a[64:67],a[204:207],a[216:219],a[64:67]
s_waitcnt vmcnt(7)
v_lshlrev_b32 v234,16,v208
v_lshlrev_b32 v232,16,v204
M a[64:67],a[236:239],a[252:255],a[64:67]
ds_write2st64_b64 v247,v[192:193],v[202:203] offset0:136 offset1:153
M a[68:71],a[236:239],a[196:199],a[68:71]
s_add_u32 s28,s71,7077888
buffer_load_dwordx4 v[220:223],v250,s[20:23],s48 offen offset:0 sc1
M a[68:71],a[204:207],a[252:255],a[68:71]
v_lshlrev_b32 v233,16,v206
v_lshlrev_b32 v237,16,v214
M a[68:71],v[224:227],a[216:219],a[68:71]
ds_write2st64_b64 v247,v[194:195],v[196:197] offset0:0 offset1:17
M a[72:75],v[224:227],a[252:255],a[72:75]
buffer_load_dwordx4 a[212:215],v250,s[20:23],s48 offen offset:1024 sc1
M a[72:75],a[204:207],a[196:199],a[72:75]
s_waitcnt vmcnt(7)
v_lshlrev_b32 v236,16,v212
v_lshlrev_b32 v235,16,v210
M a[72:75],a[236:239],a[224:227],a[72:75]
v_fmac_f32 v232,s43,v234
v_fmac_f32 v237,4.0,v233
M a[76:79],a[236:239],v[228:231],a[76:79]
v_fma_f32 v238,-4.0,v234,v236
v_fmac_f32 v232,s45,v236
M a[76:79],a[204:207],a[224:227],a[76:79]
buffer_load_dwordx4 a[216:219],v250,s[20:23],s48 offen offset:2048 sc1
M a[76:79],v[224:227],a[196:199],a[76:79]
s_add_u32 s46,s76,27648
v_fmac_f32 v237,s41,v235
v_sub_f32 v236,v236,v234
M a[80:83],v[224:227],a[224:227],a[80:83]
v_fma_f32 v234,-4.0,v233,v235
v_sub_f32 v235,v235,v233
M a[80:83],a[204:207],v[228:231],a[80:83]
v_add_f32 v233,v238,v234
v_sub_f32 v238,v238,v234
M a[80:83],a[236:239],a[192:195],a[80:83]
buffer_load_dwordx4 a[252:255],v250,s[20:23],s46 offen offset:0 sc1
M a[84:87],a[236:239],a[232:235],a[84:87]
v_fma_f32 v234,2.0,v235,v236
v_fmac_f32 v236,-2.0,v235
M a[84:87],a[204:207],a[192:195],a[84:87]
ds_read_b128 a[196:199],v248 offset:8704
v_and_b32 v208,s42,v208
M a[84:87],v[224:227],v[228:231],a[84:87]
ds_read_b128 a[224:227],v249 offset:8704
v_and_b32 v204,s42,v204
M a[88:91],v[224:227],a[192:195],a[88:91]
buffer_load_dwordx2 v[192:193],v245,s[12:15],s28 offen offset:0
M a[88:91],a[204:207],a[232:235],a[88:91]
ds_read_b128 v[228:231],v248 offset:9216
ds_read_b128 a[192:195],v249 offset:9216
M a[88:91],a[236:239],a[208:211],a[88:91]
v_and_b32 v206,s42,v206
v_and_b32 v214,s42,v214
M a[92:95],a[236:239],a[244:247],a[92:95]
v_and_b32 v212,s42,v212
v_and_b32 v210,s42,v210
M a[92:95],a[204:207],a[208:211],a[92:95]
buffer_load_dwordx2 v[202:203],v245,s[16:19],s28 offen offset:1536
M a[92:95],v[224:227],a[232:235],a[92:95]
s_waitcnt lgkmcnt(3)
v_fmac_f32 v204,s43,v208
v_fmac_f32 v214,4.0,v206
M a[96:99],v[216:219],a[196:199],a[96:99]
s_waitcnt vmcnt(10) lgkmcnt(2)
ds_read_b128 a[236:239],v248 offset:9728
v_fma_f32 v235,-4.0,v208,v212
M a[96:99],a[240:243],a[224:227],a[96:99]
s_waitcnt vmcnt(9) lgkmcnt(2)
ds_read_b128 a[244:247],v249 offset:9728
v_fmac_f32 v204,s45,v212
M a[96:99],a[248:251],v[228:231],a[96:99]
s_waitcnt lgkmcnt(2)
buffer_load_dwordx2 v[194:195],v245,s[8:11],s28 offen offset:0
M a[100:103],a[248:251],a[192:195],a[100:103]
v_fmac_f32 v214,s41,v210
v_sub_f32 v212,v212,v208
M a[100:103],a[240:243],v[228:231],a[100:103]
v_fma_f32 v208,-4.0,v206,v210
v_sub_f32 v210,v210,v206
M a[100:103],v[216:219],a[224:227],a[100:103]
v_add_f32 v206,v235,v208
v_sub_f32 v235,v235,v208
M a[104:107],v[216:219],v[228:231],a[104:107]
buffer_load_dwordx2 v[196:197],v245,s[8:11],s28 offen offset:384
M a[104:107],a[240:243],a[192:195],a[104:107]
s_waitcnt lgkmcnt(1)
ds_read_b128 a[204:207],v248 offset:10240
ds_read_b128 a[208:211],v249 offset:10240
M a[104:107],a[248:251],a[236:239],a[104:107]
s_waitcnt lgkmcnt(2)
v_fma_f32 v208,2.0,v210,v212
v_fmac_f32 v212,-2.0,v210
M a[108:111],a[248:251],a[244:247],a[108:111]
v_cvt_pk_bf16_f32 v204,v232,v204
v_cvt_pk_bf16_f32 v214,v237,v214
M a[108:111],a[240:243],a[236:239],a[108:111]
v_cvt_pk_bf16_f32 v206,v233,v206
v_cvt_pk_bf16_f32 v210,v234,v208
M a[108:111],v[216:219],a[192:195],a[108:111]
v_cvt_pk_bf16_f32 v208,v238,v235
v_cvt_pk_bf16_f32 v212,v236,v212
M a[112:115],v[216:219],a[236:239],a[112:115]
ds_read_b128 a[232:235],v249 offset:10752
v_lshlrev_b32 v234,16,v209
M a[112:115],a[240:243],a[244:247],a[112:115]
s_waitcnt lgkmcnt(2)
ds_read_b128 v[224:227],v248 offset:10752
v_lshlrev_b32 v232,16,v205
M a[112:115],a[248:251],a[204:207],a[112:115]
s_waitcnt lgkmcnt(2)
v_lshlrev_b32 v233,16,v207
v_lshlrev_b32 v237,16,v215
M a[116:119],a[248:251],a[208:211],a[116:119]
v_lshlrev_b32 v236,16,v213
v_lshlrev_b32 v235,16,v211
M a[116:119],a[240:243],a[204:207],a[116:119]
v_fmac_f32 v232,s43,v234
v_fmac_f32 v237,4.0,v233
M a[116:119],v[216:219],a[244:247],a[116:119]
v_fma_f32 v238,-4.0,v234,v236
v_fmac_f32 v232,s45,v236
M a[120:123],v[216:219],a[204:207],a[120:123]
v_fmac_f32 v237,s41,v235
v_sub_f32 v236,v236,v234
M a[120:123],a[240:243],a[208:211],a[120:123]
s_waitcnt lgkmcnt(1)
v_fma_f32 v234,-4.0,v233,v235
v_sub_f32 v235,v235,v233
M a[120:123],a[248:251],a[232:235],a[120:123]
s_waitcnt lgkmcnt(0)
v_add_f32 v233,v238,v234
v_sub_f32 v238,v238,v234
M a[124:127],a[248:251],v[224:227],a[124:127]
buffer_load_dwordx4 a[248:251],v250,s[20:23],s46 offen offset:1024 sc1
M a[124:127],a[240:243],a[232:235],a[124:127]
v_fma_f32 v234,2.0,v235,v236
v_fmac_f32 v236,-2.0,v235
M a[124:127],v[216:219],a[208:211],a[124:127]
s_waitcnt vmcnt(11)
buffer_load_dwordx4 a[240:243],v250,s[20:23],s46 offen offset:2048 sc1
M a[128:131],a[228:231],a[196:199],a[128:131]
s_waitcnt vmcnt(11)
s_add_u32 s47,s76,30720
v_and_b32 v209,s42,v209
v_and_b32 v205,s42,v205
M a[128:131],a[200:203],a[224:227],a[128:131]
s_waitcnt vmcnt(10)
v_and_b32 v207,s42,v207
v_and_b32 v215,s42,v215
M a[128:131],a[220:223],v[228:231],a[128:131]
v_and_b32 v213,s42,v213
v_and_b32 v211,s42,v211
M a[132:135],a[220:223],a[192:195],a[132:135]
buffer_load_dwordx4 v[216:219],v250,s[20:23],s47 offen offset:0 sc1
M a[132:135],a[200:203],v[228:231],a[132:135]
v_fmac_f32 v205,s43,v209
v_fmac_f32 v215,4.0,v207
M a[132:135],a[228:231],a[224:227],a[132:135]
v_fma_f32 v235,-4.0,v209,v213
v_fmac_f32 v205,s45,v213
M a[136:139],a[228:231],v[228:231],a[136:139]
s_barrier
v_fmac_f32 v215,s41,v211
M a[136:139],a[200:203],a[192:195],a[136:139]
v_sub_f32 v213,v213,v209
v_fma_f32 v209,-4.0,v207,v211
M a[136:139],a[220:223],a[236:239],a[136:139]
ds_write2st64_b64 v247,v[198:199],v[200:201] offset0:34 offset1:51
M a[140:143],a[220:223],a[244:247],a[140:143]
buffer_load_dwordx2 v[198:199],v245,s[8:11],s28 offen offset:768
M a[140:143],a[200:203],a[236:239],a[140:143]
v_sub_f32 v211,v211,v207
v_add_f32 v207,v235,v209
M a[140:143],a[228:231],a[192:195],a[140:143]
buffer_load_dwordx2 v[200:201],v245,s[8:11],s28 offen offset:1152
M a[144:147],a[228:231],a[236:239],a[144:147]
v_sub_f32 v235,v235,v209
v_fma_f32 v209,2.0,v211,v213
M a[144:147],a[200:203],a[244:247],a[144:147]
v_fmac_f32 v213,-2.0,v211
v_cvt_pk_bf16_f32 v205,v232,v205
M a[144:147],a[220:223],a[204:207],a[144:147]
v_cvt_pk_bf16_f32 v215,v237,v215
v_cvt_pk_bf16_f32 v207,v233,v207
M a[148:151],a[220:223],a[208:211],a[148:151]
v_cvt_pk_bf16_f32 v211,v234,v209
v_cvt_pk_bf16_f32 v209,v238,v235
M a[148:151],a[200:203],a[204:207],a[148:151]
v_cvt_pk_bf16_f32 v213,v236,v213
v_fmac_f32 v239,s43,v241
M a[148:151],a[228:231],a[244:247],a[148:151]
ds_write2st64_b64 v247,v[204:205],v[214:215] offset0:137 offset1:154
M a[152:155],a[228:231],a[204:207],a[152:155]
s_add_u32 s28,s71,7471104
buffer_load_dwordx2 v[204:205],v245,s[12:15],s28 offen offset:0
M a[152:155],a[200:203],a[208:211],a[152:155]
v_fmac_f32 v244,4.0,v240
v_fma_f32 v232,-4.0,v241,v243
M a[152:155],a[220:223],a[232:235],a[152:155]
buffer_load_dwordx2 v[214:215],v245,s[16:19],s28 offen offset:1536
M a[156:159],a[220:223],v[224:227],a[156:159]
v_fmac_f32 v239,s45,v243
v_fmac_f32 v244,s41,v242
M a[156:159],a[200:203],a[232:235],a[156:159]
v_sub_f32 v243,v243,v241
v_fma_f32 v241,-4.0,v240,v242
M a[156:159],a[228:231],a[208:211],a[156:159]
s_waitcnt vmcnt(14)
ds_write2st64_b64 v247,v[206:207],v[208:209] offset0:1 offset1:18
M a[160:163],v[220:223],a[196:199],a[160:163]
s_waitcnt vmcnt(13)
buffer_load_dwordx4 a[220:223],v250,s[20:23],s47 offen offset:1024 sc1
M a[160:163],a[212:215],a[224:227],a[160:163]
s_waitcnt vmcnt(13)
v_sub_f32 v242,v242,v240
v_add_f32 v240,v232,v241
M a[160:163],a[216:219],v[228:231],a[160:163]
ds_write2st64_b64 v247,v[210:211],v[212:213] offset0:35 offset1:52
M a[164:167],a[216:219],a[192:195],a[164:167]
buffer_load_dwordx4 a[200:203],v250,s[20:23],s47 offen offset:2048 sc1
M a[164:167],a[212:215],v[228:231],a[164:167]
s_add_u32 s48,s76,33792
v_sub_f32 v232,v232,v241
v_fma_f32 v241,2.0,v242,v243
M a[164:167],v[220:223],a[224:227],a[164:167]
v_fmac_f32 v243,-2.0,v242
v_cvt_pk_bf16_f32 v233,v239,v244
M a[168:171],v[220:223],v[228:231],a[168:171]
v_cvt_pk_bf16_f32 v234,v240,v232
v_cvt_pk_bf16_f32 v235,v241,v243
M a[168:171],a[212:215],a[192:195],a[168:171]
buffer_load_dwordx4 a[228:231],v250,s[20:23],s48 offen offset:0 sc1
M a[168:171],a[216:219],a[236:239],a[168:171]
v_add_u32 v232,69632,v252
M a[172:175],a[216:219],a[244:247],a[172:175]
ds_write_b16 v232,v233 offset:0
M a[172:175],a[212:215],a[236:239],a[172:175]
ds_write_b16_d16_hi v232,v233 offset:8704
M a[172:175],v[220:223],a[192:195],a[172:175]
buffer_load_dwordx4 a[196:199],v250,s[20:23],s48 offen offset:1024 sc1
M a[176:179],v[220:223],a[236:239],a[176:179]
ds_write_b16 v252,v234 offset:0
M a[176:179],a[212:215],a[244:247],a[176:179]
ds_write_b16_d16_hi v252,v234 offset:8704
M a[176:179],a[216:219],a[204:207],a[176:179]
ds_write_b16 v252,v235 offset:17408
M a[180:183],a[216:219],a[208:211],a[180:183]
buffer_load_dwordx4 a[224:227],v250,s[20:23],s48 offen offset:2048 sc1
M a[180:183],a[212:215],a[204:207],a[180:183]
s_add_u32 s46,s76,36864
ds_read_b128 a[192:195],v248 offset:17408
ds_write_b16_d16_hi v252,v235 offset:26112
M a[180:183],v[220:223],a[244:247],a[180:183]
s_waitcnt vmcnt(12)
ds_read_b128 a[236:239],v249 offset:17408
v_lshlrev_b32 v234,16,v196
M a[184:187],v[220:223],a[204:207],a[184:187]
ds_read_b128 a[244:247],v248 offset:17920
v_lshlrev_b32 v232,16,v192
M a[184:187],a[212:215],a[208:211],a[184:187]
buffer_load_dwordx4 v[228:231],v250,s[20:23],s46 offen offset:0 sc1
M a[184:187],a[216:219],a[232:235],a[184:187]
ds_read_b128 a[204:207],v249 offset:17920
v_lshlrev_b32 v233,16,v194
M a[188:191],a[216:219],v[224:227],a[188:191]
s_waitcnt vmcnt(8)
v_lshlrev_b32 v237,16,v202
v_lshlrev_b32 v236,16,v200
M a[188:191],a[212:215],a[232:235],a[188:191]
v_lshlrev_b32 v235,16,v198
v_fmac_f32 v232,s43,v234
M a[188:191],v[220:223],a[208:211],a[188:191]
s_waitcnt lgkmcnt(4)
buffer_load_dwordx2 v[206:207],v245,s[8:11],s28 offen offset:0
M v[0:3],a[252:255],a[192:195],v[0:3]
s_waitcnt lgkmcnt(2)
ds_read_b128 a[216:219],v248 offset:18432
v_fmac_f32 v237,4.0,v233
M v[0:3],a[248:251],a[236:239],v[0:3]
s_waitcnt lgkmcnt(2)
ds_read_b128 v[224:227],v249 offset:18432
v_fma_f32 v238,-4.0,v234,v236
M v[0:3],a[240:243],a[244:247],v[0:3]
s_waitcnt lgkmcnt(2)
v_fmac_f32 v232,s45,v236
v_fmac_f32 v237,s41,v235
M v[4:7],a[240:243],a[204:207],v[4:7]
buffer_load_dwordx2 v[208:209],v245,s[8:11],s28 offen offset:384
M v[4:7],a[248:251],a[244:247],v[4:7]
v_sub_f32 v236,v236,v234
v_fma_f32 v234,-4.0,v233,v235
M v[4:7],a[252:255],a[236:239],v[4:7]
v_sub_f32 v235,v235,v233
v_add_f32 v233,v238,v234
M v[8:11],a[252:255],a[244:247],v[8:11]
ds_read_b128 a[212:215],v248 offset:18944
v_sub_f32 v238,v238,v234
M v[8:11],a[248:251],a[204:207],v[8:11]
s_waitcnt lgkmcnt(2)
buffer_load_dwordx2 v[210:211],v245,s[8:11],s28 offen offset:768
M v[8:11],a[240:243],a[216:219],v[8:11]
s_waitcnt lgkmcnt(1)
ds_read_b128 a[232:235],v249 offset:18944
v_fma_f32 v234,2.0,v235,v236
M v[12:15],a[240:243],v[224:227],v[12:15]
v_fmac_f32 v236,-2.0,v235
v_and_b32 v196,s42,v196
M v[12:15],a[248:251],a[216:219],v[12:15]
v_and_b32 v192,s42,v192
v_and_b32 v194,s42,v194
M v[12:15],a[252:255],a[204:207],v[12:15]
buffer_load_dwordx2 v[212:213],v245,s[8:11],s28 offen offset:1152
M v[16:19],a[252:255],a[216:219],v[16:19]
ds_read_b128 a[208:211],v249 offset:19456
v_and_b32 v202,s42,v202
M v[16:19],a[248:251],v[224:227],v[16:19]
s_waitcnt lgkmcnt(2)
ds_read_b128 v[220:223],v248 offset:19456
v_and_b32 v200,s42,v200
M v[16:19],a[240:243],a[212:215],v[16:19]
s_waitcnt lgkmcnt(2)
v_and_b32 v198,s42,v198
v_fmac_f32 v192,s43,v196
M v[20:23],a[240:243],a[232:235],v[20:23]
v_fmac_f32 v202,4.0,v194
v_fma_f32 v235,-4.0,v196,v200
M v[20:23],a[248:251],a[212:215],v[20:23]
v_fmac_f32 v192,s45,v200
v_fmac_f32 v202,s41,v198
M v[20:23],a[252:255],v[224:227],v[20:23]
v_sub_f32 v200,v200,v196
v_fma_f32 v196,-4.0,v194,v198
M v[24:27],a[252:255],a[212:215],v[24:27]
v_sub_f32 v198,v198,v194
v_add_f32 v194,v235,v196
M v[24:27],a[248:251],a[232:235],v[24:27]
s_waitcnt lgkmcnt(1)
v_sub_f32 v235,v235,v196
v_fma_f32 v196,2.0,v198,v200
M v[24:27],a[240:243],a[208:211],v[24:27]
s_waitcnt lgkmcnt(0)
v_fmac_f32 v200,-2.0,v198
v_cvt_pk_bf16_f32 v192,v232,v192
M v[28:31],a[240:243],v[220:223],v[28:31]
global_load_dword a240,v250,s[64:65]
M v[28:31],a[248:251],a[208:211],v[28:31]
buffer_load_dwordx4 a[240:243],v250,s[20:23],s46 offen offset:1024 sc1
M v[28:31],a[252:255],a[232:235],v[28:31]
v_cvt_pk_bf16_f32 v202,v237,v202
v_cvt_pk_bf16_f32 v194,v233,v194
M v[32:35],v[216:219],a[192:195],v[32:35]
s_waitcnt vmcnt(11)
v_cvt_pk_bf16_f32 v198,v234,v196
v_cvt_pk_bf16_f32 v196,v238,v235
M v[32:35],a[220:223],a[236:239],v[32:35]
s_waitcnt vmcnt(10)
buffer_load_dwordx4 a[248:251],v250,s[20:23],s46 offen offset:2048 sc1
M v[32:35],a[200:203],a[244:247],v[32:35]
s_add_u32 s47,s76,39936
v_cvt_pk_bf16_f32 v200,v236,v200
v_lshlrev_b32 v234,16,v197
M v[36:39],a[200:203],a[204:207],v[36:39]
v_lshlrev_b32 v232,16,v193
v_lshlrev_b32 v233,16,v195
M v[36:39],a[220:223],a[244:247],v[36:39]
v_lshlrev_b32 v237,16,v203
v_lshlrev_b32 v236,16,v201
M v[36:39],v[216:219],a[236:239],v[36:39]
buffer_load_dwordx4 a[252:255],v250,s[20:23],s47 offen offset:0 sc1
M v[40:43],v[216:219],a[244:247],v[40:43]
v_lshlrev_b32 v235,16,v199
v_fmac_f32 v232,s43,v234
M v[40:43],a[220:223],a[204:207],v[40:43]
v_fmac_f32 v237,4.0,v233
v_fma_f32 v238,-4.0,v234,v236
M v[40:43],a[200:203],a[216:219],v[40:43]
v_fmac_f32 v232,s45,v236
v_fmac_f32 v237,s41,v235
M v[44:47],a[200:203],v[224:227],v[44:47]
v_sub_f32 v236,v236,v234
v_fma_f32 v234,-4.0,v233,v235
M v[44:47],a[220:223],a[216:219],v[44:47]
v_sub_f32 v235,v235,v233
v_add_f32 v233,v238,v234
M v[44:47],v[216:219],a[204:207],v[44:47]
v_sub_f32 v238,v238,v234
v_fma_f32 v234,2.0,v235,v236
M v[48:51],v[216:219],a[216:219],v[48:51]
v_fmac_f32 v236,-2.0,v235
v_and_b32 v197,s42,v197
M v[48:51],a[220:223],v[224:227],v[48:51]
v_and_b32 v193,s42,v193
v_and_b32 v195,s42,v195
M v[48:51],a[200:203],a[212:215],v[48:51]
v_and_b32 v203,s42,v203
v_and_b32 v201,s42,v201
M v[52:55],a[200:203],a[232:235],v[52:55]
v_and_b32 v199,s42,v199
v_fmac_f32 v193,s43,v197
M v[52:55],a[220:223],a[212:215],v[52:55]
v_fmac_f32 v203,4.0,v195
v_fma_f32 v235,-4.0,v197,v201
M v[52:55],v[216:219],v[224:227],v[52:55]
v_fmac_f32 v193,s45,v201
v_fmac_f32 v203,s41,v199
M v[56:59],v[216:219],a[212:215],v[56:59]
v_sub_f32 v201,v201,v197
v_fma_f32 v197,-4.0,v195,v199
M v[56:59],a[220:223],a[232:235],v[56:59]
v_sub_f32 v199,v199,v195
v_add_f32 v195,v235,v197
M v[56:59],a[200:203],a[208:211],v[56:59]
v_sub_f32 v235,v235,v197
v_fma_f32 v197,2.0,v199,v201
M v[60:63],a[200:203],v[220:223],v[60:63]
buffer_load_dwordx4 a[200:203],v250,s[20:23],s47 offen offset:1024 sc1
M v[60:63],a[220:223],a[208:211],v[60:63]
v_fmac_f32 v201,-2.0,v199
v_cvt_pk_bf16_f32 v193,v232,v193
M v[60:63],v[216:219],a[232:235],v[60:63]
s_waitcnt vmcnt(12)
buffer_load_dwordx4 a[220:223],v250,s[20:23],s47 offen offset:2048 sc1
M v[64:67],a[228:231],a[192:195],v[64:67]
s_waitcnt vmcnt(12)
s_add_u32 s48,s76,43008
v_cvt_pk_bf16_f32 v203,v237,v203
v_cvt_pk_bf16_f32 v195,v233,v195
M v[64:67],a[196:199],a[236:239],v[64:67]
s_waitcnt vmcnt(11)
v_cvt_pk_bf16_f32 v199,v234,v197
v_cvt_pk_bf16_f32 v197,v238,v235
M v[64:67],a[224:227],a[244:247],v[64:67]
s_waitcnt vmcnt(8)
v_cvt_pk_bf16_f32 v201,v236,v201
v_lshlrev_b32 v234,16,v208
M v[68:71],a[224:227],a[204:207],v[68:71]
buffer_load_dwordx4 v[216:219],v250,s[20:23],s48 offen offset:0 sc1
M v[68:71],a[196:199],a[244:247],v[68:71]
v_lshlrev_b32 v232,16,v204
v_lshlrev_b32 v233,16,v206
M v[68:71],a[228:231],a[236:239],v[68:71]
ds_write2st64_b64 v247,v[192:193],v[202:203] offset0:138 offset1:155
M v[72:75],a[228:231],a[244:247],v[72:75]
s_waitcnt vmcnt(7)
v_lshlrev_b32 v237,16,v214
v_lshlrev_b32 v236,16,v212
M v[72:75],a[196:199],a[204:207],v[72:75]
buffer_load_dwordx4 a[192:195],v250,s[20:23],s48 offen offset:1024 sc1
M v[72:75],a[224:227],a[216:219],v[72:75]
ds_write2st64_b64 v247,v[194:195],v[196:197] offset0:2 offset1:19
M v[76:79],a[224:227],v[224:227],v[76:79]
v_lshlrev_b32 v235,16,v210
v_fmac_f32 v232,s43,v234
M v[76:79],a[196:199],a[216:219],v[76:79]
buffer_load_dwordx4 a[236:239],v250,s[20:23],s48 offen offset:2048 sc1
M v[76:79],a[228:231],a[204:207],v[76:79]
s_add_u32 s46,s77,9216
ds_write2st64_b64 v247,v[198:199],v[200:201] offset0:36 offset1:53
M v[80:83],a[228:231],a[216:219],v[80:83]
v_fmac_f32 v237,4.0,v233
v_fma_f32 v238,-4.0,v234,v236
M v[80:83],a[196:199],v[224:227],v[80:83]
buffer_load_dwordx4 a[244:247],v250,s[20:23],s46 offen offset:0 sc1
M v[80:83],a[224:227],a[212:215],v[80:83]
v_fmac_f32 v232,s45,v236
v_fmac_f32 v237,s41,v235
M v[84:87],a[224:227],a[232:235],v[84:87]
v_sub_f32 v236,v236,v234
v_fma_f32 v234,-4.0,v233,v235
M v[84:87],a[196:199],a[212:215],v[84:87]
ds_read_b128 a[204:207],v248 offset:26112
v_sub_f32 v235,v235,v233
M v[84:87],a[228:231],v[224:227],v[84:87]
ds_read_b128 a[216:219],v249 offset:26112
v_add_f32 v233,v238,v234
M v[88:91],a[228:231],a[212:215],v[88:91]
ds_read_b128 v[224:227],v248 offset:26624
v_sub_f32 v238,v238,v234
M v[88:91],a[196:199],a[232:235],v[88:91]
ds_read_b128 a[212:215],v249 offset:26624
v_fma_f32 v234,2.0,v235,v236
M v[88:91],a[224:227],a[208:211],v[88:91]
v_fmac_f32 v236,-2.0,v235
v_and_b32 v208,s42,v208
M v[92:95],a[224:227],v[220:223],v[92:95]
v_and_b32 v204,s42,v204
v_and_b32 v206,s42,v206
M v[92:95],a[196:199],a[208:211],v[92:95]
v_and_b32 v214,s42,v214
v_and_b32 v212,s42,v212
M v[92:95],a[228:231],a[232:235],v[92:95]
s_waitcnt lgkmcnt(3)
v_and_b32 v210,s42,v210
v_fmac_f32 v204,s43,v208
M v[96:99],v[228:231],a[204:207],v[96:99]
s_waitcnt vmcnt(8) lgkmcnt(2)
ds_read_b128 a[224:227],v248 offset:27136
v_fmac_f32 v214,4.0,v206
M v[96:99],a[240:243],a[216:219],v[96:99]
s_waitcnt vmcnt(7) lgkmcnt(2)
ds_read_b128 v[220:223],v249 offset:27136
v_fma_f32 v235,-4.0,v208,v212
M v[96:99],a[248:251],v[224:227],v[96:99]
s_waitcnt lgkmcnt(2)
v_fmac_f32 v204,s45,v212
v_fmac_f32 v214,s41,v210
M v[100:103],a[248:251],a[212:215],v[100:103]
v_sub_f32 v212,v212,v208
v_fma_f32 v208,-4.0,v206,v210
M v[100:103],a[240:243],v[224:227],v[100:103]
v_sub_f32 v210,v210,v206
v_add_f32 v206,v235,v208
M v[100:103],v[228:231],a[216:219],v[100:103]
v_sub_f32 v235,v235,v208
v_fma_f32 v208,2.0,v210,v212
M v[104:107],v[228:231],v[224:227],v[104:107]
ds_read_b128 a[196:199],v248 offset:27648
v_fmac_f32 v212,-2.0,v210
M v[104:107],a[240:243],a[212:215],v[104:107]
s_waitcnt lgkmcnt(2)
ds_read_b128 a[208:211],v249 offset:27648
v_cvt_pk_bf16_f32 v204,v232,v204
M v[104:107],a[248:251],a[224:227],v[104:107]
s_waitcnt lgkmcnt(2)
v_cvt_pk_bf16_f32 v214,v237,v214
v_cvt_pk_bf16_f32 v206,v233,v206
M v[108:111],a[248:251],v[220:223],v[108:111]
v_cvt_pk_bf16_f32 v210,v234,v208
v_cvt_pk_bf16_f32 v208,v238,v235
M v[108:111],a[240:243],a[224:227],v[108:111]
v_cvt_pk_bf16_f32 v212,v236,v212
v_lshlrev_b32 v234,16,v209
M v[108:111],v[228:231],a[212:215],v[108:111]
v_lshlrev_b32 v232,16,v205
v_lshlrev_b32 v233,16,v207
M v[112:115],v[228:231],a[224:227],v[112:115]
ds_read_b128 a[228:231],v249 offset:28160
v_lshlrev_b32 v237,16,v215
M v[112:115],a[240:243],v[220:223],v[112:115]
s_waitcnt lgkmcnt(2)
ds_read_b128 a[232:235],v248 offset:28160
v_lshlrev_b32 v236,16,v213
M v[112:115],a[248:251],a[196:199],v[112:115]
s_waitcnt lgkmcnt(2)
v_lshlrev_b32 v235,16,v211
v_fmac_f32 v232,s43,v234
M v[116:119],a[248:251],a[208:211],v[116:119]
v_fmac_f32 v237,4.0,v233
v_fma_f32 v238,-4.0,v234,v236
M v[116:119],a[240:243],a[196:199],v[116:119]
v_fmac_f32 v232,s45,v236
v_fmac_f32 v237,s41,v235
M v[116:119],v[228:231],v[220:223],v[116:119]
v_sub_f32 v236,v236,v234
v_fma_f32 v234,-4.0,v233,v235
M v[120:123],v[228:231],a[196:199],v[120:123]
v_sub_f32 v235,v235,v233
v_add_f32 v233,v238,v234
M v[120:123],a[240:243],a[208:211],v[120:123]
s_waitcnt lgkmcnt(1)
v_sub_f32 v238,v238,v234
v_fma_f32 v234,2.0,v235,v236
M v[120:123],a[248:251],a[228:231],v[120:123]
s_waitcnt lgkmcnt(0)
v_fmac_f32 v236,-2.0,v235
v_and_b32 v209,s42,v209
M v[124:127],a[248:251],a[232:235],v[124:127]
buffer_load_dwordx4 a[248:251],v250,s[20:23],s46 offen offset:1024 sc1
M v[124:127],a[240:243],a[228:231],v[124:127]
v_and_b32 v205,s42,v205
v_and_b32 v207,s42,v207
M v[124:127],v[228:231],a[208:211],v[124:127]
s_waitcnt vmcnt(7)
buffer_load_dwordx4 a[240:243],v250,s[20:23],s46 offen offset:2048 sc1
M v[128:131],a[252:255],a[204:207],v[128:131]
s_waitcnt vmcnt(7)
s_add_u32 s46,s77,18432
v_and_b32 v215,s42,v215
v_and_b32 v213,s42,v213
M v[128:131],a[200:203],a[216:219],v[128:131]
s_waitcnt vmcnt(6)
v_and_b32 v211,s42,v211
v_fmac_f32 v205,s43,v209
M v[128:131],a[220:223],v[224:227],v[128:131]
v_fmac_f32 v215,4.0,v207
v_fma_f32 v235,-4.0,v209,v213
M v[132:135],a[220:223],a[212:215],v[132:135]
buffer_load_dwordx4 v[228:231],v250,s[20:23],s46 offen offset:0 sc1
M v[132:135],a[200:203],v[224:227],v[132:135]
v_fmac_f32 v205,s45,v213
v_fmac_f32 v215,s41,v211
M v[132:135],a[252:255],a[216:219],v[132:135]
v_sub_f32 v213,v213,v209
v_fma_f32 v209,-4.0,v207,v211
M v[136:139],a[252:255],v[224:227],v[136:139]
v_sub_f32 v211,v211,v207
v_add_f32 v207,v235,v209
M v[136:139],a[200:203],a[212:215],v[136:139]
v_sub_f32 v235,v235,v209
v_fma_f32 v209,2.0,v211,v213
M v[136:139],a[220:223],a[224:227],v[136:139]
v_fmac_f32 v213,-2.0,v211
v_cvt_pk_bf16_f32 v205,v232,v205
M v[140:143],a[220:223],v[220:223],v[140:143]
v_cvt_pk_bf16_f32 v215,v237,v215
v_cvt_pk_bf16_f32 v207,v233,v207
M v[140:143],a[200:203],a[224:227],v[140:143]
v_cvt_pk_bf16_f32 v211,v234,v209
v_cvt_pk_bf16_f32 v209,v238,v235
M v[140:143],a[252:255],a[212:215],v[140:143]
v_cvt_pk_bf16_f32 v213,v236,v213
M v[144:147],a[252:255],a[224:227],v[144:147]
M v[144:147],a[200:203],v[220:223],v[144:147]
M v[144:147],a[220:223],a[196:199],v[144:147]
ds_write2st64_b64 v247,v[204:205],v[214:215] offset0:139 offset1:156
M v[148:151],a[220:223],a[208:211],v[148:151]
M v[148:151],a[200:203],a[196:199],v[148:151]
M v[148:151],a[252:255],v[220:223],v[148:151]
ds_write2st64_b64 v247,v[206:207],v[208:209] offset0:3 offset1:20
M v[152:155],a[252:255],a[196:199],v[152:155]
M v[152:155],a[200:203],a[208:211],v[152:155]
M v[152:155],a[220:223],a[228:231],v[152:155]
ds_write2st64_b64 v247,v[210:211],v[212:213] offset0:37 offset1:54
M v[156:159],a[220:223],a[232:235],v[156:159]
buffer_load_dwordx4 a[220:223],v250,s[20:23],s46 offen offset:1024 sc1
M v[156:159],a[200:203],a[228:231],v[156:159]
M v[156:159],a[252:255],a[208:211],v[156:159]
s_waitcnt vmcnt(7)
buffer_load_dwordx4 a[200:203],v250,s[20:23],s46 offen offset:2048 sc1
M v[160:163],v[216:219],a[204:207],v[160:163]
s_waitcnt vmcnt(7)
s_add_u32 s46,s77,27648
M v[160:163],a[192:195],a[216:219],v[160:163]
s_waitcnt vmcnt(6)
M v[160:163],a[236:239],v[224:227],v[160:163]
M v[164:167],a[236:239],a[212:215],v[164:167]
buffer_load_dwordx4 a[252:255],v250,s[20:23],s46 offen offset:0 sc1
M v[164:167],a[192:195],v[224:227],v[164:167]
M v[164:167],v[216:219],a[216:219],v[164:167]
M v[168:171],v[216:219],v[224:227],v[168:171]
M v[168:171],a[192:195],a[212:215],v[168:171]
buffer_load_dwordx4 a[204:207],v250,s[20:23],s46 offen offset:1024 sc1
M v[168:171],a[236:239],a[224:227],v[168:171]
M v[172:175],a[236:239],v[220:223],v[172:175]
M v[172:175],a[192:195],a[224:227],v[172:175]
M v[172:175],v[216:219],a[212:215],v[172:175]
buffer_load_dwordx4 a[216:219],v250,s[20:23],s46 offen offset:2048 sc1
M v[176:179],v[216:219],a[224:227],v[176:179]
s_add_u32 s46,s77,36864
M v[176:179],a[192:195],v[220:223],v[176:179]
v_add_u32 v248,0xffffbc00,v248
v_add_u32 v249,0xffffbc00,v249
M v[176:179],a[236:239],a[196:199],v[176:179]
s_waitcnt lgkmcnt(0)
s_barrier
M v[180:183],a[236:239],a[208:211],v[180:183]
buffer_load_dwordx4 v[224:227],v250,s[20:23],s46 offen offset:0 sc1
M v[180:183],a[192:195],a[196:199],v[180:183]
ds_read_b128 a[212:215],v248 offset:0
M v[180:183],v[216:219],v[220:223],v[180:183]
ds_read_b128 a[224:227],v249 offset:0
M v[184:187],v[216:219],a[196:199],v[184:187]
ds_read_b128 v[220:223],v248 offset:512
M v[184:187],a[192:195],a[208:211],v[184:187]
ds_read_b128 a[196:199],v249 offset:512
M v[184:187],a[236:239],a[228:231],v[184:187]
M v[188:191],a[236:239],a[232:235],v[188:191]
buffer_load_dwordx4 a[232:235],v250,s[20:23],s46 offen offset:1024 sc1
M v[188:191],a[192:195],a[228:231],v[188:191]
M v[188:191],v[216:219],a[208:211],v[188:191]
s_waitcnt vmcnt(10) lgkmcnt(3)
buffer_load_dwordx4 a[236:239],v250,s[20:23],s46 offen offset:2048 sc1
M a[0:3],a[244:247],a[212:215],a[0:3]
s_waitcnt vmcnt(10) lgkmcnt(2)
s_add_u32 s47,s77,12288
ds_read_b128 a[228:231],v248 offset:1024
M a[0:3],a[248:251],a[224:227],a[0:3]
s_waitcnt vmcnt(9) lgkmcnt(2)
ds_read_b128 a[208:211],v249 offset:1024
M a[0:3],a[240:243],v[220:223],a[0:3]
s_waitcnt lgkmcnt(2)
M a[4:7],a[240:243],a[196:199],a[4:7]
buffer_load_dwordx4 a[192:195],v250,s[20:23],s47 offen offset:0 sc1
M a[4:7],a[248:251],v[220:223],a[4:7]
M a[4:7],a[244:247],a[224:227],a[4:7]
M a[8:11],a[244:247],v[220:223],a[8:11]
ds_read_b128 v[216:219],v248 offset:1536
M a[8:11],a[248:251],a[196:199],a[8:11]
s_waitcnt lgkmcnt(2)
ds_read_b128 a[212:215],v249 offset:1536
M a[8:11],a[240:243],a[228:231],a[8:11]
s_waitcnt lgkmcnt(2)
M a[12:15],a[240:243],a[208:211],a[12:15]
M a[12:15],a[248:251],a[228:231],a[12:15]
M a[12:15],a[244:247],a[196:199],a[12:15]
M a[16:19],a[244:247],a[228:231],a[16:19]
ds_read_b128 a[224:227],v249 offset:2048
M a[16:19],a[248:251],a[208:211],a[16:19]
s_waitcnt lgkmcnt(2)
ds_read_b128 v[220:223],v248 offset:2048
M a[16:19],a[240:243],v[216:219],a[16:19]
s_waitcnt lgkmcnt(2)
M a[20:23],a[240:243],a[212:215],a[20:23]
M a[20:23],a[248:251],v[216:219],a[20:23]
ds_read_b128 a[196:199],v248 offset:8704
M a[20:23],a[244:247],a[208:211],a[20:23]
ds_read_b128 a[228:231],v249 offset:8704
M a[24:27],a[244:247],v[216:219],a[24:27]
ds_read_b128 a[208:211],v248 offset:9216
M a[24:27],a[248:251],a[212:215],a[24:27]
s_waitcnt lgkmcnt(4)
ds_read_b128 v[216:219],v249 offset:9216
M a[24:27],a[240:243],a[224:227],a[24:27]
s_waitcnt lgkmcnt(4)
M a[28:31],a[240:243],v[220:223],a[28:31]
buffer_load_dwordx4 a[240:243],v250,s[20:23],s47 offen offset:1024 sc1
M a[28:31],a[248:251],a[224:227],a[28:31]
M a[28:31],a[244:247],a[212:215],a[28:31]
s_waitcnt vmcnt(10) lgkmcnt(3)
buffer_load_dwordx4 v[220:223],v250,s[20:23],s47 offen offset:2048 sc1
M a[96:99],v[228:231],a[196:199],a[96:99]
s_waitcnt vmcnt(10) lgkmcnt(2)
s_add_u32 s48,s77,15360
ds_read_b128 a[248:251],v248 offset:9728
M a[96:99],a[220:223],a[228:231],a[96:99]
s_waitcnt vmcnt(9) lgkmcnt(2)
ds_read_b128 a[212:215],v249 offset:9728
M a[96:99],a[200:203],a[208:211],a[96:99]
s_waitcnt lgkmcnt(2)
M a[100:103],a[200:203],v[216:219],a[100:103]
buffer_load_dwordx4 a[224:227],v250,s[20:23],s48 offen offset:0 sc1
M a[100:103],a[220:223],a[208:211],a[100:103]
M a[100:103],v[228:231],a[228:231],a[100:103]
M a[104:107],v[228:231],a[208:211],a[104:107]
ds_read_b128 a[244:247],v248 offset:10240
M a[104:107],a[220:223],v[216:219],a[104:107]
s_waitcnt lgkmcnt(2)
ds_read_b128 a[196:199],v249 offset:10240
M a[104:107],a[200:203],a[248:251],a[104:107]
s_waitcnt lgkmcnt(2)
M a[108:111],a[200:203],a[212:215],a[108:111]
M a[108:111],a[220:223],a[248:251],a[108:111]
M a[108:111],v[228:231],v[216:219],a[108:111]
M a[112:115],v[228:231],a[248:251],a[112:115]
ds_read_b128 a[228:231],v249 offset:10752
M a[112:115],a[220:223],a[212:215],a[112:115]
s_waitcnt lgkmcnt(2)
ds_read_b128 a[208:211],v248 offset:10752
M a[112:115],a[200:203],a[244:247],a[112:115]
s_waitcnt lgkmcnt(2)
M a[116:119],a[200:203],a[196:199],a[116:119]
M a[116:119],a[220:223],a[244:247],a[116:119]
ds_read_b128 v[216:219],v248 offset:17408
M a[116:119],v[228:231],a[212:215],a[116:119]
ds_read_b128 a[248:251],v249 offset:17408
M a[120:123],v[228:231],a[244:247],a[120:123]
ds_read_b128 a[212:215],v248 offset:17920
M a[120:123],a[220:223],a[196:199],a[120:123]
s_waitcnt lgkmcnt(4)
ds_read_b128 a[244:247],v249 offset:17920
M a[120:123],a[200:203],a[228:231],a[120:123]
s_waitcnt lgkmcnt(4)
M a[124:127],a[200:203],a[208:211],a[124:127]
buffer_load_dwordx4 a[200:203],v250,s[20:23],s48 offen offset:1024 sc1
M a[124:127],a[220:223],a[228:231],a[124:127]
M a[124:127],v[228:231],a[196:199],a[124:127]
s_waitcnt vmcnt(10) lgkmcnt(3)
buffer_load_dwordx4 a[208:211],v250,s[20:23],s48 offen offset:2048 sc1
M v[0:3],a[252:255],v[216:219],v[0:3]
s_waitcnt vmcnt(10) lgkmcnt(2)
s_add_u32 s47,s77,21504
ds_read_b128 a[228:231],v248 offset:18432
M v[0:3],a[204:207],a[248:251],v[0:3]
s_waitcnt vmcnt(9) lgkmcnt(2)
ds_read_b128 a[196:199],v249 offset:18432
M v[0:3],a[216:219],a[212:215],v[0:3]
s_waitcnt lgkmcnt(2)
M v[4:7],a[216:219],a[244:247],v[4:7]
buffer_load_dwordx4 a[220:223],v250,s[20:23],s47 offen offset:0 sc1
M v[4:7],a[204:207],a[212:215],v[4:7]
M v[4:7],a[252:255],a[248:251],v[4:7]
M v[8:11],a[252:255],a[212:215],v[8:11]
ds_read_b128 v[228:231],v248 offset:18944
M v[8:11],a[204:207],a[244:247],v[8:11]
s_waitcnt lgkmcnt(2)
ds_read_b128 v[216:219],v249 offset:18944
M v[8:11],a[216:219],a[228:231],v[8:11]
s_waitcnt lgkmcnt(2)
M v[12:15],a[216:219],a[196:199],v[12:15]
M v[12:15],a[204:207],a[228:231],v[12:15]
M v[12:15],a[252:255],a[244:247],v[12:15]
M v[16:19],a[252:255],a[228:231],v[16:19]
ds_read_b128 a[248:251],v249 offset:19456
M v[16:19],a[204:207],a[196:199],v[16:19]
s_waitcnt lgkmcnt(2)
ds_read_b128 a[212:215],v248 offset:19456
M v[16:19],a[216:219],v[228:231],v[16:19]
s_waitcnt lgkmcnt(2)
M v[20:23],a[216:219],v[216:219],v[20:23]
M v[20:23],a[204:207],v[228:231],v[20:23]
ds_read_b128 a[244:247],v248 offset:26112
M v[20:23],a[252:255],a[196:199],v[20:23]
ds_read_b128 a[228:231],v249 offset:26112
M v[24:27],a[252:255],v[228:231],v[24:27]
ds_read_b128 a[196:199],v248 offset:26624
M v[24:27],a[204:207],v[216:219],v[24:27]
s_waitcnt lgkmcnt(4)
ds_read_b128 v[228:231],v249 offset:26624
M v[24:27],a[216:219],a[248:251],v[24:27]
s_waitcnt lgkmcnt(4)
M v[28:31],a[216:219],a[212:215],v[28:31]
buffer_load_dwordx4 a[212:215],v250,s[20:23],s47 offen offset:1024 sc1
M v[28:31],a[204:207],a[248:251],v[28:31]
M v[28:31],a[252:255],v[216:219],v[28:31]
s_waitcnt vmcnt(10) lgkmcnt(3)
buffer_load_dwordx4 a[216:219],v250,s[20:23],s47 offen offset:2048 sc1
M v[96:99],v[224:227],a[244:247],v[96:99]
s_waitcnt vmcnt(10) lgkmcnt(2)
s_add_u32 s48,s77,24576
ds_read_b128 a[248:251],v248 offset:27136
M v[96:99],a[232:235],a[228:231],v[96:99]
s_waitcnt vmcnt(9) lgkmcnt(2)
ds_read_b128 a[252:255],v249 offset:27136
M v[96:99],a[236:239],a[196:199],v[96:99]
s_waitcnt lgkmcnt(2)
M v[100:103],a[236:239],v[228:231],v[100:103]
buffer_load_dwordx4 a[204:207],v250,s[20:23],s48 offen offset:0 sc1
M v[100:103],a[232:235],a[196:199],v[100:103]
M v[100:103],v[224:227],a[228:231],v[100:103]
v_accvgpr_read_b32 v238,a0
v_accvgpr_read_b32 v232,a96
M v[104:107],v[224:227],a[196:199],v[104:107]
ds_read_b128 v[216:219],v248 offset:27648
v_add_f32 v234,v238,v232
M v[104:107],a[232:235],v[228:231],v[104:107]
s_waitcnt lgkmcnt(2)
ds_read_b128 a[244:247],v249 offset:27648
v_sub_f32 v238,v238,v232
M v[104:107],a[236:239],a[248:251],v[104:107]
s_waitcnt lgkmcnt(2)
v_add_f32 v232,v0,v96
v_sub_f32 v96,v0,v96
M v[108:111],a[236:239],a[252:255],v[108:111]
v_add_f32 v0,v234,v232
v_fmac_f32 v234,4.0,v232
M v[108:111],a[232:235],a[248:251],v[108:111]
v_fma_f32 v232,2.0,v96,v238
v_fma_f32 v96,s40,v96,v238
M v[108:111],v[224:227],v[228:231],v[108:111]
v_accvgpr_read_b32 v238,a1
v_accvgpr_read_b32 v237,a97
M v[112:115],v[224:227],a[248:251],v[112:115]
ds_read_b128 a[228:231],v249 offset:28160
v_add_f32 v236,v238,v237
M v[112:115],a[232:235],a[252:255],v[112:115]
s_waitcnt lgkmcnt(2)
ds_read_b128 a[196:199],v248 offset:28160
v_sub_f32 v238,v238,v237
M v[112:115],a[236:239],v[216:219],v[112:115]
s_waitcnt lgkmcnt(2)
v_add_f32 v237,v1,v97
v_sub_f32 v97,v1,v97
M v[116:119],a[236:239],a[244:247],v[116:119]
v_add_f32 v1,v236,v237
v_fmac_f32 v236,4.0,v237
M v[116:119],a[232:235],v[216:219],v[116:119]
ds_read_b128 v[228:231],v248 offset:0
v_fma_f32 v237,2.0,v97,v238
M v[116:119],v[224:227],a[252:255],v[116:119]
ds_read_b128 a[248:251],v249 offset:0
v_fma_f32 v97,s40,v97,v238
M v[120:123],v[224:227],v[216:219],v[120:123]
ds_read_b128 a[252:255],v248 offset:512
v_cvt_pk_bf16_f32 v232,v232,v237
M v[120:123],a[232:235],a[244:247],v[120:123]
s_waitcnt lgkmcnt(4)
ds_read_b128 v[216:219],v249 offset:512
v_cvt_pk_bf16_f32 v234,v234,v236
M v[120:123],a[236:239],a[228:231],v[120:123]
s_waitcnt lgkmcnt(4)
v_accvgpr_read_b32 v238,a2
v_accvgpr_read_b32 v233,a98
M v[124:127],a[236:239],a[196:199],v[124:127]
buffer_load_dwordx4 a[196:199],v250,s[20:23],s48 offen offset:1024 sc1
M v[124:127],a[232:235],a[228:231],v[124:127]
v_add_f32 v235,v238,v233
v_sub_f32 v238,v238,v233
M v[124:127],v[224:227],a[244:247],v[124:127]
s_waitcnt vmcnt(10) lgkmcnt(3)
v_add_f32 v233,v2,v98
v_sub_f32 v98,v2,v98
M a[32:35],a[192:195],v[228:231],a[32:35]
s_waitcnt vmcnt(9) lgkmcnt(2)
ds_read_b128 a[236:239],v248 offset:1024
v_add_f32 v2,v235,v233
M a[32:35],a[240:243],a[248:251],a[32:35]
s_waitcnt vmcnt(8) lgkmcnt(2)
ds_read_b128 a[228:231],v249 offset:1024
v_fmac_f32 v235,4.0,v233
M a[32:35],v[220:223],a[252:255],a[32:35]
s_waitcnt lgkmcnt(2)
v_fma_f32 v233,2.0,v98,v238
v_fma_f32 v98,s40,v98,v238
M a[36:39],v[220:223],v[216:219],a[36:39]
v_accvgpr_read_b32 v238,a3
v_accvgpr_read_b32 v237,a99
M a[36:39],a[240:243],a[252:255],a[36:39]
v_add_f32 v236,v238,v237
v_sub_f32 v238,v238,v237
M a[36:39],a[192:195],a[248:251],a[36:39]
v_add_f32 v237,v3,v99
v_sub_f32 v99,v3,v99
M a[40:43],a[192:195],a[252:255],a[40:43]
ds_read_b128 a[96:99],v248 offset:1536
v_add_f32 v3,v236,v237
M a[40:43],a[240:243],v[216:219],a[40:43]
s_waitcnt lgkmcnt(2)
ds_read_b128 a[232:235],v249 offset:1536
v_fmac_f32 v236,4.0,v237
M a[40:43],v[220:223],a[236:239],a[40:43]
s_waitcnt lgkmcnt(2)
v_fma_f32 v237,2.0,v99,v238
v_fma_f32 v99,s40,v99,v238
M a[44:47],v[220:223],a[228:231],a[44:47]
v_cvt_pk_bf16_f32 v233,v233,v237
v_cvt_pk_bf16_f32 v235,v235,v236
M a[44:47],a[240:243],a[236:239],a[44:47]
ds_write2st64_b64 v254,v[232:233],v[234:235] offset0:68 offset1:72
M a[44:47],a[192:195],v[216:219],a[44:47]
v_accvgpr_read_b32 v238,a4
v_accvgpr_read_b32 v232,a100
M a[48:51],a[192:195],a[236:239],a[48:51]
ds_read_b128 a[244:247],v249 offset:2048
v_add_f32 v234,v238,v232
M a[48:51],a[240:243],a[228:231],a[48:51]
s_waitcnt lgkmcnt(3)
ds_read_b128 v[224:227],v248 offset:2048
v_sub_f32 v238,v238,v232
M a[48:51],v[220:223],a[96:99],a[48:51]
s_waitcnt lgkmcnt(3)
v_add_f32 v232,v4,v100
v_sub_f32 v100,v4,v100
M a[52:55],v[220:223],a[232:235],a[52:55]
v_add_f32 v4,v234,v232
v_fmac_f32 v234,4.0,v232
M a[52:55],a[240:243],a[96:99],a[52:55]
v_fma_f32 v232,2.0,v100,v238
v_fma_f32 v100,s40,v100,v238
M a[52:55],a[192:195],a[228:231],a[52:55]
v_accvgpr_read_b32 v238,a5
v_accvgpr_read_b32 v237,a101
M a[56:59],a[192:195],a[96:99],a[56:59]
v_add_f32 v236,v238,v237
v_sub_f32 v238,v238,v237
M a[56:59],a[240:243],a[232:235],a[56:59]
s_waitcnt lgkmcnt(1)
v_add_f32 v237,v5,v101
v_sub_f32 v101,v5,v101
M a[56:59],v[220:223],a[244:247],a[56:59]
s_waitcnt lgkmcnt(0)
v_add_f32 v5,v236,v237
v_fmac_f32 v236,4.0,v237
M a[60:63],v[220:223],v[224:227],a[60:63]
buffer_load_dwordx4 v[220:223],v250,s[20:23],s48 offen offset:2048 sc1
M a[60:63],a[240:243],a[244:247],a[60:63]
s_add_u32 s47,s77,30720
v_fma_f32 v237,2.0,v101,v238
v_fma_f32 v101,s40,v101,v238
M a[60:63],a[192:195],a[232:235],a[60:63]
s_waitcnt vmcnt(8)
buffer_load_dwordx4 a[240:243],v250,s[20:23],s47 offen offset:0 sc1
M a[64:67],a[224:227],v[228:231],a[64:67]
s_waitcnt vmcnt(8)
v_cvt_pk_bf16_f32 v232,v232,v237
v_cvt_pk_bf16_f32 v234,v234,v236
M a[64:67],a[200:203],a[248:251],a[64:67]
s_waitcnt vmcnt(7)
v_accvgpr_read_b32 v238,a6
v_accvgpr_read_b32 v233,a102
M a[64:67],a[208:211],a[252:255],a[64:67]
v_add_f32 v235,v238,v233
v_sub_f32 v238,v238,v233
M a[68:71],a[208:211],v[216:219],a[68:71]
buffer_load_dwordx4 a[192:195],v250,s[20:23],s47 offen offset:1024 sc1
M a[68:71],a[200:203],a[252:255],a[68:71]
v_add_f32 v233,v6,v102
v_sub_f32 v102,v6,v102
M a[68:71],a[224:227],a[248:251],a[68:71]
v_add_f32 v6,v235,v233
v_fmac_f32 v235,4.0,v233
M a[72:75],a[224:227],a[252:255],a[72:75]
v_fma_f32 v233,2.0,v102,v238
v_fma_f32 v102,s40,v102,v238
M a[72:75],a[200:203],v[216:219],a[72:75]
buffer_load_dwordx4 v[228:231],v250,s[20:23],s47 offen offset:2048 sc1
M a[72:75],a[208:211],a[236:239],a[72:75]
s_add_u32 s48,s77,33792
v_accvgpr_read_b32 v238,a7
v_accvgpr_read_b32 v237,a103
M a[76:79],a[208:211],a[228:231],a[76:79]
v_add_f32 v236,v238,v237
v_sub_f32 v238,v238,v237
M a[76:79],a[200:203],a[236:239],a[76:79]
v_add_f32 v237,v7,v103
v_sub_f32 v103,v7,v103
M a[76:79],a[224:227],v[216:219],a[76:79]
buffer_load_dwordx4 a[248:251],v250,s[20:23],s48 offen offset:0 sc1
M a[80:83],a[224:227],a[236:239],a[80:83]
v_add_f32 v7,v236,v237
v_fmac_f32 v236,4.0,v237
M a[80:83],a[200:203],a[228:231],a[80:83]
v_fma_f32 v237,2.0,v103,v238
v_fma_f32 v103,s40,v103,v238
M a[80:83],a[208:211],a[96:99],a[80:83]
v_cvt_pk_bf16_f32 v233,v233,v237
v_cvt_pk_bf16_f32 v235,v235,v236
M a[84:87],a[208:211],a[232:235],a[84:87]
buffer_load_dwordx4 a[252:255],v250,s[20:23],s48 offen offset:1024 sc1
M a[84:87],a[200:203],a[96:99],a[84:87]
ds_read_b128 v[216:219],v248 offset:8704
ds_write2st64_b64 v254,v[232:233],v[234:235] offset0:76 offset1:80
M a[84:87],a[224:227],a[228:231],a[84:87]
ds_read_b128 a[236:239],v249 offset:8704
v_accvgpr_read_b32 v238,a8
M a[88:91],a[224:227],a[96:99],a[88:91]
buffer_load_dwordx4 a[100:103],v250,s[20:23],s48 offen offset:2048 sc1
M a[88:91],a[200:203],a[232:235],a[88:91]
ds_read_b128 a[96:99],v248 offset:9216
ds_read_b128 a[228:231],v249 offset:9216
M a[88:91],a[208:211],a[244:247],a[88:91]
v_accvgpr_read_b32 v232,a104
v_add_f32 v234,v238,v232
M a[92:95],a[208:211],v[224:227],a[92:95]
v_sub_f32 v238,v238,v232
v_add_f32 v232,v8,v104
M a[92:95],a[200:203],a[244:247],a[92:95]
v_sub_f32 v104,v8,v104
v_add_f32 v8,v234,v232
M a[92:95],a[224:227],a[232:235],a[92:95]
s_waitcnt vmcnt(11) lgkmcnt(4)
v_fmac_f32 v234,4.0,v232
v_fma_f32 v232,2.0,v104,v238
M a[128:131],a[220:223],v[216:219],a[128:131]
s_waitcnt vmcnt(10) lgkmcnt(2)
ds_read_b128 a[208:211],v248 offset:9728
v_fma_f32 v104,s40,v104,v238
M a[128:131],a[212:215],a[236:239],a[128:131]
s_waitcnt vmcnt(9) lgkmcnt(2)
s_barrier
ds_read_b128 a[0:3],v250 offset:34816
M a[128:131],a[216:219],a[96:99],a[128:131]
s_waitcnt lgkmcnt(2)
ds_read_b128 a[4:7],v250 offset:38912
ds_read_b128 v[224:227],v249 offset:9728
M a[132:135],a[216:219],a[228:231],a[132:135]
v_accvgpr_read_b32 v238,a9
v_accvgpr_read_b32 v237,a105
M a[132:135],a[212:215],a[96:99],a[132:135]
v_add_f32 v236,v238,v237
v_sub_f32 v238,v238,v237
M a[132:135],a[220:223],a[236:239],a[132:135]
v_add_f32 v237,v9,v105
v_sub_f32 v105,v9,v105
M a[136:139],a[220:223],a[96:99],a[136:139]
s_add_u32 s34,s32,6291456
ds_read_b128 a[200:203],v248 offset:10240
v_add_f32 v9,v236,v237
M a[136:139],a[212:215],a[228:231],a[136:139]
s_waitcnt lgkmcnt(4)
ds_read_b128 a[244:247],v249 offset:10240
v_fmac_f32 v236,4.0,v237
M a[136:139],a[216:219],a[208:211],a[136:139]
s_waitcnt lgkmcnt(2)
buffer_store_dwordx4 a[0:3],v253,s[24:27],s34 offen offset:384 nt
M a[140:143],a[216:219],v[224:227],a[140:143]
v_fma_f32 v237,2.0,v105,v238
v_fma_f32 v105,s40,v105,v238
M a[140:143],a[212:215],a[208:211],a[140:143]
v_cvt_pk_bf16_f32 v232,v232,v237
v_cvt_pk_bf16_f32 v234,v234,v236
M a[140:143],a[220:223],a[228:231],a[140:143]
v_accvgpr_read_b32 v238,a10
v_accvgpr_read_b32 v233,a106
M a[144:147],a[220:223],a[208:211],a[144:147]
ds_read_b128 a[224:227],v249 offset:10752
v_add_f32 v235,v238,v233
M a[144:147],a[212:215],v[224:227],a[144:147]
s_waitcnt lgkmcnt(2)
ds_read_b128 a[232:235],v248 offset:10752
v_sub_f32 v238,v238,v233
M a[144:147],a[216:219],a[200:203],a[144:147]
s_waitcnt lgkmcnt(2)
v_add_f32 v233,v10,v106
v_sub_f32 v106,v10,v106
M a[148:151],a[216:219],a[244:247],a[148:151]
s_add_u32 s47,s77,39936
v_add_f32 v10,v235,v233
v_fmac_f32 v235,4.0,v233
M a[148:151],a[212:215],a[200:203],a[148:151]
v_fma_f32 v233,2.0,v106,v238
v_fma_f32 v106,s40,v106,v238
M a[148:151],a[220:223],v[224:227],a[148:151]
v_accvgpr_read_b32 v238,a11
v_accvgpr_read_b32 v237,a107
M a[152:155],a[220:223],a[200:203],a[152:155]
v_add_f32 v236,v238,v237
v_sub_f32 v238,v238,v237
M a[152:155],a[212:215],a[244:247],a[152:155]
s_waitcnt lgkmcnt(1)
v_add_f32 v237,v11,v107
v_sub_f32 v107,v11,v107
M a[152:155],a[216:219],a[224:227],a[152:155]
s_waitcnt lgkmcnt(0)
v_add_f32 v11,v236,v237
v_fmac_f32 v236,4.0,v237
M a[156:159],a[216:219],a[232:235],a[156:159]
buffer_load_dwordx4 a[104:107],v250,s[20:23],s47 offen offset:0 sc1
M a[156:159],a[212:215],a[224:227],a[156:159]
v_fma_f32 v237,2.0,v107,v238
v_fma_f32 v107,s40,v107,v238
M a[156:159],a[220:223],a[244:247],a[156:159]
s_waitcnt vmcnt(10)
buffer_load_dwordx4 a[216:219],v250,s[20:23],s47 offen offset:1024 sc1
M a[160:163],a[204:207],v[216:219],a[160:163]
s_waitcnt vmcnt(10)
v_cvt_pk_bf16_f32 v233,v233,v237
v_cvt_pk_bf16_f32 v235,v235,v236
M a[160:163],a[196:199],a[236:239],a[160:163]
s_waitcnt vmcnt(9)
ds_write2st64_b64 v254,v[232:233],v[234:235] offset0:85 offset1:89
M a[160:163],v[220:223],a[96:99],a[160:163]
v_accvgpr_read_b32 v204,a12
v_accvgpr_read_b32 v208,a108
M a[164:167],v[220:223],a[228:231],a[164:167]
buffer_load_dwordx4 a[212:215],v250,s[20:23],s47 offen offset:2048 sc1
M a[164:167],a[196:199],a[96:99],a[164:167]
s_add_u32 s48,s77,43008
s_add_u32 s34,s32,6488064
v_accvgpr_read_b32 v205,a13
M a[164:167],a[204:207],a[236:239],a[164:167]
v_accvgpr_read_b32 v209,a109
v_accvgpr_read_b32 v206,a14
M a[168:171],a[204:207],a[96:99],a[168:171]
v_accvgpr_read_b32 v210,a110
v_accvgpr_read_b32 v207,a15
v_accvgpr_read_b32 v211,a111
v_pk_add_f32 v[212:213],v[204:205],v[208:209]
v_pk_add_f32 v[214:215],v[206:207],v[210:211]
v_pk_add_f32 v[204:205],v[204:205],v[208:209] neg_lo:[0,1] neg_hi:[0,1]
v_pk_add_f32 v[206:207],v[206:207],v[210:211] neg_lo:[0,1] neg_hi:[0,1]
v_pk_add_f32 v[208:209],v[12:13],v[108:109]
v_pk_add_f32 v[210:211],v[14:15],v[110:111]
v_pk_add_f32 v[108:109],v[12:13],v[108:109] neg_lo:[0,1] neg_hi:[0,1]
v_pk_add_f32 v[110:111],v[14:15],v[110:111] neg_lo:[0,1] neg_hi:[0,1]
v_pk_add_f32 v[12:13],v[212:213],v[208:209]
v_pk_add_f32 v[14:15],v[214:215],v[210:211]
v_pk_fma_f32 v[212:213],v[208:209],4.0,v[212:213] op_sel_hi:[1,0,1]
v_pk_fma_f32 v[214:215],v[210:211],4.0,v[214:215] op_sel_hi:[1,0,1]
v_pk_fma_f32 v[208:209],v[108:109],2.0,v[204:205] op_sel_hi:[1,0,1]
v_pk_fma_f32 v[210:211],v[110:111],2.0,v[206:207] op_sel_hi:[1,0,1]
v_pk_fma_f32 v[108:109],v[108:109],s[40:41],v[204:205] op_sel_hi:[1,0,1]
v_pk_fma_f32 v[110:111],v[110:111],s[40:41],v[206:207] op_sel_hi:[1,0,1]
M a[168:171],a[196:199],a[228:231],a[168:171]
buffer_load_dwordx4 a[220:223],v250,s[20:23],s48 offen offset:0 sc1
M a[168:171],v[220:223],a[208:211],a[168:171]
v_cvt_pk_bf16_f32 v208,v208,v209
v_cvt_pk_bf16_f32 v209,v210,v211
M a[172:175],v[220:223],v[224:227],a[172:175]
buffer_load_dwordx4 v[216:219],v250,s[20:23],s48 offen offset:1024 sc1
M a[172:175],a[196:199],a[208:211],a[172:175]
v_cvt_pk_bf16_f32 v212,v212,v213
v_cvt_pk_bf16_f32 v213,v214,v215
M a[172:175],a[204:207],a[228:231],a[172:175]
ds_write2st64_b64 v254,v[208:209],v[212:213] offset0:93 offset1:97
M a[176:179],a[204:207],a[208:211],a[176:179]
v_accvgpr_read_b32 v238,a16
v_accvgpr_read_b32 v232,a112
M a[176:179],a[196:199],v[224:227],a[176:179]
buffer_load_dwordx4 a[236:239],v250,s[20:23],s48 offen offset:2048 sc1
M a[176:179],v[220:223],a[200:203],a[176:179]
s_add_u32 s46,s72,0
v_add_f32 v234,v238,v232
v_sub_f32 v238,v238,v232
M a[180:183],v[220:223],a[244:247],a[180:183]
v_add_f32 v232,v16,v112
v_sub_f32 v112,v16,v112
M a[180:183],a[196:199],a[200:203],a[180:183]
ds_read_b128 a[228:231],v248 offset:17408
v_add_f32 v16,v234,v232
M a[180:183],a[204:207],v[224:227],a[180:183]
buffer_store_dwordx4 a[4:7],v253,s[24:27],s34 offen offset:384 nt
M a[184:187],a[204:207],a[200:203],a[184:187]
ds_read_b128 a[208:211],v249 offset:17408
ds_read_b128 v[224:227],v248 offset:17920
M a[184:187],a[196:199],a[244:247],a[184:187]
ds_read_b128 a[200:203],v249 offset:17920
v_fmac_f32 v234,4.0,v232
M a[184:187],v[220:223],a[224:227],a[184:187]
buffer_load_dwordx4 a[96:99],v250,s[20:23],s46 offen offset:0 sc1
M a[188:191],v[220:223],a[232:235],a[188:191]
v_fma_f32 v232,2.0,v112,v238
v_fma_f32 v112,s40,v112,v238
M a[188:191],a[196:199],a[224:227],a[188:191]
s_waitcnt lgkmcnt(4)
s_barrier
ds_read_b128 a[8:11],v250 offset:43520
M a[188:191],a[204:207],a[244:247],a[188:191]
s_waitcnt vmcnt(14) lgkmcnt(4)
ds_read_b128 a[12:15],v250 offset:47616
v_accvgpr_read_b32 v238,a17
M v[32:35],a[240:243],a[228:231],v[32:35]
s_waitcnt vmcnt(13) lgkmcnt(4)
buffer_load_dwordx4 a[108:111],v250,s[20:23],s46 offen offset:1024 sc1
M v[32:35],a[192:195],a[208:211],v[32:35]
s_waitcnt vmcnt(13) lgkmcnt(3)
ds_read_b128 a[232:235],v248 offset:18432
ds_read_b128 v[220:223],v249 offset:18432
M v[32:35],v[228:231],v[224:227],v[32:35]
s_waitcnt lgkmcnt(4)
v_accvgpr_read_b32 v237,a113
v_add_f32 v236,v238,v237
M v[36:39],v[228:231],a[200:203],v[36:39]
s_add_u32 s34,s32,6684672
v_sub_f32 v238,v238,v237
v_add_f32 v237,v17,v113
M v[36:39],a[192:195],v[224:227],v[36:39]
v_sub_f32 v113,v17,v113
v_add_f32 v17,v236,v237
M v[36:39],a[240:243],a[208:211],v[36:39]
s_waitcnt lgkmcnt(3)
buffer_store_dwordx4 a[8:11],v253,s[24:27],s34 offen offset:384 nt
M v[40:43],a[240:243],v[224:227],v[40:43]
ds_read_b128 a[196:199],v248 offset:18944
v_fmac_f32 v236,4.0,v237
M v[40:43],a[192:195],a[200:203],v[40:43]
s_waitcnt lgkmcnt(2)
ds_read_b128 a[224:227],v249 offset:18944
v_fma_f32 v237,2.0,v113,v238
M v[40:43],v[228:231],a[232:235],v[40:43]
s_waitcnt lgkmcnt(2)
v_fma_f32 v113,s40,v113,v238
v_cvt_pk_bf16_f32 v232,v232,v237
M v[44:47],v[228:231],v[220:223],v[44:47]
v_cvt_pk_bf16_f32 v234,v234,v236
v_accvgpr_read_b32 v238,a18
M v[44:47],a[192:195],a[232:235],v[44:47]
v_accvgpr_read_b32 v233,a114
v_add_f32 v235,v238,v233
M v[44:47],a[240:243],a[200:203],v[44:47]
v_sub_f32 v238,v238,v233
v_add_f32 v233,v18,v114
M v[48:51],a[240:243],a[232:235],v[48:51]
ds_read_b128 a[204:207],v249 offset:19456
v_sub_f32 v114,v18,v114
M v[48:51],a[192:195],v[220:223],v[48:51]
s_waitcnt lgkmcnt(2)
ds_read_b128 a[244:247],v248 offset:19456
v_add_f32 v18,v235,v233
M v[48:51],v[228:231],a[196:199],v[48:51]
s_waitcnt lgkmcnt(2)
v_fmac_f32 v235,4.0,v233
v_fma_f32 v233,2.0,v114,v238
M v[52:55],v[228:231],a[224:227],v[52:55]
v_fma_f32 v114,s40,v114,v238
v_accvgpr_read_b32 v238,a19
M v[52:55],a[192:195],a[196:199],v[52:55]
v_accvgpr_read_b32 v237,a115
v_add_f32 v236,v238,v237
M v[52:55],a[240:243],v[220:223],v[52:55]
v_sub_f32 v238,v238,v237
v_add_f32 v237,v19,v115
M v[56:59],a[240:243],a[196:199],v[56:59]
v_sub_f32 v115,v19,v115
v_add_f32 v19,v236,v237
M v[56:59],a[192:195],a[224:227],v[56:59]
s_waitcnt lgkmcnt(1)
v_fmac_f32 v236,4.0,v237
v_fma_f32 v237,2.0,v115,v238
M v[56:59],v[228:231],a[204:207],v[56:59]
s_waitcnt lgkmcnt(0)
v_fma_f32 v115,s40,v115,v238
v_cvt_pk_bf16_f32 v233,v233,v237
M v[60:63],v[228:231],a[244:247],v[60:63]
buffer_load_dwordx4 a[112:115],v250,s[20:23],s46 offen offset:2048 sc1
M v[60:63],a[192:195],a[204:207],v[60:63]
s_add_u32 s46,s73,0
v_cvt_pk_bf16_f32 v235,v235,v236
M v[60:63],a[240:243],a[224:227],v[60:63]
s_waitcnt vmcnt(14)
buffer_load_dwordx4 v[228:231],v250,s[20:23],s46 offen offset:0 sc1
M v[64:67],a[248:251],a[228:231],v[64:67]
s_waitcnt vmcnt(14)
s_add_u32 s34,s32,6881280
ds_write2st64_b64 v254,v[232:233],v[234:235] offset0:68 offset1:72
M v[64:67],a[252:255],a[208:211],v[64:67]
s_waitcnt vmcnt(13)
v_accvgpr_read_b32 v238,a20
v_accvgpr_read_b32 v232,a116
M v[64:67],a[100:103],v[224:227],v[64:67]
v_add_f32 v234,v238,v232
v_sub_f32 v238,v238,v232
M v[68:71],a[100:103],a[200:203],v[68:71]
buffer_load_dwordx4 a[192:195],v250,s[20:23],s46 offen offset:1024 sc1
M v[68:71],a[252:255],v[224:227],v[68:71]
v_add_f32 v232,v20,v116
v_sub_f32 v116,v20,v116
M v[68:71],a[248:251],a[208:211],v[68:71]
v_add_f32 v20,v234,v232
v_fmac_f32 v234,4.0,v232
M v[72:75],a[248:251],v[224:227],v[72:75]
v_fma_f32 v232,2.0,v116,v238
v_fma_f32 v116,s40,v116,v238
M v[72:75],a[252:255],a[200:203],v[72:75]
buffer_load_dwordx4 a[240:243],v250,s[20:23],s46 offen offset:2048 sc1
M v[72:75],a[100:103],a[232:235],v[72:75]
s_add_u32 s46,s74,0
v_accvgpr_read_b32 v238,a21
v_accvgpr_read_b32 v237,a117
M v[76:79],a[100:103],v[220:223],v[76:79]
v_add_f32 v236,v238,v237
v_sub_f32 v238,v238,v237
M v[76:79],a[252:255],a[232:235],v[76:79]
v_add_f32 v237,v21,v117
v_sub_f32 v117,v21,v117
M v[76:79],a[248:251],a[200:203],v[76:79]
buffer_store_dwordx4 a[12:15],v253,s[24:27],s34 offen offset:384 nt
M v[80:83],a[248:251],a[232:235],v[80:83]
v_add_f32 v21,v236,v237
v_fmac_f32 v236,4.0,v237
M v[80:83],a[252:255],v[220:223],v[80:83]
v_fma_f32 v237,2.0,v117,v238
v_fma_f32 v117,s40,v117,v238
M v[80:83],a[100:103],a[196:199],v[80:83]
buffer_load_dwordx4 a[228:231],v250,s[20:23],s46 offen offset:0 sc1
M v[84:87],a[100:103],a[224:227],v[84:87]
v_cvt_pk_bf16_f32 v232,v232,v237
v_cvt_pk_bf16_f32 v234,v234,v236
M v[84:87],a[252:255],a[196:199],v[84:87]
ds_read_b128 a[200:203],v248 offset:26112
v_accvgpr_read_b32 v238,a22
M v[84:87],a[248:251],v[220:223],v[84:87]
ds_read_b128 a[232:235],v249 offset:26112
v_accvgpr_read_b32 v233,a118
M v[88:91],a[248:251],a[196:199],v[88:91]
buffer_load_dwordx4 a[208:211],v250,s[20:23],s46 offen offset:1024 sc1
M v[88:91],a[252:255],a[224:227],v[88:91]
ds_read_b128 v[220:223],v248 offset:26624
ds_read_b128 a[196:199],v249 offset:26624
M v[88:91],a[100:103],a[204:207],v[88:91]
v_add_f32 v235,v238,v233
v_sub_f32 v238,v238,v233
M v[92:95],a[100:103],a[244:247],v[92:95]
v_add_f32 v233,v22,v118
v_sub_f32 v118,v22,v118
M v[92:95],a[252:255],a[204:207],v[92:95]
buffer_load_dwordx4 v[224:227],v250,s[20:23],s46 offen offset:2048 sc1
M v[92:95],a[248:251],a[224:227],v[92:95]
s_waitcnt vmcnt(17) lgkmcnt(3)
s_add_u32 s46,s75,0
v_add_f32 v22,v235,v233
v_fmac_f32 v235,4.0,v233
M v[128:131],a[104:107],a[200:203],v[128:131]
s_waitcnt vmcnt(16) lgkmcnt(2)
ds_read_b128 a[244:247],v248 offset:27136
v_fma_f32 v233,2.0,v118,v238
M v[128:131],a[216:219],a[232:235],v[128:131]
s_waitcnt vmcnt(15) lgkmcnt(2)
ds_read_b128 a[204:207],v249 offset:27136
v_fma_f32 v118,s40,v118,v238
M v[128:131],a[212:215],v[220:223],v[128:131]
s_waitcnt lgkmcnt(2)
buffer_load_dwordx4 a[100:103],v250,s[20:23],s46 offen offset:0 sc1
M v[132:135],a[212:215],a[196:199],v[132:135]
v_accvgpr_read_b32 v238,a23
v_accvgpr_read_b32 v237,a119
M v[132:135],a[216:219],v[220:223],v[132:135]
v_add_f32 v236,v238,v237
v_sub_f32 v238,v238,v237
M v[132:135],a[104:107],a[232:235],v[132:135]
v_add_f32 v237,v23,v119
v_sub_f32 v119,v23,v119
M v[136:139],a[104:107],v[220:223],v[136:139]
ds_read_b128 a[116:119],v248 offset:27648
v_add_f32 v23,v236,v237
M v[136:139],a[216:219],a[196:199],v[136:139]
s_waitcnt lgkmcnt(2)
ds_read_b128 a[252:255],v249 offset:27648
v_fmac_f32 v236,4.0,v237
M v[136:139],a[212:215],a[244:247],v[136:139]
s_waitcnt lgkmcnt(2)
v_fma_f32 v237,2.0,v119,v238
v_fma_f32 v119,s40,v119,v238
M v[140:143],a[212:215],a[204:207],v[140:143]
v_cvt_pk_bf16_f32 v233,v233,v237
v_cvt_pk_bf16_f32 v235,v235,v236
M v[140:143],a[216:219],a[244:247],v[140:143]
ds_write2st64_b64 v254,v[232:233],v[234:235] offset0:76 offset1:80
M v[140:143],a[104:107],a[196:199],v[140:143]
v_accvgpr_read_b32 v238,a24
v_accvgpr_read_b32 v232,a120
M v[144:147],a[104:107],a[244:247],v[144:147]
ds_read_b128 a[224:227],v249 offset:28160
v_add_f32 v234,v238,v232
M v[144:147],a[216:219],a[204:207],v[144:147]
s_waitcnt lgkmcnt(3)
ds_read_b128 a[248:251],v248 offset:28160
v_sub_f32 v238,v238,v232
M v[144:147],a[212:215],a[116:119],v[144:147]
s_waitcnt lgkmcnt(3)
v_add_f32 v232,v24,v120
v_sub_f32 v120,v24,v120
M v[148:151],a[212:215],a[252:255],v[148:151]
v_add_f32 v24,v234,v232
v_fmac_f32 v234,4.0,v232
M v[148:151],a[216:219],a[116:119],v[148:151]
v_fma_f32 v232,2.0,v120,v238
v_fma_f32 v120,s40,v120,v238
M v[148:151],a[104:107],a[204:207],v[148:151]
s_waitcnt lgkmcnt(2)
s_barrier
ds_read_b128 a[16:19],v250 offset:34816
M v[152:155],a[104:107],a[116:119],v[152:155]
ds_read_b128 a[20:23],v250 offset:38912
v_accvgpr_read_b32 v238,a25
M v[152:155],a[216:219],a[252:255],v[152:155]
s_waitcnt lgkmcnt(3)
v_accvgpr_read_b32 v237,a121
v_add_f32 v236,v238,v237
M v[152:155],a[212:215],a[224:227],v[152:155]
s_waitcnt lgkmcnt(2)
v_sub_f32 v238,v238,v237
v_add_f32 v237,v25,v121
M v[156:159],a[212:215],a[248:251],v[156:159]
buffer_load_dwordx4 a[212:215],v250,s[20:23],s46 offen offset:1024 sc1
M v[156:159],a[216:219],a[224:227],v[156:159]
s_add_u32 s34,s32,7077888
v_sub_f32 v121,v25,v121
v_add_f32 v25,v236,v237
M v[156:159],a[104:107],a[252:255],v[156:159]
s_waitcnt vmcnt(16) lgkmcnt(1)
buffer_store_dwordx4 a[16:19],v253,s[24:27],s34 offen offset:384 nt
M v[160:163],a[220:223],a[200:203],v[160:163]
s_waitcnt vmcnt(16)
s_add_u32 s34,s32,7274496
v_fmac_f32 v236,4.0,v237
v_fma_f32 v237,2.0,v121,v238
M v[160:163],v[216:219],a[232:235],v[160:163]
s_waitcnt vmcnt(15)
v_fma_f32 v121,s40,v121,v238
v_cvt_pk_bf16_f32 v232,v232,v237
M v[160:163],a[236:239],v[220:223],v[160:163]
s_waitcnt lgkmcnt(0)
buffer_store_dwordx4 a[20:23],v253,s[24:27],s34 offen offset:384 nt
M v[164:167],a[236:239],a[196:199],v[164:167]
v_cvt_pk_bf16_f32 v234,v234,v236
v_accvgpr_read_b32 v238,a26
M v[164:167],v[216:219],v[220:223],v[164:167]
v_accvgpr_read_b32 v233,a122
v_add_f32 v235,v238,v233
M v[164:167],a[220:223],a[232:235],v[164:167]
buffer_load_dwordx4 a[216:219],v250,s[20:23],s46 offen offset:2048 sc1
M v[168:171],a[220:223],v[220:223],v[168:171]
s_add_u32 s46,s76,0
v_sub_f32 v238,v238,v233
v_add_f32 v233,v26,v122
M v[168:171],v[216:219],a[196:199],v[168:171]
v_sub_f32 v122,v26,v122
v_add_f32 v26,v235,v233
M v[168:171],a[236:239],a[244:247],v[168:171]
v_fmac_f32 v235,4.0,v233
v_fma_f32 v233,2.0,v122,v238
M v[172:175],a[236:239],a[204:207],v[172:175]
buffer_load_dwordx4 a[104:107],v250,s[20:23],s46 offen offset:0 sc1
M v[172:175],v[216:219],a[244:247],v[172:175]
v_fma_f32 v122,s40,v122,v238
v_accvgpr_read_b32 v238,a27
M v[172:175],a[220:223],a[196:199],v[172:175]
v_accvgpr_read_b32 v237,a123
v_add_f32 v236,v238,v237
M v[176:179],a[220:223],a[244:247],v[176:179]
v_sub_f32 v238,v238,v237
v_add_f32 v237,v27,v123
M v[176:179],v[216:219],a[204:207],v[176:179]
buffer_load_dwordx4 a[200:203],v250,s[20:23],s46 offen offset:1024 sc1
M v[176:179],a[236:239],a[116:119],v[176:179]
v_sub_f32 v123,v27,v123
v_add_f32 v27,v236,v237
M v[180:183],a[236:239],a[252:255],v[180:183]
v_fmac_f32 v236,4.0,v237
v_fma_f32 v237,2.0,v123,v238
M v[180:183],v[216:219],a[116:119],v[180:183]
ds_read_b128 a[120:123],v248 offset:52224
v_fma_f32 v123,s40,v123,v238
M v[180:183],a[220:223],a[204:207],v[180:183]
buffer_load_dwordx4 a[232:235],v250,s[20:23],s46 offen offset:2048 sc1
M v[184:187],a[220:223],a[116:119],v[184:187]
s_add_u32 s46,s77,0
ds_read_b128 a[196:199],v249 offset:52224
ds_read_b128 a[116:119],v248 offset:52736
M v[184:187],v[216:219],a[252:255],v[184:187]
ds_read_b128 a[244:247],v249 offset:52736
v_cvt_pk_bf16_f32 v233,v233,v237
M v[184:187],a[236:239],a[224:227],v[184:187]
v_cvt_pk_bf16_f32 v235,v235,v236
M v[188:191],a[236:239],a[248:251],v[188:191]
buffer_load_dwordx4 v[220:223],v250,s[20:23],s46 offen offset:0 sc1
M v[188:191],v[216:219],a[224:227],v[188:191]
ds_write2st64_b64 v254,v[232:233],v[234:235] offset0:85 offset1:89
M v[188:191],a[220:223],a[252:255],v[188:191]
s_waitcnt vmcnt(19) lgkmcnt(4)
v_accvgpr_read_b32 v204,a28
v_accvgpr_read_b32 v208,a124
M v[0:3],a[96:99],a[120:123],v[0:3]
s_waitcnt vmcnt(18) lgkmcnt(3)
ds_read_b128 a[120:123],v248 offset:53248
v_accvgpr_read_b32 v205,a29
M v[0:3],a[108:111],a[196:199],v[0:3]
s_waitcnt vmcnt(16) lgkmcnt(3)
buffer_load_dwordx4 a[204:207],v250,s[20:23],s46 offen offset:1024 sc1
M v[0:3],a[112:115],a[116:119],v[0:3]
s_waitcnt lgkmcnt(2)
ds_read_b128 a[220:223],v249 offset:53248
v_accvgpr_read_b32 v209,a125
M v[4:7],a[112:115],a[244:247],v[4:7]
v_accvgpr_read_b32 v206,a30
v_accvgpr_read_b32 v210,a126
v_accvgpr_read_b32 v207,a31
v_accvgpr_read_b32 v211,a127
v_pk_add_f32 v[212:213],v[204:205],v[208:209]
v_pk_add_f32 v[214:215],v[206:207],v[210:211]
v_pk_add_f32 v[204:205],v[204:205],v[208:209] neg_lo:[0,1] neg_hi:[0,1]
v_pk_add_f32 v[206:207],v[206:207],v[210:211] neg_lo:[0,1] neg_hi:[0,1]
v_pk_add_f32 v[208:209],v[28:29],v[124:125]
v_pk_add_f32 v[210:211],v[30:31],v[126:127]
v_pk_add_f32 v[124:125],v[28:29],v[124:125] neg_lo:[0,1] neg_hi:[0,1]
v_pk_add_f32 v[126:127],v[30:31],v[126:127] neg_lo:[0,1] neg_hi:[0,1]
v_pk_add_f32 v[28:29],v[212:213],v[208:209]
v_pk_add_f32 v[30:31],v[214:215],v[210:211]
v_pk_fma_f32 v[212:213],v[208:209],4.0,v[212:213] op_sel_hi:[1,0,1]
v_pk_fma_f32 v[214:215],v[210:211],4.0,v[214:215] op_sel_hi:[1,0,1]
v_pk_fma_f32 v[208:209],v[124:125],2.0,v[204:205] op_sel_hi:[1,0,1]
v_pk_fma_f32 v[210:211],v[126:127],2.0,v[206:207] op_sel_hi:[1,0,1]
v_pk_fma_f32 v[124:125],v[124:125],s[40:41],v[204:205] op_sel_hi:[1,0,1]
v_pk_fma_f32 v[126:127],v[126:127],s[40:41],v[206:207] op_sel_hi:[1,0,1]
M v[4:7],a[108:111],a[116:119],v[4:7]
buffer_load_dwordx4 a[236:239],v250,s[20:23],s46 offen offset:2048 sc1
M v[4:7],a[96:99],a[196:199],v[4:7]
s_add_u32 s46,s72,46080
v_cvt_pk_bf16_f32 v208,v208,v209
v_cvt_pk_bf16_f32 v209,v210,v211
M v[8:11],a[96:99],a[116:119],v[8:11]
buffer_load_dwordx4 a[248:251],v250,s[20:23],s46 offen offset:0 sc1
M v[8:11],a[108:111],a[244:247],v[8:11]
s_waitcnt lgkmcnt(1)
ds_read_b128 a[124:127],v248 offset:53760
ds_read_b128 a[116:119],v249 offset:53760
M v[8:11],a[112:115],a[120:123],v[8:11]
s_waitcnt lgkmcnt(2)
v_cvt_pk_bf16_f32 v212,v212,v213
v_cvt_pk_bf16_f32 v213,v214,v215
M v[12:15],a[112:115],a[220:223],v[12:15]
ds_write2st64_b64 v254,v[208:209],v[212:213] offset0:93 offset1:97
M v[12:15],a[108:111],a[120:123],v[12:15]
buffer_load_dwordx4 a[224:227],v250,s[20:23],s46 offen offset:1024 sc1
M v[12:15],a[96:99],a[244:247],v[12:15]
v_accvgpr_read_b32 v238,a32
v_accvgpr_read_b32 v232,a128
M v[16:19],a[96:99],a[120:123],v[16:19]
ds_read_b128 a[120:123],v249 offset:54272
v_add_f32 v234,v238,v232
M v[16:19],a[108:111],a[220:223],v[16:19]
s_waitcnt lgkmcnt(3)
ds_read_b128 a[252:255],v248 offset:54272
v_add_u32 v248,0x15400,v248
M v[16:19],a[112:115],a[124:127],v[16:19]
s_waitcnt lgkmcnt(3)
buffer_load_dwordx4 v[216:219],v250,s[20:23],s46 offen offset:2048 sc1
M v[20:23],a[112:115],a[116:119],v[20:23]
s_add_u32 s47,s72,49152
v_add_u32 v249,0x15400,v249
v_sub_f32 v238,v238,v232
M v[20:23],a[108:111],a[124:127],v[20:23]
ds_read_b128 a[196:199],v248 offset:0
v_add_f32 v232,v32,v128
M v[20:23],a[96:99],a[220:223],v[20:23]
ds_read_b128 a[244:247],v249 offset:0
v_sub_f32 v128,v32,v128
M v[24:27],a[96:99],a[124:127],v[24:27]
ds_read_b128 a[124:127],v248 offset:512
v_add_f32 v32,v234,v232
M v[24:27],a[108:111],a[116:119],v[24:27]
s_waitcnt lgkmcnt(4)
ds_read_b128 a[220:223],v249 offset:512
v_fmac_f32 v234,4.0,v232
M v[24:27],a[112:115],a[120:123],v[24:27]
s_waitcnt lgkmcnt(4)
v_fma_f32 v232,2.0,v128,v238
v_fma_f32 v128,s40,v128,v238
M v[28:31],a[112:115],a[252:255],v[28:31]
s_barrier
ds_read_b128 a[24:27],v250 offset:43520
M v[28:31],a[108:111],a[120:123],v[28:31]
ds_read_b128 a[28:31],v250 offset:47616
v_accvgpr_read_b32 v238,a33
M v[28:31],a[96:99],a[116:119],v[28:31]
s_waitcnt vmcnt(20) lgkmcnt(5)
buffer_load_dwordx4 a[112:115],v250,s[20:23],s47 offen offset:0 sc1
M v[0:3],v[228:231],a[196:199],v[0:3]
s_waitcnt vmcnt(20) lgkmcnt(4)
ds_read_b128 a[120:123],v248 offset:1024
v_accvgpr_read_b32 v237,a129
M v[0:3],a[192:195],a[244:247],v[0:3]
s_waitcnt vmcnt(19) lgkmcnt(4)
buffer_load_dwordx4 a[252:255],v250,s[20:23],s47 offen offset:1024 sc1
M v[0:3],a[240:243],a[124:127],v[0:3]
s_waitcnt lgkmcnt(3)
s_add_u32 s34,s32,7471104
ds_read_b128 a[96:99],v249 offset:1024
v_add_f32 v236,v238,v237
M v[4:7],a[240:243],a[220:223],v[4:7]
v_sub_f32 v238,v238,v237
v_add_f32 v237,v33,v129
M v[4:7],a[192:195],a[124:127],v[4:7]
v_sub_f32 v129,v33,v129
v_add_f32 v33,v236,v237
M v[4:7],v[228:231],a[244:247],v[4:7]
s_waitcnt lgkmcnt(3)
buffer_store_dwordx4 a[24:27],v253,s[24:27],s34 offen offset:384 nt
M v[8:11],v[228:231],a[124:127],v[8:11]
s_add_u32 s34,s32,7667712
ds_read_b128 a[116:119],v248 offset:1536
v_fmac_f32 v236,4.0,v237
M v[8:11],a[192:195],a[220:223],v[8:11]
s_waitcnt lgkmcnt(2)
ds_read_b128 a[124:127],v249 offset:1536
v_fma_f32 v237,2.0,v129,v238
M v[8:11],a[240:243],a[120:123],v[8:11]
s_waitcnt lgkmcnt(2)
buffer_store_dwordx4 a[28:31],v253,s[24:27],s34 offen offset:384 nt
M v[12:15],a[240:243],a[96:99],v[12:15]
v_fma_f32 v129,s40,v129,v238
v_cvt_pk_bf16_f32 v232,v232,v237
M v[12:15],a[192:195],a[120:123],v[12:15]
v_cvt_pk_bf16_f32 v234,v234,v236
v_accvgpr_read_b32 v238,a34
M v[12:15],v[228:231],a[220:223],v[12:15]
buffer_load_dwordx4 a[108:111],v250,s[20:23],s47 offen offset:2048 sc1
M v[16:19],v[228:231],a[120:123],v[16:19]
ds_read_b128 a[120:123],v249 offset:2048
v_accvgpr_read_b32 v233,a130
M v[16:19],a[192:195],a[96:99],v[16:19]
s_waitcnt lgkmcnt(2)
ds_read_b128 a[196:199],v248 offset:2048
v_add_f32 v235,v238,v233
M v[16:19],a[240:243],a[116:119],v[16:19]
s_waitcnt lgkmcnt(2)
v_sub_f32 v238,v238,v233
v_add_f32 v233,v34,v130
M v[20:23],a[240:243],a[124:127],v[20:23]
s_add_u32 s46,s73,46080
v_sub_f32 v130,v34,v130
v_add_f32 v34,v235,v233
M v[20:23],a[192:195],a[116:119],v[20:23]
ds_read_b128 a[244:247],v248 offset:17408
v_fmac_f32 v235,4.0,v233
M v[20:23],v[228:231],a[96:99],v[20:23]
ds_read_b128 a[96:99],v249 offset:17408
v_fma_f32 v233,2.0,v130,v238
M v[24:27],v[228:231],a[116:119],v[24:27]
ds_read_b128 a[116:119],v248 offset:17920
v_fma_f32 v130,s40,v130,v238
M v[24:27],a[192:195],a[124:127],v[24:27]
s_waitcnt lgkmcnt(4)
v_accvgpr_read_b32 v238,a35
v_accvgpr_read_b32 v237,a131
M v[24:27],a[240:243],a[120:123],v[24:27]
s_waitcnt lgkmcnt(3)
ds_read_b128 a[128:131],v249 offset:17920
v_add_f32 v236,v238,v237
M v[28:31],a[240:243],a[196:199],v[28:31]
buffer_load_dwordx4 a[220:223],v250,s[20:23],s46 offen offset:0 sc1
M v[28:31],a[192:195],a[120:123],v[28:31]
v_sub_f32 v238,v238,v237
v_add_f32 v237,v35,v131
M v[28:31],v[228:231],a[124:127],v[28:31]
s_waitcnt vmcnt(22) lgkmcnt(3)
buffer_load_dwordx4 a[196:199],v250,s[20:23],s46 offen offset:1024 sc1
M v[0:3],a[228:231],a[244:247],v[0:3]
s_waitcnt vmcnt(22) lgkmcnt(2)
ds_read_b128 a[124:127],v248 offset:18432
v_sub_f32 v131,v35,v131
M v[0:3],a[208:211],a[96:99],v[0:3]
s_waitcnt vmcnt(21) lgkmcnt(2)
ds_read_b128 a[240:243],v249 offset:18432
v_add_f32 v35,v236,v237
M v[0:3],v[224:227],a[116:119],v[0:3]
s_waitcnt lgkmcnt(2)
v_fmac_f32 v236,4.0,v237
v_fma_f32 v237,2.0,v131,v238
M v[4:7],v[224:227],a[128:131],v[4:7]
buffer_load_dwordx4 a[120:123],v250,s[20:23],s46 offen offset:2048 sc1
M v[4:7],a[208:211],a[116:119],v[4:7]
v_fma_f32 v131,s40,v131,v238
v_cvt_pk_bf16_f32 v233,v233,v237
M v[4:7],a[228:231],a[96:99],v[4:7]
v_cvt_pk_bf16_f32 v235,v235,v236
M v[8:11],a[228:231],a[116:119],v[8:11]
ds_read_b128 a[96:99],v248 offset:18944
ds_write2st64_b64 v254,v[232:233],v[234:235] offset0:34 offset1:38
M v[8:11],a[208:211],a[128:131],v[8:11]
s_waitcnt lgkmcnt(3)
ds_read_b128 a[116:119],v249 offset:18944
v_accvgpr_read_b32 v204,a36
M v[8:11],v[224:227],a[124:127],v[8:11]
s_waitcnt lgkmcnt(3)
v_accvgpr_read_b32 v208,a132
v_accvgpr_read_b32 v205,a37
M v[12:15],v[224:227],a[240:243],v[12:15]
v_accvgpr_read_b32 v209,a133
v_accvgpr_read_b32 v206,a38
M v[12:15],a[208:211],a[124:127],v[12:15]
v_accvgpr_read_b32 v210,a134
v_accvgpr_read_b32 v207,a39
v_accvgpr_read_b32 v211,a135
v_pk_add_f32 v[212:213],v[204:205],v[208:209]
v_pk_add_f32 v[214:215],v[206:207],v[210:211]
v_pk_add_f32 v[204:205],v[204:205],v[208:209] neg_lo:[0,1] neg_hi:[0,1]
v_pk_add_f32 v[206:207],v[206:207],v[210:211] neg_lo:[0,1] neg_hi:[0,1]
v_pk_add_f32 v[208:209],v[36:37],v[132:133]
v_pk_add_f32 v[210:211],v[38:39],v[134:135]
v_pk_add_f32 v[132:133],v[36:37],v[132:133] neg_lo:[0,1] neg_hi:[0,1]
v_pk_add_f32 v[134:135],v[38:39],v[134:135] neg_lo:[0,1] neg_hi:[0,1]
v_pk_add_f32 v[36:37],v[212:213],v[208:209]
v_pk_add_f32 v[38:39],v[214:215],v[210:211]
v_pk_fma_f32 v[212:213],v[208:209],4.0,v[212:213] op_sel_hi:[1,0,1]
v_pk_fma_f32 v[214:215],v[210:211],4.0,v[214:215] op_sel_hi:[1,0,1]
v_pk_fma_f32 v[208:209],v[132:133],2.0,v[204:205] op_sel_hi:[1,0,1]
v_pk_fma_f32 v[210:211],v[134:135],2.0,v[206:207] op_sel_hi:[1,0,1]
v_pk_fma_f32 v[132:133],v[132:133],s[40:41],v[204:205] op_sel_hi:[1,0,1]
v_pk_fma_f32 v[134:135],v[134:135],s[40:41],v[206:207] op_sel_hi:[1,0,1]
M v[12:15],a[228:231],a[128:131],v[12:15]
v_cvt_pk_bf16_f32 v208,v208,v209
v_cvt_pk_bf16_f32 v209,v210,v211
M v[16:19],a[228:231],a[124:127],v[16:19]
s_add_u32 s47,s73,49152
ds_read_b128 a[128:131],v249 offset:19456
v_cvt_pk_bf16_f32 v212,v212,v213
M v[16:19],a[208:211],a[240:243],v[16:19]
s_waitcnt lgkmcnt(3)
ds_read_b128 a[132:135],v248 offset:19456
v_cvt_pk_bf16_f32 v213,v214,v215
M v[16:19],v[224:227],a[96:99],v[16:19]
s_waitcnt lgkmcnt(2)
ds_write2st64_b64 v254,v[208:209],v[212:213] offset0:42 offset1:46
M v[20:23],v[224:227],a[116:119],v[20:23]
v_accvgpr_read_b32 v204,a40
v_accvgpr_read_b32 v208,a136
M v[20:23],a[208:211],a[96:99],v[20:23]
ds_read_b128 a[124:127],v248 offset:34816
v_accvgpr_read_b32 v205,a41
M v[20:23],a[228:231],a[240:243],v[20:23]
ds_read_b128 a[192:195],v249 offset:34816
v_accvgpr_read_b32 v209,a137
M v[24:27],a[228:231],a[96:99],v[24:27]
buffer_load_dwordx4 a[96:99],v250,s[20:23],s47 offen offset:0 sc1
M v[24:27],a[208:211],a[116:119],v[24:27]
s_waitcnt lgkmcnt(4)
v_accvgpr_read_b32 v206,a42
v_accvgpr_read_b32 v210,a138
v_accvgpr_read_b32 v207,a43
v_accvgpr_read_b32 v211,a139
v_pk_add_f32 v[212:213],v[204:205],v[208:209]
v_pk_add_f32 v[214:215],v[206:207],v[210:211]
v_pk_add_f32 v[204:205],v[204:205],v[208:209] neg_lo:[0,1] neg_hi:[0,1]
v_pk_add_f32 v[206:207],v[206:207],v[210:211] neg_lo:[0,1] neg_hi:[0,1]
v_pk_add_f32 v[208:209],v[40:41],v[136:137]
v_pk_add_f32 v[210:211],v[42:43],v[138:139]
v_pk_add_f32 v[136:137],v[40:41],v[136:137] neg_lo:[0,1] neg_hi:[0,1]
v_pk_add_f32 v[138:139],v[42:43],v[138:139] neg_lo:[0,1] neg_hi:[0,1]
v_pk_add_f32 v[40:41],v[212:213],v[208:209]
v_pk_add_f32 v[42:43],v[214:215],v[210:211]
v_pk_fma_f32 v[212:213],v[208:209],4.0,v[212:213] op_sel_hi:[1,0,1]
v_pk_fma_f32 v[214:215],v[210:211],4.0,v[214:215] op_sel_hi:[1,0,1]
v_pk_fma_f32 v[208:209],v[136:137],2.0,v[204:205] op_sel_hi:[1,0,1]
v_pk_fma_f32 v[210:211],v[138:139],2.0,v[206:207] op_sel_hi:[1,0,1]
v_pk_fma_f32 v[136:137],v[136:137],s[40:41],v[204:205] op_sel_hi:[1,0,1]
v_pk_fma_f32 v[138:139],v[138:139],s[40:41],v[206:207] op_sel_hi:[1,0,1]
M v[24:27],v[224:227],a[128:131],v[24:27]
s_waitcnt lgkmcnt(3)
ds_read_b128 a[136:139],v248 offset:35328
ds_read_b128 v[228:231],v249 offset:35328
M v[28:31],v[224:227],a[132:135],v[28:31]
buffer_load_dwordx4 a[244:247],v250,s[20:23],s47 offen offset:1024 sc1
M v[28:31],a[208:211],a[128:131],v[28:31]
v_cvt_pk_bf16_f32 v208,v208,v209
v_cvt_pk_bf16_f32 v209,v210,v211
M v[28:31],a[228:231],a[116:119],v[28:31]
s_waitcnt vmcnt(23) lgkmcnt(3)
buffer_load_dwordx4 a[132:135],v250,s[20:23],s47 offen offset:2048 sc1
M v[0:3],a[100:103],a[124:127],v[0:3]
s_waitcnt vmcnt(23) lgkmcnt(2)
ds_read_b128 a[128:131],v248 offset:35840
v_cvt_pk_bf16_f32 v212,v212,v213
M v[0:3],a[212:215],a[192:195],v[0:3]
s_waitcnt vmcnt(20) lgkmcnt(2)
ds_read_b128 a[116:119],v249 offset:35840
v_cvt_pk_bf16_f32 v213,v214,v215
M v[0:3],a[216:219],a[136:139],v[0:3]
s_waitcnt lgkmcnt(2)
ds_write2st64_b64 v254,v[208:209],v[212:213] offset0:51 offset1:55
M v[4:7],a[216:219],v[228:231],v[4:7]
v_accvgpr_read_b32 v204,a44
v_accvgpr_read_b32 v208,a140
M v[4:7],a[212:215],a[136:139],v[4:7]
v_accvgpr_read_b32 v205,a45
v_accvgpr_read_b32 v209,a141
M v[4:7],a[100:103],a[192:195],v[4:7]
v_accvgpr_read_b32 v206,a46
v_accvgpr_read_b32 v210,a142
v_accvgpr_read_b32 v207,a47
v_accvgpr_read_b32 v211,a143
v_pk_add_f32 v[212:213],v[204:205],v[208:209]
v_pk_add_f32 v[214:215],v[206:207],v[210:211]
v_pk_add_f32 v[204:205],v[204:205],v[208:209] neg_lo:[0,1] neg_hi:[0,1]
v_pk_add_f32 v[206:207],v[206:207],v[210:211] neg_lo:[0,1] neg_hi:[0,1]
v_pk_add_f32 v[208:209],v[44:45],v[140:141]
v_pk_add_f32 v[210:211],v[46:47],v[142:143]
v_pk_add_f32 v[140:141],v[44:45],v[140:141] neg_lo:[0,1] neg_hi:[0,1]
v_pk_add_f32 v[142:143],v[46:47],v[142:143] neg_lo:[0,1] neg_hi:[0,1]
v_pk_add_f32 v[44:45],v[212:213],v[208:209]
v_pk_add_f32 v[46:47],v[214:215],v[210:211]
v_pk_fma_f32 v[212:213],v[208:209],4.0,v[212:213] op_sel_hi:[1,0,1]
v_pk_fma_f32 v[214:215],v[210:211],4.0,v[214:215] op_sel_hi:[1,0,1]
v_pk_fma_f32 v[208:209],v[140:141],2.0,v[204:205] op_sel_hi:[1,0,1]
v_pk_fma_f32 v[210:211],v[142:143],2.0,v[206:207] op_sel_hi:[1,0,1]
v_pk_fma_f32 v[140:141],v[140:141],s[40:41],v[204:205] op_sel_hi:[1,0,1]
v_pk_fma_f32 v[142:143],v[142:143],s[40:41],v[206:207] op_sel_hi:[1,0,1]
M v[8:11],a[100:103],a[136:139],v[8:11]
ds_read_b128 a[124:127],v248 offset:36352
v_cvt_pk_bf16_f32 v208,v208,v209
M v[8:11],a[212:215],v[228:231],v[8:11]
s_waitcnt lgkmcnt(3)
ds_read_b128 a[136:139],v249 offset:36352
v_cvt_pk_bf16_f32 v209,v210,v211
M v[8:11],a[216:219],a[128:131],v[8:11]
s_waitcnt lgkmcnt(3)
v_cvt_pk_bf16_f32 v212,v212,v213
v_cvt_pk_bf16_f32 v213,v214,v215
M v[12:15],a[216:219],a[116:119],v[12:15]
ds_write2st64_b64 v254,v[208:209],v[212:213] offset0:59 offset1:63
M v[12:15],a[212:215],a[128:131],v[12:15]
v_accvgpr_read_b32 v238,a48
v_accvgpr_read_b32 v232,a144
M v[12:15],a[100:103],v[228:231],v[12:15]
v_add_f32 v234,v238,v232
v_sub_f32 v238,v238,v232
M v[16:19],a[100:103],a[128:131],v[16:19]
s_add_u32 s46,s74,46080
ds_read_b128 a[140:143],v249 offset:36864
v_add_f32 v232,v48,v144
M v[16:19],a[212:215],a[116:119],v[16:19]
s_waitcnt lgkmcnt(3)
ds_read_b128 a[128:131],v248 offset:36864
v_sub_f32 v144,v48,v144
M v[16:19],a[216:219],a[124:127],v[16:19]
s_waitcnt lgkmcnt(3)
v_add_f32 v48,v234,v232
v_fmac_f32 v234,4.0,v232
M v[20:23],a[216:219],a[136:139],v[20:23]
v_fma_f32 v232,2.0,v144,v238
v_fma_f32 v144,s40,v144,v238
M v[20:23],a[212:215],a[124:127],v[20:23]
ds_read_b128 a[240:243],v248 offset:52224
v_accvgpr_read_b32 v238,a49
M v[20:23],a[100:103],a[116:119],v[20:23]
ds_read_b128 a[116:119],v249 offset:52224
v_accvgpr_read_b32 v237,a145
M v[24:27],a[100:103],a[124:127],v[24:27]
buffer_load_dwordx4 a[124:127],v250,s[20:23],s46 offen offset:0 sc1
M v[24:27],a[212:215],a[136:139],v[24:27]
s_waitcnt lgkmcnt(3)
ds_read_b128 v[224:227],v248 offset:52736
ds_read_b128 a[228:231],v249 offset:52736
M v[24:27],a[216:219],a[140:143],v[24:27]
s_waitcnt lgkmcnt(4)
buffer_load_dwordx4 a[208:211],v250,s[20:23],s46 offen offset:1024 sc1
M v[28:31],a[216:219],a[128:131],v[28:31]
v_add_f32 v236,v238,v237
v_sub_f32 v238,v238,v237
M v[28:31],a[212:215],a[140:143],v[28:31]
v_add_f32 v237,v49,v145
v_sub_f32 v145,v49,v145
M v[28:31],a[100:103],a[136:139],v[28:31]
s_waitcnt vmcnt(21) lgkmcnt(3)
v_add_f32 v49,v236,v237
v_fmac_f32 v236,4.0,v237
M v[0:3],a[104:107],a[240:243],v[0:3]
s_waitcnt vmcnt(20) lgkmcnt(2)
buffer_load_dwordx4 a[192:195],v250,s[20:23],s46 offen offset:2048 sc1
M v[0:3],a[200:203],a[116:119],v[0:3]
s_waitcnt vmcnt(20) lgkmcnt(1)
ds_read_b128 a[128:131],v248 offset:53248
ds_read_b128 a[140:143],v249 offset:53248
M v[0:3],a[232:235],v[224:227],v[0:3]
s_waitcnt lgkmcnt(2)
v_fma_f32 v237,2.0,v145,v238
v_fma_f32 v145,s40,v145,v238
M v[4:7],a[232:235],a[228:231],v[4:7]
v_cvt_pk_bf16_f32 v232,v232,v237
v_cvt_pk_bf16_f32 v234,v234,v236
M v[4:7],a[200:203],v[224:227],v[4:7]
v_accvgpr_read_b32 v238,a50
v_accvgpr_read_b32 v233,a146
M v[4:7],a[104:107],a[116:119],v[4:7]
v_add_f32 v235,v238,v233
v_sub_f32 v238,v238,v233
M v[8:11],a[104:107],v[224:227],v[8:11]
ds_read_b128 a[100:103],v248 offset:53760
v_add_f32 v233,v50,v146
M v[8:11],a[200:203],a[228:231],v[8:11]
s_waitcnt lgkmcnt(2)
ds_read_b128 a[136:139],v249 offset:53760
v_sub_f32 v146,v50,v146
M v[8:11],a[232:235],a[128:131],v[8:11]
s_waitcnt lgkmcnt(2)
v_add_f32 v50,v235,v233
v_fmac_f32 v235,4.0,v233
M v[12:15],a[232:235],a[140:143],v[12:15]
v_fma_f32 v233,2.0,v146,v238
v_fma_f32 v146,s40,v146,v238
M v[12:15],a[200:203],a[128:131],v[12:15]
v_accvgpr_read_b32 v238,a51
v_accvgpr_read_b32 v237,a147
M v[12:15],a[104:107],a[228:231],v[12:15]
v_add_f32 v236,v238,v237
v_sub_f32 v238,v238,v237
M v[16:19],a[104:107],a[128:131],v[16:19]
s_add_u32 s47,s74,49152
ds_read_b128 a[116:119],v249 offset:54272
v_add_f32 v237,v51,v147
M v[16:19],a[200:203],a[140:143],v[16:19]
s_waitcnt lgkmcnt(2)
ds_read_b128 a[144:147],v248 offset:54272
v_add_u32 v248,0xffff9a00,v248
M v[16:19],a[232:235],a[100:103],v[16:19]
s_waitcnt lgkmcnt(2)
v_add_u32 v249,0xffff9a00,v249
v_sub_f32 v147,v51,v147
M v[20:23],a[232:235],a[136:139],v[20:23]
v_add_f32 v51,v236,v237
v_fmac_f32 v236,4.0,v237
M v[20:23],a[200:203],a[100:103],v[20:23]
ds_read_b128 a[128:131],v248 offset:8704
v_fma_f32 v237,2.0,v147,v238
M v[20:23],a[104:107],a[140:143],v[20:23]
ds_read_b128 a[140:143],v249 offset:8704
v_fma_f32 v147,s40,v147,v238
M v[24:27],a[104:107],a[100:103],v[24:27]
buffer_load_dwordx4 a[100:103],v250,s[20:23],s47 offen offset:0 sc1
M v[24:27],a[200:203],a[136:139],v[24:27]
s_waitcnt lgkmcnt(3)
ds_read_b128 v[228:231],v248 offset:9216
ds_read_b128 a[212:215],v249 offset:9216
M v[24:27],a[232:235],a[116:119],v[24:27]
s_waitcnt lgkmcnt(4)
buffer_load_dwordx4 a[216:219],v250,s[20:23],s47 offen offset:1024 sc1
M v[28:31],a[232:235],a[144:147],v[28:31]
v_cvt_pk_bf16_f32 v233,v233,v237
v_cvt_pk_bf16_f32 v235,v235,v236
M v[28:31],a[200:203],a[116:119],v[28:31]
ds_write2st64_b64 v254,v[232:233],v[234:235] offset0:0 offset1:4
M v[28:31],a[104:107],a[136:139],v[28:31]
s_waitcnt vmcnt(21) lgkmcnt(4)
v_accvgpr_read_b32 v204,a52
v_accvgpr_read_b32 v208,a148
M v[0:3],v[220:223],a[128:131],v[0:3]
s_waitcnt vmcnt(20) lgkmcnt(3)
buffer_load_dwordx4 a[240:243],v250,s[20:23],s47 offen offset:2048 sc1
M v[0:3],a[204:207],a[140:143],v[0:3]
s_waitcnt vmcnt(20) lgkmcnt(2)
ds_read_b128 a[144:147],v248 offset:9728
ds_read_b128 a[116:119],v249 offset:9728
M v[0:3],a[236:239],v[228:231],v[0:3]
s_waitcnt lgkmcnt(3)
v_accvgpr_read_b32 v205,a53
v_accvgpr_read_b32 v209,a149
M v[4:7],a[236:239],a[212:215],v[4:7]
v_accvgpr_read_b32 v206,a54
v_accvgpr_read_b32 v210,a150
v_accvgpr_read_b32 v207,a55
v_accvgpr_read_b32 v211,a151
v_pk_add_f32 v[212:213],v[204:205],v[208:209]
v_pk_add_f32 v[214:215],v[206:207],v[210:211]
v_pk_add_f32 v[204:205],v[204:205],v[208:209] neg_lo:[0,1] neg_hi:[0,1]
v_pk_add_f32 v[206:207],v[206:207],v[210:211] neg_lo:[0,1] neg_hi:[0,1]
v_pk_add_f32 v[208:209],v[52:53],v[148:149]
v_pk_add_f32 v[210:211],v[54:55],v[150:151]
v_pk_add_f32 v[148:149],v[52:53],v[148:149] neg_lo:[0,1] neg_hi:[0,1]
v_pk_add_f32 v[150:151],v[54:55],v[150:151] neg_lo:[0,1] neg_hi:[0,1]
v_pk_add_f32 v[52:53],v[212:213],v[208:209]
v_pk_add_f32 v[54:55],v[214:215],v[210:211]
v_pk_fma_f32 v[212:213],v[208:209],4.0,v[212:213] op_sel_hi:[1,0,1]
v_pk_fma_f32 v[214:215],v[210:211],4.0,v[214:215] op_sel_hi:[1,0,1]
v_pk_fma_f32 v[208:209],v[148:149],2.0,v[204:205] op_sel_hi:[1,0,1]
v_pk_fma_f32 v[210:211],v[150:151],2.0,v[206:207] op_sel_hi:[1,0,1]
v_pk_fma_f32 v[148:149],v[148:149],s[40:41],v[204:205] op_sel_hi:[1,0,1]
v_pk_fma_f32 v[150:151],v[150:151],s[40:41],v[206:207] op_sel_hi:[1,0,1]
M v[4:7],a[204:207],v[228:231],v[4:7]
v_cvt_pk_bf16_f32 v208,v208,v209
v_cvt_pk_bf16_f32 v209,v210,v211
M v[4:7],v[220:223],a[140:143],v[4:7]
v_cvt_pk_bf16_f32 v212,v212,v213
v_cvt_pk_bf16_f32 v213,v214,v215
M v[8:11],v[220:223],v[228:231],v[8:11]
ds_read_b128 a[104:107],v248 offset:10240
ds_write2st64_b64 v254,v[208:209],v[212:213] offset0:8 offset1:12
M v[8:11],a[204:207],a[212:215],v[8:11]
s_waitcnt lgkmcnt(3)
ds_read_b128 a[136:139],v249 offset:10240
v_accvgpr_read_b32 v204,a56
M v[8:11],a[236:239],a[144:147],v[8:11]
s_waitcnt lgkmcnt(3)
v_accvgpr_read_b32 v208,a152
v_accvgpr_read_b32 v205,a57
M v[12:15],a[236:239],a[116:119],v[12:15]
v_accvgpr_read_b32 v209,a153
v_accvgpr_read_b32 v206,a58
M v[12:15],a[204:207],a[144:147],v[12:15]
v_accvgpr_read_b32 v210,a154
v_accvgpr_read_b32 v207,a59
v_accvgpr_read_b32 v211,a155
v_pk_add_f32 v[212:213],v[204:205],v[208:209]
v_pk_add_f32 v[214:215],v[206:207],v[210:211]
v_pk_add_f32 v[204:205],v[204:205],v[208:209] neg_lo:[0,1] neg_hi:[0,1]
v_pk_add_f32 v[206:207],v[206:207],v[210:211] neg_lo:[0,1] neg_hi:[0,1]
v_pk_add_f32 v[208:209],v[56:57],v[152:153]
v_pk_add_f32 v[210:211],v[58:59],v[154:155]
v_pk_add_f32 v[152:153],v[56:57],v[152:153] neg_lo:[0,1] neg_hi:[0,1]
v_pk_add_f32 v[154:155],v[58:59],v[154:155] neg_lo:[0,1] neg_hi:[0,1]
v_pk_add_f32 v[56:57],v[212:213],v[208:209]
v_pk_add_f32 v[58:59],v[214:215],v[210:211]
v_pk_fma_f32 v[212:213],v[208:209],4.0,v[212:213] op_sel_hi:[1,0,1]
v_pk_fma_f32 v[214:215],v[210:211],4.0,v[214:215] op_sel_hi:[1,0,1]
v_pk_fma_f32 v[208:209],v[152:153],2.0,v[204:205] op_sel_hi:[1,0,1]
v_pk_fma_f32 v[210:211],v[154:155],2.0,v[206:207] op_sel_hi:[1,0,1]
v_pk_fma_f32 v[152:153],v[152:153],s[40:41],v[204:205] op_sel_hi:[1,0,1]
v_pk_fma_f32 v[154:155],v[154:155],s[40:41],v[206:207] op_sel_hi:[1,0,1]
M v[12:15],v[220:223],a[212:215],v[12:15]
v_cvt_pk_bf16_f32 v208,v208,v209
v_cvt_pk_bf16_f32 v209,v210,v211
M v[16:19],v[220:223],a[144:147],v[16:19]
s_add_u32 s46,s75,46080
ds_read_b128 a[128:131],v249 offset:10752
v_cvt_pk_bf16_f32 v212,v212,v213
M v[16:19],a[204:207],a[116:119],v[16:19]
s_waitcnt lgkmcnt(3)
ds_read_b128 a[148:151],v248 offset:10752
v_cvt_pk_bf16_f32 v213,v214,v215
M v[16:19],a[236:239],a[104:107],v[16:19]
s_waitcnt lgkmcnt(2)
ds_write2st64_b64 v254,v[208:209],v[212:213] offset0:17 offset1:21
M v[20:23],a[236:239],a[136:139],v[20:23]
v_accvgpr_read_b32 v204,a60
v_accvgpr_read_b32 v208,a156
M v[20:23],a[204:207],a[104:107],v[20:23]
ds_read_b128 a[140:143],v248 offset:0
v_accvgpr_read_b32 v205,a61
M v[20:23],v[220:223],a[116:119],v[20:23]
ds_read_b128 a[152:155],v249 offset:0
v_accvgpr_read_b32 v209,a157
M v[24:27],v[220:223],a[104:107],v[24:27]
buffer_load_dwordx4 a[144:147],v250,s[20:23],s46 offen offset:0 sc1
M v[24:27],a[204:207],a[136:139],v[24:27]
s_waitcnt lgkmcnt(4)
ds_read_b128 a[116:119],v248 offset:512
ds_read_b128 v[224:227],v249 offset:512
M v[24:27],a[236:239],a[128:131],v[24:27]
s_waitcnt lgkmcnt(5)
buffer_load_dwordx4 a[104:107],v250,s[20:23],s46 offen offset:1024 sc1
M v[28:31],a[236:239],a[148:151],v[28:31]
v_accvgpr_read_b32 v206,a62
v_accvgpr_read_b32 v210,a158
v_accvgpr_read_b32 v207,a63
v_accvgpr_read_b32 v211,a159
v_pk_add_f32 v[212:213],v[204:205],v[208:209]
v_pk_add_f32 v[214:215],v[206:207],v[210:211]
v_pk_add_f32 v[204:205],v[204:205],v[208:209] neg_lo:[0,1] neg_hi:[0,1]
v_pk_add_f32 v[206:207],v[206:207],v[210:211] neg_lo:[0,1] neg_hi:[0,1]
v_pk_add_f32 v[208:209],v[60:61],v[156:157]
v_pk_add_f32 v[210:211],v[62:63],v[158:159]
v_pk_add_f32 v[156:157],v[60:61],v[156:157] neg_lo:[0,1] neg_hi:[0,1]
v_pk_add_f32 v[158:159],v[62:63],v[158:159] neg_lo:[0,1] neg_hi:[0,1]
v_pk_add_f32 v[60:61],v[212:213],v[208:209]
v_pk_add_f32 v[62:63],v[214:215],v[210:211]
v_pk_fma_f32 v[212:213],v[208:209],4.0,v[212:213] op_sel_hi:[1,0,1]
v_pk_fma_f32 v[214:215],v[210:211],4.0,v[214:215] op_sel_hi:[1,0,1]
v_pk_fma_f32 v[208:209],v[156:157],2.0,v[204:205] op_sel_hi:[1,0,1]
v_pk_fma_f32 v[210:211],v[158:159],2.0,v[206:207] op_sel_hi:[1,0,1]
v_pk_fma_f32 v[156:157],v[156:157],s[40:41],v[204:205] op_sel_hi:[1,0,1]
v_pk_fma_f32 v[158:159],v[158:159],s[40:41],v[206:207] op_sel_hi:[1,0,1]
M v[28:31],a[204:207],a[128:131],v[28:31]
buffer_load_dwordx4 a[156:159],v250,s[20:23],s46 offen offset:2048 sc1
M v[28:31],v[220:223],a[136:139],v[28:31]
s_waitcnt vmcnt(22) lgkmcnt(3)
v_cvt_pk_bf16_f32 v208,v208,v209
v_cvt_pk_bf16_f32 v209,v210,v211
M v[96:99],a[248:251],a[140:143],v[96:99]
s_waitcnt vmcnt(21) lgkmcnt(2)
ds_read_b128 a[148:151],v248 offset:1024
v_cvt_pk_bf16_f32 v212,v212,v213
M v[96:99],a[224:227],a[152:155],v[96:99]
s_waitcnt vmcnt(20) lgkmcnt(2)
ds_read_b128 a[128:131],v249 offset:1024
v_cvt_pk_bf16_f32 v213,v214,v215
M v[96:99],v[216:219],a[116:119],v[96:99]
s_waitcnt lgkmcnt(2)
ds_write2st64_b64 v254,v[208:209],v[212:213] offset0:25 offset1:29
M v[100:103],v[216:219],v[224:227],v[100:103]
v_cvt_pk_bf16_f32 v0,v0,v1
v_cvt_pk_bf16_f32 v1,v2,v3
M v[100:103],a[224:227],a[116:119],v[100:103]
v_cvt_pk_bf16_f32 v4,v4,v5
v_cvt_pk_bf16_f32 v5,v6,v7
M v[100:103],a[248:251],a[152:155],v[100:103]
s_waitcnt lgkmcnt(0)
s_barrier
ds_read_b128 a[32:35],v250 offset:17408
M v[104:107],a[248:251],a[116:119],v[104:107]
ds_read_b128 a[36:39],v250 offset:21504
ds_read_b128 a[40:43],v250 offset:26112
M v[104:107],a[224:227],v[224:227],v[104:107]
ds_read_b128 a[44:47],v250 offset:30208
ds_read_b128 a[48:51],v250 offset:0
M v[104:107],v[216:219],a[148:151],v[104:107]
ds_read_b128 a[52:55],v250 offset:4096
ds_read_b128 a[56:59],v250 offset:8704
M v[108:111],v[216:219],a[128:131],v[108:111]
ds_read_b128 a[60:63],v250 offset:12800
ds_read_b128 a[136:139],v248 offset:1536
M v[108:111],a[224:227],a[148:151],v[108:111]
s_add_u32 s34,s32,6291456
ds_read_b128 a[228:231],v249 offset:1536
ds_write2st64_b64 v254,v[0:1],v[4:5] offset0:68 offset1:72
M v[108:111],a[248:251],v[224:227],v[108:111]
s_waitcnt lgkmcnt(10)
buffer_store_dwordx4 a[32:35],v253,s[24:27],s34 offen offset:512 nt
M v[112:115],a[248:251],a[148:151],v[112:115]
s_add_u32 s34,s32,6488064
ds_read_b128 a[232:235],v249 offset:2048
v_cvt_pk_bf16_f32 v8,v8,v9
M v[112:115],a[224:227],a[128:131],v[112:115]
s_waitcnt lgkmcnt(3)
ds_read_b128 a[200:203],v248 offset:2048
v_cvt_pk_bf16_f32 v9,v10,v11
M v[112:115],v[216:219],a[136:139],v[112:115]
s_waitcnt lgkmcnt(3)
buffer_store_dwordx4 a[36:39],v253,s[24:27],s34 offen offset:512 nt
M v[116:119],v[216:219],a[228:231],v[116:119]
s_add_u32 s34,s32,6684672
v_cvt_pk_bf16_f32 v12,v12,v13
v_cvt_pk_bf16_f32 v13,v14,v15
M v[116:119],a[224:227],a[136:139],v[116:119]
ds_write2st64_b64 v254,v[8:9],v[12:13] offset0:76 offset1:80
M v[116:119],a[248:251],a[128:131],v[116:119]
buffer_store_dwordx4 a[40:43],v253,s[24:27],s34 offen offset:512 nt
M v[120:123],a[248:251],a[136:139],v[120:123]
s_add_u32 s34,s32,6881280
global_load_dword v228,v250,s[64:65]
M v[120:123],a[224:227],a[228:231],v[120:123]
s_waitcnt lgkmcnt(2)
s_add_u32 s47,s75,49152
v_cvt_pk_bf16_f32 v16,v16,v17
v_cvt_pk_bf16_f32 v17,v18,v19
M v[120:123],v[216:219],a[232:235],v[120:123]
s_waitcnt lgkmcnt(1)
buffer_store_dwordx4 a[44:47],v253,s[24:27],s34 offen offset:512 nt
M v[124:127],v[216:219],a[200:203],v[124:127]
s_add_u32 s34,s32,7077888
v_cvt_pk_bf16_f32 v20,v20,v21
v_cvt_pk_bf16_f32 v21,v22,v23
M v[124:127],a[224:227],a[232:235],v[124:127]
ds_write2st64_b64 v254,v[16:17],v[20:21] offset0:85 offset1:89
M v[124:127],a[248:251],a[228:231],v[124:127]
s_waitcnt vmcnt(24)
buffer_store_dwordx4 a[48:51],v253,s[24:27],s34 offen offset:512 nt
M v[128:131],a[112:115],a[140:143],v[128:131]
s_waitcnt vmcnt(24)
s_add_u32 s34,s32,7274496
v_cvt_pk_bf16_f32 v24,v24,v25
v_cvt_pk_bf16_f32 v25,v26,v27
M v[128:131],a[252:255],a[152:155],v[128:131]
s_waitcnt vmcnt(21)
v_cvt_pk_bf16_f32 v28,v28,v29
v_cvt_pk_bf16_f32 v29,v30,v31
M v[128:131],a[108:111],a[116:119],v[128:131]
buffer_store_dwordx4 a[52:55],v253,s[24:27],s34 offen offset:512 nt
M v[132:135],a[108:111],v[224:227],v[132:135]
s_add_u32 s34,s32,7471104
ds_write2st64_b64 v254,v[24:25],v[28:29] offset0:93 offset1:97
M v[132:135],a[252:255],a[116:119],v[132:135]
buffer_load_dwordx4 v[228:231],v250,s[20:23],s47 offen offset:0 sc1
M v[132:135],a[112:115],a[152:155],v[132:135]
v_accvgpr_read_b32 v238,a64
v_accvgpr_read_b32 v232,a160
M v[136:139],a[112:115],a[116:119],v[136:139]
v_add_f32 v234,v238,v232
v_sub_f32 v238,v238,v232
M v[136:139],a[252:255],v[224:227],v[136:139]
v_add_f32 v232,v64,v160
v_sub_f32 v160,v64,v160
M v[136:139],a[108:111],a[148:151],v[136:139]
buffer_load_dwordx4 a[212:215],v250,s[20:23],s47 offen offset:1024 sc1
M v[140:143],a[108:111],a[128:131],v[140:143]
v_add_f32 v64,v234,v232
v_fmac_f32 v234,4.0,v232
M v[140:143],a[252:255],a[148:151],v[140:143]
v_fma_f32 v232,2.0,v160,v238
v_fma_f32 v160,s40,v160,v238
M v[140:143],a[112:115],v[224:227],v[140:143]
s_waitcnt lgkmcnt(0)
s_barrier
ds_read_b128 v[0:3],v250 offset:34816
M v[144:147],a[112:115],a[148:151],v[144:147]
ds_read_b128 v[8:11],v250 offset:38912
ds_read_b128 v[16:19],v250 offset:43520
M v[144:147],a[252:255],a[128:131],v[144:147]
ds_read_b128 v[24:27],v250 offset:47616
v_accvgpr_read_b32 v238,a65
M v[144:147],a[108:111],a[136:139],v[144:147]
buffer_load_dwordx4 a[236:239],v250,s[20:23],s47 offen offset:2048 sc1
M v[148:151],a[108:111],a[228:231],v[148:151]
s_add_u32 s46,s76,46080
v_accvgpr_read_b32 v237,a161
v_add_f32 v236,v238,v237
M v[148:151],a[252:255],a[136:139],v[148:151]
ds_read_b128 a[140:143],v248 offset:34816
v_sub_f32 v238,v238,v237
M v[148:151],a[112:115],a[128:131],v[148:151]
buffer_store_dwordx4 a[56:59],v253,s[24:27],s34 offen offset:512 nt
M v[152:155],a[112:115],a[136:139],v[152:155]
ds_read_b128 a[152:155],v249 offset:34816
ds_read_b128 a[148:151],v248 offset:35328
M v[152:155],a[252:255],a[228:231],v[152:155]
buffer_load_dwordx4 a[116:119],v250,s[20:23],s46 offen offset:0 sc1
M v[152:155],a[108:111],a[232:235],v[152:155]
ds_read_b128 a[136:139],v249 offset:35328
v_add_f32 v237,v65,v161
M v[156:159],a[108:111],a[200:203],v[156:159]
v_sub_f32 v161,v65,v161
v_add_f32 v65,v236,v237
M v[156:159],a[252:255],a[232:235],v[156:159]
v_fmac_f32 v236,4.0,v237
v_fma_f32 v237,2.0,v161,v238
M v[156:159],a[112:115],a[228:231],v[156:159]
s_waitcnt vmcnt(26) lgkmcnt(3)
buffer_load_dwordx4 a[128:131],v250,s[20:23],s46 offen offset:1024 sc1
M v[96:99],a[220:223],a[140:143],v[96:99]
s_waitcnt vmcnt(26) lgkmcnt(2)
ds_read_b128 a[108:111],v248 offset:35840
v_fma_f32 v161,s40,v161,v238
M v[96:99],a[196:199],a[152:155],v[96:99]
s_waitcnt vmcnt(25) lgkmcnt(2)
s_add_u32 s34,s32,7667712
ds_read_b128 a[112:115],v249 offset:35840
v_cvt_pk_bf16_f32 v232,v232,v237
M v[96:99],a[120:123],a[148:151],v[96:99]
s_waitcnt lgkmcnt(2)
v_cvt_pk_bf16_f32 v234,v234,v236
v_accvgpr_read_b32 v238,a66
M v[100:103],a[120:123],a[136:139],v[100:103]
buffer_load_dwordx4 a[204:207],v250,s[20:23],s46 offen offset:2048 sc1
M v[100:103],a[196:199],a[148:151],v[100:103]
v_accvgpr_read_b32 v233,a162
v_add_f32 v235,v238,v233
M v[100:103],a[220:223],a[152:155],v[100:103]
v_sub_f32 v238,v238,v233
v_add_f32 v233,v66,v162
M v[104:107],a[220:223],a[148:151],v[104:107]
ds_read_b128 v[220:223],v248 offset:36352
v_sub_f32 v162,v66,v162
M v[104:107],a[196:199],a[136:139],v[104:107]
s_waitcnt lgkmcnt(2)
ds_read_b128 v[216:219],v249 offset:36352
v_add_f32 v66,v235,v233
M v[104:107],a[120:123],a[108:111],v[104:107]
s_waitcnt lgkmcnt(2)
buffer_store_dwordx4 a[60:63],v253,s[24:27],s34 offen offset:512 nt
M v[108:111],a[120:123],a[112:115],v[108:111]
v_fmac_f32 v235,4.0,v233
v_fma_f32 v233,2.0,v162,v238
M v[108:111],a[196:199],a[108:111],v[108:111]
v_fma_f32 v162,s40,v162,v238
v_accvgpr_read_b32 v238,a67
M v[108:111],a[220:223],a[136:139],v[108:111]
v_accvgpr_read_b32 v237,a163
v_add_f32 v236,v238,v237
M v[112:115],a[220:223],a[108:111],v[112:115]
s_add_u32 s47,s76,49152
ds_read_b128 a[160:163],v249 offset:36864
v_sub_f32 v238,v238,v237
M v[112:115],a[196:199],a[112:115],v[112:115]
s_waitcnt lgkmcnt(2)
ds_read_b128 a[224:227],v248 offset:36864
v_add_f32 v237,v67,v163
M v[112:115],a[120:123],v[220:223],v[112:115]
s_waitcnt lgkmcnt(2)
v_sub_f32 v163,v67,v163
v_add_f32 v67,v236,v237
M v[116:119],a[120:123],v[216:219],v[116:119]
v_fmac_f32 v236,4.0,v237
v_fma_f32 v237,2.0,v163,v238
M v[116:119],a[196:199],v[220:223],v[116:119]
v_fma_f32 v163,s40,v163,v238
v_cvt_pk_bf16_f32 v233,v233,v237
M v[116:119],a[220:223],a[112:115],v[116:119]
v_cvt_pk_bf16_f32 v235,v235,v236
M v[120:123],a[220:223],v[220:223],v[120:123]
buffer_load_dwordx4 a[248:251],v250,s[20:23],s47 offen offset:0 sc1
M v[120:123],a[196:199],v[216:219],v[120:123]
s_waitcnt lgkmcnt(1)
ds_write2st64_b64 v254,v[232:233],v[234:235] offset0:34 offset1:38
M v[120:123],a[120:123],a[160:163],v[120:123]
s_waitcnt lgkmcnt(1)
buffer_load_dwordx4 v[224:227],v250,s[20:23],s47 offen offset:1024 sc1
M v[124:127],a[120:123],a[224:227],v[124:127]
v_accvgpr_read_b32 v238,a68
v_accvgpr_read_b32 v232,a164
M v[124:127],a[196:199],a[160:163],v[124:127]
v_add_f32 v234,v238,v232
v_sub_f32 v238,v238,v232
M v[124:127],a[220:223],v[216:219],v[124:127]
s_waitcnt vmcnt(28)
s_add_u32 s34,s33,6291456
v_add_f32 v232,v68,v164
v_sub_f32 v164,v68,v164
M v[128:131],a[96:99],a[140:143],v[128:131]
s_waitcnt vmcnt(27)
buffer_load_dwordx4 a[200:203],v250,s[20:23],s47 offen offset:2048 sc1
M v[128:131],a[244:247],a[152:155],v[128:131]
s_waitcnt vmcnt(27)
v_add_f32 v68,v234,v232
v_fmac_f32 v234,4.0,v232
M v[128:131],a[132:135],a[148:151],v[128:131]
v_fma_f32 v232,2.0,v164,v238
v_fma_f32 v164,s40,v164,v238
M v[132:135],a[132:135],a[136:139],v[132:135]
v_accvgpr_read_b32 v238,a69
v_accvgpr_read_b32 v237,a165
M v[132:135],a[244:247],a[148:151],v[132:135]
v_add_f32 v236,v238,v237
v_sub_f32 v238,v238,v237
M v[132:135],a[96:99],a[152:155],v[132:135]
buffer_store_dwordx4 v[0:3],v253,s[24:27],s34 offen offset:0 nt
M v[136:139],a[96:99],a[148:151],v[136:139]
v_add_f32 v237,v69,v165
v_sub_f32 v165,v69,v165
M v[136:139],a[244:247],a[136:139],v[136:139]
v_add_f32 v69,v236,v237
v_fmac_f32 v236,4.0,v237
M v[136:139],a[132:135],a[108:111],v[136:139]
v_fma_f32 v237,2.0,v165,v238
v_fma_f32 v165,s40,v165,v238
M v[140:143],a[132:135],a[112:115],v[140:143]
v_cvt_pk_bf16_f32 v232,v232,v237
v_cvt_pk_bf16_f32 v234,v234,v236
M v[140:143],a[244:247],a[108:111],v[140:143]
v_accvgpr_read_b32 v238,a70
v_accvgpr_read_b32 v233,a166
M v[140:143],a[96:99],a[136:139],v[140:143]
v_add_f32 v235,v238,v233
v_sub_f32 v238,v238,v233
M v[144:147],a[96:99],a[108:111],v[144:147]
s_add_u32 s46,s77,46080
v_add_f32 v233,v70,v166
v_sub_f32 v166,v70,v166
M v[144:147],a[244:247],a[112:115],v[144:147]
v_add_f32 v70,v235,v233
v_fmac_f32 v235,4.0,v233
M v[144:147],a[132:135],v[220:223],v[144:147]
v_fma_f32 v233,2.0,v166,v238
v_fma_f32 v166,s40,v166,v238
M v[148:151],a[132:135],v[216:219],v[148:151]
v_accvgpr_read_b32 v238,a71
v_accvgpr_read_b32 v237,a167
M v[148:151],a[244:247],v[220:223],v[148:151]
ds_read_b128 a[120:123],v248 offset:52224
v_add_f32 v236,v238,v237
M v[148:151],a[96:99],a[112:115],v[148:151]
ds_read_b128 a[140:143],v249 offset:52224
v_sub_f32 v238,v238,v237
M v[152:155],a[96:99],v[220:223],v[152:155]
buffer_load_dwordx4 a[152:155],v250,s[20:23],s46 offen offset:0 sc1
M v[152:155],a[244:247],v[216:219],v[152:155]
ds_read_b128 a[148:151],v248 offset:52736
ds_read_b128 a[108:111],v249 offset:52736
M v[152:155],a[132:135],a[160:163],v[152:155]
buffer_load_dwordx4 a[136:139],v250,s[20:23],s46 offen offset:1024 sc1
M v[156:159],a[132:135],a[224:227],v[156:159]
s_add_u32 s34,s33,6684672
v_add_f32 v237,v71,v167
v_sub_f32 v167,v71,v167
M v[156:159],a[244:247],a[160:163],v[156:159]
v_add_f32 v71,v236,v237
v_fmac_f32 v236,4.0,v237
M v[156:159],a[96:99],v[216:219],v[156:159]
s_waitcnt vmcnt(29) lgkmcnt(3)
v_fma_f32 v237,2.0,v167,v238
v_fma_f32 v167,s40,v167,v238
M v[96:99],a[124:127],a[120:123],v[96:99]
s_waitcnt vmcnt(28) lgkmcnt(2)
buffer_load_dwordx4 a[164:167],v250,s[20:23],s46 offen offset:2048 sc1
M v[96:99],a[208:211],a[140:143],v[96:99]
s_waitcnt vmcnt(28) lgkmcnt(1)
ds_read_b128 a[112:115],v248 offset:53248
ds_read_b128 a[132:135],v249 offset:53248
M v[96:99],a[192:195],a[148:151],v[96:99]
s_waitcnt lgkmcnt(2)
v_cvt_pk_bf16_f32 v233,v233,v237
v_cvt_pk_bf16_f32 v235,v235,v236
M v[100:103],a[192:195],a[108:111],v[100:103]
ds_write2st64_b64 v254,v[232:233],v[234:235] offset0:42 offset1:46
M v[100:103],a[208:211],a[148:151],v[100:103]
v_accvgpr_read_b32 v238,a72
v_accvgpr_read_b32 v232,a168
M v[100:103],a[124:127],a[140:143],v[100:103]
buffer_store_dwordx4 v[8:11],v253,s[24:27],s34 offen offset:0 nt
M v[104:107],a[124:127],a[148:151],v[104:107]
ds_read_b128 a[160:163],v248 offset:53760
v_add_f32 v234,v238,v232
M v[104:107],a[208:211],a[108:111],v[104:107]
s_waitcnt lgkmcnt(3)
ds_read_b128 a[96:99],v249 offset:53760
v_sub_f32 v238,v238,v232
M v[104:107],a[192:195],a[112:115],v[104:107]
s_waitcnt lgkmcnt(3)
v_add_f32 v232,v72,v168
v_sub_f32 v168,v72,v168
M v[108:111],a[192:195],a[132:135],v[108:111]
v_add_f32 v72,v234,v232
v_fmac_f32 v234,4.0,v232
M v[108:111],a[208:211],a[112:115],v[108:111]
v_fma_f32 v232,2.0,v168,v238
v_fma_f32 v168,s40,v168,v238
M v[108:111],a[124:127],a[108:111],v[108:111]
v_accvgpr_read_b32 v238,a73
v_accvgpr_read_b32 v237,a169
M v[112:115],a[124:127],a[112:115],v[112:115]
s_add_u32 s47,s77,49152
ds_read_b128 a[232:235],v249 offset:54272
v_add_f32 v236,v238,v237
M v[112:115],a[208:211],a[132:135],v[112:115]
s_waitcnt lgkmcnt(2)
ds_read_b128 a[252:255],v248 offset:54272
v_sub_f32 v238,v238,v237
M v[112:115],a[192:195],a[160:163],v[112:115]
s_waitcnt lgkmcnt(2)
v_add_f32 v237,v73,v169
v_sub_f32 v169,v73,v169
M v[116:119],a[192:195],a[96:99],v[116:119]
v_add_f32 v73,v236,v237
v_fmac_f32 v236,4.0,v237
M v[116:119],a[208:211],a[160:163],v[116:119]
v_fma_f32 v237,2.0,v169,v238
v_fma_f32 v169,s40,v169,v238
M v[116:119],a[124:127],a[132:135],v[116:119]
v_cvt_pk_bf16_f32 v232,v232,v237
v_cvt_pk_bf16_f32 v234,v234,v236
M v[120:123],a[124:127],a[160:163],v[120:123]
buffer_load_dwordx4 a[228:231],v250,s[20:23],s47 offen offset:0 sc1
M v[120:123],a[208:211],a[96:99],v[120:123]
s_waitcnt lgkmcnt(1)
s_add_u32 s34,s33,7077888
v_accvgpr_read_b32 v238,a74
v_accvgpr_read_b32 v233,a170
M v[120:123],a[192:195],a[232:235],v[120:123]
s_waitcnt lgkmcnt(0)
buffer_load_dwordx4 a[196:199],v250,s[20:23],s47 offen offset:1024 sc1
M v[124:127],a[192:195],a[252:255],v[124:127]
v_add_f32 v235,v238,v233
v_sub_f32 v238,v238,v233
M v[124:127],a[208:211],a[232:235],v[124:127]
v_add_f32 v233,v74,v170
v_sub_f32 v170,v74,v170
M v[124:127],a[124:127],a[96:99],v[124:127]
s_waitcnt vmcnt(30)
v_add_f32 v74,v235,v233
v_fmac_f32 v235,4.0,v233
M v[128:131],a[100:103],a[120:123],v[128:131]
s_waitcnt vmcnt(29)
buffer_load_dwordx4 a[220:223],v250,s[20:23],s47 offen offset:2048 sc1
M v[128:131],a[216:219],a[140:143],v[128:131]
s_waitcnt vmcnt(29)
v_fma_f32 v233,2.0,v170,v238
v_fma_f32 v170,s40,v170,v238
M v[128:131],a[240:243],a[148:151],v[128:131]
v_accvgpr_read_b32 v238,a75
v_accvgpr_read_b32 v237,a171
M v[132:135],a[240:243],a[108:111],v[132:135]
v_add_f32 v236,v238,v237
v_sub_f32 v238,v238,v237
M v[132:135],a[216:219],a[148:151],v[132:135]
v_add_f32 v237,v75,v171
v_sub_f32 v171,v75,v171
M v[132:135],a[100:103],a[140:143],v[132:135]
buffer_store_dwordx4 v[16:19],v253,s[24:27],s34 offen offset:0 nt
M v[136:139],a[100:103],a[148:151],v[136:139]
v_add_f32 v75,v236,v237
v_fmac_f32 v236,4.0,v237
M v[136:139],a[216:219],a[108:111],v[136:139]
v_fma_f32 v237,2.0,v171,v238
v_fma_f32 v171,s40,v171,v238
M v[136:139],a[240:243],a[112:115],v[136:139]
v_cvt_pk_bf16_f32 v233,v233,v237
v_cvt_pk_bf16_f32 v235,v235,v236
M v[140:143],a[240:243],a[132:135],v[140:143]
ds_write2st64_b64 v254,v[232:233],v[234:235] offset0:51 offset1:55
M v[140:143],a[216:219],a[112:115],v[140:143]
v_accvgpr_read_b32 v238,a76
v_accvgpr_read_b32 v232,a172
M v[140:143],a[100:103],a[108:111],v[140:143]
v_add_f32 v234,v238,v232
v_sub_f32 v238,v238,v232
M v[144:147],a[100:103],a[112:115],v[144:147]
s_add_u32 s47,s72,3072
v_add_f32 v232,v76,v172
v_sub_f32 v172,v76,v172
M v[144:147],a[216:219],a[132:135],v[144:147]
v_add_u32 v248,0x11000,v248
v_add_u32 v249,0x11000,v249
M v[144:147],a[240:243],a[160:163],v[144:147]
v_add_f32 v76,v234,v232
v_fmac_f32 v234,4.0,v232
M v[148:151],a[240:243],a[96:99],v[148:151]
v_fma_f32 v232,2.0,v172,v238
v_fma_f32 v172,s40,v172,v238
M v[148:151],a[216:219],a[160:163],v[148:151]
ds_read_b128 a[124:127],v248 offset:0
v_accvgpr_read_b32 v238,a77
M v[148:151],a[100:103],a[132:135],v[148:151]
s_add_u32 s34,s33,7471104
buffer_store_dwordx4 v[24:27],v253,s[24:27],s34 offen offset:0 nt
M v[152:155],a[100:103],a[160:163],v[152:155]
buffer_load_dwordx4 a[168:171],v250,s[20:23],s47 offen offset:0 sc1
M v[152:155],a[216:219],a[96:99],v[152:155]
ds_read_b128 a[120:123],v249 offset:0
ds_read_b128 a[140:143],v248 offset:512
M v[152:155],a[240:243],a[232:235],v[152:155]
ds_read_b128 a[108:111],v249 offset:512
v_accvgpr_read_b32 v237,a173
M v[156:159],a[240:243],a[252:255],v[156:159]
v_add_f32 v236,v238,v237
v_sub_f32 v238,v238,v237
M v[156:159],a[216:219],a[232:235],v[156:159]
buffer_load_dwordx4 a[148:151],v250,s[20:23],s47 offen offset:1024 sc1
M v[156:159],a[100:103],a[96:99],v[156:159]
s_waitcnt vmcnt(32) lgkmcnt(3)
v_add_f32 v237,v77,v173
v_sub_f32 v173,v77,v173
M v[96:99],a[144:147],a[124:127],v[96:99]
s_waitcnt vmcnt(31) lgkmcnt(2)
ds_read_b128 a[132:135],v248 offset:1024
v_add_f32 v77,v236,v237
M v[96:99],a[104:107],a[120:123],v[96:99]
s_waitcnt vmcnt(30) lgkmcnt(2)
ds_read_b128 a[160:163],v249 offset:1024
v_fmac_f32 v236,4.0,v237
M v[96:99],a[156:159],a[140:143],v[96:99]
s_waitcnt lgkmcnt(2)
buffer_load_dwordx4 a[112:115],v250,s[20:23],s47 offen offset:2048 sc1
M v[100:103],a[156:159],a[108:111],v[100:103]
v_fma_f32 v237,2.0,v173,v238
v_fma_f32 v173,s40,v173,v238
M v[100:103],a[104:107],a[140:143],v[100:103]
v_cvt_pk_bf16_f32 v232,v232,v237
v_cvt_pk_bf16_f32 v234,v234,v236
M v[100:103],a[144:147],a[120:123],v[100:103]
v_accvgpr_read_b32 v238,a78
v_accvgpr_read_b32 v233,a174
M v[104:107],a[144:147],a[140:143],v[104:107]
ds_read_b128 a[96:99],v248 offset:1536
v_add_f32 v235,v238,v233
M v[104:107],a[104:107],a[108:111],v[104:107]
s_waitcnt lgkmcnt(2)
ds_read_b128 a[100:103],v249 offset:1536
v_sub_f32 v238,v238,v233
M v[104:107],a[156:159],a[132:135],v[104:107]
s_waitcnt lgkmcnt(2)
v_add_f32 v233,v78,v174
v_sub_f32 v174,v78,v174
M v[108:111],a[156:159],a[160:163],v[108:111]
v_add_f32 v78,v235,v233
v_fmac_f32 v235,4.0,v233
M v[108:111],a[104:107],a[132:135],v[108:111]
v_fma_f32 v233,2.0,v174,v238
v_fma_f32 v174,s40,v174,v238
M v[108:111],a[144:147],a[108:111],v[108:111]
v_accvgpr_read_b32 v238,a79
v_accvgpr_read_b32 v237,a175
M v[112:115],a[144:147],a[132:135],v[112:115]
s_add_u32 s48,s72,6144
ds_read_b128 a[172:175],v249 offset:2048
v_add_f32 v236,v238,v237
M v[112:115],a[104:107],a[160:163],v[112:115]
s_waitcnt lgkmcnt(2)
ds_read_b128 v[220:223],v248 offset:2048
v_sub_f32 v238,v238,v237
M v[112:115],a[156:159],a[96:99],v[112:115]
s_waitcnt lgkmcnt(2)
v_add_f32 v237,v79,v175
v_sub_f32 v175,v79,v175
M v[116:119],a[156:159],a[100:103],v[116:119]
v_add_f32 v79,v236,v237
v_fmac_f32 v236,4.0,v237
M v[116:119],a[104:107],a[96:99],v[116:119]
v_fma_f32 v237,2.0,v175,v238
v_fma_f32 v175,s40,v175,v238
M v[116:119],a[144:147],a[160:163],v[116:119]
v_cvt_pk_bf16_f32 v233,v233,v237
v_cvt_pk_bf16_f32 v235,v235,v236
M v[120:123],a[144:147],a[96:99],v[120:123]
buffer_load_dwordx4 a[224:227],v250,s[20:23],s48 offen offset:0 sc1
M v[120:123],a[104:107],a[100:103],v[120:123]
s_waitcnt lgkmcnt(1)
ds_write2st64_b64 v254,v[232:233],v[234:235] offset0:59 offset1:63
M v[120:123],a[156:159],a[172:175],v[120:123]
s_waitcnt lgkmcnt(1)
buffer_load_dwordx4 a[244:247],v250,s[20:23],s48 offen offset:1024 sc1
M v[124:127],a[156:159],v[220:223],v[124:127]
v_accvgpr_read_b32 v238,a80
v_accvgpr_read_b32 v232,a176
M v[124:127],a[104:107],a[172:175],v[124:127]
v_add_f32 v234,v238,v232
v_sub_f32 v238,v238,v232
M v[124:127],a[144:147],a[100:103],v[124:127]
s_waitcnt vmcnt(25)
v_add_f32 v232,v80,v176
v_sub_f32 v176,v80,v176
M v[128:131],v[228:231],a[124:127],v[128:131]
s_waitcnt vmcnt(24)
buffer_load_dwordx4 v[216:219],v250,s[20:23],s48 offen offset:2048 sc1
M v[128:131],a[212:215],a[120:123],v[128:131]
s_waitcnt vmcnt(24)
v_add_f32 v80,v234,v232
v_fmac_f32 v234,4.0,v232
M v[128:131],a[236:239],a[140:143],v[128:131]
v_fma_f32 v232,2.0,v176,v238
v_fma_f32 v176,s40,v176,v238
M v[132:135],a[236:239],a[108:111],v[132:135]
v_accvgpr_read_b32 v238,a81
v_accvgpr_read_b32 v237,a177
M v[132:135],a[212:215],a[140:143],v[132:135]
v_add_f32 v236,v238,v237
v_sub_f32 v238,v238,v237
M v[132:135],v[228:231],a[120:123],v[132:135]
v_add_f32 v237,v81,v177
v_sub_f32 v177,v81,v177
M v[136:139],v[228:231],a[140:143],v[136:139]
v_add_f32 v81,v236,v237
v_fmac_f32 v236,4.0,v237
M v[136:139],a[212:215],a[108:111],v[136:139]
v_fma_f32 v237,2.0,v177,v238
v_fma_f32 v177,s40,v177,v238
M v[136:139],a[236:239],a[132:135],v[136:139]
v_cvt_pk_bf16_f32 v232,v232,v237
v_cvt_pk_bf16_f32 v234,v234,v236
M v[140:143],a[236:239],a[160:163],v[140:143]
v_accvgpr_read_b32 v238,a82
v_accvgpr_read_b32 v233,a178
M v[140:143],a[212:215],a[132:135],v[140:143]
v_add_f32 v235,v238,v233
v_sub_f32 v238,v238,v233
M v[140:143],v[228:231],a[108:111],v[140:143]
v_add_f32 v233,v82,v178
v_sub_f32 v178,v82,v178
M v[144:147],v[228:231],a[132:135],v[144:147]
s_add_u32 s47,s73,3072
v_add_f32 v82,v235,v233
v_fmac_f32 v235,4.0,v233
M v[144:147],a[212:215],a[160:163],v[144:147]
v_fma_f32 v233,2.0,v178,v238
v_fma_f32 v178,s40,v178,v238
M v[144:147],a[236:239],a[96:99],v[144:147]
v_accvgpr_read_b32 v238,a83
v_accvgpr_read_b32 v237,a179
M v[148:151],a[236:239],a[100:103],v[148:151]
v_add_f32 v236,v238,v237
v_sub_f32 v238,v238,v237
M v[148:151],a[212:215],a[96:99],v[148:151]
ds_read_b128 a[156:159],v248 offset:17408
v_add_f32 v237,v83,v179
M v[148:151],v[228:231],a[160:163],v[148:151]
ds_read_b128 a[104:107],v249 offset:17408
v_sub_f32 v179,v83,v179
M v[152:155],v[228:231],a[96:99],v[152:155]
buffer_load_dwordx4 a[144:147],v250,s[20:23],s47 offen offset:0 sc1
M v[152:155],a[212:215],a[100:103],v[152:155]
ds_read_b128 a[124:127],v248 offset:17920
ds_read_b128 a[140:143],v249 offset:17920
M v[152:155],a[236:239],a[172:175],v[152:155]
buffer_load_dwordx4 a[120:123],v250,s[20:23],s47 offen offset:1024 sc1
M v[156:159],a[236:239],v[220:223],v[156:159]
v_add_f32 v83,v236,v237
v_fmac_f32 v236,4.0,v237
M v[156:159],a[212:215],a[172:175],v[156:159]
v_fma_f32 v237,2.0,v179,v238
v_fma_f32 v179,s40,v179,v238
M v[156:159],v[228:231],a[100:103],v[156:159]
s_waitcnt vmcnt(24) lgkmcnt(3)
v_cvt_pk_bf16_f32 v233,v233,v237
v_cvt_pk_bf16_f32 v235,v235,v236
M v[96:99],a[116:119],a[156:159],v[96:99]
s_waitcnt vmcnt(23) lgkmcnt(2)
buffer_load_dwordx4 a[108:111],v250,s[20:23],s47 offen offset:2048 sc1
M v[96:99],a[128:131],a[104:107],v[96:99]
s_waitcnt vmcnt(23) lgkmcnt(1)
ds_read_b128 a[132:135],v248 offset:18432
ds_read_b128 a[176:179],v249 offset:18432
M v[96:99],a[204:207],a[124:127],v[96:99]
s_waitcnt lgkmcnt(2)
ds_write2st64_b64 v254,v[232:233],v[234:235] offset0:0 offset1:4
M v[100:103],a[204:207],a[140:143],v[100:103]
v_accvgpr_read_b32 v238,a84
v_accvgpr_read_b32 v232,a180
M v[100:103],a[128:131],a[124:127],v[100:103]
v_add_f32 v234,v238,v232
v_sub_f32 v238,v238,v232
M v[100:103],a[116:119],a[104:107],v[100:103]
v_add_f32 v232,v84,v180
v_sub_f32 v180,v84,v180
M v[104:107],a[116:119],a[124:127],v[104:107]
ds_read_b128 a[160:163],v248 offset:18944
v_add_f32 v84,v234,v232
M v[104:107],a[128:131],a[140:143],v[104:107]
s_waitcnt lgkmcnt(3)
ds_read_b128 a[96:99],v249 offset:18944
v_fmac_f32 v234,4.0,v232
M v[104:107],a[204:207],a[132:135],v[104:107]
s_waitcnt lgkmcnt(3)
v_fma_f32 v232,2.0,v180,v238
v_fma_f32 v180,s40,v180,v238
M v[108:111],a[204:207],a[176:179],v[108:111]
v_accvgpr_read_b32 v238,a85
v_accvgpr_read_b32 v237,a181
M v[108:111],a[128:131],a[132:135],v[108:111]
v_add_f32 v236,v238,v237
v_sub_f32 v238,v238,v237
M v[108:111],a[116:119],a[140:143],v[108:111]
v_add_f32 v237,v85,v181
v_sub_f32 v181,v85,v181
M v[112:115],a[116:119],a[132:135],v[112:115]
s_add_u32 s48,s73,6144
ds_read_b128 a[172:175],v249 offset:19456
v_add_f32 v85,v236,v237
M v[112:115],a[128:131],a[176:179],v[112:115]
s_waitcnt lgkmcnt(2)
ds_read_b128 a[100:103],v248 offset:19456
v_fmac_f32 v236,4.0,v237
M v[112:115],a[204:207],a[160:163],v[112:115]
s_waitcnt lgkmcnt(2)
v_fma_f32 v237,2.0,v181,v238
v_fma_f32 v181,s40,v181,v238
M v[116:119],a[204:207],a[96:99],v[116:119]
v_cvt_pk_bf16_f32 v232,v232,v237
v_cvt_pk_bf16_f32 v234,v234,v236
M v[116:119],a[128:131],a[160:163],v[116:119]
v_accvgpr_read_b32 v238,a86
v_accvgpr_read_b32 v233,a182
M v[116:119],a[116:119],a[176:179],v[116:119]
v_add_f32 v235,v238,v233
v_sub_f32 v238,v238,v233
M v[120:123],a[116:119],a[160:163],v[120:123]
buffer_load_dwordx4 a[192:195],v250,s[20:23],s48 offen offset:0 sc1
M v[120:123],a[128:131],a[96:99],v[120:123]
s_waitcnt lgkmcnt(1)
v_add_f32 v233,v86,v182
v_sub_f32 v182,v86,v182
M v[120:123],a[204:207],a[172:175],v[120:123]
s_waitcnt lgkmcnt(0)
buffer_load_dwordx4 a[208:211],v250,s[20:23],s48 offen offset:1024 sc1
M v[124:127],a[204:207],a[100:103],v[124:127]
v_add_f32 v86,v235,v233
v_fmac_f32 v235,4.0,v233
M v[124:127],a[128:131],a[172:175],v[124:127]
v_fma_f32 v233,2.0,v182,v238
v_fma_f32 v182,s40,v182,v238
M v[124:127],a[116:119],a[96:99],v[124:127]
s_waitcnt vmcnt(23)
v_accvgpr_read_b32 v238,a87
v_accvgpr_read_b32 v237,a183
M v[128:131],a[248:251],a[156:159],v[128:131]
s_waitcnt vmcnt(22)
buffer_load_dwordx4 a[240:243],v250,s[20:23],s48 offen offset:2048 sc1
M v[128:131],v[224:227],a[104:107],v[128:131]
s_waitcnt vmcnt(22)
v_add_f32 v236,v238,v237
v_sub_f32 v238,v238,v237
M v[128:131],a[200:203],a[124:127],v[128:131]
v_add_f32 v237,v87,v183
v_sub_f32 v183,v87,v183
M v[132:135],a[200:203],a[140:143],v[132:135]
v_add_f32 v87,v236,v237
v_fmac_f32 v236,4.0,v237
M v[132:135],v[224:227],a[124:127],v[132:135]
v_fma_f32 v237,2.0,v183,v238
v_fma_f32 v183,s40,v183,v238
M v[132:135],a[248:251],a[104:107],v[132:135]
v_cvt_pk_bf16_f32 v233,v233,v237
v_cvt_pk_bf16_f32 v235,v235,v236
M v[136:139],a[248:251],a[124:127],v[136:139]
ds_write2st64_b64 v254,v[232:233],v[234:235] offset0:8 offset1:12
M v[136:139],v[224:227],a[140:143],v[136:139]
v_accvgpr_read_b32 v238,a88
v_accvgpr_read_b32 v232,a184
M v[136:139],a[200:203],a[132:135],v[136:139]
v_add_f32 v234,v238,v232
v_sub_f32 v238,v238,v232
M v[140:143],a[200:203],a[176:179],v[140:143]
v_add_f32 v232,v88,v184
v_sub_f32 v184,v88,v184
M v[140:143],v[224:227],a[132:135],v[140:143]
v_add_f32 v88,v234,v232
v_fmac_f32 v234,4.0,v232
M v[140:143],a[248:251],a[140:143],v[140:143]
v_fma_f32 v232,2.0,v184,v238
v_fma_f32 v184,s40,v184,v238
M v[144:147],a[248:251],a[132:135],v[144:147]
s_add_u32 s47,s74,3072
v_accvgpr_read_b32 v238,a89
v_accvgpr_read_b32 v237,a185
M v[144:147],v[224:227],a[176:179],v[144:147]
v_add_u32 v248,0xfffece00,v248
v_add_u32 v249,0xfffece00,v249
M v[144:147],a[200:203],a[160:163],v[144:147]
v_add_f32 v236,v238,v237
v_sub_f32 v238,v238,v237
M v[148:151],a[200:203],a[96:99],v[148:151]
v_add_f32 v237,v89,v185
v_sub_f32 v185,v89,v185
M v[148:151],v[224:227],a[160:163],v[148:151]
ds_read_b128 a[128:131],v248 offset:26112
v_add_f32 v89,v236,v237
M v[148:151],a[248:251],a[176:179],v[148:151]
ds_read_b128 a[116:119],v249 offset:26112
v_fmac_f32 v236,4.0,v237
M v[152:155],a[248:251],a[160:163],v[152:155]
buffer_load_dwordx4 a[156:159],v250,s[20:23],s47 offen offset:0 sc1
M v[152:155],v[224:227],a[96:99],v[152:155]
ds_read_b128 a[180:183],v248 offset:26624
ds_read_b128 a[124:127],v249 offset:26624
M v[152:155],a[200:203],a[172:175],v[152:155]
buffer_load_dwordx4 a[104:107],v250,s[20:23],s47 offen offset:1024 sc1
M v[156:159],a[200:203],a[100:103],v[156:159]
v_fma_f32 v237,2.0,v185,v238
v_fma_f32 v185,s40,v185,v238
M v[156:159],v[224:227],a[172:175],v[156:159]
v_cvt_pk_bf16_f32 v232,v232,v237
v_cvt_pk_bf16_f32 v234,v234,v236
M v[156:159],a[248:251],a[96:99],v[156:159]
s_waitcnt vmcnt(22) lgkmcnt(3)
v_accvgpr_read_b32 v238,a90
v_accvgpr_read_b32 v233,a186
M v[96:99],a[152:155],a[128:131],v[96:99]
s_waitcnt vmcnt(21) lgkmcnt(2)
buffer_load_dwordx4 a[140:143],v250,s[20:23],s47 offen offset:2048 sc1
M v[96:99],a[136:139],a[116:119],v[96:99]
s_waitcnt vmcnt(21) lgkmcnt(1)
ds_read_b128 a[132:135],v248 offset:27136
ds_read_b128 a[176:179],v249 offset:27136
M v[96:99],a[164:167],a[180:183],v[96:99]
s_waitcnt lgkmcnt(2)
v_add_f32 v235,v238,v233
v_sub_f32 v238,v238,v233
M v[100:103],a[164:167],a[124:127],v[100:103]
v_add_f32 v233,v90,v186
v_sub_f32 v186,v90,v186
M v[100:103],a[136:139],a[180:183],v[100:103]
v_add_f32 v90,v235,v233
v_fmac_f32 v235,4.0,v233
M v[100:103],a[152:155],a[116:119],v[100:103]
v_fma_f32 v233,2.0,v186,v238
v_fma_f32 v186,s40,v186,v238
M v[104:107],a[152:155],a[180:183],v[104:107]
ds_read_b128 a[160:163],v248 offset:27648
v_accvgpr_read_b32 v238,a91
M v[104:107],a[136:139],a[124:127],v[104:107]
s_waitcnt lgkmcnt(2)
ds_read_b128 a[100:103],v249 offset:27648
v_accvgpr_read_b32 v237,a187
M v[104:107],a[164:167],a[132:135],v[104:107]
s_waitcnt lgkmcnt(2)
v_add_f32 v236,v238,v237
v_sub_f32 v238,v238,v237
M v[108:111],a[164:167],a[176:179],v[108:111]
v_add_f32 v237,v91,v187
v_sub_f32 v187,v91,v187
M v[108:111],a[136:139],a[132:135],v[108:111]
v_add_f32 v91,v236,v237
v_fmac_f32 v236,4.0,v237
M v[108:111],a[152:155],a[124:127],v[108:111]
v_fma_f32 v237,2.0,v187,v238
v_fma_f32 v187,s40,v187,v238
M v[112:115],a[152:155],a[132:135],v[112:115]
s_add_u32 s48,s74,6144
ds_read_b128 a[172:175],v249 offset:28160
v_cvt_pk_bf16_f32 v233,v233,v237
M v[112:115],a[136:139],a[176:179],v[112:115]
s_waitcnt lgkmcnt(2)
ds_read_b128 a[96:99],v248 offset:28160
v_cvt_pk_bf16_f32 v235,v235,v236
M v[112:115],a[164:167],a[160:163],v[112:115]
s_waitcnt lgkmcnt(2)
ds_write2st64_b64 v254,v[232:233],v[234:235] offset0:17 offset1:21
M v[116:119],a[164:167],a[100:103],v[116:119]
v_accvgpr_read_b32 v238,a92
v_accvgpr_read_b32 v232,a188
M v[116:119],a[136:139],a[160:163],v[116:119]
v_add_f32 v234,v238,v232
v_sub_f32 v238,v238,v232
M v[116:119],a[152:155],a[176:179],v[116:119]
v_add_f32 v232,v92,v188
v_sub_f32 v188,v92,v188
M v[120:123],a[152:155],a[160:163],v[120:123]
buffer_load_dwordx4 a[184:187],v250,s[20:23],s48 offen offset:0 sc1
M v[120:123],a[136:139],a[100:103],v[120:123]
s_waitcnt lgkmcnt(2)
v_add_f32 v92,v234,v232
v_fmac_f32 v234,4.0,v232
M v[120:123],a[164:167],a[172:175],v[120:123]
s_waitcnt lgkmcnt(1)
buffer_load_dwordx4 a[252:255],v250,s[20:23],s48 offen offset:1024 sc1
M v[124:127],a[164:167],a[96:99],v[124:127]
v_fma_f32 v232,2.0,v188,v238
v_fma_f32 v188,s40,v188,v238
M v[124:127],a[136:139],a[172:175],v[124:127]
v_accvgpr_read_b32 v238,a93
v_accvgpr_read_b32 v237,a189
M v[124:127],a[152:155],a[100:103],v[124:127]
s_waitcnt vmcnt(21)
v_add_f32 v236,v238,v237
v_sub_f32 v238,v238,v237
M v[128:131],a[228:231],a[128:131],v[128:131]
s_waitcnt vmcnt(20)
buffer_load_dwordx4 a[216:219],v250,s[20:23],s48 offen offset:2048 sc1
M v[128:131],a[196:199],a[116:119],v[128:131]
s_waitcnt vmcnt(20)
v_add_f32 v237,v93,v189
v_sub_f32 v189,v93,v189
M v[128:131],a[220:223],a[180:183],v[128:131]
v_add_f32 v93,v236,v237
v_fmac_f32 v236,4.0,v237
M v[132:135],a[220:223],a[124:127],v[132:135]
v_fma_f32 v237,2.0,v189,v238
v_fma_f32 v189,s40,v189,v238
M v[132:135],a[196:199],a[180:183],v[132:135]
v_cvt_pk_bf16_f32 v232,v232,v237
v_cvt_pk_bf16_f32 v234,v234,v236
M v[132:135],a[228:231],a[116:119],v[132:135]
v_accvgpr_read_b32 v238,a94
v_accvgpr_read_b32 v233,a190
M v[136:139],a[228:231],a[180:183],v[136:139]
v_add_f32 v235,v238,v233
v_sub_f32 v238,v238,v233
M v[136:139],a[196:199],a[124:127],v[136:139]
v_add_f32 v233,v94,v190
v_sub_f32 v190,v94,v190
M v[136:139],a[220:223],a[132:135],v[136:139]
v_add_f32 v94,v235,v233
v_fmac_f32 v235,4.0,v233
M v[140:143],a[220:223],a[176:179],v[140:143]
v_fma_f32 v233,2.0,v190,v238
v_fma_f32 v190,s40,v190,v238
M v[140:143],a[196:199],a[132:135],v[140:143]
v_accvgpr_read_b32 v238,a95
v_accvgpr_read_b32 v237,a191
M v[140:143],a[228:231],a[124:127],v[140:143]
v_add_f32 v236,v238,v237
v_sub_f32 v238,v238,v237
M v[144:147],a[228:231],a[132:135],v[144:147]
s_add_u32 s47,s75,3072
v_add_f32 v237,v95,v191
v_sub_f32 v191,v95,v191
M v[144:147],a[196:199],a[176:179],v[144:147]
v_add_f32 v95,v236,v237
v_fmac_f32 v236,4.0,v237
M v[144:147],a[220:223],a[160:163],v[144:147]
v_fma_f32 v237,2.0,v191,v238
v_fma_f32 v191,s40,v191,v238
M v[148:151],a[220:223],a[100:103],v[148:151]
v_cvt_pk_bf16_f32 v233,v233,v237
v_cvt_pk_bf16_f32 v235,v235,v236
M v[148:151],a[196:199],a[160:163],v[148:151]
ds_read_b128 a[164:167],v248 offset:0
ds_write2st64_b64 v254,v[232:233],v[234:235] offset0:25 offset1:29
M v[148:151],a[228:231],a[176:179],v[148:151]
ds_read_b128 a[136:139],v249 offset:0
v_cvt_pk_bf16_f32 v96,v96,v97
M v[152:155],a[228:231],a[160:163],v[152:155]
buffer_load_dwordx4 a[152:155],v250,s[20:23],s47 offen offset:0 sc1
M v[152:155],a[196:199],a[100:103],v[152:155]
ds_read_b128 a[128:131],v248 offset:512
ds_read_b128 a[180:183],v249 offset:512
M v[152:155],a[220:223],a[172:175],v[152:155]
buffer_load_dwordx4 a[116:119],v250,s[20:23],s47 offen offset:1024 sc1
M v[156:159],a[220:223],a[96:99],v[156:159]
v_cvt_pk_bf16_f32 v97,v98,v99
v_cvt_pk_bf16_f32 v100,v100,v101
M v[156:159],a[196:199],a[172:175],v[156:159]
v_cvt_pk_bf16_f32 v101,v102,v103
M v[156:159],a[228:231],a[100:103],v[156:159]
s_waitcnt vmcnt(19) lgkmcnt(3)
s_barrier
ds_read_b128 a[64:67],v250 offset:17408
M v[32:35],a[168:171],a[164:167],v[32:35]
s_waitcnt vmcnt(18) lgkmcnt(3)
ds_read_b128 a[68:71],v250 offset:21504
ds_read_b128 a[72:75],v250 offset:26112
M v[32:35],a[148:151],a[136:139],v[32:35]
s_waitcnt vmcnt(17) lgkmcnt(4)
ds_read_b128 a[76:79],v250 offset:30208
ds_read_b128 a[80:83],v250 offset:0
M v[32:35],a[112:115],a[128:131],v[32:35]
s_waitcnt lgkmcnt(5)
ds_read_b128 a[84:87],v250 offset:4096
ds_read_b128 a[88:91],v250 offset:8704
M v[36:39],a[112:115],a[180:183],v[36:39]
ds_read_b128 a[92:95],v250 offset:12800
ds_read_b128 a[188:191],v248 offset:1024
M v[36:39],a[148:151],a[128:131],v[36:39]
s_add_u32 s34,s32,6291456
buffer_load_dwordx4 a[124:127],v250,s[20:23],s47 offen offset:2048 sc1
ds_read_b128 a[132:135],v249 offset:1024
M v[36:39],a[168:171],a[136:139],v[36:39]
ds_write2st64_b64 v254,v[96:97],v[100:101] offset0:68 offset1:72
M v[40:43],a[168:171],a[128:131],v[40:43]
ds_read_b128 a[176:179],v248 offset:1536
v_cvt_pk_bf16_f32 v104,v104,v105
M v[40:43],a[148:151],a[180:183],v[40:43]
s_waitcnt lgkmcnt(3)
ds_read_b128 a[160:163],v249 offset:1536
v_cvt_pk_bf16_f32 v105,v106,v107
M v[40:43],a[112:115],a[188:191],v[40:43]
s_waitcnt lgkmcnt(3)
buffer_store_dwordx4 a[64:67],v253,s[24:27],s34 offen offset:640 nt
M v[44:47],a[112:115],a[132:135],v[44:47]
s_add_u32 s34,s32,6488064
v_cvt_pk_bf16_f32 v108,v108,v109
v_cvt_pk_bf16_f32 v109,v110,v111
M v[44:47],a[148:151],a[188:191],v[44:47]
ds_write2st64_b64 v254,v[104:105],v[108:109] offset0:76 offset1:80
M v[44:47],a[168:171],a[180:183],v[44:47]
buffer_store_dwordx4 a[68:71],v253,s[24:27],s34 offen offset:640 nt
M v[48:51],a[168:171],a[188:191],v[48:51]
s_add_u32 s34,s32,6684672
ds_read_b128 a[96:99],v249 offset:2048
s_add_u32 s48,s75,6144
M v[48:51],a[148:151],a[132:135],v[48:51]
s_waitcnt lgkmcnt(3)
ds_read_b128 a[172:175],v248 offset:2048
v_cvt_pk_bf16_f32 v112,v112,v113
M v[48:51],a[112:115],a[176:179],v[48:51]
s_waitcnt lgkmcnt(3)
buffer_store_dwordx4 a[72:75],v253,s[24:27],s34 offen offset:640 nt
M v[52:55],a[112:115],a[160:163],v[52:55]
s_add_u32 s34,s32,6881280
v_cvt_pk_bf16_f32 v113,v114,v115
v_cvt_pk_bf16_f32 v116,v116,v117
M v[52:55],a[148:151],a[176:179],v[52:55]
v_cvt_pk_bf16_f32 v117,v118,v119
M v[52:55],a[168:171],a[132:135],v[52:55]
buffer_store_dwordx4 a[76:79],v253,s[24:27],s34 offen offset:640 nt
M v[56:59],a[168:171],a[176:179],v[56:59]
s_add_u32 s34,s32,7077888
buffer_load_dwordx4 a[100:103],v250,s[20:23],s48 offen offset:0 sc1
M v[56:59],a[148:151],a[160:163],v[56:59]
s_waitcnt lgkmcnt(1)
ds_write2st64_b64 v254,v[112:113],v[116:117] offset0:85 offset1:89
M v[56:59],a[112:115],a[96:99],v[56:59]
s_waitcnt lgkmcnt(1)
v_cvt_pk_bf16_f32 v120,v120,v121
v_cvt_pk_bf16_f32 v121,v122,v123
M v[60:63],a[112:115],a[172:175],v[60:63]
v_cvt_pk_bf16_f32 v124,v124,v125
v_cvt_pk_bf16_f32 v125,v126,v127
M v[60:63],a[148:151],a[96:99],v[60:63]
buffer_load_dwordx4 a[232:235],v250,s[20:23],s48 offen offset:1024 sc1
M v[60:63],a[168:171],a[160:163],v[60:63]
s_waitcnt vmcnt(23)
ds_write2st64_b64 v254,v[120:121],v[124:125] offset0:93 offset1:97
M v[64:67],a[224:227],a[164:167],v[64:67]
s_waitcnt vmcnt(22)
v_cvt_pk_bf16_f32 v128,v128,v129
v_cvt_pk_bf16_f32 v129,v130,v131
M v[64:67],a[244:247],a[136:139],v[64:67]
s_waitcnt vmcnt(21)
buffer_load_dwordx4 a[236:239],v250,s[20:23],s48 offen offset:2048 sc1
M v[64:67],v[216:219],a[128:131],v[64:67]
v_cvt_pk_bf16_f32 v132,v132,v133
v_cvt_pk_bf16_f32 v133,v134,v135
M v[68:71],v[216:219],a[180:183],v[68:71]
s_waitcnt lgkmcnt(0)
s_barrier
ds_read_b128 v[96:99],v250 offset:34816
M v[68:71],a[244:247],a[128:131],v[68:71]
ds_read_b128 v[104:107],v250 offset:38912
ds_read_b128 v[112:115],v250 offset:43520
M v[68:71],a[224:227],a[136:139],v[68:71]
ds_read_b128 v[120:123],v250 offset:47616
buffer_store_dwordx4 a[80:83],v253,s[24:27],s34 offen offset:640 nt
M v[72:75],a[224:227],a[128:131],v[72:75]
s_add_u32 s34,s32,7274496
ds_write2st64_b64 v254,v[128:129],v[132:133] offset0:34 offset1:38
M v[72:75],a[244:247],a[180:183],v[72:75]
v_cvt_pk_bf16_f32 v136,v136,v137
v_cvt_pk_bf16_f32 v137,v138,v139
M v[72:75],v[216:219],a[188:191],v[72:75]
buffer_store_dwordx4 a[84:87],v253,s[24:27],s34 offen offset:640 nt
M v[76:79],v[216:219],a[132:135],v[76:79]
s_add_u32 s34,s32,7471104
v_cvt_pk_bf16_f32 v140,v140,v141
v_cvt_pk_bf16_f32 v141,v142,v143
M v[76:79],a[244:247],a[188:191],v[76:79]
ds_write2st64_b64 v254,v[136:137],v[140:141] offset0:42 offset1:46
M v[76:79],a[224:227],a[180:183],v[76:79]
buffer_store_dwordx4 a[88:91],v253,s[24:27],s34 offen offset:640 nt
M v[80:83],a[224:227],a[188:191],v[80:83]
s_add_u32 s34,s32,7667712
s_add_u32 s47,s76,3072
v_cvt_pk_bf16_f32 v144,v144,v145
M v[80:83],a[244:247],a[132:135],v[80:83]
v_cvt_pk_bf16_f32 v145,v146,v147
v_cvt_pk_bf16_f32 v148,v148,v149
M v[80:83],v[216:219],a[176:179],v[80:83]
buffer_store_dwordx4 a[92:95],v253,s[24:27],s34 offen offset:640 nt
M v[84:87],v[216:219],a[160:163],v[84:87]
v_cvt_pk_bf16_f32 v149,v150,v151
M v[84:87],a[244:247],a[176:179],v[84:87]
ds_read_b128 a[112:115],v248 offset:34816
ds_write2st64_b64 v254,v[144:145],v[148:149] offset0:51 offset1:55
M v[84:87],a[224:227],a[132:135],v[84:87]
ds_read_b128 a[148:151],v249 offset:34816
v_cvt_pk_bf16_f32 v152,v152,v153
M v[88:91],a[224:227],a[176:179],v[88:91]
buffer_load_dwordx4 a[168:171],v250,s[20:23],s47 offen offset:0 sc1
M v[88:91],a[244:247],a[160:163],v[88:91]
ds_read_b128 a[164:167],v248 offset:35328
ds_read_b128 a[128:131],v249 offset:35328
M v[88:91],v[216:219],a[96:99],v[88:91]
buffer_load_dwordx4 a[136:139],v250,s[20:23],s47 offen offset:1024 sc1
M v[92:95],v[216:219],a[172:175],v[92:95]
v_cvt_pk_bf16_f32 v153,v154,v155
v_cvt_pk_bf16_f32 v156,v156,v157
M v[92:95],a[244:247],a[96:99],v[92:95]
v_cvt_pk_bf16_f32 v157,v158,v159
M v[92:95],a[224:227],a[160:163],v[92:95]
s_waitcnt vmcnt(27) lgkmcnt(4)
ds_write2st64_b64 v254,v[152:153],v[156:157] offset0:59 offset1:63
M v[32:35],a[144:147],a[112:115],v[32:35]
s_waitcnt vmcnt(26) lgkmcnt(3)
s_add_u32 s34,s33,6291456
buffer_load_dwordx4 a[180:183],v250,s[20:23],s47 offen offset:2048 sc1
M v[32:35],a[120:123],a[148:151],v[32:35]
s_waitcnt vmcnt(26) lgkmcnt(2)
ds_read_b128 a[188:191],v248 offset:35840
ds_read_b128 a[132:135],v249 offset:35840
M v[32:35],a[108:111],a[164:167],v[32:35]
s_waitcnt lgkmcnt(2)
s_barrier
ds_read_b128 v[128:131],v250 offset:17408
M v[36:39],a[108:111],a[128:131],v[36:39]
ds_read_b128 v[136:139],v250 offset:21504
ds_read_b128 v[144:147],v250 offset:26112
M v[36:39],a[120:123],a[164:167],v[36:39]
ds_read_b128 v[152:155],v250 offset:30208
M v[36:39],a[144:147],a[148:151],v[36:39]
buffer_store_dwordx4 v[96:99],v253,s[24:27],s34 offen offset:1152 nt
M v[40:43],a[144:147],a[164:167],v[40:43]
ds_read_b128 a[176:179],v248 offset:36352
M v[40:43],a[120:123],a[128:131],v[40:43]
s_waitcnt lgkmcnt(6)
ds_read_b128 a[172:175],v249 offset:36352
M v[40:43],a[108:111],a[188:191],v[40:43]
s_waitcnt lgkmcnt(2)
s_barrier
M v[44:47],a[108:111],a[132:135],v[44:47]
M v[44:47],a[120:123],a[188:191],v[44:47]
M v[44:47],a[144:147],a[128:131],v[44:47]
M v[48:51],a[144:147],a[188:191],v[48:51]
s_add_u32 s48,s76,6144
ds_read_b128 a[96:99],v249 offset:36864
M v[48:51],a[120:123],a[132:135],v[48:51]
s_waitcnt lgkmcnt(2)
ds_read_b128 a[160:163],v248 offset:36864
M v[48:51],a[108:111],a[176:179],v[48:51]
s_waitcnt lgkmcnt(2)
M v[52:55],a[108:111],a[172:175],v[52:55]
M v[52:55],a[120:123],a[176:179],v[52:55]
M v[52:55],a[144:147],a[132:135],v[52:55]
M v[56:59],a[144:147],a[176:179],v[56:59]
buffer_load_dwordx4 v[220:223],v250,s[20:23],s48 offen offset:0 sc1
M v[56:59],a[120:123],a[172:175],v[56:59]
s_waitcnt lgkmcnt(1)
M v[56:59],a[108:111],a[96:99],v[56:59]
s_waitcnt lgkmcnt(0)
buffer_load_dwordx4 a[212:215],v250,s[20:23],s48 offen offset:1024 sc1
M v[60:63],a[108:111],a[160:163],v[60:63]
M v[60:63],a[120:123],a[96:99],v[60:63]
s_add_u32 s34,s33,6684672
M v[60:63],a[144:147],a[172:175],v[60:63]
s_waitcnt vmcnt(28)
M v[64:67],a[192:195],a[112:115],v[64:67]
s_waitcnt vmcnt(27)
buffer_load_dwordx4 v[228:231],v250,s[20:23],s48 offen offset:2048 sc1
M v[64:67],a[208:211],a[148:151],v[64:67]
s_waitcnt vmcnt(27)
M v[64:67],a[240:243],a[164:167],v[64:67]
M v[68:71],a[240:243],a[128:131],v[68:71]
M v[68:71],a[208:211],a[164:167],v[68:71]
M v[68:71],a[192:195],a[148:151],v[68:71]
buffer_store_dwordx4 v[104:107],v253,s[24:27],s34 offen offset:1152 nt
M v[72:75],a[192:195],a[164:167],v[72:75]
M v[72:75],a[208:211],a[128:131],v[72:75]
M v[72:75],a[240:243],a[188:191],v[72:75]
M v[76:79],a[240:243],a[132:135],v[76:79]
M v[76:79],a[208:211],a[188:191],v[76:79]
M v[76:79],a[192:195],a[128:131],v[76:79]
M v[80:83],a[192:195],a[188:191],v[80:83]
s_add_u32 s47,s77,3072
M v[80:83],a[208:211],a[132:135],v[80:83]
M v[80:83],a[240:243],a[176:179],v[80:83]
M v[84:87],a[240:243],a[172:175],v[84:87]
M v[84:87],a[208:211],a[176:179],v[84:87]
ds_read_b128 a[108:111],v248 offset:52224
M v[84:87],a[192:195],a[132:135],v[84:87]
ds_read_b128 a[120:123],v249 offset:52224
M v[88:91],a[192:195],a[176:179],v[88:91]
buffer_load_dwordx4 a[144:147],v250,s[20:23],s47 offen offset:0 sc1
M v[88:91],a[208:211],a[172:175],v[88:91]
ds_read_b128 a[112:115],v248 offset:52736
ds_read_b128 a[164:167],v249 offset:52736
M v[88:91],a[240:243],a[96:99],v[88:91]
s_add_u32 s34,s33,7077888
buffer_load_dwordx4 a[148:151],v250,s[20:23],s47 offen offset:1024 sc1
M v[92:95],a[240:243],a[160:163],v[92:95]
M v[92:95],a[208:211],a[96:99],v[92:95]
M v[92:95],a[192:195],a[172:175],v[92:95]
s_waitcnt vmcnt(29) lgkmcnt(3)
M v[32:35],a[156:159],a[108:111],v[32:35]
s_waitcnt vmcnt(28) lgkmcnt(2)
buffer_load_dwordx4 a[128:131],v250,s[20:23],s47 offen offset:2048 sc1
M v[32:35],a[104:107],a[120:123],v[32:35]
s_waitcnt vmcnt(28) lgkmcnt(1)
ds_read_b128 a[188:191],v248 offset:53248
ds_read_b128 a[132:135],v249 offset:53248
M v[32:35],a[140:143],a[112:115],v[32:35]
s_waitcnt lgkmcnt(2)
M v[36:39],a[140:143],a[164:167],v[36:39]
M v[36:39],a[104:107],a[112:115],v[36:39]
M v[36:39],a[156:159],a[120:123],v[36:39]
buffer_store_dwordx4 v[112:115],v253,s[24:27],s34 offen offset:1152 nt
M v[40:43],a[156:159],a[112:115],v[40:43]
ds_read_b128 a[176:179],v248 offset:53760
M v[40:43],a[104:107],a[164:167],v[40:43]
s_waitcnt lgkmcnt(2)
ds_read_b128 a[160:163],v249 offset:53760
M v[40:43],a[140:143],a[188:191],v[40:43]
s_waitcnt lgkmcnt(2)
M v[44:47],a[140:143],a[132:135],v[44:47]
M v[44:47],a[104:107],a[188:191],v[44:47]
M v[44:47],a[156:159],a[164:167],v[44:47]
M v[48:51],a[156:159],a[188:191],v[48:51]
s_add_u32 s48,s77,6144
ds_read_b128 a[96:99],v249 offset:54272
M v[48:51],a[104:107],a[132:135],v[48:51]
s_waitcnt lgkmcnt(2)
ds_read_b128 a[172:175],v248 offset:54272
M v[48:51],a[140:143],a[176:179],v[48:51]
s_waitcnt lgkmcnt(2)
M v[52:55],a[140:143],a[160:163],v[52:55]
M v[52:55],a[104:107],a[176:179],v[52:55]
M v[52:55],a[156:159],a[132:135],v[52:55]
M v[56:59],a[156:159],a[176:179],v[56:59]
s_add_u32 s34,s33,7471104
buffer_load_dwordx4 a[204:207],v250,s[20:23],s48 offen offset:0 sc1
M v[56:59],a[104:107],a[160:163],v[56:59]
s_waitcnt lgkmcnt(1)
M v[56:59],a[140:143],a[96:99],v[56:59]
s_waitcnt lgkmcnt(0)
buffer_store_dwordx4 v[120:123],v253,s[24:27],s34 offen offset:1152 nt
M v[60:63],a[140:143],a[172:175],v[60:63]
M v[60:63],a[104:107],a[96:99],v[60:63]
M v[60:63],a[156:159],a[160:163],v[60:63]
s_waitcnt vmcnt(30)
buffer_load_dwordx4 a[200:203],v250,s[20:23],s48 offen offset:1024 sc1
M v[64:67],a[184:187],a[108:111],v[64:67]
s_waitcnt vmcnt(30)
M v[64:67],a[252:255],a[120:123],v[64:67]
s_waitcnt vmcnt(29)
M v[64:67],a[216:219],a[112:115],v[64:67]
M v[68:71],a[216:219],a[164:167],v[68:71]
buffer_load_dwordx4 v[224:227],v250,s[20:23],s48 offen offset:2048 sc1
M v[68:71],a[252:255],a[112:115],v[68:71]
M v[68:71],a[184:187],a[120:123],v[68:71]
M v[72:75],a[184:187],a[112:115],v[72:75]
M v[72:75],a[252:255],a[164:167],v[72:75]
M v[72:75],a[216:219],a[188:191],v[72:75]
M v[76:79],a[216:219],a[132:135],v[76:79]
M v[76:79],a[252:255],a[188:191],v[76:79]
M v[76:79],a[184:187],a[164:167],v[76:79]
M v[80:83],a[184:187],a[188:191],v[80:83]
s_add_u32 s48,s72,52224
M v[80:83],a[252:255],a[132:135],v[80:83]
v_add_u32 v248,0x11000,v248
v_add_u32 v249,0x11000,v249
M v[80:83],a[216:219],a[176:179],v[80:83]
M v[84:87],a[216:219],a[160:163],v[84:87]
M v[84:87],a[252:255],a[176:179],v[84:87]
s_add_u32 s34,s33,6291456
ds_read_b128 a[140:143],v248 offset:0
M v[84:87],a[184:187],a[132:135],v[84:87]
buffer_store_dwordx4 v[128:131],v253,s[24:27],s34 offen offset:1280 nt
M v[88:91],a[184:187],a[176:179],v[88:91]
buffer_load_dwordx4 a[156:159],v250,s[20:23],s48 offen offset:0 sc1
M v[88:91],a[252:255],a[160:163],v[88:91]
ds_read_b128 a[104:107],v249 offset:0
ds_read_b128 a[108:111],v248 offset:512
M v[88:91],a[216:219],a[96:99],v[88:91]
ds_read_b128 a[112:115],v249 offset:512
M v[92:95],a[216:219],a[172:175],v[92:95]
M v[92:95],a[252:255],a[96:99],v[92:95]
buffer_load_dwordx4 a[120:123],v250,s[20:23],s48 offen offset:1024 sc1
M v[92:95],a[184:187],a[160:163],v[92:95]
s_waitcnt vmcnt(32) lgkmcnt(3)
M v[32:35],a[152:155],a[140:143],v[32:35]
s_waitcnt vmcnt(31) lgkmcnt(2)
ds_read_b128 a[188:191],v248 offset:1024
M v[32:35],a[116:119],a[104:107],v[32:35]
s_waitcnt vmcnt(30) lgkmcnt(2)
ds_read_b128 a[132:135],v249 offset:1024
M v[32:35],a[124:127],a[108:111],v[32:35]
s_waitcnt lgkmcnt(2)
buffer_load_dwordx4 a[164:167],v250,s[20:23],s48 offen offset:2048 sc1
M v[36:39],a[124:127],a[112:115],v[36:39]
M v[36:39],a[116:119],a[108:111],v[36:39]
M v[36:39],a[152:155],a[104:107],v[36:39]
M v[40:43],a[152:155],a[108:111],v[40:43]
ds_read_b128 a[176:179],v248 offset:1536
M v[40:43],a[116:119],a[112:115],v[40:43]
s_waitcnt lgkmcnt(2)
ds_read_b128 a[172:175],v249 offset:1536
M v[40:43],a[124:127],a[188:191],v[40:43]
s_waitcnt lgkmcnt(2)
M v[44:47],a[124:127],a[132:135],v[44:47]
M v[44:47],a[116:119],a[188:191],v[44:47]
M v[44:47],a[152:155],a[112:115],v[44:47]
M v[48:51],a[152:155],a[188:191],v[48:51]
s_add_u32 s48,s73,52224
ds_read_b128 a[96:99],v249 offset:2048
M v[48:51],a[116:119],a[132:135],v[48:51]
s_waitcnt lgkmcnt(2)
ds_read_b128 a[160:163],v248 offset:2048
M v[48:51],a[124:127],a[176:179],v[48:51]
s_waitcnt lgkmcnt(2)
M v[52:55],a[124:127],a[172:175],v[52:55]
s_add_u32 s34,s33,6684672
M v[52:55],a[116:119],a[176:179],v[52:55]
M v[52:55],a[152:155],a[132:135],v[52:55]
buffer_store_dwordx4 v[136:139],v253,s[24:27],s34 offen offset:1280 nt
M v[56:59],a[152:155],a[176:179],v[56:59]
buffer_load_dwordx4 a[184:187],v250,s[20:23],s48 offen offset:0 sc1
M v[56:59],a[116:119],a[172:175],v[56:59]
s_waitcnt lgkmcnt(1)
M v[56:59],a[124:127],a[96:99],v[56:59]
s_waitcnt lgkmcnt(0)
M v[60:63],a[124:127],a[160:163],v[60:63]
M v[60:63],a[116:119],a[96:99],v[60:63]
buffer_load_dwordx4 a[248:251],v250,s[20:23],s48 offen offset:1024 sc1
M v[60:63],a[152:155],a[172:175],v[60:63]
s_waitcnt vmcnt(29)
M v[64:67],a[100:103],a[140:143],v[64:67]
s_waitcnt vmcnt(28)
M v[64:67],a[232:235],a[104:107],v[64:67]
s_waitcnt vmcnt(27)
M v[64:67],a[236:239],a[108:111],v[64:67]
buffer_load_dwordx4 a[220:223],v250,s[20:23],s48 offen offset:2048 sc1
M v[68:71],a[236:239],a[112:115],v[68:71]
M v[68:71],a[232:235],a[108:111],v[68:71]
M v[68:71],a[100:103],a[104:107],v[68:71]
M v[72:75],a[100:103],a[108:111],v[72:75]
M v[72:75],a[232:235],a[112:115],v[72:75]
M v[72:75],a[236:239],a[188:191],v[72:75]
M v[76:79],a[236:239],a[132:135],v[76:79]
M v[76:79],a[232:235],a[188:191],v[76:79]
M v[76:79],a[100:103],a[112:115],v[76:79]
M v[80:83],a[100:103],a[188:191],v[80:83]
s_add_u32 s48,s74,52224
M v[80:83],a[232:235],a[132:135],v[80:83]
s_add_u32 s34,s33,7077888
M v[80:83],a[236:239],a[176:179],v[80:83]
buffer_store_dwordx4 v[144:147],v253,s[24:27],s34 offen offset:1280 nt
M v[84:87],a[236:239],a[172:175],v[84:87]
M v[84:87],a[232:235],a[176:179],v[84:87]
ds_read_b128 a[124:127],v248 offset:17408
M v[84:87],a[100:103],a[132:135],v[84:87]
ds_read_b128 a[116:119],v249 offset:17408
M v[88:91],a[100:103],a[176:179],v[88:91]
buffer_load_dwordx4 a[152:155],v250,s[20:23],s48 offen offset:0 sc1
M v[88:91],a[232:235],a[172:175],v[88:91]
ds_read_b128 a[140:143],v248 offset:17920
ds_read_b128 a[108:111],v249 offset:17920
M v[88:91],a[236:239],a[96:99],v[88:91]
buffer_load_dwordx4 a[104:107],v250,s[20:23],s48 offen offset:1024 sc1
M v[92:95],a[236:239],a[160:163],v[92:95]
M v[92:95],a[232:235],a[96:99],v[92:95]
M v[92:95],a[100:103],a[172:175],v[92:95]
s_waitcnt vmcnt(26) lgkmcnt(3)
M v[32:35],a[168:171],a[124:127],v[32:35]
s_waitcnt vmcnt(25) lgkmcnt(2)
buffer_load_dwordx4 a[112:115],v250,s[20:23],s48 offen offset:2048 sc1
M v[32:35],a[136:139],a[116:119],v[32:35]
s_waitcnt vmcnt(25) lgkmcnt(1)
ds_read_b128 a[188:191],v248 offset:18432
ds_read_b128 a[132:135],v249 offset:18432
M v[32:35],a[180:183],a[140:143],v[32:35]
s_waitcnt lgkmcnt(2)
M v[36:39],a[180:183],a[108:111],v[36:39]
M v[36:39],a[136:139],a[140:143],v[36:39]
M v[36:39],a[168:171],a[116:119],v[36:39]
M v[40:43],a[168:171],a[140:143],v[40:43]
ds_read_b128 a[176:179],v248 offset:18944
M v[40:43],a[136:139],a[108:111],v[40:43]
s_waitcnt lgkmcnt(2)
ds_read_b128 a[160:163],v249 offset:18944
M v[40:43],a[180:183],a[188:191],v[40:43]
s_waitcnt lgkmcnt(2)
M v[44:47],a[180:183],a[132:135],v[44:47]
M v[44:47],a[136:139],a[188:191],v[44:47]
M v[44:47],a[168:171],a[108:111],v[44:47]
s_add_u32 s34,s33,7471104
buffer_store_dwordx4 v[152:155],v253,s[24:27],s34 offen offset:1280 nt
M v[48:51],a[168:171],a[188:191],v[48:51]
s_add_u32 s48,s75,52224
ds_read_b128 a[96:99],v249 offset:19456
M v[48:51],a[136:139],a[132:135],v[48:51]
s_waitcnt lgkmcnt(2)
ds_read_b128 a[100:103],v248 offset:19456
M v[48:51],a[180:183],a[176:179],v[48:51]
s_waitcnt lgkmcnt(2)
M v[52:55],a[180:183],a[160:163],v[52:55]
M v[52:55],a[136:139],a[176:179],v[52:55]
M v[52:55],a[168:171],a[132:135],v[52:55]
M v[56:59],a[168:171],a[176:179],v[56:59]
buffer_load_dwordx4 a[172:175],v250,s[20:23],s48 offen offset:0 sc1
M v[56:59],a[136:139],a[160:163],v[56:59]
s_waitcnt lgkmcnt(1)
M v[56:59],a[180:183],a[96:99],v[56:59]
s_waitcnt lgkmcnt(0)
buffer_load_dwordx4 a[196:199],v250,s[20:23],s48 offen offset:1024 sc1
M v[60:63],a[180:183],a[100:103],v[60:63]
M v[60:63],a[136:139],a[96:99],v[60:63]
M v[60:63],a[168:171],a[160:163],v[60:63]
s_waitcnt vmcnt(26)
M v[64:67],v[220:223],a[124:127],v[64:67]
s_waitcnt vmcnt(25)
buffer_load_dwordx4 a[228:231],v250,s[20:23],s48 offen offset:2048 sc1
M v[64:67],a[212:215],a[116:119],v[64:67]
s_waitcnt vmcnt(25)
M v[64:67],v[228:231],a[140:143],v[64:67]
M v[68:71],v[228:231],a[108:111],v[68:71]
M v[68:71],a[212:215],a[140:143],v[68:71]
M v[68:71],v[220:223],a[116:119],v[68:71]
M v[72:75],v[220:223],a[140:143],v[72:75]
M v[72:75],a[212:215],a[108:111],v[72:75]
M v[72:75],v[228:231],a[188:191],v[72:75]
M v[76:79],v[228:231],a[132:135],v[76:79]
M v[76:79],a[212:215],a[188:191],v[76:79]
M v[76:79],v[220:223],a[108:111],v[76:79]
M v[80:83],v[220:223],a[188:191],v[80:83]
s_add_u32 s48,s76,52224
M v[80:83],a[212:215],a[132:135],v[80:83]
v_add_u32 v248,0xffff1200,v248
v_add_u32 v249,0xffff1200,v249
M v[80:83],v[228:231],a[176:179],v[80:83]
M v[84:87],v[228:231],a[160:163],v[84:87]
M v[84:87],a[212:215],a[176:179],v[84:87]
ds_read_b128 a[180:183],v248 offset:8704
M v[84:87],v[220:223],a[132:135],v[84:87]
ds_read_b128 a[136:139],v249 offset:8704
M v[88:91],v[220:223],a[176:179],v[88:91]
buffer_load_dwordx4 a[168:171],v250,s[20:23],s48 offen offset:0 sc1
M v[88:91],a[212:215],a[160:163],v[88:91]
ds_read_b128 a[124:127],v248 offset:9216
ds_read_b128 a[140:143],v249 offset:9216
M v[88:91],v[228:231],a[96:99],v[88:91]
buffer_load_dwordx4 a[116:119],v250,s[20:23],s48 offen offset:1024 sc1
M v[92:95],v[228:231],a[100:103],v[92:95]
M v[92:95],a[212:215],a[96:99],v[92:95]
M v[92:95],v[220:223],a[160:163],v[92:95]
s_waitcnt vmcnt(25) lgkmcnt(3)
M v[32:35],a[144:147],a[180:183],v[32:35]
s_waitcnt vmcnt(24) lgkmcnt(2)
buffer_load_dwordx4 a[108:111],v250,s[20:23],s48 offen offset:2048 sc1
M v[32:35],a[148:151],a[136:139],v[32:35]
s_waitcnt vmcnt(24) lgkmcnt(1)
ds_read_b128 a[188:191],v248 offset:9728
ds_read_b128 a[132:135],v249 offset:9728
M v[32:35],a[128:131],a[124:127],v[32:35]
s_waitcnt lgkmcnt(2)
M v[36:39],a[128:131],a[140:143],v[36:39]
M v[36:39],a[148:151],a[124:127],v[36:39]
M v[36:39],a[144:147],a[136:139],v[36:39]
s_nop 3
v_cvt_pk_bf16_f32 v32,v32,v33
v_cvt_pk_bf16_f32 v33,v34,v35
M v[40:43],a[144:147],a[124:127],v[40:43]
ds_read_b128 a[176:179],v248 offset:10240
M v[40:43],a[148:151],a[140:143],v[40:43]
s_waitcnt lgkmcnt(2)
ds_read_b128 a[100:103],v249 offset:10240
M v[40:43],a[128:131],a[188:191],v[40:43]
s_waitcnt lgkmcnt(2)
v_cvt_pk_bf16_f32 v36,v36,v37
v_cvt_pk_bf16_f32 v37,v38,v39
M v[44:47],a[128:131],a[132:135],v[44:47]
ds_write2st64_b64 v254,v[32:33],v[36:37] offset0:34 offset1:38
M v[44:47],a[148:151],a[188:191],v[44:47]
M v[44:47],a[144:147],a[140:143],v[44:47]
s_nop 0
v_cvt_pk_bf16_f32 v40,v40,v41
v_cvt_pk_bf16_f32 v41,v42,v43
M v[48:51],a[144:147],a[188:191],v[48:51]
s_add_u32 s48,s77,52224
ds_read_b128 a[96:99],v249 offset:10752
M v[48:51],a[148:151],a[132:135],v[48:51]
s_waitcnt lgkmcnt(3)
ds_read_b128 a[160:163],v248 offset:10752
M v[48:51],a[128:131],a[176:179],v[48:51]
s_waitcnt lgkmcnt(3)
v_cvt_pk_bf16_f32 v44,v44,v45
v_cvt_pk_bf16_f32 v45,v46,v47
M v[52:55],a[128:131],a[100:103],v[52:55]
ds_write2st64_b64 v254,v[40:41],v[44:45] offset0:42 offset1:46
M v[52:55],a[148:151],a[176:179],v[52:55]
M v[52:55],a[144:147],a[132:135],v[52:55]
s_nop 0
v_cvt_pk_bf16_f32 v48,v48,v49
v_cvt_pk_bf16_f32 v49,v50,v51
M v[56:59],a[144:147],a[176:179],v[56:59]
buffer_load_dwordx4 v[216:219],v250,s[20:23],s48 offen offset:0 sc1
M v[56:59],a[148:151],a[100:103],v[56:59]
s_waitcnt lgkmcnt(2)
M v[56:59],a[128:131],a[96:99],v[56:59]
s_waitcnt lgkmcnt(1)
buffer_load_dwordx4 a[244:247],v250,s[20:23],s48 offen offset:1024 sc1
M v[60:63],a[128:131],a[160:163],v[60:63]
v_cvt_pk_bf16_f32 v52,v52,v53
v_cvt_pk_bf16_f32 v53,v54,v55
M v[60:63],a[148:151],a[96:99],v[60:63]
ds_write2st64_b64 v254,v[48:49],v[52:53] offset0:51 offset1:55
M v[60:63],a[144:147],a[100:103],v[60:63]
s_waitcnt vmcnt(24)
v_cvt_pk_bf16_f32 v56,v56,v57
v_cvt_pk_bf16_f32 v57,v58,v59
M v[64:67],a[204:207],a[180:183],v[64:67]
s_waitcnt vmcnt(22)
buffer_load_dwordx4 a[224:227],v250,s[20:23],s48 offen offset:2048 sc1
M v[64:67],a[200:203],a[136:139],v[64:67]
s_waitcnt vmcnt(22)
M v[64:67],v[224:227],a[124:127],v[64:67]
v_cvt_pk_bf16_f32 v60,v60,v61
v_cvt_pk_bf16_f32 v61,v62,v63
M v[68:71],v[224:227],a[140:143],v[68:71]
ds_write2st64_b64 v254,v[56:57],v[60:61] offset0:59 offset1:63
M v[68:71],a[200:203],a[124:127],v[68:71]
M v[68:71],a[204:207],a[136:139],v[68:71]
s_nop 1
v_cvt_pk_bf16_f32 v64,v64,v65
v_cvt_pk_bf16_f32 v65,v66,v67
M v[72:75],a[204:207],a[124:127],v[72:75]
M v[72:75],a[200:203],a[140:143],v[72:75]
M v[72:75],v[224:227],a[188:191],v[72:75]
s_nop 0
v_cvt_pk_bf16_f32 v68,v68,v69
v_cvt_pk_bf16_f32 v69,v70,v71
M v[76:79],v[224:227],a[132:135],v[76:79]
ds_write2st64_b64 v254,v[64:65],v[68:69] offset0:0 offset1:4
M v[76:79],a[200:203],a[188:191],v[76:79]
M v[76:79],a[204:207],a[140:143],v[76:79]
s_nop 0
v_cvt_pk_bf16_f32 v72,v72,v73
v_cvt_pk_bf16_f32 v73,v74,v75
M v[80:83],a[204:207],a[188:191],v[80:83]
M v[80:83],a[200:203],a[132:135],v[80:83]
M v[80:83],v[224:227],a[176:179],v[80:83]
s_nop 1
v_cvt_pk_bf16_f32 v76,v76,v77
v_cvt_pk_bf16_f32 v77,v78,v79
M v[84:87],v[224:227],a[100:103],v[84:87]
ds_write2st64_b64 v254,v[72:73],v[76:77] offset0:8 offset1:12
M v[84:87],a[200:203],a[176:179],v[84:87]
ds_read_b128 a[128:131],v248 offset:0
M v[84:87],a[204:207],a[132:135],v[84:87]
ds_read_b128 a[148:151],v249 offset:0
v_cvt_pk_bf16_f32 v80,v80,v81
M v[88:91],a[204:207],a[176:179],v[88:91]
ds_read_b128 a[144:147],v248 offset:512
v_cvt_pk_bf16_f32 v81,v82,v83
M v[88:91],a[200:203],a[100:103],v[88:91]
ds_read_b128 a[180:183],v249 offset:512
M v[88:91],v[224:227],a[96:99],v[88:91]
v_cvt_pk_bf16_f32 v84,v84,v85
v_cvt_pk_bf16_f32 v85,v86,v87
M v[92:95],v[224:227],a[160:163],v[92:95]
ds_write2st64_b64 v254,v[80:81],v[84:85] offset0:17 offset1:21
M v[92:95],a[200:203],a[96:99],v[92:95]
M v[92:95],a[204:207],a[100:103],v[92:95]
s_waitcnt vmcnt(20) lgkmcnt(4)
s_nop 0
v_cvt_pk_bf16_f32 v88,v88,v89
v_cvt_pk_bf16_f32 v89,v90,v91
M v[160:163],a[156:159],a[128:131],v[160:163]
s_waitcnt vmcnt(19) lgkmcnt(3)
ds_read_b128 a[136:139],v248 offset:1024
M v[160:163],a[120:123],a[148:151],v[160:163]
s_waitcnt vmcnt(18) lgkmcnt(3)
ds_read_b128 a[124:127],v249 offset:1024
M v[160:163],a[164:167],a[144:147],v[160:163]
s_waitcnt lgkmcnt(3)
v_cvt_pk_bf16_f32 v92,v92,v93
v_cvt_pk_bf16_f32 v93,v94,v95
M v[164:167],a[164:167],a[180:183],v[164:167]
ds_write2st64_b64 v254,v[88:89],v[92:93] offset0:25 offset1:29
M v[164:167],a[120:123],a[144:147],v[164:167]
M v[164:167],a[156:159],a[148:151],v[164:167]
M v[168:171],a[156:159],a[144:147],v[168:171]
s_waitcnt lgkmcnt(0)
s_barrier
ds_read_b128 v[32:35],v250 offset:17408
M v[168:171],a[120:123],a[180:183],v[168:171]
ds_read_b128 v[40:43],v250 offset:21504
ds_read_b128 v[48:51],v250 offset:26112
M v[168:171],a[164:167],a[136:139],v[168:171]
ds_read_b128 v[56:59],v250 offset:30208
ds_read_b128 v[64:67],v250 offset:0
M v[172:175],a[164:167],a[124:127],v[172:175]
ds_read_b128 v[72:75],v250 offset:4096
ds_read_b128 v[80:83],v250 offset:8704
ds_read_b128 a[140:143],v248 offset:1536
M v[172:175],a[120:123],a[136:139],v[172:175]
ds_read_b128 v[88:91],v250 offset:12800
ds_read_b128 a[188:191],v249 offset:1536
M v[172:175],a[156:159],a[180:183],v[172:175]
s_waitcnt lgkmcnt(9)
s_add_u32 s34,s33,6291456
buffer_store_dwordx4 v[32:35],v253,s[24:27],s34 offen offset:128 nt
M v[176:179],a[156:159],a[136:139],v[176:179]
s_add_u32 s34,s33,6684672
ds_read_b128 a[132:135],v249 offset:2048
M v[176:179],a[120:123],a[124:127],v[176:179]
s_waitcnt lgkmcnt(3)
ds_read_b128 a[176:179],v248 offset:2048
M v[176:179],a[164:167],a[140:143],v[176:179]
s_waitcnt lgkmcnt(2)
buffer_store_dwordx4 v[40:43],v253,s[24:27],s34 offen offset:128 nt
M v[180:183],a[164:167],a[188:191],v[180:183]
s_add_u32 s34,s33,7077888
M v[180:183],a[120:123],a[140:143],v[180:183]
ds_read_b128 a[160:163],v248 offset:34816
M v[180:183],a[156:159],a[124:127],v[180:183]
buffer_store_dwordx4 v[48:51],v253,s[24:27],s34 offen offset:128 nt
M v[184:187],a[156:159],a[140:143],v[184:187]
s_add_u32 s34,s33,7471104
ds_read_b128 a[96:99],v249 offset:34816
ds_read_b128 a[100:103],v248 offset:35328
M v[184:187],a[120:123],a[188:191],v[184:187]
s_waitcnt lgkmcnt(4)
ds_read_b128 a[128:131],v249 offset:35328
M v[184:187],a[164:167],a[132:135],v[184:187]
s_waitcnt lgkmcnt(4)
buffer_store_dwordx4 v[56:59],v253,s[24:27],s34 offen offset:128 nt
M v[188:191],a[164:167],a[176:179],v[188:191]
M v[188:191],a[120:123],a[132:135],v[188:191]
M v[188:191],a[156:159],a[188:191],v[188:191]
s_waitcnt vmcnt(20) lgkmcnt(3)
M v[160:163],a[184:187],a[160:163],v[160:163]
s_waitcnt vmcnt(19) lgkmcnt(2)
ds_read_b128 a[148:151],v248 offset:35840
M v[160:163],a[248:251],a[96:99],v[160:163]
s_waitcnt vmcnt(18) lgkmcnt(2)
s_add_u32 s34,s33,6291456
ds_read_b128 a[144:147],v249 offset:35840
M v[160:163],a[220:223],a[100:103],v[160:163]
s_waitcnt lgkmcnt(2)
buffer_store_dwordx4 v[64:67],v253,s[24:27],s34 offen offset:256 nt
M v[164:167],a[220:223],a[128:131],v[164:167]
M v[164:167],a[248:251],a[100:103],v[164:167]
M v[164:167],a[184:187],a[96:99],v[164:167]
M v[168:171],a[184:187],a[100:103],v[168:171]
ds_read_b128 a[180:183],v248 offset:36352
M v[168:171],a[248:251],a[128:131],v[168:171]
s_waitcnt lgkmcnt(2)
ds_read_b128 a[136:139],v249 offset:36352
M v[168:171],a[220:223],a[148:151],v[168:171]
s_waitcnt lgkmcnt(2)
M v[172:175],a[220:223],a[144:147],v[172:175]
M v[172:175],a[248:251],a[148:151],v[172:175]
M v[172:175],a[184:187],a[128:131],v[172:175]
M v[176:179],a[184:187],a[148:151],v[176:179]
ds_read_b128 a[124:127],v249 offset:36864
M v[176:179],a[248:251],a[144:147],v[176:179]
s_waitcnt lgkmcnt(2)
ds_read_b128 a[140:143],v248 offset:36864
M v[176:179],a[220:223],a[180:183],v[176:179]
s_waitcnt lgkmcnt(2)
M v[180:183],a[220:223],a[136:139],v[180:183]
M v[180:183],a[248:251],a[180:183],v[180:183]
ds_read_b128 a[164:167],v248 offset:52224
M v[180:183],a[184:187],a[144:147],v[180:183]
ds_read_b128 a[176:179],v249 offset:52224
M v[184:187],a[184:187],a[180:183],v[184:187]
ds_read_b128 a[120:123],v248 offset:52736
M v[184:187],a[248:251],a[136:139],v[184:187]
s_waitcnt lgkmcnt(4)
ds_read_b128 a[132:135],v249 offset:52736
M v[184:187],a[220:223],a[124:127],v[184:187]
s_waitcnt lgkmcnt(4)
M v[188:191],a[220:223],a[140:143],v[188:191]
M v[188:191],a[248:251],a[124:127],v[188:191]
M v[188:191],a[184:187],a[136:139],v[188:191]
s_waitcnt vmcnt(17) lgkmcnt(3)
s_add_u32 s34,s33,6684672
buffer_store_dwordx4 v[72:75],v253,s[24:27],s34 offen offset:256 nt
M v[160:163],a[152:155],a[164:167],v[160:163]
s_waitcnt vmcnt(17) lgkmcnt(2)
ds_read_b128 a[156:159],v248 offset:53248
M v[160:163],a[104:107],a[176:179],v[160:163]
s_waitcnt vmcnt(16) lgkmcnt(2)
ds_read_b128 a[188:191],v249 offset:53248
M v[160:163],a[112:115],a[120:123],v[160:163]
s_waitcnt lgkmcnt(2)
M v[164:167],a[112:115],a[132:135],v[164:167]
M v[164:167],a[104:107],a[120:123],v[164:167]
M v[164:167],a[152:155],a[176:179],v[164:167]
M v[168:171],a[152:155],a[120:123],v[168:171]
ds_read_b128 a[160:163],v248 offset:53760
M v[168:171],a[104:107],a[132:135],v[168:171]
s_waitcnt lgkmcnt(2)
ds_read_b128 a[96:99],v249 offset:53760
M v[168:171],a[112:115],a[156:159],v[168:171]
s_waitcnt lgkmcnt(2)
M v[172:175],a[112:115],a[188:191],v[172:175]
M v[172:175],a[104:107],a[156:159],v[172:175]
M v[172:175],a[152:155],a[132:135],v[172:175]
M v[176:179],a[152:155],a[156:159],v[176:179]
ds_read_b128 a[100:103],v249 offset:54272
M v[176:179],a[104:107],a[188:191],v[176:179]
s_waitcnt lgkmcnt(2)
ds_read_b128 a[128:131],v248 offset:54272
v_add_u32 v248,0x11000,v248
M v[176:179],a[112:115],a[160:163],v[176:179]
s_waitcnt lgkmcnt(2)
v_add_u32 v249,0x11000,v249
M v[180:183],a[112:115],a[96:99],v[180:183]
M v[180:183],a[104:107],a[160:163],v[180:183]
ds_read_b128 a[148:151],v248 offset:0
M v[180:183],a[152:155],a[188:191],v[180:183]
ds_read_b128 a[144:147],v249 offset:0
M v[184:187],a[152:155],a[160:163],v[184:187]
ds_read_b128 a[180:183],v248 offset:512
M v[184:187],a[104:107],a[96:99],v[184:187]
s_waitcnt lgkmcnt(4)
ds_read_b128 a[140:143],v249 offset:512
M v[184:187],a[112:115],a[100:103],v[184:187]
s_waitcnt lgkmcnt(4)
M v[188:191],a[112:115],a[128:131],v[188:191]
s_add_u32 s34,s33,7077888
M v[188:191],a[104:107],a[100:103],v[188:191]
M v[188:191],a[152:155],a[96:99],v[188:191]
s_waitcnt vmcnt(14) lgkmcnt(3)
buffer_store_dwordx4 v[80:83],v253,s[24:27],s34 offen offset:256 nt
M v[160:163],a[172:175],a[148:151],v[160:163]
s_waitcnt vmcnt(14) lgkmcnt(2)
ds_read_b128 a[124:127],v248 offset:1024
M v[160:163],a[196:199],a[144:147],v[160:163]
s_waitcnt vmcnt(13) lgkmcnt(2)
ds_read_b128 a[136:139],v249 offset:1024
M v[160:163],a[228:231],a[180:183],v[160:163]
s_waitcnt lgkmcnt(2)
M v[164:167],a[228:231],a[140:143],v[164:167]
M v[164:167],a[196:199],a[180:183],v[164:167]
M v[164:167],a[172:175],a[144:147],v[164:167]
M v[168:171],a[172:175],a[180:183],v[168:171]
ds_read_b128 a[184:187],v248 offset:1536
M v[168:171],a[196:199],a[140:143],v[168:171]
s_waitcnt lgkmcnt(2)
ds_read_b128 a[164:167],v249 offset:1536
M v[168:171],a[228:231],a[124:127],v[168:171]
s_waitcnt lgkmcnt(2)
M v[172:175],a[228:231],a[136:139],v[172:175]
M v[172:175],a[196:199],a[124:127],v[172:175]
M v[172:175],a[172:175],a[140:143],v[172:175]
M v[176:179],a[172:175],a[124:127],v[176:179]
ds_read_b128 a[176:179],v249 offset:2048
M v[176:179],a[196:199],a[136:139],v[176:179]
s_waitcnt lgkmcnt(2)
ds_read_b128 a[120:123],v248 offset:2048
M v[176:179],a[228:231],a[184:187],v[176:179]
s_waitcnt lgkmcnt(2)
M v[180:183],a[228:231],a[164:167],v[180:183]
M v[180:183],a[196:199],a[184:187],v[180:183]
ds_read_b128 a[132:135],v248 offset:17408
M v[180:183],a[172:175],a[136:139],v[180:183]
ds_read_b128 a[156:159],v249 offset:17408
M v[184:187],a[172:175],a[184:187],v[184:187]
ds_read_b128 a[188:191],v248 offset:17920
M v[184:187],a[196:199],a[164:167],v[184:187]
s_waitcnt lgkmcnt(4)
s_add_u32 s34,s33,7471104
ds_read_b128 a[160:163],v249 offset:17920
M v[184:187],a[228:231],a[176:179],v[184:187]
s_waitcnt lgkmcnt(4)
buffer_store_dwordx4 v[88:91],v253,s[24:27],s34 offen offset:256 nt
M v[188:191],a[228:231],a[120:123],v[188:191]
M v[188:191],a[196:199],a[176:179],v[188:191]
M v[188:191],a[172:175],a[164:167],v[188:191]
s_waitcnt vmcnt(13) lgkmcnt(3)
M v[160:163],a[168:171],a[132:135],v[160:163]
s_waitcnt vmcnt(12) lgkmcnt(2)
ds_read_b128 a[112:115],v248 offset:18432
M v[160:163],a[116:119],a[156:159],v[160:163]
s_waitcnt vmcnt(11) lgkmcnt(2)
ds_read_b128 a[128:131],v249 offset:18432
M v[160:163],a[108:111],a[188:191],v[160:163]
s_waitcnt lgkmcnt(2)
M v[164:167],a[108:111],a[160:163],v[164:167]
M v[164:167],a[116:119],a[188:191],v[164:167]
M v[164:167],a[168:171],a[156:159],v[164:167]
M v[168:171],a[168:171],a[188:191],v[168:171]
ds_read_b128 a[100:103],v248 offset:18944
M v[168:171],a[116:119],a[160:163],v[168:171]
s_waitcnt lgkmcnt(2)
ds_read_b128 a[104:107],v249 offset:18944
M v[168:171],a[108:111],a[112:115],v[168:171]
s_waitcnt lgkmcnt(2)
M v[172:175],a[108:111],a[128:131],v[172:175]
M v[172:175],a[116:119],a[112:115],v[172:175]
M v[172:175],a[168:171],a[160:163],v[172:175]
M v[176:179],a[168:171],a[112:115],v[176:179]
ds_read_b128 a[96:99],v249 offset:19456
M v[176:179],a[116:119],a[128:131],v[176:179]
s_waitcnt lgkmcnt(2)
ds_read_b128 a[152:155],v248 offset:19456
v_add_u32 v248,0xffff3400,v248
M v[176:179],a[108:111],a[100:103],v[176:179]
s_waitcnt lgkmcnt(2)
v_add_u32 v249,0xffff3400,v249
M v[180:183],a[108:111],a[104:107],v[180:183]
M v[180:183],a[116:119],a[100:103],v[180:183]
ds_read_b128 a[148:151],v248 offset:0
M v[180:183],a[168:171],a[128:131],v[180:183]
ds_read_b128 a[144:147],v249 offset:0
M v[184:187],a[168:171],a[100:103],v[184:187]
ds_read_b128 a[180:183],v248 offset:512
M v[184:187],a[116:119],a[104:107],v[184:187]
s_waitcnt lgkmcnt(4)
ds_read_b128 a[140:143],v249 offset:512
M v[184:187],a[108:111],a[96:99],v[184:187]
s_waitcnt lgkmcnt(4)
M v[188:191],a[108:111],a[152:155],v[188:191]
M v[188:191],a[116:119],a[96:99],v[188:191]
M v[188:191],a[168:171],a[104:107],v[188:191]
s_waitcnt vmcnt(10) lgkmcnt(3)
M v[160:163],v[216:219],a[148:151],v[160:163]
s_waitcnt vmcnt(9) lgkmcnt(2)
ds_read_b128 a[124:127],v248 offset:1024
M v[160:163],a[244:247],a[144:147],v[160:163]
s_waitcnt vmcnt(8) lgkmcnt(2)
ds_read_b128 a[136:139],v249 offset:1024
M v[160:163],a[224:227],a[180:183],v[160:163]
s_waitcnt lgkmcnt(2)
M v[164:167],a[224:227],a[140:143],v[164:167]
M v[164:167],a[244:247],a[180:183],v[164:167]
M v[164:167],v[216:219],a[144:147],v[164:167]
s_nop 3
v_cvt_pk_bf16_f32 v160,v160,v161
v_cvt_pk_bf16_f32 v161,v162,v163
M v[168:171],v[216:219],a[180:183],v[168:171]
ds_read_b128 a[184:187],v248 offset:1536
M v[168:171],a[244:247],a[140:143],v[168:171]
s_waitcnt lgkmcnt(2)
ds_read_b128 a[120:123],v249 offset:1536
M v[168:171],a[224:227],a[124:127],v[168:171]
s_waitcnt lgkmcnt(2)
v_cvt_pk_bf16_f32 v164,v164,v165
v_cvt_pk_bf16_f32 v165,v166,v167
M v[172:175],a[224:227],a[136:139],v[172:175]
ds_write2st64_b64 v254,v[160:161],v[164:165] offset0:68 offset1:72
M v[172:175],a[244:247],a[124:127],v[172:175]
M v[172:175],v[216:219],a[140:143],v[172:175]
s_nop 0
v_cvt_pk_bf16_f32 v168,v168,v169
v_cvt_pk_bf16_f32 v169,v170,v171
M v[176:179],v[216:219],a[124:127],v[176:179]
ds_read_b128 a[176:179],v249 offset:2048
M v[176:179],a[244:247],a[136:139],v[176:179]
s_waitcnt lgkmcnt(3)
ds_read_b128 a[164:167],v248 offset:2048
M v[176:179],a[224:227],a[184:187],v[176:179]
s_waitcnt lgkmcnt(3)
v_cvt_pk_bf16_f32 v172,v172,v173
v_cvt_pk_bf16_f32 v173,v174,v175
M v[180:183],a[224:227],a[120:123],v[180:183]
ds_write2st64_b64 v254,v[168:169],v[172:173] offset0:76 offset1:80
M v[180:183],a[244:247],a[184:187],v[180:183]
M v[180:183],v[216:219],a[136:139],v[180:183]
s_nop 0
v_cvt_pk_bf16_f32 v176,v176,v177
v_cvt_pk_bf16_f32 v177,v178,v179
M v[184:187],v[216:219],a[184:187],v[184:187]
M v[184:187],a[244:247],a[120:123],v[184:187]
s_waitcnt lgkmcnt(2)
M v[184:187],a[224:227],a[176:179],v[184:187]
s_waitcnt lgkmcnt(1)
v_cvt_pk_bf16_f32 v180,v180,v181
v_cvt_pk_bf16_f32 v181,v182,v183
M v[188:191],a[224:227],a[164:167],v[188:191]
ds_write2st64_b64 v254,v[176:177],v[180:181] offset0:85 offset1:89
M v[188:191],a[244:247],a[176:179],v[188:191]
M v[188:191],v[216:219],a[120:123],v[188:191]
s_nop 0
v_cvt_pk_bf16_f32 v184,v184,v185
v_cvt_pk_bf16_f32 v185,v186,v187
s_nop 4
v_cvt_pk_bf16_f32 v188,v188,v189
v_cvt_pk_bf16_f32 v189,v190,v191
ds_write2st64_b64 v254,v[184:185],v[188:189] offset0:93 offset1:97
s_waitcnt lgkmcnt(0)
s_barrier
ds_read_b128 v[160:163],v250 offset:34816
ds_read_b128 v[168:171],v250 offset:38912
ds_read_b128 v[176:179],v250 offset:43520
ds_read_b128 v[184:187],v250 offset:47616
s_add_u32 s34,s33,6291456
s_waitcnt lgkmcnt(3)
buffer_store_dwordx4 v[160:163],v253,s[24:27],s34 offen offset:1408 nt
s_add_u32 s34,s33,6684672
s_waitcnt lgkmcnt(2)
buffer_store_dwordx4 v[168:171],v253,s[24:27],s34 offen offset:1408 nt
s_add_u32 s34,s33,7077888
s_waitcnt lgkmcnt(1)
buffer_store_dwordx4 v[176:179],v253,s[24:27],s34 offen offset:1408 nt
s_add_u32 s34,s33,7471104
s_waitcnt lgkmcnt(0)
buffer_store_dwordx4 v[184:187],v253,s[24:27],s34 offen offset:1408 nt
s_endpgm
L_code_end:
L_fallback:
s_mov_b32 s84,0
L_itemF:
s_and_b32 s85,s84,3
s_lshr_b32 s86,s84,2
s_mul_hi_u32 s87,s86,0x55555556
s_mul_i32 s88,s87,3
s_sub_u32 s86,s86,s88
s_mul_hi_u32 s88,s87,0x2aaaaaab
s_mul_i32 s89,s88,6
s_sub_u32 s87,s87,s89
s_mul_i32 s89,s86,221184
s_mul_i32 s90,s87,12288
s_add_u32 s89,s89,s90
s_mul_i32 s90,s85,3072
s_add_u32 s89,s89,s90
s_lshl_b32 s90,s88,7
s_add_u32 s89,s89,s90
s_add_u32 s90,s89,73728
s_add_u32 s91,s90,73728
v_lshlrev_b32 v149,1,v164
buffer_load_short_d16_hi v68,v149,s[36:39],s89 offen offset:0
buffer_load_short_d16_hi v69,v149,s[36:39],s89 offen offset:384
buffer_load_short_d16_hi v70,v149,s[36:39],s89 offen offset:768
buffer_load_short_d16_hi v71,v149,s[36:39],s89 offen offset:1152
buffer_load_short_d16_hi v72,v149,s[36:39],s89 offen offset:1536
buffer_load_short_d16_hi v73,v149,s[36:39],s89 offen offset:1920
buffer_load_short_d16_hi v74,v149,s[36:39],s89 offen offset:2304
buffer_load_short_d16_hi v75,v149,s[36:39],s89 offen offset:2688
buffer_load_short_d16_hi v76,v149,s[36:39],s90 offen offset:0
buffer_load_short_d16_hi v77,v149,s[36:39],s90 offen offset:384
buffer_load_short_d16_hi v78,v149,s[36:39],s90 offen offset:768
buffer_load_short_d16_hi v79,v149,s[36:39],s90 offen offset:1152
buffer_load_short_d16_hi v80,v149,s[36:39],s90 offen offset:1536
buffer_load_short_d16_hi v81,v149,s[36:39],s90 offen offset:1920
buffer_load_short_d16_hi v82,v149,s[36:39],s90 offen offset:2304
buffer_load_short_d16_hi v83,v149,s[36:39],s90 offen offset:2688
buffer_load_short_d16_hi v84,v149,s[36:39],s91 offen offset:0
buffer_load_short_d16_hi v85,v149,s[36:39],s91 offen offset:384
buffer_load_short_d16_hi v86,v149,s[36:39],s91 offen offset:768
buffer_load_short_d16_hi v87,v149,s[36:39],s91 offen offset:1152
buffer_load_short_d16_hi v88,v149,s[36:39],s91 offen offset:1536
buffer_load_short_d16_hi v89,v149,s[36:39],s91 offen offset:1920
buffer_load_short_d16_hi v90,v149,s[36:39],s91 offen offset:2304
buffer_load_short_d16_hi v91,v149,s[36:39],s91 offen offset:2688
s_and_b32 s92,s85,1
s_lshl_b32 s92,s92,2
s_lshr_b32 s85,s85,1
s_lshl_b32 s85,s85,2
v_bfe_u32 v148,v164,2,2
v_or_b32 v148,s92,v148
v_and_b32 v151,3,v164
v_or_b32 v151,s85,v151
v_xor_b32 v151,v151,v148
v_lshrrev_b32 v150,4,v164
v_mul_u32_u24 v150,331776,v150
v_lshl_add_u32 v150,v148,7,v150
v_lshl_add_u32 v150,v151,4,v150
s_mul_i32 s87,s87,55296
s_mul_i32 s88,s88,3072
s_add_u32 s87,s87,s88
s_lshl_b32 s86,s86,10
s_add_u32 s87,s87,s86
s_mov_b32 s85,0xbe2aaaab
s_mov_b32 s86,0x3d2aaaab
s_mov_b32 s88,0x3e2aaaab
s_mov_b32 s92,0x3daaaaab
s_waitcnt vmcnt(0)
v_add_f32 v148,v68,v84
v_add_f32 v92,v148,v76
v_sub_f32 v100,v148,v76
v_mul_f32 v92,s85,v92
v_mul_f32 v100,s85,v100
v_mul_f32 v148,s86,v68
v_fmac_f32 v148,s88,v84
v_fma_f32 v108,s92,v76,v148
v_fma_f32 v116,-s92,v76,v148
v_add_f32 v148,v69,v85
v_add_f32 v93,v148,v77
v_sub_f32 v101,v148,v77
v_mul_f32 v93,s85,v93
v_mul_f32 v101,s85,v101
v_mul_f32 v148,s86,v69
v_fmac_f32 v148,s88,v85
v_fma_f32 v109,s92,v77,v148
v_fma_f32 v117,-s92,v77,v148
v_add_f32 v148,v70,v86
v_add_f32 v94,v148,v78
v_sub_f32 v102,v148,v78
v_mul_f32 v94,s85,v94
v_mul_f32 v102,s85,v102
v_mul_f32 v148,s86,v70
v_fmac_f32 v148,s88,v86
v_fma_f32 v110,s92,v78,v148
v_fma_f32 v118,-s92,v78,v148
v_add_f32 v148,v71,v87
v_add_f32 v95,v148,v79
v_sub_f32 v103,v148,v79
v_mul_f32 v95,s85,v95
v_mul_f32 v103,s85,v103
v_mul_f32 v148,s86,v71
v_fmac_f32 v148,s88,v87
v_fma_f32 v111,s92,v79,v148
v_fma_f32 v119,-s92,v79,v148
v_add_f32 v148,v72,v88
v_add_f32 v96,v148,v80
v_sub_f32 v104,v148,v80
v_mul_f32 v96,s85,v96
v_mul_f32 v104,s85,v104
v_mul_f32 v148,s86,v72
v_fmac_f32 v148,s88,v88
v_fma_f32 v112,s92,v80,v148
v_fma_f32 v120,-s92,v80,v148
v_add_f32 v148,v73,v89
v_add_f32 v97,v148,v81
v_sub_f32 v105,v148,v81
v_mul_f32 v97,s85,v97
v_mul_f32 v105,s85,v105
v_mul_f32 v148,s86,v73
v_fmac_f32 v148,s88,v89
v_fma_f32 v113,s92,v81,v148
v_fma_f32 v121,-s92,v81,v148
v_add_f32 v148,v74,v90
v_add_f32 v98,v148,v82
v_sub_f32 v106,v148,v82
v_mul_f32 v98,s85,v98
v_mul_f32 v106,s85,v106
v_mul_f32 v148,s86,v74
v_fmac_f32 v148,s88,v90
v_fma_f32 v114,s92,v82,v148
v_fma_f32 v122,-s92,v82,v148
v_add_f32 v148,v75,v91
v_add_f32 v99,v148,v83
v_sub_f32 v107,v148,v83
v_mul_f32 v99,s85,v99
v_mul_f32 v107,s85,v107
v_mul_f32 v148,s86,v75
v_fmac_f32 v148,s88,v91
v_fma_f32 v115,s92,v83,v148
v_fma_f32 v123,-s92,v83,v148
v_cvt_pk_bf16_f32 v124,v68,v69
v_cvt_pk_bf16_f32 v125,v70,v71
v_cvt_pk_bf16_f32 v126,v72,v73
v_cvt_pk_bf16_f32 v127,v74,v75
s_add_u32 s89,s87,0
buffer_store_dwordx4 v[124:127],v150,s[20:23],s89 offen sc1
v_cvt_pk_bf16_f32 v144,v84,v85
v_cvt_pk_bf16_f32 v145,v86,v87
v_cvt_pk_bf16_f32 v146,v88,v89
v_cvt_pk_bf16_f32 v147,v90,v91
s_add_u32 s89,s87,46080
buffer_store_dwordx4 v[144:147],v150,s[20:23],s89 offen sc1
v_cvt_pk_bf16_f32 v128,v92,v93
v_cvt_pk_bf16_f32 v129,v94,v95
v_cvt_pk_bf16_f32 v130,v96,v97
v_cvt_pk_bf16_f32 v131,v98,v99
s_add_u32 s89,s87,9216
buffer_store_dwordx4 v[128:131],v150,s[20:23],s89 offen sc1
v_cvt_pk_bf16_f32 v132,v100,v101
v_cvt_pk_bf16_f32 v133,v102,v103
v_cvt_pk_bf16_f32 v134,v104,v105
v_cvt_pk_bf16_f32 v135,v106,v107
s_add_u32 s89,s87,18432
buffer_store_dwordx4 v[132:135],v150,s[20:23],s89 offen sc1
v_cvt_pk_bf16_f32 v136,v108,v109
v_cvt_pk_bf16_f32 v137,v110,v111
v_cvt_pk_bf16_f32 v138,v112,v113
v_cvt_pk_bf16_f32 v139,v114,v115
s_add_u32 s89,s87,27648
buffer_store_dwordx4 v[136:139],v150,s[20:23],s89 offen sc1
v_cvt_pk_bf16_f32 v140,v116,v117
v_cvt_pk_bf16_f32 v141,v118,v119
v_cvt_pk_bf16_f32 v142,v120,v121
v_cvt_pk_bf16_f32 v143,v122,v123
s_add_u32 s89,s87,36864
buffer_store_dwordx4 v[140:143],v150,s[20:23],s89 offen sc1
s_waitcnt vmcnt(0)
s_add_u32 s84,s84,1
s_cmp_lt_u32 s84,216
s_cbranch_scc1 L_itemF
s_branch L_uready
.section .rodata,"a"
.p2align 6
.amdhsa_kernel standalone__winograd__vision_kernel
  .amdhsa_next_free_vgpr 512
  .amdhsa_next_free_sgpr 96
  .amdhsa_accum_offset 256
  .amdhsa_group_segment_fixed_size 0
  .amdhsa_kernarg_size 40
  .amdhsa_user_sgpr_count 2
  .amdhsa_user_sgpr_kernarg_segment_ptr 1
  .amdhsa_system_sgpr_workgroup_id_x 1
  .amdhsa_float_denorm_mode_32 3
.end_amdhsa_kernel
```

```asm
; @launch grid=(256,1,1) block=(256,1,1) lds=156672
.amdgcn_target "amdgcn-amd-amdhsa--gfx950"
.macro M d,a,b,c
v_mfma_f32_16x16x32_bf16 \d,\a,\b,\c
.endm
.text
.globl standalone__winograd__vision_kernel
.p2align 8
.type standalone__winograd__vision_kernel,@function
standalone__winograd__vision_kernel:
s_cmp_ge_u32 s2,256
s_cbranch_scc0 L_go
s_endpgm
L_go:
s_load_dwordx4 s[4:7],s[0:1],0
s_load_dwordx4 s[24:27],s[0:1],16
s_load_dwordx2 s[20:21],s[0:1],32
v_lshlrev_b32 v165,4,v0
s_getpc_b64 s[64:65]
L_pc:
s_lshr_b32 s58,s2,3
s_lshl_b32 s58,s58,12
s_min_u32 s58,s58,L_code_end-L_pc-4096
s_add_u32 s64,s64,s58
s_addc_u32 s65,s65,0
global_load_dword v167,v165,s[64:65]
v_lshrrev_b32 v160,6,v0
v_and_b32 v164,63,v0
v_readfirstlane_b32 s50,v160
v_bfe_u32 v160,v164,3,2
v_bfe_u32 v161,v164,2,1
v_lshl_add_u32 v161,v160,3,v161
v_lshrrev_b32 v162,5,v164
v_xor_b32 v162,v162,v160
v_and_b32 v162,1,v162
v_and_b32 v163,3,v164
v_lshl_add_u32 v162,v162,2,v163
v_mul_u32_u24 v245,196608,v161
v_lshl_add_u32 v245,v162,3,v245
s_and_b32 s54,s2,7
s_lshr_b32 s55,s2,3
s_lshl_b32 s49,s54,6
s_lshl_b32 s55,s55,4
s_lshl_b32 s56,s50,2
s_add_u32 s56,s56,s55
s_mul_i32 s30,s56,384
s_mul_i32 s57,s49,196608
s_add_u32 s30,s30,s57
s_mul_i32 s44,s50,330752
s_mov_b32 s58,0
s_add_u32 s59,s58,0
s_lshl_b32 s84,s59,6
s_add_u32 s66,s30,s84
s_mul_i32 s84,s59,55296
s_add_u32 s72,s44,s84
s_add_u32 s59,s58,1
s_lshl_b32 s84,s59,6
s_add_u32 s67,s30,s84
s_mul_i32 s84,s59,55296
s_add_u32 s73,s44,s84
s_add_u32 s59,s58,2
s_lshl_b32 s84,s59,6
s_add_u32 s68,s30,s84
s_mul_i32 s84,s59,55296
s_add_u32 s74,s44,s84
s_add_u32 s59,s58,3
s_lshl_b32 s84,s59,6
s_add_u32 s69,s30,s84
s_mul_i32 s84,s59,55296
s_add_u32 s75,s44,s84
s_add_u32 s59,s58,4
s_lshl_b32 s84,s59,6
s_add_u32 s70,s30,s84
s_mul_i32 s84,s59,55296
s_add_u32 s76,s44,s84
s_add_u32 s59,s58,5
s_cmp_eq_u32 s59,6
s_cselect_b32 s59,0,s59
s_lshl_b32 s84,s59,6
s_add_u32 s71,s30,s84
s_mul_i32 s84,s59,55296
s_add_u32 s77,s44,s84
s_cmp_eq_u32 s49,0
s_cselect_b32 s58,1,0
v_cmp_gt_u32 vcc,s58,v161
v_lshrrev_b32 v163,5,v164
v_add_u32 v163,32,v163
v_mul_u32_u24 v246,196608,v163
v_bfrev_b32 v163,1
v_cndmask_b32 v251,v245,v163,vcc
v_lshl_add_u32 v168,v162,3,v245
v_cndmask_b32 v169,v168,v163,vcc
v_and_b32 v163,31,v164
v_lshlrev_b32 v163,1,v163
v_lshl_add_u32 v170,v163,1,v246
v_add_u32 v246,v246,v163
v_mov_b32 v166,1
s_mov_b32 s38,663552
s_mov_b32 s39,0x20000
s_mov_b32 s62,0
s_mov_b32 s63,0x20000
s_mov_b32 s22,1327104
s_mov_b32 s23,0x20000
s_waitcnt lgkmcnt(0)
s_and_b32 s21,s21,0xffff
s_mov_b32 s36,s6
s_and_b32 s37,s7,0xffff
s_mov_b32 s60,s26
s_and_b32 s61,s27,0xffff
s_mov_b32 s52,s26
s_mov_b32 s53,s27
s_cmp_lt_u32 s2,54
s_cbranch_scc0 L_noitem
s_lshl_b32 s84,s2,2
s_add_u32 s84,s84,s50
L_itemP:
s_and_b32 s85,s84,3
s_lshr_b32 s86,s84,2
s_mul_hi_u32 s87,s86,0x55555556
s_mul_i32 s88,s87,3
s_sub_u32 s86,s86,s88
s_mul_hi_u32 s88,s87,0x2aaaaaab
s_mul_i32 s89,s88,6
s_sub_u32 s87,s87,s89
s_mul_i32 s89,s86,221184
s_mul_i32 s90,s87,12288
s_add_u32 s89,s89,s90
s_mul_i32 s90,s85,3072
s_add_u32 s89,s89,s90
s_lshl_b32 s90,s88,7
s_add_u32 s89,s89,s90
s_add_u32 s90,s89,73728
s_add_u32 s91,s90,73728
v_lshlrev_b32 v149,1,v164
buffer_load_short_d16_hi v68,v149,s[36:39],s89 offen offset:0
buffer_load_short_d16_hi v69,v149,s[36:39],s89 offen offset:384
buffer_load_short_d16_hi v70,v149,s[36:39],s89 offen offset:768
buffer_load_short_d16_hi v71,v149,s[36:39],s89 offen offset:1152
buffer_load_short_d16_hi v72,v149,s[36:39],s89 offen offset:1536
buffer_load_short_d16_hi v73,v149,s[36:39],s89 offen offset:1920
buffer_load_short_d16_hi v74,v149,s[36:39],s89 offen offset:2304
buffer_load_short_d16_hi v75,v149,s[36:39],s89 offen offset:2688
buffer_load_short_d16_hi v76,v149,s[36:39],s90 offen offset:0
buffer_load_short_d16_hi v77,v149,s[36:39],s90 offen offset:384
buffer_load_short_d16_hi v78,v149,s[36:39],s90 offen offset:768
buffer_load_short_d16_hi v79,v149,s[36:39],s90 offen offset:1152
buffer_load_short_d16_hi v80,v149,s[36:39],s90 offen offset:1536
buffer_load_short_d16_hi v81,v149,s[36:39],s90 offen offset:1920
buffer_load_short_d16_hi v82,v149,s[36:39],s90 offen offset:2304
buffer_load_short_d16_hi v83,v149,s[36:39],s90 offen offset:2688
buffer_load_short_d16_hi v84,v149,s[36:39],s91 offen offset:0
buffer_load_short_d16_hi v85,v149,s[36:39],s91 offen offset:384
buffer_load_short_d16_hi v86,v149,s[36:39],s91 offen offset:768
buffer_load_short_d16_hi v87,v149,s[36:39],s91 offen offset:1152
buffer_load_short_d16_hi v88,v149,s[36:39],s91 offen offset:1536
buffer_load_short_d16_hi v89,v149,s[36:39],s91 offen offset:1920
buffer_load_short_d16_hi v90,v149,s[36:39],s91 offen offset:2304
buffer_load_short_d16_hi v91,v149,s[36:39],s91 offen offset:2688
s_and_b32 s92,s85,1
s_lshl_b32 s92,s92,2
s_lshr_b32 s85,s85,1
s_lshl_b32 s85,s85,2
v_bfe_u32 v148,v164,2,2
v_or_b32 v148,s92,v148
v_and_b32 v151,3,v164
v_or_b32 v151,s85,v151
v_xor_b32 v151,v151,v148
v_lshrrev_b32 v150,4,v164
v_mul_u32_u24 v150,331776,v150
v_lshl_add_u32 v150,v148,7,v150
v_lshl_add_u32 v150,v151,4,v150
s_mul_i32 s87,s87,55296
s_mul_i32 s88,s88,3072
s_add_u32 s87,s87,s88
s_lshl_b32 s86,s86,10
s_add_u32 s87,s87,s86
s_mov_b32 s85,0xbe2aaaab
s_mov_b32 s86,0x3d2aaaab
s_mov_b32 s88,0x3e2aaaab
s_mov_b32 s92,0x3daaaaab
s_waitcnt vmcnt(0)
v_add_f32 v148,v68,v84
v_add_f32 v92,v148,v76
v_sub_f32 v100,v148,v76
v_mul_f32 v92,s85,v92
v_mul_f32 v100,s85,v100
v_mul_f32 v148,s86,v68
v_fmac_f32 v148,s88,v84
v_fma_f32 v108,s92,v76,v148
v_fma_f32 v116,-s92,v76,v148
v_add_f32 v148,v69,v85
v_add_f32 v93,v148,v77
v_sub_f32 v101,v148,v77
v_mul_f32 v93,s85,v93
v_mul_f32 v101,s85,v101
v_mul_f32 v148,s86,v69
v_fmac_f32 v148,s88,v85
v_fma_f32 v109,s92,v77,v148
v_fma_f32 v117,-s92,v77,v148
v_add_f32 v148,v70,v86
v_add_f32 v94,v148,v78
v_sub_f32 v102,v148,v78
v_mul_f32 v94,s85,v94
v_mul_f32 v102,s85,v102
v_mul_f32 v148,s86,v70
v_fmac_f32 v148,s88,v86
v_fma_f32 v110,s92,v78,v148
v_fma_f32 v118,-s92,v78,v148
v_add_f32 v148,v71,v87
v_add_f32 v95,v148,v79
v_sub_f32 v103,v148,v79
v_mul_f32 v95,s85,v95
v_mul_f32 v103,s85,v103
v_mul_f32 v148,s86,v71
v_fmac_f32 v148,s88,v87
v_fma_f32 v111,s92,v79,v148
v_fma_f32 v119,-s92,v79,v148
v_add_f32 v148,v72,v88
v_add_f32 v96,v148,v80
v_sub_f32 v104,v148,v80
v_mul_f32 v96,s85,v96
v_mul_f32 v104,s85,v104
v_mul_f32 v148,s86,v72
v_fmac_f32 v148,s88,v88
v_fma_f32 v112,s92,v80,v148
v_fma_f32 v120,-s92,v80,v148
v_add_f32 v148,v73,v89
v_add_f32 v97,v148,v81
v_sub_f32 v105,v148,v81
v_mul_f32 v97,s85,v97
v_mul_f32 v105,s85,v105
v_mul_f32 v148,s86,v73
v_fmac_f32 v148,s88,v89
v_fma_f32 v113,s92,v81,v148
v_fma_f32 v121,-s92,v81,v148
v_add_f32 v148,v74,v90
v_add_f32 v98,v148,v82
v_sub_f32 v106,v148,v82
v_mul_f32 v98,s85,v98
v_mul_f32 v106,s85,v106
v_mul_f32 v148,s86,v74
v_fmac_f32 v148,s88,v90
v_fma_f32 v114,s92,v82,v148
v_fma_f32 v122,-s92,v82,v148
v_add_f32 v148,v75,v91
v_add_f32 v99,v148,v83
v_sub_f32 v107,v148,v83
v_mul_f32 v99,s85,v99
v_mul_f32 v107,s85,v107
v_mul_f32 v148,s86,v75
v_fmac_f32 v148,s88,v91
v_fma_f32 v115,s92,v83,v148
v_fma_f32 v123,-s92,v83,v148
v_cvt_pk_bf16_f32 v124,v68,v69
v_cvt_pk_bf16_f32 v125,v70,v71
v_cvt_pk_bf16_f32 v126,v72,v73
v_cvt_pk_bf16_f32 v127,v74,v75
s_add_u32 s89,s87,0
buffer_store_dwordx4 v[124:127],v150,s[20:23],s89 offen sc1
v_cvt_pk_bf16_f32 v144,v84,v85
v_cvt_pk_bf16_f32 v145,v86,v87
v_cvt_pk_bf16_f32 v146,v88,v89
v_cvt_pk_bf16_f32 v147,v90,v91
s_add_u32 s89,s87,46080
buffer_store_dwordx4 v[144:147],v150,s[20:23],s89 offen sc1
v_cvt_pk_bf16_f32 v128,v92,v93
v_cvt_pk_bf16_f32 v129,v94,v95
v_cvt_pk_bf16_f32 v130,v96,v97
v_cvt_pk_bf16_f32 v131,v98,v99
s_add_u32 s89,s87,9216
buffer_store_dwordx4 v[128:131],v150,s[20:23],s89 offen sc1
v_cvt_pk_bf16_f32 v132,v100,v101
v_cvt_pk_bf16_f32 v133,v102,v103
v_cvt_pk_bf16_f32 v134,v104,v105
v_cvt_pk_bf16_f32 v135,v106,v107
s_add_u32 s89,s87,18432
buffer_store_dwordx4 v[132:135],v150,s[20:23],s89 offen sc1
v_cvt_pk_bf16_f32 v136,v108,v109
v_cvt_pk_bf16_f32 v137,v110,v111
v_cvt_pk_bf16_f32 v138,v112,v113
v_cvt_pk_bf16_f32 v139,v114,v115
s_add_u32 s89,s87,27648
buffer_store_dwordx4 v[136:139],v150,s[20:23],s89 offen sc1
v_cvt_pk_bf16_f32 v140,v116,v117
v_cvt_pk_bf16_f32 v141,v118,v119
v_cvt_pk_bf16_f32 v142,v120,v121
v_cvt_pk_bf16_f32 v143,v122,v123
s_add_u32 s89,s87,36864
buffer_store_dwordx4 v[140:143],v150,s[20:23],s89 offen sc1
s_waitcnt vmcnt(0)
s_barrier
s_cmp_eq_u32 s50,0
s_cselect_b32 s62,256,0
L_noitem:
s_and_b32 s84,s2,1
s_lshl_b32 s59,s84,6
s_lshl_b32 s84,s84,2
s_mov_b64 exec,1
buffer_atomic_add v166,off,s[60:63],s59 sc0 sc1
s_mov_b64 exec,-1
s_and_b32 s5,s5,0xffff
s_sub_u32 s8,s4,196608
s_subb_u32 s9,s5,0
s_mov_b32 s10,100859904
s_mov_b32 s11,0x20000
s_sub_u32 s12,s4,196992
s_subb_u32 s13,s5,0
s_cmp_eq_u32 s56,0
s_cselect_b32 s14,0,100860288
s_mov_b32 s15,0x20000
s_mov_b32 s16,s8
s_mov_b32 s17,s9
s_cmp_eq_u32 s56,508
s_cselect_b32 s18,0,100859904
s_mov_b32 s19,0x20000
s_add_u32 s28,s30,0
buffer_load_dwordx4 v[8:11],v169,s[8:11],s28 offen offset:384
buffer_load_dwordx4 v[0:3],v169,s[12:15],s28 offen offset:0
buffer_load_dwordx4 v[4:7],v169,s[8:11],s28 offen offset:0
buffer_load_dwordx4 v[20:23],v169,s[16:19],s28 offen offset:1536
buffer_load_dwordx4 v[16:19],v169,s[8:11],s28 offen offset:1152
buffer_load_dwordx4 v[12:15],v169,s[8:11],s28 offen offset:768
s_mov_b64 exec,1
s_waitcnt vmcnt(6)
v_cmp_eq_u32 vcc,26,v166
v_mov_b32 v165,1
s_nop 2
s_and_b64 exec,exec,vcc
s_cselect_b32 s62,s62,0
s_mov_b64 exec,1
buffer_store_dword v165,off,s[60:63],s84 offset:128 sc1
s_mov_b64 exec,-1
s_add_u32 s28,s30,393216
buffer_load_dwordx4 v[32:35],v168,s[8:11],s28 offen offset:384
buffer_load_dwordx4 v[24:27],v168,s[12:15],s28 offen offset:0
buffer_load_dwordx4 v[28:31],v168,s[8:11],s28 offen offset:0
buffer_load_dwordx4 v[44:47],v168,s[16:19],s28 offen offset:1536
buffer_load_dwordx4 v[40:43],v168,s[8:11],s28 offen offset:1152
buffer_load_dwordx4 v[36:39],v168,s[8:11],s28 offen offset:768
v_bfe_u32 v165,v164,2,3
v_lshrrev_b32 v159,5,v164
v_and_b32 v163,3,v164
v_lshl_add_u32 v159,v159,2,v163
v_xor_b32 v163,v159,v165
v_lshlrev_b32 v163,4,v163
v_lshl_add_u32 v163,v165,7,v163
v_lshl_add_u32 v250,s50,10,v163
s_and_b32 s25,s25,0xffff
s_mov_b32 s26,100663296
s_mov_b32 s27,0x20000
s_mov_b32 s41,0xc0a00000
s_mov_b32 s40,0x41000000
s_mov_b32 s42,0xffff0000
s_mov_b32 s43,0xbfa00000
s_mov_b32 s45,0x3e800000
s_mul_i32 s58,s55,384
s_add_u32 s58,s57,s58
s_lshr_b32 s59,s50,1
s_mul_i32 s32,s59,384
s_mul_i32 s33,s59,196608
s_add_u32 s32,s32,s58
s_add_u32 s33,s33,s58
s_lshl_b32 s58,s59,5
s_lshl_b32 s59,s50,7
v_lshlrev_b32 v247,11,v160
v_xor_b32 v163,v160,v161
v_and_b32 v163,1,v163
v_lshl_add_u32 v247,v163,6,v247
v_lshlrev_b32 v163,3,v162
v_xor_b32 v163,s58,v163
v_add3_u32 v247,v247,v163,s59
v_and_b32 v171,0xffffffc0,v247
v_and_b32 v163,3,v162
v_lshlrev_b32 v163,4,v163
v_xor_b32 v163,s58,v163
v_add_u32 v171,v171,v163
v_lshrrev_b32 v163,2,v162
v_mul_u32_u24 v163,17408,v163
v_mad_u32_u24 v172,v163,5,v171
v_lshl_add_u32 v171,v163,1,v171
v_and_b32 v163,15,v164
v_lshlrev_b32 v163,2,v163
v_xor_b32 v163,s58,v163
v_lshrrev_b32 v173,5,v164
v_lshl_add_u32 v173,v173,6,v163
v_add_u32 v173,s59,v173
v_add_u32 v173,8192,v173
v_bfe_u32 v163,v164,4,1
v_mul_u32_u24 v163,17408,v163
v_mad_u32_u24 v174,v163,5,v173
v_lshl_add_u32 v173,v163,1,v173
v_lshrrev_b32 v160,5,v164
v_lshlrev_b32 v160,6,v160
v_and_b32 v161,63,v246
v_xor_b32 v161,s58,v161
v_add3_u32 v252,v160,v161,s59
v_add_u32 v252,8192,v252
v_bfe_u32 v160,v164,2,2
v_and_b32 v161,3,v164
v_lshrrev_b32 v162,4,v164
v_lshlrev_b32 v248,11,v160
v_lshl_add_u32 v248,v161,7,v248
v_and_b32 v163,1,v160
v_lshl_add_u32 v248,v163,6,v248
v_and_b32 v163,2,v161
v_xor_b32 v163,v163,v162
v_lshl_add_u32 v248,v163,4,v248
v_xor_b32 v249,64,v248
v_lshrrev_b32 v160,1,v162
v_lshl_add_u32 v160,s50,1,v160
v_and_b32 v161,7,v164
v_xor_b32 v160,v160,v161
v_and_b32 v163,15,v164
v_lshlrev_b32 v254,7,v163
v_lshl_add_u32 v254,v160,4,v254
v_and_b32 v163,1,v162
v_lshl_add_u32 v254,v163,3,v254
v_bfe_u32 v160,v250,7,4
v_lshrrev_b32 v162,2,v160
v_mul_u32_u24 v253,1572864,v162
v_and_b32 v162,3,v160
v_mul_u32_u24 v162,1536,v162
v_lshl_add_u32 v160,v159,4,v162
v_add_u32 v253,v253,v160
s_waitcnt vmcnt(12)
v_lshlrev_b32 v180,16,v8
v_and_b32 v181,s42,v8
s_waitcnt vmcnt(11)
v_lshlrev_b32 v176,16,v0
v_and_b32 v177,s42,v0
s_waitcnt vmcnt(10)
v_lshlrev_b32 v178,16,v4
v_and_b32 v179,s42,v4
s_add_u32 s28,s30,786432
buffer_load_dwordx4 v[56:59],v168,s[8:11],s28 offen offset:384
s_waitcnt vmcnt(10)
v_lshlrev_b32 v186,16,v20
v_and_b32 v187,s42,v20
s_waitcnt vmcnt(9)
v_lshlrev_b32 v184,16,v16
v_and_b32 v185,s42,v16
s_waitcnt vmcnt(8)
v_lshlrev_b32 v182,16,v12
v_and_b32 v183,s42,v12
v_pk_fma_f32 v[176:177],v[180:181],s[42:43],v[176:177] op_sel:[0,1,0] op_sel_hi:[1,1,1]
v_pk_fma_f32 v[186:187],v[178:179],4.0,v[186:187] op_sel_hi:[1,0,1]
v_pk_fma_f32 v[188:189],v[180:181],-4.0,v[184:185] op_sel_hi:[1,0,1]
v_pk_fma_f32 v[176:177],v[184:185],s[44:45],v[176:177] op_sel:[0,1,0] op_sel_hi:[1,1,1]
v_pk_fma_f32 v[186:187],v[182:183],s[40:41],v[186:187] op_sel:[0,1,0] op_sel_hi:[1,1,1]
v_pk_add_f32 v[184:185],v[184:185],v[180:181] neg_lo:[0,1] neg_hi:[0,1]
buffer_load_dwordx4 v[48:51],v168,s[12:15],s28 offen offset:0
v_pk_fma_f32 v[180:181],v[178:179],-4.0,v[182:183] op_sel_hi:[1,0,1]
v_pk_add_f32 v[182:183],v[182:183],v[178:179] neg_lo:[0,1] neg_hi:[0,1]
v_pk_add_f32 v[178:179],v[188:189],v[180:181]
v_pk_add_f32 v[188:189],v[188:189],v[180:181] neg_lo:[0,1] neg_hi:[0,1]
v_pk_fma_f32 v[180:181],v[182:183],2.0,v[184:185] op_sel_hi:[1,0,1]
v_pk_fma_f32 v[184:185],v[182:183],-2.0,v[184:185] op_sel_hi:[1,0,1]
v_cvt_pk_bf16_f32 v0,v176,v177
v_cvt_pk_bf16_f32 v4,v178,v179
v_cvt_pk_bf16_f32 v8,v188,v189
v_cvt_pk_bf16_f32 v12,v180,v181
v_cvt_pk_bf16_f32 v16,v184,v185
v_cvt_pk_bf16_f32 v20,v186,v187
buffer_load_dwordx4 v[52:55],v168,s[8:11],s28 offen offset:0
v_lshlrev_b32 v180,16,v9
v_and_b32 v181,s42,v9
v_lshlrev_b32 v176,16,v1
v_and_b32 v177,s42,v1
v_lshlrev_b32 v178,16,v5
v_and_b32 v179,s42,v5
v_lshlrev_b32 v186,16,v21
v_and_b32 v187,s42,v21
v_lshlrev_b32 v184,16,v17
v_and_b32 v185,s42,v17
v_lshlrev_b32 v182,16,v13
v_and_b32 v183,s42,v13
buffer_load_dwordx4 v[68:71],v168,s[16:19],s28 offen offset:1536
v_pk_fma_f32 v[176:177],v[180:181],s[42:43],v[176:177] op_sel:[0,1,0] op_sel_hi:[1,1,1]
v_pk_fma_f32 v[186:187],v[178:179],4.0,v[186:187] op_sel_hi:[1,0,1]
v_pk_fma_f32 v[188:189],v[180:181],-4.0,v[184:185] op_sel_hi:[1,0,1]
v_pk_fma_f32 v[176:177],v[184:185],s[44:45],v[176:177] op_sel:[0,1,0] op_sel_hi:[1,1,1]
v_pk_fma_f32 v[186:187],v[182:183],s[40:41],v[186:187] op_sel:[0,1,0] op_sel_hi:[1,1,1]
v_pk_add_f32 v[184:185],v[184:185],v[180:181] neg_lo:[0,1] neg_hi:[0,1]
v_pk_fma_f32 v[180:181],v[178:179],-4.0,v[182:183] op_sel_hi:[1,0,1]
v_pk_add_f32 v[182:183],v[182:183],v[178:179] neg_lo:[0,1] neg_hi:[0,1]
v_pk_add_f32 v[178:179],v[188:189],v[180:181]
v_pk_add_f32 v[188:189],v[188:189],v[180:181] neg_lo:[0,1] neg_hi:[0,1]
v_pk_fma_f32 v[180:181],v[182:183],2.0,v[184:185] op_sel_hi:[1,0,1]
v_pk_fma_f32 v[184:185],v[182:183],-2.0,v[184:185] op_sel_hi:[1,0,1]
buffer_load_dwordx4 v[64:67],v168,s[8:11],s28 offen offset:1152
v_cvt_pk_bf16_f32 v1,v176,v177
v_cvt_pk_bf16_f32 v5,v178,v179
v_cvt_pk_bf16_f32 v9,v188,v189
v_cvt_pk_bf16_f32 v13,v180,v181
v_cvt_pk_bf16_f32 v17,v184,v185
v_cvt_pk_bf16_f32 v21,v186,v187
v_lshlrev_b32 v180,16,v10
v_and_b32 v181,s42,v10
v_lshlrev_b32 v176,16,v2
v_and_b32 v177,s42,v2
v_lshlrev_b32 v178,16,v6
v_and_b32 v179,s42,v6
buffer_load_dwordx4 v[60:63],v168,s[8:11],s28 offen offset:768
v_lshlrev_b32 v186,16,v22
v_and_b32 v187,s42,v22
v_lshlrev_b32 v184,16,v18
v_and_b32 v185,s42,v18
v_lshlrev_b32 v182,16,v14
v_and_b32 v183,s42,v14
v_pk_fma_f32 v[176:177],v[180:181],s[42:43],v[176:177] op_sel:[0,1,0] op_sel_hi:[1,1,1]
v_pk_fma_f32 v[186:187],v[178:179],4.0,v[186:187] op_sel_hi:[1,0,1]
v_pk_fma_f32 v[188:189],v[180:181],-4.0,v[184:185] op_sel_hi:[1,0,1]
v_pk_fma_f32 v[176:177],v[184:185],s[44:45],v[176:177] op_sel:[0,1,0] op_sel_hi:[1,1,1]
v_pk_fma_f32 v[186:187],v[182:183],s[40:41],v[186:187] op_sel:[0,1,0] op_sel_hi:[1,1,1]
v_pk_add_f32 v[184:185],v[184:185],v[180:181] neg_lo:[0,1] neg_hi:[0,1]
s_add_u32 s28,s30,1179648
buffer_load_dwordx4 v[80:83],v168,s[8:11],s28 offen offset:384
v_pk_fma_f32 v[180:181],v[178:179],-4.0,v[182:183] op_sel_hi:[1,0,1]
v_pk_add_f32 v[182:183],v[182:183],v[178:179] neg_lo:[0,1] neg_hi:[0,1]
v_pk_add_f32 v[178:179],v[188:189],v[180:181]
v_pk_add_f32 v[188:189],v[188:189],v[180:181] neg_lo:[0,1] neg_hi:[0,1]
v_pk_fma_f32 v[180:181],v[182:183],2.0,v[184:185] op_sel_hi:[1,0,1]
v_pk_fma_f32 v[184:185],v[182:183],-2.0,v[184:185] op_sel_hi:[1,0,1]
v_cvt_pk_bf16_f32 v2,v176,v177
v_cvt_pk_bf16_f32 v6,v178,v179
v_cvt_pk_bf16_f32 v10,v188,v189
v_cvt_pk_bf16_f32 v14,v180,v181
v_cvt_pk_bf16_f32 v18,v184,v185
v_cvt_pk_bf16_f32 v22,v186,v187
buffer_load_dwordx4 v[72:75],v168,s[12:15],s28 offen offset:0
v_lshlrev_b32 v180,16,v11
v_and_b32 v181,s42,v11
v_lshlrev_b32 v176,16,v3
v_and_b32 v177,s42,v3
v_lshlrev_b32 v178,16,v7
v_and_b32 v179,s42,v7
v_lshlrev_b32 v186,16,v23
v_and_b32 v187,s42,v23
v_lshlrev_b32 v184,16,v19
v_and_b32 v185,s42,v19
v_lshlrev_b32 v182,16,v15
v_and_b32 v183,s42,v15
buffer_load_dwordx4 v[76:79],v168,s[8:11],s28 offen offset:0
v_pk_fma_f32 v[176:177],v[180:181],s[42:43],v[176:177] op_sel:[0,1,0] op_sel_hi:[1,1,1]
v_pk_fma_f32 v[186:187],v[178:179],4.0,v[186:187] op_sel_hi:[1,0,1]
v_pk_fma_f32 v[188:189],v[180:181],-4.0,v[184:185] op_sel_hi:[1,0,1]
v_pk_fma_f32 v[176:177],v[184:185],s[44:45],v[176:177] op_sel:[0,1,0] op_sel_hi:[1,1,1]
v_pk_fma_f32 v[186:187],v[182:183],s[40:41],v[186:187] op_sel:[0,1,0] op_sel_hi:[1,1,1]
v_pk_add_f32 v[184:185],v[184:185],v[180:181] neg_lo:[0,1] neg_hi:[0,1]
v_pk_fma_f32 v[180:181],v[178:179],-4.0,v[182:183] op_sel_hi:[1,0,1]
v_pk_add_f32 v[182:183],v[182:183],v[178:179] neg_lo:[0,1] neg_hi:[0,1]
v_pk_add_f32 v[178:179],v[188:189],v[180:181]
v_pk_add_f32 v[188:189],v[188:189],v[180:181] neg_lo:[0,1] neg_hi:[0,1]
v_pk_fma_f32 v[180:181],v[182:183],2.0,v[184:185] op_sel_hi:[1,0,1]
v_pk_fma_f32 v[184:185],v[182:183],-2.0,v[184:185] op_sel_hi:[1,0,1]
buffer_load_dwordx4 v[92:95],v168,s[16:19],s28 offen offset:1536
v_cvt_pk_bf16_f32 v3,v176,v177
v_cvt_pk_bf16_f32 v7,v178,v179
v_cvt_pk_bf16_f32 v11,v188,v189
v_cvt_pk_bf16_f32 v15,v180,v181
v_cvt_pk_bf16_f32 v19,v184,v185
v_cvt_pk_bf16_f32 v23,v186,v187
ds_write_b128 v172,v[0:3] offset:0
ds_write_b128 v171,v[4:7] offset:17408
ds_write_b128 v171,v[8:11] offset:26112
ds_write_b128 v171,v[12:15] offset:34816
ds_write_b128 v171,v[16:19] offset:43520
ds_write_b128 v172,v[20:23] offset:8704
buffer_load_dwordx4 v[88:91],v168,s[8:11],s28 offen offset:1152
s_waitcnt vmcnt(16)
v_lshlrev_b32 v180,16,v32
v_and_b32 v181,s42,v32
s_waitcnt vmcnt(15)
v_lshlrev_b32 v176,16,v24
v_and_b32 v177,s42,v24
s_waitcnt vmcnt(14)
v_lshlrev_b32 v178,16,v28
v_and_b32 v179,s42,v28
buffer_load_dwordx4 v[84:87],v168,s[8:11],s28 offen offset:768
s_waitcnt vmcnt(14)
v_lshlrev_b32 v186,16,v44
v_and_b32 v187,s42,v44
s_waitcnt vmcnt(13)
v_lshlrev_b32 v184,16,v40
v_and_b32 v185,s42,v40
s_waitcnt vmcnt(12)
v_lshlrev_b32 v182,16,v36
v_and_b32 v183,s42,v36
v_pk_fma_f32 v[176:177],v[180:181],s[42:43],v[176:177] op_sel:[0,1,0] op_sel_hi:[1,1,1]
v_pk_fma_f32 v[186:187],v[178:179],4.0,v[186:187] op_sel_hi:[1,0,1]
v_pk_fma_f32 v[188:189],v[180:181],-4.0,v[184:185] op_sel_hi:[1,0,1]
v_pk_fma_f32 v[176:177],v[184:185],s[44:45],v[176:177] op_sel:[0,1,0] op_sel_hi:[1,1,1]
v_pk_fma_f32 v[186:187],v[182:183],s[40:41],v[186:187] op_sel:[0,1,0] op_sel_hi:[1,1,1]
v_pk_add_f32 v[184:185],v[184:185],v[180:181] neg_lo:[0,1] neg_hi:[0,1]
buffer_load_dword v96,v170,s[12:15],s30 offen offset:0
v_pk_fma_f32 v[180:181],v[178:179],-4.0,v[182:183] op_sel_hi:[1,0,1]
v_pk_add_f32 v[182:183],v[182:183],v[178:179] neg_lo:[0,1] neg_hi:[0,1]
v_pk_add_f32 v[178:179],v[188:189],v[180:181]
v_pk_add_f32 v[188:189],v[188:189],v[180:181] neg_lo:[0,1] neg_hi:[0,1]
v_pk_fma_f32 v[180:181],v[182:183],2.0,v[184:185] op_sel_hi:[1,0,1]
v_pk_fma_f32 v[184:185],v[182:183],-2.0,v[184:185] op_sel_hi:[1,0,1]
v_cvt_pk_bf16_f32 v24,v176,v177
v_cvt_pk_bf16_f32 v28,v178,v179
v_cvt_pk_bf16_f32 v32,v188,v189
v_cvt_pk_bf16_f32 v36,v180,v181
v_cvt_pk_bf16_f32 v40,v184,v185
v_cvt_pk_bf16_f32 v44,v186,v187
buffer_load_dword v97,v170,s[8:11],s30 offen offset:0
v_lshlrev_b32 v180,16,v33
v_and_b32 v181,s42,v33
v_lshlrev_b32 v176,16,v25
v_and_b32 v177,s42,v25
v_lshlrev_b32 v178,16,v29
v_and_b32 v179,s42,v29
v_lshlrev_b32 v186,16,v45
v_and_b32 v187,s42,v45
v_lshlrev_b32 v184,16,v41
v_and_b32 v185,s42,v41
v_lshlrev_b32 v182,16,v37
v_and_b32 v183,s42,v37
buffer_load_dword v98,v170,s[8:11],s30 offen offset:384
v_pk_fma_f32 v[176:177],v[180:181],s[42:43],v[176:177] op_sel:[0,1,0] op_sel_hi:[1,1,1]
v_pk_fma_f32 v[186:187],v[178:179],4.0,v[186:187] op_sel_hi:[1,0,1]
v_pk_fma_f32 v[188:189],v[180:181],-4.0,v[184:185] op_sel_hi:[1,0,1]
v_pk_fma_f32 v[176:177],v[184:185],s[44:45],v[176:177] op_sel:[0,1,0] op_sel_hi:[1,1,1]
v_pk_fma_f32 v[186:187],v[182:183],s[40:41],v[186:187] op_sel:[0,1,0] op_sel_hi:[1,1,1]
v_pk_add_f32 v[184:185],v[184:185],v[180:181] neg_lo:[0,1] neg_hi:[0,1]
v_pk_fma_f32 v[180:181],v[178:179],-4.0,v[182:183] op_sel_hi:[1,0,1]
v_pk_add_f32 v[182:183],v[182:183],v[178:179] neg_lo:[0,1] neg_hi:[0,1]
v_pk_add_f32 v[178:179],v[188:189],v[180:181]
v_pk_add_f32 v[188:189],v[188:189],v[180:181] neg_lo:[0,1] neg_hi:[0,1]
v_pk_fma_f32 v[180:181],v[182:183],2.0,v[184:185] op_sel_hi:[1,0,1]
v_pk_fma_f32 v[184:185],v[182:183],-2.0,v[184:185] op_sel_hi:[1,0,1]
buffer_load_dword v99,v170,s[8:11],s30 offen offset:768
v_cvt_pk_bf16_f32 v25,v176,v177
v_cvt_pk_bf16_f32 v29,v178,v179
v_cvt_pk_bf16_f32 v33,v188,v189
v_cvt_pk_bf16_f32 v37,v180,v181
v_cvt_pk_bf16_f32 v41,v184,v185
v_cvt_pk_bf16_f32 v45,v186,v187
v_lshlrev_b32 v180,16,v34
v_and_b32 v181,s42,v34
v_lshlrev_b32 v176,16,v26
v_and_b32 v177,s42,v26
v_lshlrev_b32 v178,16,v30
v_and_b32 v179,s42,v30
buffer_load_dword v100,v170,s[8:11],s30 offen offset:1152
v_lshlrev_b32 v186,16,v46
v_and_b32 v187,s42,v46
v_lshlrev_b32 v184,16,v42
v_and_b32 v185,s42,v42
v_lshlrev_b32 v182,16,v38
v_and_b32 v183,s42,v38
v_pk_fma_f32 v[176:177],v[180:181],s[42:43],v[176:177] op_sel:[0,1,0] op_sel_hi:[1,1,1]
v_pk_fma_f32 v[186:187],v[178:179],4.0,v[186:187] op_sel_hi:[1,0,1]
v_pk_fma_f32 v[188:189],v[180:181],-4.0,v[184:185] op_sel_hi:[1,0,1]
v_pk_fma_f32 v[176:177],v[184:185],s[44:45],v[176:177] op_sel:[0,1,0] op_sel_hi:[1,1,1]
v_pk_fma_f32 v[186:187],v[182:183],s[40:41],v[186:187] op_sel:[0,1,0] op_sel_hi:[1,1,1]
v_pk_add_f32 v[184:185],v[184:185],v[180:181] neg_lo:[0,1] neg_hi:[0,1]
buffer_load_dword v101,v170,s[16:19],s30 offen offset:1536
v_pk_fma_f32 v[180:181],v[178:179],-4.0,v[182:183] op_sel_hi:[1,0,1]
v_pk_add_f32 v[182:183],v[182:183],v[178:179] neg_lo:[0,1] neg_hi:[0,1]
v_pk_add_f32 v[178:179],v[188:189],v[180:181]
v_pk_add_f32 v[188:189],v[188:189],v[180:181] neg_lo:[0,1] neg_hi:[0,1]
v_pk_fma_f32 v[180:181],v[182:183],2.0,v[184:185] op_sel_hi:[1,0,1]
v_pk_fma_f32 v[184:185],v[182:183],-2.0,v[184:185] op_sel_hi:[1,0,1]
v_cvt_pk_bf16_f32 v26,v176,v177
v_cvt_pk_bf16_f32 v30,v178,v179
v_cvt_pk_bf16_f32 v34,v188,v189
v_cvt_pk_bf16_f32 v38,v180,v181
v_cvt_pk_bf16_f32 v42,v184,v185
v_cvt_pk_bf16_f32 v46,v186,v187
v_lshlrev_b32 v180,16,v35
v_and_b32 v181,s42,v35
v_lshlrev_b32 v176,16,v27
v_and_b32 v177,s42,v27
v_lshlrev_b32 v178,16,v31
v_and_b32 v179,s42,v31
v_lshlrev_b32 v186,16,v47
v_and_b32 v187,s42,v47
v_lshlrev_b32 v184,16,v43
v_and_b32 v185,s42,v43
v_lshlrev_b32 v182,16,v39
v_and_b32 v183,s42,v39
v_pk_fma_f32 v[176:177],v[180:181],s[42:43],v[176:177] op_sel:[0,1,0] op_sel_hi:[1,1,1]
v_pk_fma_f32 v[186:187],v[178:179],4.0,v[186:187] op_sel_hi:[1,0,1]
v_pk_fma_f32 v[188:189],v[180:181],-4.0,v[184:185] op_sel_hi:[1,0,1]
v_pk_fma_f32 v[176:177],v[184:185],s[44:45],v[176:177] op_sel:[0,1,0] op_sel_hi:[1,1,1]
v_pk_fma_f32 v[186:187],v[182:183],s[40:41],v[186:187] op_sel:[0,1,0] op_sel_hi:[1,1,1]
v_pk_add_f32 v[184:185],v[184:185],v[180:181] neg_lo:[0,1] neg_hi:[0,1]
v_pk_fma_f32 v[180:181],v[178:179],-4.0,v[182:183] op_sel_hi:[1,0,1]
v_pk_add_f32 v[182:183],v[182:183],v[178:179] neg_lo:[0,1] neg_hi:[0,1]
v_pk_add_f32 v[178:179],v[188:189],v[180:181]
v_pk_add_f32 v[188:189],v[188:189],v[180:181] neg_lo:[0,1] neg_hi:[0,1]
v_pk_fma_f32 v[180:181],v[182:183],2.0,v[184:185] op_sel_hi:[1,0,1]
v_pk_fma_f32 v[184:185],v[182:183],-2.0,v[184:185] op_sel_hi:[1,0,1]
v_cvt_pk_bf16_f32 v27,v176,v177
v_cvt_pk_bf16_f32 v31,v178,v179
v_cvt_pk_bf16_f32 v35,v188,v189
v_cvt_pk_bf16_f32 v39,v180,v181
v_cvt_pk_bf16_f32 v43,v184,v185
v_cvt_pk_bf16_f32 v47,v186,v187
ds_write_b128 v172,v[24:27] offset:512
ds_write_b128 v171,v[28:31] offset:17920
ds_write_b128 v171,v[32:35] offset:26624
ds_write_b128 v171,v[36:39] offset:35328
ds_write_b128 v171,v[40:43] offset:44032
ds_write_b128 v172,v[44:47] offset:9216
s_waitcnt vmcnt(17)
v_lshlrev_b32 v180,16,v56
v_and_b32 v181,s42,v56
s_waitcnt vmcnt(16)
v_lshlrev_b32 v176,16,v48
v_and_b32 v177,s42,v48
s_waitcnt vmcnt(15)
v_lshlrev_b32 v178,16,v52
v_and_b32 v179,s42,v52
s_waitcnt vmcnt(14)
v_lshlrev_b32 v186,16,v68
v_and_b32 v187,s42,v68
s_waitcnt vmcnt(13)
v_lshlrev_b32 v184,16,v64
v_and_b32 v185,s42,v64
s_waitcnt vmcnt(12)
v_lshlrev_b32 v182,16,v60
v_and_b32 v183,s42,v60
v_pk_fma_f32 v[176:177],v[180:181],s[42:43],v[176:177] op_sel:[0,1,0] op_sel_hi:[1,1,1]
v_pk_fma_f32 v[186:187],v[178:179],4.0,v[186:187] op_sel_hi:[1,0,1]
v_pk_fma_f32 v[188:189],v[180:181],-4.0,v[184:185] op_sel_hi:[1,0,1]
v_pk_fma_f32 v[176:177],v[184:185],s[44:45],v[176:177] op_sel:[0,1,0] op_sel_hi:[1,1,1]
v_pk_fma_f32 v[186:187],v[182:183],s[40:41],v[186:187] op_sel:[0,1,0] op_sel_hi:[1,1,1]
v_pk_add_f32 v[184:185],v[184:185],v[180:181] neg_lo:[0,1] neg_hi:[0,1]
v_pk_fma_f32 v[180:181],v[178:179],-4.0,v[182:183] op_sel_hi:[1,0,1]
v_pk_add_f32 v[182:183],v[182:183],v[178:179] neg_lo:[0,1] neg_hi:[0,1]
v_pk_add_f32 v[178:179],v[188:189],v[180:181]
v_pk_add_f32 v[188:189],v[188:189],v[180:181] neg_lo:[0,1] neg_hi:[0,1]
v_pk_fma_f32 v[180:181],v[182:183],2.0,v[184:185] op_sel_hi:[1,0,1]
v_pk_fma_f32 v[184:185],v[182:183],-2.0,v[184:185] op_sel_hi:[1,0,1]
v_cvt_pk_bf16_f32 v48,v176,v177
v_cvt_pk_bf16_f32 v52,v178,v179
v_cvt_pk_bf16_f32 v56,v188,v189
v_cvt_pk_bf16_f32 v60,v180,v181
v_cvt_pk_bf16_f32 v64,v184,v185
v_cvt_pk_bf16_f32 v68,v186,v187
v_lshlrev_b32 v180,16,v57
v_and_b32 v181,s42,v57
v_lshlrev_b32 v176,16,v49
v_and_b32 v177,s42,v49
v_lshlrev_b32 v178,16,v53
v_and_b32 v179,s42,v53
v_lshlrev_b32 v186,16,v69
v_and_b32 v187,s42,v69
v_lshlrev_b32 v184,16,v65
v_and_b32 v185,s42,v65
v_lshlrev_b32 v182,16,v61
v_and_b32 v183,s42,v61
v_pk_fma_f32 v[176:177],v[180:181],s[42:43],v[176:177] op_sel:[0,1,0] op_sel_hi:[1,1,1]
v_pk_fma_f32 v[186:187],v[178:179],4.0,v[186:187] op_sel_hi:[1,0,1]
v_pk_fma_f32 v[188:189],v[180:181],-4.0,v[184:185] op_sel_hi:[1,0,1]
v_pk_fma_f32 v[176:177],v[184:185],s[44:45],v[176:177] op_sel:[0,1,0] op_sel_hi:[1,1,1]
v_pk_fma_f32 v[186:187],v[182:183],s[40:41],v[186:187] op_sel:[0,1,0] op_sel_hi:[1,1,1]
v_pk_add_f32 v[184:185],v[184:185],v[180:181] neg_lo:[0,1] neg_hi:[0,1]
v_pk_fma_f32 v[180:181],v[178:179],-4.0,v[182:183] op_sel_hi:[1,0,1]
v_pk_add_f32 v[182:183],v[182:183],v[178:179] neg_lo:[0,1] neg_hi:[0,1]
v_pk_add_f32 v[178:179],v[188:189],v[180:181]
v_pk_add_f32 v[188:189],v[188:189],v[180:181] neg_lo:[0,1] neg_hi:[0,1]
v_pk_fma_f32 v[180:181],v[182:183],2.0,v[184:185] op_sel_hi:[1,0,1]
v_pk_fma_f32 v[184:185],v[182:183],-2.0,v[184:185] op_sel_hi:[1,0,1]
v_cvt_pk_bf16_f32 v49,v176,v177
v_cvt_pk_bf16_f32 v53,v178,v179
v_cvt_pk_bf16_f32 v57,v188,v189
v_cvt_pk_bf16_f32 v61,v180,v181
v_cvt_pk_bf16_f32 v65,v184,v185
v_cvt_pk_bf16_f32 v69,v186,v187
v_lshlrev_b32 v180,16,v58
v_and_b32 v181,s42,v58
v_lshlrev_b32 v176,16,v50
v_and_b32 v177,s42,v50
v_lshlrev_b32 v178,16,v54
v_and_b32 v179,s42,v54
v_lshlrev_b32 v186,16,v70
v_and_b32 v187,s42,v70
v_lshlrev_b32 v184,16,v66
v_and_b32 v185,s42,v66
v_lshlrev_b32 v182,16,v62
v_and_b32 v183,s42,v62
v_pk_fma_f32 v[176:177],v[180:181],s[42:43],v[176:177] op_sel:[0,1,0] op_sel_hi:[1,1,1]
v_pk_fma_f32 v[186:187],v[178:179],4.0,v[186:187] op_sel_hi:[1,0,1]
v_pk_fma_f32 v[188:189],v[180:181],-4.0,v[184:185] op_sel_hi:[1,0,1]
v_pk_fma_f32 v[176:177],v[184:185],s[44:45],v[176:177] op_sel:[0,1,0] op_sel_hi:[1,1,1]
v_pk_fma_f32 v[186:187],v[182:183],s[40:41],v[186:187] op_sel:[0,1,0] op_sel_hi:[1,1,1]
v_pk_add_f32 v[184:185],v[184:185],v[180:181] neg_lo:[0,1] neg_hi:[0,1]
v_pk_fma_f32 v[180:181],v[178:179],-4.0,v[182:183] op_sel_hi:[1,0,1]
v_pk_add_f32 v[182:183],v[182:183],v[178:179] neg_lo:[0,1] neg_hi:[0,1]
v_pk_add_f32 v[178:179],v[188:189],v[180:181]
v_pk_add_f32 v[188:189],v[188:189],v[180:181] neg_lo:[0,1] neg_hi:[0,1]
v_pk_fma_f32 v[180:181],v[182:183],2.0,v[184:185] op_sel_hi:[1,0,1]
v_pk_fma_f32 v[184:185],v[182:183],-2.0,v[184:185] op_sel_hi:[1,0,1]
v_cvt_pk_bf16_f32 v50,v176,v177
v_cvt_pk_bf16_f32 v54,v178,v179
v_cvt_pk_bf16_f32 v58,v188,v189
v_cvt_pk_bf16_f32 v62,v180,v181
v_cvt_pk_bf16_f32 v66,v184,v185
v_cvt_pk_bf16_f32 v70,v186,v187
v_lshlrev_b32 v180,16,v59
v_and_b32 v181,s42,v59
v_lshlrev_b32 v176,16,v51
v_and_b32 v177,s42,v51
v_lshlrev_b32 v178,16,v55
v_and_b32 v179,s42,v55
v_lshlrev_b32 v186,16,v71
v_and_b32 v187,s42,v71
v_lshlrev_b32 v184,16,v67
v_and_b32 v185,s42,v67
v_lshlrev_b32 v182,16,v63
v_and_b32 v183,s42,v63
v_pk_fma_f32 v[176:177],v[180:181],s[42:43],v[176:177] op_sel:[0,1,0] op_sel_hi:[1,1,1]
v_pk_fma_f32 v[186:187],v[178:179],4.0,v[186:187] op_sel_hi:[1,0,1]
v_pk_fma_f32 v[188:189],v[180:181],-4.0,v[184:185] op_sel_hi:[1,0,1]
v_pk_fma_f32 v[176:177],v[184:185],s[44:45],v[176:177] op_sel:[0,1,0] op_sel_hi:[1,1,1]
v_pk_fma_f32 v[186:187],v[182:183],s[40:41],v[186:187] op_sel:[0,1,0] op_sel_hi:[1,1,1]
v_pk_add_f32 v[184:185],v[184:185],v[180:181] neg_lo:[0,1] neg_hi:[0,1]
v_pk_fma_f32 v[180:181],v[178:179],-4.0,v[182:183] op_sel_hi:[1,0,1]
v_pk_add_f32 v[182:183],v[182:183],v[178:179] neg_lo:[0,1] neg_hi:[0,1]
v_pk_add_f32 v[178:179],v[188:189],v[180:181]
v_pk_add_f32 v[188:189],v[188:189],v[180:181] neg_lo:[0,1] neg_hi:[0,1]
v_pk_fma_f32 v[180:181],v[182:183],2.0,v[184:185] op_sel_hi:[1,0,1]
v_pk_fma_f32 v[184:185],v[182:183],-2.0,v[184:185] op_sel_hi:[1,0,1]
v_cvt_pk_bf16_f32 v51,v176,v177
v_cvt_pk_bf16_f32 v55,v178,v179
v_cvt_pk_bf16_f32 v59,v188,v189
v_cvt_pk_bf16_f32 v63,v180,v181
v_cvt_pk_bf16_f32 v67,v184,v185
v_cvt_pk_bf16_f32 v71,v186,v187
ds_write_b128 v172,v[48:51] offset:1024
ds_write_b128 v171,v[52:55] offset:18432
ds_write_b128 v171,v[56:59] offset:27136
ds_write_b128 v171,v[60:63] offset:35840
ds_write_b128 v171,v[64:67] offset:44544
ds_write_b128 v172,v[68:71] offset:9728
s_waitcnt vmcnt(11)
v_lshlrev_b32 v180,16,v80
v_and_b32 v181,s42,v80
s_waitcnt vmcnt(10)
v_lshlrev_b32 v176,16,v72
v_and_b32 v177,s42,v72
s_waitcnt vmcnt(9)
v_lshlrev_b32 v178,16,v76
v_and_b32 v179,s42,v76
s_waitcnt vmcnt(8)
v_lshlrev_b32 v186,16,v92
v_and_b32 v187,s42,v92
s_waitcnt vmcnt(7)
v_lshlrev_b32 v184,16,v88
v_and_b32 v185,s42,v88
s_waitcnt vmcnt(6)
v_lshlrev_b32 v182,16,v84
v_and_b32 v183,s42,v84
v_pk_fma_f32 v[176:177],v[180:181],s[42:43],v[176:177] op_sel:[0,1,0] op_sel_hi:[1,1,1]
v_pk_fma_f32 v[186:187],v[178:179],4.0,v[186:187] op_sel_hi:[1,0,1]
v_pk_fma_f32 v[188:189],v[180:181],-4.0,v[184:185] op_sel_hi:[1,0,1]
v_pk_fma_f32 v[176:177],v[184:185],s[44:45],v[176:177] op_sel:[0,1,0] op_sel_hi:[1,1,1]
v_pk_fma_f32 v[186:187],v[182:183],s[40:41],v[186:187] op_sel:[0,1,0] op_sel_hi:[1,1,1]
v_pk_add_f32 v[184:185],v[184:185],v[180:181] neg_lo:[0,1] neg_hi:[0,1]
v_pk_fma_f32 v[180:181],v[178:179],-4.0,v[182:183] op_sel_hi:[1,0,1]
v_pk_add_f32 v[182:183],v[182:183],v[178:179] neg_lo:[0,1] neg_hi:[0,1]
v_pk_add_f32 v[178:179],v[188:189],v[180:181]
v_pk_add_f32 v[188:189],v[188:189],v[180:181] neg_lo:[0,1] neg_hi:[0,1]
v_pk_fma_f32 v[180:181],v[182:183],2.0,v[184:185] op_sel_hi:[1,0,1]
v_pk_fma_f32 v[184:185],v[182:183],-2.0,v[184:185] op_sel_hi:[1,0,1]
v_cvt_pk_bf16_f32 v72,v176,v177
v_cvt_pk_bf16_f32 v76,v178,v179
v_cvt_pk_bf16_f32 v80,v188,v189
v_cvt_pk_bf16_f32 v84,v180,v181
v_cvt_pk_bf16_f32 v88,v184,v185
v_cvt_pk_bf16_f32 v92,v186,v187
v_lshlrev_b32 v180,16,v81
v_and_b32 v181,s42,v81
v_lshlrev_b32 v176,16,v73
v_and_b32 v177,s42,v73
v_lshlrev_b32 v178,16,v77
v_and_b32 v179,s42,v77
v_lshlrev_b32 v186,16,v93
v_and_b32 v187,s42,v93
v_lshlrev_b32 v184,16,v89
v_and_b32 v185,s42,v89
v_lshlrev_b32 v182,16,v85
v_and_b32 v183,s42,v85
v_pk_fma_f32 v[176:177],v[180:181],s[42:43],v[176:177] op_sel:[0,1,0] op_sel_hi:[1,1,1]
v_pk_fma_f32 v[186:187],v[178:179],4.0,v[186:187] op_sel_hi:[1,0,1]
v_pk_fma_f32 v[188:189],v[180:181],-4.0,v[184:185] op_sel_hi:[1,0,1]
v_pk_fma_f32 v[176:177],v[184:185],s[44:45],v[176:177] op_sel:[0,1,0] op_sel_hi:[1,1,1]
v_pk_fma_f32 v[186:187],v[182:183],s[40:41],v[186:187] op_sel:[0,1,0] op_sel_hi:[1,1,1]
v_pk_add_f32 v[184:185],v[184:185],v[180:181] neg_lo:[0,1] neg_hi:[0,1]
v_pk_fma_f32 v[180:181],v[178:179],-4.0,v[182:183] op_sel_hi:[1,0,1]
v_pk_add_f32 v[182:183],v[182:183],v[178:179] neg_lo:[0,1] neg_hi:[0,1]
v_pk_add_f32 v[178:179],v[188:189],v[180:181]
v_pk_add_f32 v[188:189],v[188:189],v[180:181] neg_lo:[0,1] neg_hi:[0,1]
v_pk_fma_f32 v[180:181],v[182:183],2.0,v[184:185] op_sel_hi:[1,0,1]
v_pk_fma_f32 v[184:185],v[182:183],-2.0,v[184:185] op_sel_hi:[1,0,1]
v_cvt_pk_bf16_f32 v73,v176,v177
v_cvt_pk_bf16_f32 v77,v178,v179
v_cvt_pk_bf16_f32 v81,v188,v189
v_cvt_pk_bf16_f32 v85,v180,v181
v_cvt_pk_bf16_f32 v89,v184,v185
v_cvt_pk_bf16_f32 v93,v186,v187
v_lshlrev_b32 v180,16,v82
v_and_b32 v181,s42,v82
v_lshlrev_b32 v176,16,v74
v_and_b32 v177,s42,v74
v_lshlrev_b32 v178,16,v78
v_and_b32 v179,s42,v78
v_lshlrev_b32 v186,16,v94
v_and_b32 v187,s42,v94
v_lshlrev_b32 v184,16,v90
v_and_b32 v185,s42,v90
v_lshlrev_b32 v182,16,v86
v_and_b32 v183,s42,v86
v_pk_fma_f32 v[176:177],v[180:181],s[42:43],v[176:177] op_sel:[0,1,0] op_sel_hi:[1,1,1]
v_pk_fma_f32 v[186:187],v[178:179],4.0,v[186:187] op_sel_hi:[1,0,1]
v_pk_fma_f32 v[188:189],v[180:181],-4.0,v[184:185] op_sel_hi:[1,0,1]
v_pk_fma_f32 v[176:177],v[184:185],s[44:45],v[176:177] op_sel:[0,1,0] op_sel_hi:[1,1,1]
v_pk_fma_f32 v[186:187],v[182:183],s[40:41],v[186:187] op_sel:[0,1,0] op_sel_hi:[1,1,1]
v_pk_add_f32 v[184:185],v[184:185],v[180:181] neg_lo:[0,1] neg_hi:[0,1]
v_pk_fma_f32 v[180:181],v[178:179],-4.0,v[182:183] op_sel_hi:[1,0,1]
v_pk_add_f32 v[182:183],v[182:183],v[178:179] neg_lo:[0,1] neg_hi:[0,1]
v_pk_add_f32 v[178:179],v[188:189],v[180:181]
v_pk_add_f32 v[188:189],v[188:189],v[180:181] neg_lo:[0,1] neg_hi:[0,1]
v_pk_fma_f32 v[180:181],v[182:183],2.0,v[184:185] op_sel_hi:[1,0,1]
v_pk_fma_f32 v[184:185],v[182:183],-2.0,v[184:185] op_sel_hi:[1,0,1]
v_cvt_pk_bf16_f32 v74,v176,v177
v_cvt_pk_bf16_f32 v78,v178,v179
v_cvt_pk_bf16_f32 v82,v188,v189
v_cvt_pk_bf16_f32 v86,v180,v181
v_cvt_pk_bf16_f32 v90,v184,v185
v_cvt_pk_bf16_f32 v94,v186,v187
v_lshlrev_b32 v180,16,v83
v_and_b32 v181,s42,v83
v_lshlrev_b32 v176,16,v75
v_and_b32 v177,s42,v75
v_lshlrev_b32 v178,16,v79
v_and_b32 v179,s42,v79
v_lshlrev_b32 v186,16,v95
v_and_b32 v187,s42,v95
v_lshlrev_b32 v184,16,v91
v_and_b32 v185,s42,v91
v_lshlrev_b32 v182,16,v87
v_and_b32 v183,s42,v87
v_pk_fma_f32 v[176:177],v[180:181],s[42:43],v[176:177] op_sel:[0,1,0] op_sel_hi:[1,1,1]
v_pk_fma_f32 v[186:187],v[178:179],4.0,v[186:187] op_sel_hi:[1,0,1]
v_pk_fma_f32 v[188:189],v[180:181],-4.0,v[184:185] op_sel_hi:[1,0,1]
v_pk_fma_f32 v[176:177],v[184:185],s[44:45],v[176:177] op_sel:[0,1,0] op_sel_hi:[1,1,1]
v_pk_fma_f32 v[186:187],v[182:183],s[40:41],v[186:187] op_sel:[0,1,0] op_sel_hi:[1,1,1]
v_pk_add_f32 v[184:185],v[184:185],v[180:181] neg_lo:[0,1] neg_hi:[0,1]
v_pk_fma_f32 v[180:181],v[178:179],-4.0,v[182:183] op_sel_hi:[1,0,1]
v_pk_add_f32 v[182:183],v[182:183],v[178:179] neg_lo:[0,1] neg_hi:[0,1]
v_pk_add_f32 v[178:179],v[188:189],v[180:181]
v_pk_add_f32 v[188:189],v[188:189],v[180:181] neg_lo:[0,1] neg_hi:[0,1]
v_pk_fma_f32 v[180:181],v[182:183],2.0,v[184:185] op_sel_hi:[1,0,1]
v_pk_fma_f32 v[184:185],v[182:183],-2.0,v[184:185] op_sel_hi:[1,0,1]
v_cvt_pk_bf16_f32 v75,v176,v177
v_cvt_pk_bf16_f32 v79,v178,v179
v_cvt_pk_bf16_f32 v83,v188,v189
v_cvt_pk_bf16_f32 v87,v180,v181
v_cvt_pk_bf16_f32 v91,v184,v185
v_cvt_pk_bf16_f32 v95,v186,v187
ds_write_b128 v172,v[72:75] offset:1536
ds_write_b128 v171,v[76:79] offset:18944
ds_write_b128 v171,v[80:83] offset:27648
ds_write_b128 v171,v[84:87] offset:36352
ds_write_b128 v171,v[88:91] offset:45056
ds_write_b128 v172,v[92:95] offset:10240
s_waitcnt vmcnt(3)
v_lshlrev_b32 v180,16,v98
v_and_b32 v181,s42,v98
v_lshlrev_b32 v176,16,v96
v_and_b32 v177,s42,v96
v_lshlrev_b32 v178,16,v97
v_and_b32 v179,s42,v97
s_waitcnt vmcnt(0)
v_lshlrev_b32 v186,16,v101
v_and_b32 v187,s42,v101
v_lshlrev_b32 v184,16,v100
v_and_b32 v185,s42,v100
v_lshlrev_b32 v182,16,v99
v_and_b32 v183,s42,v99
v_pk_fma_f32 v[176:177],v[180:181],s[42:43],v[176:177] op_sel:[0,1,0] op_sel_hi:[1,1,1]
v_pk_fma_f32 v[186:187],v[178:179],4.0,v[186:187] op_sel_hi:[1,0,1]
v_pk_fma_f32 v[188:189],v[180:181],-4.0,v[184:185] op_sel_hi:[1,0,1]
v_pk_fma_f32 v[176:177],v[184:185],s[44:45],v[176:177] op_sel:[0,1,0] op_sel_hi:[1,1,1]
v_pk_fma_f32 v[186:187],v[182:183],s[40:41],v[186:187] op_sel:[0,1,0] op_sel_hi:[1,1,1]
v_pk_add_f32 v[184:185],v[184:185],v[180:181] neg_lo:[0,1] neg_hi:[0,1]
v_pk_fma_f32 v[180:181],v[178:179],-4.0,v[182:183] op_sel_hi:[1,0,1]
v_pk_add_f32 v[182:183],v[182:183],v[178:179] neg_lo:[0,1] neg_hi:[0,1]
v_pk_add_f32 v[178:179],v[188:189],v[180:181]
v_pk_add_f32 v[188:189],v[188:189],v[180:181] neg_lo:[0,1] neg_hi:[0,1]
v_pk_fma_f32 v[180:181],v[182:183],2.0,v[184:185] op_sel_hi:[1,0,1]
v_pk_fma_f32 v[184:185],v[182:183],-2.0,v[184:185] op_sel_hi:[1,0,1]
v_cvt_pk_bf16_f32 v96,v176,v177
v_cvt_pk_bf16_f32 v97,v178,v179
v_cvt_pk_bf16_f32 v98,v188,v189
v_cvt_pk_bf16_f32 v99,v180,v181
v_cvt_pk_bf16_f32 v100,v184,v185
v_cvt_pk_bf16_f32 v101,v186,v187
ds_write_b32 v174,v96 offset:0
ds_write_b32 v173,v97 offset:17408
ds_write_b32 v173,v98 offset:26112
ds_write_b32 v173,v99 offset:34816
ds_write_b32 v173,v100 offset:43520
ds_write_b32 v174,v101 offset:8704
s_waitcnt lgkmcnt(0)
s_barrier
ds_read_b128 a[192:195],v248 offset:17408
ds_read_b128 a[196:199],v249 offset:17408
ds_read_b128 a[200:203],v248 offset:17920
ds_read_b128 a[204:207],v249 offset:17920
v_and_b32 v165,1,v164
v_lshlrev_b32 v165,2,v165
s_mov_b32 s84,0
L_poll:
global_load_dword v166,v165,s[52:53] offset:128 sc1
s_add_u32 s84,s84,1
s_waitcnt vmcnt(0)
v_cmp_eq_u32 vcc,0,v166
s_cmp_gt_u32 s84,0x4000
s_cbranch_scc1 L_fallback
s_cbranch_vccnz L_poll
L_uready:
s_add_u32 s46,s72,9216
buffer_load_dwordx4 a[96:99],v250,s[20:23],s46 offen offset:0 sc1
buffer_load_dwordx4 a[100:103],v250,s[20:23],s46 offen offset:1024 sc1
buffer_load_dwordx4 a[104:107],v250,s[20:23],s46 offen offset:2048 sc1
s_add_u32 s47,s72,12288
buffer_load_dwordx4 a[108:111],v250,s[20:23],s47 offen offset:0 sc1
buffer_load_dwordx4 a[112:115],v250,s[20:23],s47 offen offset:1024 sc1
buffer_load_dwordx4 a[116:119],v250,s[20:23],s47 offen offset:2048 sc1
s_add_u32 s48,s72,15360
buffer_load_dwordx4 a[120:123],v250,s[20:23],s48 offen offset:0 sc1
buffer_load_dwordx4 a[124:127],v250,s[20:23],s48 offen offset:1024 sc1
buffer_load_dwordx4 a[128:131],v250,s[20:23],s48 offen offset:2048 sc1
s_getpc_b64 s[62:63]
L_pc2:
s_sub_u32 s62,s62,L_pc2-L_pc
s_subb_u32 s63,s63,0
s_lshr_b32 s61,s2,3
s_waitcnt vmcnt(8) lgkmcnt(3)
M a[0:3],a[96:99],a[192:195],0
s_waitcnt vmcnt(7) lgkmcnt(2)
s_add_u32 s46,s72,18432
buffer_load_dwordx4 a[132:135],v250,s[20:23],s46 offen offset:0 sc1
M a[0:3],a[100:103],a[196:199],a[0:3]
s_waitcnt vmcnt(7) lgkmcnt(1)
ds_read_b128 a[208:211],v248 offset:18432
ds_read_b128 a[212:215],v249 offset:18432
M a[0:3],a[104:107],a[200:203],a[0:3]
s_waitcnt lgkmcnt(2)
buffer_load_dwordx4 a[136:139],v250,s[20:23],s46 offen offset:1024 sc1
M a[4:7],a[104:107],a[204:207],0
M a[4:7],a[100:103],a[200:203],a[4:7]
M a[4:7],a[96:99],a[196:199],a[4:7]
M a[8:11],a[96:99],a[200:203],0
buffer_load_dwordx4 a[140:143],v250,s[20:23],s46 offen offset:2048 sc1
M a[8:11],a[100:103],a[204:207],a[8:11]
s_waitcnt lgkmcnt(1)
s_add_u32 s47,s72,21504
ds_read_b128 a[216:219],v248 offset:18944
ds_read_b128 a[220:223],v249 offset:18944
M a[8:11],a[104:107],a[208:211],a[8:11]
s_waitcnt lgkmcnt(2)
M a[12:15],a[104:107],a[212:215],0
M a[12:15],a[100:103],a[208:211],a[12:15]
buffer_load_dwordx4 a[164:167],v250,s[20:23],s47 offen offset:0 sc1
M a[12:15],a[96:99],a[204:207],a[12:15]
M a[16:19],a[96:99],a[208:211],0
ds_read_b128 a[224:227],v249 offset:19456
M a[16:19],a[100:103],a[212:215],a[16:19]
s_waitcnt lgkmcnt(2)
ds_read_b128 a[228:231],v248 offset:19456
M a[16:19],a[104:107],a[216:219],a[16:19]
s_waitcnt lgkmcnt(2)
buffer_load_dwordx4 a[160:163],v250,s[20:23],s47 offen offset:1024 sc1
M a[20:23],a[104:107],a[220:223],0
M a[20:23],a[100:103],a[216:219],a[20:23]
M a[20:23],a[96:99],a[212:215],a[20:23]
M a[24:27],a[96:99],a[216:219],0
buffer_load_dwordx4 a[168:171],v250,s[20:23],s47 offen offset:2048 sc1
M a[24:27],a[100:103],a[220:223],a[24:27]
s_waitcnt lgkmcnt(1)
s_add_u32 s48,s72,24576
M a[24:27],a[104:107],a[224:227],a[24:27]
s_waitcnt lgkmcnt(0)
M a[28:31],a[104:107],a[228:231],0
M a[28:31],a[100:103],a[224:227],a[28:31]
buffer_load_dwordx4 v[4:7],v250,s[20:23],s48 offen offset:0 sc1
M a[28:31],a[96:99],a[220:223],a[28:31]
s_waitcnt vmcnt(12)
M a[32:35],a[108:111],a[192:195],0
s_waitcnt vmcnt(11)
M a[32:35],a[112:115],a[196:199],a[32:35]
s_waitcnt vmcnt(10)
M a[32:35],a[116:119],a[200:203],a[32:35]
buffer_load_dwordx4 v[0:3],v250,s[20:23],s48 offen offset:1024 sc1
M a[36:39],a[116:119],a[204:207],0
M a[36:39],a[112:115],a[200:203],a[36:39]
M a[36:39],a[108:111],a[196:199],a[36:39]
M a[40:43],a[108:111],a[200:203],0
buffer_load_dwordx4 v[8:11],v250,s[20:23],s48 offen offset:2048 sc1
M a[40:43],a[112:115],a[204:207],a[40:43]
s_add_u32 s46,s72,27648
M a[40:43],a[116:119],a[208:211],a[40:43]
M a[44:47],a[116:119],a[212:215],0
M a[44:47],a[112:115],a[208:211],a[44:47]
buffer_load_dwordx4 v[36:39],v250,s[20:23],s46 offen offset:0 sc1
M a[44:47],a[108:111],a[204:207],a[44:47]
M a[48:51],a[108:111],a[208:211],0
M a[48:51],a[112:115],a[212:215],a[48:51]
M a[48:51],a[116:119],a[216:219],a[48:51]
buffer_load_dwordx4 v[32:35],v250,s[20:23],s46 offen offset:1024 sc1
M a[52:55],a[116:119],a[220:223],0
M a[52:55],a[112:115],a[216:219],a[52:55]
M a[52:55],a[108:111],a[212:215],a[52:55]
M a[56:59],a[108:111],a[216:219],0
buffer_load_dwordx4 v[40:43],v250,s[20:23],s46 offen offset:2048 sc1
M a[56:59],a[112:115],a[220:223],a[56:59]
s_add_u32 s47,s72,30720
M a[56:59],a[116:119],a[224:227],a[56:59]
M a[60:63],a[116:119],a[228:231],0
M a[60:63],a[112:115],a[224:227],a[60:63]
buffer_load_dwordx4 v[68:71],v250,s[20:23],s47 offen offset:0 sc1
M a[60:63],a[108:111],a[220:223],a[60:63]
s_waitcnt vmcnt(15)
M a[64:67],a[120:123],a[192:195],0
s_waitcnt vmcnt(14)
M a[64:67],a[124:127],a[196:199],a[64:67]
s_waitcnt vmcnt(13)
M a[64:67],a[128:131],a[200:203],a[64:67]
buffer_load_dwordx4 v[64:67],v250,s[20:23],s47 offen offset:1024 sc1
M a[68:71],a[128:131],a[204:207],0
M a[68:71],a[124:127],a[200:203],a[68:71]
M a[68:71],a[120:123],a[196:199],a[68:71]
M a[72:75],a[120:123],a[200:203],0
buffer_load_dwordx4 v[72:75],v250,s[20:23],s47 offen offset:2048 sc1
M a[72:75],a[124:127],a[204:207],a[72:75]
s_add_u32 s48,s72,33792
M a[72:75],a[128:131],a[208:211],a[72:75]
M a[76:79],a[128:131],a[212:215],0
M a[76:79],a[124:127],a[208:211],a[76:79]
buffer_load_dwordx4 v[100:103],v250,s[20:23],s48 offen offset:0 sc1
M a[76:79],a[120:123],a[204:207],a[76:79]
M a[80:83],a[120:123],a[208:211],0
M a[80:83],a[124:127],a[212:215],a[80:83]
M a[80:83],a[128:131],a[216:219],a[80:83]
buffer_load_dwordx4 v[96:99],v250,s[20:23],s48 offen offset:1024 sc1
M a[84:87],a[128:131],a[220:223],0
M a[84:87],a[124:127],a[216:219],a[84:87]
ds_read_b128 a[232:235],v248 offset:26112
M a[84:87],a[120:123],a[212:215],a[84:87]
ds_read_b128 a[236:239],v249 offset:26112
M a[88:91],a[120:123],a[216:219],0
buffer_load_dwordx4 v[104:107],v250,s[20:23],s48 offen offset:2048 sc1
M a[88:91],a[124:127],a[220:223],a[88:91]
s_add_u32 s46,s72,36864
ds_read_b128 a[240:243],v248 offset:26624
ds_read_b128 a[244:247],v249 offset:26624
M a[88:91],a[128:131],a[224:227],a[88:91]
M a[92:95],a[128:131],a[228:231],0
M a[92:95],a[124:127],a[224:227],a[92:95]
s_add_u32 s28,s68,0
buffer_load_dwordx4 v[132:135],v250,s[20:23],s46 offen offset:0 sc1
M a[92:95],a[120:123],a[220:223],a[92:95]
s_waitcnt vmcnt(18) lgkmcnt(3)
M a[96:99],a[132:135],a[232:235],0
s_waitcnt vmcnt(17) lgkmcnt(2)
ds_read_b128 a[248:251],v248 offset:27136
M a[96:99],a[136:139],a[236:239],a[96:99]
s_waitcnt vmcnt(16) lgkmcnt(2)
ds_read_b128 a[252:255],v249 offset:27136
M a[96:99],a[140:143],a[240:243],a[96:99]
s_waitcnt lgkmcnt(2)
buffer_load_dwordx4 v[128:131],v250,s[20:23],s46 offen offset:1024 sc1
M a[100:103],a[140:143],a[244:247],0
M a[100:103],a[136:139],a[240:243],a[100:103]
M a[100:103],a[132:135],a[236:239],a[100:103]
M a[104:107],a[132:135],a[240:243],0
buffer_load_dwordx4 v[136:139],v250,s[20:23],s46 offen offset:2048 sc1
M a[104:107],a[136:139],a[244:247],a[104:107]
s_waitcnt lgkmcnt(1)
ds_read_b128 v[216:219],v248 offset:27648
ds_read_b128 v[220:223],v249 offset:27648
M a[104:107],a[140:143],a[248:251],a[104:107]
s_waitcnt lgkmcnt(2)
M a[108:111],a[140:143],a[252:255],0
M a[108:111],a[136:139],a[248:251],a[108:111]
buffer_load_dwordx2 v[192:193],v251,s[12:15],s28 offen offset:0
M a[108:111],a[132:135],a[244:247],a[108:111]
M a[112:115],a[132:135],a[248:251],0
ds_read_b128 v[224:227],v249 offset:28160
M a[112:115],a[136:139],a[252:255],a[112:115]
s_waitcnt lgkmcnt(2)
ds_read_b128 v[228:231],v248 offset:28160
M a[112:115],a[140:143],v[216:219],a[112:115]
s_waitcnt lgkmcnt(2)
buffer_load_dwordx2 v[202:203],v251,s[16:19],s28 offen offset:1536
M a[116:119],a[140:143],v[220:223],0
M a[116:119],a[136:139],v[216:219],a[116:119]
M a[116:119],a[132:135],a[252:255],a[116:119]
M a[120:123],a[132:135],v[216:219],0
buffer_load_dwordx2 v[194:195],v251,s[8:11],s28 offen offset:0
M a[120:123],a[136:139],v[220:223],a[120:123]
s_waitcnt lgkmcnt(1)
M a[120:123],a[140:143],v[224:227],a[120:123]
s_waitcnt lgkmcnt(0)
M a[124:127],a[140:143],v[228:231],0
M a[124:127],a[136:139],v[224:227],a[124:127]
buffer_load_dwordx2 v[196:197],v251,s[8:11],s28 offen offset:384
M a[124:127],a[132:135],v[220:223],a[124:127]
s_waitcnt vmcnt(21)
M a[128:131],a[164:167],a[232:235],0
s_waitcnt vmcnt(20)
M a[128:131],a[160:163],a[236:239],a[128:131]
s_waitcnt vmcnt(19)
M a[128:131],a[168:171],a[240:243],a[128:131]
buffer_load_dwordx2 v[198:199],v251,s[8:11],s28 offen offset:768
M a[132:135],a[168:171],a[244:247],0
M a[132:135],a[160:163],a[240:243],a[132:135]
M a[132:135],a[164:167],a[236:239],a[132:135]
M a[136:139],a[164:167],a[240:243],0
buffer_load_dwordx2 v[200:201],v251,s[8:11],s28 offen offset:1152
M a[136:139],a[160:163],a[244:247],a[136:139]
M a[136:139],a[168:171],a[248:251],a[136:139]
M a[140:143],a[168:171],a[252:255],0
M a[140:143],a[160:163],a[248:251],a[140:143]
M a[140:143],a[164:167],a[244:247],a[140:143]
M a[144:147],a[164:167],a[248:251],0
M a[144:147],a[160:163],a[252:255],a[144:147]
M a[144:147],a[168:171],v[216:219],a[144:147]
M a[148:151],a[168:171],v[220:223],0
M a[148:151],a[160:163],v[216:219],a[148:151]
M a[148:151],a[164:167],a[252:255],a[148:151]
M a[152:155],a[164:167],v[216:219],0
M a[152:155],a[160:163],v[220:223],a[152:155]
M a[152:155],a[168:171],v[224:227],a[152:155]
M a[156:159],a[168:171],v[228:231],0
M a[156:159],a[160:163],v[224:227],a[156:159]
s_add_u32 s47,s72,39936
M a[156:159],a[164:167],v[220:223],a[156:159]
s_waitcnt vmcnt(20)
M a[160:163],v[4:7],a[232:235],0
s_waitcnt vmcnt(19)
M a[160:163],v[0:3],a[236:239],a[160:163]
s_waitcnt vmcnt(18)
M a[160:163],v[8:11],a[240:243],a[160:163]
M a[164:167],v[8:11],a[244:247],0
M a[164:167],v[0:3],a[240:243],a[164:167]
buffer_load_dwordx4 v[164:167],v250,s[20:23],s47 offen offset:0 sc1
M a[164:167],v[4:7],a[236:239],a[164:167]
M a[168:171],v[4:7],a[240:243],0
buffer_load_dwordx4 v[160:163],v250,s[20:23],s47 offen offset:1024 sc1
M a[168:171],v[0:3],a[244:247],a[168:171]
M a[168:171],v[8:11],a[248:251],a[168:171]
M a[172:175],v[8:11],a[252:255],0
M a[172:175],v[0:3],a[248:251],a[172:175]
buffer_load_dwordx4 v[168:171],v250,s[20:23],s47 offen offset:2048 sc1
M a[172:175],v[4:7],a[244:247],a[172:175]
s_add_u32 s48,s72,43008
M a[176:179],v[4:7],a[248:251],0
M a[176:179],v[0:3],a[252:255],a[176:179]
M a[176:179],v[8:11],v[216:219],a[176:179]
buffer_load_dwordx4 a[192:195],v250,s[20:23],s48 offen offset:0 sc1
M a[180:183],v[8:11],v[220:223],0
M a[180:183],v[0:3],v[216:219],a[180:183]
ds_read_b128 a[204:207],v248 offset:34816
M a[180:183],v[4:7],a[252:255],a[180:183]
ds_read_b128 a[208:211],v249 offset:34816
M a[184:187],v[4:7],v[216:219],0
buffer_load_dwordx4 a[196:199],v250,s[20:23],s48 offen offset:1024 sc1
M a[184:187],v[0:3],v[220:223],a[184:187]
ds_read_b128 a[216:219],v248 offset:35328
ds_read_b128 a[228:231],v249 offset:35328
M a[184:187],v[8:11],v[224:227],a[184:187]
M a[188:191],v[8:11],v[228:231],0
M a[188:191],v[0:3],v[224:227],a[188:191]
buffer_load_dwordx4 a[200:203],v250,s[20:23],s48 offen offset:2048 sc1
M a[188:191],v[4:7],v[220:223],a[188:191]
s_waitcnt vmcnt(23) lgkmcnt(3)
s_add_u32 s46,s73,9216
M v[0:3],v[36:39],a[204:207],0
s_waitcnt vmcnt(22) lgkmcnt(2)
ds_read_b128 a[224:227],v248 offset:35840
M v[0:3],v[32:35],a[208:211],v[0:3]
s_waitcnt vmcnt(21) lgkmcnt(2)
ds_read_b128 a[220:223],v249 offset:35840
M v[0:3],v[40:43],a[216:219],v[0:3]
s_waitcnt lgkmcnt(2)
buffer_load_dwordx4 a[212:215],v250,s[20:23],s46 offen offset:0 sc1
M v[4:7],v[40:43],a[228:231],0
M v[4:7],v[32:35],a[216:219],v[4:7]
M v[4:7],v[36:39],a[208:211],v[4:7]
M v[8:11],v[36:39],a[216:219],0
ds_read_b128 a[232:235],v248 offset:36352
M v[8:11],v[32:35],a[228:231],v[8:11]
s_waitcnt lgkmcnt(2)
ds_read_b128 a[236:239],v249 offset:36352
M v[8:11],v[40:43],a[224:227],v[8:11]
s_waitcnt lgkmcnt(2)
M v[12:15],v[40:43],a[220:223],0
M v[12:15],v[32:35],a[224:227],v[12:15]
M v[12:15],v[36:39],a[228:231],v[12:15]
s_add_u32 s28,s68,393216
buffer_load_dwordx2 v[204:205],v245,s[12:15],s28 offen offset:0
M v[16:19],v[36:39],a[224:227],0
ds_read_b128 a[240:243],v249 offset:36864
M v[16:19],v[32:35],a[220:223],v[16:19]
s_waitcnt lgkmcnt(2)
buffer_load_dwordx2 v[214:215],v245,s[16:19],s28 offen offset:1536
M v[16:19],v[40:43],a[232:235],v[16:19]
s_waitcnt lgkmcnt(1)
ds_read_b128 a[244:247],v248 offset:36864
M v[20:23],v[40:43],a[236:239],0
M v[20:23],v[32:35],a[232:235],v[20:23]
M v[20:23],v[36:39],a[220:223],v[20:23]
buffer_load_dwordx2 v[206:207],v245,s[8:11],s28 offen offset:0
M v[24:27],v[36:39],a[232:235],0
M v[24:27],v[32:35],a[236:239],v[24:27]
s_waitcnt lgkmcnt(1)
M v[24:27],v[40:43],a[240:243],v[24:27]
s_waitcnt lgkmcnt(0)
M v[28:31],v[40:43],a[244:247],0
buffer_load_dwordx2 v[208:209],v245,s[8:11],s28 offen offset:384
M v[28:31],v[32:35],a[240:243],v[28:31]
M v[28:31],v[36:39],a[236:239],v[28:31]
s_waitcnt vmcnt(25)
M v[32:35],v[68:71],a[204:207],0
s_waitcnt vmcnt(24)
M v[32:35],v[64:67],a[208:211],v[32:35]
s_waitcnt vmcnt(23)
buffer_load_dwordx2 v[210:211],v245,s[8:11],s28 offen offset:768
M v[32:35],v[72:75],a[216:219],v[32:35]
M v[36:39],v[72:75],a[228:231],0
M v[36:39],v[64:67],a[216:219],v[36:39]
M v[36:39],v[68:71],a[208:211],v[36:39]
buffer_load_dwordx2 v[212:213],v245,s[8:11],s28 offen offset:1152
M v[40:43],v[68:71],a[216:219],0
s_add_u32 s29,s68,0
M v[40:43],v[64:67],a[228:231],v[40:43]
M v[40:43],v[72:75],a[224:227],v[40:43]
M v[44:47],v[72:75],a[220:223],0
buffer_load_short_d16_hi v239,v246,s[12:15],s29 offen offset:0
M v[44:47],v[64:67],a[224:227],v[44:47]
M v[44:47],v[68:71],a[228:231],v[44:47]
buffer_load_short_d16_hi v240,v246,s[8:11],s29 offen offset:0
M v[48:51],v[68:71],a[224:227],0
M v[48:51],v[64:67],a[220:223],v[48:51]
buffer_load_short_d16_hi v241,v246,s[8:11],s29 offen offset:384
M v[48:51],v[72:75],a[232:235],v[48:51]
M v[52:55],v[72:75],a[236:239],0
buffer_load_short_d16_hi v242,v246,s[8:11],s29 offen offset:768
M v[52:55],v[64:67],a[232:235],v[52:55]
M v[52:55],v[68:71],a[220:223],v[52:55]
buffer_load_short_d16_hi v243,v246,s[8:11],s29 offen offset:1152
M v[56:59],v[68:71],a[232:235],0
M v[56:59],v[64:67],a[236:239],v[56:59]
buffer_load_short_d16_hi v244,v246,s[16:19],s29 offen offset:1536
M v[56:59],v[72:75],a[240:243],v[56:59]
M v[60:63],v[72:75],a[244:247],0
M v[60:63],v[64:67],a[240:243],v[60:63]
M v[60:63],v[68:71],a[236:239],v[60:63]
s_waitcnt vmcnt(30)
M v[64:67],v[100:103],a[204:207],0
s_waitcnt vmcnt(29)
M v[64:67],v[96:99],a[208:211],v[64:67]
s_waitcnt vmcnt(28)
M v[64:67],v[104:107],a[216:219],v[64:67]
M v[68:71],v[104:107],a[228:231],0
M v[68:71],v[96:99],a[216:219],v[68:71]
M v[68:71],v[100:103],a[208:211],v[68:71]
M v[72:75],v[100:103],a[216:219],0
M v[72:75],v[96:99],a[228:231],v[72:75]
M v[72:75],v[104:107],a[224:227],v[72:75]
M v[76:79],v[104:107],a[220:223],0
M v[76:79],v[96:99],a[224:227],v[76:79]
M v[76:79],v[100:103],a[228:231],v[76:79]
M v[80:83],v[100:103],a[224:227],0
M v[80:83],v[96:99],a[220:223],v[80:83]
M v[80:83],v[104:107],a[232:235],v[80:83]
M v[84:87],v[104:107],a[236:239],0
M v[84:87],v[96:99],a[232:235],v[84:87]
ds_read_b128 a[248:251],v248 offset:43520
M v[84:87],v[100:103],a[220:223],v[84:87]
ds_read_b128 a[252:255],v249 offset:43520
M v[88:91],v[100:103],a[232:235],0
ds_read_b128 v[216:219],v248 offset:44032
M v[88:91],v[96:99],a[236:239],v[88:91]
ds_read_b128 v[228:231],v249 offset:44032
M v[88:91],v[104:107],a[240:243],v[88:91]
M v[92:95],v[104:107],a[244:247],0
M v[92:95],v[96:99],a[240:243],v[92:95]
M v[92:95],v[100:103],a[236:239],v[92:95]
s_waitcnt vmcnt(27) lgkmcnt(3)
M v[96:99],v[132:135],a[248:251],0
s_waitcnt vmcnt(26) lgkmcnt(2)
ds_read_b128 v[224:227],v248 offset:44544
M v[96:99],v[128:131],a[252:255],v[96:99]
s_waitcnt vmcnt(25) lgkmcnt(2)
ds_read_b128 v[220:223],v249 offset:44544
M v[96:99],v[136:139],v[216:219],v[96:99]
s_waitcnt lgkmcnt(2)
M v[100:103],v[136:139],v[228:231],0
M v[100:103],v[128:131],v[216:219],v[100:103]
M v[100:103],v[132:135],a[252:255],v[100:103]
M v[104:107],v[132:135],v[216:219],0
ds_read_b128 a[204:207],v248 offset:45056
M v[104:107],v[128:131],v[228:231],v[104:107]
s_waitcnt lgkmcnt(2)
ds_read_b128 a[208:211],v249 offset:45056
M v[104:107],v[136:139],v[224:227],v[104:107]
s_waitcnt lgkmcnt(2)
M v[108:111],v[136:139],v[220:223],0
s_waitcnt vmcnt(21)
v_lshlrev_b32 v234,16,v196
v_lshlrev_b32 v232,16,v192
M v[108:111],v[128:131],v[224:227],v[108:111]
v_lshlrev_b32 v233,16,v194
v_lshlrev_b32 v237,16,v202
M v[108:111],v[132:135],v[228:231],v[108:111]
s_waitcnt vmcnt(19)
v_lshlrev_b32 v236,16,v200
v_lshlrev_b32 v235,16,v198
M v[112:115],v[132:135],v[224:227],0
ds_read_b128 a[216:219],v249 offset:45568
v_fmac_f32 v232,s43,v234
M v[112:115],v[128:131],v[220:223],v[112:115]
s_waitcnt lgkmcnt(2)
ds_read_b128 a[228:231],v248 offset:45568
v_fmac_f32 v237,4.0,v233
M v[112:115],v[136:139],a[204:207],v[112:115]
s_waitcnt lgkmcnt(2)
v_fma_f32 v238,-4.0,v234,v236
v_fmac_f32 v232,s45,v236
M v[116:119],v[136:139],a[208:211],0
v_fmac_f32 v237,s41,v235
v_sub_f32 v236,v236,v234
M v[116:119],v[128:131],a[204:207],v[116:119]
v_fma_f32 v234,-4.0,v233,v235
v_sub_f32 v235,v235,v233
M v[116:119],v[132:135],v[220:223],v[116:119]
v_add_f32 v233,v238,v234
v_sub_f32 v238,v238,v234
M v[120:123],v[132:135],a[204:207],0
v_fma_f32 v234,2.0,v235,v236
v_fmac_f32 v236,-2.0,v235
M v[120:123],v[128:131],a[208:211],v[120:123]
s_waitcnt lgkmcnt(1)
v_and_b32 v196,s42,v196
v_and_b32 v192,s42,v192
M v[120:123],v[136:139],a[216:219],v[120:123]
s_waitcnt lgkmcnt(0)
v_and_b32 v194,s42,v194
v_and_b32 v202,s42,v202
M v[124:127],v[136:139],a[228:231],0
buffer_load_dwordx4 a[224:227],v250,s[20:23],s46 offen offset:1024 sc1
M v[124:127],v[128:131],a[216:219],v[124:127]
v_and_b32 v200,s42,v200
v_and_b32 v198,s42,v198
M v[124:127],v[132:135],a[208:211],v[124:127]
s_waitcnt vmcnt(19)
buffer_load_dwordx4 a[220:223],v250,s[20:23],s46 offen offset:2048 sc1
M v[128:131],v[164:167],a[248:251],0
s_waitcnt vmcnt(19)
s_add_u32 s47,s73,12288
v_fmac_f32 v192,s43,v196
v_fmac_f32 v202,4.0,v194
M v[128:131],v[160:163],a[252:255],v[128:131]
s_waitcnt vmcnt(18)
v_fma_f32 v235,-4.0,v196,v200
v_fmac_f32 v192,s45,v200
M v[128:131],v[168:171],v[216:219],v[128:131]
v_fmac_f32 v202,s41,v198
v_sub_f32 v200,v200,v196
M v[132:135],v[168:171],v[228:231],0
buffer_load_dwordx4 a[232:235],v250,s[20:23],s47 offen offset:0 sc1
M v[132:135],v[160:163],v[216:219],v[132:135]
v_fma_f32 v196,-4.0,v194,v198
v_sub_f32 v198,v198,v194
M v[132:135],v[164:167],a[252:255],v[132:135]
v_add_f32 v194,v235,v196
v_sub_f32 v235,v235,v196
M v[136:139],v[164:167],v[216:219],0
v_fma_f32 v196,2.0,v198,v200
v_fmac_f32 v200,-2.0,v198
M v[136:139],v[160:163],v[228:231],v[136:139]
v_cvt_pk_bf16_f32 v192,v232,v192
v_cvt_pk_bf16_f32 v202,v237,v202
M v[136:139],v[168:171],v[224:227],v[136:139]
v_cvt_pk_bf16_f32 v194,v233,v194
v_cvt_pk_bf16_f32 v198,v234,v196
M v[140:143],v[168:171],v[220:223],0
v_cvt_pk_bf16_f32 v196,v238,v235
v_cvt_pk_bf16_f32 v200,v236,v200
M v[140:143],v[160:163],v[224:227],v[140:143]
v_lshlrev_b32 v234,16,v197
v_lshlrev_b32 v232,16,v193
M v[140:143],v[164:167],v[228:231],v[140:143]
v_lshlrev_b32 v233,16,v195
v_lshlrev_b32 v237,16,v203
M v[144:147],v[164:167],v[224:227],0
v_lshlrev_b32 v236,16,v201
v_lshlrev_b32 v235,16,v199
M v[144:147],v[160:163],v[220:223],v[144:147]
v_fmac_f32 v232,s43,v234
v_fmac_f32 v237,4.0,v233
M v[144:147],v[168:171],a[204:207],v[144:147]
v_fma_f32 v238,-4.0,v234,v236
v_fmac_f32 v232,s45,v236
M v[148:151],v[168:171],a[208:211],0
v_fmac_f32 v237,s41,v235
v_sub_f32 v236,v236,v234
M v[148:151],v[160:163],a[204:207],v[148:151]
v_fma_f32 v234,-4.0,v233,v235
v_sub_f32 v235,v235,v233
M v[148:151],v[164:167],v[220:223],v[148:151]
v_add_f32 v233,v238,v234
v_sub_f32 v238,v238,v234
M v[152:155],v[164:167],a[204:207],0
v_fma_f32 v234,2.0,v235,v236
v_fmac_f32 v236,-2.0,v235
M v[152:155],v[160:163],a[208:211],v[152:155]
v_and_b32 v197,s42,v197
v_and_b32 v193,s42,v193
M v[152:155],v[168:171],a[216:219],v[152:155]
v_and_b32 v195,s42,v195
v_and_b32 v203,s42,v203
M v[156:159],v[168:171],a[228:231],0
buffer_load_dwordx4 a[244:247],v250,s[20:23],s47 offen offset:1024 sc1
M v[156:159],v[160:163],a[216:219],v[156:159]
v_and_b32 v201,s42,v201
v_and_b32 v199,s42,v199
M v[156:159],v[164:167],a[208:211],v[156:159]
s_waitcnt vmcnt(19)
buffer_load_dwordx4 a[240:243],v250,s[20:23],s47 offen offset:2048 sc1
M v[160:163],a[192:195],a[248:251],0
s_waitcnt vmcnt(19)
s_add_u32 s48,s73,15360
v_fmac_f32 v193,s43,v197
v_fmac_f32 v203,4.0,v195
M v[160:163],a[196:199],a[252:255],v[160:163]
s_waitcnt vmcnt(18)
v_fma_f32 v235,-4.0,v197,v201
v_fmac_f32 v193,s45,v201
M v[160:163],a[200:203],v[216:219],v[160:163]
v_fmac_f32 v203,s41,v199
v_sub_f32 v201,v201,v197
M v[164:167],a[200:203],v[228:231],0
buffer_load_dwordx4 a[236:239],v250,s[20:23],s48 offen offset:0 sc1
M v[164:167],a[196:199],v[216:219],v[164:167]
v_fma_f32 v197,-4.0,v195,v199
v_sub_f32 v199,v199,v195
M v[164:167],a[192:195],a[252:255],v[164:167]
v_add_f32 v195,v235,v197
v_sub_f32 v235,v235,v197
M v[168:171],a[192:195],v[216:219],0
v_fma_f32 v197,2.0,v199,v201
v_fmac_f32 v201,-2.0,v199
M v[168:171],a[196:199],v[228:231],v[168:171]
buffer_load_dwordx4 a[248:251],v250,s[20:23],s48 offen offset:1024 sc1
M v[168:171],a[200:203],v[224:227],v[168:171]
v_cvt_pk_bf16_f32 v193,v232,v193
v_cvt_pk_bf16_f32 v203,v237,v203
M v[172:175],a[200:203],v[220:223],0
v_cvt_pk_bf16_f32 v195,v233,v195
v_cvt_pk_bf16_f32 v199,v234,v197
M v[172:175],a[196:199],v[224:227],v[172:175]
v_cvt_pk_bf16_f32 v197,v238,v235
v_cvt_pk_bf16_f32 v201,v236,v201
M v[172:175],a[192:195],v[228:231],v[172:175]
buffer_load_dwordx4 a[252:255],v250,s[20:23],s48 offen offset:2048 sc1
M v[176:179],a[192:195],v[224:227],0
s_waitcnt vmcnt(16)
s_add_u32 s46,s73,18432
v_lshlrev_b32 v234,16,v208
v_lshlrev_b32 v232,16,v204
M v[176:179],a[196:199],v[220:223],v[176:179]
v_lshlrev_b32 v233,16,v206
v_lshlrev_b32 v237,16,v214
M v[176:179],a[200:203],a[204:207],v[176:179]
s_waitcnt vmcnt(14)
s_barrier
v_lshlrev_b32 v236,16,v212
M v[180:183],a[200:203],a[208:211],0
buffer_load_dwordx4 v[216:219],v250,s[20:23],s46 offen offset:0 sc1
M v[180:183],a[196:199],a[204:207],v[180:183]
ds_read_b128 v[228:231],v248 offset:52224
v_lshlrev_b32 v235,16,v210
M v[180:183],a[192:195],v[220:223],v[180:183]
ds_write2st64_b64 v247,v[192:193],v[202:203] offset0:204 offset1:221
M v[184:187],a[192:195],a[204:207],0
s_add_u32 s28,s68,786432
ds_read_b128 v[224:227],v249 offset:52224
ds_read_b128 v[220:223],v248 offset:52736
M v[184:187],a[196:199],a[208:211],v[184:187]
buffer_load_dwordx2 v[192:193],v245,s[12:15],s28 offen offset:0
M v[184:187],a[200:203],a[216:219],v[184:187]
ds_write2st64_b64 v247,v[194:195],v[196:197] offset0:34 offset1:51
M v[188:191],a[200:203],a[228:231],0
ds_read_b128 a[204:207],v249 offset:52736
v_fmac_f32 v232,s43,v234
M v[188:191],a[196:199],a[216:219],v[188:191]
buffer_load_dwordx2 v[202:203],v245,s[16:19],s28 offen offset:1536
M v[188:191],a[192:195],a[208:211],v[188:191]
s_waitcnt lgkmcnt(5)
ds_write2st64_b64 v247,v[198:199],v[200:201] offset0:68 offset1:85
M a[0:3],a[212:215],v[228:231],a[0:3]
s_waitcnt vmcnt(10) lgkmcnt(4)
ds_read_b128 a[200:203],v248 offset:53248
v_fmac_f32 v237,4.0,v233
M a[0:3],a[224:227],v[224:227],a[0:3]
s_waitcnt vmcnt(9) lgkmcnt(4)
buffer_load_dwordx2 v[194:195],v245,s[8:11],s28 offen offset:0
M a[0:3],a[220:223],v[220:223],a[0:3]
s_waitcnt lgkmcnt(2)
ds_read_b128 a[228:231],v249 offset:53248
v_fma_f32 v238,-4.0,v234,v236
M a[4:7],a[220:223],a[204:207],a[4:7]
v_fmac_f32 v232,s45,v236
v_fmac_f32 v237,s41,v235
M a[4:7],a[224:227],v[220:223],a[4:7]
v_sub_f32 v236,v236,v234
v_fma_f32 v234,-4.0,v233,v235
M a[4:7],a[212:215],v[224:227],a[4:7]
buffer_load_dwordx2 v[196:197],v245,s[8:11],s28 offen offset:384
M a[8:11],a[212:215],v[220:223],a[8:11]
ds_read_b128 a[196:199],v248 offset:53760
v_sub_f32 v235,v235,v233
M a[8:11],a[224:227],a[204:207],a[8:11]
s_waitcnt lgkmcnt(2)
ds_read_b128 a[216:219],v249 offset:53760
v_add_f32 v233,v238,v234
M a[8:11],a[220:223],a[200:203],a[8:11]
s_waitcnt lgkmcnt(2)
v_sub_f32 v238,v238,v234
v_fma_f32 v234,2.0,v235,v236
M a[12:15],a[220:223],a[228:231],a[12:15]
buffer_load_dwordx2 v[198:199],v245,s[8:11],s28 offen offset:768
M a[12:15],a[224:227],a[200:203],a[12:15]
v_fmac_f32 v236,-2.0,v235
v_and_b32 v208,s42,v208
M a[12:15],a[212:215],a[204:207],a[12:15]
v_and_b32 v204,s42,v204
v_and_b32 v206,s42,v206
M a[16:19],a[212:215],a[200:203],a[16:19]
ds_read_b128 a[192:195],v249 offset:54272
v_and_b32 v214,s42,v214
M a[16:19],a[224:227],a[228:231],a[16:19]
s_waitcnt lgkmcnt(2)
buffer_load_dwordx2 v[200:201],v245,s[8:11],s28 offen offset:1152
M a[16:19],a[220:223],a[196:199],a[16:19]
s_waitcnt lgkmcnt(1)
ds_read_b128 a[208:211],v248 offset:54272
v_and_b32 v212,s42,v212
M a[20:23],a[220:223],a[216:219],a[20:23]
v_and_b32 v210,s42,v210
v_fmac_f32 v204,s43,v208
M a[20:23],a[224:227],a[196:199],a[20:23]
v_fmac_f32 v214,4.0,v206
v_fma_f32 v235,-4.0,v208,v212
M a[20:23],a[212:215],a[228:231],a[20:23]
v_fmac_f32 v204,s45,v212
v_fmac_f32 v214,s41,v210
M a[24:27],a[212:215],a[196:199],a[24:27]
v_sub_f32 v212,v212,v208
v_fma_f32 v208,-4.0,v206,v210
M a[24:27],a[224:227],a[216:219],a[24:27]
s_waitcnt lgkmcnt(1)
v_sub_f32 v210,v210,v206
v_add_f32 v206,v235,v208
M a[24:27],a[220:223],a[192:195],a[24:27]
s_waitcnt lgkmcnt(0)
v_sub_f32 v235,v235,v208
v_fma_f32 v208,2.0,v210,v212
M a[28:31],a[220:223],a[208:211],a[28:31]
buffer_load_dwordx4 a[220:223],v250,s[20:23],s46 offen offset:1024 sc1
M a[28:31],a[224:227],a[192:195],a[28:31]
v_fmac_f32 v212,-2.0,v210
v_cvt_pk_bf16_f32 v204,v232,v204
M a[28:31],a[212:215],a[216:219],a[28:31]
s_waitcnt vmcnt(13)
buffer_load_dwordx4 a[224:227],v250,s[20:23],s46 offen offset:2048 sc1
M a[32:35],a[232:235],v[228:231],a[32:35]
s_waitcnt vmcnt(13)
s_add_u32 s47,s73,21504
v_cvt_pk_bf16_f32 v214,v237,v214
v_cvt_pk_bf16_f32 v206,v233,v206
M a[32:35],a[244:247],v[224:227],a[32:35]
s_waitcnt vmcnt(12)
v_cvt_pk_bf16_f32 v210,v234,v208
v_cvt_pk_bf16_f32 v208,v238,v235
M a[32:35],a[240:243],v[220:223],a[32:35]
v_cvt_pk_bf16_f32 v212,v236,v212
v_lshlrev_b32 v234,16,v209
M a[36:39],a[240:243],a[204:207],a[36:39]
buffer_load_dwordx4 a[212:215],v250,s[20:23],s47 offen offset:0 sc1
M a[36:39],a[244:247],v[220:223],a[36:39]
v_lshlrev_b32 v232,16,v205
v_lshlrev_b32 v233,16,v207
M a[36:39],a[232:235],v[224:227],a[36:39]
v_lshlrev_b32 v237,16,v215
v_lshlrev_b32 v236,16,v213
M a[40:43],a[232:235],v[220:223],a[40:43]
v_lshlrev_b32 v235,16,v211
v_fmac_f32 v232,s43,v234
M a[40:43],a[244:247],a[204:207],a[40:43]
v_fmac_f32 v237,4.0,v233
v_fma_f32 v238,-4.0,v234,v236
M a[40:43],a[240:243],a[200:203],a[40:43]
v_fmac_f32 v232,s45,v236
v_fmac_f32 v237,s41,v235
M a[44:47],a[240:243],a[228:231],a[44:47]
v_sub_f32 v236,v236,v234
v_fma_f32 v234,-4.0,v233,v235
M a[44:47],a[244:247],a[200:203],a[44:47]
v_sub_f32 v235,v235,v233
v_add_f32 v233,v238,v234
M a[44:47],a[232:235],a[204:207],a[44:47]
v_sub_f32 v238,v238,v234
v_fma_f32 v234,2.0,v235,v236
M a[48:51],a[232:235],a[200:203],a[48:51]
v_fmac_f32 v236,-2.0,v235
v_and_b32 v209,s42,v209
M a[48:51],a[244:247],a[228:231],a[48:51]
v_and_b32 v205,s42,v205
v_and_b32 v207,s42,v207
M a[48:51],a[240:243],a[196:199],a[48:51]
v_and_b32 v215,s42,v215
v_and_b32 v213,s42,v213
M a[52:55],a[240:243],a[216:219],a[52:55]
v_and_b32 v211,s42,v211
v_fmac_f32 v205,s43,v209
M a[52:55],a[244:247],a[196:199],a[52:55]
v_fmac_f32 v215,4.0,v207
v_fma_f32 v235,-4.0,v209,v213
M a[52:55],a[232:235],a[228:231],a[52:55]
v_fmac_f32 v205,s45,v213
v_fmac_f32 v215,s41,v211
M a[56:59],a[232:235],a[196:199],a[56:59]
v_sub_f32 v213,v213,v209
v_fma_f32 v209,-4.0,v207,v211
M a[56:59],a[244:247],a[216:219],a[56:59]
v_sub_f32 v211,v211,v207
v_add_f32 v207,v235,v209
M a[56:59],a[240:243],a[192:195],a[56:59]
v_sub_f32 v235,v235,v209
v_fma_f32 v209,2.0,v211,v213
M a[60:63],a[240:243],a[208:211],a[60:63]
buffer_load_dwordx4 a[240:243],v250,s[20:23],s47 offen offset:1024 sc1
M a[60:63],a[244:247],a[192:195],a[60:63]
v_fmac_f32 v213,-2.0,v211
v_cvt_pk_bf16_f32 v205,v232,v205
M a[60:63],a[232:235],a[216:219],a[60:63]
s_waitcnt vmcnt(13)
buffer_load_dwordx4 a[244:247],v250,s[20:23],s47 offen offset:2048 sc1
M a[64:67],a[236:239],v[228:231],a[64:67]
s_waitcnt vmcnt(13)
s_add_u32 s48,s73,24576
v_cvt_pk_bf16_f32 v215,v237,v215
v_cvt_pk_bf16_f32 v207,v233,v207
M a[64:67],a[248:251],v[224:227],a[64:67]
s_waitcnt vmcnt(12)
v_cvt_pk_bf16_f32 v211,v234,v209
v_cvt_pk_bf16_f32 v209,v238,v235
M a[64:67],a[252:255],v[220:223],a[64:67]
v_cvt_pk_bf16_f32 v213,v236,v213
v_fmac_f32 v239,s43,v241
M a[68:71],a[252:255],a[204:207],a[68:71]
buffer_load_dwordx4 a[232:235],v250,s[20:23],s48 offen offset:0 sc1
M a[68:71],a[248:251],v[220:223],a[68:71]
v_fmac_f32 v244,4.0,v240
v_fma_f32 v232,-4.0,v241,v243
M a[68:71],a[236:239],v[224:227],a[68:71]
ds_write2st64_b64 v247,v[204:205],v[214:215] offset0:205 offset1:222
M a[72:75],a[236:239],v[220:223],a[72:75]
s_add_u32 s28,s68,1179648
v_fmac_f32 v239,s45,v243
v_fmac_f32 v244,s41,v242
M a[72:75],a[248:251],a[204:207],a[72:75]
buffer_load_dwordx4 v[228:231],v250,s[20:23],s48 offen offset:1024 sc1
M a[72:75],a[252:255],a[200:203],a[72:75]
ds_write2st64_b64 v247,v[206:207],v[208:209] offset0:35 offset1:52
M a[76:79],a[252:255],a[228:231],a[76:79]
v_sub_f32 v243,v243,v241
v_fma_f32 v241,-4.0,v240,v242
M a[76:79],a[248:251],a[200:203],a[76:79]
buffer_load_dwordx4 v[224:227],v250,s[20:23],s48 offen offset:2048 sc1
M a[76:79],a[236:239],a[204:207],a[76:79]
s_add_u32 s46,s73,27648
ds_write2st64_b64 v247,v[210:211],v[212:213] offset0:69 offset1:86
M a[80:83],a[236:239],a[200:203],a[80:83]
v_sub_f32 v242,v242,v240
v_add_f32 v240,v232,v241
M a[80:83],a[248:251],a[228:231],a[80:83]
buffer_load_dwordx4 v[220:223],v250,s[20:23],s46 offen offset:0 sc1
M a[80:83],a[252:255],a[196:199],a[80:83]
v_sub_f32 v232,v232,v241
v_fma_f32 v241,2.0,v242,v243
M a[84:87],a[252:255],a[216:219],a[84:87]
v_fmac_f32 v243,-2.0,v242
v_cvt_pk_bf16_f32 v233,v239,v244
M a[84:87],a[248:251],a[196:199],a[84:87]
ds_read_b128 a[204:207],v248 offset:60928
v_cvt_pk_bf16_f32 v234,v240,v232
M a[84:87],a[236:239],a[228:231],a[84:87]
buffer_load_dwordx2 v[204:205],v245,s[12:15],s28 offen offset:0
M a[88:91],a[236:239],a[196:199],a[88:91]
ds_read_b128 a[200:203],v249 offset:60928
ds_read_b128 a[228:231],v248 offset:61440
M a[88:91],a[248:251],a[216:219],a[88:91]
ds_read_b128 a[196:199],v249 offset:61440
v_cvt_pk_bf16_f32 v235,v241,v243
M a[88:91],a[252:255],a[192:195],a[88:91]
v_add_u32 v232,104448,v252
M a[92:95],a[252:255],a[208:211],a[92:95]
buffer_load_dwordx2 v[214:215],v245,s[16:19],s28 offen offset:1536
M a[92:95],a[248:251],a[192:195],a[92:95]
ds_write_b16 v232,v233 offset:0
M a[92:95],a[236:239],a[216:219],a[92:95]
s_waitcnt vmcnt(17) lgkmcnt(4)
ds_write_b16_d16_hi v232,v233 offset:8704
M a[96:99],v[216:219],a[204:207],a[96:99]
s_waitcnt vmcnt(10) lgkmcnt(4)
ds_read_b128 a[208:211],v248 offset:61952
ds_write_b16 v252,v234 offset:17408
M a[96:99],a[220:223],a[200:203],a[96:99]
s_waitcnt vmcnt(9) lgkmcnt(5)
buffer_load_dwordx2 v[206:207],v245,s[8:11],s28 offen offset:0
M a[96:99],a[224:227],a[228:231],a[96:99]
s_waitcnt lgkmcnt(4)
ds_read_b128 a[252:255],v249 offset:61952
ds_write_b16_d16_hi v252,v234 offset:26112
M a[100:103],a[224:227],a[196:199],a[100:103]
ds_write_b16 v252,v235 offset:34816
M a[100:103],a[220:223],a[228:231],a[100:103]
ds_write_b16_d16_hi v252,v235 offset:43520
M a[100:103],v[216:219],a[200:203],a[100:103]
buffer_load_dwordx2 v[208:209],v245,s[8:11],s28 offen offset:384
M a[104:107],v[216:219],a[228:231],a[104:107]
ds_read_b128 a[192:195],v248 offset:62464
v_lshlrev_b32 v234,16,v196
M a[104:107],a[220:223],a[196:199],a[104:107]
s_waitcnt lgkmcnt(6)
ds_read_b128 a[248:251],v249 offset:62464
v_lshlrev_b32 v232,16,v192
M a[104:107],a[224:227],a[208:211],a[104:107]
s_waitcnt lgkmcnt(5)
v_lshlrev_b32 v233,16,v194
v_lshlrev_b32 v237,16,v202
M a[108:111],a[224:227],a[252:255],a[108:111]
buffer_load_dwordx2 v[210:211],v245,s[8:11],s28 offen offset:768
M a[108:111],a[220:223],a[208:211],a[108:111]
v_lshlrev_b32 v236,16,v200
v_lshlrev_b32 v235,16,v198
M a[108:111],v[216:219],a[196:199],a[108:111]
v_fmac_f32 v232,s43,v234
v_fmac_f32 v237,4.0,v233
M a[112:115],v[216:219],a[208:211],a[112:115]
ds_read_b128 a[216:219],v249 offset:62976
v_fma_f32 v238,-4.0,v234,v236
M a[112:115],a[220:223],a[252:255],a[112:115]
s_waitcnt lgkmcnt(2)
buffer_load_dwordx2 v[212:213],v245,s[8:11],s28 offen offset:1152
M a[112:115],a[224:227],a[192:195],a[112:115]
s_waitcnt lgkmcnt(1)
s_add_u32 s29,s69,0
ds_read_b128 a[236:239],v248 offset:62976
v_fmac_f32 v232,s45,v236
M a[116:119],a[224:227],a[248:251],a[116:119]
v_fmac_f32 v237,s41,v235
v_sub_f32 v236,v236,v234
M a[116:119],a[220:223],a[192:195],a[116:119]
v_fma_f32 v234,-4.0,v233,v235
v_sub_f32 v235,v235,v233
M a[116:119],v[216:219],a[252:255],a[116:119]
buffer_load_short_d16_hi v239,v246,s[12:15],s29 offen offset:0
M a[120:123],v[216:219],a[192:195],a[120:123]
v_add_f32 v233,v238,v234
v_sub_f32 v238,v238,v234
M a[120:123],a[220:223],a[248:251],a[120:123]
s_waitcnt lgkmcnt(1)
buffer_load_short_d16_hi v240,v246,s[8:11],s29 offen offset:0
M a[120:123],a[224:227],a[216:219],a[120:123]
s_waitcnt lgkmcnt(0)
v_fma_f32 v234,2.0,v235,v236
v_fmac_f32 v236,-2.0,v235
M a[124:127],a[224:227],a[236:239],a[124:127]
buffer_load_dwordx4 a[224:227],v250,s[20:23],s46 offen offset:1024 sc1
M a[124:127],a[220:223],a[216:219],a[124:127]
v_and_b32 v196,s42,v196
v_and_b32 v192,s42,v192
M a[124:127],v[216:219],a[248:251],a[124:127]
s_waitcnt vmcnt(15)
v_and_b32 v194,s42,v194
v_and_b32 v202,s42,v202
M a[128:131],a[212:215],a[204:207],a[128:131]
s_waitcnt vmcnt(14)
v_and_b32 v200,s42,v200
v_and_b32 v198,s42,v198
M a[128:131],a[240:243],a[200:203],a[128:131]
s_waitcnt vmcnt(13)
buffer_load_dwordx4 a[220:223],v250,s[20:23],s46 offen offset:2048 sc1
M a[128:131],a[244:247],a[228:231],a[128:131]
s_add_u32 s47,s73,30720
v_fmac_f32 v192,s43,v196
v_fmac_f32 v202,4.0,v194
M a[132:135],a[244:247],a[196:199],a[132:135]
v_fma_f32 v235,-4.0,v196,v200
v_fmac_f32 v192,s45,v200
M a[132:135],a[240:243],a[228:231],a[132:135]
v_fmac_f32 v202,s41,v198
v_sub_f32 v200,v200,v196
M a[132:135],a[212:215],a[200:203],a[132:135]
buffer_load_dwordx4 v[216:219],v250,s[20:23],s47 offen offset:0 sc1
M a[136:139],a[212:215],a[228:231],a[136:139]
v_fma_f32 v196,-4.0,v194,v198
v_sub_f32 v198,v198,v194
M a[136:139],a[240:243],a[196:199],a[136:139]
v_add_f32 v194,v235,v196
v_sub_f32 v235,v235,v196
M a[136:139],a[244:247],a[208:211],a[136:139]
v_fma_f32 v196,2.0,v198,v200
v_fmac_f32 v200,-2.0,v198
M a[140:143],a[244:247],a[252:255],a[140:143]
buffer_load_short_d16_hi v241,v246,s[8:11],s29 offen offset:384
M a[140:143],a[240:243],a[208:211],a[140:143]
v_cvt_pk_bf16_f32 v192,v232,v192
v_cvt_pk_bf16_f32 v202,v237,v202
M a[140:143],a[212:215],a[196:199],a[140:143]
buffer_load_short_d16_hi v242,v246,s[8:11],s29 offen offset:768
M a[144:147],a[212:215],a[208:211],a[144:147]
v_cvt_pk_bf16_f32 v194,v233,v194
v_cvt_pk_bf16_f32 v198,v234,v196
M a[144:147],a[240:243],a[252:255],a[144:147]
buffer_load_short_d16_hi v243,v246,s[8:11],s29 offen offset:1152
M a[144:147],a[244:247],a[192:195],a[144:147]
v_cvt_pk_bf16_f32 v196,v238,v235
v_cvt_pk_bf16_f32 v200,v236,v200
M a[148:151],a[244:247],a[248:251],a[148:151]
buffer_load_short_d16_hi v244,v246,s[16:19],s29 offen offset:1536
M a[148:151],a[240:243],a[192:195],a[148:151]
v_lshlrev_b32 v234,16,v197
v_lshlrev_b32 v232,16,v193
M a[148:151],a[212:215],a[252:255],a[148:151]
v_lshlrev_b32 v233,16,v195
v_lshlrev_b32 v237,16,v203
M a[152:155],a[212:215],a[192:195],a[152:155]
v_lshlrev_b32 v236,16,v201
v_lshlrev_b32 v235,16,v199
M a[152:155],a[240:243],a[248:251],a[152:155]
v_fmac_f32 v232,s43,v234
v_fmac_f32 v237,4.0,v233
M a[152:155],a[244:247],a[216:219],a[152:155]
v_fma_f32 v238,-4.0,v234,v236
v_fmac_f32 v232,s45,v236
M a[156:159],a[244:247],a[236:239],a[156:159]
buffer_load_dwordx4 a[244:247],v250,s[20:23],s47 offen offset:1024 sc1
M a[156:159],a[240:243],a[216:219],a[156:159]
v_fmac_f32 v237,s41,v235
v_sub_f32 v236,v236,v234
M a[156:159],a[212:215],a[248:251],a[156:159]
s_waitcnt vmcnt(19)
buffer_load_dwordx4 a[240:243],v250,s[20:23],s47 offen offset:2048 sc1
M a[160:163],a[232:235],a[204:207],a[160:163]
s_waitcnt vmcnt(19)
s_add_u32 s48,s73,33792
v_fma_f32 v234,-4.0,v233,v235
v_sub_f32 v235,v235,v233
M a[160:163],v[228:231],a[200:203],a[160:163]
s_waitcnt vmcnt(18)
v_add_f32 v233,v238,v234
v_sub_f32 v238,v238,v234
M a[160:163],v[224:227],a[228:231],a[160:163]
v_fma_f32 v234,2.0,v235,v236
v_fmac_f32 v236,-2.0,v235
M a[164:167],v[224:227],a[196:199],a[164:167]
buffer_load_dwordx4 a[212:215],v250,s[20:23],s48 offen offset:0 sc1
M a[164:167],v[228:231],a[228:231],a[164:167]
v_and_b32 v197,s42,v197
v_and_b32 v193,s42,v193
M a[164:167],a[232:235],a[200:203],a[164:167]
v_and_b32 v195,s42,v195
v_and_b32 v203,s42,v203
M a[168:171],a[232:235],a[228:231],a[168:171]
v_and_b32 v201,s42,v201
v_and_b32 v199,s42,v199
M a[168:171],v[228:231],a[196:199],a[168:171]
buffer_load_dwordx4 a[204:207],v250,s[20:23],s48 offen offset:1024 sc1
M a[168:171],v[224:227],a[208:211],a[168:171]
v_fmac_f32 v193,s43,v197
v_fmac_f32 v203,4.0,v195
M a[172:175],v[224:227],a[252:255],a[172:175]
v_fma_f32 v235,-4.0,v197,v201
v_fmac_f32 v193,s45,v201
M a[172:175],v[228:231],a[208:211],a[172:175]
v_fmac_f32 v203,s41,v199
v_sub_f32 v201,v201,v197
M a[172:175],a[232:235],a[196:199],a[172:175]
buffer_load_dwordx4 a[200:203],v250,s[20:23],s48 offen offset:2048 sc1
M a[176:179],a[232:235],a[208:211],a[176:179]
s_add_u32 s46,s73,36864
v_fma_f32 v197,-4.0,v195,v199
v_sub_f32 v199,v199,v195
M a[176:179],v[228:231],a[252:255],a[176:179]
v_add_u32 v248,0x4400,v248
v_add_u32 v249,0x4400,v249
M a[176:179],v[224:227],a[192:195],a[176:179]
v_add_f32 v195,v235,v197
v_sub_f32 v235,v235,v197
M a[180:183],v[224:227],a[248:251],a[180:183]
buffer_load_dwordx4 a[228:231],v250,s[20:23],s46 offen offset:0 sc1
M a[180:183],v[228:231],a[192:195],a[180:183]
ds_read_b128 a[196:199],v248 offset:52224
v_fma_f32 v197,2.0,v199,v201
M a[180:183],a[232:235],a[252:255],a[180:183]
ds_read_b128 a[208:211],v249 offset:52224
v_fmac_f32 v201,-2.0,v199
M a[184:187],a[232:235],a[192:195],a[184:187]
ds_read_b128 a[252:255],v248 offset:52736
v_cvt_pk_bf16_f32 v193,v232,v193
M a[184:187],v[228:231],a[248:251],a[184:187]
ds_read_b128 a[192:195],v249 offset:52736
v_cvt_pk_bf16_f32 v203,v237,v203
M a[184:187],v[224:227],a[216:219],a[184:187]
v_cvt_pk_bf16_f32 v195,v233,v195
v_cvt_pk_bf16_f32 v199,v234,v197
M a[188:191],v[224:227],a[236:239],a[188:191]
v_cvt_pk_bf16_f32 v197,v238,v235
v_cvt_pk_bf16_f32 v201,v236,v201
M a[188:191],v[228:231],a[216:219],a[188:191]
M a[188:191],a[232:235],a[248:251],a[188:191]
s_waitcnt vmcnt(21) lgkmcnt(3)
ds_write2st64_b64 v247,v[192:193],v[202:203] offset0:206 offset1:223
M v[0:3],v[220:223],a[196:199],v[0:3]
s_waitcnt vmcnt(12) lgkmcnt(3)
s_add_u32 s28,s69,0
buffer_load_dwordx2 v[192:193],v251,s[12:15],s28 offen offset:0
M v[0:3],a[224:227],a[208:211],v[0:3]
s_waitcnt vmcnt(12) lgkmcnt(2)
ds_read_b128 a[236:239],v248 offset:53248
ds_read_b128 v[224:227],v249 offset:53248
M v[0:3],a[220:223],a[252:255],v[0:3]
s_waitcnt lgkmcnt(3)
buffer_load_dwordx2 v[202:203],v251,s[16:19],s28 offen offset:1536
M v[4:7],a[220:223],a[192:195],v[4:7]
v_lshlrev_b32 v234,16,v208
v_lshlrev_b32 v232,16,v204
M v[4:7],a[224:227],a[252:255],v[4:7]
v_lshlrev_b32 v233,16,v206
v_lshlrev_b32 v237,16,v214
M v[4:7],v[220:223],a[208:211],v[4:7]
ds_write2st64_b64 v247,v[194:195],v[196:197] offset0:36 offset1:53
M v[8:11],v[220:223],a[252:255],v[8:11]
buffer_load_dwordx2 v[194:195],v251,s[8:11],s28 offen offset:0
M v[8:11],a[224:227],a[192:195],v[8:11]
s_waitcnt lgkmcnt(2)
ds_read_b128 a[216:219],v248 offset:53760
ds_read_b128 v[228:231],v249 offset:53760
M v[8:11],a[220:223],a[236:239],v[8:11]
s_waitcnt lgkmcnt(3)
ds_write2st64_b64 v247,v[198:199],v[200:201] offset0:70 offset1:87
M v[12:15],a[220:223],v[224:227],v[12:15]
buffer_load_dwordx2 v[196:197],v251,s[8:11],s28 offen offset:384
M v[12:15],a[224:227],a[236:239],v[12:15]
v_lshlrev_b32 v236,16,v212
v_lshlrev_b32 v235,16,v210
M v[12:15],v[220:223],a[192:195],v[12:15]
v_fmac_f32 v232,s43,v234
v_fmac_f32 v237,4.0,v233
M v[16:19],v[220:223],a[236:239],v[16:19]
ds_read_b128 a[232:235],v249 offset:54272
v_fma_f32 v238,-4.0,v234,v236
M v[16:19],a[224:227],v[224:227],v[16:19]
s_waitcnt lgkmcnt(3)
buffer_load_dwordx2 v[198:199],v251,s[8:11],s28 offen offset:768
M v[16:19],a[220:223],a[216:219],v[16:19]
s_waitcnt lgkmcnt(2)
ds_read_b128 a[248:251],v248 offset:54272
v_fmac_f32 v232,s45,v236
M v[20:23],a[220:223],v[228:231],v[20:23]
v_fmac_f32 v237,s41,v235
v_sub_f32 v236,v236,v234
M v[20:23],a[224:227],a[216:219],v[20:23]
v_fma_f32 v234,-4.0,v233,v235
v_sub_f32 v235,v235,v233
M v[20:23],v[220:223],v[224:227],v[20:23]
buffer_load_dwordx2 v[200:201],v251,s[8:11],s28 offen offset:1152
M v[24:27],v[220:223],a[216:219],v[24:27]
v_add_f32 v233,v238,v234
v_sub_f32 v238,v238,v234
M v[24:27],a[224:227],v[228:231],v[24:27]
s_waitcnt lgkmcnt(1)
v_fma_f32 v234,2.0,v235,v236
v_fmac_f32 v236,-2.0,v235
M v[24:27],a[220:223],a[232:235],v[24:27]
s_waitcnt lgkmcnt(0)
v_and_b32 v208,s42,v208
v_and_b32 v204,s42,v204
M v[28:31],a[220:223],a[248:251],v[28:31]
global_load_dword a220,v250,s[64:65]
M v[28:31],a[224:227],a[232:235],v[28:31]
v_and_b32 v206,s42,v206
v_and_b32 v214,s42,v214
M v[28:31],v[220:223],v[228:231],v[28:31]
s_waitcnt vmcnt(17)
buffer_load_dwordx4 a[220:223],v250,s[20:23],s46 offen offset:1024 sc1
M v[32:35],v[216:219],a[196:199],v[32:35]
s_waitcnt vmcnt(13)
v_and_b32 v212,s42,v212
v_and_b32 v210,s42,v210
M v[32:35],a[244:247],a[208:211],v[32:35]
s_waitcnt vmcnt(12)
v_fmac_f32 v204,s43,v208
v_fmac_f32 v214,4.0,v206
M v[32:35],a[240:243],a[252:255],v[32:35]
v_fma_f32 v235,-4.0,v208,v212
v_fmac_f32 v204,s45,v212
M v[36:39],a[240:243],a[192:195],v[36:39]
buffer_load_dwordx4 a[224:227],v250,s[20:23],s46 offen offset:2048 sc1
M v[36:39],a[244:247],a[252:255],v[36:39]
s_add_u32 s47,s73,39936
v_fmac_f32 v214,s41,v210
v_sub_f32 v212,v212,v208
M v[36:39],v[216:219],a[208:211],v[36:39]
v_fma_f32 v208,-4.0,v206,v210
v_sub_f32 v210,v210,v206
M v[40:43],v[216:219],a[252:255],v[40:43]
v_add_f32 v206,v235,v208
v_sub_f32 v235,v235,v208
M v[40:43],a[244:247],a[192:195],v[40:43]
buffer_load_dwordx4 v[220:223],v250,s[20:23],s47 offen offset:0 sc1
M v[40:43],a[240:243],a[236:239],v[40:43]
v_fma_f32 v208,2.0,v210,v212
v_fmac_f32 v212,-2.0,v210
M v[44:47],a[240:243],v[224:227],v[44:47]
v_cvt_pk_bf16_f32 v204,v232,v204
v_cvt_pk_bf16_f32 v214,v237,v214
M v[44:47],a[244:247],a[236:239],v[44:47]
v_cvt_pk_bf16_f32 v206,v233,v206
v_cvt_pk_bf16_f32 v210,v234,v208
M v[44:47],v[216:219],a[192:195],v[44:47]
v_cvt_pk_bf16_f32 v208,v238,v235
v_cvt_pk_bf16_f32 v212,v236,v212
M v[48:51],v[216:219],a[236:239],v[48:51]
v_lshlrev_b32 v234,16,v209
v_lshlrev_b32 v232,16,v205
M v[48:51],a[244:247],v[224:227],v[48:51]
v_lshlrev_b32 v233,16,v207
v_lshlrev_b32 v237,16,v215
M v[48:51],a[240:243],a[216:219],v[48:51]
v_lshlrev_b32 v236,16,v213
v_lshlrev_b32 v235,16,v211
M v[52:55],a[240:243],v[228:231],v[52:55]
v_fmac_f32 v232,s43,v234
v_fmac_f32 v237,4.0,v233
M v[52:55],a[244:247],a[216:219],v[52:55]
v_fma_f32 v238,-4.0,v234,v236
v_fmac_f32 v232,s45,v236
M v[52:55],v[216:219],v[224:227],v[52:55]
v_fmac_f32 v237,s41,v235
v_sub_f32 v236,v236,v234
M v[56:59],v[216:219],a[216:219],v[56:59]
v_fma_f32 v234,-4.0,v233,v235
v_sub_f32 v235,v235,v233
M v[56:59],a[244:247],v[228:231],v[56:59]
v_add_f32 v233,v238,v234
v_sub_f32 v238,v238,v234
M v[56:59],a[240:243],a[232:235],v[56:59]
v_fma_f32 v234,2.0,v235,v236
v_fmac_f32 v236,-2.0,v235
M v[60:63],a[240:243],a[248:251],v[60:63]
buffer_load_dwordx4 a[240:243],v250,s[20:23],s47 offen offset:1024 sc1
M v[60:63],a[244:247],a[232:235],v[60:63]
v_and_b32 v209,s42,v209
v_and_b32 v205,s42,v205
M v[60:63],v[216:219],v[228:231],v[60:63]
s_waitcnt vmcnt(14)
buffer_load_dwordx4 a[244:247],v250,s[20:23],s47 offen offset:2048 sc1
M v[64:67],a[212:215],a[196:199],v[64:67]
s_waitcnt vmcnt(14)
s_add_u32 s48,s73,43008
v_and_b32 v207,s42,v207
v_and_b32 v215,s42,v215
M v[64:67],a[204:207],a[208:211],v[64:67]
s_waitcnt vmcnt(13)
v_and_b32 v213,s42,v213
v_and_b32 v211,s42,v211
M v[64:67],a[200:203],a[252:255],v[64:67]
v_fmac_f32 v205,s43,v209
v_fmac_f32 v215,4.0,v207
M v[68:71],a[200:203],a[192:195],v[68:71]
buffer_load_dwordx4 v[216:219],v250,s[20:23],s48 offen offset:0 sc1
M v[68:71],a[204:207],a[252:255],v[68:71]
v_fma_f32 v235,-4.0,v209,v213
v_fmac_f32 v205,s45,v213
M v[68:71],a[212:215],a[208:211],v[68:71]
v_fmac_f32 v215,s41,v211
v_sub_f32 v213,v213,v209
M v[72:75],a[212:215],a[252:255],v[72:75]
v_fma_f32 v209,-4.0,v207,v211
v_sub_f32 v211,v211,v207
M v[72:75],a[204:207],a[192:195],v[72:75]
buffer_load_dwordx4 a[196:199],v250,s[20:23],s48 offen offset:1024 sc1
M v[72:75],a[200:203],a[236:239],v[72:75]
v_add_f32 v207,v235,v209
v_sub_f32 v235,v235,v209
M v[76:79],a[200:203],v[224:227],v[76:79]
v_fma_f32 v209,2.0,v211,v213
v_fmac_f32 v213,-2.0,v211
M v[76:79],a[204:207],a[236:239],v[76:79]
v_cvt_pk_bf16_f32 v205,v232,v205
v_cvt_pk_bf16_f32 v215,v237,v215
M v[76:79],a[212:215],a[192:195],v[76:79]
buffer_load_dwordx4 a[208:211],v250,s[20:23],s48 offen offset:2048 sc1
M v[80:83],a[212:215],a[236:239],v[80:83]
s_add_u32 s46,s74,9216
v_cvt_pk_bf16_f32 v207,v233,v207
v_cvt_pk_bf16_f32 v211,v234,v209
M v[80:83],a[204:207],v[224:227],v[80:83]
v_cvt_pk_bf16_f32 v209,v238,v235
v_cvt_pk_bf16_f32 v213,v236,v213
M v[80:83],a[200:203],a[216:219],v[80:83]
ds_write2st64_b64 v247,v[204:205],v[214:215] offset0:207 offset1:224
M v[84:87],a[200:203],v[228:231],v[84:87]
s_add_u32 s28,s69,393216
buffer_load_dwordx4 a[252:255],v250,s[20:23],s46 offen offset:0 sc1
M v[84:87],a[204:207],a[216:219],v[84:87]
s_waitcnt vmcnt(12)
ds_read_b128 a[192:195],v248 offset:60928
v_lshlrev_b32 v234,16,v196
M v[84:87],a[212:215],v[224:227],v[84:87]
ds_write2st64_b64 v247,v[206:207],v[208:209] offset0:37 offset1:54
M v[88:91],a[212:215],a[216:219],v[88:91]
buffer_load_dwordx2 v[204:205],v245,s[12:15],s28 offen offset:0
M v[88:91],a[204:207],v[228:231],v[88:91]
ds_read_b128 a[236:239],v249 offset:60928
ds_read_b128 v[224:227],v248 offset:61440
M v[88:91],a[200:203],a[232:235],v[88:91]
ds_write2st64_b64 v247,v[210:211],v[212:213] offset0:71 offset1:88
M v[92:95],a[200:203],a[248:251],v[92:95]
buffer_load_dwordx2 v[214:215],v245,s[16:19],s28 offen offset:1536
M v[92:95],a[204:207],a[232:235],v[92:95]
ds_read_b128 a[216:219],v249 offset:61440
v_lshlrev_b32 v232,16,v192
M v[92:95],a[212:215],v[228:231],v[92:95]
s_waitcnt lgkmcnt(5)
v_lshlrev_b32 v233,16,v194
v_lshlrev_b32 v237,16,v202
M v[96:99],a[228:231],a[192:195],v[96:99]
s_waitcnt vmcnt(10) lgkmcnt(3)
ds_read_b128 a[200:203],v248 offset:61952
v_lshlrev_b32 v236,16,v200
M v[96:99],a[220:223],a[236:239],v[96:99]
s_waitcnt vmcnt(9) lgkmcnt(3)
buffer_load_dwordx2 v[206:207],v245,s[8:11],s28 offen offset:0
M v[96:99],a[224:227],v[224:227],v[96:99]
s_waitcnt lgkmcnt(1)
ds_read_b128 a[248:251],v249 offset:61952
v_lshlrev_b32 v235,16,v198
M v[100:103],a[224:227],a[216:219],v[100:103]
v_fmac_f32 v232,s43,v234
v_fmac_f32 v237,4.0,v233
M v[100:103],a[220:223],v[224:227],v[100:103]
v_fma_f32 v238,-4.0,v234,v236
v_fmac_f32 v232,s45,v236
M v[100:103],a[228:231],a[236:239],v[100:103]
buffer_load_dwordx2 v[208:209],v245,s[8:11],s28 offen offset:384
M v[104:107],a[228:231],v[224:227],v[104:107]
ds_read_b128 a[204:207],v248 offset:62464
v_fmac_f32 v237,s41,v235
M v[104:107],a[220:223],a[216:219],v[104:107]
s_waitcnt lgkmcnt(2)
ds_read_b128 a[232:235],v249 offset:62464
v_sub_f32 v236,v236,v234
M v[104:107],a[224:227],a[200:203],v[104:107]
s_waitcnt lgkmcnt(2)
v_fma_f32 v234,-4.0,v233,v235
v_sub_f32 v235,v235,v233
M v[108:111],a[224:227],a[248:251],v[108:111]
buffer_load_dwordx2 v[210:211],v245,s[8:11],s28 offen offset:768
M v[108:111],a[220:223],a[200:203],v[108:111]
v_add_f32 v233,v238,v234
v_sub_f32 v238,v238,v234
M v[108:111],a[228:231],a[216:219],v[108:111]
v_fma_f32 v234,2.0,v235,v236
v_fmac_f32 v236,-2.0,v235
M v[112:115],a[228:231],a[200:203],v[112:115]
ds_read_b128 a[212:215],v249 offset:62976
v_and_b32 v196,s42,v196
M v[112:115],a[220:223],a[248:251],v[112:115]
s_waitcnt lgkmcnt(2)
buffer_load_dwordx2 v[212:213],v245,s[8:11],s28 offen offset:1152
M v[112:115],a[224:227],a[204:207],v[112:115]
s_waitcnt lgkmcnt(1)
ds_read_b128 v[228:231],v248 offset:62976
v_and_b32 v192,s42,v192
M v[116:119],a[224:227],a[232:235],v[116:119]
v_and_b32 v194,s42,v194
v_and_b32 v202,s42,v202
M v[116:119],a[220:223],a[204:207],v[116:119]
v_and_b32 v200,s42,v200
v_and_b32 v198,s42,v198
M v[116:119],a[228:231],a[248:251],v[116:119]
v_fmac_f32 v192,s43,v196
v_fmac_f32 v202,4.0,v194
M v[120:123],a[228:231],a[204:207],v[120:123]
v_fma_f32 v235,-4.0,v196,v200
v_fmac_f32 v192,s45,v200
M v[120:123],a[220:223],a[232:235],v[120:123]
s_waitcnt lgkmcnt(1)
v_fmac_f32 v202,s41,v198
v_sub_f32 v200,v200,v196
M v[120:123],a[224:227],a[212:215],v[120:123]
s_waitcnt lgkmcnt(0)
v_fma_f32 v196,-4.0,v194,v198
v_sub_f32 v198,v198,v194
M v[124:127],a[224:227],v[228:231],v[124:127]
buffer_load_dwordx4 a[224:227],v250,s[20:23],s46 offen offset:1024 sc1
M v[124:127],a[220:223],a[212:215],v[124:127]
v_add_f32 v194,v235,v196
v_sub_f32 v235,v235,v196
M v[124:127],a[228:231],a[232:235],v[124:127]
s_waitcnt vmcnt(13)
buffer_load_dwordx4 a[220:223],v250,s[20:23],s46 offen offset:2048 sc1
M v[128:131],v[220:223],a[192:195],v[128:131]
s_waitcnt vmcnt(13)
s_add_u32 s47,s74,12288
v_fma_f32 v196,2.0,v198,v200
v_fmac_f32 v200,-2.0,v198
M v[128:131],a[240:243],a[236:239],v[128:131]
s_waitcnt vmcnt(12)
v_cvt_pk_bf16_f32 v192,v232,v192
v_cvt_pk_bf16_f32 v202,v237,v202
M v[128:131],a[244:247],v[224:227],v[128:131]
v_cvt_pk_bf16_f32 v194,v233,v194
v_cvt_pk_bf16_f32 v198,v234,v196
M v[132:135],a[244:247],a[216:219],v[132:135]
buffer_load_dwordx4 a[228:231],v250,s[20:23],s47 offen offset:0 sc1
M v[132:135],a[240:243],v[224:227],v[132:135]
v_cvt_pk_bf16_f32 v196,v238,v235
v_cvt_pk_bf16_f32 v200,v236,v200
M v[132:135],v[220:223],a[236:239],v[132:135]
v_lshlrev_b32 v234,16,v197
v_lshlrev_b32 v232,16,v193
M v[136:139],v[220:223],v[224:227],v[136:139]
v_lshlrev_b32 v233,16,v195
v_lshlrev_b32 v237,16,v203
M v[136:139],a[240:243],a[216:219],v[136:139]
v_lshlrev_b32 v236,16,v201
v_lshlrev_b32 v235,16,v199
M v[136:139],a[244:247],a[200:203],v[136:139]
v_fmac_f32 v232,s43,v234
v_fmac_f32 v237,4.0,v233
M v[140:143],a[244:247],a[248:251],v[140:143]
v_fma_f32 v238,-4.0,v234,v236
v_fmac_f32 v232,s45,v236
M v[140:143],a[240:243],a[200:203],v[140:143]
v_fmac_f32 v237,s41,v235
v_sub_f32 v236,v236,v234
M v[140:143],v[220:223],a[216:219],v[140:143]
v_fma_f32 v234,-4.0,v233,v235
v_sub_f32 v235,v235,v233
M v[144:147],v[220:223],a[200:203],v[144:147]
v_add_f32 v233,v238,v234
v_sub_f32 v238,v238,v234
M v[144:147],a[240:243],a[248:251],v[144:147]
v_fma_f32 v234,2.0,v235,v236
v_fmac_f32 v236,-2.0,v235
M v[144:147],a[244:247],a[204:207],v[144:147]
v_and_b32 v197,s42,v197
v_and_b32 v193,s42,v193
M v[148:151],a[244:247],a[232:235],v[148:151]
v_and_b32 v195,s42,v195
v_and_b32 v203,s42,v203
M v[148:151],a[240:243],a[204:207],v[148:151]
v_and_b32 v201,s42,v201
v_and_b32 v199,s42,v199
M v[148:151],v[220:223],a[248:251],v[148:151]
v_fmac_f32 v193,s43,v197
v_fmac_f32 v203,4.0,v195
M v[152:155],v[220:223],a[204:207],v[152:155]
v_fma_f32 v235,-4.0,v197,v201
v_fmac_f32 v193,s45,v201
M v[152:155],a[240:243],a[232:235],v[152:155]
v_fmac_f32 v203,s41,v199
v_sub_f32 v201,v201,v197
M v[152:155],a[244:247],a[212:215],v[152:155]
v_fma_f32 v197,-4.0,v195,v199
v_sub_f32 v199,v199,v195
M v[156:159],a[244:247],v[228:231],v[156:159]
buffer_load_dwordx4 a[244:247],v250,s[20:23],s47 offen offset:1024 sc1
M v[156:159],a[240:243],a[212:215],v[156:159]
v_add_f32 v195,v235,v197
v_sub_f32 v235,v235,v197
M v[156:159],v[220:223],a[232:235],v[156:159]
s_waitcnt vmcnt(13)
buffer_load_dwordx4 a[240:243],v250,s[20:23],s47 offen offset:2048 sc1
M v[160:163],v[216:219],a[192:195],v[160:163]
s_waitcnt vmcnt(13)
s_add_u32 s48,s74,15360
v_fma_f32 v197,2.0,v199,v201
v_fmac_f32 v201,-2.0,v199
M v[160:163],a[196:199],a[236:239],v[160:163]
s_waitcnt vmcnt(12)
v_cvt_pk_bf16_f32 v193,v232,v193
v_cvt_pk_bf16_f32 v203,v237,v203
M v[160:163],a[208:211],v[224:227],v[160:163]
v_cvt_pk_bf16_f32 v195,v233,v195
v_cvt_pk_bf16_f32 v199,v234,v197
M v[164:167],a[208:211],a[216:219],v[164:167]
buffer_load_dwordx4 v[220:223],v250,s[20:23],s48 offen offset:0 sc1
M v[164:167],a[196:199],v[224:227],v[164:167]
v_cvt_pk_bf16_f32 v197,v238,v235
v_cvt_pk_bf16_f32 v201,v236,v201
M v[164:167],v[216:219],a[236:239],v[164:167]
s_waitcnt vmcnt(8)
v_lshlrev_b32 v234,16,v208
v_lshlrev_b32 v232,16,v204
M v[168:171],v[216:219],v[224:227],v[168:171]
v_lshlrev_b32 v233,16,v206
v_lshlrev_b32 v237,16,v214
M v[168:171],a[196:199],a[216:219],v[168:171]
buffer_load_dwordx4 a[192:195],v250,s[20:23],s48 offen offset:1024 sc1
M v[168:171],a[208:211],a[200:203],v[168:171]
s_waitcnt vmcnt(7)
v_lshlrev_b32 v236,16,v212
v_lshlrev_b32 v235,16,v210
M v[172:175],a[208:211],a[248:251],v[172:175]
v_fmac_f32 v232,s43,v234
v_fmac_f32 v237,4.0,v233
M v[172:175],a[196:199],a[200:203],v[172:175]
v_fma_f32 v238,-4.0,v234,v236
v_fmac_f32 v232,s45,v236
M v[172:175],v[216:219],a[216:219],v[172:175]
buffer_load_dwordx4 a[236:239],v250,s[20:23],s48 offen offset:2048 sc1
M v[176:179],v[216:219],a[200:203],v[176:179]
s_add_u32 s46,s74,18432
v_fmac_f32 v237,s41,v235
v_sub_f32 v236,v236,v234
M v[176:179],a[196:199],a[248:251],v[176:179]
v_fma_f32 v234,-4.0,v233,v235
v_sub_f32 v235,v235,v233
M v[176:179],a[208:211],a[204:207],v[176:179]
s_barrier
v_add_f32 v233,v238,v234
M v[180:183],a[208:211],a[232:235],v[180:183]
buffer_load_dwordx4 v[224:227],v250,s[20:23],s46 offen offset:0 sc1
M v[180:183],a[196:199],a[204:207],v[180:183]
ds_read_b128 a[216:219],v248 offset:0
v_sub_f32 v238,v238,v234
M v[180:183],v[216:219],a[248:251],v[180:183]
ds_write2st64_b64 v247,v[192:193],v[202:203] offset0:238 offset1:255
M v[184:187],v[216:219],a[204:207],v[184:187]
s_add_u32 s28,s69,786432
ds_read_b128 a[200:203],v249 offset:0
ds_read_b128 a[248:251],v248 offset:512
M v[184:187],a[196:199],a[232:235],v[184:187]
buffer_load_dwordx2 v[192:193],v245,s[12:15],s28 offen offset:0
M v[184:187],a[208:211],a[212:215],v[184:187]
ds_write2st64_b64 v247,v[194:195],v[196:197] offset0:102 offset1:119
M v[188:191],a[208:211],v[228:231],v[188:191]
ds_read_b128 a[204:207],v249 offset:512
v_fma_f32 v234,2.0,v235,v236
M v[188:191],a[196:199],a[212:215],v[188:191]
buffer_load_dwordx2 v[202:203],v245,s[16:19],s28 offen offset:1536
M v[188:191],v[216:219],a[232:235],v[188:191]
s_waitcnt lgkmcnt(5)
ds_write2st64_b64 v247,v[198:199],v[200:201] offset0:136 offset1:153
M a[0:3],a[252:255],a[216:219],a[0:3]
s_waitcnt vmcnt(10) lgkmcnt(4)
ds_read_b128 a[208:211],v248 offset:1024
v_fmac_f32 v236,-2.0,v235
M a[0:3],a[224:227],a[200:203],a[0:3]
s_waitcnt vmcnt(9) lgkmcnt(4)
buffer_load_dwordx2 v[194:195],v245,s[8:11],s28 offen offset:0
M a[0:3],a[220:223],a[248:251],a[0:3]
s_waitcnt lgkmcnt(2)
ds_read_b128 v[228:231],v249 offset:1024
v_and_b32 v208,s42,v208
M a[4:7],a[220:223],a[204:207],a[4:7]
v_and_b32 v204,s42,v204
v_and_b32 v206,s42,v206
M a[4:7],a[224:227],a[248:251],a[4:7]
v_and_b32 v214,s42,v214
v_and_b32 v212,s42,v212
M a[4:7],a[252:255],a[200:203],a[4:7]
buffer_load_dwordx2 v[196:197],v245,s[8:11],s28 offen offset:384
M a[8:11],a[252:255],a[248:251],a[8:11]
ds_read_b128 a[196:199],v248 offset:1536
v_and_b32 v210,s42,v210
M a[8:11],a[224:227],a[204:207],a[8:11]
s_waitcnt lgkmcnt(2)
ds_read_b128 a[212:215],v249 offset:1536
v_fmac_f32 v204,s43,v208
M a[8:11],a[220:223],a[208:211],a[8:11]
s_waitcnt lgkmcnt(2)
v_fmac_f32 v214,4.0,v206
v_fma_f32 v235,-4.0,v208,v212
M a[12:15],a[220:223],v[228:231],a[12:15]
buffer_load_dwordx2 v[198:199],v245,s[8:11],s28 offen offset:768
M a[12:15],a[224:227],a[208:211],a[12:15]
v_fmac_f32 v204,s45,v212
v_fmac_f32 v214,s41,v210
M a[12:15],a[252:255],a[204:207],a[12:15]
v_sub_f32 v212,v212,v208
v_fma_f32 v208,-4.0,v206,v210
M a[16:19],a[252:255],a[208:211],a[16:19]
ds_read_b128 a[232:235],v249 offset:2048
v_sub_f32 v210,v210,v206
M a[16:19],a[224:227],v[228:231],a[16:19]
s_waitcnt lgkmcnt(2)
buffer_load_dwordx2 v[200:201],v245,s[8:11],s28 offen offset:1152
M a[16:19],a[220:223],a[196:199],a[16:19]
s_waitcnt lgkmcnt(1)
ds_read_b128 v[216:219],v248 offset:2048
v_add_f32 v206,v235,v208
M a[20:23],a[220:223],a[212:215],a[20:23]
v_sub_f32 v235,v235,v208
v_fma_f32 v208,2.0,v210,v212
M a[20:23],a[224:227],a[196:199],a[20:23]
v_fmac_f32 v212,-2.0,v210
v_cvt_pk_bf16_f32 v204,v232,v204
M a[20:23],a[252:255],v[228:231],a[20:23]
v_cvt_pk_bf16_f32 v214,v237,v214
v_cvt_pk_bf16_f32 v206,v233,v206
M a[24:27],a[252:255],a[196:199],a[24:27]
v_cvt_pk_bf16_f32 v210,v234,v208
v_cvt_pk_bf16_f32 v208,v238,v235
M a[24:27],a[224:227],a[212:215],a[24:27]
s_waitcnt lgkmcnt(1)
v_cvt_pk_bf16_f32 v212,v236,v212
v_lshlrev_b32 v234,16,v209
M a[24:27],a[220:223],a[232:235],a[24:27]
s_waitcnt lgkmcnt(0)
v_lshlrev_b32 v232,16,v205
v_lshlrev_b32 v233,16,v207
M a[28:31],a[220:223],v[216:219],a[28:31]
buffer_load_dwordx4 a[220:223],v250,s[20:23],s46 offen offset:1024 sc1
M a[28:31],a[224:227],a[232:235],a[28:31]
v_lshlrev_b32 v237,16,v215
v_lshlrev_b32 v236,16,v213
M a[28:31],a[252:255],a[212:215],a[28:31]
s_waitcnt vmcnt(13)
buffer_load_dwordx4 a[224:227],v250,s[20:23],s46 offen offset:2048 sc1
M a[32:35],a[228:231],a[216:219],a[32:35]
s_waitcnt vmcnt(13)
s_add_u32 s47,s74,21504
v_lshlrev_b32 v235,16,v211
v_fmac_f32 v232,s43,v234
M a[32:35],a[244:247],a[200:203],a[32:35]
s_waitcnt vmcnt(12)
v_fmac_f32 v237,4.0,v233
v_fma_f32 v238,-4.0,v234,v236
M a[32:35],a[240:243],a[248:251],a[32:35]
v_fmac_f32 v232,s45,v236
v_fmac_f32 v237,s41,v235
M a[36:39],a[240:243],a[204:207],a[36:39]
buffer_load_dwordx4 a[252:255],v250,s[20:23],s47 offen offset:0 sc1
M a[36:39],a[244:247],a[248:251],a[36:39]
v_sub_f32 v236,v236,v234
v_fma_f32 v234,-4.0,v233,v235
M a[36:39],a[228:231],a[200:203],a[36:39]
v_sub_f32 v235,v235,v233
v_add_f32 v233,v238,v234
M a[40:43],a[228:231],a[248:251],a[40:43]
v_sub_f32 v238,v238,v234
v_fma_f32 v234,2.0,v235,v236
M a[40:43],a[244:247],a[204:207],a[40:43]
v_fmac_f32 v236,-2.0,v235
v_and_b32 v209,s42,v209
M a[40:43],a[240:243],a[208:211],a[40:43]
v_and_b32 v205,s42,v205
v_and_b32 v207,s42,v207
M a[44:47],a[240:243],v[228:231],a[44:47]
v_and_b32 v215,s42,v215
v_and_b32 v213,s42,v213
M a[44:47],a[244:247],a[208:211],a[44:47]
v_and_b32 v211,s42,v211
v_fmac_f32 v205,s43,v209
M a[44:47],a[228:231],a[204:207],a[44:47]
v_fmac_f32 v215,4.0,v207
v_fma_f32 v235,-4.0,v209,v213
M a[48:51],a[228:231],a[208:211],a[48:51]
v_fmac_f32 v205,s45,v213
v_fmac_f32 v215,s41,v211
M a[48:51],a[244:247],v[228:231],a[48:51]
v_sub_f32 v213,v213,v209
v_fma_f32 v209,-4.0,v207,v211
M a[48:51],a[240:243],a[196:199],a[48:51]
v_sub_f32 v211,v211,v207
v_add_f32 v207,v235,v209
M a[52:55],a[240:243],a[212:215],a[52:55]
v_sub_f32 v235,v235,v209
v_fma_f32 v209,2.0,v211,v213
M a[52:55],a[244:247],a[196:199],a[52:55]
v_fmac_f32 v213,-2.0,v211
v_cvt_pk_bf16_f32 v205,v232,v205
M a[52:55],a[228:231],v[228:231],a[52:55]
v_cvt_pk_bf16_f32 v215,v237,v215
v_cvt_pk_bf16_f32 v207,v233,v207
M a[56:59],a[228:231],a[196:199],a[56:59]
v_cvt_pk_bf16_f32 v211,v234,v209
v_cvt_pk_bf16_f32 v209,v238,v235
M a[56:59],a[244:247],a[212:215],a[56:59]
v_cvt_pk_bf16_f32 v213,v236,v213
v_add_u32 v238,121856,v247
M a[56:59],a[240:243],a[232:235],a[56:59]
ds_write2st64_b64 v238,v[204:205],v[214:215] offset0:1 offset1:18
M a[60:63],a[240:243],v[216:219],a[60:63]
s_add_u32 s28,s69,1179648
buffer_load_dwordx4 a[240:243],v250,s[20:23],s47 offen offset:1024 sc1
M a[60:63],a[244:247],a[232:235],a[60:63]
v_fmac_f32 v239,s43,v241
v_fmac_f32 v244,4.0,v240
M a[60:63],a[228:231],a[212:215],a[60:63]
s_waitcnt vmcnt(13)
buffer_load_dwordx4 a[244:247],v250,s[20:23],s47 offen offset:2048 sc1
M a[64:67],v[220:223],a[216:219],a[64:67]
s_waitcnt vmcnt(13)
s_add_u32 s48,s74,24576
v_fma_f32 v232,-4.0,v241,v243
v_fmac_f32 v239,s45,v243
M a[64:67],a[192:195],a[200:203],a[64:67]
s_waitcnt vmcnt(12)
v_fmac_f32 v244,s41,v242
v_sub_f32 v243,v243,v241
M a[64:67],a[236:239],a[248:251],a[64:67]
ds_write2st64_b64 v247,v[206:207],v[208:209] offset0:103 offset1:120
M a[68:71],a[236:239],a[204:207],a[68:71]
buffer_load_dwordx4 a[228:231],v250,s[20:23],s48 offen offset:0 sc1
M a[68:71],a[192:195],a[248:251],a[68:71]
v_fma_f32 v241,-4.0,v240,v242
v_sub_f32 v242,v242,v240
M a[68:71],v[220:223],a[200:203],a[68:71]
ds_write2st64_b64 v247,v[210:211],v[212:213] offset0:137 offset1:154
M a[72:75],v[220:223],a[248:251],a[72:75]
buffer_load_dwordx4 a[216:219],v250,s[20:23],s48 offen offset:1024 sc1
M a[72:75],a[192:195],a[204:207],a[72:75]
v_add_f32 v240,v232,v241
v_sub_f32 v232,v232,v241
M a[72:75],a[236:239],a[208:211],a[72:75]
v_fma_f32 v241,2.0,v242,v243
v_fmac_f32 v243,-2.0,v242
M a[76:79],a[236:239],v[228:231],a[76:79]
v_cvt_pk_bf16_f32 v233,v239,v244
v_cvt_pk_bf16_f32 v234,v240,v232
M a[76:79],a[192:195],a[208:211],a[76:79]
buffer_load_dwordx4 a[200:203],v250,s[20:23],s48 offen offset:2048 sc1
M a[76:79],v[220:223],a[204:207],a[76:79]
s_add_u32 s46,s74,27648
v_cvt_pk_bf16_f32 v235,v241,v243
v_add_u32 v232,121856,v252
M a[80:83],v[220:223],a[208:211],a[80:83]
ds_write_b16 v232,v233 offset:0
M a[80:83],a[192:195],v[228:231],a[80:83]
ds_write_b16_d16_hi v232,v233 offset:8704
M a[80:83],a[236:239],a[196:199],a[80:83]
buffer_load_dwordx4 a[248:251],v250,s[20:23],s46 offen offset:0 sc1
M a[84:87],a[236:239],a[212:215],a[84:87]
ds_write_b16 v252,v234 offset:52224
M a[84:87],a[192:195],a[196:199],a[84:87]
ds_read_b128 a[204:207],v248 offset:8704
ds_write_b16_d16_hi v252,v234 offset:60928
M a[84:87],v[220:223],v[228:231],a[84:87]
ds_read_b128 a[208:211],v249 offset:8704
v_add_u32 v232,69632,v252
M a[88:91],v[220:223],a[196:199],a[88:91]
buffer_load_dwordx2 v[204:205],v245,s[12:15],s28 offen offset:0
M a[88:91],a[192:195],a[212:215],a[88:91]
ds_read_b128 v[228:231],v248 offset:9216
ds_read_b128 a[196:199],v249 offset:9216
M a[88:91],a[236:239],a[232:235],a[88:91]
ds_write_b16 v232,v235 offset:0
M a[92:95],a[236:239],v[216:219],a[92:95]
ds_write_b16_d16_hi v232,v235 offset:8704
M a[92:95],a[192:195],a[232:235],a[92:95]
buffer_load_dwordx2 v[214:215],v245,s[16:19],s28 offen offset:1536
M a[92:95],v[220:223],a[212:215],a[92:95]
s_waitcnt vmcnt(13) lgkmcnt(6)
v_lshlrev_b32 v234,16,v196
v_lshlrev_b32 v232,16,v192
M a[96:99],v[224:227],a[204:207],a[96:99]
s_waitcnt vmcnt(10) lgkmcnt(4)
ds_read_b128 a[236:239],v248 offset:9728
v_lshlrev_b32 v233,16,v194
M a[96:99],a[220:223],a[208:211],a[96:99]
s_waitcnt vmcnt(9) lgkmcnt(4)
ds_read_b128 v[216:219],v249 offset:9728
v_lshlrev_b32 v237,16,v202
M a[96:99],a[224:227],v[228:231],a[96:99]
s_waitcnt lgkmcnt(4)
buffer_load_dwordx2 v[206:207],v245,s[8:11],s28 offen offset:0
M a[100:103],a[224:227],a[196:199],a[100:103]
v_lshlrev_b32 v236,16,v200
v_lshlrev_b32 v235,16,v198
M a[100:103],a[220:223],v[228:231],a[100:103]
v_fmac_f32 v232,s43,v234
v_fmac_f32 v237,4.0,v233
M a[100:103],v[224:227],a[208:211],a[100:103]
v_fma_f32 v238,-4.0,v234,v236
v_fmac_f32 v232,s45,v236
M a[104:107],v[224:227],v[228:231],a[104:107]
buffer_load_dwordx2 v[208:209],v245,s[8:11],s28 offen offset:384
M a[104:107],a[220:223],a[196:199],a[104:107]
s_waitcnt lgkmcnt(1)
ds_read_b128 a[192:195],v248 offset:10240
ds_read_b128 a[232:235],v249 offset:10240
M a[104:107],a[224:227],a[236:239],a[104:107]
s_waitcnt lgkmcnt(2)
v_fmac_f32 v237,s41,v235
v_sub_f32 v236,v236,v234
M a[108:111],a[224:227],v[216:219],a[108:111]
v_fma_f32 v234,-4.0,v233,v235
v_sub_f32 v235,v235,v233
M a[108:111],a[220:223],a[236:239],a[108:111]
buffer_load_dwordx2 v[210:211],v245,s[8:11],s28 offen offset:768
M a[108:111],v[224:227],a[196:199],a[108:111]
v_add_f32 v233,v238,v234
v_sub_f32 v238,v238,v234
M a[112:115],v[224:227],a[236:239],a[112:115]
ds_read_b128 a[212:215],v249 offset:10752
v_fma_f32 v234,2.0,v235,v236
M a[112:115],a[220:223],v[216:219],a[112:115]
s_waitcnt lgkmcnt(2)
ds_read_b128 v[220:223],v248 offset:10752
v_fmac_f32 v236,-2.0,v235
M a[112:115],a[224:227],a[192:195],a[112:115]
s_waitcnt lgkmcnt(2)
buffer_load_dwordx2 v[212:213],v245,s[8:11],s28 offen offset:1152
M a[116:119],a[224:227],a[232:235],a[116:119]
s_add_u32 s29,s70,0
v_and_b32 v196,s42,v196
v_and_b32 v192,s42,v192
M a[116:119],a[220:223],a[192:195],a[116:119]
v_and_b32 v194,s42,v194
v_and_b32 v202,s42,v202
M a[116:119],v[224:227],v[216:219],a[116:119]
v_and_b32 v200,s42,v200
v_and_b32 v198,s42,v198
M a[120:123],v[224:227],a[192:195],a[120:123]
buffer_load_short_d16_hi v239,v246,s[12:15],s29 offen offset:0
M a[120:123],a[220:223],a[232:235],a[120:123]
s_waitcnt lgkmcnt(1)
v_fmac_f32 v192,s43,v196
v_fmac_f32 v202,4.0,v194
M a[120:123],a[224:227],a[212:215],a[120:123]
s_waitcnt lgkmcnt(0)
buffer_load_short_d16_hi v240,v246,s[8:11],s29 offen offset:0
M a[124:127],a[224:227],v[220:223],a[124:127]
v_fma_f32 v235,-4.0,v196,v200
v_fmac_f32 v192,s45,v200
M a[124:127],a[220:223],a[212:215],a[124:127]
buffer_load_dwordx4 a[224:227],v250,s[20:23],s46 offen offset:1024 sc1
M a[124:127],v[224:227],a[232:235],a[124:127]
s_waitcnt vmcnt(15)
v_fmac_f32 v202,s41,v198
v_sub_f32 v200,v200,v196
M a[128:131],a[252:255],a[204:207],a[128:131]
s_waitcnt vmcnt(14)
v_fma_f32 v196,-4.0,v194,v198
v_sub_f32 v198,v198,v194
M a[128:131],a[240:243],a[208:211],a[128:131]
s_waitcnt vmcnt(13)
v_add_f32 v194,v235,v196
v_sub_f32 v235,v235,v196
M a[128:131],a[244:247],v[228:231],a[128:131]
buffer_load_dwordx4 a[220:223],v250,s[20:23],s46 offen offset:2048 sc1
M a[132:135],a[244:247],a[196:199],a[132:135]
s_add_u32 s47,s74,30720
v_fma_f32 v196,2.0,v198,v200
v_fmac_f32 v200,-2.0,v198
M a[132:135],a[240:243],v[228:231],a[132:135]
v_cvt_pk_bf16_f32 v192,v232,v192
v_cvt_pk_bf16_f32 v202,v237,v202
M a[132:135],a[252:255],a[208:211],a[132:135]
v_cvt_pk_bf16_f32 v194,v233,v194
v_cvt_pk_bf16_f32 v198,v234,v196
M a[136:139],a[252:255],v[228:231],a[136:139]
buffer_load_dwordx4 v[224:227],v250,s[20:23],s47 offen offset:0 sc1
M a[136:139],a[240:243],a[196:199],a[136:139]
v_cvt_pk_bf16_f32 v196,v238,v235
v_cvt_pk_bf16_f32 v200,v236,v200
M a[136:139],a[244:247],a[236:239],a[136:139]
v_lshlrev_b32 v234,16,v197
v_lshlrev_b32 v232,16,v193
M a[140:143],a[244:247],v[216:219],a[140:143]
v_lshlrev_b32 v233,16,v195
v_lshlrev_b32 v237,16,v203
M a[140:143],a[240:243],a[236:239],a[140:143]
buffer_load_short_d16_hi v241,v246,s[8:11],s29 offen offset:384
M a[140:143],a[252:255],a[196:199],a[140:143]
v_lshlrev_b32 v236,16,v201
v_lshlrev_b32 v235,16,v199
M a[144:147],a[252:255],a[236:239],a[144:147]
buffer_load_short_d16_hi v242,v246,s[8:11],s29 offen offset:768
M a[144:147],a[240:243],v[216:219],a[144:147]
v_fmac_f32 v232,s43,v234
v_fmac_f32 v237,4.0,v233
M a[144:147],a[244:247],a[192:195],a[144:147]
buffer_load_short_d16_hi v243,v246,s[8:11],s29 offen offset:1152
M a[148:151],a[244:247],a[232:235],a[148:151]
v_fma_f32 v238,-4.0,v234,v236
v_fmac_f32 v232,s45,v236
M a[148:151],a[240:243],a[192:195],a[148:151]
buffer_load_short_d16_hi v244,v246,s[16:19],s29 offen offset:1536
M a[148:151],a[252:255],v[216:219],a[148:151]
v_fmac_f32 v237,s41,v235
v_sub_f32 v236,v236,v234
M a[152:155],a[252:255],a[192:195],a[152:155]
v_fma_f32 v234,-4.0,v233,v235
v_sub_f32 v235,v235,v233
M a[152:155],a[240:243],a[232:235],a[152:155]
v_add_f32 v233,v238,v234
v_sub_f32 v238,v238,v234
M a[152:155],a[244:247],a[212:215],a[152:155]
v_fma_f32 v234,2.0,v235,v236
v_fmac_f32 v236,-2.0,v235
M a[156:159],a[244:247],v[220:223],a[156:159]
buffer_load_dwordx4 a[244:247],v250,s[20:23],s47 offen offset:1024 sc1
M a[156:159],a[240:243],a[212:215],a[156:159]
v_and_b32 v197,s42,v197
v_and_b32 v193,s42,v193
M a[156:159],a[252:255],a[232:235],a[156:159]
s_waitcnt vmcnt(19)
buffer_load_dwordx4 a[240:243],v250,s[20:23],s47 offen offset:2048 sc1
M a[160:163],a[228:231],a[204:207],a[160:163]
s_waitcnt vmcnt(19)
s_add_u32 s48,s74,33792
v_and_b32 v195,s42,v195
v_and_b32 v203,s42,v203
M a[160:163],a[216:219],a[208:211],a[160:163]
s_waitcnt vmcnt(18)
v_and_b32 v201,s42,v201
v_and_b32 v199,s42,v199
M a[160:163],a[200:203],v[228:231],a[160:163]
v_fmac_f32 v193,s43,v197
v_fmac_f32 v203,4.0,v195
M a[164:167],a[200:203],a[196:199],a[164:167]
buffer_load_dwordx4 a[252:255],v250,s[20:23],s48 offen offset:0 sc1
M a[164:167],a[216:219],v[228:231],a[164:167]
v_fma_f32 v235,-4.0,v197,v201
v_fmac_f32 v193,s45,v201
M a[164:167],a[228:231],a[208:211],a[164:167]
v_fmac_f32 v203,s41,v199
v_sub_f32 v201,v201,v197
M a[168:171],a[228:231],v[228:231],a[168:171]
v_fma_f32 v197,-4.0,v195,v199
v_sub_f32 v199,v199,v195
M a[168:171],a[216:219],a[196:199],a[168:171]
buffer_load_dwordx4 a[204:207],v250,s[20:23],s48 offen offset:1024 sc1
M a[168:171],a[200:203],a[236:239],a[168:171]
v_add_f32 v195,v235,v197
v_sub_f32 v235,v235,v197
M a[172:175],a[200:203],v[216:219],a[172:175]
v_fma_f32 v197,2.0,v199,v201
v_fmac_f32 v201,-2.0,v199
M a[172:175],a[216:219],a[236:239],a[172:175]
v_cvt_pk_bf16_f32 v193,v232,v193
v_cvt_pk_bf16_f32 v203,v237,v203
M a[172:175],a[228:231],a[196:199],a[172:175]
buffer_load_dwordx4 a[208:211],v250,s[20:23],s48 offen offset:2048 sc1
M a[176:179],a[228:231],a[236:239],a[176:179]
s_add_u32 s46,s74,36864
v_cvt_pk_bf16_f32 v195,v233,v195
v_cvt_pk_bf16_f32 v199,v234,v197
M a[176:179],a[216:219],v[216:219],a[176:179]
v_cvt_pk_bf16_f32 v197,v238,v235
v_cvt_pk_bf16_f32 v201,v236,v201
M a[176:179],a[200:203],a[192:195],a[176:179]
s_waitcnt vmcnt(16)
v_add_u32 v238,121856,v247
v_lshlrev_b32 v234,16,v208
M a[180:183],a[200:203],a[232:235],a[180:183]
buffer_load_dwordx4 v[228:231],v250,s[20:23],s46 offen offset:0 sc1
M a[180:183],a[216:219],a[192:195],a[180:183]
ds_read_b128 a[196:199],v248 offset:17408
v_lshlrev_b32 v232,16,v204
M a[180:183],a[228:231],v[216:219],a[180:183]
ds_write2st64_b64 v238,v[192:193],v[202:203] offset0:2 offset1:19
M a[184:187],a[228:231],a[192:195],a[184:187]
s_add_u32 s28,s70,0
ds_read_b128 a[236:239],v249 offset:17408
ds_read_b128 v[216:219],v248 offset:17920
M a[184:187],a[216:219],a[232:235],a[184:187]
buffer_load_dwordx2 v[192:193],v251,s[12:15],s28 offen offset:0
M a[184:187],a[200:203],a[212:215],a[184:187]
ds_write2st64_b64 v247,v[194:195],v[196:197] offset0:104 offset1:121
M a[188:191],a[200:203],v[220:223],a[188:191]
ds_read_b128 a[192:195],v249 offset:17920
v_lshlrev_b32 v233,16,v206
M a[188:191],a[216:219],a[212:215],a[188:191]
buffer_load_dwordx2 v[202:203],v251,s[16:19],s28 offen offset:1536
M a[188:191],a[228:231],a[232:235],a[188:191]
s_waitcnt lgkmcnt(5)
ds_write2st64_b64 v247,v[198:199],v[200:201] offset0:138 offset1:155
M v[0:3],a[248:251],a[196:199],v[0:3]
s_waitcnt vmcnt(14) lgkmcnt(4)
ds_read_b128 a[200:203],v248 offset:18432
v_lshlrev_b32 v237,16,v214
M v[0:3],a[224:227],a[236:239],v[0:3]
s_waitcnt vmcnt(13) lgkmcnt(4)
buffer_load_dwordx2 v[194:195],v251,s[8:11],s28 offen offset:0
M v[0:3],a[220:223],v[216:219],v[0:3]
s_waitcnt lgkmcnt(2)
ds_read_b128 v[220:223],v249 offset:18432
v_lshlrev_b32 v236,16,v212
M v[4:7],a[220:223],a[192:195],v[4:7]
v_lshlrev_b32 v235,16,v210
v_fmac_f32 v232,s43,v234
M v[4:7],a[224:227],v[216:219],v[4:7]
v_fmac_f32 v237,4.0,v233
v_fma_f32 v238,-4.0,v234,v236
M v[4:7],a[248:251],a[236:239],v[4:7]
buffer_load_dwordx2 v[196:197],v251,s[8:11],s28 offen offset:384
M v[8:11],a[248:251],v[216:219],v[8:11]
ds_read_b128 a[212:215],v248 offset:18944
v_fmac_f32 v232,s45,v236
M v[8:11],a[224:227],a[192:195],v[8:11]
s_waitcnt lgkmcnt(2)
ds_read_b128 a[216:219],v249 offset:18944
v_fmac_f32 v237,s41,v235
M v[8:11],a[220:223],a[200:203],v[8:11]
s_waitcnt lgkmcnt(2)
v_sub_f32 v236,v236,v234
v_fma_f32 v234,-4.0,v233,v235
M v[12:15],a[220:223],v[220:223],v[12:15]
buffer_load_dwordx2 v[198:199],v251,s[8:11],s28 offen offset:768
M v[12:15],a[224:227],a[200:203],v[12:15]
v_sub_f32 v235,v235,v233
v_add_f32 v233,v238,v234
M v[12:15],a[248:251],a[192:195],v[12:15]
v_sub_f32 v238,v238,v234
v_fma_f32 v234,2.0,v235,v236
M v[16:19],a[248:251],a[200:203],v[16:19]
ds_read_b128 a[228:231],v249 offset:19456
v_fmac_f32 v236,-2.0,v235
M v[16:19],a[224:227],v[220:223],v[16:19]
s_waitcnt lgkmcnt(2)
buffer_load_dwordx2 v[200:201],v251,s[8:11],s28 offen offset:1152
M v[16:19],a[220:223],a[212:215],v[16:19]
s_waitcnt lgkmcnt(1)
ds_read_b128 a[232:235],v248 offset:19456
v_and_b32 v208,s42,v208
M v[20:23],a[220:223],a[216:219],v[20:23]
v_and_b32 v204,s42,v204
v_and_b32 v206,s42,v206
M v[20:23],a[224:227],a[212:215],v[20:23]
v_and_b32 v214,s42,v214
v_and_b32 v212,s42,v212
M v[20:23],a[248:251],v[220:223],v[20:23]
v_and_b32 v210,s42,v210
v_fmac_f32 v204,s43,v208
M v[24:27],a[248:251],a[212:215],v[24:27]
v_fmac_f32 v214,4.0,v206
v_fma_f32 v235,-4.0,v208,v212
M v[24:27],a[224:227],a[216:219],v[24:27]
s_waitcnt lgkmcnt(1)
v_fmac_f32 v204,s45,v212
v_fmac_f32 v214,s41,v210
M v[24:27],a[220:223],a[228:231],v[24:27]
s_waitcnt lgkmcnt(0)
v_sub_f32 v212,v212,v208
v_fma_f32 v208,-4.0,v206,v210
M v[28:31],a[220:223],a[232:235],v[28:31]
buffer_load_dwordx4 a[220:223],v250,s[20:23],s46 offen offset:1024 sc1
M v[28:31],a[224:227],a[228:231],v[28:31]
v_sub_f32 v210,v210,v206
v_add_f32 v206,v235,v208
M v[28:31],a[248:251],a[216:219],v[28:31]
s_waitcnt vmcnt(17)
buffer_load_dwordx4 a[224:227],v250,s[20:23],s46 offen offset:2048 sc1
M v[32:35],v[224:227],a[196:199],v[32:35]
s_waitcnt vmcnt(13)
s_add_u32 s47,s74,39936
v_sub_f32 v235,v235,v208
v_fma_f32 v208,2.0,v210,v212
M v[32:35],a[244:247],a[236:239],v[32:35]
s_waitcnt vmcnt(12)
v_fmac_f32 v212,-2.0,v210
v_cvt_pk_bf16_f32 v204,v232,v204
M v[32:35],a[240:243],v[216:219],v[32:35]
v_cvt_pk_bf16_f32 v214,v237,v214
v_cvt_pk_bf16_f32 v206,v233,v206
M v[36:39],a[240:243],a[192:195],v[36:39]
buffer_load_dwordx4 a[248:251],v250,s[20:23],s47 offen offset:0 sc1
M v[36:39],a[244:247],v[216:219],v[36:39]
v_cvt_pk_bf16_f32 v210,v234,v208
v_cvt_pk_bf16_f32 v208,v238,v235
M v[36:39],v[224:227],a[236:239],v[36:39]
v_cvt_pk_bf16_f32 v212,v236,v212
v_lshlrev_b32 v234,16,v209
M v[40:43],v[224:227],v[216:219],v[40:43]
v_lshlrev_b32 v232,16,v205
v_lshlrev_b32 v233,16,v207
M v[40:43],a[244:247],a[192:195],v[40:43]
v_lshlrev_b32 v237,16,v215
v_lshlrev_b32 v236,16,v213
M v[40:43],a[240:243],a[200:203],v[40:43]
v_lshlrev_b32 v235,16,v211
v_fmac_f32 v232,s43,v234
M v[44:47],a[240:243],v[220:223],v[44:47]
v_fmac_f32 v237,4.0,v233
v_fma_f32 v238,-4.0,v234,v236
M v[44:47],a[244:247],a[200:203],v[44:47]
v_fmac_f32 v232,s45,v236
v_fmac_f32 v237,s41,v235
M v[44:47],v[224:227],a[192:195],v[44:47]
v_sub_f32 v236,v236,v234
v_fma_f32 v234,-4.0,v233,v235
M v[48:51],v[224:227],a[200:203],v[48:51]
v_sub_f32 v235,v235,v233
v_add_f32 v233,v238,v234
M v[48:51],a[244:247],v[220:223],v[48:51]
v_sub_f32 v238,v238,v234
v_fma_f32 v234,2.0,v235,v236
M v[48:51],a[240:243],a[212:215],v[48:51]
v_fmac_f32 v236,-2.0,v235
v_and_b32 v209,s42,v209
M v[52:55],a[240:243],a[216:219],v[52:55]
v_and_b32 v205,s42,v205
v_and_b32 v207,s42,v207
M v[52:55],a[244:247],a[212:215],v[52:55]
v_and_b32 v215,s42,v215
v_and_b32 v213,s42,v213
M v[52:55],v[224:227],v[220:223],v[52:55]
v_and_b32 v211,s42,v211
v_fmac_f32 v205,s43,v209
M v[56:59],v[224:227],a[212:215],v[56:59]
v_fmac_f32 v215,4.0,v207
v_fma_f32 v235,-4.0,v209,v213
M v[56:59],a[244:247],a[216:219],v[56:59]
v_fmac_f32 v205,s45,v213
v_fmac_f32 v215,s41,v211
M v[56:59],a[240:243],a[228:231],v[56:59]
v_sub_f32 v213,v213,v209
v_fma_f32 v209,-4.0,v207,v211
M v[60:63],a[240:243],a[232:235],v[60:63]
buffer_load_dwordx4 a[240:243],v250,s[20:23],s47 offen offset:1024 sc1
M v[60:63],a[244:247],a[228:231],v[60:63]
v_sub_f32 v211,v211,v207
v_add_f32 v207,v235,v209
M v[60:63],v[224:227],a[216:219],v[60:63]
s_waitcnt vmcnt(13)
buffer_load_dwordx4 a[244:247],v250,s[20:23],s47 offen offset:2048 sc1
M v[64:67],a[252:255],a[196:199],v[64:67]
s_waitcnt vmcnt(13)
s_add_u32 s48,s74,43008
v_sub_f32 v235,v235,v209
v_fma_f32 v209,2.0,v211,v213
M v[64:67],a[204:207],a[236:239],v[64:67]
s_waitcnt vmcnt(12)
v_fmac_f32 v213,-2.0,v211
v_cvt_pk_bf16_f32 v205,v232,v205
M v[64:67],a[208:211],v[216:219],v[64:67]
v_cvt_pk_bf16_f32 v215,v237,v215
v_cvt_pk_bf16_f32 v207,v233,v207
M v[68:71],a[208:211],a[192:195],v[68:71]
buffer_load_dwordx4 v[224:227],v250,s[20:23],s48 offen offset:0 sc1
M v[68:71],a[204:207],v[216:219],v[68:71]
v_cvt_pk_bf16_f32 v211,v234,v209
v_cvt_pk_bf16_f32 v209,v238,v235
M v[68:71],a[252:255],a[236:239],v[68:71]
v_cvt_pk_bf16_f32 v213,v236,v213
v_add_u32 v238,121856,v247
M v[72:75],a[252:255],v[216:219],v[72:75]
M v[72:75],a[204:207],a[192:195],v[72:75]
buffer_load_dwordx4 a[196:199],v250,s[20:23],s48 offen offset:1024 sc1
M v[72:75],a[208:211],a[200:203],v[72:75]
ds_write2st64_b64 v238,v[204:205],v[214:215] offset0:3 offset1:20
M v[76:79],a[208:211],v[220:223],v[76:79]
s_add_u32 s28,s70,393216
M v[76:79],a[204:207],a[200:203],v[76:79]
M v[76:79],a[252:255],a[192:195],v[76:79]
buffer_load_dwordx4 a[236:239],v250,s[20:23],s48 offen offset:2048 sc1
M v[80:83],a[252:255],a[200:203],v[80:83]
s_add_u32 s46,s75,9216
M v[80:83],a[204:207],v[220:223],v[80:83]
M v[80:83],a[208:211],a[212:215],v[80:83]
ds_write2st64_b64 v247,v[206:207],v[208:209] offset0:105 offset1:122
M v[84:87],a[208:211],a[216:219],v[84:87]
buffer_load_dwordx4 v[216:219],v250,s[20:23],s46 offen offset:0 sc1
M v[84:87],a[204:207],a[212:215],v[84:87]
ds_read_b128 a[192:195],v248 offset:26112
M v[84:87],a[252:255],v[220:223],v[84:87]
ds_write2st64_b64 v247,v[210:211],v[212:213] offset0:139 offset1:156
M v[88:91],a[252:255],a[212:215],v[88:91]
buffer_load_dwordx2 v[204:205],v245,s[12:15],s28 offen offset:0
M v[88:91],a[204:207],a[216:219],v[88:91]
ds_read_b128 a[200:203],v249 offset:26112
ds_read_b128 v[220:223],v248 offset:26624
M v[88:91],a[208:211],a[228:231],v[88:91]
ds_read_b128 a[212:215],v249 offset:26624
M v[92:95],a[208:211],a[232:235],v[92:95]
buffer_load_dwordx2 v[214:215],v245,s[16:19],s28 offen offset:1536
M v[92:95],a[204:207],a[228:231],v[92:95]
M v[92:95],a[252:255],a[216:219],v[92:95]
s_waitcnt vmcnt(17) lgkmcnt(4)
M v[96:99],v[228:231],a[192:195],v[96:99]
s_waitcnt vmcnt(10) lgkmcnt(2)
ds_read_b128 a[208:211],v248 offset:27136
M v[96:99],a[220:223],a[200:203],v[96:99]
s_waitcnt vmcnt(9) lgkmcnt(2)
buffer_load_dwordx2 v[206:207],v245,s[8:11],s28 offen offset:0
M v[96:99],a[224:227],v[220:223],v[96:99]
s_waitcnt lgkmcnt(1)
ds_read_b128 a[232:235],v249 offset:27136
v_lshlrev_b32 v234,16,v196
M v[100:103],a[224:227],a[212:215],v[100:103]
v_lshlrev_b32 v232,16,v192
v_lshlrev_b32 v233,16,v194
M v[100:103],a[220:223],v[220:223],v[100:103]
v_lshlrev_b32 v237,16,v202
v_lshlrev_b32 v236,16,v200
M v[100:103],v[228:231],a[200:203],v[100:103]
buffer_load_dwordx2 v[208:209],v245,s[8:11],s28 offen offset:384
M v[104:107],v[228:231],v[220:223],v[104:107]
ds_read_b128 a[204:207],v248 offset:27648
v_lshlrev_b32 v235,16,v198
M v[104:107],a[220:223],a[212:215],v[104:107]
s_waitcnt lgkmcnt(2)
ds_read_b128 a[228:231],v249 offset:27648
v_fmac_f32 v232,s43,v234
M v[104:107],a[224:227],a[208:211],v[104:107]
s_waitcnt lgkmcnt(2)
v_fmac_f32 v237,4.0,v233
v_fma_f32 v238,-4.0,v234,v236
M v[108:111],a[224:227],a[232:235],v[108:111]
buffer_load_dwordx2 v[210:211],v245,s[8:11],s28 offen offset:768
M v[108:111],a[220:223],a[208:211],v[108:111]
v_fmac_f32 v232,s45,v236
v_fmac_f32 v237,s41,v235
M v[108:111],v[228:231],a[212:215],v[108:111]
v_sub_f32 v236,v236,v234
v_fma_f32 v234,-4.0,v233,v235
M v[112:115],v[228:231],a[208:211],v[112:115]
ds_read_b128 a[216:219],v249 offset:28160
v_sub_f32 v235,v235,v233
M v[112:115],a[220:223],a[232:235],v[112:115]
s_waitcnt lgkmcnt(2)
buffer_load_dwordx2 v[212:213],v245,s[8:11],s28 offen offset:1152
M v[112:115],a[224:227],a[204:207],v[112:115]
s_waitcnt lgkmcnt(1)
ds_read_b128 a[252:255],v248 offset:28160
v_add_f32 v233,v238,v234
M v[116:119],a[224:227],a[228:231],v[116:119]
v_sub_f32 v238,v238,v234
v_fma_f32 v234,2.0,v235,v236
M v[116:119],a[220:223],a[204:207],v[116:119]
v_fmac_f32 v236,-2.0,v235
v_and_b32 v196,s42,v196
M v[116:119],v[228:231],a[232:235],v[116:119]
v_and_b32 v192,s42,v192
v_and_b32 v194,s42,v194
M v[120:123],v[228:231],a[204:207],v[120:123]
v_and_b32 v202,s42,v202
v_and_b32 v200,s42,v200
M v[120:123],a[220:223],a[228:231],v[120:123]
s_waitcnt lgkmcnt(1)
v_and_b32 v198,s42,v198
v_fmac_f32 v192,s43,v196
M v[120:123],a[224:227],a[216:219],v[120:123]
s_waitcnt lgkmcnt(0)
v_fmac_f32 v202,4.0,v194
v_fma_f32 v235,-4.0,v196,v200
M v[124:127],a[224:227],a[252:255],v[124:127]
buffer_load_dwordx4 a[224:227],v250,s[20:23],s46 offen offset:1024 sc1
M v[124:127],a[220:223],a[216:219],v[124:127]
v_fmac_f32 v192,s45,v200
v_fmac_f32 v202,s41,v198
M v[124:127],v[228:231],a[228:231],v[124:127]
s_waitcnt vmcnt(13)
buffer_load_dwordx4 a[220:223],v250,s[20:23],s46 offen offset:2048 sc1
M v[128:131],a[248:251],a[192:195],v[128:131]
s_waitcnt vmcnt(13)
s_add_u32 s47,s75,12288
v_sub_f32 v200,v200,v196
v_fma_f32 v196,-4.0,v194,v198
M v[128:131],a[240:243],a[200:203],v[128:131]
s_waitcnt vmcnt(12)
v_sub_f32 v198,v198,v194
v_add_f32 v194,v235,v196
M v[128:131],a[244:247],v[220:223],v[128:131]
v_sub_f32 v235,v235,v196
v_fma_f32 v196,2.0,v198,v200
M v[132:135],a[244:247],a[212:215],v[132:135]
buffer_load_dwordx4 v[228:231],v250,s[20:23],s47 offen offset:0 sc1
M v[132:135],a[240:243],v[220:223],v[132:135]
v_fmac_f32 v200,-2.0,v198
v_cvt_pk_bf16_f32 v192,v232,v192
M v[132:135],a[248:251],a[200:203],v[132:135]
v_cvt_pk_bf16_f32 v202,v237,v202
v_cvt_pk_bf16_f32 v194,v233,v194
M v[136:139],a[248:251],v[220:223],v[136:139]
v_cvt_pk_bf16_f32 v198,v234,v196
v_cvt_pk_bf16_f32 v196,v238,v235
M v[136:139],a[240:243],a[212:215],v[136:139]
v_cvt_pk_bf16_f32 v200,v236,v200
v_lshlrev_b32 v234,16,v197
M v[136:139],a[244:247],a[208:211],v[136:139]
v_lshlrev_b32 v232,16,v193
v_lshlrev_b32 v233,16,v195
M v[140:143],a[244:247],a[232:235],v[140:143]
v_lshlrev_b32 v237,16,v203
v_lshlrev_b32 v236,16,v201
M v[140:143],a[240:243],a[208:211],v[140:143]
v_lshlrev_b32 v235,16,v199
v_fmac_f32 v232,s43,v234
M v[140:143],a[248:251],a[212:215],v[140:143]
v_fmac_f32 v237,4.0,v233
v_fma_f32 v238,-4.0,v234,v236
M v[144:147],a[248:251],a[208:211],v[144:147]
v_fmac_f32 v232,s45,v236
v_fmac_f32 v237,s41,v235
M v[144:147],a[240:243],a[232:235],v[144:147]
v_sub_f32 v236,v236,v234
v_fma_f32 v234,-4.0,v233,v235
M v[144:147],a[244:247],a[204:207],v[144:147]
v_sub_f32 v235,v235,v233
v_add_f32 v233,v238,v234
M v[148:151],a[244:247],a[228:231],v[148:151]
v_sub_f32 v238,v238,v234
v_fma_f32 v234,2.0,v235,v236
M v[148:151],a[240:243],a[204:207],v[148:151]
v_fmac_f32 v236,-2.0,v235
v_and_b32 v197,s42,v197
M v[148:151],a[248:251],a[232:235],v[148:151]
v_and_b32 v193,s42,v193
v_and_b32 v195,s42,v195
M v[152:155],a[248:251],a[204:207],v[152:155]
v_and_b32 v203,s42,v203
v_and_b32 v201,s42,v201
M v[152:155],a[240:243],a[228:231],v[152:155]
v_and_b32 v199,s42,v199
v_fmac_f32 v193,s43,v197
M v[152:155],a[244:247],a[216:219],v[152:155]
v_fmac_f32 v203,4.0,v195
v_fma_f32 v235,-4.0,v197,v201
M v[156:159],a[244:247],a[252:255],v[156:159]
buffer_load_dwordx4 a[244:247],v250,s[20:23],s47 offen offset:1024 sc1
M v[156:159],a[240:243],a[216:219],v[156:159]
v_fmac_f32 v193,s45,v201
v_fmac_f32 v203,s41,v199
M v[156:159],a[248:251],a[228:231],v[156:159]
s_waitcnt vmcnt(13)
buffer_load_dwordx4 a[240:243],v250,s[20:23],s47 offen offset:2048 sc1
M v[160:163],v[224:227],a[192:195],v[160:163]
s_waitcnt vmcnt(13)
s_add_u32 s48,s75,15360
v_sub_f32 v201,v201,v197
v_fma_f32 v197,-4.0,v195,v199
M v[160:163],a[196:199],a[200:203],v[160:163]
s_waitcnt vmcnt(12)
v_sub_f32 v199,v199,v195
v_add_f32 v195,v235,v197
M v[160:163],a[236:239],v[220:223],v[160:163]
v_sub_f32 v235,v235,v197
v_fma_f32 v197,2.0,v199,v201
M v[164:167],a[236:239],a[212:215],v[164:167]
buffer_load_dwordx4 a[248:251],v250,s[20:23],s48 offen offset:0 sc1
M v[164:167],a[196:199],v[220:223],v[164:167]
v_fmac_f32 v201,-2.0,v199
v_cvt_pk_bf16_f32 v193,v232,v193
M v[164:167],v[224:227],a[200:203],v[164:167]
v_cvt_pk_bf16_f32 v203,v237,v203
v_cvt_pk_bf16_f32 v195,v233,v195
M v[168:171],v[224:227],v[220:223],v[168:171]
v_cvt_pk_bf16_f32 v199,v234,v197
v_cvt_pk_bf16_f32 v197,v238,v235
M v[168:171],a[196:199],a[212:215],v[168:171]
buffer_load_dwordx4 a[192:195],v250,s[20:23],s48 offen offset:1024 sc1
M v[168:171],a[236:239],a[208:211],v[168:171]
v_cvt_pk_bf16_f32 v201,v236,v201
v_add_u32 v238,139264,v247
M v[172:175],a[236:239],a[232:235],v[172:175]
M v[172:175],a[196:199],a[208:211],v[172:175]
M v[172:175],v[224:227],a[212:215],v[172:175]
buffer_load_dwordx4 a[200:203],v250,s[20:23],s48 offen offset:2048 sc1
M v[176:179],v[224:227],a[208:211],v[176:179]
s_add_u32 s46,s75,18432
M v[176:179],a[196:199],a[232:235],v[176:179]
M v[176:179],a[236:239],a[204:207],v[176:179]
s_barrier
ds_write2st64_b64 v238,v[192:193],v[202:203] offset0:0 offset1:17
M v[180:183],a[236:239],a[228:231],v[180:183]
s_add_u32 s28,s70,786432
buffer_load_dwordx4 v[220:223],v250,s[20:23],s46 offen offset:0 sc1
M v[180:183],a[196:199],a[204:207],v[180:183]
ds_read_b128 a[212:215],v248 offset:34816
M v[180:183],v[224:227],a[232:235],v[180:183]
ds_write2st64_b64 v247,v[194:195],v[196:197] offset0:34 offset1:51
M v[184:187],v[224:227],a[204:207],v[184:187]
buffer_load_dwordx2 v[192:193],v245,s[12:15],s28 offen offset:0
M v[184:187],a[196:199],a[228:231],v[184:187]
ds_read_b128 a[208:211],v249 offset:34816
ds_read_b128 a[232:235],v248 offset:35328
M v[184:187],a[236:239],a[216:219],v[184:187]
ds_write2st64_b64 v247,v[198:199],v[200:201] offset0:68 offset1:85
M v[188:191],a[236:239],a[252:255],v[188:191]
buffer_load_dwordx2 v[202:203],v245,s[16:19],s28 offen offset:1536
M v[188:191],a[196:199],a[216:219],v[188:191]
ds_read_b128 a[204:207],v249 offset:35328
M v[188:191],v[224:227],a[228:231],v[188:191]
s_waitcnt vmcnt(17) lgkmcnt(5)
M a[0:3],v[216:219],a[212:215],a[0:3]
s_waitcnt vmcnt(10) lgkmcnt(3)
ds_read_b128 a[236:239],v248 offset:35840
M a[0:3],a[224:227],a[208:211],a[0:3]
s_waitcnt vmcnt(9) lgkmcnt(3)
buffer_load_dwordx2 v[194:195],v245,s[8:11],s28 offen offset:0
M a[0:3],a[220:223],a[232:235],a[0:3]
s_waitcnt lgkmcnt(1)
ds_read_b128 a[252:255],v249 offset:35840
v_lshlrev_b32 v234,16,v208
M a[4:7],a[220:223],a[204:207],a[4:7]
v_lshlrev_b32 v232,16,v204
v_lshlrev_b32 v233,16,v206
M a[4:7],a[224:227],a[232:235],a[4:7]
v_lshlrev_b32 v237,16,v214
v_lshlrev_b32 v236,16,v212
M a[4:7],v[216:219],a[208:211],a[4:7]
buffer_load_dwordx2 v[196:197],v245,s[8:11],s28 offen offset:384
M a[8:11],v[216:219],a[232:235],a[8:11]
ds_read_b128 a[196:199],v248 offset:36352
v_lshlrev_b32 v235,16,v210
M a[8:11],a[224:227],a[204:207],a[8:11]
s_waitcnt lgkmcnt(2)
ds_read_b128 a[216:219],v249 offset:36352
v_fmac_f32 v232,s43,v234
M a[8:11],a[220:223],a[236:239],a[8:11]
s_waitcnt lgkmcnt(2)
v_fmac_f32 v237,4.0,v233
v_fma_f32 v238,-4.0,v234,v236
M a[12:15],a[220:223],a[252:255],a[12:15]
buffer_load_dwordx2 v[198:199],v245,s[8:11],s28 offen offset:768
M a[12:15],a[224:227],a[236:239],a[12:15]
v_fmac_f32 v232,s45,v236
v_fmac_f32 v237,s41,v235
M a[12:15],v[216:219],a[204:207],a[12:15]
v_sub_f32 v236,v236,v234
v_fma_f32 v234,-4.0,v233,v235
M a[16:19],v[216:219],a[236:239],a[16:19]
ds_read_b128 a[228:231],v249 offset:36864
v_sub_f32 v235,v235,v233
M a[16:19],a[224:227],a[252:255],a[16:19]
s_waitcnt lgkmcnt(2)
buffer_load_dwordx2 v[200:201],v245,s[8:11],s28 offen offset:1152
M a[16:19],a[220:223],a[196:199],a[16:19]
s_waitcnt lgkmcnt(1)
ds_read_b128 v[224:227],v248 offset:36864
v_add_f32 v233,v238,v234
M a[20:23],a[220:223],a[216:219],a[20:23]
v_sub_f32 v238,v238,v234
v_fma_f32 v234,2.0,v235,v236
M a[20:23],a[224:227],a[196:199],a[20:23]
v_fmac_f32 v236,-2.0,v235
v_and_b32 v208,s42,v208
M a[20:23],v[216:219],a[252:255],a[20:23]
v_and_b32 v204,s42,v204
v_and_b32 v206,s42,v206
M a[24:27],v[216:219],a[196:199],a[24:27]
v_and_b32 v214,s42,v214
v_and_b32 v212,s42,v212
M a[24:27],a[224:227],a[216:219],a[24:27]
s_waitcnt lgkmcnt(1)
v_and_b32 v210,s42,v210
v_fmac_f32 v204,s43,v208
M a[24:27],a[220:223],a[228:231],a[24:27]
s_waitcnt lgkmcnt(0)
v_fmac_f32 v214,4.0,v206
v_fma_f32 v235,-4.0,v208,v212
M a[28:31],a[220:223],v[224:227],a[28:31]
buffer_load_dwordx4 a[220:223],v250,s[20:23],s46 offen offset:1024 sc1
M a[28:31],a[224:227],a[228:231],a[28:31]
v_fmac_f32 v204,s45,v212
v_fmac_f32 v214,s41,v210
M a[28:31],v[216:219],a[216:219],a[28:31]
s_waitcnt vmcnt(13)
buffer_load_dwordx4 a[224:227],v250,s[20:23],s46 offen offset:2048 sc1
M a[32:35],v[228:231],a[212:215],a[32:35]
s_waitcnt vmcnt(13)
s_add_u32 s47,s75,21504
v_sub_f32 v212,v212,v208
v_fma_f32 v208,-4.0,v206,v210
M a[32:35],a[244:247],a[208:211],a[32:35]
s_waitcnt vmcnt(12)
v_sub_f32 v210,v210,v206
v_add_f32 v206,v235,v208
M a[32:35],a[240:243],a[232:235],a[32:35]
v_sub_f32 v235,v235,v208
v_fma_f32 v208,2.0,v210,v212
M a[36:39],a[240:243],a[204:207],a[36:39]
buffer_load_dwordx4 v[216:219],v250,s[20:23],s47 offen offset:0 sc1
M a[36:39],a[244:247],a[232:235],a[36:39]
v_fmac_f32 v212,-2.0,v210
v_cvt_pk_bf16_f32 v204,v232,v204
M a[36:39],v[228:231],a[208:211],a[36:39]
v_cvt_pk_bf16_f32 v214,v237,v214
v_cvt_pk_bf16_f32 v206,v233,v206
M a[40:43],v[228:231],a[232:235],a[40:43]
v_cvt_pk_bf16_f32 v210,v234,v208
v_cvt_pk_bf16_f32 v208,v238,v235
M a[40:43],a[244:247],a[204:207],a[40:43]
v_cvt_pk_bf16_f32 v212,v236,v212
v_lshlrev_b32 v234,16,v209
M a[40:43],a[240:243],a[236:239],a[40:43]
v_lshlrev_b32 v232,16,v205
v_lshlrev_b32 v233,16,v207
M a[44:47],a[240:243],a[252:255],a[44:47]
v_lshlrev_b32 v237,16,v215
v_lshlrev_b32 v236,16,v213
M a[44:47],a[244:247],a[236:239],a[44:47]
v_lshlrev_b32 v235,16,v211
v_fmac_f32 v232,s43,v234
M a[44:47],v[228:231],a[204:207],a[44:47]
v_fmac_f32 v237,4.0,v233
v_fma_f32 v238,-4.0,v234,v236
M a[48:51],v[228:231],a[236:239],a[48:51]
v_fmac_f32 v232,s45,v236
v_fmac_f32 v237,s41,v235
M a[48:51],a[244:247],a[252:255],a[48:51]
v_sub_f32 v236,v236,v234
v_fma_f32 v234,-4.0,v233,v235
M a[48:51],a[240:243],a[196:199],a[48:51]
v_sub_f32 v235,v235,v233
v_add_f32 v233,v238,v234
M a[52:55],a[240:243],a[216:219],a[52:55]
v_sub_f32 v238,v238,v234
v_fma_f32 v234,2.0,v235,v236
M a[52:55],a[244:247],a[196:199],a[52:55]
v_fmac_f32 v236,-2.0,v235
v_and_b32 v209,s42,v209
M a[52:55],v[228:231],a[252:255],a[52:55]
v_and_b32 v205,s42,v205
v_and_b32 v207,s42,v207
M a[56:59],v[228:231],a[196:199],a[56:59]
v_and_b32 v215,s42,v215
v_and_b32 v213,s42,v213
M a[56:59],a[244:247],a[216:219],a[56:59]
v_and_b32 v211,s42,v211
v_fmac_f32 v205,s43,v209
M a[56:59],a[240:243],a[228:231],a[56:59]
v_fmac_f32 v215,4.0,v207
v_fma_f32 v235,-4.0,v209,v213
M a[60:63],a[240:243],v[224:227],a[60:63]
buffer_load_dwordx4 a[240:243],v250,s[20:23],s47 offen offset:1024 sc1
M a[60:63],a[244:247],a[228:231],a[60:63]
v_fmac_f32 v205,s45,v213
v_fmac_f32 v215,s41,v211
M a[60:63],v[228:231],a[216:219],a[60:63]
s_waitcnt vmcnt(13)
buffer_load_dwordx4 a[244:247],v250,s[20:23],s47 offen offset:2048 sc1
M a[64:67],a[248:251],a[212:215],a[64:67]
s_waitcnt vmcnt(13)
s_add_u32 s48,s75,24576
v_sub_f32 v213,v213,v209
v_fma_f32 v209,-4.0,v207,v211
M a[64:67],a[192:195],a[208:211],a[64:67]
s_waitcnt vmcnt(12)
v_sub_f32 v211,v211,v207
v_add_f32 v207,v235,v209
M a[64:67],a[200:203],a[232:235],a[64:67]
v_sub_f32 v235,v235,v209
v_fma_f32 v209,2.0,v211,v213
M a[68:71],a[200:203],a[204:207],a[68:71]
buffer_load_dwordx4 v[228:231],v250,s[20:23],s48 offen offset:0 sc1
M a[68:71],a[192:195],a[232:235],a[68:71]
v_fmac_f32 v213,-2.0,v211
v_cvt_pk_bf16_f32 v205,v232,v205
M a[68:71],a[248:251],a[208:211],a[68:71]
v_cvt_pk_bf16_f32 v215,v237,v215
v_cvt_pk_bf16_f32 v207,v233,v207
M a[72:75],a[248:251],a[232:235],a[72:75]
v_cvt_pk_bf16_f32 v211,v234,v209
v_cvt_pk_bf16_f32 v209,v238,v235
M a[72:75],a[192:195],a[204:207],a[72:75]
buffer_load_dwordx4 a[212:215],v250,s[20:23],s48 offen offset:1024 sc1
M a[72:75],a[200:203],a[236:239],a[72:75]
v_cvt_pk_bf16_f32 v213,v236,v213
v_add_u32 v238,139264,v247
M a[76:79],a[200:203],a[252:255],a[76:79]
v_fmac_f32 v239,s43,v241
v_fmac_f32 v244,4.0,v240
M a[76:79],a[192:195],a[236:239],a[76:79]
v_fma_f32 v232,-4.0,v241,v243
v_fmac_f32 v239,s45,v243
M a[76:79],a[248:251],a[204:207],a[76:79]
buffer_load_dwordx4 a[208:211],v250,s[20:23],s48 offen offset:2048 sc1
M a[80:83],a[248:251],a[236:239],a[80:83]
s_add_u32 s46,s75,27648
v_fmac_f32 v244,s41,v242
v_sub_f32 v243,v243,v241
M a[80:83],a[192:195],a[252:255],a[80:83]
v_fma_f32 v241,-4.0,v240,v242
v_sub_f32 v242,v242,v240
M a[80:83],a[200:203],a[196:199],a[80:83]
ds_write2st64_b64 v238,v[204:205],v[214:215] offset0:1 offset1:18
M a[84:87],a[200:203],a[216:219],a[84:87]
s_add_u32 s28,s70,1179648
buffer_load_dwordx4 a[232:235],v250,s[20:23],s46 offen offset:0 sc1
M a[84:87],a[192:195],a[196:199],a[84:87]
ds_read_b128 a[204:207],v248 offset:43520
v_add_f32 v240,v232,v241
M a[84:87],a[248:251],a[252:255],a[84:87]
ds_write2st64_b64 v247,v[206:207],v[208:209] offset0:35 offset1:52
M a[88:91],a[248:251],a[196:199],a[88:91]
buffer_load_dwordx2 v[204:205],v245,s[12:15],s28 offen offset:0
M a[88:91],a[192:195],a[216:219],a[88:91]
ds_read_b128 a[236:239],v249 offset:43520
ds_read_b128 a[252:255],v248 offset:44032
M a[88:91],a[200:203],a[228:231],a[88:91]
ds_write2st64_b64 v247,v[210:211],v[212:213] offset0:69 offset1:86
M a[92:95],a[200:203],v[224:227],a[92:95]
buffer_load_dwordx2 v[214:215],v245,s[16:19],s28 offen offset:1536
M a[92:95],a[192:195],a[228:231],a[92:95]
ds_read_b128 a[196:199],v249 offset:44032
v_sub_f32 v232,v232,v241
M a[92:95],a[248:251],a[216:219],a[92:95]
s_waitcnt vmcnt(17) lgkmcnt(5)
v_fma_f32 v241,2.0,v242,v243
v_fmac_f32 v243,-2.0,v242
M a[96:99],v[220:223],a[204:207],a[96:99]
s_waitcnt vmcnt(10) lgkmcnt(3)
ds_read_b128 a[200:203],v248 offset:44544
v_cvt_pk_bf16_f32 v233,v239,v244
M a[96:99],a[220:223],a[236:239],a[96:99]
s_waitcnt vmcnt(9) lgkmcnt(3)
buffer_load_dwordx2 v[206:207],v245,s[8:11],s28 offen offset:0
M a[96:99],a[224:227],a[252:255],a[96:99]
s_waitcnt lgkmcnt(1)
ds_read_b128 v[224:227],v249 offset:44544
v_cvt_pk_bf16_f32 v234,v240,v232
M a[100:103],a[224:227],a[196:199],a[100:103]
v_cvt_pk_bf16_f32 v235,v241,v243
v_add_u32 v232,139264,v252
M a[100:103],a[220:223],a[252:255],a[100:103]
ds_write_b16 v232,v233 offset:0
M a[100:103],v[220:223],a[236:239],a[100:103]
buffer_load_dwordx2 v[208:209],v245,s[8:11],s28 offen offset:384
M a[104:107],v[220:223],a[252:255],a[104:107]
ds_read_b128 a[192:195],v248 offset:45056
ds_write_b16_d16_hi v232,v233 offset:8704
M a[104:107],a[220:223],a[196:199],a[104:107]
s_waitcnt lgkmcnt(4)
ds_read_b128 a[228:231],v249 offset:45056
ds_write_b16 v252,v234 offset:17408
M a[104:107],a[224:227],a[200:203],a[104:107]
s_waitcnt lgkmcnt(5)
ds_write_b16_d16_hi v252,v234 offset:26112
M a[108:111],a[224:227],v[224:227],a[108:111]
buffer_load_dwordx2 v[210:211],v245,s[8:11],s28 offen offset:768
M a[108:111],a[220:223],a[200:203],a[108:111]
ds_write_b16 v252,v235 offset:34816
M a[108:111],v[220:223],a[196:199],a[108:111]
ds_write_b16_d16_hi v252,v235 offset:43520
M a[112:115],v[220:223],a[200:203],a[112:115]
ds_read_b128 a[216:219],v249 offset:45568
v_lshlrev_b32 v234,16,v196
M a[112:115],a[220:223],v[224:227],a[112:115]
s_waitcnt lgkmcnt(7)
buffer_load_dwordx2 v[212:213],v245,s[8:11],s28 offen offset:1152
M a[112:115],a[224:227],a[192:195],a[112:115]
s_waitcnt lgkmcnt(5)
s_add_u32 s29,s71,0
ds_read_b128 a[248:251],v248 offset:45568
v_lshlrev_b32 v232,16,v192
M a[116:119],a[224:227],a[228:231],a[116:119]
v_lshlrev_b32 v233,16,v194
v_lshlrev_b32 v237,16,v202
M a[116:119],a[220:223],a[192:195],a[116:119]
v_lshlrev_b32 v236,16,v200
v_lshlrev_b32 v235,16,v198
M a[116:119],v[220:223],v[224:227],a[116:119]
buffer_load_short_d16_hi v239,v246,s[12:15],s29 offen offset:0
M a[120:123],v[220:223],a[192:195],a[120:123]
v_fmac_f32 v232,s43,v234
v_fmac_f32 v237,4.0,v233
M a[120:123],a[220:223],a[228:231],a[120:123]
s_waitcnt lgkmcnt(1)
buffer_load_short_d16_hi v240,v246,s[8:11],s29 offen offset:0
M a[120:123],a[224:227],a[216:219],a[120:123]
s_waitcnt lgkmcnt(0)
v_fma_f32 v238,-4.0,v234,v236
v_fmac_f32 v232,s45,v236
M a[124:127],a[224:227],a[248:251],a[124:127]
buffer_load_dwordx4 a[224:227],v250,s[20:23],s46 offen offset:1024 sc1
M a[124:127],a[220:223],a[216:219],a[124:127]
v_fmac_f32 v237,s41,v235
v_sub_f32 v236,v236,v234
M a[124:127],v[220:223],a[228:231],a[124:127]
s_waitcnt vmcnt(15)
v_fma_f32 v234,-4.0,v233,v235
v_sub_f32 v235,v235,v233
M a[128:131],v[216:219],a[204:207],a[128:131]
s_waitcnt vmcnt(14)
v_add_f32 v233,v238,v234
v_sub_f32 v238,v238,v234
M a[128:131],a[240:243],a[236:239],a[128:131]
s_waitcnt vmcnt(13)
buffer_load_dwordx4 a[220:223],v250,s[20:23],s46 offen offset:2048 sc1
M a[128:131],a[244:247],a[252:255],a[128:131]
s_add_u32 s47,s75,30720
v_fma_f32 v234,2.0,v235,v236
v_fmac_f32 v236,-2.0,v235
M a[132:135],a[244:247],a[196:199],a[132:135]
v_and_b32 v196,s42,v196
v_and_b32 v192,s42,v192
M a[132:135],a[240:243],a[252:255],a[132:135]
v_and_b32 v194,s42,v194
v_and_b32 v202,s42,v202
M a[132:135],v[216:219],a[236:239],a[132:135]
buffer_load_dwordx4 v[220:223],v250,s[20:23],s47 offen offset:0 sc1
M a[136:139],v[216:219],a[252:255],a[136:139]
v_and_b32 v200,s42,v200
v_and_b32 v198,s42,v198
M a[136:139],a[240:243],a[196:199],a[136:139]
v_fmac_f32 v192,s43,v196
v_fmac_f32 v202,4.0,v194
M a[136:139],a[244:247],a[200:203],a[136:139]
v_fma_f32 v235,-4.0,v196,v200
v_fmac_f32 v192,s45,v200
M a[140:143],a[244:247],v[224:227],a[140:143]
buffer_load_short_d16_hi v241,v246,s[8:11],s29 offen offset:384
M a[140:143],a[240:243],a[200:203],a[140:143]
v_fmac_f32 v202,s41,v198
v_sub_f32 v200,v200,v196
M a[140:143],v[216:219],a[196:199],a[140:143]
buffer_load_short_d16_hi v242,v246,s[8:11],s29 offen offset:768
M a[144:147],v[216:219],a[200:203],a[144:147]
v_fma_f32 v196,-4.0,v194,v198
v_sub_f32 v198,v198,v194
M a[144:147],a[240:243],v[224:227],a[144:147]
buffer_load_short_d16_hi v243,v246,s[8:11],s29 offen offset:1152
M a[144:147],a[244:247],a[192:195],a[144:147]
v_add_f32 v194,v235,v196
v_sub_f32 v235,v235,v196
M a[148:151],a[244:247],a[228:231],a[148:151]
buffer_load_short_d16_hi v244,v246,s[16:19],s29 offen offset:1536
M a[148:151],a[240:243],a[192:195],a[148:151]
v_fma_f32 v196,2.0,v198,v200
v_fmac_f32 v200,-2.0,v198
M a[148:151],v[216:219],v[224:227],a[148:151]
v_cvt_pk_bf16_f32 v192,v232,v192
v_cvt_pk_bf16_f32 v202,v237,v202
M a[152:155],v[216:219],a[192:195],a[152:155]
v_cvt_pk_bf16_f32 v194,v233,v194
v_cvt_pk_bf16_f32 v198,v234,v196
M a[152:155],a[240:243],a[228:231],a[152:155]
v_cvt_pk_bf16_f32 v196,v238,v235
v_cvt_pk_bf16_f32 v200,v236,v200
M a[152:155],a[244:247],a[216:219],a[152:155]
v_lshlrev_b32 v234,16,v197
v_lshlrev_b32 v232,16,v193
M a[156:159],a[244:247],a[248:251],a[156:159]
buffer_load_dwordx4 a[244:247],v250,s[20:23],s47 offen offset:1024 sc1
M a[156:159],a[240:243],a[216:219],a[156:159]
v_lshlrev_b32 v233,16,v195
v_lshlrev_b32 v237,16,v203
M a[156:159],v[216:219],a[228:231],a[156:159]
s_waitcnt vmcnt(19)
buffer_load_dwordx4 a[240:243],v250,s[20:23],s47 offen offset:2048 sc1
M a[160:163],v[228:231],a[204:207],a[160:163]
s_waitcnt vmcnt(19)
s_add_u32 s48,s75,33792
v_lshlrev_b32 v236,16,v201
v_lshlrev_b32 v235,16,v199
M a[160:163],a[212:215],a[236:239],a[160:163]
s_waitcnt vmcnt(18)
v_fmac_f32 v232,s43,v234
v_fmac_f32 v237,4.0,v233
M a[160:163],a[208:211],a[252:255],a[160:163]
v_fma_f32 v238,-4.0,v234,v236
v_fmac_f32 v232,s45,v236
M a[164:167],a[208:211],a[196:199],a[164:167]
buffer_load_dwordx4 v[216:219],v250,s[20:23],s48 offen offset:0 sc1
M a[164:167],a[212:215],a[252:255],a[164:167]
v_fmac_f32 v237,s41,v235
v_sub_f32 v236,v236,v234
M a[164:167],v[228:231],a[236:239],a[164:167]
v_fma_f32 v234,-4.0,v233,v235
v_sub_f32 v235,v235,v233
M a[168:171],v[228:231],a[252:255],a[168:171]
v_add_f32 v233,v238,v234
v_sub_f32 v238,v238,v234
M a[168:171],a[212:215],a[196:199],a[168:171]
buffer_load_dwordx4 a[204:207],v250,s[20:23],s48 offen offset:1024 sc1
M a[168:171],a[208:211],a[200:203],a[168:171]
v_fma_f32 v234,2.0,v235,v236
v_fmac_f32 v236,-2.0,v235
M a[172:175],a[208:211],v[224:227],a[172:175]
v_and_b32 v197,s42,v197
v_and_b32 v193,s42,v193
M a[172:175],a[212:215],a[200:203],a[172:175]
v_and_b32 v195,s42,v195
v_and_b32 v203,s42,v203
M a[172:175],v[228:231],a[196:199],a[172:175]
buffer_load_dwordx4 a[236:239],v250,s[20:23],s48 offen offset:2048 sc1
M a[176:179],v[228:231],a[200:203],a[176:179]
s_add_u32 s46,s75,36864
v_and_b32 v201,s42,v201
v_and_b32 v199,s42,v199
M a[176:179],a[212:215],v[224:227],a[176:179]
v_fmac_f32 v193,s43,v197
v_fmac_f32 v203,4.0,v195
M a[176:179],a[208:211],a[192:195],a[176:179]
v_fma_f32 v235,-4.0,v197,v201
v_fmac_f32 v193,s45,v201
M a[180:183],a[208:211],a[228:231],a[180:183]
buffer_load_dwordx4 a[252:255],v250,s[20:23],s46 offen offset:0 sc1
M a[180:183],a[212:215],a[192:195],a[180:183]
ds_read_b128 a[196:199],v248 offset:52224
v_fmac_f32 v203,s41,v199
M a[180:183],v[228:231],v[224:227],a[180:183]
ds_read_b128 a[200:203],v249 offset:52224
v_sub_f32 v201,v201,v197
M a[184:187],v[228:231],a[192:195],a[184:187]
ds_read_b128 v[224:227],v248 offset:52736
v_fma_f32 v197,-4.0,v195,v199
M a[184:187],a[212:215],a[228:231],a[184:187]
ds_read_b128 a[192:195],v249 offset:52736
v_sub_f32 v199,v199,v195
M a[184:187],a[208:211],a[216:219],a[184:187]
v_add_f32 v195,v235,v197
v_sub_f32 v235,v235,v197
M a[188:191],a[208:211],a[248:251],a[188:191]
v_fma_f32 v197,2.0,v199,v201
v_fmac_f32 v201,-2.0,v199
M a[188:191],a[212:215],a[216:219],a[188:191]
v_cvt_pk_bf16_f32 v193,v232,v193
v_cvt_pk_bf16_f32 v203,v237,v203
M a[188:191],v[228:231],a[228:231],a[188:191]
s_waitcnt vmcnt(21) lgkmcnt(3)
v_cvt_pk_bf16_f32 v195,v233,v195
v_cvt_pk_bf16_f32 v199,v234,v197
M v[0:3],a[232:235],a[196:199],v[0:3]
s_waitcnt vmcnt(12) lgkmcnt(2)
ds_read_b128 a[208:211],v248 offset:53248
v_cvt_pk_bf16_f32 v197,v238,v235
M v[0:3],a[224:227],a[200:203],v[0:3]
s_waitcnt vmcnt(11) lgkmcnt(2)
ds_read_b128 a[248:251],v249 offset:53248
v_cvt_pk_bf16_f32 v201,v236,v201
M v[0:3],a[220:223],v[224:227],v[0:3]
s_waitcnt lgkmcnt(2)
v_add_u32 v238,139264,v247
v_lshlrev_b32 v234,16,v208
M v[4:7],a[220:223],a[192:195],v[4:7]
v_lshlrev_b32 v232,16,v204
v_lshlrev_b32 v233,16,v206
M v[4:7],a[224:227],v[224:227],v[4:7]
v_lshlrev_b32 v237,16,v214
v_lshlrev_b32 v236,16,v212
M v[4:7],a[232:235],a[200:203],v[4:7]
ds_write2st64_b64 v238,v[192:193],v[202:203] offset0:2 offset1:19
M v[8:11],a[232:235],v[224:227],v[8:11]
s_add_u32 s28,s71,0
buffer_load_dwordx2 v[192:193],v251,s[12:15],s28 offen offset:0
M v[8:11],a[224:227],a[192:195],v[8:11]
s_waitcnt lgkmcnt(2)
ds_read_b128 a[212:215],v248 offset:53760
ds_read_b128 a[216:219],v249 offset:53760
M v[8:11],a[220:223],a[208:211],v[8:11]
s_waitcnt lgkmcnt(3)
buffer_load_dwordx2 v[202:203],v251,s[16:19],s28 offen offset:1536
M v[12:15],a[220:223],a[248:251],v[12:15]
v_lshlrev_b32 v235,16,v210
v_fmac_f32 v232,s43,v234
M v[12:15],a[224:227],a[208:211],v[12:15]
v_fmac_f32 v237,4.0,v233
v_fma_f32 v238,-4.0,v234,v236
M v[12:15],a[232:235],a[192:195],v[12:15]
ds_write2st64_b64 v247,v[194:195],v[196:197] offset0:36 offset1:53
M v[16:19],a[232:235],a[208:211],v[16:19]
buffer_load_dwordx2 v[194:195],v251,s[8:11],s28 offen offset:0
M v[16:19],a[224:227],a[248:251],v[16:19]
s_waitcnt lgkmcnt(2)
ds_read_b128 a[228:231],v249 offset:54272
ds_read_b128 v[228:231],v248 offset:54272
M v[16:19],a[220:223],a[212:215],v[16:19]
s_waitcnt lgkmcnt(3)
ds_write2st64_b64 v247,v[198:199],v[200:201] offset0:70 offset1:87
M v[20:23],a[220:223],a[216:219],v[20:23]
buffer_load_dwordx2 v[196:197],v251,s[8:11],s28 offen offset:384
M v[20:23],a[224:227],a[212:215],v[20:23]
v_fmac_f32 v232,s45,v236
v_fmac_f32 v237,s41,v235
M v[20:23],a[232:235],a[248:251],v[20:23]
v_sub_f32 v236,v236,v234
v_fma_f32 v234,-4.0,v233,v235
M v[24:27],a[232:235],a[212:215],v[24:27]
v_sub_f32 v235,v235,v233
v_add_f32 v233,v238,v234
M v[24:27],a[224:227],a[216:219],v[24:27]
s_waitcnt lgkmcnt(2)
buffer_load_dwordx2 v[198:199],v251,s[8:11],s28 offen offset:768
M v[24:27],a[220:223],a[228:231],v[24:27]
s_waitcnt lgkmcnt(1)
v_sub_f32 v238,v238,v234
v_fma_f32 v234,2.0,v235,v236
M v[28:31],a[220:223],v[228:231],v[28:31]
v_fmac_f32 v236,-2.0,v235
v_and_b32 v208,s42,v208
M v[28:31],a[224:227],a[228:231],v[28:31]
v_and_b32 v204,s42,v204
v_and_b32 v206,s42,v206
M v[28:31],a[232:235],a[216:219],v[28:31]
s_waitcnt vmcnt(15)
buffer_load_dwordx2 v[200:201],v251,s[8:11],s28 offen offset:1152
M v[32:35],v[220:223],a[196:199],v[32:35]
s_waitcnt vmcnt(11)
v_and_b32 v214,s42,v214
v_and_b32 v212,s42,v212
M v[32:35],a[244:247],a[200:203],v[32:35]
s_waitcnt vmcnt(10)
v_and_b32 v210,s42,v210
v_fmac_f32 v204,s43,v208
M v[32:35],a[240:243],v[224:227],v[32:35]
v_fmac_f32 v214,4.0,v206
v_fma_f32 v235,-4.0,v208,v212
M v[36:39],a[240:243],a[192:195],v[36:39]
global_load_dword a220,v250,s[64:65]
M v[36:39],a[244:247],v[224:227],v[36:39]
v_fmac_f32 v204,s45,v212
v_fmac_f32 v214,s41,v210
M v[36:39],v[220:223],a[200:203],v[36:39]
buffer_load_dwordx4 a[220:223],v250,s[20:23],s46 offen offset:1024 sc1
M v[40:43],v[220:223],v[224:227],v[40:43]
v_sub_f32 v212,v212,v208
v_fma_f32 v208,-4.0,v206,v210
M v[40:43],a[244:247],a[192:195],v[40:43]
v_sub_f32 v210,v210,v206
v_add_f32 v206,v235,v208
M v[40:43],a[240:243],a[208:211],v[40:43]
v_sub_f32 v235,v235,v208
v_fma_f32 v208,2.0,v210,v212
M v[44:47],a[240:243],a[248:251],v[44:47]
buffer_load_dwordx4 a[224:227],v250,s[20:23],s46 offen offset:2048 sc1
M v[44:47],a[244:247],a[208:211],v[44:47]
s_add_u32 s47,s75,39936
v_fmac_f32 v212,-2.0,v210
v_cvt_pk_bf16_f32 v204,v232,v204
M v[44:47],v[220:223],a[192:195],v[44:47]
v_cvt_pk_bf16_f32 v214,v237,v214
v_cvt_pk_bf16_f32 v206,v233,v206
M v[48:51],v[220:223],a[208:211],v[48:51]
v_cvt_pk_bf16_f32 v210,v234,v208
v_cvt_pk_bf16_f32 v208,v238,v235
M v[48:51],a[244:247],a[248:251],v[48:51]
buffer_load_dwordx4 a[232:235],v250,s[20:23],s47 offen offset:0 sc1
M v[48:51],a[240:243],a[212:215],v[48:51]
v_cvt_pk_bf16_f32 v212,v236,v212
v_lshlrev_b32 v234,16,v209
M v[52:55],a[240:243],a[216:219],v[52:55]
v_lshlrev_b32 v232,16,v205
v_lshlrev_b32 v233,16,v207
M v[52:55],a[244:247],a[212:215],v[52:55]
v_lshlrev_b32 v237,16,v215
v_lshlrev_b32 v236,16,v213
M v[52:55],v[220:223],a[248:251],v[52:55]
v_lshlrev_b32 v235,16,v211
v_fmac_f32 v232,s43,v234
M v[56:59],v[220:223],a[212:215],v[56:59]
v_fmac_f32 v237,4.0,v233
v_fma_f32 v238,-4.0,v234,v236
M v[56:59],a[244:247],a[216:219],v[56:59]
v_fmac_f32 v232,s45,v236
v_fmac_f32 v237,s41,v235
M v[56:59],a[240:243],a[228:231],v[56:59]
v_sub_f32 v236,v236,v234
v_fma_f32 v234,-4.0,v233,v235
M v[60:63],a[240:243],v[228:231],v[60:63]
buffer_load_dwordx4 a[240:243],v250,s[20:23],s47 offen offset:1024 sc1
M v[60:63],a[244:247],a[228:231],v[60:63]
v_sub_f32 v235,v235,v233
v_add_f32 v233,v238,v234
M v[60:63],v[220:223],a[216:219],v[60:63]
s_waitcnt vmcnt(14)
buffer_load_dwordx4 a[244:247],v250,s[20:23],s47 offen offset:2048 sc1
M v[64:67],v[216:219],a[196:199],v[64:67]
s_waitcnt vmcnt(14)
s_add_u32 s48,s75,43008
v_sub_f32 v238,v238,v234
v_fma_f32 v234,2.0,v235,v236
M v[64:67],a[204:207],a[200:203],v[64:67]
s_waitcnt vmcnt(13)
v_fmac_f32 v236,-2.0,v235
v_and_b32 v209,s42,v209
M v[64:67],a[236:239],v[224:227],v[64:67]
v_and_b32 v205,s42,v205
v_and_b32 v207,s42,v207
M v[68:71],a[236:239],a[192:195],v[68:71]
buffer_load_dwordx4 v[220:223],v250,s[20:23],s48 offen offset:0 sc1
M v[68:71],a[204:207],v[224:227],v[68:71]
v_and_b32 v215,s42,v215
v_and_b32 v213,s42,v213
M v[68:71],v[216:219],a[200:203],v[68:71]
v_and_b32 v211,s42,v211
v_fmac_f32 v205,s43,v209
M v[72:75],v[216:219],v[224:227],v[72:75]
v_fmac_f32 v215,4.0,v207
v_fma_f32 v235,-4.0,v209,v213
M v[72:75],a[204:207],a[192:195],v[72:75]
buffer_load_dwordx4 a[196:199],v250,s[20:23],s48 offen offset:1024 sc1
M v[72:75],a[236:239],a[208:211],v[72:75]
v_fmac_f32 v205,s45,v213
v_fmac_f32 v215,s41,v211
M v[76:79],a[236:239],a[248:251],v[76:79]
v_sub_f32 v213,v213,v209
v_fma_f32 v209,-4.0,v207,v211
M v[76:79],a[204:207],a[208:211],v[76:79]
v_sub_f32 v211,v211,v207
v_add_f32 v207,v235,v209
M v[76:79],v[216:219],a[192:195],v[76:79]
buffer_load_dwordx4 a[200:203],v250,s[20:23],s48 offen offset:2048 sc1
M v[80:83],v[216:219],a[208:211],v[80:83]
s_add_u32 s46,s76,9216
v_sub_f32 v235,v235,v209
v_fma_f32 v209,2.0,v211,v213
M v[80:83],a[204:207],a[248:251],v[80:83]
v_fmac_f32 v213,-2.0,v211
v_cvt_pk_bf16_f32 v205,v232,v205
M v[80:83],a[236:239],a[212:215],v[80:83]
v_cvt_pk_bf16_f32 v215,v237,v215
v_cvt_pk_bf16_f32 v207,v233,v207
M v[84:87],a[236:239],a[216:219],v[84:87]
buffer_load_dwordx4 v[224:227],v250,s[20:23],s46 offen offset:0 sc1
M v[84:87],a[204:207],a[212:215],v[84:87]
ds_read_b128 a[192:195],v248 offset:60928
v_cvt_pk_bf16_f32 v211,v234,v209
M v[84:87],v[216:219],a[248:251],v[84:87]
ds_read_b128 a[208:211],v249 offset:60928
v_cvt_pk_bf16_f32 v209,v238,v235
M v[88:91],v[216:219],a[212:215],v[88:91]
ds_read_b128 a[248:251],v248 offset:61440
v_cvt_pk_bf16_f32 v213,v236,v213
M v[88:91],a[204:207],a[216:219],v[88:91]
ds_read_b128 a[212:215],v249 offset:61440
v_add_u32 v238,139264,v247
M v[88:91],a[236:239],a[228:231],v[88:91]
ds_write2st64_b64 v238,v[204:205],v[214:215] offset0:3 offset1:20
M v[92:95],a[236:239],v[228:231],v[92:95]
s_add_u32 s28,s71,393216
buffer_load_dwordx2 v[204:205],v245,s[12:15],s28 offen offset:0
M v[92:95],a[204:207],a[228:231],v[92:95]
s_waitcnt vmcnt(13)
v_lshlrev_b32 v234,16,v196
v_lshlrev_b32 v232,16,v192
M v[92:95],v[216:219],a[216:219],v[92:95]
s_waitcnt lgkmcnt(4)
buffer_load_dwordx2 v[214:215],v245,s[16:19],s28 offen offset:1536
M v[96:99],a[252:255],a[192:195],v[96:99]
s_waitcnt vmcnt(10) lgkmcnt(3)
ds_read_b128 a[236:239],v248 offset:61952
v_lshlrev_b32 v233,16,v194
M v[96:99],a[220:223],a[208:211],v[96:99]
s_waitcnt vmcnt(9) lgkmcnt(3)
ds_read_b128 v[228:231],v249 offset:61952
v_lshlrev_b32 v237,16,v202
M v[96:99],a[224:227],a[248:251],v[96:99]
s_waitcnt lgkmcnt(3)
ds_write2st64_b64 v247,v[206:207],v[208:209] offset0:37 offset1:54
M v[100:103],a[224:227],a[212:215],v[100:103]
buffer_load_dwordx2 v[206:207],v245,s[8:11],s28 offen offset:0
M v[100:103],a[220:223],a[248:251],v[100:103]
v_lshlrev_b32 v236,16,v200
v_lshlrev_b32 v235,16,v198
M v[100:103],a[252:255],a[208:211],v[100:103]
ds_write2st64_b64 v247,v[210:211],v[212:213] offset0:71 offset1:88
M v[104:107],a[252:255],a[248:251],v[104:107]
buffer_load_dwordx2 v[208:209],v245,s[8:11],s28 offen offset:384
M v[104:107],a[220:223],a[212:215],v[104:107]
s_waitcnt lgkmcnt(3)
ds_read_b128 a[204:207],v248 offset:62464
ds_read_b128 a[228:231],v249 offset:62464
M v[104:107],a[224:227],a[236:239],v[104:107]
s_waitcnt lgkmcnt(4)
v_fmac_f32 v232,s43,v234
v_fmac_f32 v237,4.0,v233
M v[108:111],a[224:227],v[228:231],v[108:111]
v_fma_f32 v238,-4.0,v234,v236
v_fmac_f32 v232,s45,v236
M v[108:111],a[220:223],a[236:239],v[108:111]
buffer_load_dwordx2 v[210:211],v245,s[8:11],s28 offen offset:768
M v[108:111],a[252:255],a[212:215],v[108:111]
v_fmac_f32 v237,s41,v235
v_sub_f32 v236,v236,v234
M v[112:115],a[252:255],a[236:239],v[112:115]
ds_read_b128 a[216:219],v249 offset:62976
v_fma_f32 v234,-4.0,v233,v235
M v[112:115],a[220:223],v[228:231],v[112:115]
s_waitcnt lgkmcnt(2)
ds_read_b128 v[216:219],v248 offset:62976
v_sub_f32 v235,v235,v233
M v[112:115],a[224:227],a[204:207],v[112:115]
s_waitcnt lgkmcnt(2)
buffer_load_dwordx2 v[212:213],v245,s[8:11],s28 offen offset:1152
M v[116:119],a[224:227],a[228:231],v[116:119]
v_add_f32 v233,v238,v234
v_sub_f32 v238,v238,v234
M v[116:119],a[220:223],a[204:207],v[116:119]
v_fma_f32 v234,2.0,v235,v236
v_fmac_f32 v236,-2.0,v235
M v[116:119],a[252:255],v[228:231],v[116:119]
v_and_b32 v196,s42,v196
v_and_b32 v192,s42,v192
M v[120:123],a[252:255],a[204:207],v[120:123]
v_and_b32 v194,s42,v194
v_and_b32 v202,s42,v202
M v[120:123],a[220:223],a[228:231],v[120:123]
s_waitcnt lgkmcnt(1)
v_and_b32 v200,s42,v200
v_and_b32 v198,s42,v198
M v[120:123],a[224:227],a[216:219],v[120:123]
s_waitcnt lgkmcnt(0)
v_fmac_f32 v192,s43,v196
v_fmac_f32 v202,4.0,v194
M v[124:127],a[224:227],v[216:219],v[124:127]
buffer_load_dwordx4 a[224:227],v250,s[20:23],s46 offen offset:1024 sc1
M v[124:127],a[220:223],a[216:219],v[124:127]
v_fma_f32 v235,-4.0,v196,v200
v_fmac_f32 v192,s45,v200
M v[124:127],a[252:255],a[228:231],v[124:127]
s_waitcnt vmcnt(13)
buffer_load_dwordx4 a[220:223],v250,s[20:23],s46 offen offset:2048 sc1
M v[128:131],a[232:235],a[192:195],v[128:131]
s_waitcnt vmcnt(13)
s_add_u32 s47,s76,12288
v_fmac_f32 v202,s41,v198
v_sub_f32 v200,v200,v196
M v[128:131],a[240:243],a[208:211],v[128:131]
s_waitcnt vmcnt(12)
v_fma_f32 v196,-4.0,v194,v198
v_sub_f32 v198,v198,v194
M v[128:131],a[244:247],a[248:251],v[128:131]
v_add_f32 v194,v235,v196
v_sub_f32 v235,v235,v196
M v[132:135],a[244:247],a[212:215],v[132:135]
buffer_load_dwordx4 a[252:255],v250,s[20:23],s47 offen offset:0 sc1
M v[132:135],a[240:243],a[248:251],v[132:135]
v_fma_f32 v196,2.0,v198,v200
v_fmac_f32 v200,-2.0,v198
M v[132:135],a[232:235],a[208:211],v[132:135]
v_cvt_pk_bf16_f32 v192,v232,v192
v_cvt_pk_bf16_f32 v202,v237,v202
M v[136:139],a[232:235],a[248:251],v[136:139]
v_cvt_pk_bf16_f32 v194,v233,v194
v_cvt_pk_bf16_f32 v198,v234,v196
M v[136:139],a[240:243],a[212:215],v[136:139]
v_cvt_pk_bf16_f32 v196,v238,v235
v_cvt_pk_bf16_f32 v200,v236,v200
M v[136:139],a[244:247],a[236:239],v[136:139]
v_lshlrev_b32 v234,16,v197
v_lshlrev_b32 v232,16,v193
M v[140:143],a[244:247],v[228:231],v[140:143]
v_lshlrev_b32 v233,16,v195
v_lshlrev_b32 v237,16,v203
M v[140:143],a[240:243],a[236:239],v[140:143]
v_lshlrev_b32 v236,16,v201
v_lshlrev_b32 v235,16,v199
M v[140:143],a[232:235],a[212:215],v[140:143]
v_fmac_f32 v232,s43,v234
v_fmac_f32 v237,4.0,v233
M v[144:147],a[232:235],a[236:239],v[144:147]
v_fma_f32 v238,-4.0,v234,v236
v_fmac_f32 v232,s45,v236
M v[144:147],a[240:243],v[228:231],v[144:147]
v_fmac_f32 v237,s41,v235
v_sub_f32 v236,v236,v234
M v[144:147],a[244:247],a[204:207],v[144:147]
v_fma_f32 v234,-4.0,v233,v235
v_sub_f32 v235,v235,v233
M v[148:151],a[244:247],a[228:231],v[148:151]
v_add_f32 v233,v238,v234
v_sub_f32 v238,v238,v234
M v[148:151],a[240:243],a[204:207],v[148:151]
v_fma_f32 v234,2.0,v235,v236
v_fmac_f32 v236,-2.0,v235
M v[148:151],a[232:235],v[228:231],v[148:151]
v_and_b32 v197,s42,v197
v_and_b32 v193,s42,v193
M v[152:155],a[232:235],a[204:207],v[152:155]
v_and_b32 v195,s42,v195
v_and_b32 v203,s42,v203
M v[152:155],a[240:243],a[228:231],v[152:155]
v_and_b32 v201,s42,v201
v_and_b32 v199,s42,v199
M v[152:155],a[244:247],a[216:219],v[152:155]
v_fmac_f32 v193,s43,v197
v_fmac_f32 v203,4.0,v195
M v[156:159],a[244:247],v[216:219],v[156:159]
buffer_load_dwordx4 a[244:247],v250,s[20:23],s47 offen offset:1024 sc1
M v[156:159],a[240:243],a[216:219],v[156:159]
v_fma_f32 v235,-4.0,v197,v201
v_fmac_f32 v193,s45,v201
M v[156:159],a[232:235],a[228:231],v[156:159]
s_waitcnt vmcnt(13)
buffer_load_dwordx4 a[240:243],v250,s[20:23],s47 offen offset:2048 sc1
M v[160:163],v[220:223],a[192:195],v[160:163]
s_waitcnt vmcnt(13)
s_add_u32 s48,s76,15360
v_fmac_f32 v203,s41,v199
v_sub_f32 v201,v201,v197
M v[160:163],a[196:199],a[208:211],v[160:163]
s_waitcnt vmcnt(12)
v_fma_f32 v197,-4.0,v195,v199
v_sub_f32 v199,v199,v195
M v[160:163],a[200:203],a[248:251],v[160:163]
v_add_f32 v195,v235,v197
v_sub_f32 v235,v235,v197
M v[164:167],a[200:203],a[212:215],v[164:167]
buffer_load_dwordx4 a[232:235],v250,s[20:23],s48 offen offset:0 sc1
M v[164:167],a[196:199],a[248:251],v[164:167]
v_fma_f32 v197,2.0,v199,v201
v_fmac_f32 v201,-2.0,v199
M v[164:167],v[220:223],a[208:211],v[164:167]
v_cvt_pk_bf16_f32 v193,v232,v193
v_cvt_pk_bf16_f32 v203,v237,v203
M v[168:171],v[220:223],a[248:251],v[168:171]
v_cvt_pk_bf16_f32 v195,v233,v195
v_cvt_pk_bf16_f32 v199,v234,v197
M v[168:171],a[196:199],a[212:215],v[168:171]
buffer_load_dwordx4 a[192:195],v250,s[20:23],s48 offen offset:1024 sc1
M v[168:171],a[200:203],a[236:239],v[168:171]
v_cvt_pk_bf16_f32 v197,v238,v235
v_cvt_pk_bf16_f32 v201,v236,v201
M v[172:175],a[200:203],v[228:231],v[172:175]
s_waitcnt vmcnt(9)
v_lshlrev_b32 v234,16,v208
v_lshlrev_b32 v232,16,v204
M v[172:175],a[196:199],a[236:239],v[172:175]
v_lshlrev_b32 v233,16,v206
v_lshlrev_b32 v237,16,v214
M v[172:175],v[220:223],a[212:215],v[172:175]
buffer_load_dwordx4 a[208:211],v250,s[20:23],s48 offen offset:2048 sc1
M v[176:179],v[220:223],a[236:239],v[176:179]
s_waitcnt vmcnt(8)
s_add_u32 s46,s76,18432
v_lshlrev_b32 v236,16,v212
v_lshlrev_b32 v235,16,v210
M v[176:179],a[196:199],v[228:231],v[176:179]
v_fmac_f32 v232,s43,v234
v_fmac_f32 v237,4.0,v233
M v[176:179],a[200:203],a[204:207],v[176:179]
s_barrier
v_fma_f32 v238,-4.0,v234,v236
M v[180:183],a[200:203],a[228:231],v[180:183]
buffer_load_dwordx4 a[248:251],v250,s[20:23],s46 offen offset:0 sc1
M v[180:183],a[196:199],a[204:207],v[180:183]
ds_read_b128 a[212:215],v248 offset:0
v_fmac_f32 v232,s45,v236
M v[180:183],v[220:223],v[228:231],v[180:183]
ds_write2st64_b64 v247,v[192:193],v[202:203] offset0:136 offset1:153
M v[184:187],v[220:223],a[204:207],v[184:187]
s_add_u32 s28,s71,786432
ds_read_b128 a[236:239],v249 offset:0
ds_read_b128 v[228:231],v248 offset:512
M v[184:187],a[196:199],a[228:231],v[184:187]
buffer_load_dwordx2 v[192:193],v245,s[12:15],s28 offen offset:0
M v[184:187],a[200:203],a[216:219],v[184:187]
ds_write2st64_b64 v247,v[194:195],v[196:197] offset0:102 offset1:119
M v[188:191],a[200:203],v[216:219],v[188:191]
ds_read_b128 a[204:207],v249 offset:512
v_fmac_f32 v237,s41,v235
M v[188:191],a[196:199],a[216:219],v[188:191]
buffer_load_dwordx2 v[202:203],v245,s[16:19],s28 offen offset:1536
M v[188:191],v[220:223],a[228:231],v[188:191]
s_waitcnt lgkmcnt(5)
v_sub_f32 v236,v236,v234
v_fma_f32 v234,-4.0,v233,v235
M a[0:3],v[224:227],a[212:215],a[0:3]
s_waitcnt vmcnt(10) lgkmcnt(3)
ds_read_b128 a[200:203],v248 offset:1024
v_sub_f32 v235,v235,v233
M a[0:3],a[224:227],a[236:239],a[0:3]
s_waitcnt vmcnt(9) lgkmcnt(3)
ds_read_b128 v[216:219],v249 offset:1024
v_add_f32 v233,v238,v234
M a[0:3],a[220:223],v[228:231],a[0:3]
s_waitcnt lgkmcnt(2)
buffer_load_dwordx2 v[194:195],v245,s[8:11],s28 offen offset:0
M a[4:7],a[220:223],a[204:207],a[4:7]
v_sub_f32 v238,v238,v234
v_fma_f32 v234,2.0,v235,v236
M a[4:7],a[224:227],v[228:231],a[4:7]
v_fmac_f32 v236,-2.0,v235
v_and_b32 v208,s42,v208
M a[4:7],v[224:227],a[236:239],a[4:7]
v_and_b32 v204,s42,v204
v_and_b32 v206,s42,v206
M a[8:11],v[224:227],v[228:231],a[8:11]
buffer_load_dwordx2 v[196:197],v245,s[8:11],s28 offen offset:384
M a[8:11],a[224:227],a[204:207],a[8:11]
s_waitcnt lgkmcnt(1)
ds_read_b128 a[196:199],v248 offset:1536
ds_read_b128 a[216:219],v249 offset:1536
M a[8:11],a[220:223],a[200:203],a[8:11]
s_waitcnt lgkmcnt(2)
v_and_b32 v214,s42,v214
v_and_b32 v212,s42,v212
M a[12:15],a[220:223],v[216:219],a[12:15]
v_and_b32 v210,s42,v210
v_fmac_f32 v204,s43,v208
M a[12:15],a[224:227],a[200:203],a[12:15]
v_fmac_f32 v214,4.0,v206
v_fma_f32 v235,-4.0,v208,v212
M a[12:15],v[224:227],a[204:207],a[12:15]
v_fmac_f32 v204,s45,v212
v_fmac_f32 v214,s41,v210
M a[16:19],v[224:227],a[200:203],a[16:19]
ds_read_b128 a[228:231],v249 offset:2048
v_sub_f32 v212,v212,v208
M a[16:19],a[224:227],v[216:219],a[16:19]
s_waitcnt lgkmcnt(2)
ds_read_b128 v[220:223],v248 offset:2048
v_fma_f32 v208,-4.0,v206,v210
M a[16:19],a[220:223],a[196:199],a[16:19]
s_waitcnt lgkmcnt(2)
v_sub_f32 v210,v210,v206
v_add_f32 v206,v235,v208
M a[20:23],a[220:223],a[216:219],a[20:23]
v_sub_f32 v235,v235,v208
v_fma_f32 v208,2.0,v210,v212
M a[20:23],a[224:227],a[196:199],a[20:23]
v_fmac_f32 v212,-2.0,v210
v_cvt_pk_bf16_f32 v204,v232,v204
M a[20:23],v[224:227],v[216:219],a[20:23]
v_cvt_pk_bf16_f32 v214,v237,v214
v_cvt_pk_bf16_f32 v206,v233,v206
M a[24:27],v[224:227],a[196:199],a[24:27]
v_cvt_pk_bf16_f32 v210,v234,v208
v_cvt_pk_bf16_f32 v208,v238,v235
M a[24:27],a[224:227],a[216:219],a[24:27]
s_waitcnt lgkmcnt(1)
v_cvt_pk_bf16_f32 v212,v236,v212
v_lshlrev_b32 v234,16,v209
M a[24:27],a[220:223],a[228:231],a[24:27]
s_waitcnt lgkmcnt(0)
v_lshlrev_b32 v232,16,v205
v_lshlrev_b32 v233,16,v207
M a[28:31],a[220:223],v[220:223],a[28:31]
buffer_load_dwordx4 a[220:223],v250,s[20:23],s46 offen offset:1024 sc1
M a[28:31],a[224:227],a[228:231],a[28:31]
v_lshlrev_b32 v237,16,v215
v_lshlrev_b32 v236,16,v213
M a[28:31],v[224:227],a[216:219],a[28:31]
s_waitcnt vmcnt(11)
buffer_load_dwordx4 a[224:227],v250,s[20:23],s46 offen offset:2048 sc1
M a[32:35],a[252:255],a[212:215],a[32:35]
s_waitcnt vmcnt(11)
s_add_u32 s47,s76,21504
v_lshlrev_b32 v235,16,v211
v_fmac_f32 v232,s43,v234
M a[32:35],a[244:247],a[236:239],a[32:35]
s_waitcnt vmcnt(10)
v_fmac_f32 v237,4.0,v233
v_fma_f32 v238,-4.0,v234,v236
M a[32:35],a[240:243],v[228:231],a[32:35]
v_fmac_f32 v232,s45,v236
v_fmac_f32 v237,s41,v235
M a[36:39],a[240:243],a[204:207],a[36:39]
buffer_load_dwordx4 v[224:227],v250,s[20:23],s47 offen offset:0 sc1
M a[36:39],a[244:247],v[228:231],a[36:39]
v_sub_f32 v236,v236,v234
v_fma_f32 v234,-4.0,v233,v235
M a[36:39],a[252:255],a[236:239],a[36:39]
v_sub_f32 v235,v235,v233
v_add_f32 v233,v238,v234
M a[40:43],a[252:255],v[228:231],a[40:43]
v_sub_f32 v238,v238,v234
v_fma_f32 v234,2.0,v235,v236
M a[40:43],a[244:247],a[204:207],a[40:43]
v_fmac_f32 v236,-2.0,v235
v_and_b32 v209,s42,v209
M a[40:43],a[240:243],a[200:203],a[40:43]
v_and_b32 v205,s42,v205
v_and_b32 v207,s42,v207
M a[44:47],a[240:243],v[216:219],a[44:47]
v_and_b32 v215,s42,v215
v_and_b32 v213,s42,v213
M a[44:47],a[244:247],a[200:203],a[44:47]
v_and_b32 v211,s42,v211
v_fmac_f32 v205,s43,v209
M a[44:47],a[252:255],a[204:207],a[44:47]
v_fmac_f32 v215,4.0,v207
v_fma_f32 v235,-4.0,v209,v213
M a[48:51],a[252:255],a[200:203],a[48:51]
v_fmac_f32 v205,s45,v213
v_fmac_f32 v215,s41,v211
M a[48:51],a[244:247],v[216:219],a[48:51]
v_sub_f32 v213,v213,v209
v_fma_f32 v209,-4.0,v207,v211
M a[48:51],a[240:243],a[196:199],a[48:51]
v_sub_f32 v211,v211,v207
v_add_f32 v207,v235,v209
M a[52:55],a[240:243],a[216:219],a[52:55]
v_sub_f32 v235,v235,v209
v_fma_f32 v209,2.0,v211,v213
M a[52:55],a[244:247],a[196:199],a[52:55]
v_fmac_f32 v213,-2.0,v211
v_cvt_pk_bf16_f32 v205,v232,v205
M a[52:55],a[252:255],v[216:219],a[52:55]
v_cvt_pk_bf16_f32 v215,v237,v215
v_cvt_pk_bf16_f32 v207,v233,v207
M a[56:59],a[252:255],a[196:199],a[56:59]
v_cvt_pk_bf16_f32 v211,v234,v209
v_cvt_pk_bf16_f32 v209,v238,v235
M a[56:59],a[244:247],a[216:219],a[56:59]
v_cvt_pk_bf16_f32 v213,v236,v213
v_fmac_f32 v239,s43,v241
M a[56:59],a[240:243],a[228:231],a[56:59]
v_fmac_f32 v244,4.0,v240
v_fma_f32 v232,-4.0,v241,v243
M a[60:63],a[240:243],v[220:223],a[60:63]
buffer_load_dwordx4 a[240:243],v250,s[20:23],s47 offen offset:1024 sc1
M a[60:63],a[244:247],a[228:231],a[60:63]
v_fmac_f32 v239,s45,v243
v_fmac_f32 v244,s41,v242
M a[60:63],a[252:255],a[216:219],a[60:63]
s_waitcnt vmcnt(11)
buffer_load_dwordx4 a[244:247],v250,s[20:23],s47 offen offset:2048 sc1
M a[64:67],a[232:235],a[212:215],a[64:67]
s_waitcnt vmcnt(11)
s_add_u32 s48,s76,24576
v_sub_f32 v243,v243,v241
v_fma_f32 v241,-4.0,v240,v242
M a[64:67],a[192:195],a[236:239],a[64:67]
s_waitcnt vmcnt(10)
v_sub_f32 v242,v242,v240
v_add_f32 v240,v232,v241
M a[64:67],a[208:211],v[228:231],a[64:67]
v_sub_f32 v232,v232,v241
v_fma_f32 v241,2.0,v242,v243
M a[68:71],a[208:211],a[204:207],a[68:71]
buffer_load_dwordx4 a[252:255],v250,s[20:23],s48 offen offset:0 sc1
M a[68:71],a[192:195],v[228:231],a[68:71]
v_fmac_f32 v243,-2.0,v242
v_cvt_pk_bf16_f32 v233,v239,v244
M a[68:71],a[232:235],a[236:239],a[68:71]
v_cvt_pk_bf16_f32 v234,v240,v232
v_cvt_pk_bf16_f32 v235,v241,v243
M a[72:75],a[232:235],v[228:231],a[72:75]
v_add_u32 v232,69632,v252
M a[72:75],a[192:195],a[204:207],a[72:75]
buffer_load_dwordx4 a[212:215],v250,s[20:23],s48 offen offset:1024 sc1
M a[72:75],a[208:211],a[200:203],a[72:75]
ds_write_b16 v232,v233 offset:0
M a[76:79],a[208:211],v[216:219],a[76:79]
ds_write_b16_d16_hi v232,v233 offset:8704
M a[76:79],a[192:195],a[200:203],a[76:79]
ds_write_b16 v252,v234 offset:52224
M a[76:79],a[232:235],a[204:207],a[76:79]
buffer_load_dwordx4 a[236:239],v250,s[20:23],s48 offen offset:2048 sc1
M a[80:83],a[232:235],a[200:203],a[80:83]
s_add_u32 s46,s76,27648
ds_write_b16_d16_hi v252,v234 offset:60928
M a[80:83],a[192:195],v[216:219],a[80:83]
M a[80:83],a[208:211],a[196:199],a[80:83]
M a[84:87],a[208:211],a[216:219],a[84:87]
buffer_load_dwordx4 v[228:231],v250,s[20:23],s46 offen offset:0 sc1
M a[84:87],a[192:195],a[196:199],a[84:87]
ds_read_b128 a[204:207],v248 offset:8704
M a[84:87],a[232:235],v[216:219],a[84:87]
ds_read_b128 a[200:203],v249 offset:8704
M a[88:91],a[232:235],a[196:199],a[88:91]
ds_read_b128 v[216:219],v248 offset:9216
M a[88:91],a[192:195],a[216:219],a[88:91]
ds_read_b128 a[196:199],v249 offset:9216
M a[88:91],a[208:211],a[228:231],a[88:91]
M a[92:95],a[208:211],v[220:223],a[92:95]
M a[92:95],a[192:195],a[228:231],a[92:95]
M a[92:95],a[232:235],a[216:219],a[92:95]
s_waitcnt vmcnt(13) lgkmcnt(3)
M a[96:99],a[248:251],a[204:207],a[96:99]
s_waitcnt vmcnt(8) lgkmcnt(2)
ds_read_b128 a[208:211],v248 offset:9728
M a[96:99],a[220:223],a[200:203],a[96:99]
s_waitcnt vmcnt(7) lgkmcnt(2)
ds_read_b128 v[220:223],v249 offset:9728
M a[96:99],a[224:227],v[216:219],a[96:99]
s_waitcnt lgkmcnt(2)
M a[100:103],a[224:227],a[196:199],a[100:103]
M a[100:103],a[220:223],v[216:219],a[100:103]
M a[100:103],a[248:251],a[200:203],a[100:103]
M a[104:107],a[248:251],v[216:219],a[104:107]
ds_read_b128 a[192:195],v248 offset:10240
M a[104:107],a[220:223],a[196:199],a[104:107]
s_waitcnt lgkmcnt(2)
ds_read_b128 a[228:231],v249 offset:10240
M a[104:107],a[224:227],a[208:211],a[104:107]
s_waitcnt lgkmcnt(2)
M a[108:111],a[224:227],v[220:223],a[108:111]
M a[108:111],a[220:223],a[208:211],a[108:111]
M a[108:111],a[248:251],a[196:199],a[108:111]
M a[112:115],a[248:251],a[208:211],a[112:115]
ds_read_b128 a[216:219],v249 offset:10752
M a[112:115],a[220:223],v[220:223],a[112:115]
s_waitcnt lgkmcnt(2)
ds_read_b128 a[232:235],v248 offset:10752
M a[112:115],a[224:227],a[192:195],a[112:115]
s_waitcnt lgkmcnt(2)
M a[116:119],a[224:227],a[228:231],a[116:119]
M a[116:119],a[220:223],a[192:195],a[116:119]
M a[116:119],a[248:251],v[220:223],a[116:119]
M a[120:123],a[248:251],a[192:195],a[120:123]
M a[120:123],a[220:223],a[228:231],a[120:123]
s_waitcnt lgkmcnt(1)
M a[120:123],a[224:227],a[216:219],a[120:123]
s_waitcnt lgkmcnt(0)
M a[124:127],a[224:227],a[232:235],a[124:127]
buffer_load_dwordx4 a[224:227],v250,s[20:23],s46 offen offset:1024 sc1
M a[124:127],a[220:223],a[216:219],a[124:127]
M a[124:127],a[248:251],a[228:231],a[124:127]
s_waitcnt vmcnt(7)
buffer_load_dwordx4 a[220:223],v250,s[20:23],s46 offen offset:2048 sc1
M a[128:131],v[224:227],a[204:207],a[128:131]
s_waitcnt vmcnt(7)
s_add_u32 s47,s76,30720
M a[128:131],a[240:243],a[200:203],a[128:131]
s_waitcnt vmcnt(6)
M a[128:131],a[244:247],v[216:219],a[128:131]
M a[132:135],a[244:247],a[196:199],a[132:135]
buffer_load_dwordx4 a[248:251],v250,s[20:23],s47 offen offset:0 sc1
M a[132:135],a[240:243],v[216:219],a[132:135]
M a[132:135],v[224:227],a[200:203],a[132:135]
M a[136:139],v[224:227],v[216:219],a[136:139]
s_barrier
ds_write_b16 v252,v235 offset:17408
M a[136:139],a[240:243],a[196:199],a[136:139]
ds_write_b16_d16_hi v252,v235 offset:26112
M a[136:139],a[244:247],a[208:211],a[136:139]
ds_write2st64_b64 v247,v[198:199],v[200:201] offset0:34 offset1:51
M a[140:143],a[244:247],v[220:223],a[140:143]
buffer_load_dwordx2 v[198:199],v245,s[8:11],s28 offen offset:768
M a[140:143],a[240:243],a[208:211],a[140:143]
M a[140:143],v[224:227],a[196:199],a[140:143]
buffer_load_dwordx2 v[200:201],v245,s[8:11],s28 offen offset:1152
M a[144:147],v[224:227],a[208:211],a[144:147]
M a[144:147],a[240:243],v[220:223],a[144:147]
M a[144:147],a[244:247],a[192:195],a[144:147]
ds_write2st64_b64 v247,v[204:205],v[214:215] offset0:137 offset1:154
M a[148:151],a[244:247],a[228:231],a[148:151]
s_add_u32 s28,s71,1179648
buffer_load_dwordx2 v[204:205],v245,s[12:15],s28 offen offset:0
M a[148:151],a[240:243],a[192:195],a[148:151]
M a[148:151],v[224:227],v[220:223],a[148:151]
ds_write2st64_b64 v247,v[206:207],v[208:209] offset0:103 offset1:120
M a[152:155],v[224:227],a[192:195],a[152:155]
buffer_load_dwordx2 v[214:215],v245,s[16:19],s28 offen offset:1536
M a[152:155],a[240:243],a[228:231],a[152:155]
M a[152:155],a[244:247],a[216:219],a[152:155]
ds_write2st64_b64 v247,v[210:211],v[212:213] offset0:35 offset1:52
M a[156:159],a[244:247],a[232:235],a[156:159]
buffer_load_dwordx4 a[244:247],v250,s[20:23],s47 offen offset:1024 sc1
M a[156:159],a[240:243],a[216:219],a[156:159]
M a[156:159],v[224:227],a[228:231],a[156:159]
s_waitcnt vmcnt(11)
M a[160:163],a[252:255],a[204:207],a[160:163]
s_waitcnt vmcnt(10)
M a[160:163],a[212:215],a[200:203],a[160:163]
s_waitcnt vmcnt(9)
buffer_load_dwordx4 a[240:243],v250,s[20:23],s47 offen offset:2048 sc1
M a[160:163],a[236:239],v[216:219],a[160:163]
s_add_u32 s48,s76,33792
M a[164:167],a[236:239],a[196:199],a[164:167]
M a[164:167],a[212:215],v[216:219],a[164:167]
M a[164:167],a[252:255],a[200:203],a[164:167]
buffer_load_dwordx4 v[224:227],v250,s[20:23],s48 offen offset:0 sc1
M a[168:171],a[252:255],v[216:219],a[168:171]
M a[168:171],a[212:215],a[196:199],a[168:171]
M a[168:171],a[236:239],a[208:211],a[168:171]
M a[172:175],a[236:239],v[220:223],a[172:175]
buffer_load_dwordx4 a[204:207],v250,s[20:23],s48 offen offset:1024 sc1
M a[172:175],a[212:215],a[208:211],a[172:175]
M a[172:175],a[252:255],a[196:199],a[172:175]
M a[176:179],a[252:255],a[208:211],a[176:179]
M a[176:179],a[212:215],v[220:223],a[176:179]
buffer_load_dwordx4 a[200:203],v250,s[20:23],s48 offen offset:2048 sc1
M a[176:179],a[236:239],a[192:195],a[176:179]
s_add_u32 s46,s76,36864
M a[180:183],a[236:239],a[228:231],a[180:183]
M a[180:183],a[212:215],a[192:195],a[180:183]
ds_read_b128 a[196:199],v248 offset:17408
M a[180:183],a[252:255],v[220:223],a[180:183]
buffer_load_dwordx4 v[216:219],v250,s[20:23],s46 offen offset:0 sc1
M a[184:187],a[252:255],a[192:195],a[184:187]
ds_read_b128 a[208:211],v249 offset:17408
ds_read_b128 v[220:223],v248 offset:17920
M a[184:187],a[212:215],a[228:231],a[184:187]
ds_read_b128 a[192:195],v249 offset:17920
v_lshlrev_b32 v234,16,v196
M a[184:187],a[236:239],a[216:219],a[184:187]
v_lshlrev_b32 v232,16,v192
v_lshlrev_b32 v233,16,v194
M a[188:191],a[236:239],a[232:235],a[188:191]
buffer_load_dwordx2 v[206:207],v245,s[8:11],s28 offen offset:0
M a[188:191],a[212:215],a[216:219],a[188:191]
s_waitcnt vmcnt(9)
v_lshlrev_b32 v237,16,v202
v_lshlrev_b32 v236,16,v200
M a[188:191],a[252:255],a[228:231],a[188:191]
s_waitcnt lgkmcnt(3)
v_lshlrev_b32 v235,16,v198
v_fmac_f32 v232,s43,v234
M v[0:3],v[228:231],a[196:199],v[0:3]
s_waitcnt lgkmcnt(2)
ds_read_b128 a[232:235],v248 offset:18432
v_fmac_f32 v237,4.0,v233
M v[0:3],a[224:227],a[208:211],v[0:3]
s_waitcnt lgkmcnt(2)
buffer_load_dwordx2 v[208:209],v245,s[8:11],s28 offen offset:384
M v[0:3],a[220:223],v[220:223],v[0:3]
s_waitcnt lgkmcnt(1)
ds_read_b128 a[236:239],v249 offset:18432
v_fma_f32 v238,-4.0,v234,v236
M v[4:7],a[220:223],a[192:195],v[4:7]
v_fmac_f32 v232,s45,v236
v_fmac_f32 v237,s41,v235
M v[4:7],a[224:227],v[220:223],v[4:7]
v_sub_f32 v236,v236,v234
v_fma_f32 v234,-4.0,v233,v235
M v[4:7],v[228:231],a[208:211],v[4:7]
buffer_load_dwordx2 v[210:211],v245,s[8:11],s28 offen offset:768
M v[8:11],v[228:231],v[220:223],v[8:11]
ds_read_b128 a[212:215],v248 offset:18944
v_sub_f32 v235,v235,v233
M v[8:11],a[224:227],a[192:195],v[8:11]
s_waitcnt lgkmcnt(2)
ds_read_b128 a[216:219],v249 offset:18944
v_add_f32 v233,v238,v234
M v[8:11],a[220:223],a[232:235],v[8:11]
s_waitcnt lgkmcnt(2)
v_sub_f32 v238,v238,v234
v_fma_f32 v234,2.0,v235,v236
M v[12:15],a[220:223],a[236:239],v[12:15]
buffer_load_dwordx2 v[212:213],v245,s[8:11],s28 offen offset:1152
M v[12:15],a[224:227],a[232:235],v[12:15]
s_add_u32 s29,s66,6291456
v_fmac_f32 v236,-2.0,v235
v_and_b32 v196,s42,v196
M v[12:15],v[228:231],a[192:195],v[12:15]
v_and_b32 v192,s42,v192
v_and_b32 v194,s42,v194
M v[16:19],v[228:231],a[232:235],v[16:19]
ds_read_b128 a[228:231],v249 offset:19456
v_and_b32 v202,s42,v202
M v[16:19],a[224:227],a[236:239],v[16:19]
s_waitcnt lgkmcnt(2)
buffer_load_short_d16_hi v239,v246,s[12:15],s29 offen offset:0
M v[16:19],a[220:223],a[212:215],v[16:19]
s_waitcnt lgkmcnt(1)
ds_read_b128 a[252:255],v248 offset:19456
v_and_b32 v200,s42,v200
M v[20:23],a[220:223],a[216:219],v[20:23]
buffer_load_short_d16_hi v240,v246,s[8:11],s29 offen offset:0
M v[20:23],a[224:227],a[212:215],v[20:23]
v_and_b32 v198,s42,v198
v_fmac_f32 v192,s43,v196
M v[20:23],v[228:231],a[236:239],v[20:23]
buffer_load_short_d16_hi v241,v246,s[8:11],s29 offen offset:384
M v[24:27],v[228:231],a[212:215],v[24:27]
v_fmac_f32 v202,4.0,v194
v_fma_f32 v235,-4.0,v196,v200
M v[24:27],a[224:227],a[216:219],v[24:27]
s_waitcnt lgkmcnt(1)
buffer_load_short_d16_hi v242,v246,s[8:11],s29 offen offset:768
M v[24:27],a[220:223],a[228:231],v[24:27]
s_waitcnt lgkmcnt(0)
v_fmac_f32 v192,s45,v200
v_fmac_f32 v202,s41,v198
M v[28:31],a[220:223],a[252:255],v[28:31]
buffer_load_dwordx4 a[220:223],v250,s[20:23],s46 offen offset:1024 sc1
M v[28:31],a[224:227],a[228:231],v[28:31]
v_sub_f32 v200,v200,v196
v_fma_f32 v196,-4.0,v194,v198
M v[28:31],v[228:231],a[216:219],v[28:31]
v_sub_f32 v198,v198,v194
v_add_f32 v194,v235,v196
M v[32:35],a[248:251],a[196:199],v[32:35]
s_waitcnt vmcnt(14)
v_sub_f32 v235,v235,v196
v_fma_f32 v196,2.0,v198,v200
M v[32:35],a[244:247],a[208:211],v[32:35]
s_waitcnt vmcnt(13)
buffer_load_dwordx4 a[224:227],v250,s[20:23],s46 offen offset:2048 sc1
M v[32:35],a[240:243],v[220:223],v[32:35]
s_add_u32 s47,s76,39936
v_fmac_f32 v200,-2.0,v198
v_cvt_pk_bf16_f32 v192,v232,v192
M v[36:39],a[240:243],a[192:195],v[36:39]
v_cvt_pk_bf16_f32 v202,v237,v202
v_cvt_pk_bf16_f32 v194,v233,v194
M v[36:39],a[244:247],v[220:223],v[36:39]
v_cvt_pk_bf16_f32 v198,v234,v196
v_cvt_pk_bf16_f32 v196,v238,v235
M v[36:39],a[248:251],a[208:211],v[36:39]
buffer_load_dwordx4 v[228:231],v250,s[20:23],s47 offen offset:0 sc1
M v[40:43],a[248:251],v[220:223],v[40:43]
v_cvt_pk_bf16_f32 v200,v236,v200
v_lshlrev_b32 v234,16,v197
M v[40:43],a[244:247],a[192:195],v[40:43]
v_lshlrev_b32 v232,16,v193
v_lshlrev_b32 v233,16,v195
M v[40:43],a[240:243],a[232:235],v[40:43]
v_lshlrev_b32 v237,16,v203
v_lshlrev_b32 v236,16,v201
M v[44:47],a[240:243],a[236:239],v[44:47]
buffer_load_short_d16_hi v243,v246,s[8:11],s29 offen offset:1152
M v[44:47],a[244:247],a[232:235],v[44:47]
v_lshlrev_b32 v235,16,v199
v_fmac_f32 v232,s43,v234
M v[44:47],a[248:251],a[192:195],v[44:47]
buffer_load_short_d16_hi v244,v246,s[16:19],s29 offen offset:1536
M v[48:51],a[248:251],a[232:235],v[48:51]
v_fmac_f32 v237,4.0,v233
v_fma_f32 v238,-4.0,v234,v236
M v[48:51],a[244:247],a[236:239],v[48:51]
v_fmac_f32 v232,s45,v236
v_fmac_f32 v237,s41,v235
M v[48:51],a[240:243],a[212:215],v[48:51]
v_sub_f32 v236,v236,v234
v_fma_f32 v234,-4.0,v233,v235
M v[52:55],a[240:243],a[216:219],v[52:55]
v_sub_f32 v235,v235,v233
v_add_f32 v233,v238,v234
M v[52:55],a[244:247],a[212:215],v[52:55]
v_sub_f32 v238,v238,v234
v_fma_f32 v234,2.0,v235,v236
M v[52:55],a[248:251],a[236:239],v[52:55]
v_fmac_f32 v236,-2.0,v235
v_and_b32 v197,s42,v197
M v[56:59],a[248:251],a[212:215],v[56:59]
v_and_b32 v193,s42,v193
v_and_b32 v195,s42,v195
M v[56:59],a[244:247],a[216:219],v[56:59]
v_and_b32 v203,s42,v203
v_and_b32 v201,s42,v201
M v[56:59],a[240:243],a[228:231],v[56:59]
v_and_b32 v199,s42,v199
v_fmac_f32 v193,s43,v197
M v[60:63],a[240:243],a[252:255],v[60:63]
buffer_load_dwordx4 a[240:243],v250,s[20:23],s47 offen offset:1024 sc1
M v[60:63],a[244:247],a[228:231],v[60:63]
v_fmac_f32 v203,4.0,v195
v_fma_f32 v235,-4.0,v197,v201
M v[60:63],a[248:251],a[216:219],v[60:63]
s_waitcnt vmcnt(17)
buffer_load_dwordx4 a[244:247],v250,s[20:23],s47 offen offset:2048 sc1
M v[64:67],v[224:227],a[196:199],v[64:67]
s_waitcnt vmcnt(17)
s_add_u32 s48,s76,43008
v_fmac_f32 v193,s45,v201
v_fmac_f32 v203,s41,v199
M v[64:67],a[204:207],a[208:211],v[64:67]
s_waitcnt vmcnt(16)
v_sub_f32 v201,v201,v197
v_fma_f32 v197,-4.0,v195,v199
M v[64:67],a[200:203],v[220:223],v[64:67]
v_sub_f32 v199,v199,v195
v_add_f32 v195,v235,v197
M v[68:71],a[200:203],a[192:195],v[68:71]
buffer_load_dwordx4 a[248:251],v250,s[20:23],s48 offen offset:0 sc1
M v[68:71],a[204:207],v[220:223],v[68:71]
v_sub_f32 v235,v235,v197
v_fma_f32 v197,2.0,v199,v201
M v[68:71],v[224:227],a[208:211],v[68:71]
v_fmac_f32 v201,-2.0,v199
v_cvt_pk_bf16_f32 v193,v232,v193
M v[72:75],v[224:227],v[220:223],v[72:75]
v_cvt_pk_bf16_f32 v203,v237,v203
v_cvt_pk_bf16_f32 v195,v233,v195
M v[72:75],a[204:207],a[192:195],v[72:75]
buffer_load_dwordx4 a[196:199],v250,s[20:23],s48 offen offset:1024 sc1
M v[72:75],a[200:203],a[232:235],v[72:75]
v_cvt_pk_bf16_f32 v199,v234,v197
v_cvt_pk_bf16_f32 v197,v238,v235
M v[76:79],a[200:203],a[236:239],v[76:79]
s_waitcnt vmcnt(15)
v_cvt_pk_bf16_f32 v201,v236,v201
v_lshlrev_b32 v234,16,v208
M v[76:79],a[204:207],a[232:235],v[76:79]
v_lshlrev_b32 v232,16,v204
v_lshlrev_b32 v233,16,v206
M v[76:79],v[224:227],a[192:195],v[76:79]
buffer_load_dwordx4 a[208:211],v250,s[20:23],s48 offen offset:2048 sc1
M v[80:83],v[224:227],a[232:235],v[80:83]
s_waitcnt vmcnt(14)
s_add_u32 s46,s77,9216
v_lshlrev_b32 v237,16,v214
v_lshlrev_b32 v236,16,v212
M v[80:83],a[204:207],a[236:239],v[80:83]
v_lshlrev_b32 v235,16,v210
v_fmac_f32 v232,s43,v234
M v[80:83],a[200:203],a[212:215],v[80:83]
ds_write2st64_b64 v247,v[192:193],v[202:203] offset0:138 offset1:155
M v[84:87],a[200:203],a[216:219],v[84:87]
s_add_u32 s28,s66,6291456
buffer_load_dwordx4 v[220:223],v250,s[20:23],s46 offen offset:0 sc1
M v[84:87],a[204:207],a[212:215],v[84:87]
ds_read_b128 a[192:195],v248 offset:26112
v_fmac_f32 v237,4.0,v233
M v[84:87],v[224:227],a[236:239],v[84:87]
ds_write2st64_b64 v247,v[194:195],v[196:197] offset0:104 offset1:121
M v[88:91],v[224:227],a[212:215],v[88:91]
buffer_load_dwordx2 v[192:193],v245,s[12:15],s28 offen offset:0
M v[88:91],a[204:207],a[216:219],v[88:91]
ds_read_b128 a[232:235],v249 offset:26112
ds_read_b128 a[236:239],v248 offset:26624
M v[88:91],a[200:203],a[228:231],v[88:91]
ds_write2st64_b64 v247,v[198:199],v[200:201] offset0:36 offset1:53
M v[92:95],a[200:203],a[252:255],v[92:95]
buffer_load_dwordx2 v[202:203],v245,s[16:19],s28 offen offset:1536
M v[92:95],a[204:207],a[228:231],v[92:95]
ds_read_b128 a[212:215],v249 offset:26624
v_fma_f32 v238,-4.0,v234,v236
M v[92:95],v[224:227],a[216:219],v[92:95]
s_waitcnt lgkmcnt(5)
v_fmac_f32 v232,s45,v236
v_fmac_f32 v237,s41,v235
M v[96:99],v[216:219],a[192:195],v[96:99]
s_waitcnt vmcnt(12) lgkmcnt(3)
ds_read_b128 a[200:203],v248 offset:27136
v_sub_f32 v236,v236,v234
M v[96:99],a[220:223],a[232:235],v[96:99]
s_waitcnt vmcnt(11) lgkmcnt(3)
buffer_load_dwordx2 v[194:195],v245,s[8:11],s28 offen offset:0
M v[96:99],a[224:227],a[236:239],v[96:99]
s_waitcnt lgkmcnt(1)
ds_read_b128 a[252:255],v249 offset:27136
v_fma_f32 v234,-4.0,v233,v235
M v[100:103],a[224:227],a[212:215],v[100:103]
v_sub_f32 v235,v235,v233
v_add_f32 v233,v238,v234
M v[100:103],a[220:223],a[236:239],v[100:103]
v_sub_f32 v238,v238,v234
v_fma_f32 v234,2.0,v235,v236
M v[100:103],v[216:219],a[232:235],v[100:103]
buffer_load_dwordx2 v[196:197],v245,s[8:11],s28 offen offset:384
M v[104:107],v[216:219],a[236:239],v[104:107]
ds_read_b128 a[204:207],v248 offset:27648
v_fmac_f32 v236,-2.0,v235
M v[104:107],a[220:223],a[212:215],v[104:107]
s_waitcnt lgkmcnt(2)
ds_read_b128 a[228:231],v249 offset:27648
v_and_b32 v208,s42,v208
M v[104:107],a[224:227],a[200:203],v[104:107]
s_waitcnt lgkmcnt(2)
v_and_b32 v204,s42,v204
v_and_b32 v206,s42,v206
M v[108:111],a[224:227],a[252:255],v[108:111]
buffer_load_dwordx2 v[198:199],v245,s[8:11],s28 offen offset:768
M v[108:111],a[220:223],a[200:203],v[108:111]
v_and_b32 v214,s42,v214
v_and_b32 v212,s42,v212
M v[108:111],v[216:219],a[212:215],v[108:111]
v_and_b32 v210,s42,v210
v_fmac_f32 v204,s43,v208
M v[112:115],v[216:219],a[200:203],v[112:115]
ds_read_b128 a[216:219],v249 offset:28160
v_fmac_f32 v214,4.0,v206
M v[112:115],a[220:223],a[252:255],v[112:115]
s_waitcnt lgkmcnt(2)
buffer_load_dwordx2 v[200:201],v245,s[8:11],s28 offen offset:1152
M v[112:115],a[224:227],a[204:207],v[112:115]
s_waitcnt lgkmcnt(1)
ds_read_b128 v[224:227],v248 offset:28160
v_fma_f32 v235,-4.0,v208,v212
M v[116:119],a[224:227],a[228:231],v[116:119]
v_fmac_f32 v204,s45,v212
v_fmac_f32 v214,s41,v210
M v[116:119],a[220:223],a[204:207],v[116:119]
v_sub_f32 v212,v212,v208
v_fma_f32 v208,-4.0,v206,v210
M v[116:119],v[216:219],a[252:255],v[116:119]
v_sub_f32 v210,v210,v206
v_add_f32 v206,v235,v208
M v[120:123],v[216:219],a[204:207],v[120:123]
v_sub_f32 v235,v235,v208
v_fma_f32 v208,2.0,v210,v212
M v[120:123],a[220:223],a[228:231],v[120:123]
s_waitcnt lgkmcnt(1)
v_fmac_f32 v212,-2.0,v210
v_cvt_pk_bf16_f32 v204,v232,v204
M v[120:123],a[224:227],a[216:219],v[120:123]
s_waitcnt lgkmcnt(0)
v_cvt_pk_bf16_f32 v214,v237,v214
v_cvt_pk_bf16_f32 v206,v233,v206
M v[124:127],a[224:227],v[224:227],v[124:127]
buffer_load_dwordx4 a[224:227],v250,s[20:23],s46 offen offset:1024 sc1
M v[124:127],a[220:223],a[216:219],v[124:127]
v_cvt_pk_bf16_f32 v210,v234,v208
v_cvt_pk_bf16_f32 v208,v238,v235
M v[124:127],v[216:219],a[228:231],v[124:127]
s_waitcnt vmcnt(15)
buffer_load_dwordx4 a[220:223],v250,s[20:23],s46 offen offset:2048 sc1
M v[128:131],v[228:231],a[192:195],v[128:131]
s_waitcnt vmcnt(13)
s_add_u32 s46,s77,18432
v_cvt_pk_bf16_f32 v212,v236,v212
v_lshlrev_b32 v234,16,v209
M v[128:131],a[240:243],a[232:235],v[128:131]
s_waitcnt vmcnt(12)
v_lshlrev_b32 v232,16,v205
v_lshlrev_b32 v233,16,v207
M v[128:131],a[244:247],a[236:239],v[128:131]
v_lshlrev_b32 v237,16,v215
v_lshlrev_b32 v236,16,v213
M v[132:135],a[244:247],a[212:215],v[132:135]
buffer_load_dwordx4 v[216:219],v250,s[20:23],s46 offen offset:0 sc1
M v[132:135],a[240:243],a[236:239],v[132:135]
v_lshlrev_b32 v235,16,v211
v_fmac_f32 v232,s43,v234
M v[132:135],v[228:231],a[232:235],v[132:135]
v_fmac_f32 v237,4.0,v233
v_fma_f32 v238,-4.0,v234,v236
M v[136:139],v[228:231],a[236:239],v[136:139]
v_fmac_f32 v232,s45,v236
v_fmac_f32 v237,s41,v235
M v[136:139],a[240:243],a[212:215],v[136:139]
v_sub_f32 v236,v236,v234
v_fma_f32 v234,-4.0,v233,v235
M v[136:139],a[244:247],a[200:203],v[136:139]
v_sub_f32 v235,v235,v233
v_add_f32 v233,v238,v234
M v[140:143],a[244:247],a[252:255],v[140:143]
v_sub_f32 v238,v238,v234
v_fma_f32 v234,2.0,v235,v236
M v[140:143],a[240:243],a[200:203],v[140:143]
v_fmac_f32 v236,-2.0,v235
v_and_b32 v209,s42,v209
M v[140:143],v[228:231],a[212:215],v[140:143]
v_and_b32 v205,s42,v205
v_and_b32 v207,s42,v207
M v[144:147],v[228:231],a[200:203],v[144:147]
v_and_b32 v215,s42,v215
v_and_b32 v213,s42,v213
M v[144:147],a[240:243],a[252:255],v[144:147]
v_and_b32 v211,s42,v211
v_fmac_f32 v205,s43,v209
M v[144:147],a[244:247],a[204:207],v[144:147]
v_fmac_f32 v215,4.0,v207
v_fma_f32 v235,-4.0,v209,v213
M v[148:151],a[244:247],a[228:231],v[148:151]
v_fmac_f32 v205,s45,v213
v_fmac_f32 v215,s41,v211
M v[148:151],a[240:243],a[204:207],v[148:151]
v_sub_f32 v213,v213,v209
v_fma_f32 v209,-4.0,v207,v211
M v[148:151],v[228:231],a[252:255],v[148:151]
v_sub_f32 v211,v211,v207
v_add_f32 v207,v235,v209
M v[152:155],v[228:231],a[204:207],v[152:155]
v_sub_f32 v235,v235,v209
v_fma_f32 v209,2.0,v211,v213
M v[152:155],a[240:243],a[228:231],v[152:155]
v_fmac_f32 v213,-2.0,v211
v_cvt_pk_bf16_f32 v205,v232,v205
M v[152:155],a[244:247],a[216:219],v[152:155]
v_cvt_pk_bf16_f32 v215,v237,v215
v_cvt_pk_bf16_f32 v207,v233,v207
M v[156:159],a[244:247],v[224:227],v[156:159]
buffer_load_dwordx4 a[244:247],v250,s[20:23],s46 offen offset:1024 sc1
M v[156:159],a[240:243],a[216:219],v[156:159]
v_cvt_pk_bf16_f32 v211,v234,v209
v_cvt_pk_bf16_f32 v209,v238,v235
M v[156:159],v[228:231],a[228:231],v[156:159]
s_waitcnt vmcnt(13)
buffer_load_dwordx4 a[240:243],v250,s[20:23],s46 offen offset:2048 sc1
M v[160:163],a[248:251],a[192:195],v[160:163]
s_waitcnt vmcnt(13)
s_add_u32 s46,s77,27648
v_cvt_pk_bf16_f32 v213,v236,v213
M v[160:163],a[196:199],a[232:235],v[160:163]
s_waitcnt vmcnt(12)
M v[160:163],a[208:211],a[236:239],v[160:163]
ds_write2st64_b64 v247,v[204:205],v[214:215] offset0:139 offset1:156
M v[164:167],a[208:211],a[212:215],v[164:167]
buffer_load_dwordx4 v[228:231],v250,s[20:23],s46 offen offset:0 sc1
M v[164:167],a[196:199],a[236:239],v[164:167]
M v[164:167],a[248:251],a[232:235],v[164:167]
ds_write2st64_b64 v247,v[206:207],v[208:209] offset0:105 offset1:122
M v[168:171],a[248:251],a[236:239],v[168:171]
buffer_load_dwordx4 a[192:195],v250,s[20:23],s46 offen offset:1024 sc1
M v[168:171],a[196:199],a[212:215],v[168:171]
M v[168:171],a[208:211],a[200:203],v[168:171]
ds_write2st64_b64 v247,v[210:211],v[212:213] offset0:37 offset1:54
M v[172:175],a[208:211],a[252:255],v[172:175]
buffer_load_dwordx4 a[232:235],v250,s[20:23],s46 offen offset:2048 sc1
M v[172:175],a[196:199],a[200:203],v[172:175]
s_add_u32 s46,s77,36864
M v[172:175],a[248:251],a[212:215],v[172:175]
M v[176:179],a[248:251],a[200:203],v[176:179]
M v[176:179],a[196:199],a[252:255],v[176:179]
buffer_load_dwordx4 a[236:239],v250,s[20:23],s46 offen offset:0 sc1
M v[176:179],a[208:211],a[204:207],v[176:179]
s_waitcnt lgkmcnt(0)
s_barrier
M v[180:183],a[208:211],a[228:231],v[180:183]
s_waitcnt vmcnt(11)
v_lshlrev_b32 v234,16,v196
v_lshlrev_b32 v232,16,v192
M v[180:183],a[196:199],a[204:207],v[180:183]
ds_read_b128 a[212:215],v248 offset:34816
v_lshlrev_b32 v233,16,v194
M v[180:183],a[248:251],a[252:255],v[180:183]
ds_read_b128 a[200:203],v249 offset:34816
v_lshlrev_b32 v237,16,v202
M v[184:187],a[248:251],a[204:207],v[184:187]
s_waitcnt vmcnt(9)
ds_read_b128 a[252:255],v248 offset:35328
v_lshlrev_b32 v236,16,v200
M v[184:187],a[196:199],a[228:231],v[184:187]
ds_read_b128 a[204:207],v249 offset:35328
v_lshlrev_b32 v235,16,v198
M v[184:187],a[208:211],a[216:219],v[184:187]
v_fmac_f32 v232,s43,v234
v_fmac_f32 v237,4.0,v233
M v[188:191],a[208:211],v[224:227],v[188:191]
buffer_load_dwordx4 a[208:211],v250,s[20:23],s46 offen offset:1024 sc1
M v[188:191],a[196:199],a[216:219],v[188:191]
v_fma_f32 v238,-4.0,v234,v236
v_fmac_f32 v232,s45,v236
M v[188:191],a[248:251],a[228:231],v[188:191]
s_waitcnt lgkmcnt(3)
buffer_load_dwordx4 v[224:227],v250,s[20:23],s46 offen offset:2048 sc1
M a[0:3],v[220:223],a[212:215],a[0:3]
s_waitcnt vmcnt(10) lgkmcnt(2)
s_add_u32 s47,s77,12288
ds_read_b128 a[216:219],v248 offset:35840
v_fmac_f32 v237,s41,v235
M a[0:3],a[224:227],a[200:203],a[0:3]
s_waitcnt vmcnt(9) lgkmcnt(2)
ds_read_b128 a[228:231],v249 offset:35840
v_sub_f32 v236,v236,v234
M a[0:3],a[220:223],a[252:255],a[0:3]
s_waitcnt lgkmcnt(2)
v_fma_f32 v234,-4.0,v233,v235
v_sub_f32 v235,v235,v233
M a[4:7],a[220:223],a[204:207],a[4:7]
buffer_load_dwordx4 a[196:199],v250,s[20:23],s47 offen offset:0 sc1
M a[4:7],a[224:227],a[252:255],a[4:7]
v_add_f32 v233,v238,v234
v_sub_f32 v238,v238,v234
M a[4:7],v[220:223],a[200:203],a[4:7]
v_fma_f32 v234,2.0,v235,v236
v_fmac_f32 v236,-2.0,v235
M a[8:11],v[220:223],a[252:255],a[8:11]
ds_read_b128 a[248:251],v248 offset:36352
v_and_b32 v196,s42,v196
M a[8:11],a[224:227],a[204:207],a[8:11]
s_waitcnt lgkmcnt(2)
ds_read_b128 a[212:215],v249 offset:36352
v_and_b32 v192,s42,v192
M a[8:11],a[220:223],a[216:219],a[8:11]
s_waitcnt lgkmcnt(2)
v_and_b32 v194,s42,v194
v_and_b32 v202,s42,v202
M a[12:15],a[220:223],a[228:231],a[12:15]
v_and_b32 v200,s42,v200
v_and_b32 v198,s42,v198
M a[12:15],a[224:227],a[216:219],a[12:15]
v_fmac_f32 v192,s43,v196
v_fmac_f32 v202,4.0,v194
M a[12:15],v[220:223],a[204:207],a[12:15]
v_fma_f32 v235,-4.0,v196,v200
v_fmac_f32 v192,s45,v200
M a[16:19],v[220:223],a[216:219],a[16:19]
ds_read_b128 a[200:203],v249 offset:36864
v_fmac_f32 v202,s41,v198
M a[16:19],a[224:227],a[228:231],a[16:19]
s_waitcnt lgkmcnt(2)
ds_read_b128 a[252:255],v248 offset:36864
v_sub_f32 v200,v200,v196
M a[16:19],a[220:223],a[248:251],a[16:19]
s_waitcnt lgkmcnt(2)
v_fma_f32 v196,-4.0,v194,v198
v_sub_f32 v198,v198,v194
M a[20:23],a[220:223],a[212:215],a[20:23]
v_add_f32 v194,v235,v196
v_sub_f32 v235,v235,v196
M a[20:23],a[224:227],a[248:251],a[20:23]
ds_read_b128 a[204:207],v248 offset:43520
v_fma_f32 v196,2.0,v198,v200
M a[20:23],v[220:223],a[228:231],a[20:23]
ds_read_b128 a[216:219],v249 offset:43520
v_fmac_f32 v200,-2.0,v198
M a[24:27],v[220:223],a[248:251],a[24:27]
ds_read_b128 a[228:231],v248 offset:44032
v_cvt_pk_bf16_f32 v192,v232,v192
M a[24:27],a[224:227],a[212:215],a[24:27]
s_waitcnt lgkmcnt(4)
ds_read_b128 a[248:251],v249 offset:44032
v_cvt_pk_bf16_f32 v202,v237,v202
M a[24:27],a[220:223],a[200:203],a[24:27]
s_waitcnt lgkmcnt(4)
v_cvt_pk_bf16_f32 v194,v233,v194
v_cvt_pk_bf16_f32 v198,v234,v196
M a[28:31],a[220:223],a[252:255],a[28:31]
buffer_load_dwordx4 a[220:223],v250,s[20:23],s47 offen offset:1024 sc1
M a[28:31],a[224:227],a[200:203],a[28:31]
v_cvt_pk_bf16_f32 v196,v238,v235
v_cvt_pk_bf16_f32 v200,v236,v200
M a[28:31],v[220:223],a[212:215],a[28:31]
s_waitcnt vmcnt(10) lgkmcnt(3)
buffer_load_dwordx4 a[252:255],v250,s[20:23],s47 offen offset:2048 sc1
M a[96:99],v[216:219],a[204:207],a[96:99]
s_waitcnt vmcnt(10) lgkmcnt(2)
s_add_u32 s48,s77,15360
ds_read_b128 a[224:227],v248 offset:44544
v_lshlrev_b32 v234,16,v197
M a[96:99],a[244:247],a[216:219],a[96:99]
s_waitcnt vmcnt(9) lgkmcnt(2)
ds_read_b128 a[212:215],v249 offset:44544
v_lshlrev_b32 v232,16,v193
M a[96:99],a[240:243],a[228:231],a[96:99]
s_waitcnt lgkmcnt(2)
v_lshlrev_b32 v233,16,v195
v_lshlrev_b32 v237,16,v203
M a[100:103],a[240:243],a[248:251],a[100:103]
buffer_load_dwordx4 a[200:203],v250,s[20:23],s48 offen offset:0 sc1
M a[100:103],a[244:247],a[228:231],a[100:103]
v_lshlrev_b32 v236,16,v201
v_lshlrev_b32 v235,16,v199
M a[100:103],v[216:219],a[216:219],a[100:103]
v_fmac_f32 v232,s43,v234
v_fmac_f32 v237,4.0,v233
M a[104:107],v[216:219],a[228:231],a[104:107]
ds_read_b128 v[220:223],v248 offset:45056
v_fma_f32 v238,-4.0,v234,v236
M a[104:107],a[244:247],a[248:251],a[104:107]
s_waitcnt lgkmcnt(2)
ds_read_b128 a[204:207],v249 offset:45056
v_fmac_f32 v232,s45,v236
M a[104:107],a[240:243],a[224:227],a[104:107]
s_waitcnt lgkmcnt(2)
v_fmac_f32 v237,s41,v235
v_sub_f32 v236,v236,v234
M a[108:111],a[240:243],a[212:215],a[108:111]
v_fma_f32 v234,-4.0,v233,v235
v_sub_f32 v235,v235,v233
M a[108:111],a[244:247],a[224:227],a[108:111]
v_add_f32 v233,v238,v234
v_sub_f32 v238,v238,v234
M a[108:111],v[216:219],a[248:251],a[108:111]
v_fma_f32 v234,2.0,v235,v236
v_fmac_f32 v236,-2.0,v235
M a[112:115],v[216:219],a[224:227],a[112:115]
ds_read_b128 a[216:219],v249 offset:45568
v_and_b32 v197,s42,v197
M a[112:115],a[244:247],a[212:215],a[112:115]
s_waitcnt lgkmcnt(2)
ds_read_b128 a[228:231],v248 offset:45568
v_and_b32 v255,32,v245
M a[112:115],a[240:243],v[220:223],a[112:115]
s_waitcnt lgkmcnt(2)
v_mul_u32_u24 v255,24,v255
v_and_or_b32 v255,v245,s42,v255
M a[116:119],a[240:243],a[204:207],a[116:119]
v_and_b32 v193,s42,v193
v_and_b32 v195,s42,v195
M a[116:119],a[244:247],v[220:223],a[116:119]
ds_read_b128 a[248:251],v248 offset:0
v_and_b32 v203,s42,v203
M a[116:119],v[216:219],a[212:215],a[116:119]
s_add_u32 s31,s66,6684672
ds_read_b128 a[224:227],v249 offset:0
v_and_b32 v201,s42,v201
M a[120:123],v[216:219],v[220:223],a[120:123]
ds_read_b128 a[212:215],v248 offset:512
v_and_b32 v199,s42,v199
M a[120:123],a[244:247],a[204:207],a[120:123]
s_waitcnt lgkmcnt(4)
ds_read_b128 v[220:223],v249 offset:512
v_fmac_f32 v193,s43,v197
M a[120:123],a[240:243],a[216:219],a[120:123]
s_waitcnt lgkmcnt(4)
v_fmac_f32 v203,4.0,v195
v_fma_f32 v235,-4.0,v197,v201
M a[124:127],a[240:243],a[228:231],a[124:127]
buffer_load_dword a228,v255,s[8:11],s31 offen offset:0
M a[124:127],a[244:247],a[216:219],a[124:127]
v_fmac_f32 v193,s45,v201
v_fmac_f32 v203,s41,v199
M a[124:127],v[216:219],a[204:207],a[124:127]
s_waitcnt vmcnt(10) lgkmcnt(3)
v_sub_f32 v201,v201,v197
v_fma_f32 v197,-4.0,v195,v199
M v[0:3],v[228:231],a[248:251],v[0:3]
s_waitcnt vmcnt(9) lgkmcnt(2)
ds_read_b128 a[240:243],v248 offset:1024
v_sub_f32 v199,v199,v195
M v[0:3],a[192:195],a[224:227],v[0:3]
s_waitcnt vmcnt(8) lgkmcnt(2)
buffer_load_dword a228,v255,s[8:11],s31 offen offset:384
M v[0:3],a[232:235],a[212:215],v[0:3]
s_waitcnt lgkmcnt(1)
ds_read_b128 a[216:219],v249 offset:1024
v_add_f32 v195,v235,v197
M v[4:7],a[232:235],v[220:223],v[4:7]
v_sub_f32 v235,v235,v197
v_fma_f32 v197,2.0,v199,v201
M v[4:7],a[192:195],a[212:215],v[4:7]
v_fmac_f32 v201,-2.0,v199
v_cvt_pk_bf16_f32 v193,v232,v193
M v[4:7],v[228:231],a[224:227],v[4:7]
v_cvt_pk_bf16_f32 v203,v237,v203
v_cvt_pk_bf16_f32 v195,v233,v195
M v[8:11],v[228:231],a[212:215],v[8:11]
ds_read_b128 a[244:247],v248 offset:1536
v_cvt_pk_bf16_f32 v199,v234,v197
M v[8:11],a[192:195],v[220:223],v[8:11]
s_waitcnt lgkmcnt(2)
ds_read_b128 a[204:207],v249 offset:1536
v_cvt_pk_bf16_f32 v197,v238,v235
M v[8:11],a[232:235],a[240:243],v[8:11]
s_waitcnt lgkmcnt(2)
v_cvt_pk_bf16_f32 v201,v236,v201
M v[12:15],a[232:235],a[216:219],v[12:15]
M v[12:15],a[192:195],a[240:243],v[12:15]
M v[12:15],v[228:231],v[220:223],v[12:15]
M v[16:19],v[228:231],a[240:243],v[16:19]
ds_read_b128 v[216:219],v249 offset:2048
M v[16:19],a[192:195],a[216:219],v[16:19]
s_waitcnt lgkmcnt(2)
buffer_load_dwordx4 a[228:231],v250,s[20:23],s48 offen offset:1024 sc1
M v[16:19],a[232:235],a[244:247],v[16:19]
s_waitcnt lgkmcnt(1)
ds_read_b128 a[248:251],v248 offset:2048
M v[20:23],a[232:235],a[204:207],v[20:23]
buffer_load_dwordx4 a[224:227],v250,s[20:23],s48 offen offset:2048 sc1
M v[20:23],a[192:195],a[244:247],v[20:23]
ds_read_b128 a[212:215],v248 offset:8704
M v[20:23],v[228:231],a[216:219],v[20:23]
ds_read_b128 v[220:223],v249 offset:8704
M v[24:27],v[228:231],a[244:247],v[24:27]
ds_read_b128 a[240:243],v248 offset:9216
M v[24:27],a[192:195],a[204:207],v[24:27]
s_waitcnt lgkmcnt(4)
ds_read_b128 a[216:219],v249 offset:9216
M v[24:27],a[232:235],v[216:219],v[24:27]
s_waitcnt lgkmcnt(4)
M v[28:31],a[232:235],a[248:251],v[28:31]
s_add_u32 s47,s77,21504
M v[28:31],a[192:195],v[216:219],v[28:31]
M v[28:31],v[228:231],a[204:207],v[28:31]
s_waitcnt vmcnt(10) lgkmcnt(3)
M v[96:99],a[236:239],a[212:215],v[96:99]
s_waitcnt vmcnt(9) lgkmcnt(2)
ds_read_b128 a[244:247],v248 offset:9728
M v[96:99],a[208:211],v[220:223],v[96:99]
s_waitcnt vmcnt(8) lgkmcnt(2)
ds_read_b128 a[232:235],v249 offset:9728
M v[96:99],v[224:227],a[240:243],v[96:99]
s_waitcnt lgkmcnt(2)
M v[100:103],v[224:227],a[216:219],v[100:103]
buffer_load_dwordx4 a[248:251],v250,s[20:23],s47 offen offset:0 sc1
M v[100:103],a[208:211],a[240:243],v[100:103]
M v[100:103],a[236:239],v[220:223],v[100:103]
buffer_load_dwordx4 a[192:195],v250,s[20:23],s47 offen offset:1024 sc1
M v[104:107],a[236:239],a[240:243],v[104:107]
ds_read_b128 v[228:231],v248 offset:10240
v_accvgpr_read_b32 v238,a0
M v[104:107],a[208:211],a[216:219],v[104:107]
s_waitcnt lgkmcnt(2)
ds_read_b128 a[212:215],v249 offset:10240
v_accvgpr_read_b32 v232,a96
M v[104:107],v[224:227],a[244:247],v[104:107]
s_waitcnt lgkmcnt(2)
v_add_f32 v234,v238,v232
v_sub_f32 v238,v238,v232
M v[108:111],v[224:227],a[232:235],v[108:111]
buffer_load_dwordx4 v[216:219],v250,s[20:23],s47 offen offset:2048 sc1
M v[108:111],a[208:211],a[244:247],v[108:111]
s_add_u32 s48,s77,24576
v_add_f32 v232,v0,v96
v_sub_f32 v96,v0,v96
M v[108:111],a[236:239],a[216:219],v[108:111]
v_add_f32 v0,v234,v232
v_fmac_f32 v234,4.0,v232
M v[112:115],a[236:239],a[244:247],v[112:115]
ds_read_b128 v[220:223],v249 offset:10752
v_fma_f32 v232,2.0,v96,v238
M v[112:115],a[208:211],a[232:235],v[112:115]
s_waitcnt lgkmcnt(2)
buffer_load_dwordx4 a[204:207],v250,s[20:23],s48 offen offset:0 sc1
M v[112:115],v[224:227],v[228:231],v[112:115]
s_waitcnt lgkmcnt(1)
ds_read_b128 a[240:243],v248 offset:10752
v_fma_f32 v96,s40,v96,v238
M v[116:119],v[224:227],a[212:215],v[116:119]
v_accvgpr_read_b32 v238,a1
v_accvgpr_read_b32 v237,a97
M v[116:119],a[208:211],v[228:231],v[116:119]
ds_read_b128 a[216:219],v248 offset:34816
v_add_f32 v236,v238,v237
M v[116:119],a[236:239],a[232:235],v[116:119]
ds_read_b128 a[244:247],v249 offset:34816
v_sub_f32 v238,v238,v237
M v[120:123],a[236:239],v[228:231],v[120:123]
ds_read_b128 a[232:235],v248 offset:35328
v_add_f32 v237,v1,v97
M v[120:123],a[208:211],a[212:215],v[120:123]
s_waitcnt lgkmcnt(4)
ds_read_b128 v[228:231],v249 offset:35328
v_sub_f32 v97,v1,v97
M v[120:123],v[224:227],v[220:223],v[120:123]
s_waitcnt lgkmcnt(4)
v_add_f32 v1,v236,v237
v_fmac_f32 v236,4.0,v237
M v[124:127],v[224:227],a[240:243],v[124:127]
v_fma_f32 v237,2.0,v97,v238
v_fma_f32 v97,s40,v97,v238
M v[124:127],a[208:211],v[220:223],v[124:127]
v_cvt_pk_bf16_f32 v232,v232,v237
v_cvt_pk_bf16_f32 v234,v234,v236
M v[124:127],a[236:239],a[212:215],v[124:127]
s_waitcnt vmcnt(11) lgkmcnt(3)
v_accvgpr_read_b32 v238,a2
v_accvgpr_read_b32 v233,a98
M a[32:35],a[196:199],a[216:219],a[32:35]
s_waitcnt vmcnt(10) lgkmcnt(2)
ds_read_b128 a[240:243],v248 offset:35840
v_add_f32 v235,v238,v233
M a[32:35],a[220:223],a[244:247],a[32:35]
s_waitcnt vmcnt(9) lgkmcnt(2)
ds_read_b128 v[224:227],v249 offset:35840
v_sub_f32 v238,v238,v233
M a[32:35],a[252:255],a[232:235],a[32:35]
s_waitcnt lgkmcnt(2)
v_add_f32 v233,v2,v98
v_sub_f32 v98,v2,v98
M a[36:39],a[252:255],v[228:231],a[36:39]
v_add_f32 v2,v235,v233
v_fmac_f32 v235,4.0,v233
M a[36:39],a[220:223],a[232:235],a[36:39]
v_fma_f32 v233,2.0,v98,v238
v_fma_f32 v98,s40,v98,v238
M a[36:39],a[196:199],a[244:247],a[36:39]
v_accvgpr_read_b32 v238,a3
v_accvgpr_read_b32 v237,a99
M a[40:43],a[196:199],a[232:235],a[40:43]
ds_read_b128 a[96:99],v248 offset:36352
v_add_f32 v236,v238,v237
M a[40:43],a[220:223],v[228:231],a[40:43]
s_waitcnt lgkmcnt(2)
ds_read_b128 a[208:211],v249 offset:36352
v_sub_f32 v238,v238,v237
M a[40:43],a[252:255],a[240:243],a[40:43]
s_waitcnt lgkmcnt(2)
v_add_f32 v237,v3,v99
v_sub_f32 v99,v3,v99
M a[44:47],a[252:255],v[224:227],a[44:47]
v_add_f32 v3,v236,v237
v_fmac_f32 v236,4.0,v237
M a[44:47],a[220:223],a[240:243],a[44:47]
v_fma_f32 v237,2.0,v99,v238
v_fma_f32 v99,s40,v99,v238
M a[44:47],a[196:199],v[228:231],a[44:47]
v_cvt_pk_bf16_f32 v233,v233,v237
v_cvt_pk_bf16_f32 v235,v235,v236
M a[48:51],a[196:199],a[240:243],a[48:51]
ds_read_b128 v[220:223],v249 offset:36864
ds_write2st64_b64 v254,v[232:233],v[234:235] offset0:68 offset1:72
M a[48:51],a[220:223],v[224:227],a[48:51]
s_waitcnt lgkmcnt(3)
ds_read_b128 a[212:215],v248 offset:36864
v_accvgpr_read_b32 v238,a4
M a[48:51],a[252:255],a[96:99],a[48:51]
s_waitcnt lgkmcnt(3)
v_accvgpr_read_b32 v232,a100
v_add_f32 v234,v238,v232
M a[52:55],a[252:255],a[208:211],a[52:55]
buffer_load_dwordx4 a[236:239],v250,s[20:23],s48 offen offset:1024 sc1
M a[52:55],a[220:223],a[96:99],a[52:55]
v_sub_f32 v238,v238,v232
v_add_f32 v232,v4,v100
M a[52:55],a[196:199],v[224:227],a[52:55]
v_sub_f32 v100,v4,v100
v_add_f32 v4,v234,v232
M a[56:59],a[196:199],a[96:99],a[56:59]
v_fmac_f32 v234,4.0,v232
v_fma_f32 v232,2.0,v100,v238
M a[56:59],a[220:223],a[208:211],a[56:59]
s_waitcnt lgkmcnt(2)
v_fma_f32 v100,s40,v100,v238
v_accvgpr_read_b32 v238,a5
M a[56:59],a[252:255],v[220:223],a[56:59]
s_waitcnt lgkmcnt(0)
v_accvgpr_read_b32 v237,a101
v_add_f32 v236,v238,v237
M a[60:63],a[252:255],a[212:215],a[60:63]
buffer_load_dwordx4 a[252:255],v250,s[20:23],s48 offen offset:2048 sc1
M a[60:63],a[220:223],v[220:223],a[60:63]
s_add_u32 s47,s77,30720
v_sub_f32 v238,v238,v237
v_add_f32 v237,v5,v101
M a[60:63],a[196:199],a[208:211],a[60:63]
s_waitcnt vmcnt(10)
buffer_load_dwordx4 a[220:223],v250,s[20:23],s47 offen offset:0 sc1
M a[64:67],a[200:203],a[216:219],a[64:67]
s_waitcnt vmcnt(8)
v_sub_f32 v101,v5,v101
v_add_f32 v5,v236,v237
M a[64:67],a[228:231],a[244:247],a[64:67]
s_waitcnt vmcnt(7)
v_fmac_f32 v236,4.0,v237
v_fma_f32 v237,2.0,v101,v238
M a[64:67],a[224:227],a[232:235],a[64:67]
v_fma_f32 v101,s40,v101,v238
v_cvt_pk_bf16_f32 v232,v232,v237
M a[68:71],a[224:227],v[228:231],a[68:71]
buffer_load_dwordx4 a[196:199],v250,s[20:23],s47 offen offset:1024 sc1
M a[68:71],a[228:231],a[232:235],a[68:71]
v_cvt_pk_bf16_f32 v234,v234,v236
v_accvgpr_read_b32 v238,a6
M a[68:71],a[200:203],a[244:247],a[68:71]
v_accvgpr_read_b32 v233,a102
v_add_f32 v235,v238,v233
M a[72:75],a[200:203],a[232:235],a[72:75]
v_sub_f32 v238,v238,v233
v_add_f32 v233,v6,v102
M a[72:75],a[228:231],v[228:231],a[72:75]
buffer_load_dwordx4 a[216:219],v250,s[20:23],s47 offen offset:2048 sc1
M a[72:75],a[224:227],a[240:243],a[72:75]
s_add_u32 s48,s77,33792
v_sub_f32 v102,v6,v102
v_add_f32 v6,v235,v233
M a[76:79],a[224:227],v[224:227],a[76:79]
v_fmac_f32 v235,4.0,v233
v_fma_f32 v233,2.0,v102,v238
M a[76:79],a[228:231],a[240:243],a[76:79]
v_fma_f32 v102,s40,v102,v238
v_accvgpr_read_b32 v238,a7
M a[76:79],a[200:203],v[228:231],a[76:79]
buffer_load_dwordx4 a[244:247],v250,s[20:23],s48 offen offset:0 sc1
M a[80:83],a[200:203],a[240:243],a[80:83]
v_accvgpr_read_b32 v237,a103
v_add_f32 v236,v238,v237
M a[80:83],a[228:231],v[224:227],a[80:83]
v_sub_f32 v238,v238,v237
v_add_f32 v237,v7,v103
M a[80:83],a[224:227],a[96:99],a[80:83]
v_sub_f32 v103,v7,v103
v_add_f32 v7,v236,v237
M a[84:87],a[224:227],a[208:211],a[84:87]
buffer_load_dwordx4 a[232:235],v250,s[20:23],s48 offen offset:1024 sc1
M a[84:87],a[228:231],a[96:99],a[84:87]
ds_read_b128 a[100:103],v248 offset:43520
v_fmac_f32 v236,4.0,v237
M a[84:87],a[200:203],v[224:227],a[84:87]
s_add_u32 s31,s66,7077888
ds_read_b128 v[228:231],v249 offset:43520
v_fma_f32 v237,2.0,v103,v238
M a[88:91],a[200:203],a[96:99],a[88:91]
ds_read_b128 a[96:99],v248 offset:44032
v_fma_f32 v103,s40,v103,v238
M a[88:91],a[228:231],a[208:211],a[88:91]
ds_read_b128 a[240:243],v249 offset:44032
v_cvt_pk_bf16_f32 v233,v233,v237
M a[88:91],a[224:227],v[220:223],a[88:91]
v_cvt_pk_bf16_f32 v235,v235,v236
M a[92:95],a[224:227],a[212:215],a[92:95]
buffer_load_dword v224,v255,s[8:11],s31 offen offset:0
M a[92:95],a[228:231],v[220:223],a[92:95]
ds_write2st64_b64 v254,v[232:233],v[234:235] offset0:76 offset1:80
M a[92:95],a[200:203],a[208:211],a[92:95]
s_waitcnt vmcnt(11) lgkmcnt(4)
v_accvgpr_read_b32 v238,a8
v_accvgpr_read_b32 v232,a104
M a[128:131],a[248:251],a[100:103],a[128:131]
s_waitcnt vmcnt(10) lgkmcnt(3)
ds_read_b128 a[212:215],v248 offset:44544
v_add_f32 v234,v238,v232
M a[128:131],a[192:195],v[228:231],a[128:131]
s_waitcnt vmcnt(9) lgkmcnt(3)
buffer_load_dword v224,v255,s[8:11],s31 offen offset:384
M a[128:131],v[216:219],a[96:99],a[128:131]
s_waitcnt lgkmcnt(2)
ds_read_b128 a[224:227],v249 offset:44544
v_sub_f32 v238,v238,v232
M a[132:135],v[216:219],a[240:243],a[132:135]
v_add_f32 v232,v8,v104
v_sub_f32 v104,v8,v104
M a[132:135],a[192:195],a[96:99],a[132:135]
v_add_f32 v8,v234,v232
v_fmac_f32 v234,4.0,v232
M a[132:135],a[248:251],v[228:231],a[132:135]
v_fma_f32 v232,2.0,v104,v238
v_fma_f32 v104,s40,v104,v238
M a[136:139],a[248:251],a[96:99],a[136:139]
s_waitcnt lgkmcnt(2)
s_barrier
ds_read_b128 a[0:3],v250 offset:34816
M a[136:139],a[192:195],a[240:243],a[136:139]
s_waitcnt lgkmcnt(2)
ds_read_b128 a[4:7],v250 offset:38912
ds_read_b128 a[228:231],v248 offset:45056
M a[136:139],v[216:219],a[212:215],a[136:139]
s_waitcnt lgkmcnt(3)
ds_read_b128 v[220:223],v249 offset:45056
v_accvgpr_read_b32 v238,a9
M a[140:143],v[216:219],a[224:227],a[140:143]
v_accvgpr_read_b32 v237,a105
v_add_f32 v236,v238,v237
M a[140:143],a[192:195],a[212:215],a[140:143]
v_sub_f32 v238,v238,v237
v_add_f32 v237,v9,v105
M a[140:143],a[248:251],a[240:243],a[140:143]
v_sub_f32 v105,v9,v105
v_add_f32 v9,v236,v237
M a[144:147],a[248:251],a[212:215],a[144:147]
ds_read_b128 a[200:203],v249 offset:45568
v_fmac_f32 v236,4.0,v237
M a[144:147],a[192:195],a[224:227],a[144:147]
s_waitcnt lgkmcnt(2)
ds_read_b128 a[208:211],v248 offset:45568
v_fma_f32 v237,2.0,v105,v238
M a[144:147],v[216:219],a[228:231],a[144:147]
s_waitcnt lgkmcnt(2)
buffer_load_dwordx4 v[224:227],v250,s[20:23],s48 offen offset:2048 sc1
M a[148:151],v[216:219],v[220:223],a[148:151]
v_fma_f32 v105,s40,v105,v238
v_cvt_pk_bf16_f32 v232,v232,v237
M a[148:151],a[192:195],a[228:231],a[148:151]
v_cvt_pk_bf16_f32 v234,v234,v236
v_accvgpr_read_b32 v238,a10
M a[148:151],a[248:251],a[224:227],a[148:151]
v_accvgpr_read_b32 v233,a106
v_add_f32 v235,v238,v233
M a[152:155],a[248:251],a[228:231],a[152:155]
v_sub_f32 v238,v238,v233
v_add_f32 v233,v10,v106
M a[152:155],a[192:195],v[220:223],a[152:155]
s_waitcnt lgkmcnt(1)
v_sub_f32 v106,v10,v106
v_add_f32 v10,v235,v233
M a[152:155],v[216:219],a[200:203],a[152:155]
s_waitcnt lgkmcnt(0)
v_fmac_f32 v235,4.0,v233
v_fma_f32 v233,2.0,v106,v238
M a[156:159],v[216:219],a[208:211],a[156:159]
global_load_dword v216,v250,s[64:65]
M a[156:159],a[192:195],a[200:203],a[156:159]
s_add_u32 s47,s77,39936
v_fma_f32 v106,s40,v106,v238
v_accvgpr_read_b32 v238,a11
M a[156:159],a[248:251],v[220:223],a[156:159]
s_waitcnt vmcnt(11)
v_accvgpr_read_b32 v237,a107
v_add_f32 v236,v238,v237
M a[160:163],a[204:207],a[100:103],a[160:163]
s_waitcnt vmcnt(10)
v_sub_f32 v238,v238,v237
v_add_f32 v237,v11,v107
M a[160:163],a[236:239],v[228:231],a[160:163]
s_waitcnt vmcnt(9)
v_sub_f32 v107,v11,v107
v_add_f32 v11,v236,v237
M a[160:163],a[252:255],a[96:99],a[160:163]
v_fmac_f32 v236,4.0,v237
v_fma_f32 v237,2.0,v107,v238
M a[164:167],a[252:255],a[240:243],a[164:167]
buffer_load_dwordx4 v[216:219],v250,s[20:23],s47 offen offset:0 sc1
M a[164:167],a[236:239],a[96:99],a[164:167]
v_fma_f32 v107,s40,v107,v238
v_cvt_pk_bf16_f32 v233,v233,v237
M a[164:167],a[204:207],v[228:231],a[164:167]
buffer_load_dwordx4 a[100:103],v250,s[20:23],s47 offen offset:1024 sc1
M a[168:171],a[204:207],a[96:99],a[168:171]
v_cvt_pk_bf16_f32 v235,v235,v236
M a[168:171],a[236:239],a[240:243],a[168:171]
ds_write2st64_b64 v254,v[232:233],v[234:235] offset0:85 offset1:89
M a[168:171],a[252:255],a[212:215],a[168:171]
v_accvgpr_read_b32 v204,a12
v_accvgpr_read_b32 v208,a108
M a[172:175],a[252:255],a[224:227],a[172:175]
buffer_load_dwordx4 a[104:107],v250,s[20:23],s47 offen offset:2048 sc1
M a[172:175],a[236:239],a[212:215],a[172:175]
s_add_u32 s48,s77,43008
v_accvgpr_read_b32 v205,a13
v_accvgpr_read_b32 v209,a109
M a[172:175],a[204:207],a[240:243],a[172:175]
v_accvgpr_read_b32 v206,a14
v_accvgpr_read_b32 v210,a110
v_accvgpr_read_b32 v207,a15
v_accvgpr_read_b32 v211,a111
v_pk_add_f32 v[212:213],v[204:205],v[208:209]
v_pk_add_f32 v[214:215],v[206:207],v[210:211]
v_pk_add_f32 v[204:205],v[204:205],v[208:209] neg_lo:[0,1] neg_hi:[0,1]
v_pk_add_f32 v[206:207],v[206:207],v[210:211] neg_lo:[0,1] neg_hi:[0,1]
v_pk_add_f32 v[208:209],v[12:13],v[108:109]
v_pk_add_f32 v[210:211],v[14:15],v[110:111]
v_pk_add_f32 v[108:109],v[12:13],v[108:109] neg_lo:[0,1] neg_hi:[0,1]
v_pk_add_f32 v[110:111],v[14:15],v[110:111] neg_lo:[0,1] neg_hi:[0,1]
v_pk_add_f32 v[12:13],v[212:213],v[208:209]
v_pk_add_f32 v[14:15],v[214:215],v[210:211]
v_pk_fma_f32 v[212:213],v[208:209],4.0,v[212:213] op_sel_hi:[1,0,1]
v_pk_fma_f32 v[214:215],v[210:211],4.0,v[214:215] op_sel_hi:[1,0,1]
v_pk_fma_f32 v[208:209],v[108:109],2.0,v[204:205] op_sel_hi:[1,0,1]
v_pk_fma_f32 v[210:211],v[110:111],2.0,v[206:207] op_sel_hi:[1,0,1]
v_pk_fma_f32 v[108:109],v[108:109],s[40:41],v[204:205] op_sel_hi:[1,0,1]
v_pk_fma_f32 v[110:111],v[110:111],s[40:41],v[206:207] op_sel_hi:[1,0,1]
M a[176:179],a[204:207],a[212:215],a[176:179]
buffer_load_dwordx4 a[192:195],v250,s[20:23],s48 offen offset:0 sc1
M a[176:179],a[236:239],a[224:227],a[176:179]
v_cvt_pk_bf16_f32 v208,v208,v209
v_cvt_pk_bf16_f32 v209,v210,v211
M a[176:179],a[252:255],a[228:231],a[176:179]
buffer_load_dwordx4 a[248:251],v250,s[20:23],s48 offen offset:1024 sc1
M a[180:183],a[252:255],v[220:223],a[180:183]
v_cvt_pk_bf16_f32 v212,v212,v213
v_cvt_pk_bf16_f32 v213,v214,v215
M a[180:183],a[236:239],a[228:231],a[180:183]
ds_read_b128 a[108:111],v248 offset:0
ds_write2st64_b64 v254,v[208:209],v[212:213] offset0:93 offset1:97
M a[180:183],a[204:207],a[224:227],a[180:183]
buffer_load_dwordx4 a[96:99],v250,s[20:23],s48 offen offset:2048 sc1
M a[184:187],a[204:207],a[228:231],a[184:187]
s_add_u32 s46,s72,0
ds_read_b128 a[240:243],v249 offset:0
ds_read_b128 a[212:215],v248 offset:512
M a[184:187],a[236:239],v[220:223],a[184:187]
ds_read_b128 a[224:227],v249 offset:512
v_accvgpr_read_b32 v238,a16
M a[184:187],a[252:255],a[200:203],a[184:187]
v_accvgpr_read_b32 v232,a112
v_add_f32 v234,v238,v232
M a[188:191],a[252:255],a[208:211],a[188:191]
buffer_load_dwordx4 v[228:231],v250,s[20:23],s46 offen offset:0 sc1
M a[188:191],a[236:239],a[200:203],a[188:191]
v_sub_f32 v238,v238,v232
v_add_f32 v232,v16,v112
M a[188:191],a[204:207],v[220:223],a[188:191]
s_waitcnt vmcnt(15) lgkmcnt(4)
v_sub_f32 v112,v16,v112
v_add_f32 v16,v234,v232
M v[32:35],a[220:223],a[108:111],v[32:35]
s_waitcnt vmcnt(14) lgkmcnt(2)
ds_read_b128 a[208:211],v248 offset:1024
v_fmac_f32 v234,4.0,v232
M v[32:35],a[196:199],a[240:243],v[32:35]
s_waitcnt vmcnt(13) lgkmcnt(2)
buffer_load_dwordx4 a[228:231],v250,s[20:23],s46 offen offset:1024 sc1
M v[32:35],a[216:219],a[212:215],v[32:35]
s_waitcnt lgkmcnt(1)
ds_read_b128 a[252:255],v249 offset:1024
v_fma_f32 v232,2.0,v112,v238
M v[36:39],a[216:219],a[224:227],v[36:39]
v_fma_f32 v112,s40,v112,v238
M v[36:39],a[196:199],a[212:215],v[36:39]
s_barrier
ds_read_b128 a[8:11],v250 offset:43520
M v[36:39],a[220:223],a[240:243],v[36:39]
ds_read_b128 a[12:15],v250 offset:47616
v_accvgpr_read_b32 v238,a17
M v[40:43],a[220:223],a[212:215],v[40:43]
ds_read_b128 a[200:203],v248 offset:1536
v_accvgpr_read_b32 v237,a113
M v[40:43],a[196:199],a[224:227],v[40:43]
s_waitcnt lgkmcnt(4)
ds_read_b128 a[236:239],v249 offset:1536
v_add_f32 v236,v238,v237
M v[40:43],a[216:219],a[208:211],v[40:43]
s_waitcnt lgkmcnt(4)
v_sub_f32 v238,v238,v237
v_add_f32 v237,v17,v113
M v[44:47],a[216:219],a[252:255],v[44:47]
v_sub_f32 v113,v17,v113
v_add_f32 v17,v236,v237
M v[44:47],a[196:199],a[208:211],v[44:47]
v_fmac_f32 v236,4.0,v237
v_fma_f32 v237,2.0,v113,v238
M v[44:47],a[220:223],a[224:227],v[44:47]
v_fma_f32 v113,s40,v113,v238
v_cvt_pk_bf16_f32 v232,v232,v237
M v[48:51],a[220:223],a[208:211],v[48:51]
ds_read_b128 a[204:207],v249 offset:2048
v_cvt_pk_bf16_f32 v234,v234,v236
M v[48:51],a[196:199],a[252:255],v[48:51]
s_waitcnt lgkmcnt(2)
ds_read_b128 v[220:223],v248 offset:2048
v_accvgpr_read_b32 v238,a18
M v[48:51],a[216:219],a[200:203],v[48:51]
s_waitcnt lgkmcnt(2)
v_accvgpr_read_b32 v233,a114
v_add_f32 v235,v238,v233
M v[52:55],a[216:219],a[236:239],v[52:55]
v_sub_f32 v238,v238,v233
v_add_f32 v233,v18,v114
M v[52:55],a[196:199],a[200:203],v[52:55]
v_sub_f32 v114,v18,v114
v_add_f32 v18,v235,v233
M v[52:55],a[220:223],a[252:255],v[52:55]
v_fmac_f32 v235,4.0,v233
v_fma_f32 v233,2.0,v114,v238
M v[56:59],a[220:223],a[200:203],v[56:59]
v_fma_f32 v114,s40,v114,v238
v_accvgpr_read_b32 v238,a19
M v[56:59],a[196:199],a[236:239],v[56:59]
s_waitcnt lgkmcnt(1)
v_accvgpr_read_b32 v237,a115
v_add_f32 v236,v238,v237
M v[56:59],a[216:219],a[204:207],v[56:59]
s_waitcnt lgkmcnt(0)
v_sub_f32 v238,v238,v237
v_add_f32 v237,v19,v115
M v[60:63],a[216:219],v[220:223],v[60:63]
buffer_load_dwordx4 a[112:115],v250,s[20:23],s46 offen offset:2048 sc1
M v[60:63],a[196:199],a[204:207],v[60:63]
s_add_u32 s46,s73,0
v_sub_f32 v115,v19,v115
v_add_f32 v19,v236,v237
M v[60:63],a[220:223],a[236:239],v[60:63]
s_waitcnt vmcnt(14)
buffer_load_dwordx4 a[216:219],v250,s[20:23],s46 offen offset:0 sc1
M v[64:67],a[244:247],a[108:111],v[64:67]
s_waitcnt vmcnt(14)
v_fmac_f32 v236,4.0,v237
v_fma_f32 v237,2.0,v115,v238
M v[64:67],a[232:235],a[240:243],v[64:67]
s_waitcnt vmcnt(11)
v_fma_f32 v115,s40,v115,v238
v_cvt_pk_bf16_f32 v233,v233,v237
M v[64:67],v[224:227],a[212:215],v[64:67]
v_cvt_pk_bf16_f32 v235,v235,v236
M v[68:71],v[224:227],a[224:227],v[68:71]
buffer_load_dwordx4 a[196:199],v250,s[20:23],s46 offen offset:1024 sc1
M v[68:71],a[232:235],a[212:215],v[68:71]
ds_write2st64_b64 v254,v[232:233],v[234:235] offset0:68 offset1:72
M v[68:71],a[244:247],a[240:243],v[68:71]
v_accvgpr_read_b32 v238,a20
v_accvgpr_read_b32 v232,a116
M v[72:75],a[244:247],a[212:215],v[72:75]
v_add_f32 v234,v238,v232
v_sub_f32 v238,v238,v232
M v[72:75],a[232:235],a[224:227],v[72:75]
buffer_load_dwordx4 a[108:111],v250,s[20:23],s46 offen offset:2048 sc1
M v[72:75],v[224:227],a[208:211],v[72:75]
s_add_u32 s31,s66,7471104
v_add_f32 v232,v20,v116
v_sub_f32 v116,v20,v116
M v[76:79],v[224:227],a[252:255],v[76:79]
v_add_f32 v20,v234,v232
v_fmac_f32 v234,4.0,v232
M v[76:79],a[232:235],a[208:211],v[76:79]
v_fma_f32 v232,2.0,v116,v238
v_fma_f32 v116,s40,v116,v238
M v[76:79],a[244:247],a[224:227],v[76:79]
buffer_load_dword a220,v255,s[8:11],s31 offen offset:0
M v[80:83],a[244:247],a[208:211],v[80:83]
v_accvgpr_read_b32 v238,a21
v_accvgpr_read_b32 v237,a117
M v[80:83],a[232:235],a[252:255],v[80:83]
v_add_f32 v236,v238,v237
v_sub_f32 v238,v238,v237
M v[80:83],v[224:227],a[200:203],v[80:83]
v_add_f32 v237,v21,v117
v_sub_f32 v117,v21,v117
M v[84:87],v[224:227],a[236:239],v[84:87]
buffer_load_dword a220,v255,s[8:11],s31 offen offset:384
M v[84:87],a[232:235],a[200:203],v[84:87]
ds_read_b128 a[240:243],v248 offset:8704
v_add_f32 v21,v236,v237
M v[84:87],a[244:247],a[252:255],v[84:87]
ds_read_b128 a[212:215],v249 offset:8704
v_fmac_f32 v236,4.0,v237
M v[88:91],a[244:247],a[200:203],v[88:91]
ds_read_b128 a[224:227],v248 offset:9216
v_fma_f32 v237,2.0,v117,v238
M v[88:91],a[232:235],a[236:239],v[88:91]
ds_read_b128 a[208:211],v249 offset:9216
v_fma_f32 v117,s40,v117,v238
M v[88:91],v[224:227],a[204:207],v[88:91]
v_cvt_pk_bf16_f32 v232,v232,v237
v_cvt_pk_bf16_f32 v234,v234,v236
M v[92:95],v[224:227],v[220:223],v[92:95]
v_accvgpr_read_b32 v238,a22
v_accvgpr_read_b32 v233,a118
M v[92:95],a[232:235],a[204:207],v[92:95]
v_add_f32 v235,v238,v233
v_sub_f32 v238,v238,v233
M v[92:95],a[244:247],a[236:239],v[92:95]
s_waitcnt vmcnt(13) lgkmcnt(3)
v_add_f32 v233,v22,v118
v_sub_f32 v118,v22,v118
M v[128:131],v[216:219],a[240:243],v[128:131]
s_waitcnt vmcnt(12) lgkmcnt(2)
ds_read_b128 a[252:255],v248 offset:9728
v_add_f32 v22,v235,v233
M v[128:131],a[100:103],a[212:215],v[128:131]
s_waitcnt vmcnt(11) lgkmcnt(2)
ds_read_b128 a[200:203],v249 offset:9728
v_fmac_f32 v235,4.0,v233
M v[128:131],a[104:107],a[224:227],v[128:131]
s_waitcnt lgkmcnt(2)
v_fma_f32 v233,2.0,v118,v238
v_fma_f32 v118,s40,v118,v238
M v[132:135],a[104:107],a[208:211],v[132:135]
v_accvgpr_read_b32 v238,a23
v_accvgpr_read_b32 v237,a119
M v[132:135],a[100:103],a[224:227],v[132:135]
v_add_f32 v236,v238,v237
v_sub_f32 v238,v238,v237
M v[132:135],v[216:219],a[212:215],v[132:135]
s_add_u32 s46,s74,0
v_add_f32 v237,v23,v119
v_sub_f32 v119,v23,v119
M v[136:139],v[216:219],a[224:227],v[136:139]
ds_read_b128 a[116:119],v248 offset:10240
v_add_f32 v23,v236,v237
M v[136:139],a[100:103],a[208:211],v[136:139]
s_waitcnt lgkmcnt(2)
ds_read_b128 v[220:223],v249 offset:10240
v_fmac_f32 v236,4.0,v237
M v[136:139],a[104:107],a[252:255],v[136:139]
s_waitcnt lgkmcnt(2)
v_fma_f32 v237,2.0,v119,v238
v_fma_f32 v119,s40,v119,v238
M v[140:143],a[104:107],a[200:203],v[140:143]
v_cvt_pk_bf16_f32 v233,v233,v237
v_cvt_pk_bf16_f32 v235,v235,v236
M v[140:143],a[100:103],a[252:255],v[140:143]
ds_write2st64_b64 v254,v[232:233],v[234:235] offset0:76 offset1:80
M v[140:143],v[216:219],a[208:211],v[140:143]
buffer_load_dwordx4 a[220:223],v250,s[20:23],s46 offen offset:0 sc1
M v[144:147],v[216:219],a[252:255],v[144:147]
ds_read_b128 a[232:235],v249 offset:10752
v_accvgpr_read_b32 v238,a24
M v[144:147],a[100:103],a[200:203],v[144:147]
s_waitcnt lgkmcnt(3)
buffer_load_dwordx4 v[224:227],v250,s[20:23],s46 offen offset:1024 sc1
M v[144:147],a[104:107],a[116:119],v[144:147]
s_waitcnt lgkmcnt(2)
ds_read_b128 a[236:239],v248 offset:10752
v_accvgpr_read_b32 v232,a120
M v[148:151],a[104:107],v[220:223],v[148:151]
v_add_f32 v234,v238,v232
v_sub_f32 v238,v238,v232
M v[148:151],a[100:103],a[116:119],v[148:151]
v_add_f32 v232,v24,v120
v_sub_f32 v120,v24,v120
M v[148:151],v[216:219],a[200:203],v[148:151]
buffer_load_dwordx4 a[204:207],v250,s[20:23],s46 offen offset:2048 sc1
M v[152:155],v[216:219],a[116:119],v[152:155]
s_add_u32 s46,s75,0
v_add_f32 v24,v234,v232
v_fmac_f32 v234,4.0,v232
M v[152:155],a[100:103],v[220:223],v[152:155]
s_waitcnt lgkmcnt(1)
v_fma_f32 v232,2.0,v120,v238
v_fma_f32 v120,s40,v120,v238
M v[152:155],a[104:107],a[232:235],v[152:155]
s_waitcnt lgkmcnt(0)
s_barrier
ds_read_b128 a[16:19],v250 offset:34816
M v[156:159],a[104:107],a[236:239],v[156:159]
ds_read_b128 a[20:23],v250 offset:38912
v_accvgpr_read_b32 v238,a25
M v[156:159],a[100:103],a[232:235],v[156:159]
buffer_load_dwordx4 a[244:247],v250,s[20:23],s46 offen offset:0 sc1
M v[156:159],v[216:219],v[220:223],v[156:159]
s_waitcnt vmcnt(14)
v_accvgpr_read_b32 v237,a121
v_add_f32 v236,v238,v237
M v[160:163],a[192:195],a[240:243],v[160:163]
s_waitcnt vmcnt(13)
v_sub_f32 v238,v238,v237
v_add_f32 v237,v25,v121
M v[160:163],a[248:251],a[212:215],v[160:163]
s_waitcnt vmcnt(12)
buffer_load_dwordx4 a[104:107],v250,s[20:23],s46 offen offset:1024 sc1
M v[160:163],a[96:99],a[224:227],v[160:163]
v_sub_f32 v121,v25,v121
v_add_f32 v25,v236,v237
M v[164:167],a[96:99],a[208:211],v[164:167]
v_fmac_f32 v236,4.0,v237
v_fma_f32 v237,2.0,v121,v238
M v[164:167],a[248:251],a[224:227],v[164:167]
v_fma_f32 v121,s40,v121,v238
v_cvt_pk_bf16_f32 v232,v232,v237
M v[164:167],a[192:195],a[212:215],v[164:167]
buffer_load_dwordx4 a[100:103],v250,s[20:23],s46 offen offset:2048 sc1
M v[168:171],a[192:195],a[224:227],v[168:171]
s_add_u32 s46,s76,0
v_cvt_pk_bf16_f32 v234,v234,v236
v_accvgpr_read_b32 v238,a26
M v[168:171],a[248:251],a[208:211],v[168:171]
v_accvgpr_read_b32 v233,a122
v_add_f32 v235,v238,v233
M v[168:171],a[96:99],a[252:255],v[168:171]
v_sub_f32 v238,v238,v233
v_add_f32 v233,v26,v122
M v[172:175],a[96:99],a[200:203],v[172:175]
buffer_load_dwordx4 v[216:219],v250,s[20:23],s46 offen offset:0 sc1
M v[172:175],a[248:251],a[252:255],v[172:175]
v_sub_f32 v122,v26,v122
v_add_f32 v26,v235,v233
M v[172:175],a[192:195],a[208:211],v[172:175]
v_fmac_f32 v235,4.0,v233
v_fma_f32 v233,2.0,v122,v238
M v[176:179],a[192:195],a[252:255],v[176:179]
v_fma_f32 v122,s40,v122,v238
v_accvgpr_read_b32 v238,a27
M v[176:179],a[248:251],a[200:203],v[176:179]
buffer_load_dwordx4 a[240:243],v250,s[20:23],s46 offen offset:1024 sc1
M v[176:179],a[96:99],a[116:119],v[176:179]
v_add_u32 v248,0xffffbc00,v248
v_add_u32 v249,0xffffbc00,v249
M v[180:183],a[96:99],v[220:223],v[180:183]
v_accvgpr_read_b32 v237,a123
v_add_f32 v236,v238,v237
M v[180:183],a[248:251],a[116:119],v[180:183]
ds_read_b128 a[208:211],v248 offset:0
v_sub_f32 v238,v238,v237
M v[180:183],a[192:195],a[200:203],v[180:183]
buffer_load_dwordx4 a[212:215],v250,s[20:23],s46 offen offset:2048 sc1
M v[184:187],a[192:195],a[116:119],v[184:187]
s_add_u32 s46,s77,0
ds_read_b128 a[120:123],v249 offset:0
ds_read_b128 a[116:119],v248 offset:512
M v[184:187],a[248:251],v[220:223],v[184:187]
ds_read_b128 a[252:255],v249 offset:512
v_add_f32 v237,v27,v123
M v[184:187],a[96:99],a[232:235],v[184:187]
v_sub_f32 v123,v27,v123
v_add_f32 v27,v236,v237
M v[188:191],a[96:99],a[236:239],v[188:191]
buffer_load_dwordx4 a[224:227],v250,s[20:23],s46 offen offset:0 sc1
M v[188:191],a[248:251],a[232:235],v[188:191]
v_fmac_f32 v236,4.0,v237
v_fma_f32 v237,2.0,v123,v238
M v[188:191],a[192:195],v[220:223],v[188:191]
s_waitcnt vmcnt(17) lgkmcnt(3)
v_fma_f32 v123,s40,v123,v238
v_cvt_pk_bf16_f32 v233,v233,v237
M v[0:3],v[228:231],a[208:211],v[0:3]
s_waitcnt vmcnt(16) lgkmcnt(2)
ds_read_b128 a[248:251],v248 offset:1024
v_cvt_pk_bf16_f32 v235,v235,v236
M v[0:3],a[228:231],a[120:123],v[0:3]
s_waitcnt vmcnt(15) lgkmcnt(2)
buffer_load_dwordx4 a[96:99],v250,s[20:23],s46 offen offset:1024 sc1
M v[0:3],a[112:115],a[116:119],v[0:3]
s_waitcnt lgkmcnt(1)
ds_read_b128 a[192:195],v249 offset:1024
ds_write2st64_b64 v254,v[232:233],v[234:235] offset0:85 offset1:89
M v[4:7],a[112:115],a[252:255],v[4:7]
v_accvgpr_read_b32 v204,a28
v_accvgpr_read_b32 v208,a124
M v[4:7],a[228:231],a[116:119],v[4:7]
buffer_load_dwordx4 a[200:203],v250,s[20:23],s46 offen offset:2048 sc1
M v[4:7],v[228:231],a[120:123],v[4:7]
s_add_u32 s46,s72,46080
v_accvgpr_read_b32 v205,a29
v_accvgpr_read_b32 v209,a125
M v[8:11],v[228:231],a[116:119],v[8:11]
ds_read_b128 a[116:119],v248 offset:1536
v_accvgpr_read_b32 v206,a30
M v[8:11],a[228:231],a[252:255],v[8:11]
s_waitcnt lgkmcnt(3)
ds_read_b128 a[120:123],v249 offset:1536
v_accvgpr_read_b32 v210,a126
v_accvgpr_read_b32 v207,a31
v_accvgpr_read_b32 v211,a127
v_pk_add_f32 v[212:213],v[204:205],v[208:209]
v_pk_add_f32 v[214:215],v[206:207],v[210:211]
v_pk_add_f32 v[204:205],v[204:205],v[208:209] neg_lo:[0,1] neg_hi:[0,1]
v_pk_add_f32 v[206:207],v[206:207],v[210:211] neg_lo:[0,1] neg_hi:[0,1]
v_pk_add_f32 v[208:209],v[28:29],v[124:125]
v_pk_add_f32 v[210:211],v[30:31],v[126:127]
v_pk_add_f32 v[124:125],v[28:29],v[124:125] neg_lo:[0,1] neg_hi:[0,1]
v_pk_add_f32 v[126:127],v[30:31],v[126:127] neg_lo:[0,1] neg_hi:[0,1]
v_pk_add_f32 v[28:29],v[212:213],v[208:209]
v_pk_add_f32 v[30:31],v[214:215],v[210:211]
v_pk_fma_f32 v[212:213],v[208:209],4.0,v[212:213] op_sel_hi:[1,0,1]
v_pk_fma_f32 v[214:215],v[210:211],4.0,v[214:215] op_sel_hi:[1,0,1]
v_pk_fma_f32 v[208:209],v[124:125],2.0,v[204:205] op_sel_hi:[1,0,1]
v_pk_fma_f32 v[210:211],v[126:127],2.0,v[206:207] op_sel_hi:[1,0,1]
v_pk_fma_f32 v[124:125],v[124:125],s[40:41],v[204:205] op_sel_hi:[1,0,1]
v_pk_fma_f32 v[126:127],v[126:127],s[40:41],v[206:207] op_sel_hi:[1,0,1]
M v[8:11],a[112:115],a[248:251],v[8:11]
s_waitcnt lgkmcnt(3)
buffer_load_dwordx4 a[236:239],v250,s[20:23],s46 offen offset:0 sc1
M v[12:15],a[112:115],a[192:195],v[12:15]
v_cvt_pk_bf16_f32 v208,v208,v209
v_cvt_pk_bf16_f32 v209,v210,v211
M v[12:15],a[228:231],a[248:251],v[12:15]
buffer_load_dwordx4 a[232:235],v250,s[20:23],s46 offen offset:1024 sc1
M v[12:15],v[228:231],a[252:255],v[12:15]
v_cvt_pk_bf16_f32 v212,v212,v213
v_cvt_pk_bf16_f32 v213,v214,v215
M v[16:19],v[228:231],a[248:251],v[16:19]
ds_read_b128 a[124:127],v249 offset:2048
ds_write2st64_b64 v254,v[208:209],v[212:213] offset0:93 offset1:97
M v[16:19],a[228:231],a[192:195],v[16:19]
s_waitcnt lgkmcnt(3)
ds_read_b128 v[220:223],v248 offset:2048
v_add_u32 v248,0x15400,v248
M v[16:19],a[112:115],a[116:119],v[16:19]
s_waitcnt lgkmcnt(3)
v_add_u32 v249,0x15400,v249
v_accvgpr_read_b32 v238,a32
M v[20:23],a[112:115],a[120:123],v[20:23]
v_accvgpr_read_b32 v232,a128
v_add_f32 v234,v238,v232
M v[20:23],a[228:231],a[116:119],v[20:23]
ds_read_b128 a[208:211],v248 offset:0
v_sub_f32 v238,v238,v232
M v[20:23],v[228:231],a[192:195],v[20:23]
ds_read_b128 a[252:255],v249 offset:0
v_add_f32 v232,v32,v128
M v[24:27],v[228:231],a[116:119],v[24:27]
ds_read_b128 a[116:119],v248 offset:512
v_sub_f32 v128,v32,v128
M v[24:27],a[228:231],a[120:123],v[24:27]
s_waitcnt lgkmcnt(5)
ds_read_b128 a[248:251],v249 offset:512
v_add_f32 v32,v234,v232
M v[24:27],a[112:115],a[124:127],v[24:27]
s_waitcnt lgkmcnt(4)
buffer_load_dwordx4 a[192:195],v250,s[20:23],s46 offen offset:2048 sc1
M v[28:31],a[112:115],v[220:223],v[28:31]
s_add_u32 s47,s72,49152
v_fmac_f32 v234,4.0,v232
v_fma_f32 v232,2.0,v128,v238
M v[28:31],a[228:231],a[124:127],v[28:31]
buffer_load_dwordx4 a[112:115],v250,s[20:23],s47 offen offset:0 sc1
M v[28:31],v[228:231],a[120:123],v[28:31]
s_waitcnt vmcnt(20) lgkmcnt(3)
v_fma_f32 v128,s40,v128,v238
M v[0:3],a[216:219],a[208:211],v[0:3]
s_waitcnt vmcnt(19) lgkmcnt(2)
s_barrier
ds_read_b128 a[24:27],v250 offset:43520
M v[0:3],a[196:199],a[252:255],v[0:3]
s_waitcnt vmcnt(18) lgkmcnt(2)
ds_read_b128 a[28:31],v250 offset:47616
ds_read_b128 a[120:123],v248 offset:1024
M v[0:3],a[108:111],a[116:119],v[0:3]
s_waitcnt lgkmcnt(3)
buffer_load_dwordx4 v[220:223],v250,s[20:23],s47 offen offset:1024 sc1
M v[4:7],a[108:111],a[248:251],v[4:7]
ds_read_b128 a[228:231],v249 offset:1024
v_accvgpr_read_b32 v238,a33
M v[4:7],a[196:199],a[116:119],v[4:7]
v_accvgpr_read_b32 v237,a129
v_add_f32 v236,v238,v237
M v[4:7],a[216:219],a[252:255],v[4:7]
v_sub_f32 v238,v238,v237
v_add_f32 v237,v33,v129
M v[8:11],a[216:219],a[116:119],v[8:11]
buffer_load_dwordx4 a[124:127],v250,s[20:23],s47 offen offset:2048 sc1
M v[8:11],a[196:199],a[248:251],v[8:11]
s_waitcnt lgkmcnt(1)
ds_read_b128 a[116:119],v248 offset:1536
ds_read_b128 v[228:231],v249 offset:1536
M v[8:11],a[108:111],a[120:123],v[8:11]
s_waitcnt lgkmcnt(2)
s_add_u32 s34,s32,0
v_sub_f32 v129,v33,v129
v_add_f32 v33,v236,v237
M v[12:15],a[108:111],a[228:231],v[12:15]
v_fmac_f32 v236,4.0,v237
v_fma_f32 v237,2.0,v129,v238
M v[12:15],a[196:199],a[120:123],v[12:15]
v_fma_f32 v129,s40,v129,v238
v_cvt_pk_bf16_f32 v232,v232,v237
M v[12:15],a[216:219],a[248:251],v[12:15]
buffer_store_dwordx4 a[0:3],v253,s[24:27],s34 offen offset:384 nt
M v[16:19],a[216:219],a[120:123],v[16:19]
ds_read_b128 a[120:123],v249 offset:2048
v_cvt_pk_bf16_f32 v234,v234,v236
M v[16:19],a[196:199],a[228:231],v[16:19]
s_waitcnt lgkmcnt(2)
ds_read_b128 a[208:211],v248 offset:2048
v_accvgpr_read_b32 v238,a34
M v[16:19],a[108:111],a[116:119],v[16:19]
s_waitcnt lgkmcnt(2)
v_accvgpr_read_b32 v233,a130
v_add_f32 v235,v238,v233
M v[20:23],a[108:111],v[228:231],v[20:23]
s_add_u32 s46,s73,46080
v_sub_f32 v238,v238,v233
v_add_f32 v233,v34,v130
M v[20:23],a[196:199],a[116:119],v[20:23]
ds_read_b128 a[252:255],v248 offset:17408
v_sub_f32 v130,v34,v130
M v[20:23],a[216:219],a[228:231],v[20:23]
ds_read_b128 a[248:251],v249 offset:17408
v_add_f32 v34,v235,v233
M v[24:27],a[216:219],a[116:119],v[24:27]
ds_read_b128 a[116:119],v248 offset:17920
v_fmac_f32 v235,4.0,v233
M v[24:27],a[196:199],v[228:231],v[24:27]
s_waitcnt lgkmcnt(4)
ds_read_b128 a[228:231],v249 offset:17920
v_fma_f32 v233,2.0,v130,v238
M v[24:27],a[108:111],a[120:123],v[24:27]
s_waitcnt lgkmcnt(4)
v_fma_f32 v130,s40,v130,v238
v_accvgpr_read_b32 v238,a35
M v[28:31],a[108:111],a[208:211],v[28:31]
buffer_load_dwordx4 a[108:111],v250,s[20:23],s46 offen offset:0 sc1
M v[28:31],a[196:199],a[120:123],v[28:31]
v_accvgpr_read_b32 v237,a131
v_add_f32 v236,v238,v237
M v[28:31],a[216:219],v[228:231],v[28:31]
s_waitcnt vmcnt(19) lgkmcnt(3)
buffer_load_dwordx4 a[208:211],v250,s[20:23],s46 offen offset:1024 sc1
M v[0:3],a[220:223],a[252:255],v[0:3]
s_waitcnt vmcnt(19) lgkmcnt(2)
ds_read_b128 a[128:131],v248 offset:18432
v_sub_f32 v238,v238,v237
M v[0:3],v[224:227],a[248:251],v[0:3]
s_waitcnt vmcnt(18) lgkmcnt(2)
ds_read_b128 a[196:199],v249 offset:18432
v_add_f32 v237,v35,v131
M v[0:3],a[204:207],a[116:119],v[0:3]
s_waitcnt lgkmcnt(2)
s_add_u32 s34,s32,196608
v_sub_f32 v131,v35,v131
v_add_f32 v35,v236,v237
M v[4:7],a[204:207],a[228:231],v[4:7]
buffer_load_dwordx4 a[120:123],v250,s[20:23],s46 offen offset:2048 sc1
M v[4:7],v[224:227],a[116:119],v[4:7]
v_fmac_f32 v236,4.0,v237
v_fma_f32 v237,2.0,v131,v238
M v[4:7],a[220:223],a[248:251],v[4:7]
v_fma_f32 v131,s40,v131,v238
v_cvt_pk_bf16_f32 v233,v233,v237
M v[8:11],a[220:223],a[116:119],v[8:11]
ds_read_b128 a[116:119],v248 offset:18944
v_cvt_pk_bf16_f32 v235,v235,v236
M v[8:11],v[224:227],a[228:231],v[8:11]
s_waitcnt lgkmcnt(2)
ds_read_b128 a[216:219],v249 offset:18944
ds_write2st64_b64 v254,v[232:233],v[234:235] offset0:34 offset1:38
M v[8:11],a[204:207],a[128:131],v[8:11]
s_waitcnt lgkmcnt(3)
buffer_store_dwordx4 a[4:7],v253,s[24:27],s34 offen offset:384 nt
M v[12:15],a[204:207],a[196:199],v[12:15]
v_accvgpr_read_b32 v204,a36
v_accvgpr_read_b32 v208,a132
M v[12:15],v[224:227],a[128:131],v[12:15]
v_accvgpr_read_b32 v205,a37
v_accvgpr_read_b32 v209,a133
M v[12:15],a[220:223],a[228:231],v[12:15]
v_accvgpr_read_b32 v206,a38
v_accvgpr_read_b32 v210,a134
v_accvgpr_read_b32 v207,a39
v_accvgpr_read_b32 v211,a135
v_pk_add_f32 v[212:213],v[204:205],v[208:209]
v_pk_add_f32 v[214:215],v[206:207],v[210:211]
v_pk_add_f32 v[204:205],v[204:205],v[208:209] neg_lo:[0,1] neg_hi:[0,1]
v_pk_add_f32 v[206:207],v[206:207],v[210:211] neg_lo:[0,1] neg_hi:[0,1]
v_pk_add_f32 v[208:209],v[36:37],v[132:133]
v_pk_add_f32 v[210:211],v[38:39],v[134:135]
v_pk_add_f32 v[132:133],v[36:37],v[132:133] neg_lo:[0,1] neg_hi:[0,1]
v_pk_add_f32 v[134:135],v[38:39],v[134:135] neg_lo:[0,1] neg_hi:[0,1]
v_pk_add_f32 v[36:37],v[212:213],v[208:209]
v_pk_add_f32 v[38:39],v[214:215],v[210:211]
v_pk_fma_f32 v[212:213],v[208:209],4.0,v[212:213] op_sel_hi:[1,0,1]
v_pk_fma_f32 v[214:215],v[210:211],4.0,v[214:215] op_sel_hi:[1,0,1]
v_pk_fma_f32 v[208:209],v[132:133],2.0,v[204:205] op_sel_hi:[1,0,1]
v_pk_fma_f32 v[210:211],v[134:135],2.0,v[206:207] op_sel_hi:[1,0,1]
v_pk_fma_f32 v[132:133],v[132:133],s[40:41],v[204:205] op_sel_hi:[1,0,1]
v_pk_fma_f32 v[134:135],v[134:135],s[40:41],v[206:207] op_sel_hi:[1,0,1]
M v[16:19],a[220:223],a[128:131],v[16:19]
s_add_u32 s47,s73,49152
ds_read_b128 a[128:131],v249 offset:19456
v_cvt_pk_bf16_f32 v208,v208,v209
M v[16:19],v[224:227],a[196:199],v[16:19]
s_waitcnt lgkmcnt(3)
ds_read_b128 v[228:231],v248 offset:19456
v_cvt_pk_bf16_f32 v209,v210,v211
M v[16:19],a[204:207],a[116:119],v[16:19]
s_waitcnt lgkmcnt(3)
v_cvt_pk_bf16_f32 v212,v212,v213
v_cvt_pk_bf16_f32 v213,v214,v215
M v[20:23],a[204:207],a[216:219],v[20:23]
ds_write2st64_b64 v254,v[208:209],v[212:213] offset0:42 offset1:46
M v[20:23],v[224:227],a[116:119],v[20:23]
ds_read_b128 a[132:135],v248 offset:34816
v_accvgpr_read_b32 v204,a40
M v[20:23],a[220:223],a[196:199],v[20:23]
ds_read_b128 a[252:255],v249 offset:34816
v_accvgpr_read_b32 v208,a136
M v[24:27],a[220:223],a[116:119],v[24:27]
buffer_load_dwordx4 a[116:119],v250,s[20:23],s47 offen offset:0 sc1
M v[24:27],v[224:227],a[216:219],v[24:27]
s_waitcnt lgkmcnt(4)
ds_read_b128 a[248:251],v248 offset:35328
ds_read_b128 a[228:231],v249 offset:35328
M v[24:27],a[204:207],a[128:131],v[24:27]
s_waitcnt lgkmcnt(5)
s_add_u32 s34,s32,393216
buffer_store_dwordx4 a[8:11],v253,s[24:27],s34 offen offset:384 nt
M v[28:31],a[204:207],v[228:231],v[28:31]
v_accvgpr_read_b32 v205,a41
v_accvgpr_read_b32 v209,a137
M v[28:31],v[224:227],a[128:131],v[28:31]
v_accvgpr_read_b32 v206,a42
v_accvgpr_read_b32 v210,a138
v_accvgpr_read_b32 v207,a43
v_accvgpr_read_b32 v211,a139
v_pk_add_f32 v[212:213],v[204:205],v[208:209]
v_pk_add_f32 v[214:215],v[206:207],v[210:211]
v_pk_add_f32 v[204:205],v[204:205],v[208:209] neg_lo:[0,1] neg_hi:[0,1]
v_pk_add_f32 v[206:207],v[206:207],v[210:211] neg_lo:[0,1] neg_hi:[0,1]
v_pk_add_f32 v[208:209],v[40:41],v[136:137]
v_pk_add_f32 v[210:211],v[42:43],v[138:139]
v_pk_add_f32 v[136:137],v[40:41],v[136:137] neg_lo:[0,1] neg_hi:[0,1]
v_pk_add_f32 v[138:139],v[42:43],v[138:139] neg_lo:[0,1] neg_hi:[0,1]
v_pk_add_f32 v[40:41],v[212:213],v[208:209]
v_pk_add_f32 v[42:43],v[214:215],v[210:211]
v_pk_fma_f32 v[212:213],v[208:209],4.0,v[212:213] op_sel_hi:[1,0,1]
v_pk_fma_f32 v[214:215],v[210:211],4.0,v[214:215] op_sel_hi:[1,0,1]
v_pk_fma_f32 v[208:209],v[136:137],2.0,v[204:205] op_sel_hi:[1,0,1]
v_pk_fma_f32 v[210:211],v[138:139],2.0,v[206:207] op_sel_hi:[1,0,1]
v_pk_fma_f32 v[136:137],v[136:137],s[40:41],v[204:205] op_sel_hi:[1,0,1]
v_pk_fma_f32 v[138:139],v[138:139],s[40:41],v[206:207] op_sel_hi:[1,0,1]
M v[28:31],a[220:223],a[216:219],v[28:31]
s_waitcnt vmcnt(21) lgkmcnt(3)
buffer_load_dwordx4 a[196:199],v250,s[20:23],s47 offen offset:1024 sc1
M v[0:3],a[244:247],a[132:135],v[0:3]
s_waitcnt vmcnt(21) lgkmcnt(2)
ds_read_b128 a[128:131],v248 offset:35840
v_cvt_pk_bf16_f32 v208,v208,v209
M v[0:3],a[104:107],a[252:255],v[0:3]
s_waitcnt vmcnt(20) lgkmcnt(2)
buffer_load_dwordx4 a[204:207],v250,s[20:23],s47 offen offset:2048 sc1
M v[0:3],a[100:103],a[248:251],v[0:3]
s_waitcnt lgkmcnt(1)
ds_read_b128 a[132:135],v249 offset:35840
v_cvt_pk_bf16_f32 v209,v210,v211
M v[4:7],a[100:103],a[228:231],v[4:7]
v_cvt_pk_bf16_f32 v212,v212,v213
v_cvt_pk_bf16_f32 v213,v214,v215
M v[4:7],a[104:107],a[248:251],v[4:7]
ds_write2st64_b64 v254,v[208:209],v[212:213] offset0:51 offset1:55
M v[4:7],a[244:247],a[252:255],v[4:7]
v_accvgpr_read_b32 v204,a44
v_accvgpr_read_b32 v208,a140
M v[8:11],a[244:247],a[248:251],v[8:11]
ds_read_b128 a[136:139],v248 offset:36352
v_accvgpr_read_b32 v205,a45
M v[8:11],a[104:107],a[228:231],v[8:11]
s_waitcnt lgkmcnt(3)
ds_read_b128 v[228:231],v249 offset:36352
v_accvgpr_read_b32 v209,a141
M v[8:11],a[100:103],a[128:131],v[8:11]
s_waitcnt lgkmcnt(3)
v_accvgpr_read_b32 v206,a46
v_accvgpr_read_b32 v210,a142
v_accvgpr_read_b32 v207,a47
v_accvgpr_read_b32 v211,a143
v_pk_add_f32 v[212:213],v[204:205],v[208:209]
v_pk_add_f32 v[214:215],v[206:207],v[210:211]
v_pk_add_f32 v[204:205],v[204:205],v[208:209] neg_lo:[0,1] neg_hi:[0,1]
v_pk_add_f32 v[206:207],v[206:207],v[210:211] neg_lo:[0,1] neg_hi:[0,1]
v_pk_add_f32 v[208:209],v[44:45],v[140:141]
v_pk_add_f32 v[210:211],v[46:47],v[142:143]
v_pk_add_f32 v[140:141],v[44:45],v[140:141] neg_lo:[0,1] neg_hi:[0,1]
v_pk_add_f32 v[142:143],v[46:47],v[142:143] neg_lo:[0,1] neg_hi:[0,1]
v_pk_add_f32 v[44:45],v[212:213],v[208:209]
v_pk_add_f32 v[46:47],v[214:215],v[210:211]
v_pk_fma_f32 v[212:213],v[208:209],4.0,v[212:213] op_sel_hi:[1,0,1]
v_pk_fma_f32 v[214:215],v[210:211],4.0,v[214:215] op_sel_hi:[1,0,1]
v_pk_fma_f32 v[208:209],v[140:141],2.0,v[204:205] op_sel_hi:[1,0,1]
v_pk_fma_f32 v[210:211],v[142:143],2.0,v[206:207] op_sel_hi:[1,0,1]
v_pk_fma_f32 v[140:141],v[140:141],s[40:41],v[204:205] op_sel_hi:[1,0,1]
v_pk_fma_f32 v[142:143],v[142:143],s[40:41],v[206:207] op_sel_hi:[1,0,1]
M v[12:15],a[100:103],a[132:135],v[12:15]
v_cvt_pk_bf16_f32 v208,v208,v209
v_cvt_pk_bf16_f32 v209,v210,v211
M v[12:15],a[104:107],a[128:131],v[12:15]
v_cvt_pk_bf16_f32 v212,v212,v213
v_cvt_pk_bf16_f32 v213,v214,v215
M v[12:15],a[244:247],a[228:231],v[12:15]
ds_write2st64_b64 v254,v[208:209],v[212:213] offset0:59 offset1:63
M v[16:19],a[244:247],a[128:131],v[16:19]
s_add_u32 s46,s74,46080
ds_read_b128 a[128:131],v249 offset:36864
v_accvgpr_read_b32 v238,a48
M v[16:19],a[104:107],a[132:135],v[16:19]
s_waitcnt lgkmcnt(3)
ds_read_b128 v[224:227],v248 offset:36864
v_accvgpr_read_b32 v232,a144
M v[16:19],a[100:103],a[136:139],v[16:19]
s_waitcnt lgkmcnt(3)
s_add_u32 s34,s32,589824
buffer_store_dwordx4 a[12:15],v253,s[24:27],s34 offen offset:384 nt
M v[20:23],a[100:103],v[228:231],v[20:23]
v_add_f32 v234,v238,v232
v_sub_f32 v238,v238,v232
M v[20:23],a[104:107],a[136:139],v[20:23]
ds_read_b128 a[140:143],v248 offset:52224
v_add_f32 v232,v48,v144
M v[20:23],a[244:247],a[132:135],v[20:23]
ds_read_b128 a[132:135],v249 offset:52224
v_sub_f32 v144,v48,v144
M v[24:27],a[244:247],a[136:139],v[24:27]
buffer_load_dwordx4 a[136:139],v250,s[20:23],s46 offen offset:0 sc1
M v[24:27],a[104:107],v[228:231],v[24:27]
s_waitcnt lgkmcnt(3)
ds_read_b128 a[216:219],v248 offset:52736
ds_read_b128 a[252:255],v249 offset:52736
M v[24:27],a[100:103],a[128:131],v[24:27]
s_waitcnt lgkmcnt(4)
buffer_load_dwordx4 a[220:223],v250,s[20:23],s46 offen offset:1024 sc1
M v[28:31],a[100:103],v[224:227],v[28:31]
v_add_f32 v48,v234,v232
v_fmac_f32 v234,4.0,v232
M v[28:31],a[104:107],a[128:131],v[28:31]
v_fma_f32 v232,2.0,v144,v238
v_fma_f32 v144,s40,v144,v238
M v[28:31],a[244:247],v[228:231],v[28:31]
s_waitcnt vmcnt(23) lgkmcnt(3)
v_accvgpr_read_b32 v238,a49
v_accvgpr_read_b32 v237,a145
M v[0:3],v[216:219],a[140:143],v[0:3]
s_waitcnt vmcnt(22) lgkmcnt(2)
buffer_load_dwordx4 a[248:251],v250,s[20:23],s46 offen offset:2048 sc1
M v[0:3],a[240:243],a[132:135],v[0:3]
s_waitcnt vmcnt(22) lgkmcnt(1)
ds_read_b128 a[100:103],v248 offset:53248
ds_read_b128 a[104:107],v249 offset:53248
M v[0:3],a[212:215],a[216:219],v[0:3]
s_waitcnt lgkmcnt(2)
v_add_f32 v236,v238,v237
v_sub_f32 v238,v238,v237
M v[4:7],a[212:215],a[252:255],v[4:7]
v_add_f32 v237,v49,v145
v_sub_f32 v145,v49,v145
M v[4:7],a[240:243],a[216:219],v[4:7]
v_add_f32 v49,v236,v237
v_fmac_f32 v236,4.0,v237
M v[4:7],v[216:219],a[132:135],v[4:7]
v_fma_f32 v237,2.0,v145,v238
v_fma_f32 v145,s40,v145,v238
M v[8:11],v[216:219],a[216:219],v[8:11]
ds_read_b128 a[128:131],v248 offset:53760
v_cvt_pk_bf16_f32 v232,v232,v237
M v[8:11],a[240:243],a[252:255],v[8:11]
s_waitcnt lgkmcnt(2)
ds_read_b128 a[132:135],v249 offset:53760
v_cvt_pk_bf16_f32 v234,v234,v236
M v[8:11],a[212:215],a[100:103],v[8:11]
s_waitcnt lgkmcnt(2)
s_add_u32 s34,s32,786432
buffer_store_dwordx4 a[16:19],v253,s[24:27],s34 offen offset:384 nt
M v[12:15],a[212:215],a[104:107],v[12:15]
v_accvgpr_read_b32 v238,a50
v_accvgpr_read_b32 v233,a146
M v[12:15],a[240:243],a[100:103],v[12:15]
v_add_f32 v235,v238,v233
v_sub_f32 v238,v238,v233
M v[12:15],v[216:219],a[252:255],v[12:15]
v_add_f32 v233,v50,v146
v_sub_f32 v146,v50,v146
M v[16:19],v[216:219],a[100:103],v[16:19]
s_add_u32 s47,s74,49152
ds_read_b128 a[100:103],v249 offset:54272
v_add_f32 v50,v235,v233
M v[16:19],a[240:243],a[104:107],v[16:19]
s_waitcnt lgkmcnt(2)
ds_read_b128 a[140:143],v248 offset:54272
v_add_u32 v248,0xfffece00,v248
M v[16:19],a[212:215],a[128:131],v[16:19]
s_waitcnt lgkmcnt(2)
v_add_u32 v249,0xfffece00,v249
v_fmac_f32 v235,4.0,v233
M v[20:23],a[212:215],a[132:135],v[20:23]
v_fma_f32 v233,2.0,v146,v238
v_fma_f32 v146,s40,v146,v238
M v[20:23],a[240:243],a[128:131],v[20:23]
ds_read_b128 a[228:231],v248 offset:60928
v_accvgpr_read_b32 v238,a51
M v[20:23],v[216:219],a[104:107],v[20:23]
ds_read_b128 a[104:107],v249 offset:60928
v_accvgpr_read_b32 v237,a147
M v[24:27],v[216:219],a[128:131],v[24:27]
buffer_load_dwordx4 a[128:131],v250,s[20:23],s47 offen offset:0 sc1
M v[24:27],a[240:243],a[132:135],v[24:27]
s_waitcnt lgkmcnt(3)
ds_read_b128 v[224:227],v248 offset:61440
ds_read_b128 v[228:231],v249 offset:61440
M v[24:27],a[212:215],a[100:103],v[24:27]
s_waitcnt lgkmcnt(4)
buffer_load_dwordx4 a[244:247],v250,s[20:23],s47 offen offset:1024 sc1
M v[28:31],a[212:215],a[140:143],v[28:31]
v_add_f32 v236,v238,v237
v_sub_f32 v238,v238,v237
M v[28:31],a[240:243],a[100:103],v[28:31]
v_add_f32 v237,v51,v147
v_sub_f32 v147,v51,v147
M v[28:31],v[216:219],a[132:135],v[28:31]
s_waitcnt vmcnt(24) lgkmcnt(3)
v_add_f32 v51,v236,v237
v_fmac_f32 v236,4.0,v237
M v[0:3],a[224:227],a[228:231],v[0:3]
s_waitcnt vmcnt(23) lgkmcnt(2)
buffer_load_dwordx4 a[216:219],v250,s[20:23],s47 offen offset:2048 sc1
M v[0:3],a[96:99],a[104:107],v[0:3]
s_waitcnt vmcnt(23) lgkmcnt(1)
ds_read_b128 a[100:103],v248 offset:61952
ds_read_b128 a[132:135],v249 offset:61952
M v[0:3],a[200:203],v[224:227],v[0:3]
s_waitcnt lgkmcnt(2)
s_add_u32 s34,s32,983040
v_fma_f32 v237,2.0,v147,v238
v_fma_f32 v147,s40,v147,v238
M v[4:7],a[200:203],v[228:231],v[4:7]
v_cvt_pk_bf16_f32 v233,v233,v237
v_cvt_pk_bf16_f32 v235,v235,v236
M v[4:7],a[96:99],v[224:227],v[4:7]
ds_write2st64_b64 v254,v[232:233],v[234:235] offset0:102 offset1:106
M v[4:7],a[224:227],a[104:107],v[4:7]
buffer_store_dwordx4 a[20:23],v253,s[24:27],s34 offen offset:384 nt
M v[8:11],a[224:227],v[224:227],v[8:11]
ds_read_b128 a[104:107],v248 offset:62464
v_accvgpr_read_b32 v204,a52
M v[8:11],a[96:99],v[228:231],v[8:11]
s_waitcnt lgkmcnt(3)
ds_read_b128 a[140:143],v249 offset:62464
v_accvgpr_read_b32 v208,a148
M v[8:11],a[200:203],a[100:103],v[8:11]
s_waitcnt lgkmcnt(3)
v_accvgpr_read_b32 v205,a53
v_accvgpr_read_b32 v209,a149
M v[12:15],a[200:203],a[132:135],v[12:15]
v_accvgpr_read_b32 v206,a54
v_accvgpr_read_b32 v210,a150
v_accvgpr_read_b32 v207,a55
v_accvgpr_read_b32 v211,a151
v_pk_add_f32 v[212:213],v[204:205],v[208:209]
v_pk_add_f32 v[214:215],v[206:207],v[210:211]
v_pk_add_f32 v[204:205],v[204:205],v[208:209] neg_lo:[0,1] neg_hi:[0,1]
v_pk_add_f32 v[206:207],v[206:207],v[210:211] neg_lo:[0,1] neg_hi:[0,1]
v_pk_add_f32 v[208:209],v[52:53],v[148:149]
v_pk_add_f32 v[210:211],v[54:55],v[150:151]
v_pk_add_f32 v[148:149],v[52:53],v[148:149] neg_lo:[0,1] neg_hi:[0,1]
v_pk_add_f32 v[150:151],v[54:55],v[150:151] neg_lo:[0,1] neg_hi:[0,1]
v_pk_add_f32 v[52:53],v[212:213],v[208:209]
v_pk_add_f32 v[54:55],v[214:215],v[210:211]
v_pk_fma_f32 v[212:213],v[208:209],4.0,v[212:213] op_sel_hi:[1,0,1]
v_pk_fma_f32 v[214:215],v[210:211],4.0,v[214:215] op_sel_hi:[1,0,1]
v_pk_fma_f32 v[208:209],v[148:149],2.0,v[204:205] op_sel_hi:[1,0,1]
v_pk_fma_f32 v[210:211],v[150:151],2.0,v[206:207] op_sel_hi:[1,0,1]
v_pk_fma_f32 v[148:149],v[148:149],s[40:41],v[204:205] op_sel_hi:[1,0,1]
v_pk_fma_f32 v[150:151],v[150:151],s[40:41],v[206:207] op_sel_hi:[1,0,1]
M v[12:15],a[96:99],a[100:103],v[12:15]
v_cvt_pk_bf16_f32 v208,v208,v209
v_cvt_pk_bf16_f32 v209,v210,v211
M v[12:15],a[224:227],v[228:231],v[12:15]
v_cvt_pk_bf16_f32 v212,v212,v213
v_cvt_pk_bf16_f32 v213,v214,v215
M v[16:19],a[224:227],a[100:103],v[16:19]
s_add_u32 s46,s75,46080
ds_read_b128 a[100:103],v249 offset:62976
ds_write2st64_b64 v254,v[208:209],v[212:213] offset0:110 offset1:114
M v[16:19],a[96:99],a[132:135],v[16:19]
s_waitcnt lgkmcnt(3)
ds_read_b128 a[144:147],v248 offset:62976
v_accvgpr_read_b32 v204,a56
M v[16:19],a[200:203],a[104:107],v[16:19]
s_waitcnt lgkmcnt(3)
v_accvgpr_read_b32 v208,a152
v_accvgpr_read_b32 v205,a57
M v[20:23],a[200:203],a[140:143],v[20:23]
v_accvgpr_read_b32 v209,a153
v_accvgpr_read_b32 v206,a58
M v[20:23],a[96:99],a[104:107],v[20:23]
ds_read_b128 a[148:151],v248 offset:0
v_accvgpr_read_b32 v210,a154
v_accvgpr_read_b32 v207,a59
v_accvgpr_read_b32 v211,a155
v_pk_add_f32 v[212:213],v[204:205],v[208:209]
v_pk_add_f32 v[214:215],v[206:207],v[210:211]
v_pk_add_f32 v[204:205],v[204:205],v[208:209] neg_lo:[0,1] neg_hi:[0,1]
v_pk_add_f32 v[206:207],v[206:207],v[210:211] neg_lo:[0,1] neg_hi:[0,1]
v_pk_add_f32 v[208:209],v[56:57],v[152:153]
v_pk_add_f32 v[210:211],v[58:59],v[154:155]
v_pk_add_f32 v[152:153],v[56:57],v[152:153] neg_lo:[0,1] neg_hi:[0,1]
v_pk_add_f32 v[154:155],v[58:59],v[154:155] neg_lo:[0,1] neg_hi:[0,1]
v_pk_add_f32 v[56:57],v[212:213],v[208:209]
v_pk_add_f32 v[58:59],v[214:215],v[210:211]
v_pk_fma_f32 v[212:213],v[208:209],4.0,v[212:213] op_sel_hi:[1,0,1]
v_pk_fma_f32 v[214:215],v[210:211],4.0,v[214:215] op_sel_hi:[1,0,1]
v_pk_fma_f32 v[208:209],v[152:153],2.0,v[204:205] op_sel_hi:[1,0,1]
v_pk_fma_f32 v[210:211],v[154:155],2.0,v[206:207] op_sel_hi:[1,0,1]
v_pk_fma_f32 v[152:153],v[152:153],s[40:41],v[204:205] op_sel_hi:[1,0,1]
v_pk_fma_f32 v[154:155],v[154:155],s[40:41],v[206:207] op_sel_hi:[1,0,1]
M v[20:23],a[224:227],a[132:135],v[20:23]
ds_read_b128 a[132:135],v249 offset:0
v_cvt_pk_bf16_f32 v208,v208,v209
M v[24:27],a[224:227],a[104:107],v[24:27]
buffer_load_dwordx4 a[104:107],v250,s[20:23],s46 offen offset:0 sc1
M v[24:27],a[96:99],a[140:143],v[24:27]
s_waitcnt lgkmcnt(4)
ds_read_b128 a[252:255],v248 offset:512
ds_read_b128 a[240:243],v249 offset:512
M v[24:27],a[200:203],a[100:103],v[24:27]
s_waitcnt lgkmcnt(4)
s_add_u32 s34,s32,1179648
buffer_load_dwordx4 a[212:215],v250,s[20:23],s46 offen offset:1024 sc1
M v[28:31],a[200:203],a[144:147],v[28:31]
v_cvt_pk_bf16_f32 v209,v210,v211
v_cvt_pk_bf16_f32 v212,v212,v213
M v[28:31],a[96:99],a[100:103],v[28:31]
v_cvt_pk_bf16_f32 v213,v214,v215
M v[28:31],a[224:227],a[140:143],v[28:31]
s_waitcnt vmcnt(25) lgkmcnt(3)
ds_write2st64_b64 v254,v[208:209],v[212:213] offset0:119 offset1:123
M v[96:99],a[236:239],a[148:151],v[96:99]
s_waitcnt vmcnt(24) lgkmcnt(3)
buffer_load_dwordx4 v[216:219],v250,s[20:23],s46 offen offset:2048 sc1
M v[96:99],a[232:235],a[132:135],v[96:99]
s_waitcnt vmcnt(24) lgkmcnt(2)
ds_read_b128 a[96:99],v248 offset:1024
ds_read_b128 a[100:103],v249 offset:1024
M v[96:99],a[192:195],a[252:255],v[96:99]
s_waitcnt lgkmcnt(3)
v_accvgpr_read_b32 v204,a60
v_accvgpr_read_b32 v208,a156
M v[100:103],a[192:195],a[240:243],v[100:103]
v_accvgpr_read_b32 v205,a61
v_accvgpr_read_b32 v209,a157
M v[100:103],a[232:235],a[252:255],v[100:103]
v_accvgpr_read_b32 v206,a62
v_accvgpr_read_b32 v210,a158
v_accvgpr_read_b32 v207,a63
v_accvgpr_read_b32 v211,a159
v_pk_add_f32 v[212:213],v[204:205],v[208:209]
v_pk_add_f32 v[214:215],v[206:207],v[210:211]
v_pk_add_f32 v[204:205],v[204:205],v[208:209] neg_lo:[0,1] neg_hi:[0,1]
v_pk_add_f32 v[206:207],v[206:207],v[210:211] neg_lo:[0,1] neg_hi:[0,1]
v_pk_add_f32 v[208:209],v[60:61],v[156:157]
v_pk_add_f32 v[210:211],v[62:63],v[158:159]
v_pk_add_f32 v[156:157],v[60:61],v[156:157] neg_lo:[0,1] neg_hi:[0,1]
v_pk_add_f32 v[158:159],v[62:63],v[158:159] neg_lo:[0,1] neg_hi:[0,1]
v_pk_add_f32 v[60:61],v[212:213],v[208:209]
v_pk_add_f32 v[62:63],v[214:215],v[210:211]
v_pk_fma_f32 v[212:213],v[208:209],4.0,v[212:213] op_sel_hi:[1,0,1]
v_pk_fma_f32 v[214:215],v[210:211],4.0,v[214:215] op_sel_hi:[1,0,1]
v_pk_fma_f32 v[208:209],v[156:157],2.0,v[204:205] op_sel_hi:[1,0,1]
v_pk_fma_f32 v[210:211],v[158:159],2.0,v[206:207] op_sel_hi:[1,0,1]
v_pk_fma_f32 v[156:157],v[156:157],s[40:41],v[204:205] op_sel_hi:[1,0,1]
v_pk_fma_f32 v[158:159],v[158:159],s[40:41],v[206:207] op_sel_hi:[1,0,1]
M v[100:103],a[236:239],a[132:135],v[100:103]
buffer_store_dwordx4 a[24:27],v253,s[24:27],s34 offen offset:384 nt
M v[104:107],a[236:239],a[252:255],v[104:107]
ds_read_b128 a[140:143],v248 offset:1536
v_cvt_pk_bf16_f32 v208,v208,v209
M v[104:107],a[232:235],a[240:243],v[104:107]
s_waitcnt lgkmcnt(2)
ds_read_b128 a[144:147],v249 offset:1536
v_cvt_pk_bf16_f32 v209,v210,v211
M v[104:107],a[192:195],a[96:99],v[104:107]
s_waitcnt lgkmcnt(2)
v_cvt_pk_bf16_f32 v212,v212,v213
v_cvt_pk_bf16_f32 v213,v214,v215
M v[108:111],a[192:195],a[100:103],v[108:111]
ds_write2st64_b64 v254,v[208:209],v[212:213] offset0:127 offset1:131
M v[108:111],a[232:235],a[96:99],v[108:111]
s_add_u32 s28,s66,6684672
buffer_load_dwordx2 v[204:205],v245,s[12:15],s28 offen offset:0
M v[108:111],a[236:239],a[240:243],v[108:111]
v_cvt_pk_bf16_f32 v0,v0,v1
v_cvt_pk_bf16_f32 v1,v2,v3
M v[112:115],a[236:239],a[96:99],v[112:115]
s_add_u32 s47,s75,49152
buffer_load_dwordx2 v[214:215],v245,s[16:19],s28 offen offset:1536
M v[112:115],a[232:235],a[100:103],v[112:115]
s_waitcnt lgkmcnt(2)
ds_read_b128 a[152:155],v249 offset:2048
ds_read_b128 a[156:159],v248 offset:2048
M v[112:115],a[192:195],a[140:143],v[112:115]
s_waitcnt lgkmcnt(3)
s_add_u32 s34,s32,1376256
v_cvt_pk_bf16_f32 v4,v4,v5
v_cvt_pk_bf16_f32 v5,v6,v7
M v[116:119],a[192:195],a[144:147],v[116:119]
s_waitcnt lgkmcnt(2)
s_barrier
ds_read_b128 a[32:35],v250 offset:17408
M v[116:119],a[232:235],a[140:143],v[116:119]
buffer_load_dwordx2 v[206:207],v245,s[8:11],s28 offen offset:0
M v[116:119],a[236:239],a[100:103],v[116:119]
ds_read_b128 a[36:39],v250 offset:21504
ds_read_b128 a[40:43],v250 offset:26112
M v[120:123],a[236:239],a[140:143],v[120:123]
ds_read_b128 a[44:47],v250 offset:30208
ds_read_b128 a[48:51],v250 offset:52224
M v[120:123],a[232:235],a[144:147],v[120:123]
s_waitcnt lgkmcnt(6)
ds_read_b128 a[52:55],v250 offset:56320
ds_read_b128 a[56:59],v250 offset:60928
M v[120:123],a[192:195],a[152:155],v[120:123]
s_waitcnt lgkmcnt(7)
buffer_load_dwordx2 v[208:209],v245,s[8:11],s28 offen offset:384
M v[124:127],a[192:195],a[156:159],v[124:127]
ds_read_b128 a[60:63],v250 offset:65024
ds_write2st64_b64 v254,v[0:1],v[4:5] offset0:68 offset1:72
M v[124:127],a[232:235],a[152:155],v[124:127]
v_cvt_pk_bf16_f32 v8,v8,v9
v_cvt_pk_bf16_f32 v9,v10,v11
M v[124:127],a[236:239],a[144:147],v[124:127]
s_waitcnt vmcnt(28)
buffer_load_dwordx2 v[210:211],v245,s[8:11],s28 offen offset:768
M v[128:131],a[112:115],a[148:151],v[128:131]
s_waitcnt vmcnt(28)
v_cvt_pk_bf16_f32 v12,v12,v13
v_cvt_pk_bf16_f32 v13,v14,v15
M v[128:131],v[220:223],a[132:135],v[128:131]
s_waitcnt vmcnt(27)
ds_write2st64_b64 v254,v[8:9],v[12:13] offset0:76 offset1:80
M v[128:131],a[124:127],a[252:255],v[128:131]
v_cvt_pk_bf16_f32 v16,v16,v17
v_cvt_pk_bf16_f32 v17,v18,v19
M v[132:135],a[124:127],a[240:243],v[132:135]
buffer_load_dwordx2 v[212:213],v245,s[8:11],s28 offen offset:1152
M v[132:135],v[220:223],a[252:255],v[132:135]
v_cvt_pk_bf16_f32 v20,v20,v21
v_cvt_pk_bf16_f32 v21,v22,v23
M v[132:135],a[112:115],a[132:135],v[132:135]
ds_write2st64_b64 v254,v[16:17],v[20:21] offset0:85 offset1:89
M v[136:139],a[112:115],a[252:255],v[136:139]
buffer_load_dwordx4 a[228:231],v250,s[20:23],s47 offen offset:0 sc1
M v[136:139],v[220:223],a[240:243],v[136:139]
v_cvt_pk_bf16_f32 v24,v24,v25
v_cvt_pk_bf16_f32 v25,v26,v27
M v[136:139],a[124:127],a[96:99],v[136:139]
v_cvt_pk_bf16_f32 v28,v28,v29
v_cvt_pk_bf16_f32 v29,v30,v31
M v[140:143],a[124:127],a[100:103],v[140:143]
ds_write2st64_b64 v254,v[24:25],v[28:29] offset0:93 offset1:97
M v[140:143],v[220:223],a[96:99],v[140:143]
buffer_load_dwordx4 v[224:227],v250,s[20:23],s47 offen offset:1024 sc1
M v[140:143],a[112:115],a[240:243],v[140:143]
v_accvgpr_read_b32 v238,a64
v_accvgpr_read_b32 v232,a160
M v[144:147],a[112:115],a[96:99],v[144:147]
v_add_f32 v234,v238,v232
v_sub_f32 v238,v238,v232
M v[144:147],v[220:223],a[100:103],v[144:147]
buffer_load_dwordx4 v[228:231],v250,s[20:23],s47 offen offset:2048 sc1
M v[144:147],a[124:127],a[140:143],v[144:147]
s_add_u32 s46,s76,46080
v_add_u32 v248,0x15400,v248
v_add_u32 v249,0x15400,v249
M v[148:151],a[124:127],a[144:147],v[148:151]
v_add_f32 v232,v64,v160
v_sub_f32 v160,v64,v160
M v[148:151],v[220:223],a[140:143],v[148:151]
ds_read_b128 a[96:99],v248 offset:0
v_add_f32 v64,v234,v232
M v[148:151],a[112:115],a[100:103],v[148:151]
buffer_store_dwordx4 a[28:31],v253,s[24:27],s34 offen offset:384 nt
M v[152:155],a[112:115],a[140:143],v[152:155]
s_add_u32 s34,s32,0
ds_read_b128 a[100:103],v249 offset:0
ds_read_b128 a[140:143],v248 offset:512
M v[152:155],v[220:223],a[144:147],v[152:155]
ds_read_b128 a[200:203],v249 offset:512
v_fmac_f32 v234,4.0,v232
M v[152:155],a[124:127],a[152:155],v[152:155]
s_waitcnt lgkmcnt(15)
buffer_store_dwordx4 a[32:35],v253,s[24:27],s34 offen offset:512 nt
M v[156:159],a[124:127],a[156:159],v[156:159]
v_fma_f32 v232,2.0,v160,v238
v_fma_f32 v160,s40,v160,v238
M v[156:159],v[220:223],a[152:155],v[156:159]
s_waitcnt lgkmcnt(4)
s_barrier
ds_read_b128 v[0:3],v250 offset:34816
M v[156:159],a[112:115],a[144:147],v[156:159]
s_waitcnt vmcnt(31) lgkmcnt(4)
ds_read_b128 v[8:11],v250 offset:38912
ds_read_b128 v[16:19],v250 offset:43520
M v[96:99],a[108:111],a[96:99],v[96:99]
s_waitcnt vmcnt(30) lgkmcnt(5)
ds_read_b128 v[24:27],v250 offset:47616
ds_read_b128 a[112:115],v248 offset:1024
M v[96:99],a[208:211],a[100:103],v[96:99]
s_waitcnt vmcnt(29) lgkmcnt(6)
buffer_load_dwordx4 a[132:135],v250,s[20:23],s46 offen offset:0 sc1
M v[96:99],a[120:123],a[140:143],v[96:99]
s_waitcnt lgkmcnt(5)
s_add_u32 s34,s32,196608
ds_read_b128 a[124:127],v249 offset:1024
v_accvgpr_read_b32 v238,a65
M v[100:103],a[120:123],a[200:203],v[100:103]
buffer_load_dwordx4 a[148:151],v250,s[20:23],s46 offen offset:1024 sc1
M v[100:103],a[208:211],a[140:143],v[100:103]
v_accvgpr_read_b32 v237,a161
v_add_f32 v236,v238,v237
M v[100:103],a[108:111],a[100:103],v[100:103]
v_sub_f32 v238,v238,v237
v_add_f32 v237,v65,v161
M v[104:107],a[108:111],a[140:143],v[104:107]
ds_read_b128 a[144:147],v248 offset:1536
v_sub_f32 v161,v65,v161
M v[104:107],a[208:211],a[200:203],v[104:107]
s_waitcnt lgkmcnt(2)
buffer_load_dwordx4 a[224:227],v250,s[20:23],s46 offen offset:2048 sc1
M v[104:107],a[120:123],a[112:115],v[104:107]
s_waitcnt lgkmcnt(1)
ds_read_b128 a[152:155],v249 offset:1536
v_add_f32 v65,v236,v237
M v[108:111],a[120:123],a[124:127],v[108:111]
v_fmac_f32 v236,4.0,v237
v_fma_f32 v237,2.0,v161,v238
M v[108:111],a[208:211],a[112:115],v[108:111]
v_fma_f32 v161,s40,v161,v238
v_cvt_pk_bf16_f32 v232,v232,v237
M v[108:111],a[108:111],a[200:203],v[108:111]
buffer_store_dwordx4 a[36:39],v253,s[24:27],s34 offen offset:512 nt
M v[112:115],a[108:111],a[112:115],v[112:115]
s_add_u32 s47,s76,49152
ds_read_b128 a[156:159],v249 offset:2048
v_cvt_pk_bf16_f32 v234,v234,v236
M v[112:115],a[208:211],a[124:127],v[112:115]
s_waitcnt lgkmcnt(2)
ds_read_b128 a[192:195],v248 offset:2048
v_accvgpr_read_b32 v238,a66
M v[112:115],a[120:123],a[144:147],v[112:115]
s_waitcnt lgkmcnt(2)
v_accvgpr_read_b32 v233,a162
v_add_f32 v235,v238,v233
M v[116:119],a[120:123],a[152:155],v[116:119]
v_sub_f32 v238,v238,v233
v_add_f32 v233,v66,v162
M v[116:119],a[208:211],a[144:147],v[116:119]
v_sub_f32 v162,v66,v162
v_add_f32 v66,v235,v233
M v[116:119],a[108:111],a[124:127],v[116:119]
v_fmac_f32 v235,4.0,v233
v_fma_f32 v233,2.0,v162,v238
v_fma_f32 v162,s40,v162,v238
v_accvgpr_read_b32 v238,a67
v_accvgpr_read_b32 v237,a163
M v[120:123],a[108:111],a[144:147],v[120:123]
buffer_load_dwordx4 a[232:235],v250,s[20:23],s47 offen offset:0 sc1
M v[120:123],a[208:211],a[152:155],v[120:123]
s_waitcnt lgkmcnt(1)
v_add_f32 v236,v238,v237
v_sub_f32 v238,v238,v237
M v[120:123],a[120:123],a[156:159],v[120:123]
s_waitcnt lgkmcnt(0)
s_add_u32 s34,s32,393216
buffer_load_dwordx4 a[236:239],v250,s[20:23],s47 offen offset:1024 sc1
v_add_f32 v237,v67,v163
v_sub_f32 v163,v67,v163
v_add_f32 v67,v236,v237
M v[124:127],a[120:123],a[192:195],v[124:127]
v_fmac_f32 v236,4.0,v237
v_fma_f32 v237,2.0,v163,v238
M v[124:127],a[208:211],a[156:159],v[124:127]
v_fma_f32 v163,s40,v163,v238
v_cvt_pk_bf16_f32 v233,v233,v237
M v[124:127],a[108:111],a[152:155],v[124:127]
s_waitcnt vmcnt(33)
v_cvt_pk_bf16_f32 v235,v235,v236
M v[128:131],a[116:119],a[96:99],v[128:131]
s_waitcnt vmcnt(31)
buffer_load_dwordx4 a[252:255],v250,s[20:23],s47 offen offset:2048 sc1
M v[128:131],a[196:199],a[100:103],v[128:131]
s_waitcnt vmcnt(31)
ds_write2st64_b64 v254,v[232:233],v[234:235] offset0:34 offset1:38
M v[128:131],a[204:207],a[140:143],v[128:131]
v_accvgpr_read_b32 v238,a68
v_accvgpr_read_b32 v232,a164
v_add_f32 v234,v238,v232
M v[132:135],a[204:207],a[200:203],v[132:135]
v_sub_f32 v238,v238,v232
v_add_f32 v232,v68,v164
M v[132:135],a[196:199],a[140:143],v[132:135]
v_sub_f32 v164,v68,v164
v_add_f32 v68,v234,v232
M v[132:135],a[116:119],a[100:103],v[132:135]
buffer_store_dwordx4 a[40:43],v253,s[24:27],s34 offen offset:512 nt
M v[136:139],a[116:119],a[140:143],v[136:139]
v_fmac_f32 v234,4.0,v232
v_fma_f32 v232,2.0,v164,v238
M v[136:139],a[196:199],a[200:203],v[136:139]
v_fma_f32 v164,s40,v164,v238
v_accvgpr_read_b32 v238,a69
M v[136:139],a[204:207],a[112:115],v[136:139]
v_accvgpr_read_b32 v237,a165
v_add_f32 v236,v238,v237
v_sub_f32 v238,v238,v237
M v[140:143],a[204:207],a[124:127],v[140:143]
v_add_f32 v237,v69,v165
v_sub_f32 v165,v69,v165
M v[140:143],a[196:199],a[112:115],v[140:143]
v_add_f32 v69,v236,v237
v_fmac_f32 v236,4.0,v237
M v[140:143],a[116:119],a[200:203],v[140:143]
v_fma_f32 v237,2.0,v165,v238
v_fma_f32 v165,s40,v165,v238
v_cvt_pk_bf16_f32 v232,v232,v237
v_cvt_pk_bf16_f32 v234,v234,v236
v_accvgpr_read_b32 v238,a70
M v[144:147],a[116:119],a[112:115],v[144:147]
s_add_u32 s46,s77,46080
v_accvgpr_read_b32 v233,a166
v_add_f32 v235,v238,v233
M v[144:147],a[196:199],a[124:127],v[144:147]
v_sub_f32 v238,v238,v233
v_add_f32 v233,v70,v166
M v[144:147],a[204:207],a[144:147],v[144:147]
s_add_u32 s34,s32,589824
buffer_store_dwordx4 a[44:47],v253,s[24:27],s34 offen offset:512 nt
M v[148:151],a[204:207],a[152:155],v[148:151]
v_sub_f32 v166,v70,v166
v_add_f32 v70,v235,v233
M v[148:151],a[196:199],a[144:147],v[148:151]
ds_read_b128 a[96:99],v248 offset:17408
v_fmac_f32 v235,4.0,v233
M v[148:151],a[116:119],a[124:127],v[148:151]
ds_read_b128 a[100:103],v249 offset:17408
v_fma_f32 v233,2.0,v166,v238
v_fma_f32 v166,s40,v166,v238
M v[152:155],a[116:119],a[144:147],v[152:155]
buffer_load_dwordx4 a[108:111],v250,s[20:23],s46 offen offset:0 sc1
M v[152:155],a[196:199],a[152:155],v[152:155]
ds_read_b128 a[112:115],v248 offset:17920
ds_read_b128 a[124:127],v249 offset:17920
M v[152:155],a[204:207],a[156:159],v[152:155]
buffer_load_dwordx4 a[120:123],v250,s[20:23],s46 offen offset:1024 sc1
v_accvgpr_read_b32 v238,a71
v_accvgpr_read_b32 v237,a167
v_add_f32 v236,v238,v237
M v[156:159],a[204:207],a[192:195],v[156:159]
v_sub_f32 v238,v238,v237
v_add_f32 v237,v71,v167
M v[156:159],a[196:199],a[156:159],v[156:159]
v_sub_f32 v167,v71,v167
v_add_f32 v71,v236,v237
M v[156:159],a[116:119],a[152:155],v[156:159]
s_waitcnt vmcnt(33) lgkmcnt(3)
v_fmac_f32 v236,4.0,v237
v_fma_f32 v237,2.0,v167,v238
v_fma_f32 v167,s40,v167,v238
v_cvt_pk_bf16_f32 v233,v233,v237
M v[96:99],a[136:139],a[96:99],v[96:99]
s_waitcnt vmcnt(32) lgkmcnt(2)
buffer_load_dwordx4 a[140:143],v250,s[20:23],s46 offen offset:2048 sc1
M v[96:99],a[220:223],a[100:103],v[96:99]
s_waitcnt vmcnt(32) lgkmcnt(1)
ds_read_b128 a[116:119],v248 offset:18432
ds_read_b128 a[144:147],v249 offset:18432
M v[96:99],a[248:251],a[112:115],v[96:99]
s_waitcnt lgkmcnt(2)
v_cvt_pk_bf16_f32 v235,v235,v236
M v[100:103],a[248:251],a[124:127],v[100:103]
ds_write2st64_b64 v254,v[232:233],v[234:235] offset0:42 offset1:46
M v[100:103],a[220:223],a[112:115],v[100:103]
v_accvgpr_read_b32 v238,a72
v_accvgpr_read_b32 v232,a168
M v[100:103],a[136:139],a[100:103],v[100:103]
v_add_f32 v234,v238,v232
v_sub_f32 v238,v238,v232
v_add_f32 v232,v72,v168
v_sub_f32 v168,v72,v168
M v[104:107],a[136:139],a[112:115],v[104:107]
ds_read_b128 a[152:155],v248 offset:18944
v_add_f32 v72,v234,v232
M v[104:107],a[220:223],a[124:127],v[104:107]
s_waitcnt lgkmcnt(3)
ds_read_b128 a[156:159],v249 offset:18944
v_fmac_f32 v234,4.0,v232
M v[104:107],a[248:251],a[116:119],v[104:107]
s_waitcnt lgkmcnt(3)
s_add_u32 s34,s32,786432
buffer_store_dwordx4 a[48:51],v253,s[24:27],s34 offen offset:512 nt
M v[108:111],a[248:251],a[144:147],v[108:111]
v_fma_f32 v232,2.0,v168,v238
v_fma_f32 v168,s40,v168,v238
M v[108:111],a[220:223],a[116:119],v[108:111]
v_accvgpr_read_b32 v238,a73
v_accvgpr_read_b32 v237,a169
M v[108:111],a[136:139],a[124:127],v[108:111]
v_add_f32 v236,v238,v237
v_sub_f32 v238,v238,v237
v_add_f32 v237,v73,v169
M v[112:115],a[136:139],a[116:119],v[112:115]
s_add_u32 s47,s77,49152
ds_read_b128 a[160:163],v249 offset:19456
v_sub_f32 v169,v73,v169
M v[112:115],a[220:223],a[144:147],v[112:115]
s_waitcnt lgkmcnt(2)
ds_read_b128 a[164:167],v248 offset:19456
v_add_f32 v73,v236,v237
M v[112:115],a[248:251],a[152:155],v[112:115]
s_waitcnt lgkmcnt(2)
v_fmac_f32 v236,4.0,v237
v_fma_f32 v237,2.0,v169,v238
v_fma_f32 v169,s40,v169,v238
v_cvt_pk_bf16_f32 v232,v232,v237
v_cvt_pk_bf16_f32 v234,v234,v236
M v[116:119],a[248:251],a[156:159],v[116:119]
v_accvgpr_read_b32 v238,a74
v_accvgpr_read_b32 v233,a170
M v[116:119],a[220:223],a[152:155],v[116:119]
v_add_f32 v235,v238,v233
v_sub_f32 v238,v238,v233
M v[116:119],a[136:139],a[144:147],v[116:119]
v_add_f32 v233,v74,v170
v_sub_f32 v170,v74,v170
v_add_f32 v74,v235,v233
v_fmac_f32 v235,4.0,v233
M v[120:123],a[136:139],a[152:155],v[120:123]
buffer_load_dwordx4 a[240:243],v250,s[20:23],s47 offen offset:0 sc1
M v[120:123],a[220:223],a[156:159],v[120:123]
s_waitcnt lgkmcnt(1)
v_fma_f32 v233,2.0,v170,v238
v_fma_f32 v170,s40,v170,v238
M v[120:123],a[248:251],a[160:163],v[120:123]
s_waitcnt lgkmcnt(0)
buffer_load_dwordx4 v[220:223],v250,s[20:23],s47 offen offset:1024 sc1
v_accvgpr_read_b32 v238,a75
v_accvgpr_read_b32 v237,a171
v_add_f32 v236,v238,v237
M v[124:127],a[248:251],a[164:167],v[124:127]
v_sub_f32 v238,v238,v237
v_add_f32 v237,v75,v171
M v[124:127],a[220:223],a[160:163],v[124:127]
v_sub_f32 v171,v75,v171
v_add_f32 v75,v236,v237
M v[124:127],a[136:139],a[156:159],v[124:127]
s_waitcnt vmcnt(33)
v_fmac_f32 v236,4.0,v237
v_fma_f32 v237,2.0,v171,v238
v_fma_f32 v171,s40,v171,v238
v_cvt_pk_bf16_f32 v233,v233,v237
M v[128:131],a[128:131],a[96:99],v[128:131]
s_waitcnt vmcnt(32)
buffer_load_dwordx4 a[208:211],v250,s[20:23],s47 offen offset:2048 sc1
M v[128:131],a[244:247],a[100:103],v[128:131]
s_waitcnt vmcnt(32)
v_cvt_pk_bf16_f32 v235,v235,v236
M v[128:131],a[216:219],a[112:115],v[128:131]
s_add_u32 s34,s32,983040
ds_write2st64_b64 v254,v[232:233],v[234:235] offset0:51 offset1:55
M v[132:135],a[216:219],a[124:127],v[132:135]
v_accvgpr_read_b32 v238,a76
v_accvgpr_read_b32 v232,a172
M v[132:135],a[244:247],a[112:115],v[132:135]
v_add_f32 v234,v238,v232
v_sub_f32 v238,v238,v232
M v[132:135],a[128:131],a[100:103],v[132:135]
buffer_store_dwordx4 a[52:55],v253,s[24:27],s34 offen offset:512 nt
M v[136:139],a[128:131],a[112:115],v[136:139]
v_add_f32 v232,v76,v172
v_sub_f32 v172,v76,v172
M v[136:139],a[244:247],a[124:127],v[136:139]
v_add_f32 v76,v234,v232
v_fmac_f32 v234,4.0,v232
M v[136:139],a[216:219],a[116:119],v[136:139]
v_fma_f32 v232,2.0,v172,v238
v_fma_f32 v172,s40,v172,v238
v_accvgpr_read_b32 v238,a77
M v[140:143],a[216:219],a[144:147],v[140:143]
v_accvgpr_read_b32 v237,a173
v_add_f32 v236,v238,v237
M v[140:143],a[244:247],a[116:119],v[140:143]
v_sub_f32 v238,v238,v237
v_add_f32 v237,v77,v173
M v[140:143],a[128:131],a[124:127],v[140:143]
v_sub_f32 v173,v77,v173
v_add_f32 v77,v236,v237
v_fmac_f32 v236,4.0,v237
v_fma_f32 v237,2.0,v173,v238
v_fma_f32 v173,s40,v173,v238
M v[144:147],a[128:131],a[116:119],v[144:147]
s_add_u32 s47,s72,3072
v_cvt_pk_bf16_f32 v232,v232,v237
v_cvt_pk_bf16_f32 v234,v234,v236
M v[144:147],a[244:247],a[144:147],v[144:147]
v_accvgpr_read_b32 v238,a78
v_accvgpr_read_b32 v233,a174
M v[144:147],a[216:219],a[152:155],v[144:147]
v_add_f32 v235,v238,v233
v_sub_f32 v238,v238,v233
v_add_f32 v233,v78,v174
v_sub_f32 v174,v78,v174
M v[148:151],a[216:219],a[156:159],v[148:151]
v_add_f32 v78,v235,v233
v_fmac_f32 v235,4.0,v233
M v[148:151],a[244:247],a[152:155],v[148:151]
ds_read_b128 a[96:99],v248 offset:34816
v_fma_f32 v233,2.0,v174,v238
M v[148:151],a[128:131],a[144:147],v[148:151]
ds_read_b128 a[100:103],v249 offset:34816
v_fma_f32 v174,s40,v174,v238
v_accvgpr_read_b32 v238,a79
v_accvgpr_read_b32 v237,a175
v_add_f32 v236,v238,v237
M v[152:155],a[128:131],a[152:155],v[152:155]
buffer_load_dwordx4 a[112:115],v250,s[20:23],s47 offen offset:0 sc1
M v[152:155],a[244:247],a[156:159],v[152:155]
ds_read_b128 a[116:119],v248 offset:35328
ds_read_b128 a[136:139],v249 offset:35328
M v[152:155],a[216:219],a[160:163],v[152:155]
s_add_u32 s34,s32,1179648
buffer_load_dwordx4 a[124:127],v250,s[20:23],s47 offen offset:1024 sc1
v_sub_f32 v238,v238,v237
v_add_f32 v237,v79,v175
M v[156:159],a[216:219],a[164:167],v[156:159]
v_sub_f32 v175,v79,v175
v_add_f32 v79,v236,v237
M v[156:159],a[244:247],a[160:163],v[156:159]
v_fmac_f32 v236,4.0,v237
v_fma_f32 v237,2.0,v175,v238
M v[156:159],a[128:131],a[156:159],v[156:159]
s_waitcnt vmcnt(33) lgkmcnt(3)
v_fma_f32 v175,s40,v175,v238
v_cvt_pk_bf16_f32 v233,v233,v237
v_cvt_pk_bf16_f32 v235,v235,v236
M v[96:99],a[104:107],a[96:99],v[96:99]
s_waitcnt vmcnt(32) lgkmcnt(2)
buffer_load_dwordx4 a[144:147],v250,s[20:23],s47 offen offset:2048 sc1
M v[96:99],a[212:215],a[100:103],v[96:99]
s_waitcnt vmcnt(32) lgkmcnt(1)
ds_read_b128 a[128:131],v248 offset:35840
ds_read_b128 a[152:155],v249 offset:35840
M v[96:99],v[216:219],a[116:119],v[96:99]
s_waitcnt lgkmcnt(2)
ds_write2st64_b64 v254,v[232:233],v[234:235] offset0:59 offset1:63
M v[100:103],v[216:219],a[136:139],v[100:103]
v_accvgpr_read_b32 v238,a80
v_accvgpr_read_b32 v232,a176
M v[100:103],a[212:215],a[116:119],v[100:103]
v_add_f32 v234,v238,v232
v_sub_f32 v238,v238,v232
M v[100:103],a[104:107],a[100:103],v[100:103]
buffer_store_dwordx4 a[56:59],v253,s[24:27],s34 offen offset:512 nt
M v[104:107],a[104:107],a[116:119],v[104:107]
ds_read_b128 a[156:159],v248 offset:36352
v_add_f32 v232,v80,v176
M v[104:107],a[212:215],a[136:139],v[104:107]
s_waitcnt lgkmcnt(3)
ds_read_b128 a[160:163],v249 offset:36352
v_sub_f32 v176,v80,v176
M v[104:107],v[216:219],a[128:131],v[104:107]
s_waitcnt lgkmcnt(3)
v_add_f32 v80,v234,v232
v_fmac_f32 v234,4.0,v232
M v[108:111],v[216:219],a[152:155],v[108:111]
v_fma_f32 v232,2.0,v176,v238
v_fma_f32 v176,s40,v176,v238
M v[108:111],a[212:215],a[128:131],v[108:111]
v_accvgpr_read_b32 v238,a81
v_accvgpr_read_b32 v237,a177
M v[108:111],a[104:107],a[136:139],v[108:111]
v_add_f32 v236,v238,v237
v_sub_f32 v238,v238,v237
M v[112:115],a[104:107],a[128:131],v[112:115]
s_add_u32 s48,s72,6144
ds_read_b128 a[164:167],v249 offset:36864
v_add_f32 v237,v81,v177
M v[112:115],a[212:215],a[152:155],v[112:115]
s_waitcnt lgkmcnt(2)
ds_read_b128 a[168:171],v248 offset:36864
v_sub_f32 v177,v81,v177
M v[112:115],v[216:219],a[156:159],v[112:115]
s_waitcnt lgkmcnt(2)
s_add_u32 s34,s32,1376256
buffer_store_dwordx4 a[60:63],v253,s[24:27],s34 offen offset:512 nt
M v[116:119],v[216:219],a[160:163],v[116:119]
v_add_f32 v81,v236,v237
v_fmac_f32 v236,4.0,v237
M v[116:119],a[212:215],a[156:159],v[116:119]
v_fma_f32 v237,2.0,v177,v238
v_fma_f32 v177,s40,v177,v238
M v[116:119],a[104:107],a[152:155],v[116:119]
v_cvt_pk_bf16_f32 v232,v232,v237
v_cvt_pk_bf16_f32 v234,v234,v236
M v[120:123],a[104:107],a[156:159],v[120:123]
buffer_load_dwordx4 a[172:175],v250,s[20:23],s48 offen offset:0 sc1
M v[120:123],a[212:215],a[160:163],v[120:123]
s_waitcnt lgkmcnt(1)
v_accvgpr_read_b32 v238,a82
v_accvgpr_read_b32 v233,a178
M v[120:123],v[216:219],a[164:167],v[120:123]
s_waitcnt lgkmcnt(0)
buffer_load_dwordx4 a[200:203],v250,s[20:23],s48 offen offset:1024 sc1
M v[124:127],v[216:219],a[168:171],v[124:127]
v_add_f32 v235,v238,v233
v_sub_f32 v238,v238,v233
M v[124:127],a[212:215],a[164:167],v[124:127]
v_add_f32 v233,v82,v178
v_sub_f32 v178,v82,v178
M v[124:127],a[104:107],a[160:163],v[124:127]
s_waitcnt vmcnt(28)
v_add_f32 v82,v235,v233
v_fmac_f32 v235,4.0,v233
M v[128:131],a[228:231],a[96:99],v[128:131]
s_waitcnt vmcnt(27)
buffer_load_dwordx4 a[192:195],v250,s[20:23],s48 offen offset:2048 sc1
M v[128:131],v[224:227],a[100:103],v[128:131]
s_waitcnt vmcnt(27)
v_fma_f32 v233,2.0,v178,v238
v_fma_f32 v178,s40,v178,v238
M v[128:131],v[228:231],a[116:119],v[128:131]
v_accvgpr_read_b32 v238,a83
v_accvgpr_read_b32 v237,a179
v_add_f32 v236,v238,v237
v_sub_f32 v238,v238,v237
M v[132:135],v[228:231],a[136:139],v[132:135]
v_add_f32 v237,v83,v179
v_sub_f32 v179,v83,v179
M v[132:135],v[224:227],a[116:119],v[132:135]
v_add_f32 v83,v236,v237
v_fmac_f32 v236,4.0,v237
M v[132:135],a[228:231],a[100:103],v[132:135]
v_fma_f32 v237,2.0,v179,v238
v_fma_f32 v179,s40,v179,v238
v_cvt_pk_bf16_f32 v233,v233,v237
M v[136:139],a[228:231],a[116:119],v[136:139]
v_cvt_pk_bf16_f32 v235,v235,v236
M v[136:139],v[224:227],a[136:139],v[136:139]
ds_write2st64_b64 v254,v[232:233],v[234:235] offset0:102 offset1:106
M v[136:139],v[228:231],a[128:131],v[136:139]
s_add_u32 s34,s33,0
buffer_store_dwordx4 v[0:3],v253,s[24:27],s34 offen offset:0 nt
M v[140:143],v[228:231],a[152:155],v[140:143]
v_accvgpr_read_b32 v238,a84
v_accvgpr_read_b32 v232,a180
M v[140:143],v[224:227],a[128:131],v[140:143]
v_add_f32 v234,v238,v232
v_sub_f32 v238,v238,v232
M v[140:143],a[228:231],a[136:139],v[140:143]
v_add_f32 v232,v84,v180
v_sub_f32 v180,v84,v180
M v[144:147],a[228:231],a[128:131],v[144:147]
s_add_u32 s47,s73,3072
v_add_f32 v84,v234,v232
v_fmac_f32 v234,4.0,v232
M v[144:147],v[224:227],a[152:155],v[144:147]
v_fma_f32 v232,2.0,v180,v238
v_fma_f32 v180,s40,v180,v238
M v[144:147],v[228:231],a[156:159],v[144:147]
v_accvgpr_read_b32 v238,a85
v_accvgpr_read_b32 v237,a181
M v[148:151],v[228:231],a[160:163],v[148:151]
v_add_f32 v236,v238,v237
v_sub_f32 v238,v238,v237
M v[148:151],v[224:227],a[156:159],v[148:151]
ds_read_b128 a[96:99],v248 offset:52224
v_add_f32 v237,v85,v181
M v[148:151],a[228:231],a[152:155],v[148:151]
ds_read_b128 a[100:103],v249 offset:52224
v_sub_f32 v181,v85,v181
M v[152:155],a[228:231],a[156:159],v[152:155]
buffer_load_dwordx4 a[104:107],v250,s[20:23],s47 offen offset:0 sc1
M v[152:155],v[224:227],a[160:163],v[152:155]
ds_read_b128 a[116:119],v248 offset:52736
ds_read_b128 a[136:139],v249 offset:52736
M v[152:155],v[228:231],a[164:167],v[152:155]
buffer_load_dwordx4 a[128:131],v250,s[20:23],s47 offen offset:1024 sc1
M v[156:159],v[228:231],a[168:171],v[156:159]
v_add_f32 v85,v236,v237
v_fmac_f32 v236,4.0,v237
M v[156:159],v[224:227],a[164:167],v[156:159]
v_fma_f32 v237,2.0,v181,v238
v_fma_f32 v181,s40,v181,v238
M v[156:159],a[228:231],a[160:163],v[156:159]
s_waitcnt vmcnt(27) lgkmcnt(3)
v_cvt_pk_bf16_f32 v232,v232,v237
v_cvt_pk_bf16_f32 v234,v234,v236
M v[96:99],a[132:135],a[96:99],v[96:99]
s_waitcnt vmcnt(26) lgkmcnt(2)
buffer_load_dwordx4 a[152:155],v250,s[20:23],s47 offen offset:2048 sc1
M v[96:99],a[148:151],a[100:103],v[96:99]
s_waitcnt vmcnt(26) lgkmcnt(1)
ds_read_b128 a[156:159],v248 offset:53248
ds_read_b128 a[160:163],v249 offset:53248
M v[96:99],a[224:227],a[116:119],v[96:99]
s_waitcnt lgkmcnt(2)
s_add_u32 s34,s33,393216
v_accvgpr_read_b32 v238,a86
v_accvgpr_read_b32 v233,a182
v_add_f32 v235,v238,v233
M v[100:103],a[224:227],a[136:139],v[100:103]
v_sub_f32 v238,v238,v233
v_add_f32 v233,v86,v182
M v[100:103],a[148:151],a[116:119],v[100:103]
v_sub_f32 v182,v86,v182
v_add_f32 v86,v235,v233
M v[100:103],a[132:135],a[100:103],v[100:103]
buffer_store_dwordx4 v[8:11],v253,s[24:27],s34 offen offset:0 nt
M v[104:107],a[132:135],a[116:119],v[104:107]
ds_read_b128 a[164:167],v248 offset:53760
v_fmac_f32 v235,4.0,v233
M v[104:107],a[148:151],a[136:139],v[104:107]
s_waitcnt lgkmcnt(2)
ds_read_b128 a[168:171],v249 offset:53760
v_fma_f32 v233,2.0,v182,v238
M v[104:107],a[224:227],a[156:159],v[104:107]
s_waitcnt lgkmcnt(2)
v_fma_f32 v182,s40,v182,v238
v_accvgpr_read_b32 v238,a87
M v[108:111],a[224:227],a[160:163],v[108:111]
v_accvgpr_read_b32 v237,a183
v_add_f32 v236,v238,v237
M v[108:111],a[148:151],a[156:159],v[108:111]
v_sub_f32 v238,v238,v237
v_add_f32 v237,v87,v183
M v[108:111],a[132:135],a[136:139],v[108:111]
v_sub_f32 v183,v87,v183
v_add_f32 v87,v236,v237
M v[112:115],a[132:135],a[156:159],v[112:115]
s_add_u32 s48,s73,6144
ds_read_b128 a[176:179],v249 offset:54272
v_fmac_f32 v236,4.0,v237
M v[112:115],a[148:151],a[160:163],v[112:115]
s_waitcnt lgkmcnt(2)
ds_read_b128 a[204:207],v248 offset:54272
v_fma_f32 v237,2.0,v183,v238
M v[112:115],a[224:227],a[164:167],v[112:115]
s_waitcnt lgkmcnt(2)
v_fma_f32 v183,s40,v183,v238
v_cvt_pk_bf16_f32 v233,v233,v237
v_cvt_pk_bf16_f32 v235,v235,v236
M v[116:119],a[224:227],a[168:171],v[116:119]
ds_write2st64_b64 v254,v[232:233],v[234:235] offset0:110 offset1:114
M v[116:119],a[148:151],a[164:167],v[116:119]
v_accvgpr_read_b32 v238,a88
v_accvgpr_read_b32 v232,a184
M v[116:119],a[132:135],a[160:163],v[116:119]
v_add_f32 v234,v238,v232
v_sub_f32 v238,v238,v232
M v[120:123],a[132:135],a[164:167],v[120:123]
buffer_load_dwordx4 a[180:183],v250,s[20:23],s48 offen offset:0 sc1
M v[120:123],a[148:151],a[168:171],v[120:123]
s_waitcnt lgkmcnt(2)
v_add_f32 v232,v88,v184
v_sub_f32 v184,v88,v184
M v[120:123],a[224:227],a[176:179],v[120:123]
s_waitcnt lgkmcnt(1)
s_add_u32 s34,s33,786432
buffer_load_dwordx4 a[196:199],v250,s[20:23],s48 offen offset:1024 sc1
M v[124:127],a[224:227],a[204:207],v[124:127]
v_add_f32 v88,v234,v232
v_fmac_f32 v234,4.0,v232
M v[124:127],a[148:151],a[176:179],v[124:127]
v_fma_f32 v232,2.0,v184,v238
v_fma_f32 v184,s40,v184,v238
M v[124:127],a[132:135],a[168:171],v[124:127]
s_waitcnt vmcnt(27)
v_accvgpr_read_b32 v238,a89
v_accvgpr_read_b32 v237,a185
v_add_f32 v236,v238,v237
M v[128:131],a[232:235],a[96:99],v[128:131]
s_waitcnt vmcnt(26)
buffer_load_dwordx4 a[248:251],v250,s[20:23],s48 offen offset:2048 sc1
M v[128:131],a[236:239],a[100:103],v[128:131]
s_waitcnt vmcnt(26)
v_sub_f32 v238,v238,v237
v_add_f32 v237,v89,v185
M v[128:131],a[252:255],a[116:119],v[128:131]
v_sub_f32 v185,v89,v185
v_add_f32 v89,v236,v237
v_fmac_f32 v236,4.0,v237
M v[132:135],a[252:255],a[136:139],v[132:135]
v_fma_f32 v237,2.0,v185,v238
v_fma_f32 v185,s40,v185,v238
M v[132:135],a[236:239],a[116:119],v[132:135]
v_cvt_pk_bf16_f32 v232,v232,v237
v_cvt_pk_bf16_f32 v234,v234,v236
M v[132:135],a[232:235],a[100:103],v[132:135]
buffer_store_dwordx4 v[16:19],v253,s[24:27],s34 offen offset:0 nt
M v[136:139],a[232:235],a[116:119],v[136:139]
v_accvgpr_read_b32 v238,a90
v_accvgpr_read_b32 v233,a186
M v[136:139],a[236:239],a[136:139],v[136:139]
v_add_f32 v235,v238,v233
v_sub_f32 v238,v238,v233
M v[136:139],a[252:255],a[156:159],v[136:139]
v_add_f32 v233,v90,v186
v_sub_f32 v186,v90,v186
M v[140:143],a[252:255],a[160:163],v[140:143]
v_add_f32 v90,v235,v233
v_fmac_f32 v235,4.0,v233
M v[140:143],a[236:239],a[156:159],v[140:143]
v_fma_f32 v233,2.0,v186,v238
v_fma_f32 v186,s40,v186,v238
M v[140:143],a[232:235],a[136:139],v[140:143]
v_accvgpr_read_b32 v238,a91
v_accvgpr_read_b32 v237,a187
M v[144:147],a[232:235],a[156:159],v[144:147]
s_add_u32 s47,s74,3072
v_add_f32 v236,v238,v237
v_sub_f32 v238,v238,v237
M v[144:147],a[236:239],a[160:163],v[144:147]
v_add_u32 v248,0xffffbc00,v248
v_add_u32 v249,0xffffbc00,v249
M v[144:147],a[252:255],a[164:167],v[144:147]
s_add_u32 s34,s33,1179648
buffer_store_dwordx4 v[24:27],v253,s[24:27],s34 offen offset:0 nt
M v[148:151],a[252:255],a[168:171],v[148:151]
v_add_f32 v237,v91,v187
v_sub_f32 v187,v91,v187
M v[148:151],a[236:239],a[164:167],v[148:151]
ds_read_b128 a[96:99],v248 offset:0
v_add_f32 v91,v236,v237
M v[148:151],a[232:235],a[160:163],v[148:151]
ds_read_b128 a[100:103],v249 offset:0
v_fmac_f32 v236,4.0,v237
M v[152:155],a[232:235],a[164:167],v[152:155]
buffer_load_dwordx4 a[116:119],v250,s[20:23],s47 offen offset:0 sc1
M v[152:155],a[236:239],a[168:171],v[152:155]
ds_read_b128 a[132:135],v248 offset:512
ds_read_b128 a[148:151],v249 offset:512
M v[152:155],a[252:255],a[176:179],v[152:155]
buffer_load_dwordx4 a[136:139],v250,s[20:23],s47 offen offset:1024 sc1
M v[156:159],a[252:255],a[204:207],v[156:159]
v_fma_f32 v237,2.0,v187,v238
v_fma_f32 v187,s40,v187,v238
M v[156:159],a[236:239],a[176:179],v[156:159]
v_cvt_pk_bf16_f32 v233,v233,v237
v_cvt_pk_bf16_f32 v235,v235,v236
M v[156:159],a[232:235],a[168:171],v[156:159]
s_waitcnt vmcnt(27) lgkmcnt(3)
ds_write2st64_b64 v254,v[232:233],v[234:235] offset0:119 offset1:123
M v[96:99],a[108:111],a[96:99],v[96:99]
s_waitcnt vmcnt(26) lgkmcnt(3)
buffer_load_dwordx4 a[156:159],v250,s[20:23],s47 offen offset:2048 sc1
M v[96:99],a[120:123],a[100:103],v[96:99]
s_waitcnt vmcnt(26) lgkmcnt(2)
ds_read_b128 a[160:163],v248 offset:1024
ds_read_b128 a[164:167],v249 offset:1024
M v[96:99],a[140:143],a[132:135],v[96:99]
s_waitcnt lgkmcnt(3)
v_accvgpr_read_b32 v238,a92
v_accvgpr_read_b32 v232,a188
M v[100:103],a[140:143],a[148:151],v[100:103]
v_add_f32 v234,v238,v232
v_sub_f32 v238,v238,v232
M v[100:103],a[120:123],a[132:135],v[100:103]
v_add_f32 v232,v92,v188
v_sub_f32 v188,v92,v188
M v[100:103],a[108:111],a[100:103],v[100:103]
v_add_f32 v92,v234,v232
v_fmac_f32 v234,4.0,v232
M v[104:107],a[108:111],a[132:135],v[104:107]
ds_read_b128 a[168:171],v248 offset:1536
v_fma_f32 v232,2.0,v188,v238
M v[104:107],a[120:123],a[148:151],v[104:107]
s_waitcnt lgkmcnt(2)
ds_read_b128 a[176:179],v249 offset:1536
v_fma_f32 v188,s40,v188,v238
M v[104:107],a[140:143],a[160:163],v[104:107]
s_waitcnt lgkmcnt(2)
v_accvgpr_read_b32 v238,a93
v_accvgpr_read_b32 v237,a189
v_add_f32 v236,v238,v237
M v[108:111],a[140:143],a[164:167],v[108:111]
v_sub_f32 v238,v238,v237
v_add_f32 v237,v93,v189
M v[108:111],a[120:123],a[160:163],v[108:111]
v_sub_f32 v189,v93,v189
v_add_f32 v93,v236,v237
M v[108:111],a[108:111],a[148:151],v[108:111]
v_fmac_f32 v236,4.0,v237
v_fma_f32 v237,2.0,v189,v238
v_fma_f32 v189,s40,v189,v238
M v[112:115],a[108:111],a[160:163],v[112:115]
s_add_u32 s48,s74,6144
ds_read_b128 a[184:187],v249 offset:2048
v_cvt_pk_bf16_f32 v232,v232,v237
M v[112:115],a[120:123],a[164:167],v[112:115]
s_waitcnt lgkmcnt(2)
ds_read_b128 a[220:223],v248 offset:2048
v_cvt_pk_bf16_f32 v234,v234,v236
M v[112:115],a[140:143],a[168:171],v[112:115]
s_waitcnt lgkmcnt(2)
v_accvgpr_read_b32 v238,a94
v_accvgpr_read_b32 v233,a190
v_add_f32 v235,v238,v233
M v[116:119],a[140:143],a[176:179],v[116:119]
v_sub_f32 v238,v238,v233
v_add_f32 v233,v94,v190
M v[116:119],a[120:123],a[168:171],v[116:119]
v_sub_f32 v190,v94,v190
v_add_f32 v94,v235,v233
M v[116:119],a[108:111],a[164:167],v[116:119]
v_fmac_f32 v235,4.0,v233
v_fma_f32 v233,2.0,v190,v238
v_fma_f32 v190,s40,v190,v238
M v[120:123],a[108:111],a[168:171],v[120:123]
buffer_load_dwordx4 a[216:219],v250,s[20:23],s48 offen offset:0 sc1
M v[120:123],a[120:123],a[176:179],v[120:123]
s_waitcnt lgkmcnt(1)
v_accvgpr_read_b32 v238,a95
v_accvgpr_read_b32 v237,a191
M v[120:123],a[140:143],a[184:187],v[120:123]
s_waitcnt lgkmcnt(0)
buffer_load_dwordx4 a[244:247],v250,s[20:23],s48 offen offset:1024 sc1
v_add_f32 v236,v238,v237
v_sub_f32 v238,v238,v237
M v[124:127],a[140:143],a[220:223],v[124:127]
v_add_f32 v237,v95,v191
v_sub_f32 v191,v95,v191
M v[124:127],a[120:123],a[184:187],v[124:127]
v_add_f32 v95,v236,v237
v_fmac_f32 v236,4.0,v237
M v[124:127],a[108:111],a[176:179],v[124:127]
s_waitcnt vmcnt(26)
v_fma_f32 v237,2.0,v191,v238
v_fma_f32 v191,s40,v191,v238
v_cvt_pk_bf16_f32 v233,v233,v237
M v[128:131],a[240:243],a[96:99],v[128:131]
s_waitcnt vmcnt(25)
buffer_load_dwordx4 v[216:219],v250,s[20:23],s48 offen offset:2048 sc1
M v[128:131],v[220:223],a[100:103],v[128:131]
s_waitcnt vmcnt(25)
v_cvt_pk_bf16_f32 v235,v235,v236
M v[128:131],a[208:211],a[132:135],v[128:131]
ds_write2st64_b64 v254,v[232:233],v[234:235] offset0:127 offset1:131
M v[132:135],a[208:211],a[148:151],v[132:135]
v_cvt_pk_bf16_f32 v96,v96,v97
v_cvt_pk_bf16_f32 v97,v98,v99
M v[132:135],v[220:223],a[132:135],v[132:135]
v_cvt_pk_bf16_f32 v100,v100,v101
v_cvt_pk_bf16_f32 v101,v102,v103
M v[132:135],a[240:243],a[100:103],v[132:135]
s_waitcnt lgkmcnt(0)
s_barrier
ds_read_b128 a[64:67],v250 offset:17408
M v[136:139],a[240:243],a[132:135],v[136:139]
ds_read_b128 a[68:71],v250 offset:21504
ds_read_b128 a[72:75],v250 offset:26112
M v[136:139],v[220:223],a[148:151],v[136:139]
ds_read_b128 a[76:79],v250 offset:30208
ds_read_b128 a[80:83],v250 offset:52224
M v[136:139],a[208:211],a[160:163],v[136:139]
ds_read_b128 a[84:87],v250 offset:56320
ds_read_b128 a[88:91],v250 offset:60928
M v[140:143],a[208:211],a[164:167],v[140:143]
ds_read_b128 a[92:95],v250 offset:65024
v_add_u32 v4,69632,v250
M v[140:143],v[220:223],a[160:163],v[140:143]
s_add_u32 s34,s32,0
ds_write2st64_b64 v254,v[96:97],v[100:101] offset0:68 offset1:72
M v[140:143],a[240:243],a[148:151],v[140:143]
s_waitcnt lgkmcnt(8)
buffer_store_dwordx4 a[64:67],v253,s[24:27],s34 offen offset:640 nt
M v[144:147],a[240:243],a[160:163],v[144:147]
s_add_u32 s34,s32,196608
s_add_u32 s47,s75,3072
v_cvt_pk_bf16_f32 v104,v104,v105
M v[144:147],v[220:223],a[164:167],v[144:147]
v_add_u32 v248,0xfffece00,v248
v_add_u32 v249,0xfffece00,v249
M v[144:147],a[208:211],a[168:171],v[144:147]
s_waitcnt lgkmcnt(7)
buffer_store_dwordx4 a[68:71],v253,s[24:27],s34 offen offset:640 nt
M v[148:151],a[208:211],a[176:179],v[148:151]
v_cvt_pk_bf16_f32 v105,v106,v107
v_cvt_pk_bf16_f32 v108,v108,v109
M v[148:151],v[220:223],a[168:171],v[148:151]
ds_read_b128 a[96:99],v248 offset:0
v_cvt_pk_bf16_f32 v109,v110,v111
M v[148:151],a[240:243],a[164:167],v[148:151]
ds_read_b128 a[100:103],v249 offset:0
ds_write2st64_b64 v254,v[104:105],v[108:109] offset0:76 offset1:80
M v[152:155],a[240:243],a[168:171],v[152:155]
buffer_load_dwordx4 a[108:111],v250,s[20:23],s47 offen offset:0 sc1
M v[152:155],v[220:223],a[176:179],v[152:155]
ds_read_b128 a[120:123],v248 offset:512
ds_read_b128 a[140:143],v249 offset:512
M v[152:155],a[208:211],a[184:187],v[152:155]
s_add_u32 s34,s32,393216
buffer_load_dwordx4 a[132:135],v250,s[20:23],s47 offen offset:1024 sc1
M v[156:159],a[208:211],a[220:223],v[156:159]
v_cvt_pk_bf16_f32 v112,v112,v113
v_cvt_pk_bf16_f32 v113,v114,v115
M v[156:159],v[220:223],a[184:187],v[156:159]
v_cvt_pk_bf16_f32 v116,v116,v117
v_cvt_pk_bf16_f32 v117,v118,v119
M v[156:159],a[240:243],a[176:179],v[156:159]
s_waitcnt vmcnt(27) lgkmcnt(4)
ds_write2st64_b64 v254,v[112:113],v[116:117] offset0:85 offset1:89
M v[32:35],a[112:115],a[96:99],v[32:35]
s_waitcnt vmcnt(26) lgkmcnt(4)
buffer_load_dwordx4 a[148:151],v250,s[20:23],s47 offen offset:2048 sc1
M v[32:35],a[124:127],a[100:103],v[32:35]
s_waitcnt vmcnt(26) lgkmcnt(2)
ds_read_b128 a[160:163],v248 offset:1024
ds_read_b128 a[164:167],v249 offset:1024
M v[32:35],a[144:147],a[120:123],v[32:35]
s_waitcnt lgkmcnt(3)
v_cvt_pk_bf16_f32 v120,v120,v121
v_cvt_pk_bf16_f32 v121,v122,v123
M v[36:39],a[144:147],a[140:143],v[36:39]
v_cvt_pk_bf16_f32 v124,v124,v125
v_cvt_pk_bf16_f32 v125,v126,v127
M v[36:39],a[124:127],a[120:123],v[36:39]
ds_write2st64_b64 v254,v[120:121],v[124:125] offset0:93 offset1:97
M v[36:39],a[112:115],a[100:103],v[36:39]
buffer_store_dwordx4 a[72:75],v253,s[24:27],s34 offen offset:640 nt
M v[40:43],a[112:115],a[120:123],v[40:43]
ds_read_b128 a[168:171],v248 offset:1536
v_cvt_pk_bf16_f32 v128,v128,v129
M v[40:43],a[124:127],a[140:143],v[40:43]
s_waitcnt lgkmcnt(3)
ds_read_b128 a[176:179],v249 offset:1536
v_cvt_pk_bf16_f32 v129,v130,v131
M v[40:43],a[144:147],a[160:163],v[40:43]
s_waitcnt lgkmcnt(3)
v_cvt_pk_bf16_f32 v132,v132,v133
v_cvt_pk_bf16_f32 v133,v134,v135
M v[44:47],a[144:147],a[164:167],v[44:47]
s_waitcnt lgkmcnt(2)
s_barrier
ds_read_b128 v[96:99],v250 offset:34816
M v[44:47],a[124:127],a[160:163],v[44:47]
ds_read_b128 v[104:107],v250 offset:38912
ds_read_b128 v[112:115],v250 offset:43520
M v[44:47],a[112:115],a[140:143],v[44:47]
ds_read_b128 v[120:123],v250 offset:47616
ds_write2st64_b64 v254,v[128:129],v[132:133] offset0:34 offset1:38
M v[48:51],a[112:115],a[160:163],v[48:51]
ds_read_b128 a[184:187],v249 offset:2048
v_cvt_pk_bf16_f32 v136,v136,v137
M v[48:51],a[124:127],a[164:167],v[48:51]
s_waitcnt lgkmcnt(7)
ds_read_b128 a[188:191],v248 offset:2048
v_cvt_pk_bf16_f32 v137,v138,v139
M v[48:51],a[144:147],a[168:171],v[48:51]
s_waitcnt lgkmcnt(7)
s_add_u32 s34,s32,589824
buffer_store_dwordx4 a[76:79],v253,s[24:27],s34 offen offset:640 nt
M v[52:55],a[144:147],a[176:179],v[52:55]
v_cvt_pk_bf16_f32 v140,v140,v141
v_cvt_pk_bf16_f32 v141,v142,v143
M v[52:55],a[124:127],a[168:171],v[52:55]
ds_write2st64_b64 v254,v[136:137],v[140:141] offset0:42 offset1:46
M v[52:55],a[112:115],a[164:167],v[52:55]
v_cvt_pk_bf16_f32 v144,v144,v145
v_cvt_pk_bf16_f32 v145,v146,v147
M v[56:59],a[112:115],a[168:171],v[56:59]
global_load_dword a212,v250,s[64:65]
M v[56:59],a[124:127],a[176:179],v[56:59]
s_waitcnt lgkmcnt(2)
s_add_u32 s48,s75,6144
buffer_load_dwordx4 a[212:215],v250,s[20:23],s48 offen offset:0 sc1
M v[56:59],a[144:147],a[184:187],v[56:59]
s_waitcnt lgkmcnt(1)
v_cvt_pk_bf16_f32 v148,v148,v149
v_cvt_pk_bf16_f32 v149,v150,v151
M v[60:63],a[144:147],a[188:191],v[60:63]
ds_write2st64_b64 v254,v[144:145],v[148:149] offset0:51 offset1:55
M v[60:63],a[124:127],a[184:187],v[60:63]
buffer_load_dwordx4 v[228:231],v250,s[20:23],s48 offen offset:1024 sc1
M v[60:63],a[112:115],a[176:179],v[60:63]
s_waitcnt vmcnt(28)
v_cvt_pk_bf16_f32 v152,v152,v153
v_cvt_pk_bf16_f32 v153,v154,v155
M v[64:67],a[172:175],a[96:99],v[64:67]
s_waitcnt vmcnt(27)
v_cvt_pk_bf16_f32 v156,v156,v157
v_cvt_pk_bf16_f32 v157,v158,v159
M v[64:67],a[200:203],a[100:103],v[64:67]
s_waitcnt vmcnt(26)
ds_write2st64_b64 v254,v[152:153],v[156:157] offset0:59 offset1:63
M v[64:67],a[192:195],a[120:123],v[64:67]
buffer_load_dwordx4 v[224:227],v250,s[20:23],s48 offen offset:2048 sc1
M v[68:71],a[192:195],a[140:143],v[68:71]
v_lshlrev_b32 v234,16,v208
v_lshlrev_b32 v232,16,v204
M v[68:71],a[200:203],a[120:123],v[68:71]
v_lshlrev_b32 v233,16,v206
v_lshlrev_b32 v237,16,v214
M v[68:71],a[172:175],a[100:103],v[68:71]
v_lshlrev_b32 v236,16,v212
v_lshlrev_b32 v235,16,v210
M v[72:75],a[172:175],a[120:123],v[72:75]
v_fmac_f32 v232,s43,v234
v_fmac_f32 v237,4.0,v233
M v[72:75],a[200:203],a[140:143],v[72:75]
v_fma_f32 v238,-4.0,v234,v236
v_fmac_f32 v232,s45,v236
M v[72:75],a[192:195],a[160:163],v[72:75]
s_add_u32 s34,s32,786432
buffer_store_dwordx4 a[80:83],v253,s[24:27],s34 offen offset:640 nt
M v[76:79],a[192:195],a[164:167],v[76:79]
s_waitcnt lgkmcnt(0)
s_barrier
ds_read_b128 v[128:131],v250 offset:17408
M v[76:79],a[200:203],a[160:163],v[76:79]
ds_read_b128 v[136:139],v250 offset:21504
ds_read_b128 v[144:147],v250 offset:26112
M v[76:79],a[172:175],a[140:143],v[76:79]
ds_read_b128 v[152:155],v250 offset:30208
v_fmac_f32 v237,s41,v235
M v[80:83],a[172:175],a[160:163],v[80:83]
s_add_u32 s47,s76,3072
v_sub_f32 v236,v236,v234
v_fma_f32 v234,-4.0,v233,v235
M v[80:83],a[200:203],a[164:167],v[80:83]
v_add_u32 v248,0x15400,v248
v_add_u32 v249,0x15400,v249
M v[80:83],a[192:195],a[168:171],v[80:83]
v_sub_f32 v235,v235,v233
v_add_f32 v233,v238,v234
M v[84:87],a[192:195],a[176:179],v[84:87]
v_sub_f32 v238,v238,v234
v_fma_f32 v234,2.0,v235,v236
M v[84:87],a[200:203],a[168:171],v[84:87]
ds_read_b128 a[96:99],v248 offset:0
v_fmac_f32 v236,-2.0,v235
M v[84:87],a[172:175],a[164:167],v[84:87]
ds_read_b128 a[100:103],v249 offset:0
v_and_b32 v208,s42,v208
M v[88:91],a[172:175],a[168:171],v[88:91]
buffer_load_dwordx4 a[112:115],v250,s[20:23],s47 offen offset:0 sc1
M v[88:91],a[200:203],a[176:179],v[88:91]
ds_read_b128 a[120:123],v248 offset:512
ds_read_b128 a[140:143],v249 offset:512
M v[88:91],a[192:195],a[184:187],v[88:91]
buffer_load_dwordx4 a[124:127],v250,s[20:23],s47 offen offset:1024 sc1
M v[92:95],a[192:195],a[188:191],v[92:95]
v_and_b32 v204,s42,v204
v_and_b32 v206,s42,v206
M v[92:95],a[200:203],a[184:187],v[92:95]
v_and_b32 v214,s42,v214
v_and_b32 v212,s42,v212
M v[92:95],a[172:175],a[176:179],v[92:95]
s_waitcnt vmcnt(28) lgkmcnt(3)
v_and_b32 v210,s42,v210
v_fmac_f32 v204,s43,v208
M v[32:35],a[104:107],a[96:99],v[32:35]
s_waitcnt vmcnt(27) lgkmcnt(2)
buffer_load_dwordx4 a[144:147],v250,s[20:23],s47 offen offset:2048 sc1
M v[32:35],a[128:131],a[100:103],v[32:35]
s_waitcnt vmcnt(27) lgkmcnt(1)
ds_read_b128 a[160:163],v248 offset:1024
ds_read_b128 a[164:167],v249 offset:1024
M v[32:35],a[152:155],a[120:123],v[32:35]
s_waitcnt lgkmcnt(2)
s_add_u32 s34,s32,983040
v_fmac_f32 v214,4.0,v206
v_fma_f32 v235,-4.0,v208,v212
M v[36:39],a[152:155],a[140:143],v[36:39]
v_fmac_f32 v204,s45,v212
v_fmac_f32 v214,s41,v210
M v[36:39],a[128:131],a[120:123],v[36:39]
v_sub_f32 v212,v212,v208
v_fma_f32 v208,-4.0,v206,v210
M v[36:39],a[104:107],a[100:103],v[36:39]
buffer_store_dwordx4 a[84:87],v253,s[24:27],s34 offen offset:640 nt
M v[40:43],a[104:107],a[120:123],v[40:43]
ds_read_b128 a[168:171],v248 offset:1536
v_sub_f32 v210,v210,v206
M v[40:43],a[128:131],a[140:143],v[40:43]
s_waitcnt lgkmcnt(2)
ds_read_b128 a[172:175],v249 offset:1536
v_add_f32 v206,v235,v208
M v[40:43],a[152:155],a[160:163],v[40:43]
s_waitcnt lgkmcnt(2)
v_sub_f32 v235,v235,v208
v_fma_f32 v208,2.0,v210,v212
M v[44:47],a[152:155],a[164:167],v[44:47]
v_fmac_f32 v212,-2.0,v210
v_cvt_pk_bf16_f32 v204,v232,v204
M v[44:47],a[128:131],a[160:163],v[44:47]
v_cvt_pk_bf16_f32 v214,v237,v214
v_cvt_pk_bf16_f32 v206,v233,v206
M v[44:47],a[104:107],a[140:143],v[44:47]
v_cvt_pk_bf16_f32 v210,v234,v208
v_cvt_pk_bf16_f32 v208,v238,v235
M v[48:51],a[104:107],a[160:163],v[48:51]
s_add_u32 s48,s76,6144
ds_read_b128 a[176:179],v249 offset:2048
v_cvt_pk_bf16_f32 v212,v236,v212
M v[48:51],a[128:131],a[164:167],v[48:51]
s_waitcnt lgkmcnt(2)
ds_read_b128 a[184:187],v248 offset:2048
v_lshlrev_b32 v234,16,v209
M v[48:51],a[152:155],a[168:171],v[48:51]
s_waitcnt lgkmcnt(2)
v_lshlrev_b32 v232,16,v205
v_lshlrev_b32 v233,16,v207
M v[52:55],a[152:155],a[172:175],v[52:55]
v_lshlrev_b32 v237,16,v215
v_lshlrev_b32 v236,16,v213
M v[52:55],a[128:131],a[168:171],v[52:55]
v_lshlrev_b32 v235,16,v211
v_fmac_f32 v232,s43,v234
M v[52:55],a[104:107],a[164:167],v[52:55]
v_fmac_f32 v237,4.0,v233
v_fma_f32 v238,-4.0,v234,v236
M v[56:59],a[104:107],a[168:171],v[56:59]
buffer_load_dwordx4 a[188:191],v250,s[20:23],s48 offen offset:0 sc1
M v[56:59],a[128:131],a[172:175],v[56:59]
s_waitcnt lgkmcnt(1)
v_fmac_f32 v232,s45,v236
v_fmac_f32 v237,s41,v235
M v[56:59],a[152:155],a[176:179],v[56:59]
s_waitcnt lgkmcnt(0)
s_add_u32 s34,s32,1179648
buffer_load_dwordx4 a[228:231],v250,s[20:23],s48 offen offset:1024 sc1
M v[60:63],a[152:155],a[184:187],v[60:63]
v_sub_f32 v236,v236,v234
v_fma_f32 v234,-4.0,v233,v235
M v[60:63],a[128:131],a[176:179],v[60:63]
v_sub_f32 v235,v235,v233
v_add_f32 v233,v238,v234
M v[60:63],a[104:107],a[172:175],v[60:63]
s_waitcnt vmcnt(28)
v_sub_f32 v238,v238,v234
v_fma_f32 v234,2.0,v235,v236
M v[64:67],a[180:183],a[96:99],v[64:67]
s_waitcnt vmcnt(27)
buffer_load_dwordx4 a[224:227],v250,s[20:23],s48 offen offset:2048 sc1
M v[64:67],a[196:199],a[100:103],v[64:67]
s_waitcnt vmcnt(27)
v_fmac_f32 v236,-2.0,v235
v_and_b32 v209,s42,v209
M v[64:67],a[248:251],a[120:123],v[64:67]
v_and_b32 v205,s42,v205
v_and_b32 v207,s42,v207
M v[68:71],a[248:251],a[140:143],v[68:71]
v_and_b32 v215,s42,v215
v_and_b32 v213,s42,v213
M v[68:71],a[196:199],a[120:123],v[68:71]
v_and_b32 v211,s42,v211
v_fmac_f32 v205,s43,v209
M v[68:71],a[180:183],a[100:103],v[68:71]
buffer_store_dwordx4 a[88:91],v253,s[24:27],s34 offen offset:640 nt
M v[72:75],a[180:183],a[120:123],v[72:75]
v_fmac_f32 v215,4.0,v207
v_fma_f32 v235,-4.0,v209,v213
M v[72:75],a[196:199],a[140:143],v[72:75]
v_fmac_f32 v205,s45,v213
v_fmac_f32 v215,s41,v211
M v[72:75],a[248:251],a[160:163],v[72:75]
v_sub_f32 v213,v213,v209
v_fma_f32 v209,-4.0,v207,v211
M v[76:79],a[248:251],a[164:167],v[76:79]
v_sub_f32 v211,v211,v207
v_add_f32 v207,v235,v209
M v[76:79],a[196:199],a[160:163],v[76:79]
v_sub_f32 v235,v235,v209
v_fma_f32 v209,2.0,v211,v213
M v[76:79],a[180:183],a[140:143],v[76:79]
v_fmac_f32 v213,-2.0,v211
v_cvt_pk_bf16_f32 v205,v232,v205
M v[80:83],a[180:183],a[160:163],v[80:83]
s_add_u32 s47,s77,3072
v_cvt_pk_bf16_f32 v215,v237,v215
v_cvt_pk_bf16_f32 v207,v233,v207
M v[80:83],a[196:199],a[164:167],v[80:83]
v_cvt_pk_bf16_f32 v211,v234,v209
v_cvt_pk_bf16_f32 v209,v238,v235
M v[80:83],a[248:251],a[168:171],v[80:83]
s_add_u32 s34,s32,1376256
buffer_store_dwordx4 a[92:95],v253,s[24:27],s34 offen offset:640 nt
M v[84:87],a[248:251],a[172:175],v[84:87]
v_cvt_pk_bf16_f32 v213,v236,v213
M v[84:87],a[196:199],a[168:171],v[84:87]
s_barrier
ds_read_b128 a[96:99],v248 offset:17408
M v[84:87],a[180:183],a[164:167],v[84:87]
ds_write2st64_b64 v247,v[192:193],v[202:203] offset0:102 offset1:119
M v[88:91],a[180:183],a[168:171],v[88:91]
s_add_u32 s28,s66,7077888
buffer_load_dwordx2 v[192:193],v245,s[12:15],s28 offen offset:0
M v[88:91],a[196:199],a[172:175],v[88:91]
ds_read_b128 a[100:103],v249 offset:17408
ds_read_b128 a[120:123],v248 offset:17920
M v[88:91],a[248:251],a[176:179],v[88:91]
buffer_load_dwordx2 v[202:203],v245,s[16:19],s28 offen offset:1536
M v[92:95],a[248:251],a[184:187],v[92:95]
ds_read_b128 a[140:143],v249 offset:17920
v_fmac_f32 v239,s43,v241
M v[92:95],a[196:199],a[176:179],v[92:95]
v_fmac_f32 v244,4.0,v240
v_fma_f32 v232,-4.0,v241,v243
M v[92:95],a[180:183],a[172:175],v[92:95]
s_waitcnt vmcnt(28) lgkmcnt(4)
ds_write2st64_b64 v247,v[194:195],v[196:197] offset0:34 offset1:51
M v[32:35],a[116:119],a[96:99],v[32:35]
s_waitcnt vmcnt(27) lgkmcnt(3)
buffer_load_dwordx2 v[194:195],v245,s[8:11],s28 offen offset:0
M v[32:35],a[136:139],a[100:103],v[32:35]
s_waitcnt vmcnt(27) lgkmcnt(2)
ds_read_b128 a[160:163],v248 offset:18432
ds_read_b128 a[164:167],v249 offset:18432
M v[32:35],a[156:159],a[120:123],v[32:35]
s_waitcnt lgkmcnt(3)
ds_write2st64_b64 v247,v[198:199],v[200:201] offset0:68 offset1:85
M v[36:39],a[156:159],a[140:143],v[36:39]
buffer_load_dwordx2 v[196:197],v245,s[8:11],s28 offen offset:384
M v[36:39],a[136:139],a[120:123],v[36:39]
v_fmac_f32 v239,s45,v243
v_fmac_f32 v244,s41,v242
M v[36:39],a[116:119],a[100:103],v[36:39]
ds_write2st64_b64 v247,v[204:205],v[214:215] offset0:103 offset1:120
M v[40:43],a[116:119],a[120:123],v[40:43]
buffer_load_dwordx2 v[198:199],v245,s[8:11],s28 offen offset:768
M v[40:43],a[136:139],a[140:143],v[40:43]
s_waitcnt lgkmcnt(3)
ds_read_b128 a[168:171],v248 offset:18944
ds_read_b128 a[172:175],v249 offset:18944
M v[40:43],a[156:159],a[160:163],v[40:43]
s_waitcnt lgkmcnt(4)
s_add_u32 s34,s33,0
ds_write2st64_b64 v247,v[206:207],v[208:209] offset0:35 offset1:52
M v[44:47],a[156:159],a[164:167],v[44:47]
buffer_load_dwordx2 v[200:201],v245,s[8:11],s28 offen offset:1152
M v[44:47],a[136:139],a[160:163],v[44:47]
s_add_u32 s28,s66,7471104
v_sub_f32 v243,v243,v241
v_fma_f32 v241,-4.0,v240,v242
M v[44:47],a[116:119],a[140:143],v[44:47]
ds_write2st64_b64 v247,v[210:211],v[212:213] offset0:69 offset1:86
M v[48:51],a[116:119],a[160:163],v[48:51]
ds_read_b128 a[176:179],v249 offset:19456
v_sub_f32 v242,v242,v240
M v[48:51],a[136:139],a[164:167],v[48:51]
s_waitcnt lgkmcnt(4)
buffer_load_dwordx2 v[204:205],v245,s[12:15],s28 offen offset:0
M v[48:51],a[156:159],a[168:171],v[48:51]
s_waitcnt lgkmcnt(3)
ds_read_b128 a[180:183],v248 offset:19456
v_add_f32 v240,v232,v241
M v[52:55],a[156:159],a[172:175],v[52:55]
v_sub_f32 v232,v232,v241
v_fma_f32 v241,2.0,v242,v243
M v[52:55],a[136:139],a[168:171],v[52:55]
v_fmac_f32 v243,-2.0,v242
v_cvt_pk_bf16_f32 v233,v239,v244
M v[52:55],a[116:119],a[164:167],v[52:55]
buffer_load_dwordx2 v[214:215],v245,s[16:19],s28 offen offset:1536
M v[56:59],a[116:119],a[168:171],v[56:59]
v_cvt_pk_bf16_f32 v234,v240,v232
v_cvt_pk_bf16_f32 v235,v241,v243
M v[56:59],a[136:139],a[172:175],v[56:59]
s_waitcnt lgkmcnt(1)
ds_write_b16 v252,v233 offset:52224
M v[56:59],a[156:159],a[176:179],v[56:59]
s_waitcnt lgkmcnt(1)
ds_write_b16_d16_hi v252,v233 offset:60928
M v[60:63],a[156:159],a[180:183],v[60:63]
buffer_load_dwordx2 v[206:207],v245,s[8:11],s28 offen offset:0
M v[60:63],a[136:139],a[176:179],v[60:63]
ds_write_b16 v252,v234 offset:17408
M v[60:63],a[116:119],a[172:175],v[60:63]
s_waitcnt vmcnt(32)
ds_write_b16_d16_hi v252,v234 offset:26112
M v[64:67],a[216:219],a[96:99],v[64:67]
s_waitcnt vmcnt(31)
ds_write_b16 v252,v235 offset:34816
M v[64:67],a[244:247],a[100:103],v[64:67]
s_waitcnt vmcnt(30)
buffer_load_dwordx2 v[208:209],v245,s[8:11],s28 offen offset:384
M v[64:67],v[216:219],a[120:123],v[64:67]
ds_write_b16_d16_hi v252,v235 offset:43520
M v[68:71],v[216:219],a[140:143],v[68:71]
M v[68:71],a[244:247],a[120:123],v[68:71]
M v[68:71],a[216:219],a[100:103],v[68:71]
buffer_load_dwordx2 v[210:211],v245,s[8:11],s28 offen offset:768
M v[72:75],a[216:219],a[120:123],v[72:75]
M v[72:75],a[244:247],a[140:143],v[72:75]
M v[72:75],v[216:219],a[160:163],v[72:75]
M v[76:79],v[216:219],a[164:167],v[76:79]
buffer_load_dwordx2 v[212:213],v245,s[8:11],s28 offen offset:1152
M v[76:79],a[244:247],a[160:163],v[76:79]
s_add_u32 s29,s67,6291456
M v[76:79],a[216:219],a[140:143],v[76:79]
M v[80:83],a[216:219],a[160:163],v[80:83]
M v[80:83],a[244:247],a[164:167],v[80:83]
buffer_load_short_d16_hi v239,v246,s[12:15],s29 offen offset:0
M v[80:83],v[216:219],a[168:171],v[80:83]
M v[84:87],v[216:219],a[172:175],v[84:87]
buffer_load_short_d16_hi v240,v246,s[8:11],s29 offen offset:0
M v[84:87],a[244:247],a[168:171],v[84:87]
ds_read_b128 a[96:99],v248 offset:34816
M v[84:87],a[216:219],a[164:167],v[84:87]
buffer_load_short_d16_hi v241,v246,s[8:11],s29 offen offset:384
M v[88:91],a[216:219],a[168:171],v[88:91]
ds_read_b128 a[100:103],v249 offset:34816
ds_read_b128 a[120:123],v248 offset:35328
M v[88:91],a[244:247],a[172:175],v[88:91]
buffer_load_short_d16_hi v242,v246,s[8:11],s29 offen offset:768
M v[88:91],v[216:219],a[176:179],v[88:91]
ds_read_b128 a[140:143],v249 offset:35328
M v[92:95],v[216:219],a[180:183],v[92:95]
buffer_load_short_d16_hi v243,v246,s[8:11],s29 offen offset:1152
M v[92:95],a[244:247],a[176:179],v[92:95]
M v[92:95],a[216:219],a[172:175],v[92:95]
s_waitcnt vmcnt(35) lgkmcnt(3)
buffer_load_short_d16_hi v244,v246,s[16:19],s29 offen offset:1536
M v[32:35],a[108:111],a[96:99],v[32:35]
s_waitcnt vmcnt(35) lgkmcnt(2)
ds_read_b128 a[160:163],v248 offset:35840
M v[32:35],a[132:135],a[100:103],v[32:35]
s_waitcnt vmcnt(34) lgkmcnt(2)
buffer_load_dwordx4 a[104:107],v250,s[20:23],s47 offen offset:0 sc1
M v[32:35],a[148:151],a[120:123],v[32:35]
s_waitcnt lgkmcnt(1)
ds_read_b128 a[164:167],v249 offset:35840
M v[36:39],a[148:151],a[140:143],v[36:39]
M v[36:39],a[132:135],a[120:123],v[36:39]
M v[36:39],a[108:111],a[100:103],v[36:39]
buffer_load_dwordx4 a[128:131],v250,s[20:23],s47 offen offset:1024 sc1
M v[40:43],a[108:111],a[120:123],v[40:43]
ds_read_b128 a[168:171],v248 offset:36352
M v[40:43],a[132:135],a[140:143],v[40:43]
s_waitcnt lgkmcnt(2)
ds_read_b128 a[172:175],v249 offset:36352
M v[40:43],a[148:151],a[160:163],v[40:43]
s_waitcnt lgkmcnt(2)
M v[44:47],a[148:151],a[164:167],v[44:47]
buffer_load_dwordx4 a[152:155],v250,s[20:23],s47 offen offset:2048 sc1
M v[44:47],a[132:135],a[160:163],v[44:47]
s_add_u32 s48,s77,6144
M v[44:47],a[108:111],a[140:143],v[44:47]
s_waitcnt vmcnt(17)
v_lshlrev_b32 v234,16,v196
v_lshlrev_b32 v232,16,v192
M v[48:51],a[108:111],a[160:163],v[48:51]
ds_read_b128 a[176:179],v249 offset:36864
v_lshlrev_b32 v233,16,v194
M v[48:51],a[132:135],a[164:167],v[48:51]
s_waitcnt lgkmcnt(2)
buffer_load_dwordx4 a[184:187],v250,s[20:23],s48 offen offset:0 sc1
M v[48:51],a[148:151],a[168:171],v[48:51]
s_waitcnt lgkmcnt(1)
ds_read_b128 a[180:183],v248 offset:36864
v_lshlrev_b32 v237,16,v202
M v[52:55],a[148:151],a[172:175],v[52:55]
s_waitcnt vmcnt(16)
v_lshlrev_b32 v236,16,v200
v_lshlrev_b32 v235,16,v198
M v[52:55],a[132:135],a[168:171],v[52:55]
v_fmac_f32 v232,s43,v234
v_fmac_f32 v237,4.0,v233
M v[52:55],a[108:111],a[164:167],v[52:55]
buffer_store_dwordx4 v[96:99],v253,s[24:27],s34 offen offset:1152 nt
M v[56:59],a[108:111],a[168:171],v[56:59]
s_add_u32 s34,s33,393216
v_fma_f32 v238,-4.0,v234,v236
v_fmac_f32 v232,s45,v236
M v[56:59],a[132:135],a[172:175],v[56:59]
s_waitcnt lgkmcnt(1)
v_fmac_f32 v237,s41,v235
v_sub_f32 v236,v236,v234
M v[56:59],a[148:151],a[176:179],v[56:59]
s_waitcnt lgkmcnt(0)
buffer_load_dwordx4 a[204:207],v250,s[20:23],s48 offen offset:1024 sc1
M v[60:63],a[148:151],a[180:183],v[60:63]
v_fma_f32 v234,-4.0,v233,v235
v_sub_f32 v235,v235,v233
M v[60:63],a[132:135],a[176:179],v[60:63]
v_add_f32 v233,v238,v234
v_sub_f32 v238,v238,v234
M v[60:63],a[108:111],a[172:175],v[60:63]
v_fma_f32 v234,2.0,v235,v236
v_fmac_f32 v236,-2.0,v235
M v[64:67],a[212:215],a[96:99],v[64:67]
buffer_load_dwordx4 a[252:255],v250,s[20:23],s48 offen offset:2048 sc1
M v[64:67],v[228:231],a[100:103],v[64:67]
s_add_u32 s48,s72,52224
v_and_b32 v196,s42,v196
v_and_b32 v192,s42,v192
M v[64:67],v[224:227],a[120:123],v[64:67]
v_and_b32 v194,s42,v194
v_and_b32 v202,s42,v202
M v[68:71],v[224:227],a[140:143],v[68:71]
v_and_b32 v200,s42,v200
v_and_b32 v198,s42,v198
M v[68:71],v[228:231],a[120:123],v[68:71]
buffer_load_dwordx4 a[116:119],v250,s[20:23],s48 offen offset:0 sc1
M v[68:71],a[212:215],a[100:103],v[68:71]
v_fmac_f32 v192,s43,v196
v_fmac_f32 v202,4.0,v194
M v[72:75],a[212:215],a[120:123],v[72:75]
v_fma_f32 v235,-4.0,v196,v200
v_fmac_f32 v192,s45,v200
M v[72:75],v[228:231],a[140:143],v[72:75]
v_fmac_f32 v202,s41,v198
v_sub_f32 v200,v200,v196
M v[72:75],v[224:227],a[160:163],v[72:75]
buffer_store_dwordx4 v[104:107],v253,s[24:27],s34 offen offset:1152 nt
M v[76:79],v[224:227],a[164:167],v[76:79]
s_add_u32 s34,s33,786432
v_fma_f32 v196,-4.0,v194,v198
v_sub_f32 v198,v198,v194
M v[76:79],v[228:231],a[160:163],v[76:79]
v_add_f32 v194,v235,v196
v_sub_f32 v235,v235,v196
M v[76:79],a[212:215],a[140:143],v[76:79]
buffer_load_dwordx4 a[136:139],v250,s[20:23],s48 offen offset:1024 sc1
M v[80:83],a[212:215],a[160:163],v[80:83]
v_fma_f32 v196,2.0,v198,v200
v_fmac_f32 v200,-2.0,v198
M v[80:83],v[228:231],a[164:167],v[80:83]
v_cvt_pk_bf16_f32 v192,v232,v192
v_cvt_pk_bf16_f32 v202,v237,v202
M v[80:83],v[224:227],a[168:171],v[80:83]
v_cvt_pk_bf16_f32 v194,v233,v194
v_cvt_pk_bf16_f32 v198,v234,v196
M v[84:87],v[224:227],a[172:175],v[84:87]
buffer_load_dwordx4 a[156:159],v250,s[20:23],s48 offen offset:2048 sc1
M v[84:87],v[228:231],a[168:171],v[84:87]
s_add_u32 s48,s73,52224
ds_read_b128 a[96:99],v248 offset:52224
v_cvt_pk_bf16_f32 v196,v238,v235
M v[84:87],a[212:215],a[164:167],v[84:87]
ds_read_b128 a[100:103],v249 offset:52224
v_cvt_pk_bf16_f32 v200,v236,v200
M v[88:91],a[212:215],a[168:171],v[88:91]
ds_read_b128 a[120:123],v248 offset:52736
v_lshlrev_b32 v234,16,v197
M v[88:91],v[228:231],a[172:175],v[88:91]
buffer_load_dwordx4 a[236:239],v250,s[20:23],s48 offen offset:0 sc1
M v[88:91],v[224:227],a[176:179],v[88:91]
ds_read_b128 a[140:143],v249 offset:52736
v_lshlrev_b32 v232,16,v193
M v[92:95],v[224:227],a[180:183],v[92:95]
v_lshlrev_b32 v233,16,v195
v_lshlrev_b32 v237,16,v203
M v[92:95],v[228:231],a[176:179],v[92:95]
v_lshlrev_b32 v236,16,v201
v_lshlrev_b32 v235,16,v199
M v[92:95],a[212:215],a[172:175],v[92:95]
s_waitcnt lgkmcnt(3)
buffer_store_dwordx4 v[112:115],v253,s[24:27],s34 offen offset:1152 nt
M v[32:35],a[112:115],a[96:99],v[32:35]
s_waitcnt lgkmcnt(2)
s_add_u32 s34,s33,1179648
ds_read_b128 a[160:163],v248 offset:53248
v_fmac_f32 v232,s43,v234
M v[32:35],a[124:127],a[100:103],v[32:35]
s_waitcnt lgkmcnt(2)
ds_read_b128 a[164:167],v249 offset:53248
v_fmac_f32 v237,4.0,v233
M v[32:35],a[144:147],a[120:123],v[32:35]
s_waitcnt lgkmcnt(2)
buffer_store_dwordx4 v[120:123],v253,s[24:27],s34 offen offset:1152 nt
M v[36:39],a[144:147],a[140:143],v[36:39]
s_add_u32 s34,s33,0
v_fma_f32 v238,-4.0,v234,v236
v_fmac_f32 v232,s45,v236
M v[36:39],a[124:127],a[120:123],v[36:39]
v_fmac_f32 v237,s41,v235
v_sub_f32 v236,v236,v234
M v[36:39],a[112:115],a[100:103],v[36:39]
buffer_load_dwordx4 a[232:235],v250,s[20:23],s48 offen offset:1024 sc1
M v[40:43],a[112:115],a[120:123],v[40:43]
ds_read_b128 a[168:171],v248 offset:53760
v_fma_f32 v234,-4.0,v233,v235
M v[40:43],a[124:127],a[140:143],v[40:43]
s_waitcnt lgkmcnt(2)
ds_read_b128 a[172:175],v249 offset:53760
v_sub_f32 v235,v235,v233
M v[40:43],a[144:147],a[160:163],v[40:43]
s_waitcnt lgkmcnt(2)
v_add_f32 v233,v238,v234
v_sub_f32 v238,v238,v234
M v[44:47],a[144:147],a[164:167],v[44:47]
buffer_load_dwordx4 a[208:211],v250,s[20:23],s48 offen offset:2048 sc1
M v[44:47],a[124:127],a[160:163],v[44:47]
s_add_u32 s48,s74,52224
v_fma_f32 v234,2.0,v235,v236
v_fmac_f32 v236,-2.0,v235
M v[44:47],a[112:115],a[140:143],v[44:47]
v_and_b32 v197,s42,v197
v_and_b32 v193,s42,v193
M v[48:51],a[112:115],a[160:163],v[48:51]
ds_read_b128 a[176:179],v249 offset:54272
v_and_b32 v195,s42,v195
M v[48:51],a[124:127],a[164:167],v[48:51]
s_waitcnt lgkmcnt(2)
buffer_load_dwordx4 a[108:111],v250,s[20:23],s48 offen offset:0 sc1
M v[48:51],a[144:147],a[168:171],v[48:51]
s_waitcnt lgkmcnt(1)
ds_read_b128 a[180:183],v248 offset:54272
v_and_b32 v203,s42,v203
M v[52:55],a[144:147],a[172:175],v[52:55]
v_and_b32 v201,s42,v201
v_and_b32 v199,s42,v199
M v[52:55],a[124:127],a[168:171],v[52:55]
v_fmac_f32 v193,s43,v197
v_fmac_f32 v203,4.0,v195
M v[52:55],a[112:115],a[164:167],v[52:55]
buffer_store_dwordx4 v[128:131],v253,s[24:27],s34 offen offset:1280 nt
M v[56:59],a[112:115],a[168:171],v[56:59]
s_add_u32 s34,s33,393216
v_fma_f32 v235,-4.0,v197,v201
v_fmac_f32 v193,s45,v201
M v[56:59],a[124:127],a[172:175],v[56:59]
s_waitcnt lgkmcnt(1)
v_fmac_f32 v203,s41,v199
v_sub_f32 v201,v201,v197
M v[56:59],a[144:147],a[176:179],v[56:59]
s_waitcnt lgkmcnt(0)
buffer_load_dwordx4 a[132:135],v250,s[20:23],s48 offen offset:1024 sc1
M v[60:63],a[144:147],a[180:183],v[60:63]
v_fma_f32 v197,-4.0,v195,v199
v_sub_f32 v199,v199,v195
M v[60:63],a[124:127],a[176:179],v[60:63]
v_add_f32 v195,v235,v197
v_sub_f32 v235,v235,v197
M v[60:63],a[112:115],a[172:175],v[60:63]
v_fma_f32 v197,2.0,v199,v201
v_fmac_f32 v201,-2.0,v199
M v[64:67],a[188:191],a[96:99],v[64:67]
buffer_load_dwordx4 a[148:151],v250,s[20:23],s48 offen offset:2048 sc1
M v[64:67],a[228:231],a[100:103],v[64:67]
s_add_u32 s48,s75,52224
v_cvt_pk_bf16_f32 v193,v232,v193
v_cvt_pk_bf16_f32 v203,v237,v203
M v[64:67],a[224:227],a[120:123],v[64:67]
v_cvt_pk_bf16_f32 v195,v233,v195
v_cvt_pk_bf16_f32 v199,v234,v197
M v[68:71],a[224:227],a[140:143],v[68:71]
v_cvt_pk_bf16_f32 v197,v238,v235
v_cvt_pk_bf16_f32 v201,v236,v201
M v[68:71],a[228:231],a[120:123],v[68:71]
buffer_load_dwordx4 a[220:223],v250,s[20:23],s48 offen offset:0 sc1
M v[68:71],a[188:191],a[100:103],v[68:71]
ds_write2st64_b64 v247,v[192:193],v[202:203] offset0:104 offset1:121
M v[72:75],a[188:191],a[120:123],v[72:75]
s_waitcnt vmcnt(29)
s_add_u32 s28,s67,6291456
v_lshlrev_b32 v234,16,v208
v_lshlrev_b32 v232,16,v204
M v[72:75],a[228:231],a[140:143],v[72:75]
buffer_load_dwordx2 v[192:193],v245,s[12:15],s28 offen offset:0
M v[72:75],a[224:227],a[160:163],v[72:75]
ds_write2st64_b64 v247,v[194:195],v[196:197] offset0:36 offset1:53
M v[76:79],a[224:227],a[164:167],v[76:79]
v_lshlrev_b32 v233,16,v206
v_lshlrev_b32 v237,16,v214
M v[76:79],a[228:231],a[160:163],v[76:79]
buffer_load_dwordx2 v[202:203],v245,s[16:19],s28 offen offset:1536
M v[76:79],a[188:191],a[140:143],v[76:79]
ds_write2st64_b64 v247,v[198:199],v[200:201] offset0:70 offset1:87
M v[80:83],a[188:191],a[160:163],v[80:83]
s_waitcnt vmcnt(29)
v_lshlrev_b32 v236,16,v212
v_lshlrev_b32 v235,16,v210
M v[80:83],a[228:231],a[164:167],v[80:83]
buffer_load_dwordx2 v[194:195],v245,s[8:11],s28 offen offset:0
M v[80:83],a[224:227],a[168:171],v[80:83]
v_add_u32 v248,0xfffece00,v248
v_add_u32 v249,0xfffece00,v249
M v[84:87],a[224:227],a[172:175],v[84:87]
v_fmac_f32 v232,s43,v234
v_fmac_f32 v237,4.0,v233
M v[84:87],a[228:231],a[168:171],v[84:87]
ds_read_b128 a[96:99],v248 offset:60928
v_fma_f32 v238,-4.0,v234,v236
M v[84:87],a[188:191],a[164:167],v[84:87]
buffer_load_dwordx2 v[196:197],v245,s[8:11],s28 offen offset:384
M v[88:91],a[188:191],a[168:171],v[88:91]
ds_read_b128 a[100:103],v249 offset:60928
ds_read_b128 a[120:123],v248 offset:61440
M v[88:91],a[228:231],a[172:175],v[88:91]
ds_read_b128 a[140:143],v249 offset:61440
v_fmac_f32 v232,s45,v236
M v[88:91],a[224:227],a[176:179],v[88:91]
v_fmac_f32 v237,s41,v235
v_sub_f32 v236,v236,v234
M v[92:95],a[224:227],a[180:183],v[92:95]
buffer_load_dwordx2 v[198:199],v245,s[8:11],s28 offen offset:768
M v[92:95],a[228:231],a[176:179],v[92:95]
v_fma_f32 v234,-4.0,v233,v235
v_sub_f32 v235,v235,v233
M v[92:95],a[188:191],a[172:175],v[92:95]
s_waitcnt vmcnt(25) lgkmcnt(3)
v_add_f32 v233,v238,v234
v_sub_f32 v238,v238,v234
M v[32:35],a[104:107],a[96:99],v[32:35]
s_waitcnt vmcnt(24) lgkmcnt(2)
ds_read_b128 a[160:163],v248 offset:61952
v_fma_f32 v234,2.0,v235,v236
M v[32:35],a[128:131],a[100:103],v[32:35]
s_waitcnt vmcnt(23) lgkmcnt(2)
buffer_load_dwordx2 v[200:201],v245,s[8:11],s28 offen offset:1152
M v[32:35],a[152:155],a[120:123],v[32:35]
s_waitcnt lgkmcnt(1)
ds_read_b128 a[164:167],v249 offset:61952
v_fmac_f32 v236,-2.0,v235
M v[36:39],a[152:155],a[140:143],v[36:39]
v_and_b32 v208,s42,v208
v_and_b32 v204,s42,v204
M v[36:39],a[128:131],a[120:123],v[36:39]
v_and_b32 v206,s42,v206
v_and_b32 v214,s42,v214
M v[36:39],a[104:107],a[100:103],v[36:39]
buffer_store_dwordx4 v[136:139],v253,s[24:27],s34 offen offset:1280 nt
M v[40:43],a[104:107],a[120:123],v[40:43]
s_add_u32 s34,s33,786432
ds_read_b128 a[168:171],v248 offset:62464
v_and_b32 v212,s42,v212
M v[40:43],a[128:131],a[140:143],v[40:43]
s_waitcnt lgkmcnt(2)
ds_read_b128 a[172:175],v249 offset:62464
v_and_b32 v210,s42,v210
M v[40:43],a[152:155],a[160:163],v[40:43]
s_waitcnt lgkmcnt(2)
buffer_load_dwordx4 v[220:223],v250,s[20:23],s48 offen offset:1024 sc1
M v[44:47],a[152:155],a[164:167],v[44:47]
v_fmac_f32 v204,s43,v208
v_fmac_f32 v214,4.0,v206
M v[44:47],a[128:131],a[160:163],v[44:47]
v_fma_f32 v235,-4.0,v208,v212
v_fmac_f32 v204,s45,v212
M v[44:47],a[104:107],a[140:143],v[44:47]
v_fmac_f32 v214,s41,v210
v_sub_f32 v212,v212,v208
M v[48:51],a[104:107],a[160:163],v[48:51]
buffer_load_dwordx4 a[240:243],v250,s[20:23],s48 offen offset:2048 sc1
M v[48:51],a[128:131],a[164:167],v[48:51]
s_waitcnt lgkmcnt(1)
s_add_u32 s48,s76,52224
ds_read_b128 a[176:179],v249 offset:62976
ds_read_b128 a[180:183],v248 offset:62976
M v[48:51],a[152:155],a[168:171],v[48:51]
s_waitcnt lgkmcnt(2)
v_fma_f32 v208,-4.0,v206,v210
v_sub_f32 v210,v210,v206
M v[52:55],a[152:155],a[172:175],v[52:55]
v_add_f32 v206,v235,v208
v_sub_f32 v235,v235,v208
M v[52:55],a[128:131],a[168:171],v[52:55]
buffer_load_dwordx4 a[112:115],v250,s[20:23],s48 offen offset:0 sc1
M v[52:55],a[104:107],a[164:167],v[52:55]
v_fma_f32 v208,2.0,v210,v212
v_fmac_f32 v212,-2.0,v210
M v[56:59],a[104:107],a[168:171],v[56:59]
v_cvt_pk_bf16_f32 v204,v232,v204
v_cvt_pk_bf16_f32 v214,v237,v214
M v[56:59],a[128:131],a[172:175],v[56:59]
s_waitcnt lgkmcnt(1)
v_cvt_pk_bf16_f32 v206,v233,v206
v_cvt_pk_bf16_f32 v210,v234,v208
M v[56:59],a[152:155],a[176:179],v[56:59]
s_waitcnt lgkmcnt(0)
buffer_store_dwordx4 v[144:147],v253,s[24:27],s34 offen offset:1280 nt
M v[60:63],a[152:155],a[180:183],v[60:63]
s_add_u32 s34,s33,1179648
v_cvt_pk_bf16_f32 v208,v238,v235
v_cvt_pk_bf16_f32 v212,v236,v212
M v[60:63],a[128:131],a[176:179],v[60:63]
v_lshlrev_b32 v234,16,v209
v_lshlrev_b32 v232,16,v205
M v[60:63],a[104:107],a[172:175],v[60:63]
s_waitcnt vmcnt(28)
buffer_store_dwordx4 v[152:155],v253,s[24:27],s34 offen offset:1280 nt
M v[64:67],a[184:187],a[96:99],v[64:67]
s_waitcnt vmcnt(27)
v_lshlrev_b32 v233,16,v207
v_lshlrev_b32 v237,16,v215
M v[64:67],a[204:207],a[100:103],v[64:67]
s_waitcnt vmcnt(26)
v_lshlrev_b32 v236,16,v213
v_lshlrev_b32 v235,16,v211
M v[64:67],a[252:255],a[120:123],v[64:67]
buffer_load_dwordx4 a[124:127],v250,s[20:23],s48 offen offset:1024 sc1
M v[68:71],a[252:255],a[140:143],v[68:71]
v_fmac_f32 v232,s43,v234
v_fmac_f32 v237,4.0,v233
M v[68:71],a[204:207],a[120:123],v[68:71]
v_fma_f32 v238,-4.0,v234,v236
v_fmac_f32 v232,s45,v236
M v[68:71],a[184:187],a[100:103],v[68:71]
v_fmac_f32 v237,s41,v235
v_sub_f32 v236,v236,v234
M v[72:75],a[184:187],a[120:123],v[72:75]
buffer_load_dwordx4 a[144:147],v250,s[20:23],s48 offen offset:2048 sc1
M v[72:75],a[204:207],a[140:143],v[72:75]
s_add_u32 s48,s77,52224
v_fma_f32 v234,-4.0,v233,v235
v_sub_f32 v235,v235,v233
M v[72:75],a[252:255],a[160:163],v[72:75]
v_add_f32 v233,v238,v234
v_sub_f32 v238,v238,v234
M v[76:79],a[252:255],a[164:167],v[76:79]
v_fma_f32 v234,2.0,v235,v236
v_fmac_f32 v236,-2.0,v235
M v[76:79],a[204:207],a[160:163],v[76:79]
buffer_load_dwordx4 a[188:191],v250,s[20:23],s48 offen offset:0 sc1
M v[76:79],a[184:187],a[140:143],v[76:79]
v_and_b32 v209,s42,v209
v_and_b32 v205,s42,v205
M v[80:83],a[184:187],a[160:163],v[80:83]
v_and_b32 v207,s42,v207
v_and_b32 v215,s42,v215
M v[80:83],a[204:207],a[164:167],v[80:83]
v_and_b32 v213,s42,v213
v_and_b32 v211,s42,v211
M v[80:83],a[252:255],a[168:171],v[80:83]
buffer_load_dwordx4 a[192:195],v250,s[20:23],s48 offen offset:1024 sc1
M v[84:87],a[252:255],a[172:175],v[84:87]
v_fmac_f32 v205,s43,v209
v_fmac_f32 v215,4.0,v207
M v[84:87],a[204:207],a[168:171],v[84:87]
ds_read_b128 a[96:99],v248 offset:0
v_fma_f32 v235,-4.0,v209,v213
M v[84:87],a[184:187],a[164:167],v[84:87]
ds_read_b128 a[100:103],v249 offset:0
v_fmac_f32 v205,s45,v213
M v[88:91],a[184:187],a[168:171],v[88:91]
buffer_load_dwordx4 a[200:203],v250,s[20:23],s48 offen offset:2048 sc1
M v[88:91],a[204:207],a[172:175],v[88:91]
s_add_u32 s46,s72,9216
ds_read_b128 a[120:123],v248 offset:512
ds_read_b128 a[140:143],v249 offset:512
M v[88:91],a[252:255],a[176:179],v[88:91]
v_fmac_f32 v215,s41,v211
v_sub_f32 v213,v213,v209
M v[92:95],a[252:255],a[180:183],v[92:95]
v_fma_f32 v209,-4.0,v207,v211
v_sub_f32 v211,v211,v207
M v[92:95],a[204:207],a[176:179],v[92:95]
buffer_load_dwordx4 a[104:107],v250,s[20:23],s46 offen offset:0 sc1
M v[92:95],a[184:187],a[172:175],v[92:95]
s_waitcnt vmcnt(31) lgkmcnt(3)
v_add_f32 v207,v235,v209
v_sub_f32 v235,v235,v209
M v[160:163],a[116:119],a[96:99],v[160:163]
s_waitcnt vmcnt(29) lgkmcnt(2)
ds_read_b128 a[96:99],v248 offset:1024
v_fma_f32 v209,2.0,v211,v213
M v[160:163],a[136:139],a[100:103],v[160:163]
s_waitcnt vmcnt(28) lgkmcnt(2)
ds_read_b128 a[160:163],v249 offset:1024
v_fmac_f32 v213,-2.0,v211
M v[160:163],a[156:159],a[120:123],v[160:163]
s_waitcnt lgkmcnt(2)
buffer_load_dwordx4 a[128:131],v250,s[20:23],s46 offen offset:1024 sc1
M v[164:167],a[156:159],a[140:143],v[164:167]
v_cvt_pk_bf16_f32 v205,v232,v205
v_cvt_pk_bf16_f32 v215,v237,v215
M v[164:167],a[136:139],a[120:123],v[164:167]
v_cvt_pk_bf16_f32 v207,v233,v207
v_cvt_pk_bf16_f32 v211,v234,v209
M v[164:167],a[116:119],a[100:103],v[164:167]
v_cvt_pk_bf16_f32 v209,v238,v235
v_cvt_pk_bf16_f32 v213,v236,v213
M v[168:171],a[116:119],a[120:123],v[168:171]
s_barrier
ds_read_b128 a[100:103],v248 offset:1536
M v[168:171],a[136:139],a[140:143],v[168:171]
s_waitcnt lgkmcnt(2)
buffer_load_dwordx4 a[152:155],v250,s[20:23],s46 offen offset:2048 sc1
M v[168:171],a[156:159],a[96:99],v[168:171]
s_waitcnt lgkmcnt(1)
ds_write2st64_b64 v247,v[204:205],v[214:215] offset0:105 offset1:122
M v[172:175],a[156:159],a[160:163],v[172:175]
s_add_u32 s28,s67,6684672
ds_read_b128 a[120:123],v249 offset:1536
v_cvt_pk_bf16_f32 v32,v32,v33
M v[172:175],a[136:139],a[96:99],v[172:175]
buffer_load_dwordx2 v[204:205],v245,s[12:15],s28 offen offset:0
M v[172:175],a[116:119],a[140:143],v[172:175]
ds_write2st64_b64 v247,v[206:207],v[208:209] offset0:37 offset1:54
M v[176:179],a[116:119],a[96:99],v[176:179]
s_add_u32 s47,s72,12288
ds_read_b128 a[96:99],v249 offset:2048
v_cvt_pk_bf16_f32 v33,v34,v35
M v[176:179],a[136:139],a[160:163],v[176:179]
s_waitcnt lgkmcnt(4)
buffer_load_dwordx2 v[214:215],v245,s[16:19],s28 offen offset:1536
M v[176:179],a[156:159],a[100:103],v[176:179]
s_waitcnt lgkmcnt(2)
ds_write2st64_b64 v247,v[210:211],v[212:213] offset0:71 offset1:88
M v[180:183],a[156:159],a[120:123],v[180:183]
ds_read_b128 a[140:143],v248 offset:2048
v_add_u32 v248,0x15400,v248
M v[180:183],a[136:139],a[100:103],v[180:183]
buffer_load_dwordx2 v[206:207],v245,s[8:11],s28 offen offset:0
M v[180:183],a[116:119],a[160:163],v[180:183]
v_add_u32 v249,0x15400,v249
v_cvt_pk_bf16_f32 v36,v36,v37
M v[184:187],a[116:119],a[100:103],v[184:187]
ds_read_b128 a[164:167],v248 offset:0
ds_read_b128 a[160:163],v249 offset:0
M v[184:187],a[136:139],a[120:123],v[184:187]
s_waitcnt lgkmcnt(4)
ds_read_b128 a[168:171],v248 offset:512
ds_read_b128 a[176:179],v249 offset:512
M v[184:187],a[156:159],a[96:99],v[184:187]
s_waitcnt lgkmcnt(4)
buffer_load_dwordx2 v[208:209],v245,s[8:11],s28 offen offset:384
M v[188:191],a[156:159],a[140:143],v[188:191]
v_cvt_pk_bf16_f32 v37,v38,v39
M v[188:191],a[136:139],a[96:99],v[188:191]
ds_write2st64_b64 v254,v[32:33],v[36:37] offset0:0 offset1:4
M v[188:191],a[116:119],a[120:123],v[188:191]
s_waitcnt vmcnt(33) lgkmcnt(4)
buffer_load_dwordx2 v[210:211],v245,s[8:11],s28 offen offset:768
M v[160:163],a[236:239],a[164:167],v[160:163]
s_waitcnt vmcnt(31) lgkmcnt(3)
ds_read_b128 a[96:99],v248 offset:1024
v_cvt_pk_bf16_f32 v40,v40,v41
M v[160:163],a[232:235],a[160:163],v[160:163]
s_waitcnt vmcnt(30) lgkmcnt(3)
ds_read_b128 a[116:119],v249 offset:1024
v_cvt_pk_bf16_f32 v41,v42,v43
M v[160:163],a[208:211],a[168:171],v[160:163]
s_waitcnt lgkmcnt(3)
v_cvt_pk_bf16_f32 v44,v44,v45
v_cvt_pk_bf16_f32 v45,v46,v47
M v[164:167],a[208:211],a[176:179],v[164:167]
buffer_load_dwordx2 v[212:213],v245,s[8:11],s28 offen offset:1152
M v[164:167],a[232:235],a[168:171],v[164:167]
ds_write2st64_b64 v254,v[40:41],v[44:45] offset0:8 offset1:12
M v[164:167],a[236:239],a[160:163],v[164:167]
v_cvt_pk_bf16_f32 v48,v48,v49
v_cvt_pk_bf16_f32 v49,v50,v51
M v[168:171],a[236:239],a[168:171],v[168:171]
ds_read_b128 a[120:123],v248 offset:1536
v_cvt_pk_bf16_f32 v52,v52,v53
M v[168:171],a[232:235],a[176:179],v[168:171]
s_waitcnt lgkmcnt(3)
buffer_load_dwordx4 a[100:103],v250,s[20:23],s47 offen offset:0 sc1
M v[168:171],a[208:211],a[96:99],v[168:171]
s_waitcnt lgkmcnt(2)
ds_read_b128 a[136:139],v249 offset:1536
v_cvt_pk_bf16_f32 v53,v54,v55
M v[172:175],a[208:211],a[116:119],v[172:175]
ds_write2st64_b64 v254,v[48:49],v[52:53] offset0:136 offset1:140
M v[172:175],a[232:235],a[96:99],v[172:175]
buffer_load_dwordx4 a[172:175],v250,s[20:23],s47 offen offset:1024 sc1
M v[172:175],a[236:239],a[176:179],v[172:175]
v_cvt_pk_bf16_f32 v56,v56,v57
v_cvt_pk_bf16_f32 v57,v58,v59
M v[176:179],a[236:239],a[96:99],v[176:179]
ds_read_b128 a[96:99],v249 offset:2048
v_cvt_pk_bf16_f32 v60,v60,v61
M v[176:179],a[232:235],a[116:119],v[176:179]
s_waitcnt lgkmcnt(3)
ds_read_b128 a[140:143],v248 offset:2048
v_cvt_pk_bf16_f32 v61,v62,v63
M v[176:179],a[208:211],a[120:123],v[176:179]
s_waitcnt lgkmcnt(3)
buffer_load_dwordx4 a[180:183],v250,s[20:23],s47 offen offset:2048 sc1
M v[180:183],a[208:211],a[136:139],v[180:183]
s_add_u32 s48,s72,15360
ds_write2st64_b64 v254,v[56:57],v[60:61] offset0:144 offset1:148
M v[180:183],a[232:235],a[120:123],v[180:183]
ds_read_b128 a[156:159],v248 offset:17408
v_cvt_pk_bf16_f32 v64,v64,v65
M v[180:183],a[236:239],a[116:119],v[180:183]
ds_read_b128 a[116:119],v249 offset:17408
v_cvt_pk_bf16_f32 v65,v66,v67
M v[184:187],a[236:239],a[120:123],v[184:187]
buffer_load_dwordx4 a[120:123],v250,s[20:23],s48 offen offset:0 sc1
M v[184:187],a[232:235],a[136:139],v[184:187]
s_waitcnt lgkmcnt(4)
ds_read_b128 a[160:163],v248 offset:17920
ds_read_b128 a[168:171],v249 offset:17920
M v[184:187],a[208:211],a[96:99],v[184:187]
s_waitcnt lgkmcnt(5)
v_cvt_pk_bf16_f32 v68,v68,v69
v_cvt_pk_bf16_f32 v69,v70,v71
M v[188:191],a[208:211],a[140:143],v[188:191]
buffer_load_dwordx4 a[164:167],v250,s[20:23],s48 offen offset:1024 sc1
M v[188:191],a[232:235],a[96:99],v[188:191]
ds_write2st64_b64 v254,v[64:65],v[68:69] offset0:170 offset1:174
M v[188:191],a[236:239],a[136:139],v[188:191]
s_waitcnt vmcnt(35) lgkmcnt(4)
v_cvt_pk_bf16_f32 v72,v72,v73
v_cvt_pk_bf16_f32 v73,v74,v75
M v[160:163],a[108:111],a[156:159],v[160:163]
s_waitcnt vmcnt(33) lgkmcnt(3)
buffer_load_dwordx4 a[176:179],v250,s[20:23],s48 offen offset:2048 sc1
M v[160:163],a[132:135],a[116:119],v[160:163]
s_waitcnt vmcnt(33) lgkmcnt(2)
ds_read_b128 a[96:99],v248 offset:18432
ds_read_b128 a[136:139],v249 offset:18432
M v[160:163],a[148:151],a[160:163],v[160:163]
s_waitcnt lgkmcnt(3)
v_cvt_pk_bf16_f32 v76,v76,v77
v_cvt_pk_bf16_f32 v77,v78,v79
M v[164:167],a[148:151],a[168:171],v[164:167]
ds_write2st64_b64 v254,v[72:73],v[76:77] offset0:178 offset1:182
M v[164:167],a[132:135],a[160:163],v[164:167]
v_cvt_pk_bf16_f32 v80,v80,v81
v_cvt_pk_bf16_f32 v81,v82,v83
M v[164:167],a[108:111],a[116:119],v[164:167]
v_cvt_pk_bf16_f32 v84,v84,v85
v_cvt_pk_bf16_f32 v85,v86,v87
M v[168:171],a[108:111],a[160:163],v[168:171]
ds_read_b128 a[116:119],v248 offset:18944
ds_write2st64_b64 v254,v[80:81],v[84:85] offset0:204 offset1:208
M v[168:171],a[132:135],a[168:171],v[168:171]
s_waitcnt lgkmcnt(4)
ds_read_b128 a[140:143],v249 offset:18944
v_cvt_pk_bf16_f32 v88,v88,v89
M v[168:171],a[148:151],a[96:99],v[168:171]
s_waitcnt lgkmcnt(4)
v_cvt_pk_bf16_f32 v89,v90,v91
v_cvt_pk_bf16_f32 v92,v92,v93
M v[172:175],a[148:151],a[136:139],v[172:175]
v_cvt_pk_bf16_f32 v93,v94,v95
M v[172:175],a[132:135],a[96:99],v[172:175]
ds_write2st64_b64 v254,v[88:89],v[92:93] offset0:212 offset1:216
M v[172:175],a[108:111],a[168:171],v[172:175]
M v[176:179],a[108:111],a[96:99],v[176:179]
s_add_u32 s46,s72,18432
ds_read_b128 a[96:99],v249 offset:19456
M v[176:179],a[132:135],a[136:139],v[176:179]
s_waitcnt lgkmcnt(1)
s_barrier
ds_read_b128 v[32:35],v250 offset:0
M v[176:179],a[148:151],a[116:119],v[176:179]
ds_read_b128 v[40:43],v250 offset:4096
ds_read_b128 v[48:51],v4 offset:0
M v[180:183],a[148:151],a[140:143],v[180:183]
ds_read_b128 v[56:59],v4 offset:4096
ds_read_b128 v[64:67],v4 offset:17408
M v[180:183],a[132:135],a[116:119],v[180:183]
ds_read_b128 v[72:75],v4 offset:21504
ds_read_b128 v[80:83],v4 offset:34816
ds_read_b128 a[156:159],v248 offset:19456
M v[180:183],a[108:111],a[136:139],v[180:183]
ds_read_b128 v[88:91],v4 offset:38912
ds_read_b128 a[160:163],v248 offset:34816
M v[184:187],a[108:111],a[116:119],v[184:187]
s_add_u32 s34,s33,0
buffer_load_dwordx4 a[168:171],v250,s[20:23],s46 offen offset:0 sc1
M v[184:187],a[132:135],a[140:143],v[184:187]
s_waitcnt lgkmcnt(10)
ds_read_b128 a[136:139],v249 offset:34816
ds_read_b128 a[116:119],v248 offset:35328
M v[184:187],a[148:151],a[96:99],v[184:187]
s_waitcnt lgkmcnt(4)
buffer_store_dwordx4 v[32:35],v253,s[24:27],s34 offen offset:128 nt
M v[188:191],a[148:151],a[156:159],v[188:191]
s_add_u32 s34,s33,393216
ds_read_b128 a[248:251],v249 offset:35328
M v[188:191],a[132:135],a[96:99],v[188:191]
M v[188:191],a[108:111],a[140:143],v[188:191]
s_waitcnt vmcnt(34) lgkmcnt(3)
buffer_store_dwordx4 v[40:43],v253,s[24:27],s34 offen offset:128 nt
M v[160:163],a[220:223],a[160:163],v[160:163]
s_waitcnt vmcnt(27) lgkmcnt(2)
s_add_u32 s34,s33,786432
ds_read_b128 a[96:99],v248 offset:35840
M v[160:163],v[220:223],a[136:139],v[160:163]
s_waitcnt vmcnt(26) lgkmcnt(2)
ds_read_b128 a[108:111],v249 offset:35840
M v[160:163],a[240:243],a[116:119],v[160:163]
s_waitcnt lgkmcnt(2)
buffer_store_dwordx4 v[48:51],v253,s[24:27],s34 offen offset:128 nt
M v[164:167],a[240:243],a[248:251],v[164:167]
s_add_u32 s34,s33,1179648
M v[164:167],v[220:223],a[116:119],v[164:167]
M v[164:167],a[220:223],a[136:139],v[164:167]
buffer_store_dwordx4 v[56:59],v253,s[24:27],s34 offen offset:128 nt
M v[168:171],a[220:223],a[116:119],v[168:171]
s_add_u32 s34,s33,0
ds_read_b128 a[116:119],v248 offset:36352
M v[168:171],v[220:223],a[248:251],v[168:171]
s_waitcnt lgkmcnt(2)
ds_read_b128 a[132:135],v249 offset:36352
M v[168:171],a[240:243],a[96:99],v[168:171]
s_waitcnt lgkmcnt(2)
buffer_store_dwordx4 v[64:67],v253,s[24:27],s34 offen offset:256 nt
M v[172:175],a[240:243],a[108:111],v[172:175]
s_add_u32 s34,s33,393216
M v[172:175],v[220:223],a[96:99],v[172:175]
M v[172:175],a[220:223],a[248:251],v[172:175]
buffer_store_dwordx4 v[72:75],v253,s[24:27],s34 offen offset:256 nt
M v[176:179],a[220:223],a[96:99],v[176:179]
s_add_u32 s34,s33,786432
ds_read_b128 a[96:99],v249 offset:36864
M v[176:179],v[220:223],a[108:111],v[176:179]
s_waitcnt lgkmcnt(2)
ds_read_b128 a[136:139],v248 offset:36864
M v[176:179],a[240:243],a[116:119],v[176:179]
s_waitcnt lgkmcnt(2)
buffer_load_dwordx4 a[184:187],v250,s[20:23],s46 offen offset:1024 sc1
M v[180:183],a[240:243],a[132:135],v[180:183]
M v[180:183],v[220:223],a[116:119],v[180:183]
ds_read_b128 a[140:143],v248 offset:52224
M v[180:183],a[220:223],a[108:111],v[180:183]
ds_read_b128 a[108:111],v249 offset:52224
M v[184:187],a[220:223],a[116:119],v[184:187]
buffer_load_dwordx4 a[196:199],v250,s[20:23],s46 offen offset:2048 sc1
M v[184:187],v[220:223],a[132:135],v[184:187]
s_waitcnt lgkmcnt(3)
s_add_u32 s47,s72,21504
ds_read_b128 a[116:119],v248 offset:52736
ds_read_b128 a[148:151],v249 offset:52736
M v[184:187],a[240:243],a[96:99],v[184:187]
s_waitcnt lgkmcnt(4)
M v[188:191],a[240:243],a[136:139],v[188:191]
M v[188:191],v[220:223],a[96:99],v[188:191]
buffer_load_dwordx4 v[216:219],v250,s[20:23],s47 offen offset:0 sc1
M v[188:191],a[220:223],a[132:135],v[188:191]
s_waitcnt vmcnt(32) lgkmcnt(3)
M v[160:163],a[112:115],a[140:143],v[160:163]
s_waitcnt vmcnt(29) lgkmcnt(2)
ds_read_b128 a[96:99],v248 offset:53248
M v[160:163],a[124:127],a[108:111],v[160:163]
s_waitcnt vmcnt(28) lgkmcnt(2)
ds_read_b128 a[132:135],v249 offset:53248
M v[160:163],a[144:147],a[116:119],v[160:163]
s_waitcnt lgkmcnt(2)
buffer_store_dwordx4 v[80:83],v253,s[24:27],s34 offen offset:256 nt
M v[164:167],a[144:147],a[148:151],v[164:167]
s_add_u32 s34,s33,1179648
M v[164:167],a[124:127],a[116:119],v[164:167]
M v[164:167],a[112:115],a[108:111],v[164:167]
buffer_store_dwordx4 v[88:91],v253,s[24:27],s34 offen offset:256 nt
M v[168:171],a[112:115],a[116:119],v[168:171]
ds_read_b128 a[108:111],v248 offset:53760
M v[168:171],a[124:127],a[148:151],v[168:171]
s_waitcnt lgkmcnt(2)
ds_read_b128 a[116:119],v249 offset:53760
M v[168:171],a[144:147],a[96:99],v[168:171]
s_waitcnt lgkmcnt(2)
buffer_load_dwordx4 a[160:163],v250,s[20:23],s47 offen offset:1024 sc1
M v[172:175],a[144:147],a[132:135],v[172:175]
M v[172:175],a[124:127],a[96:99],v[172:175]
M v[172:175],a[112:115],a[148:151],v[172:175]
M v[176:179],a[112:115],a[96:99],v[176:179]
buffer_load_dwordx4 a[244:247],v250,s[20:23],s47 offen offset:2048 sc1
M v[176:179],a[124:127],a[132:135],v[176:179]
s_waitcnt lgkmcnt(1)
s_add_u32 s48,s72,24576
ds_read_b128 a[96:99],v249 offset:54272
ds_read_b128 a[136:139],v248 offset:54272
M v[176:179],a[144:147],a[108:111],v[176:179]
s_waitcnt lgkmcnt(2)
v_add_u32 v248,0xfffece00,v248
v_add_u32 v249,0xfffece00,v249
M v[180:183],a[144:147],a[116:119],v[180:183]
M v[180:183],a[124:127],a[108:111],v[180:183]
ds_read_b128 a[140:143],v248 offset:60928
M v[180:183],a[112:115],a[132:135],v[180:183]
ds_read_b128 a[132:135],v249 offset:60928
M v[184:187],a[112:115],a[108:111],v[184:187]
buffer_load_dwordx4 a[216:219],v250,s[20:23],s48 offen offset:0 sc1
M v[184:187],a[124:127],a[116:119],v[184:187]
s_waitcnt lgkmcnt(3)
ds_read_b128 a[108:111],v248 offset:61440
ds_read_b128 a[148:151],v249 offset:61440
M v[184:187],a[144:147],a[96:99],v[184:187]
s_waitcnt lgkmcnt(4)
buffer_load_dwordx4 v[224:227],v250,s[20:23],s48 offen offset:1024 sc1
M v[188:191],a[144:147],a[136:139],v[188:191]
M v[188:191],a[124:127],a[96:99],v[188:191]
M v[188:191],a[112:115],a[116:119],v[188:191]
s_waitcnt vmcnt(33) lgkmcnt(3)
M v[160:163],a[188:191],a[140:143],v[160:163]
s_waitcnt vmcnt(32) lgkmcnt(2)
buffer_load_dwordx4 v[228:231],v250,s[20:23],s48 offen offset:2048 sc1
M v[160:163],a[192:195],a[132:135],v[160:163]
s_waitcnt vmcnt(32) lgkmcnt(1)
ds_read_b128 a[96:99],v248 offset:61952
ds_read_b128 a[112:115],v249 offset:61952
M v[160:163],a[200:203],a[108:111],v[160:163]
s_waitcnt lgkmcnt(2)
M v[164:167],a[200:203],a[148:151],v[164:167]
M v[164:167],a[192:195],a[108:111],v[164:167]
M v[164:167],a[188:191],a[132:135],v[164:167]
s_nop 3
v_cvt_pk_bf16_f32 v160,v160,v161
v_cvt_pk_bf16_f32 v161,v162,v163
M v[168:171],a[188:191],a[108:111],v[168:171]
ds_read_b128 a[108:111],v248 offset:62464
M v[168:171],a[192:195],a[148:151],v[168:171]
s_waitcnt lgkmcnt(2)
ds_read_b128 a[116:119],v249 offset:62464
M v[168:171],a[200:203],a[96:99],v[168:171]
s_waitcnt lgkmcnt(2)
v_cvt_pk_bf16_f32 v164,v164,v165
v_cvt_pk_bf16_f32 v165,v166,v167
M v[172:175],a[200:203],a[112:115],v[172:175]
M v[172:175],a[192:195],a[96:99],v[172:175]
ds_read_b128 a[124:127],v249 offset:62976
ds_read_b128 a[132:135],v248 offset:62976
M v[172:175],a[188:191],a[148:151],v[172:175]
M v[176:179],a[188:191],a[96:99],v[176:179]
s_add_u32 s46,s72,27648
M v[176:179],a[192:195],a[112:115],v[176:179]
s_waitcnt lgkmcnt(3)
M v[176:179],a[200:203],a[108:111],v[176:179]
s_waitcnt lgkmcnt(0)
s_barrier
ds_write2st64_b64 v254,v[160:161],v[164:165] offset0:221 offset1:225
M v[180:183],a[200:203],a[116:119],v[180:183]
v_cvt_pk_bf16_f32 v168,v168,v169
v_cvt_pk_bf16_f32 v169,v170,v171
M v[180:183],a[192:195],a[108:111],v[180:183]
ds_read_b128 a[96:99],v248 offset:0
v_cvt_pk_bf16_f32 v172,v172,v173
M v[180:183],a[188:191],a[112:115],v[180:183]
ds_read_b128 a[112:115],v249 offset:0
v_cvt_pk_bf16_f32 v173,v174,v175
M v[184:187],a[188:191],a[108:111],v[184:187]
buffer_load_dwordx4 a[212:215],v250,s[20:23],s46 offen offset:0 sc1
M v[184:187],a[192:195],a[116:119],v[184:187]
ds_read_b128 a[108:111],v248 offset:512
ds_read_b128 a[136:139],v249 offset:512
M v[184:187],a[200:203],a[124:127],v[184:187]
ds_write2st64_b64 v254,v[168:169],v[172:173] offset0:229 offset1:233
M v[188:191],a[200:203],a[132:135],v[188:191]
v_cvt_pk_bf16_f32 v176,v176,v177
v_cvt_pk_bf16_f32 v177,v178,v179
M v[188:191],a[192:195],a[124:127],v[188:191]
v_cvt_pk_bf16_f32 v180,v180,v181
v_cvt_pk_bf16_f32 v181,v182,v183
M v[188:191],a[188:191],a[116:119],v[188:191]
s_waitcnt vmcnt(32) lgkmcnt(4)
ds_write2st64_b64 v254,v[176:177],v[180:181] offset0:238 offset1:242
M a[0:3],a[104:107],a[96:99],0
s_waitcnt vmcnt(31) lgkmcnt(4)
ds_read_b128 a[116:119],v248 offset:1024
v_cvt_pk_bf16_f32 v184,v184,v185
M a[0:3],a[128:131],a[112:115],a[0:3]
s_waitcnt vmcnt(30) lgkmcnt(4)
ds_read_b128 a[124:127],v249 offset:1024
v_cvt_pk_bf16_f32 v185,v186,v187
M a[0:3],a[152:155],a[108:111],a[0:3]
s_waitcnt lgkmcnt(4)
v_cvt_pk_bf16_f32 v188,v188,v189
v_cvt_pk_bf16_f32 v189,v190,v191
M a[4:7],a[152:155],a[136:139],0
ds_write2st64_b64 v254,v[184:185],v[188:189] offset0:246 offset1:250
M a[4:7],a[128:131],a[108:111],a[4:7]
v_lshlrev_b32 v234,16,v196
v_lshlrev_b32 v232,16,v192
M a[4:7],a[104:107],a[112:115],a[4:7]
v_lshlrev_b32 v233,16,v194
v_lshlrev_b32 v237,16,v202
M a[8:11],a[104:107],a[108:111],0
ds_read_b128 a[132:135],v248 offset:1536
v_lshlrev_b32 v236,16,v200
M a[8:11],a[128:131],a[136:139],a[8:11]
s_waitcnt lgkmcnt(3)
ds_read_b128 a[140:143],v249 offset:1536
v_lshlrev_b32 v235,16,v198
M a[8:11],a[152:155],a[116:119],a[8:11]
s_waitcnt lgkmcnt(3)
v_fmac_f32 v232,s43,v234
v_fmac_f32 v237,4.0,v233
M a[12:15],a[152:155],a[124:127],0
v_fma_f32 v238,-4.0,v234,v236
v_fmac_f32 v232,s45,v236
M a[12:15],a[128:131],a[116:119],a[12:15]
s_waitcnt lgkmcnt(2)
s_barrier
ds_read_b128 v[160:163],v4 offset:43520
M a[12:15],a[104:107],a[136:139],a[12:15]
ds_read_b128 v[168:171],v4 offset:47616
ds_read_b128 v[176:179],v4 offset:52224
M a[16:19],a[104:107],a[116:119],0
ds_read_b128 v[184:187],v4 offset:56320
ds_read_b128 a[144:147],v249 offset:2048
M a[16:19],a[128:131],a[124:127],a[16:19]
s_waitcnt lgkmcnt(6)
ds_read_b128 a[148:151],v248 offset:2048
v_fmac_f32 v237,s41,v235
M a[16:19],a[152:155],a[132:135],a[16:19]
s_waitcnt lgkmcnt(6)
v_sub_f32 v236,v236,v234
v_fma_f32 v234,-4.0,v233,v235
M a[20:23],a[152:155],a[140:143],0
s_add_u32 s34,s33,0
v_sub_f32 v235,v235,v233
v_add_f32 v233,v238,v234
M a[20:23],a[128:131],a[132:135],a[20:23]
v_sub_f32 v238,v238,v234
v_fma_f32 v234,2.0,v235,v236
M a[20:23],a[104:107],a[124:127],a[20:23]
s_waitcnt lgkmcnt(5)
buffer_store_dwordx4 v[160:163],v253,s[24:27],s34 offen offset:1408 nt
M a[24:27],a[104:107],a[132:135],0
s_add_u32 s34,s33,393216
v_fmac_f32 v236,-2.0,v235
v_and_b32 v196,s42,v196
M a[24:27],a[128:131],a[140:143],a[24:27]
s_waitcnt lgkmcnt(1)
v_and_b32 v192,s42,v192
v_and_b32 v194,s42,v194
M a[24:27],a[152:155],a[144:147],a[24:27]
s_waitcnt lgkmcnt(0)
buffer_store_dwordx4 v[168:171],v253,s[24:27],s34 offen offset:1408 nt
M a[28:31],a[152:155],a[148:151],0
s_add_u32 s34,s33,786432
v_and_b32 v202,s42,v202
v_and_b32 v200,s42,v200
M a[28:31],a[128:131],a[144:147],a[28:31]
v_and_b32 v198,s42,v198
v_fmac_f32 v192,s43,v196
M a[28:31],a[104:107],a[140:143],a[28:31]
s_waitcnt vmcnt(25)
buffer_store_dwordx4 v[176:179],v253,s[24:27],s34 offen offset:1408 nt
M a[32:35],a[100:103],a[96:99],0
s_waitcnt vmcnt(25)
s_add_u32 s34,s33,1179648
v_fmac_f32 v202,4.0,v194
v_fma_f32 v235,-4.0,v196,v200
M a[32:35],a[172:175],a[112:115],a[32:35]
s_waitcnt vmcnt(24)
v_fmac_f32 v192,s45,v200
v_fmac_f32 v202,s41,v198
M a[32:35],a[180:183],a[108:111],a[32:35]
buffer_store_dwordx4 v[184:187],v253,s[24:27],s34 offen offset:1408 nt
M a[36:39],a[180:183],a[136:139],0
v_sub_f32 v200,v200,v196
v_fma_f32 v196,-4.0,v194,v198
M a[36:39],a[172:175],a[108:111],a[36:39]
v_sub_f32 v198,v198,v194
v_add_f32 v194,v235,v196
M a[36:39],a[100:103],a[112:115],a[36:39]
v_sub_f32 v235,v235,v196
v_fma_f32 v196,2.0,v198,v200
M a[40:43],a[100:103],a[108:111],0
v_fmac_f32 v200,-2.0,v198
v_cvt_pk_bf16_f32 v192,v232,v192
M a[40:43],a[172:175],a[136:139],a[40:43]
v_cvt_pk_bf16_f32 v202,v237,v202
v_cvt_pk_bf16_f32 v194,v233,v194
M a[40:43],a[180:183],a[116:119],a[40:43]
v_cvt_pk_bf16_f32 v198,v234,v196
v_cvt_pk_bf16_f32 v196,v238,v235
M a[44:47],a[180:183],a[124:127],0
v_cvt_pk_bf16_f32 v200,v236,v200
v_lshlrev_b32 v234,16,v197
M a[44:47],a[172:175],a[116:119],a[44:47]
v_lshlrev_b32 v232,16,v193
v_lshlrev_b32 v233,16,v195
M a[44:47],a[100:103],a[136:139],a[44:47]
v_lshlrev_b32 v237,16,v203
v_lshlrev_b32 v236,16,v201
M a[48:51],a[100:103],a[116:119],0
v_lshlrev_b32 v235,16,v199
v_fmac_f32 v232,s43,v234
M a[48:51],a[172:175],a[124:127],a[48:51]
v_fmac_f32 v237,4.0,v233
v_fma_f32 v238,-4.0,v234,v236
M a[48:51],a[180:183],a[132:135],a[48:51]
v_fmac_f32 v232,s45,v236
v_fmac_f32 v237,s41,v235
M a[52:55],a[180:183],a[140:143],0
v_sub_f32 v236,v236,v234
v_fma_f32 v234,-4.0,v233,v235
M a[52:55],a[172:175],a[132:135],a[52:55]
v_sub_f32 v235,v235,v233
v_add_f32 v233,v238,v234
M a[52:55],a[100:103],a[124:127],a[52:55]
v_sub_f32 v238,v238,v234
v_fma_f32 v234,2.0,v235,v236
M a[56:59],a[100:103],a[132:135],0
v_fmac_f32 v236,-2.0,v235
v_and_b32 v197,s42,v197
M a[56:59],a[172:175],a[140:143],a[56:59]
v_and_b32 v193,s42,v193
v_and_b32 v195,s42,v195
M a[56:59],a[180:183],a[144:147],a[56:59]
v_and_b32 v203,s42,v203
v_and_b32 v201,s42,v201
M a[60:63],a[180:183],a[148:151],0
v_and_b32 v199,s42,v199
v_fmac_f32 v193,s43,v197
M a[60:63],a[172:175],a[144:147],a[60:63]
v_fmac_f32 v203,4.0,v195
v_fma_f32 v235,-4.0,v197,v201
M a[60:63],a[100:103],a[140:143],a[60:63]
s_waitcnt vmcnt(24)
v_fmac_f32 v193,s45,v201
v_fmac_f32 v203,s41,v199
M a[64:67],a[120:123],a[96:99],0
s_waitcnt vmcnt(23)
v_sub_f32 v201,v201,v197
v_fma_f32 v197,-4.0,v195,v199
M a[64:67],a[164:167],a[112:115],a[64:67]
s_waitcnt vmcnt(22)
v_sub_f32 v199,v199,v195
v_add_f32 v195,v235,v197
M a[64:67],a[176:179],a[108:111],a[64:67]
v_sub_f32 v235,v235,v197
v_fma_f32 v197,2.0,v199,v201
M a[68:71],a[176:179],a[136:139],0
v_fmac_f32 v201,-2.0,v199
v_cvt_pk_bf16_f32 v193,v232,v193
M a[68:71],a[164:167],a[108:111],a[68:71]
v_cvt_pk_bf16_f32 v203,v237,v203
v_cvt_pk_bf16_f32 v195,v233,v195
M a[68:71],a[120:123],a[112:115],a[68:71]
v_cvt_pk_bf16_f32 v199,v234,v197
v_cvt_pk_bf16_f32 v197,v238,v235
M a[72:75],a[120:123],a[108:111],0
v_cvt_pk_bf16_f32 v201,v236,v201
v_lshlrev_b32 v234,16,v208
M a[72:75],a[164:167],a[136:139],a[72:75]
v_lshlrev_b32 v232,16,v204
v_lshlrev_b32 v233,16,v206
M a[72:75],a[176:179],a[116:119],a[72:75]
ds_write2st64_b64 v247,v[192:193],v[202:203] offset0:170 offset1:187
M a[76:79],a[176:179],a[124:127],0
s_add_u32 s28,s67,7077888
buffer_load_dwordx2 v[192:193],v245,s[12:15],s28 offen offset:0
M a[76:79],a[164:167],a[116:119],a[76:79]
v_lshlrev_b32 v237,16,v214
v_lshlrev_b32 v236,16,v212
M a[76:79],a[120:123],a[136:139],a[76:79]
buffer_load_dwordx2 v[202:203],v245,s[16:19],s28 offen offset:1536
M a[80:83],a[120:123],a[116:119],0
v_lshlrev_b32 v235,16,v210
v_fmac_f32 v232,s43,v234
M a[80:83],a[164:167],a[124:127],a[80:83]
v_fmac_f32 v237,4.0,v233
v_fma_f32 v238,-4.0,v234,v236
M a[80:83],a[176:179],a[132:135],a[80:83]
ds_write2st64_b64 v247,v[194:195],v[196:197] offset0:0 offset1:17
M a[84:87],a[176:179],a[140:143],0
buffer_load_dwordx2 v[194:195],v245,s[8:11],s28 offen offset:0
M a[84:87],a[164:167],a[132:135],a[84:87]
ds_read_b128 a[172:175],v248 offset:8704
v_fmac_f32 v232,s45,v236
M a[84:87],a[120:123],a[124:127],a[84:87]
ds_write2st64_b64 v247,v[198:199],v[200:201] offset0:136 offset1:153
M a[88:91],a[120:123],a[132:135],0
buffer_load_dwordx2 v[196:197],v245,s[8:11],s28 offen offset:384
M a[88:91],a[164:167],a[140:143],a[88:91]
ds_read_b128 a[180:183],v249 offset:8704
ds_read_b128 a[188:191],v248 offset:9216
M a[88:91],a[176:179],a[144:147],a[88:91]
ds_read_b128 a[224:227],v249 offset:9216
v_fmac_f32 v237,s41,v235
M a[92:95],a[176:179],a[148:151],0
v_sub_f32 v236,v236,v234
v_fma_f32 v234,-4.0,v233,v235
M a[92:95],a[164:167],a[144:147],a[92:95]
buffer_load_dwordx2 v[198:199],v245,s[8:11],s28 offen offset:768
M a[92:95],a[120:123],a[140:143],a[92:95]
s_waitcnt vmcnt(26) lgkmcnt(4)
v_sub_f32 v235,v235,v233
v_add_f32 v233,v238,v234
M a[96:99],a[168:171],a[172:175],0
s_waitcnt vmcnt(19) lgkmcnt(2)
ds_read_b128 a[228:231],v248 offset:9728
v_sub_f32 v238,v238,v234
M a[96:99],a[184:187],a[180:183],a[96:99]
s_waitcnt vmcnt(18) lgkmcnt(2)
ds_read_b128 a[252:255],v249 offset:9728
v_fma_f32 v234,2.0,v235,v236
M a[96:99],a[196:199],a[188:191],a[96:99]
s_waitcnt lgkmcnt(2)
buffer_load_dwordx2 v[200:201],v245,s[8:11],s28 offen offset:1152
M a[100:103],a[196:199],a[224:227],0
v_fmac_f32 v236,-2.0,v235
v_and_b32 v208,s42,v208
M a[100:103],a[184:187],a[188:191],a[100:103]
v_and_b32 v204,s42,v204
v_and_b32 v206,s42,v206
M a[100:103],a[168:171],a[180:183],a[100:103]
v_and_b32 v214,s42,v214
v_and_b32 v212,s42,v212
M a[104:107],a[168:171],a[188:191],0
ds_read_b128 a[204:207],v248 offset:10240
v_and_b32 v210,s42,v210
M a[104:107],a[184:187],a[224:227],a[104:107]
s_waitcnt lgkmcnt(2)
ds_read_b128 a[208:211],v249 offset:10240
v_fmac_f32 v204,s43,v208
M a[104:107],a[196:199],a[228:231],a[104:107]
s_waitcnt lgkmcnt(2)
v_fmac_f32 v214,4.0,v206
v_fma_f32 v235,-4.0,v208,v212
M a[108:111],a[196:199],a[252:255],0
v_fmac_f32 v204,s45,v212
v_fmac_f32 v214,s41,v210
M a[108:111],a[184:187],a[228:231],a[108:111]
v_sub_f32 v212,v212,v208
v_fma_f32 v208,-4.0,v206,v210
M a[108:111],a[168:171],a[224:227],a[108:111]
v_sub_f32 v210,v210,v206
v_add_f32 v206,v235,v208
M a[112:115],a[168:171],a[228:231],0
ds_read_b128 a[232:235],v249 offset:10752
v_sub_f32 v235,v235,v208
M a[112:115],a[184:187],a[252:255],a[112:115]
s_waitcnt lgkmcnt(2)
ds_read_b128 a[236:239],v248 offset:10752
v_fma_f32 v208,2.0,v210,v212
M a[112:115],a[196:199],a[204:207],a[112:115]
s_waitcnt lgkmcnt(2)
v_fmac_f32 v212,-2.0,v210
v_cvt_pk_bf16_f32 v204,v232,v204
M a[116:119],a[196:199],a[208:211],0
v_cvt_pk_bf16_f32 v214,v237,v214
v_cvt_pk_bf16_f32 v206,v233,v206
M a[116:119],a[184:187],a[204:207],a[116:119]
v_cvt_pk_bf16_f32 v210,v234,v208
v_cvt_pk_bf16_f32 v208,v238,v235
M a[116:119],a[168:171],a[252:255],a[116:119]
v_cvt_pk_bf16_f32 v212,v236,v212
v_lshlrev_b32 v234,16,v209
M a[120:123],a[168:171],a[204:207],0
v_lshlrev_b32 v232,16,v205
v_lshlrev_b32 v233,16,v207
M a[120:123],a[184:187],a[208:211],a[120:123]
s_waitcnt lgkmcnt(1)
v_lshlrev_b32 v237,16,v215
v_lshlrev_b32 v236,16,v213
M a[120:123],a[196:199],a[232:235],a[120:123]
s_waitcnt lgkmcnt(0)
v_lshlrev_b32 v235,16,v211
v_fmac_f32 v232,s43,v234
M a[124:127],a[196:199],a[236:239],0
buffer_load_dwordx4 a[248:251],v250,s[20:23],s46 offen offset:1024 sc1
M a[124:127],a[184:187],a[232:235],a[124:127]
v_fmac_f32 v237,4.0,v233
v_fma_f32 v238,-4.0,v234,v236
M a[124:127],a[168:171],a[208:211],a[124:127]
s_waitcnt vmcnt(19)
buffer_load_dwordx4 a[240:243],v250,s[20:23],s46 offen offset:2048 sc1
M a[128:131],v[216:219],a[172:175],0
s_waitcnt vmcnt(17)
s_add_u32 s47,s72,30720
v_fmac_f32 v232,s45,v236
v_fmac_f32 v237,s41,v235
M a[128:131],a[160:163],a[180:183],a[128:131]
s_waitcnt vmcnt(16)
v_sub_f32 v236,v236,v234
v_fma_f32 v234,-4.0,v233,v235
M a[128:131],a[244:247],a[188:191],a[128:131]
v_sub_f32 v235,v235,v233
v_add_f32 v233,v238,v234
M a[132:135],a[244:247],a[224:227],0
buffer_load_dwordx4 v[220:223],v250,s[20:23],s47 offen offset:0 sc1
M a[132:135],a[160:163],a[188:191],a[132:135]
v_sub_f32 v238,v238,v234
v_fma_f32 v234,2.0,v235,v236
M a[132:135],v[216:219],a[180:183],a[132:135]
v_fmac_f32 v236,-2.0,v235
v_and_b32 v209,s42,v209
M a[136:139],v[216:219],a[188:191],0
v_and_b32 v205,s42,v205
v_and_b32 v207,s42,v207
M a[136:139],a[160:163],a[224:227],a[136:139]
v_and_b32 v215,s42,v215
v_and_b32 v213,s42,v213
M a[136:139],a[244:247],a[228:231],a[136:139]
v_and_b32 v211,s42,v211
v_fmac_f32 v205,s43,v209
M a[140:143],a[244:247],a[252:255],0
v_fmac_f32 v215,4.0,v207
v_fma_f32 v235,-4.0,v209,v213
M a[140:143],a[160:163],a[228:231],a[140:143]
v_fmac_f32 v205,s45,v213
v_fmac_f32 v215,s41,v211
M a[140:143],v[216:219],a[224:227],a[140:143]
v_sub_f32 v213,v213,v209
v_fma_f32 v209,-4.0,v207,v211
M a[144:147],v[216:219],a[228:231],0
v_sub_f32 v211,v211,v207
v_add_f32 v207,v235,v209
M a[144:147],a[160:163],a[252:255],a[144:147]
v_sub_f32 v235,v235,v209
v_fma_f32 v209,2.0,v211,v213
M a[144:147],a[244:247],a[204:207],a[144:147]
v_fmac_f32 v213,-2.0,v211
v_cvt_pk_bf16_f32 v205,v232,v205
M a[148:151],a[244:247],a[208:211],0
v_cvt_pk_bf16_f32 v215,v237,v215
v_cvt_pk_bf16_f32 v207,v233,v207
M a[148:151],a[160:163],a[204:207],a[148:151]
v_cvt_pk_bf16_f32 v211,v234,v209
v_cvt_pk_bf16_f32 v209,v238,v235
M a[148:151],v[216:219],a[252:255],a[148:151]
v_cvt_pk_bf16_f32 v213,v236,v213
v_fmac_f32 v239,s43,v241
M a[152:155],v[216:219],a[204:207],0
v_fmac_f32 v244,4.0,v240
v_fma_f32 v232,-4.0,v241,v243
M a[152:155],a[160:163],a[208:211],a[152:155]
v_fmac_f32 v239,s45,v243
v_fmac_f32 v244,s41,v242
M a[152:155],a[244:247],a[232:235],a[152:155]
ds_write2st64_b64 v247,v[204:205],v[214:215] offset0:171 offset1:188
M a[156:159],a[244:247],a[236:239],0
s_add_u32 s28,s67,7471104
buffer_load_dwordx4 a[220:223],v250,s[20:23],s47 offen offset:1024 sc1
M a[156:159],a[160:163],a[232:235],a[156:159]
v_sub_f32 v243,v243,v241
v_fma_f32 v241,-4.0,v240,v242
M a[156:159],v[216:219],a[208:211],a[156:159]
s_waitcnt vmcnt(17)
buffer_load_dwordx4 a[200:203],v250,s[20:23],s47 offen offset:2048 sc1
M a[160:163],a[216:219],a[172:175],0
s_waitcnt vmcnt(17)
s_add_u32 s48,s72,33792
v_sub_f32 v242,v242,v240
v_add_f32 v240,v232,v241
M a[160:163],v[224:227],a[180:183],a[160:163]
s_waitcnt vmcnt(16)
v_sub_f32 v232,v232,v241
v_fma_f32 v241,2.0,v242,v243
M a[160:163],v[228:231],a[188:191],a[160:163]
ds_write2st64_b64 v247,v[206:207],v[208:209] offset0:1 offset1:18
M a[164:167],v[228:231],a[224:227],0
buffer_load_dwordx4 a[192:195],v250,s[20:23],s48 offen offset:0 sc1
M a[164:167],v[224:227],a[188:191],a[164:167]
v_fmac_f32 v243,-2.0,v242
v_cvt_pk_bf16_f32 v233,v239,v244
M a[164:167],a[216:219],a[180:183],a[164:167]
ds_write2st64_b64 v247,v[210:211],v[212:213] offset0:137 offset1:154
M a[168:171],a[216:219],a[188:191],0
buffer_load_dwordx4 a[196:199],v250,s[20:23],s48 offen offset:1024 sc1
M a[168:171],v[224:227],a[224:227],a[168:171]
v_cvt_pk_bf16_f32 v234,v240,v232
v_cvt_pk_bf16_f32 v235,v241,v243
M a[168:171],v[228:231],a[228:231],a[168:171]
v_add_u32 v232,87040,v252
M a[172:175],v[228:231],a[252:255],0
ds_write_b16 v232,v233 offset:0
M a[172:175],v[224:227],a[228:231],a[172:175]
buffer_load_dwordx4 a[244:247],v250,s[20:23],s48 offen offset:2048 sc1
M a[172:175],a[216:219],a[224:227],a[172:175]
s_add_u32 s46,s72,36864
ds_write_b16_d16_hi v232,v233 offset:8704
M a[176:179],a[216:219],a[228:231],0
ds_write_b16 v252,v234 offset:0
M a[176:179],v[224:227],a[252:255],a[176:179]
ds_write_b16_d16_hi v252,v234 offset:8704
M a[176:179],v[228:231],a[204:207],a[176:179]
buffer_load_dwordx4 v[216:219],v250,s[20:23],s46 offen offset:0 sc1
M a[180:183],v[228:231],a[208:211],0
v_add_u32 v232,69632,v252
M a[180:183],v[224:227],a[204:207],a[180:183]
ds_read_b128 a[224:227],v248 offset:17408
ds_write_b16 v232,v235 offset:0
M a[180:183],a[216:219],a[252:255],a[180:183]
ds_read_b128 a[228:231],v249 offset:17408
ds_write_b16_d16_hi v232,v235 offset:8704
M a[184:187],a[216:219],a[204:207],0
buffer_load_dwordx2 v[204:205],v245,s[12:15],s28 offen offset:0
M a[184:187],v[224:227],a[208:211],a[184:187]
ds_read_b128 a[252:255],v248 offset:17920
ds_read_b128 a[204:207],v249 offset:17920
M a[184:187],v[228:231],a[232:235],a[184:187]
s_waitcnt vmcnt(12)
v_lshlrev_b32 v234,16,v196
v_lshlrev_b32 v232,16,v192
M a[188:191],v[228:231],a[236:239],0
buffer_load_dwordx2 v[214:215],v245,s[16:19],s28 offen offset:1536
M a[188:191],v[224:227],a[232:235],a[188:191]
v_lshlrev_b32 v233,16,v194
v_lshlrev_b32 v237,16,v202
M a[188:191],a[216:219],a[208:211],a[188:191]
s_waitcnt vmcnt(11) lgkmcnt(5)
v_lshlrev_b32 v236,16,v200
v_lshlrev_b32 v235,16,v198
M v[0:3],a[212:215],a[224:227],0
s_waitcnt vmcnt(10) lgkmcnt(3)
ds_read_b128 a[236:239],v248 offset:18432
v_fmac_f32 v232,s43,v234
M v[0:3],a[248:251],a[228:231],v[0:3]
s_waitcnt vmcnt(9) lgkmcnt(2)
buffer_load_dwordx2 v[206:207],v245,s[8:11],s28 offen offset:0
M v[0:3],a[240:243],a[252:255],v[0:3]
s_waitcnt lgkmcnt(1)
ds_read_b128 v[228:231],v249 offset:18432
v_fmac_f32 v237,4.0,v233
M v[4:7],a[240:243],a[204:207],0
v_fma_f32 v238,-4.0,v234,v236
v_fmac_f32 v232,s45,v236
M v[4:7],a[248:251],a[252:255],v[4:7]
v_fmac_f32 v237,s41,v235
v_sub_f32 v236,v236,v234
M v[4:7],a[212:215],a[228:231],v[4:7]
buffer_load_dwordx2 v[208:209],v245,s[8:11],s28 offen offset:384
M v[8:11],a[212:215],a[252:255],0
ds_read_b128 a[232:235],v248 offset:18944
v_fma_f32 v234,-4.0,v233,v235
M v[8:11],a[248:251],a[204:207],v[8:11]
s_waitcnt lgkmcnt(2)
ds_read_b128 v[224:227],v249 offset:18944
v_sub_f32 v235,v235,v233
M v[8:11],a[240:243],a[236:239],v[8:11]
s_waitcnt lgkmcnt(2)
v_add_f32 v233,v238,v234
v_sub_f32 v238,v238,v234
M v[12:15],a[240:243],v[228:231],0
buffer_load_dwordx2 v[210:211],v245,s[8:11],s28 offen offset:768
M v[12:15],a[248:251],a[236:239],v[12:15]
v_fma_f32 v234,2.0,v235,v236
v_fmac_f32 v236,-2.0,v235
M v[12:15],a[212:215],a[204:207],v[12:15]
v_and_b32 v196,s42,v196
v_and_b32 v192,s42,v192
M v[16:19],a[212:215],a[236:239],0
ds_read_b128 a[208:211],v249 offset:19456
v_and_b32 v194,s42,v194
M v[16:19],a[248:251],v[228:231],v[16:19]
s_waitcnt lgkmcnt(2)
buffer_load_dwordx2 v[212:213],v245,s[8:11],s28 offen offset:1152
M v[16:19],a[240:243],a[232:235],v[16:19]
s_waitcnt lgkmcnt(1)
s_add_u32 s29,s68,6291456
ds_read_b128 a[216:219],v248 offset:19456
v_and_b32 v202,s42,v202
M v[20:23],a[240:243],v[224:227],0
v_and_b32 v200,s42,v200
v_and_b32 v198,s42,v198
M v[20:23],a[248:251],a[232:235],v[20:23]
v_fmac_f32 v192,s43,v196
v_fmac_f32 v202,4.0,v194
M v[20:23],a[212:215],v[228:231],v[20:23]
buffer_load_short_d16_hi v239,v246,s[12:15],s29 offen offset:0
M v[24:27],a[212:215],a[232:235],0
v_fma_f32 v235,-4.0,v196,v200
v_fmac_f32 v192,s45,v200
M v[24:27],a[248:251],v[224:227],v[24:27]
s_waitcnt lgkmcnt(1)
buffer_load_short_d16_hi v240,v246,s[8:11],s29 offen offset:0
M v[24:27],a[240:243],a[208:211],v[24:27]
s_waitcnt lgkmcnt(0)
v_fmac_f32 v202,s41,v198
v_sub_f32 v200,v200,v196
M v[28:31],a[240:243],a[216:219],0
buffer_load_short_d16_hi v241,v246,s[8:11],s29 offen offset:384
M v[28:31],a[248:251],a[208:211],v[28:31]
v_fma_f32 v196,-4.0,v194,v198
v_sub_f32 v198,v198,v194
M v[28:31],a[212:215],v[224:227],v[28:31]
s_waitcnt vmcnt(15)
buffer_load_short_d16_hi v242,v246,s[8:11],s29 offen offset:768
M v[32:35],v[220:223],a[224:227],0
s_waitcnt vmcnt(15)
v_add_f32 v194,v235,v196
v_sub_f32 v235,v235,v196
M v[32:35],a[220:223],a[228:231],v[32:35]
s_waitcnt vmcnt(14)
buffer_load_short_d16_hi v243,v246,s[8:11],s29 offen offset:1152
M v[32:35],a[200:203],a[252:255],v[32:35]
v_fma_f32 v196,2.0,v198,v200
v_fmac_f32 v200,-2.0,v198
M v[36:39],a[200:203],a[204:207],0
buffer_load_short_d16_hi v244,v246,s[16:19],s29 offen offset:1536
M v[36:39],a[220:223],a[252:255],v[36:39]
v_cvt_pk_bf16_f32 v192,v232,v192
v_cvt_pk_bf16_f32 v202,v237,v202
M v[36:39],v[220:223],a[228:231],v[36:39]
global_load_dword a240,v250,s[64:65]
M v[40:43],v[220:223],a[252:255],0
v_cvt_pk_bf16_f32 v194,v233,v194
v_cvt_pk_bf16_f32 v198,v234,v196
M v[40:43],a[220:223],a[204:207],v[40:43]
buffer_load_dwordx4 a[240:243],v250,s[20:23],s46 offen offset:1024 sc1
M v[40:43],a[200:203],a[236:239],v[40:43]
v_cvt_pk_bf16_f32 v196,v238,v235
v_cvt_pk_bf16_f32 v200,v236,v200
M v[44:47],a[200:203],v[228:231],0
v_lshlrev_b32 v234,16,v197
v_lshlrev_b32 v232,16,v193
M v[44:47],a[220:223],a[236:239],v[44:47]
buffer_load_dwordx4 a[248:251],v250,s[20:23],s46 offen offset:2048 sc1
M v[44:47],v[220:223],a[204:207],v[44:47]
s_add_u32 s47,s72,39936
v_lshlrev_b32 v233,16,v195
v_lshlrev_b32 v237,16,v203
M v[48:51],v[220:223],a[236:239],0
v_lshlrev_b32 v236,16,v201
v_lshlrev_b32 v235,16,v199
M v[48:51],a[220:223],v[228:231],v[48:51]
v_fmac_f32 v232,s43,v234
v_fmac_f32 v237,4.0,v233
M v[48:51],a[200:203],a[232:235],v[48:51]
v_fma_f32 v238,-4.0,v234,v236
v_fmac_f32 v232,s45,v236
M v[52:55],a[200:203],v[224:227],0
buffer_load_dwordx4 a[212:215],v250,s[20:23],s47 offen offset:0 sc1
M v[52:55],a[220:223],a[232:235],v[52:55]
v_fmac_f32 v237,s41,v235
v_sub_f32 v236,v236,v234
M v[52:55],v[220:223],v[228:231],v[52:55]
v_fma_f32 v234,-4.0,v233,v235
v_sub_f32 v235,v235,v233
M v[56:59],v[220:223],a[232:235],0
v_add_f32 v233,v238,v234
v_sub_f32 v238,v238,v234
M v[56:59],a[220:223],v[224:227],v[56:59]
v_fma_f32 v234,2.0,v235,v236
v_fmac_f32 v236,-2.0,v235
M v[56:59],a[200:203],a[208:211],v[56:59]
v_and_b32 v197,s42,v197
v_and_b32 v193,s42,v193
M v[60:63],a[200:203],a[216:219],0
buffer_load_dwordx4 a[200:203],v250,s[20:23],s47 offen offset:1024 sc1
M v[60:63],a[220:223],a[208:211],v[60:63]
v_and_b32 v195,s42,v195
v_and_b32 v203,s42,v203
M v[60:63],v[220:223],v[224:227],v[60:63]
s_waitcnt vmcnt(20)
buffer_load_dwordx4 a[220:223],v250,s[20:23],s47 offen offset:2048 sc1
M v[64:67],a[192:195],a[224:227],0
s_waitcnt vmcnt(20)
s_add_u32 s48,s72,43008
v_and_b32 v201,s42,v201
v_and_b32 v199,s42,v199
M v[64:67],a[196:199],a[228:231],v[64:67]
s_waitcnt vmcnt(19)
v_fmac_f32 v193,s43,v197
v_fmac_f32 v203,4.0,v195
M v[64:67],a[244:247],a[252:255],v[64:67]
v_fma_f32 v235,-4.0,v197,v201
v_fmac_f32 v193,s45,v201
M v[68:71],a[244:247],a[204:207],0
buffer_load_dwordx4 v[220:223],v250,s[20:23],s48 offen offset:0 sc1
M v[68:71],a[196:199],a[252:255],v[68:71]
v_fmac_f32 v203,s41,v199
v_sub_f32 v201,v201,v197
M v[68:71],a[192:195],a[228:231],v[68:71]
v_fma_f32 v197,-4.0,v195,v199
v_sub_f32 v199,v199,v195
M v[72:75],a[192:195],a[252:255],0
v_add_f32 v195,v235,v197
v_sub_f32 v235,v235,v197
M v[72:75],a[196:199],a[204:207],v[72:75]
buffer_load_dwordx4 a[224:227],v250,s[20:23],s48 offen offset:1024 sc1
M v[72:75],a[244:247],a[236:239],v[72:75]
v_fma_f32 v197,2.0,v199,v201
v_fmac_f32 v201,-2.0,v199
M v[76:79],a[244:247],v[228:231],0
v_cvt_pk_bf16_f32 v193,v232,v193
v_cvt_pk_bf16_f32 v203,v237,v203
M v[76:79],a[196:199],a[236:239],v[76:79]
v_cvt_pk_bf16_f32 v195,v233,v195
v_cvt_pk_bf16_f32 v199,v234,v197
M v[76:79],a[192:195],a[204:207],v[76:79]
buffer_load_dwordx4 a[228:231],v250,s[20:23],s48 offen offset:2048 sc1
M v[80:83],a[192:195],a[236:239],0
s_add_u32 s46,s73,9216
v_cvt_pk_bf16_f32 v197,v238,v235
v_cvt_pk_bf16_f32 v201,v236,v201
M v[80:83],a[196:199],v[228:231],v[80:83]
s_waitcnt vmcnt(17)
v_lshlrev_b32 v234,16,v208
v_lshlrev_b32 v232,16,v204
M v[80:83],a[244:247],a[232:235],v[80:83]
ds_write2st64_b64 v247,v[192:193],v[202:203] offset0:172 offset1:189
M v[84:87],a[244:247],v[224:227],0
s_add_u32 s28,s68,6291456
buffer_load_dwordx4 a[252:255],v250,s[20:23],s46 offen offset:0 sc1
M v[84:87],a[196:199],a[232:235],v[84:87]
ds_read_b128 a[204:207],v248 offset:26112
v_lshlrev_b32 v233,16,v206
M v[84:87],a[192:195],v[228:231],v[84:87]
ds_write2st64_b64 v247,v[194:195],v[196:197] offset0:2 offset1:19
M v[88:91],a[192:195],a[232:235],0
buffer_load_dwordx2 v[192:193],v245,s[12:15],s28 offen offset:0
M v[88:91],a[196:199],v[224:227],v[88:91]
ds_read_b128 a[236:239],v249 offset:26112
ds_read_b128 v[228:231],v248 offset:26624
M v[88:91],a[244:247],a[208:211],v[88:91]
ds_write2st64_b64 v247,v[198:199],v[200:201] offset0:138 offset1:155
M v[92:95],a[244:247],a[216:219],0
buffer_load_dwordx2 v[202:203],v245,s[16:19],s28 offen offset:1536
M v[92:95],a[196:199],a[208:211],v[92:95]
ds_read_b128 a[232:235],v249 offset:26624
v_lshlrev_b32 v237,16,v214
M v[92:95],a[192:195],v[224:227],v[92:95]
s_waitcnt vmcnt(18) lgkmcnt(5)
v_lshlrev_b32 v236,16,v212
v_lshlrev_b32 v235,16,v210
M v[96:99],v[216:219],a[204:207],0
s_waitcnt vmcnt(10) lgkmcnt(3)
ds_read_b128 a[216:219],v248 offset:27136
v_fmac_f32 v232,s43,v234
M v[96:99],a[240:243],a[236:239],v[96:99]
s_waitcnt vmcnt(9) lgkmcnt(3)
buffer_load_dwordx2 v[194:195],v245,s[8:11],s28 offen offset:0
M v[96:99],a[248:251],v[228:231],v[96:99]
s_waitcnt lgkmcnt(1)
ds_read_b128 a[244:247],v249 offset:27136
v_fmac_f32 v237,4.0,v233
M v[100:103],a[248:251],a[232:235],0
v_fma_f32 v238,-4.0,v234,v236
v_fmac_f32 v232,s45,v236
M v[100:103],a[240:243],v[228:231],v[100:103]
v_fmac_f32 v237,s41,v235
v_sub_f32 v236,v236,v234
M v[100:103],v[216:219],a[236:239],v[100:103]
buffer_load_dwordx2 v[196:197],v245,s[8:11],s28 offen offset:384
M v[104:107],v[216:219],v[228:231],0
ds_read_b128 a[196:199],v248 offset:27648
v_fma_f32 v234,-4.0,v233,v235
M v[104:107],a[240:243],a[232:235],v[104:107]
s_waitcnt lgkmcnt(2)
ds_read_b128 a[208:211],v249 offset:27648
v_sub_f32 v235,v235,v233
M v[104:107],a[248:251],a[216:219],v[104:107]
s_waitcnt lgkmcnt(2)
v_add_f32 v233,v238,v234
v_sub_f32 v238,v238,v234
M v[108:111],a[248:251],a[244:247],0
buffer_load_dwordx2 v[198:199],v245,s[8:11],s28 offen offset:768
M v[108:111],a[240:243],a[216:219],v[108:111]
v_fma_f32 v234,2.0,v235,v236
v_fmac_f32 v236,-2.0,v235
M v[108:111],v[216:219],a[232:235],v[108:111]
v_and_b32 v208,s42,v208
v_and_b32 v204,s42,v204
M v[112:115],v[216:219],a[216:219],0
ds_read_b128 a[192:195],v249 offset:28160
v_and_b32 v206,s42,v206
M v[112:115],a[240:243],a[244:247],v[112:115]
s_waitcnt lgkmcnt(2)
buffer_load_dwordx2 v[200:201],v245,s[8:11],s28 offen offset:1152
M v[112:115],a[248:251],a[196:199],v[112:115]
s_waitcnt lgkmcnt(1)
ds_read_b128 v[224:227],v248 offset:28160
v_and_b32 v214,s42,v214
M v[116:119],a[248:251],a[208:211],0
v_and_b32 v212,s42,v212
v_and_b32 v210,s42,v210
M v[116:119],a[240:243],a[196:199],v[116:119]
v_fmac_f32 v204,s43,v208
v_fmac_f32 v214,4.0,v206
M v[116:119],v[216:219],a[244:247],v[116:119]
v_fma_f32 v235,-4.0,v208,v212
v_fmac_f32 v204,s45,v212
M v[120:123],v[216:219],a[196:199],0
v_fmac_f32 v214,s41,v210
v_sub_f32 v212,v212,v208
M v[120:123],a[240:243],a[208:211],v[120:123]
s_waitcnt lgkmcnt(1)
v_fma_f32 v208,-4.0,v206,v210
v_sub_f32 v210,v210,v206
M v[120:123],a[248:251],a[192:195],v[120:123]
s_waitcnt lgkmcnt(0)
v_add_f32 v206,v235,v208
v_sub_f32 v235,v235,v208
M v[124:127],a[248:251],v[224:227],0
buffer_load_dwordx4 a[248:251],v250,s[20:23],s46 offen offset:1024 sc1
M v[124:127],a[240:243],a[192:195],v[124:127]
v_fma_f32 v208,2.0,v210,v212
v_fmac_f32 v212,-2.0,v210
M v[124:127],v[216:219],a[208:211],v[124:127]
s_waitcnt vmcnt(13)
buffer_load_dwordx4 a[240:243],v250,s[20:23],s46 offen offset:2048 sc1
M v[128:131],a[212:215],a[204:207],0
s_waitcnt vmcnt(13)
s_add_u32 s47,s73,12288
v_cvt_pk_bf16_f32 v204,v232,v204
v_cvt_pk_bf16_f32 v214,v237,v214
M v[128:131],a[200:203],a[236:239],v[128:131]
s_waitcnt vmcnt(12)
v_cvt_pk_bf16_f32 v206,v233,v206
v_cvt_pk_bf16_f32 v210,v234,v208
M v[128:131],a[220:223],v[228:231],v[128:131]
v_cvt_pk_bf16_f32 v208,v238,v235
v_cvt_pk_bf16_f32 v212,v236,v212
M v[132:135],a[220:223],a[232:235],0
buffer_load_dwordx4 v[216:219],v250,s[20:23],s47 offen offset:0 sc1
M v[132:135],a[200:203],v[228:231],v[132:135]
v_lshlrev_b32 v234,16,v209
v_lshlrev_b32 v232,16,v205
M v[132:135],a[212:215],a[236:239],v[132:135]
v_lshlrev_b32 v233,16,v207
v_lshlrev_b32 v237,16,v215
M v[136:139],a[212:215],v[228:231],0
v_lshlrev_b32 v236,16,v213
v_lshlrev_b32 v235,16,v211
M v[136:139],a[200:203],a[232:235],v[136:139]
v_fmac_f32 v232,s43,v234
v_fmac_f32 v237,4.0,v233
M v[136:139],a[220:223],a[216:219],v[136:139]
v_fma_f32 v238,-4.0,v234,v236
v_fmac_f32 v232,s45,v236
M v[140:143],a[220:223],a[244:247],0
v_fmac_f32 v237,s41,v235
v_sub_f32 v236,v236,v234
M v[140:143],a[200:203],a[216:219],v[140:143]
v_fma_f32 v234,-4.0,v233,v235
v_sub_f32 v235,v235,v233
M v[140:143],a[212:215],a[232:235],v[140:143]
v_add_f32 v233,v238,v234
v_sub_f32 v238,v238,v234
M v[144:147],a[212:215],a[216:219],0
v_fma_f32 v234,2.0,v235,v236
v_fmac_f32 v236,-2.0,v235
M v[144:147],a[200:203],a[244:247],v[144:147]
v_and_b32 v209,s42,v209
v_and_b32 v205,s42,v205
M v[144:147],a[220:223],a[196:199],v[144:147]
v_and_b32 v207,s42,v207
v_and_b32 v215,s42,v215
M v[148:151],a[220:223],a[208:211],0
v_and_b32 v213,s42,v213
v_and_b32 v211,s42,v211
M v[148:151],a[200:203],a[196:199],v[148:151]
v_fmac_f32 v205,s43,v209
v_fmac_f32 v215,4.0,v207
M v[148:151],a[212:215],a[244:247],v[148:151]
v_fma_f32 v235,-4.0,v209,v213
v_fmac_f32 v205,s45,v213
M v[152:155],a[212:215],a[196:199],0
v_fmac_f32 v215,s41,v211
v_sub_f32 v213,v213,v209
M v[152:155],a[200:203],a[208:211],v[152:155]
v_fma_f32 v209,-4.0,v207,v211
v_sub_f32 v211,v211,v207
M v[152:155],a[220:223],a[192:195],v[152:155]
v_add_f32 v207,v235,v209
v_sub_f32 v235,v235,v209
M v[156:159],a[220:223],v[224:227],0
buffer_load_dwordx4 a[220:223],v250,s[20:23],s47 offen offset:1024 sc1
M v[156:159],a[200:203],a[192:195],v[156:159]
v_fma_f32 v209,2.0,v211,v213
v_fmac_f32 v213,-2.0,v211
M v[156:159],a[212:215],a[208:211],v[156:159]
s_waitcnt vmcnt(13)
buffer_load_dwordx4 a[200:203],v250,s[20:23],s47 offen offset:2048 sc1
M v[160:163],v[220:223],a[204:207],0
s_waitcnt vmcnt(13)
s_add_u32 s48,s73,15360
v_cvt_pk_bf16_f32 v205,v232,v205
v_cvt_pk_bf16_f32 v215,v237,v215
M v[160:163],a[224:227],a[236:239],v[160:163]
s_waitcnt vmcnt(12)
v_cvt_pk_bf16_f32 v207,v233,v207
v_cvt_pk_bf16_f32 v211,v234,v209
M v[160:163],a[228:231],v[228:231],v[160:163]
v_cvt_pk_bf16_f32 v209,v238,v235
v_cvt_pk_bf16_f32 v213,v236,v213
M v[164:167],a[228:231],a[232:235],0
buffer_load_dwordx4 a[212:215],v250,s[20:23],s48 offen offset:0 sc1
M v[164:167],a[224:227],v[228:231],v[164:167]
M v[164:167],v[220:223],a[236:239],v[164:167]
ds_write2st64_b64 v247,v[204:205],v[214:215] offset0:173 offset1:190
M v[168:171],v[220:223],v[228:231],0
s_add_u32 s28,s68,6684672
M v[168:171],a[224:227],a[232:235],v[168:171]
buffer_load_dwordx4 a[204:207],v250,s[20:23],s48 offen offset:1024 sc1
M v[168:171],a[228:231],a[216:219],v[168:171]
ds_write2st64_b64 v247,v[206:207],v[208:209] offset0:3 offset1:20
M v[172:175],a[228:231],a[244:247],0
M v[172:175],a[224:227],a[216:219],v[172:175]
buffer_load_dwordx4 a[236:239],v250,s[20:23],s48 offen offset:2048 sc1
M v[172:175],v[220:223],a[232:235],v[172:175]
s_add_u32 s46,s73,18432
ds_write2st64_b64 v247,v[210:211],v[212:213] offset0:139 offset1:156
M v[176:179],v[220:223],a[216:219],0
M v[176:179],a[224:227],a[244:247],v[176:179]
buffer_load_dwordx4 v[228:231],v250,s[20:23],s46 offen offset:0 sc1
M v[176:179],a[228:231],a[196:199],v[176:179]
s_waitcnt lgkmcnt(0)
s_barrier
v_add_u32 v248,0xffffbc00,v248
M v[180:183],a[228:231],a[208:211],0
v_add_u32 v249,0xffffbc00,v249
M v[180:183],a[224:227],a[196:199],v[180:183]
ds_read_b128 a[232:235],v248 offset:0
M v[180:183],v[220:223],a[244:247],v[180:183]
buffer_load_dwordx2 v[204:205],v245,s[12:15],s28 offen offset:0
M v[184:187],v[220:223],a[196:199],0
ds_read_b128 a[216:219],v249 offset:0
ds_read_b128 a[244:247],v248 offset:512
M v[184:187],a[224:227],a[208:211],v[184:187]
ds_read_b128 a[196:199],v249 offset:512
M v[184:187],a[228:231],a[192:195],v[184:187]
M v[188:191],a[228:231],v[224:227],0
buffer_load_dwordx2 v[214:215],v245,s[16:19],s28 offen offset:1536
M v[188:191],a[224:227],a[192:195],v[188:191]
M v[188:191],v[220:223],a[208:211],v[188:191]
s_waitcnt vmcnt(17) lgkmcnt(3)
M a[0:3],a[252:255],a[232:235],a[0:3]
s_waitcnt vmcnt(10) lgkmcnt(2)
ds_read_b128 a[228:231],v248 offset:1024
M a[0:3],a[248:251],a[216:219],a[0:3]
s_waitcnt vmcnt(9) lgkmcnt(2)
buffer_load_dwordx2 v[206:207],v245,s[8:11],s28 offen offset:0
M a[0:3],a[240:243],a[244:247],a[0:3]
s_waitcnt lgkmcnt(1)
ds_read_b128 v[224:227],v249 offset:1024
v_lshlrev_b32 v234,16,v196
M a[4:7],a[240:243],a[196:199],a[4:7]
v_lshlrev_b32 v232,16,v192
v_lshlrev_b32 v233,16,v194
M a[4:7],a[248:251],a[244:247],a[4:7]
v_lshlrev_b32 v237,16,v202
v_lshlrev_b32 v236,16,v200
M a[4:7],a[252:255],a[216:219],a[4:7]
buffer_load_dwordx2 v[208:209],v245,s[8:11],s28 offen offset:384
M a[8:11],a[252:255],a[244:247],a[8:11]
ds_read_b128 a[192:195],v248 offset:1536
v_lshlrev_b32 v235,16,v198
M a[8:11],a[248:251],a[196:199],a[8:11]
s_waitcnt lgkmcnt(2)
ds_read_b128 a[224:227],v249 offset:1536
v_fmac_f32 v232,s43,v234
M a[8:11],a[240:243],a[228:231],a[8:11]
s_waitcnt lgkmcnt(2)
v_fmac_f32 v237,4.0,v233
v_fma_f32 v238,-4.0,v234,v236
M a[12:15],a[240:243],v[224:227],a[12:15]
buffer_load_dwordx2 v[210:211],v245,s[8:11],s28 offen offset:768
M a[12:15],a[248:251],a[228:231],a[12:15]
v_fmac_f32 v232,s45,v236
v_fmac_f32 v237,s41,v235
M a[12:15],a[252:255],a[196:199],a[12:15]
v_sub_f32 v236,v236,v234
v_fma_f32 v234,-4.0,v233,v235
M a[16:19],a[252:255],a[228:231],a[16:19]
ds_read_b128 a[208:211],v249 offset:2048
v_sub_f32 v235,v235,v233
M a[16:19],a[248:251],v[224:227],a[16:19]
s_waitcnt lgkmcnt(2)
buffer_load_dwordx2 v[212:213],v245,s[8:11],s28 offen offset:1152
M a[16:19],a[240:243],a[192:195],a[16:19]
s_waitcnt lgkmcnt(1)
ds_read_b128 v[220:223],v248 offset:2048
v_add_f32 v233,v238,v234
M a[20:23],a[240:243],a[224:227],a[20:23]
v_sub_f32 v238,v238,v234
v_fma_f32 v234,2.0,v235,v236
M a[20:23],a[248:251],a[192:195],a[20:23]
v_fmac_f32 v236,-2.0,v235
v_and_b32 v196,s42,v196
M a[20:23],a[252:255],v[224:227],a[20:23]
v_and_b32 v192,s42,v192
v_and_b32 v194,s42,v194
M a[24:27],a[252:255],a[192:195],a[24:27]
v_and_b32 v202,s42,v202
v_and_b32 v200,s42,v200
M a[24:27],a[248:251],a[224:227],a[24:27]
s_waitcnt lgkmcnt(1)
v_and_b32 v198,s42,v198
v_fmac_f32 v192,s43,v196
M a[24:27],a[240:243],a[208:211],a[24:27]
s_waitcnt lgkmcnt(0)
v_fmac_f32 v202,4.0,v194
v_fma_f32 v235,-4.0,v196,v200
M a[28:31],a[240:243],v[220:223],a[28:31]
buffer_load_dwordx4 a[240:243],v250,s[20:23],s46 offen offset:1024 sc1
M a[28:31],a[248:251],a[208:211],a[28:31]
v_fmac_f32 v192,s45,v200
v_fmac_f32 v202,s41,v198
M a[28:31],a[252:255],a[224:227],a[28:31]
s_waitcnt vmcnt(13)
buffer_load_dwordx4 a[248:251],v250,s[20:23],s46 offen offset:2048 sc1
M a[32:35],v[216:219],a[232:235],a[32:35]
s_waitcnt vmcnt(13)
s_add_u32 s47,s73,21504
v_sub_f32 v200,v200,v196
v_fma_f32 v196,-4.0,v194,v198
M a[32:35],a[220:223],a[216:219],a[32:35]
s_waitcnt vmcnt(12)
v_sub_f32 v198,v198,v194
v_add_f32 v194,v235,v196
M a[32:35],a[200:203],a[244:247],a[32:35]
v_sub_f32 v235,v235,v196
v_fma_f32 v196,2.0,v198,v200
M a[36:39],a[200:203],a[196:199],a[36:39]
buffer_load_dwordx4 a[252:255],v250,s[20:23],s47 offen offset:0 sc1
M a[36:39],a[220:223],a[244:247],a[36:39]
v_fmac_f32 v200,-2.0,v198
v_cvt_pk_bf16_f32 v192,v232,v192
M a[36:39],v[216:219],a[216:219],a[36:39]
v_cvt_pk_bf16_f32 v202,v237,v202
v_cvt_pk_bf16_f32 v194,v233,v194
M a[40:43],v[216:219],a[244:247],a[40:43]
v_cvt_pk_bf16_f32 v198,v234,v196
v_cvt_pk_bf16_f32 v196,v238,v235
M a[40:43],a[220:223],a[196:199],a[40:43]
v_cvt_pk_bf16_f32 v200,v236,v200
v_lshlrev_b32 v234,16,v197
M a[40:43],a[200:203],a[228:231],a[40:43]
v_lshlrev_b32 v232,16,v193
v_lshlrev_b32 v233,16,v195
M a[44:47],a[200:203],v[224:227],a[44:47]
v_lshlrev_b32 v237,16,v203
v_lshlrev_b32 v236,16,v201
M a[44:47],a[220:223],a[228:231],a[44:47]
v_lshlrev_b32 v235,16,v199
v_fmac_f32 v232,s43,v234
M a[44:47],v[216:219],a[196:199],a[44:47]
v_fmac_f32 v237,4.0,v233
v_fma_f32 v238,-4.0,v234,v236
M a[48:51],v[216:219],a[228:231],a[48:51]
v_fmac_f32 v232,s45,v236
v_fmac_f32 v237,s41,v235
M a[48:51],a[220:223],v[224:227],a[48:51]
v_sub_f32 v236,v236,v234
v_fma_f32 v234,-4.0,v233,v235
M a[48:51],a[200:203],a[192:195],a[48:51]
v_sub_f32 v235,v235,v233
v_add_f32 v233,v238,v234
M a[52:55],a[200:203],a[224:227],a[52:55]
v_sub_f32 v238,v238,v234
v_fma_f32 v234,2.0,v235,v236
M a[52:55],a[220:223],a[192:195],a[52:55]
v_fmac_f32 v236,-2.0,v235
v_and_b32 v197,s42,v197
M a[52:55],v[216:219],v[224:227],a[52:55]
v_and_b32 v193,s42,v193
v_and_b32 v195,s42,v195
M a[56:59],v[216:219],a[192:195],a[56:59]
v_and_b32 v203,s42,v203
v_and_b32 v201,s42,v201
M a[56:59],a[220:223],a[224:227],a[56:59]
v_and_b32 v199,s42,v199
v_fmac_f32 v193,s43,v197
M a[56:59],a[200:203],a[208:211],a[56:59]
v_fmac_f32 v203,4.0,v195
v_fma_f32 v235,-4.0,v197,v201
M a[60:63],a[200:203],v[220:223],a[60:63]
buffer_load_dwordx4 a[200:203],v250,s[20:23],s47 offen offset:1024 sc1
M a[60:63],a[220:223],a[208:211],a[60:63]
v_fmac_f32 v193,s45,v201
v_fmac_f32 v203,s41,v199
M a[60:63],v[216:219],a[224:227],a[60:63]
s_waitcnt vmcnt(13)
buffer_load_dwordx4 a[220:223],v250,s[20:23],s47 offen offset:2048 sc1
M a[64:67],a[212:215],a[232:235],a[64:67]
s_waitcnt vmcnt(13)
s_add_u32 s48,s73,24576
v_sub_f32 v201,v201,v197
v_fma_f32 v197,-4.0,v195,v199
M a[64:67],a[204:207],a[216:219],a[64:67]
s_waitcnt vmcnt(12)
v_sub_f32 v199,v199,v195
v_add_f32 v195,v235,v197
M a[64:67],a[236:239],a[244:247],a[64:67]
v_sub_f32 v235,v235,v197
v_fma_f32 v197,2.0,v199,v201
M a[68:71],a[236:239],a[196:199],a[68:71]
buffer_load_dwordx4 v[216:219],v250,s[20:23],s48 offen offset:0 sc1
M a[68:71],a[204:207],a[244:247],a[68:71]
v_fmac_f32 v201,-2.0,v199
v_cvt_pk_bf16_f32 v193,v232,v193
M a[68:71],a[212:215],a[216:219],a[68:71]
v_cvt_pk_bf16_f32 v203,v237,v203
v_cvt_pk_bf16_f32 v195,v233,v195
M a[72:75],a[212:215],a[244:247],a[72:75]
v_cvt_pk_bf16_f32 v199,v234,v197
v_cvt_pk_bf16_f32 v197,v238,v235
M a[72:75],a[204:207],a[196:199],a[72:75]
buffer_load_dwordx4 a[232:235],v250,s[20:23],s48 offen offset:1024 sc1
M a[72:75],a[236:239],a[228:231],a[72:75]
v_cvt_pk_bf16_f32 v201,v236,v201
M a[76:79],a[236:239],v[224:227],a[76:79]
M a[76:79],a[204:207],a[228:231],a[76:79]
M a[76:79],a[212:215],a[196:199],a[76:79]
buffer_load_dwordx4 a[216:219],v250,s[20:23],s48 offen offset:2048 sc1
M a[80:83],a[212:215],a[228:231],a[80:83]
s_add_u32 s46,s73,27648
M a[80:83],a[204:207],v[224:227],a[80:83]
M a[80:83],a[236:239],a[192:195],a[80:83]
ds_write2st64_b64 v247,v[192:193],v[202:203] offset0:204 offset1:221
M a[84:87],a[236:239],a[224:227],a[84:87]
s_add_u32 s28,s68,7077888
buffer_load_dwordx4 a[244:247],v250,s[20:23],s46 offen offset:0 sc1
M a[84:87],a[204:207],a[192:195],a[84:87]
ds_read_b128 a[196:199],v248 offset:8704
M a[84:87],a[212:215],v[224:227],a[84:87]
ds_write2st64_b64 v247,v[194:195],v[196:197] offset0:34 offset1:51
M a[88:91],a[212:215],a[192:195],a[88:91]
buffer_load_dwordx2 v[192:193],v245,s[12:15],s28 offen offset:0
M a[88:91],a[204:207],a[224:227],a[88:91]
ds_read_b128 a[228:231],v249 offset:8704
ds_read_b128 v[224:227],v248 offset:9216
M a[88:91],a[236:239],a[208:211],a[88:91]
ds_write2st64_b64 v247,v[198:199],v[200:201] offset0:68 offset1:85
M a[92:95],a[236:239],v[220:223],a[92:95]
buffer_load_dwordx2 v[202:203],v245,s[16:19],s28 offen offset:1536
M a[92:95],a[204:207],a[208:211],a[92:95]
ds_read_b128 a[192:195],v249 offset:9216
M a[92:95],a[212:215],a[224:227],a[92:95]
s_waitcnt vmcnt(17) lgkmcnt(5)
M a[96:99],v[228:231],a[196:199],a[96:99]
s_waitcnt vmcnt(10) lgkmcnt(3)
ds_read_b128 a[236:239],v248 offset:9728
M a[96:99],a[240:243],a[228:231],a[96:99]
s_waitcnt vmcnt(9) lgkmcnt(3)
buffer_load_dwordx2 v[194:195],v245,s[8:11],s28 offen offset:0
M a[96:99],a[248:251],v[224:227],a[96:99]
s_waitcnt lgkmcnt(1)
ds_read_b128 v[220:223],v249 offset:9728
v_lshlrev_b32 v234,16,v208
M a[100:103],a[248:251],a[192:195],a[100:103]
v_lshlrev_b32 v232,16,v204
v_lshlrev_b32 v233,16,v206
M a[100:103],a[240:243],v[224:227],a[100:103]
v_lshlrev_b32 v237,16,v214
v_lshlrev_b32 v236,16,v212
M a[100:103],v[228:231],a[228:231],a[100:103]
buffer_load_dwordx2 v[196:197],v245,s[8:11],s28 offen offset:384
M a[104:107],v[228:231],v[224:227],a[104:107]
ds_read_b128 a[204:207],v248 offset:10240
v_lshlrev_b32 v235,16,v210
M a[104:107],a[240:243],a[192:195],a[104:107]
s_waitcnt lgkmcnt(2)
ds_read_b128 a[208:211],v249 offset:10240
v_fmac_f32 v232,s43,v234
M a[104:107],a[248:251],a[236:239],a[104:107]
s_waitcnt lgkmcnt(2)
v_fmac_f32 v237,4.0,v233
v_fma_f32 v238,-4.0,v234,v236
M a[108:111],a[248:251],v[220:223],a[108:111]
buffer_load_dwordx2 v[198:199],v245,s[8:11],s28 offen offset:768
M a[108:111],a[240:243],a[236:239],a[108:111]
v_fmac_f32 v232,s45,v236
v_fmac_f32 v237,s41,v235
M a[108:111],v[228:231],a[192:195],a[108:111]
v_sub_f32 v236,v236,v234
v_fma_f32 v234,-4.0,v233,v235
M a[112:115],v[228:231],a[236:239],a[112:115]
ds_read_b128 a[212:215],v249 offset:10752
v_sub_f32 v235,v235,v233
M a[112:115],a[240:243],v[220:223],a[112:115]
s_waitcnt lgkmcnt(2)
buffer_load_dwordx2 v[200:201],v245,s[8:11],s28 offen offset:1152
M a[112:115],a[248:251],a[204:207],a[112:115]
s_waitcnt lgkmcnt(1)
ds_read_b128 a[224:227],v248 offset:10752
v_add_f32 v233,v238,v234
M a[116:119],a[248:251],a[208:211],a[116:119]
v_sub_f32 v238,v238,v234
v_fma_f32 v234,2.0,v235,v236
M a[116:119],a[240:243],a[204:207],a[116:119]
v_fmac_f32 v236,-2.0,v235
v_and_b32 v208,s42,v208
M a[116:119],v[228:231],v[220:223],a[116:119]
v_and_b32 v204,s42,v204
v_and_b32 v206,s42,v206
M a[120:123],v[228:231],a[204:207],a[120:123]
v_and_b32 v214,s42,v214
v_and_b32 v212,s42,v212
M a[120:123],a[240:243],a[208:211],a[120:123]
s_waitcnt lgkmcnt(1)
v_and_b32 v210,s42,v210
v_fmac_f32 v204,s43,v208
M a[120:123],a[248:251],a[212:215],a[120:123]
s_waitcnt lgkmcnt(0)
v_fmac_f32 v214,4.0,v206
v_fma_f32 v235,-4.0,v208,v212
M a[124:127],a[248:251],a[224:227],a[124:127]
buffer_load_dwordx4 a[248:251],v250,s[20:23],s46 offen offset:1024 sc1
M a[124:127],a[240:243],a[212:215],a[124:127]
v_fmac_f32 v204,s45,v212
v_fmac_f32 v214,s41,v210
M a[124:127],v[228:231],a[208:211],a[124:127]
s_waitcnt vmcnt(13)
buffer_load_dwordx4 a[240:243],v250,s[20:23],s46 offen offset:2048 sc1
M a[128:131],a[252:255],a[196:199],a[128:131]
s_waitcnt vmcnt(13)
s_add_u32 s47,s73,30720
v_sub_f32 v212,v212,v208
v_fma_f32 v208,-4.0,v206,v210
M a[128:131],a[200:203],a[228:231],a[128:131]
s_waitcnt vmcnt(12)
v_sub_f32 v210,v210,v206
v_add_f32 v206,v235,v208
M a[128:131],a[220:223],v[224:227],a[128:131]
v_sub_f32 v235,v235,v208
v_fma_f32 v208,2.0,v210,v212
M a[132:135],a[220:223],a[192:195],a[132:135]
buffer_load_dwordx4 v[228:231],v250,s[20:23],s47 offen offset:0 sc1
M a[132:135],a[200:203],v[224:227],a[132:135]
v_fmac_f32 v212,-2.0,v210
v_cvt_pk_bf16_f32 v204,v232,v204
M a[132:135],a[252:255],a[228:231],a[132:135]
v_cvt_pk_bf16_f32 v214,v237,v214
v_cvt_pk_bf16_f32 v206,v233,v206
M a[136:139],a[252:255],v[224:227],a[136:139]
v_cvt_pk_bf16_f32 v210,v234,v208
v_cvt_pk_bf16_f32 v208,v238,v235
M a[136:139],a[200:203],a[192:195],a[136:139]
v_cvt_pk_bf16_f32 v212,v236,v212
v_lshlrev_b32 v234,16,v209
M a[136:139],a[220:223],a[236:239],a[136:139]
v_lshlrev_b32 v232,16,v205
v_lshlrev_b32 v233,16,v207
M a[140:143],a[220:223],v[220:223],a[140:143]
v_lshlrev_b32 v237,16,v215
v_lshlrev_b32 v236,16,v213
M a[140:143],a[200:203],a[236:239],a[140:143]
v_lshlrev_b32 v235,16,v211
v_fmac_f32 v232,s43,v234
M a[140:143],a[252:255],a[192:195],a[140:143]
v_fmac_f32 v237,4.0,v233
v_fma_f32 v238,-4.0,v234,v236
M a[144:147],a[252:255],a[236:239],a[144:147]
v_fmac_f32 v232,s45,v236
v_fmac_f32 v237,s41,v235
M a[144:147],a[200:203],v[220:223],a[144:147]
v_sub_f32 v236,v236,v234
v_fma_f32 v234,-4.0,v233,v235
M a[144:147],a[220:223],a[204:207],a[144:147]
v_sub_f32 v235,v235,v233
v_add_f32 v233,v238,v234
M a[148:151],a[220:223],a[208:211],a[148:151]
v_sub_f32 v238,v238,v234
v_fma_f32 v234,2.0,v235,v236
M a[148:151],a[200:203],a[204:207],a[148:151]
v_fmac_f32 v236,-2.0,v235
v_and_b32 v209,s42,v209
M a[148:151],a[252:255],v[220:223],a[148:151]
v_and_b32 v205,s42,v205
v_and_b32 v207,s42,v207
M a[152:155],a[252:255],a[204:207],a[152:155]
v_and_b32 v215,s42,v215
v_and_b32 v213,s42,v213
M a[152:155],a[200:203],a[208:211],a[152:155]
v_and_b32 v211,s42,v211
v_fmac_f32 v205,s43,v209
M a[152:155],a[220:223],a[212:215],a[152:155]
v_fmac_f32 v215,4.0,v207
v_fma_f32 v235,-4.0,v209,v213
M a[156:159],a[220:223],a[224:227],a[156:159]
buffer_load_dwordx4 a[220:223],v250,s[20:23],s47 offen offset:1024 sc1
M a[156:159],a[200:203],a[212:215],a[156:159]
v_fmac_f32 v205,s45,v213
v_fmac_f32 v215,s41,v211
M a[156:159],a[252:255],a[208:211],a[156:159]
s_waitcnt vmcnt(13)
buffer_load_dwordx4 a[200:203],v250,s[20:23],s47 offen offset:2048 sc1
M a[160:163],v[216:219],a[196:199],a[160:163]
s_waitcnt vmcnt(13)
s_add_u32 s48,s73,33792
v_sub_f32 v213,v213,v209
v_fma_f32 v209,-4.0,v207,v211
M a[160:163],a[232:235],a[228:231],a[160:163]
s_waitcnt vmcnt(12)
v_sub_f32 v211,v211,v207
v_add_f32 v207,v235,v209
M a[160:163],a[216:219],v[224:227],a[160:163]
v_sub_f32 v235,v235,v209
v_fma_f32 v209,2.0,v211,v213
M a[164:167],a[216:219],a[192:195],a[164:167]
buffer_load_dwordx4 a[252:255],v250,s[20:23],s48 offen offset:0 sc1
M a[164:167],a[232:235],v[224:227],a[164:167]
v_fmac_f32 v213,-2.0,v211
v_cvt_pk_bf16_f32 v205,v232,v205
M a[164:167],v[216:219],a[228:231],a[164:167]
v_cvt_pk_bf16_f32 v215,v237,v215
v_cvt_pk_bf16_f32 v207,v233,v207
M a[168:171],v[216:219],v[224:227],a[168:171]
v_cvt_pk_bf16_f32 v211,v234,v209
v_cvt_pk_bf16_f32 v209,v238,v235
M a[168:171],a[232:235],a[192:195],a[168:171]
buffer_load_dwordx4 a[196:199],v250,s[20:23],s48 offen offset:1024 sc1
M a[168:171],a[216:219],a[236:239],a[168:171]
v_cvt_pk_bf16_f32 v213,v236,v213
v_fmac_f32 v239,s43,v241
M a[172:175],a[216:219],v[220:223],a[172:175]
v_fmac_f32 v244,4.0,v240
v_fma_f32 v232,-4.0,v241,v243
M a[172:175],a[232:235],a[236:239],a[172:175]
v_fmac_f32 v239,s45,v243
v_fmac_f32 v244,s41,v242
M a[172:175],v[216:219],a[192:195],a[172:175]
buffer_load_dwordx4 a[228:231],v250,s[20:23],s48 offen offset:2048 sc1
M a[176:179],v[216:219],a[236:239],a[176:179]
s_add_u32 s46,s73,36864
v_sub_f32 v243,v243,v241
v_fma_f32 v241,-4.0,v240,v242
M a[176:179],a[232:235],v[220:223],a[176:179]
v_add_u32 v248,0x4400,v248
v_add_u32 v249,0x4400,v249
M a[176:179],a[216:219],a[204:207],a[176:179]
ds_write2st64_b64 v247,v[204:205],v[214:215] offset0:205 offset1:222
M a[180:183],a[216:219],a[208:211],a[180:183]
s_add_u32 s28,s68,7471104
buffer_load_dwordx4 v[224:227],v250,s[20:23],s46 offen offset:0 sc1
M a[180:183],a[232:235],a[204:207],a[180:183]
ds_read_b128 a[192:195],v248 offset:52224
v_sub_f32 v242,v242,v240
M a[180:183],v[216:219],v[220:223],a[180:183]
ds_write2st64_b64 v247,v[206:207],v[208:209] offset0:35 offset1:52
M a[184:187],v[216:219],a[204:207],a[184:187]
buffer_load_dwordx2 v[204:205],v245,s[12:15],s28 offen offset:0
M a[184:187],a[232:235],a[208:211],a[184:187]
ds_read_b128 a[236:239],v249 offset:52224
ds_read_b128 v[220:223],v248 offset:52736
M a[184:187],a[216:219],a[212:215],a[184:187]
ds_write2st64_b64 v247,v[210:211],v[212:213] offset0:69 offset1:86
M a[188:191],a[216:219],a[224:227],a[188:191]
buffer_load_dwordx2 v[214:215],v245,s[16:19],s28 offen offset:1536
M a[188:191],a[232:235],a[212:215],a[188:191]
ds_read_b128 a[204:207],v249 offset:52736
v_add_f32 v240,v232,v241
M a[188:191],v[216:219],a[208:211],a[188:191]
s_waitcnt vmcnt(17) lgkmcnt(5)
v_sub_f32 v232,v232,v241
v_fma_f32 v241,2.0,v242,v243
M v[0:3],a[244:247],a[192:195],v[0:3]
s_waitcnt vmcnt(10) lgkmcnt(3)
ds_read_b128 a[216:219],v248 offset:53248
v_fmac_f32 v243,-2.0,v242
M v[0:3],a[248:251],a[236:239],v[0:3]
s_waitcnt vmcnt(9) lgkmcnt(3)
buffer_load_dwordx2 v[206:207],v245,s[8:11],s28 offen offset:0
M v[0:3],a[240:243],v[220:223],v[0:3]
s_waitcnt lgkmcnt(1)
ds_read_b128 a[224:227],v249 offset:53248
v_cvt_pk_bf16_f32 v233,v239,v244
M v[4:7],a[240:243],a[204:207],v[4:7]
v_cvt_pk_bf16_f32 v234,v240,v232
v_cvt_pk_bf16_f32 v235,v241,v243
M v[4:7],a[248:251],v[220:223],v[4:7]
v_add_u32 v232,104448,v252
M v[4:7],a[244:247],a[236:239],v[4:7]
buffer_load_dwordx2 v[208:209],v245,s[8:11],s28 offen offset:384
M v[8:11],a[244:247],v[220:223],v[8:11]
ds_read_b128 a[212:215],v248 offset:53760
ds_write_b16 v232,v233 offset:0
M v[8:11],a[248:251],a[204:207],v[8:11]
s_waitcnt lgkmcnt(3)
ds_read_b128 a[232:235],v249 offset:53760
ds_write_b16_d16_hi v232,v233 offset:8704
M v[8:11],a[240:243],a[216:219],v[8:11]
s_waitcnt lgkmcnt(4)
ds_write_b16 v252,v234 offset:17408
M v[12:15],a[240:243],a[224:227],v[12:15]
buffer_load_dwordx2 v[210:211],v245,s[8:11],s28 offen offset:768
M v[12:15],a[248:251],a[216:219],v[12:15]
ds_write_b16_d16_hi v252,v234 offset:26112
M v[12:15],a[244:247],a[204:207],v[12:15]
ds_write_b16 v252,v235 offset:34816
M v[16:19],a[244:247],a[216:219],v[16:19]
ds_read_b128 a[208:211],v249 offset:54272
ds_write_b16_d16_hi v252,v235 offset:43520
M v[16:19],a[248:251],a[224:227],v[16:19]
s_waitcnt lgkmcnt(8)
buffer_load_dwordx2 v[212:213],v245,s[8:11],s28 offen offset:1152
M v[16:19],a[240:243],a[212:215],v[16:19]
s_waitcnt lgkmcnt(6)
s_add_u32 s29,s69,6291456
ds_read_b128 v[216:219],v248 offset:54272
v_lshlrev_b32 v234,16,v196
M v[20:23],a[240:243],a[232:235],v[20:23]
v_lshlrev_b32 v232,16,v192
v_lshlrev_b32 v233,16,v194
M v[20:23],a[248:251],a[212:215],v[20:23]
buffer_load_short_d16_hi v239,v246,s[12:15],s29 offen offset:0
M v[20:23],a[244:247],a[224:227],v[20:23]
v_lshlrev_b32 v237,16,v202
v_lshlrev_b32 v236,16,v200
M v[24:27],a[244:247],a[212:215],v[24:27]
buffer_load_short_d16_hi v240,v246,s[8:11],s29 offen offset:0
M v[24:27],a[248:251],a[232:235],v[24:27]
s_waitcnt lgkmcnt(2)
v_lshlrev_b32 v235,16,v198
v_fmac_f32 v232,s43,v234
M v[24:27],a[240:243],a[208:211],v[24:27]
s_waitcnt lgkmcnt(0)
buffer_load_short_d16_hi v241,v246,s[8:11],s29 offen offset:384
M v[28:31],a[240:243],v[216:219],v[28:31]
v_fmac_f32 v237,4.0,v233
v_fma_f32 v238,-4.0,v234,v236
M v[28:31],a[248:251],a[208:211],v[28:31]
buffer_load_dwordx4 a[240:243],v250,s[20:23],s46 offen offset:1024 sc1
M v[28:31],a[244:247],a[232:235],v[28:31]
s_waitcnt vmcnt(16)
v_fmac_f32 v232,s45,v236
v_fmac_f32 v237,s41,v235
M v[32:35],v[228:231],a[192:195],v[32:35]
s_waitcnt vmcnt(15)
v_sub_f32 v236,v236,v234
v_fma_f32 v234,-4.0,v233,v235
M v[32:35],a[220:223],a[236:239],v[32:35]
s_waitcnt vmcnt(14)
v_sub_f32 v235,v235,v233
v_add_f32 v233,v238,v234
M v[32:35],a[200:203],v[220:223],v[32:35]
buffer_load_dwordx4 a[248:251],v250,s[20:23],s46 offen offset:2048 sc1
M v[36:39],a[200:203],a[204:207],v[36:39]
s_add_u32 s47,s73,39936
v_sub_f32 v238,v238,v234
v_fma_f32 v234,2.0,v235,v236
M v[36:39],a[220:223],v[220:223],v[36:39]
v_fmac_f32 v236,-2.0,v235
v_and_b32 v196,s42,v196
M v[36:39],v[228:231],a[236:239],v[36:39]
v_and_b32 v192,s42,v192
v_and_b32 v194,s42,v194
M v[40:43],v[228:231],v[220:223],v[40:43]
buffer_load_dwordx4 a[244:247],v250,s[20:23],s47 offen offset:0 sc1
M v[40:43],a[220:223],a[204:207],v[40:43]
v_and_b32 v202,s42,v202
v_and_b32 v200,s42,v200
M v[40:43],a[200:203],a[216:219],v[40:43]
v_and_b32 v198,s42,v198
v_fmac_f32 v192,s43,v196
M v[44:47],a[200:203],a[224:227],v[44:47]
v_fmac_f32 v202,4.0,v194
v_fma_f32 v235,-4.0,v196,v200
M v[44:47],a[220:223],a[216:219],v[44:47]
buffer_load_short_d16_hi v242,v246,s[8:11],s29 offen offset:768
M v[44:47],v[228:231],a[204:207],v[44:47]
v_fmac_f32 v192,s45,v200
v_fmac_f32 v202,s41,v198
M v[48:51],v[228:231],a[216:219],v[48:51]
buffer_load_short_d16_hi v243,v246,s[8:11],s29 offen offset:1152
M v[48:51],a[220:223],a[224:227],v[48:51]
v_sub_f32 v200,v200,v196
v_fma_f32 v196,-4.0,v194,v198
M v[48:51],a[200:203],a[212:215],v[48:51]
buffer_load_short_d16_hi v244,v246,s[16:19],s29 offen offset:1536
M v[52:55],a[200:203],a[232:235],v[52:55]
v_sub_f32 v198,v198,v194
v_add_f32 v194,v235,v196
M v[52:55],a[220:223],a[212:215],v[52:55]
v_sub_f32 v235,v235,v196
v_fma_f32 v196,2.0,v198,v200
M v[52:55],v[228:231],a[224:227],v[52:55]
v_fmac_f32 v200,-2.0,v198
v_cvt_pk_bf16_f32 v192,v232,v192
M v[56:59],v[228:231],a[212:215],v[56:59]
v_cvt_pk_bf16_f32 v202,v237,v202
v_cvt_pk_bf16_f32 v194,v233,v194
M v[56:59],a[220:223],a[232:235],v[56:59]
v_cvt_pk_bf16_f32 v198,v234,v196
v_cvt_pk_bf16_f32 v196,v238,v235
M v[56:59],a[200:203],a[208:211],v[56:59]
v_cvt_pk_bf16_f32 v200,v236,v200
v_lshlrev_b32 v234,16,v197
M v[60:63],a[200:203],v[216:219],v[60:63]
buffer_load_dwordx4 a[200:203],v250,s[20:23],s47 offen offset:1024 sc1
M v[60:63],a[220:223],a[208:211],v[60:63]
v_lshlrev_b32 v232,16,v193
v_lshlrev_b32 v233,16,v195
M v[60:63],v[228:231],a[232:235],v[60:63]
s_waitcnt vmcnt(19)
buffer_load_dwordx4 a[220:223],v250,s[20:23],s47 offen offset:2048 sc1
M v[64:67],a[252:255],a[192:195],v[64:67]
s_waitcnt vmcnt(19)
s_add_u32 s48,s73,43008
v_lshlrev_b32 v237,16,v203
v_lshlrev_b32 v236,16,v201
M v[64:67],a[196:199],a[236:239],v[64:67]
s_waitcnt vmcnt(18)
v_lshlrev_b32 v235,16,v199
v_fmac_f32 v232,s43,v234
M v[64:67],a[228:231],v[220:223],v[64:67]
v_fmac_f32 v237,4.0,v233
v_fma_f32 v238,-4.0,v234,v236
M v[68:71],a[228:231],a[204:207],v[68:71]
buffer_load_dwordx4 v[228:231],v250,s[20:23],s48 offen offset:0 sc1
M v[68:71],a[196:199],v[220:223],v[68:71]
v_fmac_f32 v232,s45,v236
v_fmac_f32 v237,s41,v235
M v[68:71],a[252:255],a[236:239],v[68:71]
v_sub_f32 v236,v236,v234
v_fma_f32 v234,-4.0,v233,v235
M v[72:75],a[252:255],v[220:223],v[72:75]
v_sub_f32 v235,v235,v233
v_add_f32 v233,v238,v234
M v[72:75],a[196:199],a[204:207],v[72:75]
buffer_load_dwordx4 a[192:195],v250,s[20:23],s48 offen offset:1024 sc1
M v[72:75],a[228:231],a[216:219],v[72:75]
v_sub_f32 v238,v238,v234
v_fma_f32 v234,2.0,v235,v236
M v[76:79],a[228:231],a[224:227],v[76:79]
v_fmac_f32 v236,-2.0,v235
v_and_b32 v197,s42,v197
M v[76:79],a[196:199],a[216:219],v[76:79]
v_and_b32 v193,s42,v193
v_and_b32 v195,s42,v195
M v[76:79],a[252:255],a[204:207],v[76:79]
buffer_load_dwordx4 a[236:239],v250,s[20:23],s48 offen offset:2048 sc1
M v[80:83],a[252:255],a[216:219],v[80:83]
s_add_u32 s46,s74,9216
v_and_b32 v203,s42,v203
v_and_b32 v201,s42,v201
M v[80:83],a[196:199],a[224:227],v[80:83]
v_and_b32 v199,s42,v199
v_fmac_f32 v193,s43,v197
M v[80:83],a[228:231],a[212:215],v[80:83]
v_fmac_f32 v203,4.0,v195
v_fma_f32 v235,-4.0,v197,v201
M v[84:87],a[228:231],a[232:235],v[84:87]
buffer_load_dwordx4 v[220:223],v250,s[20:23],s46 offen offset:0 sc1
M v[84:87],a[196:199],a[212:215],v[84:87]
ds_read_b128 a[204:207],v248 offset:60928
v_fmac_f32 v193,s45,v201
M v[84:87],a[252:255],a[224:227],v[84:87]
ds_read_b128 a[216:219],v249 offset:60928
v_fmac_f32 v203,s41,v199
M v[88:91],a[252:255],a[212:215],v[88:91]
ds_read_b128 a[224:227],v248 offset:61440
v_sub_f32 v201,v201,v197
M v[88:91],a[196:199],a[232:235],v[88:91]
ds_read_b128 a[212:215],v249 offset:61440
v_fma_f32 v197,-4.0,v195,v199
M v[88:91],a[228:231],a[208:211],v[88:91]
v_sub_f32 v199,v199,v195
v_add_f32 v195,v235,v197
M v[92:95],a[228:231],v[216:219],v[92:95]
v_sub_f32 v235,v235,v197
v_fma_f32 v197,2.0,v199,v201
M v[92:95],a[196:199],a[208:211],v[92:95]
v_fmac_f32 v201,-2.0,v199
v_cvt_pk_bf16_f32 v193,v232,v193
M v[92:95],a[252:255],a[232:235],v[92:95]
s_waitcnt vmcnt(21) lgkmcnt(3)
v_cvt_pk_bf16_f32 v203,v237,v203
v_cvt_pk_bf16_f32 v195,v233,v195
M v[96:99],v[224:227],a[204:207],v[96:99]
s_waitcnt vmcnt(11) lgkmcnt(2)
ds_read_b128 a[228:231],v248 offset:61952
v_cvt_pk_bf16_f32 v199,v234,v197
M v[96:99],a[240:243],a[216:219],v[96:99]
s_waitcnt vmcnt(10) lgkmcnt(2)
ds_read_b128 v[216:219],v249 offset:61952
v_cvt_pk_bf16_f32 v197,v238,v235
M v[96:99],a[248:251],a[224:227],v[96:99]
s_waitcnt lgkmcnt(2)
v_cvt_pk_bf16_f32 v201,v236,v201
v_lshlrev_b32 v234,16,v208
M v[100:103],a[248:251],a[212:215],v[100:103]
v_lshlrev_b32 v232,16,v204
v_lshlrev_b32 v233,16,v206
M v[100:103],a[240:243],a[224:227],v[100:103]
v_lshlrev_b32 v237,16,v214
v_lshlrev_b32 v236,16,v212
M v[100:103],v[224:227],a[216:219],v[100:103]
ds_write2st64_b64 v247,v[192:193],v[202:203] offset0:206 offset1:223
M v[104:107],v[224:227],a[224:227],v[104:107]
s_add_u32 s28,s69,6291456
buffer_load_dwordx2 v[192:193],v245,s[12:15],s28 offen offset:0
M v[104:107],a[240:243],a[212:215],v[104:107]
s_waitcnt lgkmcnt(2)
ds_read_b128 a[196:199],v248 offset:62464
ds_read_b128 a[208:211],v249 offset:62464
M v[104:107],a[248:251],a[228:231],v[104:107]
s_waitcnt lgkmcnt(3)
buffer_load_dwordx2 v[202:203],v245,s[16:19],s28 offen offset:1536
M v[108:111],a[248:251],v[216:219],v[108:111]
v_lshlrev_b32 v235,16,v210
v_fmac_f32 v232,s43,v234
M v[108:111],a[240:243],a[228:231],v[108:111]
v_fmac_f32 v237,4.0,v233
v_fma_f32 v238,-4.0,v234,v236
M v[108:111],v[224:227],a[212:215],v[108:111]
ds_write2st64_b64 v247,v[194:195],v[196:197] offset0:36 offset1:53
M v[112:115],v[224:227],a[228:231],v[112:115]
buffer_load_dwordx2 v[194:195],v245,s[8:11],s28 offen offset:0
M v[112:115],a[240:243],v[216:219],v[112:115]
s_waitcnt lgkmcnt(2)
ds_read_b128 a[232:235],v249 offset:62976
ds_read_b128 a[252:255],v248 offset:62976
M v[112:115],a[248:251],a[196:199],v[112:115]
s_waitcnt lgkmcnt(3)
ds_write2st64_b64 v247,v[198:199],v[200:201] offset0:70 offset1:87
M v[116:119],a[248:251],a[208:211],v[116:119]
buffer_load_dwordx2 v[196:197],v245,s[8:11],s28 offen offset:384
M v[116:119],a[240:243],a[196:199],v[116:119]
v_fmac_f32 v232,s45,v236
v_fmac_f32 v237,s41,v235
M v[116:119],v[224:227],v[216:219],v[116:119]
v_sub_f32 v236,v236,v234
v_fma_f32 v234,-4.0,v233,v235
M v[120:123],v[224:227],a[196:199],v[120:123]
v_sub_f32 v235,v235,v233
v_add_f32 v233,v238,v234
M v[120:123],a[240:243],a[208:211],v[120:123]
s_waitcnt lgkmcnt(2)
buffer_load_dwordx2 v[198:199],v245,s[8:11],s28 offen offset:768
M v[120:123],a[248:251],a[232:235],v[120:123]
s_waitcnt lgkmcnt(1)
v_sub_f32 v238,v238,v234
v_fma_f32 v234,2.0,v235,v236
M v[124:127],a[248:251],a[252:255],v[124:127]
v_fmac_f32 v236,-2.0,v235
v_and_b32 v208,s42,v208
M v[124:127],a[240:243],a[232:235],v[124:127]
v_and_b32 v204,s42,v204
v_and_b32 v206,s42,v206
M v[124:127],v[224:227],a[208:211],v[124:127]
s_waitcnt vmcnt(14)
buffer_load_dwordx4 a[248:251],v250,s[20:23],s46 offen offset:1024 sc1
M v[128:131],a[244:247],a[204:207],v[128:131]
s_waitcnt vmcnt(11)
v_and_b32 v214,s42,v214
v_and_b32 v212,s42,v212
M v[128:131],a[200:203],a[216:219],v[128:131]
s_waitcnt vmcnt(10)
v_and_b32 v210,s42,v210
v_fmac_f32 v204,s43,v208
M v[128:131],a[220:223],a[224:227],v[128:131]
v_fmac_f32 v214,4.0,v206
v_fma_f32 v235,-4.0,v208,v212
M v[132:135],a[220:223],a[212:215],v[132:135]
buffer_load_dwordx4 a[240:243],v250,s[20:23],s46 offen offset:2048 sc1
M v[132:135],a[200:203],a[224:227],v[132:135]
s_add_u32 s47,s74,12288
v_fmac_f32 v204,s45,v212
v_fmac_f32 v214,s41,v210
M v[132:135],a[244:247],a[216:219],v[132:135]
v_sub_f32 v212,v212,v208
v_fma_f32 v208,-4.0,v206,v210
M v[136:139],a[244:247],a[224:227],v[136:139]
v_sub_f32 v210,v210,v206
v_add_f32 v206,v235,v208
M v[136:139],a[200:203],a[212:215],v[136:139]
buffer_load_dwordx4 v[224:227],v250,s[20:23],s47 offen offset:0 sc1
M v[136:139],a[220:223],a[228:231],v[136:139]
v_sub_f32 v235,v235,v208
v_fma_f32 v208,2.0,v210,v212
M v[140:143],a[220:223],v[216:219],v[140:143]
v_fmac_f32 v212,-2.0,v210
v_cvt_pk_bf16_f32 v204,v232,v204
M v[140:143],a[200:203],a[228:231],v[140:143]
v_cvt_pk_bf16_f32 v214,v237,v214
v_cvt_pk_bf16_f32 v206,v233,v206
M v[140:143],a[244:247],a[212:215],v[140:143]
buffer_load_dwordx2 v[200:201],v245,s[8:11],s28 offen offset:1152
M v[144:147],a[244:247],a[228:231],v[144:147]
v_cvt_pk_bf16_f32 v210,v234,v208
v_cvt_pk_bf16_f32 v208,v238,v235
M v[144:147],a[200:203],v[216:219],v[144:147]
v_cvt_pk_bf16_f32 v212,v236,v212
v_lshlrev_b32 v234,16,v209
M v[144:147],a[220:223],a[196:199],v[144:147]
v_lshlrev_b32 v232,16,v205
v_lshlrev_b32 v233,16,v207
M v[148:151],a[220:223],a[208:211],v[148:151]
v_lshlrev_b32 v237,16,v215
v_lshlrev_b32 v236,16,v213
M v[148:151],a[200:203],a[196:199],v[148:151]
v_lshlrev_b32 v235,16,v211
v_fmac_f32 v232,s43,v234
M v[148:151],a[244:247],v[216:219],v[148:151]
v_fmac_f32 v237,4.0,v233
v_fma_f32 v238,-4.0,v234,v236
M v[152:155],a[244:247],a[196:199],v[152:155]
v_fmac_f32 v232,s45,v236
v_fmac_f32 v237,s41,v235
M v[152:155],a[200:203],a[208:211],v[152:155]
v_sub_f32 v236,v236,v234
v_fma_f32 v234,-4.0,v233,v235
M v[152:155],a[220:223],a[232:235],v[152:155]
v_sub_f32 v235,v235,v233
v_add_f32 v233,v238,v234
M v[156:159],a[220:223],a[252:255],v[156:159]
buffer_load_dwordx4 a[220:223],v250,s[20:23],s47 offen offset:1024 sc1
v_sub_f32 v238,v238,v234
v_fma_f32 v234,2.0,v235,v236
M v[156:159],a[200:203],a[232:235],v[156:159]
v_fmac_f32 v236,-2.0,v235
v_and_b32 v209,s42,v209
v_and_b32 v205,s42,v205
v_and_b32 v207,s42,v207
M v[156:159],a[244:247],a[208:211],v[156:159]
s_waitcnt vmcnt(13)
buffer_load_dwordx4 a[200:203],v250,s[20:23],s47 offen offset:2048 sc1
v_and_b32 v215,s42,v215
v_and_b32 v213,s42,v213
v_and_b32 v211,s42,v211
v_fmac_f32 v205,s43,v209
M v[160:163],v[228:231],a[204:207],v[160:163]
s_waitcnt vmcnt(13)
s_add_u32 s48,s74,15360
v_fmac_f32 v215,4.0,v207
v_fma_f32 v235,-4.0,v209,v213
v_fmac_f32 v205,s45,v213
v_fmac_f32 v215,s41,v211
M v[160:163],a[192:195],a[216:219],v[160:163]
s_waitcnt vmcnt(12)
buffer_load_dwordx4 a[244:247],v250,s[20:23],s48 offen offset:0 sc1
v_sub_f32 v213,v213,v209
v_fma_f32 v209,-4.0,v207,v211
v_sub_f32 v211,v211,v207
v_add_f32 v207,v235,v209
M v[160:163],a[236:239],a[224:227],v[160:163]
v_sub_f32 v235,v235,v209
v_fma_f32 v209,2.0,v211,v213
v_fmac_f32 v213,-2.0,v211
v_cvt_pk_bf16_f32 v205,v232,v205
M v[164:167],a[236:239],a[212:215],v[164:167]
buffer_load_dwordx4 a[204:207],v250,s[20:23],s48 offen offset:1024 sc1
v_cvt_pk_bf16_f32 v215,v237,v215
v_cvt_pk_bf16_f32 v207,v233,v207
v_cvt_pk_bf16_f32 v211,v234,v209
v_cvt_pk_bf16_f32 v209,v238,v235
M v[164:167],a[192:195],a[224:227],v[164:167]
v_cvt_pk_bf16_f32 v213,v236,v213
M v[164:167],v[228:231],a[216:219],v[164:167]
ds_write2st64_b64 v247,v[204:205],v[214:215] offset0:207 offset1:224
M v[168:171],v[228:231],a[224:227],v[168:171]
s_add_u32 s28,s69,6684672
buffer_load_dwordx4 a[216:219],v250,s[20:23],s48 offen offset:2048 sc1
M v[168:171],a[192:195],a[212:215],v[168:171]
s_add_u32 s46,s74,18432
M v[168:171],a[236:239],a[228:231],v[168:171]
ds_write2st64_b64 v247,v[206:207],v[208:209] offset0:37 offset1:54
M v[172:175],a[236:239],v[216:219],v[172:175]
buffer_load_dwordx4 a[224:227],v250,s[20:23],s46 offen offset:0 sc1
M v[172:175],a[192:195],a[228:231],v[172:175]
M v[172:175],v[228:231],a[212:215],v[172:175]
ds_write2st64_b64 v247,v[210:211],v[212:213] offset0:71 offset1:88
M v[176:179],v[228:231],a[228:231],v[176:179]
buffer_load_dwordx2 v[204:205],v245,s[12:15],s28 offen offset:0
M v[176:179],a[192:195],v[216:219],v[176:179]
M v[176:179],a[236:239],a[196:199],v[176:179]
s_waitcnt lgkmcnt(0)
s_barrier
M v[180:183],a[236:239],a[208:211],v[180:183]
M v[180:183],a[192:195],a[196:199],v[180:183]
buffer_load_dwordx2 v[214:215],v245,s[16:19],s28 offen offset:1536
M v[180:183],v[228:231],v[216:219],v[180:183]
ds_read_b128 a[212:215],v248 offset:0
ds_read_b128 a[228:231],v249 offset:0
M v[184:187],v[228:231],a[196:199],v[184:187]
s_waitcnt vmcnt(13)
ds_read_b128 v[216:219],v248 offset:512
v_lshlrev_b32 v234,16,v196
M v[184:187],a[192:195],a[208:211],v[184:187]
ds_read_b128 a[196:199],v249 offset:512
v_lshlrev_b32 v232,16,v192
M v[184:187],a[236:239],a[232:235],v[184:187]
buffer_load_dwordx2 v[206:207],v245,s[8:11],s28 offen offset:0
M v[188:191],a[236:239],a[252:255],v[188:191]
v_lshlrev_b32 v233,16,v194
v_lshlrev_b32 v237,16,v202
M v[188:191],a[192:195],a[232:235],v[188:191]
s_waitcnt vmcnt(9)
v_lshlrev_b32 v236,16,v200
v_lshlrev_b32 v235,16,v198
M v[188:191],v[228:231],a[208:211],v[188:191]
s_waitcnt lgkmcnt(3)
v_fmac_f32 v232,s43,v234
v_fmac_f32 v237,4.0,v233
M a[0:3],v[220:223],a[212:215],a[0:3]
s_waitcnt lgkmcnt(2)
buffer_load_dwordx2 v[208:209],v245,s[8:11],s28 offen offset:384
M a[0:3],a[248:251],a[228:231],a[0:3]
s_waitcnt lgkmcnt(1)
ds_read_b128 a[236:239],v248 offset:1024
ds_read_b128 a[252:255],v249 offset:1024
M a[0:3],a[240:243],v[216:219],a[0:3]
s_waitcnt lgkmcnt(2)
v_fma_f32 v238,-4.0,v234,v236
v_fmac_f32 v232,s45,v236
M a[4:7],a[240:243],a[196:199],a[4:7]
v_fmac_f32 v237,s41,v235
v_sub_f32 v236,v236,v234
M a[4:7],a[248:251],v[216:219],a[4:7]
buffer_load_dwordx2 v[210:211],v245,s[8:11],s28 offen offset:768
M a[4:7],v[220:223],a[228:231],a[4:7]
v_fma_f32 v234,-4.0,v233,v235
v_sub_f32 v235,v235,v233
M a[8:11],v[220:223],v[216:219],a[8:11]
ds_read_b128 a[192:195],v248 offset:1536
v_add_f32 v233,v238,v234
M a[8:11],a[248:251],a[196:199],a[8:11]
s_waitcnt lgkmcnt(2)
ds_read_b128 a[232:235],v249 offset:1536
v_sub_f32 v238,v238,v234
M a[8:11],a[240:243],a[236:239],a[8:11]
s_waitcnt lgkmcnt(2)
buffer_load_dwordx2 v[212:213],v245,s[8:11],s28 offen offset:1152
M a[12:15],a[240:243],a[252:255],a[12:15]
v_fma_f32 v234,2.0,v235,v236
v_fmac_f32 v236,-2.0,v235
M a[12:15],a[248:251],a[236:239],a[12:15]
v_and_b32 v196,s42,v196
v_and_b32 v192,s42,v192
M a[12:15],v[220:223],a[196:199],a[12:15]
v_and_b32 v194,s42,v194
v_and_b32 v202,s42,v202
M a[16:19],v[220:223],a[236:239],a[16:19]
ds_read_b128 a[208:211],v249 offset:2048
v_and_b32 v200,s42,v200
M a[16:19],a[248:251],a[252:255],a[16:19]
s_waitcnt lgkmcnt(2)
ds_read_b128 v[228:231],v248 offset:2048
v_and_b32 v198,s42,v198
M a[16:19],a[240:243],a[192:195],a[16:19]
s_waitcnt lgkmcnt(2)
v_fmac_f32 v192,s43,v196
v_fmac_f32 v202,4.0,v194
M a[20:23],a[240:243],a[232:235],a[20:23]
v_fma_f32 v235,-4.0,v196,v200
v_fmac_f32 v192,s45,v200
M a[20:23],a[248:251],a[192:195],a[20:23]
v_fmac_f32 v202,s41,v198
v_sub_f32 v200,v200,v196
M a[20:23],v[220:223],a[252:255],a[20:23]
v_fma_f32 v196,-4.0,v194,v198
v_sub_f32 v198,v198,v194
M a[24:27],v[220:223],a[192:195],a[24:27]
v_add_f32 v194,v235,v196
v_sub_f32 v235,v235,v196
M a[24:27],a[248:251],a[232:235],a[24:27]
s_waitcnt lgkmcnt(1)
v_fma_f32 v196,2.0,v198,v200
v_fmac_f32 v200,-2.0,v198
M a[24:27],a[240:243],a[208:211],a[24:27]
s_waitcnt lgkmcnt(0)
v_cvt_pk_bf16_f32 v192,v232,v192
v_cvt_pk_bf16_f32 v202,v237,v202
M a[28:31],a[240:243],v[228:231],a[28:31]
buffer_load_dwordx4 a[240:243],v250,s[20:23],s46 offen offset:1024 sc1
M a[28:31],a[248:251],a[208:211],a[28:31]
v_cvt_pk_bf16_f32 v194,v233,v194
v_cvt_pk_bf16_f32 v198,v234,v196
M a[28:31],v[220:223],a[232:235],a[28:31]
buffer_load_dwordx4 a[248:251],v250,s[20:23],s46 offen offset:2048 sc1
M a[32:35],v[224:227],a[212:215],a[32:35]
s_waitcnt vmcnt(13)
s_add_u32 s47,s74,21504
v_cvt_pk_bf16_f32 v196,v238,v235
v_cvt_pk_bf16_f32 v200,v236,v200
M a[32:35],a[220:223],a[228:231],a[32:35]
s_waitcnt vmcnt(12)
v_lshlrev_b32 v234,16,v197
v_lshlrev_b32 v232,16,v193
M a[32:35],a[200:203],v[216:219],a[32:35]
v_lshlrev_b32 v233,16,v195
v_lshlrev_b32 v237,16,v203
M a[36:39],a[200:203],a[196:199],a[36:39]
buffer_load_dwordx4 v[220:223],v250,s[20:23],s47 offen offset:0 sc1
M a[36:39],a[220:223],v[216:219],a[36:39]
v_lshlrev_b32 v236,16,v201
v_lshlrev_b32 v235,16,v199
M a[36:39],v[224:227],a[228:231],a[36:39]
v_fmac_f32 v232,s43,v234
v_fmac_f32 v237,4.0,v233
M a[40:43],v[224:227],v[216:219],a[40:43]
v_fma_f32 v238,-4.0,v234,v236
v_fmac_f32 v232,s45,v236
M a[40:43],a[220:223],a[196:199],a[40:43]
v_fmac_f32 v237,s41,v235
v_sub_f32 v236,v236,v234
M a[40:43],a[200:203],a[236:239],a[40:43]
v_fma_f32 v234,-4.0,v233,v235
v_sub_f32 v235,v235,v233
M a[44:47],a[200:203],a[252:255],a[44:47]
v_add_f32 v233,v238,v234
v_sub_f32 v238,v238,v234
M a[44:47],a[220:223],a[236:239],a[44:47]
v_fma_f32 v234,2.0,v235,v236
v_fmac_f32 v236,-2.0,v235
M a[44:47],v[224:227],a[196:199],a[44:47]
v_and_b32 v197,s42,v197
v_and_b32 v193,s42,v193
M a[48:51],v[224:227],a[236:239],a[48:51]
v_and_b32 v195,s42,v195
v_and_b32 v203,s42,v203
M a[48:51],a[220:223],a[252:255],a[48:51]
v_and_b32 v201,s42,v201
v_and_b32 v199,s42,v199
M a[48:51],a[200:203],a[192:195],a[48:51]
v_fmac_f32 v193,s43,v197
v_fmac_f32 v203,4.0,v195
M a[52:55],a[200:203],a[232:235],a[52:55]
v_fma_f32 v235,-4.0,v197,v201
v_fmac_f32 v193,s45,v201
M a[52:55],a[220:223],a[192:195],a[52:55]
v_fmac_f32 v203,s41,v199
v_sub_f32 v201,v201,v197
M a[52:55],v[224:227],a[252:255],a[52:55]
v_fma_f32 v197,-4.0,v195,v199
v_sub_f32 v199,v199,v195
M a[56:59],v[224:227],a[192:195],a[56:59]
v_add_f32 v195,v235,v197
v_sub_f32 v235,v235,v197
M a[56:59],a[220:223],a[232:235],a[56:59]
v_fma_f32 v197,2.0,v199,v201
v_fmac_f32 v201,-2.0,v199
M a[56:59],a[200:203],a[208:211],a[56:59]
v_cvt_pk_bf16_f32 v193,v232,v193
v_cvt_pk_bf16_f32 v203,v237,v203
M a[60:63],a[200:203],v[228:231],a[60:63]
buffer_load_dwordx4 a[200:203],v250,s[20:23],s47 offen offset:1024 sc1
M a[60:63],a[220:223],a[208:211],a[60:63]
v_cvt_pk_bf16_f32 v195,v233,v195
v_cvt_pk_bf16_f32 v199,v234,v197
M a[60:63],v[224:227],a[232:235],a[60:63]
s_waitcnt vmcnt(13)
buffer_load_dwordx4 a[220:223],v250,s[20:23],s47 offen offset:2048 sc1
M a[64:67],a[244:247],a[212:215],a[64:67]
s_waitcnt vmcnt(13)
s_add_u32 s48,s74,24576
v_cvt_pk_bf16_f32 v197,v238,v235
v_cvt_pk_bf16_f32 v201,v236,v201
M a[64:67],a[204:207],a[228:231],a[64:67]
s_waitcnt vmcnt(7)
v_lshlrev_b32 v234,16,v208
v_lshlrev_b32 v232,16,v204
M a[64:67],a[216:219],v[216:219],a[64:67]
ds_write2st64_b64 v247,v[192:193],v[202:203] offset0:238 offset1:255
M a[68:71],a[216:219],a[196:199],a[68:71]
s_add_u32 s28,s69,7077888
buffer_load_dwordx4 v[224:227],v250,s[20:23],s48 offen offset:0 sc1
M a[68:71],a[204:207],v[216:219],a[68:71]
v_lshlrev_b32 v233,16,v206
v_lshlrev_b32 v237,16,v214
M a[68:71],a[244:247],a[228:231],a[68:71]
ds_write2st64_b64 v247,v[194:195],v[196:197] offset0:0 offset1:17
M a[72:75],a[244:247],v[216:219],a[72:75]
buffer_load_dwordx4 a[212:215],v250,s[20:23],s48 offen offset:1024 sc1
M a[72:75],a[204:207],a[196:199],a[72:75]
s_waitcnt vmcnt(7)
v_lshlrev_b32 v236,16,v212
v_lshlrev_b32 v235,16,v210
M a[72:75],a[216:219],a[236:239],a[72:75]
ds_write2st64_b64 v247,v[198:199],v[200:201] offset0:136 offset1:153
M a[76:79],a[216:219],a[252:255],a[76:79]
buffer_load_dwordx4 a[228:231],v250,s[20:23],s48 offen offset:2048 sc1
M a[76:79],a[204:207],a[236:239],a[76:79]
s_add_u32 s46,s74,27648
v_fmac_f32 v232,s43,v234
v_fmac_f32 v237,4.0,v233
M a[76:79],a[244:247],a[196:199],a[76:79]
v_fma_f32 v238,-4.0,v234,v236
v_fmac_f32 v232,s45,v236
M a[80:83],a[244:247],a[236:239],a[80:83]
v_fmac_f32 v237,s41,v235
v_sub_f32 v236,v236,v234
M a[80:83],a[204:207],a[252:255],a[80:83]
buffer_load_dwordx4 v[216:219],v250,s[20:23],s46 offen offset:0 sc1
M a[80:83],a[216:219],a[192:195],a[80:83]
v_fma_f32 v234,-4.0,v233,v235
v_sub_f32 v235,v235,v233
M a[84:87],a[216:219],a[232:235],a[84:87]
v_add_f32 v233,v238,v234
v_sub_f32 v238,v238,v234
M a[84:87],a[204:207],a[192:195],a[84:87]
ds_read_b128 a[196:199],v248 offset:8704
v_fma_f32 v234,2.0,v235,v236
M a[84:87],a[244:247],a[252:255],a[84:87]
buffer_load_dwordx2 v[192:193],v245,s[12:15],s28 offen offset:0
M a[88:91],a[244:247],a[192:195],a[88:91]
ds_read_b128 a[236:239],v249 offset:8704
ds_read_b128 a[252:255],v248 offset:9216
M a[88:91],a[204:207],a[232:235],a[88:91]
ds_read_b128 a[192:195],v249 offset:9216
v_fmac_f32 v236,-2.0,v235
M a[88:91],a[216:219],a[208:211],a[88:91]
v_and_b32 v208,s42,v208
v_and_b32 v204,s42,v204
M a[92:95],a[216:219],v[228:231],a[92:95]
buffer_load_dwordx2 v[202:203],v245,s[16:19],s28 offen offset:1536
M a[92:95],a[204:207],a[208:211],a[92:95]
v_and_b32 v206,s42,v206
v_and_b32 v214,s42,v214
M a[92:95],a[244:247],a[232:235],a[92:95]
s_waitcnt lgkmcnt(3)
v_and_b32 v212,s42,v212
v_and_b32 v210,s42,v210
M a[96:99],a[224:227],a[196:199],a[96:99]
s_waitcnt vmcnt(10) lgkmcnt(2)
ds_read_b128 a[216:219],v248 offset:9728
v_fmac_f32 v204,s43,v208
M a[96:99],a[240:243],a[236:239],a[96:99]
s_waitcnt vmcnt(9) lgkmcnt(2)
buffer_load_dwordx2 v[194:195],v245,s[8:11],s28 offen offset:0
M a[96:99],a[248:251],a[252:255],a[96:99]
s_waitcnt lgkmcnt(1)
ds_read_b128 v[228:231],v249 offset:9728
v_fmac_f32 v214,4.0,v206
M a[100:103],a[248:251],a[192:195],a[100:103]
v_fma_f32 v235,-4.0,v208,v212
v_fmac_f32 v204,s45,v212
M a[100:103],a[240:243],a[252:255],a[100:103]
v_fmac_f32 v214,s41,v210
v_sub_f32 v212,v212,v208
M a[100:103],a[224:227],a[236:239],a[100:103]
buffer_load_dwordx2 v[196:197],v245,s[8:11],s28 offen offset:384
M a[104:107],a[224:227],a[252:255],a[104:107]
ds_read_b128 a[204:207],v248 offset:10240
v_fma_f32 v208,-4.0,v206,v210
M a[104:107],a[240:243],a[192:195],a[104:107]
s_waitcnt lgkmcnt(2)
ds_read_b128 a[208:211],v249 offset:10240
v_sub_f32 v210,v210,v206
M a[104:107],a[248:251],a[216:219],a[104:107]
s_waitcnt lgkmcnt(2)
v_add_f32 v206,v235,v208
v_sub_f32 v235,v235,v208
M a[108:111],a[248:251],v[228:231],a[108:111]
buffer_load_dwordx2 v[198:199],v245,s[8:11],s28 offen offset:768
M a[108:111],a[240:243],a[216:219],a[108:111]
v_fma_f32 v208,2.0,v210,v212
v_fmac_f32 v212,-2.0,v210
M a[108:111],a[224:227],a[192:195],a[108:111]
v_cvt_pk_bf16_f32 v204,v232,v204
v_cvt_pk_bf16_f32 v214,v237,v214
M a[112:115],a[224:227],a[216:219],a[112:115]
ds_read_b128 a[232:235],v249 offset:10752
v_cvt_pk_bf16_f32 v206,v233,v206
M a[112:115],a[240:243],v[228:231],a[112:115]
s_waitcnt lgkmcnt(2)
buffer_load_dwordx2 v[200:201],v245,s[8:11],s28 offen offset:1152
M a[112:115],a[248:251],a[204:207],a[112:115]
s_waitcnt lgkmcnt(1)
ds_read_b128 a[244:247],v248 offset:10752
v_cvt_pk_bf16_f32 v210,v234,v208
M a[116:119],a[248:251],a[208:211],a[116:119]
v_cvt_pk_bf16_f32 v208,v238,v235
v_cvt_pk_bf16_f32 v212,v236,v212
M a[116:119],a[240:243],a[204:207],a[116:119]
v_lshlrev_b32 v234,16,v209
v_lshlrev_b32 v232,16,v205
M a[116:119],a[224:227],v[228:231],a[116:119]
v_lshlrev_b32 v233,16,v207
v_lshlrev_b32 v237,16,v215
M a[120:123],a[224:227],a[204:207],a[120:123]
v_lshlrev_b32 v236,16,v213
v_lshlrev_b32 v235,16,v211
M a[120:123],a[240:243],a[208:211],a[120:123]
s_waitcnt lgkmcnt(1)
v_fmac_f32 v232,s43,v234
v_fmac_f32 v237,4.0,v233
M a[120:123],a[248:251],a[232:235],a[120:123]
s_waitcnt lgkmcnt(0)
v_fma_f32 v238,-4.0,v234,v236
v_fmac_f32 v232,s45,v236
M a[124:127],a[248:251],a[244:247],a[124:127]
buffer_load_dwordx4 a[248:251],v250,s[20:23],s46 offen offset:1024 sc1
M a[124:127],a[240:243],a[232:235],a[124:127]
v_fmac_f32 v237,s41,v235
v_sub_f32 v236,v236,v234
M a[124:127],a[224:227],a[208:211],a[124:127]
s_waitcnt vmcnt(13)
buffer_load_dwordx4 a[240:243],v250,s[20:23],s46 offen offset:2048 sc1
M a[128:131],v[220:223],a[196:199],a[128:131]
s_waitcnt vmcnt(13)
s_add_u32 s47,s74,30720
v_fma_f32 v234,-4.0,v233,v235
v_sub_f32 v235,v235,v233
M a[128:131],a[200:203],a[236:239],a[128:131]
s_waitcnt vmcnt(12)
v_add_f32 v233,v238,v234
v_sub_f32 v238,v238,v234
M a[128:131],a[220:223],a[252:255],a[128:131]
v_fma_f32 v234,2.0,v235,v236
v_fmac_f32 v236,-2.0,v235
M a[132:135],a[220:223],a[192:195],a[132:135]
buffer_load_dwordx4 a[224:227],v250,s[20:23],s47 offen offset:0 sc1
M a[132:135],a[200:203],a[252:255],a[132:135]
v_and_b32 v209,s42,v209
v_and_b32 v205,s42,v205
M a[132:135],v[220:223],a[236:239],a[132:135]
v_and_b32 v207,s42,v207
v_and_b32 v215,s42,v215
M a[136:139],v[220:223],a[252:255],a[136:139]
v_and_b32 v213,s42,v213
v_and_b32 v211,s42,v211
M a[136:139],a[200:203],a[192:195],a[136:139]
v_fmac_f32 v205,s43,v209
v_fmac_f32 v215,4.0,v207
M a[136:139],a[220:223],a[216:219],a[136:139]
v_fma_f32 v235,-4.0,v209,v213
v_fmac_f32 v205,s45,v213
M a[140:143],a[220:223],v[228:231],a[140:143]
v_fmac_f32 v215,s41,v211
v_sub_f32 v213,v213,v209
M a[140:143],a[200:203],a[216:219],a[140:143]
v_fma_f32 v209,-4.0,v207,v211
v_sub_f32 v211,v211,v207
M a[140:143],v[220:223],a[192:195],a[140:143]
v_add_f32 v207,v235,v209
v_sub_f32 v235,v235,v209
M a[144:147],v[220:223],a[216:219],a[144:147]
v_fma_f32 v209,2.0,v211,v213
v_fmac_f32 v213,-2.0,v211
M a[144:147],a[200:203],v[228:231],a[144:147]
v_cvt_pk_bf16_f32 v205,v232,v205
v_cvt_pk_bf16_f32 v215,v237,v215
M a[144:147],a[220:223],a[204:207],a[144:147]
v_cvt_pk_bf16_f32 v207,v233,v207
v_cvt_pk_bf16_f32 v211,v234,v209
M a[148:151],a[220:223],a[208:211],a[148:151]
v_cvt_pk_bf16_f32 v209,v238,v235
v_cvt_pk_bf16_f32 v213,v236,v213
M a[148:151],a[200:203],a[204:207],a[148:151]
v_add_u32 v238,121856,v247
v_fmac_f32 v239,s43,v241
M a[148:151],v[220:223],v[228:231],a[148:151]
ds_write2st64_b64 v238,v[204:205],v[214:215] offset0:1 offset1:18
M a[152:155],v[220:223],a[204:207],a[152:155]
s_add_u32 s28,s69,7471104
buffer_load_dwordx2 v[204:205],v245,s[12:15],s28 offen offset:0
M a[152:155],a[200:203],a[208:211],a[152:155]
v_fmac_f32 v244,4.0,v240
v_fma_f32 v232,-4.0,v241,v243
M a[152:155],a[220:223],a[232:235],a[152:155]
buffer_load_dwordx2 v[214:215],v245,s[16:19],s28 offen offset:1536
M a[156:159],a[220:223],a[244:247],a[156:159]
v_fmac_f32 v239,s45,v243
v_fmac_f32 v244,s41,v242
M a[156:159],a[200:203],a[232:235],a[156:159]
v_sub_f32 v243,v243,v241
v_fma_f32 v241,-4.0,v240,v242
M a[156:159],v[220:223],a[208:211],a[156:159]
s_waitcnt vmcnt(14)
ds_write2st64_b64 v247,v[206:207],v[208:209] offset0:1 offset1:18
M a[160:163],v[224:227],a[196:199],a[160:163]
s_waitcnt vmcnt(13)
buffer_load_dwordx4 a[220:223],v250,s[20:23],s47 offen offset:1024 sc1
M a[160:163],a[212:215],a[236:239],a[160:163]
s_waitcnt vmcnt(13)
v_sub_f32 v242,v242,v240
v_add_f32 v240,v232,v241
M a[160:163],a[228:231],a[252:255],a[160:163]
ds_write2st64_b64 v247,v[210:211],v[212:213] offset0:137 offset1:154
M a[164:167],a[228:231],a[192:195],a[164:167]
buffer_load_dwordx4 a[200:203],v250,s[20:23],s47 offen offset:2048 sc1
M a[164:167],a[212:215],a[252:255],a[164:167]
s_add_u32 s48,s74,33792
v_sub_f32 v232,v232,v241
v_fma_f32 v241,2.0,v242,v243
M a[164:167],v[224:227],a[236:239],a[164:167]
v_fmac_f32 v243,-2.0,v242
v_cvt_pk_bf16_f32 v233,v239,v244
M a[168:171],v[224:227],a[252:255],a[168:171]
v_cvt_pk_bf16_f32 v234,v240,v232
v_cvt_pk_bf16_f32 v235,v241,v243
M a[168:171],a[212:215],a[192:195],a[168:171]
buffer_load_dwordx4 v[220:223],v250,s[20:23],s48 offen offset:0 sc1
M a[168:171],a[228:231],a[216:219],a[168:171]
v_add_u32 v232,121856,v252
M a[172:175],a[228:231],v[228:231],a[172:175]
ds_write_b16 v232,v233 offset:0
M a[172:175],a[212:215],a[216:219],a[172:175]
ds_write_b16_d16_hi v232,v233 offset:8704
M a[172:175],v[224:227],a[192:195],a[172:175]
buffer_load_dwordx4 a[196:199],v250,s[20:23],s48 offen offset:1024 sc1
M a[176:179],v[224:227],a[216:219],a[176:179]
ds_write_b16 v252,v234 offset:0
M a[176:179],a[212:215],v[228:231],a[176:179]
ds_write_b16_d16_hi v252,v234 offset:8704
M a[176:179],a[228:231],a[204:207],a[176:179]
v_add_u32 v232,69632,v252
M a[180:183],a[228:231],a[208:211],a[180:183]
buffer_load_dwordx4 a[236:239],v250,s[20:23],s48 offen offset:2048 sc1
M a[180:183],a[212:215],a[204:207],a[180:183]
s_add_u32 s46,s74,36864
ds_read_b128 a[192:195],v248 offset:17408
ds_write_b16 v232,v235 offset:0
M a[180:183],v[224:227],v[228:231],a[180:183]
ds_read_b128 a[216:219],v249 offset:17408
ds_write_b16_d16_hi v232,v235 offset:8704
M a[184:187],v[224:227],a[204:207],a[184:187]
buffer_load_dwordx4 a[252:255],v250,s[20:23],s46 offen offset:0 sc1
M a[184:187],a[212:215],a[208:211],a[184:187]
ds_read_b128 v[228:231],v248 offset:17920
ds_read_b128 a[204:207],v249 offset:17920
M a[184:187],a[228:231],a[232:235],a[184:187]
s_waitcnt vmcnt(13)
v_lshlrev_b32 v234,16,v196
v_lshlrev_b32 v232,16,v192
M a[188:191],a[228:231],a[244:247],a[188:191]
v_lshlrev_b32 v233,16,v194
v_lshlrev_b32 v237,16,v202
M a[188:191],a[212:215],a[232:235],a[188:191]
buffer_load_dwordx2 v[206:207],v245,s[8:11],s28 offen offset:0
M a[188:191],v[224:227],a[208:211],a[188:191]
s_waitcnt vmcnt(12) lgkmcnt(5)
v_lshlrev_b32 v236,16,v200
v_lshlrev_b32 v235,16,v198
M v[0:3],v[216:219],a[192:195],v[0:3]
s_waitcnt vmcnt(11) lgkmcnt(3)
ds_read_b128 a[228:231],v248 offset:18432
v_fmac_f32 v232,s43,v234
M v[0:3],a[248:251],a[216:219],v[0:3]
s_waitcnt vmcnt(10) lgkmcnt(2)
ds_read_b128 a[244:247],v249 offset:18432
v_fmac_f32 v237,4.0,v233
M v[0:3],a[240:243],v[228:231],v[0:3]
s_waitcnt lgkmcnt(2)
buffer_load_dwordx2 v[208:209],v245,s[8:11],s28 offen offset:384
M v[4:7],a[240:243],a[204:207],v[4:7]
v_fma_f32 v238,-4.0,v234,v236
v_fmac_f32 v232,s45,v236
M v[4:7],a[248:251],v[228:231],v[4:7]
v_fmac_f32 v237,s41,v235
v_sub_f32 v236,v236,v234
M v[4:7],v[216:219],a[216:219],v[4:7]
v_fma_f32 v234,-4.0,v233,v235
v_sub_f32 v235,v235,v233
M v[8:11],v[216:219],v[228:231],v[8:11]
buffer_load_dwordx2 v[210:211],v245,s[8:11],s28 offen offset:768
M v[8:11],a[248:251],a[204:207],v[8:11]
s_waitcnt lgkmcnt(1)
ds_read_b128 a[212:215],v248 offset:18944
ds_read_b128 a[232:235],v249 offset:18944
M v[8:11],a[240:243],a[228:231],v[8:11]
s_waitcnt lgkmcnt(2)
v_add_f32 v233,v238,v234
v_sub_f32 v238,v238,v234
M v[12:15],a[240:243],a[244:247],v[12:15]
v_fma_f32 v234,2.0,v235,v236
v_fmac_f32 v236,-2.0,v235
M v[12:15],a[248:251],a[228:231],v[12:15]
buffer_load_dwordx2 v[212:213],v245,s[8:11],s28 offen offset:1152
M v[12:15],v[216:219],a[204:207],v[12:15]
s_add_u32 s29,s70,6291456
v_and_b32 v196,s42,v196
v_and_b32 v192,s42,v192
M v[16:19],v[216:219],a[228:231],v[16:19]
ds_read_b128 a[208:211],v249 offset:19456
v_and_b32 v194,s42,v194
M v[16:19],a[248:251],a[244:247],v[16:19]
s_waitcnt lgkmcnt(2)
ds_read_b128 v[224:227],v248 offset:19456
v_and_b32 v202,s42,v202
M v[16:19],a[240:243],a[212:215],v[16:19]
s_waitcnt lgkmcnt(2)
buffer_load_short_d16_hi v239,v246,s[12:15],s29 offen offset:0
M v[20:23],a[240:243],a[232:235],v[20:23]
v_and_b32 v200,s42,v200
v_and_b32 v198,s42,v198
M v[20:23],a[248:251],a[212:215],v[20:23]
buffer_load_short_d16_hi v240,v246,s[8:11],s29 offen offset:0
M v[20:23],v[216:219],a[244:247],v[20:23]
v_fmac_f32 v192,s43,v196
v_fmac_f32 v202,4.0,v194
M v[24:27],v[216:219],a[212:215],v[24:27]
buffer_load_short_d16_hi v241,v246,s[8:11],s29 offen offset:384
M v[24:27],a[248:251],a[232:235],v[24:27]
s_waitcnt lgkmcnt(1)
v_fma_f32 v235,-4.0,v196,v200
v_fmac_f32 v192,s45,v200
M v[24:27],a[240:243],a[208:211],v[24:27]
s_waitcnt lgkmcnt(0)
buffer_load_short_d16_hi v242,v246,s[8:11],s29 offen offset:768
M v[28:31],a[240:243],v[224:227],v[28:31]
v_fmac_f32 v202,s41,v198
v_sub_f32 v200,v200,v196
M v[28:31],a[248:251],a[208:211],v[28:31]
buffer_load_short_d16_hi v243,v246,s[8:11],s29 offen offset:1152
M v[28:31],v[216:219],a[232:235],v[28:31]
s_waitcnt vmcnt(17)
v_fma_f32 v196,-4.0,v194,v198
v_sub_f32 v198,v198,v194
M v[32:35],a[224:227],a[192:195],v[32:35]
s_waitcnt vmcnt(14)
buffer_load_short_d16_hi v244,v246,s[16:19],s29 offen offset:1536
M v[32:35],a[220:223],a[216:219],v[32:35]
s_waitcnt vmcnt(14)
v_add_f32 v194,v235,v196
v_sub_f32 v235,v235,v196
M v[32:35],a[200:203],v[228:231],v[32:35]
global_load_dword a240,v250,s[64:65]
M v[36:39],a[200:203],a[204:207],v[36:39]
v_fma_f32 v196,2.0,v198,v200
v_fmac_f32 v200,-2.0,v198
M v[36:39],a[220:223],v[228:231],v[36:39]
buffer_load_dwordx4 a[240:243],v250,s[20:23],s46 offen offset:1024 sc1
M v[36:39],a[224:227],a[216:219],v[36:39]
v_cvt_pk_bf16_f32 v192,v232,v192
v_cvt_pk_bf16_f32 v202,v237,v202
M v[40:43],a[224:227],v[228:231],v[40:43]
v_cvt_pk_bf16_f32 v194,v233,v194
v_cvt_pk_bf16_f32 v198,v234,v196
M v[40:43],a[220:223],a[204:207],v[40:43]
v_cvt_pk_bf16_f32 v196,v238,v235
v_cvt_pk_bf16_f32 v200,v236,v200
M v[40:43],a[200:203],a[228:231],v[40:43]
buffer_load_dwordx4 a[248:251],v250,s[20:23],s46 offen offset:2048 sc1
M v[44:47],a[200:203],a[244:247],v[44:47]
s_add_u32 s47,s74,39936
v_lshlrev_b32 v234,16,v197
v_lshlrev_b32 v232,16,v193
M v[44:47],a[220:223],a[228:231],v[44:47]
v_lshlrev_b32 v233,16,v195
v_lshlrev_b32 v237,16,v203
M v[44:47],a[224:227],a[204:207],v[44:47]
v_lshlrev_b32 v236,16,v201
v_lshlrev_b32 v235,16,v199
M v[48:51],a[224:227],a[228:231],v[48:51]
buffer_load_dwordx4 v[216:219],v250,s[20:23],s47 offen offset:0 sc1
M v[48:51],a[220:223],a[244:247],v[48:51]
v_fmac_f32 v232,s43,v234
v_fmac_f32 v237,4.0,v233
M v[48:51],a[200:203],a[212:215],v[48:51]
v_fma_f32 v238,-4.0,v234,v236
v_fmac_f32 v232,s45,v236
M v[52:55],a[200:203],a[232:235],v[52:55]
v_fmac_f32 v237,s41,v235
v_sub_f32 v236,v236,v234
M v[52:55],a[220:223],a[212:215],v[52:55]
v_fma_f32 v234,-4.0,v233,v235
v_sub_f32 v235,v235,v233
M v[52:55],a[224:227],a[244:247],v[52:55]
v_add_f32 v233,v238,v234
v_sub_f32 v238,v238,v234
M v[56:59],a[224:227],a[212:215],v[56:59]
v_fma_f32 v234,2.0,v235,v236
v_fmac_f32 v236,-2.0,v235
M v[56:59],a[220:223],a[232:235],v[56:59]
v_and_b32 v197,s42,v197
v_and_b32 v193,s42,v193
M v[56:59],a[200:203],a[208:211],v[56:59]
v_and_b32 v195,s42,v195
v_and_b32 v203,s42,v203
M v[60:63],a[200:203],v[224:227],v[60:63]
buffer_load_dwordx4 a[200:203],v250,s[20:23],s47 offen offset:1024 sc1
M v[60:63],a[220:223],a[208:211],v[60:63]
v_and_b32 v201,s42,v201
v_and_b32 v199,s42,v199
M v[60:63],a[224:227],a[232:235],v[60:63]
s_waitcnt vmcnt(18)
buffer_load_dwordx4 a[220:223],v250,s[20:23],s47 offen offset:2048 sc1
M v[64:67],v[220:223],a[192:195],v[64:67]
s_waitcnt vmcnt(18)
s_add_u32 s48,s74,43008
v_fmac_f32 v193,s43,v197
v_fmac_f32 v203,4.0,v195
M v[64:67],a[196:199],a[216:219],v[64:67]
s_waitcnt vmcnt(17)
v_fma_f32 v235,-4.0,v197,v201
v_fmac_f32 v193,s45,v201
M v[64:67],a[236:239],v[228:231],v[64:67]
v_fmac_f32 v203,s41,v199
v_sub_f32 v201,v201,v197
M v[68:71],a[236:239],a[204:207],v[68:71]
buffer_load_dwordx4 a[224:227],v250,s[20:23],s48 offen offset:0 sc1
M v[68:71],a[196:199],v[228:231],v[68:71]
v_fma_f32 v197,-4.0,v195,v199
v_sub_f32 v199,v199,v195
M v[68:71],v[220:223],a[216:219],v[68:71]
v_add_f32 v195,v235,v197
v_sub_f32 v235,v235,v197
M v[72:75],v[220:223],v[228:231],v[72:75]
v_fma_f32 v197,2.0,v199,v201
v_fmac_f32 v201,-2.0,v199
M v[72:75],a[196:199],a[204:207],v[72:75]
buffer_load_dwordx4 a[192:195],v250,s[20:23],s48 offen offset:1024 sc1
M v[72:75],a[236:239],a[228:231],v[72:75]
v_cvt_pk_bf16_f32 v193,v232,v193
v_cvt_pk_bf16_f32 v203,v237,v203
M v[76:79],a[236:239],a[244:247],v[76:79]
v_cvt_pk_bf16_f32 v195,v233,v195
v_cvt_pk_bf16_f32 v199,v234,v197
M v[76:79],a[196:199],a[228:231],v[76:79]
v_cvt_pk_bf16_f32 v197,v238,v235
v_cvt_pk_bf16_f32 v201,v236,v201
M v[76:79],v[220:223],a[204:207],v[76:79]
buffer_load_dwordx4 a[216:219],v250,s[20:23],s48 offen offset:2048 sc1
M v[80:83],v[220:223],a[228:231],v[80:83]
s_waitcnt vmcnt(17)
s_add_u32 s46,s75,9216
v_add_u32 v238,121856,v247
v_lshlrev_b32 v234,16,v208
M v[80:83],a[196:199],a[244:247],v[80:83]
v_lshlrev_b32 v232,16,v204
v_lshlrev_b32 v233,16,v206
M v[80:83],a[236:239],a[212:215],v[80:83]
ds_write2st64_b64 v238,v[192:193],v[202:203] offset0:2 offset1:19
M v[84:87],a[236:239],a[232:235],v[84:87]
s_add_u32 s28,s70,6291456
buffer_load_dwordx4 v[228:231],v250,s[20:23],s46 offen offset:0 sc1
M v[84:87],a[196:199],a[212:215],v[84:87]
ds_read_b128 a[204:207],v248 offset:26112
v_lshlrev_b32 v237,16,v214
M v[84:87],v[220:223],a[244:247],v[84:87]
ds_write2st64_b64 v247,v[194:195],v[196:197] offset0:2 offset1:19
M v[88:91],v[220:223],a[212:215],v[88:91]
buffer_load_dwordx2 v[192:193],v245,s[12:15],s28 offen offset:0
M v[88:91],a[196:199],a[232:235],v[88:91]
ds_read_b128 a[228:231],v249 offset:26112
ds_read_b128 a[244:247],v248 offset:26624
M v[88:91],a[236:239],a[208:211],v[88:91]
ds_write2st64_b64 v247,v[198:199],v[200:201] offset0:138 offset1:155
M v[92:95],a[236:239],v[224:227],v[92:95]
buffer_load_dwordx2 v[202:203],v245,s[16:19],s28 offen offset:1536
M v[92:95],a[196:199],a[208:211],v[92:95]
s_waitcnt vmcnt(18)
ds_read_b128 a[212:215],v249 offset:26624
v_lshlrev_b32 v236,16,v212
M v[92:95],v[220:223],a[232:235],v[92:95]
s_waitcnt lgkmcnt(5)
v_lshlrev_b32 v235,16,v210
v_fmac_f32 v232,s43,v234
M v[96:99],a[252:255],a[204:207],v[96:99]
s_waitcnt vmcnt(10) lgkmcnt(3)
ds_read_b128 a[236:239],v248 offset:27136
v_fmac_f32 v237,4.0,v233
M v[96:99],a[240:243],a[228:231],v[96:99]
s_waitcnt vmcnt(9) lgkmcnt(3)
buffer_load_dwordx2 v[194:195],v245,s[8:11],s28 offen offset:0
M v[96:99],a[248:251],a[244:247],v[96:99]
s_waitcnt lgkmcnt(1)
ds_read_b128 v[224:227],v249 offset:27136
v_fma_f32 v238,-4.0,v234,v236
M v[100:103],a[248:251],a[212:215],v[100:103]
v_fmac_f32 v232,s45,v236
v_fmac_f32 v237,s41,v235
M v[100:103],a[240:243],a[244:247],v[100:103]
v_sub_f32 v236,v236,v234
v_fma_f32 v234,-4.0,v233,v235
M v[100:103],a[252:255],a[228:231],v[100:103]
buffer_load_dwordx2 v[196:197],v245,s[8:11],s28 offen offset:384
M v[104:107],a[252:255],a[244:247],v[104:107]
ds_read_b128 a[196:199],v248 offset:27648
v_sub_f32 v235,v235,v233
M v[104:107],a[240:243],a[212:215],v[104:107]
s_waitcnt lgkmcnt(2)
ds_read_b128 a[208:211],v249 offset:27648
v_add_f32 v233,v238,v234
M v[104:107],a[248:251],a[236:239],v[104:107]
s_waitcnt lgkmcnt(2)
v_sub_f32 v238,v238,v234
v_fma_f32 v234,2.0,v235,v236
M v[108:111],a[248:251],v[224:227],v[108:111]
buffer_load_dwordx2 v[198:199],v245,s[8:11],s28 offen offset:768
M v[108:111],a[240:243],a[236:239],v[108:111]
v_fmac_f32 v236,-2.0,v235
v_and_b32 v208,s42,v208
M v[108:111],a[252:255],a[212:215],v[108:111]
v_and_b32 v204,s42,v204
v_and_b32 v206,s42,v206
M v[112:115],a[252:255],a[236:239],v[112:115]
ds_read_b128 a[232:235],v249 offset:28160
v_and_b32 v214,s42,v214
M v[112:115],a[240:243],v[224:227],v[112:115]
s_waitcnt lgkmcnt(2)
buffer_load_dwordx2 v[200:201],v245,s[8:11],s28 offen offset:1152
M v[112:115],a[248:251],a[196:199],v[112:115]
s_waitcnt lgkmcnt(1)
ds_read_b128 v[220:223],v248 offset:28160
v_and_b32 v212,s42,v212
M v[116:119],a[248:251],a[208:211],v[116:119]
v_and_b32 v210,s42,v210
v_fmac_f32 v204,s43,v208
M v[116:119],a[240:243],a[196:199],v[116:119]
v_fmac_f32 v214,4.0,v206
v_fma_f32 v235,-4.0,v208,v212
M v[116:119],a[252:255],v[224:227],v[116:119]
v_fmac_f32 v204,s45,v212
v_fmac_f32 v214,s41,v210
M v[120:123],a[252:255],a[196:199],v[120:123]
v_sub_f32 v212,v212,v208
v_fma_f32 v208,-4.0,v206,v210
M v[120:123],a[240:243],a[208:211],v[120:123]
s_waitcnt lgkmcnt(1)
v_sub_f32 v210,v210,v206
v_add_f32 v206,v235,v208
M v[120:123],a[248:251],a[232:235],v[120:123]
s_waitcnt lgkmcnt(0)
v_sub_f32 v235,v235,v208
v_fma_f32 v208,2.0,v210,v212
M v[124:127],a[248:251],v[220:223],v[124:127]
buffer_load_dwordx4 a[248:251],v250,s[20:23],s46 offen offset:1024 sc1
M v[124:127],a[240:243],a[232:235],v[124:127]
v_fmac_f32 v212,-2.0,v210
v_cvt_pk_bf16_f32 v204,v232,v204
M v[124:127],a[252:255],a[208:211],v[124:127]
s_waitcnt vmcnt(13)
buffer_load_dwordx4 a[240:243],v250,s[20:23],s46 offen offset:2048 sc1
M v[128:131],v[216:219],a[204:207],v[128:131]
s_waitcnt vmcnt(13)
s_add_u32 s47,s75,12288
v_cvt_pk_bf16_f32 v214,v237,v214
v_cvt_pk_bf16_f32 v206,v233,v206
M v[128:131],a[200:203],a[228:231],v[128:131]
s_waitcnt vmcnt(12)
v_cvt_pk_bf16_f32 v210,v234,v208
v_cvt_pk_bf16_f32 v208,v238,v235
M v[128:131],a[220:223],a[244:247],v[128:131]
v_cvt_pk_bf16_f32 v212,v236,v212
v_lshlrev_b32 v234,16,v209
M v[132:135],a[220:223],a[212:215],v[132:135]
buffer_load_dwordx4 a[252:255],v250,s[20:23],s47 offen offset:0 sc1
M v[132:135],a[200:203],a[244:247],v[132:135]
v_lshlrev_b32 v232,16,v205
v_lshlrev_b32 v233,16,v207
M v[132:135],v[216:219],a[228:231],v[132:135]
v_lshlrev_b32 v237,16,v215
v_lshlrev_b32 v236,16,v213
M v[136:139],v[216:219],a[244:247],v[136:139]
v_lshlrev_b32 v235,16,v211
v_fmac_f32 v232,s43,v234
M v[136:139],a[200:203],a[212:215],v[136:139]
v_fmac_f32 v237,4.0,v233
v_fma_f32 v238,-4.0,v234,v236
M v[136:139],a[220:223],a[236:239],v[136:139]
v_fmac_f32 v232,s45,v236
v_fmac_f32 v237,s41,v235
M v[140:143],a[220:223],v[224:227],v[140:143]
v_sub_f32 v236,v236,v234
v_fma_f32 v234,-4.0,v233,v235
M v[140:143],a[200:203],a[236:239],v[140:143]
v_sub_f32 v235,v235,v233
v_add_f32 v233,v238,v234
M v[140:143],v[216:219],a[212:215],v[140:143]
v_sub_f32 v238,v238,v234
v_fma_f32 v234,2.0,v235,v236
M v[144:147],v[216:219],a[236:239],v[144:147]
v_fmac_f32 v236,-2.0,v235
v_and_b32 v209,s42,v209
M v[144:147],a[200:203],v[224:227],v[144:147]
v_and_b32 v205,s42,v205
v_and_b32 v207,s42,v207
M v[144:147],a[220:223],a[196:199],v[144:147]
v_and_b32 v215,s42,v215
v_and_b32 v213,s42,v213
M v[148:151],a[220:223],a[208:211],v[148:151]
v_and_b32 v211,s42,v211
v_fmac_f32 v205,s43,v209
M v[148:151],a[200:203],a[196:199],v[148:151]
v_fmac_f32 v215,4.0,v207
v_fma_f32 v235,-4.0,v209,v213
M v[148:151],v[216:219],v[224:227],v[148:151]
v_fmac_f32 v205,s45,v213
v_fmac_f32 v215,s41,v211
M v[152:155],v[216:219],a[196:199],v[152:155]
v_sub_f32 v213,v213,v209
v_fma_f32 v209,-4.0,v207,v211
M v[152:155],a[200:203],a[208:211],v[152:155]
v_sub_f32 v211,v211,v207
v_add_f32 v207,v235,v209
M v[152:155],a[220:223],a[232:235],v[152:155]
v_sub_f32 v235,v235,v209
v_fma_f32 v209,2.0,v211,v213
M v[156:159],a[220:223],v[220:223],v[156:159]
buffer_load_dwordx4 a[220:223],v250,s[20:23],s47 offen offset:1024 sc1
M v[156:159],a[200:203],a[232:235],v[156:159]
v_fmac_f32 v213,-2.0,v211
v_cvt_pk_bf16_f32 v205,v232,v205
M v[156:159],v[216:219],a[208:211],v[156:159]
s_waitcnt vmcnt(13)
buffer_load_dwordx4 a[200:203],v250,s[20:23],s47 offen offset:2048 sc1
M v[160:163],a[224:227],a[204:207],v[160:163]
s_waitcnt vmcnt(13)
s_add_u32 s48,s75,15360
v_cvt_pk_bf16_f32 v215,v237,v215
v_cvt_pk_bf16_f32 v207,v233,v207
M v[160:163],a[192:195],a[228:231],v[160:163]
s_waitcnt vmcnt(12)
v_cvt_pk_bf16_f32 v211,v234,v209
v_cvt_pk_bf16_f32 v209,v238,v235
M v[160:163],a[216:219],a[244:247],v[160:163]
v_cvt_pk_bf16_f32 v213,v236,v213
v_add_u32 v238,121856,v247
M v[164:167],a[216:219],a[212:215],v[164:167]
buffer_load_dwordx4 v[216:219],v250,s[20:23],s48 offen offset:0 sc1
M v[164:167],a[192:195],a[244:247],v[164:167]
M v[164:167],a[224:227],a[228:231],v[164:167]
ds_write2st64_b64 v238,v[204:205],v[214:215] offset0:3 offset1:20
M v[168:171],a[224:227],a[244:247],v[168:171]
s_add_u32 s28,s70,6684672
M v[168:171],a[192:195],a[212:215],v[168:171]
buffer_load_dwordx4 a[204:207],v250,s[20:23],s48 offen offset:1024 sc1
M v[168:171],a[216:219],a[236:239],v[168:171]
ds_write2st64_b64 v247,v[206:207],v[208:209] offset0:3 offset1:20
M v[172:175],a[216:219],v[224:227],v[172:175]
M v[172:175],a[192:195],a[236:239],v[172:175]
buffer_load_dwordx4 a[228:231],v250,s[20:23],s48 offen offset:2048 sc1
M v[172:175],a[224:227],a[212:215],v[172:175]
s_add_u32 s46,s75,18432
ds_write2st64_b64 v247,v[210:211],v[212:213] offset0:139 offset1:156
M v[176:179],a[224:227],a[236:239],v[176:179]
M v[176:179],a[192:195],v[224:227],v[176:179]
buffer_load_dwordx4 a[244:247],v250,s[20:23],s46 offen offset:0 sc1
M v[176:179],a[216:219],a[196:199],v[176:179]
s_waitcnt lgkmcnt(0)
s_barrier
v_add_u32 v248,0xffffbc00,v248
M v[180:183],a[216:219],a[208:211],v[180:183]
v_add_u32 v249,0xffffbc00,v249
M v[180:183],a[192:195],a[196:199],v[180:183]
ds_read_b128 a[212:215],v248 offset:0
M v[180:183],a[224:227],v[224:227],v[180:183]
buffer_load_dwordx2 v[204:205],v245,s[12:15],s28 offen offset:0
M v[184:187],a[224:227],a[196:199],v[184:187]
ds_read_b128 a[236:239],v249 offset:0
ds_read_b128 v[224:227],v248 offset:512
M v[184:187],a[192:195],a[208:211],v[184:187]
ds_read_b128 a[196:199],v249 offset:512
M v[184:187],a[216:219],a[232:235],v[184:187]
M v[188:191],a[216:219],v[220:223],v[188:191]
buffer_load_dwordx2 v[214:215],v245,s[16:19],s28 offen offset:1536
M v[188:191],a[192:195],a[232:235],v[188:191]
M v[188:191],a[224:227],a[208:211],v[188:191]
s_waitcnt vmcnt(17) lgkmcnt(3)
M a[0:3],v[228:231],a[212:215],a[0:3]
s_waitcnt vmcnt(10) lgkmcnt(2)
ds_read_b128 a[216:219],v248 offset:1024
M a[0:3],a[248:251],a[236:239],a[0:3]
s_waitcnt vmcnt(9) lgkmcnt(2)
buffer_load_dwordx2 v[206:207],v245,s[8:11],s28 offen offset:0
M a[0:3],a[240:243],v[224:227],a[0:3]
s_waitcnt lgkmcnt(1)
ds_read_b128 v[220:223],v249 offset:1024
v_lshlrev_b32 v234,16,v196
M a[4:7],a[240:243],a[196:199],a[4:7]
v_lshlrev_b32 v232,16,v192
v_lshlrev_b32 v233,16,v194
M a[4:7],a[248:251],v[224:227],a[4:7]
v_lshlrev_b32 v237,16,v202
v_lshlrev_b32 v236,16,v200
M a[4:7],v[228:231],a[236:239],a[4:7]
buffer_load_dwordx2 v[208:209],v245,s[8:11],s28 offen offset:384
M a[8:11],v[228:231],v[224:227],a[8:11]
ds_read_b128 a[192:195],v248 offset:1536
v_lshlrev_b32 v235,16,v198
M a[8:11],a[248:251],a[196:199],a[8:11]
s_waitcnt lgkmcnt(2)
ds_read_b128 a[232:235],v249 offset:1536
v_fmac_f32 v232,s43,v234
M a[8:11],a[240:243],a[216:219],a[8:11]
s_waitcnt lgkmcnt(2)
v_fmac_f32 v237,4.0,v233
v_fma_f32 v238,-4.0,v234,v236
M a[12:15],a[240:243],v[220:223],a[12:15]
buffer_load_dwordx2 v[210:211],v245,s[8:11],s28 offen offset:768
M a[12:15],a[248:251],a[216:219],a[12:15]
v_fmac_f32 v232,s45,v236
v_fmac_f32 v237,s41,v235
M a[12:15],v[228:231],a[196:199],a[12:15]
v_sub_f32 v236,v236,v234
v_fma_f32 v234,-4.0,v233,v235
M a[16:19],v[228:231],a[216:219],a[16:19]
ds_read_b128 a[208:211],v249 offset:2048
v_sub_f32 v235,v235,v233
M a[16:19],a[248:251],v[220:223],a[16:19]
s_waitcnt lgkmcnt(2)
buffer_load_dwordx2 v[212:213],v245,s[8:11],s28 offen offset:1152
M a[16:19],a[240:243],a[192:195],a[16:19]
s_waitcnt lgkmcnt(1)
ds_read_b128 a[224:227],v248 offset:2048
v_add_f32 v233,v238,v234
M a[20:23],a[240:243],a[232:235],a[20:23]
v_sub_f32 v238,v238,v234
v_fma_f32 v234,2.0,v235,v236
M a[20:23],a[248:251],a[192:195],a[20:23]
v_fmac_f32 v236,-2.0,v235
v_and_b32 v196,s42,v196
M a[20:23],v[228:231],v[220:223],a[20:23]
v_and_b32 v192,s42,v192
v_and_b32 v194,s42,v194
M a[24:27],v[228:231],a[192:195],a[24:27]
v_and_b32 v202,s42,v202
v_and_b32 v200,s42,v200
M a[24:27],a[248:251],a[232:235],a[24:27]
s_waitcnt lgkmcnt(1)
v_and_b32 v198,s42,v198
v_fmac_f32 v192,s43,v196
M a[24:27],a[240:243],a[208:211],a[24:27]
s_waitcnt lgkmcnt(0)
v_fmac_f32 v202,4.0,v194
v_fma_f32 v235,-4.0,v196,v200
M a[28:31],a[240:243],a[224:227],a[28:31]
buffer_load_dwordx4 a[240:243],v250,s[20:23],s46 offen offset:1024 sc1
M a[28:31],a[248:251],a[208:211],a[28:31]
v_fmac_f32 v192,s45,v200
v_fmac_f32 v202,s41,v198
M a[28:31],v[228:231],a[232:235],a[28:31]
s_waitcnt vmcnt(13)
buffer_load_dwordx4 a[248:251],v250,s[20:23],s46 offen offset:2048 sc1
M a[32:35],a[252:255],a[212:215],a[32:35]
s_waitcnt vmcnt(13)
s_add_u32 s47,s75,21504
v_sub_f32 v200,v200,v196
v_fma_f32 v196,-4.0,v194,v198
M a[32:35],a[220:223],a[236:239],a[32:35]
s_waitcnt vmcnt(12)
v_sub_f32 v198,v198,v194
v_add_f32 v194,v235,v196
M a[32:35],a[200:203],v[224:227],a[32:35]
v_sub_f32 v235,v235,v196
v_fma_f32 v196,2.0,v198,v200
M a[36:39],a[200:203],a[196:199],a[36:39]
buffer_load_dwordx4 v[228:231],v250,s[20:23],s47 offen offset:0 sc1
M a[36:39],a[220:223],v[224:227],a[36:39]
v_fmac_f32 v200,-2.0,v198
v_cvt_pk_bf16_f32 v192,v232,v192
M a[36:39],a[252:255],a[236:239],a[36:39]
v_cvt_pk_bf16_f32 v202,v237,v202
v_cvt_pk_bf16_f32 v194,v233,v194
M a[40:43],a[252:255],v[224:227],a[40:43]
v_cvt_pk_bf16_f32 v198,v234,v196
v_cvt_pk_bf16_f32 v196,v238,v235
M a[40:43],a[220:223],a[196:199],a[40:43]
v_cvt_pk_bf16_f32 v200,v236,v200
v_lshlrev_b32 v234,16,v197
M a[40:43],a[200:203],a[216:219],a[40:43]
v_lshlrev_b32 v232,16,v193
v_lshlrev_b32 v233,16,v195
M a[44:47],a[200:203],v[220:223],a[44:47]
v_lshlrev_b32 v237,16,v203
v_lshlrev_b32 v236,16,v201
M a[44:47],a[220:223],a[216:219],a[44:47]
v_lshlrev_b32 v235,16,v199
v_fmac_f32 v232,s43,v234
M a[44:47],a[252:255],a[196:199],a[44:47]
v_fmac_f32 v237,4.0,v233
v_fma_f32 v238,-4.0,v234,v236
M a[48:51],a[252:255],a[216:219],a[48:51]
v_fmac_f32 v232,s45,v236
v_fmac_f32 v237,s41,v235
M a[48:51],a[220:223],v[220:223],a[48:51]
v_sub_f32 v236,v236,v234
v_fma_f32 v234,-4.0,v233,v235
M a[48:51],a[200:203],a[192:195],a[48:51]
v_sub_f32 v235,v235,v233
v_add_f32 v233,v238,v234
M a[52:55],a[200:203],a[232:235],a[52:55]
v_sub_f32 v238,v238,v234
v_fma_f32 v234,2.0,v235,v236
M a[52:55],a[220:223],a[192:195],a[52:55]
v_fmac_f32 v236,-2.0,v235
v_and_b32 v197,s42,v197
M a[52:55],a[252:255],v[220:223],a[52:55]
v_and_b32 v193,s42,v193
v_and_b32 v195,s42,v195
M a[56:59],a[252:255],a[192:195],a[56:59]
v_and_b32 v203,s42,v203
v_and_b32 v201,s42,v201
M a[56:59],a[220:223],a[232:235],a[56:59]
v_and_b32 v199,s42,v199
v_fmac_f32 v193,s43,v197
M a[56:59],a[200:203],a[208:211],a[56:59]
v_fmac_f32 v203,4.0,v195
v_fma_f32 v235,-4.0,v197,v201
M a[60:63],a[200:203],a[224:227],a[60:63]
buffer_load_dwordx4 a[200:203],v250,s[20:23],s47 offen offset:1024 sc1
M a[60:63],a[220:223],a[208:211],a[60:63]
v_fmac_f32 v193,s45,v201
v_fmac_f32 v203,s41,v199
M a[60:63],a[252:255],a[232:235],a[60:63]
s_waitcnt vmcnt(13)
buffer_load_dwordx4 a[220:223],v250,s[20:23],s47 offen offset:2048 sc1
M a[64:67],v[216:219],a[212:215],a[64:67]
s_waitcnt vmcnt(13)
s_add_u32 s48,s75,24576
v_sub_f32 v201,v201,v197
v_fma_f32 v197,-4.0,v195,v199
M a[64:67],a[204:207],a[236:239],a[64:67]
s_waitcnt vmcnt(12)
v_sub_f32 v199,v199,v195
v_add_f32 v195,v235,v197
M a[64:67],a[228:231],v[224:227],a[64:67]
v_sub_f32 v235,v235,v197
v_fma_f32 v197,2.0,v199,v201
M a[68:71],a[228:231],a[196:199],a[68:71]
buffer_load_dwordx4 a[252:255],v250,s[20:23],s48 offen offset:0 sc1
M a[68:71],a[204:207],v[224:227],a[68:71]
v_fmac_f32 v201,-2.0,v199
v_cvt_pk_bf16_f32 v193,v232,v193
M a[68:71],v[216:219],a[236:239],a[68:71]
v_cvt_pk_bf16_f32 v203,v237,v203
v_cvt_pk_bf16_f32 v195,v233,v195
M a[72:75],v[216:219],v[224:227],a[72:75]
v_cvt_pk_bf16_f32 v199,v234,v197
v_cvt_pk_bf16_f32 v197,v238,v235
M a[72:75],a[204:207],a[196:199],a[72:75]
buffer_load_dwordx4 a[212:215],v250,s[20:23],s48 offen offset:1024 sc1
M a[72:75],a[228:231],a[216:219],a[72:75]
v_cvt_pk_bf16_f32 v201,v236,v201
v_add_u32 v238,139264,v247
M a[76:79],a[228:231],v[220:223],a[76:79]
M a[76:79],a[204:207],a[216:219],a[76:79]
M a[76:79],v[216:219],a[196:199],a[76:79]
buffer_load_dwordx4 a[236:239],v250,s[20:23],s48 offen offset:2048 sc1
M a[80:83],v[216:219],a[216:219],a[80:83]
s_add_u32 s46,s75,27648
M a[80:83],a[204:207],v[220:223],a[80:83]
M a[80:83],a[228:231],a[192:195],a[80:83]
ds_write2st64_b64 v238,v[192:193],v[202:203] offset0:0 offset1:17
M a[84:87],a[228:231],a[232:235],a[84:87]
s_add_u32 s28,s70,7077888
buffer_load_dwordx4 v[224:227],v250,s[20:23],s46 offen offset:0 sc1
M a[84:87],a[204:207],a[192:195],a[84:87]
ds_read_b128 a[196:199],v248 offset:8704
M a[84:87],v[216:219],v[220:223],a[84:87]
ds_write2st64_b64 v247,v[194:195],v[196:197] offset0:34 offset1:51
M a[88:91],v[216:219],a[192:195],a[88:91]
buffer_load_dwordx2 v[192:193],v245,s[12:15],s28 offen offset:0
M a[88:91],a[204:207],a[232:235],a[88:91]
ds_read_b128 a[216:219],v249 offset:8704
ds_read_b128 v[220:223],v248 offset:9216
M a[88:91],a[228:231],a[208:211],a[88:91]
ds_write2st64_b64 v247,v[198:199],v[200:201] offset0:68 offset1:85
M a[92:95],a[228:231],a[224:227],a[92:95]
buffer_load_dwordx2 v[202:203],v245,s[16:19],s28 offen offset:1536
M a[92:95],a[204:207],a[208:211],a[92:95]
ds_read_b128 a[192:195],v249 offset:9216
M a[92:95],v[216:219],a[232:235],a[92:95]
s_waitcnt vmcnt(17) lgkmcnt(5)
M a[96:99],a[244:247],a[196:199],a[96:99]
s_waitcnt vmcnt(10) lgkmcnt(3)
ds_read_b128 a[224:227],v248 offset:9728
M a[96:99],a[240:243],a[216:219],a[96:99]
s_waitcnt vmcnt(9) lgkmcnt(3)
buffer_load_dwordx2 v[194:195],v245,s[8:11],s28 offen offset:0
M a[96:99],a[248:251],v[220:223],a[96:99]
s_waitcnt lgkmcnt(1)
ds_read_b128 a[228:231],v249 offset:9728
v_lshlrev_b32 v234,16,v208
M a[100:103],a[248:251],a[192:195],a[100:103]
v_lshlrev_b32 v232,16,v204
v_lshlrev_b32 v233,16,v206
M a[100:103],a[240:243],v[220:223],a[100:103]
v_lshlrev_b32 v237,16,v214
v_lshlrev_b32 v236,16,v212
M a[100:103],a[244:247],a[216:219],a[100:103]
buffer_load_dwordx2 v[196:197],v245,s[8:11],s28 offen offset:384
M a[104:107],a[244:247],v[220:223],a[104:107]
ds_read_b128 a[204:207],v248 offset:10240
v_lshlrev_b32 v235,16,v210
M a[104:107],a[240:243],a[192:195],a[104:107]
s_waitcnt lgkmcnt(2)
ds_read_b128 a[208:211],v249 offset:10240
v_fmac_f32 v232,s43,v234
M a[104:107],a[248:251],a[224:227],a[104:107]
s_waitcnt lgkmcnt(2)
v_fmac_f32 v237,4.0,v233
v_fma_f32 v238,-4.0,v234,v236
M a[108:111],a[248:251],a[228:231],a[108:111]
buffer_load_dwordx2 v[198:199],v245,s[8:11],s28 offen offset:768
M a[108:111],a[240:243],a[224:227],a[108:111]
v_fmac_f32 v232,s45,v236
v_fmac_f32 v237,s41,v235
M a[108:111],a[244:247],a[192:195],a[108:111]
v_sub_f32 v236,v236,v234
v_fma_f32 v234,-4.0,v233,v235
M a[112:115],a[244:247],a[224:227],a[112:115]
ds_read_b128 a[232:235],v249 offset:10752
v_sub_f32 v235,v235,v233
M a[112:115],a[240:243],a[228:231],a[112:115]
s_waitcnt lgkmcnt(2)
buffer_load_dwordx2 v[200:201],v245,s[8:11],s28 offen offset:1152
M a[112:115],a[248:251],a[204:207],a[112:115]
s_waitcnt lgkmcnt(1)
ds_read_b128 v[216:219],v248 offset:10752
v_add_f32 v233,v238,v234
M a[116:119],a[248:251],a[208:211],a[116:119]
v_sub_f32 v238,v238,v234
v_fma_f32 v234,2.0,v235,v236
M a[116:119],a[240:243],a[204:207],a[116:119]
v_fmac_f32 v236,-2.0,v235
v_and_b32 v208,s42,v208
M a[116:119],a[244:247],a[228:231],a[116:119]
v_and_b32 v204,s42,v204
v_and_b32 v206,s42,v206
M a[120:123],a[244:247],a[204:207],a[120:123]
v_and_b32 v214,s42,v214
v_and_b32 v212,s42,v212
M a[120:123],a[240:243],a[208:211],a[120:123]
s_waitcnt lgkmcnt(1)
v_and_b32 v210,s42,v210
v_fmac_f32 v204,s43,v208
M a[120:123],a[248:251],a[232:235],a[120:123]
s_waitcnt lgkmcnt(0)
v_fmac_f32 v214,4.0,v206
v_fma_f32 v235,-4.0,v208,v212
M a[124:127],a[248:251],v[216:219],a[124:127]
buffer_load_dwordx4 a[248:251],v250,s[20:23],s46 offen offset:1024 sc1
M a[124:127],a[240:243],a[232:235],a[124:127]
v_fmac_f32 v204,s45,v212
v_fmac_f32 v214,s41,v210
M a[124:127],a[244:247],a[208:211],a[124:127]
s_waitcnt vmcnt(13)
buffer_load_dwordx4 a[240:243],v250,s[20:23],s46 offen offset:2048 sc1
M a[128:131],v[228:231],a[196:199],a[128:131]
s_waitcnt vmcnt(13)
s_add_u32 s47,s75,30720
v_sub_f32 v212,v212,v208
v_fma_f32 v208,-4.0,v206,v210
M a[128:131],a[200:203],a[216:219],a[128:131]
s_waitcnt vmcnt(12)
v_sub_f32 v210,v210,v206
v_add_f32 v206,v235,v208
M a[128:131],a[220:223],v[220:223],a[128:131]
v_sub_f32 v235,v235,v208
v_fma_f32 v208,2.0,v210,v212
M a[132:135],a[220:223],a[192:195],a[132:135]
buffer_load_dwordx4 a[244:247],v250,s[20:23],s47 offen offset:0 sc1
M a[132:135],a[200:203],v[220:223],a[132:135]
v_fmac_f32 v212,-2.0,v210
v_cvt_pk_bf16_f32 v204,v232,v204
M a[132:135],v[228:231],a[216:219],a[132:135]
v_cvt_pk_bf16_f32 v214,v237,v214
v_cvt_pk_bf16_f32 v206,v233,v206
M a[136:139],v[228:231],v[220:223],a[136:139]
v_cvt_pk_bf16_f32 v210,v234,v208
v_cvt_pk_bf16_f32 v208,v238,v235
M a[136:139],a[200:203],a[192:195],a[136:139]
v_cvt_pk_bf16_f32 v212,v236,v212
v_lshlrev_b32 v234,16,v209
M a[136:139],a[220:223],a[224:227],a[136:139]
v_lshlrev_b32 v232,16,v205
v_lshlrev_b32 v233,16,v207
M a[140:143],a[220:223],a[228:231],a[140:143]
v_lshlrev_b32 v237,16,v215
v_lshlrev_b32 v236,16,v213
M a[140:143],a[200:203],a[224:227],a[140:143]
v_lshlrev_b32 v235,16,v211
v_fmac_f32 v232,s43,v234
M a[140:143],v[228:231],a[192:195],a[140:143]
v_fmac_f32 v237,4.0,v233
v_fma_f32 v238,-4.0,v234,v236
M a[144:147],v[228:231],a[224:227],a[144:147]
v_fmac_f32 v232,s45,v236
v_fmac_f32 v237,s41,v235
M a[144:147],a[200:203],a[228:231],a[144:147]
v_sub_f32 v236,v236,v234
v_fma_f32 v234,-4.0,v233,v235
M a[144:147],a[220:223],a[204:207],a[144:147]
v_sub_f32 v235,v235,v233
v_add_f32 v233,v238,v234
M a[148:151],a[220:223],a[208:211],a[148:151]
v_sub_f32 v238,v238,v234
v_fma_f32 v234,2.0,v235,v236
M a[148:151],a[200:203],a[204:207],a[148:151]
v_fmac_f32 v236,-2.0,v235
v_and_b32 v209,s42,v209
M a[148:151],v[228:231],a[228:231],a[148:151]
v_and_b32 v205,s42,v205
v_and_b32 v207,s42,v207
M a[152:155],v[228:231],a[204:207],a[152:155]
v_and_b32 v215,s42,v215
v_and_b32 v213,s42,v213
M a[152:155],a[200:203],a[208:211],a[152:155]
v_and_b32 v211,s42,v211
v_fmac_f32 v205,s43,v209
M a[152:155],a[220:223],a[232:235],a[152:155]
v_fmac_f32 v215,4.0,v207
v_fma_f32 v235,-4.0,v209,v213
M a[156:159],a[220:223],v[216:219],a[156:159]
buffer_load_dwordx4 a[220:223],v250,s[20:23],s47 offen offset:1024 sc1
M a[156:159],a[200:203],a[232:235],a[156:159]
v_fmac_f32 v205,s45,v213
v_fmac_f32 v215,s41,v211
M a[156:159],v[228:231],a[208:211],a[156:159]
s_waitcnt vmcnt(13)
buffer_load_dwordx4 a[200:203],v250,s[20:23],s47 offen offset:2048 sc1
M a[160:163],a[252:255],a[196:199],a[160:163]
s_waitcnt vmcnt(13)
s_add_u32 s48,s75,33792
v_sub_f32 v213,v213,v209
v_fma_f32 v209,-4.0,v207,v211
M a[160:163],a[212:215],a[216:219],a[160:163]
s_waitcnt vmcnt(12)
v_sub_f32 v211,v211,v207
v_add_f32 v207,v235,v209
M a[160:163],a[236:239],v[220:223],a[160:163]
v_sub_f32 v235,v235,v209
v_fma_f32 v209,2.0,v211,v213
M a[164:167],a[236:239],a[192:195],a[164:167]
buffer_load_dwordx4 v[228:231],v250,s[20:23],s48 offen offset:0 sc1
M a[164:167],a[212:215],v[220:223],a[164:167]
v_fmac_f32 v213,-2.0,v211
v_cvt_pk_bf16_f32 v205,v232,v205
M a[164:167],a[252:255],a[216:219],a[164:167]
v_cvt_pk_bf16_f32 v215,v237,v215
v_cvt_pk_bf16_f32 v207,v233,v207
M a[168:171],a[252:255],v[220:223],a[168:171]
v_cvt_pk_bf16_f32 v211,v234,v209
v_cvt_pk_bf16_f32 v209,v238,v235
M a[168:171],a[212:215],a[192:195],a[168:171]
buffer_load_dwordx4 a[196:199],v250,s[20:23],s48 offen offset:1024 sc1
M a[168:171],a[236:239],a[224:227],a[168:171]
v_cvt_pk_bf16_f32 v213,v236,v213
v_add_u32 v238,139264,v247
M a[172:175],a[236:239],a[228:231],a[172:175]
v_fmac_f32 v239,s43,v241
v_fmac_f32 v244,4.0,v240
M a[172:175],a[212:215],a[224:227],a[172:175]
v_fma_f32 v232,-4.0,v241,v243
v_fmac_f32 v239,s45,v243
M a[172:175],a[252:255],a[192:195],a[172:175]
buffer_load_dwordx4 a[216:219],v250,s[20:23],s48 offen offset:2048 sc1
M a[176:179],a[252:255],a[224:227],a[176:179]
s_add_u32 s46,s75,36864
v_fmac_f32 v244,s41,v242
v_sub_f32 v243,v243,v241
M a[176:179],a[212:215],a[228:231],a[176:179]
v_add_u32 v248,0x4400,v248
v_add_u32 v249,0x4400,v249
M a[176:179],a[236:239],a[204:207],a[176:179]
ds_write2st64_b64 v238,v[204:205],v[214:215] offset0:1 offset1:18
M a[180:183],a[236:239],a[208:211],a[180:183]
s_add_u32 s28,s70,7471104
buffer_load_dwordx4 v[220:223],v250,s[20:23],s46 offen offset:0 sc1
M a[180:183],a[212:215],a[204:207],a[180:183]
ds_read_b128 a[192:195],v248 offset:52224
v_fma_f32 v241,-4.0,v240,v242
M a[180:183],a[252:255],a[228:231],a[180:183]
ds_write2st64_b64 v247,v[206:207],v[208:209] offset0:35 offset1:52
M a[184:187],a[252:255],a[204:207],a[184:187]
buffer_load_dwordx2 v[204:205],v245,s[12:15],s28 offen offset:0
M a[184:187],a[212:215],a[208:211],a[184:187]
ds_read_b128 a[224:227],v249 offset:52224
ds_read_b128 a[228:231],v248 offset:52736
M a[184:187],a[236:239],a[232:235],a[184:187]
ds_write2st64_b64 v247,v[210:211],v[212:213] offset0:69 offset1:86
M a[188:191],a[236:239],v[216:219],a[188:191]
buffer_load_dwordx2 v[214:215],v245,s[16:19],s28 offen offset:1536
M a[188:191],a[212:215],a[232:235],a[188:191]
ds_read_b128 a[204:207],v249 offset:52736
v_sub_f32 v242,v242,v240
M a[188:191],a[252:255],a[208:211],a[188:191]
s_waitcnt vmcnt(17) lgkmcnt(5)
v_add_f32 v240,v232,v241
v_sub_f32 v232,v232,v241
M v[0:3],v[224:227],a[192:195],v[0:3]
s_waitcnt vmcnt(10) lgkmcnt(3)
ds_read_b128 a[236:239],v248 offset:53248
v_fma_f32 v241,2.0,v242,v243
M v[0:3],a[248:251],a[224:227],v[0:3]
s_waitcnt vmcnt(9) lgkmcnt(3)
buffer_load_dwordx2 v[206:207],v245,s[8:11],s28 offen offset:0
M v[0:3],a[240:243],a[228:231],v[0:3]
s_waitcnt lgkmcnt(1)
ds_read_b128 v[216:219],v249 offset:53248
v_fmac_f32 v243,-2.0,v242
M v[4:7],a[240:243],a[204:207],v[4:7]
v_cvt_pk_bf16_f32 v233,v239,v244
v_cvt_pk_bf16_f32 v234,v240,v232
M v[4:7],a[248:251],a[228:231],v[4:7]
v_cvt_pk_bf16_f32 v235,v241,v243
v_add_u32 v232,139264,v252
M v[4:7],v[224:227],a[224:227],v[4:7]
buffer_load_dwordx2 v[208:209],v245,s[8:11],s28 offen offset:384
M v[8:11],v[224:227],a[228:231],v[8:11]
ds_read_b128 a[212:215],v248 offset:53760
ds_write_b16 v232,v233 offset:0
M v[8:11],a[248:251],a[204:207],v[8:11]
s_waitcnt lgkmcnt(3)
ds_read_b128 a[232:235],v249 offset:53760
ds_write_b16_d16_hi v232,v233 offset:8704
M v[8:11],a[240:243],a[236:239],v[8:11]
s_waitcnt lgkmcnt(4)
ds_write_b16 v252,v234 offset:17408
M v[12:15],a[240:243],v[216:219],v[12:15]
buffer_load_dwordx2 v[210:211],v245,s[8:11],s28 offen offset:768
M v[12:15],a[248:251],a[236:239],v[12:15]
ds_write_b16_d16_hi v252,v234 offset:26112
M v[12:15],v[224:227],a[204:207],v[12:15]
ds_write_b16 v252,v235 offset:34816
M v[16:19],v[224:227],a[236:239],v[16:19]
ds_read_b128 a[208:211],v249 offset:54272
ds_write_b16_d16_hi v252,v235 offset:43520
M v[16:19],a[248:251],v[216:219],v[16:19]
s_waitcnt lgkmcnt(8)
buffer_load_dwordx2 v[212:213],v245,s[8:11],s28 offen offset:1152
M v[16:19],a[240:243],a[212:215],v[16:19]
s_waitcnt lgkmcnt(6)
s_add_u32 s29,s71,6291456
ds_read_b128 a[252:255],v248 offset:54272
v_lshlrev_b32 v234,16,v196
M v[20:23],a[240:243],a[232:235],v[20:23]
v_lshlrev_b32 v232,16,v192
v_lshlrev_b32 v233,16,v194
M v[20:23],a[248:251],a[212:215],v[20:23]
buffer_load_short_d16_hi v239,v246,s[12:15],s29 offen offset:0
M v[20:23],v[224:227],v[216:219],v[20:23]
v_lshlrev_b32 v237,16,v202
v_lshlrev_b32 v236,16,v200
M v[24:27],v[224:227],a[212:215],v[24:27]
buffer_load_short_d16_hi v240,v246,s[8:11],s29 offen offset:0
M v[24:27],a[248:251],a[232:235],v[24:27]
s_waitcnt lgkmcnt(2)
v_lshlrev_b32 v235,16,v198
v_fmac_f32 v232,s43,v234
M v[24:27],a[240:243],a[208:211],v[24:27]
s_waitcnt lgkmcnt(0)
buffer_load_short_d16_hi v241,v246,s[8:11],s29 offen offset:384
M v[28:31],a[240:243],a[252:255],v[28:31]
v_fmac_f32 v237,4.0,v233
v_fma_f32 v238,-4.0,v234,v236
M v[28:31],a[248:251],a[208:211],v[28:31]
buffer_load_dwordx4 a[240:243],v250,s[20:23],s46 offen offset:1024 sc1
M v[28:31],v[224:227],a[232:235],v[28:31]
s_waitcnt vmcnt(16)
v_fmac_f32 v232,s45,v236
v_fmac_f32 v237,s41,v235
M v[32:35],a[244:247],a[192:195],v[32:35]
s_waitcnt vmcnt(15)
v_sub_f32 v236,v236,v234
v_fma_f32 v234,-4.0,v233,v235
M v[32:35],a[220:223],a[224:227],v[32:35]
s_waitcnt vmcnt(14)
v_sub_f32 v235,v235,v233
v_add_f32 v233,v238,v234
M v[32:35],a[200:203],a[228:231],v[32:35]
buffer_load_dwordx4 a[248:251],v250,s[20:23],s46 offen offset:2048 sc1
M v[36:39],a[200:203],a[204:207],v[36:39]
s_add_u32 s47,s75,39936
v_sub_f32 v238,v238,v234
v_fma_f32 v234,2.0,v235,v236
M v[36:39],a[220:223],a[228:231],v[36:39]
v_fmac_f32 v236,-2.0,v235
v_and_b32 v196,s42,v196
M v[36:39],a[244:247],a[224:227],v[36:39]
v_and_b32 v192,s42,v192
v_and_b32 v194,s42,v194
M v[40:43],a[244:247],a[228:231],v[40:43]
buffer_load_dwordx4 v[224:227],v250,s[20:23],s47 offen offset:0 sc1
M v[40:43],a[220:223],a[204:207],v[40:43]
v_and_b32 v202,s42,v202
v_and_b32 v200,s42,v200
M v[40:43],a[200:203],a[236:239],v[40:43]
v_and_b32 v198,s42,v198
v_fmac_f32 v192,s43,v196
M v[44:47],a[200:203],v[216:219],v[44:47]
v_fmac_f32 v202,4.0,v194
v_fma_f32 v235,-4.0,v196,v200
M v[44:47],a[220:223],a[236:239],v[44:47]
buffer_load_short_d16_hi v242,v246,s[8:11],s29 offen offset:768
M v[44:47],a[244:247],a[204:207],v[44:47]
v_fmac_f32 v192,s45,v200
v_fmac_f32 v202,s41,v198
M v[48:51],a[244:247],a[236:239],v[48:51]
buffer_load_short_d16_hi v243,v246,s[8:11],s29 offen offset:1152
M v[48:51],a[220:223],v[216:219],v[48:51]
v_sub_f32 v200,v200,v196
v_fma_f32 v196,-4.0,v194,v198
M v[48:51],a[200:203],a[212:215],v[48:51]
buffer_load_short_d16_hi v244,v246,s[16:19],s29 offen offset:1536
M v[52:55],a[200:203],a[232:235],v[52:55]
v_sub_f32 v198,v198,v194
v_add_f32 v194,v235,v196
M v[52:55],a[220:223],a[212:215],v[52:55]
v_sub_f32 v235,v235,v196
v_fma_f32 v196,2.0,v198,v200
M v[52:55],a[244:247],v[216:219],v[52:55]
v_fmac_f32 v200,-2.0,v198
v_cvt_pk_bf16_f32 v192,v232,v192
M v[56:59],a[244:247],a[212:215],v[56:59]
v_cvt_pk_bf16_f32 v202,v237,v202
v_cvt_pk_bf16_f32 v194,v233,v194
M v[56:59],a[220:223],a[232:235],v[56:59]
v_cvt_pk_bf16_f32 v198,v234,v196
v_cvt_pk_bf16_f32 v196,v238,v235
M v[56:59],a[200:203],a[208:211],v[56:59]
v_cvt_pk_bf16_f32 v200,v236,v200
v_lshlrev_b32 v234,16,v197
M v[60:63],a[200:203],a[252:255],v[60:63]
buffer_load_dwordx4 a[200:203],v250,s[20:23],s47 offen offset:1024 sc1
M v[60:63],a[220:223],a[208:211],v[60:63]
v_lshlrev_b32 v232,16,v193
v_lshlrev_b32 v233,16,v195
M v[60:63],a[244:247],a[232:235],v[60:63]
s_waitcnt vmcnt(19)
buffer_load_dwordx4 a[220:223],v250,s[20:23],s47 offen offset:2048 sc1
M v[64:67],v[228:231],a[192:195],v[64:67]
s_waitcnt vmcnt(19)
s_add_u32 s48,s75,43008
v_lshlrev_b32 v237,16,v203
v_lshlrev_b32 v236,16,v201
M v[64:67],a[196:199],a[224:227],v[64:67]
s_waitcnt vmcnt(18)
v_lshlrev_b32 v235,16,v199
v_fmac_f32 v232,s43,v234
M v[64:67],a[216:219],a[228:231],v[64:67]
v_fmac_f32 v237,4.0,v233
v_fma_f32 v238,-4.0,v234,v236
M v[68:71],a[216:219],a[204:207],v[68:71]
buffer_load_dwordx4 a[244:247],v250,s[20:23],s48 offen offset:0 sc1
M v[68:71],a[196:199],a[228:231],v[68:71]
v_fmac_f32 v232,s45,v236
v_fmac_f32 v237,s41,v235
M v[68:71],v[228:231],a[224:227],v[68:71]
v_sub_f32 v236,v236,v234
v_fma_f32 v234,-4.0,v233,v235
M v[72:75],v[228:231],a[228:231],v[72:75]
v_sub_f32 v235,v235,v233
v_add_f32 v233,v238,v234
M v[72:75],a[196:199],a[204:207],v[72:75]
buffer_load_dwordx4 a[192:195],v250,s[20:23],s48 offen offset:1024 sc1
M v[72:75],a[216:219],a[236:239],v[72:75]
v_sub_f32 v238,v238,v234
v_fma_f32 v234,2.0,v235,v236
M v[76:79],a[216:219],v[216:219],v[76:79]
v_fmac_f32 v236,-2.0,v235
v_and_b32 v197,s42,v197
M v[76:79],a[196:199],a[236:239],v[76:79]
v_and_b32 v193,s42,v193
v_and_b32 v195,s42,v195
M v[76:79],v[228:231],a[204:207],v[76:79]
buffer_load_dwordx4 a[224:227],v250,s[20:23],s48 offen offset:2048 sc1
M v[80:83],v[228:231],a[236:239],v[80:83]
s_add_u32 s46,s76,9216
v_and_b32 v203,s42,v203
v_and_b32 v201,s42,v201
M v[80:83],a[196:199],v[216:219],v[80:83]
v_and_b32 v199,s42,v199
v_fmac_f32 v193,s43,v197
M v[80:83],a[216:219],a[212:215],v[80:83]
v_fmac_f32 v203,4.0,v195
v_fma_f32 v235,-4.0,v197,v201
M v[84:87],a[216:219],a[232:235],v[84:87]
buffer_load_dwordx4 a[228:231],v250,s[20:23],s46 offen offset:0 sc1
M v[84:87],a[196:199],a[212:215],v[84:87]
ds_read_b128 a[204:207],v248 offset:60928
v_fmac_f32 v193,s45,v201
M v[84:87],v[228:231],v[216:219],v[84:87]
ds_read_b128 a[236:239],v249 offset:60928
v_fmac_f32 v203,s41,v199
M v[88:91],v[228:231],a[212:215],v[88:91]
ds_read_b128 v[216:219],v248 offset:61440
v_sub_f32 v201,v201,v197
M v[88:91],a[196:199],a[232:235],v[88:91]
ds_read_b128 a[212:215],v249 offset:61440
v_fma_f32 v197,-4.0,v195,v199
M v[88:91],a[216:219],a[208:211],v[88:91]
v_sub_f32 v199,v199,v195
v_add_f32 v195,v235,v197
M v[92:95],a[216:219],a[252:255],v[92:95]
v_sub_f32 v235,v235,v197
v_fma_f32 v197,2.0,v199,v201
M v[92:95],a[196:199],a[208:211],v[92:95]
v_fmac_f32 v201,-2.0,v199
v_cvt_pk_bf16_f32 v193,v232,v193
M v[92:95],v[228:231],a[232:235],v[92:95]
s_waitcnt vmcnt(21) lgkmcnt(3)
v_cvt_pk_bf16_f32 v203,v237,v203
v_cvt_pk_bf16_f32 v195,v233,v195
M v[96:99],v[220:223],a[204:207],v[96:99]
s_waitcnt vmcnt(11) lgkmcnt(2)
ds_read_b128 a[216:219],v248 offset:61952
v_cvt_pk_bf16_f32 v199,v234,v197
M v[96:99],a[240:243],a[236:239],v[96:99]
s_waitcnt vmcnt(10) lgkmcnt(2)
ds_read_b128 a[252:255],v249 offset:61952
v_cvt_pk_bf16_f32 v197,v238,v235
M v[96:99],a[248:251],v[216:219],v[96:99]
s_waitcnt lgkmcnt(2)
v_cvt_pk_bf16_f32 v201,v236,v201
v_add_u32 v238,139264,v247
M v[100:103],a[248:251],a[212:215],v[100:103]
v_lshlrev_b32 v234,16,v208
v_lshlrev_b32 v232,16,v204
M v[100:103],a[240:243],v[216:219],v[100:103]
v_lshlrev_b32 v233,16,v206
v_lshlrev_b32 v237,16,v214
M v[100:103],v[220:223],a[236:239],v[100:103]
ds_write2st64_b64 v238,v[192:193],v[202:203] offset0:2 offset1:19
M v[104:107],v[220:223],v[216:219],v[104:107]
s_add_u32 s28,s71,6291456
buffer_load_dwordx2 v[192:193],v245,s[12:15],s28 offen offset:0
M v[104:107],a[240:243],a[212:215],v[104:107]
s_waitcnt lgkmcnt(2)
ds_read_b128 a[196:199],v248 offset:62464
ds_read_b128 a[208:211],v249 offset:62464
M v[104:107],a[248:251],a[216:219],v[104:107]
s_waitcnt lgkmcnt(3)
buffer_load_dwordx2 v[202:203],v245,s[16:19],s28 offen offset:1536
M v[108:111],a[248:251],a[252:255],v[108:111]
v_lshlrev_b32 v236,16,v212
v_lshlrev_b32 v235,16,v210
M v[108:111],a[240:243],a[216:219],v[108:111]
v_fmac_f32 v232,s43,v234
v_fmac_f32 v237,4.0,v233
M v[108:111],v[220:223],a[212:215],v[108:111]
ds_write2st64_b64 v247,v[194:195],v[196:197] offset0:36 offset1:53
M v[112:115],v[220:223],a[216:219],v[112:115]
buffer_load_dwordx2 v[194:195],v245,s[8:11],s28 offen offset:0
M v[112:115],a[240:243],a[252:255],v[112:115]
s_waitcnt lgkmcnt(2)
ds_read_b128 a[232:235],v249 offset:62976
ds_read_b128 v[228:231],v248 offset:62976
M v[112:115],a[248:251],a[196:199],v[112:115]
s_waitcnt lgkmcnt(3)
ds_write2st64_b64 v247,v[198:199],v[200:201] offset0:70 offset1:87
M v[116:119],a[248:251],a[208:211],v[116:119]
buffer_load_dwordx2 v[196:197],v245,s[8:11],s28 offen offset:384
M v[116:119],a[240:243],a[196:199],v[116:119]
v_fma_f32 v238,-4.0,v234,v236
v_fmac_f32 v232,s45,v236
M v[116:119],v[220:223],a[252:255],v[116:119]
v_fmac_f32 v237,s41,v235
v_sub_f32 v236,v236,v234
M v[120:123],v[220:223],a[196:199],v[120:123]
v_fma_f32 v234,-4.0,v233,v235
v_sub_f32 v235,v235,v233
M v[120:123],a[240:243],a[208:211],v[120:123]
s_waitcnt lgkmcnt(2)
buffer_load_dwordx2 v[198:199],v245,s[8:11],s28 offen offset:768
M v[120:123],a[248:251],a[232:235],v[120:123]
s_waitcnt lgkmcnt(1)
v_add_f32 v233,v238,v234
v_sub_f32 v238,v238,v234
M v[124:127],a[248:251],v[228:231],v[124:127]
v_fma_f32 v234,2.0,v235,v236
v_fmac_f32 v236,-2.0,v235
M v[124:127],a[240:243],a[232:235],v[124:127]
v_and_b32 v208,s42,v208
v_and_b32 v204,s42,v204
M v[124:127],v[220:223],a[208:211],v[124:127]
s_waitcnt vmcnt(14)
buffer_load_dwordx4 a[248:251],v250,s[20:23],s46 offen offset:1024 sc1
M v[128:131],v[224:227],a[204:207],v[128:131]
s_waitcnt vmcnt(11)
v_and_b32 v206,s42,v206
v_and_b32 v214,s42,v214
M v[128:131],a[200:203],a[236:239],v[128:131]
s_waitcnt vmcnt(10)
v_and_b32 v212,s42,v212
v_and_b32 v210,s42,v210
M v[128:131],a[220:223],v[216:219],v[128:131]
v_fmac_f32 v204,s43,v208
v_fmac_f32 v214,4.0,v206
M v[132:135],a[220:223],a[212:215],v[132:135]
buffer_load_dwordx4 a[240:243],v250,s[20:23],s46 offen offset:2048 sc1
M v[132:135],a[200:203],v[216:219],v[132:135]
s_add_u32 s47,s76,12288
v_fma_f32 v235,-4.0,v208,v212
v_fmac_f32 v204,s45,v212
M v[132:135],v[224:227],a[236:239],v[132:135]
v_fmac_f32 v214,s41,v210
v_sub_f32 v212,v212,v208
M v[136:139],v[224:227],v[216:219],v[136:139]
v_fma_f32 v208,-4.0,v206,v210
v_sub_f32 v210,v210,v206
M v[136:139],a[200:203],a[212:215],v[136:139]
buffer_load_dwordx4 v[220:223],v250,s[20:23],s47 offen offset:0 sc1
M v[136:139],a[220:223],a[216:219],v[136:139]
v_add_f32 v206,v235,v208
v_sub_f32 v235,v235,v208
M v[140:143],a[220:223],a[252:255],v[140:143]
v_fma_f32 v208,2.0,v210,v212
v_fmac_f32 v212,-2.0,v210
M v[140:143],a[200:203],a[216:219],v[140:143]
v_cvt_pk_bf16_f32 v204,v232,v204
v_cvt_pk_bf16_f32 v214,v237,v214
M v[140:143],v[224:227],a[212:215],v[140:143]
buffer_load_dwordx2 v[200:201],v245,s[8:11],s28 offen offset:1152
M v[144:147],v[224:227],a[216:219],v[144:147]
v_cvt_pk_bf16_f32 v206,v233,v206
v_cvt_pk_bf16_f32 v210,v234,v208
M v[144:147],a[200:203],a[252:255],v[144:147]
v_cvt_pk_bf16_f32 v208,v238,v235
v_cvt_pk_bf16_f32 v212,v236,v212
M v[144:147],a[220:223],a[196:199],v[144:147]
v_lshlrev_b32 v234,16,v209
v_lshlrev_b32 v232,16,v205
M v[148:151],a[220:223],a[208:211],v[148:151]
v_lshlrev_b32 v233,16,v207
v_lshlrev_b32 v237,16,v215
M v[148:151],a[200:203],a[196:199],v[148:151]
v_lshlrev_b32 v236,16,v213
v_lshlrev_b32 v235,16,v211
M v[148:151],v[224:227],a[252:255],v[148:151]
v_fmac_f32 v232,s43,v234
v_fmac_f32 v237,4.0,v233
M v[152:155],v[224:227],a[196:199],v[152:155]
v_fma_f32 v238,-4.0,v234,v236
v_fmac_f32 v232,s45,v236
M v[152:155],a[200:203],a[208:211],v[152:155]
v_fmac_f32 v237,s41,v235
v_sub_f32 v236,v236,v234
M v[152:155],a[220:223],a[232:235],v[152:155]
v_fma_f32 v234,-4.0,v233,v235
v_sub_f32 v235,v235,v233
M v[156:159],a[220:223],v[228:231],v[156:159]
buffer_load_dwordx4 a[220:223],v250,s[20:23],s47 offen offset:1024 sc1
v_add_f32 v233,v238,v234
v_sub_f32 v238,v238,v234
v_fma_f32 v234,2.0,v235,v236
v_fmac_f32 v236,-2.0,v235
M v[156:159],a[200:203],a[232:235],v[156:159]
buffer_load_dwordx4 a[200:203],v250,s[20:23],s47 offen offset:2048 sc1
v_and_b32 v209,s42,v209
v_and_b32 v205,s42,v205
v_and_b32 v207,s42,v207
v_and_b32 v215,s42,v215
M v[156:159],v[224:227],a[208:211],v[156:159]
s_waitcnt vmcnt(14)
s_add_u32 s48,s76,15360
v_and_b32 v213,s42,v213
v_and_b32 v211,s42,v211
v_fmac_f32 v205,s43,v209
v_fmac_f32 v215,4.0,v207
M v[160:163],a[244:247],a[204:207],v[160:163]
s_waitcnt vmcnt(13)
v_fma_f32 v235,-4.0,v209,v213
v_fmac_f32 v205,s45,v213
v_fmac_f32 v215,s41,v211
v_sub_f32 v213,v213,v209
M v[160:163],a[192:195],a[236:239],v[160:163]
s_waitcnt vmcnt(12)
buffer_load_dwordx4 v[224:227],v250,s[20:23],s48 offen offset:0 sc1
v_fma_f32 v209,-4.0,v207,v211
v_sub_f32 v211,v211,v207
v_add_f32 v207,v235,v209
v_sub_f32 v235,v235,v209
M v[160:163],a[224:227],v[216:219],v[160:163]
v_fma_f32 v209,2.0,v211,v213
v_fmac_f32 v213,-2.0,v211
v_cvt_pk_bf16_f32 v205,v232,v205
v_cvt_pk_bf16_f32 v215,v237,v215
M v[164:167],a[224:227],a[212:215],v[164:167]
buffer_load_dwordx4 a[204:207],v250,s[20:23],s48 offen offset:1024 sc1
v_cvt_pk_bf16_f32 v207,v233,v207
v_cvt_pk_bf16_f32 v211,v234,v209
v_cvt_pk_bf16_f32 v209,v238,v235
v_cvt_pk_bf16_f32 v213,v236,v213
M v[164:167],a[192:195],v[216:219],v[164:167]
v_add_u32 v238,139264,v247
M v[164:167],a[244:247],a[236:239],v[164:167]
ds_write2st64_b64 v238,v[204:205],v[214:215] offset0:3 offset1:20
M v[168:171],a[244:247],v[216:219],v[168:171]
s_add_u32 s28,s71,6684672
buffer_load_dwordx4 a[236:239],v250,s[20:23],s48 offen offset:2048 sc1
M v[168:171],a[192:195],a[212:215],v[168:171]
s_add_u32 s46,s76,18432
M v[168:171],a[224:227],a[216:219],v[168:171]
ds_write2st64_b64 v247,v[206:207],v[208:209] offset0:37 offset1:54
M v[172:175],a[224:227],a[252:255],v[172:175]
buffer_load_dwordx4 v[216:219],v250,s[20:23],s46 offen offset:0 sc1
M v[172:175],a[192:195],a[216:219],v[172:175]
M v[172:175],a[244:247],a[212:215],v[172:175]
ds_write2st64_b64 v247,v[210:211],v[212:213] offset0:71 offset1:88
M v[176:179],a[244:247],a[216:219],v[176:179]
buffer_load_dwordx2 v[204:205],v245,s[12:15],s28 offen offset:0
M v[176:179],a[192:195],a[252:255],v[176:179]
M v[176:179],a[224:227],a[196:199],v[176:179]
s_waitcnt lgkmcnt(0)
s_barrier
M v[180:183],a[224:227],a[208:211],v[180:183]
M v[180:183],a[192:195],a[196:199],v[180:183]
buffer_load_dwordx2 v[214:215],v245,s[16:19],s28 offen offset:1536
M v[180:183],a[244:247],a[252:255],v[180:183]
ds_read_b128 a[212:215],v248 offset:0
ds_read_b128 a[216:219],v249 offset:0
M v[184:187],a[244:247],a[196:199],v[184:187]
s_waitcnt vmcnt(13)
ds_read_b128 a[252:255],v248 offset:512
v_lshlrev_b32 v234,16,v196
M v[184:187],a[192:195],a[208:211],v[184:187]
ds_read_b128 a[196:199],v249 offset:512
v_lshlrev_b32 v232,16,v192
M v[184:187],a[224:227],a[232:235],v[184:187]
buffer_load_dwordx2 v[206:207],v245,s[8:11],s28 offen offset:0
M v[188:191],a[224:227],v[228:231],v[188:191]
v_lshlrev_b32 v233,16,v194
v_lshlrev_b32 v237,16,v202
M v[188:191],a[192:195],a[232:235],v[188:191]
s_waitcnt vmcnt(9)
v_lshlrev_b32 v236,16,v200
v_lshlrev_b32 v235,16,v198
M v[188:191],a[244:247],a[208:211],v[188:191]
s_waitcnt lgkmcnt(3)
v_fmac_f32 v232,s43,v234
v_fmac_f32 v237,4.0,v233
M a[0:3],a[228:231],a[212:215],a[0:3]
s_waitcnt lgkmcnt(2)
buffer_load_dwordx2 v[208:209],v245,s[8:11],s28 offen offset:384
M a[0:3],a[248:251],a[216:219],a[0:3]
s_waitcnt lgkmcnt(1)
ds_read_b128 a[224:227],v248 offset:1024
ds_read_b128 v[228:231],v249 offset:1024
M a[0:3],a[240:243],a[252:255],a[0:3]
s_waitcnt lgkmcnt(2)
v_fma_f32 v238,-4.0,v234,v236
v_fmac_f32 v232,s45,v236
M a[4:7],a[240:243],a[196:199],a[4:7]
v_fmac_f32 v237,s41,v235
v_sub_f32 v236,v236,v234
M a[4:7],a[248:251],a[252:255],a[4:7]
buffer_load_dwordx2 v[210:211],v245,s[8:11],s28 offen offset:768
M a[4:7],a[228:231],a[216:219],a[4:7]
v_fma_f32 v234,-4.0,v233,v235
v_sub_f32 v235,v235,v233
M a[8:11],a[228:231],a[252:255],a[8:11]
ds_read_b128 a[192:195],v248 offset:1536
v_add_f32 v233,v238,v234
M a[8:11],a[248:251],a[196:199],a[8:11]
s_waitcnt lgkmcnt(2)
ds_read_b128 a[232:235],v249 offset:1536
v_sub_f32 v238,v238,v234
M a[8:11],a[240:243],a[224:227],a[8:11]
s_waitcnt lgkmcnt(2)
buffer_load_dwordx2 v[212:213],v245,s[8:11],s28 offen offset:1152
M a[12:15],a[240:243],v[228:231],a[12:15]
v_fma_f32 v234,2.0,v235,v236
v_fmac_f32 v236,-2.0,v235
M a[12:15],a[248:251],a[224:227],a[12:15]
v_and_b32 v196,s42,v196
v_and_b32 v192,s42,v192
M a[12:15],a[228:231],a[196:199],a[12:15]
v_and_b32 v194,s42,v194
v_and_b32 v202,s42,v202
M a[16:19],a[228:231],a[224:227],a[16:19]
ds_read_b128 a[208:211],v249 offset:2048
v_and_b32 v200,s42,v200
M a[16:19],a[248:251],v[228:231],a[16:19]
s_waitcnt lgkmcnt(2)
ds_read_b128 a[244:247],v248 offset:2048
v_and_b32 v198,s42,v198
M a[16:19],a[240:243],a[192:195],a[16:19]
s_waitcnt lgkmcnt(2)
v_fmac_f32 v192,s43,v196
v_fmac_f32 v202,4.0,v194
M a[20:23],a[240:243],a[232:235],a[20:23]
v_fma_f32 v235,-4.0,v196,v200
v_fmac_f32 v192,s45,v200
M a[20:23],a[248:251],a[192:195],a[20:23]
v_fmac_f32 v202,s41,v198
v_sub_f32 v200,v200,v196
M a[20:23],a[228:231],v[228:231],a[20:23]
v_fma_f32 v196,-4.0,v194,v198
v_sub_f32 v198,v198,v194
M a[24:27],a[228:231],a[192:195],a[24:27]
v_add_f32 v194,v235,v196
v_sub_f32 v235,v235,v196
M a[24:27],a[248:251],a[232:235],a[24:27]
s_waitcnt lgkmcnt(1)
v_fma_f32 v196,2.0,v198,v200
v_fmac_f32 v200,-2.0,v198
M a[24:27],a[240:243],a[208:211],a[24:27]
s_waitcnt lgkmcnt(0)
v_cvt_pk_bf16_f32 v192,v232,v192
v_cvt_pk_bf16_f32 v202,v237,v202
M a[28:31],a[240:243],a[244:247],a[28:31]
buffer_load_dwordx4 a[240:243],v250,s[20:23],s46 offen offset:1024 sc1
M a[28:31],a[248:251],a[208:211],a[28:31]
v_cvt_pk_bf16_f32 v194,v233,v194
v_cvt_pk_bf16_f32 v198,v234,v196
M a[28:31],a[228:231],a[232:235],a[28:31]
buffer_load_dwordx4 a[248:251],v250,s[20:23],s46 offen offset:2048 sc1
M a[32:35],v[220:223],a[212:215],a[32:35]
s_waitcnt vmcnt(13)
s_add_u32 s47,s76,21504
v_cvt_pk_bf16_f32 v196,v238,v235
v_cvt_pk_bf16_f32 v200,v236,v200
M a[32:35],a[220:223],a[216:219],a[32:35]
s_waitcnt vmcnt(12)
v_lshlrev_b32 v234,16,v197
v_lshlrev_b32 v232,16,v193
M a[32:35],a[200:203],a[252:255],a[32:35]
v_lshlrev_b32 v233,16,v195
v_lshlrev_b32 v237,16,v203
M a[36:39],a[200:203],a[196:199],a[36:39]
buffer_load_dwordx4 a[228:231],v250,s[20:23],s47 offen offset:0 sc1
M a[36:39],a[220:223],a[252:255],a[36:39]
v_lshlrev_b32 v236,16,v201
v_lshlrev_b32 v235,16,v199
M a[36:39],v[220:223],a[216:219],a[36:39]
v_fmac_f32 v232,s43,v234
v_fmac_f32 v237,4.0,v233
M a[40:43],v[220:223],a[252:255],a[40:43]
v_fma_f32 v238,-4.0,v234,v236
v_fmac_f32 v232,s45,v236
M a[40:43],a[220:223],a[196:199],a[40:43]
v_fmac_f32 v237,s41,v235
v_sub_f32 v236,v236,v234
M a[40:43],a[200:203],a[224:227],a[40:43]
v_fma_f32 v234,-4.0,v233,v235
v_sub_f32 v235,v235,v233
M a[44:47],a[200:203],v[228:231],a[44:47]
v_add_f32 v233,v238,v234
v_sub_f32 v238,v238,v234
M a[44:47],a[220:223],a[224:227],a[44:47]
v_fma_f32 v234,2.0,v235,v236
v_fmac_f32 v236,-2.0,v235
M a[44:47],v[220:223],a[196:199],a[44:47]
v_and_b32 v197,s42,v197
v_and_b32 v193,s42,v193
M a[48:51],v[220:223],a[224:227],a[48:51]
v_and_b32 v195,s42,v195
v_and_b32 v203,s42,v203
M a[48:51],a[220:223],v[228:231],a[48:51]
v_and_b32 v201,s42,v201
v_and_b32 v199,s42,v199
M a[48:51],a[200:203],a[192:195],a[48:51]
v_fmac_f32 v193,s43,v197
v_fmac_f32 v203,4.0,v195
M a[52:55],a[200:203],a[232:235],a[52:55]
v_fma_f32 v235,-4.0,v197,v201
v_fmac_f32 v193,s45,v201
M a[52:55],a[220:223],a[192:195],a[52:55]
v_fmac_f32 v203,s41,v199
v_sub_f32 v201,v201,v197
M a[52:55],v[220:223],v[228:231],a[52:55]
v_fma_f32 v197,-4.0,v195,v199
v_sub_f32 v199,v199,v195
M a[56:59],v[220:223],a[192:195],a[56:59]
v_add_f32 v195,v235,v197
v_sub_f32 v235,v235,v197
M a[56:59],a[220:223],a[232:235],a[56:59]
v_fma_f32 v197,2.0,v199,v201
v_fmac_f32 v201,-2.0,v199
M a[56:59],a[200:203],a[208:211],a[56:59]
v_cvt_pk_bf16_f32 v193,v232,v193
v_cvt_pk_bf16_f32 v203,v237,v203
M a[60:63],a[200:203],a[244:247],a[60:63]
buffer_load_dwordx4 a[200:203],v250,s[20:23],s47 offen offset:1024 sc1
M a[60:63],a[220:223],a[208:211],a[60:63]
v_cvt_pk_bf16_f32 v195,v233,v195
v_cvt_pk_bf16_f32 v199,v234,v197
M a[60:63],v[220:223],a[232:235],a[60:63]
s_waitcnt vmcnt(13)
buffer_load_dwordx4 a[220:223],v250,s[20:23],s47 offen offset:2048 sc1
M a[64:67],v[224:227],a[212:215],a[64:67]
s_waitcnt vmcnt(13)
s_add_u32 s48,s76,24576
v_cvt_pk_bf16_f32 v197,v238,v235
v_cvt_pk_bf16_f32 v201,v236,v201
M a[64:67],a[204:207],a[216:219],a[64:67]
s_waitcnt vmcnt(7)
v_lshlrev_b32 v234,16,v208
v_lshlrev_b32 v232,16,v204
M a[64:67],a[236:239],a[252:255],a[64:67]
ds_write2st64_b64 v247,v[192:193],v[202:203] offset0:136 offset1:153
M a[68:71],a[236:239],a[196:199],a[68:71]
s_add_u32 s28,s71,7077888
buffer_load_dwordx4 v[220:223],v250,s[20:23],s48 offen offset:0 sc1
M a[68:71],a[204:207],a[252:255],a[68:71]
v_lshlrev_b32 v233,16,v206
v_lshlrev_b32 v237,16,v214
M a[68:71],v[224:227],a[216:219],a[68:71]
ds_write2st64_b64 v247,v[194:195],v[196:197] offset0:0 offset1:17
M a[72:75],v[224:227],a[252:255],a[72:75]
buffer_load_dwordx4 a[212:215],v250,s[20:23],s48 offen offset:1024 sc1
M a[72:75],a[204:207],a[196:199],a[72:75]
s_waitcnt vmcnt(7)
v_lshlrev_b32 v236,16,v212
v_lshlrev_b32 v235,16,v210
M a[72:75],a[236:239],a[224:227],a[72:75]
v_fmac_f32 v232,s43,v234
v_fmac_f32 v237,4.0,v233
M a[76:79],a[236:239],v[228:231],a[76:79]
v_fma_f32 v238,-4.0,v234,v236
v_fmac_f32 v232,s45,v236
M a[76:79],a[204:207],a[224:227],a[76:79]
buffer_load_dwordx4 a[216:219],v250,s[20:23],s48 offen offset:2048 sc1
M a[76:79],v[224:227],a[196:199],a[76:79]
s_add_u32 s46,s76,27648
v_fmac_f32 v237,s41,v235
v_sub_f32 v236,v236,v234
M a[80:83],v[224:227],a[224:227],a[80:83]
v_fma_f32 v234,-4.0,v233,v235
v_sub_f32 v235,v235,v233
M a[80:83],a[204:207],v[228:231],a[80:83]
v_add_f32 v233,v238,v234
v_sub_f32 v238,v238,v234
M a[80:83],a[236:239],a[192:195],a[80:83]
buffer_load_dwordx4 a[252:255],v250,s[20:23],s46 offen offset:0 sc1
M a[84:87],a[236:239],a[232:235],a[84:87]
v_fma_f32 v234,2.0,v235,v236
v_fmac_f32 v236,-2.0,v235
M a[84:87],a[204:207],a[192:195],a[84:87]
ds_read_b128 a[196:199],v248 offset:8704
v_and_b32 v208,s42,v208
M a[84:87],v[224:227],v[228:231],a[84:87]
ds_read_b128 a[224:227],v249 offset:8704
v_and_b32 v204,s42,v204
M a[88:91],v[224:227],a[192:195],a[88:91]
buffer_load_dwordx2 v[192:193],v245,s[12:15],s28 offen offset:0
M a[88:91],a[204:207],a[232:235],a[88:91]
ds_read_b128 v[228:231],v248 offset:9216
ds_read_b128 a[192:195],v249 offset:9216
M a[88:91],a[236:239],a[208:211],a[88:91]
v_and_b32 v206,s42,v206
v_and_b32 v214,s42,v214
M a[92:95],a[236:239],a[244:247],a[92:95]
v_and_b32 v212,s42,v212
v_and_b32 v210,s42,v210
M a[92:95],a[204:207],a[208:211],a[92:95]
buffer_load_dwordx2 v[202:203],v245,s[16:19],s28 offen offset:1536
M a[92:95],v[224:227],a[232:235],a[92:95]
s_waitcnt lgkmcnt(3)
v_fmac_f32 v204,s43,v208
v_fmac_f32 v214,4.0,v206
M a[96:99],v[216:219],a[196:199],a[96:99]
s_waitcnt vmcnt(10) lgkmcnt(2)
ds_read_b128 a[236:239],v248 offset:9728
v_fma_f32 v235,-4.0,v208,v212
M a[96:99],a[240:243],a[224:227],a[96:99]
s_waitcnt vmcnt(9) lgkmcnt(2)
ds_read_b128 a[244:247],v249 offset:9728
v_fmac_f32 v204,s45,v212
M a[96:99],a[248:251],v[228:231],a[96:99]
s_waitcnt lgkmcnt(2)
buffer_load_dwordx2 v[194:195],v245,s[8:11],s28 offen offset:0
M a[100:103],a[248:251],a[192:195],a[100:103]
v_fmac_f32 v214,s41,v210
v_sub_f32 v212,v212,v208
M a[100:103],a[240:243],v[228:231],a[100:103]
v_fma_f32 v208,-4.0,v206,v210
v_sub_f32 v210,v210,v206
M a[100:103],v[216:219],a[224:227],a[100:103]
v_add_f32 v206,v235,v208
v_sub_f32 v235,v235,v208
M a[104:107],v[216:219],v[228:231],a[104:107]
buffer_load_dwordx2 v[196:197],v245,s[8:11],s28 offen offset:384
M a[104:107],a[240:243],a[192:195],a[104:107]
s_waitcnt lgkmcnt(1)
ds_read_b128 a[204:207],v248 offset:10240
ds_read_b128 a[208:211],v249 offset:10240
M a[104:107],a[248:251],a[236:239],a[104:107]
s_waitcnt lgkmcnt(2)
v_fma_f32 v208,2.0,v210,v212
v_fmac_f32 v212,-2.0,v210
M a[108:111],a[248:251],a[244:247],a[108:111]
v_cvt_pk_bf16_f32 v204,v232,v204
v_cvt_pk_bf16_f32 v214,v237,v214
M a[108:111],a[240:243],a[236:239],a[108:111]
v_cvt_pk_bf16_f32 v206,v233,v206
v_cvt_pk_bf16_f32 v210,v234,v208
M a[108:111],v[216:219],a[192:195],a[108:111]
v_cvt_pk_bf16_f32 v208,v238,v235
v_cvt_pk_bf16_f32 v212,v236,v212
M a[112:115],v[216:219],a[236:239],a[112:115]
ds_read_b128 a[232:235],v249 offset:10752
v_lshlrev_b32 v234,16,v209
M a[112:115],a[240:243],a[244:247],a[112:115]
s_waitcnt lgkmcnt(2)
ds_read_b128 v[224:227],v248 offset:10752
v_lshlrev_b32 v232,16,v205
M a[112:115],a[248:251],a[204:207],a[112:115]
s_waitcnt lgkmcnt(2)
v_lshlrev_b32 v233,16,v207
v_lshlrev_b32 v237,16,v215
M a[116:119],a[248:251],a[208:211],a[116:119]
v_lshlrev_b32 v236,16,v213
v_lshlrev_b32 v235,16,v211
M a[116:119],a[240:243],a[204:207],a[116:119]
v_fmac_f32 v232,s43,v234
v_fmac_f32 v237,4.0,v233
M a[116:119],v[216:219],a[244:247],a[116:119]
v_fma_f32 v238,-4.0,v234,v236
v_fmac_f32 v232,s45,v236
M a[120:123],v[216:219],a[204:207],a[120:123]
v_fmac_f32 v237,s41,v235
v_sub_f32 v236,v236,v234
M a[120:123],a[240:243],a[208:211],a[120:123]
s_waitcnt lgkmcnt(1)
v_fma_f32 v234,-4.0,v233,v235
v_sub_f32 v235,v235,v233
M a[120:123],a[248:251],a[232:235],a[120:123]
s_waitcnt lgkmcnt(0)
v_add_f32 v233,v238,v234
v_sub_f32 v238,v238,v234
M a[124:127],a[248:251],v[224:227],a[124:127]
buffer_load_dwordx4 a[248:251],v250,s[20:23],s46 offen offset:1024 sc1
M a[124:127],a[240:243],a[232:235],a[124:127]
v_fma_f32 v234,2.0,v235,v236
v_fmac_f32 v236,-2.0,v235
M a[124:127],v[216:219],a[208:211],a[124:127]
s_waitcnt vmcnt(11)
buffer_load_dwordx4 a[240:243],v250,s[20:23],s46 offen offset:2048 sc1
M a[128:131],a[228:231],a[196:199],a[128:131]
s_waitcnt vmcnt(11)
s_add_u32 s47,s76,30720
v_and_b32 v209,s42,v209
v_and_b32 v205,s42,v205
M a[128:131],a[200:203],a[224:227],a[128:131]
s_waitcnt vmcnt(10)
v_and_b32 v207,s42,v207
v_and_b32 v215,s42,v215
M a[128:131],a[220:223],v[228:231],a[128:131]
v_and_b32 v213,s42,v213
v_and_b32 v211,s42,v211
M a[132:135],a[220:223],a[192:195],a[132:135]
buffer_load_dwordx4 v[216:219],v250,s[20:23],s47 offen offset:0 sc1
M a[132:135],a[200:203],v[228:231],a[132:135]
v_fmac_f32 v205,s43,v209
v_fmac_f32 v215,4.0,v207
M a[132:135],a[228:231],a[224:227],a[132:135]
v_fma_f32 v235,-4.0,v209,v213
v_fmac_f32 v205,s45,v213
M a[136:139],a[228:231],v[228:231],a[136:139]
s_barrier
v_fmac_f32 v215,s41,v211
M a[136:139],a[200:203],a[192:195],a[136:139]
v_sub_f32 v213,v213,v209
v_fma_f32 v209,-4.0,v207,v211
M a[136:139],a[220:223],a[236:239],a[136:139]
ds_write2st64_b64 v247,v[198:199],v[200:201] offset0:34 offset1:51
M a[140:143],a[220:223],a[244:247],a[140:143]
buffer_load_dwordx2 v[198:199],v245,s[8:11],s28 offen offset:768
M a[140:143],a[200:203],a[236:239],a[140:143]
v_sub_f32 v211,v211,v207
v_add_f32 v207,v235,v209
M a[140:143],a[228:231],a[192:195],a[140:143]
buffer_load_dwordx2 v[200:201],v245,s[8:11],s28 offen offset:1152
M a[144:147],a[228:231],a[236:239],a[144:147]
v_sub_f32 v235,v235,v209
v_fma_f32 v209,2.0,v211,v213
M a[144:147],a[200:203],a[244:247],a[144:147]
v_fmac_f32 v213,-2.0,v211
v_cvt_pk_bf16_f32 v205,v232,v205
M a[144:147],a[220:223],a[204:207],a[144:147]
v_cvt_pk_bf16_f32 v215,v237,v215
v_cvt_pk_bf16_f32 v207,v233,v207
M a[148:151],a[220:223],a[208:211],a[148:151]
v_cvt_pk_bf16_f32 v211,v234,v209
v_cvt_pk_bf16_f32 v209,v238,v235
M a[148:151],a[200:203],a[204:207],a[148:151]
v_cvt_pk_bf16_f32 v213,v236,v213
v_fmac_f32 v239,s43,v241
M a[148:151],a[228:231],a[244:247],a[148:151]
ds_write2st64_b64 v247,v[204:205],v[214:215] offset0:137 offset1:154
M a[152:155],a[228:231],a[204:207],a[152:155]
s_add_u32 s28,s71,7471104
buffer_load_dwordx2 v[204:205],v245,s[12:15],s28 offen offset:0
M a[152:155],a[200:203],a[208:211],a[152:155]
v_fmac_f32 v244,4.0,v240
v_fma_f32 v232,-4.0,v241,v243
M a[152:155],a[220:223],a[232:235],a[152:155]
buffer_load_dwordx2 v[214:215],v245,s[16:19],s28 offen offset:1536
M a[156:159],a[220:223],v[224:227],a[156:159]
v_fmac_f32 v239,s45,v243
v_fmac_f32 v244,s41,v242
M a[156:159],a[200:203],a[232:235],a[156:159]
v_sub_f32 v243,v243,v241
v_fma_f32 v241,-4.0,v240,v242
M a[156:159],a[228:231],a[208:211],a[156:159]
s_waitcnt vmcnt(14)
ds_write2st64_b64 v247,v[206:207],v[208:209] offset0:1 offset1:18
M a[160:163],v[220:223],a[196:199],a[160:163]
s_waitcnt vmcnt(13)
buffer_load_dwordx4 a[220:223],v250,s[20:23],s47 offen offset:1024 sc1
M a[160:163],a[212:215],a[224:227],a[160:163]
s_waitcnt vmcnt(13)
v_sub_f32 v242,v242,v240
v_add_f32 v240,v232,v241
M a[160:163],a[216:219],v[228:231],a[160:163]
ds_write2st64_b64 v247,v[210:211],v[212:213] offset0:35 offset1:52
M a[164:167],a[216:219],a[192:195],a[164:167]
buffer_load_dwordx4 a[200:203],v250,s[20:23],s47 offen offset:2048 sc1
M a[164:167],a[212:215],v[228:231],a[164:167]
s_add_u32 s48,s76,33792
v_sub_f32 v232,v232,v241
v_fma_f32 v241,2.0,v242,v243
M a[164:167],v[220:223],a[224:227],a[164:167]
v_fmac_f32 v243,-2.0,v242
v_cvt_pk_bf16_f32 v233,v239,v244
M a[168:171],v[220:223],v[228:231],a[168:171]
v_cvt_pk_bf16_f32 v234,v240,v232
v_cvt_pk_bf16_f32 v235,v241,v243
M a[168:171],a[212:215],a[192:195],a[168:171]
buffer_load_dwordx4 a[228:231],v250,s[20:23],s48 offen offset:0 sc1
M a[168:171],a[216:219],a[236:239],a[168:171]
v_add_u32 v232,69632,v252
M a[172:175],a[216:219],a[244:247],a[172:175]
ds_write_b16 v232,v233 offset:0
M a[172:175],a[212:215],a[236:239],a[172:175]
ds_write_b16_d16_hi v232,v233 offset:8704
M a[172:175],v[220:223],a[192:195],a[172:175]
buffer_load_dwordx4 a[196:199],v250,s[20:23],s48 offen offset:1024 sc1
M a[176:179],v[220:223],a[236:239],a[176:179]
ds_write_b16 v252,v234 offset:0
M a[176:179],a[212:215],a[244:247],a[176:179]
ds_write_b16_d16_hi v252,v234 offset:8704
M a[176:179],a[216:219],a[204:207],a[176:179]
ds_write_b16 v252,v235 offset:17408
M a[180:183],a[216:219],a[208:211],a[180:183]
buffer_load_dwordx4 a[224:227],v250,s[20:23],s48 offen offset:2048 sc1
M a[180:183],a[212:215],a[204:207],a[180:183]
s_add_u32 s46,s76,36864
ds_read_b128 a[192:195],v248 offset:17408
ds_write_b16_d16_hi v252,v235 offset:26112
M a[180:183],v[220:223],a[244:247],a[180:183]
s_waitcnt vmcnt(12)
ds_read_b128 a[236:239],v249 offset:17408
v_lshlrev_b32 v234,16,v196
M a[184:187],v[220:223],a[204:207],a[184:187]
ds_read_b128 a[244:247],v248 offset:17920
v_lshlrev_b32 v232,16,v192
M a[184:187],a[212:215],a[208:211],a[184:187]
buffer_load_dwordx4 v[228:231],v250,s[20:23],s46 offen offset:0 sc1
M a[184:187],a[216:219],a[232:235],a[184:187]
ds_read_b128 a[204:207],v249 offset:17920
v_lshlrev_b32 v233,16,v194
M a[188:191],a[216:219],v[224:227],a[188:191]
s_waitcnt vmcnt(8)
v_lshlrev_b32 v237,16,v202
v_lshlrev_b32 v236,16,v200
M a[188:191],a[212:215],a[232:235],a[188:191]
v_lshlrev_b32 v235,16,v198
v_fmac_f32 v232,s43,v234
M a[188:191],v[220:223],a[208:211],a[188:191]
s_waitcnt lgkmcnt(4)
buffer_load_dwordx2 v[206:207],v245,s[8:11],s28 offen offset:0
M v[0:3],a[252:255],a[192:195],v[0:3]
s_waitcnt lgkmcnt(2)
ds_read_b128 a[216:219],v248 offset:18432
v_fmac_f32 v237,4.0,v233
M v[0:3],a[248:251],a[236:239],v[0:3]
s_waitcnt lgkmcnt(2)
ds_read_b128 v[224:227],v249 offset:18432
v_fma_f32 v238,-4.0,v234,v236
M v[0:3],a[240:243],a[244:247],v[0:3]
s_waitcnt lgkmcnt(2)
v_fmac_f32 v232,s45,v236
v_fmac_f32 v237,s41,v235
M v[4:7],a[240:243],a[204:207],v[4:7]
buffer_load_dwordx2 v[208:209],v245,s[8:11],s28 offen offset:384
M v[4:7],a[248:251],a[244:247],v[4:7]
v_sub_f32 v236,v236,v234
v_fma_f32 v234,-4.0,v233,v235
M v[4:7],a[252:255],a[236:239],v[4:7]
v_sub_f32 v235,v235,v233
v_add_f32 v233,v238,v234
M v[8:11],a[252:255],a[244:247],v[8:11]
ds_read_b128 a[212:215],v248 offset:18944
v_sub_f32 v238,v238,v234
M v[8:11],a[248:251],a[204:207],v[8:11]
s_waitcnt lgkmcnt(2)
buffer_load_dwordx2 v[210:211],v245,s[8:11],s28 offen offset:768
M v[8:11],a[240:243],a[216:219],v[8:11]
s_waitcnt lgkmcnt(1)
ds_read_b128 a[232:235],v249 offset:18944
v_fma_f32 v234,2.0,v235,v236
M v[12:15],a[240:243],v[224:227],v[12:15]
v_fmac_f32 v236,-2.0,v235
v_and_b32 v196,s42,v196
M v[12:15],a[248:251],a[216:219],v[12:15]
v_and_b32 v192,s42,v192
v_and_b32 v194,s42,v194
M v[12:15],a[252:255],a[204:207],v[12:15]
buffer_load_dwordx2 v[212:213],v245,s[8:11],s28 offen offset:1152
M v[16:19],a[252:255],a[216:219],v[16:19]
ds_read_b128 a[208:211],v249 offset:19456
v_and_b32 v202,s42,v202
M v[16:19],a[248:251],v[224:227],v[16:19]
s_waitcnt lgkmcnt(2)
ds_read_b128 v[220:223],v248 offset:19456
v_and_b32 v200,s42,v200
M v[16:19],a[240:243],a[212:215],v[16:19]
s_waitcnt lgkmcnt(2)
v_and_b32 v198,s42,v198
v_fmac_f32 v192,s43,v196
M v[20:23],a[240:243],a[232:235],v[20:23]
v_fmac_f32 v202,4.0,v194
v_fma_f32 v235,-4.0,v196,v200
M v[20:23],a[248:251],a[212:215],v[20:23]
v_fmac_f32 v192,s45,v200
v_fmac_f32 v202,s41,v198
M v[20:23],a[252:255],v[224:227],v[20:23]
v_sub_f32 v200,v200,v196
v_fma_f32 v196,-4.0,v194,v198
M v[24:27],a[252:255],a[212:215],v[24:27]
v_sub_f32 v198,v198,v194
v_add_f32 v194,v235,v196
M v[24:27],a[248:251],a[232:235],v[24:27]
s_waitcnt lgkmcnt(1)
v_sub_f32 v235,v235,v196
v_fma_f32 v196,2.0,v198,v200
M v[24:27],a[240:243],a[208:211],v[24:27]
s_waitcnt lgkmcnt(0)
v_fmac_f32 v200,-2.0,v198
v_cvt_pk_bf16_f32 v192,v232,v192
M v[28:31],a[240:243],v[220:223],v[28:31]
global_load_dword a240,v250,s[64:65]
M v[28:31],a[248:251],a[208:211],v[28:31]
buffer_load_dwordx4 a[240:243],v250,s[20:23],s46 offen offset:1024 sc1
M v[28:31],a[252:255],a[232:235],v[28:31]
v_cvt_pk_bf16_f32 v202,v237,v202
v_cvt_pk_bf16_f32 v194,v233,v194
M v[32:35],v[216:219],a[192:195],v[32:35]
s_waitcnt vmcnt(11)
v_cvt_pk_bf16_f32 v198,v234,v196
v_cvt_pk_bf16_f32 v196,v238,v235
M v[32:35],a[220:223],a[236:239],v[32:35]
s_waitcnt vmcnt(10)
buffer_load_dwordx4 a[248:251],v250,s[20:23],s46 offen offset:2048 sc1
M v[32:35],a[200:203],a[244:247],v[32:35]
s_add_u32 s47,s76,39936
v_cvt_pk_bf16_f32 v200,v236,v200
v_lshlrev_b32 v234,16,v197
M v[36:39],a[200:203],a[204:207],v[36:39]
v_lshlrev_b32 v232,16,v193
v_lshlrev_b32 v233,16,v195
M v[36:39],a[220:223],a[244:247],v[36:39]
v_lshlrev_b32 v237,16,v203
v_lshlrev_b32 v236,16,v201
M v[36:39],v[216:219],a[236:239],v[36:39]
buffer_load_dwordx4 a[252:255],v250,s[20:23],s47 offen offset:0 sc1
M v[40:43],v[216:219],a[244:247],v[40:43]
v_lshlrev_b32 v235,16,v199
v_fmac_f32 v232,s43,v234
M v[40:43],a[220:223],a[204:207],v[40:43]
v_fmac_f32 v237,4.0,v233
v_fma_f32 v238,-4.0,v234,v236
M v[40:43],a[200:203],a[216:219],v[40:43]
v_fmac_f32 v232,s45,v236
v_fmac_f32 v237,s41,v235
M v[44:47],a[200:203],v[224:227],v[44:47]
v_sub_f32 v236,v236,v234
v_fma_f32 v234,-4.0,v233,v235
M v[44:47],a[220:223],a[216:219],v[44:47]
v_sub_f32 v235,v235,v233
v_add_f32 v233,v238,v234
M v[44:47],v[216:219],a[204:207],v[44:47]
v_sub_f32 v238,v238,v234
v_fma_f32 v234,2.0,v235,v236
M v[48:51],v[216:219],a[216:219],v[48:51]
v_fmac_f32 v236,-2.0,v235
v_and_b32 v197,s42,v197
M v[48:51],a[220:223],v[224:227],v[48:51]
v_and_b32 v193,s42,v193
v_and_b32 v195,s42,v195
M v[48:51],a[200:203],a[212:215],v[48:51]
v_and_b32 v203,s42,v203
v_and_b32 v201,s42,v201
M v[52:55],a[200:203],a[232:235],v[52:55]
v_and_b32 v199,s42,v199
v_fmac_f32 v193,s43,v197
M v[52:55],a[220:223],a[212:215],v[52:55]
v_fmac_f32 v203,4.0,v195
v_fma_f32 v235,-4.0,v197,v201
M v[52:55],v[216:219],v[224:227],v[52:55]
v_fmac_f32 v193,s45,v201
v_fmac_f32 v203,s41,v199
M v[56:59],v[216:219],a[212:215],v[56:59]
v_sub_f32 v201,v201,v197
v_fma_f32 v197,-4.0,v195,v199
M v[56:59],a[220:223],a[232:235],v[56:59]
v_sub_f32 v199,v199,v195
v_add_f32 v195,v235,v197
M v[56:59],a[200:203],a[208:211],v[56:59]
v_sub_f32 v235,v235,v197
v_fma_f32 v197,2.0,v199,v201
M v[60:63],a[200:203],v[220:223],v[60:63]
buffer_load_dwordx4 a[200:203],v250,s[20:23],s47 offen offset:1024 sc1
M v[60:63],a[220:223],a[208:211],v[60:63]
v_fmac_f32 v201,-2.0,v199
v_cvt_pk_bf16_f32 v193,v232,v193
M v[60:63],v[216:219],a[232:235],v[60:63]
s_waitcnt vmcnt(12)
buffer_load_dwordx4 a[220:223],v250,s[20:23],s47 offen offset:2048 sc1
M v[64:67],a[228:231],a[192:195],v[64:67]
s_waitcnt vmcnt(12)
s_add_u32 s48,s76,43008
v_cvt_pk_bf16_f32 v203,v237,v203
v_cvt_pk_bf16_f32 v195,v233,v195
M v[64:67],a[196:199],a[236:239],v[64:67]
s_waitcnt vmcnt(11)
v_cvt_pk_bf16_f32 v199,v234,v197
v_cvt_pk_bf16_f32 v197,v238,v235
M v[64:67],a[224:227],a[244:247],v[64:67]
s_waitcnt vmcnt(8)
v_cvt_pk_bf16_f32 v201,v236,v201
v_lshlrev_b32 v234,16,v208
M v[68:71],a[224:227],a[204:207],v[68:71]
buffer_load_dwordx4 v[216:219],v250,s[20:23],s48 offen offset:0 sc1
M v[68:71],a[196:199],a[244:247],v[68:71]
v_lshlrev_b32 v232,16,v204
v_lshlrev_b32 v233,16,v206
M v[68:71],a[228:231],a[236:239],v[68:71]
ds_write2st64_b64 v247,v[192:193],v[202:203] offset0:138 offset1:155
M v[72:75],a[228:231],a[244:247],v[72:75]
s_waitcnt vmcnt(7)
v_lshlrev_b32 v237,16,v214
v_lshlrev_b32 v236,16,v212
M v[72:75],a[196:199],a[204:207],v[72:75]
buffer_load_dwordx4 a[192:195],v250,s[20:23],s48 offen offset:1024 sc1
M v[72:75],a[224:227],a[216:219],v[72:75]
ds_write2st64_b64 v247,v[194:195],v[196:197] offset0:2 offset1:19
M v[76:79],a[224:227],v[224:227],v[76:79]
v_lshlrev_b32 v235,16,v210
v_fmac_f32 v232,s43,v234
M v[76:79],a[196:199],a[216:219],v[76:79]
buffer_load_dwordx4 a[236:239],v250,s[20:23],s48 offen offset:2048 sc1
M v[76:79],a[228:231],a[204:207],v[76:79]
s_add_u32 s46,s77,9216
ds_write2st64_b64 v247,v[198:199],v[200:201] offset0:36 offset1:53
M v[80:83],a[228:231],a[216:219],v[80:83]
v_fmac_f32 v237,4.0,v233
v_fma_f32 v238,-4.0,v234,v236
M v[80:83],a[196:199],v[224:227],v[80:83]
buffer_load_dwordx4 a[244:247],v250,s[20:23],s46 offen offset:0 sc1
M v[80:83],a[224:227],a[212:215],v[80:83]
v_fmac_f32 v232,s45,v236
v_fmac_f32 v237,s41,v235
M v[84:87],a[224:227],a[232:235],v[84:87]
v_sub_f32 v236,v236,v234
v_fma_f32 v234,-4.0,v233,v235
M v[84:87],a[196:199],a[212:215],v[84:87]
ds_read_b128 a[204:207],v248 offset:26112
v_sub_f32 v235,v235,v233
M v[84:87],a[228:231],v[224:227],v[84:87]
ds_read_b128 a[216:219],v249 offset:26112
v_add_f32 v233,v238,v234
M v[88:91],a[228:231],a[212:215],v[88:91]
ds_read_b128 v[224:227],v248 offset:26624
v_sub_f32 v238,v238,v234
M v[88:91],a[196:199],a[232:235],v[88:91]
ds_read_b128 a[212:215],v249 offset:26624
v_fma_f32 v234,2.0,v235,v236
M v[88:91],a[224:227],a[208:211],v[88:91]
v_fmac_f32 v236,-2.0,v235
v_and_b32 v208,s42,v208
M v[92:95],a[224:227],v[220:223],v[92:95]
v_and_b32 v204,s42,v204
v_and_b32 v206,s42,v206
M v[92:95],a[196:199],a[208:211],v[92:95]
v_and_b32 v214,s42,v214
v_and_b32 v212,s42,v212
M v[92:95],a[228:231],a[232:235],v[92:95]
s_waitcnt lgkmcnt(3)
v_and_b32 v210,s42,v210
v_fmac_f32 v204,s43,v208
M v[96:99],v[228:231],a[204:207],v[96:99]
s_waitcnt vmcnt(8) lgkmcnt(2)
ds_read_b128 a[224:227],v248 offset:27136
v_fmac_f32 v214,4.0,v206
M v[96:99],a[240:243],a[216:219],v[96:99]
s_waitcnt vmcnt(7) lgkmcnt(2)
ds_read_b128 v[220:223],v249 offset:27136
v_fma_f32 v235,-4.0,v208,v212
M v[96:99],a[248:251],v[224:227],v[96:99]
s_waitcnt lgkmcnt(2)
v_fmac_f32 v204,s45,v212
v_fmac_f32 v214,s41,v210
M v[100:103],a[248:251],a[212:215],v[100:103]
v_sub_f32 v212,v212,v208
v_fma_f32 v208,-4.0,v206,v210
M v[100:103],a[240:243],v[224:227],v[100:103]
v_sub_f32 v210,v210,v206
v_add_f32 v206,v235,v208
M v[100:103],v[228:231],a[216:219],v[100:103]
v_sub_f32 v235,v235,v208
v_fma_f32 v208,2.0,v210,v212
M v[104:107],v[228:231],v[224:227],v[104:107]
ds_read_b128 a[196:199],v248 offset:27648
v_fmac_f32 v212,-2.0,v210
M v[104:107],a[240:243],a[212:215],v[104:107]
s_waitcnt lgkmcnt(2)
ds_read_b128 a[208:211],v249 offset:27648
v_cvt_pk_bf16_f32 v204,v232,v204
M v[104:107],a[248:251],a[224:227],v[104:107]
s_waitcnt lgkmcnt(2)
v_cvt_pk_bf16_f32 v214,v237,v214
v_cvt_pk_bf16_f32 v206,v233,v206
M v[108:111],a[248:251],v[220:223],v[108:111]
v_cvt_pk_bf16_f32 v210,v234,v208
v_cvt_pk_bf16_f32 v208,v238,v235
M v[108:111],a[240:243],a[224:227],v[108:111]
v_cvt_pk_bf16_f32 v212,v236,v212
v_lshlrev_b32 v234,16,v209
M v[108:111],v[228:231],a[212:215],v[108:111]
v_lshlrev_b32 v232,16,v205
v_lshlrev_b32 v233,16,v207
M v[112:115],v[228:231],a[224:227],v[112:115]
ds_read_b128 a[228:231],v249 offset:28160
v_lshlrev_b32 v237,16,v215
M v[112:115],a[240:243],v[220:223],v[112:115]
s_waitcnt lgkmcnt(2)
ds_read_b128 a[232:235],v248 offset:28160
v_lshlrev_b32 v236,16,v213
M v[112:115],a[248:251],a[196:199],v[112:115]
s_waitcnt lgkmcnt(2)
v_lshlrev_b32 v235,16,v211
v_fmac_f32 v232,s43,v234
M v[116:119],a[248:251],a[208:211],v[116:119]
v_fmac_f32 v237,4.0,v233
v_fma_f32 v238,-4.0,v234,v236
M v[116:119],a[240:243],a[196:199],v[116:119]
v_fmac_f32 v232,s45,v236
v_fmac_f32 v237,s41,v235
M v[116:119],v[228:231],v[220:223],v[116:119]
v_sub_f32 v236,v236,v234
v_fma_f32 v234,-4.0,v233,v235
M v[120:123],v[228:231],a[196:199],v[120:123]
v_sub_f32 v235,v235,v233
v_add_f32 v233,v238,v234
M v[120:123],a[240:243],a[208:211],v[120:123]
s_waitcnt lgkmcnt(1)
v_sub_f32 v238,v238,v234
v_fma_f32 v234,2.0,v235,v236
M v[120:123],a[248:251],a[228:231],v[120:123]
s_waitcnt lgkmcnt(0)
v_fmac_f32 v236,-2.0,v235
v_and_b32 v209,s42,v209
M v[124:127],a[248:251],a[232:235],v[124:127]
buffer_load_dwordx4 a[248:251],v250,s[20:23],s46 offen offset:1024 sc1
M v[124:127],a[240:243],a[228:231],v[124:127]
v_and_b32 v205,s42,v205
v_and_b32 v207,s42,v207
M v[124:127],v[228:231],a[208:211],v[124:127]
s_waitcnt vmcnt(7)
buffer_load_dwordx4 a[240:243],v250,s[20:23],s46 offen offset:2048 sc1
M v[128:131],a[252:255],a[204:207],v[128:131]
s_waitcnt vmcnt(7)
s_add_u32 s46,s77,18432
v_and_b32 v215,s42,v215
v_and_b32 v213,s42,v213
M v[128:131],a[200:203],a[216:219],v[128:131]
s_waitcnt vmcnt(6)
v_and_b32 v211,s42,v211
v_fmac_f32 v205,s43,v209
M v[128:131],a[220:223],v[224:227],v[128:131]
v_fmac_f32 v215,4.0,v207
v_fma_f32 v235,-4.0,v209,v213
M v[132:135],a[220:223],a[212:215],v[132:135]
buffer_load_dwordx4 v[228:231],v250,s[20:23],s46 offen offset:0 sc1
M v[132:135],a[200:203],v[224:227],v[132:135]
v_fmac_f32 v205,s45,v213
v_fmac_f32 v215,s41,v211
M v[132:135],a[252:255],a[216:219],v[132:135]
v_sub_f32 v213,v213,v209
v_fma_f32 v209,-4.0,v207,v211
M v[136:139],a[252:255],v[224:227],v[136:139]
v_sub_f32 v211,v211,v207
v_add_f32 v207,v235,v209
M v[136:139],a[200:203],a[212:215],v[136:139]
v_sub_f32 v235,v235,v209
v_fma_f32 v209,2.0,v211,v213
M v[136:139],a[220:223],a[224:227],v[136:139]
v_fmac_f32 v213,-2.0,v211
v_cvt_pk_bf16_f32 v205,v232,v205
M v[140:143],a[220:223],v[220:223],v[140:143]
v_cvt_pk_bf16_f32 v215,v237,v215
v_cvt_pk_bf16_f32 v207,v233,v207
M v[140:143],a[200:203],a[224:227],v[140:143]
v_cvt_pk_bf16_f32 v211,v234,v209
v_cvt_pk_bf16_f32 v209,v238,v235
M v[140:143],a[252:255],a[212:215],v[140:143]
v_cvt_pk_bf16_f32 v213,v236,v213
M v[144:147],a[252:255],a[224:227],v[144:147]
M v[144:147],a[200:203],v[220:223],v[144:147]
M v[144:147],a[220:223],a[196:199],v[144:147]
ds_write2st64_b64 v247,v[204:205],v[214:215] offset0:139 offset1:156
M v[148:151],a[220:223],a[208:211],v[148:151]
M v[148:151],a[200:203],a[196:199],v[148:151]
M v[148:151],a[252:255],v[220:223],v[148:151]
ds_write2st64_b64 v247,v[206:207],v[208:209] offset0:3 offset1:20
M v[152:155],a[252:255],a[196:199],v[152:155]
M v[152:155],a[200:203],a[208:211],v[152:155]
M v[152:155],a[220:223],a[228:231],v[152:155]
ds_write2st64_b64 v247,v[210:211],v[212:213] offset0:37 offset1:54
M v[156:159],a[220:223],a[232:235],v[156:159]
buffer_load_dwordx4 a[220:223],v250,s[20:23],s46 offen offset:1024 sc1
M v[156:159],a[200:203],a[228:231],v[156:159]
M v[156:159],a[252:255],a[208:211],v[156:159]
s_waitcnt vmcnt(7)
buffer_load_dwordx4 a[200:203],v250,s[20:23],s46 offen offset:2048 sc1
M v[160:163],v[216:219],a[204:207],v[160:163]
s_waitcnt vmcnt(7)
s_add_u32 s46,s77,27648
M v[160:163],a[192:195],a[216:219],v[160:163]
s_waitcnt vmcnt(6)
M v[160:163],a[236:239],v[224:227],v[160:163]
M v[164:167],a[236:239],a[212:215],v[164:167]
buffer_load_dwordx4 a[252:255],v250,s[20:23],s46 offen offset:0 sc1
M v[164:167],a[192:195],v[224:227],v[164:167]
M v[164:167],v[216:219],a[216:219],v[164:167]
M v[168:171],v[216:219],v[224:227],v[168:171]
M v[168:171],a[192:195],a[212:215],v[168:171]
buffer_load_dwordx4 a[204:207],v250,s[20:23],s46 offen offset:1024 sc1
M v[168:171],a[236:239],a[224:227],v[168:171]
M v[172:175],a[236:239],v[220:223],v[172:175]
M v[172:175],a[192:195],a[224:227],v[172:175]
M v[172:175],v[216:219],a[212:215],v[172:175]
buffer_load_dwordx4 a[216:219],v250,s[20:23],s46 offen offset:2048 sc1
M v[176:179],v[216:219],a[224:227],v[176:179]
s_add_u32 s46,s77,36864
M v[176:179],a[192:195],v[220:223],v[176:179]
v_add_u32 v248,0xffffbc00,v248
v_add_u32 v249,0xffffbc00,v249
M v[176:179],a[236:239],a[196:199],v[176:179]
s_waitcnt lgkmcnt(0)
s_barrier
M v[180:183],a[236:239],a[208:211],v[180:183]
buffer_load_dwordx4 v[224:227],v250,s[20:23],s46 offen offset:0 sc1
M v[180:183],a[192:195],a[196:199],v[180:183]
ds_read_b128 a[212:215],v248 offset:0
M v[180:183],v[216:219],v[220:223],v[180:183]
ds_read_b128 a[224:227],v249 offset:0
M v[184:187],v[216:219],a[196:199],v[184:187]
ds_read_b128 v[220:223],v248 offset:512
M v[184:187],a[192:195],a[208:211],v[184:187]
ds_read_b128 a[196:199],v249 offset:512
M v[184:187],a[236:239],a[228:231],v[184:187]
M v[188:191],a[236:239],a[232:235],v[188:191]
buffer_load_dwordx4 a[232:235],v250,s[20:23],s46 offen offset:1024 sc1
M v[188:191],a[192:195],a[228:231],v[188:191]
M v[188:191],v[216:219],a[208:211],v[188:191]
s_waitcnt vmcnt(10) lgkmcnt(3)
buffer_load_dwordx4 a[236:239],v250,s[20:23],s46 offen offset:2048 sc1
M a[0:3],a[244:247],a[212:215],a[0:3]
s_waitcnt vmcnt(10) lgkmcnt(2)
s_add_u32 s47,s77,12288
ds_read_b128 a[228:231],v248 offset:1024
M a[0:3],a[248:251],a[224:227],a[0:3]
s_waitcnt vmcnt(9) lgkmcnt(2)
ds_read_b128 a[208:211],v249 offset:1024
M a[0:3],a[240:243],v[220:223],a[0:3]
s_waitcnt lgkmcnt(2)
M a[4:7],a[240:243],a[196:199],a[4:7]
buffer_load_dwordx4 a[192:195],v250,s[20:23],s47 offen offset:0 sc1
M a[4:7],a[248:251],v[220:223],a[4:7]
M a[4:7],a[244:247],a[224:227],a[4:7]
M a[8:11],a[244:247],v[220:223],a[8:11]
ds_read_b128 v[216:219],v248 offset:1536
M a[8:11],a[248:251],a[196:199],a[8:11]
s_waitcnt lgkmcnt(2)
ds_read_b128 a[212:215],v249 offset:1536
M a[8:11],a[240:243],a[228:231],a[8:11]
s_waitcnt lgkmcnt(2)
M a[12:15],a[240:243],a[208:211],a[12:15]
M a[12:15],a[248:251],a[228:231],a[12:15]
M a[12:15],a[244:247],a[196:199],a[12:15]
M a[16:19],a[244:247],a[228:231],a[16:19]
ds_read_b128 a[224:227],v249 offset:2048
M a[16:19],a[248:251],a[208:211],a[16:19]
s_waitcnt lgkmcnt(2)
ds_read_b128 v[220:223],v248 offset:2048
M a[16:19],a[240:243],v[216:219],a[16:19]
s_waitcnt lgkmcnt(2)
M a[20:23],a[240:243],a[212:215],a[20:23]
M a[20:23],a[248:251],v[216:219],a[20:23]
ds_read_b128 a[196:199],v248 offset:8704
M a[20:23],a[244:247],a[208:211],a[20:23]
ds_read_b128 a[228:231],v249 offset:8704
M a[24:27],a[244:247],v[216:219],a[24:27]
ds_read_b128 a[208:211],v248 offset:9216
M a[24:27],a[248:251],a[212:215],a[24:27]
s_waitcnt lgkmcnt(4)
ds_read_b128 v[216:219],v249 offset:9216
M a[24:27],a[240:243],a[224:227],a[24:27]
s_waitcnt lgkmcnt(4)
M a[28:31],a[240:243],v[220:223],a[28:31]
buffer_load_dwordx4 a[240:243],v250,s[20:23],s47 offen offset:1024 sc1
M a[28:31],a[248:251],a[224:227],a[28:31]
M a[28:31],a[244:247],a[212:215],a[28:31]
s_waitcnt vmcnt(10) lgkmcnt(3)
buffer_load_dwordx4 v[220:223],v250,s[20:23],s47 offen offset:2048 sc1
M a[96:99],v[228:231],a[196:199],a[96:99]
s_waitcnt vmcnt(10) lgkmcnt(2)
s_add_u32 s48,s77,15360
ds_read_b128 a[248:251],v248 offset:9728
M a[96:99],a[220:223],a[228:231],a[96:99]
s_waitcnt vmcnt(9) lgkmcnt(2)
ds_read_b128 a[212:215],v249 offset:9728
M a[96:99],a[200:203],a[208:211],a[96:99]
s_waitcnt lgkmcnt(2)
M a[100:103],a[200:203],v[216:219],a[100:103]
buffer_load_dwordx4 a[224:227],v250,s[20:23],s48 offen offset:0 sc1
M a[100:103],a[220:223],a[208:211],a[100:103]
M a[100:103],v[228:231],a[228:231],a[100:103]
M a[104:107],v[228:231],a[208:211],a[104:107]
ds_read_b128 a[244:247],v248 offset:10240
M a[104:107],a[220:223],v[216:219],a[104:107]
s_waitcnt lgkmcnt(2)
ds_read_b128 a[196:199],v249 offset:10240
M a[104:107],a[200:203],a[248:251],a[104:107]
s_waitcnt lgkmcnt(2)
M a[108:111],a[200:203],a[212:215],a[108:111]
M a[108:111],a[220:223],a[248:251],a[108:111]
M a[108:111],v[228:231],v[216:219],a[108:111]
M a[112:115],v[228:231],a[248:251],a[112:115]
ds_read_b128 a[228:231],v249 offset:10752
M a[112:115],a[220:223],a[212:215],a[112:115]
s_waitcnt lgkmcnt(2)
ds_read_b128 a[208:211],v248 offset:10752
M a[112:115],a[200:203],a[244:247],a[112:115]
s_waitcnt lgkmcnt(2)
M a[116:119],a[200:203],a[196:199],a[116:119]
M a[116:119],a[220:223],a[244:247],a[116:119]
ds_read_b128 v[216:219],v248 offset:17408
M a[116:119],v[228:231],a[212:215],a[116:119]
ds_read_b128 a[248:251],v249 offset:17408
M a[120:123],v[228:231],a[244:247],a[120:123]
ds_read_b128 a[212:215],v248 offset:17920
M a[120:123],a[220:223],a[196:199],a[120:123]
s_waitcnt lgkmcnt(4)
ds_read_b128 a[244:247],v249 offset:17920
M a[120:123],a[200:203],a[228:231],a[120:123]
s_waitcnt lgkmcnt(4)
M a[124:127],a[200:203],a[208:211],a[124:127]
buffer_load_dwordx4 a[200:203],v250,s[20:23],s48 offen offset:1024 sc1
M a[124:127],a[220:223],a[228:231],a[124:127]
M a[124:127],v[228:231],a[196:199],a[124:127]
s_waitcnt vmcnt(10) lgkmcnt(3)
buffer_load_dwordx4 a[208:211],v250,s[20:23],s48 offen offset:2048 sc1
M v[0:3],a[252:255],v[216:219],v[0:3]
s_waitcnt vmcnt(10) lgkmcnt(2)
s_add_u32 s47,s77,21504
ds_read_b128 a[228:231],v248 offset:18432
M v[0:3],a[204:207],a[248:251],v[0:3]
s_waitcnt vmcnt(9) lgkmcnt(2)
ds_read_b128 a[196:199],v249 offset:18432
M v[0:3],a[216:219],a[212:215],v[0:3]
s_waitcnt lgkmcnt(2)
M v[4:7],a[216:219],a[244:247],v[4:7]
buffer_load_dwordx4 a[220:223],v250,s[20:23],s47 offen offset:0 sc1
M v[4:7],a[204:207],a[212:215],v[4:7]
M v[4:7],a[252:255],a[248:251],v[4:7]
M v[8:11],a[252:255],a[212:215],v[8:11]
ds_read_b128 v[228:231],v248 offset:18944
M v[8:11],a[204:207],a[244:247],v[8:11]
s_waitcnt lgkmcnt(2)
ds_read_b128 v[216:219],v249 offset:18944
M v[8:11],a[216:219],a[228:231],v[8:11]
s_waitcnt lgkmcnt(2)
M v[12:15],a[216:219],a[196:199],v[12:15]
M v[12:15],a[204:207],a[228:231],v[12:15]
M v[12:15],a[252:255],a[244:247],v[12:15]
M v[16:19],a[252:255],a[228:231],v[16:19]
ds_read_b128 a[248:251],v249 offset:19456
M v[16:19],a[204:207],a[196:199],v[16:19]
s_waitcnt lgkmcnt(2)
ds_read_b128 a[212:215],v248 offset:19456
M v[16:19],a[216:219],v[228:231],v[16:19]
s_waitcnt lgkmcnt(2)
M v[20:23],a[216:219],v[216:219],v[20:23]
M v[20:23],a[204:207],v[228:231],v[20:23]
ds_read_b128 a[244:247],v248 offset:26112
M v[20:23],a[252:255],a[196:199],v[20:23]
ds_read_b128 a[228:231],v249 offset:26112
M v[24:27],a[252:255],v[228:231],v[24:27]
ds_read_b128 a[196:199],v248 offset:26624
M v[24:27],a[204:207],v[216:219],v[24:27]
s_waitcnt lgkmcnt(4)
ds_read_b128 v[228:231],v249 offset:26624
M v[24:27],a[216:219],a[248:251],v[24:27]
s_waitcnt lgkmcnt(4)
M v[28:31],a[216:219],a[212:215],v[28:31]
buffer_load_dwordx4 a[212:215],v250,s[20:23],s47 offen offset:1024 sc1
M v[28:31],a[204:207],a[248:251],v[28:31]
M v[28:31],a[252:255],v[216:219],v[28:31]
s_waitcnt vmcnt(10) lgkmcnt(3)
buffer_load_dwordx4 a[216:219],v250,s[20:23],s47 offen offset:2048 sc1
M v[96:99],v[224:227],a[244:247],v[96:99]
s_waitcnt vmcnt(10) lgkmcnt(2)
s_add_u32 s48,s77,24576
ds_read_b128 a[248:251],v248 offset:27136
M v[96:99],a[232:235],a[228:231],v[96:99]
s_waitcnt vmcnt(9) lgkmcnt(2)
ds_read_b128 a[252:255],v249 offset:27136
M v[96:99],a[236:239],a[196:199],v[96:99]
s_waitcnt lgkmcnt(2)
M v[100:103],a[236:239],v[228:231],v[100:103]
buffer_load_dwordx4 a[204:207],v250,s[20:23],s48 offen offset:0 sc1
M v[100:103],a[232:235],a[196:199],v[100:103]
M v[100:103],v[224:227],a[228:231],v[100:103]
v_accvgpr_read_b32 v238,a0
v_accvgpr_read_b32 v232,a96
M v[104:107],v[224:227],a[196:199],v[104:107]
ds_read_b128 v[216:219],v248 offset:27648
v_add_f32 v234,v238,v232
M v[104:107],a[232:235],v[228:231],v[104:107]
s_waitcnt lgkmcnt(2)
ds_read_b128 a[244:247],v249 offset:27648
v_sub_f32 v238,v238,v232
M v[104:107],a[236:239],a[248:251],v[104:107]
s_waitcnt lgkmcnt(2)
v_add_f32 v232,v0,v96
v_sub_f32 v96,v0,v96
M v[108:111],a[236:239],a[252:255],v[108:111]
v_add_f32 v0,v234,v232
v_fmac_f32 v234,4.0,v232
M v[108:111],a[232:235],a[248:251],v[108:111]
v_fma_f32 v232,2.0,v96,v238
v_fma_f32 v96,s40,v96,v238
M v[108:111],v[224:227],v[228:231],v[108:111]
v_accvgpr_read_b32 v238,a1
v_accvgpr_read_b32 v237,a97
M v[112:115],v[224:227],a[248:251],v[112:115]
ds_read_b128 a[228:231],v249 offset:28160
v_add_f32 v236,v238,v237
M v[112:115],a[232:235],a[252:255],v[112:115]
s_waitcnt lgkmcnt(2)
ds_read_b128 a[196:199],v248 offset:28160
v_sub_f32 v238,v238,v237
M v[112:115],a[236:239],v[216:219],v[112:115]
s_waitcnt lgkmcnt(2)
v_add_f32 v237,v1,v97
v_sub_f32 v97,v1,v97
M v[116:119],a[236:239],a[244:247],v[116:119]
v_add_f32 v1,v236,v237
v_fmac_f32 v236,4.0,v237
M v[116:119],a[232:235],v[216:219],v[116:119]
ds_read_b128 v[228:231],v248 offset:0
v_fma_f32 v237,2.0,v97,v238
M v[116:119],v[224:227],a[252:255],v[116:119]
ds_read_b128 a[248:251],v249 offset:0
v_fma_f32 v97,s40,v97,v238
M v[120:123],v[224:227],v[216:219],v[120:123]
ds_read_b128 a[252:255],v248 offset:512
v_cvt_pk_bf16_f32 v232,v232,v237
M v[120:123],a[232:235],a[244:247],v[120:123]
s_waitcnt lgkmcnt(4)
ds_read_b128 v[216:219],v249 offset:512
v_cvt_pk_bf16_f32 v234,v234,v236
M v[120:123],a[236:239],a[228:231],v[120:123]
s_waitcnt lgkmcnt(4)
v_accvgpr_read_b32 v238,a2
v_accvgpr_read_b32 v233,a98
M v[124:127],a[236:239],a[196:199],v[124:127]
buffer_load_dwordx4 a[196:199],v250,s[20:23],s48 offen offset:1024 sc1
M v[124:127],a[232:235],a[228:231],v[124:127]
v_add_f32 v235,v238,v233
v_sub_f32 v238,v238,v233
M v[124:127],v[224:227],a[244:247],v[124:127]
s_waitcnt vmcnt(10) lgkmcnt(3)
v_add_f32 v233,v2,v98
v_sub_f32 v98,v2,v98
M a[32:35],a[192:195],v[228:231],a[32:35]
s_waitcnt vmcnt(9) lgkmcnt(2)
ds_read_b128 a[236:239],v248 offset:1024
v_add_f32 v2,v235,v233
M a[32:35],a[240:243],a[248:251],a[32:35]
s_waitcnt vmcnt(8) lgkmcnt(2)
ds_read_b128 a[228:231],v249 offset:1024
v_fmac_f32 v235,4.0,v233
M a[32:35],v[220:223],a[252:255],a[32:35]
s_waitcnt lgkmcnt(2)
v_fma_f32 v233,2.0,v98,v238
v_fma_f32 v98,s40,v98,v238
M a[36:39],v[220:223],v[216:219],a[36:39]
v_accvgpr_read_b32 v238,a3
v_accvgpr_read_b32 v237,a99
M a[36:39],a[240:243],a[252:255],a[36:39]
v_add_f32 v236,v238,v237
v_sub_f32 v238,v238,v237
M a[36:39],a[192:195],a[248:251],a[36:39]
v_add_f32 v237,v3,v99
v_sub_f32 v99,v3,v99
M a[40:43],a[192:195],a[252:255],a[40:43]
ds_read_b128 a[96:99],v248 offset:1536
v_add_f32 v3,v236,v237
M a[40:43],a[240:243],v[216:219],a[40:43]
s_waitcnt lgkmcnt(2)
ds_read_b128 a[232:235],v249 offset:1536
v_fmac_f32 v236,4.0,v237
M a[40:43],v[220:223],a[236:239],a[40:43]
s_waitcnt lgkmcnt(2)
v_fma_f32 v237,2.0,v99,v238
v_fma_f32 v99,s40,v99,v238
M a[44:47],v[220:223],a[228:231],a[44:47]
v_cvt_pk_bf16_f32 v233,v233,v237
v_cvt_pk_bf16_f32 v235,v235,v236
M a[44:47],a[240:243],a[236:239],a[44:47]
ds_write2st64_b64 v254,v[232:233],v[234:235] offset0:68 offset1:72
M a[44:47],a[192:195],v[216:219],a[44:47]
v_accvgpr_read_b32 v238,a4
v_accvgpr_read_b32 v232,a100
M a[48:51],a[192:195],a[236:239],a[48:51]
ds_read_b128 a[244:247],v249 offset:2048
v_add_f32 v234,v238,v232
M a[48:51],a[240:243],a[228:231],a[48:51]
s_waitcnt lgkmcnt(3)
ds_read_b128 v[224:227],v248 offset:2048
v_sub_f32 v238,v238,v232
M a[48:51],v[220:223],a[96:99],a[48:51]
s_waitcnt lgkmcnt(3)
v_add_f32 v232,v4,v100
v_sub_f32 v100,v4,v100
M a[52:55],v[220:223],a[232:235],a[52:55]
v_add_f32 v4,v234,v232
v_fmac_f32 v234,4.0,v232
M a[52:55],a[240:243],a[96:99],a[52:55]
v_fma_f32 v232,2.0,v100,v238
v_fma_f32 v100,s40,v100,v238
M a[52:55],a[192:195],a[228:231],a[52:55]
v_accvgpr_read_b32 v238,a5
v_accvgpr_read_b32 v237,a101
M a[56:59],a[192:195],a[96:99],a[56:59]
v_add_f32 v236,v238,v237
v_sub_f32 v238,v238,v237
M a[56:59],a[240:243],a[232:235],a[56:59]
s_waitcnt lgkmcnt(1)
v_add_f32 v237,v5,v101
v_sub_f32 v101,v5,v101
M a[56:59],v[220:223],a[244:247],a[56:59]
s_waitcnt lgkmcnt(0)
v_add_f32 v5,v236,v237
v_fmac_f32 v236,4.0,v237
M a[60:63],v[220:223],v[224:227],a[60:63]
buffer_load_dwordx4 v[220:223],v250,s[20:23],s48 offen offset:2048 sc1
M a[60:63],a[240:243],a[244:247],a[60:63]
s_add_u32 s47,s77,30720
v_fma_f32 v237,2.0,v101,v238
v_fma_f32 v101,s40,v101,v238
M a[60:63],a[192:195],a[232:235],a[60:63]
s_waitcnt vmcnt(8)
buffer_load_dwordx4 a[240:243],v250,s[20:23],s47 offen offset:0 sc1
M a[64:67],a[224:227],v[228:231],a[64:67]
s_waitcnt vmcnt(8)
v_cvt_pk_bf16_f32 v232,v232,v237
v_cvt_pk_bf16_f32 v234,v234,v236
M a[64:67],a[200:203],a[248:251],a[64:67]
s_waitcnt vmcnt(7)
v_accvgpr_read_b32 v238,a6
v_accvgpr_read_b32 v233,a102
M a[64:67],a[208:211],a[252:255],a[64:67]
v_add_f32 v235,v238,v233
v_sub_f32 v238,v238,v233
M a[68:71],a[208:211],v[216:219],a[68:71]
buffer_load_dwordx4 a[192:195],v250,s[20:23],s47 offen offset:1024 sc1
M a[68:71],a[200:203],a[252:255],a[68:71]
v_add_f32 v233,v6,v102
v_sub_f32 v102,v6,v102
M a[68:71],a[224:227],a[248:251],a[68:71]
v_add_f32 v6,v235,v233
v_fmac_f32 v235,4.0,v233
M a[72:75],a[224:227],a[252:255],a[72:75]
v_fma_f32 v233,2.0,v102,v238
v_fma_f32 v102,s40,v102,v238
M a[72:75],a[200:203],v[216:219],a[72:75]
buffer_load_dwordx4 v[228:231],v250,s[20:23],s47 offen offset:2048 sc1
M a[72:75],a[208:211],a[236:239],a[72:75]
s_add_u32 s48,s77,33792
v_accvgpr_read_b32 v238,a7
v_accvgpr_read_b32 v237,a103
M a[76:79],a[208:211],a[228:231],a[76:79]
v_add_f32 v236,v238,v237
v_sub_f32 v238,v238,v237
M a[76:79],a[200:203],a[236:239],a[76:79]
v_add_f32 v237,v7,v103
v_sub_f32 v103,v7,v103
M a[76:79],a[224:227],v[216:219],a[76:79]
buffer_load_dwordx4 a[248:251],v250,s[20:23],s48 offen offset:0 sc1
M a[80:83],a[224:227],a[236:239],a[80:83]
v_add_f32 v7,v236,v237
v_fmac_f32 v236,4.0,v237
M a[80:83],a[200:203],a[228:231],a[80:83]
v_fma_f32 v237,2.0,v103,v238
v_fma_f32 v103,s40,v103,v238
M a[80:83],a[208:211],a[96:99],a[80:83]
v_cvt_pk_bf16_f32 v233,v233,v237
v_cvt_pk_bf16_f32 v235,v235,v236
M a[84:87],a[208:211],a[232:235],a[84:87]
buffer_load_dwordx4 a[252:255],v250,s[20:23],s48 offen offset:1024 sc1
M a[84:87],a[200:203],a[96:99],a[84:87]
ds_read_b128 v[216:219],v248 offset:8704
ds_write2st64_b64 v254,v[232:233],v[234:235] offset0:76 offset1:80
M a[84:87],a[224:227],a[228:231],a[84:87]
ds_read_b128 a[236:239],v249 offset:8704
v_accvgpr_read_b32 v238,a8
M a[88:91],a[224:227],a[96:99],a[88:91]
buffer_load_dwordx4 a[100:103],v250,s[20:23],s48 offen offset:2048 sc1
M a[88:91],a[200:203],a[232:235],a[88:91]
ds_read_b128 a[96:99],v248 offset:9216
ds_read_b128 a[228:231],v249 offset:9216
M a[88:91],a[208:211],a[244:247],a[88:91]
v_accvgpr_read_b32 v232,a104
v_add_f32 v234,v238,v232
M a[92:95],a[208:211],v[224:227],a[92:95]
v_sub_f32 v238,v238,v232
v_add_f32 v232,v8,v104
M a[92:95],a[200:203],a[244:247],a[92:95]
v_sub_f32 v104,v8,v104
v_add_f32 v8,v234,v232
M a[92:95],a[224:227],a[232:235],a[92:95]
s_waitcnt vmcnt(11) lgkmcnt(4)
v_fmac_f32 v234,4.0,v232
v_fma_f32 v232,2.0,v104,v238
M a[128:131],a[220:223],v[216:219],a[128:131]
s_waitcnt vmcnt(10) lgkmcnt(2)
ds_read_b128 a[208:211],v248 offset:9728
v_fma_f32 v104,s40,v104,v238
M a[128:131],a[212:215],a[236:239],a[128:131]
s_waitcnt vmcnt(9) lgkmcnt(2)
s_barrier
ds_read_b128 a[0:3],v250 offset:34816
M a[128:131],a[216:219],a[96:99],a[128:131]
s_waitcnt lgkmcnt(2)
ds_read_b128 a[4:7],v250 offset:38912
ds_read_b128 v[224:227],v249 offset:9728
M a[132:135],a[216:219],a[228:231],a[132:135]
v_accvgpr_read_b32 v238,a9
v_accvgpr_read_b32 v237,a105
M a[132:135],a[212:215],a[96:99],a[132:135]
v_add_f32 v236,v238,v237
v_sub_f32 v238,v238,v237
M a[132:135],a[220:223],a[236:239],a[132:135]
v_add_f32 v237,v9,v105
v_sub_f32 v105,v9,v105
M a[136:139],a[220:223],a[96:99],a[136:139]
s_add_u32 s34,s32,6291456
ds_read_b128 a[200:203],v248 offset:10240
v_add_f32 v9,v236,v237
M a[136:139],a[212:215],a[228:231],a[136:139]
s_waitcnt lgkmcnt(4)
ds_read_b128 a[244:247],v249 offset:10240
v_fmac_f32 v236,4.0,v237
M a[136:139],a[216:219],a[208:211],a[136:139]
s_waitcnt lgkmcnt(2)
buffer_store_dwordx4 a[0:3],v253,s[24:27],s34 offen offset:384 nt
M a[140:143],a[216:219],v[224:227],a[140:143]
v_fma_f32 v237,2.0,v105,v238
v_fma_f32 v105,s40,v105,v238
M a[140:143],a[212:215],a[208:211],a[140:143]
v_cvt_pk_bf16_f32 v232,v232,v237
v_cvt_pk_bf16_f32 v234,v234,v236
M a[140:143],a[220:223],a[228:231],a[140:143]
v_accvgpr_read_b32 v238,a10
v_accvgpr_read_b32 v233,a106
M a[144:147],a[220:223],a[208:211],a[144:147]
ds_read_b128 a[224:227],v249 offset:10752
v_add_f32 v235,v238,v233
M a[144:147],a[212:215],v[224:227],a[144:147]
s_waitcnt lgkmcnt(2)
ds_read_b128 a[232:235],v248 offset:10752
v_sub_f32 v238,v238,v233
M a[144:147],a[216:219],a[200:203],a[144:147]
s_waitcnt lgkmcnt(2)
v_add_f32 v233,v10,v106
v_sub_f32 v106,v10,v106
M a[148:151],a[216:219],a[244:247],a[148:151]
s_add_u32 s47,s77,39936
v_add_f32 v10,v235,v233
v_fmac_f32 v235,4.0,v233
M a[148:151],a[212:215],a[200:203],a[148:151]
v_fma_f32 v233,2.0,v106,v238
v_fma_f32 v106,s40,v106,v238
M a[148:151],a[220:223],v[224:227],a[148:151]
v_accvgpr_read_b32 v238,a11
v_accvgpr_read_b32 v237,a107
M a[152:155],a[220:223],a[200:203],a[152:155]
v_add_f32 v236,v238,v237
v_sub_f32 v238,v238,v237
M a[152:155],a[212:215],a[244:247],a[152:155]
s_waitcnt lgkmcnt(1)
v_add_f32 v237,v11,v107
v_sub_f32 v107,v11,v107
M a[152:155],a[216:219],a[224:227],a[152:155]
s_waitcnt lgkmcnt(0)
v_add_f32 v11,v236,v237
v_fmac_f32 v236,4.0,v237
M a[156:159],a[216:219],a[232:235],a[156:159]
buffer_load_dwordx4 a[104:107],v250,s[20:23],s47 offen offset:0 sc1
M a[156:159],a[212:215],a[224:227],a[156:159]
v_fma_f32 v237,2.0,v107,v238
v_fma_f32 v107,s40,v107,v238
M a[156:159],a[220:223],a[244:247],a[156:159]
s_waitcnt vmcnt(10)
buffer_load_dwordx4 a[216:219],v250,s[20:23],s47 offen offset:1024 sc1
M a[160:163],a[204:207],v[216:219],a[160:163]
s_waitcnt vmcnt(10)
v_cvt_pk_bf16_f32 v233,v233,v237
v_cvt_pk_bf16_f32 v235,v235,v236
M a[160:163],a[196:199],a[236:239],a[160:163]
s_waitcnt vmcnt(9)
ds_write2st64_b64 v254,v[232:233],v[234:235] offset0:85 offset1:89
M a[160:163],v[220:223],a[96:99],a[160:163]
v_accvgpr_read_b32 v204,a12
v_accvgpr_read_b32 v208,a108
M a[164:167],v[220:223],a[228:231],a[164:167]
buffer_load_dwordx4 a[212:215],v250,s[20:23],s47 offen offset:2048 sc1
M a[164:167],a[196:199],a[96:99],a[164:167]
s_add_u32 s48,s77,43008
s_add_u32 s34,s32,6488064
v_accvgpr_read_b32 v205,a13
M a[164:167],a[204:207],a[236:239],a[164:167]
v_accvgpr_read_b32 v209,a109
v_accvgpr_read_b32 v206,a14
M a[168:171],a[204:207],a[96:99],a[168:171]
v_accvgpr_read_b32 v210,a110
v_accvgpr_read_b32 v207,a15
v_accvgpr_read_b32 v211,a111
v_pk_add_f32 v[212:213],v[204:205],v[208:209]
v_pk_add_f32 v[214:215],v[206:207],v[210:211]
v_pk_add_f32 v[204:205],v[204:205],v[208:209] neg_lo:[0,1] neg_hi:[0,1]
v_pk_add_f32 v[206:207],v[206:207],v[210:211] neg_lo:[0,1] neg_hi:[0,1]
v_pk_add_f32 v[208:209],v[12:13],v[108:109]
v_pk_add_f32 v[210:211],v[14:15],v[110:111]
v_pk_add_f32 v[108:109],v[12:13],v[108:109] neg_lo:[0,1] neg_hi:[0,1]
v_pk_add_f32 v[110:111],v[14:15],v[110:111] neg_lo:[0,1] neg_hi:[0,1]
v_pk_add_f32 v[12:13],v[212:213],v[208:209]
v_pk_add_f32 v[14:15],v[214:215],v[210:211]
v_pk_fma_f32 v[212:213],v[208:209],4.0,v[212:213] op_sel_hi:[1,0,1]
v_pk_fma_f32 v[214:215],v[210:211],4.0,v[214:215] op_sel_hi:[1,0,1]
v_pk_fma_f32 v[208:209],v[108:109],2.0,v[204:205] op_sel_hi:[1,0,1]
v_pk_fma_f32 v[210:211],v[110:111],2.0,v[206:207] op_sel_hi:[1,0,1]
v_pk_fma_f32 v[108:109],v[108:109],s[40:41],v[204:205] op_sel_hi:[1,0,1]
v_pk_fma_f32 v[110:111],v[110:111],s[40:41],v[206:207] op_sel_hi:[1,0,1]
M a[168:171],a[196:199],a[228:231],a[168:171]
buffer_load_dwordx4 a[220:223],v250,s[20:23],s48 offen offset:0 sc1
M a[168:171],v[220:223],a[208:211],a[168:171]
v_cvt_pk_bf16_f32 v208,v208,v209
v_cvt_pk_bf16_f32 v209,v210,v211
M a[172:175],v[220:223],v[224:227],a[172:175]
buffer_load_dwordx4 v[216:219],v250,s[20:23],s48 offen offset:1024 sc1
M a[172:175],a[196:199],a[208:211],a[172:175]
v_cvt_pk_bf16_f32 v212,v212,v213
v_cvt_pk_bf16_f32 v213,v214,v215
M a[172:175],a[204:207],a[228:231],a[172:175]
ds_write2st64_b64 v254,v[208:209],v[212:213] offset0:93 offset1:97
M a[176:179],a[204:207],a[208:211],a[176:179]
v_accvgpr_read_b32 v238,a16
v_accvgpr_read_b32 v232,a112
M a[176:179],a[196:199],v[224:227],a[176:179]
buffer_load_dwordx4 a[236:239],v250,s[20:23],s48 offen offset:2048 sc1
M a[176:179],v[220:223],a[200:203],a[176:179]
s_add_u32 s46,s72,0
v_add_f32 v234,v238,v232
v_sub_f32 v238,v238,v232
M a[180:183],v[220:223],a[244:247],a[180:183]
v_add_f32 v232,v16,v112
v_sub_f32 v112,v16,v112
M a[180:183],a[196:199],a[200:203],a[180:183]
ds_read_b128 a[228:231],v248 offset:17408
v_add_f32 v16,v234,v232
M a[180:183],a[204:207],v[224:227],a[180:183]
buffer_store_dwordx4 a[4:7],v253,s[24:27],s34 offen offset:384 nt
M a[184:187],a[204:207],a[200:203],a[184:187]
ds_read_b128 a[208:211],v249 offset:17408
ds_read_b128 v[224:227],v248 offset:17920
M a[184:187],a[196:199],a[244:247],a[184:187]
ds_read_b128 a[200:203],v249 offset:17920
v_fmac_f32 v234,4.0,v232
M a[184:187],v[220:223],a[224:227],a[184:187]
buffer_load_dwordx4 a[96:99],v250,s[20:23],s46 offen offset:0 sc1
M a[188:191],v[220:223],a[232:235],a[188:191]
v_fma_f32 v232,2.0,v112,v238
v_fma_f32 v112,s40,v112,v238
M a[188:191],a[196:199],a[224:227],a[188:191]
s_waitcnt lgkmcnt(4)
s_barrier
ds_read_b128 a[8:11],v250 offset:43520
M a[188:191],a[204:207],a[244:247],a[188:191]
s_waitcnt vmcnt(14) lgkmcnt(4)
ds_read_b128 a[12:15],v250 offset:47616
v_accvgpr_read_b32 v238,a17
M v[32:35],a[240:243],a[228:231],v[32:35]
s_waitcnt vmcnt(13) lgkmcnt(4)
buffer_load_dwordx4 a[108:111],v250,s[20:23],s46 offen offset:1024 sc1
M v[32:35],a[192:195],a[208:211],v[32:35]
s_waitcnt vmcnt(13) lgkmcnt(3)
ds_read_b128 a[232:235],v248 offset:18432
ds_read_b128 v[220:223],v249 offset:18432
M v[32:35],v[228:231],v[224:227],v[32:35]
s_waitcnt lgkmcnt(4)
v_accvgpr_read_b32 v237,a113
v_add_f32 v236,v238,v237
M v[36:39],v[228:231],a[200:203],v[36:39]
s_add_u32 s34,s32,6684672
v_sub_f32 v238,v238,v237
v_add_f32 v237,v17,v113
M v[36:39],a[192:195],v[224:227],v[36:39]
v_sub_f32 v113,v17,v113
v_add_f32 v17,v236,v237
M v[36:39],a[240:243],a[208:211],v[36:39]
s_waitcnt lgkmcnt(3)
buffer_store_dwordx4 a[8:11],v253,s[24:27],s34 offen offset:384 nt
M v[40:43],a[240:243],v[224:227],v[40:43]
ds_read_b128 a[196:199],v248 offset:18944
v_fmac_f32 v236,4.0,v237
M v[40:43],a[192:195],a[200:203],v[40:43]
s_waitcnt lgkmcnt(2)
ds_read_b128 a[224:227],v249 offset:18944
v_fma_f32 v237,2.0,v113,v238
M v[40:43],v[228:231],a[232:235],v[40:43]
s_waitcnt lgkmcnt(2)
v_fma_f32 v113,s40,v113,v238
v_cvt_pk_bf16_f32 v232,v232,v237
M v[44:47],v[228:231],v[220:223],v[44:47]
v_cvt_pk_bf16_f32 v234,v234,v236
v_accvgpr_read_b32 v238,a18
M v[44:47],a[192:195],a[232:235],v[44:47]
v_accvgpr_read_b32 v233,a114
v_add_f32 v235,v238,v233
M v[44:47],a[240:243],a[200:203],v[44:47]
v_sub_f32 v238,v238,v233
v_add_f32 v233,v18,v114
M v[48:51],a[240:243],a[232:235],v[48:51]
ds_read_b128 a[204:207],v249 offset:19456
v_sub_f32 v114,v18,v114
M v[48:51],a[192:195],v[220:223],v[48:51]
s_waitcnt lgkmcnt(2)
ds_read_b128 a[244:247],v248 offset:19456
v_add_f32 v18,v235,v233
M v[48:51],v[228:231],a[196:199],v[48:51]
s_waitcnt lgkmcnt(2)
v_fmac_f32 v235,4.0,v233
v_fma_f32 v233,2.0,v114,v238
M v[52:55],v[228:231],a[224:227],v[52:55]
v_fma_f32 v114,s40,v114,v238
v_accvgpr_read_b32 v238,a19
M v[52:55],a[192:195],a[196:199],v[52:55]
v_accvgpr_read_b32 v237,a115
v_add_f32 v236,v238,v237
M v[52:55],a[240:243],v[220:223],v[52:55]
v_sub_f32 v238,v238,v237
v_add_f32 v237,v19,v115
M v[56:59],a[240:243],a[196:199],v[56:59]
v_sub_f32 v115,v19,v115
v_add_f32 v19,v236,v237
M v[56:59],a[192:195],a[224:227],v[56:59]
s_waitcnt lgkmcnt(1)
v_fmac_f32 v236,4.0,v237
v_fma_f32 v237,2.0,v115,v238
M v[56:59],v[228:231],a[204:207],v[56:59]
s_waitcnt lgkmcnt(0)
v_fma_f32 v115,s40,v115,v238
v_cvt_pk_bf16_f32 v233,v233,v237
M v[60:63],v[228:231],a[244:247],v[60:63]
buffer_load_dwordx4 a[112:115],v250,s[20:23],s46 offen offset:2048 sc1
M v[60:63],a[192:195],a[204:207],v[60:63]
s_add_u32 s46,s73,0
v_cvt_pk_bf16_f32 v235,v235,v236
M v[60:63],a[240:243],a[224:227],v[60:63]
s_waitcnt vmcnt(14)
buffer_load_dwordx4 v[228:231],v250,s[20:23],s46 offen offset:0 sc1
M v[64:67],a[248:251],a[228:231],v[64:67]
s_waitcnt vmcnt(14)
s_add_u32 s34,s32,6881280
ds_write2st64_b64 v254,v[232:233],v[234:235] offset0:68 offset1:72
M v[64:67],a[252:255],a[208:211],v[64:67]
s_waitcnt vmcnt(13)
v_accvgpr_read_b32 v238,a20
v_accvgpr_read_b32 v232,a116
M v[64:67],a[100:103],v[224:227],v[64:67]
v_add_f32 v234,v238,v232
v_sub_f32 v238,v238,v232
M v[68:71],a[100:103],a[200:203],v[68:71]
buffer_load_dwordx4 a[192:195],v250,s[20:23],s46 offen offset:1024 sc1
M v[68:71],a[252:255],v[224:227],v[68:71]
v_add_f32 v232,v20,v116
v_sub_f32 v116,v20,v116
M v[68:71],a[248:251],a[208:211],v[68:71]
v_add_f32 v20,v234,v232
v_fmac_f32 v234,4.0,v232
M v[72:75],a[248:251],v[224:227],v[72:75]
v_fma_f32 v232,2.0,v116,v238
v_fma_f32 v116,s40,v116,v238
M v[72:75],a[252:255],a[200:203],v[72:75]
buffer_load_dwordx4 a[240:243],v250,s[20:23],s46 offen offset:2048 sc1
M v[72:75],a[100:103],a[232:235],v[72:75]
s_add_u32 s46,s74,0
v_accvgpr_read_b32 v238,a21
v_accvgpr_read_b32 v237,a117
M v[76:79],a[100:103],v[220:223],v[76:79]
v_add_f32 v236,v238,v237
v_sub_f32 v238,v238,v237
M v[76:79],a[252:255],a[232:235],v[76:79]
v_add_f32 v237,v21,v117
v_sub_f32 v117,v21,v117
M v[76:79],a[248:251],a[200:203],v[76:79]
buffer_store_dwordx4 a[12:15],v253,s[24:27],s34 offen offset:384 nt
M v[80:83],a[248:251],a[232:235],v[80:83]
v_add_f32 v21,v236,v237
v_fmac_f32 v236,4.0,v237
M v[80:83],a[252:255],v[220:223],v[80:83]
v_fma_f32 v237,2.0,v117,v238
v_fma_f32 v117,s40,v117,v238
M v[80:83],a[100:103],a[196:199],v[80:83]
buffer_load_dwordx4 a[228:231],v250,s[20:23],s46 offen offset:0 sc1
M v[84:87],a[100:103],a[224:227],v[84:87]
v_cvt_pk_bf16_f32 v232,v232,v237
v_cvt_pk_bf16_f32 v234,v234,v236
M v[84:87],a[252:255],a[196:199],v[84:87]
ds_read_b128 a[200:203],v248 offset:26112
v_accvgpr_read_b32 v238,a22
M v[84:87],a[248:251],v[220:223],v[84:87]
ds_read_b128 a[232:235],v249 offset:26112
v_accvgpr_read_b32 v233,a118
M v[88:91],a[248:251],a[196:199],v[88:91]
buffer_load_dwordx4 a[208:211],v250,s[20:23],s46 offen offset:1024 sc1
M v[88:91],a[252:255],a[224:227],v[88:91]
ds_read_b128 v[220:223],v248 offset:26624
ds_read_b128 a[196:199],v249 offset:26624
M v[88:91],a[100:103],a[204:207],v[88:91]
v_add_f32 v235,v238,v233
v_sub_f32 v238,v238,v233
M v[92:95],a[100:103],a[244:247],v[92:95]
v_add_f32 v233,v22,v118
v_sub_f32 v118,v22,v118
M v[92:95],a[252:255],a[204:207],v[92:95]
buffer_load_dwordx4 v[224:227],v250,s[20:23],s46 offen offset:2048 sc1
M v[92:95],a[248:251],a[224:227],v[92:95]
s_waitcnt vmcnt(17) lgkmcnt(3)
s_add_u32 s46,s75,0
v_add_f32 v22,v235,v233
v_fmac_f32 v235,4.0,v233
M v[128:131],a[104:107],a[200:203],v[128:131]
s_waitcnt vmcnt(16) lgkmcnt(2)
ds_read_b128 a[244:247],v248 offset:27136
v_fma_f32 v233,2.0,v118,v238
M v[128:131],a[216:219],a[232:235],v[128:131]
s_waitcnt vmcnt(15) lgkmcnt(2)
ds_read_b128 a[204:207],v249 offset:27136
v_fma_f32 v118,s40,v118,v238
M v[128:131],a[212:215],v[220:223],v[128:131]
s_waitcnt lgkmcnt(2)
buffer_load_dwordx4 a[100:103],v250,s[20:23],s46 offen offset:0 sc1
M v[132:135],a[212:215],a[196:199],v[132:135]
v_accvgpr_read_b32 v238,a23
v_accvgpr_read_b32 v237,a119
M v[132:135],a[216:219],v[220:223],v[132:135]
v_add_f32 v236,v238,v237
v_sub_f32 v238,v238,v237
M v[132:135],a[104:107],a[232:235],v[132:135]
v_add_f32 v237,v23,v119
v_sub_f32 v119,v23,v119
M v[136:139],a[104:107],v[220:223],v[136:139]
ds_read_b128 a[116:119],v248 offset:27648
v_add_f32 v23,v236,v237
M v[136:139],a[216:219],a[196:199],v[136:139]
s_waitcnt lgkmcnt(2)
ds_read_b128 a[252:255],v249 offset:27648
v_fmac_f32 v236,4.0,v237
M v[136:139],a[212:215],a[244:247],v[136:139]
s_waitcnt lgkmcnt(2)
v_fma_f32 v237,2.0,v119,v238
v_fma_f32 v119,s40,v119,v238
M v[140:143],a[212:215],a[204:207],v[140:143]
v_cvt_pk_bf16_f32 v233,v233,v237
v_cvt_pk_bf16_f32 v235,v235,v236
M v[140:143],a[216:219],a[244:247],v[140:143]
ds_write2st64_b64 v254,v[232:233],v[234:235] offset0:76 offset1:80
M v[140:143],a[104:107],a[196:199],v[140:143]
v_accvgpr_read_b32 v238,a24
v_accvgpr_read_b32 v232,a120
M v[144:147],a[104:107],a[244:247],v[144:147]
ds_read_b128 a[224:227],v249 offset:28160
v_add_f32 v234,v238,v232
M v[144:147],a[216:219],a[204:207],v[144:147]
s_waitcnt lgkmcnt(3)
ds_read_b128 a[248:251],v248 offset:28160
v_sub_f32 v238,v238,v232
M v[144:147],a[212:215],a[116:119],v[144:147]
s_waitcnt lgkmcnt(3)
v_add_f32 v232,v24,v120
v_sub_f32 v120,v24,v120
M v[148:151],a[212:215],a[252:255],v[148:151]
v_add_f32 v24,v234,v232
v_fmac_f32 v234,4.0,v232
M v[148:151],a[216:219],a[116:119],v[148:151]
v_fma_f32 v232,2.0,v120,v238
v_fma_f32 v120,s40,v120,v238
M v[148:151],a[104:107],a[204:207],v[148:151]
s_waitcnt lgkmcnt(2)
s_barrier
ds_read_b128 a[16:19],v250 offset:34816
M v[152:155],a[104:107],a[116:119],v[152:155]
ds_read_b128 a[20:23],v250 offset:38912
v_accvgpr_read_b32 v238,a25
M v[152:155],a[216:219],a[252:255],v[152:155]
s_waitcnt lgkmcnt(3)
v_accvgpr_read_b32 v237,a121
v_add_f32 v236,v238,v237
M v[152:155],a[212:215],a[224:227],v[152:155]
s_waitcnt lgkmcnt(2)
v_sub_f32 v238,v238,v237
v_add_f32 v237,v25,v121
M v[156:159],a[212:215],a[248:251],v[156:159]
buffer_load_dwordx4 a[212:215],v250,s[20:23],s46 offen offset:1024 sc1
M v[156:159],a[216:219],a[224:227],v[156:159]
s_add_u32 s34,s32,7077888
v_sub_f32 v121,v25,v121
v_add_f32 v25,v236,v237
M v[156:159],a[104:107],a[252:255],v[156:159]
s_waitcnt vmcnt(16) lgkmcnt(1)
buffer_store_dwordx4 a[16:19],v253,s[24:27],s34 offen offset:384 nt
M v[160:163],a[220:223],a[200:203],v[160:163]
s_waitcnt vmcnt(16)
s_add_u32 s34,s32,7274496
v_fmac_f32 v236,4.0,v237
v_fma_f32 v237,2.0,v121,v238
M v[160:163],v[216:219],a[232:235],v[160:163]
s_waitcnt vmcnt(15)
v_fma_f32 v121,s40,v121,v238
v_cvt_pk_bf16_f32 v232,v232,v237
M v[160:163],a[236:239],v[220:223],v[160:163]
s_waitcnt lgkmcnt(0)
buffer_store_dwordx4 a[20:23],v253,s[24:27],s34 offen offset:384 nt
M v[164:167],a[236:239],a[196:199],v[164:167]
v_cvt_pk_bf16_f32 v234,v234,v236
v_accvgpr_read_b32 v238,a26
M v[164:167],v[216:219],v[220:223],v[164:167]
v_accvgpr_read_b32 v233,a122
v_add_f32 v235,v238,v233
M v[164:167],a[220:223],a[232:235],v[164:167]
buffer_load_dwordx4 a[216:219],v250,s[20:23],s46 offen offset:2048 sc1
M v[168:171],a[220:223],v[220:223],v[168:171]
s_add_u32 s46,s76,0
v_sub_f32 v238,v238,v233
v_add_f32 v233,v26,v122
M v[168:171],v[216:219],a[196:199],v[168:171]
v_sub_f32 v122,v26,v122
v_add_f32 v26,v235,v233
M v[168:171],a[236:239],a[244:247],v[168:171]
v_fmac_f32 v235,4.0,v233
v_fma_f32 v233,2.0,v122,v238
M v[172:175],a[236:239],a[204:207],v[172:175]
buffer_load_dwordx4 a[104:107],v250,s[20:23],s46 offen offset:0 sc1
M v[172:175],v[216:219],a[244:247],v[172:175]
v_fma_f32 v122,s40,v122,v238
v_accvgpr_read_b32 v238,a27
M v[172:175],a[220:223],a[196:199],v[172:175]
v_accvgpr_read_b32 v237,a123
v_add_f32 v236,v238,v237
M v[176:179],a[220:223],a[244:247],v[176:179]
v_sub_f32 v238,v238,v237
v_add_f32 v237,v27,v123
M v[176:179],v[216:219],a[204:207],v[176:179]
buffer_load_dwordx4 a[200:203],v250,s[20:23],s46 offen offset:1024 sc1
M v[176:179],a[236:239],a[116:119],v[176:179]
v_sub_f32 v123,v27,v123
v_add_f32 v27,v236,v237
M v[180:183],a[236:239],a[252:255],v[180:183]
v_fmac_f32 v236,4.0,v237
v_fma_f32 v237,2.0,v123,v238
M v[180:183],v[216:219],a[116:119],v[180:183]
ds_read_b128 a[120:123],v248 offset:52224
v_fma_f32 v123,s40,v123,v238
M v[180:183],a[220:223],a[204:207],v[180:183]
buffer_load_dwordx4 a[232:235],v250,s[20:23],s46 offen offset:2048 sc1
M v[184:187],a[220:223],a[116:119],v[184:187]
s_add_u32 s46,s77,0
ds_read_b128 a[196:199],v249 offset:52224
ds_read_b128 a[116:119],v248 offset:52736
M v[184:187],v[216:219],a[252:255],v[184:187]
ds_read_b128 a[244:247],v249 offset:52736
v_cvt_pk_bf16_f32 v233,v233,v237
M v[184:187],a[236:239],a[224:227],v[184:187]
v_cvt_pk_bf16_f32 v235,v235,v236
M v[188:191],a[236:239],a[248:251],v[188:191]
buffer_load_dwordx4 v[220:223],v250,s[20:23],s46 offen offset:0 sc1
M v[188:191],v[216:219],a[224:227],v[188:191]
ds_write2st64_b64 v254,v[232:233],v[234:235] offset0:85 offset1:89
M v[188:191],a[220:223],a[252:255],v[188:191]
s_waitcnt vmcnt(19) lgkmcnt(4)
v_accvgpr_read_b32 v204,a28
v_accvgpr_read_b32 v208,a124
M v[0:3],a[96:99],a[120:123],v[0:3]
s_waitcnt vmcnt(18) lgkmcnt(3)
ds_read_b128 a[120:123],v248 offset:53248
v_accvgpr_read_b32 v205,a29
M v[0:3],a[108:111],a[196:199],v[0:3]
s_waitcnt vmcnt(16) lgkmcnt(3)
buffer_load_dwordx4 a[204:207],v250,s[20:23],s46 offen offset:1024 sc1
M v[0:3],a[112:115],a[116:119],v[0:3]
s_waitcnt lgkmcnt(2)
ds_read_b128 a[220:223],v249 offset:53248
v_accvgpr_read_b32 v209,a125
M v[4:7],a[112:115],a[244:247],v[4:7]
v_accvgpr_read_b32 v206,a30
v_accvgpr_read_b32 v210,a126
v_accvgpr_read_b32 v207,a31
v_accvgpr_read_b32 v211,a127
v_pk_add_f32 v[212:213],v[204:205],v[208:209]
v_pk_add_f32 v[214:215],v[206:207],v[210:211]
v_pk_add_f32 v[204:205],v[204:205],v[208:209] neg_lo:[0,1] neg_hi:[0,1]
v_pk_add_f32 v[206:207],v[206:207],v[210:211] neg_lo:[0,1] neg_hi:[0,1]
v_pk_add_f32 v[208:209],v[28:29],v[124:125]
v_pk_add_f32 v[210:211],v[30:31],v[126:127]
v_pk_add_f32 v[124:125],v[28:29],v[124:125] neg_lo:[0,1] neg_hi:[0,1]
v_pk_add_f32 v[126:127],v[30:31],v[126:127] neg_lo:[0,1] neg_hi:[0,1]
v_pk_add_f32 v[28:29],v[212:213],v[208:209]
v_pk_add_f32 v[30:31],v[214:215],v[210:211]
v_pk_fma_f32 v[212:213],v[208:209],4.0,v[212:213] op_sel_hi:[1,0,1]
v_pk_fma_f32 v[214:215],v[210:211],4.0,v[214:215] op_sel_hi:[1,0,1]
v_pk_fma_f32 v[208:209],v[124:125],2.0,v[204:205] op_sel_hi:[1,0,1]
v_pk_fma_f32 v[210:211],v[126:127],2.0,v[206:207] op_sel_hi:[1,0,1]
v_pk_fma_f32 v[124:125],v[124:125],s[40:41],v[204:205] op_sel_hi:[1,0,1]
v_pk_fma_f32 v[126:127],v[126:127],s[40:41],v[206:207] op_sel_hi:[1,0,1]
M v[4:7],a[108:111],a[116:119],v[4:7]
buffer_load_dwordx4 a[236:239],v250,s[20:23],s46 offen offset:2048 sc1
M v[4:7],a[96:99],a[196:199],v[4:7]
s_add_u32 s46,s72,46080
v_cvt_pk_bf16_f32 v208,v208,v209
v_cvt_pk_bf16_f32 v209,v210,v211
M v[8:11],a[96:99],a[116:119],v[8:11]
buffer_load_dwordx4 a[248:251],v250,s[20:23],s46 offen offset:0 sc1
M v[8:11],a[108:111],a[244:247],v[8:11]
s_waitcnt lgkmcnt(1)
ds_read_b128 a[124:127],v248 offset:53760
ds_read_b128 a[116:119],v249 offset:53760
M v[8:11],a[112:115],a[120:123],v[8:11]
s_waitcnt lgkmcnt(2)
v_cvt_pk_bf16_f32 v212,v212,v213
v_cvt_pk_bf16_f32 v213,v214,v215
M v[12:15],a[112:115],a[220:223],v[12:15]
ds_write2st64_b64 v254,v[208:209],v[212:213] offset0:93 offset1:97
M v[12:15],a[108:111],a[120:123],v[12:15]
buffer_load_dwordx4 a[224:227],v250,s[20:23],s46 offen offset:1024 sc1
M v[12:15],a[96:99],a[244:247],v[12:15]
v_accvgpr_read_b32 v238,a32
v_accvgpr_read_b32 v232,a128
M v[16:19],a[96:99],a[120:123],v[16:19]
ds_read_b128 a[120:123],v249 offset:54272
v_add_f32 v234,v238,v232
M v[16:19],a[108:111],a[220:223],v[16:19]
s_waitcnt lgkmcnt(3)
ds_read_b128 a[252:255],v248 offset:54272
v_add_u32 v248,0x15400,v248
M v[16:19],a[112:115],a[124:127],v[16:19]
s_waitcnt lgkmcnt(3)
buffer_load_dwordx4 v[216:219],v250,s[20:23],s46 offen offset:2048 sc1
M v[20:23],a[112:115],a[116:119],v[20:23]
s_add_u32 s47,s72,49152
v_add_u32 v249,0x15400,v249
v_sub_f32 v238,v238,v232
M v[20:23],a[108:111],a[124:127],v[20:23]
ds_read_b128 a[196:199],v248 offset:0
v_add_f32 v232,v32,v128
M v[20:23],a[96:99],a[220:223],v[20:23]
ds_read_b128 a[244:247],v249 offset:0
v_sub_f32 v128,v32,v128
M v[24:27],a[96:99],a[124:127],v[24:27]
ds_read_b128 a[124:127],v248 offset:512
v_add_f32 v32,v234,v232
M v[24:27],a[108:111],a[116:119],v[24:27]
s_waitcnt lgkmcnt(4)
ds_read_b128 a[220:223],v249 offset:512
v_fmac_f32 v234,4.0,v232
M v[24:27],a[112:115],a[120:123],v[24:27]
s_waitcnt lgkmcnt(4)
v_fma_f32 v232,2.0,v128,v238
v_fma_f32 v128,s40,v128,v238
M v[28:31],a[112:115],a[252:255],v[28:31]
s_barrier
ds_read_b128 a[24:27],v250 offset:43520
M v[28:31],a[108:111],a[120:123],v[28:31]
ds_read_b128 a[28:31],v250 offset:47616
v_accvgpr_read_b32 v238,a33
M v[28:31],a[96:99],a[116:119],v[28:31]
s_waitcnt vmcnt(20) lgkmcnt(5)
buffer_load_dwordx4 a[112:115],v250,s[20:23],s47 offen offset:0 sc1
M v[0:3],v[228:231],a[196:199],v[0:3]
s_waitcnt vmcnt(20) lgkmcnt(4)
ds_read_b128 a[120:123],v248 offset:1024
v_accvgpr_read_b32 v237,a129
M v[0:3],a[192:195],a[244:247],v[0:3]
s_waitcnt vmcnt(19) lgkmcnt(4)
buffer_load_dwordx4 a[252:255],v250,s[20:23],s47 offen offset:1024 sc1
M v[0:3],a[240:243],a[124:127],v[0:3]
s_waitcnt lgkmcnt(3)
s_add_u32 s34,s32,7471104
ds_read_b128 a[96:99],v249 offset:1024
v_add_f32 v236,v238,v237
M v[4:7],a[240:243],a[220:223],v[4:7]
v_sub_f32 v238,v238,v237
v_add_f32 v237,v33,v129
M v[4:7],a[192:195],a[124:127],v[4:7]
v_sub_f32 v129,v33,v129
v_add_f32 v33,v236,v237
M v[4:7],v[228:231],a[244:247],v[4:7]
s_waitcnt lgkmcnt(3)
buffer_store_dwordx4 a[24:27],v253,s[24:27],s34 offen offset:384 nt
M v[8:11],v[228:231],a[124:127],v[8:11]
s_add_u32 s34,s32,7667712
ds_read_b128 a[116:119],v248 offset:1536
v_fmac_f32 v236,4.0,v237
M v[8:11],a[192:195],a[220:223],v[8:11]
s_waitcnt lgkmcnt(2)
ds_read_b128 a[124:127],v249 offset:1536
v_fma_f32 v237,2.0,v129,v238
M v[8:11],a[240:243],a[120:123],v[8:11]
s_waitcnt lgkmcnt(2)
buffer_store_dwordx4 a[28:31],v253,s[24:27],s34 offen offset:384 nt
M v[12:15],a[240:243],a[96:99],v[12:15]
v_fma_f32 v129,s40,v129,v238
v_cvt_pk_bf16_f32 v232,v232,v237
M v[12:15],a[192:195],a[120:123],v[12:15]
v_cvt_pk_bf16_f32 v234,v234,v236
v_accvgpr_read_b32 v238,a34
M v[12:15],v[228:231],a[220:223],v[12:15]
buffer_load_dwordx4 a[108:111],v250,s[20:23],s47 offen offset:2048 sc1
M v[16:19],v[228:231],a[120:123],v[16:19]
ds_read_b128 a[120:123],v249 offset:2048
v_accvgpr_read_b32 v233,a130
M v[16:19],a[192:195],a[96:99],v[16:19]
s_waitcnt lgkmcnt(2)
ds_read_b128 a[196:199],v248 offset:2048
v_add_f32 v235,v238,v233
M v[16:19],a[240:243],a[116:119],v[16:19]
s_waitcnt lgkmcnt(2)
v_sub_f32 v238,v238,v233
v_add_f32 v233,v34,v130
M v[20:23],a[240:243],a[124:127],v[20:23]
s_add_u32 s46,s73,46080
v_sub_f32 v130,v34,v130
v_add_f32 v34,v235,v233
M v[20:23],a[192:195],a[116:119],v[20:23]
ds_read_b128 a[244:247],v248 offset:17408
v_fmac_f32 v235,4.0,v233
M v[20:23],v[228:231],a[96:99],v[20:23]
ds_read_b128 a[96:99],v249 offset:17408
v_fma_f32 v233,2.0,v130,v238
M v[24:27],v[228:231],a[116:119],v[24:27]
ds_read_b128 a[116:119],v248 offset:17920
v_fma_f32 v130,s40,v130,v238
M v[24:27],a[192:195],a[124:127],v[24:27]
s_waitcnt lgkmcnt(4)
v_accvgpr_read_b32 v238,a35
v_accvgpr_read_b32 v237,a131
M v[24:27],a[240:243],a[120:123],v[24:27]
s_waitcnt lgkmcnt(3)
ds_read_b128 a[128:131],v249 offset:17920
v_add_f32 v236,v238,v237
M v[28:31],a[240:243],a[196:199],v[28:31]
buffer_load_dwordx4 a[220:223],v250,s[20:23],s46 offen offset:0 sc1
M v[28:31],a[192:195],a[120:123],v[28:31]
v_sub_f32 v238,v238,v237
v_add_f32 v237,v35,v131
M v[28:31],v[228:231],a[124:127],v[28:31]
s_waitcnt vmcnt(22) lgkmcnt(3)
buffer_load_dwordx4 a[196:199],v250,s[20:23],s46 offen offset:1024 sc1
M v[0:3],a[228:231],a[244:247],v[0:3]
s_waitcnt vmcnt(22) lgkmcnt(2)
ds_read_b128 a[124:127],v248 offset:18432
v_sub_f32 v131,v35,v131
M v[0:3],a[208:211],a[96:99],v[0:3]
s_waitcnt vmcnt(21) lgkmcnt(2)
ds_read_b128 a[240:243],v249 offset:18432
v_add_f32 v35,v236,v237
M v[0:3],v[224:227],a[116:119],v[0:3]
s_waitcnt lgkmcnt(2)
v_fmac_f32 v236,4.0,v237
v_fma_f32 v237,2.0,v131,v238
M v[4:7],v[224:227],a[128:131],v[4:7]
buffer_load_dwordx4 a[120:123],v250,s[20:23],s46 offen offset:2048 sc1
M v[4:7],a[208:211],a[116:119],v[4:7]
v_fma_f32 v131,s40,v131,v238
v_cvt_pk_bf16_f32 v233,v233,v237
M v[4:7],a[228:231],a[96:99],v[4:7]
v_cvt_pk_bf16_f32 v235,v235,v236
M v[8:11],a[228:231],a[116:119],v[8:11]
ds_read_b128 a[96:99],v248 offset:18944
ds_write2st64_b64 v254,v[232:233],v[234:235] offset0:34 offset1:38
M v[8:11],a[208:211],a[128:131],v[8:11]
s_waitcnt lgkmcnt(3)
ds_read_b128 a[116:119],v249 offset:18944
v_accvgpr_read_b32 v204,a36
M v[8:11],v[224:227],a[124:127],v[8:11]
s_waitcnt lgkmcnt(3)
v_accvgpr_read_b32 v208,a132
v_accvgpr_read_b32 v205,a37
M v[12:15],v[224:227],a[240:243],v[12:15]
v_accvgpr_read_b32 v209,a133
v_accvgpr_read_b32 v206,a38
M v[12:15],a[208:211],a[124:127],v[12:15]
v_accvgpr_read_b32 v210,a134
v_accvgpr_read_b32 v207,a39
v_accvgpr_read_b32 v211,a135
v_pk_add_f32 v[212:213],v[204:205],v[208:209]
v_pk_add_f32 v[214:215],v[206:207],v[210:211]
v_pk_add_f32 v[204:205],v[204:205],v[208:209] neg_lo:[0,1] neg_hi:[0,1]
v_pk_add_f32 v[206:207],v[206:207],v[210:211] neg_lo:[0,1] neg_hi:[0,1]
v_pk_add_f32 v[208:209],v[36:37],v[132:133]
v_pk_add_f32 v[210:211],v[38:39],v[134:135]
v_pk_add_f32 v[132:133],v[36:37],v[132:133] neg_lo:[0,1] neg_hi:[0,1]
v_pk_add_f32 v[134:135],v[38:39],v[134:135] neg_lo:[0,1] neg_hi:[0,1]
v_pk_add_f32 v[36:37],v[212:213],v[208:209]
v_pk_add_f32 v[38:39],v[214:215],v[210:211]
v_pk_fma_f32 v[212:213],v[208:209],4.0,v[212:213] op_sel_hi:[1,0,1]
v_pk_fma_f32 v[214:215],v[210:211],4.0,v[214:215] op_sel_hi:[1,0,1]
v_pk_fma_f32 v[208:209],v[132:133],2.0,v[204:205] op_sel_hi:[1,0,1]
v_pk_fma_f32 v[210:211],v[134:135],2.0,v[206:207] op_sel_hi:[1,0,1]
v_pk_fma_f32 v[132:133],v[132:133],s[40:41],v[204:205] op_sel_hi:[1,0,1]
v_pk_fma_f32 v[134:135],v[134:135],s[40:41],v[206:207] op_sel_hi:[1,0,1]
M v[12:15],a[228:231],a[128:131],v[12:15]
v_cvt_pk_bf16_f32 v208,v208,v209
v_cvt_pk_bf16_f32 v209,v210,v211
M v[16:19],a[228:231],a[124:127],v[16:19]
s_add_u32 s47,s73,49152
ds_read_b128 a[128:131],v249 offset:19456
v_cvt_pk_bf16_f32 v212,v212,v213
M v[16:19],a[208:211],a[240:243],v[16:19]
s_waitcnt lgkmcnt(3)
ds_read_b128 a[132:135],v248 offset:19456
v_cvt_pk_bf16_f32 v213,v214,v215
M v[16:19],v[224:227],a[96:99],v[16:19]
s_waitcnt lgkmcnt(2)
ds_write2st64_b64 v254,v[208:209],v[212:213] offset0:42 offset1:46
M v[20:23],v[224:227],a[116:119],v[20:23]
v_accvgpr_read_b32 v204,a40
v_accvgpr_read_b32 v208,a136
M v[20:23],a[208:211],a[96:99],v[20:23]
ds_read_b128 a[124:127],v248 offset:34816
v_accvgpr_read_b32 v205,a41
M v[20:23],a[228:231],a[240:243],v[20:23]
ds_read_b128 a[192:195],v249 offset:34816
v_accvgpr_read_b32 v209,a137
M v[24:27],a[228:231],a[96:99],v[24:27]
buffer_load_dwordx4 a[96:99],v250,s[20:23],s47 offen offset:0 sc1
M v[24:27],a[208:211],a[116:119],v[24:27]
s_waitcnt lgkmcnt(4)
v_accvgpr_read_b32 v206,a42
v_accvgpr_read_b32 v210,a138
v_accvgpr_read_b32 v207,a43
v_accvgpr_read_b32 v211,a139
v_pk_add_f32 v[212:213],v[204:205],v[208:209]
v_pk_add_f32 v[214:215],v[206:207],v[210:211]
v_pk_add_f32 v[204:205],v[204:205],v[208:209] neg_lo:[0,1] neg_hi:[0,1]
v_pk_add_f32 v[206:207],v[206:207],v[210:211] neg_lo:[0,1] neg_hi:[0,1]
v_pk_add_f32 v[208:209],v[40:41],v[136:137]
v_pk_add_f32 v[210:211],v[42:43],v[138:139]
v_pk_add_f32 v[136:137],v[40:41],v[136:137] neg_lo:[0,1] neg_hi:[0,1]
v_pk_add_f32 v[138:139],v[42:43],v[138:139] neg_lo:[0,1] neg_hi:[0,1]
v_pk_add_f32 v[40:41],v[212:213],v[208:209]
v_pk_add_f32 v[42:43],v[214:215],v[210:211]
v_pk_fma_f32 v[212:213],v[208:209],4.0,v[212:213] op_sel_hi:[1,0,1]
v_pk_fma_f32 v[214:215],v[210:211],4.0,v[214:215] op_sel_hi:[1,0,1]
v_pk_fma_f32 v[208:209],v[136:137],2.0,v[204:205] op_sel_hi:[1,0,1]
v_pk_fma_f32 v[210:211],v[138:139],2.0,v[206:207] op_sel_hi:[1,0,1]
v_pk_fma_f32 v[136:137],v[136:137],s[40:41],v[204:205] op_sel_hi:[1,0,1]
v_pk_fma_f32 v[138:139],v[138:139],s[40:41],v[206:207] op_sel_hi:[1,0,1]
M v[24:27],v[224:227],a[128:131],v[24:27]
s_waitcnt lgkmcnt(3)
ds_read_b128 a[136:139],v248 offset:35328
ds_read_b128 v[228:231],v249 offset:35328
M v[28:31],v[224:227],a[132:135],v[28:31]
buffer_load_dwordx4 a[244:247],v250,s[20:23],s47 offen offset:1024 sc1
M v[28:31],a[208:211],a[128:131],v[28:31]
v_cvt_pk_bf16_f32 v208,v208,v209
v_cvt_pk_bf16_f32 v209,v210,v211
M v[28:31],a[228:231],a[116:119],v[28:31]
s_waitcnt vmcnt(23) lgkmcnt(3)
buffer_load_dwordx4 a[132:135],v250,s[20:23],s47 offen offset:2048 sc1
M v[0:3],a[100:103],a[124:127],v[0:3]
s_waitcnt vmcnt(23) lgkmcnt(2)
ds_read_b128 a[128:131],v248 offset:35840
v_cvt_pk_bf16_f32 v212,v212,v213
M v[0:3],a[212:215],a[192:195],v[0:3]
s_waitcnt vmcnt(20) lgkmcnt(2)
ds_read_b128 a[116:119],v249 offset:35840
v_cvt_pk_bf16_f32 v213,v214,v215
M v[0:3],a[216:219],a[136:139],v[0:3]
s_waitcnt lgkmcnt(2)
ds_write2st64_b64 v254,v[208:209],v[212:213] offset0:51 offset1:55
M v[4:7],a[216:219],v[228:231],v[4:7]
v_accvgpr_read_b32 v204,a44
v_accvgpr_read_b32 v208,a140
M v[4:7],a[212:215],a[136:139],v[4:7]
v_accvgpr_read_b32 v205,a45
v_accvgpr_read_b32 v209,a141
M v[4:7],a[100:103],a[192:195],v[4:7]
v_accvgpr_read_b32 v206,a46
v_accvgpr_read_b32 v210,a142
v_accvgpr_read_b32 v207,a47
v_accvgpr_read_b32 v211,a143
v_pk_add_f32 v[212:213],v[204:205],v[208:209]
v_pk_add_f32 v[214:215],v[206:207],v[210:211]
v_pk_add_f32 v[204:205],v[204:205],v[208:209] neg_lo:[0,1] neg_hi:[0,1]
v_pk_add_f32 v[206:207],v[206:207],v[210:211] neg_lo:[0,1] neg_hi:[0,1]
v_pk_add_f32 v[208:209],v[44:45],v[140:141]
v_pk_add_f32 v[210:211],v[46:47],v[142:143]
v_pk_add_f32 v[140:141],v[44:45],v[140:141] neg_lo:[0,1] neg_hi:[0,1]
v_pk_add_f32 v[142:143],v[46:47],v[142:143] neg_lo:[0,1] neg_hi:[0,1]
v_pk_add_f32 v[44:45],v[212:213],v[208:209]
v_pk_add_f32 v[46:47],v[214:215],v[210:211]
v_pk_fma_f32 v[212:213],v[208:209],4.0,v[212:213] op_sel_hi:[1,0,1]
v_pk_fma_f32 v[214:215],v[210:211],4.0,v[214:215] op_sel_hi:[1,0,1]
v_pk_fma_f32 v[208:209],v[140:141],2.0,v[204:205] op_sel_hi:[1,0,1]
v_pk_fma_f32 v[210:211],v[142:143],2.0,v[206:207] op_sel_hi:[1,0,1]
v_pk_fma_f32 v[140:141],v[140:141],s[40:41],v[204:205] op_sel_hi:[1,0,1]
v_pk_fma_f32 v[142:143],v[142:143],s[40:41],v[206:207] op_sel_hi:[1,0,1]
M v[8:11],a[100:103],a[136:139],v[8:11]
ds_read_b128 a[124:127],v248 offset:36352
v_cvt_pk_bf16_f32 v208,v208,v209
M v[8:11],a[212:215],v[228:231],v[8:11]
s_waitcnt lgkmcnt(3)
ds_read_b128 a[136:139],v249 offset:36352
v_cvt_pk_bf16_f32 v209,v210,v211
M v[8:11],a[216:219],a[128:131],v[8:11]
s_waitcnt lgkmcnt(3)
v_cvt_pk_bf16_f32 v212,v212,v213
v_cvt_pk_bf16_f32 v213,v214,v215
M v[12:15],a[216:219],a[116:119],v[12:15]
ds_write2st64_b64 v254,v[208:209],v[212:213] offset0:59 offset1:63
M v[12:15],a[212:215],a[128:131],v[12:15]
v_accvgpr_read_b32 v238,a48
v_accvgpr_read_b32 v232,a144
M v[12:15],a[100:103],v[228:231],v[12:15]
v_add_f32 v234,v238,v232
v_sub_f32 v238,v238,v232
M v[16:19],a[100:103],a[128:131],v[16:19]
s_add_u32 s46,s74,46080
ds_read_b128 a[140:143],v249 offset:36864
v_add_f32 v232,v48,v144
M v[16:19],a[212:215],a[116:119],v[16:19]
s_waitcnt lgkmcnt(3)
ds_read_b128 a[128:131],v248 offset:36864
v_sub_f32 v144,v48,v144
M v[16:19],a[216:219],a[124:127],v[16:19]
s_waitcnt lgkmcnt(3)
v_add_f32 v48,v234,v232
v_fmac_f32 v234,4.0,v232
M v[20:23],a[216:219],a[136:139],v[20:23]
v_fma_f32 v232,2.0,v144,v238
v_fma_f32 v144,s40,v144,v238
M v[20:23],a[212:215],a[124:127],v[20:23]
ds_read_b128 a[240:243],v248 offset:52224
v_accvgpr_read_b32 v238,a49
M v[20:23],a[100:103],a[116:119],v[20:23]
ds_read_b128 a[116:119],v249 offset:52224
v_accvgpr_read_b32 v237,a145
M v[24:27],a[100:103],a[124:127],v[24:27]
buffer_load_dwordx4 a[124:127],v250,s[20:23],s46 offen offset:0 sc1
M v[24:27],a[212:215],a[136:139],v[24:27]
s_waitcnt lgkmcnt(3)
ds_read_b128 v[224:227],v248 offset:52736
ds_read_b128 a[228:231],v249 offset:52736
M v[24:27],a[216:219],a[140:143],v[24:27]
s_waitcnt lgkmcnt(4)
buffer_load_dwordx4 a[208:211],v250,s[20:23],s46 offen offset:1024 sc1
M v[28:31],a[216:219],a[128:131],v[28:31]
v_add_f32 v236,v238,v237
v_sub_f32 v238,v238,v237
M v[28:31],a[212:215],a[140:143],v[28:31]
v_add_f32 v237,v49,v145
v_sub_f32 v145,v49,v145
M v[28:31],a[100:103],a[136:139],v[28:31]
s_waitcnt vmcnt(21) lgkmcnt(3)
v_add_f32 v49,v236,v237
v_fmac_f32 v236,4.0,v237
M v[0:3],a[104:107],a[240:243],v[0:3]
s_waitcnt vmcnt(20) lgkmcnt(2)
buffer_load_dwordx4 a[192:195],v250,s[20:23],s46 offen offset:2048 sc1
M v[0:3],a[200:203],a[116:119],v[0:3]
s_waitcnt vmcnt(20) lgkmcnt(1)
ds_read_b128 a[128:131],v248 offset:53248
ds_read_b128 a[140:143],v249 offset:53248
M v[0:3],a[232:235],v[224:227],v[0:3]
s_waitcnt lgkmcnt(2)
v_fma_f32 v237,2.0,v145,v238
v_fma_f32 v145,s40,v145,v238
M v[4:7],a[232:235],a[228:231],v[4:7]
v_cvt_pk_bf16_f32 v232,v232,v237
v_cvt_pk_bf16_f32 v234,v234,v236
M v[4:7],a[200:203],v[224:227],v[4:7]
v_accvgpr_read_b32 v238,a50
v_accvgpr_read_b32 v233,a146
M v[4:7],a[104:107],a[116:119],v[4:7]
v_add_f32 v235,v238,v233
v_sub_f32 v238,v238,v233
M v[8:11],a[104:107],v[224:227],v[8:11]
ds_read_b128 a[100:103],v248 offset:53760
v_add_f32 v233,v50,v146
M v[8:11],a[200:203],a[228:231],v[8:11]
s_waitcnt lgkmcnt(2)
ds_read_b128 a[136:139],v249 offset:53760
v_sub_f32 v146,v50,v146
M v[8:11],a[232:235],a[128:131],v[8:11]
s_waitcnt lgkmcnt(2)
v_add_f32 v50,v235,v233
v_fmac_f32 v235,4.0,v233
M v[12:15],a[232:235],a[140:143],v[12:15]
v_fma_f32 v233,2.0,v146,v238
v_fma_f32 v146,s40,v146,v238
M v[12:15],a[200:203],a[128:131],v[12:15]
v_accvgpr_read_b32 v238,a51
v_accvgpr_read_b32 v237,a147
M v[12:15],a[104:107],a[228:231],v[12:15]
v_add_f32 v236,v238,v237
v_sub_f32 v238,v238,v237
M v[16:19],a[104:107],a[128:131],v[16:19]
s_add_u32 s47,s74,49152
ds_read_b128 a[116:119],v249 offset:54272
v_add_f32 v237,v51,v147
M v[16:19],a[200:203],a[140:143],v[16:19]
s_waitcnt lgkmcnt(2)
ds_read_b128 a[144:147],v248 offset:54272
v_add_u32 v248,0xffff9a00,v248
M v[16:19],a[232:235],a[100:103],v[16:19]
s_waitcnt lgkmcnt(2)
v_add_u32 v249,0xffff9a00,v249
v_sub_f32 v147,v51,v147
M v[20:23],a[232:235],a[136:139],v[20:23]
v_add_f32 v51,v236,v237
v_fmac_f32 v236,4.0,v237
M v[20:23],a[200:203],a[100:103],v[20:23]
ds_read_b128 a[128:131],v248 offset:8704
v_fma_f32 v237,2.0,v147,v238
M v[20:23],a[104:107],a[140:143],v[20:23]
ds_read_b128 a[140:143],v249 offset:8704
v_fma_f32 v147,s40,v147,v238
M v[24:27],a[104:107],a[100:103],v[24:27]
buffer_load_dwordx4 a[100:103],v250,s[20:23],s47 offen offset:0 sc1
M v[24:27],a[200:203],a[136:139],v[24:27]
s_waitcnt lgkmcnt(3)
ds_read_b128 v[228:231],v248 offset:9216
ds_read_b128 a[212:215],v249 offset:9216
M v[24:27],a[232:235],a[116:119],v[24:27]
s_waitcnt lgkmcnt(4)
buffer_load_dwordx4 a[216:219],v250,s[20:23],s47 offen offset:1024 sc1
M v[28:31],a[232:235],a[144:147],v[28:31]
v_cvt_pk_bf16_f32 v233,v233,v237
v_cvt_pk_bf16_f32 v235,v235,v236
M v[28:31],a[200:203],a[116:119],v[28:31]
ds_write2st64_b64 v254,v[232:233],v[234:235] offset0:0 offset1:4
M v[28:31],a[104:107],a[136:139],v[28:31]
s_waitcnt vmcnt(21) lgkmcnt(4)
v_accvgpr_read_b32 v204,a52
v_accvgpr_read_b32 v208,a148
M v[0:3],v[220:223],a[128:131],v[0:3]
s_waitcnt vmcnt(20) lgkmcnt(3)
buffer_load_dwordx4 a[240:243],v250,s[20:23],s47 offen offset:2048 sc1
M v[0:3],a[204:207],a[140:143],v[0:3]
s_waitcnt vmcnt(20) lgkmcnt(2)
ds_read_b128 a[144:147],v248 offset:9728
ds_read_b128 a[116:119],v249 offset:9728
M v[0:3],a[236:239],v[228:231],v[0:3]
s_waitcnt lgkmcnt(3)
v_accvgpr_read_b32 v205,a53
v_accvgpr_read_b32 v209,a149
M v[4:7],a[236:239],a[212:215],v[4:7]
v_accvgpr_read_b32 v206,a54
v_accvgpr_read_b32 v210,a150
v_accvgpr_read_b32 v207,a55
v_accvgpr_read_b32 v211,a151
v_pk_add_f32 v[212:213],v[204:205],v[208:209]
v_pk_add_f32 v[214:215],v[206:207],v[210:211]
v_pk_add_f32 v[204:205],v[204:205],v[208:209] neg_lo:[0,1] neg_hi:[0,1]
v_pk_add_f32 v[206:207],v[206:207],v[210:211] neg_lo:[0,1] neg_hi:[0,1]
v_pk_add_f32 v[208:209],v[52:53],v[148:149]
v_pk_add_f32 v[210:211],v[54:55],v[150:151]
v_pk_add_f32 v[148:149],v[52:53],v[148:149] neg_lo:[0,1] neg_hi:[0,1]
v_pk_add_f32 v[150:151],v[54:55],v[150:151] neg_lo:[0,1] neg_hi:[0,1]
v_pk_add_f32 v[52:53],v[212:213],v[208:209]
v_pk_add_f32 v[54:55],v[214:215],v[210:211]
v_pk_fma_f32 v[212:213],v[208:209],4.0,v[212:213] op_sel_hi:[1,0,1]
v_pk_fma_f32 v[214:215],v[210:211],4.0,v[214:215] op_sel_hi:[1,0,1]
v_pk_fma_f32 v[208:209],v[148:149],2.0,v[204:205] op_sel_hi:[1,0,1]
v_pk_fma_f32 v[210:211],v[150:151],2.0,v[206:207] op_sel_hi:[1,0,1]
v_pk_fma_f32 v[148:149],v[148:149],s[40:41],v[204:205] op_sel_hi:[1,0,1]
v_pk_fma_f32 v[150:151],v[150:151],s[40:41],v[206:207] op_sel_hi:[1,0,1]
M v[4:7],a[204:207],v[228:231],v[4:7]
v_cvt_pk_bf16_f32 v208,v208,v209
v_cvt_pk_bf16_f32 v209,v210,v211
M v[4:7],v[220:223],a[140:143],v[4:7]
v_cvt_pk_bf16_f32 v212,v212,v213
v_cvt_pk_bf16_f32 v213,v214,v215
M v[8:11],v[220:223],v[228:231],v[8:11]
ds_read_b128 a[104:107],v248 offset:10240
ds_write2st64_b64 v254,v[208:209],v[212:213] offset0:8 offset1:12
M v[8:11],a[204:207],a[212:215],v[8:11]
s_waitcnt lgkmcnt(3)
ds_read_b128 a[136:139],v249 offset:10240
v_accvgpr_read_b32 v204,a56
M v[8:11],a[236:239],a[144:147],v[8:11]
s_waitcnt lgkmcnt(3)
v_accvgpr_read_b32 v208,a152
v_accvgpr_read_b32 v205,a57
M v[12:15],a[236:239],a[116:119],v[12:15]
v_accvgpr_read_b32 v209,a153
v_accvgpr_read_b32 v206,a58
M v[12:15],a[204:207],a[144:147],v[12:15]
v_accvgpr_read_b32 v210,a154
v_accvgpr_read_b32 v207,a59
v_accvgpr_read_b32 v211,a155
v_pk_add_f32 v[212:213],v[204:205],v[208:209]
v_pk_add_f32 v[214:215],v[206:207],v[210:211]
v_pk_add_f32 v[204:205],v[204:205],v[208:209] neg_lo:[0,1] neg_hi:[0,1]
v_pk_add_f32 v[206:207],v[206:207],v[210:211] neg_lo:[0,1] neg_hi:[0,1]
v_pk_add_f32 v[208:209],v[56:57],v[152:153]
v_pk_add_f32 v[210:211],v[58:59],v[154:155]
v_pk_add_f32 v[152:153],v[56:57],v[152:153] neg_lo:[0,1] neg_hi:[0,1]
v_pk_add_f32 v[154:155],v[58:59],v[154:155] neg_lo:[0,1] neg_hi:[0,1]
v_pk_add_f32 v[56:57],v[212:213],v[208:209]
v_pk_add_f32 v[58:59],v[214:215],v[210:211]
v_pk_fma_f32 v[212:213],v[208:209],4.0,v[212:213] op_sel_hi:[1,0,1]
v_pk_fma_f32 v[214:215],v[210:211],4.0,v[214:215] op_sel_hi:[1,0,1]
v_pk_fma_f32 v[208:209],v[152:153],2.0,v[204:205] op_sel_hi:[1,0,1]
v_pk_fma_f32 v[210:211],v[154:155],2.0,v[206:207] op_sel_hi:[1,0,1]
v_pk_fma_f32 v[152:153],v[152:153],s[40:41],v[204:205] op_sel_hi:[1,0,1]
v_pk_fma_f32 v[154:155],v[154:155],s[40:41],v[206:207] op_sel_hi:[1,0,1]
M v[12:15],v[220:223],a[212:215],v[12:15]
v_cvt_pk_bf16_f32 v208,v208,v209
v_cvt_pk_bf16_f32 v209,v210,v211
M v[16:19],v[220:223],a[144:147],v[16:19]
s_add_u32 s46,s75,46080
ds_read_b128 a[128:131],v249 offset:10752
v_cvt_pk_bf16_f32 v212,v212,v213
M v[16:19],a[204:207],a[116:119],v[16:19]
s_waitcnt lgkmcnt(3)
ds_read_b128 a[148:151],v248 offset:10752
v_cvt_pk_bf16_f32 v213,v214,v215
M v[16:19],a[236:239],a[104:107],v[16:19]
s_waitcnt lgkmcnt(2)
ds_write2st64_b64 v254,v[208:209],v[212:213] offset0:17 offset1:21
M v[20:23],a[236:239],a[136:139],v[20:23]
v_accvgpr_read_b32 v204,a60
v_accvgpr_read_b32 v208,a156
M v[20:23],a[204:207],a[104:107],v[20:23]
ds_read_b128 a[140:143],v248 offset:0
v_accvgpr_read_b32 v205,a61
M v[20:23],v[220:223],a[116:119],v[20:23]
ds_read_b128 a[152:155],v249 offset:0
v_accvgpr_read_b32 v209,a157
M v[24:27],v[220:223],a[104:107],v[24:27]
buffer_load_dwordx4 a[144:147],v250,s[20:23],s46 offen offset:0 sc1
M v[24:27],a[204:207],a[136:139],v[24:27]
s_waitcnt lgkmcnt(4)
ds_read_b128 a[116:119],v248 offset:512
ds_read_b128 v[224:227],v249 offset:512
M v[24:27],a[236:239],a[128:131],v[24:27]
s_waitcnt lgkmcnt(5)
buffer_load_dwordx4 a[104:107],v250,s[20:23],s46 offen offset:1024 sc1
M v[28:31],a[236:239],a[148:151],v[28:31]
v_accvgpr_read_b32 v206,a62
v_accvgpr_read_b32 v210,a158
v_accvgpr_read_b32 v207,a63
v_accvgpr_read_b32 v211,a159
v_pk_add_f32 v[212:213],v[204:205],v[208:209]
v_pk_add_f32 v[214:215],v[206:207],v[210:211]
v_pk_add_f32 v[204:205],v[204:205],v[208:209] neg_lo:[0,1] neg_hi:[0,1]
v_pk_add_f32 v[206:207],v[206:207],v[210:211] neg_lo:[0,1] neg_hi:[0,1]
v_pk_add_f32 v[208:209],v[60:61],v[156:157]
v_pk_add_f32 v[210:211],v[62:63],v[158:159]
v_pk_add_f32 v[156:157],v[60:61],v[156:157] neg_lo:[0,1] neg_hi:[0,1]
v_pk_add_f32 v[158:159],v[62:63],v[158:159] neg_lo:[0,1] neg_hi:[0,1]
v_pk_add_f32 v[60:61],v[212:213],v[208:209]
v_pk_add_f32 v[62:63],v[214:215],v[210:211]
v_pk_fma_f32 v[212:213],v[208:209],4.0,v[212:213] op_sel_hi:[1,0,1]
v_pk_fma_f32 v[214:215],v[210:211],4.0,v[214:215] op_sel_hi:[1,0,1]
v_pk_fma_f32 v[208:209],v[156:157],2.0,v[204:205] op_sel_hi:[1,0,1]
v_pk_fma_f32 v[210:211],v[158:159],2.0,v[206:207] op_sel_hi:[1,0,1]
v_pk_fma_f32 v[156:157],v[156:157],s[40:41],v[204:205] op_sel_hi:[1,0,1]
v_pk_fma_f32 v[158:159],v[158:159],s[40:41],v[206:207] op_sel_hi:[1,0,1]
M v[28:31],a[204:207],a[128:131],v[28:31]
buffer_load_dwordx4 a[156:159],v250,s[20:23],s46 offen offset:2048 sc1
M v[28:31],v[220:223],a[136:139],v[28:31]
s_waitcnt vmcnt(22) lgkmcnt(3)
v_cvt_pk_bf16_f32 v208,v208,v209
v_cvt_pk_bf16_f32 v209,v210,v211
M v[96:99],a[248:251],a[140:143],v[96:99]
s_waitcnt vmcnt(21) lgkmcnt(2)
ds_read_b128 a[148:151],v248 offset:1024
v_cvt_pk_bf16_f32 v212,v212,v213
M v[96:99],a[224:227],a[152:155],v[96:99]
s_waitcnt vmcnt(20) lgkmcnt(2)
ds_read_b128 a[128:131],v249 offset:1024
v_cvt_pk_bf16_f32 v213,v214,v215
M v[96:99],v[216:219],a[116:119],v[96:99]
s_waitcnt lgkmcnt(2)
ds_write2st64_b64 v254,v[208:209],v[212:213] offset0:25 offset1:29
M v[100:103],v[216:219],v[224:227],v[100:103]
v_cvt_pk_bf16_f32 v0,v0,v1
v_cvt_pk_bf16_f32 v1,v2,v3
M v[100:103],a[224:227],a[116:119],v[100:103]
v_cvt_pk_bf16_f32 v4,v4,v5
v_cvt_pk_bf16_f32 v5,v6,v7
M v[100:103],a[248:251],a[152:155],v[100:103]
s_waitcnt lgkmcnt(0)
s_barrier
ds_read_b128 a[32:35],v250 offset:17408
M v[104:107],a[248:251],a[116:119],v[104:107]
ds_read_b128 a[36:39],v250 offset:21504
ds_read_b128 a[40:43],v250 offset:26112
M v[104:107],a[224:227],v[224:227],v[104:107]
ds_read_b128 a[44:47],v250 offset:30208
ds_read_b128 a[48:51],v250 offset:0
M v[104:107],v[216:219],a[148:151],v[104:107]
ds_read_b128 a[52:55],v250 offset:4096
ds_read_b128 a[56:59],v250 offset:8704
M v[108:111],v[216:219],a[128:131],v[108:111]
ds_read_b128 a[60:63],v250 offset:12800
ds_read_b128 a[136:139],v248 offset:1536
M v[108:111],a[224:227],a[148:151],v[108:111]
s_add_u32 s34,s32,6291456
ds_read_b128 a[228:231],v249 offset:1536
ds_write2st64_b64 v254,v[0:1],v[4:5] offset0:68 offset1:72
M v[108:111],a[248:251],v[224:227],v[108:111]
s_waitcnt lgkmcnt(10)
buffer_store_dwordx4 a[32:35],v253,s[24:27],s34 offen offset:512 nt
M v[112:115],a[248:251],a[148:151],v[112:115]
s_add_u32 s34,s32,6488064
ds_read_b128 a[232:235],v249 offset:2048
v_cvt_pk_bf16_f32 v8,v8,v9
M v[112:115],a[224:227],a[128:131],v[112:115]
s_waitcnt lgkmcnt(3)
ds_read_b128 a[200:203],v248 offset:2048
v_cvt_pk_bf16_f32 v9,v10,v11
M v[112:115],v[216:219],a[136:139],v[112:115]
s_waitcnt lgkmcnt(3)
buffer_store_dwordx4 a[36:39],v253,s[24:27],s34 offen offset:512 nt
M v[116:119],v[216:219],a[228:231],v[116:119]
s_add_u32 s34,s32,6684672
v_cvt_pk_bf16_f32 v12,v12,v13
v_cvt_pk_bf16_f32 v13,v14,v15
M v[116:119],a[224:227],a[136:139],v[116:119]
ds_write2st64_b64 v254,v[8:9],v[12:13] offset0:76 offset1:80
M v[116:119],a[248:251],a[128:131],v[116:119]
buffer_store_dwordx4 a[40:43],v253,s[24:27],s34 offen offset:512 nt
M v[120:123],a[248:251],a[136:139],v[120:123]
s_add_u32 s34,s32,6881280
global_load_dword v228,v250,s[64:65]
M v[120:123],a[224:227],a[228:231],v[120:123]
s_waitcnt lgkmcnt(2)
s_add_u32 s47,s75,49152
v_cvt_pk_bf16_f32 v16,v16,v17
v_cvt_pk_bf16_f32 v17,v18,v19
M v[120:123],v[216:219],a[232:235],v[120:123]
s_waitcnt lgkmcnt(1)
buffer_store_dwordx4 a[44:47],v253,s[24:27],s34 offen offset:512 nt
M v[124:127],v[216:219],a[200:203],v[124:127]
s_add_u32 s34,s32,7077888
v_cvt_pk_bf16_f32 v20,v20,v21
v_cvt_pk_bf16_f32 v21,v22,v23
M v[124:127],a[224:227],a[232:235],v[124:127]
ds_write2st64_b64 v254,v[16:17],v[20:21] offset0:85 offset1:89
M v[124:127],a[248:251],a[228:231],v[124:127]
s_waitcnt vmcnt(24)
buffer_store_dwordx4 a[48:51],v253,s[24:27],s34 offen offset:512 nt
M v[128:131],a[112:115],a[140:143],v[128:131]
s_waitcnt vmcnt(24)
s_add_u32 s34,s32,7274496
v_cvt_pk_bf16_f32 v24,v24,v25
v_cvt_pk_bf16_f32 v25,v26,v27
M v[128:131],a[252:255],a[152:155],v[128:131]
s_waitcnt vmcnt(21)
v_cvt_pk_bf16_f32 v28,v28,v29
v_cvt_pk_bf16_f32 v29,v30,v31
M v[128:131],a[108:111],a[116:119],v[128:131]
buffer_store_dwordx4 a[52:55],v253,s[24:27],s34 offen offset:512 nt
M v[132:135],a[108:111],v[224:227],v[132:135]
s_add_u32 s34,s32,7471104
ds_write2st64_b64 v254,v[24:25],v[28:29] offset0:93 offset1:97
M v[132:135],a[252:255],a[116:119],v[132:135]
buffer_load_dwordx4 v[228:231],v250,s[20:23],s47 offen offset:0 sc1
M v[132:135],a[112:115],a[152:155],v[132:135]
v_accvgpr_read_b32 v238,a64
v_accvgpr_read_b32 v232,a160
M v[136:139],a[112:115],a[116:119],v[136:139]
v_add_f32 v234,v238,v232
v_sub_f32 v238,v238,v232
M v[136:139],a[252:255],v[224:227],v[136:139]
v_add_f32 v232,v64,v160
v_sub_f32 v160,v64,v160
M v[136:139],a[108:111],a[148:151],v[136:139]
buffer_load_dwordx4 a[212:215],v250,s[20:23],s47 offen offset:1024 sc1
M v[140:143],a[108:111],a[128:131],v[140:143]
v_add_f32 v64,v234,v232
v_fmac_f32 v234,4.0,v232
M v[140:143],a[252:255],a[148:151],v[140:143]
v_fma_f32 v232,2.0,v160,v238
v_fma_f32 v160,s40,v160,v238
M v[140:143],a[112:115],v[224:227],v[140:143]
s_waitcnt lgkmcnt(0)
s_barrier
ds_read_b128 v[0:3],v250 offset:34816
M v[144:147],a[112:115],a[148:151],v[144:147]
ds_read_b128 v[8:11],v250 offset:38912
ds_read_b128 v[16:19],v250 offset:43520
M v[144:147],a[252:255],a[128:131],v[144:147]
ds_read_b128 v[24:27],v250 offset:47616
v_accvgpr_read_b32 v238,a65
M v[144:147],a[108:111],a[136:139],v[144:147]
buffer_load_dwordx4 a[236:239],v250,s[20:23],s47 offen offset:2048 sc1
M v[148:151],a[108:111],a[228:231],v[148:151]
s_add_u32 s46,s76,46080
v_accvgpr_read_b32 v237,a161
v_add_f32 v236,v238,v237
M v[148:151],a[252:255],a[136:139],v[148:151]
ds_read_b128 a[140:143],v248 offset:34816
v_sub_f32 v238,v238,v237
M v[148:151],a[112:115],a[128:131],v[148:151]
buffer_store_dwordx4 a[56:59],v253,s[24:27],s34 offen offset:512 nt
M v[152:155],a[112:115],a[136:139],v[152:155]
ds_read_b128 a[152:155],v249 offset:34816
ds_read_b128 a[148:151],v248 offset:35328
M v[152:155],a[252:255],a[228:231],v[152:155]
buffer_load_dwordx4 a[116:119],v250,s[20:23],s46 offen offset:0 sc1
M v[152:155],a[108:111],a[232:235],v[152:155]
ds_read_b128 a[136:139],v249 offset:35328
v_add_f32 v237,v65,v161
M v[156:159],a[108:111],a[200:203],v[156:159]
v_sub_f32 v161,v65,v161
v_add_f32 v65,v236,v237
M v[156:159],a[252:255],a[232:235],v[156:159]
v_fmac_f32 v236,4.0,v237
v_fma_f32 v237,2.0,v161,v238
M v[156:159],a[112:115],a[228:231],v[156:159]
s_waitcnt vmcnt(26) lgkmcnt(3)
buffer_load_dwordx4 a[128:131],v250,s[20:23],s46 offen offset:1024 sc1
M v[96:99],a[220:223],a[140:143],v[96:99]
s_waitcnt vmcnt(26) lgkmcnt(2)
ds_read_b128 a[108:111],v248 offset:35840
v_fma_f32 v161,s40,v161,v238
M v[96:99],a[196:199],a[152:155],v[96:99]
s_waitcnt vmcnt(25) lgkmcnt(2)
s_add_u32 s34,s32,7667712
ds_read_b128 a[112:115],v249 offset:35840
v_cvt_pk_bf16_f32 v232,v232,v237
M v[96:99],a[120:123],a[148:151],v[96:99]
s_waitcnt lgkmcnt(2)
v_cvt_pk_bf16_f32 v234,v234,v236
v_accvgpr_read_b32 v238,a66
M v[100:103],a[120:123],a[136:139],v[100:103]
buffer_load_dwordx4 a[204:207],v250,s[20:23],s46 offen offset:2048 sc1
M v[100:103],a[196:199],a[148:151],v[100:103]
v_accvgpr_read_b32 v233,a162
v_add_f32 v235,v238,v233
M v[100:103],a[220:223],a[152:155],v[100:103]
v_sub_f32 v238,v238,v233
v_add_f32 v233,v66,v162
M v[104:107],a[220:223],a[148:151],v[104:107]
ds_read_b128 v[220:223],v248 offset:36352
v_sub_f32 v162,v66,v162
M v[104:107],a[196:199],a[136:139],v[104:107]
s_waitcnt lgkmcnt(2)
ds_read_b128 v[216:219],v249 offset:36352
v_add_f32 v66,v235,v233
M v[104:107],a[120:123],a[108:111],v[104:107]
s_waitcnt lgkmcnt(2)
buffer_store_dwordx4 a[60:63],v253,s[24:27],s34 offen offset:512 nt
M v[108:111],a[120:123],a[112:115],v[108:111]
v_fmac_f32 v235,4.0,v233
v_fma_f32 v233,2.0,v162,v238
M v[108:111],a[196:199],a[108:111],v[108:111]
v_fma_f32 v162,s40,v162,v238
v_accvgpr_read_b32 v238,a67
M v[108:111],a[220:223],a[136:139],v[108:111]
v_accvgpr_read_b32 v237,a163
v_add_f32 v236,v238,v237
M v[112:115],a[220:223],a[108:111],v[112:115]
s_add_u32 s47,s76,49152
ds_read_b128 a[160:163],v249 offset:36864
v_sub_f32 v238,v238,v237
M v[112:115],a[196:199],a[112:115],v[112:115]
s_waitcnt lgkmcnt(2)
ds_read_b128 a[224:227],v248 offset:36864
v_add_f32 v237,v67,v163
M v[112:115],a[120:123],v[220:223],v[112:115]
s_waitcnt lgkmcnt(2)
v_sub_f32 v163,v67,v163
v_add_f32 v67,v236,v237
M v[116:119],a[120:123],v[216:219],v[116:119]
v_fmac_f32 v236,4.0,v237
v_fma_f32 v237,2.0,v163,v238
M v[116:119],a[196:199],v[220:223],v[116:119]
v_fma_f32 v163,s40,v163,v238
v_cvt_pk_bf16_f32 v233,v233,v237
M v[116:119],a[220:223],a[112:115],v[116:119]
v_cvt_pk_bf16_f32 v235,v235,v236
M v[120:123],a[220:223],v[220:223],v[120:123]
buffer_load_dwordx4 a[248:251],v250,s[20:23],s47 offen offset:0 sc1
M v[120:123],a[196:199],v[216:219],v[120:123]
s_waitcnt lgkmcnt(1)
ds_write2st64_b64 v254,v[232:233],v[234:235] offset0:34 offset1:38
M v[120:123],a[120:123],a[160:163],v[120:123]
s_waitcnt lgkmcnt(1)
buffer_load_dwordx4 v[224:227],v250,s[20:23],s47 offen offset:1024 sc1
M v[124:127],a[120:123],a[224:227],v[124:127]
v_accvgpr_read_b32 v238,a68
v_accvgpr_read_b32 v232,a164
M v[124:127],a[196:199],a[160:163],v[124:127]
v_add_f32 v234,v238,v232
v_sub_f32 v238,v238,v232
M v[124:127],a[220:223],v[216:219],v[124:127]
s_waitcnt vmcnt(28)
s_add_u32 s34,s33,6291456
v_add_f32 v232,v68,v164
v_sub_f32 v164,v68,v164
M v[128:131],a[96:99],a[140:143],v[128:131]
s_waitcnt vmcnt(27)
buffer_load_dwordx4 a[200:203],v250,s[20:23],s47 offen offset:2048 sc1
M v[128:131],a[244:247],a[152:155],v[128:131]
s_waitcnt vmcnt(27)
v_add_f32 v68,v234,v232
v_fmac_f32 v234,4.0,v232
M v[128:131],a[132:135],a[148:151],v[128:131]
v_fma_f32 v232,2.0,v164,v238
v_fma_f32 v164,s40,v164,v238
M v[132:135],a[132:135],a[136:139],v[132:135]
v_accvgpr_read_b32 v238,a69
v_accvgpr_read_b32 v237,a165
M v[132:135],a[244:247],a[148:151],v[132:135]
v_add_f32 v236,v238,v237
v_sub_f32 v238,v238,v237
M v[132:135],a[96:99],a[152:155],v[132:135]
buffer_store_dwordx4 v[0:3],v253,s[24:27],s34 offen offset:0 nt
M v[136:139],a[96:99],a[148:151],v[136:139]
v_add_f32 v237,v69,v165
v_sub_f32 v165,v69,v165
M v[136:139],a[244:247],a[136:139],v[136:139]
v_add_f32 v69,v236,v237
v_fmac_f32 v236,4.0,v237
M v[136:139],a[132:135],a[108:111],v[136:139]
v_fma_f32 v237,2.0,v165,v238
v_fma_f32 v165,s40,v165,v238
M v[140:143],a[132:135],a[112:115],v[140:143]
v_cvt_pk_bf16_f32 v232,v232,v237
v_cvt_pk_bf16_f32 v234,v234,v236
M v[140:143],a[244:247],a[108:111],v[140:143]
v_accvgpr_read_b32 v238,a70
v_accvgpr_read_b32 v233,a166
M v[140:143],a[96:99],a[136:139],v[140:143]
v_add_f32 v235,v238,v233
v_sub_f32 v238,v238,v233
M v[144:147],a[96:99],a[108:111],v[144:147]
s_add_u32 s46,s77,46080
v_add_f32 v233,v70,v166
v_sub_f32 v166,v70,v166
M v[144:147],a[244:247],a[112:115],v[144:147]
v_add_f32 v70,v235,v233
v_fmac_f32 v235,4.0,v233
M v[144:147],a[132:135],v[220:223],v[144:147]
v_fma_f32 v233,2.0,v166,v238
v_fma_f32 v166,s40,v166,v238
M v[148:151],a[132:135],v[216:219],v[148:151]
v_accvgpr_read_b32 v238,a71
v_accvgpr_read_b32 v237,a167
M v[148:151],a[244:247],v[220:223],v[148:151]
ds_read_b128 a[120:123],v248 offset:52224
v_add_f32 v236,v238,v237
M v[148:151],a[96:99],a[112:115],v[148:151]
ds_read_b128 a[140:143],v249 offset:52224
v_sub_f32 v238,v238,v237
M v[152:155],a[96:99],v[220:223],v[152:155]
buffer_load_dwordx4 a[152:155],v250,s[20:23],s46 offen offset:0 sc1
M v[152:155],a[244:247],v[216:219],v[152:155]
ds_read_b128 a[148:151],v248 offset:52736
ds_read_b128 a[108:111],v249 offset:52736
M v[152:155],a[132:135],a[160:163],v[152:155]
buffer_load_dwordx4 a[136:139],v250,s[20:23],s46 offen offset:1024 sc1
M v[156:159],a[132:135],a[224:227],v[156:159]
s_add_u32 s34,s33,6684672
v_add_f32 v237,v71,v167
v_sub_f32 v167,v71,v167
M v[156:159],a[244:247],a[160:163],v[156:159]
v_add_f32 v71,v236,v237
v_fmac_f32 v236,4.0,v237
M v[156:159],a[96:99],v[216:219],v[156:159]
s_waitcnt vmcnt(29) lgkmcnt(3)
v_fma_f32 v237,2.0,v167,v238
v_fma_f32 v167,s40,v167,v238
M v[96:99],a[124:127],a[120:123],v[96:99]
s_waitcnt vmcnt(28) lgkmcnt(2)
buffer_load_dwordx4 a[164:167],v250,s[20:23],s46 offen offset:2048 sc1
M v[96:99],a[208:211],a[140:143],v[96:99]
s_waitcnt vmcnt(28) lgkmcnt(1)
ds_read_b128 a[112:115],v248 offset:53248
ds_read_b128 a[132:135],v249 offset:53248
M v[96:99],a[192:195],a[148:151],v[96:99]
s_waitcnt lgkmcnt(2)
v_cvt_pk_bf16_f32 v233,v233,v237
v_cvt_pk_bf16_f32 v235,v235,v236
M v[100:103],a[192:195],a[108:111],v[100:103]
ds_write2st64_b64 v254,v[232:233],v[234:235] offset0:42 offset1:46
M v[100:103],a[208:211],a[148:151],v[100:103]
v_accvgpr_read_b32 v238,a72
v_accvgpr_read_b32 v232,a168
M v[100:103],a[124:127],a[140:143],v[100:103]
buffer_store_dwordx4 v[8:11],v253,s[24:27],s34 offen offset:0 nt
M v[104:107],a[124:127],a[148:151],v[104:107]
ds_read_b128 a[160:163],v248 offset:53760
v_add_f32 v234,v238,v232
M v[104:107],a[208:211],a[108:111],v[104:107]
s_waitcnt lgkmcnt(3)
ds_read_b128 a[96:99],v249 offset:53760
v_sub_f32 v238,v238,v232
M v[104:107],a[192:195],a[112:115],v[104:107]
s_waitcnt lgkmcnt(3)
v_add_f32 v232,v72,v168
v_sub_f32 v168,v72,v168
M v[108:111],a[192:195],a[132:135],v[108:111]
v_add_f32 v72,v234,v232
v_fmac_f32 v234,4.0,v232
M v[108:111],a[208:211],a[112:115],v[108:111]
v_fma_f32 v232,2.0,v168,v238
v_fma_f32 v168,s40,v168,v238
M v[108:111],a[124:127],a[108:111],v[108:111]
v_accvgpr_read_b32 v238,a73
v_accvgpr_read_b32 v237,a169
M v[112:115],a[124:127],a[112:115],v[112:115]
s_add_u32 s47,s77,49152
ds_read_b128 a[232:235],v249 offset:54272
v_add_f32 v236,v238,v237
M v[112:115],a[208:211],a[132:135],v[112:115]
s_waitcnt lgkmcnt(2)
ds_read_b128 a[252:255],v248 offset:54272
v_sub_f32 v238,v238,v237
M v[112:115],a[192:195],a[160:163],v[112:115]
s_waitcnt lgkmcnt(2)
v_add_f32 v237,v73,v169
v_sub_f32 v169,v73,v169
M v[116:119],a[192:195],a[96:99],v[116:119]
v_add_f32 v73,v236,v237
v_fmac_f32 v236,4.0,v237
M v[116:119],a[208:211],a[160:163],v[116:119]
v_fma_f32 v237,2.0,v169,v238
v_fma_f32 v169,s40,v169,v238
M v[116:119],a[124:127],a[132:135],v[116:119]
v_cvt_pk_bf16_f32 v232,v232,v237
v_cvt_pk_bf16_f32 v234,v234,v236
M v[120:123],a[124:127],a[160:163],v[120:123]
buffer_load_dwordx4 a[228:231],v250,s[20:23],s47 offen offset:0 sc1
M v[120:123],a[208:211],a[96:99],v[120:123]
s_waitcnt lgkmcnt(1)
s_add_u32 s34,s33,7077888
v_accvgpr_read_b32 v238,a74
v_accvgpr_read_b32 v233,a170
M v[120:123],a[192:195],a[232:235],v[120:123]
s_waitcnt lgkmcnt(0)
buffer_load_dwordx4 a[196:199],v250,s[20:23],s47 offen offset:1024 sc1
M v[124:127],a[192:195],a[252:255],v[124:127]
v_add_f32 v235,v238,v233
v_sub_f32 v238,v238,v233
M v[124:127],a[208:211],a[232:235],v[124:127]
v_add_f32 v233,v74,v170
v_sub_f32 v170,v74,v170
M v[124:127],a[124:127],a[96:99],v[124:127]
s_waitcnt vmcnt(30)
v_add_f32 v74,v235,v233
v_fmac_f32 v235,4.0,v233
M v[128:131],a[100:103],a[120:123],v[128:131]
s_waitcnt vmcnt(29)
buffer_load_dwordx4 a[220:223],v250,s[20:23],s47 offen offset:2048 sc1
M v[128:131],a[216:219],a[140:143],v[128:131]
s_waitcnt vmcnt(29)
v_fma_f32 v233,2.0,v170,v238
v_fma_f32 v170,s40,v170,v238
M v[128:131],a[240:243],a[148:151],v[128:131]
v_accvgpr_read_b32 v238,a75
v_accvgpr_read_b32 v237,a171
M v[132:135],a[240:243],a[108:111],v[132:135]
v_add_f32 v236,v238,v237
v_sub_f32 v238,v238,v237
M v[132:135],a[216:219],a[148:151],v[132:135]
v_add_f32 v237,v75,v171
v_sub_f32 v171,v75,v171
M v[132:135],a[100:103],a[140:143],v[132:135]
buffer_store_dwordx4 v[16:19],v253,s[24:27],s34 offen offset:0 nt
M v[136:139],a[100:103],a[148:151],v[136:139]
v_add_f32 v75,v236,v237
v_fmac_f32 v236,4.0,v237
M v[136:139],a[216:219],a[108:111],v[136:139]
v_fma_f32 v237,2.0,v171,v238
v_fma_f32 v171,s40,v171,v238
M v[136:139],a[240:243],a[112:115],v[136:139]
v_cvt_pk_bf16_f32 v233,v233,v237
v_cvt_pk_bf16_f32 v235,v235,v236
M v[140:143],a[240:243],a[132:135],v[140:143]
ds_write2st64_b64 v254,v[232:233],v[234:235] offset0:51 offset1:55
M v[140:143],a[216:219],a[112:115],v[140:143]
v_accvgpr_read_b32 v238,a76
v_accvgpr_read_b32 v232,a172
M v[140:143],a[100:103],a[108:111],v[140:143]
v_add_f32 v234,v238,v232
v_sub_f32 v238,v238,v232
M v[144:147],a[100:103],a[112:115],v[144:147]
s_add_u32 s47,s72,3072
v_add_f32 v232,v76,v172
v_sub_f32 v172,v76,v172
M v[144:147],a[216:219],a[132:135],v[144:147]
v_add_u32 v248,0x11000,v248
v_add_u32 v249,0x11000,v249
M v[144:147],a[240:243],a[160:163],v[144:147]
v_add_f32 v76,v234,v232
v_fmac_f32 v234,4.0,v232
M v[148:151],a[240:243],a[96:99],v[148:151]
v_fma_f32 v232,2.0,v172,v238
v_fma_f32 v172,s40,v172,v238
M v[148:151],a[216:219],a[160:163],v[148:151]
ds_read_b128 a[124:127],v248 offset:0
v_accvgpr_read_b32 v238,a77
M v[148:151],a[100:103],a[132:135],v[148:151]
s_add_u32 s34,s33,7471104
buffer_store_dwordx4 v[24:27],v253,s[24:27],s34 offen offset:0 nt
M v[152:155],a[100:103],a[160:163],v[152:155]
buffer_load_dwordx4 a[168:171],v250,s[20:23],s47 offen offset:0 sc1
M v[152:155],a[216:219],a[96:99],v[152:155]
ds_read_b128 a[120:123],v249 offset:0
ds_read_b128 a[140:143],v248 offset:512
M v[152:155],a[240:243],a[232:235],v[152:155]
ds_read_b128 a[108:111],v249 offset:512
v_accvgpr_read_b32 v237,a173
M v[156:159],a[240:243],a[252:255],v[156:159]
v_add_f32 v236,v238,v237
v_sub_f32 v238,v238,v237
M v[156:159],a[216:219],a[232:235],v[156:159]
buffer_load_dwordx4 a[148:151],v250,s[20:23],s47 offen offset:1024 sc1
M v[156:159],a[100:103],a[96:99],v[156:159]
s_waitcnt vmcnt(32) lgkmcnt(3)
v_add_f32 v237,v77,v173
v_sub_f32 v173,v77,v173
M v[96:99],a[144:147],a[124:127],v[96:99]
s_waitcnt vmcnt(31) lgkmcnt(2)
ds_read_b128 a[132:135],v248 offset:1024
v_add_f32 v77,v236,v237
M v[96:99],a[104:107],a[120:123],v[96:99]
s_waitcnt vmcnt(30) lgkmcnt(2)
ds_read_b128 a[160:163],v249 offset:1024
v_fmac_f32 v236,4.0,v237
M v[96:99],a[156:159],a[140:143],v[96:99]
s_waitcnt lgkmcnt(2)
buffer_load_dwordx4 a[112:115],v250,s[20:23],s47 offen offset:2048 sc1
M v[100:103],a[156:159],a[108:111],v[100:103]
v_fma_f32 v237,2.0,v173,v238
v_fma_f32 v173,s40,v173,v238
M v[100:103],a[104:107],a[140:143],v[100:103]
v_cvt_pk_bf16_f32 v232,v232,v237
v_cvt_pk_bf16_f32 v234,v234,v236
M v[100:103],a[144:147],a[120:123],v[100:103]
v_accvgpr_read_b32 v238,a78
v_accvgpr_read_b32 v233,a174
M v[104:107],a[144:147],a[140:143],v[104:107]
ds_read_b128 a[96:99],v248 offset:1536
v_add_f32 v235,v238,v233
M v[104:107],a[104:107],a[108:111],v[104:107]
s_waitcnt lgkmcnt(2)
ds_read_b128 a[100:103],v249 offset:1536
v_sub_f32 v238,v238,v233
M v[104:107],a[156:159],a[132:135],v[104:107]
s_waitcnt lgkmcnt(2)
v_add_f32 v233,v78,v174
v_sub_f32 v174,v78,v174
M v[108:111],a[156:159],a[160:163],v[108:111]
v_add_f32 v78,v235,v233
v_fmac_f32 v235,4.0,v233
M v[108:111],a[104:107],a[132:135],v[108:111]
v_fma_f32 v233,2.0,v174,v238
v_fma_f32 v174,s40,v174,v238
M v[108:111],a[144:147],a[108:111],v[108:111]
v_accvgpr_read_b32 v238,a79
v_accvgpr_read_b32 v237,a175
M v[112:115],a[144:147],a[132:135],v[112:115]
s_add_u32 s48,s72,6144
ds_read_b128 a[172:175],v249 offset:2048
v_add_f32 v236,v238,v237
M v[112:115],a[104:107],a[160:163],v[112:115]
s_waitcnt lgkmcnt(2)
ds_read_b128 v[220:223],v248 offset:2048
v_sub_f32 v238,v238,v237
M v[112:115],a[156:159],a[96:99],v[112:115]
s_waitcnt lgkmcnt(2)
v_add_f32 v237,v79,v175
v_sub_f32 v175,v79,v175
M v[116:119],a[156:159],a[100:103],v[116:119]
v_add_f32 v79,v236,v237
v_fmac_f32 v236,4.0,v237
M v[116:119],a[104:107],a[96:99],v[116:119]
v_fma_f32 v237,2.0,v175,v238
v_fma_f32 v175,s40,v175,v238
M v[116:119],a[144:147],a[160:163],v[116:119]
v_cvt_pk_bf16_f32 v233,v233,v237
v_cvt_pk_bf16_f32 v235,v235,v236
M v[120:123],a[144:147],a[96:99],v[120:123]
buffer_load_dwordx4 a[224:227],v250,s[20:23],s48 offen offset:0 sc1
M v[120:123],a[104:107],a[100:103],v[120:123]
s_waitcnt lgkmcnt(1)
ds_write2st64_b64 v254,v[232:233],v[234:235] offset0:59 offset1:63
M v[120:123],a[156:159],a[172:175],v[120:123]
s_waitcnt lgkmcnt(1)
buffer_load_dwordx4 a[244:247],v250,s[20:23],s48 offen offset:1024 sc1
M v[124:127],a[156:159],v[220:223],v[124:127]
v_accvgpr_read_b32 v238,a80
v_accvgpr_read_b32 v232,a176
M v[124:127],a[104:107],a[172:175],v[124:127]
v_add_f32 v234,v238,v232
v_sub_f32 v238,v238,v232
M v[124:127],a[144:147],a[100:103],v[124:127]
s_waitcnt vmcnt(25)
v_add_f32 v232,v80,v176
v_sub_f32 v176,v80,v176
M v[128:131],v[228:231],a[124:127],v[128:131]
s_waitcnt vmcnt(24)
buffer_load_dwordx4 v[216:219],v250,s[20:23],s48 offen offset:2048 sc1
M v[128:131],a[212:215],a[120:123],v[128:131]
s_waitcnt vmcnt(24)
v_add_f32 v80,v234,v232
v_fmac_f32 v234,4.0,v232
M v[128:131],a[236:239],a[140:143],v[128:131]
v_fma_f32 v232,2.0,v176,v238
v_fma_f32 v176,s40,v176,v238
M v[132:135],a[236:239],a[108:111],v[132:135]
v_accvgpr_read_b32 v238,a81
v_accvgpr_read_b32 v237,a177
M v[132:135],a[212:215],a[140:143],v[132:135]
v_add_f32 v236,v238,v237
v_sub_f32 v238,v238,v237
M v[132:135],v[228:231],a[120:123],v[132:135]
v_add_f32 v237,v81,v177
v_sub_f32 v177,v81,v177
M v[136:139],v[228:231],a[140:143],v[136:139]
v_add_f32 v81,v236,v237
v_fmac_f32 v236,4.0,v237
M v[136:139],a[212:215],a[108:111],v[136:139]
v_fma_f32 v237,2.0,v177,v238
v_fma_f32 v177,s40,v177,v238
M v[136:139],a[236:239],a[132:135],v[136:139]
v_cvt_pk_bf16_f32 v232,v232,v237
v_cvt_pk_bf16_f32 v234,v234,v236
M v[140:143],a[236:239],a[160:163],v[140:143]
v_accvgpr_read_b32 v238,a82
v_accvgpr_read_b32 v233,a178
M v[140:143],a[212:215],a[132:135],v[140:143]
v_add_f32 v235,v238,v233
v_sub_f32 v238,v238,v233
M v[140:143],v[228:231],a[108:111],v[140:143]
v_add_f32 v233,v82,v178
v_sub_f32 v178,v82,v178
M v[144:147],v[228:231],a[132:135],v[144:147]
s_add_u32 s47,s73,3072
v_add_f32 v82,v235,v233
v_fmac_f32 v235,4.0,v233
M v[144:147],a[212:215],a[160:163],v[144:147]
v_fma_f32 v233,2.0,v178,v238
v_fma_f32 v178,s40,v178,v238
M v[144:147],a[236:239],a[96:99],v[144:147]
v_accvgpr_read_b32 v238,a83
v_accvgpr_read_b32 v237,a179
M v[148:151],a[236:239],a[100:103],v[148:151]
v_add_f32 v236,v238,v237
v_sub_f32 v238,v238,v237
M v[148:151],a[212:215],a[96:99],v[148:151]
ds_read_b128 a[156:159],v248 offset:17408
v_add_f32 v237,v83,v179
M v[148:151],v[228:231],a[160:163],v[148:151]
ds_read_b128 a[104:107],v249 offset:17408
v_sub_f32 v179,v83,v179
M v[152:155],v[228:231],a[96:99],v[152:155]
buffer_load_dwordx4 a[144:147],v250,s[20:23],s47 offen offset:0 sc1
M v[152:155],a[212:215],a[100:103],v[152:155]
ds_read_b128 a[124:127],v248 offset:17920
ds_read_b128 a[140:143],v249 offset:17920
M v[152:155],a[236:239],a[172:175],v[152:155]
buffer_load_dwordx4 a[120:123],v250,s[20:23],s47 offen offset:1024 sc1
M v[156:159],a[236:239],v[220:223],v[156:159]
v_add_f32 v83,v236,v237
v_fmac_f32 v236,4.0,v237
M v[156:159],a[212:215],a[172:175],v[156:159]
v_fma_f32 v237,2.0,v179,v238
v_fma_f32 v179,s40,v179,v238
M v[156:159],v[228:231],a[100:103],v[156:159]
s_waitcnt vmcnt(24) lgkmcnt(3)
v_cvt_pk_bf16_f32 v233,v233,v237
v_cvt_pk_bf16_f32 v235,v235,v236
M v[96:99],a[116:119],a[156:159],v[96:99]
s_waitcnt vmcnt(23) lgkmcnt(2)
buffer_load_dwordx4 a[108:111],v250,s[20:23],s47 offen offset:2048 sc1
M v[96:99],a[128:131],a[104:107],v[96:99]
s_waitcnt vmcnt(23) lgkmcnt(1)
ds_read_b128 a[132:135],v248 offset:18432
ds_read_b128 a[176:179],v249 offset:18432
M v[96:99],a[204:207],a[124:127],v[96:99]
s_waitcnt lgkmcnt(2)
ds_write2st64_b64 v254,v[232:233],v[234:235] offset0:0 offset1:4
M v[100:103],a[204:207],a[140:143],v[100:103]
v_accvgpr_read_b32 v238,a84
v_accvgpr_read_b32 v232,a180
M v[100:103],a[128:131],a[124:127],v[100:103]
v_add_f32 v234,v238,v232
v_sub_f32 v238,v238,v232
M v[100:103],a[116:119],a[104:107],v[100:103]
v_add_f32 v232,v84,v180
v_sub_f32 v180,v84,v180
M v[104:107],a[116:119],a[124:127],v[104:107]
ds_read_b128 a[160:163],v248 offset:18944
v_add_f32 v84,v234,v232
M v[104:107],a[128:131],a[140:143],v[104:107]
s_waitcnt lgkmcnt(3)
ds_read_b128 a[96:99],v249 offset:18944
v_fmac_f32 v234,4.0,v232
M v[104:107],a[204:207],a[132:135],v[104:107]
s_waitcnt lgkmcnt(3)
v_fma_f32 v232,2.0,v180,v238
v_fma_f32 v180,s40,v180,v238
M v[108:111],a[204:207],a[176:179],v[108:111]
v_accvgpr_read_b32 v238,a85
v_accvgpr_read_b32 v237,a181
M v[108:111],a[128:131],a[132:135],v[108:111]
v_add_f32 v236,v238,v237
v_sub_f32 v238,v238,v237
M v[108:111],a[116:119],a[140:143],v[108:111]
v_add_f32 v237,v85,v181
v_sub_f32 v181,v85,v181
M v[112:115],a[116:119],a[132:135],v[112:115]
s_add_u32 s48,s73,6144
ds_read_b128 a[172:175],v249 offset:19456
v_add_f32 v85,v236,v237
M v[112:115],a[128:131],a[176:179],v[112:115]
s_waitcnt lgkmcnt(2)
ds_read_b128 a[100:103],v248 offset:19456
v_fmac_f32 v236,4.0,v237
M v[112:115],a[204:207],a[160:163],v[112:115]
s_waitcnt lgkmcnt(2)
v_fma_f32 v237,2.0,v181,v238
v_fma_f32 v181,s40,v181,v238
M v[116:119],a[204:207],a[96:99],v[116:119]
v_cvt_pk_bf16_f32 v232,v232,v237
v_cvt_pk_bf16_f32 v234,v234,v236
M v[116:119],a[128:131],a[160:163],v[116:119]
v_accvgpr_read_b32 v238,a86
v_accvgpr_read_b32 v233,a182
M v[116:119],a[116:119],a[176:179],v[116:119]
v_add_f32 v235,v238,v233
v_sub_f32 v238,v238,v233
M v[120:123],a[116:119],a[160:163],v[120:123]
buffer_load_dwordx4 a[192:195],v250,s[20:23],s48 offen offset:0 sc1
M v[120:123],a[128:131],a[96:99],v[120:123]
s_waitcnt lgkmcnt(1)
v_add_f32 v233,v86,v182
v_sub_f32 v182,v86,v182
M v[120:123],a[204:207],a[172:175],v[120:123]
s_waitcnt lgkmcnt(0)
buffer_load_dwordx4 a[208:211],v250,s[20:23],s48 offen offset:1024 sc1
M v[124:127],a[204:207],a[100:103],v[124:127]
v_add_f32 v86,v235,v233
v_fmac_f32 v235,4.0,v233
M v[124:127],a[128:131],a[172:175],v[124:127]
v_fma_f32 v233,2.0,v182,v238
v_fma_f32 v182,s40,v182,v238
M v[124:127],a[116:119],a[96:99],v[124:127]
s_waitcnt vmcnt(23)
v_accvgpr_read_b32 v238,a87
v_accvgpr_read_b32 v237,a183
M v[128:131],a[248:251],a[156:159],v[128:131]
s_waitcnt vmcnt(22)
buffer_load_dwordx4 a[240:243],v250,s[20:23],s48 offen offset:2048 sc1
M v[128:131],v[224:227],a[104:107],v[128:131]
s_waitcnt vmcnt(22)
v_add_f32 v236,v238,v237
v_sub_f32 v238,v238,v237
M v[128:131],a[200:203],a[124:127],v[128:131]
v_add_f32 v237,v87,v183
v_sub_f32 v183,v87,v183
M v[132:135],a[200:203],a[140:143],v[132:135]
v_add_f32 v87,v236,v237
v_fmac_f32 v236,4.0,v237
M v[132:135],v[224:227],a[124:127],v[132:135]
v_fma_f32 v237,2.0,v183,v238
v_fma_f32 v183,s40,v183,v238
M v[132:135],a[248:251],a[104:107],v[132:135]
v_cvt_pk_bf16_f32 v233,v233,v237
v_cvt_pk_bf16_f32 v235,v235,v236
M v[136:139],a[248:251],a[124:127],v[136:139]
ds_write2st64_b64 v254,v[232:233],v[234:235] offset0:8 offset1:12
M v[136:139],v[224:227],a[140:143],v[136:139]
v_accvgpr_read_b32 v238,a88
v_accvgpr_read_b32 v232,a184
M v[136:139],a[200:203],a[132:135],v[136:139]
v_add_f32 v234,v238,v232
v_sub_f32 v238,v238,v232
M v[140:143],a[200:203],a[176:179],v[140:143]
v_add_f32 v232,v88,v184
v_sub_f32 v184,v88,v184
M v[140:143],v[224:227],a[132:135],v[140:143]
v_add_f32 v88,v234,v232
v_fmac_f32 v234,4.0,v232
M v[140:143],a[248:251],a[140:143],v[140:143]
v_fma_f32 v232,2.0,v184,v238
v_fma_f32 v184,s40,v184,v238
M v[144:147],a[248:251],a[132:135],v[144:147]
s_add_u32 s47,s74,3072
v_accvgpr_read_b32 v238,a89
v_accvgpr_read_b32 v237,a185
M v[144:147],v[224:227],a[176:179],v[144:147]
v_add_u32 v248,0xfffece00,v248
v_add_u32 v249,0xfffece00,v249
M v[144:147],a[200:203],a[160:163],v[144:147]
v_add_f32 v236,v238,v237
v_sub_f32 v238,v238,v237
M v[148:151],a[200:203],a[96:99],v[148:151]
v_add_f32 v237,v89,v185
v_sub_f32 v185,v89,v185
M v[148:151],v[224:227],a[160:163],v[148:151]
ds_read_b128 a[128:131],v248 offset:26112
v_add_f32 v89,v236,v237
M v[148:151],a[248:251],a[176:179],v[148:151]
ds_read_b128 a[116:119],v249 offset:26112
v_fmac_f32 v236,4.0,v237
M v[152:155],a[248:251],a[160:163],v[152:155]
buffer_load_dwordx4 a[156:159],v250,s[20:23],s47 offen offset:0 sc1
M v[152:155],v[224:227],a[96:99],v[152:155]
ds_read_b128 a[180:183],v248 offset:26624
ds_read_b128 a[124:127],v249 offset:26624
M v[152:155],a[200:203],a[172:175],v[152:155]
buffer_load_dwordx4 a[104:107],v250,s[20:23],s47 offen offset:1024 sc1
M v[156:159],a[200:203],a[100:103],v[156:159]
v_fma_f32 v237,2.0,v185,v238
v_fma_f32 v185,s40,v185,v238
M v[156:159],v[224:227],a[172:175],v[156:159]
v_cvt_pk_bf16_f32 v232,v232,v237
v_cvt_pk_bf16_f32 v234,v234,v236
M v[156:159],a[248:251],a[96:99],v[156:159]
s_waitcnt vmcnt(22) lgkmcnt(3)
v_accvgpr_read_b32 v238,a90
v_accvgpr_read_b32 v233,a186
M v[96:99],a[152:155],a[128:131],v[96:99]
s_waitcnt vmcnt(21) lgkmcnt(2)
buffer_load_dwordx4 a[140:143],v250,s[20:23],s47 offen offset:2048 sc1
M v[96:99],a[136:139],a[116:119],v[96:99]
s_waitcnt vmcnt(21) lgkmcnt(1)
ds_read_b128 a[132:135],v248 offset:27136
ds_read_b128 a[176:179],v249 offset:27136
M v[96:99],a[164:167],a[180:183],v[96:99]
s_waitcnt lgkmcnt(2)
v_add_f32 v235,v238,v233
v_sub_f32 v238,v238,v233
M v[100:103],a[164:167],a[124:127],v[100:103]
v_add_f32 v233,v90,v186
v_sub_f32 v186,v90,v186
M v[100:103],a[136:139],a[180:183],v[100:103]
v_add_f32 v90,v235,v233
v_fmac_f32 v235,4.0,v233
M v[100:103],a[152:155],a[116:119],v[100:103]
v_fma_f32 v233,2.0,v186,v238
v_fma_f32 v186,s40,v186,v238
M v[104:107],a[152:155],a[180:183],v[104:107]
ds_read_b128 a[160:163],v248 offset:27648
v_accvgpr_read_b32 v238,a91
M v[104:107],a[136:139],a[124:127],v[104:107]
s_waitcnt lgkmcnt(2)
ds_read_b128 a[100:103],v249 offset:27648
v_accvgpr_read_b32 v237,a187
M v[104:107],a[164:167],a[132:135],v[104:107]
s_waitcnt lgkmcnt(2)
v_add_f32 v236,v238,v237
v_sub_f32 v238,v238,v237
M v[108:111],a[164:167],a[176:179],v[108:111]
v_add_f32 v237,v91,v187
v_sub_f32 v187,v91,v187
M v[108:111],a[136:139],a[132:135],v[108:111]
v_add_f32 v91,v236,v237
v_fmac_f32 v236,4.0,v237
M v[108:111],a[152:155],a[124:127],v[108:111]
v_fma_f32 v237,2.0,v187,v238
v_fma_f32 v187,s40,v187,v238
M v[112:115],a[152:155],a[132:135],v[112:115]
s_add_u32 s48,s74,6144
ds_read_b128 a[172:175],v249 offset:28160
v_cvt_pk_bf16_f32 v233,v233,v237
M v[112:115],a[136:139],a[176:179],v[112:115]
s_waitcnt lgkmcnt(2)
ds_read_b128 a[96:99],v248 offset:28160
v_cvt_pk_bf16_f32 v235,v235,v236
M v[112:115],a[164:167],a[160:163],v[112:115]
s_waitcnt lgkmcnt(2)
ds_write2st64_b64 v254,v[232:233],v[234:235] offset0:17 offset1:21
M v[116:119],a[164:167],a[100:103],v[116:119]
v_accvgpr_read_b32 v238,a92
v_accvgpr_read_b32 v232,a188
M v[116:119],a[136:139],a[160:163],v[116:119]
v_add_f32 v234,v238,v232
v_sub_f32 v238,v238,v232
M v[116:119],a[152:155],a[176:179],v[116:119]
v_add_f32 v232,v92,v188
v_sub_f32 v188,v92,v188
M v[120:123],a[152:155],a[160:163],v[120:123]
buffer_load_dwordx4 a[184:187],v250,s[20:23],s48 offen offset:0 sc1
M v[120:123],a[136:139],a[100:103],v[120:123]
s_waitcnt lgkmcnt(2)
v_add_f32 v92,v234,v232
v_fmac_f32 v234,4.0,v232
M v[120:123],a[164:167],a[172:175],v[120:123]
s_waitcnt lgkmcnt(1)
buffer_load_dwordx4 a[252:255],v250,s[20:23],s48 offen offset:1024 sc1
M v[124:127],a[164:167],a[96:99],v[124:127]
v_fma_f32 v232,2.0,v188,v238
v_fma_f32 v188,s40,v188,v238
M v[124:127],a[136:139],a[172:175],v[124:127]
v_accvgpr_read_b32 v238,a93
v_accvgpr_read_b32 v237,a189
M v[124:127],a[152:155],a[100:103],v[124:127]
s_waitcnt vmcnt(21)
v_add_f32 v236,v238,v237
v_sub_f32 v238,v238,v237
M v[128:131],a[228:231],a[128:131],v[128:131]
s_waitcnt vmcnt(20)
buffer_load_dwordx4 a[216:219],v250,s[20:23],s48 offen offset:2048 sc1
M v[128:131],a[196:199],a[116:119],v[128:131]
s_waitcnt vmcnt(20)
v_add_f32 v237,v93,v189
v_sub_f32 v189,v93,v189
M v[128:131],a[220:223],a[180:183],v[128:131]
v_add_f32 v93,v236,v237
v_fmac_f32 v236,4.0,v237
M v[132:135],a[220:223],a[124:127],v[132:135]
v_fma_f32 v237,2.0,v189,v238
v_fma_f32 v189,s40,v189,v238
M v[132:135],a[196:199],a[180:183],v[132:135]
v_cvt_pk_bf16_f32 v232,v232,v237
v_cvt_pk_bf16_f32 v234,v234,v236
M v[132:135],a[228:231],a[116:119],v[132:135]
v_accvgpr_read_b32 v238,a94
v_accvgpr_read_b32 v233,a190
M v[136:139],a[228:231],a[180:183],v[136:139]
v_add_f32 v235,v238,v233
v_sub_f32 v238,v238,v233
M v[136:139],a[196:199],a[124:127],v[136:139]
v_add_f32 v233,v94,v190
v_sub_f32 v190,v94,v190
M v[136:139],a[220:223],a[132:135],v[136:139]
v_add_f32 v94,v235,v233
v_fmac_f32 v235,4.0,v233
M v[140:143],a[220:223],a[176:179],v[140:143]
v_fma_f32 v233,2.0,v190,v238
v_fma_f32 v190,s40,v190,v238
M v[140:143],a[196:199],a[132:135],v[140:143]
v_accvgpr_read_b32 v238,a95
v_accvgpr_read_b32 v237,a191
M v[140:143],a[228:231],a[124:127],v[140:143]
v_add_f32 v236,v238,v237
v_sub_f32 v238,v238,v237
M v[144:147],a[228:231],a[132:135],v[144:147]
s_add_u32 s47,s75,3072
v_add_f32 v237,v95,v191
v_sub_f32 v191,v95,v191
M v[144:147],a[196:199],a[176:179],v[144:147]
v_add_f32 v95,v236,v237
v_fmac_f32 v236,4.0,v237
M v[144:147],a[220:223],a[160:163],v[144:147]
v_fma_f32 v237,2.0,v191,v238
v_fma_f32 v191,s40,v191,v238
M v[148:151],a[220:223],a[100:103],v[148:151]
v_cvt_pk_bf16_f32 v233,v233,v237
v_cvt_pk_bf16_f32 v235,v235,v236
M v[148:151],a[196:199],a[160:163],v[148:151]
ds_read_b128 a[164:167],v248 offset:0
ds_write2st64_b64 v254,v[232:233],v[234:235] offset0:25 offset1:29
M v[148:151],a[228:231],a[176:179],v[148:151]
ds_read_b128 a[136:139],v249 offset:0
v_cvt_pk_bf16_f32 v96,v96,v97
M v[152:155],a[228:231],a[160:163],v[152:155]
buffer_load_dwordx4 a[152:155],v250,s[20:23],s47 offen offset:0 sc1
M v[152:155],a[196:199],a[100:103],v[152:155]
ds_read_b128 a[128:131],v248 offset:512
ds_read_b128 a[180:183],v249 offset:512
M v[152:155],a[220:223],a[172:175],v[152:155]
buffer_load_dwordx4 a[116:119],v250,s[20:23],s47 offen offset:1024 sc1
M v[156:159],a[220:223],a[96:99],v[156:159]
v_cvt_pk_bf16_f32 v97,v98,v99
v_cvt_pk_bf16_f32 v100,v100,v101
M v[156:159],a[196:199],a[172:175],v[156:159]
v_cvt_pk_bf16_f32 v101,v102,v103
M v[156:159],a[228:231],a[100:103],v[156:159]
s_waitcnt vmcnt(19) lgkmcnt(3)
s_barrier
ds_read_b128 a[64:67],v250 offset:17408
M v[32:35],a[168:171],a[164:167],v[32:35]
s_waitcnt vmcnt(18) lgkmcnt(3)
ds_read_b128 a[68:71],v250 offset:21504
ds_read_b128 a[72:75],v250 offset:26112
M v[32:35],a[148:151],a[136:139],v[32:35]
s_waitcnt vmcnt(17) lgkmcnt(4)
ds_read_b128 a[76:79],v250 offset:30208
ds_read_b128 a[80:83],v250 offset:0
M v[32:35],a[112:115],a[128:131],v[32:35]
s_waitcnt lgkmcnt(5)
ds_read_b128 a[84:87],v250 offset:4096
ds_read_b128 a[88:91],v250 offset:8704
M v[36:39],a[112:115],a[180:183],v[36:39]
ds_read_b128 a[92:95],v250 offset:12800
ds_read_b128 a[188:191],v248 offset:1024
M v[36:39],a[148:151],a[128:131],v[36:39]
s_add_u32 s34,s32,6291456
buffer_load_dwordx4 a[124:127],v250,s[20:23],s47 offen offset:2048 sc1
ds_read_b128 a[132:135],v249 offset:1024
M v[36:39],a[168:171],a[136:139],v[36:39]
ds_write2st64_b64 v254,v[96:97],v[100:101] offset0:68 offset1:72
M v[40:43],a[168:171],a[128:131],v[40:43]
ds_read_b128 a[176:179],v248 offset:1536
v_cvt_pk_bf16_f32 v104,v104,v105
M v[40:43],a[148:151],a[180:183],v[40:43]
s_waitcnt lgkmcnt(3)
ds_read_b128 a[160:163],v249 offset:1536
v_cvt_pk_bf16_f32 v105,v106,v107
M v[40:43],a[112:115],a[188:191],v[40:43]
s_waitcnt lgkmcnt(3)
buffer_store_dwordx4 a[64:67],v253,s[24:27],s34 offen offset:640 nt
M v[44:47],a[112:115],a[132:135],v[44:47]
s_add_u32 s34,s32,6488064
v_cvt_pk_bf16_f32 v108,v108,v109
v_cvt_pk_bf16_f32 v109,v110,v111
M v[44:47],a[148:151],a[188:191],v[44:47]
ds_write2st64_b64 v254,v[104:105],v[108:109] offset0:76 offset1:80
M v[44:47],a[168:171],a[180:183],v[44:47]
buffer_store_dwordx4 a[68:71],v253,s[24:27],s34 offen offset:640 nt
M v[48:51],a[168:171],a[188:191],v[48:51]
s_add_u32 s34,s32,6684672
ds_read_b128 a[96:99],v249 offset:2048
s_add_u32 s48,s75,6144
M v[48:51],a[148:151],a[132:135],v[48:51]
s_waitcnt lgkmcnt(3)
ds_read_b128 a[172:175],v248 offset:2048
v_cvt_pk_bf16_f32 v112,v112,v113
M v[48:51],a[112:115],a[176:179],v[48:51]
s_waitcnt lgkmcnt(3)
buffer_store_dwordx4 a[72:75],v253,s[24:27],s34 offen offset:640 nt
M v[52:55],a[112:115],a[160:163],v[52:55]
s_add_u32 s34,s32,6881280
v_cvt_pk_bf16_f32 v113,v114,v115
v_cvt_pk_bf16_f32 v116,v116,v117
M v[52:55],a[148:151],a[176:179],v[52:55]
v_cvt_pk_bf16_f32 v117,v118,v119
M v[52:55],a[168:171],a[132:135],v[52:55]
buffer_store_dwordx4 a[76:79],v253,s[24:27],s34 offen offset:640 nt
M v[56:59],a[168:171],a[176:179],v[56:59]
s_add_u32 s34,s32,7077888
buffer_load_dwordx4 a[100:103],v250,s[20:23],s48 offen offset:0 sc1
M v[56:59],a[148:151],a[160:163],v[56:59]
s_waitcnt lgkmcnt(1)
ds_write2st64_b64 v254,v[112:113],v[116:117] offset0:85 offset1:89
M v[56:59],a[112:115],a[96:99],v[56:59]
s_waitcnt lgkmcnt(1)
v_cvt_pk_bf16_f32 v120,v120,v121
v_cvt_pk_bf16_f32 v121,v122,v123
M v[60:63],a[112:115],a[172:175],v[60:63]
v_cvt_pk_bf16_f32 v124,v124,v125
v_cvt_pk_bf16_f32 v125,v126,v127
M v[60:63],a[148:151],a[96:99],v[60:63]
buffer_load_dwordx4 a[232:235],v250,s[20:23],s48 offen offset:1024 sc1
M v[60:63],a[168:171],a[160:163],v[60:63]
s_waitcnt vmcnt(23)
ds_write2st64_b64 v254,v[120:121],v[124:125] offset0:93 offset1:97
M v[64:67],a[224:227],a[164:167],v[64:67]
s_waitcnt vmcnt(22)
v_cvt_pk_bf16_f32 v128,v128,v129
v_cvt_pk_bf16_f32 v129,v130,v131
M v[64:67],a[244:247],a[136:139],v[64:67]
s_waitcnt vmcnt(21)
buffer_load_dwordx4 a[236:239],v250,s[20:23],s48 offen offset:2048 sc1
M v[64:67],v[216:219],a[128:131],v[64:67]
v_cvt_pk_bf16_f32 v132,v132,v133
v_cvt_pk_bf16_f32 v133,v134,v135
M v[68:71],v[216:219],a[180:183],v[68:71]
s_waitcnt lgkmcnt(0)
s_barrier
ds_read_b128 v[96:99],v250 offset:34816
M v[68:71],a[244:247],a[128:131],v[68:71]
ds_read_b128 v[104:107],v250 offset:38912
ds_read_b128 v[112:115],v250 offset:43520
M v[68:71],a[224:227],a[136:139],v[68:71]
ds_read_b128 v[120:123],v250 offset:47616
buffer_store_dwordx4 a[80:83],v253,s[24:27],s34 offen offset:640 nt
M v[72:75],a[224:227],a[128:131],v[72:75]
s_add_u32 s34,s32,7274496
ds_write2st64_b64 v254,v[128:129],v[132:133] offset0:34 offset1:38
M v[72:75],a[244:247],a[180:183],v[72:75]
v_cvt_pk_bf16_f32 v136,v136,v137
v_cvt_pk_bf16_f32 v137,v138,v139
M v[72:75],v[216:219],a[188:191],v[72:75]
buffer_store_dwordx4 a[84:87],v253,s[24:27],s34 offen offset:640 nt
M v[76:79],v[216:219],a[132:135],v[76:79]
s_add_u32 s34,s32,7471104
v_cvt_pk_bf16_f32 v140,v140,v141
v_cvt_pk_bf16_f32 v141,v142,v143
M v[76:79],a[244:247],a[188:191],v[76:79]
ds_write2st64_b64 v254,v[136:137],v[140:141] offset0:42 offset1:46
M v[76:79],a[224:227],a[180:183],v[76:79]
buffer_store_dwordx4 a[88:91],v253,s[24:27],s34 offen offset:640 nt
M v[80:83],a[224:227],a[188:191],v[80:83]
s_add_u32 s34,s32,7667712
s_add_u32 s47,s76,3072
v_cvt_pk_bf16_f32 v144,v144,v145
M v[80:83],a[244:247],a[132:135],v[80:83]
v_cvt_pk_bf16_f32 v145,v146,v147
v_cvt_pk_bf16_f32 v148,v148,v149
M v[80:83],v[216:219],a[176:179],v[80:83]
buffer_store_dwordx4 a[92:95],v253,s[24:27],s34 offen offset:640 nt
M v[84:87],v[216:219],a[160:163],v[84:87]
v_cvt_pk_bf16_f32 v149,v150,v151
M v[84:87],a[244:247],a[176:179],v[84:87]
ds_read_b128 a[112:115],v248 offset:34816
ds_write2st64_b64 v254,v[144:145],v[148:149] offset0:51 offset1:55
M v[84:87],a[224:227],a[132:135],v[84:87]
ds_read_b128 a[148:151],v249 offset:34816
v_cvt_pk_bf16_f32 v152,v152,v153
M v[88:91],a[224:227],a[176:179],v[88:91]
buffer_load_dwordx4 a[168:171],v250,s[20:23],s47 offen offset:0 sc1
M v[88:91],a[244:247],a[160:163],v[88:91]
ds_read_b128 a[164:167],v248 offset:35328
ds_read_b128 a[128:131],v249 offset:35328
M v[88:91],v[216:219],a[96:99],v[88:91]
buffer_load_dwordx4 a[136:139],v250,s[20:23],s47 offen offset:1024 sc1
M v[92:95],v[216:219],a[172:175],v[92:95]
v_cvt_pk_bf16_f32 v153,v154,v155
v_cvt_pk_bf16_f32 v156,v156,v157
M v[92:95],a[244:247],a[96:99],v[92:95]
v_cvt_pk_bf16_f32 v157,v158,v159
M v[92:95],a[224:227],a[160:163],v[92:95]
s_waitcnt vmcnt(27) lgkmcnt(4)
ds_write2st64_b64 v254,v[152:153],v[156:157] offset0:59 offset1:63
M v[32:35],a[144:147],a[112:115],v[32:35]
s_waitcnt vmcnt(26) lgkmcnt(3)
s_add_u32 s34,s33,6291456
buffer_load_dwordx4 a[180:183],v250,s[20:23],s47 offen offset:2048 sc1
M v[32:35],a[120:123],a[148:151],v[32:35]
s_waitcnt vmcnt(26) lgkmcnt(2)
ds_read_b128 a[188:191],v248 offset:35840
ds_read_b128 a[132:135],v249 offset:35840
M v[32:35],a[108:111],a[164:167],v[32:35]
s_waitcnt lgkmcnt(2)
s_barrier
ds_read_b128 v[128:131],v250 offset:17408
M v[36:39],a[108:111],a[128:131],v[36:39]
ds_read_b128 v[136:139],v250 offset:21504
ds_read_b128 v[144:147],v250 offset:26112
M v[36:39],a[120:123],a[164:167],v[36:39]
ds_read_b128 v[152:155],v250 offset:30208
M v[36:39],a[144:147],a[148:151],v[36:39]
buffer_store_dwordx4 v[96:99],v253,s[24:27],s34 offen offset:1152 nt
M v[40:43],a[144:147],a[164:167],v[40:43]
ds_read_b128 a[176:179],v248 offset:36352
M v[40:43],a[120:123],a[128:131],v[40:43]
s_waitcnt lgkmcnt(6)
ds_read_b128 a[172:175],v249 offset:36352
M v[40:43],a[108:111],a[188:191],v[40:43]
s_waitcnt lgkmcnt(2)
s_barrier
M v[44:47],a[108:111],a[132:135],v[44:47]
M v[44:47],a[120:123],a[188:191],v[44:47]
M v[44:47],a[144:147],a[128:131],v[44:47]
M v[48:51],a[144:147],a[188:191],v[48:51]
s_add_u32 s48,s76,6144
ds_read_b128 a[96:99],v249 offset:36864
M v[48:51],a[120:123],a[132:135],v[48:51]
s_waitcnt lgkmcnt(2)
ds_read_b128 a[160:163],v248 offset:36864
M v[48:51],a[108:111],a[176:179],v[48:51]
s_waitcnt lgkmcnt(2)
M v[52:55],a[108:111],a[172:175],v[52:55]
M v[52:55],a[120:123],a[176:179],v[52:55]
M v[52:55],a[144:147],a[132:135],v[52:55]
M v[56:59],a[144:147],a[176:179],v[56:59]
buffer_load_dwordx4 v[220:223],v250,s[20:23],s48 offen offset:0 sc1
M v[56:59],a[120:123],a[172:175],v[56:59]
s_waitcnt lgkmcnt(1)
M v[56:59],a[108:111],a[96:99],v[56:59]
s_waitcnt lgkmcnt(0)
buffer_load_dwordx4 a[212:215],v250,s[20:23],s48 offen offset:1024 sc1
M v[60:63],a[108:111],a[160:163],v[60:63]
M v[60:63],a[120:123],a[96:99],v[60:63]
s_add_u32 s34,s33,6684672
M v[60:63],a[144:147],a[172:175],v[60:63]
s_waitcnt vmcnt(28)
M v[64:67],a[192:195],a[112:115],v[64:67]
s_waitcnt vmcnt(27)
buffer_load_dwordx4 v[228:231],v250,s[20:23],s48 offen offset:2048 sc1
M v[64:67],a[208:211],a[148:151],v[64:67]
s_waitcnt vmcnt(27)
M v[64:67],a[240:243],a[164:167],v[64:67]
M v[68:71],a[240:243],a[128:131],v[68:71]
M v[68:71],a[208:211],a[164:167],v[68:71]
M v[68:71],a[192:195],a[148:151],v[68:71]
buffer_store_dwordx4 v[104:107],v253,s[24:27],s34 offen offset:1152 nt
M v[72:75],a[192:195],a[164:167],v[72:75]
M v[72:75],a[208:211],a[128:131],v[72:75]
M v[72:75],a[240:243],a[188:191],v[72:75]
M v[76:79],a[240:243],a[132:135],v[76:79]
M v[76:79],a[208:211],a[188:191],v[76:79]
M v[76:79],a[192:195],a[128:131],v[76:79]
M v[80:83],a[192:195],a[188:191],v[80:83]
s_add_u32 s47,s77,3072
M v[80:83],a[208:211],a[132:135],v[80:83]
M v[80:83],a[240:243],a[176:179],v[80:83]
M v[84:87],a[240:243],a[172:175],v[84:87]
M v[84:87],a[208:211],a[176:179],v[84:87]
ds_read_b128 a[108:111],v248 offset:52224
M v[84:87],a[192:195],a[132:135],v[84:87]
ds_read_b128 a[120:123],v249 offset:52224
M v[88:91],a[192:195],a[176:179],v[88:91]
buffer_load_dwordx4 a[144:147],v250,s[20:23],s47 offen offset:0 sc1
M v[88:91],a[208:211],a[172:175],v[88:91]
ds_read_b128 a[112:115],v248 offset:52736
ds_read_b128 a[164:167],v249 offset:52736
M v[88:91],a[240:243],a[96:99],v[88:91]
s_add_u32 s34,s33,7077888
buffer_load_dwordx4 a[148:151],v250,s[20:23],s47 offen offset:1024 sc1
M v[92:95],a[240:243],a[160:163],v[92:95]
M v[92:95],a[208:211],a[96:99],v[92:95]
M v[92:95],a[192:195],a[172:175],v[92:95]
s_waitcnt vmcnt(29) lgkmcnt(3)
M v[32:35],a[156:159],a[108:111],v[32:35]
s_waitcnt vmcnt(28) lgkmcnt(2)
buffer_load_dwordx4 a[128:131],v250,s[20:23],s47 offen offset:2048 sc1
M v[32:35],a[104:107],a[120:123],v[32:35]
s_waitcnt vmcnt(28) lgkmcnt(1)
ds_read_b128 a[188:191],v248 offset:53248
ds_read_b128 a[132:135],v249 offset:53248
M v[32:35],a[140:143],a[112:115],v[32:35]
s_waitcnt lgkmcnt(2)
M v[36:39],a[140:143],a[164:167],v[36:39]
M v[36:39],a[104:107],a[112:115],v[36:39]
M v[36:39],a[156:159],a[120:123],v[36:39]
buffer_store_dwordx4 v[112:115],v253,s[24:27],s34 offen offset:1152 nt
M v[40:43],a[156:159],a[112:115],v[40:43]
ds_read_b128 a[176:179],v248 offset:53760
M v[40:43],a[104:107],a[164:167],v[40:43]
s_waitcnt lgkmcnt(2)
ds_read_b128 a[160:163],v249 offset:53760
M v[40:43],a[140:143],a[188:191],v[40:43]
s_waitcnt lgkmcnt(2)
M v[44:47],a[140:143],a[132:135],v[44:47]
M v[44:47],a[104:107],a[188:191],v[44:47]
M v[44:47],a[156:159],a[164:167],v[44:47]
M v[48:51],a[156:159],a[188:191],v[48:51]
s_add_u32 s48,s77,6144
ds_read_b128 a[96:99],v249 offset:54272
M v[48:51],a[104:107],a[132:135],v[48:51]
s_waitcnt lgkmcnt(2)
ds_read_b128 a[172:175],v248 offset:54272
M v[48:51],a[140:143],a[176:179],v[48:51]
s_waitcnt lgkmcnt(2)
M v[52:55],a[140:143],a[160:163],v[52:55]
M v[52:55],a[104:107],a[176:179],v[52:55]
M v[52:55],a[156:159],a[132:135],v[52:55]
M v[56:59],a[156:159],a[176:179],v[56:59]
s_add_u32 s34,s33,7471104
buffer_load_dwordx4 a[204:207],v250,s[20:23],s48 offen offset:0 sc1
M v[56:59],a[104:107],a[160:163],v[56:59]
s_waitcnt lgkmcnt(1)
M v[56:59],a[140:143],a[96:99],v[56:59]
s_waitcnt lgkmcnt(0)
buffer_store_dwordx4 v[120:123],v253,s[24:27],s34 offen offset:1152 nt
M v[60:63],a[140:143],a[172:175],v[60:63]
M v[60:63],a[104:107],a[96:99],v[60:63]
M v[60:63],a[156:159],a[160:163],v[60:63]
s_waitcnt vmcnt(30)
buffer_load_dwordx4 a[200:203],v250,s[20:23],s48 offen offset:1024 sc1
M v[64:67],a[184:187],a[108:111],v[64:67]
s_waitcnt vmcnt(30)
M v[64:67],a[252:255],a[120:123],v[64:67]
s_waitcnt vmcnt(29)
M v[64:67],a[216:219],a[112:115],v[64:67]
M v[68:71],a[216:219],a[164:167],v[68:71]
buffer_load_dwordx4 v[224:227],v250,s[20:23],s48 offen offset:2048 sc1
M v[68:71],a[252:255],a[112:115],v[68:71]
M v[68:71],a[184:187],a[120:123],v[68:71]
M v[72:75],a[184:187],a[112:115],v[72:75]
M v[72:75],a[252:255],a[164:167],v[72:75]
M v[72:75],a[216:219],a[188:191],v[72:75]
M v[76:79],a[216:219],a[132:135],v[76:79]
M v[76:79],a[252:255],a[188:191],v[76:79]
M v[76:79],a[184:187],a[164:167],v[76:79]
M v[80:83],a[184:187],a[188:191],v[80:83]
s_add_u32 s48,s72,52224
M v[80:83],a[252:255],a[132:135],v[80:83]
v_add_u32 v248,0x11000,v248
v_add_u32 v249,0x11000,v249
M v[80:83],a[216:219],a[176:179],v[80:83]
M v[84:87],a[216:219],a[160:163],v[84:87]
M v[84:87],a[252:255],a[176:179],v[84:87]
s_add_u32 s34,s33,6291456
ds_read_b128 a[140:143],v248 offset:0
M v[84:87],a[184:187],a[132:135],v[84:87]
buffer_store_dwordx4 v[128:131],v253,s[24:27],s34 offen offset:1280 nt
M v[88:91],a[184:187],a[176:179],v[88:91]
buffer_load_dwordx4 a[156:159],v250,s[20:23],s48 offen offset:0 sc1
M v[88:91],a[252:255],a[160:163],v[88:91]
ds_read_b128 a[104:107],v249 offset:0
ds_read_b128 a[108:111],v248 offset:512
M v[88:91],a[216:219],a[96:99],v[88:91]
ds_read_b128 a[112:115],v249 offset:512
M v[92:95],a[216:219],a[172:175],v[92:95]
M v[92:95],a[252:255],a[96:99],v[92:95]
buffer_load_dwordx4 a[120:123],v250,s[20:23],s48 offen offset:1024 sc1
M v[92:95],a[184:187],a[160:163],v[92:95]
s_waitcnt vmcnt(32) lgkmcnt(3)
M v[32:35],a[152:155],a[140:143],v[32:35]
s_waitcnt vmcnt(31) lgkmcnt(2)
ds_read_b128 a[188:191],v248 offset:1024
M v[32:35],a[116:119],a[104:107],v[32:35]
s_waitcnt vmcnt(30) lgkmcnt(2)
ds_read_b128 a[132:135],v249 offset:1024
M v[32:35],a[124:127],a[108:111],v[32:35]
s_waitcnt lgkmcnt(2)
buffer_load_dwordx4 a[164:167],v250,s[20:23],s48 offen offset:2048 sc1
M v[36:39],a[124:127],a[112:115],v[36:39]
M v[36:39],a[116:119],a[108:111],v[36:39]
M v[36:39],a[152:155],a[104:107],v[36:39]
M v[40:43],a[152:155],a[108:111],v[40:43]
ds_read_b128 a[176:179],v248 offset:1536
M v[40:43],a[116:119],a[112:115],v[40:43]
s_waitcnt lgkmcnt(2)
ds_read_b128 a[172:175],v249 offset:1536
M v[40:43],a[124:127],a[188:191],v[40:43]
s_waitcnt lgkmcnt(2)
M v[44:47],a[124:127],a[132:135],v[44:47]
M v[44:47],a[116:119],a[188:191],v[44:47]
M v[44:47],a[152:155],a[112:115],v[44:47]
M v[48:51],a[152:155],a[188:191],v[48:51]
s_add_u32 s48,s73,52224
ds_read_b128 a[96:99],v249 offset:2048
M v[48:51],a[116:119],a[132:135],v[48:51]
s_waitcnt lgkmcnt(2)
ds_read_b128 a[160:163],v248 offset:2048
M v[48:51],a[124:127],a[176:179],v[48:51]
s_waitcnt lgkmcnt(2)
M v[52:55],a[124:127],a[172:175],v[52:55]
s_add_u32 s34,s33,6684672
M v[52:55],a[116:119],a[176:179],v[52:55]
M v[52:55],a[152:155],a[132:135],v[52:55]
buffer_store_dwordx4 v[136:139],v253,s[24:27],s34 offen offset:1280 nt
M v[56:59],a[152:155],a[176:179],v[56:59]
buffer_load_dwordx4 a[184:187],v250,s[20:23],s48 offen offset:0 sc1
M v[56:59],a[116:119],a[172:175],v[56:59]
s_waitcnt lgkmcnt(1)
M v[56:59],a[124:127],a[96:99],v[56:59]
s_waitcnt lgkmcnt(0)
M v[60:63],a[124:127],a[160:163],v[60:63]
M v[60:63],a[116:119],a[96:99],v[60:63]
buffer_load_dwordx4 a[248:251],v250,s[20:23],s48 offen offset:1024 sc1
M v[60:63],a[152:155],a[172:175],v[60:63]
s_waitcnt vmcnt(29)
M v[64:67],a[100:103],a[140:143],v[64:67]
s_waitcnt vmcnt(28)
M v[64:67],a[232:235],a[104:107],v[64:67]
s_waitcnt vmcnt(27)
M v[64:67],a[236:239],a[108:111],v[64:67]
buffer_load_dwordx4 a[220:223],v250,s[20:23],s48 offen offset:2048 sc1
M v[68:71],a[236:239],a[112:115],v[68:71]
M v[68:71],a[232:235],a[108:111],v[68:71]
M v[68:71],a[100:103],a[104:107],v[68:71]
M v[72:75],a[100:103],a[108:111],v[72:75]
M v[72:75],a[232:235],a[112:115],v[72:75]
M v[72:75],a[236:239],a[188:191],v[72:75]
M v[76:79],a[236:239],a[132:135],v[76:79]
M v[76:79],a[232:235],a[188:191],v[76:79]
M v[76:79],a[100:103],a[112:115],v[76:79]
M v[80:83],a[100:103],a[188:191],v[80:83]
s_add_u32 s48,s74,52224
M v[80:83],a[232:235],a[132:135],v[80:83]
s_add_u32 s34,s33,7077888
M v[80:83],a[236:239],a[176:179],v[80:83]
buffer_store_dwordx4 v[144:147],v253,s[24:27],s34 offen offset:1280 nt
M v[84:87],a[236:239],a[172:175],v[84:87]
M v[84:87],a[232:235],a[176:179],v[84:87]
ds_read_b128 a[124:127],v248 offset:17408
M v[84:87],a[100:103],a[132:135],v[84:87]
ds_read_b128 a[116:119],v249 offset:17408
M v[88:91],a[100:103],a[176:179],v[88:91]
buffer_load_dwordx4 a[152:155],v250,s[20:23],s48 offen offset:0 sc1
M v[88:91],a[232:235],a[172:175],v[88:91]
ds_read_b128 a[140:143],v248 offset:17920
ds_read_b128 a[108:111],v249 offset:17920
M v[88:91],a[236:239],a[96:99],v[88:91]
buffer_load_dwordx4 a[104:107],v250,s[20:23],s48 offen offset:1024 sc1
M v[92:95],a[236:239],a[160:163],v[92:95]
M v[92:95],a[232:235],a[96:99],v[92:95]
M v[92:95],a[100:103],a[172:175],v[92:95]
s_waitcnt vmcnt(26) lgkmcnt(3)
M v[32:35],a[168:171],a[124:127],v[32:35]
s_waitcnt vmcnt(25) lgkmcnt(2)
buffer_load_dwordx4 a[112:115],v250,s[20:23],s48 offen offset:2048 sc1
M v[32:35],a[136:139],a[116:119],v[32:35]
s_waitcnt vmcnt(25) lgkmcnt(1)
ds_read_b128 a[188:191],v248 offset:18432
ds_read_b128 a[132:135],v249 offset:18432
M v[32:35],a[180:183],a[140:143],v[32:35]
s_waitcnt lgkmcnt(2)
M v[36:39],a[180:183],a[108:111],v[36:39]
M v[36:39],a[136:139],a[140:143],v[36:39]
M v[36:39],a[168:171],a[116:119],v[36:39]
M v[40:43],a[168:171],a[140:143],v[40:43]
ds_read_b128 a[176:179],v248 offset:18944
M v[40:43],a[136:139],a[108:111],v[40:43]
s_waitcnt lgkmcnt(2)
ds_read_b128 a[160:163],v249 offset:18944
M v[40:43],a[180:183],a[188:191],v[40:43]
s_waitcnt lgkmcnt(2)
M v[44:47],a[180:183],a[132:135],v[44:47]
M v[44:47],a[136:139],a[188:191],v[44:47]
M v[44:47],a[168:171],a[108:111],v[44:47]
s_add_u32 s34,s33,7471104
buffer_store_dwordx4 v[152:155],v253,s[24:27],s34 offen offset:1280 nt
M v[48:51],a[168:171],a[188:191],v[48:51]
s_add_u32 s48,s75,52224
ds_read_b128 a[96:99],v249 offset:19456
M v[48:51],a[136:139],a[132:135],v[48:51]
s_waitcnt lgkmcnt(2)
ds_read_b128 a[100:103],v248 offset:19456
M v[48:51],a[180:183],a[176:179],v[48:51]
s_waitcnt lgkmcnt(2)
M v[52:55],a[180:183],a[160:163],v[52:55]
M v[52:55],a[136:139],a[176:179],v[52:55]
M v[52:55],a[168:171],a[132:135],v[52:55]
M v[56:59],a[168:171],a[176:179],v[56:59]
buffer_load_dwordx4 a[172:175],v250,s[20:23],s48 offen offset:0 sc1
M v[56:59],a[136:139],a[160:163],v[56:59]
s_waitcnt lgkmcnt(1)
M v[56:59],a[180:183],a[96:99],v[56:59]
s_waitcnt lgkmcnt(0)
buffer_load_dwordx4 a[196:199],v250,s[20:23],s48 offen offset:1024 sc1
M v[60:63],a[180:183],a[100:103],v[60:63]
M v[60:63],a[136:139],a[96:99],v[60:63]
M v[60:63],a[168:171],a[160:163],v[60:63]
s_waitcnt vmcnt(26)
M v[64:67],v[220:223],a[124:127],v[64:67]
s_waitcnt vmcnt(25)
buffer_load_dwordx4 a[228:231],v250,s[20:23],s48 offen offset:2048 sc1
M v[64:67],a[212:215],a[116:119],v[64:67]
s_waitcnt vmcnt(25)
M v[64:67],v[228:231],a[140:143],v[64:67]
M v[68:71],v[228:231],a[108:111],v[68:71]
M v[68:71],a[212:215],a[140:143],v[68:71]
M v[68:71],v[220:223],a[116:119],v[68:71]
M v[72:75],v[220:223],a[140:143],v[72:75]
M v[72:75],a[212:215],a[108:111],v[72:75]
M v[72:75],v[228:231],a[188:191],v[72:75]
M v[76:79],v[228:231],a[132:135],v[76:79]
M v[76:79],a[212:215],a[188:191],v[76:79]
M v[76:79],v[220:223],a[108:111],v[76:79]
M v[80:83],v[220:223],a[188:191],v[80:83]
s_add_u32 s48,s76,52224
M v[80:83],a[212:215],a[132:135],v[80:83]
v_add_u32 v248,0xffff1200,v248
v_add_u32 v249,0xffff1200,v249
M v[80:83],v[228:231],a[176:179],v[80:83]
M v[84:87],v[228:231],a[160:163],v[84:87]
M v[84:87],a[212:215],a[176:179],v[84:87]
ds_read_b128 a[180:183],v248 offset:8704
M v[84:87],v[220:223],a[132:135],v[84:87]
ds_read_b128 a[136:139],v249 offset:8704
M v[88:91],v[220:223],a[176:179],v[88:91]
buffer_load_dwordx4 a[168:171],v250,s[20:23],s48 offen offset:0 sc1
M v[88:91],a[212:215],a[160:163],v[88:91]
ds_read_b128 a[124:127],v248 offset:9216
ds_read_b128 a[140:143],v249 offset:9216
M v[88:91],v[228:231],a[96:99],v[88:91]
buffer_load_dwordx4 a[116:119],v250,s[20:23],s48 offen offset:1024 sc1
M v[92:95],v[228:231],a[100:103],v[92:95]
M v[92:95],a[212:215],a[96:99],v[92:95]
M v[92:95],v[220:223],a[160:163],v[92:95]
s_waitcnt vmcnt(25) lgkmcnt(3)
M v[32:35],a[144:147],a[180:183],v[32:35]
s_waitcnt vmcnt(24) lgkmcnt(2)
buffer_load_dwordx4 a[108:111],v250,s[20:23],s48 offen offset:2048 sc1
M v[32:35],a[148:151],a[136:139],v[32:35]
s_waitcnt vmcnt(24) lgkmcnt(1)
s_add_u32 s48,s77,52224
ds_read_b128 a[100:103],v248 offset:9728
ds_read_b128 a[96:99],v249 offset:9728
M v[32:35],a[128:131],a[124:127],v[32:35]
s_waitcnt lgkmcnt(2)
M v[36:39],a[128:131],a[140:143],v[36:39]
M v[36:39],a[148:151],a[124:127],v[36:39]
buffer_load_dwordx4 a[188:191],v250,s[20:23],s48 offen offset:0 sc1
M v[36:39],a[144:147],a[136:139],v[36:39]
s_nop 2
v_cvt_pk_bf16_f32 v32,v32,v33
v_cvt_pk_bf16_f32 v33,v34,v35
M v[40:43],a[144:147],a[124:127],v[40:43]
ds_read_b128 a[160:163],v248 offset:10240
M v[40:43],a[148:151],a[140:143],v[40:43]
s_waitcnt lgkmcnt(2)
ds_read_b128 v[216:219],v249 offset:10240
M v[40:43],a[128:131],a[100:103],v[40:43]
s_waitcnt lgkmcnt(2)
buffer_load_dwordx4 a[132:135],v250,s[20:23],s48 offen offset:1024 sc1
M v[44:47],a[128:131],a[96:99],v[44:47]
v_cvt_pk_bf16_f32 v36,v36,v37
v_cvt_pk_bf16_f32 v37,v38,v39
M v[44:47],a[148:151],a[100:103],v[44:47]
ds_write2st64_b64 v254,v[32:33],v[36:37] offset0:34 offset1:38
M v[44:47],a[144:147],a[140:143],v[44:47]
v_cvt_pk_bf16_f32 v40,v40,v41
v_cvt_pk_bf16_f32 v41,v42,v43
M v[48:51],a[144:147],a[100:103],v[48:51]
buffer_load_dwordx4 a[176:179],v250,s[20:23],s48 offen offset:2048 sc1
M v[48:51],a[148:151],a[96:99],v[48:51]
s_waitcnt lgkmcnt(2)
ds_read_b128 a[244:247],v249 offset:10752
ds_read_b128 a[224:227],v248 offset:10752
M v[48:51],a[128:131],a[160:163],v[48:51]
s_waitcnt lgkmcnt(3)
v_cvt_pk_bf16_f32 v44,v44,v45
v_cvt_pk_bf16_f32 v45,v46,v47
M v[52:55],a[128:131],v[216:219],v[52:55]
ds_write2st64_b64 v254,v[40:41],v[44:45] offset0:42 offset1:46
M v[52:55],a[148:151],a[160:163],v[52:55]
M v[52:55],a[144:147],a[96:99],v[52:55]
s_nop 0
v_cvt_pk_bf16_f32 v48,v48,v49
v_cvt_pk_bf16_f32 v49,v50,v51
M v[56:59],a[144:147],a[160:163],v[56:59]
M v[56:59],a[148:151],v[216:219],v[56:59]
s_waitcnt lgkmcnt(2)
M v[56:59],a[128:131],a[244:247],v[56:59]
s_waitcnt lgkmcnt(1)
v_cvt_pk_bf16_f32 v52,v52,v53
v_cvt_pk_bf16_f32 v53,v54,v55
M v[60:63],a[128:131],a[224:227],v[60:63]
ds_write2st64_b64 v254,v[48:49],v[52:53] offset0:51 offset1:55
M v[60:63],a[148:151],a[244:247],v[60:63]
M v[60:63],a[144:147],v[216:219],v[60:63]
s_waitcnt vmcnt(25)
v_cvt_pk_bf16_f32 v56,v56,v57
v_cvt_pk_bf16_f32 v57,v58,v59
M v[64:67],a[204:207],a[180:183],v[64:67]
s_waitcnt vmcnt(23)
M v[64:67],a[200:203],a[136:139],v[64:67]
s_waitcnt vmcnt(22)
M v[64:67],v[224:227],a[124:127],v[64:67]
v_cvt_pk_bf16_f32 v60,v60,v61
v_cvt_pk_bf16_f32 v61,v62,v63
M v[68:71],v[224:227],a[140:143],v[68:71]
ds_write2st64_b64 v254,v[56:57],v[60:61] offset0:59 offset1:63
M v[68:71],a[200:203],a[124:127],v[68:71]
M v[68:71],a[204:207],a[136:139],v[68:71]
s_nop 1
v_cvt_pk_bf16_f32 v64,v64,v65
v_cvt_pk_bf16_f32 v65,v66,v67
M v[72:75],a[204:207],a[124:127],v[72:75]
M v[72:75],a[200:203],a[140:143],v[72:75]
M v[72:75],v[224:227],a[100:103],v[72:75]
s_nop 0
v_cvt_pk_bf16_f32 v68,v68,v69
v_cvt_pk_bf16_f32 v69,v70,v71
M v[76:79],v[224:227],a[96:99],v[76:79]
ds_write2st64_b64 v254,v[64:65],v[68:69] offset0:0 offset1:4
M v[76:79],a[200:203],a[100:103],v[76:79]
M v[76:79],a[204:207],a[140:143],v[76:79]
s_nop 0
v_cvt_pk_bf16_f32 v72,v72,v73
v_cvt_pk_bf16_f32 v73,v74,v75
M v[80:83],a[204:207],a[100:103],v[80:83]
M v[80:83],a[200:203],a[96:99],v[80:83]
M v[80:83],v[224:227],a[160:163],v[80:83]
s_nop 1
v_cvt_pk_bf16_f32 v76,v76,v77
v_cvt_pk_bf16_f32 v77,v78,v79
M v[84:87],v[224:227],v[216:219],v[84:87]
ds_write2st64_b64 v254,v[72:73],v[76:77] offset0:8 offset1:12
M v[84:87],a[200:203],a[160:163],v[84:87]
ds_read_b128 a[128:131],v248 offset:0
M v[84:87],a[204:207],a[96:99],v[84:87]
ds_read_b128 a[148:151],v249 offset:0
v_cvt_pk_bf16_f32 v80,v80,v81
M v[88:91],a[204:207],a[160:163],v[88:91]
ds_read_b128 a[144:147],v248 offset:512
v_cvt_pk_bf16_f32 v81,v82,v83
M v[88:91],a[200:203],v[216:219],v[88:91]
ds_read_b128 a[180:183],v249 offset:512
M v[88:91],v[224:227],a[244:247],v[88:91]
v_cvt_pk_bf16_f32 v84,v84,v85
v_cvt_pk_bf16_f32 v85,v86,v87
M v[92:95],v[224:227],a[224:227],v[92:95]
ds_write2st64_b64 v254,v[80:81],v[84:85] offset0:17 offset1:21
M v[92:95],a[200:203],a[244:247],v[92:95]
M v[92:95],a[204:207],v[216:219],v[92:95]
s_waitcnt vmcnt(20) lgkmcnt(4)
s_nop 0
v_cvt_pk_bf16_f32 v88,v88,v89
v_cvt_pk_bf16_f32 v89,v90,v91
M v[160:163],a[156:159],a[128:131],v[160:163]
s_waitcnt vmcnt(19) lgkmcnt(3)
ds_read_b128 a[136:139],v248 offset:1024
M v[160:163],a[120:123],a[148:151],v[160:163]
s_waitcnt vmcnt(18) lgkmcnt(3)
ds_read_b128 a[124:127],v249 offset:1024
M v[160:163],a[164:167],a[144:147],v[160:163]
s_waitcnt lgkmcnt(3)
v_cvt_pk_bf16_f32 v92,v92,v93
v_cvt_pk_bf16_f32 v93,v94,v95
M v[164:167],a[164:167],a[180:183],v[164:167]
ds_write2st64_b64 v254,v[88:89],v[92:93] offset0:25 offset1:29
M v[164:167],a[120:123],a[144:147],v[164:167]
M v[164:167],a[156:159],a[148:151],v[164:167]
M v[168:171],a[156:159],a[144:147],v[168:171]
s_waitcnt lgkmcnt(0)
s_barrier
ds_read_b128 v[32:35],v250 offset:17408
M v[168:171],a[120:123],a[180:183],v[168:171]
ds_read_b128 v[40:43],v250 offset:21504
ds_read_b128 v[48:51],v250 offset:26112
M v[168:171],a[164:167],a[136:139],v[168:171]
ds_read_b128 v[56:59],v250 offset:30208
ds_read_b128 v[64:67],v250 offset:0
M v[172:175],a[164:167],a[124:127],v[172:175]
ds_read_b128 v[72:75],v250 offset:4096
ds_read_b128 v[80:83],v250 offset:8704
ds_read_b128 a[140:143],v248 offset:1536
M v[172:175],a[120:123],a[136:139],v[172:175]
ds_read_b128 v[88:91],v250 offset:12800
ds_read_b128 a[100:103],v249 offset:1536
M v[172:175],a[156:159],a[180:183],v[172:175]
s_waitcnt lgkmcnt(9)
s_add_u32 s34,s33,6291456
buffer_store_dwordx4 v[32:35],v253,s[24:27],s34 offen offset:128 nt
M v[176:179],a[156:159],a[136:139],v[176:179]
s_add_u32 s34,s33,6684672
ds_read_b128 a[96:99],v249 offset:2048
M v[176:179],a[120:123],a[124:127],v[176:179]
s_waitcnt lgkmcnt(3)
ds_read_b128 a[160:163],v248 offset:2048
M v[176:179],a[164:167],a[140:143],v[176:179]
s_waitcnt lgkmcnt(2)
buffer_store_dwordx4 v[40:43],v253,s[24:27],s34 offen offset:128 nt
M v[180:183],a[164:167],a[100:103],v[180:183]
s_add_u32 s34,s33,7077888
M v[180:183],a[120:123],a[140:143],v[180:183]
ds_read_b128 a[128:131],v248 offset:34816
M v[180:183],a[156:159],a[124:127],v[180:183]
buffer_store_dwordx4 v[48:51],v253,s[24:27],s34 offen offset:128 nt
M v[184:187],a[156:159],a[140:143],v[184:187]
s_add_u32 s34,s33,7471104
ds_read_b128 a[148:151],v249 offset:34816
ds_read_b128 a[144:147],v248 offset:35328
M v[184:187],a[120:123],a[100:103],v[184:187]
s_waitcnt lgkmcnt(4)
ds_read_b128 a[180:183],v249 offset:35328
M v[184:187],a[164:167],a[96:99],v[184:187]
s_waitcnt lgkmcnt(4)
buffer_store_dwordx4 v[56:59],v253,s[24:27],s34 offen offset:128 nt
M v[188:191],a[164:167],a[160:163],v[188:191]
M v[188:191],a[120:123],a[96:99],v[188:191]
M v[188:191],a[156:159],a[100:103],v[188:191]
s_waitcnt vmcnt(20) lgkmcnt(3)
M v[160:163],a[184:187],a[128:131],v[160:163]
s_waitcnt vmcnt(19) lgkmcnt(2)
ds_read_b128 a[136:139],v248 offset:35840
M v[160:163],a[248:251],a[148:151],v[160:163]
s_waitcnt vmcnt(18) lgkmcnt(2)
s_add_u32 s34,s33,6291456
ds_read_b128 a[124:127],v249 offset:35840
M v[160:163],a[220:223],a[144:147],v[160:163]
s_waitcnt lgkmcnt(2)
buffer_store_dwordx4 v[64:67],v253,s[24:27],s34 offen offset:256 nt
M v[164:167],a[220:223],a[180:183],v[164:167]
M v[164:167],a[248:251],a[144:147],v[164:167]
M v[164:167],a[184:187],a[148:151],v[164:167]
M v[168:171],a[184:187],a[144:147],v[168:171]
ds_read_b128 a[140:143],v248 offset:36352
M v[168:171],a[248:251],a[180:183],v[168:171]
s_waitcnt lgkmcnt(2)
ds_read_b128 a[160:163],v249 offset:36352
M v[168:171],a[220:223],a[136:139],v[168:171]
s_waitcnt lgkmcnt(2)
M v[172:175],a[220:223],a[124:127],v[172:175]
M v[172:175],a[248:251],a[136:139],v[172:175]
M v[172:175],a[184:187],a[180:183],v[172:175]
M v[176:179],a[184:187],a[136:139],v[176:179]
ds_read_b128 a[164:167],v249 offset:36864
M v[176:179],a[248:251],a[124:127],v[176:179]
s_waitcnt lgkmcnt(2)
ds_read_b128 a[96:99],v248 offset:36864
M v[176:179],a[220:223],a[140:143],v[176:179]
s_waitcnt lgkmcnt(2)
M v[180:183],a[220:223],a[160:163],v[180:183]
M v[180:183],a[248:251],a[140:143],v[180:183]
ds_read_b128 a[120:123],v248 offset:52224
M v[180:183],a[184:187],a[124:127],v[180:183]
ds_read_b128 a[100:103],v249 offset:52224
M v[184:187],a[184:187],a[140:143],v[184:187]
ds_read_b128 a[156:159],v248 offset:52736
M v[184:187],a[248:251],a[160:163],v[184:187]
s_waitcnt lgkmcnt(4)
ds_read_b128 a[128:131],v249 offset:52736
M v[184:187],a[220:223],a[164:167],v[184:187]
s_waitcnt lgkmcnt(4)
M v[188:191],a[220:223],a[96:99],v[188:191]
M v[188:191],a[248:251],a[164:167],v[188:191]
M v[188:191],a[184:187],a[160:163],v[188:191]
s_waitcnt vmcnt(17) lgkmcnt(3)
s_add_u32 s34,s33,6684672
buffer_store_dwordx4 v[72:75],v253,s[24:27],s34 offen offset:256 nt
M v[160:163],a[152:155],a[120:123],v[160:163]
s_waitcnt vmcnt(17) lgkmcnt(2)
ds_read_b128 a[148:151],v248 offset:53248
M v[160:163],a[104:107],a[100:103],v[160:163]
s_waitcnt vmcnt(16) lgkmcnt(2)
ds_read_b128 a[144:147],v249 offset:53248
M v[160:163],a[112:115],a[156:159],v[160:163]
s_waitcnt lgkmcnt(2)
M v[164:167],a[112:115],a[128:131],v[164:167]
M v[164:167],a[104:107],a[156:159],v[164:167]
M v[164:167],a[152:155],a[100:103],v[164:167]
M v[168:171],a[152:155],a[156:159],v[168:171]
ds_read_b128 a[180:183],v248 offset:53760
M v[168:171],a[104:107],a[128:131],v[168:171]
s_waitcnt lgkmcnt(2)
ds_read_b128 a[136:139],v249 offset:53760
M v[168:171],a[112:115],a[148:151],v[168:171]
s_waitcnt lgkmcnt(2)
M v[172:175],a[112:115],a[144:147],v[172:175]
M v[172:175],a[104:107],a[148:151],v[172:175]
M v[172:175],a[152:155],a[128:131],v[172:175]
M v[176:179],a[152:155],a[148:151],v[176:179]
ds_read_b128 a[124:127],v249 offset:54272
M v[176:179],a[104:107],a[144:147],v[176:179]
s_waitcnt lgkmcnt(2)
ds_read_b128 a[140:143],v248 offset:54272
v_add_u32 v248,0x11000,v248
M v[176:179],a[112:115],a[180:183],v[176:179]
s_waitcnt lgkmcnt(2)
v_add_u32 v249,0x11000,v249
M v[180:183],a[112:115],a[136:139],v[180:183]
M v[180:183],a[104:107],a[180:183],v[180:183]
ds_read_b128 a[96:99],v248 offset:0
M v[180:183],a[152:155],a[144:147],v[180:183]
ds_read_b128 a[164:167],v249 offset:0
M v[184:187],a[152:155],a[180:183],v[184:187]
ds_read_b128 a[160:163],v248 offset:512
M v[184:187],a[104:107],a[136:139],v[184:187]
s_waitcnt lgkmcnt(4)
ds_read_b128 a[184:187],v249 offset:512
M v[184:187],a[112:115],a[124:127],v[184:187]
s_waitcnt lgkmcnt(4)
M v[188:191],a[112:115],a[140:143],v[188:191]
s_add_u32 s34,s33,7077888
M v[188:191],a[104:107],a[124:127],v[188:191]
M v[188:191],a[152:155],a[136:139],v[188:191]
s_waitcnt vmcnt(14) lgkmcnt(3)
buffer_store_dwordx4 v[80:83],v253,s[24:27],s34 offen offset:256 nt
M v[160:163],a[172:175],a[96:99],v[160:163]
s_waitcnt vmcnt(14) lgkmcnt(2)
ds_read_b128 a[120:123],v248 offset:1024
M v[160:163],a[196:199],a[164:167],v[160:163]
s_waitcnt vmcnt(13) lgkmcnt(2)
ds_read_b128 a[100:103],v249 offset:1024
M v[160:163],a[228:231],a[160:163],v[160:163]
s_waitcnt lgkmcnt(2)
M v[164:167],a[228:231],a[184:187],v[164:167]
M v[164:167],a[196:199],a[160:163],v[164:167]
M v[164:167],a[172:175],a[164:167],v[164:167]
M v[168:171],a[172:175],a[160:163],v[168:171]
ds_read_b128 a[156:159],v248 offset:1536
M v[168:171],a[196:199],a[184:187],v[168:171]
s_waitcnt lgkmcnt(2)
ds_read_b128 a[128:131],v249 offset:1536
M v[168:171],a[228:231],a[120:123],v[168:171]
s_waitcnt lgkmcnt(2)
M v[172:175],a[228:231],a[100:103],v[172:175]
M v[172:175],a[196:199],a[120:123],v[172:175]
M v[172:175],a[172:175],a[184:187],v[172:175]
M v[176:179],a[172:175],a[120:123],v[176:179]
ds_read_b128 a[148:151],v249 offset:2048
M v[176:179],a[196:199],a[100:103],v[176:179]
s_waitcnt lgkmcnt(2)
ds_read_b128 a[144:147],v248 offset:2048
M v[176:179],a[228:231],a[156:159],v[176:179]
s_waitcnt lgkmcnt(2)
M v[180:183],a[228:231],a[128:131],v[180:183]
M v[180:183],a[196:199],a[156:159],v[180:183]
ds_read_b128 a[180:183],v248 offset:17408
M v[180:183],a[172:175],a[100:103],v[180:183]
ds_read_b128 a[112:115],v249 offset:17408
M v[184:187],a[172:175],a[156:159],v[184:187]
ds_read_b128 a[140:143],v248 offset:17920
v_add_u32 v248,0xffff3400,v248
M v[184:187],a[196:199],a[128:131],v[184:187]
s_waitcnt lgkmcnt(4)
s_add_u32 s34,s33,7471104
v_add_u32 v249,0xffff3400,v249
M v[184:187],a[228:231],a[148:151],v[184:187]
s_waitcnt lgkmcnt(3)
buffer_store_dwordx4 v[88:91],v253,s[24:27],s34 offen offset:256 nt
M v[188:191],a[228:231],a[144:147],v[188:191]
ds_read_b128 a[104:107],v248 offset:0
ds_read_b128 a[124:127],v249 offset:0
M v[188:191],a[196:199],a[148:151],v[188:191]
ds_read_b128 a[136:139],v248 offset:512
ds_read_b128 a[152:155],v249 offset:512
M v[188:191],a[172:175],a[128:131],v[188:191]
s_waitcnt vmcnt(13) lgkmcnt(6)
v_add_u32 v248,0x11200,v248
v_add_u32 v249,0x11200,v249
M v[160:163],a[168:171],a[180:183],v[160:163]
s_waitcnt vmcnt(12) lgkmcnt(5)
M v[160:163],a[116:119],a[112:115],v[160:163]
s_waitcnt vmcnt(11) lgkmcnt(4)
ds_read_b128 a[96:99],v249 offset:0
M v[160:163],a[108:111],a[140:143],v[160:163]
s_waitcnt vmcnt(10) lgkmcnt(4)
M v[160:163],a[188:191],a[104:107],v[160:163]
s_waitcnt vmcnt(9) lgkmcnt(3)
M v[160:163],a[132:135],a[124:127],v[160:163]
s_waitcnt vmcnt(8) lgkmcnt(2)
M v[160:163],a[176:179],a[136:139],v[160:163]
s_waitcnt lgkmcnt(1)
M v[164:167],a[176:179],a[152:155],v[164:167]
ds_read_b128 a[164:167],v248 offset:512
v_add_u32 v248,0xfffef200,v248
M v[164:167],a[132:135],a[136:139],v[164:167]
v_add_u32 v249,0xfffef200,v249
M v[164:167],a[188:191],a[124:127],v[164:167]
s_waitcnt lgkmcnt(1)
v_cvt_pk_bf16_f32 v160,v160,v161
v_cvt_pk_bf16_f32 v161,v162,v163
M v[164:167],a[108:111],a[96:99],v[164:167]
ds_read_b128 a[160:163],v248 offset:0
M v[164:167],a[116:119],a[140:143],v[164:167]
ds_read_b128 a[184:187],v249 offset:0
v_add_u32 v248,0x11000,v248
M v[164:167],a[168:171],a[112:115],v[164:167]
v_add_u32 v249,0x11000,v249
M v[168:171],a[168:171],a[140:143],v[168:171]
M v[168:171],a[116:119],a[96:99],v[168:171]
s_waitcnt lgkmcnt(2)
ds_read_b128 a[120:123],v249 offset:0
M v[168:171],a[108:111],a[164:167],v[168:171]
s_nop 1
v_cvt_pk_bf16_f32 v164,v164,v165
v_cvt_pk_bf16_f32 v165,v166,v167
M v[168:171],a[188:191],a[136:139],v[168:171]
ds_write2st64_b64 v254,v[160:161],v[164:165] offset0:68 offset1:72
M v[168:171],a[132:135],a[152:155],v[168:171]
s_waitcnt lgkmcnt(3)
M v[168:171],a[176:179],a[160:163],v[168:171]
s_waitcnt lgkmcnt(2)
M v[172:175],a[176:179],a[184:187],v[172:175]
ds_read_b128 a[100:103],v248 offset:512
v_add_u32 v248,0xfffef200,v248
M v[172:175],a[132:135],a[160:163],v[172:175]
v_add_u32 v249,0xfffef200,v249
M v[172:175],a[188:191],a[152:155],v[172:175]
s_waitcnt lgkmcnt(2)
v_cvt_pk_bf16_f32 v168,v168,v169
v_cvt_pk_bf16_f32 v169,v170,v171
M v[172:175],a[108:111],a[120:123],v[172:175]
ds_read_b128 a[156:159],v248 offset:0
M v[172:175],a[116:119],a[164:167],v[172:175]
ds_read_b128 a[144:147],v249 offset:0
v_add_u32 v248,0x11000,v248
M v[172:175],a[168:171],a[96:99],v[172:175]
v_add_u32 v249,0x11000,v249
M v[176:179],a[168:171],a[164:167],v[176:179]
M v[176:179],a[116:119],a[120:123],v[176:179]
s_waitcnt lgkmcnt(2)
ds_read_b128 a[148:151],v249 offset:0
M v[176:179],a[108:111],a[100:103],v[176:179]
s_nop 1
v_cvt_pk_bf16_f32 v172,v172,v173
v_cvt_pk_bf16_f32 v173,v174,v175
M v[176:179],a[188:191],a[160:163],v[176:179]
ds_write2st64_b64 v254,v[168:169],v[172:173] offset0:76 offset1:80
M v[176:179],a[132:135],a[184:187],v[176:179]
s_waitcnt lgkmcnt(3)
M v[176:179],a[176:179],a[156:159],v[176:179]
s_waitcnt lgkmcnt(2)
M v[180:183],a[176:179],a[144:147],v[180:183]
s_waitcnt lgkmcnt(0)
s_barrier
ds_read_b128 v[160:163],v250 offset:34816
M v[180:183],a[132:135],a[156:159],v[180:183]
ds_read_b128 v[168:171],v250 offset:38912
ds_read_b128 a[128:131],v249 offset:512
M v[180:183],a[188:191],a[184:187],v[180:183]
v_add_u32 v248,0xfffef200,v248
v_add_u32 v249,0xfffef200,v249
M v[180:183],a[108:111],a[148:151],v[180:183]
ds_read_b128 a[172:175],v249 offset:0
v_cvt_pk_bf16_f32 v176,v176,v177
M v[180:183],a[116:119],a[100:103],v[180:183]
ds_read_b128 a[180:183],v248 offset:0
v_add_u32 v248,0x11000,v248
M v[180:183],a[168:171],a[120:123],v[180:183]
s_waitcnt lgkmcnt(4)
s_add_u32 s34,s33,6291456
buffer_store_dwordx4 v[160:163],v253,s[24:27],s34 offen offset:1408 nt
M v[184:187],a[168:171],a[100:103],v[184:187]
s_add_u32 s34,s33,6684672
v_add_u32 v249,0x11000,v249
v_cvt_pk_bf16_f32 v177,v178,v179
M v[184:187],a[116:119],a[148:151],v[184:187]
s_waitcnt lgkmcnt(2)
ds_read_b128 a[104:107],v248 offset:0
M v[184:187],a[108:111],a[128:131],v[184:187]
v_cvt_pk_bf16_f32 v180,v180,v181
v_cvt_pk_bf16_f32 v181,v182,v183
M v[184:187],a[188:191],a[156:159],v[184:187]
ds_write2st64_b64 v254,v[176:177],v[180:181] offset0:85 offset1:89
M v[184:187],a[132:135],a[144:147],v[184:187]
s_waitcnt lgkmcnt(3)
M v[184:187],a[176:179],a[172:175],v[184:187]
s_waitcnt lgkmcnt(2)
buffer_store_dwordx4 v[168:171],v253,s[24:27],s34 offen offset:1408 nt
M v[188:191],a[176:179],a[180:183],v[188:191]
s_waitcnt lgkmcnt(0)
s_barrier
ds_read_b128 v[176:179],v250 offset:43520
M v[188:191],a[132:135],a[172:175],v[188:191]
M v[188:191],a[188:191],a[144:147],v[188:191]
v_cvt_pk_bf16_f32 v184,v184,v185
v_cvt_pk_bf16_f32 v185,v186,v187
M v[188:191],a[108:111],a[104:107],v[188:191]
M v[188:191],a[116:119],a[128:131],v[188:191]
M v[188:191],a[168:171],a[148:151],v[188:191]
s_add_u32 s34,s33,7077888
s_waitcnt lgkmcnt(0)
buffer_store_dwordx4 v[176:179],v253,s[24:27],s34 offen offset:1408 nt
s_nop 4
v_cvt_pk_bf16_f32 v188,v188,v189
v_cvt_pk_bf16_f32 v189,v190,v191
ds_write2st64_b64 v254,v[184:185],v[188:189] offset0:93 offset1:97
s_waitcnt lgkmcnt(0)
s_barrier
ds_read_b128 v[184:187],v250 offset:47616
s_add_u32 s34,s33,7471104
s_waitcnt lgkmcnt(0)
buffer_store_dwordx4 v[184:187],v253,s[24:27],s34 offen offset:1408 nt
s_endpgm
L_code_end:
L_fallback:
s_mov_b32 s84,0
L_itemF:
s_and_b32 s85,s84,3
s_lshr_b32 s86,s84,2
s_mul_hi_u32 s87,s86,0x55555556
s_mul_i32 s88,s87,3
s_sub_u32 s86,s86,s88
s_mul_hi_u32 s88,s87,0x2aaaaaab
s_mul_i32 s89,s88,6
s_sub_u32 s87,s87,s89
s_mul_i32 s89,s86,221184
s_mul_i32 s90,s87,12288
s_add_u32 s89,s89,s90
s_mul_i32 s90,s85,3072
s_add_u32 s89,s89,s90
s_lshl_b32 s90,s88,7
s_add_u32 s89,s89,s90
s_add_u32 s90,s89,73728
s_add_u32 s91,s90,73728
v_lshlrev_b32 v149,1,v164
buffer_load_short_d16_hi v68,v149,s[36:39],s89 offen offset:0
buffer_load_short_d16_hi v69,v149,s[36:39],s89 offen offset:384
buffer_load_short_d16_hi v70,v149,s[36:39],s89 offen offset:768
buffer_load_short_d16_hi v71,v149,s[36:39],s89 offen offset:1152
buffer_load_short_d16_hi v72,v149,s[36:39],s89 offen offset:1536
buffer_load_short_d16_hi v73,v149,s[36:39],s89 offen offset:1920
buffer_load_short_d16_hi v74,v149,s[36:39],s89 offen offset:2304
buffer_load_short_d16_hi v75,v149,s[36:39],s89 offen offset:2688
buffer_load_short_d16_hi v76,v149,s[36:39],s90 offen offset:0
buffer_load_short_d16_hi v77,v149,s[36:39],s90 offen offset:384
buffer_load_short_d16_hi v78,v149,s[36:39],s90 offen offset:768
buffer_load_short_d16_hi v79,v149,s[36:39],s90 offen offset:1152
buffer_load_short_d16_hi v80,v149,s[36:39],s90 offen offset:1536
buffer_load_short_d16_hi v81,v149,s[36:39],s90 offen offset:1920
buffer_load_short_d16_hi v82,v149,s[36:39],s90 offen offset:2304
buffer_load_short_d16_hi v83,v149,s[36:39],s90 offen offset:2688
buffer_load_short_d16_hi v84,v149,s[36:39],s91 offen offset:0
buffer_load_short_d16_hi v85,v149,s[36:39],s91 offen offset:384
buffer_load_short_d16_hi v86,v149,s[36:39],s91 offen offset:768
buffer_load_short_d16_hi v87,v149,s[36:39],s91 offen offset:1152
buffer_load_short_d16_hi v88,v149,s[36:39],s91 offen offset:1536
buffer_load_short_d16_hi v89,v149,s[36:39],s91 offen offset:1920
buffer_load_short_d16_hi v90,v149,s[36:39],s91 offen offset:2304
buffer_load_short_d16_hi v91,v149,s[36:39],s91 offen offset:2688
s_and_b32 s92,s85,1
s_lshl_b32 s92,s92,2
s_lshr_b32 s85,s85,1
s_lshl_b32 s85,s85,2
v_bfe_u32 v148,v164,2,2
v_or_b32 v148,s92,v148
v_and_b32 v151,3,v164
v_or_b32 v151,s85,v151
v_xor_b32 v151,v151,v148
v_lshrrev_b32 v150,4,v164
v_mul_u32_u24 v150,331776,v150
v_lshl_add_u32 v150,v148,7,v150
v_lshl_add_u32 v150,v151,4,v150
s_mul_i32 s87,s87,55296
s_mul_i32 s88,s88,3072
s_add_u32 s87,s87,s88
s_lshl_b32 s86,s86,10
s_add_u32 s87,s87,s86
s_mov_b32 s85,0xbe2aaaab
s_mov_b32 s86,0x3d2aaaab
s_mov_b32 s88,0x3e2aaaab
s_mov_b32 s92,0x3daaaaab
s_waitcnt vmcnt(0)
v_add_f32 v148,v68,v84
v_add_f32 v92,v148,v76
v_sub_f32 v100,v148,v76
v_mul_f32 v92,s85,v92
v_mul_f32 v100,s85,v100
v_mul_f32 v148,s86,v68
v_fmac_f32 v148,s88,v84
v_fma_f32 v108,s92,v76,v148
v_fma_f32 v116,-s92,v76,v148
v_add_f32 v148,v69,v85
v_add_f32 v93,v148,v77
v_sub_f32 v101,v148,v77
v_mul_f32 v93,s85,v93
v_mul_f32 v101,s85,v101
v_mul_f32 v148,s86,v69
v_fmac_f32 v148,s88,v85
v_fma_f32 v109,s92,v77,v148
v_fma_f32 v117,-s92,v77,v148
v_add_f32 v148,v70,v86
v_add_f32 v94,v148,v78
v_sub_f32 v102,v148,v78
v_mul_f32 v94,s85,v94
v_mul_f32 v102,s85,v102
v_mul_f32 v148,s86,v70
v_fmac_f32 v148,s88,v86
v_fma_f32 v110,s92,v78,v148
v_fma_f32 v118,-s92,v78,v148
v_add_f32 v148,v71,v87
v_add_f32 v95,v148,v79
v_sub_f32 v103,v148,v79
v_mul_f32 v95,s85,v95
v_mul_f32 v103,s85,v103
v_mul_f32 v148,s86,v71
v_fmac_f32 v148,s88,v87
v_fma_f32 v111,s92,v79,v148
v_fma_f32 v119,-s92,v79,v148
v_add_f32 v148,v72,v88
v_add_f32 v96,v148,v80
v_sub_f32 v104,v148,v80
v_mul_f32 v96,s85,v96
v_mul_f32 v104,s85,v104
v_mul_f32 v148,s86,v72
v_fmac_f32 v148,s88,v88
v_fma_f32 v112,s92,v80,v148
v_fma_f32 v120,-s92,v80,v148
v_add_f32 v148,v73,v89
v_add_f32 v97,v148,v81
v_sub_f32 v105,v148,v81
v_mul_f32 v97,s85,v97
v_mul_f32 v105,s85,v105
v_mul_f32 v148,s86,v73
v_fmac_f32 v148,s88,v89
v_fma_f32 v113,s92,v81,v148
v_fma_f32 v121,-s92,v81,v148
v_add_f32 v148,v74,v90
v_add_f32 v98,v148,v82
v_sub_f32 v106,v148,v82
v_mul_f32 v98,s85,v98
v_mul_f32 v106,s85,v106
v_mul_f32 v148,s86,v74
v_fmac_f32 v148,s88,v90
v_fma_f32 v114,s92,v82,v148
v_fma_f32 v122,-s92,v82,v148
v_add_f32 v148,v75,v91
v_add_f32 v99,v148,v83
v_sub_f32 v107,v148,v83
v_mul_f32 v99,s85,v99
v_mul_f32 v107,s85,v107
v_mul_f32 v148,s86,v75
v_fmac_f32 v148,s88,v91
v_fma_f32 v115,s92,v83,v148
v_fma_f32 v123,-s92,v83,v148
v_cvt_pk_bf16_f32 v124,v68,v69
v_cvt_pk_bf16_f32 v125,v70,v71
v_cvt_pk_bf16_f32 v126,v72,v73
v_cvt_pk_bf16_f32 v127,v74,v75
s_add_u32 s89,s87,0
buffer_store_dwordx4 v[124:127],v150,s[20:23],s89 offen sc1
v_cvt_pk_bf16_f32 v144,v84,v85
v_cvt_pk_bf16_f32 v145,v86,v87
v_cvt_pk_bf16_f32 v146,v88,v89
v_cvt_pk_bf16_f32 v147,v90,v91
s_add_u32 s89,s87,46080
buffer_store_dwordx4 v[144:147],v150,s[20:23],s89 offen sc1
v_cvt_pk_bf16_f32 v128,v92,v93
v_cvt_pk_bf16_f32 v129,v94,v95
v_cvt_pk_bf16_f32 v130,v96,v97
v_cvt_pk_bf16_f32 v131,v98,v99
s_add_u32 s89,s87,9216
buffer_store_dwordx4 v[128:131],v150,s[20:23],s89 offen sc1
v_cvt_pk_bf16_f32 v132,v100,v101
v_cvt_pk_bf16_f32 v133,v102,v103
v_cvt_pk_bf16_f32 v134,v104,v105
v_cvt_pk_bf16_f32 v135,v106,v107
s_add_u32 s89,s87,18432
buffer_store_dwordx4 v[132:135],v150,s[20:23],s89 offen sc1
v_cvt_pk_bf16_f32 v136,v108,v109
v_cvt_pk_bf16_f32 v137,v110,v111
v_cvt_pk_bf16_f32 v138,v112,v113
v_cvt_pk_bf16_f32 v139,v114,v115
s_add_u32 s89,s87,27648
buffer_store_dwordx4 v[136:139],v150,s[20:23],s89 offen sc1
v_cvt_pk_bf16_f32 v140,v116,v117
v_cvt_pk_bf16_f32 v141,v118,v119
v_cvt_pk_bf16_f32 v142,v120,v121
v_cvt_pk_bf16_f32 v143,v122,v123
s_add_u32 s89,s87,36864
buffer_store_dwordx4 v[140:143],v150,s[20:23],s89 offen sc1
s_waitcnt vmcnt(0)
s_add_u32 s84,s84,1
s_cmp_lt_u32 s84,216
s_cbranch_scc1 L_itemF
s_branch L_uready
.section .rodata,"a"
.p2align 6
.amdhsa_kernel standalone__winograd__vision_kernel
  .amdhsa_next_free_vgpr 512
  .amdhsa_next_free_sgpr 96
  .amdhsa_accum_offset 256
  .amdhsa_group_segment_fixed_size 0
  .amdhsa_kernarg_size 40
  .amdhsa_user_sgpr_count 2
  .amdhsa_user_sgpr_kernarg_segment_ptr 1
  .amdhsa_system_sgpr_workgroup_id_x 1
  .amdhsa_float_denorm_mode_32 3
.end_amdhsa_kernel
```

```asm
; @launch grid=(256,1,1) block=(256,1,1) lds=156672
.amdgcn_target "amdgcn-amd-amdhsa--gfx950"
.macro M d,a,b,c
v_mfma_f32_16x16x32_bf16 \d,\a,\b,\c
.endm
.text
.globl standalone__winograd__vision_kernel
.p2align 8
.type standalone__winograd__vision_kernel,@function
standalone__winograd__vision_kernel:
s_cmp_ge_u32 s2,256
s_cbranch_scc0 L_go
s_endpgm
L_go:
s_load_dwordx4 s[4:7],s[0:1],0
s_load_dwordx4 s[24:27],s[0:1],16
s_load_dwordx2 s[20:21],s[0:1],32
v_lshlrev_b32 v165,4,v0
s_getpc_b64 s[64:65]
L_pc:
s_lshr_b32 s58,s2,3
s_lshl_b32 s58,s58,12
s_min_u32 s58,s58,L_code_end-L_pc-4096
s_add_u32 s64,s64,s58
s_addc_u32 s65,s65,0
global_load_dword v167,v165,s[64:65]
v_lshrrev_b32 v160,6,v0
v_and_b32 v164,63,v0
v_readfirstlane_b32 s50,v160
v_bfe_u32 v160,v164,3,2
v_bfe_u32 v161,v164,2,1
v_lshl_add_u32 v161,v160,3,v161
v_lshrrev_b32 v162,5,v164
v_xor_b32 v162,v162,v160
v_and_b32 v162,1,v162
v_and_b32 v163,3,v164
v_lshl_add_u32 v162,v162,2,v163
v_mul_u32_u24 v245,196608,v161
v_lshl_add_u32 v245,v162,3,v245
s_and_b32 s54,s2,7
s_lshr_b32 s55,s2,3
s_lshl_b32 s49,s54,6
s_lshl_b32 s55,s55,4
s_lshl_b32 s56,s50,2
s_add_u32 s56,s56,s55
s_mul_i32 s30,s56,384
s_mul_i32 s57,s49,196608
s_add_u32 s30,s30,s57
s_mul_i32 s44,s50,330752
s_mov_b32 s58,0
s_add_u32 s59,s58,0
s_lshl_b32 s84,s59,6
s_add_u32 s66,s30,s84
s_mul_i32 s84,s59,55296
s_add_u32 s72,s44,s84
s_add_u32 s59,s58,1
s_lshl_b32 s84,s59,6
s_add_u32 s67,s30,s84
s_mul_i32 s84,s59,55296
s_add_u32 s73,s44,s84
s_add_u32 s59,s58,2
s_lshl_b32 s84,s59,6
s_add_u32 s68,s30,s84
s_mul_i32 s84,s59,55296
s_add_u32 s74,s44,s84
s_add_u32 s59,s58,3
s_lshl_b32 s84,s59,6
s_add_u32 s69,s30,s84
s_mul_i32 s84,s59,55296
s_add_u32 s75,s44,s84
s_add_u32 s59,s58,4
s_lshl_b32 s84,s59,6
s_add_u32 s70,s30,s84
s_mul_i32 s84,s59,55296
s_add_u32 s76,s44,s84
s_add_u32 s59,s58,5
s_cmp_eq_u32 s59,6
s_cselect_b32 s59,0,s59
s_lshl_b32 s84,s59,6
s_add_u32 s71,s30,s84
s_mul_i32 s84,s59,55296
s_add_u32 s77,s44,s84
s_cmp_eq_u32 s49,0
s_cselect_b32 s58,1,0
v_cmp_gt_u32 vcc,s58,v161
v_lshrrev_b32 v163,5,v164
v_add_u32 v163,32,v163
v_mul_u32_u24 v246,196608,v163
v_bfrev_b32 v163,1
v_cndmask_b32 v251,v245,v163,vcc
v_lshl_add_u32 v168,v162,3,v245
v_cndmask_b32 v169,v168,v163,vcc
v_and_b32 v163,31,v164
v_lshlrev_b32 v163,1,v163
v_lshl_add_u32 v170,v163,1,v246
v_add_u32 v246,v246,v163
v_mov_b32 v166,1
s_mov_b32 s38,663552
s_mov_b32 s39,0x20000
s_mov_b32 s62,0
s_mov_b32 s63,0x20000
s_mov_b32 s22,1327104
s_mov_b32 s23,0x20000
s_waitcnt lgkmcnt(0)
s_and_b32 s21,s21,0xffff
s_mov_b32 s36,s6
s_and_b32 s37,s7,0xffff
s_mov_b32 s60,s26
s_and_b32 s61,s27,0xffff
s_mov_b32 s52,s26
s_mov_b32 s53,s27
s_cmp_lt_u32 s2,54
s_cbranch_scc0 L_noitem
s_lshl_b32 s84,s2,2
s_add_u32 s84,s84,s50
L_itemP:
s_and_b32 s85,s84,3
s_lshr_b32 s86,s84,2
s_mul_hi_u32 s87,s86,0x55555556
s_mul_i32 s88,s87,3
s_sub_u32 s86,s86,s88
s_mul_hi_u32 s88,s87,0x2aaaaaab
s_mul_i32 s89,s88,6
s_sub_u32 s87,s87,s89
s_mul_i32 s89,s86,221184
s_mul_i32 s90,s87,12288
s_add_u32 s89,s89,s90
s_mul_i32 s90,s85,3072
s_add_u32 s89,s89,s90
s_lshl_b32 s90,s88,7
s_add_u32 s89,s89,s90
s_add_u32 s90,s89,73728
s_add_u32 s91,s90,73728
v_lshlrev_b32 v149,1,v164
buffer_load_short_d16_hi v68,v149,s[36:39],s89 offen offset:0
buffer_load_short_d16_hi v69,v149,s[36:39],s89 offen offset:384
buffer_load_short_d16_hi v70,v149,s[36:39],s89 offen offset:768
buffer_load_short_d16_hi v71,v149,s[36:39],s89 offen offset:1152
buffer_load_short_d16_hi v72,v149,s[36:39],s89 offen offset:1536
buffer_load_short_d16_hi v73,v149,s[36:39],s89 offen offset:1920
buffer_load_short_d16_hi v74,v149,s[36:39],s89 offen offset:2304
buffer_load_short_d16_hi v75,v149,s[36:39],s89 offen offset:2688
buffer_load_short_d16_hi v76,v149,s[36:39],s90 offen offset:0
buffer_load_short_d16_hi v77,v149,s[36:39],s90 offen offset:384
buffer_load_short_d16_hi v78,v149,s[36:39],s90 offen offset:768
buffer_load_short_d16_hi v79,v149,s[36:39],s90 offen offset:1152
buffer_load_short_d16_hi v80,v149,s[36:39],s90 offen offset:1536
buffer_load_short_d16_hi v81,v149,s[36:39],s90 offen offset:1920
buffer_load_short_d16_hi v82,v149,s[36:39],s90 offen offset:2304
buffer_load_short_d16_hi v83,v149,s[36:39],s90 offen offset:2688
buffer_load_short_d16_hi v84,v149,s[36:39],s91 offen offset:0
buffer_load_short_d16_hi v85,v149,s[36:39],s91 offen offset:384
buffer_load_short_d16_hi v86,v149,s[36:39],s91 offen offset:768
buffer_load_short_d16_hi v87,v149,s[36:39],s91 offen offset:1152
buffer_load_short_d16_hi v88,v149,s[36:39],s91 offen offset:1536
buffer_load_short_d16_hi v89,v149,s[36:39],s91 offen offset:1920
buffer_load_short_d16_hi v90,v149,s[36:39],s91 offen offset:2304
buffer_load_short_d16_hi v91,v149,s[36:39],s91 offen offset:2688
s_and_b32 s92,s85,1
s_lshl_b32 s92,s92,2
s_lshr_b32 s85,s85,1
s_lshl_b32 s85,s85,2
v_bfe_u32 v148,v164,2,2
v_or_b32 v148,s92,v148
v_and_b32 v151,3,v164
v_or_b32 v151,s85,v151
v_xor_b32 v151,v151,v148
v_lshrrev_b32 v150,4,v164
v_mul_u32_u24 v150,331776,v150
v_lshl_add_u32 v150,v148,7,v150
v_lshl_add_u32 v150,v151,4,v150
s_mul_i32 s87,s87,55296
s_mul_i32 s88,s88,3072
s_add_u32 s87,s87,s88
s_lshl_b32 s86,s86,10
s_add_u32 s87,s87,s86
s_mov_b32 s85,0xbe2aaaab
s_mov_b32 s86,0x3d2aaaab
s_mov_b32 s88,0x3e2aaaab
s_mov_b32 s92,0x3daaaaab
s_waitcnt vmcnt(0)
v_add_f32 v148,v68,v84
v_add_f32 v92,v148,v76
v_sub_f32 v100,v148,v76
v_mul_f32 v92,s85,v92
v_mul_f32 v100,s85,v100
v_mul_f32 v148,s86,v68
v_fmac_f32 v148,s88,v84
v_fma_f32 v108,s92,v76,v148
v_fma_f32 v116,-s92,v76,v148
v_add_f32 v148,v69,v85
v_add_f32 v93,v148,v77
v_sub_f32 v101,v148,v77
v_mul_f32 v93,s85,v93
v_mul_f32 v101,s85,v101
v_mul_f32 v148,s86,v69
v_fmac_f32 v148,s88,v85
v_fma_f32 v109,s92,v77,v148
v_fma_f32 v117,-s92,v77,v148
v_add_f32 v148,v70,v86
v_add_f32 v94,v148,v78
v_sub_f32 v102,v148,v78
v_mul_f32 v94,s85,v94
v_mul_f32 v102,s85,v102
v_mul_f32 v148,s86,v70
v_fmac_f32 v148,s88,v86
v_fma_f32 v110,s92,v78,v148
v_fma_f32 v118,-s92,v78,v148
v_add_f32 v148,v71,v87
v_add_f32 v95,v148,v79
v_sub_f32 v103,v148,v79
v_mul_f32 v95,s85,v95
v_mul_f32 v103,s85,v103
v_mul_f32 v148,s86,v71
v_fmac_f32 v148,s88,v87
v_fma_f32 v111,s92,v79,v148
v_fma_f32 v119,-s92,v79,v148
v_add_f32 v148,v72,v88
v_add_f32 v96,v148,v80
v_sub_f32 v104,v148,v80
v_mul_f32 v96,s85,v96
v_mul_f32 v104,s85,v104
v_mul_f32 v148,s86,v72
v_fmac_f32 v148,s88,v88
v_fma_f32 v112,s92,v80,v148
v_fma_f32 v120,-s92,v80,v148
v_add_f32 v148,v73,v89
v_add_f32 v97,v148,v81
v_sub_f32 v105,v148,v81
v_mul_f32 v97,s85,v97
v_mul_f32 v105,s85,v105
v_mul_f32 v148,s86,v73
v_fmac_f32 v148,s88,v89
v_fma_f32 v113,s92,v81,v148
v_fma_f32 v121,-s92,v81,v148
v_add_f32 v148,v74,v90
v_add_f32 v98,v148,v82
v_sub_f32 v106,v148,v82
v_mul_f32 v98,s85,v98
v_mul_f32 v106,s85,v106
v_mul_f32 v148,s86,v74
v_fmac_f32 v148,s88,v90
v_fma_f32 v114,s92,v82,v148
v_fma_f32 v122,-s92,v82,v148
v_add_f32 v148,v75,v91
v_add_f32 v99,v148,v83
v_sub_f32 v107,v148,v83
v_mul_f32 v99,s85,v99
v_mul_f32 v107,s85,v107
v_mul_f32 v148,s86,v75
v_fmac_f32 v148,s88,v91
v_fma_f32 v115,s92,v83,v148
v_fma_f32 v123,-s92,v83,v148
v_cvt_pk_bf16_f32 v124,v68,v69
v_cvt_pk_bf16_f32 v125,v70,v71
v_cvt_pk_bf16_f32 v126,v72,v73
v_cvt_pk_bf16_f32 v127,v74,v75
s_add_u32 s89,s87,0
buffer_store_dwordx4 v[124:127],v150,s[20:23],s89 offen sc1
v_cvt_pk_bf16_f32 v144,v84,v85
v_cvt_pk_bf16_f32 v145,v86,v87
v_cvt_pk_bf16_f32 v146,v88,v89
v_cvt_pk_bf16_f32 v147,v90,v91
s_add_u32 s89,s87,46080
buffer_store_dwordx4 v[144:147],v150,s[20:23],s89 offen sc1
v_cvt_pk_bf16_f32 v128,v92,v93
v_cvt_pk_bf16_f32 v129,v94,v95
v_cvt_pk_bf16_f32 v130,v96,v97
v_cvt_pk_bf16_f32 v131,v98,v99
s_add_u32 s89,s87,9216
buffer_store_dwordx4 v[128:131],v150,s[20:23],s89 offen sc1
v_cvt_pk_bf16_f32 v132,v100,v101
v_cvt_pk_bf16_f32 v133,v102,v103
v_cvt_pk_bf16_f32 v134,v104,v105
v_cvt_pk_bf16_f32 v135,v106,v107
s_add_u32 s89,s87,18432
buffer_store_dwordx4 v[132:135],v150,s[20:23],s89 offen sc1
v_cvt_pk_bf16_f32 v136,v108,v109
v_cvt_pk_bf16_f32 v137,v110,v111
v_cvt_pk_bf16_f32 v138,v112,v113
v_cvt_pk_bf16_f32 v139,v114,v115
s_add_u32 s89,s87,27648
buffer_store_dwordx4 v[136:139],v150,s[20:23],s89 offen sc1
v_cvt_pk_bf16_f32 v140,v116,v117
v_cvt_pk_bf16_f32 v141,v118,v119
v_cvt_pk_bf16_f32 v142,v120,v121
v_cvt_pk_bf16_f32 v143,v122,v123
s_add_u32 s89,s87,36864
buffer_store_dwordx4 v[140:143],v150,s[20:23],s89 offen sc1
s_waitcnt vmcnt(0)
s_barrier
s_cmp_eq_u32 s50,0
s_cselect_b32 s62,256,0
L_noitem:
s_and_b32 s84,s2,1
s_lshl_b32 s59,s84,6
s_lshl_b32 s84,s84,2
s_mov_b64 exec,1
buffer_atomic_add v166,off,s[60:63],s59 sc0 sc1
s_mov_b64 exec,-1
s_and_b32 s5,s5,0xffff
s_sub_u32 s8,s4,196608
s_subb_u32 s9,s5,0
s_mov_b32 s10,100859904
s_mov_b32 s11,0x20000
s_sub_u32 s12,s4,196992
s_subb_u32 s13,s5,0
s_cmp_eq_u32 s56,0
s_cselect_b32 s14,0,100860288
s_mov_b32 s15,0x20000
s_mov_b32 s16,s8
s_mov_b32 s17,s9
s_cmp_eq_u32 s56,508
s_cselect_b32 s18,0,100859904
s_mov_b32 s19,0x20000
s_add_u32 s28,s30,0
buffer_load_dwordx4 v[8:11],v169,s[8:11],s28 offen offset:384
buffer_load_dwordx4 v[0:3],v169,s[12:15],s28 offen offset:0
buffer_load_dwordx4 v[4:7],v169,s[8:11],s28 offen offset:0
buffer_load_dwordx4 v[20:23],v169,s[16:19],s28 offen offset:1536
buffer_load_dwordx4 v[16:19],v169,s[8:11],s28 offen offset:1152
buffer_load_dwordx4 v[12:15],v169,s[8:11],s28 offen offset:768
s_mov_b64 exec,1
s_waitcnt vmcnt(6)
v_cmp_eq_u32 vcc,26,v166
v_mov_b32 v165,1
s_nop 2
s_and_b64 exec,exec,vcc
s_cselect_b32 s62,s62,0
s_mov_b64 exec,1
buffer_store_dword v165,off,s[60:63],s84 offset:128 sc1
s_mov_b64 exec,-1
s_add_u32 s28,s30,393216
buffer_load_dwordx4 v[32:35],v168,s[8:11],s28 offen offset:384
buffer_load_dwordx4 v[24:27],v168,s[12:15],s28 offen offset:0
buffer_load_dwordx4 v[28:31],v168,s[8:11],s28 offen offset:0
buffer_load_dwordx4 v[44:47],v168,s[16:19],s28 offen offset:1536
buffer_load_dwordx4 v[40:43],v168,s[8:11],s28 offen offset:1152
buffer_load_dwordx4 v[36:39],v168,s[8:11],s28 offen offset:768
v_bfe_u32 v165,v164,2,3
v_lshrrev_b32 v159,5,v164
v_and_b32 v163,3,v164
v_lshl_add_u32 v159,v159,2,v163
v_xor_b32 v163,v159,v165
v_lshlrev_b32 v163,4,v163
v_lshl_add_u32 v163,v165,7,v163
v_lshl_add_u32 v250,s50,10,v163
s_and_b32 s25,s25,0xffff
s_mov_b32 s26,100663296
s_mov_b32 s27,0x20000
s_mov_b32 s41,0xc0a00000
s_mov_b32 s40,0x41000000
s_mov_b32 s42,0xffff0000
s_mov_b32 s43,0xbfa00000
s_mov_b32 s45,0x3e800000
s_mul_i32 s58,s55,384
s_add_u32 s58,s57,s58
s_lshr_b32 s59,s50,1
s_mul_i32 s32,s59,384
s_mul_i32 s33,s59,196608
s_add_u32 s32,s32,s58
s_add_u32 s33,s33,s58
s_lshl_b32 s58,s59,5
s_lshl_b32 s59,s50,7
v_lshlrev_b32 v247,11,v160
v_xor_b32 v163,v160,v161
v_and_b32 v163,1,v163
v_lshl_add_u32 v247,v163,6,v247
v_lshlrev_b32 v163,3,v162
v_xor_b32 v163,s58,v163
v_add3_u32 v247,v247,v163,s59
v_and_b32 v171,0xffffffc0,v247
v_and_b32 v163,3,v162
v_lshlrev_b32 v163,4,v163
v_xor_b32 v163,s58,v163
v_add_u32 v171,v171,v163
v_lshrrev_b32 v163,2,v162
v_mul_u32_u24 v163,17408,v163
v_mad_u32_u24 v172,v163,5,v171
v_lshl_add_u32 v171,v163,1,v171
v_and_b32 v163,15,v164
v_lshlrev_b32 v163,2,v163
v_xor_b32 v163,s58,v163
v_lshrrev_b32 v173,5,v164
v_lshl_add_u32 v173,v173,6,v163
v_add_u32 v173,s59,v173
v_add_u32 v173,8192,v173
v_bfe_u32 v163,v164,4,1
v_mul_u32_u24 v163,17408,v163
v_mad_u32_u24 v174,v163,5,v173
v_lshl_add_u32 v173,v163,1,v173
v_and_b32 v163,3,v164
v_lshlrev_b32 v163,4,v163
v_and_or_b32 v245,v245,s42,v163
v_xor_b32 v163,s58,v163
v_and_b32 v247,0xffffffc0,v247
v_add_u32 v247,v247,v163
v_lshrrev_b32 v163,5,v164
v_lshl_add_u32 v247,v163,3,v247
v_mul_u32_u24 v163,384,v163
v_mad_u32_u24 v251,v163,5,v245
v_add_u32 v245,v245,v163
s_cmp_eq_u32 s56,0
s_cselect_b32 exec_lo,-1,0
s_cmp_eq_u32 s56,508
s_cselect_b32 exec_hi,-1,0
v_or_b32 v251,0x40000000,v251
s_mov_b64 exec,-1
v_lshrrev_b32 v160,5,v164
v_lshlrev_b32 v160,6,v160
v_and_b32 v161,63,v246
v_xor_b32 v161,s58,v161
v_add3_u32 v252,v160,v161,s59
v_add_u32 v252,8192,v252
v_bfe_u32 v160,v164,2,2
v_and_b32 v161,3,v164
v_lshrrev_b32 v162,4,v164
v_lshlrev_b32 v248,11,v160
v_lshl_add_u32 v248,v161,7,v248
v_and_b32 v163,1,v160
v_lshl_add_u32 v248,v163,6,v248
v_and_b32 v163,2,v161
v_xor_b32 v163,v163,v162
v_lshl_add_u32 v248,v163,4,v248
v_xor_b32 v249,64,v248
v_lshrrev_b32 v160,1,v162
v_lshl_add_u32 v160,s50,1,v160
v_and_b32 v161,7,v164
v_xor_b32 v160,v160,v161
v_and_b32 v163,15,v164
v_lshlrev_b32 v254,7,v163
v_lshl_add_u32 v254,v160,4,v254
v_and_b32 v163,1,v162
v_lshl_add_u32 v254,v163,3,v254
v_bfe_u32 v160,v250,7,4
v_lshrrev_b32 v162,2,v160
v_mul_u32_u24 v253,1572864,v162
v_and_b32 v162,3,v160
v_mul_u32_u24 v162,1536,v162
v_lshl_add_u32 v160,v159,4,v162
v_add_u32 v253,v253,v160
s_waitcnt vmcnt(12)
v_lshlrev_b32 v180,16,v8
v_and_b32 v181,s42,v8
s_waitcnt vmcnt(11)
v_lshlrev_b32 v176,16,v0
v_and_b32 v177,s42,v0
s_waitcnt vmcnt(10)
v_lshlrev_b32 v178,16,v4
v_and_b32 v179,s42,v4
s_add_u32 s28,s30,786432
buffer_load_dwordx4 v[56:59],v168,s[8:11],s28 offen offset:384
s_waitcnt vmcnt(10)
v_lshlrev_b32 v186,16,v20
v_and_b32 v187,s42,v20
s_waitcnt vmcnt(9)
v_lshlrev_b32 v184,16,v16
v_and_b32 v185,s42,v16
s_waitcnt vmcnt(8)
v_lshlrev_b32 v182,16,v12
v_and_b32 v183,s42,v12
v_pk_fma_f32 v[176:177],v[180:181],s[42:43],v[176:177] op_sel:[0,1,0] op_sel_hi:[1,1,1]
v_pk_fma_f32 v[186:187],v[178:179],4.0,v[186:187] op_sel_hi:[1,0,1]
v_pk_fma_f32 v[188:189],v[180:181],-4.0,v[184:185] op_sel_hi:[1,0,1]
v_pk_fma_f32 v[176:177],v[184:185],s[44:45],v[176:177] op_sel:[0,1,0] op_sel_hi:[1,1,1]
v_pk_fma_f32 v[186:187],v[182:183],s[40:41],v[186:187] op_sel:[0,1,0] op_sel_hi:[1,1,1]
v_pk_add_f32 v[184:185],v[184:185],v[180:181] neg_lo:[0,1] neg_hi:[0,1]
buffer_load_dwordx4 v[48:51],v168,s[12:15],s28 offen offset:0
v_pk_fma_f32 v[180:181],v[178:179],-4.0,v[182:183] op_sel_hi:[1,0,1]
v_pk_add_f32 v[182:183],v[182:183],v[178:179] neg_lo:[0,1] neg_hi:[0,1]
v_pk_add_f32 v[178:179],v[188:189],v[180:181]
v_pk_add_f32 v[188:189],v[188:189],v[180:181] neg_lo:[0,1] neg_hi:[0,1]
v_pk_fma_f32 v[180:181],v[182:183],2.0,v[184:185] op_sel_hi:[1,0,1]
v_pk_fma_f32 v[184:185],v[182:183],-2.0,v[184:185] op_sel_hi:[1,0,1]
v_cvt_pk_bf16_f32 v0,v176,v177
v_cvt_pk_bf16_f32 v4,v178,v179
v_cvt_pk_bf16_f32 v8,v188,v189
v_cvt_pk_bf16_f32 v12,v180,v181
v_cvt_pk_bf16_f32 v16,v184,v185
v_cvt_pk_bf16_f32 v20,v186,v187
buffer_load_dwordx4 v[52:55],v168,s[8:11],s28 offen offset:0
v_lshlrev_b32 v180,16,v9
v_and_b32 v181,s42,v9
v_lshlrev_b32 v176,16,v1
v_and_b32 v177,s42,v1
v_lshlrev_b32 v178,16,v5
v_and_b32 v179,s42,v5
v_lshlrev_b32 v186,16,v21
v_and_b32 v187,s42,v21
v_lshlrev_b32 v184,16,v17
v_and_b32 v185,s42,v17
v_lshlrev_b32 v182,16,v13
v_and_b32 v183,s42,v13
buffer_load_dwordx4 v[68:71],v168,s[16:19],s28 offen offset:1536
v_pk_fma_f32 v[176:177],v[180:181],s[42:43],v[176:177] op_sel:[0,1,0] op_sel_hi:[1,1,1]
v_pk_fma_f32 v[186:187],v[178:179],4.0,v[186:187] op_sel_hi:[1,0,1]
v_pk_fma_f32 v[188:189],v[180:181],-4.0,v[184:185] op_sel_hi:[1,0,1]
v_pk_fma_f32 v[176:177],v[184:185],s[44:45],v[176:177] op_sel:[0,1,0] op_sel_hi:[1,1,1]
v_pk_fma_f32 v[186:187],v[182:183],s[40:41],v[186:187] op_sel:[0,1,0] op_sel_hi:[1,1,1]
v_pk_add_f32 v[184:185],v[184:185],v[180:181] neg_lo:[0,1] neg_hi:[0,1]
v_pk_fma_f32 v[180:181],v[178:179],-4.0,v[182:183] op_sel_hi:[1,0,1]
v_pk_add_f32 v[182:183],v[182:183],v[178:179] neg_lo:[0,1] neg_hi:[0,1]
v_pk_add_f32 v[178:179],v[188:189],v[180:181]
v_pk_add_f32 v[188:189],v[188:189],v[180:181] neg_lo:[0,1] neg_hi:[0,1]
v_pk_fma_f32 v[180:181],v[182:183],2.0,v[184:185] op_sel_hi:[1,0,1]
v_pk_fma_f32 v[184:185],v[182:183],-2.0,v[184:185] op_sel_hi:[1,0,1]
buffer_load_dwordx4 v[64:67],v168,s[8:11],s28 offen offset:1152
v_cvt_pk_bf16_f32 v1,v176,v177
v_cvt_pk_bf16_f32 v5,v178,v179
v_cvt_pk_bf16_f32 v9,v188,v189
v_cvt_pk_bf16_f32 v13,v180,v181
v_cvt_pk_bf16_f32 v17,v184,v185
v_cvt_pk_bf16_f32 v21,v186,v187
v_lshlrev_b32 v180,16,v10
v_and_b32 v181,s42,v10
v_lshlrev_b32 v176,16,v2
v_and_b32 v177,s42,v2
v_lshlrev_b32 v178,16,v6
v_and_b32 v179,s42,v6
buffer_load_dwordx4 v[60:63],v168,s[8:11],s28 offen offset:768
v_lshlrev_b32 v186,16,v22
v_and_b32 v187,s42,v22
v_lshlrev_b32 v184,16,v18
v_and_b32 v185,s42,v18
v_lshlrev_b32 v182,16,v14
v_and_b32 v183,s42,v14
v_pk_fma_f32 v[176:177],v[180:181],s[42:43],v[176:177] op_sel:[0,1,0] op_sel_hi:[1,1,1]
v_pk_fma_f32 v[186:187],v[178:179],4.0,v[186:187] op_sel_hi:[1,0,1]
v_pk_fma_f32 v[188:189],v[180:181],-4.0,v[184:185] op_sel_hi:[1,0,1]
v_pk_fma_f32 v[176:177],v[184:185],s[44:45],v[176:177] op_sel:[0,1,0] op_sel_hi:[1,1,1]
v_pk_fma_f32 v[186:187],v[182:183],s[40:41],v[186:187] op_sel:[0,1,0] op_sel_hi:[1,1,1]
v_pk_add_f32 v[184:185],v[184:185],v[180:181] neg_lo:[0,1] neg_hi:[0,1]
s_add_u32 s28,s30,1179648
buffer_load_dwordx4 v[80:83],v168,s[8:11],s28 offen offset:384
v_pk_fma_f32 v[180:181],v[178:179],-4.0,v[182:183] op_sel_hi:[1,0,1]
v_pk_add_f32 v[182:183],v[182:183],v[178:179] neg_lo:[0,1] neg_hi:[0,1]
v_pk_add_f32 v[178:179],v[188:189],v[180:181]
v_pk_add_f32 v[188:189],v[188:189],v[180:181] neg_lo:[0,1] neg_hi:[0,1]
v_pk_fma_f32 v[180:181],v[182:183],2.0,v[184:185] op_sel_hi:[1,0,1]
v_pk_fma_f32 v[184:185],v[182:183],-2.0,v[184:185] op_sel_hi:[1,0,1]
v_cvt_pk_bf16_f32 v2,v176,v177
v_cvt_pk_bf16_f32 v6,v178,v179
v_cvt_pk_bf16_f32 v10,v188,v189
v_cvt_pk_bf16_f32 v14,v180,v181
v_cvt_pk_bf16_f32 v18,v184,v185
v_cvt_pk_bf16_f32 v22,v186,v187
buffer_load_dwordx4 v[72:75],v168,s[12:15],s28 offen offset:0
v_lshlrev_b32 v180,16,v11
v_and_b32 v181,s42,v11
v_lshlrev_b32 v176,16,v3
v_and_b32 v177,s42,v3
v_lshlrev_b32 v178,16,v7
v_and_b32 v179,s42,v7
v_lshlrev_b32 v186,16,v23
v_and_b32 v187,s42,v23
v_lshlrev_b32 v184,16,v19
v_and_b32 v185,s42,v19
v_lshlrev_b32 v182,16,v15
v_and_b32 v183,s42,v15
buffer_load_dwordx4 v[76:79],v168,s[8:11],s28 offen offset:0
v_pk_fma_f32 v[176:177],v[180:181],s[42:43],v[176:177] op_sel:[0,1,0] op_sel_hi:[1,1,1]
v_pk_fma_f32 v[186:187],v[178:179],4.0,v[186:187] op_sel_hi:[1,0,1]
v_pk_fma_f32 v[188:189],v[180:181],-4.0,v[184:185] op_sel_hi:[1,0,1]
v_pk_fma_f32 v[176:177],v[184:185],s[44:45],v[176:177] op_sel:[0,1,0] op_sel_hi:[1,1,1]
v_pk_fma_f32 v[186:187],v[182:183],s[40:41],v[186:187] op_sel:[0,1,0] op_sel_hi:[1,1,1]
v_pk_add_f32 v[184:185],v[184:185],v[180:181] neg_lo:[0,1] neg_hi:[0,1]
v_pk_fma_f32 v[180:181],v[178:179],-4.0,v[182:183] op_sel_hi:[1,0,1]
v_pk_add_f32 v[182:183],v[182:183],v[178:179] neg_lo:[0,1] neg_hi:[0,1]
v_pk_add_f32 v[178:179],v[188:189],v[180:181]
v_pk_add_f32 v[188:189],v[188:189],v[180:181] neg_lo:[0,1] neg_hi:[0,1]
v_pk_fma_f32 v[180:181],v[182:183],2.0,v[184:185] op_sel_hi:[1,0,1]
v_pk_fma_f32 v[184:185],v[182:183],-2.0,v[184:185] op_sel_hi:[1,0,1]
buffer_load_dwordx4 v[92:95],v168,s[16:19],s28 offen offset:1536
v_cvt_pk_bf16_f32 v3,v176,v177
v_cvt_pk_bf16_f32 v7,v178,v179
v_cvt_pk_bf16_f32 v11,v188,v189
v_cvt_pk_bf16_f32 v15,v180,v181
v_cvt_pk_bf16_f32 v19,v184,v185
v_cvt_pk_bf16_f32 v23,v186,v187
ds_write_b128 v172,v[0:3] offset:0
ds_write_b128 v171,v[4:7] offset:17408
ds_write_b128 v171,v[8:11] offset:26112
ds_write_b128 v171,v[12:15] offset:34816
ds_write_b128 v171,v[16:19] offset:43520
ds_write_b128 v172,v[20:23] offset:8704
buffer_load_dwordx4 v[88:91],v168,s[8:11],s28 offen offset:1152
s_waitcnt vmcnt(16)
v_lshlrev_b32 v180,16,v32
v_and_b32 v181,s42,v32
s_waitcnt vmcnt(15)
v_lshlrev_b32 v176,16,v24
v_and_b32 v177,s42,v24
s_waitcnt vmcnt(14)
v_lshlrev_b32 v178,16,v28
v_and_b32 v179,s42,v28
buffer_load_dwordx4 v[84:87],v168,s[8:11],s28 offen offset:768
s_waitcnt vmcnt(14)
v_lshlrev_b32 v186,16,v44
v_and_b32 v187,s42,v44
s_waitcnt vmcnt(13)
v_lshlrev_b32 v184,16,v40
v_and_b32 v185,s42,v40
s_waitcnt vmcnt(12)
v_lshlrev_b32 v182,16,v36
v_and_b32 v183,s42,v36
v_pk_fma_f32 v[176:177],v[180:181],s[42:43],v[176:177] op_sel:[0,1,0] op_sel_hi:[1,1,1]
v_pk_fma_f32 v[186:187],v[178:179],4.0,v[186:187] op_sel_hi:[1,0,1]
v_pk_fma_f32 v[188:189],v[180:181],-4.0,v[184:185] op_sel_hi:[1,0,1]
v_pk_fma_f32 v[176:177],v[184:185],s[44:45],v[176:177] op_sel:[0,1,0] op_sel_hi:[1,1,1]
v_pk_fma_f32 v[186:187],v[182:183],s[40:41],v[186:187] op_sel:[0,1,0] op_sel_hi:[1,1,1]
v_pk_add_f32 v[184:185],v[184:185],v[180:181] neg_lo:[0,1] neg_hi:[0,1]
buffer_load_dword v96,v170,s[12:15],s30 offen offset:0
v_pk_fma_f32 v[180:181],v[178:179],-4.0,v[182:183] op_sel_hi:[1,0,1]
v_pk_add_f32 v[182:183],v[182:183],v[178:179] neg_lo:[0,1] neg_hi:[0,1]
v_pk_add_f32 v[178:179],v[188:189],v[180:181]
v_pk_add_f32 v[188:189],v[188:189],v[180:181] neg_lo:[0,1] neg_hi:[0,1]
v_pk_fma_f32 v[180:181],v[182:183],2.0,v[184:185] op_sel_hi:[1,0,1]
v_pk_fma_f32 v[184:185],v[182:183],-2.0,v[184:185] op_sel_hi:[1,0,1]
v_cvt_pk_bf16_f32 v24,v176,v177
v_cvt_pk_bf16_f32 v28,v178,v179
v_cvt_pk_bf16_f32 v32,v188,v189
v_cvt_pk_bf16_f32 v36,v180,v181
v_cvt_pk_bf16_f32 v40,v184,v185
v_cvt_pk_bf16_f32 v44,v186,v187
buffer_load_dword v97,v170,s[8:11],s30 offen offset:0
v_lshlrev_b32 v180,16,v33
v_and_b32 v181,s42,v33
v_lshlrev_b32 v176,16,v25
v_and_b32 v177,s42,v25
v_lshlrev_b32 v178,16,v29
v_and_b32 v179,s42,v29
v_lshlrev_b32 v186,16,v45
v_and_b32 v187,s42,v45
v_lshlrev_b32 v184,16,v41
v_and_b32 v185,s42,v41
v_lshlrev_b32 v182,16,v37
v_and_b32 v183,s42,v37
buffer_load_dword v98,v170,s[8:11],s30 offen offset:384
v_pk_fma_f32 v[176:177],v[180:181],s[42:43],v[176:177] op_sel:[0,1,0] op_sel_hi:[1,1,1]
v_pk_fma_f32 v[186:187],v[178:179],4.0,v[186:187] op_sel_hi:[1,0,1]
v_pk_fma_f32 v[188:189],v[180:181],-4.0,v[184:185] op_sel_hi:[1,0,1]
v_pk_fma_f32 v[176:177],v[184:185],s[44:45],v[176:177] op_sel:[0,1,0] op_sel_hi:[1,1,1]
v_pk_fma_f32 v[186:187],v[182:183],s[40:41],v[186:187] op_sel:[0,1,0] op_sel_hi:[1,1,1]
v_pk_add_f32 v[184:185],v[184:185],v[180:181] neg_lo:[0,1] neg_hi:[0,1]
v_pk_fma_f32 v[180:181],v[178:179],-4.0,v[182:183] op_sel_hi:[1,0,1]
v_pk_add_f32 v[182:183],v[182:183],v[178:179] neg_lo:[0,1] neg_hi:[0,1]
v_pk_add_f32 v[178:179],v[188:189],v[180:181]
v_pk_add_f32 v[188:189],v[188:189],v[180:181] neg_lo:[0,1] neg_hi:[0,1]
v_pk_fma_f32 v[180:181],v[182:183],2.0,v[184:185] op_sel_hi:[1,0,1]
v_pk_fma_f32 v[184:185],v[182:183],-2.0,v[184:185] op_sel_hi:[1,0,1]
buffer_load_dword v99,v170,s[8:11],s30 offen offset:768
v_cvt_pk_bf16_f32 v25,v176,v177
v_cvt_pk_bf16_f32 v29,v178,v179
v_cvt_pk_bf16_f32 v33,v188,v189
v_cvt_pk_bf16_f32 v37,v180,v181
v_cvt_pk_bf16_f32 v41,v184,v185
v_cvt_pk_bf16_f32 v45,v186,v187
v_lshlrev_b32 v180,16,v34
v_and_b32 v181,s42,v34
v_lshlrev_b32 v176,16,v26
v_and_b32 v177,s42,v26
v_lshlrev_b32 v178,16,v30
v_and_b32 v179,s42,v30
buffer_load_dword v100,v170,s[8:11],s30 offen offset:1152
v_lshlrev_b32 v186,16,v46
v_and_b32 v187,s42,v46
v_lshlrev_b32 v184,16,v42
v_and_b32 v185,s42,v42
v_lshlrev_b32 v182,16,v38
v_and_b32 v183,s42,v38
v_pk_fma_f32 v[176:177],v[180:181],s[42:43],v[176:177] op_sel:[0,1,0] op_sel_hi:[1,1,1]
v_pk_fma_f32 v[186:187],v[178:179],4.0,v[186:187] op_sel_hi:[1,0,1]
v_pk_fma_f32 v[188:189],v[180:181],-4.0,v[184:185] op_sel_hi:[1,0,1]
v_pk_fma_f32 v[176:177],v[184:185],s[44:45],v[176:177] op_sel:[0,1,0] op_sel_hi:[1,1,1]
v_pk_fma_f32 v[186:187],v[182:183],s[40:41],v[186:187] op_sel:[0,1,0] op_sel_hi:[1,1,1]
v_pk_add_f32 v[184:185],v[184:185],v[180:181] neg_lo:[0,1] neg_hi:[0,1]
buffer_load_dword v101,v170,s[16:19],s30 offen offset:1536
v_pk_fma_f32 v[180:181],v[178:179],-4.0,v[182:183] op_sel_hi:[1,0,1]
v_pk_add_f32 v[182:183],v[182:183],v[178:179] neg_lo:[0,1] neg_hi:[0,1]
v_pk_add_f32 v[178:179],v[188:189],v[180:181]
v_pk_add_f32 v[188:189],v[188:189],v[180:181] neg_lo:[0,1] neg_hi:[0,1]
v_pk_fma_f32 v[180:181],v[182:183],2.0,v[184:185] op_sel_hi:[1,0,1]
v_pk_fma_f32 v[184:185],v[182:183],-2.0,v[184:185] op_sel_hi:[1,0,1]
v_cvt_pk_bf16_f32 v26,v176,v177
v_cvt_pk_bf16_f32 v30,v178,v179
v_cvt_pk_bf16_f32 v34,v188,v189
v_cvt_pk_bf16_f32 v38,v180,v181
v_cvt_pk_bf16_f32 v42,v184,v185
v_cvt_pk_bf16_f32 v46,v186,v187
v_lshlrev_b32 v180,16,v35
v_and_b32 v181,s42,v35
v_lshlrev_b32 v176,16,v27
v_and_b32 v177,s42,v27
v_lshlrev_b32 v178,16,v31
v_and_b32 v179,s42,v31
v_lshlrev_b32 v186,16,v47
v_and_b32 v187,s42,v47
v_lshlrev_b32 v184,16,v43
v_and_b32 v185,s42,v43
v_lshlrev_b32 v182,16,v39
v_and_b32 v183,s42,v39
v_pk_fma_f32 v[176:177],v[180:181],s[42:43],v[176:177] op_sel:[0,1,0] op_sel_hi:[1,1,1]
v_pk_fma_f32 v[186:187],v[178:179],4.0,v[186:187] op_sel_hi:[1,0,1]
v_pk_fma_f32 v[188:189],v[180:181],-4.0,v[184:185] op_sel_hi:[1,0,1]
v_pk_fma_f32 v[176:177],v[184:185],s[44:45],v[176:177] op_sel:[0,1,0] op_sel_hi:[1,1,1]
v_pk_fma_f32 v[186:187],v[182:183],s[40:41],v[186:187] op_sel:[0,1,0] op_sel_hi:[1,1,1]
v_pk_add_f32 v[184:185],v[184:185],v[180:181] neg_lo:[0,1] neg_hi:[0,1]
v_pk_fma_f32 v[180:181],v[178:179],-4.0,v[182:183] op_sel_hi:[1,0,1]
v_pk_add_f32 v[182:183],v[182:183],v[178:179] neg_lo:[0,1] neg_hi:[0,1]
v_pk_add_f32 v[178:179],v[188:189],v[180:181]
v_pk_add_f32 v[188:189],v[188:189],v[180:181] neg_lo:[0,1] neg_hi:[0,1]
v_pk_fma_f32 v[180:181],v[182:183],2.0,v[184:185] op_sel_hi:[1,0,1]
v_pk_fma_f32 v[184:185],v[182:183],-2.0,v[184:185] op_sel_hi:[1,0,1]
v_cvt_pk_bf16_f32 v27,v176,v177
v_cvt_pk_bf16_f32 v31,v178,v179
v_cvt_pk_bf16_f32 v35,v188,v189
v_cvt_pk_bf16_f32 v39,v180,v181
v_cvt_pk_bf16_f32 v43,v184,v185
v_cvt_pk_bf16_f32 v47,v186,v187
ds_write_b128 v172,v[24:27] offset:512
ds_write_b128 v171,v[28:31] offset:17920
ds_write_b128 v171,v[32:35] offset:26624
ds_write_b128 v171,v[36:39] offset:35328
ds_write_b128 v171,v[40:43] offset:44032
ds_write_b128 v172,v[44:47] offset:9216
s_waitcnt vmcnt(17)
v_lshlrev_b32 v180,16,v56
v_and_b32 v181,s42,v56
s_waitcnt vmcnt(16)
v_lshlrev_b32 v176,16,v48
v_and_b32 v177,s42,v48
s_waitcnt vmcnt(15)
v_lshlrev_b32 v178,16,v52
v_and_b32 v179,s42,v52
s_waitcnt vmcnt(14)
v_lshlrev_b32 v186,16,v68
v_and_b32 v187,s42,v68
s_waitcnt vmcnt(13)
v_lshlrev_b32 v184,16,v64
v_and_b32 v185,s42,v64
s_waitcnt vmcnt(12)
v_lshlrev_b32 v182,16,v60
v_and_b32 v183,s42,v60
v_pk_fma_f32 v[176:177],v[180:181],s[42:43],v[176:177] op_sel:[0,1,0] op_sel_hi:[1,1,1]
v_pk_fma_f32 v[186:187],v[178:179],4.0,v[186:187] op_sel_hi:[1,0,1]
v_pk_fma_f32 v[188:189],v[180:181],-4.0,v[184:185] op_sel_hi:[1,0,1]
v_pk_fma_f32 v[176:177],v[184:185],s[44:45],v[176:177] op_sel:[0,1,0] op_sel_hi:[1,1,1]
v_pk_fma_f32 v[186:187],v[182:183],s[40:41],v[186:187] op_sel:[0,1,0] op_sel_hi:[1,1,1]
v_pk_add_f32 v[184:185],v[184:185],v[180:181] neg_lo:[0,1] neg_hi:[0,1]
v_pk_fma_f32 v[180:181],v[178:179],-4.0,v[182:183] op_sel_hi:[1,0,1]
v_pk_add_f32 v[182:183],v[182:183],v[178:179] neg_lo:[0,1] neg_hi:[0,1]
v_pk_add_f32 v[178:179],v[188:189],v[180:181]
v_pk_add_f32 v[188:189],v[188:189],v[180:181] neg_lo:[0,1] neg_hi:[0,1]
v_pk_fma_f32 v[180:181],v[182:183],2.0,v[184:185] op_sel_hi:[1,0,1]
v_pk_fma_f32 v[184:185],v[182:183],-2.0,v[184:185] op_sel_hi:[1,0,1]
v_cvt_pk_bf16_f32 v48,v176,v177
v_cvt_pk_bf16_f32 v52,v178,v179
v_cvt_pk_bf16_f32 v56,v188,v189
v_cvt_pk_bf16_f32 v60,v180,v181
v_cvt_pk_bf16_f32 v64,v184,v185
v_cvt_pk_bf16_f32 v68,v186,v187
v_lshlrev_b32 v180,16,v57
v_and_b32 v181,s42,v57
v_lshlrev_b32 v176,16,v49
v_and_b32 v177,s42,v49
v_lshlrev_b32 v178,16,v53
v_and_b32 v179,s42,v53
v_lshlrev_b32 v186,16,v69
v_and_b32 v187,s42,v69
v_lshlrev_b32 v184,16,v65
v_and_b32 v185,s42,v65
v_lshlrev_b32 v182,16,v61
v_and_b32 v183,s42,v61
v_pk_fma_f32 v[176:177],v[180:181],s[42:43],v[176:177] op_sel:[0,1,0] op_sel_hi:[1,1,1]
v_pk_fma_f32 v[186:187],v[178:179],4.0,v[186:187] op_sel_hi:[1,0,1]
v_pk_fma_f32 v[188:189],v[180:181],-4.0,v[184:185] op_sel_hi:[1,0,1]
v_pk_fma_f32 v[176:177],v[184:185],s[44:45],v[176:177] op_sel:[0,1,0] op_sel_hi:[1,1,1]
v_pk_fma_f32 v[186:187],v[182:183],s[40:41],v[186:187] op_sel:[0,1,0] op_sel_hi:[1,1,1]
v_pk_add_f32 v[184:185],v[184:185],v[180:181] neg_lo:[0,1] neg_hi:[0,1]
v_pk_fma_f32 v[180:181],v[178:179],-4.0,v[182:183] op_sel_hi:[1,0,1]
v_pk_add_f32 v[182:183],v[182:183],v[178:179] neg_lo:[0,1] neg_hi:[0,1]
v_pk_add_f32 v[178:179],v[188:189],v[180:181]
v_pk_add_f32 v[188:189],v[188:189],v[180:181] neg_lo:[0,1] neg_hi:[0,1]
v_pk_fma_f32 v[180:181],v[182:183],2.0,v[184:185] op_sel_hi:[1,0,1]
v_pk_fma_f32 v[184:185],v[182:183],-2.0,v[184:185] op_sel_hi:[1,0,1]
v_cvt_pk_bf16_f32 v49,v176,v177
v_cvt_pk_bf16_f32 v53,v178,v179
v_cvt_pk_bf16_f32 v57,v188,v189
v_cvt_pk_bf16_f32 v61,v180,v181
v_cvt_pk_bf16_f32 v65,v184,v185
v_cvt_pk_bf16_f32 v69,v186,v187
v_lshlrev_b32 v180,16,v58
v_and_b32 v181,s42,v58
v_lshlrev_b32 v176,16,v50
v_and_b32 v177,s42,v50
v_lshlrev_b32 v178,16,v54
v_and_b32 v179,s42,v54
v_lshlrev_b32 v186,16,v70
v_and_b32 v187,s42,v70
v_lshlrev_b32 v184,16,v66
v_and_b32 v185,s42,v66
v_lshlrev_b32 v182,16,v62
v_and_b32 v183,s42,v62
v_pk_fma_f32 v[176:177],v[180:181],s[42:43],v[176:177] op_sel:[0,1,0] op_sel_hi:[1,1,1]
v_pk_fma_f32 v[186:187],v[178:179],4.0,v[186:187] op_sel_hi:[1,0,1]
v_pk_fma_f32 v[188:189],v[180:181],-4.0,v[184:185] op_sel_hi:[1,0,1]
v_pk_fma_f32 v[176:177],v[184:185],s[44:45],v[176:177] op_sel:[0,1,0] op_sel_hi:[1,1,1]
v_pk_fma_f32 v[186:187],v[182:183],s[40:41],v[186:187] op_sel:[0,1,0] op_sel_hi:[1,1,1]
v_pk_add_f32 v[184:185],v[184:185],v[180:181] neg_lo:[0,1] neg_hi:[0,1]
v_pk_fma_f32 v[180:181],v[178:179],-4.0,v[182:183] op_sel_hi:[1,0,1]
v_pk_add_f32 v[182:183],v[182:183],v[178:179] neg_lo:[0,1] neg_hi:[0,1]
v_pk_add_f32 v[178:179],v[188:189],v[180:181]
v_pk_add_f32 v[188:189],v[188:189],v[180:181] neg_lo:[0,1] neg_hi:[0,1]
v_pk_fma_f32 v[180:181],v[182:183],2.0,v[184:185] op_sel_hi:[1,0,1]
v_pk_fma_f32 v[184:185],v[182:183],-2.0,v[184:185] op_sel_hi:[1,0,1]
v_cvt_pk_bf16_f32 v50,v176,v177
v_cvt_pk_bf16_f32 v54,v178,v179
v_cvt_pk_bf16_f32 v58,v188,v189
v_cvt_pk_bf16_f32 v62,v180,v181
v_cvt_pk_bf16_f32 v66,v184,v185
v_cvt_pk_bf16_f32 v70,v186,v187
v_lshlrev_b32 v180,16,v59
v_and_b32 v181,s42,v59
v_lshlrev_b32 v176,16,v51
v_and_b32 v177,s42,v51
v_lshlrev_b32 v178,16,v55
v_and_b32 v179,s42,v55
v_lshlrev_b32 v186,16,v71
v_and_b32 v187,s42,v71
v_lshlrev_b32 v184,16,v67
v_and_b32 v185,s42,v67
v_lshlrev_b32 v182,16,v63
v_and_b32 v183,s42,v63
v_pk_fma_f32 v[176:177],v[180:181],s[42:43],v[176:177] op_sel:[0,1,0] op_sel_hi:[1,1,1]
v_pk_fma_f32 v[186:187],v[178:179],4.0,v[186:187] op_sel_hi:[1,0,1]
v_pk_fma_f32 v[188:189],v[180:181],-4.0,v[184:185] op_sel_hi:[1,0,1]
v_pk_fma_f32 v[176:177],v[184:185],s[44:45],v[176:177] op_sel:[0,1,0] op_sel_hi:[1,1,1]
v_pk_fma_f32 v[186:187],v[182:183],s[40:41],v[186:187] op_sel:[0,1,0] op_sel_hi:[1,1,1]
v_pk_add_f32 v[184:185],v[184:185],v[180:181] neg_lo:[0,1] neg_hi:[0,1]
v_pk_fma_f32 v[180:181],v[178:179],-4.0,v[182:183] op_sel_hi:[1,0,1]
v_pk_add_f32 v[182:183],v[182:183],v[178:179] neg_lo:[0,1] neg_hi:[0,1]
v_pk_add_f32 v[178:179],v[188:189],v[180:181]
v_pk_add_f32 v[188:189],v[188:189],v[180:181] neg_lo:[0,1] neg_hi:[0,1]
v_pk_fma_f32 v[180:181],v[182:183],2.0,v[184:185] op_sel_hi:[1,0,1]
v_pk_fma_f32 v[184:185],v[182:183],-2.0,v[184:185] op_sel_hi:[1,0,1]
v_cvt_pk_bf16_f32 v51,v176,v177
v_cvt_pk_bf16_f32 v55,v178,v179
v_cvt_pk_bf16_f32 v59,v188,v189
v_cvt_pk_bf16_f32 v63,v180,v181
v_cvt_pk_bf16_f32 v67,v184,v185
v_cvt_pk_bf16_f32 v71,v186,v187
ds_write_b128 v172,v[48:51] offset:1024
ds_write_b128 v171,v[52:55] offset:18432
ds_write_b128 v171,v[56:59] offset:27136
ds_write_b128 v171,v[60:63] offset:35840
ds_write_b128 v171,v[64:67] offset:44544
ds_write_b128 v172,v[68:71] offset:9728
s_waitcnt vmcnt(11)
v_lshlrev_b32 v180,16,v80
v_and_b32 v181,s42,v80
s_waitcnt vmcnt(10)
v_lshlrev_b32 v176,16,v72
v_and_b32 v177,s42,v72
s_waitcnt vmcnt(9)
v_lshlrev_b32 v178,16,v76
v_and_b32 v179,s42,v76
s_waitcnt vmcnt(8)
v_lshlrev_b32 v186,16,v92
v_and_b32 v187,s42,v92
s_waitcnt vmcnt(7)
v_lshlrev_b32 v184,16,v88
v_and_b32 v185,s42,v88
s_waitcnt vmcnt(6)
v_lshlrev_b32 v182,16,v84
v_and_b32 v183,s42,v84
v_pk_fma_f32 v[176:177],v[180:181],s[42:43],v[176:177] op_sel:[0,1,0] op_sel_hi:[1,1,1]
v_pk_fma_f32 v[186:187],v[178:179],4.0,v[186:187] op_sel_hi:[1,0,1]
v_pk_fma_f32 v[188:189],v[180:181],-4.0,v[184:185] op_sel_hi:[1,0,1]
v_pk_fma_f32 v[176:177],v[184:185],s[44:45],v[176:177] op_sel:[0,1,0] op_sel_hi:[1,1,1]
v_pk_fma_f32 v[186:187],v[182:183],s[40:41],v[186:187] op_sel:[0,1,0] op_sel_hi:[1,1,1]
v_pk_add_f32 v[184:185],v[184:185],v[180:181] neg_lo:[0,1] neg_hi:[0,1]
v_pk_fma_f32 v[180:181],v[178:179],-4.0,v[182:183] op_sel_hi:[1,0,1]
v_pk_add_f32 v[182:183],v[182:183],v[178:179] neg_lo:[0,1] neg_hi:[0,1]
v_pk_add_f32 v[178:179],v[188:189],v[180:181]
v_pk_add_f32 v[188:189],v[188:189],v[180:181] neg_lo:[0,1] neg_hi:[0,1]
v_pk_fma_f32 v[180:181],v[182:183],2.0,v[184:185] op_sel_hi:[1,0,1]
v_pk_fma_f32 v[184:185],v[182:183],-2.0,v[184:185] op_sel_hi:[1,0,1]
v_cvt_pk_bf16_f32 v72,v176,v177
v_cvt_pk_bf16_f32 v76,v178,v179
v_cvt_pk_bf16_f32 v80,v188,v189
v_cvt_pk_bf16_f32 v84,v180,v181
v_cvt_pk_bf16_f32 v88,v184,v185
v_cvt_pk_bf16_f32 v92,v186,v187
v_lshlrev_b32 v180,16,v81
v_and_b32 v181,s42,v81
v_lshlrev_b32 v176,16,v73
v_and_b32 v177,s42,v73
v_lshlrev_b32 v178,16,v77
v_and_b32 v179,s42,v77
v_lshlrev_b32 v186,16,v93
v_and_b32 v187,s42,v93
v_lshlrev_b32 v184,16,v89
v_and_b32 v185,s42,v89
v_lshlrev_b32 v182,16,v85
v_and_b32 v183,s42,v85
v_pk_fma_f32 v[176:177],v[180:181],s[42:43],v[176:177] op_sel:[0,1,0] op_sel_hi:[1,1,1]
v_pk_fma_f32 v[186:187],v[178:179],4.0,v[186:187] op_sel_hi:[1,0,1]
v_pk_fma_f32 v[188:189],v[180:181],-4.0,v[184:185] op_sel_hi:[1,0,1]
v_pk_fma_f32 v[176:177],v[184:185],s[44:45],v[176:177] op_sel:[0,1,0] op_sel_hi:[1,1,1]
v_pk_fma_f32 v[186:187],v[182:183],s[40:41],v[186:187] op_sel:[0,1,0] op_sel_hi:[1,1,1]
v_pk_add_f32 v[184:185],v[184:185],v[180:181] neg_lo:[0,1] neg_hi:[0,1]
v_pk_fma_f32 v[180:181],v[178:179],-4.0,v[182:183] op_sel_hi:[1,0,1]
v_pk_add_f32 v[182:183],v[182:183],v[178:179] neg_lo:[0,1] neg_hi:[0,1]
v_pk_add_f32 v[178:179],v[188:189],v[180:181]
v_pk_add_f32 v[188:189],v[188:189],v[180:181] neg_lo:[0,1] neg_hi:[0,1]
v_pk_fma_f32 v[180:181],v[182:183],2.0,v[184:185] op_sel_hi:[1,0,1]
v_pk_fma_f32 v[184:185],v[182:183],-2.0,v[184:185] op_sel_hi:[1,0,1]
v_cvt_pk_bf16_f32 v73,v176,v177
v_cvt_pk_bf16_f32 v77,v178,v179
v_cvt_pk_bf16_f32 v81,v188,v189
v_cvt_pk_bf16_f32 v85,v180,v181
v_cvt_pk_bf16_f32 v89,v184,v185
v_cvt_pk_bf16_f32 v93,v186,v187
v_lshlrev_b32 v180,16,v82
v_and_b32 v181,s42,v82
v_lshlrev_b32 v176,16,v74
v_and_b32 v177,s42,v74
v_lshlrev_b32 v178,16,v78
v_and_b32 v179,s42,v78
v_lshlrev_b32 v186,16,v94
v_and_b32 v187,s42,v94
v_lshlrev_b32 v184,16,v90
v_and_b32 v185,s42,v90
v_lshlrev_b32 v182,16,v86
v_and_b32 v183,s42,v86
v_pk_fma_f32 v[176:177],v[180:181],s[42:43],v[176:177] op_sel:[0,1,0] op_sel_hi:[1,1,1]
v_pk_fma_f32 v[186:187],v[178:179],4.0,v[186:187] op_sel_hi:[1,0,1]
v_pk_fma_f32 v[188:189],v[180:181],-4.0,v[184:185] op_sel_hi:[1,0,1]
v_pk_fma_f32 v[176:177],v[184:185],s[44:45],v[176:177] op_sel:[0,1,0] op_sel_hi:[1,1,1]
v_pk_fma_f32 v[186:187],v[182:183],s[40:41],v[186:187] op_sel:[0,1,0] op_sel_hi:[1,1,1]
v_pk_add_f32 v[184:185],v[184:185],v[180:181] neg_lo:[0,1] neg_hi:[0,1]
v_pk_fma_f32 v[180:181],v[178:179],-4.0,v[182:183] op_sel_hi:[1,0,1]
v_pk_add_f32 v[182:183],v[182:183],v[178:179] neg_lo:[0,1] neg_hi:[0,1]
v_pk_add_f32 v[178:179],v[188:189],v[180:181]
v_pk_add_f32 v[188:189],v[188:189],v[180:181] neg_lo:[0,1] neg_hi:[0,1]
v_pk_fma_f32 v[180:181],v[182:183],2.0,v[184:185] op_sel_hi:[1,0,1]
v_pk_fma_f32 v[184:185],v[182:183],-2.0,v[184:185] op_sel_hi:[1,0,1]
v_cvt_pk_bf16_f32 v74,v176,v177
v_cvt_pk_bf16_f32 v78,v178,v179
v_cvt_pk_bf16_f32 v82,v188,v189
v_cvt_pk_bf16_f32 v86,v180,v181
v_cvt_pk_bf16_f32 v90,v184,v185
v_cvt_pk_bf16_f32 v94,v186,v187
v_lshlrev_b32 v180,16,v83
v_and_b32 v181,s42,v83
v_lshlrev_b32 v176,16,v75
v_and_b32 v177,s42,v75
v_lshlrev_b32 v178,16,v79
v_and_b32 v179,s42,v79
v_lshlrev_b32 v186,16,v95
v_and_b32 v187,s42,v95
v_lshlrev_b32 v184,16,v91
v_and_b32 v185,s42,v91
v_lshlrev_b32 v182,16,v87
v_and_b32 v183,s42,v87
v_pk_fma_f32 v[176:177],v[180:181],s[42:43],v[176:177] op_sel:[0,1,0] op_sel_hi:[1,1,1]
v_pk_fma_f32 v[186:187],v[178:179],4.0,v[186:187] op_sel_hi:[1,0,1]
v_pk_fma_f32 v[188:189],v[180:181],-4.0,v[184:185] op_sel_hi:[1,0,1]
v_pk_fma_f32 v[176:177],v[184:185],s[44:45],v[176:177] op_sel:[0,1,0] op_sel_hi:[1,1,1]
v_pk_fma_f32 v[186:187],v[182:183],s[40:41],v[186:187] op_sel:[0,1,0] op_sel_hi:[1,1,1]
v_pk_add_f32 v[184:185],v[184:185],v[180:181] neg_lo:[0,1] neg_hi:[0,1]
v_pk_fma_f32 v[180:181],v[178:179],-4.0,v[182:183] op_sel_hi:[1,0,1]
v_pk_add_f32 v[182:183],v[182:183],v[178:179] neg_lo:[0,1] neg_hi:[0,1]
v_pk_add_f32 v[178:179],v[188:189],v[180:181]
v_pk_add_f32 v[188:189],v[188:189],v[180:181] neg_lo:[0,1] neg_hi:[0,1]
v_pk_fma_f32 v[180:181],v[182:183],2.0,v[184:185] op_sel_hi:[1,0,1]
v_pk_fma_f32 v[184:185],v[182:183],-2.0,v[184:185] op_sel_hi:[1,0,1]
v_cvt_pk_bf16_f32 v75,v176,v177
v_cvt_pk_bf16_f32 v79,v178,v179
v_cvt_pk_bf16_f32 v83,v188,v189
v_cvt_pk_bf16_f32 v87,v180,v181
v_cvt_pk_bf16_f32 v91,v184,v185
v_cvt_pk_bf16_f32 v95,v186,v187
ds_write_b128 v172,v[72:75] offset:1536
ds_write_b128 v171,v[76:79] offset:18944
ds_write_b128 v171,v[80:83] offset:27648
ds_write_b128 v171,v[84:87] offset:36352
ds_write_b128 v171,v[88:91] offset:45056
ds_write_b128 v172,v[92:95] offset:10240
s_waitcnt vmcnt(3)
v_lshlrev_b32 v180,16,v98
v_and_b32 v181,s42,v98
v_lshlrev_b32 v176,16,v96
v_and_b32 v177,s42,v96
v_lshlrev_b32 v178,16,v97
v_and_b32 v179,s42,v97
s_waitcnt vmcnt(0)
v_lshlrev_b32 v186,16,v101
v_and_b32 v187,s42,v101
v_lshlrev_b32 v184,16,v100
v_and_b32 v185,s42,v100
v_lshlrev_b32 v182,16,v99
v_and_b32 v183,s42,v99
v_pk_fma_f32 v[176:177],v[180:181],s[42:43],v[176:177] op_sel:[0,1,0] op_sel_hi:[1,1,1]
v_pk_fma_f32 v[186:187],v[178:179],4.0,v[186:187] op_sel_hi:[1,0,1]
v_pk_fma_f32 v[188:189],v[180:181],-4.0,v[184:185] op_sel_hi:[1,0,1]
v_pk_fma_f32 v[176:177],v[184:185],s[44:45],v[176:177] op_sel:[0,1,0] op_sel_hi:[1,1,1]
v_pk_fma_f32 v[186:187],v[182:183],s[40:41],v[186:187] op_sel:[0,1,0] op_sel_hi:[1,1,1]
v_pk_add_f32 v[184:185],v[184:185],v[180:181] neg_lo:[0,1] neg_hi:[0,1]
v_pk_fma_f32 v[180:181],v[178:179],-4.0,v[182:183] op_sel_hi:[1,0,1]
v_pk_add_f32 v[182:183],v[182:183],v[178:179] neg_lo:[0,1] neg_hi:[0,1]
v_pk_add_f32 v[178:179],v[188:189],v[180:181]
v_pk_add_f32 v[188:189],v[188:189],v[180:181] neg_lo:[0,1] neg_hi:[0,1]
v_pk_fma_f32 v[180:181],v[182:183],2.0,v[184:185] op_sel_hi:[1,0,1]
v_pk_fma_f32 v[184:185],v[182:183],-2.0,v[184:185] op_sel_hi:[1,0,1]
v_cvt_pk_bf16_f32 v96,v176,v177
v_cvt_pk_bf16_f32 v97,v178,v179
v_cvt_pk_bf16_f32 v98,v188,v189
v_cvt_pk_bf16_f32 v99,v180,v181
v_cvt_pk_bf16_f32 v100,v184,v185
v_cvt_pk_bf16_f32 v101,v186,v187
ds_write_b32 v174,v96 offset:0
ds_write_b32 v173,v97 offset:17408
ds_write_b32 v173,v98 offset:26112
ds_write_b32 v173,v99 offset:34816
ds_write_b32 v173,v100 offset:43520
ds_write_b32 v174,v101 offset:8704
s_waitcnt lgkmcnt(0)
s_barrier
ds_read_b128 a[192:195],v248 offset:17408
ds_read_b128 a[196:199],v249 offset:17408
ds_read_b128 a[200:203],v248 offset:17920
ds_read_b128 a[204:207],v249 offset:17920
v_and_b32 v165,1,v164
v_lshlrev_b32 v165,2,v165
s_mov_b32 s84,0
L_poll:
global_load_dword v166,v165,s[52:53] offset:128 sc1
s_add_u32 s84,s84,1
s_waitcnt vmcnt(0)
v_cmp_eq_u32 vcc,0,v166
s_cmp_gt_u32 s84,0x4000
s_cbranch_scc1 L_fallback
s_cbranch_vccnz L_poll
L_uready:
s_add_u32 s46,s72,9216
buffer_load_dwordx4 a[96:99],v250,s[20:23],s46 offen offset:0 sc1
buffer_load_dwordx4 a[100:103],v250,s[20:23],s46 offen offset:1024 sc1
buffer_load_dwordx4 a[104:107],v250,s[20:23],s46 offen offset:2048 sc1
s_add_u32 s47,s72,12288
buffer_load_dwordx4 a[108:111],v250,s[20:23],s47 offen offset:0 sc1
buffer_load_dwordx4 a[112:115],v250,s[20:23],s47 offen offset:1024 sc1
buffer_load_dwordx4 a[116:119],v250,s[20:23],s47 offen offset:2048 sc1
s_add_u32 s48,s72,15360
buffer_load_dwordx4 a[120:123],v250,s[20:23],s48 offen offset:0 sc1
buffer_load_dwordx4 a[124:127],v250,s[20:23],s48 offen offset:1024 sc1
buffer_load_dwordx4 a[128:131],v250,s[20:23],s48 offen offset:2048 sc1
s_mov_b32 s88,s12
s_mov_b32 s89,s13
s_mov_b32 s90,100860288
s_mov_b32 s91,0x20000
s_cmp_eq_u32 s49,0
s_cselect_b32 s86,15,0
s_mov_b32 s87,s86
s_getpc_b64 s[62:63]
L_pc2:
s_sub_u32 s62,s62,L_pc2-L_pc
s_subb_u32 s63,s63,0
s_lshr_b32 s61,s2,3
s_waitcnt vmcnt(8) lgkmcnt(3)
M a[0:3],a[96:99],a[192:195],0
s_waitcnt vmcnt(7) lgkmcnt(2)
s_add_u32 s46,s72,18432
buffer_load_dwordx4 a[132:135],v250,s[20:23],s46 offen offset:0 sc1
M a[0:3],a[100:103],a[196:199],a[0:3]
s_waitcnt vmcnt(7) lgkmcnt(1)
ds_read_b128 a[208:211],v248 offset:18432
ds_read_b128 a[212:215],v249 offset:18432
M a[0:3],a[104:107],a[200:203],a[0:3]
s_waitcnt lgkmcnt(2)
buffer_load_dwordx4 a[136:139],v250,s[20:23],s46 offen offset:1024 sc1
M a[4:7],a[104:107],a[204:207],0
M a[4:7],a[100:103],a[200:203],a[4:7]
M a[4:7],a[96:99],a[196:199],a[4:7]
M a[8:11],a[96:99],a[200:203],0
buffer_load_dwordx4 a[140:143],v250,s[20:23],s46 offen offset:2048 sc1
M a[8:11],a[100:103],a[204:207],a[8:11]
s_waitcnt lgkmcnt(1)
s_add_u32 s47,s72,21504
ds_read_b128 a[216:219],v248 offset:18944
ds_read_b128 a[220:223],v249 offset:18944
M a[8:11],a[104:107],a[208:211],a[8:11]
s_waitcnt lgkmcnt(2)
M a[12:15],a[104:107],a[212:215],0
M a[12:15],a[100:103],a[208:211],a[12:15]
buffer_load_dwordx4 a[164:167],v250,s[20:23],s47 offen offset:0 sc1
M a[12:15],a[96:99],a[204:207],a[12:15]
M a[16:19],a[96:99],a[208:211],0
ds_read_b128 a[224:227],v249 offset:19456
M a[16:19],a[100:103],a[212:215],a[16:19]
s_waitcnt lgkmcnt(2)
ds_read_b128 a[228:231],v248 offset:19456
M a[16:19],a[104:107],a[216:219],a[16:19]
s_waitcnt lgkmcnt(2)
buffer_load_dwordx4 a[160:163],v250,s[20:23],s47 offen offset:1024 sc1
M a[20:23],a[104:107],a[220:223],0
M a[20:23],a[100:103],a[216:219],a[20:23]
M a[20:23],a[96:99],a[212:215],a[20:23]
M a[24:27],a[96:99],a[216:219],0
buffer_load_dwordx4 a[168:171],v250,s[20:23],s47 offen offset:2048 sc1
M a[24:27],a[100:103],a[220:223],a[24:27]
s_waitcnt lgkmcnt(1)
s_add_u32 s48,s72,24576
M a[24:27],a[104:107],a[224:227],a[24:27]
s_waitcnt lgkmcnt(0)
M a[28:31],a[104:107],a[228:231],0
M a[28:31],a[100:103],a[224:227],a[28:31]
buffer_load_dwordx4 v[4:7],v250,s[20:23],s48 offen offset:0 sc1
M a[28:31],a[96:99],a[220:223],a[28:31]
s_waitcnt vmcnt(12)
M a[32:35],a[108:111],a[192:195],0
s_waitcnt vmcnt(11)
M a[32:35],a[112:115],a[196:199],a[32:35]
s_waitcnt vmcnt(10)
M a[32:35],a[116:119],a[200:203],a[32:35]
buffer_load_dwordx4 v[0:3],v250,s[20:23],s48 offen offset:1024 sc1
M a[36:39],a[116:119],a[204:207],0
M a[36:39],a[112:115],a[200:203],a[36:39]
M a[36:39],a[108:111],a[196:199],a[36:39]
M a[40:43],a[108:111],a[200:203],0
buffer_load_dwordx4 v[8:11],v250,s[20:23],s48 offen offset:2048 sc1
M a[40:43],a[112:115],a[204:207],a[40:43]
s_add_u32 s46,s72,27648
M a[40:43],a[116:119],a[208:211],a[40:43]
M a[44:47],a[116:119],a[212:215],0
M a[44:47],a[112:115],a[208:211],a[44:47]
buffer_load_dwordx4 v[36:39],v250,s[20:23],s46 offen offset:0 sc1
M a[44:47],a[108:111],a[204:207],a[44:47]
M a[48:51],a[108:111],a[208:211],0
M a[48:51],a[112:115],a[212:215],a[48:51]
M a[48:51],a[116:119],a[216:219],a[48:51]
buffer_load_dwordx4 v[32:35],v250,s[20:23],s46 offen offset:1024 sc1
M a[52:55],a[116:119],a[220:223],0
M a[52:55],a[112:115],a[216:219],a[52:55]
M a[52:55],a[108:111],a[212:215],a[52:55]
M a[56:59],a[108:111],a[216:219],0
buffer_load_dwordx4 v[40:43],v250,s[20:23],s46 offen offset:2048 sc1
M a[56:59],a[112:115],a[220:223],a[56:59]
s_add_u32 s47,s72,30720
M a[56:59],a[116:119],a[224:227],a[56:59]
M a[60:63],a[116:119],a[228:231],0
M a[60:63],a[112:115],a[224:227],a[60:63]
buffer_load_dwordx4 v[68:71],v250,s[20:23],s47 offen offset:0 sc1
M a[60:63],a[108:111],a[220:223],a[60:63]
s_waitcnt vmcnt(15)
M a[64:67],a[120:123],a[192:195],0
s_waitcnt vmcnt(14)
M a[64:67],a[124:127],a[196:199],a[64:67]
s_waitcnt vmcnt(13)
M a[64:67],a[128:131],a[200:203],a[64:67]
buffer_load_dwordx4 v[64:67],v250,s[20:23],s47 offen offset:1024 sc1
M a[68:71],a[128:131],a[204:207],0
M a[68:71],a[124:127],a[200:203],a[68:71]
M a[68:71],a[120:123],a[196:199],a[68:71]
M a[72:75],a[120:123],a[200:203],0
buffer_load_dwordx4 v[72:75],v250,s[20:23],s47 offen offset:2048 sc1
M a[72:75],a[124:127],a[204:207],a[72:75]
s_add_u32 s48,s72,33792
M a[72:75],a[128:131],a[208:211],a[72:75]
M a[76:79],a[128:131],a[212:215],0
M a[76:79],a[124:127],a[208:211],a[76:79]
buffer_load_dwordx4 v[100:103],v250,s[20:23],s48 offen offset:0 sc1
M a[76:79],a[120:123],a[204:207],a[76:79]
M a[80:83],a[120:123],a[208:211],0
M a[80:83],a[124:127],a[212:215],a[80:83]
M a[80:83],a[128:131],a[216:219],a[80:83]
buffer_load_dwordx4 v[96:99],v250,s[20:23],s48 offen offset:1024 sc1
M a[84:87],a[128:131],a[220:223],0
M a[84:87],a[124:127],a[216:219],a[84:87]
ds_read_b128 a[232:235],v248 offset:26112
M a[84:87],a[120:123],a[212:215],a[84:87]
ds_read_b128 a[236:239],v249 offset:26112
M a[88:91],a[120:123],a[216:219],0
buffer_load_dwordx4 v[104:107],v250,s[20:23],s48 offen offset:2048 sc1
M a[88:91],a[124:127],a[220:223],a[88:91]
s_add_u32 s46,s72,36864
ds_read_b128 a[240:243],v248 offset:26624
ds_read_b128 a[244:247],v249 offset:26624
M a[88:91],a[128:131],a[224:227],a[88:91]
M a[92:95],a[128:131],a[228:231],0
M a[92:95],a[124:127],a[224:227],a[92:95]
s_add_u32 s28,s68,0
buffer_load_dwordx4 v[132:135],v250,s[20:23],s46 offen offset:0 sc1
M a[92:95],a[120:123],a[220:223],a[92:95]
s_waitcnt vmcnt(18) lgkmcnt(3)
s_mov_b64 exec,s[86:87]
v_xor_b32 v245,0x80000000,v245
v_xor_b32 v251,0x80000000,v251
s_mov_b64 exec,-1
M a[96:99],a[132:135],a[232:235],0
s_waitcnt vmcnt(17) lgkmcnt(2)
ds_read_b128 a[248:251],v248 offset:27136
M a[96:99],a[136:139],a[236:239],a[96:99]
s_waitcnt vmcnt(16) lgkmcnt(2)
ds_read_b128 a[252:255],v249 offset:27136
M a[96:99],a[140:143],a[240:243],a[96:99]
s_waitcnt lgkmcnt(2)
buffer_load_dwordx4 v[128:131],v250,s[20:23],s46 offen offset:1024 sc1
M a[100:103],a[140:143],a[244:247],0
M a[100:103],a[136:139],a[240:243],a[100:103]
M a[100:103],a[132:135],a[236:239],a[100:103]
M a[104:107],a[132:135],a[240:243],0
buffer_load_dwordx4 v[136:139],v250,s[20:23],s46 offen offset:2048 sc1
M a[104:107],a[136:139],a[244:247],a[104:107]
s_waitcnt lgkmcnt(1)
ds_read_b128 v[216:219],v248 offset:27648
ds_read_b128 v[220:223],v249 offset:27648
M a[104:107],a[140:143],a[248:251],a[104:107]
s_waitcnt lgkmcnt(2)
M a[108:111],a[140:143],a[252:255],0
M a[108:111],a[136:139],a[248:251],a[108:111]
buffer_load_dwordx4 v[192:195],v251,s[88:91],s28 offen offset:0
M a[108:111],a[132:135],a[244:247],a[108:111]
M a[112:115],a[132:135],a[248:251],0
ds_read_b128 v[224:227],v249 offset:28160
M a[112:115],a[136:139],a[252:255],a[112:115]
s_waitcnt lgkmcnt(2)
ds_read_b128 v[228:231],v248 offset:28160
M a[112:115],a[140:143],v[216:219],a[112:115]
s_waitcnt lgkmcnt(2)
buffer_load_dwordx4 v[196:199],v245,s[8:11],s28 offen offset:0
M a[116:119],a[140:143],v[220:223],0
M a[116:119],a[136:139],v[216:219],a[116:119]
M a[116:119],a[132:135],a[252:255],a[116:119]
M a[120:123],a[132:135],v[216:219],0
buffer_load_dwordx4 v[200:203],v245,s[8:11],s28 offen offset:768
M a[120:123],a[136:139],v[220:223],a[120:123]
s_waitcnt lgkmcnt(1)
s_mov_b64 exec,s[86:87]
v_xor_b32 v245,0x80000000,v245
v_xor_b32 v251,0x80000000,v251
s_mov_b64 exec,-1
M a[120:123],a[140:143],v[224:227],a[120:123]
s_waitcnt lgkmcnt(0)
M a[124:127],a[140:143],v[228:231],0
M a[124:127],a[136:139],v[224:227],a[124:127]
M a[124:127],a[132:135],v[220:223],a[124:127]
s_waitcnt vmcnt(20)
M a[128:131],a[164:167],a[232:235],0
s_waitcnt vmcnt(19)
M a[128:131],a[160:163],a[236:239],a[128:131]
s_waitcnt vmcnt(18)
M a[128:131],a[168:171],a[240:243],a[128:131]
M a[132:135],a[168:171],a[244:247],0
M a[132:135],a[160:163],a[240:243],a[132:135]
M a[132:135],a[164:167],a[236:239],a[132:135]
M a[136:139],a[164:167],a[240:243],0
M a[136:139],a[160:163],a[244:247],a[136:139]
M a[136:139],a[168:171],a[248:251],a[136:139]
M a[140:143],a[168:171],a[252:255],0
M a[140:143],a[160:163],a[248:251],a[140:143]
M a[140:143],a[164:167],a[244:247],a[140:143]
M a[144:147],a[164:167],a[248:251],0
M a[144:147],a[160:163],a[252:255],a[144:147]
M a[144:147],a[168:171],v[216:219],a[144:147]
M a[148:151],a[168:171],v[220:223],0
M a[148:151],a[160:163],v[216:219],a[148:151]
M a[148:151],a[164:167],a[252:255],a[148:151]
M a[152:155],a[164:167],v[216:219],0
M a[152:155],a[160:163],v[220:223],a[152:155]
M a[152:155],a[168:171],v[224:227],a[152:155]
M a[156:159],a[168:171],v[228:231],0
M a[156:159],a[160:163],v[224:227],a[156:159]
s_add_u32 s47,s72,39936
M a[156:159],a[164:167],v[220:223],a[156:159]
s_waitcnt vmcnt(17)
M a[160:163],v[4:7],a[232:235],0
s_waitcnt vmcnt(16)
M a[160:163],v[0:3],a[236:239],a[160:163]
s_waitcnt vmcnt(15)
M a[160:163],v[8:11],a[240:243],a[160:163]
M a[164:167],v[8:11],a[244:247],0
M a[164:167],v[0:3],a[240:243],a[164:167]
buffer_load_dwordx4 v[164:167],v250,s[20:23],s47 offen offset:0 sc1
M a[164:167],v[4:7],a[236:239],a[164:167]
M a[168:171],v[4:7],a[240:243],0
buffer_load_dwordx4 v[160:163],v250,s[20:23],s47 offen offset:1024 sc1
M a[168:171],v[0:3],a[244:247],a[168:171]
M a[168:171],v[8:11],a[248:251],a[168:171]
M a[172:175],v[8:11],a[252:255],0
M a[172:175],v[0:3],a[248:251],a[172:175]
buffer_load_dwordx4 v[168:171],v250,s[20:23],s47 offen offset:2048 sc1
M a[172:175],v[4:7],a[244:247],a[172:175]
s_add_u32 s48,s72,43008
M a[176:179],v[4:7],a[248:251],0
M a[176:179],v[0:3],a[252:255],a[176:179]
M a[176:179],v[8:11],v[216:219],a[176:179]
buffer_load_dwordx4 a[192:195],v250,s[20:23],s48 offen offset:0 sc1
M a[180:183],v[8:11],v[220:223],0
M a[180:183],v[0:3],v[216:219],a[180:183]
ds_read_b128 a[204:207],v248 offset:34816
M a[180:183],v[4:7],a[252:255],a[180:183]
ds_read_b128 a[208:211],v249 offset:34816
M a[184:187],v[4:7],v[216:219],0
buffer_load_dwordx4 a[196:199],v250,s[20:23],s48 offen offset:1024 sc1
M a[184:187],v[0:3],v[220:223],a[184:187]
ds_read_b128 a[216:219],v248 offset:35328
ds_read_b128 a[228:231],v249 offset:35328
M a[184:187],v[8:11],v[224:227],a[184:187]
M a[188:191],v[8:11],v[228:231],0
M a[188:191],v[0:3],v[224:227],a[188:191]
buffer_load_dwordx4 a[200:203],v250,s[20:23],s48 offen offset:2048 sc1
M a[188:191],v[4:7],v[220:223],a[188:191]
s_waitcnt vmcnt(20) lgkmcnt(3)
s_add_u32 s46,s73,9216
M v[0:3],v[36:39],a[204:207],0
s_waitcnt vmcnt(19) lgkmcnt(2)
ds_read_b128 a[224:227],v248 offset:35840
M v[0:3],v[32:35],a[208:211],v[0:3]
s_waitcnt vmcnt(18) lgkmcnt(2)
ds_read_b128 a[220:223],v249 offset:35840
M v[0:3],v[40:43],a[216:219],v[0:3]
s_waitcnt lgkmcnt(2)
buffer_load_dwordx4 a[212:215],v250,s[20:23],s46 offen offset:0 sc1
M v[4:7],v[40:43],a[228:231],0
M v[4:7],v[32:35],a[216:219],v[4:7]
M v[4:7],v[36:39],a[208:211],v[4:7]
M v[8:11],v[36:39],a[216:219],0
ds_read_b128 a[232:235],v248 offset:36352
M v[8:11],v[32:35],a[228:231],v[8:11]
s_waitcnt lgkmcnt(2)
ds_read_b128 a[236:239],v249 offset:36352
M v[8:11],v[40:43],a[224:227],v[8:11]
s_waitcnt lgkmcnt(2)
M v[12:15],v[40:43],a[220:223],0
M v[12:15],v[32:35],a[224:227],v[12:15]
M v[12:15],v[36:39],a[228:231],v[12:15]
s_add_u32 s28,s68,393216
buffer_load_dwordx4 v[204:207],v251,s[88:91],s28 offen offset:0
M v[16:19],v[36:39],a[224:227],0
ds_read_b128 a[240:243],v249 offset:36864
M v[16:19],v[32:35],a[220:223],v[16:19]
s_waitcnt lgkmcnt(2)
buffer_load_dwordx4 v[208:211],v245,s[8:11],s28 offen offset:0
M v[16:19],v[40:43],a[232:235],v[16:19]
s_waitcnt lgkmcnt(1)
ds_read_b128 a[244:247],v248 offset:36864
M v[20:23],v[40:43],a[236:239],0
M v[20:23],v[32:35],a[232:235],v[20:23]
M v[20:23],v[36:39],a[220:223],v[20:23]
buffer_load_dwordx4 v[212:215],v245,s[8:11],s28 offen offset:768
M v[24:27],v[36:39],a[232:235],0
s_add_u32 s29,s68,0
M v[24:27],v[32:35],a[236:239],v[24:27]
s_waitcnt lgkmcnt(1)
M v[24:27],v[40:43],a[240:243],v[24:27]
s_waitcnt lgkmcnt(0)
M v[28:31],v[40:43],a[244:247],0
buffer_load_short_d16_hi v239,v246,s[12:15],s29 offen offset:0
M v[28:31],v[32:35],a[240:243],v[28:31]
M v[28:31],v[36:39],a[236:239],v[28:31]
s_waitcnt vmcnt(22)
buffer_load_short_d16_hi v240,v246,s[8:11],s29 offen offset:0
M v[32:35],v[68:71],a[204:207],0
s_waitcnt vmcnt(22)
M v[32:35],v[64:67],a[208:211],v[32:35]
s_waitcnt vmcnt(21)
buffer_load_short_d16_hi v241,v246,s[8:11],s29 offen offset:384
M v[32:35],v[72:75],a[216:219],v[32:35]
M v[36:39],v[72:75],a[228:231],0
buffer_load_short_d16_hi v242,v246,s[8:11],s29 offen offset:768
M v[36:39],v[64:67],a[216:219],v[36:39]
M v[36:39],v[68:71],a[208:211],v[36:39]
buffer_load_short_d16_hi v243,v246,s[8:11],s29 offen offset:1152
M v[40:43],v[68:71],a[216:219],0
M v[40:43],v[64:67],a[228:231],v[40:43]
buffer_load_short_d16_hi v244,v246,s[16:19],s29 offen offset:1536
M v[40:43],v[72:75],a[224:227],v[40:43]
M v[44:47],v[72:75],a[220:223],0
M v[44:47],v[64:67],a[224:227],v[44:47]
M v[44:47],v[68:71],a[228:231],v[44:47]
M v[48:51],v[68:71],a[224:227],0
M v[48:51],v[64:67],a[220:223],v[48:51]
M v[48:51],v[72:75],a[232:235],v[48:51]
M v[52:55],v[72:75],a[236:239],0
M v[52:55],v[64:67],a[232:235],v[52:55]
M v[52:55],v[68:71],a[220:223],v[52:55]
M v[56:59],v[68:71],a[232:235],0
M v[56:59],v[64:67],a[236:239],v[56:59]
M v[56:59],v[72:75],a[240:243],v[56:59]
M v[60:63],v[72:75],a[244:247],0
M v[60:63],v[64:67],a[240:243],v[60:63]
M v[60:63],v[68:71],a[236:239],v[60:63]
s_waitcnt vmcnt(24)
M v[64:67],v[100:103],a[204:207],0
s_waitcnt vmcnt(23)
M v[64:67],v[96:99],a[208:211],v[64:67]
s_waitcnt vmcnt(22)
M v[64:67],v[104:107],a[216:219],v[64:67]
M v[68:71],v[104:107],a[228:231],0
M v[68:71],v[96:99],a[216:219],v[68:71]
M v[68:71],v[100:103],a[208:211],v[68:71]
M v[72:75],v[100:103],a[216:219],0
M v[72:75],v[96:99],a[228:231],v[72:75]
M v[72:75],v[104:107],a[224:227],v[72:75]
M v[76:79],v[104:107],a[220:223],0
M v[76:79],v[96:99],a[224:227],v[76:79]
M v[76:79],v[100:103],a[228:231],v[76:79]
M v[80:83],v[100:103],a[224:227],0
M v[80:83],v[96:99],a[220:223],v[80:83]
M v[80:83],v[104:107],a[232:235],v[80:83]
M v[84:87],v[104:107],a[236:239],0
M v[84:87],v[96:99],a[232:235],v[84:87]
ds_read_b128 a[248:251],v248 offset:43520
M v[84:87],v[100:103],a[220:223],v[84:87]
ds_read_b128 a[252:255],v249 offset:43520
M v[88:91],v[100:103],a[232:235],0
ds_read_b128 v[216:219],v248 offset:44032
M v[88:91],v[96:99],a[236:239],v[88:91]
ds_read_b128 v[228:231],v249 offset:44032
M v[88:91],v[104:107],a[240:243],v[88:91]
M v[92:95],v[104:107],a[244:247],0
M v[92:95],v[96:99],a[240:243],v[92:95]
M v[92:95],v[100:103],a[236:239],v[92:95]
s_waitcnt vmcnt(21) lgkmcnt(3)
M v[96:99],v[132:135],a[248:251],0
s_waitcnt vmcnt(20) lgkmcnt(2)
ds_read_b128 v[224:227],v248 offset:44544
M v[96:99],v[128:131],a[252:255],v[96:99]
s_waitcnt vmcnt(19) lgkmcnt(2)
ds_read_b128 v[220:223],v249 offset:44544
M v[96:99],v[136:139],v[216:219],v[96:99]
s_waitcnt lgkmcnt(2)
M v[100:103],v[136:139],v[228:231],0
M v[100:103],v[128:131],v[216:219],v[100:103]
M v[100:103],v[132:135],a[252:255],v[100:103]
M v[104:107],v[132:135],v[216:219],0
ds_read_b128 a[204:207],v248 offset:45056
M v[104:107],v[128:131],v[228:231],v[104:107]
s_waitcnt lgkmcnt(2)
ds_read_b128 a[208:211],v249 offset:45056
M v[104:107],v[136:139],v[224:227],v[104:107]
s_waitcnt lgkmcnt(2)
M v[108:111],v[136:139],v[220:223],0
s_waitcnt vmcnt(17)
v_permlane32_swap_b32 v196,v198
v_permlane32_swap_b32 v192,v194
M v[108:111],v[128:131],v[224:227],v[108:111]
s_waitcnt vmcnt(16)
v_permlane32_swap_b32 v200,v202
v_lshlrev_b32 v234,16,v198
M v[108:111],v[132:135],v[228:231],v[108:111]
v_lshlrev_b32 v232,16,v192
v_lshlrev_b32 v233,16,v196
M v[112:115],v[132:135],v[224:227],0
ds_read_b128 a[216:219],v249 offset:45568
v_lshlrev_b32 v237,16,v194
M v[112:115],v[128:131],v[220:223],v[112:115]
s_waitcnt lgkmcnt(2)
ds_read_b128 a[228:231],v248 offset:45568
v_lshlrev_b32 v236,16,v202
M v[112:115],v[136:139],a[204:207],v[112:115]
s_waitcnt lgkmcnt(2)
v_lshlrev_b32 v235,16,v200
v_fmac_f32 v232,s43,v234
M v[116:119],v[136:139],a[208:211],0
v_fmac_f32 v237,4.0,v233
v_fma_f32 v238,-4.0,v234,v236
M v[116:119],v[128:131],a[204:207],v[116:119]
v_fmac_f32 v232,s45,v236
v_fmac_f32 v237,s41,v235
M v[116:119],v[132:135],v[220:223],v[116:119]
v_sub_f32 v236,v236,v234
v_fma_f32 v234,-4.0,v233,v235
M v[120:123],v[132:135],a[204:207],0
v_sub_f32 v235,v235,v233
v_add_f32 v233,v238,v234
M v[120:123],v[128:131],a[208:211],v[120:123]
s_waitcnt lgkmcnt(1)
v_sub_f32 v238,v238,v234
v_fma_f32 v234,2.0,v235,v236
M v[120:123],v[136:139],a[216:219],v[120:123]
s_waitcnt lgkmcnt(0)
v_fmac_f32 v236,-2.0,v235
v_and_b32 v198,s42,v198
M v[124:127],v[136:139],a[228:231],0
buffer_load_dwordx4 a[224:227],v250,s[20:23],s46 offen offset:1024 sc1
M v[124:127],v[128:131],a[216:219],v[124:127]
v_and_b32 v192,s42,v192
v_and_b32 v196,s42,v196
M v[124:127],v[132:135],a[208:211],v[124:127]
s_waitcnt vmcnt(16)
buffer_load_dwordx4 a[220:223],v250,s[20:23],s46 offen offset:2048 sc1
M v[128:131],v[164:167],a[248:251],0
s_waitcnt vmcnt(16)
s_add_u32 s47,s73,12288
v_and_b32 v194,s42,v194
v_and_b32 v202,s42,v202
M v[128:131],v[160:163],a[252:255],v[128:131]
s_waitcnt vmcnt(15)
v_and_b32 v200,s42,v200
v_fmac_f32 v192,s43,v198
M v[128:131],v[168:171],v[216:219],v[128:131]
v_fmac_f32 v194,4.0,v196
v_fma_f32 v235,-4.0,v198,v202
M v[132:135],v[168:171],v[228:231],0
buffer_load_dwordx4 a[232:235],v250,s[20:23],s47 offen offset:0 sc1
M v[132:135],v[160:163],v[216:219],v[132:135]
v_fmac_f32 v192,s45,v202
v_fmac_f32 v194,s41,v200
M v[132:135],v[164:167],a[252:255],v[132:135]
v_sub_f32 v202,v202,v198
v_fma_f32 v198,-4.0,v196,v200
M v[136:139],v[164:167],v[216:219],0
v_sub_f32 v200,v200,v196
v_add_f32 v196,v235,v198
M v[136:139],v[160:163],v[228:231],v[136:139]
v_sub_f32 v235,v235,v198
v_fma_f32 v198,2.0,v200,v202
M v[136:139],v[168:171],v[224:227],v[136:139]
v_fmac_f32 v202,-2.0,v200
v_cvt_pk_bf16_f32 v192,v232,v192
M v[140:143],v[168:171],v[220:223],0
v_cvt_pk_bf16_f32 v194,v237,v194
v_cvt_pk_bf16_f32 v196,v233,v196
M v[140:143],v[160:163],v[224:227],v[140:143]
v_cvt_pk_bf16_f32 v200,v234,v198
v_cvt_pk_bf16_f32 v198,v238,v235
M v[140:143],v[164:167],v[228:231],v[140:143]
v_cvt_pk_bf16_f32 v202,v236,v202
v_permlane32_swap_b32 v197,v199
M v[144:147],v[164:167],v[224:227],0
v_permlane32_swap_b32 v193,v195
v_permlane32_swap_b32 v201,v203
M v[144:147],v[160:163],v[220:223],v[144:147]
v_lshlrev_b32 v234,16,v199
v_lshlrev_b32 v232,16,v193
M v[144:147],v[168:171],a[204:207],v[144:147]
v_lshlrev_b32 v233,16,v197
v_lshlrev_b32 v237,16,v195
M v[148:151],v[168:171],a[208:211],0
v_lshlrev_b32 v236,16,v203
v_lshlrev_b32 v235,16,v201
M v[148:151],v[160:163],a[204:207],v[148:151]
v_fmac_f32 v232,s43,v234
v_fmac_f32 v237,4.0,v233
M v[148:151],v[164:167],v[220:223],v[148:151]
v_fma_f32 v238,-4.0,v234,v236
v_fmac_f32 v232,s45,v236
M v[152:155],v[164:167],a[204:207],0
v_fmac_f32 v237,s41,v235
v_sub_f32 v236,v236,v234
M v[152:155],v[160:163],a[208:211],v[152:155]
v_fma_f32 v234,-4.0,v233,v235
v_sub_f32 v235,v235,v233
M v[152:155],v[168:171],a[216:219],v[152:155]
v_add_f32 v233,v238,v234
v_sub_f32 v238,v238,v234
M v[156:159],v[168:171],a[228:231],0
buffer_load_dwordx4 a[244:247],v250,s[20:23],s47 offen offset:1024 sc1
M v[156:159],v[160:163],a[216:219],v[156:159]
v_fma_f32 v234,2.0,v235,v236
v_fmac_f32 v236,-2.0,v235
M v[156:159],v[164:167],a[208:211],v[156:159]
s_waitcnt vmcnt(16)
buffer_load_dwordx4 a[240:243],v250,s[20:23],s47 offen offset:2048 sc1
M v[160:163],a[192:195],a[248:251],0
s_waitcnt vmcnt(16)
s_add_u32 s48,s73,15360
v_and_b32 v199,s42,v199
v_and_b32 v193,s42,v193
M v[160:163],a[196:199],a[252:255],v[160:163]
s_waitcnt vmcnt(15)
v_and_b32 v197,s42,v197
v_and_b32 v195,s42,v195
M v[160:163],a[200:203],v[216:219],v[160:163]
v_and_b32 v203,s42,v203
v_and_b32 v201,s42,v201
M v[164:167],a[200:203],v[228:231],0
buffer_load_dwordx4 a[236:239],v250,s[20:23],s48 offen offset:0 sc1
M v[164:167],a[196:199],v[216:219],v[164:167]
v_fmac_f32 v193,s43,v199
v_fmac_f32 v195,4.0,v197
M v[164:167],a[192:195],a[252:255],v[164:167]
v_fma_f32 v235,-4.0,v199,v203
v_fmac_f32 v193,s45,v203
M v[168:171],a[192:195],v[216:219],0
v_fmac_f32 v195,s41,v201
v_sub_f32 v203,v203,v199
M v[168:171],a[196:199],v[228:231],v[168:171]
buffer_load_dwordx4 a[248:251],v250,s[20:23],s48 offen offset:1024 sc1
M v[168:171],a[200:203],v[224:227],v[168:171]
v_fma_f32 v199,-4.0,v197,v201
v_sub_f32 v201,v201,v197
M v[172:175],a[200:203],v[220:223],0
v_add_f32 v197,v235,v199
v_sub_f32 v235,v235,v199
M v[172:175],a[196:199],v[224:227],v[172:175]
v_fma_f32 v199,2.0,v201,v203
v_fmac_f32 v203,-2.0,v201
M v[172:175],a[192:195],v[228:231],v[172:175]
buffer_load_dwordx4 a[252:255],v250,s[20:23],s48 offen offset:2048 sc1
M v[176:179],a[192:195],v[224:227],0
s_add_u32 s46,s73,18432
v_cvt_pk_bf16_f32 v193,v232,v193
v_cvt_pk_bf16_f32 v195,v237,v195
M v[176:179],a[196:199],v[220:223],v[176:179]
v_cvt_pk_bf16_f32 v197,v233,v197
v_cvt_pk_bf16_f32 v201,v234,v199
M v[176:179],a[200:203],a[204:207],v[176:179]
s_barrier
v_cvt_pk_bf16_f32 v199,v238,v235
M v[180:183],a[200:203],a[208:211],0
buffer_load_dwordx4 v[216:219],v250,s[20:23],s46 offen offset:0 sc1
M v[180:183],a[196:199],a[204:207],v[180:183]
ds_read_b128 v[228:231],v248 offset:52224
v_cvt_pk_bf16_f32 v203,v236,v203
M v[180:183],a[192:195],v[220:223],v[180:183]
ds_write2st64_b64 v247,v[192:193],v[194:195] offset0:204 offset1:221
M v[184:187],a[192:195],a[204:207],0
s_add_u32 s28,s68,786432
ds_read_b128 v[224:227],v249 offset:52224
ds_read_b128 v[220:223],v248 offset:52736
M v[184:187],a[196:199],a[208:211],v[184:187]
buffer_load_dwordx4 v[192:195],v251,s[88:91],s28 offen offset:0
M v[184:187],a[200:203],a[216:219],v[184:187]
ds_write2st64_b64 v247,v[196:197],v[198:199] offset0:34 offset1:51
M v[188:191],a[200:203],a[228:231],0
s_waitcnt vmcnt(17)
ds_read_b128 a[204:207],v249 offset:52736
v_permlane32_swap_b32 v208,v210
M v[188:191],a[196:199],a[216:219],v[188:191]
buffer_load_dwordx4 v[196:199],v245,s[8:11],s28 offen offset:0
M v[188:191],a[192:195],a[208:211],v[188:191]
s_waitcnt lgkmcnt(5)
ds_write2st64_b64 v247,v[200:201],v[202:203] offset0:68 offset1:85
M a[0:3],a[212:215],v[228:231],a[0:3]
s_waitcnt vmcnt(10) lgkmcnt(4)
ds_read_b128 a[200:203],v248 offset:53248
v_permlane32_swap_b32 v204,v206
M a[0:3],a[224:227],v[224:227],a[0:3]
s_waitcnt vmcnt(9) lgkmcnt(4)
buffer_load_dwordx4 v[200:203],v245,s[8:11],s28 offen offset:768
M a[0:3],a[220:223],v[220:223],a[0:3]
s_waitcnt lgkmcnt(2)
ds_read_b128 a[228:231],v249 offset:53248
v_permlane32_swap_b32 v212,v214
M a[4:7],a[220:223],a[204:207],a[4:7]
v_lshlrev_b32 v234,16,v210
v_lshlrev_b32 v232,16,v204
M a[4:7],a[224:227],v[220:223],a[4:7]
v_lshlrev_b32 v233,16,v208
v_lshlrev_b32 v237,16,v206
M a[4:7],a[212:215],v[224:227],a[4:7]
v_lshlrev_b32 v236,16,v214
v_lshlrev_b32 v235,16,v212
M a[8:11],a[212:215],v[220:223],a[8:11]
ds_read_b128 a[196:199],v248 offset:53760
v_fmac_f32 v232,s43,v234
M a[8:11],a[224:227],a[204:207],a[8:11]
s_waitcnt lgkmcnt(2)
ds_read_b128 a[216:219],v249 offset:53760
v_fmac_f32 v237,4.0,v233
M a[8:11],a[220:223],a[200:203],a[8:11]
s_waitcnt lgkmcnt(2)
v_fma_f32 v238,-4.0,v234,v236
v_fmac_f32 v232,s45,v236
M a[12:15],a[220:223],a[228:231],a[12:15]
v_fmac_f32 v237,s41,v235
v_sub_f32 v236,v236,v234
M a[12:15],a[224:227],a[200:203],a[12:15]
v_fma_f32 v234,-4.0,v233,v235
v_sub_f32 v235,v235,v233
M a[12:15],a[212:215],a[204:207],a[12:15]
v_add_f32 v233,v238,v234
v_sub_f32 v238,v238,v234
M a[16:19],a[212:215],a[200:203],a[16:19]
ds_read_b128 a[192:195],v249 offset:54272
v_fma_f32 v234,2.0,v235,v236
M a[16:19],a[224:227],a[228:231],a[16:19]
s_waitcnt lgkmcnt(2)
ds_read_b128 a[208:211],v248 offset:54272
v_fmac_f32 v236,-2.0,v235
M a[16:19],a[220:223],a[196:199],a[16:19]
s_waitcnt lgkmcnt(2)
v_and_b32 v210,s42,v210
v_and_b32 v204,s42,v204
M a[20:23],a[220:223],a[216:219],a[20:23]
v_and_b32 v208,s42,v208
v_and_b32 v206,s42,v206
M a[20:23],a[224:227],a[196:199],a[20:23]
v_and_b32 v214,s42,v214
v_and_b32 v212,s42,v212
M a[20:23],a[212:215],a[228:231],a[20:23]
v_fmac_f32 v204,s43,v210
v_fmac_f32 v206,4.0,v208
M a[24:27],a[212:215],a[196:199],a[24:27]
v_fma_f32 v235,-4.0,v210,v214
v_fmac_f32 v204,s45,v214
M a[24:27],a[224:227],a[216:219],a[24:27]
s_waitcnt lgkmcnt(1)
v_fmac_f32 v206,s41,v212
v_sub_f32 v214,v214,v210
M a[24:27],a[220:223],a[192:195],a[24:27]
s_waitcnt lgkmcnt(0)
v_fma_f32 v210,-4.0,v208,v212
v_sub_f32 v212,v212,v208
M a[28:31],a[220:223],a[208:211],a[28:31]
buffer_load_dwordx4 a[220:223],v250,s[20:23],s46 offen offset:1024 sc1
M a[28:31],a[224:227],a[192:195],a[28:31]
v_add_f32 v208,v235,v210
v_sub_f32 v235,v235,v210
M a[28:31],a[212:215],a[216:219],a[28:31]
s_waitcnt vmcnt(10)
buffer_load_dwordx4 a[224:227],v250,s[20:23],s46 offen offset:2048 sc1
M a[32:35],a[232:235],v[228:231],a[32:35]
s_waitcnt vmcnt(10)
s_add_u32 s47,s73,21504
v_fma_f32 v210,2.0,v212,v214
v_fmac_f32 v214,-2.0,v212
M a[32:35],a[244:247],v[224:227],a[32:35]
s_waitcnt vmcnt(9)
v_cvt_pk_bf16_f32 v204,v232,v204
v_cvt_pk_bf16_f32 v206,v237,v206
M a[32:35],a[240:243],v[220:223],a[32:35]
v_cvt_pk_bf16_f32 v208,v233,v208
v_cvt_pk_bf16_f32 v212,v234,v210
M a[36:39],a[240:243],a[204:207],a[36:39]
buffer_load_dwordx4 a[212:215],v250,s[20:23],s47 offen offset:0 sc1
M a[36:39],a[244:247],v[220:223],a[36:39]
v_cvt_pk_bf16_f32 v210,v238,v235
v_cvt_pk_bf16_f32 v214,v236,v214
M a[36:39],a[232:235],v[224:227],a[36:39]
v_permlane32_swap_b32 v209,v211
v_permlane32_swap_b32 v205,v207
M a[40:43],a[232:235],v[220:223],a[40:43]
v_permlane32_swap_b32 v213,v215
v_lshlrev_b32 v234,16,v211
M a[40:43],a[244:247],a[204:207],a[40:43]
v_lshlrev_b32 v232,16,v205
v_lshlrev_b32 v233,16,v209
M a[40:43],a[240:243],a[200:203],a[40:43]
v_lshlrev_b32 v237,16,v207
v_lshlrev_b32 v236,16,v215
M a[44:47],a[240:243],a[228:231],a[44:47]
v_lshlrev_b32 v235,16,v213
v_fmac_f32 v232,s43,v234
M a[44:47],a[244:247],a[200:203],a[44:47]
v_fmac_f32 v237,4.0,v233
v_fma_f32 v238,-4.0,v234,v236
M a[44:47],a[232:235],a[204:207],a[44:47]
v_fmac_f32 v232,s45,v236
v_fmac_f32 v237,s41,v235
M a[48:51],a[232:235],a[200:203],a[48:51]
v_sub_f32 v236,v236,v234
v_fma_f32 v234,-4.0,v233,v235
M a[48:51],a[244:247],a[228:231],a[48:51]
v_sub_f32 v235,v235,v233
v_add_f32 v233,v238,v234
M a[48:51],a[240:243],a[196:199],a[48:51]
v_sub_f32 v238,v238,v234
v_fma_f32 v234,2.0,v235,v236
M a[52:55],a[240:243],a[216:219],a[52:55]
v_fmac_f32 v236,-2.0,v235
v_and_b32 v211,s42,v211
M a[52:55],a[244:247],a[196:199],a[52:55]
v_and_b32 v205,s42,v205
v_and_b32 v209,s42,v209
M a[52:55],a[232:235],a[228:231],a[52:55]
v_and_b32 v207,s42,v207
v_and_b32 v215,s42,v215
M a[56:59],a[232:235],a[196:199],a[56:59]
v_and_b32 v213,s42,v213
v_fmac_f32 v205,s43,v211
M a[56:59],a[244:247],a[216:219],a[56:59]
v_fmac_f32 v207,4.0,v209
v_fma_f32 v235,-4.0,v211,v215
M a[56:59],a[240:243],a[192:195],a[56:59]
v_fmac_f32 v205,s45,v215
v_fmac_f32 v207,s41,v213
M a[60:63],a[240:243],a[208:211],a[60:63]
buffer_load_dwordx4 a[240:243],v250,s[20:23],s47 offen offset:1024 sc1
M a[60:63],a[244:247],a[192:195],a[60:63]
v_sub_f32 v215,v215,v211
v_fma_f32 v211,-4.0,v209,v213
M a[60:63],a[232:235],a[216:219],a[60:63]
s_waitcnt vmcnt(10)
buffer_load_dwordx4 a[244:247],v250,s[20:23],s47 offen offset:2048 sc1
M a[64:67],a[236:239],v[228:231],a[64:67]
s_waitcnt vmcnt(10)
s_add_u32 s48,s73,24576
v_sub_f32 v213,v213,v209
v_add_f32 v209,v235,v211
M a[64:67],a[248:251],v[224:227],a[64:67]
s_waitcnt vmcnt(9)
v_sub_f32 v235,v235,v211
v_fma_f32 v211,2.0,v213,v215
M a[64:67],a[252:255],v[220:223],a[64:67]
v_fmac_f32 v215,-2.0,v213
v_cvt_pk_bf16_f32 v205,v232,v205
M a[68:71],a[252:255],a[204:207],a[68:71]
buffer_load_dwordx4 a[232:235],v250,s[20:23],s48 offen offset:0 sc1
M a[68:71],a[248:251],v[220:223],a[68:71]
v_cvt_pk_bf16_f32 v207,v237,v207
v_cvt_pk_bf16_f32 v209,v233,v209
M a[68:71],a[236:239],v[224:227],a[68:71]
v_cvt_pk_bf16_f32 v213,v234,v211
v_cvt_pk_bf16_f32 v211,v238,v235
M a[72:75],a[236:239],v[220:223],a[72:75]
v_cvt_pk_bf16_f32 v215,v236,v215
v_fmac_f32 v239,s43,v241
M a[72:75],a[248:251],a[204:207],a[72:75]
buffer_load_dwordx4 v[228:231],v250,s[20:23],s48 offen offset:1024 sc1
M a[72:75],a[252:255],a[200:203],a[72:75]
ds_write2st64_b64 v247,v[204:205],v[206:207] offset0:205 offset1:222
M a[76:79],a[252:255],a[228:231],a[76:79]
s_add_u32 s28,s68,1179648
v_fmac_f32 v244,4.0,v240
v_fma_f32 v232,-4.0,v241,v243
M a[76:79],a[248:251],a[200:203],a[76:79]
v_fmac_f32 v239,s45,v243
v_fmac_f32 v244,s41,v242
M a[76:79],a[236:239],a[204:207],a[76:79]
buffer_load_dwordx4 v[224:227],v250,s[20:23],s48 offen offset:2048 sc1
M a[80:83],a[236:239],a[200:203],a[80:83]
s_add_u32 s46,s73,27648
v_sub_f32 v243,v243,v241
v_fma_f32 v241,-4.0,v240,v242
M a[80:83],a[248:251],a[228:231],a[80:83]
v_sub_f32 v242,v242,v240
v_add_f32 v240,v232,v241
M a[80:83],a[252:255],a[196:199],a[80:83]
ds_write2st64_b64 v247,v[208:209],v[210:211] offset0:35 offset1:52
M a[84:87],a[252:255],a[216:219],a[84:87]
buffer_load_dwordx4 v[220:223],v250,s[20:23],s46 offen offset:0 sc1
M a[84:87],a[248:251],a[196:199],a[84:87]
ds_read_b128 a[204:207],v248 offset:60928
v_sub_f32 v232,v232,v241
M a[84:87],a[236:239],a[228:231],a[84:87]
ds_write2st64_b64 v247,v[212:213],v[214:215] offset0:69 offset1:86
M a[88:91],a[236:239],a[196:199],a[88:91]
buffer_load_dwordx4 v[204:207],v251,s[88:91],s28 offen offset:0
M a[88:91],a[248:251],a[216:219],a[88:91]
ds_read_b128 a[200:203],v249 offset:60928
ds_read_b128 a[228:231],v248 offset:61440
M a[88:91],a[252:255],a[192:195],a[88:91]
ds_read_b128 a[196:199],v249 offset:61440
v_fma_f32 v241,2.0,v242,v243
M a[92:95],a[252:255],a[208:211],a[92:95]
buffer_load_dwordx4 v[208:211],v245,s[8:11],s28 offen offset:0
M a[92:95],a[248:251],a[192:195],a[92:95]
v_fmac_f32 v243,-2.0,v242
v_cvt_pk_bf16_f32 v233,v239,v244
M a[92:95],a[236:239],a[216:219],a[92:95]
s_waitcnt vmcnt(14) lgkmcnt(4)
v_cvt_pk_bf16_f32 v234,v240,v232
v_cvt_pk_bf16_f32 v235,v241,v243
M a[96:99],v[216:219],a[204:207],a[96:99]
s_waitcnt vmcnt(10) lgkmcnt(2)
ds_read_b128 a[208:211],v248 offset:61952
v_add_u32 v232,104448,v252
M a[96:99],a[220:223],a[200:203],a[96:99]
s_waitcnt vmcnt(9) lgkmcnt(2)
buffer_load_dwordx4 v[212:215],v245,s[8:11],s28 offen offset:768
M a[96:99],a[224:227],a[228:231],a[96:99]
s_waitcnt lgkmcnt(1)
s_add_u32 s29,s69,0
ds_read_b128 a[252:255],v249 offset:61952
ds_write_b16 v232,v233 offset:0
M a[100:103],a[224:227],a[196:199],a[100:103]
ds_write_b16_d16_hi v232,v233 offset:8704
M a[100:103],a[220:223],a[228:231],a[100:103]
ds_write_b16 v252,v234 offset:17408
M a[100:103],v[216:219],a[200:203],a[100:103]
buffer_load_short_d16_hi v239,v246,s[12:15],s29 offen offset:0
M a[104:107],v[216:219],a[228:231],a[104:107]
ds_read_b128 a[192:195],v248 offset:62464
ds_write_b16_d16_hi v252,v234 offset:26112
M a[104:107],a[220:223],a[196:199],a[104:107]
s_waitcnt lgkmcnt(6)
buffer_load_short_d16_hi v240,v246,s[8:11],s29 offen offset:0
M a[104:107],a[224:227],a[208:211],a[104:107]
s_waitcnt lgkmcnt(5)
ds_read_b128 a[248:251],v249 offset:62464
ds_write_b16 v252,v235 offset:34816
M a[108:111],a[224:227],a[252:255],a[108:111]
buffer_load_short_d16_hi v241,v246,s[8:11],s29 offen offset:384
M a[108:111],a[220:223],a[208:211],a[108:111]
buffer_load_short_d16_hi v242,v246,s[8:11],s29 offen offset:768
M a[108:111],v[216:219],a[196:199],a[108:111]
ds_write_b16_d16_hi v252,v235 offset:43520
M a[112:115],v[216:219],a[208:211],a[112:115]
buffer_load_short_d16_hi v243,v246,s[8:11],s29 offen offset:1152
M a[112:115],a[220:223],a[252:255],a[112:115]
s_waitcnt lgkmcnt(4)
ds_read_b128 a[216:219],v249 offset:62976
ds_read_b128 a[236:239],v248 offset:62976
M a[112:115],a[224:227],a[192:195],a[112:115]
s_waitcnt lgkmcnt(4)
buffer_load_short_d16_hi v244,v246,s[16:19],s29 offen offset:1536
M a[116:119],a[224:227],a[248:251],a[116:119]
v_permlane32_swap_b32 v196,v198
v_permlane32_swap_b32 v192,v194
M a[116:119],a[220:223],a[192:195],a[116:119]
v_permlane32_swap_b32 v200,v202
v_lshlrev_b32 v234,16,v198
M a[116:119],v[216:219],a[252:255],a[116:119]
v_lshlrev_b32 v232,16,v192
v_lshlrev_b32 v233,16,v196
M a[120:123],v[216:219],a[192:195],a[120:123]
v_lshlrev_b32 v237,16,v194
v_lshlrev_b32 v236,16,v202
M a[120:123],a[220:223],a[248:251],a[120:123]
s_waitcnt lgkmcnt(1)
v_lshlrev_b32 v235,16,v200
v_fmac_f32 v232,s43,v234
M a[120:123],a[224:227],a[216:219],a[120:123]
s_waitcnt lgkmcnt(0)
v_fmac_f32 v237,4.0,v233
v_fma_f32 v238,-4.0,v234,v236
M a[124:127],a[224:227],a[236:239],a[124:127]
buffer_load_dwordx4 a[224:227],v250,s[20:23],s46 offen offset:1024 sc1
M a[124:127],a[220:223],a[216:219],a[124:127]
v_fmac_f32 v232,s45,v236
v_fmac_f32 v237,s41,v235
M a[124:127],v[216:219],a[248:251],a[124:127]
s_waitcnt vmcnt(16)
buffer_load_dwordx4 a[220:223],v250,s[20:23],s46 offen offset:2048 sc1
M a[128:131],a[212:215],a[204:207],a[128:131]
s_waitcnt vmcnt(16)
s_add_u32 s47,s73,30720
v_sub_f32 v236,v236,v234
v_fma_f32 v234,-4.0,v233,v235
M a[128:131],a[240:243],a[200:203],a[128:131]
s_waitcnt vmcnt(15)
v_sub_f32 v235,v235,v233
v_add_f32 v233,v238,v234
M a[128:131],a[244:247],a[228:231],a[128:131]
v_sub_f32 v238,v238,v234
v_fma_f32 v234,2.0,v235,v236
M a[132:135],a[244:247],a[196:199],a[132:135]
buffer_load_dwordx4 v[216:219],v250,s[20:23],s47 offen offset:0 sc1
M a[132:135],a[240:243],a[228:231],a[132:135]
v_fmac_f32 v236,-2.0,v235
v_and_b32 v198,s42,v198
M a[132:135],a[212:215],a[200:203],a[132:135]
v_and_b32 v192,s42,v192
v_and_b32 v196,s42,v196
M a[136:139],a[212:215],a[228:231],a[136:139]
v_and_b32 v194,s42,v194
v_and_b32 v202,s42,v202
M a[136:139],a[240:243],a[196:199],a[136:139]
v_and_b32 v200,s42,v200
v_fmac_f32 v192,s43,v198
M a[136:139],a[244:247],a[208:211],a[136:139]
v_fmac_f32 v194,4.0,v196
v_fma_f32 v235,-4.0,v198,v202
M a[140:143],a[244:247],a[252:255],a[140:143]
v_fmac_f32 v192,s45,v202
v_fmac_f32 v194,s41,v200
M a[140:143],a[240:243],a[208:211],a[140:143]
v_sub_f32 v202,v202,v198
v_fma_f32 v198,-4.0,v196,v200
M a[140:143],a[212:215],a[196:199],a[140:143]
v_sub_f32 v200,v200,v196
v_add_f32 v196,v235,v198
M a[144:147],a[212:215],a[208:211],a[144:147]
v_sub_f32 v235,v235,v198
v_fma_f32 v198,2.0,v200,v202
M a[144:147],a[240:243],a[252:255],a[144:147]
v_fmac_f32 v202,-2.0,v200
v_cvt_pk_bf16_f32 v192,v232,v192
M a[144:147],a[244:247],a[192:195],a[144:147]
v_cvt_pk_bf16_f32 v194,v237,v194
v_cvt_pk_bf16_f32 v196,v233,v196
M a[148:151],a[244:247],a[248:251],a[148:151]
v_cvt_pk_bf16_f32 v200,v234,v198
v_cvt_pk_bf16_f32 v198,v238,v235
M a[148:151],a[240:243],a[192:195],a[148:151]
v_cvt_pk_bf16_f32 v202,v236,v202
v_permlane32_swap_b32 v197,v199
M a[148:151],a[212:215],a[252:255],a[148:151]
v_permlane32_swap_b32 v193,v195
v_permlane32_swap_b32 v201,v203
M a[152:155],a[212:215],a[192:195],a[152:155]
v_lshlrev_b32 v234,16,v199
v_lshlrev_b32 v232,16,v193
M a[152:155],a[240:243],a[248:251],a[152:155]
v_lshlrev_b32 v233,16,v197
v_lshlrev_b32 v237,16,v195
M a[152:155],a[244:247],a[216:219],a[152:155]
v_lshlrev_b32 v236,16,v203
v_lshlrev_b32 v235,16,v201
M a[156:159],a[244:247],a[236:239],a[156:159]
buffer_load_dwordx4 a[244:247],v250,s[20:23],s47 offen offset:1024 sc1
M a[156:159],a[240:243],a[216:219],a[156:159]
v_fmac_f32 v232,s43,v234
v_fmac_f32 v237,4.0,v233
M a[156:159],a[212:215],a[248:251],a[156:159]
s_waitcnt vmcnt(16)
buffer_load_dwordx4 a[240:243],v250,s[20:23],s47 offen offset:2048 sc1
M a[160:163],a[232:235],a[204:207],a[160:163]
s_waitcnt vmcnt(16)
s_add_u32 s48,s73,33792
v_fma_f32 v238,-4.0,v234,v236
v_fmac_f32 v232,s45,v236
M a[160:163],v[228:231],a[200:203],a[160:163]
s_waitcnt vmcnt(15)
v_fmac_f32 v237,s41,v235
v_sub_f32 v236,v236,v234
M a[160:163],v[224:227],a[228:231],a[160:163]
v_fma_f32 v234,-4.0,v233,v235
v_sub_f32 v235,v235,v233
M a[164:167],v[224:227],a[196:199],a[164:167]
buffer_load_dwordx4 a[212:215],v250,s[20:23],s48 offen offset:0 sc1
M a[164:167],v[228:231],a[228:231],a[164:167]
v_add_f32 v233,v238,v234
v_sub_f32 v238,v238,v234
M a[164:167],a[232:235],a[200:203],a[164:167]
v_fma_f32 v234,2.0,v235,v236
v_fmac_f32 v236,-2.0,v235
M a[168:171],a[232:235],a[228:231],a[168:171]
v_and_b32 v199,s42,v199
v_and_b32 v193,s42,v193
M a[168:171],v[228:231],a[196:199],a[168:171]
buffer_load_dwordx4 a[204:207],v250,s[20:23],s48 offen offset:1024 sc1
M a[168:171],v[224:227],a[208:211],a[168:171]
v_and_b32 v197,s42,v197
v_and_b32 v195,s42,v195
M a[172:175],v[224:227],a[252:255],a[172:175]
v_and_b32 v203,s42,v203
v_and_b32 v201,s42,v201
M a[172:175],v[228:231],a[208:211],a[172:175]
v_fmac_f32 v193,s43,v199
v_fmac_f32 v195,4.0,v197
M a[172:175],a[232:235],a[196:199],a[172:175]
buffer_load_dwordx4 a[200:203],v250,s[20:23],s48 offen offset:2048 sc1
M a[176:179],a[232:235],a[208:211],a[176:179]
s_add_u32 s46,s73,36864
v_fma_f32 v235,-4.0,v199,v203
v_fmac_f32 v193,s45,v203
M a[176:179],v[228:231],a[252:255],a[176:179]
v_add_u32 v248,0x4400,v248
v_add_u32 v249,0x4400,v249
M a[176:179],v[224:227],a[192:195],a[176:179]
v_fmac_f32 v195,s41,v201
v_sub_f32 v203,v203,v199
M a[180:183],v[224:227],a[248:251],a[180:183]
buffer_load_dwordx4 a[228:231],v250,s[20:23],s46 offen offset:0 sc1
M a[180:183],v[228:231],a[192:195],a[180:183]
ds_read_b128 a[196:199],v248 offset:52224
v_fma_f32 v199,-4.0,v197,v201
M a[180:183],a[232:235],a[252:255],a[180:183]
ds_read_b128 a[208:211],v249 offset:52224
v_sub_f32 v201,v201,v197
M a[184:187],a[232:235],a[192:195],a[184:187]
ds_read_b128 a[252:255],v248 offset:52736
v_add_f32 v197,v235,v199
M a[184:187],v[228:231],a[248:251],a[184:187]
ds_read_b128 a[192:195],v249 offset:52736
v_sub_f32 v235,v235,v199
M a[184:187],v[224:227],a[216:219],a[184:187]
v_fma_f32 v199,2.0,v201,v203
v_fmac_f32 v203,-2.0,v201
M a[188:191],v[224:227],a[236:239],a[188:191]
v_cvt_pk_bf16_f32 v193,v232,v193
v_cvt_pk_bf16_f32 v195,v237,v195
M a[188:191],v[228:231],a[216:219],a[188:191]
v_cvt_pk_bf16_f32 v197,v233,v197
v_cvt_pk_bf16_f32 v201,v234,v199
M a[188:191],a[232:235],a[248:251],a[188:191]
s_waitcnt vmcnt(18) lgkmcnt(3)
v_cvt_pk_bf16_f32 v199,v238,v235
v_cvt_pk_bf16_f32 v203,v236,v203
M v[0:3],v[220:223],a[196:199],v[0:3]
s_waitcnt vmcnt(8) lgkmcnt(2)
ds_read_b128 a[236:239],v248 offset:53248
v_permlane32_swap_b32 v208,v210
M v[0:3],a[224:227],a[208:211],v[0:3]
s_waitcnt vmcnt(7) lgkmcnt(2)
ds_read_b128 v[224:227],v249 offset:53248
v_permlane32_swap_b32 v204,v206
M v[0:3],a[220:223],a[252:255],v[0:3]
s_waitcnt lgkmcnt(2)
ds_write2st64_b64 v247,v[192:193],v[194:195] offset0:206 offset1:223
M v[4:7],a[220:223],a[192:195],v[4:7]
s_add_u32 s28,s69,0
s_mov_b64 exec,s[86:87]
v_xor_b32 v245,0x80000000,v245
v_xor_b32 v251,0x80000000,v251
s_mov_b64 exec,-1
v_permlane32_swap_b32 v212,v214
M v[4:7],a[224:227],a[252:255],v[4:7]
buffer_load_dwordx4 v[192:195],v251,s[88:91],s28 offen offset:0
M v[4:7],v[220:223],a[208:211],v[4:7]
ds_write2st64_b64 v247,v[196:197],v[198:199] offset0:36 offset1:53
M v[8:11],v[220:223],a[252:255],v[8:11]
buffer_load_dwordx4 v[196:199],v245,s[8:11],s28 offen offset:0
M v[8:11],a[224:227],a[192:195],v[8:11]
s_waitcnt lgkmcnt(3)
ds_read_b128 a[216:219],v248 offset:53760
ds_read_b128 v[228:231],v249 offset:53760
M v[8:11],a[220:223],a[236:239],v[8:11]
s_waitcnt lgkmcnt(4)
ds_write2st64_b64 v247,v[200:201],v[202:203] offset0:70 offset1:87
M v[12:15],a[220:223],v[224:227],v[12:15]
buffer_load_dwordx4 v[200:203],v245,s[8:11],s28 offen offset:768
M v[12:15],a[224:227],a[236:239],v[12:15]
s_mov_b64 exec,s[86:87]
v_xor_b32 v245,0x80000000,v245
v_xor_b32 v251,0x80000000,v251
s_mov_b64 exec,-1
v_lshlrev_b32 v234,16,v210
M v[12:15],v[220:223],a[192:195],v[12:15]
v_lshlrev_b32 v232,16,v204
v_lshlrev_b32 v233,16,v208
M v[16:19],v[220:223],a[236:239],v[16:19]
ds_read_b128 a[232:235],v249 offset:54272
v_lshlrev_b32 v237,16,v206
M v[16:19],a[224:227],v[224:227],v[16:19]
s_waitcnt lgkmcnt(3)
ds_read_b128 a[248:251],v248 offset:54272
v_lshlrev_b32 v236,16,v214
M v[16:19],a[220:223],a[216:219],v[16:19]
s_waitcnt lgkmcnt(3)
v_lshlrev_b32 v235,16,v212
v_fmac_f32 v232,s43,v234
M v[20:23],a[220:223],v[228:231],v[20:23]
v_fmac_f32 v237,4.0,v233
v_fma_f32 v238,-4.0,v234,v236
M v[20:23],a[224:227],a[216:219],v[20:23]
v_fmac_f32 v232,s45,v236
v_fmac_f32 v237,s41,v235
M v[20:23],v[220:223],v[224:227],v[20:23]
v_sub_f32 v236,v236,v234
v_fma_f32 v234,-4.0,v233,v235
M v[24:27],v[220:223],a[216:219],v[24:27]
v_sub_f32 v235,v235,v233
v_add_f32 v233,v238,v234
M v[24:27],a[224:227],v[228:231],v[24:27]
s_waitcnt lgkmcnt(1)
v_sub_f32 v238,v238,v234
v_fma_f32 v234,2.0,v235,v236
M v[24:27],a[220:223],a[232:235],v[24:27]
s_waitcnt lgkmcnt(0)
v_fmac_f32 v236,-2.0,v235
v_and_b32 v210,s42,v210
M v[28:31],a[220:223],a[248:251],v[28:31]
global_load_dword a220,v250,s[64:65]
M v[28:31],a[224:227],a[232:235],v[28:31]
buffer_load_dwordx4 a[220:223],v250,s[20:23],s46 offen offset:1024 sc1
M v[28:31],v[220:223],v[228:231],v[28:31]
s_waitcnt vmcnt(11)
v_and_b32 v204,s42,v204
v_and_b32 v208,s42,v208
M v[32:35],v[216:219],a[196:199],v[32:35]
s_waitcnt vmcnt(10)
v_and_b32 v206,s42,v206
v_and_b32 v214,s42,v214
M v[32:35],a[244:247],a[208:211],v[32:35]
s_waitcnt vmcnt(9)
buffer_load_dwordx4 a[224:227],v250,s[20:23],s46 offen offset:2048 sc1
M v[32:35],a[240:243],a[252:255],v[32:35]
s_add_u32 s47,s73,39936
v_and_b32 v212,s42,v212
v_fmac_f32 v204,s43,v210
M v[36:39],a[240:243],a[192:195],v[36:39]
v_fmac_f32 v206,4.0,v208
v_fma_f32 v235,-4.0,v210,v214
M v[36:39],a[244:247],a[252:255],v[36:39]
v_fmac_f32 v204,s45,v214
v_fmac_f32 v206,s41,v212
M v[36:39],v[216:219],a[208:211],v[36:39]
buffer_load_dwordx4 v[220:223],v250,s[20:23],s47 offen offset:0 sc1
M v[40:43],v[216:219],a[252:255],v[40:43]
v_sub_f32 v214,v214,v210
v_fma_f32 v210,-4.0,v208,v212
M v[40:43],a[244:247],a[192:195],v[40:43]
v_sub_f32 v212,v212,v208
v_add_f32 v208,v235,v210
M v[40:43],a[240:243],a[236:239],v[40:43]
v_sub_f32 v235,v235,v210
v_fma_f32 v210,2.0,v212,v214
M v[44:47],a[240:243],v[224:227],v[44:47]
v_fmac_f32 v214,-2.0,v212
v_cvt_pk_bf16_f32 v204,v232,v204
M v[44:47],a[244:247],a[236:239],v[44:47]
v_cvt_pk_bf16_f32 v206,v237,v206
v_cvt_pk_bf16_f32 v208,v233,v208
M v[44:47],v[216:219],a[192:195],v[44:47]
v_cvt_pk_bf16_f32 v212,v234,v210
v_cvt_pk_bf16_f32 v210,v238,v235
M v[48:51],v[216:219],a[236:239],v[48:51]
v_cvt_pk_bf16_f32 v214,v236,v214
v_permlane32_swap_b32 v209,v211
M v[48:51],a[244:247],v[224:227],v[48:51]
v_permlane32_swap_b32 v205,v207
v_permlane32_swap_b32 v213,v215
M v[48:51],a[240:243],a[216:219],v[48:51]
v_lshlrev_b32 v234,16,v211
v_lshlrev_b32 v232,16,v205
M v[52:55],a[240:243],v[228:231],v[52:55]
v_lshlrev_b32 v233,16,v209
v_lshlrev_b32 v237,16,v207
M v[52:55],a[244:247],a[216:219],v[52:55]
v_lshlrev_b32 v236,16,v215
v_lshlrev_b32 v235,16,v213
M v[52:55],v[216:219],v[224:227],v[52:55]
v_fmac_f32 v232,s43,v234
v_fmac_f32 v237,4.0,v233
M v[56:59],v[216:219],a[216:219],v[56:59]
v_fma_f32 v238,-4.0,v234,v236
v_fmac_f32 v232,s45,v236
M v[56:59],a[244:247],v[228:231],v[56:59]
v_fmac_f32 v237,s41,v235
v_sub_f32 v236,v236,v234
M v[56:59],a[240:243],a[232:235],v[56:59]
v_fma_f32 v234,-4.0,v233,v235
v_sub_f32 v235,v235,v233
M v[60:63],a[240:243],a[248:251],v[60:63]
buffer_load_dwordx4 a[240:243],v250,s[20:23],s47 offen offset:1024 sc1
M v[60:63],a[244:247],a[232:235],v[60:63]
v_add_f32 v233,v238,v234
v_sub_f32 v238,v238,v234
M v[60:63],v[216:219],v[228:231],v[60:63]
s_waitcnt vmcnt(11)
buffer_load_dwordx4 a[244:247],v250,s[20:23],s47 offen offset:2048 sc1
M v[64:67],a[212:215],a[196:199],v[64:67]
s_waitcnt vmcnt(11)
s_add_u32 s48,s73,43008
v_fma_f32 v234,2.0,v235,v236
v_fmac_f32 v236,-2.0,v235
M v[64:67],a[204:207],a[208:211],v[64:67]
s_waitcnt vmcnt(10)
v_and_b32 v211,s42,v211
v_and_b32 v205,s42,v205
M v[64:67],a[200:203],a[252:255],v[64:67]
v_and_b32 v209,s42,v209
v_and_b32 v207,s42,v207
M v[68:71],a[200:203],a[192:195],v[68:71]
buffer_load_dwordx4 v[216:219],v250,s[20:23],s48 offen offset:0 sc1
M v[68:71],a[204:207],a[252:255],v[68:71]
v_and_b32 v215,s42,v215
v_and_b32 v213,s42,v213
M v[68:71],a[212:215],a[208:211],v[68:71]
v_fmac_f32 v205,s43,v211
v_fmac_f32 v207,4.0,v209
M v[72:75],a[212:215],a[252:255],v[72:75]
v_fma_f32 v235,-4.0,v211,v215
v_fmac_f32 v205,s45,v215
M v[72:75],a[204:207],a[192:195],v[72:75]
buffer_load_dwordx4 a[196:199],v250,s[20:23],s48 offen offset:1024 sc1
M v[72:75],a[200:203],a[236:239],v[72:75]
v_fmac_f32 v207,s41,v213
v_sub_f32 v215,v215,v211
M v[76:79],a[200:203],v[224:227],v[76:79]
v_fma_f32 v211,-4.0,v209,v213
v_sub_f32 v213,v213,v209
M v[76:79],a[204:207],a[236:239],v[76:79]
v_add_f32 v209,v235,v211
v_sub_f32 v235,v235,v211
M v[76:79],a[212:215],a[192:195],v[76:79]
buffer_load_dwordx4 a[208:211],v250,s[20:23],s48 offen offset:2048 sc1
M v[80:83],a[212:215],a[236:239],v[80:83]
s_add_u32 s46,s74,9216
v_fma_f32 v211,2.0,v213,v215
v_fmac_f32 v215,-2.0,v213
M v[80:83],a[204:207],v[224:227],v[80:83]
v_cvt_pk_bf16_f32 v205,v232,v205
v_cvt_pk_bf16_f32 v207,v237,v207
M v[80:83],a[200:203],a[216:219],v[80:83]
v_cvt_pk_bf16_f32 v209,v233,v209
v_cvt_pk_bf16_f32 v213,v234,v211
M v[84:87],a[200:203],v[228:231],v[84:87]
buffer_load_dwordx4 a[252:255],v250,s[20:23],s46 offen offset:0 sc1
M v[84:87],a[204:207],a[216:219],v[84:87]
ds_read_b128 a[192:195],v248 offset:60928
v_cvt_pk_bf16_f32 v211,v238,v235
M v[84:87],a[212:215],v[224:227],v[84:87]
ds_read_b128 a[236:239],v249 offset:60928
v_cvt_pk_bf16_f32 v215,v236,v215
M v[88:91],a[212:215],a[216:219],v[88:91]
s_waitcnt vmcnt(11)
ds_read_b128 v[224:227],v248 offset:61440
v_permlane32_swap_b32 v196,v198
M v[88:91],a[204:207],v[228:231],v[88:91]
ds_read_b128 a[216:219],v249 offset:61440
v_permlane32_swap_b32 v192,v194
M v[88:91],a[200:203],a[232:235],v[88:91]
ds_write2st64_b64 v247,v[204:205],v[206:207] offset0:207 offset1:224
M v[92:95],a[200:203],a[248:251],v[92:95]
s_add_u32 s28,s69,393216
buffer_load_dwordx4 v[204:207],v251,s[88:91],s28 offen offset:0
M v[92:95],a[204:207],a[232:235],v[92:95]
s_waitcnt vmcnt(11)
v_permlane32_swap_b32 v200,v202
v_lshlrev_b32 v234,16,v198
M v[92:95],a[212:215],v[228:231],v[92:95]
s_waitcnt lgkmcnt(4)
ds_write2st64_b64 v247,v[208:209],v[210:211] offset0:37 offset1:54
M v[96:99],a[228:231],a[192:195],v[96:99]
s_waitcnt vmcnt(9) lgkmcnt(4)
buffer_load_dwordx4 v[208:211],v245,s[8:11],s28 offen offset:0
M v[96:99],a[220:223],a[236:239],v[96:99]
s_waitcnt vmcnt(9) lgkmcnt(3)
ds_read_b128 a[200:203],v248 offset:61952
ds_read_b128 a[248:251],v249 offset:61952
M v[96:99],a[224:227],v[224:227],v[96:99]
s_waitcnt lgkmcnt(4)
ds_write2st64_b64 v247,v[212:213],v[214:215] offset0:71 offset1:88
M v[100:103],a[224:227],a[216:219],v[100:103]
buffer_load_dwordx4 v[212:215],v245,s[8:11],s28 offen offset:768
M v[100:103],a[220:223],v[224:227],v[100:103]
v_lshlrev_b32 v232,16,v192
v_lshlrev_b32 v233,16,v196
M v[100:103],a[228:231],a[236:239],v[100:103]
v_lshlrev_b32 v237,16,v194
v_lshlrev_b32 v236,16,v202
M v[104:107],a[228:231],v[224:227],v[104:107]
ds_read_b128 a[204:207],v248 offset:62464
v_lshlrev_b32 v235,16,v200
M v[104:107],a[220:223],a[216:219],v[104:107]
s_waitcnt lgkmcnt(3)
ds_read_b128 a[232:235],v249 offset:62464
v_fmac_f32 v232,s43,v234
M v[104:107],a[224:227],a[200:203],v[104:107]
s_waitcnt lgkmcnt(3)
v_fmac_f32 v237,4.0,v233
v_fma_f32 v238,-4.0,v234,v236
M v[108:111],a[224:227],a[248:251],v[108:111]
v_fmac_f32 v232,s45,v236
v_fmac_f32 v237,s41,v235
M v[108:111],a[220:223],a[200:203],v[108:111]
v_sub_f32 v236,v236,v234
v_fma_f32 v234,-4.0,v233,v235
M v[108:111],a[228:231],a[216:219],v[108:111]
v_sub_f32 v235,v235,v233
v_add_f32 v233,v238,v234
M v[112:115],a[228:231],a[200:203],v[112:115]
ds_read_b128 a[212:215],v249 offset:62976
v_sub_f32 v238,v238,v234
M v[112:115],a[220:223],a[248:251],v[112:115]
s_waitcnt lgkmcnt(2)
ds_read_b128 v[228:231],v248 offset:62976
v_fma_f32 v234,2.0,v235,v236
M v[112:115],a[224:227],a[204:207],v[112:115]
s_waitcnt lgkmcnt(2)
v_fmac_f32 v236,-2.0,v235
v_and_b32 v198,s42,v198
M v[116:119],a[224:227],a[232:235],v[116:119]
v_and_b32 v192,s42,v192
v_and_b32 v196,s42,v196
M v[116:119],a[220:223],a[204:207],v[116:119]
v_and_b32 v194,s42,v194
v_and_b32 v202,s42,v202
M v[116:119],a[228:231],a[248:251],v[116:119]
v_and_b32 v200,s42,v200
v_fmac_f32 v192,s43,v198
M v[120:123],a[228:231],a[204:207],v[120:123]
v_fmac_f32 v194,4.0,v196
v_fma_f32 v235,-4.0,v198,v202
M v[120:123],a[220:223],a[232:235],v[120:123]
s_waitcnt lgkmcnt(1)
v_fmac_f32 v192,s45,v202
v_fmac_f32 v194,s41,v200
M v[120:123],a[224:227],a[212:215],v[120:123]
s_waitcnt lgkmcnt(0)
v_sub_f32 v202,v202,v198
v_fma_f32 v198,-4.0,v196,v200
M v[124:127],a[224:227],v[228:231],v[124:127]
buffer_load_dwordx4 a[224:227],v250,s[20:23],s46 offen offset:1024 sc1
M v[124:127],a[220:223],a[212:215],v[124:127]
v_sub_f32 v200,v200,v196
v_add_f32 v196,v235,v198
M v[124:127],a[228:231],a[232:235],v[124:127]
s_waitcnt vmcnt(10)
buffer_load_dwordx4 a[220:223],v250,s[20:23],s46 offen offset:2048 sc1
M v[128:131],v[220:223],a[192:195],v[128:131]
s_waitcnt vmcnt(10)
s_add_u32 s47,s74,12288
v_sub_f32 v235,v235,v198
v_fma_f32 v198,2.0,v200,v202
M v[128:131],a[240:243],a[236:239],v[128:131]
s_waitcnt vmcnt(9)
v_fmac_f32 v202,-2.0,v200
v_cvt_pk_bf16_f32 v192,v232,v192
M v[128:131],a[244:247],v[224:227],v[128:131]
v_cvt_pk_bf16_f32 v194,v237,v194
v_cvt_pk_bf16_f32 v196,v233,v196
M v[132:135],a[244:247],a[216:219],v[132:135]
buffer_load_dwordx4 a[228:231],v250,s[20:23],s47 offen offset:0 sc1
M v[132:135],a[240:243],v[224:227],v[132:135]
v_cvt_pk_bf16_f32 v200,v234,v198
v_cvt_pk_bf16_f32 v198,v238,v235
M v[132:135],v[220:223],a[236:239],v[132:135]
v_cvt_pk_bf16_f32 v202,v236,v202
v_permlane32_swap_b32 v197,v199
M v[136:139],v[220:223],v[224:227],v[136:139]
v_permlane32_swap_b32 v193,v195
v_permlane32_swap_b32 v201,v203
M v[136:139],a[240:243],a[216:219],v[136:139]
v_lshlrev_b32 v234,16,v199
v_lshlrev_b32 v232,16,v193
M v[136:139],a[244:247],a[200:203],v[136:139]
v_lshlrev_b32 v233,16,v197
v_lshlrev_b32 v237,16,v195
M v[140:143],a[244:247],a[248:251],v[140:143]
v_lshlrev_b32 v236,16,v203
v_lshlrev_b32 v235,16,v201
M v[140:143],a[240:243],a[200:203],v[140:143]
v_fmac_f32 v232,s43,v234
v_fmac_f32 v237,4.0,v233
M v[140:143],v[220:223],a[216:219],v[140:143]
v_fma_f32 v238,-4.0,v234,v236
v_fmac_f32 v232,s45,v236
M v[144:147],v[220:223],a[200:203],v[144:147]
v_fmac_f32 v237,s41,v235
v_sub_f32 v236,v236,v234
M v[144:147],a[240:243],a[248:251],v[144:147]
v_fma_f32 v234,-4.0,v233,v235
v_sub_f32 v235,v235,v233
M v[144:147],a[244:247],a[204:207],v[144:147]
v_add_f32 v233,v238,v234
v_sub_f32 v238,v238,v234
M v[148:151],a[244:247],a[232:235],v[148:151]
v_fma_f32 v234,2.0,v235,v236
v_fmac_f32 v236,-2.0,v235
M v[148:151],a[240:243],a[204:207],v[148:151]
v_and_b32 v199,s42,v199
v_and_b32 v193,s42,v193
M v[148:151],v[220:223],a[248:251],v[148:151]
v_and_b32 v197,s42,v197
v_and_b32 v195,s42,v195
M v[152:155],v[220:223],a[204:207],v[152:155]
v_and_b32 v203,s42,v203
v_and_b32 v201,s42,v201
M v[152:155],a[240:243],a[232:235],v[152:155]
v_fmac_f32 v193,s43,v199
v_fmac_f32 v195,4.0,v197
M v[152:155],a[244:247],a[212:215],v[152:155]
v_fma_f32 v235,-4.0,v199,v203
v_fmac_f32 v193,s45,v203
M v[156:159],a[244:247],v[228:231],v[156:159]
buffer_load_dwordx4 a[244:247],v250,s[20:23],s47 offen offset:1024 sc1
M v[156:159],a[240:243],a[212:215],v[156:159]
v_fmac_f32 v195,s41,v201
v_sub_f32 v203,v203,v199
M v[156:159],v[220:223],a[232:235],v[156:159]
s_waitcnt vmcnt(10)
buffer_load_dwordx4 a[240:243],v250,s[20:23],s47 offen offset:2048 sc1
M v[160:163],v[216:219],a[192:195],v[160:163]
s_waitcnt vmcnt(10)
s_add_u32 s48,s74,15360
v_fma_f32 v199,-4.0,v197,v201
v_sub_f32 v201,v201,v197
M v[160:163],a[196:199],a[236:239],v[160:163]
s_waitcnt vmcnt(9)
v_add_f32 v197,v235,v199
v_sub_f32 v235,v235,v199
M v[160:163],a[208:211],v[224:227],v[160:163]
v_fma_f32 v199,2.0,v201,v203
v_fmac_f32 v203,-2.0,v201
M v[164:167],a[208:211],a[216:219],v[164:167]
buffer_load_dwordx4 v[220:223],v250,s[20:23],s48 offen offset:0 sc1
M v[164:167],a[196:199],v[224:227],v[164:167]
v_cvt_pk_bf16_f32 v193,v232,v193
v_cvt_pk_bf16_f32 v195,v237,v195
M v[164:167],v[216:219],a[236:239],v[164:167]
v_cvt_pk_bf16_f32 v197,v233,v197
v_cvt_pk_bf16_f32 v201,v234,v199
M v[168:171],v[216:219],v[224:227],v[168:171]
v_cvt_pk_bf16_f32 v199,v238,v235
v_cvt_pk_bf16_f32 v203,v236,v203
M v[168:171],a[196:199],a[216:219],v[168:171]
buffer_load_dwordx4 a[192:195],v250,s[20:23],s48 offen offset:1024 sc1
M v[168:171],a[208:211],a[200:203],v[168:171]
s_waitcnt vmcnt(8)
v_permlane32_swap_b32 v208,v210
v_permlane32_swap_b32 v204,v206
M v[172:175],a[208:211],a[248:251],v[172:175]
s_waitcnt vmcnt(7)
v_permlane32_swap_b32 v212,v214
v_lshlrev_b32 v234,16,v210
M v[172:175],a[196:199],a[200:203],v[172:175]
v_lshlrev_b32 v232,16,v204
v_lshlrev_b32 v233,16,v208
M v[172:175],v[216:219],a[216:219],v[172:175]
buffer_load_dwordx4 a[236:239],v250,s[20:23],s48 offen offset:2048 sc1
M v[176:179],v[216:219],a[200:203],v[176:179]
s_add_u32 s46,s74,18432
v_lshlrev_b32 v237,16,v206
v_lshlrev_b32 v236,16,v214
M v[176:179],a[196:199],a[248:251],v[176:179]
v_lshlrev_b32 v235,16,v212
v_fmac_f32 v232,s43,v234
M v[176:179],a[208:211],a[204:207],v[176:179]
s_barrier
v_fmac_f32 v237,4.0,v233
M v[180:183],a[208:211],a[232:235],v[180:183]
buffer_load_dwordx4 v[224:227],v250,s[20:23],s46 offen offset:0 sc1
M v[180:183],a[196:199],a[204:207],v[180:183]
ds_read_b128 a[216:219],v248 offset:0
v_fma_f32 v238,-4.0,v234,v236
M v[180:183],v[216:219],a[248:251],v[180:183]
ds_write2st64_b64 v247,v[192:193],v[194:195] offset0:238 offset1:255
M v[184:187],v[216:219],a[204:207],v[184:187]
s_add_u32 s28,s69,786432
ds_read_b128 a[200:203],v249 offset:0
ds_read_b128 a[248:251],v248 offset:512
M v[184:187],a[196:199],a[232:235],v[184:187]
buffer_load_dwordx4 v[192:195],v251,s[88:91],s28 offen offset:0
M v[184:187],a[208:211],a[212:215],v[184:187]
ds_write2st64_b64 v247,v[196:197],v[198:199] offset0:102 offset1:119
M v[188:191],a[208:211],v[228:231],v[188:191]
ds_read_b128 a[204:207],v249 offset:512
v_fmac_f32 v232,s45,v236
M v[188:191],a[196:199],a[212:215],v[188:191]
buffer_load_dwordx4 v[196:199],v245,s[8:11],s28 offen offset:0
M v[188:191],v[216:219],a[232:235],v[188:191]
s_waitcnt lgkmcnt(5)
ds_write2st64_b64 v247,v[200:201],v[202:203] offset0:136 offset1:153
M a[0:3],a[252:255],a[216:219],a[0:3]
s_waitcnt vmcnt(10) lgkmcnt(4)
ds_read_b128 a[208:211],v248 offset:1024
v_fmac_f32 v237,s41,v235
M a[0:3],a[224:227],a[200:203],a[0:3]
s_waitcnt vmcnt(9) lgkmcnt(4)
buffer_load_dwordx4 v[200:203],v245,s[8:11],s28 offen offset:768
M a[0:3],a[220:223],a[248:251],a[0:3]
s_waitcnt lgkmcnt(2)
ds_read_b128 v[228:231],v249 offset:1024
v_sub_f32 v236,v236,v234
M a[4:7],a[220:223],a[204:207],a[4:7]
v_fma_f32 v234,-4.0,v233,v235
v_sub_f32 v235,v235,v233
M a[4:7],a[224:227],a[248:251],a[4:7]
v_add_f32 v233,v238,v234
v_sub_f32 v238,v238,v234
M a[4:7],a[252:255],a[200:203],a[4:7]
v_fma_f32 v234,2.0,v235,v236
v_fmac_f32 v236,-2.0,v235
M a[8:11],a[252:255],a[248:251],a[8:11]
ds_read_b128 a[196:199],v248 offset:1536
v_and_b32 v210,s42,v210
M a[8:11],a[224:227],a[204:207],a[8:11]
s_waitcnt lgkmcnt(2)
ds_read_b128 a[212:215],v249 offset:1536
v_and_b32 v204,s42,v204
M a[8:11],a[220:223],a[208:211],a[8:11]
s_waitcnt lgkmcnt(2)
v_and_b32 v208,s42,v208
v_and_b32 v206,s42,v206
M a[12:15],a[220:223],v[228:231],a[12:15]
v_and_b32 v214,s42,v214
v_and_b32 v212,s42,v212
M a[12:15],a[224:227],a[208:211],a[12:15]
v_fmac_f32 v204,s43,v210
v_fmac_f32 v206,4.0,v208
M a[12:15],a[252:255],a[204:207],a[12:15]
v_fma_f32 v235,-4.0,v210,v214
v_fmac_f32 v204,s45,v214
M a[16:19],a[252:255],a[208:211],a[16:19]
ds_read_b128 a[232:235],v249 offset:2048
v_fmac_f32 v206,s41,v212
M a[16:19],a[224:227],v[228:231],a[16:19]
s_waitcnt lgkmcnt(2)
ds_read_b128 v[216:219],v248 offset:2048
v_sub_f32 v214,v214,v210
M a[16:19],a[220:223],a[196:199],a[16:19]
s_waitcnt lgkmcnt(2)
v_fma_f32 v210,-4.0,v208,v212
v_sub_f32 v212,v212,v208
M a[20:23],a[220:223],a[212:215],a[20:23]
v_add_f32 v208,v235,v210
v_sub_f32 v235,v235,v210
M a[20:23],a[224:227],a[196:199],a[20:23]
v_fma_f32 v210,2.0,v212,v214
v_fmac_f32 v214,-2.0,v212
M a[20:23],a[252:255],v[228:231],a[20:23]
v_cvt_pk_bf16_f32 v204,v232,v204
v_cvt_pk_bf16_f32 v206,v237,v206
M a[24:27],a[252:255],a[196:199],a[24:27]
v_cvt_pk_bf16_f32 v208,v233,v208
v_cvt_pk_bf16_f32 v212,v234,v210
M a[24:27],a[224:227],a[212:215],a[24:27]
s_waitcnt lgkmcnt(1)
v_cvt_pk_bf16_f32 v210,v238,v235
v_cvt_pk_bf16_f32 v214,v236,v214
M a[24:27],a[220:223],a[232:235],a[24:27]
s_waitcnt lgkmcnt(0)
v_permlane32_swap_b32 v209,v211
v_permlane32_swap_b32 v205,v207
M a[28:31],a[220:223],v[216:219],a[28:31]
buffer_load_dwordx4 a[220:223],v250,s[20:23],s46 offen offset:1024 sc1
M a[28:31],a[224:227],a[232:235],a[28:31]
v_permlane32_swap_b32 v213,v215
v_lshlrev_b32 v234,16,v211
M a[28:31],a[252:255],a[212:215],a[28:31]
s_waitcnt vmcnt(10)
buffer_load_dwordx4 a[224:227],v250,s[20:23],s46 offen offset:2048 sc1
M a[32:35],a[228:231],a[216:219],a[32:35]
s_waitcnt vmcnt(10)
s_add_u32 s47,s74,21504
v_lshlrev_b32 v232,16,v205
v_lshlrev_b32 v233,16,v209
M a[32:35],a[244:247],a[200:203],a[32:35]
s_waitcnt vmcnt(9)
v_lshlrev_b32 v237,16,v207
v_lshlrev_b32 v236,16,v215
M a[32:35],a[240:243],a[248:251],a[32:35]
v_lshlrev_b32 v235,16,v213
v_fmac_f32 v232,s43,v234
M a[36:39],a[240:243],a[204:207],a[36:39]
buffer_load_dwordx4 a[252:255],v250,s[20:23],s47 offen offset:0 sc1
M a[36:39],a[244:247],a[248:251],a[36:39]
v_fmac_f32 v237,4.0,v233
v_fma_f32 v238,-4.0,v234,v236
M a[36:39],a[228:231],a[200:203],a[36:39]
v_fmac_f32 v232,s45,v236
v_fmac_f32 v237,s41,v235
M a[40:43],a[228:231],a[248:251],a[40:43]
v_sub_f32 v236,v236,v234
v_fma_f32 v234,-4.0,v233,v235
M a[40:43],a[244:247],a[204:207],a[40:43]
v_sub_f32 v235,v235,v233
v_add_f32 v233,v238,v234
M a[40:43],a[240:243],a[208:211],a[40:43]
v_sub_f32 v238,v238,v234
v_fma_f32 v234,2.0,v235,v236
M a[44:47],a[240:243],v[228:231],a[44:47]
v_fmac_f32 v236,-2.0,v235
v_and_b32 v211,s42,v211
M a[44:47],a[244:247],a[208:211],a[44:47]
v_and_b32 v205,s42,v205
v_and_b32 v209,s42,v209
M a[44:47],a[228:231],a[204:207],a[44:47]
v_and_b32 v207,s42,v207
v_and_b32 v215,s42,v215
M a[48:51],a[228:231],a[208:211],a[48:51]
v_and_b32 v213,s42,v213
v_fmac_f32 v205,s43,v211
M a[48:51],a[244:247],v[228:231],a[48:51]
v_fmac_f32 v207,4.0,v209
v_fma_f32 v235,-4.0,v211,v215
M a[48:51],a[240:243],a[196:199],a[48:51]
v_fmac_f32 v205,s45,v215
v_fmac_f32 v207,s41,v213
M a[52:55],a[240:243],a[212:215],a[52:55]
v_sub_f32 v215,v215,v211
v_fma_f32 v211,-4.0,v209,v213
M a[52:55],a[244:247],a[196:199],a[52:55]
v_sub_f32 v213,v213,v209
v_add_f32 v209,v235,v211
M a[52:55],a[228:231],v[228:231],a[52:55]
v_sub_f32 v235,v235,v211
v_fma_f32 v211,2.0,v213,v215
M a[56:59],a[228:231],a[196:199],a[56:59]
v_fmac_f32 v215,-2.0,v213
v_cvt_pk_bf16_f32 v205,v232,v205
M a[56:59],a[244:247],a[212:215],a[56:59]
v_cvt_pk_bf16_f32 v207,v237,v207
v_cvt_pk_bf16_f32 v209,v233,v209
M a[56:59],a[240:243],a[232:235],a[56:59]
v_cvt_pk_bf16_f32 v213,v234,v211
v_cvt_pk_bf16_f32 v211,v238,v235
M a[60:63],a[240:243],v[216:219],a[60:63]
buffer_load_dwordx4 a[240:243],v250,s[20:23],s47 offen offset:1024 sc1
M a[60:63],a[244:247],a[232:235],a[60:63]
v_cvt_pk_bf16_f32 v215,v236,v215
v_add_u32 v238,121856,v247
M a[60:63],a[228:231],a[212:215],a[60:63]
s_waitcnt vmcnt(10)
buffer_load_dwordx4 a[244:247],v250,s[20:23],s47 offen offset:2048 sc1
M a[64:67],v[220:223],a[216:219],a[64:67]
s_waitcnt vmcnt(10)
s_add_u32 s48,s74,24576
v_fmac_f32 v239,s43,v241
v_fmac_f32 v244,4.0,v240
M a[64:67],a[192:195],a[200:203],a[64:67]
s_waitcnt vmcnt(9)
v_fma_f32 v232,-4.0,v241,v243
v_fmac_f32 v239,s45,v243
M a[64:67],a[236:239],a[248:251],a[64:67]
ds_write2st64_b64 v238,v[204:205],v[206:207] offset0:1 offset1:18
M a[68:71],a[236:239],a[204:207],a[68:71]
s_add_u32 s28,s69,1179648
buffer_load_dwordx4 a[228:231],v250,s[20:23],s48 offen offset:0 sc1
M a[68:71],a[192:195],a[248:251],a[68:71]
v_fmac_f32 v244,s41,v242
v_sub_f32 v243,v243,v241
M a[68:71],v[220:223],a[200:203],a[68:71]
ds_write2st64_b64 v247,v[208:209],v[210:211] offset0:103 offset1:120
M a[72:75],v[220:223],a[248:251],a[72:75]
buffer_load_dwordx4 a[216:219],v250,s[20:23],s48 offen offset:1024 sc1
M a[72:75],a[192:195],a[204:207],a[72:75]
v_fma_f32 v241,-4.0,v240,v242
v_sub_f32 v242,v242,v240
M a[72:75],a[236:239],a[208:211],a[72:75]
ds_write2st64_b64 v247,v[212:213],v[214:215] offset0:137 offset1:154
M a[76:79],a[236:239],v[228:231],a[76:79]
buffer_load_dwordx4 a[200:203],v250,s[20:23],s48 offen offset:2048 sc1
M a[76:79],a[192:195],a[208:211],a[76:79]
s_add_u32 s46,s74,27648
v_add_f32 v240,v232,v241
v_sub_f32 v232,v232,v241
M a[76:79],v[220:223],a[204:207],a[76:79]
v_fma_f32 v241,2.0,v242,v243
v_fmac_f32 v243,-2.0,v242
M a[80:83],v[220:223],a[208:211],a[80:83]
v_cvt_pk_bf16_f32 v233,v239,v244
v_cvt_pk_bf16_f32 v234,v240,v232
M a[80:83],a[192:195],v[228:231],a[80:83]
buffer_load_dwordx4 a[248:251],v250,s[20:23],s46 offen offset:0 sc1
M a[80:83],a[236:239],a[196:199],a[80:83]
v_cvt_pk_bf16_f32 v235,v241,v243
v_add_u32 v232,121856,v252
M a[84:87],a[236:239],a[212:215],a[84:87]
ds_write_b16 v232,v233 offset:0
M a[84:87],a[192:195],a[196:199],a[84:87]
ds_read_b128 a[204:207],v248 offset:8704
ds_write_b16_d16_hi v232,v233 offset:8704
M a[84:87],v[220:223],v[228:231],a[84:87]
buffer_load_dwordx4 v[204:207],v251,s[88:91],s28 offen offset:0
M a[88:91],v[220:223],a[196:199],a[88:91]
ds_read_b128 a[208:211],v249 offset:8704
ds_read_b128 v[228:231],v248 offset:9216
M a[88:91],a[192:195],a[212:215],a[88:91]
ds_read_b128 a[196:199],v249 offset:9216
ds_write_b16 v252,v234 offset:52224
M a[88:91],a[236:239],a[232:235],a[88:91]
ds_write_b16_d16_hi v252,v234 offset:60928
M a[92:95],a[236:239],v[216:219],a[92:95]
buffer_load_dwordx4 v[208:211],v245,s[8:11],s28 offen offset:0
M a[92:95],a[192:195],a[232:235],a[92:95]
v_add_u32 v232,69632,v252
M a[92:95],v[220:223],a[212:215],a[92:95]
s_waitcnt vmcnt(14) lgkmcnt(6)
ds_write_b16 v232,v235 offset:0
M a[96:99],v[224:227],a[204:207],a[96:99]
s_waitcnt vmcnt(10) lgkmcnt(5)
ds_read_b128 a[236:239],v248 offset:9728
ds_write_b16_d16_hi v232,v235 offset:8704
M a[96:99],a[220:223],a[208:211],a[96:99]
s_waitcnt vmcnt(9) lgkmcnt(6)
buffer_load_dwordx4 v[212:215],v245,s[8:11],s28 offen offset:768
M a[96:99],a[224:227],v[228:231],a[96:99]
s_waitcnt lgkmcnt(5)
s_add_u32 s29,s70,0
ds_read_b128 v[216:219],v249 offset:9728
v_permlane32_swap_b32 v196,v198
M a[100:103],a[224:227],a[196:199],a[100:103]
v_permlane32_swap_b32 v192,v194
v_permlane32_swap_b32 v200,v202
M a[100:103],a[220:223],v[228:231],a[100:103]
buffer_load_short_d16_hi v239,v246,s[12:15],s29 offen offset:0
M a[100:103],v[224:227],a[208:211],a[100:103]
v_lshlrev_b32 v234,16,v198
v_lshlrev_b32 v232,16,v192
M a[104:107],v[224:227],v[228:231],a[104:107]
buffer_load_short_d16_hi v240,v246,s[8:11],s29 offen offset:0
M a[104:107],a[220:223],a[196:199],a[104:107]
s_waitcnt lgkmcnt(2)
ds_read_b128 a[192:195],v248 offset:10240
ds_read_b128 a[232:235],v249 offset:10240
M a[104:107],a[224:227],a[236:239],a[104:107]
s_waitcnt lgkmcnt(2)
buffer_load_short_d16_hi v241,v246,s[8:11],s29 offen offset:384
M a[108:111],a[224:227],v[216:219],a[108:111]
v_lshlrev_b32 v233,16,v196
v_lshlrev_b32 v237,16,v194
M a[108:111],a[220:223],a[236:239],a[108:111]
buffer_load_short_d16_hi v242,v246,s[8:11],s29 offen offset:768
M a[108:111],v[224:227],a[196:199],a[108:111]
v_lshlrev_b32 v236,16,v202
v_lshlrev_b32 v235,16,v200
M a[112:115],v[224:227],a[236:239],a[112:115]
buffer_load_short_d16_hi v243,v246,s[8:11],s29 offen offset:1152
M a[112:115],a[220:223],v[216:219],a[112:115]
s_waitcnt lgkmcnt(1)
ds_read_b128 a[212:215],v249 offset:10752
ds_read_b128 v[220:223],v248 offset:10752
M a[112:115],a[224:227],a[192:195],a[112:115]
s_waitcnt lgkmcnt(2)
buffer_load_short_d16_hi v244,v246,s[16:19],s29 offen offset:1536
M a[116:119],a[224:227],a[232:235],a[116:119]
v_fmac_f32 v232,s43,v234
v_fmac_f32 v237,4.0,v233
M a[116:119],a[220:223],a[192:195],a[116:119]
v_fma_f32 v238,-4.0,v234,v236
v_fmac_f32 v232,s45,v236
M a[116:119],v[224:227],v[216:219],a[116:119]
v_fmac_f32 v237,s41,v235
v_sub_f32 v236,v236,v234
M a[120:123],v[224:227],a[192:195],a[120:123]
v_fma_f32 v234,-4.0,v233,v235
v_sub_f32 v235,v235,v233
M a[120:123],a[220:223],a[232:235],a[120:123]
s_waitcnt lgkmcnt(1)
v_add_f32 v233,v238,v234
v_sub_f32 v238,v238,v234
M a[120:123],a[224:227],a[212:215],a[120:123]
s_waitcnt lgkmcnt(0)
v_fma_f32 v234,2.0,v235,v236
v_fmac_f32 v236,-2.0,v235
M a[124:127],a[224:227],v[220:223],a[124:127]
buffer_load_dwordx4 a[224:227],v250,s[20:23],s46 offen offset:1024 sc1
M a[124:127],a[220:223],a[212:215],a[124:127]
v_and_b32 v198,s42,v198
v_and_b32 v192,s42,v192
M a[124:127],v[224:227],a[232:235],a[124:127]
s_waitcnt vmcnt(16)
buffer_load_dwordx4 a[220:223],v250,s[20:23],s46 offen offset:2048 sc1
M a[128:131],a[252:255],a[204:207],a[128:131]
s_waitcnt vmcnt(16)
s_add_u32 s47,s74,30720
v_and_b32 v196,s42,v196
v_and_b32 v194,s42,v194
M a[128:131],a[240:243],a[208:211],a[128:131]
s_waitcnt vmcnt(15)
v_and_b32 v202,s42,v202
v_and_b32 v200,s42,v200
M a[128:131],a[244:247],v[228:231],a[128:131]
v_fmac_f32 v192,s43,v198
v_fmac_f32 v194,4.0,v196
M a[132:135],a[244:247],a[196:199],a[132:135]
buffer_load_dwordx4 v[224:227],v250,s[20:23],s47 offen offset:0 sc1
M a[132:135],a[240:243],v[228:231],a[132:135]
v_fma_f32 v235,-4.0,v198,v202
v_fmac_f32 v192,s45,v202
M a[132:135],a[252:255],a[208:211],a[132:135]
v_fmac_f32 v194,s41,v200
v_sub_f32 v202,v202,v198
M a[136:139],a[252:255],v[228:231],a[136:139]
v_fma_f32 v198,-4.0,v196,v200
v_sub_f32 v200,v200,v196
M a[136:139],a[240:243],a[196:199],a[136:139]
v_add_f32 v196,v235,v198
v_sub_f32 v235,v235,v198
M a[136:139],a[244:247],a[236:239],a[136:139]
v_fma_f32 v198,2.0,v200,v202
v_fmac_f32 v202,-2.0,v200
M a[140:143],a[244:247],v[216:219],a[140:143]
v_cvt_pk_bf16_f32 v192,v232,v192
v_cvt_pk_bf16_f32 v194,v237,v194
M a[140:143],a[240:243],a[236:239],a[140:143]
v_cvt_pk_bf16_f32 v196,v233,v196
v_cvt_pk_bf16_f32 v200,v234,v198
M a[140:143],a[252:255],a[196:199],a[140:143]
v_cvt_pk_bf16_f32 v198,v238,v235
v_cvt_pk_bf16_f32 v202,v236,v202
M a[144:147],a[252:255],a[236:239],a[144:147]
v_permlane32_swap_b32 v197,v199
v_permlane32_swap_b32 v193,v195
M a[144:147],a[240:243],v[216:219],a[144:147]
v_permlane32_swap_b32 v201,v203
v_lshlrev_b32 v234,16,v199
M a[144:147],a[244:247],a[192:195],a[144:147]
v_lshlrev_b32 v232,16,v193
v_lshlrev_b32 v233,16,v197
M a[148:151],a[244:247],a[232:235],a[148:151]
v_lshlrev_b32 v237,16,v195
v_lshlrev_b32 v236,16,v203
M a[148:151],a[240:243],a[192:195],a[148:151]
v_lshlrev_b32 v235,16,v201
v_fmac_f32 v232,s43,v234
M a[148:151],a[252:255],v[216:219],a[148:151]
v_fmac_f32 v237,4.0,v233
v_fma_f32 v238,-4.0,v234,v236
M a[152:155],a[252:255],a[192:195],a[152:155]
v_fmac_f32 v232,s45,v236
v_fmac_f32 v237,s41,v235
M a[152:155],a[240:243],a[232:235],a[152:155]
v_sub_f32 v236,v236,v234
v_fma_f32 v234,-4.0,v233,v235
M a[152:155],a[244:247],a[212:215],a[152:155]
v_sub_f32 v235,v235,v233
v_add_f32 v233,v238,v234
M a[156:159],a[244:247],v[220:223],a[156:159]
buffer_load_dwordx4 a[244:247],v250,s[20:23],s47 offen offset:1024 sc1
M a[156:159],a[240:243],a[212:215],a[156:159]
v_sub_f32 v238,v238,v234
v_fma_f32 v234,2.0,v235,v236
M a[156:159],a[252:255],a[232:235],a[156:159]
s_waitcnt vmcnt(16)
buffer_load_dwordx4 a[240:243],v250,s[20:23],s47 offen offset:2048 sc1
M a[160:163],a[228:231],a[204:207],a[160:163]
s_waitcnt vmcnt(16)
s_add_u32 s48,s74,33792
v_fmac_f32 v236,-2.0,v235
v_and_b32 v199,s42,v199
M a[160:163],a[216:219],a[208:211],a[160:163]
s_waitcnt vmcnt(15)
v_and_b32 v193,s42,v193
v_and_b32 v197,s42,v197
M a[160:163],a[200:203],v[228:231],a[160:163]
v_and_b32 v195,s42,v195
v_and_b32 v203,s42,v203
M a[164:167],a[200:203],a[196:199],a[164:167]
buffer_load_dwordx4 a[252:255],v250,s[20:23],s48 offen offset:0 sc1
M a[164:167],a[216:219],v[228:231],a[164:167]
v_and_b32 v201,s42,v201
v_fmac_f32 v193,s43,v199
M a[164:167],a[228:231],a[208:211],a[164:167]
v_fmac_f32 v195,4.0,v197
v_fma_f32 v235,-4.0,v199,v203
M a[168:171],a[228:231],v[228:231],a[168:171]
v_fmac_f32 v193,s45,v203
v_fmac_f32 v195,s41,v201
M a[168:171],a[216:219],a[196:199],a[168:171]
buffer_load_dwordx4 a[204:207],v250,s[20:23],s48 offen offset:1024 sc1
M a[168:171],a[200:203],a[236:239],a[168:171]
v_sub_f32 v203,v203,v199
v_fma_f32 v199,-4.0,v197,v201
M a[172:175],a[200:203],v[216:219],a[172:175]
v_sub_f32 v201,v201,v197
v_add_f32 v197,v235,v199
M a[172:175],a[216:219],a[236:239],a[172:175]
v_sub_f32 v235,v235,v199
v_fma_f32 v199,2.0,v201,v203
M a[172:175],a[228:231],a[196:199],a[172:175]
buffer_load_dwordx4 a[208:211],v250,s[20:23],s48 offen offset:2048 sc1
M a[176:179],a[228:231],a[236:239],a[176:179]
s_add_u32 s46,s74,36864
v_fmac_f32 v203,-2.0,v201
v_cvt_pk_bf16_f32 v193,v232,v193
M a[176:179],a[216:219],v[216:219],a[176:179]
v_cvt_pk_bf16_f32 v195,v237,v195
v_cvt_pk_bf16_f32 v197,v233,v197
M a[176:179],a[200:203],a[192:195],a[176:179]
v_cvt_pk_bf16_f32 v201,v234,v199
v_cvt_pk_bf16_f32 v199,v238,v235
M a[180:183],a[200:203],a[232:235],a[180:183]
buffer_load_dwordx4 v[228:231],v250,s[20:23],s46 offen offset:0 sc1
M a[180:183],a[216:219],a[192:195],a[180:183]
ds_read_b128 a[196:199],v248 offset:17408
v_cvt_pk_bf16_f32 v203,v236,v203
M a[180:183],a[228:231],v[216:219],a[180:183]
ds_read_b128 a[236:239],v249 offset:17408
v_add_u32 v238,121856,v247
M a[184:187],a[228:231],a[192:195],a[184:187]
s_waitcnt vmcnt(16)
ds_read_b128 v[216:219],v248 offset:17920
v_permlane32_swap_b32 v208,v210
M a[184:187],a[216:219],a[232:235],a[184:187]
ds_read_b128 a[192:195],v249 offset:17920
v_permlane32_swap_b32 v204,v206
M a[184:187],a[200:203],a[212:215],a[184:187]
ds_write2st64_b64 v238,v[192:193],v[194:195] offset0:2 offset1:19
M a[188:191],a[200:203],v[220:223],a[188:191]
s_waitcnt vmcnt(15)
s_add_u32 s28,s70,0
s_mov_b64 exec,s[86:87]
v_xor_b32 v245,0x80000000,v245
v_xor_b32 v251,0x80000000,v251
s_mov_b64 exec,-1
v_permlane32_swap_b32 v212,v214
M a[188:191],a[216:219],a[212:215],a[188:191]
buffer_load_dwordx4 v[192:195],v251,s[88:91],s28 offen offset:0
M a[188:191],a[228:231],a[232:235],a[188:191]
s_waitcnt lgkmcnt(4)
ds_write2st64_b64 v247,v[196:197],v[198:199] offset0:104 offset1:121
M v[0:3],a[248:251],a[196:199],v[0:3]
s_waitcnt vmcnt(9) lgkmcnt(4)
buffer_load_dwordx4 v[196:199],v245,s[8:11],s28 offen offset:0
M v[0:3],a[224:227],a[236:239],v[0:3]
s_waitcnt vmcnt(9) lgkmcnt(3)
ds_read_b128 a[200:203],v248 offset:18432
ds_read_b128 v[220:223],v249 offset:18432
M v[0:3],a[220:223],v[216:219],v[0:3]
s_waitcnt lgkmcnt(4)
ds_write2st64_b64 v247,v[200:201],v[202:203] offset0:138 offset1:155
M v[4:7],a[220:223],a[192:195],v[4:7]
buffer_load_dwordx4 v[200:203],v245,s[8:11],s28 offen offset:768
M v[4:7],a[224:227],v[216:219],v[4:7]
s_mov_b64 exec,s[86:87]
v_xor_b32 v245,0x80000000,v245
v_xor_b32 v251,0x80000000,v251
s_mov_b64 exec,-1
v_lshlrev_b32 v234,16,v210
M v[4:7],a[248:251],a[236:239],v[4:7]
v_lshlrev_b32 v232,16,v204
v_lshlrev_b32 v233,16,v208
M v[8:11],a[248:251],v[216:219],v[8:11]
ds_read_b128 a[212:215],v248 offset:18944
v_lshlrev_b32 v237,16,v206
M v[8:11],a[224:227],a[192:195],v[8:11]
s_waitcnt lgkmcnt(3)
ds_read_b128 a[216:219],v249 offset:18944
v_lshlrev_b32 v236,16,v214
M v[8:11],a[220:223],a[200:203],v[8:11]
s_waitcnt lgkmcnt(3)
v_lshlrev_b32 v235,16,v212
v_fmac_f32 v232,s43,v234
M v[12:15],a[220:223],v[220:223],v[12:15]
v_fmac_f32 v237,4.0,v233
v_fma_f32 v238,-4.0,v234,v236
M v[12:15],a[224:227],a[200:203],v[12:15]
v_fmac_f32 v232,s45,v236
v_fmac_f32 v237,s41,v235
M v[12:15],a[248:251],a[192:195],v[12:15]
v_sub_f32 v236,v236,v234
v_fma_f32 v234,-4.0,v233,v235
M v[16:19],a[248:251],a[200:203],v[16:19]
ds_read_b128 a[228:231],v249 offset:19456
v_sub_f32 v235,v235,v233
M v[16:19],a[224:227],v[220:223],v[16:19]
s_waitcnt lgkmcnt(2)
ds_read_b128 a[232:235],v248 offset:19456
v_add_f32 v233,v238,v234
M v[16:19],a[220:223],a[212:215],v[16:19]
s_waitcnt lgkmcnt(2)
v_sub_f32 v238,v238,v234
v_fma_f32 v234,2.0,v235,v236
M v[20:23],a[220:223],a[216:219],v[20:23]
v_fmac_f32 v236,-2.0,v235
v_and_b32 v210,s42,v210
M v[20:23],a[224:227],a[212:215],v[20:23]
v_and_b32 v204,s42,v204
v_and_b32 v208,s42,v208
M v[20:23],a[248:251],v[220:223],v[20:23]
v_and_b32 v206,s42,v206
v_and_b32 v214,s42,v214
M v[24:27],a[248:251],a[212:215],v[24:27]
v_and_b32 v212,s42,v212
v_fmac_f32 v204,s43,v210
M v[24:27],a[224:227],a[216:219],v[24:27]
s_waitcnt lgkmcnt(1)
v_fmac_f32 v206,4.0,v208
v_fma_f32 v235,-4.0,v210,v214
M v[24:27],a[220:223],a[228:231],v[24:27]
s_waitcnt lgkmcnt(0)
v_fmac_f32 v204,s45,v214
v_fmac_f32 v206,s41,v212
M v[28:31],a[220:223],a[232:235],v[28:31]
buffer_load_dwordx4 a[220:223],v250,s[20:23],s46 offen offset:1024 sc1
M v[28:31],a[224:227],a[228:231],v[28:31]
v_sub_f32 v214,v214,v210
v_fma_f32 v210,-4.0,v208,v212
M v[28:31],a[248:251],a[216:219],v[28:31]
s_waitcnt vmcnt(10)
buffer_load_dwordx4 a[224:227],v250,s[20:23],s46 offen offset:2048 sc1
M v[32:35],v[224:227],a[196:199],v[32:35]
s_waitcnt vmcnt(10)
s_add_u32 s47,s74,39936
v_sub_f32 v212,v212,v208
v_add_f32 v208,v235,v210
M v[32:35],a[244:247],a[236:239],v[32:35]
s_waitcnt vmcnt(9)
v_sub_f32 v235,v235,v210
v_fma_f32 v210,2.0,v212,v214
M v[32:35],a[240:243],v[216:219],v[32:35]
v_fmac_f32 v214,-2.0,v212
v_cvt_pk_bf16_f32 v204,v232,v204
M v[36:39],a[240:243],a[192:195],v[36:39]
buffer_load_dwordx4 a[248:251],v250,s[20:23],s47 offen offset:0 sc1
M v[36:39],a[244:247],v[216:219],v[36:39]
v_cvt_pk_bf16_f32 v206,v237,v206
v_cvt_pk_bf16_f32 v208,v233,v208
M v[36:39],v[224:227],a[236:239],v[36:39]
v_cvt_pk_bf16_f32 v212,v234,v210
v_cvt_pk_bf16_f32 v210,v238,v235
M v[40:43],v[224:227],v[216:219],v[40:43]
v_cvt_pk_bf16_f32 v214,v236,v214
v_permlane32_swap_b32 v209,v211
M v[40:43],a[244:247],a[192:195],v[40:43]
v_permlane32_swap_b32 v205,v207
v_permlane32_swap_b32 v213,v215
M v[40:43],a[240:243],a[200:203],v[40:43]
v_lshlrev_b32 v234,16,v211
v_lshlrev_b32 v232,16,v205
M v[44:47],a[240:243],v[220:223],v[44:47]
v_lshlrev_b32 v233,16,v209
v_lshlrev_b32 v237,16,v207
M v[44:47],a[244:247],a[200:203],v[44:47]
v_lshlrev_b32 v236,16,v215
v_lshlrev_b32 v235,16,v213
M v[44:47],v[224:227],a[192:195],v[44:47]
v_fmac_f32 v232,s43,v234
v_fmac_f32 v237,4.0,v233
M v[48:51],v[224:227],a[200:203],v[48:51]
v_fma_f32 v238,-4.0,v234,v236
v_fmac_f32 v232,s45,v236
M v[48:51],a[244:247],v[220:223],v[48:51]
v_fmac_f32 v237,s41,v235
v_sub_f32 v236,v236,v234
M v[48:51],a[240:243],a[212:215],v[48:51]
v_fma_f32 v234,-4.0,v233,v235
v_sub_f32 v235,v235,v233
M v[52:55],a[240:243],a[216:219],v[52:55]
v_add_f32 v233,v238,v234
v_sub_f32 v238,v238,v234
M v[52:55],a[244:247],a[212:215],v[52:55]
v_fma_f32 v234,2.0,v235,v236
v_fmac_f32 v236,-2.0,v235
M v[52:55],v[224:227],v[220:223],v[52:55]
v_and_b32 v211,s42,v211
v_and_b32 v205,s42,v205
M v[56:59],v[224:227],a[212:215],v[56:59]
v_and_b32 v209,s42,v209
v_and_b32 v207,s42,v207
M v[56:59],a[244:247],a[216:219],v[56:59]
v_and_b32 v215,s42,v215
v_and_b32 v213,s42,v213
M v[56:59],a[240:243],a[228:231],v[56:59]
v_fmac_f32 v205,s43,v211
v_fmac_f32 v207,4.0,v209
M v[60:63],a[240:243],a[232:235],v[60:63]
buffer_load_dwordx4 a[240:243],v250,s[20:23],s47 offen offset:1024 sc1
M v[60:63],a[244:247],a[228:231],v[60:63]
v_fma_f32 v235,-4.0,v211,v215
v_fmac_f32 v205,s45,v215
M v[60:63],v[224:227],a[216:219],v[60:63]
s_waitcnt vmcnt(10)
buffer_load_dwordx4 a[244:247],v250,s[20:23],s47 offen offset:2048 sc1
M v[64:67],a[252:255],a[196:199],v[64:67]
s_waitcnt vmcnt(10)
s_add_u32 s48,s74,43008
v_fmac_f32 v207,s41,v213
v_sub_f32 v215,v215,v211
M v[64:67],a[204:207],a[236:239],v[64:67]
s_waitcnt vmcnt(9)
v_fma_f32 v211,-4.0,v209,v213
v_sub_f32 v213,v213,v209
M v[64:67],a[208:211],v[216:219],v[64:67]
v_add_f32 v209,v235,v211
v_sub_f32 v235,v235,v211
M v[68:71],a[208:211],a[192:195],v[68:71]
buffer_load_dwordx4 v[224:227],v250,s[20:23],s48 offen offset:0 sc1
M v[68:71],a[204:207],v[216:219],v[68:71]
v_fma_f32 v211,2.0,v213,v215
v_fmac_f32 v215,-2.0,v213
M v[68:71],a[252:255],a[236:239],v[68:71]
v_cvt_pk_bf16_f32 v205,v232,v205
v_cvt_pk_bf16_f32 v207,v237,v207
M v[72:75],a[252:255],v[216:219],v[72:75]
v_cvt_pk_bf16_f32 v209,v233,v209
v_cvt_pk_bf16_f32 v213,v234,v211
M v[72:75],a[204:207],a[192:195],v[72:75]
buffer_load_dwordx4 a[196:199],v250,s[20:23],s48 offen offset:1024 sc1
M v[72:75],a[208:211],a[200:203],v[72:75]
v_cvt_pk_bf16_f32 v211,v238,v235
v_cvt_pk_bf16_f32 v215,v236,v215
M v[76:79],a[208:211],v[220:223],v[76:79]
v_add_u32 v238,121856,v247
M v[76:79],a[204:207],a[200:203],v[76:79]
M v[76:79],a[252:255],a[192:195],v[76:79]
buffer_load_dwordx4 a[236:239],v250,s[20:23],s48 offen offset:2048 sc1
M v[80:83],a[252:255],a[200:203],v[80:83]
s_add_u32 s46,s75,9216
M v[80:83],a[204:207],v[220:223],v[80:83]
M v[80:83],a[208:211],a[212:215],v[80:83]
ds_write2st64_b64 v238,v[204:205],v[206:207] offset0:3 offset1:20
M v[84:87],a[208:211],a[216:219],v[84:87]
s_add_u32 s28,s70,393216
buffer_load_dwordx4 v[216:219],v250,s[20:23],s46 offen offset:0 sc1
M v[84:87],a[204:207],a[212:215],v[84:87]
s_waitcnt vmcnt(10)
ds_read_b128 a[192:195],v248 offset:26112
v_permlane32_swap_b32 v196,v198
M v[84:87],a[252:255],v[220:223],v[84:87]
ds_write2st64_b64 v247,v[208:209],v[210:211] offset0:105 offset1:122
M v[88:91],a[252:255],a[212:215],v[88:91]
buffer_load_dwordx4 v[204:207],v251,s[88:91],s28 offen offset:0
M v[88:91],a[204:207],a[216:219],v[88:91]
ds_read_b128 a[200:203],v249 offset:26112
ds_read_b128 v[220:223],v248 offset:26624
M v[88:91],a[208:211],a[228:231],v[88:91]
ds_write2st64_b64 v247,v[212:213],v[214:215] offset0:139 offset1:156
M v[92:95],a[208:211],a[232:235],v[92:95]
buffer_load_dwordx4 v[208:211],v245,s[8:11],s28 offen offset:0
M v[92:95],a[204:207],a[228:231],v[92:95]
ds_read_b128 a[212:215],v249 offset:26624
v_permlane32_swap_b32 v192,v194
M v[92:95],a[252:255],a[216:219],v[92:95]
s_waitcnt vmcnt(11) lgkmcnt(5)
v_permlane32_swap_b32 v200,v202
v_lshlrev_b32 v234,16,v198
M v[96:99],v[228:231],a[192:195],v[96:99]
s_waitcnt vmcnt(10) lgkmcnt(3)
ds_read_b128 a[208:211],v248 offset:27136
v_lshlrev_b32 v232,16,v192
M v[96:99],a[220:223],a[200:203],v[96:99]
s_waitcnt vmcnt(9) lgkmcnt(3)
buffer_load_dwordx4 v[212:215],v245,s[8:11],s28 offen offset:768
M v[96:99],a[224:227],v[220:223],v[96:99]
s_waitcnt lgkmcnt(1)
ds_read_b128 a[232:235],v249 offset:27136
v_lshlrev_b32 v233,16,v196
M v[100:103],a[224:227],a[212:215],v[100:103]
v_lshlrev_b32 v237,16,v194
v_lshlrev_b32 v236,16,v202
M v[100:103],a[220:223],v[220:223],v[100:103]
v_lshlrev_b32 v235,16,v200
v_fmac_f32 v232,s43,v234
M v[100:103],v[228:231],a[200:203],v[100:103]
v_fmac_f32 v237,4.0,v233
v_fma_f32 v238,-4.0,v234,v236
M v[104:107],v[228:231],v[220:223],v[104:107]
ds_read_b128 a[204:207],v248 offset:27648
v_fmac_f32 v232,s45,v236
M v[104:107],a[220:223],a[212:215],v[104:107]
s_waitcnt lgkmcnt(2)
ds_read_b128 a[228:231],v249 offset:27648
v_fmac_f32 v237,s41,v235
M v[104:107],a[224:227],a[208:211],v[104:107]
s_waitcnt lgkmcnt(2)
v_sub_f32 v236,v236,v234
v_fma_f32 v234,-4.0,v233,v235
M v[108:111],a[224:227],a[232:235],v[108:111]
v_sub_f32 v235,v235,v233
v_add_f32 v233,v238,v234
M v[108:111],a[220:223],a[208:211],v[108:111]
v_sub_f32 v238,v238,v234
v_fma_f32 v234,2.0,v235,v236
M v[108:111],v[228:231],a[212:215],v[108:111]
v_fmac_f32 v236,-2.0,v235
v_and_b32 v198,s42,v198
M v[112:115],v[228:231],a[208:211],v[112:115]
ds_read_b128 a[216:219],v249 offset:28160
v_and_b32 v192,s42,v192
M v[112:115],a[220:223],a[232:235],v[112:115]
s_waitcnt lgkmcnt(2)
ds_read_b128 a[252:255],v248 offset:28160
v_and_b32 v196,s42,v196
M v[112:115],a[224:227],a[204:207],v[112:115]
s_waitcnt lgkmcnt(2)
v_and_b32 v194,s42,v194
v_and_b32 v202,s42,v202
M v[116:119],a[224:227],a[228:231],v[116:119]
v_and_b32 v200,s42,v200
v_fmac_f32 v192,s43,v198
M v[116:119],a[220:223],a[204:207],v[116:119]
v_fmac_f32 v194,4.0,v196
v_fma_f32 v235,-4.0,v198,v202
M v[116:119],v[228:231],a[232:235],v[116:119]
v_fmac_f32 v192,s45,v202
v_fmac_f32 v194,s41,v200
M v[120:123],v[228:231],a[204:207],v[120:123]
v_sub_f32 v202,v202,v198
v_fma_f32 v198,-4.0,v196,v200
M v[120:123],a[220:223],a[228:231],v[120:123]
s_waitcnt lgkmcnt(1)
v_sub_f32 v200,v200,v196
v_add_f32 v196,v235,v198
M v[120:123],a[224:227],a[216:219],v[120:123]
s_waitcnt lgkmcnt(0)
v_sub_f32 v235,v235,v198
v_fma_f32 v198,2.0,v200,v202
M v[124:127],a[224:227],a[252:255],v[124:127]
buffer_load_dwordx4 a[224:227],v250,s[20:23],s46 offen offset:1024 sc1
M v[124:127],a[220:223],a[216:219],v[124:127]
v_fmac_f32 v202,-2.0,v200
v_cvt_pk_bf16_f32 v192,v232,v192
M v[124:127],v[228:231],a[228:231],v[124:127]
s_waitcnt vmcnt(10)
buffer_load_dwordx4 a[220:223],v250,s[20:23],s46 offen offset:2048 sc1
M v[128:131],a[248:251],a[192:195],v[128:131]
s_waitcnt vmcnt(10)
s_add_u32 s47,s75,12288
v_cvt_pk_bf16_f32 v194,v237,v194
v_cvt_pk_bf16_f32 v196,v233,v196
M v[128:131],a[240:243],a[200:203],v[128:131]
s_waitcnt vmcnt(9)
v_cvt_pk_bf16_f32 v200,v234,v198
v_cvt_pk_bf16_f32 v198,v238,v235
M v[128:131],a[244:247],v[220:223],v[128:131]
v_cvt_pk_bf16_f32 v202,v236,v202
v_permlane32_swap_b32 v197,v199
M v[132:135],a[244:247],a[212:215],v[132:135]
buffer_load_dwordx4 v[228:231],v250,s[20:23],s47 offen offset:0 sc1
M v[132:135],a[240:243],v[220:223],v[132:135]
v_permlane32_swap_b32 v193,v195
v_permlane32_swap_b32 v201,v203
M v[132:135],a[248:251],a[200:203],v[132:135]
v_lshlrev_b32 v234,16,v199
v_lshlrev_b32 v232,16,v193
M v[136:139],a[248:251],v[220:223],v[136:139]
v_lshlrev_b32 v233,16,v197
v_lshlrev_b32 v237,16,v195
M v[136:139],a[240:243],a[212:215],v[136:139]
v_lshlrev_b32 v236,16,v203
v_lshlrev_b32 v235,16,v201
M v[136:139],a[244:247],a[208:211],v[136:139]
v_fmac_f32 v232,s43,v234
v_fmac_f32 v237,4.0,v233
M v[140:143],a[244:247],a[232:235],v[140:143]
v_fma_f32 v238,-4.0,v234,v236
v_fmac_f32 v232,s45,v236
M v[140:143],a[240:243],a[208:211],v[140:143]
v_fmac_f32 v237,s41,v235
v_sub_f32 v236,v236,v234
M v[140:143],a[248:251],a[212:215],v[140:143]
v_fma_f32 v234,-4.0,v233,v235
v_sub_f32 v235,v235,v233
M v[144:147],a[248:251],a[208:211],v[144:147]
v_add_f32 v233,v238,v234
v_sub_f32 v238,v238,v234
M v[144:147],a[240:243],a[232:235],v[144:147]
v_fma_f32 v234,2.0,v235,v236
v_fmac_f32 v236,-2.0,v235
M v[144:147],a[244:247],a[204:207],v[144:147]
v_and_b32 v199,s42,v199
v_and_b32 v193,s42,v193
M v[148:151],a[244:247],a[228:231],v[148:151]
v_and_b32 v197,s42,v197
v_and_b32 v195,s42,v195
M v[148:151],a[240:243],a[204:207],v[148:151]
v_and_b32 v203,s42,v203
v_and_b32 v201,s42,v201
M v[148:151],a[248:251],a[232:235],v[148:151]
v_fmac_f32 v193,s43,v199
v_fmac_f32 v195,4.0,v197
M v[152:155],a[248:251],a[204:207],v[152:155]
v_fma_f32 v235,-4.0,v199,v203
v_fmac_f32 v193,s45,v203
M v[152:155],a[240:243],a[228:231],v[152:155]
v_fmac_f32 v195,s41,v201
v_sub_f32 v203,v203,v199
M v[152:155],a[244:247],a[216:219],v[152:155]
v_fma_f32 v199,-4.0,v197,v201
v_sub_f32 v201,v201,v197
M v[156:159],a[244:247],a[252:255],v[156:159]
buffer_load_dwordx4 a[244:247],v250,s[20:23],s47 offen offset:1024 sc1
M v[156:159],a[240:243],a[216:219],v[156:159]
v_add_f32 v197,v235,v199
v_sub_f32 v235,v235,v199
M v[156:159],a[248:251],a[228:231],v[156:159]
s_waitcnt vmcnt(10)
buffer_load_dwordx4 a[240:243],v250,s[20:23],s47 offen offset:2048 sc1
M v[160:163],v[224:227],a[192:195],v[160:163]
s_waitcnt vmcnt(10)
s_add_u32 s48,s75,15360
v_fma_f32 v199,2.0,v201,v203
v_fmac_f32 v203,-2.0,v201
M v[160:163],a[196:199],a[200:203],v[160:163]
s_waitcnt vmcnt(9)
v_cvt_pk_bf16_f32 v193,v232,v193
v_cvt_pk_bf16_f32 v195,v237,v195
M v[160:163],a[236:239],v[220:223],v[160:163]
v_cvt_pk_bf16_f32 v197,v233,v197
v_cvt_pk_bf16_f32 v201,v234,v199
M v[164:167],a[236:239],a[212:215],v[164:167]
buffer_load_dwordx4 a[248:251],v250,s[20:23],s48 offen offset:0 sc1
M v[164:167],a[196:199],v[220:223],v[164:167]
v_cvt_pk_bf16_f32 v199,v238,v235
v_cvt_pk_bf16_f32 v203,v236,v203
M v[164:167],v[224:227],a[200:203],v[164:167]
v_add_u32 v238,139264,v247
M v[168:171],v[224:227],v[220:223],v[168:171]
M v[168:171],a[196:199],a[212:215],v[168:171]
buffer_load_dwordx4 a[192:195],v250,s[20:23],s48 offen offset:1024 sc1
M v[168:171],a[236:239],a[208:211],v[168:171]
M v[172:175],a[236:239],a[232:235],v[172:175]
M v[172:175],a[196:199],a[208:211],v[172:175]
M v[172:175],v[224:227],a[212:215],v[172:175]
buffer_load_dwordx4 a[200:203],v250,s[20:23],s48 offen offset:2048 sc1
M v[176:179],v[224:227],a[208:211],v[176:179]
s_add_u32 s46,s75,18432
M v[176:179],a[196:199],a[232:235],v[176:179]
s_waitcnt vmcnt(9)
v_permlane32_swap_b32 v208,v210
v_permlane32_swap_b32 v204,v206
M v[176:179],a[236:239],a[204:207],v[176:179]
s_waitcnt vmcnt(8)
s_barrier
v_permlane32_swap_b32 v212,v214
M v[180:183],a[236:239],a[228:231],v[180:183]
buffer_load_dwordx4 v[220:223],v250,s[20:23],s46 offen offset:0 sc1
M v[180:183],a[196:199],a[204:207],v[180:183]
ds_read_b128 a[212:215],v248 offset:34816
v_lshlrev_b32 v234,16,v210
M v[180:183],v[224:227],a[232:235],v[180:183]
ds_write2st64_b64 v238,v[192:193],v[194:195] offset0:0 offset1:17
M v[184:187],v[224:227],a[204:207],v[184:187]
s_add_u32 s28,s70,786432
ds_read_b128 a[208:211],v249 offset:34816
ds_read_b128 a[232:235],v248 offset:35328
M v[184:187],a[196:199],a[228:231],v[184:187]
buffer_load_dwordx4 v[192:195],v251,s[88:91],s28 offen offset:0
M v[184:187],a[236:239],a[216:219],v[184:187]
ds_write2st64_b64 v247,v[196:197],v[198:199] offset0:34 offset1:51
M v[188:191],a[236:239],a[252:255],v[188:191]
ds_read_b128 a[204:207],v249 offset:35328
v_lshlrev_b32 v232,16,v204
M v[188:191],a[196:199],a[216:219],v[188:191]
buffer_load_dwordx4 v[196:199],v245,s[8:11],s28 offen offset:0
M v[188:191],v[224:227],a[228:231],v[188:191]
s_waitcnt lgkmcnt(5)
ds_write2st64_b64 v247,v[200:201],v[202:203] offset0:68 offset1:85
M a[0:3],v[216:219],a[212:215],a[0:3]
s_waitcnt vmcnt(10) lgkmcnt(4)
ds_read_b128 a[236:239],v248 offset:35840
v_lshlrev_b32 v233,16,v208
M a[0:3],a[224:227],a[208:211],a[0:3]
s_waitcnt vmcnt(9) lgkmcnt(4)
buffer_load_dwordx4 v[200:203],v245,s[8:11],s28 offen offset:768
M a[0:3],a[220:223],a[232:235],a[0:3]
s_waitcnt lgkmcnt(2)
ds_read_b128 a[252:255],v249 offset:35840
v_lshlrev_b32 v237,16,v206
M a[4:7],a[220:223],a[204:207],a[4:7]
v_lshlrev_b32 v236,16,v214
v_lshlrev_b32 v235,16,v212
M a[4:7],a[224:227],a[232:235],a[4:7]
v_fmac_f32 v232,s43,v234
v_fmac_f32 v237,4.0,v233
M a[4:7],v[216:219],a[208:211],a[4:7]
v_fma_f32 v238,-4.0,v234,v236
v_fmac_f32 v232,s45,v236
M a[8:11],v[216:219],a[232:235],a[8:11]
ds_read_b128 a[196:199],v248 offset:36352
v_fmac_f32 v237,s41,v235
M a[8:11],a[224:227],a[204:207],a[8:11]
s_waitcnt lgkmcnt(2)
ds_read_b128 a[216:219],v249 offset:36352
v_sub_f32 v236,v236,v234
M a[8:11],a[220:223],a[236:239],a[8:11]
s_waitcnt lgkmcnt(2)
v_fma_f32 v234,-4.0,v233,v235
v_sub_f32 v235,v235,v233
M a[12:15],a[220:223],a[252:255],a[12:15]
v_add_f32 v233,v238,v234
v_sub_f32 v238,v238,v234
M a[12:15],a[224:227],a[236:239],a[12:15]
v_fma_f32 v234,2.0,v235,v236
v_fmac_f32 v236,-2.0,v235
M a[12:15],v[216:219],a[204:207],a[12:15]
v_and_b32 v210,s42,v210
v_and_b32 v204,s42,v204
M a[16:19],v[216:219],a[236:239],a[16:19]
ds_read_b128 a[228:231],v249 offset:36864
v_and_b32 v208,s42,v208
M a[16:19],a[224:227],a[252:255],a[16:19]
s_waitcnt lgkmcnt(2)
ds_read_b128 v[224:227],v248 offset:36864
v_and_b32 v206,s42,v206
M a[16:19],a[220:223],a[196:199],a[16:19]
s_waitcnt lgkmcnt(2)
v_and_b32 v214,s42,v214
v_and_b32 v212,s42,v212
M a[20:23],a[220:223],a[216:219],a[20:23]
v_fmac_f32 v204,s43,v210
v_fmac_f32 v206,4.0,v208
M a[20:23],a[224:227],a[196:199],a[20:23]
v_fma_f32 v235,-4.0,v210,v214
v_fmac_f32 v204,s45,v214
M a[20:23],v[216:219],a[252:255],a[20:23]
v_fmac_f32 v206,s41,v212
v_sub_f32 v214,v214,v210
M a[24:27],v[216:219],a[196:199],a[24:27]
v_fma_f32 v210,-4.0,v208,v212
v_sub_f32 v212,v212,v208
M a[24:27],a[224:227],a[216:219],a[24:27]
s_waitcnt lgkmcnt(1)
v_add_f32 v208,v235,v210
v_sub_f32 v235,v235,v210
M a[24:27],a[220:223],a[228:231],a[24:27]
s_waitcnt lgkmcnt(0)
v_fma_f32 v210,2.0,v212,v214
v_fmac_f32 v214,-2.0,v212
M a[28:31],a[220:223],v[224:227],a[28:31]
buffer_load_dwordx4 a[220:223],v250,s[20:23],s46 offen offset:1024 sc1
M a[28:31],a[224:227],a[228:231],a[28:31]
v_cvt_pk_bf16_f32 v204,v232,v204
v_cvt_pk_bf16_f32 v206,v237,v206
M a[28:31],v[216:219],a[216:219],a[28:31]
s_waitcnt vmcnt(10)
buffer_load_dwordx4 a[224:227],v250,s[20:23],s46 offen offset:2048 sc1
M a[32:35],v[228:231],a[212:215],a[32:35]
s_waitcnt vmcnt(10)
s_add_u32 s47,s75,21504
v_cvt_pk_bf16_f32 v208,v233,v208
v_cvt_pk_bf16_f32 v212,v234,v210
M a[32:35],a[244:247],a[208:211],a[32:35]
s_waitcnt vmcnt(9)
v_cvt_pk_bf16_f32 v210,v238,v235
v_cvt_pk_bf16_f32 v214,v236,v214
M a[32:35],a[240:243],a[232:235],a[32:35]
v_permlane32_swap_b32 v209,v211
v_permlane32_swap_b32 v205,v207
M a[36:39],a[240:243],a[204:207],a[36:39]
buffer_load_dwordx4 v[216:219],v250,s[20:23],s47 offen offset:0 sc1
M a[36:39],a[244:247],a[232:235],a[36:39]
v_permlane32_swap_b32 v213,v215
v_lshlrev_b32 v234,16,v211
M a[36:39],v[228:231],a[208:211],a[36:39]
v_lshlrev_b32 v232,16,v205
v_lshlrev_b32 v233,16,v209
M a[40:43],v[228:231],a[232:235],a[40:43]
v_lshlrev_b32 v237,16,v207
v_lshlrev_b32 v236,16,v215
M a[40:43],a[244:247],a[204:207],a[40:43]
v_lshlrev_b32 v235,16,v213
v_fmac_f32 v232,s43,v234
M a[40:43],a[240:243],a[236:239],a[40:43]
v_fmac_f32 v237,4.0,v233
v_fma_f32 v238,-4.0,v234,v236
M a[44:47],a[240:243],a[252:255],a[44:47]
v_fmac_f32 v232,s45,v236
v_fmac_f32 v237,s41,v235
M a[44:47],a[244:247],a[236:239],a[44:47]
v_sub_f32 v236,v236,v234
v_fma_f32 v234,-4.0,v233,v235
M a[44:47],v[228:231],a[204:207],a[44:47]
v_sub_f32 v235,v235,v233
v_add_f32 v233,v238,v234
M a[48:51],v[228:231],a[236:239],a[48:51]
v_sub_f32 v238,v238,v234
v_fma_f32 v234,2.0,v235,v236
M a[48:51],a[244:247],a[252:255],a[48:51]
v_fmac_f32 v236,-2.0,v235
v_and_b32 v211,s42,v211
M a[48:51],a[240:243],a[196:199],a[48:51]
v_and_b32 v205,s42,v205
v_and_b32 v209,s42,v209
M a[52:55],a[240:243],a[216:219],a[52:55]
v_and_b32 v207,s42,v207
v_and_b32 v215,s42,v215
M a[52:55],a[244:247],a[196:199],a[52:55]
v_and_b32 v213,s42,v213
v_fmac_f32 v205,s43,v211
M a[52:55],v[228:231],a[252:255],a[52:55]
v_fmac_f32 v207,4.0,v209
v_fma_f32 v235,-4.0,v211,v215
M a[56:59],v[228:231],a[196:199],a[56:59]
v_fmac_f32 v205,s45,v215
v_fmac_f32 v207,s41,v213
M a[56:59],a[244:247],a[216:219],a[56:59]
v_sub_f32 v215,v215,v211
v_fma_f32 v211,-4.0,v209,v213
M a[56:59],a[240:243],a[228:231],a[56:59]
v_sub_f32 v213,v213,v209
v_add_f32 v209,v235,v211
M a[60:63],a[240:243],v[224:227],a[60:63]
buffer_load_dwordx4 a[240:243],v250,s[20:23],s47 offen offset:1024 sc1
M a[60:63],a[244:247],a[228:231],a[60:63]
v_sub_f32 v235,v235,v211
v_fma_f32 v211,2.0,v213,v215
M a[60:63],v[228:231],a[216:219],a[60:63]
s_waitcnt vmcnt(10)
buffer_load_dwordx4 a[244:247],v250,s[20:23],s47 offen offset:2048 sc1
M a[64:67],a[248:251],a[212:215],a[64:67]
s_waitcnt vmcnt(10)
s_add_u32 s48,s75,24576
v_fmac_f32 v215,-2.0,v213
v_cvt_pk_bf16_f32 v205,v232,v205
M a[64:67],a[192:195],a[208:211],a[64:67]
s_waitcnt vmcnt(9)
v_cvt_pk_bf16_f32 v207,v237,v207
v_cvt_pk_bf16_f32 v209,v233,v209
M a[64:67],a[200:203],a[232:235],a[64:67]
v_cvt_pk_bf16_f32 v213,v234,v211
v_cvt_pk_bf16_f32 v211,v238,v235
M a[68:71],a[200:203],a[204:207],a[68:71]
buffer_load_dwordx4 v[228:231],v250,s[20:23],s48 offen offset:0 sc1
M a[68:71],a[192:195],a[232:235],a[68:71]
v_cvt_pk_bf16_f32 v215,v236,v215
v_add_u32 v238,139264,v247
M a[68:71],a[248:251],a[208:211],a[68:71]
ds_write2st64_b64 v238,v[204:205],v[206:207] offset0:1 offset1:18
M a[72:75],a[248:251],a[232:235],a[72:75]
s_add_u32 s28,s70,1179648
v_fmac_f32 v239,s43,v241
v_fmac_f32 v244,4.0,v240
M a[72:75],a[192:195],a[204:207],a[72:75]
buffer_load_dwordx4 a[212:215],v250,s[20:23],s48 offen offset:1024 sc1
M a[72:75],a[200:203],a[236:239],a[72:75]
ds_write2st64_b64 v247,v[208:209],v[210:211] offset0:35 offset1:52
M a[76:79],a[200:203],a[252:255],a[76:79]
v_fma_f32 v232,-4.0,v241,v243
v_fmac_f32 v239,s45,v243
M a[76:79],a[192:195],a[236:239],a[76:79]
buffer_load_dwordx4 a[208:211],v250,s[20:23],s48 offen offset:2048 sc1
M a[76:79],a[248:251],a[204:207],a[76:79]
s_add_u32 s46,s75,27648
ds_write2st64_b64 v247,v[212:213],v[214:215] offset0:69 offset1:86
M a[80:83],a[248:251],a[236:239],a[80:83]
v_fmac_f32 v244,s41,v242
v_sub_f32 v243,v243,v241
M a[80:83],a[192:195],a[252:255],a[80:83]
buffer_load_dwordx4 a[232:235],v250,s[20:23],s46 offen offset:0 sc1
M a[80:83],a[200:203],a[196:199],a[80:83]
v_fma_f32 v241,-4.0,v240,v242
v_sub_f32 v242,v242,v240
M a[84:87],a[200:203],a[216:219],a[84:87]
v_add_f32 v240,v232,v241
v_sub_f32 v232,v232,v241
M a[84:87],a[192:195],a[196:199],a[84:87]
ds_read_b128 a[204:207],v248 offset:43520
v_fma_f32 v241,2.0,v242,v243
M a[84:87],a[248:251],a[252:255],a[84:87]
buffer_load_dwordx4 v[204:207],v251,s[88:91],s28 offen offset:0
M a[88:91],a[248:251],a[196:199],a[88:91]
ds_read_b128 a[236:239],v249 offset:43520
ds_read_b128 a[252:255],v248 offset:44032
M a[88:91],a[192:195],a[216:219],a[88:91]
ds_read_b128 a[196:199],v249 offset:44032
v_fmac_f32 v243,-2.0,v242
M a[88:91],a[200:203],a[228:231],a[88:91]
v_cvt_pk_bf16_f32 v233,v239,v244
v_cvt_pk_bf16_f32 v234,v240,v232
M a[92:95],a[200:203],v[224:227],a[92:95]
buffer_load_dwordx4 v[208:211],v245,s[8:11],s28 offen offset:0
M a[92:95],a[192:195],a[228:231],a[92:95]
v_cvt_pk_bf16_f32 v235,v241,v243
v_add_u32 v232,139264,v252
M a[92:95],a[248:251],a[216:219],a[92:95]
s_waitcnt vmcnt(14) lgkmcnt(3)
ds_write_b16 v232,v233 offset:0
M a[96:99],v[220:223],a[204:207],a[96:99]
s_waitcnt vmcnt(10) lgkmcnt(3)
ds_read_b128 a[200:203],v248 offset:44544
ds_write_b16_d16_hi v232,v233 offset:8704
M a[96:99],a[220:223],a[236:239],a[96:99]
s_waitcnt vmcnt(9) lgkmcnt(4)
buffer_load_dwordx4 v[212:215],v245,s[8:11],s28 offen offset:768
M a[96:99],a[224:227],a[252:255],a[96:99]
s_waitcnt lgkmcnt(3)
s_add_u32 s29,s71,0
ds_read_b128 v[224:227],v249 offset:44544
ds_write_b16 v252,v234 offset:17408
M a[100:103],a[224:227],a[196:199],a[100:103]
ds_write_b16_d16_hi v252,v234 offset:26112
M a[100:103],a[220:223],a[252:255],a[100:103]
ds_write_b16 v252,v235 offset:34816
M a[100:103],v[220:223],a[236:239],a[100:103]
buffer_load_short_d16_hi v239,v246,s[12:15],s29 offen offset:0
M a[104:107],v[220:223],a[252:255],a[104:107]
ds_read_b128 a[192:195],v248 offset:45056
ds_write_b16_d16_hi v252,v235 offset:43520
M a[104:107],a[220:223],a[196:199],a[104:107]
s_waitcnt lgkmcnt(7)
buffer_load_short_d16_hi v240,v246,s[8:11],s29 offen offset:0
M a[104:107],a[224:227],a[200:203],a[104:107]
s_waitcnt lgkmcnt(5)
buffer_load_short_d16_hi v241,v246,s[8:11],s29 offen offset:384
M a[108:111],a[224:227],v[224:227],a[108:111]
ds_read_b128 a[228:231],v249 offset:45056
v_permlane32_swap_b32 v196,v198
M a[108:111],a[220:223],a[200:203],a[108:111]
buffer_load_short_d16_hi v242,v246,s[8:11],s29 offen offset:768
M a[108:111],v[220:223],a[196:199],a[108:111]
v_permlane32_swap_b32 v192,v194
v_permlane32_swap_b32 v200,v202
M a[112:115],v[220:223],a[200:203],a[112:115]
buffer_load_short_d16_hi v243,v246,s[8:11],s29 offen offset:1152
M a[112:115],a[220:223],v[224:227],a[112:115]
s_waitcnt lgkmcnt(2)
ds_read_b128 a[216:219],v249 offset:45568
ds_read_b128 a[248:251],v248 offset:45568
M a[112:115],a[224:227],a[192:195],a[112:115]
s_waitcnt lgkmcnt(2)
buffer_load_short_d16_hi v244,v246,s[16:19],s29 offen offset:1536
M a[116:119],a[224:227],a[228:231],a[116:119]
v_lshlrev_b32 v234,16,v198
v_lshlrev_b32 v232,16,v192
M a[116:119],a[220:223],a[192:195],a[116:119]
v_lshlrev_b32 v233,16,v196
v_lshlrev_b32 v237,16,v194
M a[116:119],v[220:223],v[224:227],a[116:119]
v_lshlrev_b32 v236,16,v202
v_lshlrev_b32 v235,16,v200
M a[120:123],v[220:223],a[192:195],a[120:123]
v_fmac_f32 v232,s43,v234
v_fmac_f32 v237,4.0,v233
M a[120:123],a[220:223],a[228:231],a[120:123]
s_waitcnt lgkmcnt(1)
v_fma_f32 v238,-4.0,v234,v236
v_fmac_f32 v232,s45,v236
M a[120:123],a[224:227],a[216:219],a[120:123]
s_waitcnt lgkmcnt(0)
v_fmac_f32 v237,s41,v235
v_sub_f32 v236,v236,v234
M a[124:127],a[224:227],a[248:251],a[124:127]
buffer_load_dwordx4 a[224:227],v250,s[20:23],s46 offen offset:1024 sc1
M a[124:127],a[220:223],a[216:219],a[124:127]
v_fma_f32 v234,-4.0,v233,v235
v_sub_f32 v235,v235,v233
M a[124:127],v[220:223],a[228:231],a[124:127]
s_waitcnt vmcnt(16)
buffer_load_dwordx4 a[220:223],v250,s[20:23],s46 offen offset:2048 sc1
M a[128:131],v[216:219],a[204:207],a[128:131]
s_waitcnt vmcnt(16)
s_add_u32 s47,s75,30720
v_add_f32 v233,v238,v234
v_sub_f32 v238,v238,v234
M a[128:131],a[240:243],a[236:239],a[128:131]
s_waitcnt vmcnt(15)
v_fma_f32 v234,2.0,v235,v236
v_fmac_f32 v236,-2.0,v235
M a[128:131],a[244:247],a[252:255],a[128:131]
v_and_b32 v198,s42,v198
v_and_b32 v192,s42,v192
M a[132:135],a[244:247],a[196:199],a[132:135]
buffer_load_dwordx4 v[220:223],v250,s[20:23],s47 offen offset:0 sc1
M a[132:135],a[240:243],a[252:255],a[132:135]
v_and_b32 v196,s42,v196
v_and_b32 v194,s42,v194
M a[132:135],v[216:219],a[236:239],a[132:135]
v_and_b32 v202,s42,v202
v_and_b32 v200,s42,v200
M a[136:139],v[216:219],a[252:255],a[136:139]
v_fmac_f32 v192,s43,v198
v_fmac_f32 v194,4.0,v196
M a[136:139],a[240:243],a[196:199],a[136:139]
v_fma_f32 v235,-4.0,v198,v202
v_fmac_f32 v192,s45,v202
M a[136:139],a[244:247],a[200:203],a[136:139]
v_fmac_f32 v194,s41,v200
v_sub_f32 v202,v202,v198
M a[140:143],a[244:247],v[224:227],a[140:143]
v_fma_f32 v198,-4.0,v196,v200
v_sub_f32 v200,v200,v196
M a[140:143],a[240:243],a[200:203],a[140:143]
v_add_f32 v196,v235,v198
v_sub_f32 v235,v235,v198
M a[140:143],v[216:219],a[196:199],a[140:143]
v_fma_f32 v198,2.0,v200,v202
v_fmac_f32 v202,-2.0,v200
M a[144:147],v[216:219],a[200:203],a[144:147]
v_cvt_pk_bf16_f32 v192,v232,v192
v_cvt_pk_bf16_f32 v194,v237,v194
M a[144:147],a[240:243],v[224:227],a[144:147]
v_cvt_pk_bf16_f32 v196,v233,v196
v_cvt_pk_bf16_f32 v200,v234,v198
M a[144:147],a[244:247],a[192:195],a[144:147]
v_cvt_pk_bf16_f32 v198,v238,v235
v_cvt_pk_bf16_f32 v202,v236,v202
M a[148:151],a[244:247],a[228:231],a[148:151]
v_permlane32_swap_b32 v197,v199
v_permlane32_swap_b32 v193,v195
M a[148:151],a[240:243],a[192:195],a[148:151]
v_permlane32_swap_b32 v201,v203
v_lshlrev_b32 v234,16,v199
M a[148:151],v[216:219],v[224:227],a[148:151]
v_lshlrev_b32 v232,16,v193
v_lshlrev_b32 v233,16,v197
M a[152:155],v[216:219],a[192:195],a[152:155]
v_lshlrev_b32 v237,16,v195
v_lshlrev_b32 v236,16,v203
M a[152:155],a[240:243],a[228:231],a[152:155]
v_lshlrev_b32 v235,16,v201
v_fmac_f32 v232,s43,v234
M a[152:155],a[244:247],a[216:219],a[152:155]
v_fmac_f32 v237,4.0,v233
v_fma_f32 v238,-4.0,v234,v236
M a[156:159],a[244:247],a[248:251],a[156:159]
buffer_load_dwordx4 a[244:247],v250,s[20:23],s47 offen offset:1024 sc1
M a[156:159],a[240:243],a[216:219],a[156:159]
v_fmac_f32 v232,s45,v236
v_fmac_f32 v237,s41,v235
M a[156:159],v[216:219],a[228:231],a[156:159]
s_waitcnt vmcnt(16)
buffer_load_dwordx4 a[240:243],v250,s[20:23],s47 offen offset:2048 sc1
M a[160:163],v[228:231],a[204:207],a[160:163]
s_waitcnt vmcnt(16)
s_add_u32 s48,s75,33792
v_sub_f32 v236,v236,v234
v_fma_f32 v234,-4.0,v233,v235
M a[160:163],a[212:215],a[236:239],a[160:163]
s_waitcnt vmcnt(15)
v_sub_f32 v235,v235,v233
v_add_f32 v233,v238,v234
M a[160:163],a[208:211],a[252:255],a[160:163]
v_sub_f32 v238,v238,v234
v_fma_f32 v234,2.0,v235,v236
M a[164:167],a[208:211],a[196:199],a[164:167]
buffer_load_dwordx4 v[216:219],v250,s[20:23],s48 offen offset:0 sc1
M a[164:167],a[212:215],a[252:255],a[164:167]
v_fmac_f32 v236,-2.0,v235
v_and_b32 v199,s42,v199
M a[164:167],v[228:231],a[236:239],a[164:167]
v_and_b32 v193,s42,v193
v_and_b32 v197,s42,v197
M a[168:171],v[228:231],a[252:255],a[168:171]
v_and_b32 v195,s42,v195
v_and_b32 v203,s42,v203
M a[168:171],a[212:215],a[196:199],a[168:171]
buffer_load_dwordx4 a[204:207],v250,s[20:23],s48 offen offset:1024 sc1
M a[168:171],a[208:211],a[200:203],a[168:171]
v_and_b32 v201,s42,v201
v_fmac_f32 v193,s43,v199
M a[172:175],a[208:211],v[224:227],a[172:175]
v_fmac_f32 v195,4.0,v197
v_fma_f32 v235,-4.0,v199,v203
M a[172:175],a[212:215],a[200:203],a[172:175]
v_fmac_f32 v193,s45,v203
v_fmac_f32 v195,s41,v201
M a[172:175],v[228:231],a[196:199],a[172:175]
buffer_load_dwordx4 a[236:239],v250,s[20:23],s48 offen offset:2048 sc1
M a[176:179],v[228:231],a[200:203],a[176:179]
s_add_u32 s46,s75,36864
v_sub_f32 v203,v203,v199
v_fma_f32 v199,-4.0,v197,v201
M a[176:179],a[212:215],v[224:227],a[176:179]
v_sub_f32 v201,v201,v197
v_add_f32 v197,v235,v199
M a[176:179],a[208:211],a[192:195],a[176:179]
v_sub_f32 v235,v235,v199
v_fma_f32 v199,2.0,v201,v203
M a[180:183],a[208:211],a[228:231],a[180:183]
buffer_load_dwordx4 a[252:255],v250,s[20:23],s46 offen offset:0 sc1
M a[180:183],a[212:215],a[192:195],a[180:183]
ds_read_b128 a[196:199],v248 offset:52224
v_fmac_f32 v203,-2.0,v201
M a[180:183],v[228:231],v[224:227],a[180:183]
ds_read_b128 a[200:203],v249 offset:52224
v_cvt_pk_bf16_f32 v193,v232,v193
M a[184:187],v[228:231],a[192:195],a[184:187]
ds_read_b128 v[224:227],v248 offset:52736
v_cvt_pk_bf16_f32 v195,v237,v195
M a[184:187],a[212:215],a[228:231],a[184:187]
ds_read_b128 a[192:195],v249 offset:52736
v_cvt_pk_bf16_f32 v197,v233,v197
M a[184:187],a[208:211],a[216:219],a[184:187]
v_cvt_pk_bf16_f32 v201,v234,v199
v_cvt_pk_bf16_f32 v199,v238,v235
M a[188:191],a[208:211],a[248:251],a[188:191]
v_cvt_pk_bf16_f32 v203,v236,v203
v_add_u32 v238,139264,v247
M a[188:191],a[212:215],a[216:219],a[188:191]
s_waitcnt vmcnt(16)
v_permlane32_swap_b32 v208,v210
v_permlane32_swap_b32 v204,v206
M a[188:191],v[228:231],a[228:231],a[188:191]
s_waitcnt lgkmcnt(3)
ds_write2st64_b64 v238,v[192:193],v[194:195] offset0:2 offset1:19
M v[0:3],a[232:235],a[196:199],v[0:3]
s_waitcnt vmcnt(8) lgkmcnt(3)
s_add_u32 s28,s71,0
ds_read_b128 a[208:211],v248 offset:53248
s_mov_b64 exec,s[86:87]
v_xor_b32 v245,0x80000000,v245
v_xor_b32 v251,0x80000000,v251
s_mov_b64 exec,-1
M v[0:3],a[224:227],a[200:203],v[0:3]
s_waitcnt vmcnt(7) lgkmcnt(3)
buffer_load_dwordx4 v[192:195],v251,s[88:91],s28 offen offset:0
M v[0:3],a[220:223],v[224:227],v[0:3]
s_waitcnt lgkmcnt(2)
ds_write2st64_b64 v247,v[196:197],v[198:199] offset0:36 offset1:53
M v[4:7],a[220:223],a[192:195],v[4:7]
buffer_load_dwordx4 v[196:199],v245,s[8:11],s28 offen offset:0
M v[4:7],a[224:227],v[224:227],v[4:7]
ds_read_b128 a[248:251],v249 offset:53248
v_permlane32_swap_b32 v212,v214
M v[4:7],a[232:235],a[200:203],v[4:7]
ds_write2st64_b64 v247,v[200:201],v[202:203] offset0:70 offset1:87
M v[8:11],a[232:235],v[224:227],v[8:11]
buffer_load_dwordx4 v[200:203],v245,s[8:11],s28 offen offset:768
M v[8:11],a[224:227],a[192:195],v[8:11]
s_waitcnt lgkmcnt(3)
ds_read_b128 a[212:215],v248 offset:53760
ds_read_b128 a[216:219],v249 offset:53760
M v[8:11],a[220:223],a[208:211],v[8:11]
s_waitcnt lgkmcnt(3)
s_mov_b64 exec,s[86:87]
v_xor_b32 v245,0x80000000,v245
v_xor_b32 v251,0x80000000,v251
s_mov_b64 exec,-1
v_lshlrev_b32 v234,16,v210
M v[12:15],a[220:223],a[248:251],v[12:15]
v_lshlrev_b32 v232,16,v204
v_lshlrev_b32 v233,16,v208
M v[12:15],a[224:227],a[208:211],v[12:15]
v_lshlrev_b32 v237,16,v206
v_lshlrev_b32 v236,16,v214
M v[12:15],a[232:235],a[192:195],v[12:15]
v_lshlrev_b32 v235,16,v212
v_fmac_f32 v232,s43,v234
M v[16:19],a[232:235],a[208:211],v[16:19]
ds_read_b128 a[228:231],v249 offset:54272
v_fmac_f32 v237,4.0,v233
M v[16:19],a[224:227],a[248:251],v[16:19]
s_waitcnt lgkmcnt(2)
ds_read_b128 v[228:231],v248 offset:54272
v_fma_f32 v238,-4.0,v234,v236
M v[16:19],a[220:223],a[212:215],v[16:19]
s_waitcnt lgkmcnt(2)
v_fmac_f32 v232,s45,v236
v_fmac_f32 v237,s41,v235
M v[20:23],a[220:223],a[216:219],v[20:23]
v_sub_f32 v236,v236,v234
v_fma_f32 v234,-4.0,v233,v235
M v[20:23],a[224:227],a[212:215],v[20:23]
v_sub_f32 v235,v235,v233
v_add_f32 v233,v238,v234
M v[20:23],a[232:235],a[248:251],v[20:23]
v_sub_f32 v238,v238,v234
v_fma_f32 v234,2.0,v235,v236
M v[24:27],a[232:235],a[212:215],v[24:27]
v_fmac_f32 v236,-2.0,v235
v_and_b32 v210,s42,v210
M v[24:27],a[224:227],a[216:219],v[24:27]
s_waitcnt lgkmcnt(1)
v_and_b32 v204,s42,v204
v_and_b32 v208,s42,v208
M v[24:27],a[220:223],a[228:231],v[24:27]
s_waitcnt lgkmcnt(0)
v_and_b32 v206,s42,v206
v_and_b32 v214,s42,v214
M v[28:31],a[220:223],v[228:231],v[28:31]
global_load_dword a220,v250,s[64:65]
M v[28:31],a[224:227],a[228:231],v[28:31]
buffer_load_dwordx4 a[220:223],v250,s[20:23],s46 offen offset:1024 sc1
M v[28:31],a[232:235],a[216:219],v[28:31]
s_waitcnt vmcnt(11)
v_and_b32 v212,s42,v212
v_fmac_f32 v204,s43,v210
M v[32:35],v[220:223],a[196:199],v[32:35]
s_waitcnt vmcnt(10)
v_fmac_f32 v206,4.0,v208
v_fma_f32 v235,-4.0,v210,v214
M v[32:35],a[244:247],a[200:203],v[32:35]
s_waitcnt vmcnt(9)
buffer_load_dwordx4 a[224:227],v250,s[20:23],s46 offen offset:2048 sc1
M v[32:35],a[240:243],v[224:227],v[32:35]
s_add_u32 s47,s75,39936
v_fmac_f32 v204,s45,v214
v_fmac_f32 v206,s41,v212
M v[36:39],a[240:243],a[192:195],v[36:39]
v_sub_f32 v214,v214,v210
v_fma_f32 v210,-4.0,v208,v212
M v[36:39],a[244:247],v[224:227],v[36:39]
v_sub_f32 v212,v212,v208
v_add_f32 v208,v235,v210
M v[36:39],v[220:223],a[200:203],v[36:39]
buffer_load_dwordx4 a[232:235],v250,s[20:23],s47 offen offset:0 sc1
M v[40:43],v[220:223],v[224:227],v[40:43]
v_sub_f32 v235,v235,v210
v_fma_f32 v210,2.0,v212,v214
M v[40:43],a[244:247],a[192:195],v[40:43]
v_fmac_f32 v214,-2.0,v212
v_cvt_pk_bf16_f32 v204,v232,v204
M v[40:43],a[240:243],a[208:211],v[40:43]
v_cvt_pk_bf16_f32 v206,v237,v206
v_cvt_pk_bf16_f32 v208,v233,v208
M v[44:47],a[240:243],a[248:251],v[44:47]
v_cvt_pk_bf16_f32 v212,v234,v210
v_cvt_pk_bf16_f32 v210,v238,v235
M v[44:47],a[244:247],a[208:211],v[44:47]
v_cvt_pk_bf16_f32 v214,v236,v214
v_permlane32_swap_b32 v209,v211
M v[44:47],v[220:223],a[192:195],v[44:47]
v_permlane32_swap_b32 v205,v207
v_permlane32_swap_b32 v213,v215
M v[48:51],v[220:223],a[208:211],v[48:51]
v_lshlrev_b32 v234,16,v211
v_lshlrev_b32 v232,16,v205
M v[48:51],a[244:247],a[248:251],v[48:51]
v_lshlrev_b32 v233,16,v209
v_lshlrev_b32 v237,16,v207
M v[48:51],a[240:243],a[212:215],v[48:51]
v_lshlrev_b32 v236,16,v215
v_lshlrev_b32 v235,16,v213
M v[52:55],a[240:243],a[216:219],v[52:55]
v_fmac_f32 v232,s43,v234
v_fmac_f32 v237,4.0,v233
M v[52:55],a[244:247],a[212:215],v[52:55]
v_fma_f32 v238,-4.0,v234,v236
v_fmac_f32 v232,s45,v236
M v[52:55],v[220:223],a[248:251],v[52:55]
v_fmac_f32 v237,s41,v235
v_sub_f32 v236,v236,v234
M v[56:59],v[220:223],a[212:215],v[56:59]
v_fma_f32 v234,-4.0,v233,v235
v_sub_f32 v235,v235,v233
M v[56:59],a[244:247],a[216:219],v[56:59]
v_add_f32 v233,v238,v234
v_sub_f32 v238,v238,v234
M v[56:59],a[240:243],a[228:231],v[56:59]
v_fma_f32 v234,2.0,v235,v236
v_fmac_f32 v236,-2.0,v235
M v[60:63],a[240:243],v[228:231],v[60:63]
buffer_load_dwordx4 a[240:243],v250,s[20:23],s47 offen offset:1024 sc1
M v[60:63],a[244:247],a[228:231],v[60:63]
v_and_b32 v211,s42,v211
v_and_b32 v205,s42,v205
M v[60:63],v[220:223],a[216:219],v[60:63]
s_waitcnt vmcnt(11)
buffer_load_dwordx4 a[244:247],v250,s[20:23],s47 offen offset:2048 sc1
M v[64:67],v[216:219],a[196:199],v[64:67]
s_waitcnt vmcnt(11)
s_add_u32 s48,s75,43008
v_and_b32 v209,s42,v209
v_and_b32 v207,s42,v207
M v[64:67],a[204:207],a[200:203],v[64:67]
s_waitcnt vmcnt(10)
v_and_b32 v215,s42,v215
v_and_b32 v213,s42,v213
M v[64:67],a[236:239],v[224:227],v[64:67]
v_fmac_f32 v205,s43,v211
v_fmac_f32 v207,4.0,v209
M v[68:71],a[236:239],a[192:195],v[68:71]
buffer_load_dwordx4 v[220:223],v250,s[20:23],s48 offen offset:0 sc1
M v[68:71],a[204:207],v[224:227],v[68:71]
v_fma_f32 v235,-4.0,v211,v215
v_fmac_f32 v205,s45,v215
M v[68:71],v[216:219],a[200:203],v[68:71]
v_fmac_f32 v207,s41,v213
v_sub_f32 v215,v215,v211
M v[72:75],v[216:219],v[224:227],v[72:75]
v_fma_f32 v211,-4.0,v209,v213
v_sub_f32 v213,v213,v209
M v[72:75],a[204:207],a[192:195],v[72:75]
buffer_load_dwordx4 a[196:199],v250,s[20:23],s48 offen offset:1024 sc1
M v[72:75],a[236:239],a[208:211],v[72:75]
v_add_f32 v209,v235,v211
v_sub_f32 v235,v235,v211
M v[76:79],a[236:239],a[248:251],v[76:79]
v_fma_f32 v211,2.0,v213,v215
v_fmac_f32 v215,-2.0,v213
M v[76:79],a[204:207],a[208:211],v[76:79]
v_cvt_pk_bf16_f32 v205,v232,v205
v_cvt_pk_bf16_f32 v207,v237,v207
M v[76:79],v[216:219],a[192:195],v[76:79]
buffer_load_dwordx4 a[200:203],v250,s[20:23],s48 offen offset:2048 sc1
M v[80:83],v[216:219],a[208:211],v[80:83]
s_add_u32 s46,s76,9216
v_cvt_pk_bf16_f32 v209,v233,v209
v_cvt_pk_bf16_f32 v213,v234,v211
M v[80:83],a[204:207],a[248:251],v[80:83]
v_cvt_pk_bf16_f32 v211,v238,v235
v_cvt_pk_bf16_f32 v215,v236,v215
M v[80:83],a[236:239],a[212:215],v[80:83]
s_waitcnt vmcnt(10)
v_add_u32 v238,139264,v247
v_permlane32_swap_b32 v196,v198
M v[84:87],a[236:239],a[216:219],v[84:87]
buffer_load_dwordx4 v[224:227],v250,s[20:23],s46 offen offset:0 sc1
M v[84:87],a[204:207],a[212:215],v[84:87]
ds_read_b128 a[192:195],v248 offset:60928
v_permlane32_swap_b32 v192,v194
M v[84:87],v[216:219],a[248:251],v[84:87]
ds_write2st64_b64 v238,v[204:205],v[206:207] offset0:3 offset1:20
M v[88:91],v[216:219],a[212:215],v[88:91]
s_add_u32 s28,s71,393216
ds_read_b128 a[208:211],v249 offset:60928
ds_read_b128 a[248:251],v248 offset:61440
M v[88:91],a[204:207],a[216:219],v[88:91]
buffer_load_dwordx4 v[204:207],v251,s[88:91],s28 offen offset:0
M v[88:91],a[236:239],a[228:231],v[88:91]
ds_write2st64_b64 v247,v[208:209],v[210:211] offset0:37 offset1:54
M v[92:95],a[236:239],v[228:231],v[92:95]
s_waitcnt vmcnt(11)
ds_read_b128 a[212:215],v249 offset:61440
v_permlane32_swap_b32 v200,v202
M v[92:95],a[204:207],a[228:231],v[92:95]
buffer_load_dwordx4 v[208:211],v245,s[8:11],s28 offen offset:0
M v[92:95],v[216:219],a[216:219],v[92:95]
s_waitcnt lgkmcnt(5)
ds_write2st64_b64 v247,v[212:213],v[214:215] offset0:71 offset1:88
M v[96:99],a[252:255],a[192:195],v[96:99]
s_waitcnt vmcnt(10) lgkmcnt(4)
ds_read_b128 a[236:239],v248 offset:61952
v_lshlrev_b32 v234,16,v198
M v[96:99],a[220:223],a[208:211],v[96:99]
s_waitcnt vmcnt(9) lgkmcnt(4)
buffer_load_dwordx4 v[212:215],v245,s[8:11],s28 offen offset:768
M v[96:99],a[224:227],a[248:251],v[96:99]
s_waitcnt lgkmcnt(2)
ds_read_b128 v[228:231],v249 offset:61952
v_lshlrev_b32 v232,16,v192
M v[100:103],a[224:227],a[212:215],v[100:103]
v_lshlrev_b32 v233,16,v196
v_lshlrev_b32 v237,16,v194
M v[100:103],a[220:223],a[248:251],v[100:103]
v_lshlrev_b32 v236,16,v202
v_lshlrev_b32 v235,16,v200
M v[100:103],a[252:255],a[208:211],v[100:103]
v_fmac_f32 v232,s43,v234
v_fmac_f32 v237,4.0,v233
M v[104:107],a[252:255],a[248:251],v[104:107]
ds_read_b128 a[204:207],v248 offset:62464
v_fma_f32 v238,-4.0,v234,v236
M v[104:107],a[220:223],a[212:215],v[104:107]
s_waitcnt lgkmcnt(2)
ds_read_b128 a[228:231],v249 offset:62464
v_fmac_f32 v232,s45,v236
M v[104:107],a[224:227],a[236:239],v[104:107]
s_waitcnt lgkmcnt(2)
v_fmac_f32 v237,s41,v235
v_sub_f32 v236,v236,v234
M v[108:111],a[224:227],v[228:231],v[108:111]
v_fma_f32 v234,-4.0,v233,v235
v_sub_f32 v235,v235,v233
M v[108:111],a[220:223],a[236:239],v[108:111]
v_add_f32 v233,v238,v234
v_sub_f32 v238,v238,v234
M v[108:111],a[252:255],a[212:215],v[108:111]
v_fma_f32 v234,2.0,v235,v236
v_fmac_f32 v236,-2.0,v235
M v[112:115],a[252:255],a[236:239],v[112:115]
ds_read_b128 a[216:219],v249 offset:62976
v_and_b32 v198,s42,v198
M v[112:115],a[220:223],v[228:231],v[112:115]
s_waitcnt lgkmcnt(2)
ds_read_b128 v[216:219],v248 offset:62976
v_and_b32 v192,s42,v192
M v[112:115],a[224:227],a[204:207],v[112:115]
s_waitcnt lgkmcnt(2)
v_and_b32 v196,s42,v196
v_and_b32 v194,s42,v194
M v[116:119],a[224:227],a[228:231],v[116:119]
v_and_b32 v202,s42,v202
v_and_b32 v200,s42,v200
M v[116:119],a[220:223],a[204:207],v[116:119]
v_fmac_f32 v192,s43,v198
v_fmac_f32 v194,4.0,v196
M v[116:119],a[252:255],v[228:231],v[116:119]
v_fma_f32 v235,-4.0,v198,v202
v_fmac_f32 v192,s45,v202
M v[120:123],a[252:255],a[204:207],v[120:123]
v_fmac_f32 v194,s41,v200
v_sub_f32 v202,v202,v198
M v[120:123],a[220:223],a[228:231],v[120:123]
s_waitcnt lgkmcnt(1)
v_fma_f32 v198,-4.0,v196,v200
v_sub_f32 v200,v200,v196
M v[120:123],a[224:227],a[216:219],v[120:123]
s_waitcnt lgkmcnt(0)
v_add_f32 v196,v235,v198
v_sub_f32 v235,v235,v198
M v[124:127],a[224:227],v[216:219],v[124:127]
buffer_load_dwordx4 a[224:227],v250,s[20:23],s46 offen offset:1024 sc1
M v[124:127],a[220:223],a[216:219],v[124:127]
v_fma_f32 v198,2.0,v200,v202
v_fmac_f32 v202,-2.0,v200
M v[124:127],a[252:255],a[228:231],v[124:127]
s_waitcnt vmcnt(10)
buffer_load_dwordx4 a[220:223],v250,s[20:23],s46 offen offset:2048 sc1
M v[128:131],a[232:235],a[192:195],v[128:131]
s_waitcnt vmcnt(10)
s_add_u32 s47,s76,12288
v_cvt_pk_bf16_f32 v192,v232,v192
v_cvt_pk_bf16_f32 v194,v237,v194
M v[128:131],a[240:243],a[208:211],v[128:131]
s_waitcnt vmcnt(9)
v_cvt_pk_bf16_f32 v196,v233,v196
v_cvt_pk_bf16_f32 v200,v234,v198
M v[128:131],a[244:247],a[248:251],v[128:131]
v_cvt_pk_bf16_f32 v198,v238,v235
v_cvt_pk_bf16_f32 v202,v236,v202
M v[132:135],a[244:247],a[212:215],v[132:135]
buffer_load_dwordx4 a[252:255],v250,s[20:23],s47 offen offset:0 sc1
M v[132:135],a[240:243],a[248:251],v[132:135]
v_permlane32_swap_b32 v197,v199
v_permlane32_swap_b32 v193,v195
M v[132:135],a[232:235],a[208:211],v[132:135]
v_permlane32_swap_b32 v201,v203
v_lshlrev_b32 v234,16,v199
M v[136:139],a[232:235],a[248:251],v[136:139]
v_lshlrev_b32 v232,16,v193
v_lshlrev_b32 v233,16,v197
M v[136:139],a[240:243],a[212:215],v[136:139]
v_lshlrev_b32 v237,16,v195
v_lshlrev_b32 v236,16,v203
M v[136:139],a[244:247],a[236:239],v[136:139]
v_lshlrev_b32 v235,16,v201
v_fmac_f32 v232,s43,v234
M v[140:143],a[244:247],v[228:231],v[140:143]
v_fmac_f32 v237,4.0,v233
v_fma_f32 v238,-4.0,v234,v236
M v[140:143],a[240:243],a[236:239],v[140:143]
v_fmac_f32 v232,s45,v236
v_fmac_f32 v237,s41,v235
M v[140:143],a[232:235],a[212:215],v[140:143]
v_sub_f32 v236,v236,v234
v_fma_f32 v234,-4.0,v233,v235
M v[144:147],a[232:235],a[236:239],v[144:147]
v_sub_f32 v235,v235,v233
v_add_f32 v233,v238,v234
M v[144:147],a[240:243],v[228:231],v[144:147]
v_sub_f32 v238,v238,v234
v_fma_f32 v234,2.0,v235,v236
M v[144:147],a[244:247],a[204:207],v[144:147]
v_fmac_f32 v236,-2.0,v235
v_and_b32 v199,s42,v199
M v[148:151],a[244:247],a[228:231],v[148:151]
v_and_b32 v193,s42,v193
v_and_b32 v197,s42,v197
M v[148:151],a[240:243],a[204:207],v[148:151]
v_and_b32 v195,s42,v195
v_and_b32 v203,s42,v203
M v[148:151],a[232:235],v[228:231],v[148:151]
v_and_b32 v201,s42,v201
v_fmac_f32 v193,s43,v199
M v[152:155],a[232:235],a[204:207],v[152:155]
v_fmac_f32 v195,4.0,v197
v_fma_f32 v235,-4.0,v199,v203
M v[152:155],a[240:243],a[228:231],v[152:155]
v_fmac_f32 v193,s45,v203
v_fmac_f32 v195,s41,v201
M v[152:155],a[244:247],a[216:219],v[152:155]
v_sub_f32 v203,v203,v199
v_fma_f32 v199,-4.0,v197,v201
M v[156:159],a[244:247],v[216:219],v[156:159]
buffer_load_dwordx4 a[244:247],v250,s[20:23],s47 offen offset:1024 sc1
M v[156:159],a[240:243],a[216:219],v[156:159]
v_sub_f32 v201,v201,v197
v_add_f32 v197,v235,v199
M v[156:159],a[232:235],a[228:231],v[156:159]
s_waitcnt vmcnt(10)
buffer_load_dwordx4 a[240:243],v250,s[20:23],s47 offen offset:2048 sc1
M v[160:163],v[220:223],a[192:195],v[160:163]
s_waitcnt vmcnt(10)
s_add_u32 s48,s76,15360
v_sub_f32 v235,v235,v199
v_fma_f32 v199,2.0,v201,v203
M v[160:163],a[196:199],a[208:211],v[160:163]
s_waitcnt vmcnt(9)
v_fmac_f32 v203,-2.0,v201
v_cvt_pk_bf16_f32 v193,v232,v193
M v[160:163],a[200:203],a[248:251],v[160:163]
v_cvt_pk_bf16_f32 v195,v237,v195
v_cvt_pk_bf16_f32 v197,v233,v197
M v[164:167],a[200:203],a[212:215],v[164:167]
buffer_load_dwordx4 a[232:235],v250,s[20:23],s48 offen offset:0 sc1
M v[164:167],a[196:199],a[248:251],v[164:167]
v_cvt_pk_bf16_f32 v201,v234,v199
v_cvt_pk_bf16_f32 v199,v238,v235
M v[164:167],v[220:223],a[208:211],v[164:167]
s_waitcnt vmcnt(7)
v_cvt_pk_bf16_f32 v203,v236,v203
v_permlane32_swap_b32 v208,v210
M v[168:171],v[220:223],a[248:251],v[168:171]
s_waitcnt vmcnt(6)
v_permlane32_swap_b32 v204,v206
v_permlane32_swap_b32 v212,v214
M v[168:171],a[196:199],a[212:215],v[168:171]
buffer_load_dwordx4 a[192:195],v250,s[20:23],s48 offen offset:1024 sc1
M v[168:171],a[200:203],a[236:239],v[168:171]
v_lshlrev_b32 v234,16,v210
v_lshlrev_b32 v232,16,v204
M v[172:175],a[200:203],v[228:231],v[172:175]
v_lshlrev_b32 v233,16,v208
v_lshlrev_b32 v237,16,v206
M v[172:175],a[196:199],a[236:239],v[172:175]
v_lshlrev_b32 v236,16,v214
v_lshlrev_b32 v235,16,v212
M v[172:175],v[220:223],a[212:215],v[172:175]
buffer_load_dwordx4 a[208:211],v250,s[20:23],s48 offen offset:2048 sc1
M v[176:179],v[220:223],a[236:239],v[176:179]
s_add_u32 s46,s76,18432
v_fmac_f32 v232,s43,v234
v_fmac_f32 v237,4.0,v233
M v[176:179],a[196:199],v[228:231],v[176:179]
v_fma_f32 v238,-4.0,v234,v236
v_fmac_f32 v232,s45,v236
M v[176:179],a[200:203],a[204:207],v[176:179]
s_barrier
v_fmac_f32 v237,s41,v235
M v[180:183],a[200:203],a[228:231],v[180:183]
buffer_load_dwordx4 a[248:251],v250,s[20:23],s46 offen offset:0 sc1
M v[180:183],a[196:199],a[204:207],v[180:183]
ds_read_b128 a[212:215],v248 offset:0
v_sub_f32 v236,v236,v234
M v[180:183],v[220:223],v[228:231],v[180:183]
ds_write2st64_b64 v247,v[192:193],v[194:195] offset0:136 offset1:153
M v[184:187],v[220:223],a[204:207],v[184:187]
s_add_u32 s28,s71,786432
ds_read_b128 a[236:239],v249 offset:0
ds_read_b128 v[228:231],v248 offset:512
M v[184:187],a[196:199],a[228:231],v[184:187]
buffer_load_dwordx4 v[192:195],v251,s[88:91],s28 offen offset:0
M v[184:187],a[200:203],a[216:219],v[184:187]
ds_write2st64_b64 v247,v[196:197],v[198:199] offset0:102 offset1:119
M v[188:191],a[200:203],v[216:219],v[188:191]
ds_read_b128 a[204:207],v249 offset:512
v_fma_f32 v234,-4.0,v233,v235
M v[188:191],a[196:199],a[216:219],v[188:191]
buffer_load_dwordx4 v[196:199],v245,s[8:11],s28 offen offset:0
M v[188:191],v[220:223],a[228:231],v[188:191]
s_waitcnt lgkmcnt(5)
v_sub_f32 v235,v235,v233
v_add_f32 v233,v238,v234
M a[0:3],v[224:227],a[212:215],a[0:3]
s_waitcnt vmcnt(10) lgkmcnt(3)
ds_read_b128 a[200:203],v248 offset:1024
v_sub_f32 v238,v238,v234
M a[0:3],a[224:227],a[236:239],a[0:3]
s_waitcnt vmcnt(9) lgkmcnt(3)
ds_read_b128 v[216:219],v249 offset:1024
v_fma_f32 v234,2.0,v235,v236
M a[0:3],a[220:223],v[228:231],a[0:3]
s_waitcnt lgkmcnt(2)
v_fmac_f32 v236,-2.0,v235
v_and_b32 v210,s42,v210
M a[4:7],a[220:223],a[204:207],a[4:7]
v_and_b32 v204,s42,v204
v_and_b32 v208,s42,v208
M a[4:7],a[224:227],v[228:231],a[4:7]
v_and_b32 v206,s42,v206
v_and_b32 v214,s42,v214
M a[4:7],v[224:227],a[236:239],a[4:7]
v_and_b32 v212,s42,v212
v_fmac_f32 v204,s43,v210
M a[8:11],v[224:227],v[228:231],a[8:11]
ds_read_b128 a[196:199],v248 offset:1536
v_fmac_f32 v206,4.0,v208
M a[8:11],a[224:227],a[204:207],a[8:11]
s_waitcnt lgkmcnt(2)
ds_read_b128 a[216:219],v249 offset:1536
v_fma_f32 v235,-4.0,v210,v214
M a[8:11],a[220:223],a[200:203],a[8:11]
s_waitcnt lgkmcnt(2)
v_fmac_f32 v204,s45,v214
v_fmac_f32 v206,s41,v212
M a[12:15],a[220:223],v[216:219],a[12:15]
v_sub_f32 v214,v214,v210
v_fma_f32 v210,-4.0,v208,v212
M a[12:15],a[224:227],a[200:203],a[12:15]
v_sub_f32 v212,v212,v208
v_add_f32 v208,v235,v210
M a[12:15],v[224:227],a[204:207],a[12:15]
v_sub_f32 v235,v235,v210
v_fma_f32 v210,2.0,v212,v214
M a[16:19],v[224:227],a[200:203],a[16:19]
ds_read_b128 a[228:231],v249 offset:2048
v_fmac_f32 v214,-2.0,v212
M a[16:19],a[224:227],v[216:219],a[16:19]
s_waitcnt lgkmcnt(2)
ds_read_b128 v[220:223],v248 offset:2048
v_cvt_pk_bf16_f32 v204,v232,v204
M a[16:19],a[220:223],a[196:199],a[16:19]
s_waitcnt lgkmcnt(2)
v_cvt_pk_bf16_f32 v206,v237,v206
v_cvt_pk_bf16_f32 v208,v233,v208
M a[20:23],a[220:223],a[216:219],a[20:23]
v_cvt_pk_bf16_f32 v212,v234,v210
v_cvt_pk_bf16_f32 v210,v238,v235
M a[20:23],a[224:227],a[196:199],a[20:23]
v_cvt_pk_bf16_f32 v214,v236,v214
v_permlane32_swap_b32 v209,v211
M a[20:23],v[224:227],v[216:219],a[20:23]
v_permlane32_swap_b32 v205,v207
v_permlane32_swap_b32 v213,v215
M a[24:27],v[224:227],a[196:199],a[24:27]
v_lshlrev_b32 v234,16,v211
v_lshlrev_b32 v232,16,v205
M a[24:27],a[224:227],a[216:219],a[24:27]
s_waitcnt lgkmcnt(1)
v_lshlrev_b32 v233,16,v209
v_lshlrev_b32 v237,16,v207
M a[24:27],a[220:223],a[228:231],a[24:27]
s_waitcnt lgkmcnt(0)
v_lshlrev_b32 v236,16,v215
v_lshlrev_b32 v235,16,v213
M a[28:31],a[220:223],v[220:223],a[28:31]
buffer_load_dwordx4 a[220:223],v250,s[20:23],s46 offen offset:1024 sc1
M a[28:31],a[224:227],a[228:231],a[28:31]
v_fmac_f32 v232,s43,v234
v_fmac_f32 v237,4.0,v233
M a[28:31],v[224:227],a[216:219],a[28:31]
s_waitcnt vmcnt(9)
buffer_load_dwordx4 a[224:227],v250,s[20:23],s46 offen offset:2048 sc1
M a[32:35],a[252:255],a[212:215],a[32:35]
s_waitcnt vmcnt(9)
s_add_u32 s47,s76,21504
v_fma_f32 v238,-4.0,v234,v236
v_fmac_f32 v232,s45,v236
M a[32:35],a[244:247],a[236:239],a[32:35]
s_waitcnt vmcnt(8)
v_fmac_f32 v237,s41,v235
v_sub_f32 v236,v236,v234
M a[32:35],a[240:243],v[228:231],a[32:35]
v_fma_f32 v234,-4.0,v233,v235
v_sub_f32 v235,v235,v233
M a[36:39],a[240:243],a[204:207],a[36:39]
buffer_load_dwordx4 v[224:227],v250,s[20:23],s47 offen offset:0 sc1
M a[36:39],a[244:247],v[228:231],a[36:39]
v_add_f32 v233,v238,v234
v_sub_f32 v238,v238,v234
M a[36:39],a[252:255],a[236:239],a[36:39]
v_fma_f32 v234,2.0,v235,v236
v_fmac_f32 v236,-2.0,v235
M a[40:43],a[252:255],v[228:231],a[40:43]
v_and_b32 v211,s42,v211
v_and_b32 v205,s42,v205
M a[40:43],a[244:247],a[204:207],a[40:43]
v_and_b32 v209,s42,v209
v_and_b32 v207,s42,v207
M a[40:43],a[240:243],a[200:203],a[40:43]
v_and_b32 v215,s42,v215
v_and_b32 v213,s42,v213
M a[44:47],a[240:243],v[216:219],a[44:47]
v_fmac_f32 v205,s43,v211
v_fmac_f32 v207,4.0,v209
M a[44:47],a[244:247],a[200:203],a[44:47]
v_fma_f32 v235,-4.0,v211,v215
v_fmac_f32 v205,s45,v215
M a[44:47],a[252:255],a[204:207],a[44:47]
v_fmac_f32 v207,s41,v213
v_sub_f32 v215,v215,v211
M a[48:51],a[252:255],a[200:203],a[48:51]
v_fma_f32 v211,-4.0,v209,v213
v_sub_f32 v213,v213,v209
M a[48:51],a[244:247],v[216:219],a[48:51]
v_add_f32 v209,v235,v211
v_sub_f32 v235,v235,v211
M a[48:51],a[240:243],a[196:199],a[48:51]
v_fma_f32 v211,2.0,v213,v215
v_fmac_f32 v215,-2.0,v213
M a[52:55],a[240:243],a[216:219],a[52:55]
v_cvt_pk_bf16_f32 v205,v232,v205
v_cvt_pk_bf16_f32 v207,v237,v207
M a[52:55],a[244:247],a[196:199],a[52:55]
v_cvt_pk_bf16_f32 v209,v233,v209
v_cvt_pk_bf16_f32 v213,v234,v211
M a[52:55],a[252:255],v[216:219],a[52:55]
v_cvt_pk_bf16_f32 v211,v238,v235
v_cvt_pk_bf16_f32 v215,v236,v215
M a[56:59],a[252:255],a[196:199],a[56:59]
v_fmac_f32 v239,s43,v241
v_fmac_f32 v244,4.0,v240
M a[56:59],a[244:247],a[216:219],a[56:59]
v_fma_f32 v232,-4.0,v241,v243
v_fmac_f32 v239,s45,v243
M a[56:59],a[240:243],a[228:231],a[56:59]
v_fmac_f32 v244,s41,v242
v_sub_f32 v243,v243,v241
M a[60:63],a[240:243],v[220:223],a[60:63]
buffer_load_dwordx4 a[240:243],v250,s[20:23],s47 offen offset:1024 sc1
M a[60:63],a[244:247],a[228:231],a[60:63]
v_fma_f32 v241,-4.0,v240,v242
v_sub_f32 v242,v242,v240
M a[60:63],a[252:255],a[216:219],a[60:63]
s_waitcnt vmcnt(9)
buffer_load_dwordx4 a[244:247],v250,s[20:23],s47 offen offset:2048 sc1
M a[64:67],a[232:235],a[212:215],a[64:67]
s_waitcnt vmcnt(9)
s_add_u32 s48,s76,24576
v_add_f32 v240,v232,v241
v_sub_f32 v232,v232,v241
M a[64:67],a[192:195],a[236:239],a[64:67]
s_waitcnt vmcnt(8)
v_fma_f32 v241,2.0,v242,v243
v_fmac_f32 v243,-2.0,v242
M a[64:67],a[208:211],v[228:231],a[64:67]
v_cvt_pk_bf16_f32 v233,v239,v244
v_cvt_pk_bf16_f32 v234,v240,v232
M a[68:71],a[208:211],a[204:207],a[68:71]
buffer_load_dwordx4 a[252:255],v250,s[20:23],s48 offen offset:0 sc1
M a[68:71],a[192:195],v[228:231],a[68:71]
v_cvt_pk_bf16_f32 v235,v241,v243
v_add_u32 v232,69632,v252
M a[68:71],a[232:235],a[236:239],a[68:71]
ds_write_b16 v232,v233 offset:0
M a[72:75],a[232:235],v[228:231],a[72:75]
ds_write_b16_d16_hi v232,v233 offset:8704
M a[72:75],a[192:195],a[204:207],a[72:75]
buffer_load_dwordx4 a[212:215],v250,s[20:23],s48 offen offset:1024 sc1
M a[72:75],a[208:211],a[200:203],a[72:75]
ds_write_b16 v252,v234 offset:52224
M a[76:79],a[208:211],v[216:219],a[76:79]
ds_write_b16_d16_hi v252,v234 offset:60928
M a[76:79],a[192:195],a[200:203],a[76:79]
M a[76:79],a[232:235],a[204:207],a[76:79]
buffer_load_dwordx4 a[236:239],v250,s[20:23],s48 offen offset:2048 sc1
M a[80:83],a[232:235],a[200:203],a[80:83]
s_add_u32 s46,s76,27648
M a[80:83],a[192:195],v[216:219],a[80:83]
M a[80:83],a[208:211],a[196:199],a[80:83]
M a[84:87],a[208:211],a[216:219],a[84:87]
buffer_load_dwordx4 v[228:231],v250,s[20:23],s46 offen offset:0 sc1
M a[84:87],a[192:195],a[196:199],a[84:87]
ds_read_b128 a[204:207],v248 offset:8704
M a[84:87],a[232:235],v[216:219],a[84:87]
ds_read_b128 a[200:203],v249 offset:8704
M a[88:91],a[232:235],a[196:199],a[88:91]
ds_read_b128 v[216:219],v248 offset:9216
M a[88:91],a[192:195],a[216:219],a[88:91]
ds_read_b128 a[196:199],v249 offset:9216
M a[88:91],a[208:211],a[228:231],a[88:91]
M a[92:95],a[208:211],v[220:223],a[92:95]
M a[92:95],a[192:195],a[228:231],a[92:95]
M a[92:95],a[232:235],a[216:219],a[92:95]
s_waitcnt vmcnt(11) lgkmcnt(3)
M a[96:99],a[248:251],a[204:207],a[96:99]
s_waitcnt vmcnt(8) lgkmcnt(2)
ds_read_b128 a[208:211],v248 offset:9728
M a[96:99],a[220:223],a[200:203],a[96:99]
s_waitcnt vmcnt(7) lgkmcnt(2)
ds_read_b128 v[220:223],v249 offset:9728
M a[96:99],a[224:227],v[216:219],a[96:99]
s_waitcnt lgkmcnt(2)
M a[100:103],a[224:227],a[196:199],a[100:103]
M a[100:103],a[220:223],v[216:219],a[100:103]
M a[100:103],a[248:251],a[200:203],a[100:103]
M a[104:107],a[248:251],v[216:219],a[104:107]
ds_read_b128 a[192:195],v248 offset:10240
M a[104:107],a[220:223],a[196:199],a[104:107]
s_waitcnt lgkmcnt(2)
ds_read_b128 a[228:231],v249 offset:10240
M a[104:107],a[224:227],a[208:211],a[104:107]
s_waitcnt lgkmcnt(2)
M a[108:111],a[224:227],v[220:223],a[108:111]
M a[108:111],a[220:223],a[208:211],a[108:111]
M a[108:111],a[248:251],a[196:199],a[108:111]
M a[112:115],a[248:251],a[208:211],a[112:115]
ds_read_b128 a[216:219],v249 offset:10752
M a[112:115],a[220:223],v[220:223],a[112:115]
s_waitcnt lgkmcnt(2)
ds_read_b128 a[232:235],v248 offset:10752
M a[112:115],a[224:227],a[192:195],a[112:115]
s_waitcnt lgkmcnt(2)
M a[116:119],a[224:227],a[228:231],a[116:119]
M a[116:119],a[220:223],a[192:195],a[116:119]
M a[116:119],a[248:251],v[220:223],a[116:119]
M a[120:123],a[248:251],a[192:195],a[120:123]
M a[120:123],a[220:223],a[228:231],a[120:123]
s_waitcnt lgkmcnt(1)
M a[120:123],a[224:227],a[216:219],a[120:123]
s_waitcnt lgkmcnt(0)
M a[124:127],a[224:227],a[232:235],a[124:127]
buffer_load_dwordx4 a[224:227],v250,s[20:23],s46 offen offset:1024 sc1
M a[124:127],a[220:223],a[216:219],a[124:127]
M a[124:127],a[248:251],a[228:231],a[124:127]
s_waitcnt vmcnt(7)
buffer_load_dwordx4 a[220:223],v250,s[20:23],s46 offen offset:2048 sc1
M a[128:131],v[224:227],a[204:207],a[128:131]
s_waitcnt vmcnt(7)
s_add_u32 s47,s76,30720
M a[128:131],a[240:243],a[200:203],a[128:131]
s_waitcnt vmcnt(6)
M a[128:131],a[244:247],v[216:219],a[128:131]
M a[132:135],a[244:247],a[196:199],a[132:135]
buffer_load_dwordx4 a[248:251],v250,s[20:23],s47 offen offset:0 sc1
M a[132:135],a[240:243],v[216:219],a[132:135]
M a[132:135],v[224:227],a[200:203],a[132:135]
M a[136:139],v[224:227],v[216:219],a[136:139]
s_barrier
ds_write_b16 v252,v235 offset:17408
M a[136:139],a[240:243],a[196:199],a[136:139]
ds_write_b16_d16_hi v252,v235 offset:26112
M a[136:139],a[244:247],a[208:211],a[136:139]
ds_write2st64_b64 v247,v[200:201],v[202:203] offset0:34 offset1:51
M a[140:143],a[244:247],v[220:223],a[140:143]
buffer_load_dwordx4 v[200:203],v245,s[8:11],s28 offen offset:768
M a[140:143],a[240:243],a[208:211],a[140:143]
M a[140:143],v[224:227],a[196:199],a[140:143]
ds_write2st64_b64 v247,v[204:205],v[206:207] offset0:137 offset1:154
M a[144:147],v[224:227],a[208:211],a[144:147]
s_add_u32 s28,s71,1179648
buffer_load_dwordx4 v[204:207],v251,s[88:91],s28 offen offset:0
M a[144:147],a[240:243],v[220:223],a[144:147]
M a[144:147],a[244:247],a[192:195],a[144:147]
ds_write2st64_b64 v247,v[208:209],v[210:211] offset0:103 offset1:120
M a[148:151],a[244:247],a[228:231],a[148:151]
buffer_load_dwordx4 v[208:211],v245,s[8:11],s28 offen offset:0
M a[148:151],a[240:243],a[192:195],a[148:151]
M a[148:151],v[224:227],v[220:223],a[148:151]
ds_write2st64_b64 v247,v[212:213],v[214:215] offset0:35 offset1:52
M a[152:155],v[224:227],a[192:195],a[152:155]
buffer_load_dwordx4 v[212:215],v245,s[8:11],s28 offen offset:768
M a[152:155],a[240:243],a[228:231],a[152:155]
s_add_u32 s29,s66,6291456
M a[152:155],a[244:247],a[216:219],a[152:155]
M a[156:159],a[244:247],a[232:235],a[156:159]
buffer_load_dwordx4 a[244:247],v250,s[20:23],s47 offen offset:1024 sc1
M a[156:159],a[240:243],a[216:219],a[156:159]
M a[156:159],v[224:227],a[228:231],a[156:159]
s_waitcnt vmcnt(11)
M a[160:163],a[252:255],a[204:207],a[160:163]
s_waitcnt vmcnt(10)
M a[160:163],a[212:215],a[200:203],a[160:163]
s_waitcnt vmcnt(9)
buffer_load_dwordx4 a[240:243],v250,s[20:23],s47 offen offset:2048 sc1
M a[160:163],a[236:239],v[216:219],a[160:163]
s_add_u32 s48,s76,33792
M a[164:167],a[236:239],a[196:199],a[164:167]
M a[164:167],a[212:215],v[216:219],a[164:167]
M a[164:167],a[252:255],a[200:203],a[164:167]
buffer_load_dwordx4 v[224:227],v250,s[20:23],s48 offen offset:0 sc1
M a[168:171],a[252:255],v[216:219],a[168:171]
M a[168:171],a[212:215],a[196:199],a[168:171]
M a[168:171],a[236:239],a[208:211],a[168:171]
M a[172:175],a[236:239],v[220:223],a[172:175]
buffer_load_dwordx4 a[204:207],v250,s[20:23],s48 offen offset:1024 sc1
M a[172:175],a[212:215],a[208:211],a[172:175]
M a[172:175],a[252:255],a[196:199],a[172:175]
M a[176:179],a[252:255],a[208:211],a[176:179]
M a[176:179],a[212:215],v[220:223],a[176:179]
buffer_load_dwordx4 a[200:203],v250,s[20:23],s48 offen offset:2048 sc1
M a[176:179],a[236:239],a[192:195],a[176:179]
s_add_u32 s46,s76,36864
M a[180:183],a[236:239],a[228:231],a[180:183]
v_permlane32_swap_b32 v196,v198
v_permlane32_swap_b32 v192,v194
M a[180:183],a[212:215],a[192:195],a[180:183]
s_waitcnt vmcnt(8)
ds_read_b128 a[196:199],v248 offset:17408
v_permlane32_swap_b32 v200,v202
M a[180:183],a[252:255],v[220:223],a[180:183]
buffer_load_dwordx4 v[216:219],v250,s[20:23],s46 offen offset:0 sc1
M a[184:187],a[252:255],a[192:195],a[184:187]
ds_read_b128 a[208:211],v249 offset:17408
ds_read_b128 v[220:223],v248 offset:17920
M a[184:187],a[212:215],a[228:231],a[184:187]
ds_read_b128 a[192:195],v249 offset:17920
v_lshlrev_b32 v234,16,v198
M a[184:187],a[236:239],a[216:219],a[184:187]
v_lshlrev_b32 v232,16,v192
v_lshlrev_b32 v233,16,v196
M a[188:191],a[236:239],a[232:235],a[188:191]
buffer_load_short_d16_hi v239,v246,s[12:15],s29 offen offset:0
M a[188:191],a[212:215],a[216:219],a[188:191]
v_lshlrev_b32 v237,16,v194
v_lshlrev_b32 v236,16,v202
M a[188:191],a[252:255],a[228:231],a[188:191]
s_waitcnt lgkmcnt(3)
buffer_load_short_d16_hi v240,v246,s[8:11],s29 offen offset:0
M v[0:3],v[228:231],a[196:199],v[0:3]
s_waitcnt lgkmcnt(2)
ds_read_b128 a[232:235],v248 offset:18432
v_lshlrev_b32 v235,16,v200
M v[0:3],a[224:227],a[208:211],v[0:3]
s_waitcnt lgkmcnt(2)
buffer_load_short_d16_hi v241,v246,s[8:11],s29 offen offset:384
M v[0:3],a[220:223],v[220:223],v[0:3]
s_waitcnt lgkmcnt(1)
ds_read_b128 a[236:239],v249 offset:18432
v_fmac_f32 v232,s43,v234
M v[4:7],a[220:223],a[192:195],v[4:7]
buffer_load_short_d16_hi v242,v246,s[8:11],s29 offen offset:768
M v[4:7],a[224:227],v[220:223],v[4:7]
v_fmac_f32 v237,4.0,v233
v_fma_f32 v238,-4.0,v234,v236
M v[4:7],v[228:231],a[208:211],v[4:7]
buffer_load_short_d16_hi v243,v246,s[8:11],s29 offen offset:1152
M v[8:11],v[228:231],v[220:223],v[8:11]
ds_read_b128 a[212:215],v248 offset:18944
v_fmac_f32 v232,s45,v236
M v[8:11],a[224:227],a[192:195],v[8:11]
s_waitcnt lgkmcnt(2)
buffer_load_short_d16_hi v244,v246,s[16:19],s29 offen offset:1536
M v[8:11],a[220:223],a[232:235],v[8:11]
s_waitcnt lgkmcnt(1)
ds_read_b128 a[216:219],v249 offset:18944
v_fmac_f32 v237,s41,v235
M v[12:15],a[220:223],a[236:239],v[12:15]
v_sub_f32 v236,v236,v234
v_fma_f32 v234,-4.0,v233,v235
M v[12:15],a[224:227],a[232:235],v[12:15]
v_sub_f32 v235,v235,v233
v_add_f32 v233,v238,v234
M v[12:15],v[228:231],a[192:195],v[12:15]
v_sub_f32 v238,v238,v234
v_fma_f32 v234,2.0,v235,v236
M v[16:19],v[228:231],a[232:235],v[16:19]
ds_read_b128 a[228:231],v249 offset:19456
v_fmac_f32 v236,-2.0,v235
M v[16:19],a[224:227],a[236:239],v[16:19]
s_waitcnt lgkmcnt(2)
ds_read_b128 a[252:255],v248 offset:19456
v_and_b32 v198,s42,v198
M v[16:19],a[220:223],a[212:215],v[16:19]
s_waitcnt lgkmcnt(2)
v_and_b32 v192,s42,v192
v_and_b32 v196,s42,v196
M v[20:23],a[220:223],a[216:219],v[20:23]
v_and_b32 v194,s42,v194
v_and_b32 v202,s42,v202
M v[20:23],a[224:227],a[212:215],v[20:23]
v_and_b32 v200,s42,v200
v_fmac_f32 v192,s43,v198
M v[20:23],v[228:231],a[236:239],v[20:23]
v_fmac_f32 v194,4.0,v196
v_fma_f32 v235,-4.0,v198,v202
M v[24:27],v[228:231],a[212:215],v[24:27]
v_fmac_f32 v192,s45,v202
v_fmac_f32 v194,s41,v200
M v[24:27],a[224:227],a[216:219],v[24:27]
s_waitcnt lgkmcnt(1)
v_sub_f32 v202,v202,v198
v_fma_f32 v198,-4.0,v196,v200
M v[24:27],a[220:223],a[228:231],v[24:27]
s_waitcnt lgkmcnt(0)
v_sub_f32 v200,v200,v196
v_add_f32 v196,v235,v198
M v[28:31],a[220:223],a[252:255],v[28:31]
buffer_load_dwordx4 a[220:223],v250,s[20:23],s46 offen offset:1024 sc1
M v[28:31],a[224:227],a[228:231],v[28:31]
v_sub_f32 v235,v235,v198
v_fma_f32 v198,2.0,v200,v202
M v[28:31],v[228:231],a[216:219],v[28:31]
buffer_load_dwordx4 a[224:227],v250,s[20:23],s46 offen offset:2048 sc1
M v[32:35],a[248:251],a[196:199],v[32:35]
s_waitcnt vmcnt(13)
s_add_u32 s47,s76,39936
v_fmac_f32 v202,-2.0,v200
v_cvt_pk_bf16_f32 v192,v232,v192
M v[32:35],a[244:247],a[208:211],v[32:35]
s_waitcnt vmcnt(12)
v_cvt_pk_bf16_f32 v194,v237,v194
v_cvt_pk_bf16_f32 v196,v233,v196
M v[32:35],a[240:243],v[220:223],v[32:35]
v_cvt_pk_bf16_f32 v200,v234,v198
v_cvt_pk_bf16_f32 v198,v238,v235
M v[36:39],a[240:243],a[192:195],v[36:39]
buffer_load_dwordx4 v[228:231],v250,s[20:23],s47 offen offset:0 sc1
M v[36:39],a[244:247],v[220:223],v[36:39]
v_cvt_pk_bf16_f32 v202,v236,v202
v_permlane32_swap_b32 v197,v199
M v[36:39],a[248:251],a[208:211],v[36:39]
v_permlane32_swap_b32 v193,v195
v_permlane32_swap_b32 v201,v203
M v[40:43],a[248:251],v[220:223],v[40:43]
v_lshlrev_b32 v234,16,v199
v_lshlrev_b32 v232,16,v193
M v[40:43],a[244:247],a[192:195],v[40:43]
v_lshlrev_b32 v233,16,v197
v_lshlrev_b32 v237,16,v195
M v[40:43],a[240:243],a[232:235],v[40:43]
v_lshlrev_b32 v236,16,v203
v_lshlrev_b32 v235,16,v201
M v[44:47],a[240:243],a[236:239],v[44:47]
v_fmac_f32 v232,s43,v234
v_fmac_f32 v237,4.0,v233
M v[44:47],a[244:247],a[232:235],v[44:47]
v_fma_f32 v238,-4.0,v234,v236
v_fmac_f32 v232,s45,v236
M v[44:47],a[248:251],a[192:195],v[44:47]
v_fmac_f32 v237,s41,v235
v_sub_f32 v236,v236,v234
M v[48:51],a[248:251],a[232:235],v[48:51]
v_fma_f32 v234,-4.0,v233,v235
v_sub_f32 v235,v235,v233
M v[48:51],a[244:247],a[236:239],v[48:51]
v_add_f32 v233,v238,v234
v_sub_f32 v238,v238,v234
M v[48:51],a[240:243],a[212:215],v[48:51]
v_fma_f32 v234,2.0,v235,v236
v_fmac_f32 v236,-2.0,v235
M v[52:55],a[240:243],a[216:219],v[52:55]
v_and_b32 v199,s42,v199
v_and_b32 v193,s42,v193
M v[52:55],a[244:247],a[212:215],v[52:55]
v_and_b32 v197,s42,v197
v_and_b32 v195,s42,v195
M v[52:55],a[248:251],a[236:239],v[52:55]
v_and_b32 v203,s42,v203
v_and_b32 v201,s42,v201
M v[56:59],a[248:251],a[212:215],v[56:59]
v_fmac_f32 v193,s43,v199
v_fmac_f32 v195,4.0,v197
M v[56:59],a[244:247],a[216:219],v[56:59]
v_fma_f32 v235,-4.0,v199,v203
v_fmac_f32 v193,s45,v203
M v[56:59],a[240:243],a[228:231],v[56:59]
v_fmac_f32 v195,s41,v201
v_sub_f32 v203,v203,v199
M v[60:63],a[240:243],a[252:255],v[60:63]
buffer_load_dwordx4 a[240:243],v250,s[20:23],s47 offen offset:1024 sc1
M v[60:63],a[244:247],a[228:231],v[60:63]
v_fma_f32 v199,-4.0,v197,v201
v_sub_f32 v201,v201,v197
M v[60:63],a[248:251],a[216:219],v[60:63]
s_waitcnt vmcnt(13)
buffer_load_dwordx4 a[244:247],v250,s[20:23],s47 offen offset:2048 sc1
M v[64:67],v[224:227],a[196:199],v[64:67]
s_waitcnt vmcnt(13)
s_add_u32 s48,s76,43008
v_add_f32 v197,v235,v199
v_sub_f32 v235,v235,v199
M v[64:67],a[204:207],a[208:211],v[64:67]
s_waitcnt vmcnt(12)
v_fma_f32 v199,2.0,v201,v203
v_fmac_f32 v203,-2.0,v201
M v[64:67],a[200:203],v[220:223],v[64:67]
v_cvt_pk_bf16_f32 v193,v232,v193
v_cvt_pk_bf16_f32 v195,v237,v195
M v[68:71],a[200:203],a[192:195],v[68:71]
buffer_load_dwordx4 a[248:251],v250,s[20:23],s48 offen offset:0 sc1
M v[68:71],a[204:207],v[220:223],v[68:71]
v_cvt_pk_bf16_f32 v197,v233,v197
v_cvt_pk_bf16_f32 v201,v234,v199
M v[68:71],v[224:227],a[208:211],v[68:71]
v_cvt_pk_bf16_f32 v199,v238,v235
v_cvt_pk_bf16_f32 v203,v236,v203
M v[72:75],v[224:227],v[220:223],v[72:75]
v_permlane32_swap_b32 v208,v210
v_permlane32_swap_b32 v204,v206
M v[72:75],a[204:207],a[192:195],v[72:75]
buffer_load_dwordx4 a[196:199],v250,s[20:23],s48 offen offset:1024 sc1
M v[72:75],a[200:203],a[232:235],v[72:75]
ds_write2st64_b64 v247,v[192:193],v[194:195] offset0:138 offset1:155
M v[76:79],a[200:203],a[236:239],v[76:79]
s_add_u32 s28,s66,6291456
v_permlane32_swap_b32 v212,v214
v_lshlrev_b32 v234,16,v210
M v[76:79],a[204:207],a[232:235],v[76:79]
v_lshlrev_b32 v232,16,v204
v_lshlrev_b32 v233,16,v208
M v[76:79],v[224:227],a[192:195],v[76:79]
buffer_load_dwordx4 a[208:211],v250,s[20:23],s48 offen offset:2048 sc1
M v[80:83],v[224:227],a[232:235],v[80:83]
s_add_u32 s46,s77,9216
v_lshlrev_b32 v237,16,v206
v_lshlrev_b32 v236,16,v214
M v[80:83],a[204:207],a[236:239],v[80:83]
v_lshlrev_b32 v235,16,v212
v_fmac_f32 v232,s43,v234
M v[80:83],a[200:203],a[212:215],v[80:83]
ds_write2st64_b64 v247,v[196:197],v[198:199] offset0:104 offset1:121
M v[84:87],a[200:203],a[216:219],v[84:87]
buffer_load_dwordx4 v[220:223],v250,s[20:23],s46 offen offset:0 sc1
M v[84:87],a[204:207],a[212:215],v[84:87]
ds_read_b128 a[192:195],v248 offset:26112
v_fmac_f32 v237,4.0,v233
M v[84:87],v[224:227],a[236:239],v[84:87]
ds_write2st64_b64 v247,v[200:201],v[202:203] offset0:36 offset1:53
M v[88:91],v[224:227],a[212:215],v[88:91]
buffer_load_dwordx4 v[192:195],v251,s[88:91],s28 offen offset:0
M v[88:91],a[204:207],a[216:219],v[88:91]
ds_read_b128 a[232:235],v249 offset:26112
ds_read_b128 a[236:239],v248 offset:26624
M v[88:91],a[200:203],a[228:231],v[88:91]
ds_read_b128 a[212:215],v249 offset:26624
v_fma_f32 v238,-4.0,v234,v236
M v[92:95],a[200:203],a[252:255],v[92:95]
buffer_load_dwordx4 v[196:199],v245,s[8:11],s28 offen offset:0
M v[92:95],a[204:207],a[228:231],v[92:95]
v_fmac_f32 v232,s45,v236
v_fmac_f32 v237,s41,v235
M v[92:95],v[224:227],a[216:219],v[92:95]
s_waitcnt vmcnt(17) lgkmcnt(4)
v_sub_f32 v236,v236,v234
v_fma_f32 v234,-4.0,v233,v235
M v[96:99],v[216:219],a[192:195],v[96:99]
s_waitcnt vmcnt(10) lgkmcnt(2)
ds_read_b128 a[200:203],v248 offset:27136
v_sub_f32 v235,v235,v233
M v[96:99],a[220:223],a[232:235],v[96:99]
s_waitcnt vmcnt(9) lgkmcnt(2)
buffer_load_dwordx4 v[200:203],v245,s[8:11],s28 offen offset:768
M v[96:99],a[224:227],a[236:239],v[96:99]
s_waitcnt lgkmcnt(1)
ds_read_b128 a[252:255],v249 offset:27136
v_add_f32 v233,v238,v234
M v[100:103],a[224:227],a[212:215],v[100:103]
v_sub_f32 v238,v238,v234
v_fma_f32 v234,2.0,v235,v236
M v[100:103],a[220:223],a[236:239],v[100:103]
v_fmac_f32 v236,-2.0,v235
v_and_b32 v210,s42,v210
M v[100:103],v[216:219],a[232:235],v[100:103]
v_and_b32 v204,s42,v204
v_and_b32 v208,s42,v208
M v[104:107],v[216:219],a[236:239],v[104:107]
ds_read_b128 a[204:207],v248 offset:27648
v_and_b32 v206,s42,v206
M v[104:107],a[220:223],a[212:215],v[104:107]
s_waitcnt lgkmcnt(2)
ds_read_b128 a[228:231],v249 offset:27648
v_and_b32 v214,s42,v214
M v[104:107],a[224:227],a[200:203],v[104:107]
s_waitcnt lgkmcnt(2)
v_and_b32 v212,s42,v212
v_fmac_f32 v204,s43,v210
M v[108:111],a[224:227],a[252:255],v[108:111]
v_fmac_f32 v206,4.0,v208
v_fma_f32 v235,-4.0,v210,v214
M v[108:111],a[220:223],a[200:203],v[108:111]
v_fmac_f32 v204,s45,v214
v_fmac_f32 v206,s41,v212
M v[108:111],v[216:219],a[212:215],v[108:111]
v_sub_f32 v214,v214,v210
v_fma_f32 v210,-4.0,v208,v212
M v[112:115],v[216:219],a[200:203],v[112:115]
ds_read_b128 a[216:219],v249 offset:28160
v_sub_f32 v212,v212,v208
M v[112:115],a[220:223],a[252:255],v[112:115]
s_waitcnt lgkmcnt(2)
ds_read_b128 v[224:227],v248 offset:28160
v_add_f32 v208,v235,v210
M v[112:115],a[224:227],a[204:207],v[112:115]
s_waitcnt lgkmcnt(2)
v_sub_f32 v235,v235,v210
v_fma_f32 v210,2.0,v212,v214
M v[116:119],a[224:227],a[228:231],v[116:119]
v_fmac_f32 v214,-2.0,v212
v_cvt_pk_bf16_f32 v204,v232,v204
M v[116:119],a[220:223],a[204:207],v[116:119]
v_cvt_pk_bf16_f32 v206,v237,v206
v_cvt_pk_bf16_f32 v208,v233,v208
M v[116:119],v[216:219],a[252:255],v[116:119]
v_cvt_pk_bf16_f32 v212,v234,v210
v_cvt_pk_bf16_f32 v210,v238,v235
M v[120:123],v[216:219],a[204:207],v[120:123]
v_cvt_pk_bf16_f32 v214,v236,v214
v_permlane32_swap_b32 v209,v211
M v[120:123],a[220:223],a[228:231],v[120:123]
s_waitcnt lgkmcnt(1)
v_permlane32_swap_b32 v205,v207
v_permlane32_swap_b32 v213,v215
M v[120:123],a[224:227],a[216:219],v[120:123]
s_waitcnt lgkmcnt(0)
v_lshlrev_b32 v234,16,v211
v_lshlrev_b32 v232,16,v205
M v[124:127],a[224:227],v[224:227],v[124:127]
buffer_load_dwordx4 a[224:227],v250,s[20:23],s46 offen offset:1024 sc1
M v[124:127],a[220:223],a[216:219],v[124:127]
v_lshlrev_b32 v233,16,v209
v_lshlrev_b32 v237,16,v207
M v[124:127],v[216:219],a[228:231],v[124:127]
s_waitcnt vmcnt(10)
buffer_load_dwordx4 a[220:223],v250,s[20:23],s46 offen offset:2048 sc1
M v[128:131],v[228:231],a[192:195],v[128:131]
s_waitcnt vmcnt(10)
s_add_u32 s46,s77,18432
v_lshlrev_b32 v236,16,v215
v_lshlrev_b32 v235,16,v213
M v[128:131],a[240:243],a[232:235],v[128:131]
s_waitcnt vmcnt(9)
v_fmac_f32 v232,s43,v234
v_fmac_f32 v237,4.0,v233
M v[128:131],a[244:247],a[236:239],v[128:131]
v_fma_f32 v238,-4.0,v234,v236
v_fmac_f32 v232,s45,v236
M v[132:135],a[244:247],a[212:215],v[132:135]
buffer_load_dwordx4 v[216:219],v250,s[20:23],s46 offen offset:0 sc1
M v[132:135],a[240:243],a[236:239],v[132:135]
v_fmac_f32 v237,s41,v235
v_sub_f32 v236,v236,v234
M v[132:135],v[228:231],a[232:235],v[132:135]
v_fma_f32 v234,-4.0,v233,v235
v_sub_f32 v235,v235,v233
M v[136:139],v[228:231],a[236:239],v[136:139]
v_add_f32 v233,v238,v234
v_sub_f32 v238,v238,v234
M v[136:139],a[240:243],a[212:215],v[136:139]
v_fma_f32 v234,2.0,v235,v236
v_fmac_f32 v236,-2.0,v235
M v[136:139],a[244:247],a[200:203],v[136:139]
v_and_b32 v211,s42,v211
v_and_b32 v205,s42,v205
M v[140:143],a[244:247],a[252:255],v[140:143]
v_and_b32 v209,s42,v209
v_and_b32 v207,s42,v207
M v[140:143],a[240:243],a[200:203],v[140:143]
v_and_b32 v215,s42,v215
v_and_b32 v213,s42,v213
M v[140:143],v[228:231],a[212:215],v[140:143]
v_fmac_f32 v205,s43,v211
v_fmac_f32 v207,4.0,v209
M v[144:147],v[228:231],a[200:203],v[144:147]
v_fma_f32 v235,-4.0,v211,v215
v_fmac_f32 v205,s45,v215
M v[144:147],a[240:243],a[252:255],v[144:147]
v_fmac_f32 v207,s41,v213
v_sub_f32 v215,v215,v211
M v[144:147],a[244:247],a[204:207],v[144:147]
v_fma_f32 v211,-4.0,v209,v213
v_sub_f32 v213,v213,v209
M v[148:151],a[244:247],a[228:231],v[148:151]
v_add_f32 v209,v235,v211
v_sub_f32 v235,v235,v211
M v[148:151],a[240:243],a[204:207],v[148:151]
v_fma_f32 v211,2.0,v213,v215
v_fmac_f32 v215,-2.0,v213
M v[148:151],v[228:231],a[252:255],v[148:151]
v_cvt_pk_bf16_f32 v205,v232,v205
v_cvt_pk_bf16_f32 v207,v237,v207
M v[152:155],v[228:231],a[204:207],v[152:155]
v_cvt_pk_bf16_f32 v209,v233,v209
v_cvt_pk_bf16_f32 v213,v234,v211
M v[152:155],a[240:243],a[228:231],v[152:155]
v_cvt_pk_bf16_f32 v211,v238,v235
v_cvt_pk_bf16_f32 v215,v236,v215
M v[152:155],a[244:247],a[216:219],v[152:155]
ds_write2st64_b64 v247,v[204:205],v[206:207] offset0:139 offset1:156
M v[156:159],a[244:247],v[224:227],v[156:159]
buffer_load_dwordx4 a[244:247],v250,s[20:23],s46 offen offset:1024 sc1
M v[156:159],a[240:243],a[216:219],v[156:159]
M v[156:159],v[228:231],a[228:231],v[156:159]
s_waitcnt vmcnt(10)
buffer_load_dwordx4 a[240:243],v250,s[20:23],s46 offen offset:2048 sc1
M v[160:163],a[248:251],a[192:195],v[160:163]
s_waitcnt vmcnt(10)
s_add_u32 s46,s77,27648
M v[160:163],a[196:199],a[232:235],v[160:163]
s_waitcnt vmcnt(9)
M v[160:163],a[208:211],a[236:239],v[160:163]
ds_write2st64_b64 v247,v[208:209],v[210:211] offset0:105 offset1:122
M v[164:167],a[208:211],a[212:215],v[164:167]
buffer_load_dwordx4 v[228:231],v250,s[20:23],s46 offen offset:0 sc1
M v[164:167],a[196:199],a[236:239],v[164:167]
s_waitcnt vmcnt(7)
v_permlane32_swap_b32 v196,v198
v_permlane32_swap_b32 v192,v194
M v[164:167],a[248:251],a[232:235],v[164:167]
ds_write2st64_b64 v247,v[212:213],v[214:215] offset0:37 offset1:54
M v[168:171],a[248:251],a[236:239],v[168:171]
buffer_load_dwordx4 a[192:195],v250,s[20:23],s46 offen offset:1024 sc1
M v[168:171],a[196:199],a[212:215],v[168:171]
s_waitcnt vmcnt(7)
v_permlane32_swap_b32 v200,v202
v_lshlrev_b32 v234,16,v198
M v[168:171],a[208:211],a[200:203],v[168:171]
v_lshlrev_b32 v232,16,v192
v_lshlrev_b32 v233,16,v196
M v[172:175],a[208:211],a[252:255],v[172:175]
v_lshlrev_b32 v237,16,v194
v_lshlrev_b32 v236,16,v202
M v[172:175],a[196:199],a[200:203],v[172:175]
buffer_load_dwordx4 a[232:235],v250,s[20:23],s46 offen offset:2048 sc1
M v[172:175],a[248:251],a[212:215],v[172:175]
s_add_u32 s46,s77,36864
v_lshlrev_b32 v235,16,v200
v_fmac_f32 v232,s43,v234
M v[176:179],a[248:251],a[200:203],v[176:179]
v_fmac_f32 v237,4.0,v233
v_fma_f32 v238,-4.0,v234,v236
M v[176:179],a[196:199],a[252:255],v[176:179]
v_fmac_f32 v232,s45,v236
v_fmac_f32 v237,s41,v235
M v[176:179],a[208:211],a[204:207],v[176:179]
s_waitcnt lgkmcnt(0)
s_barrier
v_sub_f32 v236,v236,v234
M v[180:183],a[208:211],a[228:231],v[180:183]
buffer_load_dwordx4 a[236:239],v250,s[20:23],s46 offen offset:0 sc1
M v[180:183],a[196:199],a[204:207],v[180:183]
ds_read_b128 a[212:215],v248 offset:34816
v_fma_f32 v234,-4.0,v233,v235
M v[180:183],a[248:251],a[252:255],v[180:183]
ds_read_b128 a[200:203],v249 offset:34816
v_sub_f32 v235,v235,v233
M v[184:187],a[248:251],a[204:207],v[184:187]
ds_read_b128 a[252:255],v248 offset:35328
v_add_f32 v233,v238,v234
M v[184:187],a[196:199],a[228:231],v[184:187]
ds_read_b128 a[204:207],v249 offset:35328
v_sub_f32 v238,v238,v234
M v[184:187],a[208:211],a[216:219],v[184:187]
v_fma_f32 v234,2.0,v235,v236
v_fmac_f32 v236,-2.0,v235
M v[188:191],a[208:211],v[224:227],v[188:191]
buffer_load_dwordx4 a[208:211],v250,s[20:23],s46 offen offset:1024 sc1
M v[188:191],a[196:199],a[216:219],v[188:191]
v_and_b32 v198,s42,v198
v_and_b32 v192,s42,v192
M v[188:191],a[248:251],a[228:231],v[188:191]
s_waitcnt lgkmcnt(3)
buffer_load_dwordx4 v[224:227],v250,s[20:23],s46 offen offset:2048 sc1
M a[0:3],v[220:223],a[212:215],a[0:3]
s_waitcnt vmcnt(10) lgkmcnt(2)
s_add_u32 s47,s77,12288
ds_read_b128 a[216:219],v248 offset:35840
v_and_b32 v196,s42,v196
M a[0:3],a[224:227],a[200:203],a[0:3]
s_waitcnt vmcnt(9) lgkmcnt(2)
ds_read_b128 a[228:231],v249 offset:35840
v_and_b32 v194,s42,v194
M a[0:3],a[220:223],a[252:255],a[0:3]
s_waitcnt lgkmcnt(2)
v_and_b32 v202,s42,v202
v_and_b32 v200,s42,v200
M a[4:7],a[220:223],a[204:207],a[4:7]
buffer_load_dwordx4 a[196:199],v250,s[20:23],s47 offen offset:0 sc1
M a[4:7],a[224:227],a[252:255],a[4:7]
v_fmac_f32 v192,s43,v198
v_fmac_f32 v194,4.0,v196
M a[4:7],v[220:223],a[200:203],a[4:7]
v_fma_f32 v235,-4.0,v198,v202
v_fmac_f32 v192,s45,v202
M a[8:11],v[220:223],a[252:255],a[8:11]
ds_read_b128 a[248:251],v248 offset:36352
v_fmac_f32 v194,s41,v200
M a[8:11],a[224:227],a[204:207],a[8:11]
s_waitcnt lgkmcnt(2)
ds_read_b128 a[212:215],v249 offset:36352
v_sub_f32 v202,v202,v198
M a[8:11],a[220:223],a[216:219],a[8:11]
s_waitcnt lgkmcnt(2)
v_fma_f32 v198,-4.0,v196,v200
v_sub_f32 v200,v200,v196
M a[12:15],a[220:223],a[228:231],a[12:15]
v_add_f32 v196,v235,v198
v_sub_f32 v235,v235,v198
M a[12:15],a[224:227],a[216:219],a[12:15]
v_fma_f32 v198,2.0,v200,v202
v_fmac_f32 v202,-2.0,v200
M a[12:15],v[220:223],a[204:207],a[12:15]
v_cvt_pk_bf16_f32 v192,v232,v192
v_cvt_pk_bf16_f32 v194,v237,v194
M a[16:19],v[220:223],a[216:219],a[16:19]
ds_read_b128 a[200:203],v249 offset:36864
v_cvt_pk_bf16_f32 v196,v233,v196
M a[16:19],a[224:227],a[228:231],a[16:19]
s_waitcnt lgkmcnt(2)
ds_read_b128 a[252:255],v248 offset:36864
v_cvt_pk_bf16_f32 v200,v234,v198
M a[16:19],a[220:223],a[248:251],a[16:19]
s_waitcnt lgkmcnt(2)
v_cvt_pk_bf16_f32 v198,v238,v235
v_cvt_pk_bf16_f32 v202,v236,v202
M a[20:23],a[220:223],a[212:215],a[20:23]
v_permlane32_swap_b32 v197,v199
v_permlane32_swap_b32 v193,v195
M a[20:23],a[224:227],a[248:251],a[20:23]
ds_read_b128 a[204:207],v248 offset:43520
v_permlane32_swap_b32 v201,v203
M a[20:23],v[220:223],a[228:231],a[20:23]
ds_read_b128 a[216:219],v249 offset:43520
v_lshlrev_b32 v234,16,v199
M a[24:27],v[220:223],a[248:251],a[24:27]
ds_read_b128 a[228:231],v248 offset:44032
v_lshlrev_b32 v232,16,v193
M a[24:27],a[224:227],a[212:215],a[24:27]
s_waitcnt lgkmcnt(4)
ds_read_b128 a[248:251],v249 offset:44032
v_lshlrev_b32 v233,16,v197
M a[24:27],a[220:223],a[200:203],a[24:27]
s_waitcnt lgkmcnt(4)
v_lshlrev_b32 v237,16,v195
v_lshlrev_b32 v236,16,v203
M a[28:31],a[220:223],a[252:255],a[28:31]
buffer_load_dwordx4 a[220:223],v250,s[20:23],s47 offen offset:1024 sc1
M a[28:31],a[224:227],a[200:203],a[28:31]
v_lshlrev_b32 v235,16,v201
v_fmac_f32 v232,s43,v234
M a[28:31],v[220:223],a[212:215],a[28:31]
s_waitcnt vmcnt(10) lgkmcnt(3)
buffer_load_dwordx4 a[252:255],v250,s[20:23],s47 offen offset:2048 sc1
M a[96:99],v[216:219],a[204:207],a[96:99]
s_waitcnt vmcnt(10) lgkmcnt(2)
s_add_u32 s48,s77,15360
ds_read_b128 a[224:227],v248 offset:44544
v_fmac_f32 v237,4.0,v233
M a[96:99],a[244:247],a[216:219],a[96:99]
s_waitcnt vmcnt(9) lgkmcnt(2)
ds_read_b128 a[212:215],v249 offset:44544
v_fma_f32 v238,-4.0,v234,v236
M a[96:99],a[240:243],a[228:231],a[96:99]
s_waitcnt lgkmcnt(2)
v_fmac_f32 v232,s45,v236
v_fmac_f32 v237,s41,v235
M a[100:103],a[240:243],a[248:251],a[100:103]
buffer_load_dwordx4 a[200:203],v250,s[20:23],s48 offen offset:0 sc1
M a[100:103],a[244:247],a[228:231],a[100:103]
v_sub_f32 v236,v236,v234
v_fma_f32 v234,-4.0,v233,v235
M a[100:103],v[216:219],a[216:219],a[100:103]
v_sub_f32 v235,v235,v233
v_add_f32 v233,v238,v234
M a[104:107],v[216:219],a[228:231],a[104:107]
ds_read_b128 v[220:223],v248 offset:45056
v_sub_f32 v238,v238,v234
M a[104:107],a[244:247],a[248:251],a[104:107]
s_waitcnt lgkmcnt(2)
ds_read_b128 a[204:207],v249 offset:45056
v_fma_f32 v234,2.0,v235,v236
M a[104:107],a[240:243],a[224:227],a[104:107]
s_waitcnt lgkmcnt(2)
v_fmac_f32 v236,-2.0,v235
v_and_b32 v199,s42,v199
M a[108:111],a[240:243],a[212:215],a[108:111]
v_and_b32 v193,s42,v193
v_and_b32 v197,s42,v197
M a[108:111],a[244:247],a[224:227],a[108:111]
v_and_b32 v195,s42,v195
v_and_b32 v203,s42,v203
M a[108:111],v[216:219],a[248:251],a[108:111]
v_and_b32 v201,s42,v201
v_fmac_f32 v193,s43,v199
M a[112:115],v[216:219],a[224:227],a[112:115]
ds_read_b128 a[216:219],v249 offset:45568
v_fmac_f32 v195,4.0,v197
M a[112:115],a[244:247],a[212:215],a[112:115]
s_waitcnt lgkmcnt(2)
ds_read_b128 a[228:231],v248 offset:45568
v_and_b32 v255,256,v245
M a[112:115],a[240:243],v[220:223],a[112:115]
s_waitcnt lgkmcnt(2)
v_mul_u32_u24 v255,3,v255
v_and_or_b32 v255,v245,s42,v255
M a[116:119],a[240:243],a[204:207],a[116:119]
v_fma_f32 v235,-4.0,v199,v203
v_fmac_f32 v193,s45,v203
M a[116:119],a[244:247],v[220:223],a[116:119]
ds_read_b128 a[248:251],v248 offset:0
v_fmac_f32 v195,s41,v201
M a[116:119],v[216:219],a[212:215],a[116:119]
s_add_u32 s31,s66,6684672
ds_read_b128 a[224:227],v249 offset:0
v_sub_f32 v203,v203,v199
M a[120:123],v[216:219],v[220:223],a[120:123]
ds_read_b128 a[212:215],v248 offset:512
v_fma_f32 v199,-4.0,v197,v201
M a[120:123],a[244:247],a[204:207],a[120:123]
s_waitcnt lgkmcnt(4)
ds_read_b128 v[220:223],v249 offset:512
v_sub_f32 v201,v201,v197
M a[120:123],a[240:243],a[216:219],a[120:123]
s_waitcnt lgkmcnt(4)
v_add_f32 v197,v235,v199
v_sub_f32 v235,v235,v199
M a[124:127],a[240:243],a[228:231],a[124:127]
buffer_load_dword a228,v255,s[8:11],s31 offen offset:0
M a[124:127],a[244:247],a[216:219],a[124:127]
v_fma_f32 v199,2.0,v201,v203
v_fmac_f32 v203,-2.0,v201
M a[124:127],v[216:219],a[204:207],a[124:127]
s_waitcnt vmcnt(10) lgkmcnt(3)
v_cvt_pk_bf16_f32 v193,v232,v193
v_cvt_pk_bf16_f32 v195,v237,v195
M v[0:3],v[228:231],a[248:251],v[0:3]
s_waitcnt vmcnt(9) lgkmcnt(2)
ds_read_b128 a[240:243],v248 offset:1024
v_cvt_pk_bf16_f32 v197,v233,v197
M v[0:3],a[192:195],a[224:227],v[0:3]
s_waitcnt vmcnt(8) lgkmcnt(2)
buffer_load_dword a228,v255,s[8:11],s31 offen offset:384
M v[0:3],a[232:235],a[212:215],v[0:3]
s_waitcnt lgkmcnt(1)
ds_read_b128 a[216:219],v249 offset:1024
v_cvt_pk_bf16_f32 v201,v234,v199
M v[4:7],a[232:235],v[220:223],v[4:7]
v_cvt_pk_bf16_f32 v199,v238,v235
v_cvt_pk_bf16_f32 v203,v236,v203
M v[4:7],a[192:195],a[212:215],v[4:7]
M v[4:7],v[228:231],a[224:227],v[4:7]
M v[8:11],v[228:231],a[212:215],v[8:11]
ds_read_b128 a[244:247],v248 offset:1536
M v[8:11],a[192:195],v[220:223],v[8:11]
s_waitcnt lgkmcnt(2)
ds_read_b128 a[204:207],v249 offset:1536
M v[8:11],a[232:235],a[240:243],v[8:11]
s_waitcnt lgkmcnt(2)
M v[12:15],a[232:235],a[216:219],v[12:15]
M v[12:15],a[192:195],a[240:243],v[12:15]
M v[12:15],v[228:231],v[220:223],v[12:15]
M v[16:19],v[228:231],a[240:243],v[16:19]
ds_read_b128 v[216:219],v249 offset:2048
M v[16:19],a[192:195],a[216:219],v[16:19]
s_waitcnt lgkmcnt(2)
buffer_load_dwordx4 a[228:231],v250,s[20:23],s48 offen offset:1024 sc1
M v[16:19],a[232:235],a[244:247],v[16:19]
s_waitcnt lgkmcnt(1)
ds_read_b128 a[248:251],v248 offset:2048
M v[20:23],a[232:235],a[204:207],v[20:23]
buffer_load_dwordx4 a[224:227],v250,s[20:23],s48 offen offset:2048 sc1
M v[20:23],a[192:195],a[244:247],v[20:23]
ds_read_b128 a[212:215],v248 offset:8704
M v[20:23],v[228:231],a[216:219],v[20:23]
ds_read_b128 v[220:223],v249 offset:8704
M v[24:27],v[228:231],a[244:247],v[24:27]
ds_read_b128 a[240:243],v248 offset:9216
M v[24:27],a[192:195],a[204:207],v[24:27]
s_waitcnt lgkmcnt(4)
ds_read_b128 a[216:219],v249 offset:9216
M v[24:27],a[232:235],v[216:219],v[24:27]
s_waitcnt lgkmcnt(4)
M v[28:31],a[232:235],a[248:251],v[28:31]
s_add_u32 s47,s77,21504
M v[28:31],a[192:195],v[216:219],v[28:31]
M v[28:31],v[228:231],a[204:207],v[28:31]
s_waitcnt vmcnt(10) lgkmcnt(3)
M v[96:99],a[236:239],a[212:215],v[96:99]
s_waitcnt vmcnt(9) lgkmcnt(2)
ds_read_b128 a[244:247],v248 offset:9728
M v[96:99],a[208:211],v[220:223],v[96:99]
s_waitcnt vmcnt(8) lgkmcnt(2)
ds_read_b128 a[232:235],v249 offset:9728
M v[96:99],v[224:227],a[240:243],v[96:99]
s_waitcnt lgkmcnt(2)
M v[100:103],v[224:227],a[216:219],v[100:103]
buffer_load_dwordx4 a[248:251],v250,s[20:23],s47 offen offset:0 sc1
M v[100:103],a[208:211],a[240:243],v[100:103]
M v[100:103],a[236:239],v[220:223],v[100:103]
buffer_load_dwordx4 a[192:195],v250,s[20:23],s47 offen offset:1024 sc1
M v[104:107],a[236:239],a[240:243],v[104:107]
ds_read_b128 v[228:231],v248 offset:10240
v_accvgpr_read_b32 v238,a0
M v[104:107],a[208:211],a[216:219],v[104:107]
s_waitcnt lgkmcnt(2)
ds_read_b128 a[212:215],v249 offset:10240
v_accvgpr_read_b32 v232,a96
M v[104:107],v[224:227],a[244:247],v[104:107]
s_waitcnt lgkmcnt(2)
v_add_f32 v234,v238,v232
v_sub_f32 v238,v238,v232
M v[108:111],v[224:227],a[232:235],v[108:111]
buffer_load_dwordx4 v[216:219],v250,s[20:23],s47 offen offset:2048 sc1
M v[108:111],a[208:211],a[244:247],v[108:111]
s_add_u32 s48,s77,24576
v_add_f32 v232,v0,v96
v_sub_f32 v96,v0,v96
M v[108:111],a[236:239],a[216:219],v[108:111]
v_add_f32 v0,v234,v232
v_fmac_f32 v234,4.0,v232
M v[112:115],a[236:239],a[244:247],v[112:115]
ds_read_b128 v[220:223],v249 offset:10752
v_fma_f32 v232,2.0,v96,v238
M v[112:115],a[208:211],a[232:235],v[112:115]
s_waitcnt lgkmcnt(2)
buffer_load_dwordx4 a[204:207],v250,s[20:23],s48 offen offset:0 sc1
M v[112:115],v[224:227],v[228:231],v[112:115]
s_waitcnt lgkmcnt(1)
ds_read_b128 a[240:243],v248 offset:10752
v_fma_f32 v96,s40,v96,v238
M v[116:119],v[224:227],a[212:215],v[116:119]
v_accvgpr_read_b32 v238,a1
v_accvgpr_read_b32 v237,a97
M v[116:119],a[208:211],v[228:231],v[116:119]
ds_read_b128 a[216:219],v248 offset:34816
v_add_f32 v236,v238,v237
M v[116:119],a[236:239],a[232:235],v[116:119]
ds_read_b128 a[244:247],v249 offset:34816
v_sub_f32 v238,v238,v237
M v[120:123],a[236:239],v[228:231],v[120:123]
ds_read_b128 a[232:235],v248 offset:35328
v_add_f32 v237,v1,v97
M v[120:123],a[208:211],a[212:215],v[120:123]
s_waitcnt lgkmcnt(4)
ds_read_b128 v[228:231],v249 offset:35328
v_sub_f32 v97,v1,v97
M v[120:123],v[224:227],v[220:223],v[120:123]
s_waitcnt lgkmcnt(4)
v_add_f32 v1,v236,v237
v_fmac_f32 v236,4.0,v237
M v[124:127],v[224:227],a[240:243],v[124:127]
v_fma_f32 v237,2.0,v97,v238
v_fma_f32 v97,s40,v97,v238
M v[124:127],a[208:211],v[220:223],v[124:127]
v_cvt_pk_bf16_f32 v232,v232,v237
v_cvt_pk_bf16_f32 v234,v234,v236
M v[124:127],a[236:239],a[212:215],v[124:127]
s_waitcnt vmcnt(11) lgkmcnt(3)
v_accvgpr_read_b32 v238,a2
v_accvgpr_read_b32 v233,a98
M a[32:35],a[196:199],a[216:219],a[32:35]
s_waitcnt vmcnt(10) lgkmcnt(2)
ds_read_b128 a[240:243],v248 offset:35840
v_add_f32 v235,v238,v233
M a[32:35],a[220:223],a[244:247],a[32:35]
s_waitcnt vmcnt(9) lgkmcnt(2)
ds_read_b128 v[224:227],v249 offset:35840
v_sub_f32 v238,v238,v233
M a[32:35],a[252:255],a[232:235],a[32:35]
s_waitcnt lgkmcnt(2)
v_add_f32 v233,v2,v98
v_sub_f32 v98,v2,v98
M a[36:39],a[252:255],v[228:231],a[36:39]
v_add_f32 v2,v235,v233
v_fmac_f32 v235,4.0,v233
M a[36:39],a[220:223],a[232:235],a[36:39]
v_fma_f32 v233,2.0,v98,v238
v_fma_f32 v98,s40,v98,v238
M a[36:39],a[196:199],a[244:247],a[36:39]
v_accvgpr_read_b32 v238,a3
v_accvgpr_read_b32 v237,a99
M a[40:43],a[196:199],a[232:235],a[40:43]
ds_read_b128 a[96:99],v248 offset:36352
v_add_f32 v236,v238,v237
M a[40:43],a[220:223],v[228:231],a[40:43]
s_waitcnt lgkmcnt(2)
ds_read_b128 a[208:211],v249 offset:36352
v_sub_f32 v238,v238,v237
M a[40:43],a[252:255],a[240:243],a[40:43]
s_waitcnt lgkmcnt(2)
v_add_f32 v237,v3,v99
v_sub_f32 v99,v3,v99
M a[44:47],a[252:255],v[224:227],a[44:47]
v_add_f32 v3,v236,v237
v_fmac_f32 v236,4.0,v237
M a[44:47],a[220:223],a[240:243],a[44:47]
v_fma_f32 v237,2.0,v99,v238
v_fma_f32 v99,s40,v99,v238
M a[44:47],a[196:199],v[228:231],a[44:47]
v_cvt_pk_bf16_f32 v233,v233,v237
v_cvt_pk_bf16_f32 v235,v235,v236
M a[48:51],a[196:199],a[240:243],a[48:51]
ds_read_b128 v[220:223],v249 offset:36864
ds_write2st64_b64 v254,v[232:233],v[234:235] offset0:68 offset1:72
M a[48:51],a[220:223],v[224:227],a[48:51]
s_waitcnt lgkmcnt(3)
ds_read_b128 a[212:215],v248 offset:36864
v_accvgpr_read_b32 v238,a4
M a[48:51],a[252:255],a[96:99],a[48:51]
s_waitcnt lgkmcnt(3)
v_accvgpr_read_b32 v232,a100
v_add_f32 v234,v238,v232
M a[52:55],a[252:255],a[208:211],a[52:55]
buffer_load_dwordx4 a[236:239],v250,s[20:23],s48 offen offset:1024 sc1
M a[52:55],a[220:223],a[96:99],a[52:55]
v_sub_f32 v238,v238,v232
v_add_f32 v232,v4,v100
M a[52:55],a[196:199],v[224:227],a[52:55]
v_sub_f32 v100,v4,v100
v_add_f32 v4,v234,v232
M a[56:59],a[196:199],a[96:99],a[56:59]
v_fmac_f32 v234,4.0,v232
v_fma_f32 v232,2.0,v100,v238
M a[56:59],a[220:223],a[208:211],a[56:59]
s_waitcnt lgkmcnt(2)
v_fma_f32 v100,s40,v100,v238
v_accvgpr_read_b32 v238,a5
M a[56:59],a[252:255],v[220:223],a[56:59]
s_waitcnt lgkmcnt(0)
v_accvgpr_read_b32 v237,a101
v_add_f32 v236,v238,v237
M a[60:63],a[252:255],a[212:215],a[60:63]
buffer_load_dwordx4 a[252:255],v250,s[20:23],s48 offen offset:2048 sc1
M a[60:63],a[220:223],v[220:223],a[60:63]
s_add_u32 s47,s77,30720
v_sub_f32 v238,v238,v237
v_add_f32 v237,v5,v101
M a[60:63],a[196:199],a[208:211],a[60:63]
s_waitcnt vmcnt(10)
buffer_load_dwordx4 a[220:223],v250,s[20:23],s47 offen offset:0 sc1
M a[64:67],a[200:203],a[216:219],a[64:67]
s_waitcnt vmcnt(8)
v_sub_f32 v101,v5,v101
v_add_f32 v5,v236,v237
M a[64:67],a[228:231],a[244:247],a[64:67]
s_waitcnt vmcnt(7)
v_fmac_f32 v236,4.0,v237
v_fma_f32 v237,2.0,v101,v238
M a[64:67],a[224:227],a[232:235],a[64:67]
v_fma_f32 v101,s40,v101,v238
v_cvt_pk_bf16_f32 v232,v232,v237
M a[68:71],a[224:227],v[228:231],a[68:71]
buffer_load_dwordx4 a[196:199],v250,s[20:23],s47 offen offset:1024 sc1
M a[68:71],a[228:231],a[232:235],a[68:71]
v_cvt_pk_bf16_f32 v234,v234,v236
v_accvgpr_read_b32 v238,a6
M a[68:71],a[200:203],a[244:247],a[68:71]
v_accvgpr_read_b32 v233,a102
v_add_f32 v235,v238,v233
M a[72:75],a[200:203],a[232:235],a[72:75]
v_sub_f32 v238,v238,v233
v_add_f32 v233,v6,v102
M a[72:75],a[228:231],v[228:231],a[72:75]
buffer_load_dwordx4 a[216:219],v250,s[20:23],s47 offen offset:2048 sc1
M a[72:75],a[224:227],a[240:243],a[72:75]
s_add_u32 s48,s77,33792
v_sub_f32 v102,v6,v102
v_add_f32 v6,v235,v233
M a[76:79],a[224:227],v[224:227],a[76:79]
v_fmac_f32 v235,4.0,v233
v_fma_f32 v233,2.0,v102,v238
M a[76:79],a[228:231],a[240:243],a[76:79]
v_fma_f32 v102,s40,v102,v238
v_accvgpr_read_b32 v238,a7
M a[76:79],a[200:203],v[228:231],a[76:79]
buffer_load_dwordx4 a[244:247],v250,s[20:23],s48 offen offset:0 sc1
M a[80:83],a[200:203],a[240:243],a[80:83]
v_accvgpr_read_b32 v237,a103
v_add_f32 v236,v238,v237
M a[80:83],a[228:231],v[224:227],a[80:83]
v_sub_f32 v238,v238,v237
v_add_f32 v237,v7,v103
M a[80:83],a[224:227],a[96:99],a[80:83]
v_sub_f32 v103,v7,v103
v_add_f32 v7,v236,v237
M a[84:87],a[224:227],a[208:211],a[84:87]
buffer_load_dwordx4 a[232:235],v250,s[20:23],s48 offen offset:1024 sc1
M a[84:87],a[228:231],a[96:99],a[84:87]
ds_read_b128 a[100:103],v248 offset:43520
v_fmac_f32 v236,4.0,v237
M a[84:87],a[200:203],v[224:227],a[84:87]
s_add_u32 s31,s66,7077888
ds_read_b128 v[228:231],v249 offset:43520
v_fma_f32 v237,2.0,v103,v238
M a[88:91],a[200:203],a[96:99],a[88:91]
ds_read_b128 a[96:99],v248 offset:44032
v_fma_f32 v103,s40,v103,v238
M a[88:91],a[228:231],a[208:211],a[88:91]
ds_read_b128 a[240:243],v249 offset:44032
v_cvt_pk_bf16_f32 v233,v233,v237
M a[88:91],a[224:227],v[220:223],a[88:91]
v_cvt_pk_bf16_f32 v235,v235,v236
M a[92:95],a[224:227],a[212:215],a[92:95]
buffer_load_dword v224,v255,s[8:11],s31 offen offset:0
M a[92:95],a[228:231],v[220:223],a[92:95]
ds_write2st64_b64 v254,v[232:233],v[234:235] offset0:76 offset1:80
M a[92:95],a[200:203],a[208:211],a[92:95]
s_waitcnt vmcnt(11) lgkmcnt(4)
v_accvgpr_read_b32 v238,a8
v_accvgpr_read_b32 v232,a104
M a[128:131],a[248:251],a[100:103],a[128:131]
s_waitcnt vmcnt(10) lgkmcnt(3)
ds_read_b128 a[212:215],v248 offset:44544
v_add_f32 v234,v238,v232
M a[128:131],a[192:195],v[228:231],a[128:131]
s_waitcnt vmcnt(9) lgkmcnt(3)
buffer_load_dword v224,v255,s[8:11],s31 offen offset:384
M a[128:131],v[216:219],a[96:99],a[128:131]
s_waitcnt lgkmcnt(2)
ds_read_b128 a[224:227],v249 offset:44544
v_sub_f32 v238,v238,v232
M a[132:135],v[216:219],a[240:243],a[132:135]
v_add_f32 v232,v8,v104
v_sub_f32 v104,v8,v104
M a[132:135],a[192:195],a[96:99],a[132:135]
v_add_f32 v8,v234,v232
v_fmac_f32 v234,4.0,v232
M a[132:135],a[248:251],v[228:231],a[132:135]
v_fma_f32 v232,2.0,v104,v238
v_fma_f32 v104,s40,v104,v238
M a[136:139],a[248:251],a[96:99],a[136:139]
s_waitcnt lgkmcnt(2)
s_barrier
ds_read_b128 a[0:3],v250 offset:34816
M a[136:139],a[192:195],a[240:243],a[136:139]
s_waitcnt lgkmcnt(2)
ds_read_b128 a[4:7],v250 offset:38912
ds_read_b128 a[228:231],v248 offset:45056
M a[136:139],v[216:219],a[212:215],a[136:139]
s_waitcnt lgkmcnt(3)
ds_read_b128 v[220:223],v249 offset:45056
v_accvgpr_read_b32 v238,a9
M a[140:143],v[216:219],a[224:227],a[140:143]
v_accvgpr_read_b32 v237,a105
v_add_f32 v236,v238,v237
M a[140:143],a[192:195],a[212:215],a[140:143]
v_sub_f32 v238,v238,v237
v_add_f32 v237,v9,v105
M a[140:143],a[248:251],a[240:243],a[140:143]
v_sub_f32 v105,v9,v105
v_add_f32 v9,v236,v237
M a[144:147],a[248:251],a[212:215],a[144:147]
ds_read_b128 a[200:203],v249 offset:45568
v_fmac_f32 v236,4.0,v237
M a[144:147],a[192:195],a[224:227],a[144:147]
s_waitcnt lgkmcnt(2)
ds_read_b128 a[208:211],v248 offset:45568
v_fma_f32 v237,2.0,v105,v238
M a[144:147],v[216:219],a[228:231],a[144:147]
s_waitcnt lgkmcnt(2)
buffer_load_dwordx4 v[224:227],v250,s[20:23],s48 offen offset:2048 sc1
M a[148:151],v[216:219],v[220:223],a[148:151]
v_fma_f32 v105,s40,v105,v238
v_cvt_pk_bf16_f32 v232,v232,v237
M a[148:151],a[192:195],a[228:231],a[148:151]
v_cvt_pk_bf16_f32 v234,v234,v236
v_accvgpr_read_b32 v238,a10
M a[148:151],a[248:251],a[224:227],a[148:151]
v_accvgpr_read_b32 v233,a106
v_add_f32 v235,v238,v233
M a[152:155],a[248:251],a[228:231],a[152:155]
v_sub_f32 v238,v238,v233
v_add_f32 v233,v10,v106
M a[152:155],a[192:195],v[220:223],a[152:155]
s_waitcnt lgkmcnt(1)
v_sub_f32 v106,v10,v106
v_add_f32 v10,v235,v233
M a[152:155],v[216:219],a[200:203],a[152:155]
s_waitcnt lgkmcnt(0)
v_fmac_f32 v235,4.0,v233
v_fma_f32 v233,2.0,v106,v238
M a[156:159],v[216:219],a[208:211],a[156:159]
global_load_dword v216,v250,s[64:65]
M a[156:159],a[192:195],a[200:203],a[156:159]
s_add_u32 s47,s77,39936
v_fma_f32 v106,s40,v106,v238
v_accvgpr_read_b32 v238,a11
M a[156:159],a[248:251],v[220:223],a[156:159]
s_waitcnt vmcnt(11)
v_accvgpr_read_b32 v237,a107
v_add_f32 v236,v238,v237
M a[160:163],a[204:207],a[100:103],a[160:163]
s_waitcnt vmcnt(10)
v_sub_f32 v238,v238,v237
v_add_f32 v237,v11,v107
M a[160:163],a[236:239],v[228:231],a[160:163]
s_waitcnt vmcnt(9)
v_sub_f32 v107,v11,v107
v_add_f32 v11,v236,v237
M a[160:163],a[252:255],a[96:99],a[160:163]
v_fmac_f32 v236,4.0,v237
v_fma_f32 v237,2.0,v107,v238
M a[164:167],a[252:255],a[240:243],a[164:167]
buffer_load_dwordx4 v[216:219],v250,s[20:23],s47 offen offset:0 sc1
M a[164:167],a[236:239],a[96:99],a[164:167]
v_fma_f32 v107,s40,v107,v238
v_cvt_pk_bf16_f32 v233,v233,v237
M a[164:167],a[204:207],v[228:231],a[164:167]
buffer_load_dwordx4 a[100:103],v250,s[20:23],s47 offen offset:1024 sc1
M a[168:171],a[204:207],a[96:99],a[168:171]
v_cvt_pk_bf16_f32 v235,v235,v236
M a[168:171],a[236:239],a[240:243],a[168:171]
ds_write2st64_b64 v254,v[232:233],v[234:235] offset0:85 offset1:89
M a[168:171],a[252:255],a[212:215],a[168:171]
v_accvgpr_read_b32 v204,a12
v_accvgpr_read_b32 v208,a108
M a[172:175],a[252:255],a[224:227],a[172:175]
buffer_load_dwordx4 a[104:107],v250,s[20:23],s47 offen offset:2048 sc1
M a[172:175],a[236:239],a[212:215],a[172:175]
s_add_u32 s48,s77,43008
v_accvgpr_read_b32 v205,a13
v_accvgpr_read_b32 v209,a109
M a[172:175],a[204:207],a[240:243],a[172:175]
v_accvgpr_read_b32 v206,a14
v_accvgpr_read_b32 v210,a110
v_accvgpr_read_b32 v207,a15
v_accvgpr_read_b32 v211,a111
v_pk_add_f32 v[212:213],v[204:205],v[208:209]
v_pk_add_f32 v[214:215],v[206:207],v[210:211]
v_pk_add_f32 v[204:205],v[204:205],v[208:209] neg_lo:[0,1] neg_hi:[0,1]
v_pk_add_f32 v[206:207],v[206:207],v[210:211] neg_lo:[0,1] neg_hi:[0,1]
v_pk_add_f32 v[208:209],v[12:13],v[108:109]
v_pk_add_f32 v[210:211],v[14:15],v[110:111]
v_pk_add_f32 v[108:109],v[12:13],v[108:109] neg_lo:[0,1] neg_hi:[0,1]
v_pk_add_f32 v[110:111],v[14:15],v[110:111] neg_lo:[0,1] neg_hi:[0,1]
v_pk_add_f32 v[12:13],v[212:213],v[208:209]
v_pk_add_f32 v[14:15],v[214:215],v[210:211]
v_pk_fma_f32 v[212:213],v[208:209],4.0,v[212:213] op_sel_hi:[1,0,1]
v_pk_fma_f32 v[214:215],v[210:211],4.0,v[214:215] op_sel_hi:[1,0,1]
v_pk_fma_f32 v[208:209],v[108:109],2.0,v[204:205] op_sel_hi:[1,0,1]
v_pk_fma_f32 v[210:211],v[110:111],2.0,v[206:207] op_sel_hi:[1,0,1]
v_pk_fma_f32 v[108:109],v[108:109],s[40:41],v[204:205] op_sel_hi:[1,0,1]
v_pk_fma_f32 v[110:111],v[110:111],s[40:41],v[206:207] op_sel_hi:[1,0,1]
M a[176:179],a[204:207],a[212:215],a[176:179]
buffer_load_dwordx4 a[192:195],v250,s[20:23],s48 offen offset:0 sc1
M a[176:179],a[236:239],a[224:227],a[176:179]
v_cvt_pk_bf16_f32 v208,v208,v209
v_cvt_pk_bf16_f32 v209,v210,v211
M a[176:179],a[252:255],a[228:231],a[176:179]
buffer_load_dwordx4 a[248:251],v250,s[20:23],s48 offen offset:1024 sc1
M a[180:183],a[252:255],v[220:223],a[180:183]
v_cvt_pk_bf16_f32 v212,v212,v213
v_cvt_pk_bf16_f32 v213,v214,v215
M a[180:183],a[236:239],a[228:231],a[180:183]
ds_read_b128 a[108:111],v248 offset:0
ds_write2st64_b64 v254,v[208:209],v[212:213] offset0:93 offset1:97
M a[180:183],a[204:207],a[224:227],a[180:183]
buffer_load_dwordx4 a[96:99],v250,s[20:23],s48 offen offset:2048 sc1
M a[184:187],a[204:207],a[228:231],a[184:187]
s_add_u32 s46,s72,0
ds_read_b128 a[240:243],v249 offset:0
ds_read_b128 a[212:215],v248 offset:512
M a[184:187],a[236:239],v[220:223],a[184:187]
ds_read_b128 a[224:227],v249 offset:512
v_accvgpr_read_b32 v238,a16
M a[184:187],a[252:255],a[200:203],a[184:187]
v_accvgpr_read_b32 v232,a112
v_add_f32 v234,v238,v232
M a[188:191],a[252:255],a[208:211],a[188:191]
buffer_load_dwordx4 v[228:231],v250,s[20:23],s46 offen offset:0 sc1
M a[188:191],a[236:239],a[200:203],a[188:191]
v_sub_f32 v238,v238,v232
v_add_f32 v232,v16,v112
M a[188:191],a[204:207],v[220:223],a[188:191]
s_waitcnt vmcnt(15) lgkmcnt(4)
v_sub_f32 v112,v16,v112
v_add_f32 v16,v234,v232
M v[32:35],a[220:223],a[108:111],v[32:35]
s_waitcnt vmcnt(14) lgkmcnt(2)
ds_read_b128 a[208:211],v248 offset:1024
v_fmac_f32 v234,4.0,v232
M v[32:35],a[196:199],a[240:243],v[32:35]
s_waitcnt vmcnt(13) lgkmcnt(2)
buffer_load_dwordx4 a[228:231],v250,s[20:23],s46 offen offset:1024 sc1
M v[32:35],a[216:219],a[212:215],v[32:35]
s_waitcnt lgkmcnt(1)
ds_read_b128 a[252:255],v249 offset:1024
v_fma_f32 v232,2.0,v112,v238
M v[36:39],a[216:219],a[224:227],v[36:39]
v_fma_f32 v112,s40,v112,v238
M v[36:39],a[196:199],a[212:215],v[36:39]
s_barrier
ds_read_b128 a[8:11],v250 offset:43520
M v[36:39],a[220:223],a[240:243],v[36:39]
ds_read_b128 a[12:15],v250 offset:47616
v_accvgpr_read_b32 v238,a17
M v[40:43],a[220:223],a[212:215],v[40:43]
ds_read_b128 a[200:203],v248 offset:1536
v_accvgpr_read_b32 v237,a113
M v[40:43],a[196:199],a[224:227],v[40:43]
s_waitcnt lgkmcnt(4)
ds_read_b128 a[236:239],v249 offset:1536
v_add_f32 v236,v238,v237
M v[40:43],a[216:219],a[208:211],v[40:43]
s_waitcnt lgkmcnt(4)
v_sub_f32 v238,v238,v237
v_add_f32 v237,v17,v113
M v[44:47],a[216:219],a[252:255],v[44:47]
v_sub_f32 v113,v17,v113
v_add_f32 v17,v236,v237
M v[44:47],a[196:199],a[208:211],v[44:47]
v_fmac_f32 v236,4.0,v237
v_fma_f32 v237,2.0,v113,v238
M v[44:47],a[220:223],a[224:227],v[44:47]
v_fma_f32 v113,s40,v113,v238
v_cvt_pk_bf16_f32 v232,v232,v237
M v[48:51],a[220:223],a[208:211],v[48:51]
ds_read_b128 a[204:207],v249 offset:2048
v_cvt_pk_bf16_f32 v234,v234,v236
M v[48:51],a[196:199],a[252:255],v[48:51]
s_waitcnt lgkmcnt(2)
ds_read_b128 v[220:223],v248 offset:2048
v_accvgpr_read_b32 v238,a18
M v[48:51],a[216:219],a[200:203],v[48:51]
s_waitcnt lgkmcnt(2)
v_accvgpr_read_b32 v233,a114
v_add_f32 v235,v238,v233
M v[52:55],a[216:219],a[236:239],v[52:55]
v_sub_f32 v238,v238,v233
v_add_f32 v233,v18,v114
M v[52:55],a[196:199],a[200:203],v[52:55]
v_sub_f32 v114,v18,v114
v_add_f32 v18,v235,v233
M v[52:55],a[220:223],a[252:255],v[52:55]
v_fmac_f32 v235,4.0,v233
v_fma_f32 v233,2.0,v114,v238
M v[56:59],a[220:223],a[200:203],v[56:59]
v_fma_f32 v114,s40,v114,v238
v_accvgpr_read_b32 v238,a19
M v[56:59],a[196:199],a[236:239],v[56:59]
s_waitcnt lgkmcnt(1)
v_accvgpr_read_b32 v237,a115
v_add_f32 v236,v238,v237
M v[56:59],a[216:219],a[204:207],v[56:59]
s_waitcnt lgkmcnt(0)
v_sub_f32 v238,v238,v237
v_add_f32 v237,v19,v115
M v[60:63],a[216:219],v[220:223],v[60:63]
buffer_load_dwordx4 a[112:115],v250,s[20:23],s46 offen offset:2048 sc1
M v[60:63],a[196:199],a[204:207],v[60:63]
s_add_u32 s46,s73,0
v_sub_f32 v115,v19,v115
v_add_f32 v19,v236,v237
M v[60:63],a[220:223],a[236:239],v[60:63]
s_waitcnt vmcnt(14)
buffer_load_dwordx4 a[216:219],v250,s[20:23],s46 offen offset:0 sc1
M v[64:67],a[244:247],a[108:111],v[64:67]
s_waitcnt vmcnt(14)
v_fmac_f32 v236,4.0,v237
v_fma_f32 v237,2.0,v115,v238
M v[64:67],a[232:235],a[240:243],v[64:67]
s_waitcnt vmcnt(11)
v_fma_f32 v115,s40,v115,v238
v_cvt_pk_bf16_f32 v233,v233,v237
M v[64:67],v[224:227],a[212:215],v[64:67]
v_cvt_pk_bf16_f32 v235,v235,v236
M v[68:71],v[224:227],a[224:227],v[68:71]
buffer_load_dwordx4 a[196:199],v250,s[20:23],s46 offen offset:1024 sc1
M v[68:71],a[232:235],a[212:215],v[68:71]
ds_write2st64_b64 v254,v[232:233],v[234:235] offset0:68 offset1:72
M v[68:71],a[244:247],a[240:243],v[68:71]
v_accvgpr_read_b32 v238,a20
v_accvgpr_read_b32 v232,a116
M v[72:75],a[244:247],a[212:215],v[72:75]
v_add_f32 v234,v238,v232
v_sub_f32 v238,v238,v232
M v[72:75],a[232:235],a[224:227],v[72:75]
buffer_load_dwordx4 a[108:111],v250,s[20:23],s46 offen offset:2048 sc1
M v[72:75],v[224:227],a[208:211],v[72:75]
s_add_u32 s31,s66,7471104
v_add_f32 v232,v20,v116
v_sub_f32 v116,v20,v116
M v[76:79],v[224:227],a[252:255],v[76:79]
v_add_f32 v20,v234,v232
v_fmac_f32 v234,4.0,v232
M v[76:79],a[232:235],a[208:211],v[76:79]
v_fma_f32 v232,2.0,v116,v238
v_fma_f32 v116,s40,v116,v238
M v[76:79],a[244:247],a[224:227],v[76:79]
buffer_load_dword a220,v255,s[8:11],s31 offen offset:0
M v[80:83],a[244:247],a[208:211],v[80:83]
v_accvgpr_read_b32 v238,a21
v_accvgpr_read_b32 v237,a117
M v[80:83],a[232:235],a[252:255],v[80:83]
v_add_f32 v236,v238,v237
v_sub_f32 v238,v238,v237
M v[80:83],v[224:227],a[200:203],v[80:83]
v_add_f32 v237,v21,v117
v_sub_f32 v117,v21,v117
M v[84:87],v[224:227],a[236:239],v[84:87]
buffer_load_dword a220,v255,s[8:11],s31 offen offset:384
M v[84:87],a[232:235],a[200:203],v[84:87]
ds_read_b128 a[240:243],v248 offset:8704
v_add_f32 v21,v236,v237
M v[84:87],a[244:247],a[252:255],v[84:87]
ds_read_b128 a[212:215],v249 offset:8704
v_fmac_f32 v236,4.0,v237
M v[88:91],a[244:247],a[200:203],v[88:91]
ds_read_b128 a[224:227],v248 offset:9216
v_fma_f32 v237,2.0,v117,v238
M v[88:91],a[232:235],a[236:239],v[88:91]
ds_read_b128 a[208:211],v249 offset:9216
v_fma_f32 v117,s40,v117,v238
M v[88:91],v[224:227],a[204:207],v[88:91]
v_cvt_pk_bf16_f32 v232,v232,v237
v_cvt_pk_bf16_f32 v234,v234,v236
M v[92:95],v[224:227],v[220:223],v[92:95]
v_accvgpr_read_b32 v238,a22
v_accvgpr_read_b32 v233,a118
M v[92:95],a[232:235],a[204:207],v[92:95]
v_add_f32 v235,v238,v233
v_sub_f32 v238,v238,v233
M v[92:95],a[244:247],a[236:239],v[92:95]
s_waitcnt vmcnt(13) lgkmcnt(3)
v_add_f32 v233,v22,v118
v_sub_f32 v118,v22,v118
M v[128:131],v[216:219],a[240:243],v[128:131]
s_waitcnt vmcnt(12) lgkmcnt(2)
ds_read_b128 a[252:255],v248 offset:9728
v_add_f32 v22,v235,v233
M v[128:131],a[100:103],a[212:215],v[128:131]
s_waitcnt vmcnt(11) lgkmcnt(2)
ds_read_b128 a[200:203],v249 offset:9728
v_fmac_f32 v235,4.0,v233
M v[128:131],a[104:107],a[224:227],v[128:131]
s_waitcnt lgkmcnt(2)
v_fma_f32 v233,2.0,v118,v238
v_fma_f32 v118,s40,v118,v238
M v[132:135],a[104:107],a[208:211],v[132:135]
v_accvgpr_read_b32 v238,a23
v_accvgpr_read_b32 v237,a119
M v[132:135],a[100:103],a[224:227],v[132:135]
v_add_f32 v236,v238,v237
v_sub_f32 v238,v238,v237
M v[132:135],v[216:219],a[212:215],v[132:135]
s_add_u32 s46,s74,0
v_add_f32 v237,v23,v119
v_sub_f32 v119,v23,v119
M v[136:139],v[216:219],a[224:227],v[136:139]
ds_read_b128 a[116:119],v248 offset:10240
v_add_f32 v23,v236,v237
M v[136:139],a[100:103],a[208:211],v[136:139]
s_waitcnt lgkmcnt(2)
ds_read_b128 v[220:223],v249 offset:10240
v_fmac_f32 v236,4.0,v237
M v[136:139],a[104:107],a[252:255],v[136:139]
s_waitcnt lgkmcnt(2)
v_fma_f32 v237,2.0,v119,v238
v_fma_f32 v119,s40,v119,v238
M v[140:143],a[104:107],a[200:203],v[140:143]
v_cvt_pk_bf16_f32 v233,v233,v237
v_cvt_pk_bf16_f32 v235,v235,v236
M v[140:143],a[100:103],a[252:255],v[140:143]
ds_write2st64_b64 v254,v[232:233],v[234:235] offset0:76 offset1:80
M v[140:143],v[216:219],a[208:211],v[140:143]
buffer_load_dwordx4 a[220:223],v250,s[20:23],s46 offen offset:0 sc1
M v[144:147],v[216:219],a[252:255],v[144:147]
ds_read_b128 a[232:235],v249 offset:10752
v_accvgpr_read_b32 v238,a24
M v[144:147],a[100:103],a[200:203],v[144:147]
s_waitcnt lgkmcnt(3)
buffer_load_dwordx4 v[224:227],v250,s[20:23],s46 offen offset:1024 sc1
M v[144:147],a[104:107],a[116:119],v[144:147]
s_waitcnt lgkmcnt(2)
ds_read_b128 a[236:239],v248 offset:10752
v_accvgpr_read_b32 v232,a120
M v[148:151],a[104:107],v[220:223],v[148:151]
v_add_f32 v234,v238,v232
v_sub_f32 v238,v238,v232
M v[148:151],a[100:103],a[116:119],v[148:151]
v_add_f32 v232,v24,v120
v_sub_f32 v120,v24,v120
M v[148:151],v[216:219],a[200:203],v[148:151]
buffer_load_dwordx4 a[204:207],v250,s[20:23],s46 offen offset:2048 sc1
M v[152:155],v[216:219],a[116:119],v[152:155]
s_add_u32 s46,s75,0
v_add_f32 v24,v234,v232
v_fmac_f32 v234,4.0,v232
M v[152:155],a[100:103],v[220:223],v[152:155]
s_waitcnt lgkmcnt(1)
v_fma_f32 v232,2.0,v120,v238
v_fma_f32 v120,s40,v120,v238
M v[152:155],a[104:107],a[232:235],v[152:155]
s_waitcnt lgkmcnt(0)
s_barrier
ds_read_b128 a[16:19],v250 offset:34816
M v[156:159],a[104:107],a[236:239],v[156:159]
ds_read_b128 a[20:23],v250 offset:38912
v_accvgpr_read_b32 v238,a25
M v[156:159],a[100:103],a[232:235],v[156:159]
buffer_load_dwordx4 a[244:247],v250,s[20:23],s46 offen offset:0 sc1
M v[156:159],v[216:219],v[220:223],v[156:159]
s_waitcnt vmcnt(14)
v_accvgpr_read_b32 v237,a121
v_add_f32 v236,v238,v237
M v[160:163],a[192:195],a[240:243],v[160:163]
s_waitcnt vmcnt(13)
v_sub_f32 v238,v238,v237
v_add_f32 v237,v25,v121
M v[160:163],a[248:251],a[212:215],v[160:163]
s_waitcnt vmcnt(12)
buffer_load_dwordx4 a[104:107],v250,s[20:23],s46 offen offset:1024 sc1
M v[160:163],a[96:99],a[224:227],v[160:163]
v_sub_f32 v121,v25,v121
v_add_f32 v25,v236,v237
M v[164:167],a[96:99],a[208:211],v[164:167]
v_fmac_f32 v236,4.0,v237
v_fma_f32 v237,2.0,v121,v238
M v[164:167],a[248:251],a[224:227],v[164:167]
v_fma_f32 v121,s40,v121,v238
v_cvt_pk_bf16_f32 v232,v232,v237
M v[164:167],a[192:195],a[212:215],v[164:167]
buffer_load_dwordx4 a[100:103],v250,s[20:23],s46 offen offset:2048 sc1
M v[168:171],a[192:195],a[224:227],v[168:171]
s_add_u32 s46,s76,0
v_cvt_pk_bf16_f32 v234,v234,v236
v_accvgpr_read_b32 v238,a26
M v[168:171],a[248:251],a[208:211],v[168:171]
v_accvgpr_read_b32 v233,a122
v_add_f32 v235,v238,v233
M v[168:171],a[96:99],a[252:255],v[168:171]
v_sub_f32 v238,v238,v233
v_add_f32 v233,v26,v122
M v[172:175],a[96:99],a[200:203],v[172:175]
buffer_load_dwordx4 v[216:219],v250,s[20:23],s46 offen offset:0 sc1
M v[172:175],a[248:251],a[252:255],v[172:175]
v_sub_f32 v122,v26,v122
v_add_f32 v26,v235,v233
M v[172:175],a[192:195],a[208:211],v[172:175]
v_fmac_f32 v235,4.0,v233
v_fma_f32 v233,2.0,v122,v238
M v[176:179],a[192:195],a[252:255],v[176:179]
v_fma_f32 v122,s40,v122,v238
v_accvgpr_read_b32 v238,a27
M v[176:179],a[248:251],a[200:203],v[176:179]
buffer_load_dwordx4 a[240:243],v250,s[20:23],s46 offen offset:1024 sc1
M v[176:179],a[96:99],a[116:119],v[176:179]
v_add_u32 v248,0xffffbc00,v248
v_add_u32 v249,0xffffbc00,v249
M v[180:183],a[96:99],v[220:223],v[180:183]
v_accvgpr_read_b32 v237,a123
v_add_f32 v236,v238,v237
M v[180:183],a[248:251],a[116:119],v[180:183]
ds_read_b128 a[208:211],v248 offset:0
v_sub_f32 v238,v238,v237
M v[180:183],a[192:195],a[200:203],v[180:183]
buffer_load_dwordx4 a[212:215],v250,s[20:23],s46 offen offset:2048 sc1
M v[184:187],a[192:195],a[116:119],v[184:187]
s_add_u32 s46,s77,0
ds_read_b128 a[120:123],v249 offset:0
ds_read_b128 a[116:119],v248 offset:512
M v[184:187],a[248:251],v[220:223],v[184:187]
ds_read_b128 a[252:255],v249 offset:512
v_add_f32 v237,v27,v123
M v[184:187],a[96:99],a[232:235],v[184:187]
v_sub_f32 v123,v27,v123
v_add_f32 v27,v236,v237
M v[188:191],a[96:99],a[236:239],v[188:191]
buffer_load_dwordx4 a[224:227],v250,s[20:23],s46 offen offset:0 sc1
M v[188:191],a[248:251],a[232:235],v[188:191]
v_fmac_f32 v236,4.0,v237
v_fma_f32 v237,2.0,v123,v238
M v[188:191],a[192:195],v[220:223],v[188:191]
s_waitcnt vmcnt(17) lgkmcnt(3)
v_fma_f32 v123,s40,v123,v238
v_cvt_pk_bf16_f32 v233,v233,v237
M v[0:3],v[228:231],a[208:211],v[0:3]
s_waitcnt vmcnt(16) lgkmcnt(2)
ds_read_b128 a[248:251],v248 offset:1024
v_cvt_pk_bf16_f32 v235,v235,v236
M v[0:3],a[228:231],a[120:123],v[0:3]
s_waitcnt vmcnt(15) lgkmcnt(2)
buffer_load_dwordx4 a[96:99],v250,s[20:23],s46 offen offset:1024 sc1
M v[0:3],a[112:115],a[116:119],v[0:3]
s_waitcnt lgkmcnt(1)
ds_read_b128 a[192:195],v249 offset:1024
ds_write2st64_b64 v254,v[232:233],v[234:235] offset0:85 offset1:89
M v[4:7],a[112:115],a[252:255],v[4:7]
v_accvgpr_read_b32 v204,a28
v_accvgpr_read_b32 v208,a124
M v[4:7],a[228:231],a[116:119],v[4:7]
buffer_load_dwordx4 a[200:203],v250,s[20:23],s46 offen offset:2048 sc1
M v[4:7],v[228:231],a[120:123],v[4:7]
s_add_u32 s46,s72,46080
v_accvgpr_read_b32 v205,a29
v_accvgpr_read_b32 v209,a125
M v[8:11],v[228:231],a[116:119],v[8:11]
ds_read_b128 a[116:119],v248 offset:1536
v_accvgpr_read_b32 v206,a30
M v[8:11],a[228:231],a[252:255],v[8:11]
s_waitcnt lgkmcnt(3)
ds_read_b128 a[120:123],v249 offset:1536
v_accvgpr_read_b32 v210,a126
v_accvgpr_read_b32 v207,a31
v_accvgpr_read_b32 v211,a127
v_pk_add_f32 v[212:213],v[204:205],v[208:209]
v_pk_add_f32 v[214:215],v[206:207],v[210:211]
v_pk_add_f32 v[204:205],v[204:205],v[208:209] neg_lo:[0,1] neg_hi:[0,1]
v_pk_add_f32 v[206:207],v[206:207],v[210:211] neg_lo:[0,1] neg_hi:[0,1]
v_pk_add_f32 v[208:209],v[28:29],v[124:125]
v_pk_add_f32 v[210:211],v[30:31],v[126:127]
v_pk_add_f32 v[124:125],v[28:29],v[124:125] neg_lo:[0,1] neg_hi:[0,1]
v_pk_add_f32 v[126:127],v[30:31],v[126:127] neg_lo:[0,1] neg_hi:[0,1]
v_pk_add_f32 v[28:29],v[212:213],v[208:209]
v_pk_add_f32 v[30:31],v[214:215],v[210:211]
v_pk_fma_f32 v[212:213],v[208:209],4.0,v[212:213] op_sel_hi:[1,0,1]
v_pk_fma_f32 v[214:215],v[210:211],4.0,v[214:215] op_sel_hi:[1,0,1]
v_pk_fma_f32 v[208:209],v[124:125],2.0,v[204:205] op_sel_hi:[1,0,1]
v_pk_fma_f32 v[210:211],v[126:127],2.0,v[206:207] op_sel_hi:[1,0,1]
v_pk_fma_f32 v[124:125],v[124:125],s[40:41],v[204:205] op_sel_hi:[1,0,1]
v_pk_fma_f32 v[126:127],v[126:127],s[40:41],v[206:207] op_sel_hi:[1,0,1]
M v[8:11],a[112:115],a[248:251],v[8:11]
s_waitcnt lgkmcnt(3)
buffer_load_dwordx4 a[236:239],v250,s[20:23],s46 offen offset:0 sc1
M v[12:15],a[112:115],a[192:195],v[12:15]
v_cvt_pk_bf16_f32 v208,v208,v209
v_cvt_pk_bf16_f32 v209,v210,v211
M v[12:15],a[228:231],a[248:251],v[12:15]
buffer_load_dwordx4 a[232:235],v250,s[20:23],s46 offen offset:1024 sc1
M v[12:15],v[228:231],a[252:255],v[12:15]
v_cvt_pk_bf16_f32 v212,v212,v213
v_cvt_pk_bf16_f32 v213,v214,v215
M v[16:19],v[228:231],a[248:251],v[16:19]
ds_read_b128 a[124:127],v249 offset:2048
ds_write2st64_b64 v254,v[208:209],v[212:213] offset0:93 offset1:97
M v[16:19],a[228:231],a[192:195],v[16:19]
s_waitcnt lgkmcnt(3)
ds_read_b128 v[220:223],v248 offset:2048
v_add_u32 v248,0x15400,v248
M v[16:19],a[112:115],a[116:119],v[16:19]
s_waitcnt lgkmcnt(3)
v_add_u32 v249,0x15400,v249
v_accvgpr_read_b32 v238,a32
M v[20:23],a[112:115],a[120:123],v[20:23]
v_accvgpr_read_b32 v232,a128
v_add_f32 v234,v238,v232
M v[20:23],a[228:231],a[116:119],v[20:23]
ds_read_b128 a[208:211],v248 offset:0
v_sub_f32 v238,v238,v232
M v[20:23],v[228:231],a[192:195],v[20:23]
ds_read_b128 a[252:255],v249 offset:0
v_add_f32 v232,v32,v128
M v[24:27],v[228:231],a[116:119],v[24:27]
ds_read_b128 a[116:119],v248 offset:512
v_sub_f32 v128,v32,v128
M v[24:27],a[228:231],a[120:123],v[24:27]
s_waitcnt lgkmcnt(5)
ds_read_b128 a[248:251],v249 offset:512
v_add_f32 v32,v234,v232
M v[24:27],a[112:115],a[124:127],v[24:27]
s_waitcnt lgkmcnt(4)
buffer_load_dwordx4 a[192:195],v250,s[20:23],s46 offen offset:2048 sc1
M v[28:31],a[112:115],v[220:223],v[28:31]
s_add_u32 s47,s72,49152
v_fmac_f32 v234,4.0,v232
v_fma_f32 v232,2.0,v128,v238
M v[28:31],a[228:231],a[124:127],v[28:31]
buffer_load_dwordx4 a[112:115],v250,s[20:23],s47 offen offset:0 sc1
M v[28:31],v[228:231],a[120:123],v[28:31]
s_waitcnt vmcnt(20) lgkmcnt(3)
v_fma_f32 v128,s40,v128,v238
M v[0:3],a[216:219],a[208:211],v[0:3]
s_waitcnt vmcnt(19) lgkmcnt(2)
s_barrier
ds_read_b128 a[24:27],v250 offset:43520
M v[0:3],a[196:199],a[252:255],v[0:3]
s_waitcnt vmcnt(18) lgkmcnt(2)
ds_read_b128 a[28:31],v250 offset:47616
ds_read_b128 a[120:123],v248 offset:1024
M v[0:3],a[108:111],a[116:119],v[0:3]
s_waitcnt lgkmcnt(3)
buffer_load_dwordx4 v[220:223],v250,s[20:23],s47 offen offset:1024 sc1
M v[4:7],a[108:111],a[248:251],v[4:7]
ds_read_b128 a[228:231],v249 offset:1024
v_accvgpr_read_b32 v238,a33
M v[4:7],a[196:199],a[116:119],v[4:7]
v_accvgpr_read_b32 v237,a129
v_add_f32 v236,v238,v237
M v[4:7],a[216:219],a[252:255],v[4:7]
v_sub_f32 v238,v238,v237
v_add_f32 v237,v33,v129
M v[8:11],a[216:219],a[116:119],v[8:11]
buffer_load_dwordx4 a[124:127],v250,s[20:23],s47 offen offset:2048 sc1
M v[8:11],a[196:199],a[248:251],v[8:11]
s_waitcnt lgkmcnt(1)
ds_read_b128 a[116:119],v248 offset:1536
ds_read_b128 v[228:231],v249 offset:1536
M v[8:11],a[108:111],a[120:123],v[8:11]
s_waitcnt lgkmcnt(2)
s_add_u32 s34,s32,0
v_sub_f32 v129,v33,v129
v_add_f32 v33,v236,v237
M v[12:15],a[108:111],a[228:231],v[12:15]
v_fmac_f32 v236,4.0,v237
v_fma_f32 v237,2.0,v129,v238
M v[12:15],a[196:199],a[120:123],v[12:15]
v_fma_f32 v129,s40,v129,v238
v_cvt_pk_bf16_f32 v232,v232,v237
M v[12:15],a[216:219],a[248:251],v[12:15]
buffer_store_dwordx4 a[0:3],v253,s[24:27],s34 offen offset:384 nt
M v[16:19],a[216:219],a[120:123],v[16:19]
ds_read_b128 a[120:123],v249 offset:2048
v_cvt_pk_bf16_f32 v234,v234,v236
M v[16:19],a[196:199],a[228:231],v[16:19]
s_waitcnt lgkmcnt(2)
ds_read_b128 a[208:211],v248 offset:2048
v_accvgpr_read_b32 v238,a34
M v[16:19],a[108:111],a[116:119],v[16:19]
s_waitcnt lgkmcnt(2)
v_accvgpr_read_b32 v233,a130
v_add_f32 v235,v238,v233
M v[20:23],a[108:111],v[228:231],v[20:23]
s_add_u32 s46,s73,46080
v_sub_f32 v238,v238,v233
v_add_f32 v233,v34,v130
M v[20:23],a[196:199],a[116:119],v[20:23]
ds_read_b128 a[252:255],v248 offset:17408
v_sub_f32 v130,v34,v130
M v[20:23],a[216:219],a[228:231],v[20:23]
ds_read_b128 a[248:251],v249 offset:17408
v_add_f32 v34,v235,v233
M v[24:27],a[216:219],a[116:119],v[24:27]
ds_read_b128 a[116:119],v248 offset:17920
v_fmac_f32 v235,4.0,v233
M v[24:27],a[196:199],v[228:231],v[24:27]
s_waitcnt lgkmcnt(4)
ds_read_b128 a[228:231],v249 offset:17920
v_fma_f32 v233,2.0,v130,v238
M v[24:27],a[108:111],a[120:123],v[24:27]
s_waitcnt lgkmcnt(4)
v_fma_f32 v130,s40,v130,v238
v_accvgpr_read_b32 v238,a35
M v[28:31],a[108:111],a[208:211],v[28:31]
buffer_load_dwordx4 a[108:111],v250,s[20:23],s46 offen offset:0 sc1
M v[28:31],a[196:199],a[120:123],v[28:31]
v_accvgpr_read_b32 v237,a131
v_add_f32 v236,v238,v237
M v[28:31],a[216:219],v[228:231],v[28:31]
s_waitcnt vmcnt(19) lgkmcnt(3)
buffer_load_dwordx4 a[208:211],v250,s[20:23],s46 offen offset:1024 sc1
M v[0:3],a[220:223],a[252:255],v[0:3]
s_waitcnt vmcnt(19) lgkmcnt(2)
ds_read_b128 a[128:131],v248 offset:18432
v_sub_f32 v238,v238,v237
M v[0:3],v[224:227],a[248:251],v[0:3]
s_waitcnt vmcnt(18) lgkmcnt(2)
ds_read_b128 a[196:199],v249 offset:18432
v_add_f32 v237,v35,v131
M v[0:3],a[204:207],a[116:119],v[0:3]
s_waitcnt lgkmcnt(2)
s_add_u32 s34,s32,196608
v_sub_f32 v131,v35,v131
v_add_f32 v35,v236,v237
M v[4:7],a[204:207],a[228:231],v[4:7]
buffer_load_dwordx4 a[120:123],v250,s[20:23],s46 offen offset:2048 sc1
M v[4:7],v[224:227],a[116:119],v[4:7]
v_fmac_f32 v236,4.0,v237
v_fma_f32 v237,2.0,v131,v238
M v[4:7],a[220:223],a[248:251],v[4:7]
v_fma_f32 v131,s40,v131,v238
v_cvt_pk_bf16_f32 v233,v233,v237
M v[8:11],a[220:223],a[116:119],v[8:11]
ds_read_b128 a[116:119],v248 offset:18944
v_cvt_pk_bf16_f32 v235,v235,v236
M v[8:11],v[224:227],a[228:231],v[8:11]
s_waitcnt lgkmcnt(2)
ds_read_b128 a[216:219],v249 offset:18944
ds_write2st64_b64 v254,v[232:233],v[234:235] offset0:34 offset1:38
M v[8:11],a[204:207],a[128:131],v[8:11]
s_waitcnt lgkmcnt(3)
buffer_store_dwordx4 a[4:7],v253,s[24:27],s34 offen offset:384 nt
M v[12:15],a[204:207],a[196:199],v[12:15]
v_accvgpr_read_b32 v204,a36
v_accvgpr_read_b32 v208,a132
M v[12:15],v[224:227],a[128:131],v[12:15]
v_accvgpr_read_b32 v205,a37
v_accvgpr_read_b32 v209,a133
M v[12:15],a[220:223],a[228:231],v[12:15]
v_accvgpr_read_b32 v206,a38
v_accvgpr_read_b32 v210,a134
v_accvgpr_read_b32 v207,a39
v_accvgpr_read_b32 v211,a135
v_pk_add_f32 v[212:213],v[204:205],v[208:209]
v_pk_add_f32 v[214:215],v[206:207],v[210:211]
v_pk_add_f32 v[204:205],v[204:205],v[208:209] neg_lo:[0,1] neg_hi:[0,1]
v_pk_add_f32 v[206:207],v[206:207],v[210:211] neg_lo:[0,1] neg_hi:[0,1]
v_pk_add_f32 v[208:209],v[36:37],v[132:133]
v_pk_add_f32 v[210:211],v[38:39],v[134:135]
v_pk_add_f32 v[132:133],v[36:37],v[132:133] neg_lo:[0,1] neg_hi:[0,1]
v_pk_add_f32 v[134:135],v[38:39],v[134:135] neg_lo:[0,1] neg_hi:[0,1]
v_pk_add_f32 v[36:37],v[212:213],v[208:209]
v_pk_add_f32 v[38:39],v[214:215],v[210:211]
v_pk_fma_f32 v[212:213],v[208:209],4.0,v[212:213] op_sel_hi:[1,0,1]
v_pk_fma_f32 v[214:215],v[210:211],4.0,v[214:215] op_sel_hi:[1,0,1]
v_pk_fma_f32 v[208:209],v[132:133],2.0,v[204:205] op_sel_hi:[1,0,1]
v_pk_fma_f32 v[210:211],v[134:135],2.0,v[206:207] op_sel_hi:[1,0,1]
v_pk_fma_f32 v[132:133],v[132:133],s[40:41],v[204:205] op_sel_hi:[1,0,1]
v_pk_fma_f32 v[134:135],v[134:135],s[40:41],v[206:207] op_sel_hi:[1,0,1]
M v[16:19],a[220:223],a[128:131],v[16:19]
s_add_u32 s47,s73,49152
ds_read_b128 a[128:131],v249 offset:19456
v_cvt_pk_bf16_f32 v208,v208,v209
M v[16:19],v[224:227],a[196:199],v[16:19]
s_waitcnt lgkmcnt(3)
ds_read_b128 v[228:231],v248 offset:19456
v_cvt_pk_bf16_f32 v209,v210,v211
M v[16:19],a[204:207],a[116:119],v[16:19]
s_waitcnt lgkmcnt(3)
v_cvt_pk_bf16_f32 v212,v212,v213
v_cvt_pk_bf16_f32 v213,v214,v215
M v[20:23],a[204:207],a[216:219],v[20:23]
ds_write2st64_b64 v254,v[208:209],v[212:213] offset0:42 offset1:46
M v[20:23],v[224:227],a[116:119],v[20:23]
ds_read_b128 a[132:135],v248 offset:34816
v_accvgpr_read_b32 v204,a40
M v[20:23],a[220:223],a[196:199],v[20:23]
ds_read_b128 a[252:255],v249 offset:34816
v_accvgpr_read_b32 v208,a136
M v[24:27],a[220:223],a[116:119],v[24:27]
buffer_load_dwordx4 a[116:119],v250,s[20:23],s47 offen offset:0 sc1
M v[24:27],v[224:227],a[216:219],v[24:27]
s_waitcnt lgkmcnt(4)
ds_read_b128 a[248:251],v248 offset:35328
ds_read_b128 a[228:231],v249 offset:35328
M v[24:27],a[204:207],a[128:131],v[24:27]
s_waitcnt lgkmcnt(5)
s_add_u32 s34,s32,393216
buffer_store_dwordx4 a[8:11],v253,s[24:27],s34 offen offset:384 nt
M v[28:31],a[204:207],v[228:231],v[28:31]
v_accvgpr_read_b32 v205,a41
v_accvgpr_read_b32 v209,a137
M v[28:31],v[224:227],a[128:131],v[28:31]
v_accvgpr_read_b32 v206,a42
v_accvgpr_read_b32 v210,a138
v_accvgpr_read_b32 v207,a43
v_accvgpr_read_b32 v211,a139
v_pk_add_f32 v[212:213],v[204:205],v[208:209]
v_pk_add_f32 v[214:215],v[206:207],v[210:211]
v_pk_add_f32 v[204:205],v[204:205],v[208:209] neg_lo:[0,1] neg_hi:[0,1]
v_pk_add_f32 v[206:207],v[206:207],v[210:211] neg_lo:[0,1] neg_hi:[0,1]
v_pk_add_f32 v[208:209],v[40:41],v[136:137]
v_pk_add_f32 v[210:211],v[42:43],v[138:139]
v_pk_add_f32 v[136:137],v[40:41],v[136:137] neg_lo:[0,1] neg_hi:[0,1]
v_pk_add_f32 v[138:139],v[42:43],v[138:139] neg_lo:[0,1] neg_hi:[0,1]
v_pk_add_f32 v[40:41],v[212:213],v[208:209]
v_pk_add_f32 v[42:43],v[214:215],v[210:211]
v_pk_fma_f32 v[212:213],v[208:209],4.0,v[212:213] op_sel_hi:[1,0,1]
v_pk_fma_f32 v[214:215],v[210:211],4.0,v[214:215] op_sel_hi:[1,0,1]
v_pk_fma_f32 v[208:209],v[136:137],2.0,v[204:205] op_sel_hi:[1,0,1]
v_pk_fma_f32 v[210:211],v[138:139],2.0,v[206:207] op_sel_hi:[1,0,1]
v_pk_fma_f32 v[136:137],v[136:137],s[40:41],v[204:205] op_sel_hi:[1,0,1]
v_pk_fma_f32 v[138:139],v[138:139],s[40:41],v[206:207] op_sel_hi:[1,0,1]
M v[28:31],a[220:223],a[216:219],v[28:31]
s_waitcnt vmcnt(21) lgkmcnt(3)
buffer_load_dwordx4 a[196:199],v250,s[20:23],s47 offen offset:1024 sc1
M v[0:3],a[244:247],a[132:135],v[0:3]
s_waitcnt vmcnt(21) lgkmcnt(2)
ds_read_b128 a[128:131],v248 offset:35840
v_cvt_pk_bf16_f32 v208,v208,v209
M v[0:3],a[104:107],a[252:255],v[0:3]
s_waitcnt vmcnt(20) lgkmcnt(2)
buffer_load_dwordx4 a[204:207],v250,s[20:23],s47 offen offset:2048 sc1
M v[0:3],a[100:103],a[248:251],v[0:3]
s_waitcnt lgkmcnt(1)
ds_read_b128 a[132:135],v249 offset:35840
v_cvt_pk_bf16_f32 v209,v210,v211
M v[4:7],a[100:103],a[228:231],v[4:7]
v_cvt_pk_bf16_f32 v212,v212,v213
v_cvt_pk_bf16_f32 v213,v214,v215
M v[4:7],a[104:107],a[248:251],v[4:7]
ds_write2st64_b64 v254,v[208:209],v[212:213] offset0:51 offset1:55
M v[4:7],a[244:247],a[252:255],v[4:7]
v_accvgpr_read_b32 v204,a44
v_accvgpr_read_b32 v208,a140
M v[8:11],a[244:247],a[248:251],v[8:11]
ds_read_b128 a[136:139],v248 offset:36352
v_accvgpr_read_b32 v205,a45
M v[8:11],a[104:107],a[228:231],v[8:11]
s_waitcnt lgkmcnt(3)
ds_read_b128 v[228:231],v249 offset:36352
v_accvgpr_read_b32 v209,a141
M v[8:11],a[100:103],a[128:131],v[8:11]
s_waitcnt lgkmcnt(3)
v_accvgpr_read_b32 v206,a46
v_accvgpr_read_b32 v210,a142
v_accvgpr_read_b32 v207,a47
v_accvgpr_read_b32 v211,a143
v_pk_add_f32 v[212:213],v[204:205],v[208:209]
v_pk_add_f32 v[214:215],v[206:207],v[210:211]
v_pk_add_f32 v[204:205],v[204:205],v[208:209] neg_lo:[0,1] neg_hi:[0,1]
v_pk_add_f32 v[206:207],v[206:207],v[210:211] neg_lo:[0,1] neg_hi:[0,1]
v_pk_add_f32 v[208:209],v[44:45],v[140:141]
v_pk_add_f32 v[210:211],v[46:47],v[142:143]
v_pk_add_f32 v[140:141],v[44:45],v[140:141] neg_lo:[0,1] neg_hi:[0,1]
v_pk_add_f32 v[142:143],v[46:47],v[142:143] neg_lo:[0,1] neg_hi:[0,1]
v_pk_add_f32 v[44:45],v[212:213],v[208:209]
v_pk_add_f32 v[46:47],v[214:215],v[210:211]
v_pk_fma_f32 v[212:213],v[208:209],4.0,v[212:213] op_sel_hi:[1,0,1]
v_pk_fma_f32 v[214:215],v[210:211],4.0,v[214:215] op_sel_hi:[1,0,1]
v_pk_fma_f32 v[208:209],v[140:141],2.0,v[204:205] op_sel_hi:[1,0,1]
v_pk_fma_f32 v[210:211],v[142:143],2.0,v[206:207] op_sel_hi:[1,0,1]
v_pk_fma_f32 v[140:141],v[140:141],s[40:41],v[204:205] op_sel_hi:[1,0,1]
v_pk_fma_f32 v[142:143],v[142:143],s[40:41],v[206:207] op_sel_hi:[1,0,1]
M v[12:15],a[100:103],a[132:135],v[12:15]
v_cvt_pk_bf16_f32 v208,v208,v209
v_cvt_pk_bf16_f32 v209,v210,v211
M v[12:15],a[104:107],a[128:131],v[12:15]
v_cvt_pk_bf16_f32 v212,v212,v213
v_cvt_pk_bf16_f32 v213,v214,v215
M v[12:15],a[244:247],a[228:231],v[12:15]
ds_write2st64_b64 v254,v[208:209],v[212:213] offset0:59 offset1:63
M v[16:19],a[244:247],a[128:131],v[16:19]
s_add_u32 s46,s74,46080
ds_read_b128 a[128:131],v249 offset:36864
v_accvgpr_read_b32 v238,a48
M v[16:19],a[104:107],a[132:135],v[16:19]
s_waitcnt lgkmcnt(3)
ds_read_b128 v[224:227],v248 offset:36864
v_accvgpr_read_b32 v232,a144
M v[16:19],a[100:103],a[136:139],v[16:19]
s_waitcnt lgkmcnt(3)
s_add_u32 s34,s32,589824
buffer_store_dwordx4 a[12:15],v253,s[24:27],s34 offen offset:384 nt
M v[20:23],a[100:103],v[228:231],v[20:23]
v_add_f32 v234,v238,v232
v_sub_f32 v238,v238,v232
M v[20:23],a[104:107],a[136:139],v[20:23]
ds_read_b128 a[140:143],v248 offset:52224
v_add_f32 v232,v48,v144
M v[20:23],a[244:247],a[132:135],v[20:23]
ds_read_b128 a[132:135],v249 offset:52224
v_sub_f32 v144,v48,v144
M v[24:27],a[244:247],a[136:139],v[24:27]
buffer_load_dwordx4 a[136:139],v250,s[20:23],s46 offen offset:0 sc1
M v[24:27],a[104:107],v[228:231],v[24:27]
s_waitcnt lgkmcnt(3)
ds_read_b128 a[216:219],v248 offset:52736
ds_read_b128 a[252:255],v249 offset:52736
M v[24:27],a[100:103],a[128:131],v[24:27]
s_waitcnt lgkmcnt(4)
buffer_load_dwordx4 a[220:223],v250,s[20:23],s46 offen offset:1024 sc1
M v[28:31],a[100:103],v[224:227],v[28:31]
v_add_f32 v48,v234,v232
v_fmac_f32 v234,4.0,v232
M v[28:31],a[104:107],a[128:131],v[28:31]
v_fma_f32 v232,2.0,v144,v238
v_fma_f32 v144,s40,v144,v238
M v[28:31],a[244:247],v[228:231],v[28:31]
s_waitcnt vmcnt(23) lgkmcnt(3)
v_accvgpr_read_b32 v238,a49
v_accvgpr_read_b32 v237,a145
M v[0:3],v[216:219],a[140:143],v[0:3]
s_waitcnt vmcnt(22) lgkmcnt(2)
buffer_load_dwordx4 a[248:251],v250,s[20:23],s46 offen offset:2048 sc1
M v[0:3],a[240:243],a[132:135],v[0:3]
s_waitcnt vmcnt(22) lgkmcnt(1)
ds_read_b128 a[100:103],v248 offset:53248
ds_read_b128 a[104:107],v249 offset:53248
M v[0:3],a[212:215],a[216:219],v[0:3]
s_waitcnt lgkmcnt(2)
v_add_f32 v236,v238,v237
v_sub_f32 v238,v238,v237
M v[4:7],a[212:215],a[252:255],v[4:7]
v_add_f32 v237,v49,v145
v_sub_f32 v145,v49,v145
M v[4:7],a[240:243],a[216:219],v[4:7]
v_add_f32 v49,v236,v237
v_fmac_f32 v236,4.0,v237
M v[4:7],v[216:219],a[132:135],v[4:7]
v_fma_f32 v237,2.0,v145,v238
v_fma_f32 v145,s40,v145,v238
M v[8:11],v[216:219],a[216:219],v[8:11]
ds_read_b128 a[128:131],v248 offset:53760
v_cvt_pk_bf16_f32 v232,v232,v237
M v[8:11],a[240:243],a[252:255],v[8:11]
s_waitcnt lgkmcnt(2)
ds_read_b128 a[132:135],v249 offset:53760
v_cvt_pk_bf16_f32 v234,v234,v236
M v[8:11],a[212:215],a[100:103],v[8:11]
s_waitcnt lgkmcnt(2)
s_add_u32 s34,s32,786432
buffer_store_dwordx4 a[16:19],v253,s[24:27],s34 offen offset:384 nt
M v[12:15],a[212:215],a[104:107],v[12:15]
v_accvgpr_read_b32 v238,a50
v_accvgpr_read_b32 v233,a146
M v[12:15],a[240:243],a[100:103],v[12:15]
v_add_f32 v235,v238,v233
v_sub_f32 v238,v238,v233
M v[12:15],v[216:219],a[252:255],v[12:15]
v_add_f32 v233,v50,v146
v_sub_f32 v146,v50,v146
M v[16:19],v[216:219],a[100:103],v[16:19]
s_add_u32 s47,s74,49152
ds_read_b128 a[100:103],v249 offset:54272
v_add_f32 v50,v235,v233
M v[16:19],a[240:243],a[104:107],v[16:19]
s_waitcnt lgkmcnt(2)
ds_read_b128 a[140:143],v248 offset:54272
v_add_u32 v248,0xfffece00,v248
M v[16:19],a[212:215],a[128:131],v[16:19]
s_waitcnt lgkmcnt(2)
v_add_u32 v249,0xfffece00,v249
v_fmac_f32 v235,4.0,v233
M v[20:23],a[212:215],a[132:135],v[20:23]
v_fma_f32 v233,2.0,v146,v238
v_fma_f32 v146,s40,v146,v238
M v[20:23],a[240:243],a[128:131],v[20:23]
ds_read_b128 a[228:231],v248 offset:60928
v_accvgpr_read_b32 v238,a51
M v[20:23],v[216:219],a[104:107],v[20:23]
ds_read_b128 a[104:107],v249 offset:60928
v_accvgpr_read_b32 v237,a147
M v[24:27],v[216:219],a[128:131],v[24:27]
buffer_load_dwordx4 a[128:131],v250,s[20:23],s47 offen offset:0 sc1
M v[24:27],a[240:243],a[132:135],v[24:27]
s_waitcnt lgkmcnt(3)
ds_read_b128 v[224:227],v248 offset:61440
ds_read_b128 v[228:231],v249 offset:61440
M v[24:27],a[212:215],a[100:103],v[24:27]
s_waitcnt lgkmcnt(4)
buffer_load_dwordx4 a[244:247],v250,s[20:23],s47 offen offset:1024 sc1
M v[28:31],a[212:215],a[140:143],v[28:31]
v_add_f32 v236,v238,v237
v_sub_f32 v238,v238,v237
M v[28:31],a[240:243],a[100:103],v[28:31]
v_add_f32 v237,v51,v147
v_sub_f32 v147,v51,v147
M v[28:31],v[216:219],a[132:135],v[28:31]
s_waitcnt vmcnt(24) lgkmcnt(3)
v_add_f32 v51,v236,v237
v_fmac_f32 v236,4.0,v237
M v[0:3],a[224:227],a[228:231],v[0:3]
s_waitcnt vmcnt(23) lgkmcnt(2)
buffer_load_dwordx4 a[216:219],v250,s[20:23],s47 offen offset:2048 sc1
M v[0:3],a[96:99],a[104:107],v[0:3]
s_waitcnt vmcnt(23) lgkmcnt(1)
ds_read_b128 a[100:103],v248 offset:61952
ds_read_b128 a[132:135],v249 offset:61952
M v[0:3],a[200:203],v[224:227],v[0:3]
s_waitcnt lgkmcnt(2)
s_add_u32 s34,s32,983040
v_fma_f32 v237,2.0,v147,v238
v_fma_f32 v147,s40,v147,v238
M v[4:7],a[200:203],v[228:231],v[4:7]
v_cvt_pk_bf16_f32 v233,v233,v237
v_cvt_pk_bf16_f32 v235,v235,v236
M v[4:7],a[96:99],v[224:227],v[4:7]
ds_write2st64_b64 v254,v[232:233],v[234:235] offset0:102 offset1:106
M v[4:7],a[224:227],a[104:107],v[4:7]
buffer_store_dwordx4 a[20:23],v253,s[24:27],s34 offen offset:384 nt
M v[8:11],a[224:227],v[224:227],v[8:11]
ds_read_b128 a[104:107],v248 offset:62464
v_accvgpr_read_b32 v204,a52
M v[8:11],a[96:99],v[228:231],v[8:11]
s_waitcnt lgkmcnt(3)
ds_read_b128 a[140:143],v249 offset:62464
v_accvgpr_read_b32 v208,a148
M v[8:11],a[200:203],a[100:103],v[8:11]
s_waitcnt lgkmcnt(3)
v_accvgpr_read_b32 v205,a53
v_accvgpr_read_b32 v209,a149
M v[12:15],a[200:203],a[132:135],v[12:15]
v_accvgpr_read_b32 v206,a54
v_accvgpr_read_b32 v210,a150
v_accvgpr_read_b32 v207,a55
v_accvgpr_read_b32 v211,a151
v_pk_add_f32 v[212:213],v[204:205],v[208:209]
v_pk_add_f32 v[214:215],v[206:207],v[210:211]
v_pk_add_f32 v[204:205],v[204:205],v[208:209] neg_lo:[0,1] neg_hi:[0,1]
v_pk_add_f32 v[206:207],v[206:207],v[210:211] neg_lo:[0,1] neg_hi:[0,1]
v_pk_add_f32 v[208:209],v[52:53],v[148:149]
v_pk_add_f32 v[210:211],v[54:55],v[150:151]
v_pk_add_f32 v[148:149],v[52:53],v[148:149] neg_lo:[0,1] neg_hi:[0,1]
v_pk_add_f32 v[150:151],v[54:55],v[150:151] neg_lo:[0,1] neg_hi:[0,1]
v_pk_add_f32 v[52:53],v[212:213],v[208:209]
v_pk_add_f32 v[54:55],v[214:215],v[210:211]
v_pk_fma_f32 v[212:213],v[208:209],4.0,v[212:213] op_sel_hi:[1,0,1]
v_pk_fma_f32 v[214:215],v[210:211],4.0,v[214:215] op_sel_hi:[1,0,1]
v_pk_fma_f32 v[208:209],v[148:149],2.0,v[204:205] op_sel_hi:[1,0,1]
v_pk_fma_f32 v[210:211],v[150:151],2.0,v[206:207] op_sel_hi:[1,0,1]
v_pk_fma_f32 v[148:149],v[148:149],s[40:41],v[204:205] op_sel_hi:[1,0,1]
v_pk_fma_f32 v[150:151],v[150:151],s[40:41],v[206:207] op_sel_hi:[1,0,1]
M v[12:15],a[96:99],a[100:103],v[12:15]
v_cvt_pk_bf16_f32 v208,v208,v209
v_cvt_pk_bf16_f32 v209,v210,v211
M v[12:15],a[224:227],v[228:231],v[12:15]
v_cvt_pk_bf16_f32 v212,v212,v213
v_cvt_pk_bf16_f32 v213,v214,v215
M v[16:19],a[224:227],a[100:103],v[16:19]
s_add_u32 s46,s75,46080
ds_read_b128 a[100:103],v249 offset:62976
ds_write2st64_b64 v254,v[208:209],v[212:213] offset0:110 offset1:114
M v[16:19],a[96:99],a[132:135],v[16:19]
s_waitcnt lgkmcnt(3)
ds_read_b128 a[144:147],v248 offset:62976
v_accvgpr_read_b32 v204,a56
M v[16:19],a[200:203],a[104:107],v[16:19]
s_waitcnt lgkmcnt(3)
v_accvgpr_read_b32 v208,a152
v_accvgpr_read_b32 v205,a57
M v[20:23],a[200:203],a[140:143],v[20:23]
v_accvgpr_read_b32 v209,a153
v_accvgpr_read_b32 v206,a58
M v[20:23],a[96:99],a[104:107],v[20:23]
ds_read_b128 a[148:151],v248 offset:0
v_accvgpr_read_b32 v210,a154
v_accvgpr_read_b32 v207,a59
v_accvgpr_read_b32 v211,a155
v_pk_add_f32 v[212:213],v[204:205],v[208:209]
v_pk_add_f32 v[214:215],v[206:207],v[210:211]
v_pk_add_f32 v[204:205],v[204:205],v[208:209] neg_lo:[0,1] neg_hi:[0,1]
v_pk_add_f32 v[206:207],v[206:207],v[210:211] neg_lo:[0,1] neg_hi:[0,1]
v_pk_add_f32 v[208:209],v[56:57],v[152:153]
v_pk_add_f32 v[210:211],v[58:59],v[154:155]
v_pk_add_f32 v[152:153],v[56:57],v[152:153] neg_lo:[0,1] neg_hi:[0,1]
v_pk_add_f32 v[154:155],v[58:59],v[154:155] neg_lo:[0,1] neg_hi:[0,1]
v_pk_add_f32 v[56:57],v[212:213],v[208:209]
v_pk_add_f32 v[58:59],v[214:215],v[210:211]
v_pk_fma_f32 v[212:213],v[208:209],4.0,v[212:213] op_sel_hi:[1,0,1]
v_pk_fma_f32 v[214:215],v[210:211],4.0,v[214:215] op_sel_hi:[1,0,1]
v_pk_fma_f32 v[208:209],v[152:153],2.0,v[204:205] op_sel_hi:[1,0,1]
v_pk_fma_f32 v[210:211],v[154:155],2.0,v[206:207] op_sel_hi:[1,0,1]
v_pk_fma_f32 v[152:153],v[152:153],s[40:41],v[204:205] op_sel_hi:[1,0,1]
v_pk_fma_f32 v[154:155],v[154:155],s[40:41],v[206:207] op_sel_hi:[1,0,1]
M v[20:23],a[224:227],a[132:135],v[20:23]
ds_read_b128 a[132:135],v249 offset:0
v_cvt_pk_bf16_f32 v208,v208,v209
M v[24:27],a[224:227],a[104:107],v[24:27]
buffer_load_dwordx4 a[104:107],v250,s[20:23],s46 offen offset:0 sc1
M v[24:27],a[96:99],a[140:143],v[24:27]
s_waitcnt lgkmcnt(4)
ds_read_b128 a[252:255],v248 offset:512
ds_read_b128 a[240:243],v249 offset:512
M v[24:27],a[200:203],a[100:103],v[24:27]
s_waitcnt lgkmcnt(4)
s_add_u32 s34,s32,1179648
buffer_load_dwordx4 a[212:215],v250,s[20:23],s46 offen offset:1024 sc1
M v[28:31],a[200:203],a[144:147],v[28:31]
v_cvt_pk_bf16_f32 v209,v210,v211
v_cvt_pk_bf16_f32 v212,v212,v213
M v[28:31],a[96:99],a[100:103],v[28:31]
v_cvt_pk_bf16_f32 v213,v214,v215
M v[28:31],a[224:227],a[140:143],v[28:31]
s_waitcnt vmcnt(25) lgkmcnt(3)
ds_write2st64_b64 v254,v[208:209],v[212:213] offset0:119 offset1:123
M v[96:99],a[236:239],a[148:151],v[96:99]
s_waitcnt vmcnt(24) lgkmcnt(3)
buffer_load_dwordx4 v[216:219],v250,s[20:23],s46 offen offset:2048 sc1
M v[96:99],a[232:235],a[132:135],v[96:99]
s_waitcnt vmcnt(24) lgkmcnt(2)
ds_read_b128 a[96:99],v248 offset:1024
ds_read_b128 a[100:103],v249 offset:1024
M v[96:99],a[192:195],a[252:255],v[96:99]
s_waitcnt lgkmcnt(3)
v_accvgpr_read_b32 v204,a60
v_accvgpr_read_b32 v208,a156
M v[100:103],a[192:195],a[240:243],v[100:103]
v_accvgpr_read_b32 v205,a61
v_accvgpr_read_b32 v209,a157
M v[100:103],a[232:235],a[252:255],v[100:103]
v_accvgpr_read_b32 v206,a62
v_accvgpr_read_b32 v210,a158
v_accvgpr_read_b32 v207,a63
v_accvgpr_read_b32 v211,a159
v_pk_add_f32 v[212:213],v[204:205],v[208:209]
v_pk_add_f32 v[214:215],v[206:207],v[210:211]
v_pk_add_f32 v[204:205],v[204:205],v[208:209] neg_lo:[0,1] neg_hi:[0,1]
v_pk_add_f32 v[206:207],v[206:207],v[210:211] neg_lo:[0,1] neg_hi:[0,1]
v_pk_add_f32 v[208:209],v[60:61],v[156:157]
v_pk_add_f32 v[210:211],v[62:63],v[158:159]
v_pk_add_f32 v[156:157],v[60:61],v[156:157] neg_lo:[0,1] neg_hi:[0,1]
v_pk_add_f32 v[158:159],v[62:63],v[158:159] neg_lo:[0,1] neg_hi:[0,1]
v_pk_add_f32 v[60:61],v[212:213],v[208:209]
v_pk_add_f32 v[62:63],v[214:215],v[210:211]
v_pk_fma_f32 v[212:213],v[208:209],4.0,v[212:213] op_sel_hi:[1,0,1]
v_pk_fma_f32 v[214:215],v[210:211],4.0,v[214:215] op_sel_hi:[1,0,1]
v_pk_fma_f32 v[208:209],v[156:157],2.0,v[204:205] op_sel_hi:[1,0,1]
v_pk_fma_f32 v[210:211],v[158:159],2.0,v[206:207] op_sel_hi:[1,0,1]
v_pk_fma_f32 v[156:157],v[156:157],s[40:41],v[204:205] op_sel_hi:[1,0,1]
v_pk_fma_f32 v[158:159],v[158:159],s[40:41],v[206:207] op_sel_hi:[1,0,1]
M v[100:103],a[236:239],a[132:135],v[100:103]
buffer_store_dwordx4 a[24:27],v253,s[24:27],s34 offen offset:384 nt
M v[104:107],a[236:239],a[252:255],v[104:107]
ds_read_b128 a[140:143],v248 offset:1536
v_cvt_pk_bf16_f32 v208,v208,v209
M v[104:107],a[232:235],a[240:243],v[104:107]
s_waitcnt lgkmcnt(2)
ds_read_b128 a[144:147],v249 offset:1536
v_cvt_pk_bf16_f32 v209,v210,v211
M v[104:107],a[192:195],a[96:99],v[104:107]
s_waitcnt lgkmcnt(2)
v_cvt_pk_bf16_f32 v212,v212,v213
v_cvt_pk_bf16_f32 v213,v214,v215
M v[108:111],a[192:195],a[100:103],v[108:111]
ds_write2st64_b64 v254,v[208:209],v[212:213] offset0:127 offset1:131
M v[108:111],a[232:235],a[96:99],v[108:111]
s_add_u32 s28,s66,6684672
buffer_load_dwordx4 v[204:207],v251,s[88:91],s28 offen offset:0
M v[108:111],a[236:239],a[240:243],v[108:111]
v_cvt_pk_bf16_f32 v0,v0,v1
v_cvt_pk_bf16_f32 v1,v2,v3
M v[112:115],a[236:239],a[96:99],v[112:115]
s_add_u32 s47,s75,49152
buffer_load_dwordx4 v[208:211],v245,s[8:11],s28 offen offset:0
M v[112:115],a[232:235],a[100:103],v[112:115]
s_waitcnt lgkmcnt(2)
ds_read_b128 a[152:155],v249 offset:2048
ds_read_b128 a[156:159],v248 offset:2048
M v[112:115],a[192:195],a[140:143],v[112:115]
s_waitcnt lgkmcnt(3)
s_add_u32 s34,s32,1376256
v_cvt_pk_bf16_f32 v4,v4,v5
v_cvt_pk_bf16_f32 v5,v6,v7
M v[116:119],a[192:195],a[144:147],v[116:119]
s_waitcnt lgkmcnt(2)
s_barrier
ds_read_b128 a[32:35],v250 offset:17408
M v[116:119],a[232:235],a[140:143],v[116:119]
buffer_load_dwordx4 v[212:215],v245,s[8:11],s28 offen offset:768
M v[116:119],a[236:239],a[100:103],v[116:119]
ds_read_b128 a[36:39],v250 offset:21504
ds_read_b128 a[40:43],v250 offset:26112
M v[120:123],a[236:239],a[140:143],v[120:123]
ds_read_b128 a[44:47],v250 offset:30208
ds_read_b128 a[48:51],v250 offset:52224
M v[120:123],a[232:235],a[144:147],v[120:123]
s_waitcnt lgkmcnt(6)
ds_read_b128 a[52:55],v250 offset:56320
ds_read_b128 a[56:59],v250 offset:60928
M v[120:123],a[192:195],a[152:155],v[120:123]
s_waitcnt lgkmcnt(7)
ds_read_b128 a[60:63],v250 offset:65024
buffer_store_dwordx4 a[28:31],v253,s[24:27],s34 offen offset:384 nt
M v[124:127],a[192:195],a[156:159],v[124:127]
ds_write2st64_b64 v254,v[0:1],v[4:5] offset0:68 offset1:72
M v[124:127],a[232:235],a[152:155],v[124:127]
buffer_load_dwordx4 a[228:231],v250,s[20:23],s47 offen offset:0 sc1
M v[124:127],a[236:239],a[144:147],v[124:127]
s_waitcnt vmcnt(29)
v_cvt_pk_bf16_f32 v8,v8,v9
v_cvt_pk_bf16_f32 v9,v10,v11
M v[128:131],a[112:115],a[148:151],v[128:131]
s_waitcnt vmcnt(28)
v_cvt_pk_bf16_f32 v12,v12,v13
v_cvt_pk_bf16_f32 v13,v14,v15
M v[128:131],v[220:223],a[132:135],v[128:131]
s_waitcnt vmcnt(27)
ds_write2st64_b64 v254,v[8:9],v[12:13] offset0:76 offset1:80
M v[128:131],a[124:127],a[252:255],v[128:131]
buffer_load_dwordx4 v[224:227],v250,s[20:23],s47 offen offset:1024 sc1
M v[132:135],a[124:127],a[240:243],v[132:135]
v_cvt_pk_bf16_f32 v16,v16,v17
v_cvt_pk_bf16_f32 v17,v18,v19
M v[132:135],v[220:223],a[252:255],v[132:135]
v_cvt_pk_bf16_f32 v20,v20,v21
v_cvt_pk_bf16_f32 v21,v22,v23
M v[132:135],a[112:115],a[132:135],v[132:135]
ds_write2st64_b64 v254,v[16:17],v[20:21] offset0:85 offset1:89
M v[136:139],a[112:115],a[252:255],v[136:139]
buffer_load_dwordx4 v[228:231],v250,s[20:23],s47 offen offset:2048 sc1
M v[136:139],v[220:223],a[240:243],v[136:139]
v_cvt_pk_bf16_f32 v24,v24,v25
v_cvt_pk_bf16_f32 v25,v26,v27
M v[136:139],a[124:127],a[96:99],v[136:139]
s_add_u32 s34,s32,0
v_cvt_pk_bf16_f32 v28,v28,v29
v_cvt_pk_bf16_f32 v29,v30,v31
M v[140:143],a[124:127],a[100:103],v[140:143]
ds_write2st64_b64 v254,v[24:25],v[28:29] offset0:93 offset1:97
M v[140:143],v[220:223],a[96:99],v[140:143]
v_accvgpr_read_b32 v238,a64
v_accvgpr_read_b32 v232,a160
M v[140:143],a[112:115],a[240:243],v[140:143]
s_waitcnt lgkmcnt(11)
buffer_store_dwordx4 a[32:35],v253,s[24:27],s34 offen offset:512 nt
M v[144:147],a[112:115],a[96:99],v[144:147]
s_add_u32 s46,s76,46080
v_add_f32 v234,v238,v232
v_sub_f32 v238,v238,v232
M v[144:147],v[220:223],a[100:103],v[144:147]
v_add_u32 v248,0x15400,v248
v_add_u32 v249,0x15400,v249
M v[144:147],a[124:127],a[140:143],v[144:147]
v_add_f32 v232,v64,v160
v_sub_f32 v160,v64,v160
M v[148:151],a[124:127],a[144:147],v[148:151]
v_add_f32 v64,v234,v232
v_fmac_f32 v234,4.0,v232
M v[148:151],v[220:223],a[140:143],v[148:151]
ds_read_b128 a[96:99],v248 offset:0
v_fma_f32 v232,2.0,v160,v238
M v[148:151],a[112:115],a[100:103],v[148:151]
ds_read_b128 a[100:103],v249 offset:0
v_fma_f32 v160,s40,v160,v238
M v[152:155],a[112:115],a[140:143],v[152:155]
s_waitcnt lgkmcnt(2)
s_barrier
ds_read_b128 v[0:3],v250 offset:34816
M v[152:155],v[220:223],a[144:147],v[152:155]
ds_read_b128 v[8:11],v250 offset:38912
ds_read_b128 v[16:19],v250 offset:43520
M v[152:155],a[124:127],a[152:155],v[152:155]
ds_read_b128 v[24:27],v250 offset:47616
ds_read_b128 a[140:143],v248 offset:512
M v[156:159],a[124:127],a[156:159],v[156:159]
buffer_load_dwordx4 a[132:135],v250,s[20:23],s46 offen offset:0 sc1
M v[156:159],v[220:223],a[152:155],v[156:159]
ds_read_b128 a[200:203],v249 offset:512
v_accvgpr_read_b32 v238,a65
M v[156:159],a[112:115],a[144:147],v[156:159]
s_waitcnt vmcnt(29) lgkmcnt(7)
buffer_load_dwordx4 a[148:151],v250,s[20:23],s46 offen offset:1024 sc1
v_accvgpr_read_b32 v237,a161
v_add_f32 v236,v238,v237
M v[96:99],a[108:111],a[96:99],v[96:99]
s_waitcnt vmcnt(29) lgkmcnt(6)
ds_read_b128 a[112:115],v248 offset:1024
v_sub_f32 v238,v238,v237
M v[96:99],a[208:211],a[100:103],v[96:99]
s_waitcnt vmcnt(28) lgkmcnt(2)
ds_read_b128 a[124:127],v249 offset:1024
v_add_f32 v237,v65,v161
M v[96:99],a[120:123],a[140:143],v[96:99]
s_waitcnt lgkmcnt(2)
s_add_u32 s34,s32,196608
v_sub_f32 v161,v65,v161
v_add_f32 v65,v236,v237
v_fmac_f32 v236,4.0,v237
v_fma_f32 v237,2.0,v161,v238
v_fma_f32 v161,s40,v161,v238
M v[100:103],a[120:123],a[200:203],v[100:103]
buffer_load_dwordx4 a[224:227],v250,s[20:23],s46 offen offset:2048 sc1
M v[100:103],a[208:211],a[140:143],v[100:103]
v_cvt_pk_bf16_f32 v232,v232,v237
v_cvt_pk_bf16_f32 v234,v234,v236
M v[100:103],a[108:111],a[100:103],v[100:103]
v_accvgpr_read_b32 v238,a66
v_accvgpr_read_b32 v233,a162
v_add_f32 v235,v238,v233
v_sub_f32 v238,v238,v233
M v[104:107],a[108:111],a[140:143],v[104:107]
ds_read_b128 a[144:147],v248 offset:1536
v_add_f32 v233,v66,v162
M v[104:107],a[208:211],a[200:203],v[104:107]
s_waitcnt lgkmcnt(2)
ds_read_b128 a[152:155],v249 offset:1536
v_sub_f32 v162,v66,v162
M v[104:107],a[120:123],a[112:115],v[104:107]
s_waitcnt lgkmcnt(2)
buffer_store_dwordx4 a[36:39],v253,s[24:27],s34 offen offset:512 nt
M v[108:111],a[120:123],a[124:127],v[108:111]
v_add_f32 v66,v235,v233
v_fmac_f32 v235,4.0,v233
M v[108:111],a[208:211],a[112:115],v[108:111]
v_fma_f32 v233,2.0,v162,v238
v_fma_f32 v162,s40,v162,v238
M v[108:111],a[108:111],a[200:203],v[108:111]
v_accvgpr_read_b32 v238,a67
v_accvgpr_read_b32 v237,a163
v_add_f32 v236,v238,v237
v_sub_f32 v238,v238,v237
M v[112:115],a[108:111],a[112:115],v[112:115]
s_add_u32 s47,s76,49152
ds_read_b128 a[156:159],v249 offset:2048
v_add_f32 v237,v67,v163
M v[112:115],a[208:211],a[124:127],v[112:115]
s_waitcnt lgkmcnt(2)
ds_read_b128 a[192:195],v248 offset:2048
v_sub_f32 v163,v67,v163
M v[112:115],a[120:123],a[144:147],v[112:115]
s_waitcnt lgkmcnt(2)
v_add_f32 v67,v236,v237
v_fmac_f32 v236,4.0,v237
v_fma_f32 v237,2.0,v163,v238
v_fma_f32 v163,s40,v163,v238
M v[116:119],a[120:123],a[152:155],v[116:119]
v_cvt_pk_bf16_f32 v233,v233,v237
v_cvt_pk_bf16_f32 v235,v235,v236
M v[116:119],a[208:211],a[144:147],v[116:119]
ds_write2st64_b64 v254,v[232:233],v[234:235] offset0:34 offset1:38
M v[116:119],a[108:111],a[124:127],v[116:119]
v_accvgpr_read_b32 v238,a68
v_accvgpr_read_b32 v232,a164
M v[120:123],a[108:111],a[144:147],v[120:123]
buffer_load_dwordx4 a[160:163],v250,s[20:23],s47 offen offset:0 sc1
M v[120:123],a[208:211],a[152:155],v[120:123]
s_waitcnt lgkmcnt(2)
v_add_f32 v234,v238,v232
v_sub_f32 v238,v238,v232
M v[120:123],a[120:123],a[156:159],v[120:123]
s_waitcnt lgkmcnt(1)
s_add_u32 s34,s32,393216
buffer_load_dwordx4 a[232:235],v250,s[20:23],s47 offen offset:1024 sc1
v_add_f32 v232,v68,v164
v_sub_f32 v164,v68,v164
v_add_f32 v68,v234,v232
M v[124:127],a[120:123],a[192:195],v[124:127]
v_fmac_f32 v234,4.0,v232
v_fma_f32 v232,2.0,v164,v238
M v[124:127],a[208:211],a[156:159],v[124:127]
v_fma_f32 v164,s40,v164,v238
v_accvgpr_read_b32 v238,a69
M v[124:127],a[108:111],a[152:155],v[124:127]
s_waitcnt vmcnt(30)
v_accvgpr_read_b32 v237,a165
v_add_f32 v236,v238,v237
v_sub_f32 v238,v238,v237
v_add_f32 v237,v69,v165
M v[128:131],a[116:119],a[96:99],v[128:131]
s_waitcnt vmcnt(28)
buffer_load_dwordx4 a[236:239],v250,s[20:23],s47 offen offset:2048 sc1
M v[128:131],a[196:199],a[100:103],v[128:131]
s_waitcnt vmcnt(28)
v_sub_f32 v165,v69,v165
v_add_f32 v69,v236,v237
M v[128:131],a[204:207],a[140:143],v[128:131]
v_fmac_f32 v236,4.0,v237
v_fma_f32 v237,2.0,v165,v238
v_fma_f32 v165,s40,v165,v238
v_cvt_pk_bf16_f32 v232,v232,v237
v_cvt_pk_bf16_f32 v234,v234,v236
M v[132:135],a[204:207],a[200:203],v[132:135]
v_accvgpr_read_b32 v238,a70
v_accvgpr_read_b32 v233,a166
M v[132:135],a[196:199],a[140:143],v[132:135]
v_add_f32 v235,v238,v233
v_sub_f32 v238,v238,v233
M v[132:135],a[116:119],a[100:103],v[132:135]
buffer_store_dwordx4 a[40:43],v253,s[24:27],s34 offen offset:512 nt
M v[136:139],a[116:119],a[140:143],v[136:139]
v_add_f32 v233,v70,v166
v_sub_f32 v166,v70,v166
M v[136:139],a[196:199],a[200:203],v[136:139]
v_add_f32 v70,v235,v233
v_fmac_f32 v235,4.0,v233
M v[136:139],a[204:207],a[112:115],v[136:139]
v_fma_f32 v233,2.0,v166,v238
v_fma_f32 v166,s40,v166,v238
v_accvgpr_read_b32 v238,a71
M v[140:143],a[204:207],a[124:127],v[140:143]
v_accvgpr_read_b32 v237,a167
v_add_f32 v236,v238,v237
M v[140:143],a[196:199],a[112:115],v[140:143]
v_sub_f32 v238,v238,v237
v_add_f32 v237,v71,v167
M v[140:143],a[116:119],a[200:203],v[140:143]
v_sub_f32 v167,v71,v167
v_add_f32 v71,v236,v237
v_fmac_f32 v236,4.0,v237
v_fma_f32 v237,2.0,v167,v238
v_fma_f32 v167,s40,v167,v238
M v[144:147],a[116:119],a[112:115],v[144:147]
s_add_u32 s46,s77,46080
v_cvt_pk_bf16_f32 v233,v233,v237
v_cvt_pk_bf16_f32 v235,v235,v236
M v[144:147],a[196:199],a[124:127],v[144:147]
ds_write2st64_b64 v254,v[232:233],v[234:235] offset0:42 offset1:46
M v[144:147],a[204:207],a[144:147],v[144:147]
s_add_u32 s34,s32,589824
buffer_store_dwordx4 a[44:47],v253,s[24:27],s34 offen offset:512 nt
M v[148:151],a[204:207],a[152:155],v[148:151]
v_accvgpr_read_b32 v238,a72
v_accvgpr_read_b32 v232,a168
M v[148:151],a[196:199],a[144:147],v[148:151]
ds_read_b128 a[96:99],v248 offset:17408
v_add_f32 v234,v238,v232
M v[148:151],a[116:119],a[124:127],v[148:151]
ds_read_b128 a[100:103],v249 offset:17408
v_sub_f32 v238,v238,v232
M v[152:155],a[116:119],a[144:147],v[152:155]
buffer_load_dwordx4 a[108:111],v250,s[20:23],s46 offen offset:0 sc1
M v[152:155],a[196:199],a[152:155],v[152:155]
ds_read_b128 a[112:115],v248 offset:17920
ds_read_b128 a[124:127],v249 offset:17920
M v[152:155],a[204:207],a[156:159],v[152:155]
buffer_load_dwordx4 a[120:123],v250,s[20:23],s46 offen offset:1024 sc1
M v[156:159],a[204:207],a[192:195],v[156:159]
v_add_f32 v232,v72,v168
v_sub_f32 v168,v72,v168
M v[156:159],a[196:199],a[156:159],v[156:159]
v_add_f32 v72,v234,v232
v_fmac_f32 v234,4.0,v232
M v[156:159],a[116:119],a[152:155],v[156:159]
s_waitcnt vmcnt(30) lgkmcnt(3)
v_fma_f32 v232,2.0,v168,v238
v_fma_f32 v168,s40,v168,v238
v_accvgpr_read_b32 v238,a73
v_accvgpr_read_b32 v237,a169
v_add_f32 v236,v238,v237
M v[96:99],a[136:139],a[96:99],v[96:99]
s_waitcnt vmcnt(29) lgkmcnt(2)
buffer_load_dwordx4 a[140:143],v250,s[20:23],s46 offen offset:2048 sc1
M v[96:99],a[220:223],a[100:103],v[96:99]
s_waitcnt vmcnt(29) lgkmcnt(1)
ds_read_b128 a[116:119],v248 offset:18432
ds_read_b128 a[144:147],v249 offset:18432
M v[96:99],a[248:251],a[112:115],v[96:99]
s_waitcnt lgkmcnt(2)
v_sub_f32 v238,v238,v237
v_add_f32 v237,v73,v169
v_sub_f32 v169,v73,v169
v_add_f32 v73,v236,v237
v_fmac_f32 v236,4.0,v237
M v[100:103],a[248:251],a[124:127],v[100:103]
v_fma_f32 v237,2.0,v169,v238
v_fma_f32 v169,s40,v169,v238
M v[100:103],a[220:223],a[112:115],v[100:103]
v_cvt_pk_bf16_f32 v232,v232,v237
v_cvt_pk_bf16_f32 v234,v234,v236
M v[100:103],a[136:139],a[100:103],v[100:103]
v_accvgpr_read_b32 v238,a74
v_accvgpr_read_b32 v233,a170
v_add_f32 v235,v238,v233
v_sub_f32 v238,v238,v233
M v[104:107],a[136:139],a[112:115],v[104:107]
ds_read_b128 a[152:155],v248 offset:18944
v_add_f32 v233,v74,v170
M v[104:107],a[220:223],a[124:127],v[104:107]
s_waitcnt lgkmcnt(2)
ds_read_b128 a[156:159],v249 offset:18944
v_sub_f32 v170,v74,v170
M v[104:107],a[248:251],a[116:119],v[104:107]
s_waitcnt lgkmcnt(2)
s_add_u32 s34,s32,786432
buffer_store_dwordx4 a[48:51],v253,s[24:27],s34 offen offset:512 nt
M v[108:111],a[248:251],a[144:147],v[108:111]
v_add_f32 v74,v235,v233
v_fmac_f32 v235,4.0,v233
M v[108:111],a[220:223],a[116:119],v[108:111]
v_fma_f32 v233,2.0,v170,v238
v_fma_f32 v170,s40,v170,v238
M v[108:111],a[136:139],a[124:127],v[108:111]
v_accvgpr_read_b32 v238,a75
v_accvgpr_read_b32 v237,a171
v_add_f32 v236,v238,v237
M v[112:115],a[136:139],a[116:119],v[112:115]
s_add_u32 s47,s77,49152
ds_read_b128 a[164:167],v249 offset:19456
v_sub_f32 v238,v238,v237
M v[112:115],a[220:223],a[144:147],v[112:115]
s_waitcnt lgkmcnt(2)
ds_read_b128 a[252:255],v248 offset:19456
v_add_f32 v237,v75,v171
M v[112:115],a[248:251],a[152:155],v[112:115]
s_waitcnt lgkmcnt(2)
v_sub_f32 v171,v75,v171
v_add_f32 v75,v236,v237
v_fmac_f32 v236,4.0,v237
v_fma_f32 v237,2.0,v171,v238
v_fma_f32 v171,s40,v171,v238
M v[116:119],a[248:251],a[156:159],v[116:119]
v_cvt_pk_bf16_f32 v233,v233,v237
v_cvt_pk_bf16_f32 v235,v235,v236
M v[116:119],a[220:223],a[152:155],v[116:119]
ds_write2st64_b64 v254,v[232:233],v[234:235] offset0:51 offset1:55
M v[116:119],a[136:139],a[144:147],v[116:119]
v_accvgpr_read_b32 v238,a76
v_accvgpr_read_b32 v232,a172
M v[120:123],a[136:139],a[152:155],v[120:123]
buffer_load_dwordx4 a[240:243],v250,s[20:23],s47 offen offset:0 sc1
M v[120:123],a[220:223],a[156:159],v[120:123]
s_waitcnt lgkmcnt(2)
v_add_f32 v234,v238,v232
v_sub_f32 v238,v238,v232
M v[120:123],a[248:251],a[164:167],v[120:123]
s_waitcnt lgkmcnt(1)
buffer_load_dwordx4 v[220:223],v250,s[20:23],s47 offen offset:1024 sc1
v_add_f32 v232,v76,v172
v_sub_f32 v172,v76,v172
M v[124:127],a[248:251],a[252:255],v[124:127]
v_add_f32 v76,v234,v232
v_fmac_f32 v234,4.0,v232
M v[124:127],a[220:223],a[164:167],v[124:127]
v_fma_f32 v232,2.0,v172,v238
v_fma_f32 v172,s40,v172,v238
M v[124:127],a[136:139],a[156:159],v[124:127]
s_waitcnt vmcnt(30)
v_accvgpr_read_b32 v238,a77
v_accvgpr_read_b32 v237,a173
v_add_f32 v236,v238,v237
v_sub_f32 v238,v238,v237
v_add_f32 v237,v77,v173
M v[128:131],a[128:131],a[96:99],v[128:131]
s_waitcnt vmcnt(29)
buffer_load_dwordx4 a[168:171],v250,s[20:23],s47 offen offset:2048 sc1
M v[128:131],a[244:247],a[100:103],v[128:131]
s_waitcnt vmcnt(29)
v_sub_f32 v173,v77,v173
v_add_f32 v77,v236,v237
M v[128:131],a[216:219],a[112:115],v[128:131]
s_add_u32 s34,s32,983040
v_fmac_f32 v236,4.0,v237
v_fma_f32 v237,2.0,v173,v238
v_fma_f32 v173,s40,v173,v238
v_cvt_pk_bf16_f32 v232,v232,v237
M v[132:135],a[216:219],a[124:127],v[132:135]
v_cvt_pk_bf16_f32 v234,v234,v236
v_accvgpr_read_b32 v238,a78
M v[132:135],a[244:247],a[112:115],v[132:135]
v_accvgpr_read_b32 v233,a174
v_add_f32 v235,v238,v233
M v[132:135],a[128:131],a[100:103],v[132:135]
buffer_store_dwordx4 a[52:55],v253,s[24:27],s34 offen offset:512 nt
M v[136:139],a[128:131],a[112:115],v[136:139]
v_sub_f32 v238,v238,v233
v_add_f32 v233,v78,v174
M v[136:139],a[244:247],a[124:127],v[136:139]
v_sub_f32 v174,v78,v174
v_add_f32 v78,v235,v233
M v[136:139],a[216:219],a[116:119],v[136:139]
v_fmac_f32 v235,4.0,v233
v_fma_f32 v233,2.0,v174,v238
v_fma_f32 v174,s40,v174,v238
v_accvgpr_read_b32 v238,a79
M v[140:143],a[216:219],a[144:147],v[140:143]
v_accvgpr_read_b32 v237,a175
v_add_f32 v236,v238,v237
M v[140:143],a[244:247],a[116:119],v[140:143]
v_sub_f32 v238,v238,v237
v_add_f32 v237,v79,v175
M v[140:143],a[128:131],a[124:127],v[140:143]
v_sub_f32 v175,v79,v175
v_add_f32 v79,v236,v237
v_fmac_f32 v236,4.0,v237
v_fma_f32 v237,2.0,v175,v238
M v[144:147],a[128:131],a[116:119],v[144:147]
s_add_u32 s47,s72,3072
v_fma_f32 v175,s40,v175,v238
v_cvt_pk_bf16_f32 v233,v233,v237
M v[144:147],a[244:247],a[144:147],v[144:147]
v_cvt_pk_bf16_f32 v235,v235,v236
M v[144:147],a[216:219],a[152:155],v[144:147]
ds_write2st64_b64 v254,v[232:233],v[234:235] offset0:59 offset1:63
M v[148:151],a[216:219],a[156:159],v[148:151]
v_accvgpr_read_b32 v238,a80
v_accvgpr_read_b32 v232,a176
M v[148:151],a[244:247],a[152:155],v[148:151]
ds_read_b128 a[96:99],v248 offset:34816
v_add_f32 v234,v238,v232
M v[148:151],a[128:131],a[144:147],v[148:151]
ds_read_b128 a[100:103],v249 offset:34816
v_sub_f32 v238,v238,v232
v_add_f32 v232,v80,v176
v_sub_f32 v176,v80,v176
v_add_f32 v80,v234,v232
M v[152:155],a[128:131],a[152:155],v[152:155]
buffer_load_dwordx4 a[112:115],v250,s[20:23],s47 offen offset:0 sc1
M v[152:155],a[244:247],a[156:159],v[152:155]
ds_read_b128 a[116:119],v248 offset:35328
ds_read_b128 a[136:139],v249 offset:35328
M v[152:155],a[216:219],a[164:167],v[152:155]
s_add_u32 s34,s32,1179648
buffer_load_dwordx4 a[124:127],v250,s[20:23],s47 offen offset:1024 sc1
v_fmac_f32 v234,4.0,v232
v_fma_f32 v232,2.0,v176,v238
M v[156:159],a[216:219],a[252:255],v[156:159]
v_fma_f32 v176,s40,v176,v238
v_accvgpr_read_b32 v238,a81
M v[156:159],a[244:247],a[164:167],v[156:159]
v_accvgpr_read_b32 v237,a177
v_add_f32 v236,v238,v237
M v[156:159],a[128:131],a[156:159],v[156:159]
s_waitcnt vmcnt(30) lgkmcnt(3)
v_sub_f32 v238,v238,v237
v_add_f32 v237,v81,v177
v_sub_f32 v177,v81,v177
v_add_f32 v81,v236,v237
v_fmac_f32 v236,4.0,v237
M v[96:99],a[104:107],a[96:99],v[96:99]
s_waitcnt vmcnt(29) lgkmcnt(2)
buffer_load_dwordx4 a[144:147],v250,s[20:23],s47 offen offset:2048 sc1
M v[96:99],a[212:215],a[100:103],v[96:99]
s_waitcnt vmcnt(29) lgkmcnt(1)
ds_read_b128 a[128:131],v248 offset:35840
ds_read_b128 a[152:155],v249 offset:35840
M v[96:99],v[216:219],a[116:119],v[96:99]
s_waitcnt lgkmcnt(2)
v_fma_f32 v237,2.0,v177,v238
v_fma_f32 v177,s40,v177,v238
v_cvt_pk_bf16_f32 v232,v232,v237
M v[100:103],v[216:219],a[136:139],v[100:103]
v_cvt_pk_bf16_f32 v234,v234,v236
v_accvgpr_read_b32 v238,a82
M v[100:103],a[212:215],a[116:119],v[100:103]
v_accvgpr_read_b32 v233,a178
v_add_f32 v235,v238,v233
M v[100:103],a[104:107],a[100:103],v[100:103]
buffer_store_dwordx4 a[56:59],v253,s[24:27],s34 offen offset:512 nt
M v[104:107],a[104:107],a[116:119],v[104:107]
ds_read_b128 a[156:159],v248 offset:36352
v_sub_f32 v238,v238,v233
M v[104:107],a[212:215],a[136:139],v[104:107]
s_waitcnt lgkmcnt(2)
ds_read_b128 a[164:167],v249 offset:36352
v_add_f32 v233,v82,v178
M v[104:107],v[216:219],a[128:131],v[104:107]
s_waitcnt lgkmcnt(2)
v_sub_f32 v178,v82,v178
v_add_f32 v82,v235,v233
M v[108:111],v[216:219],a[152:155],v[108:111]
v_fmac_f32 v235,4.0,v233
v_fma_f32 v233,2.0,v178,v238
M v[108:111],a[212:215],a[128:131],v[108:111]
v_fma_f32 v178,s40,v178,v238
v_accvgpr_read_b32 v238,a83
M v[108:111],a[104:107],a[136:139],v[108:111]
v_accvgpr_read_b32 v237,a179
v_add_f32 v236,v238,v237
M v[112:115],a[104:107],a[128:131],v[112:115]
s_add_u32 s48,s72,6144
ds_read_b128 a[172:175],v249 offset:36864
v_sub_f32 v238,v238,v237
M v[112:115],a[212:215],a[152:155],v[112:115]
s_waitcnt lgkmcnt(2)
ds_read_b128 a[208:211],v248 offset:36864
v_add_f32 v237,v83,v179
M v[112:115],v[216:219],a[156:159],v[112:115]
s_waitcnt lgkmcnt(2)
s_add_u32 s34,s32,1376256
buffer_store_dwordx4 a[60:63],v253,s[24:27],s34 offen offset:512 nt
M v[116:119],v[216:219],a[164:167],v[116:119]
v_sub_f32 v179,v83,v179
v_add_f32 v83,v236,v237
M v[116:119],a[212:215],a[156:159],v[116:119]
v_fmac_f32 v236,4.0,v237
v_fma_f32 v237,2.0,v179,v238
M v[116:119],a[104:107],a[152:155],v[116:119]
v_fma_f32 v179,s40,v179,v238
v_cvt_pk_bf16_f32 v233,v233,v237
M v[120:123],a[104:107],a[156:159],v[120:123]
buffer_load_dwordx4 a[200:203],v250,s[20:23],s48 offen offset:0 sc1
M v[120:123],a[212:215],a[164:167],v[120:123]
s_waitcnt lgkmcnt(1)
v_cvt_pk_bf16_f32 v235,v235,v236
M v[120:123],v[216:219],a[172:175],v[120:123]
s_waitcnt lgkmcnt(0)
buffer_load_dwordx4 a[192:195],v250,s[20:23],s48 offen offset:1024 sc1
M v[124:127],v[216:219],a[208:211],v[124:127]
ds_write2st64_b64 v254,v[232:233],v[234:235] offset0:102 offset1:106
M v[124:127],a[212:215],a[172:175],v[124:127]
v_accvgpr_read_b32 v238,a84
v_accvgpr_read_b32 v232,a180
M v[124:127],a[104:107],a[164:167],v[124:127]
s_waitcnt vmcnt(27)
v_add_f32 v234,v238,v232
v_sub_f32 v238,v238,v232
M v[128:131],a[228:231],a[96:99],v[128:131]
s_waitcnt vmcnt(26)
buffer_load_dwordx4 a[204:207],v250,s[20:23],s48 offen offset:2048 sc1
M v[128:131],v[224:227],a[100:103],v[128:131]
s_waitcnt vmcnt(26)
v_add_f32 v232,v84,v180
v_sub_f32 v180,v84,v180
M v[128:131],v[228:231],a[116:119],v[128:131]
v_add_f32 v84,v234,v232
v_fmac_f32 v234,4.0,v232
M v[132:135],v[228:231],a[136:139],v[132:135]
v_fma_f32 v232,2.0,v180,v238
v_fma_f32 v180,s40,v180,v238
M v[132:135],v[224:227],a[116:119],v[132:135]
v_accvgpr_read_b32 v238,a85
v_accvgpr_read_b32 v237,a181
M v[132:135],a[228:231],a[100:103],v[132:135]
v_add_f32 v236,v238,v237
v_sub_f32 v238,v238,v237
M v[136:139],a[228:231],a[116:119],v[136:139]
v_add_f32 v237,v85,v181
v_sub_f32 v181,v85,v181
M v[136:139],v[224:227],a[136:139],v[136:139]
v_add_f32 v85,v236,v237
v_fmac_f32 v236,4.0,v237
M v[136:139],v[228:231],a[128:131],v[136:139]
s_add_u32 s34,s33,0
buffer_store_dwordx4 v[0:3],v253,s[24:27],s34 offen offset:0 nt
M v[140:143],v[228:231],a[152:155],v[140:143]
v_fma_f32 v237,2.0,v181,v238
v_fma_f32 v181,s40,v181,v238
M v[140:143],v[224:227],a[128:131],v[140:143]
v_cvt_pk_bf16_f32 v232,v232,v237
v_cvt_pk_bf16_f32 v234,v234,v236
M v[140:143],a[228:231],a[136:139],v[140:143]
v_accvgpr_read_b32 v238,a86
v_accvgpr_read_b32 v233,a182
M v[144:147],a[228:231],a[128:131],v[144:147]
s_add_u32 s47,s73,3072
v_add_f32 v235,v238,v233
v_sub_f32 v238,v238,v233
M v[144:147],v[224:227],a[152:155],v[144:147]
v_add_f32 v233,v86,v182
v_sub_f32 v182,v86,v182
M v[144:147],v[228:231],a[156:159],v[144:147]
v_add_f32 v86,v235,v233
v_fmac_f32 v235,4.0,v233
M v[148:151],v[228:231],a[164:167],v[148:151]
v_fma_f32 v233,2.0,v182,v238
v_fma_f32 v182,s40,v182,v238
M v[148:151],v[224:227],a[156:159],v[148:151]
ds_read_b128 a[96:99],v248 offset:52224
v_accvgpr_read_b32 v238,a87
M v[148:151],a[228:231],a[152:155],v[148:151]
ds_read_b128 a[100:103],v249 offset:52224
v_accvgpr_read_b32 v237,a183
v_add_f32 v236,v238,v237
M v[152:155],a[228:231],a[156:159],v[152:155]
buffer_load_dwordx4 a[104:107],v250,s[20:23],s47 offen offset:0 sc1
M v[152:155],v[224:227],a[164:167],v[152:155]
ds_read_b128 a[116:119],v248 offset:52736
ds_read_b128 a[136:139],v249 offset:52736
M v[152:155],v[228:231],a[172:175],v[152:155]
buffer_load_dwordx4 a[128:131],v250,s[20:23],s47 offen offset:1024 sc1
v_sub_f32 v238,v238,v237
M v[156:159],v[228:231],a[208:211],v[156:159]
v_add_f32 v237,v87,v183
v_sub_f32 v183,v87,v183
M v[156:159],v[224:227],a[172:175],v[156:159]
v_add_f32 v87,v236,v237
v_fmac_f32 v236,4.0,v237
M v[156:159],a[228:231],a[164:167],v[156:159]
s_waitcnt vmcnt(27) lgkmcnt(3)
v_fma_f32 v237,2.0,v183,v238
v_fma_f32 v183,s40,v183,v238
v_cvt_pk_bf16_f32 v233,v233,v237
M v[96:99],a[132:135],a[96:99],v[96:99]
s_waitcnt vmcnt(26) lgkmcnt(2)
buffer_load_dwordx4 a[152:155],v250,s[20:23],s47 offen offset:2048 sc1
M v[96:99],a[148:151],a[100:103],v[96:99]
s_waitcnt vmcnt(26) lgkmcnt(1)
ds_read_b128 a[156:159],v248 offset:53248
ds_read_b128 a[164:167],v249 offset:53248
M v[96:99],a[224:227],a[116:119],v[96:99]
s_waitcnt lgkmcnt(2)
s_add_u32 s34,s33,393216
v_cvt_pk_bf16_f32 v235,v235,v236
M v[100:103],a[224:227],a[136:139],v[100:103]
ds_write2st64_b64 v254,v[232:233],v[234:235] offset0:110 offset1:114
M v[100:103],a[148:151],a[116:119],v[100:103]
v_accvgpr_read_b32 v238,a88
v_accvgpr_read_b32 v232,a184
M v[100:103],a[132:135],a[100:103],v[100:103]
buffer_store_dwordx4 v[8:11],v253,s[24:27],s34 offen offset:0 nt
M v[104:107],a[132:135],a[116:119],v[104:107]
ds_read_b128 a[172:175],v248 offset:53760
v_add_f32 v234,v238,v232
M v[104:107],a[148:151],a[136:139],v[104:107]
s_waitcnt lgkmcnt(3)
ds_read_b128 a[176:179],v249 offset:53760
v_sub_f32 v238,v238,v232
M v[104:107],a[224:227],a[156:159],v[104:107]
s_waitcnt lgkmcnt(3)
v_add_f32 v232,v88,v184
v_sub_f32 v184,v88,v184
M v[108:111],a[224:227],a[164:167],v[108:111]
v_add_f32 v88,v234,v232
v_fmac_f32 v234,4.0,v232
M v[108:111],a[148:151],a[156:159],v[108:111]
v_fma_f32 v232,2.0,v184,v238
v_fma_f32 v184,s40,v184,v238
M v[108:111],a[132:135],a[136:139],v[108:111]
v_accvgpr_read_b32 v238,a89
v_accvgpr_read_b32 v237,a185
M v[112:115],a[132:135],a[156:159],v[112:115]
s_add_u32 s48,s73,6144
ds_read_b128 a[180:183],v249 offset:54272
v_add_f32 v236,v238,v237
M v[112:115],a[148:151],a[164:167],v[112:115]
s_waitcnt lgkmcnt(2)
ds_read_b128 a[196:199],v248 offset:54272
v_sub_f32 v238,v238,v237
M v[112:115],a[224:227],a[172:175],v[112:115]
s_waitcnt lgkmcnt(2)
v_add_f32 v237,v89,v185
v_sub_f32 v185,v89,v185
M v[116:119],a[224:227],a[176:179],v[116:119]
v_add_f32 v89,v236,v237
v_fmac_f32 v236,4.0,v237
M v[116:119],a[148:151],a[172:175],v[116:119]
v_fma_f32 v237,2.0,v185,v238
v_fma_f32 v185,s40,v185,v238
M v[116:119],a[132:135],a[164:167],v[116:119]
v_cvt_pk_bf16_f32 v232,v232,v237
v_cvt_pk_bf16_f32 v234,v234,v236
v_accvgpr_read_b32 v238,a90
M v[120:123],a[132:135],a[172:175],v[120:123]
buffer_load_dwordx4 a[248:251],v250,s[20:23],s48 offen offset:0 sc1
M v[120:123],a[148:151],a[176:179],v[120:123]
s_waitcnt lgkmcnt(1)
v_accvgpr_read_b32 v233,a186
v_add_f32 v235,v238,v233
M v[120:123],a[224:227],a[180:183],v[120:123]
s_waitcnt lgkmcnt(0)
s_add_u32 s34,s33,786432
buffer_load_dwordx4 a[220:223],v250,s[20:23],s48 offen offset:1024 sc1
v_sub_f32 v238,v238,v233
M v[124:127],a[224:227],a[196:199],v[124:127]
v_add_f32 v233,v90,v186
v_sub_f32 v186,v90,v186
M v[124:127],a[148:151],a[180:183],v[124:127]
v_add_f32 v90,v235,v233
v_fmac_f32 v235,4.0,v233
M v[124:127],a[132:135],a[176:179],v[124:127]
s_waitcnt vmcnt(27)
v_fma_f32 v233,2.0,v186,v238
v_fma_f32 v186,s40,v186,v238
v_accvgpr_read_b32 v238,a91
M v[128:131],a[160:163],a[96:99],v[128:131]
s_waitcnt vmcnt(26)
buffer_load_dwordx4 a[216:219],v250,s[20:23],s48 offen offset:2048 sc1
M v[128:131],a[232:235],a[100:103],v[128:131]
s_waitcnt vmcnt(26)
v_accvgpr_read_b32 v237,a187
v_add_f32 v236,v238,v237
M v[128:131],a[236:239],a[116:119],v[128:131]
v_sub_f32 v238,v238,v237
v_add_f32 v237,v91,v187
v_sub_f32 v187,v91,v187
M v[132:135],a[236:239],a[136:139],v[132:135]
v_add_f32 v91,v236,v237
v_fmac_f32 v236,4.0,v237
M v[132:135],a[232:235],a[116:119],v[132:135]
v_fma_f32 v237,2.0,v187,v238
v_fma_f32 v187,s40,v187,v238
M v[132:135],a[160:163],a[100:103],v[132:135]
buffer_store_dwordx4 v[16:19],v253,s[24:27],s34 offen offset:0 nt
M v[136:139],a[160:163],a[116:119],v[136:139]
v_cvt_pk_bf16_f32 v233,v233,v237
v_cvt_pk_bf16_f32 v235,v235,v236
M v[136:139],a[232:235],a[136:139],v[136:139]
ds_write2st64_b64 v254,v[232:233],v[234:235] offset0:119 offset1:123
M v[136:139],a[236:239],a[156:159],v[136:139]
v_accvgpr_read_b32 v238,a92
v_accvgpr_read_b32 v232,a188
M v[140:143],a[236:239],a[164:167],v[140:143]
v_add_f32 v234,v238,v232
v_sub_f32 v238,v238,v232
M v[140:143],a[232:235],a[156:159],v[140:143]
v_add_f32 v232,v92,v188
v_sub_f32 v188,v92,v188
M v[140:143],a[160:163],a[136:139],v[140:143]
v_add_f32 v92,v234,v232
v_fmac_f32 v234,4.0,v232
M v[144:147],a[160:163],a[156:159],v[144:147]
s_add_u32 s47,s74,3072
v_fma_f32 v232,2.0,v188,v238
v_fma_f32 v188,s40,v188,v238
M v[144:147],a[232:235],a[164:167],v[144:147]
v_add_u32 v248,0xffffbc00,v248
v_add_u32 v249,0xffffbc00,v249
M v[144:147],a[236:239],a[172:175],v[144:147]
s_add_u32 s34,s33,1179648
buffer_store_dwordx4 v[24:27],v253,s[24:27],s34 offen offset:0 nt
M v[148:151],a[236:239],a[176:179],v[148:151]
v_accvgpr_read_b32 v238,a93
v_accvgpr_read_b32 v237,a189
M v[148:151],a[232:235],a[172:175],v[148:151]
ds_read_b128 a[96:99],v248 offset:0
v_add_f32 v236,v238,v237
M v[148:151],a[160:163],a[164:167],v[148:151]
ds_read_b128 a[100:103],v249 offset:0
v_sub_f32 v238,v238,v237
M v[152:155],a[160:163],a[172:175],v[152:155]
buffer_load_dwordx4 a[116:119],v250,s[20:23],s47 offen offset:0 sc1
M v[152:155],a[232:235],a[176:179],v[152:155]
ds_read_b128 a[132:135],v248 offset:512
ds_read_b128 a[148:151],v249 offset:512
M v[152:155],a[236:239],a[180:183],v[152:155]
buffer_load_dwordx4 a[136:139],v250,s[20:23],s47 offen offset:1024 sc1
M v[156:159],a[236:239],a[196:199],v[156:159]
v_add_f32 v237,v93,v189
v_sub_f32 v189,v93,v189
M v[156:159],a[232:235],a[180:183],v[156:159]
v_add_f32 v93,v236,v237
v_fmac_f32 v236,4.0,v237
M v[156:159],a[160:163],a[176:179],v[156:159]
s_waitcnt vmcnt(27) lgkmcnt(3)
v_fma_f32 v237,2.0,v189,v238
v_fma_f32 v189,s40,v189,v238
M v[96:99],a[108:111],a[96:99],v[96:99]
s_waitcnt vmcnt(26) lgkmcnt(2)
buffer_load_dwordx4 a[156:159],v250,s[20:23],s47 offen offset:2048 sc1
M v[96:99],a[120:123],a[100:103],v[96:99]
s_waitcnt vmcnt(26) lgkmcnt(1)
ds_read_b128 a[160:163],v248 offset:1024
ds_read_b128 a[164:167],v249 offset:1024
M v[96:99],a[140:143],a[132:135],v[96:99]
s_waitcnt lgkmcnt(2)
v_cvt_pk_bf16_f32 v232,v232,v237
v_cvt_pk_bf16_f32 v234,v234,v236
M v[100:103],a[140:143],a[148:151],v[100:103]
v_accvgpr_read_b32 v238,a94
v_accvgpr_read_b32 v233,a190
M v[100:103],a[120:123],a[132:135],v[100:103]
v_add_f32 v235,v238,v233
v_sub_f32 v238,v238,v233
M v[100:103],a[108:111],a[100:103],v[100:103]
v_add_f32 v233,v94,v190
v_sub_f32 v190,v94,v190
M v[104:107],a[108:111],a[132:135],v[104:107]
ds_read_b128 a[172:175],v248 offset:1536
v_add_f32 v94,v235,v233
M v[104:107],a[120:123],a[148:151],v[104:107]
s_waitcnt lgkmcnt(2)
ds_read_b128 a[176:179],v249 offset:1536
v_fmac_f32 v235,4.0,v233
M v[104:107],a[140:143],a[160:163],v[104:107]
s_waitcnt lgkmcnt(2)
v_fma_f32 v233,2.0,v190,v238
v_fma_f32 v190,s40,v190,v238
v_accvgpr_read_b32 v238,a95
M v[108:111],a[140:143],a[164:167],v[108:111]
v_accvgpr_read_b32 v237,a191
v_add_f32 v236,v238,v237
M v[108:111],a[120:123],a[160:163],v[108:111]
v_sub_f32 v238,v238,v237
v_add_f32 v237,v95,v191
M v[108:111],a[108:111],a[148:151],v[108:111]
v_sub_f32 v191,v95,v191
v_add_f32 v95,v236,v237
v_fmac_f32 v236,4.0,v237
v_fma_f32 v237,2.0,v191,v238
M v[112:115],a[108:111],a[160:163],v[112:115]
s_add_u32 s48,s74,6144
ds_read_b128 a[180:183],v249 offset:2048
v_fma_f32 v191,s40,v191,v238
M v[112:115],a[120:123],a[164:167],v[112:115]
s_waitcnt lgkmcnt(2)
ds_read_b128 a[184:187],v248 offset:2048
v_cvt_pk_bf16_f32 v233,v233,v237
M v[112:115],a[140:143],a[172:175],v[112:115]
s_waitcnt lgkmcnt(2)
v_cvt_pk_bf16_f32 v235,v235,v236
M v[116:119],a[140:143],a[176:179],v[116:119]
ds_write2st64_b64 v254,v[232:233],v[234:235] offset0:127 offset1:131
M v[116:119],a[120:123],a[172:175],v[116:119]
v_cvt_pk_bf16_f32 v96,v96,v97
v_cvt_pk_bf16_f32 v97,v98,v99
M v[116:119],a[108:111],a[164:167],v[116:119]
v_cvt_pk_bf16_f32 v100,v100,v101
v_cvt_pk_bf16_f32 v101,v102,v103
M v[120:123],a[108:111],a[172:175],v[120:123]
s_waitcnt lgkmcnt(0)
s_barrier
ds_read_b128 a[64:67],v250 offset:17408
M v[120:123],a[120:123],a[176:179],v[120:123]
ds_read_b128 a[68:71],v250 offset:21504
ds_read_b128 a[72:75],v250 offset:26112
M v[120:123],a[140:143],a[180:183],v[120:123]
ds_read_b128 a[76:79],v250 offset:30208
ds_read_b128 a[80:83],v250 offset:52224
M v[124:127],a[140:143],a[184:187],v[124:127]
ds_read_b128 a[84:87],v250 offset:56320
ds_read_b128 a[88:91],v250 offset:60928
M v[124:127],a[120:123],a[180:183],v[124:127]
ds_read_b128 a[92:95],v250 offset:65024
v_add_u32 v4,69632,v250
M v[124:127],a[108:111],a[176:179],v[124:127]
s_waitcnt vmcnt(24) lgkmcnt(7)
s_add_u32 s34,s32,0
buffer_store_dwordx4 a[64:67],v253,s[24:27],s34 offen offset:640 nt
M v[128:131],a[240:243],a[96:99],v[128:131]
s_waitcnt vmcnt(24)
buffer_load_dwordx4 a[188:191],v250,s[20:23],s48 offen offset:0 sc1
M v[128:131],v[220:223],a[100:103],v[128:131]
s_waitcnt vmcnt(24)
ds_write2st64_b64 v254,v[96:97],v[100:101] offset0:68 offset1:72
M v[128:131],a[168:171],a[132:135],v[128:131]
s_add_u32 s34,s32,196608
v_cvt_pk_bf16_f32 v104,v104,v105
v_cvt_pk_bf16_f32 v105,v106,v107
M v[132:135],a[168:171],a[148:151],v[132:135]
v_cvt_pk_bf16_f32 v108,v108,v109
v_cvt_pk_bf16_f32 v109,v110,v111
M v[132:135],v[220:223],a[132:135],v[132:135]
buffer_load_dwordx4 a[252:255],v250,s[20:23],s48 offen offset:1024 sc1
M v[132:135],a[240:243],a[100:103],v[132:135]
ds_write2st64_b64 v254,v[104:105],v[108:109] offset0:76 offset1:80
M v[136:139],a[240:243],a[132:135],v[136:139]
v_cvt_pk_bf16_f32 v112,v112,v113
v_cvt_pk_bf16_f32 v113,v114,v115
M v[136:139],v[220:223],a[148:151],v[136:139]
buffer_load_dwordx4 a[244:247],v250,s[20:23],s48 offen offset:2048 sc1
M v[136:139],a[168:171],a[160:163],v[136:139]
v_cvt_pk_bf16_f32 v116,v116,v117
v_cvt_pk_bf16_f32 v117,v118,v119
M v[140:143],a[168:171],a[164:167],v[140:143]
ds_write2st64_b64 v254,v[112:113],v[116:117] offset0:85 offset1:89
M v[140:143],v[220:223],a[160:163],v[140:143]
v_cvt_pk_bf16_f32 v120,v120,v121
v_cvt_pk_bf16_f32 v121,v122,v123
M v[140:143],a[240:243],a[148:151],v[140:143]
s_waitcnt lgkmcnt(9)
buffer_store_dwordx4 a[68:71],v253,s[24:27],s34 offen offset:640 nt
M v[144:147],a[240:243],a[160:163],v[144:147]
s_add_u32 s47,s75,3072
v_cvt_pk_bf16_f32 v124,v124,v125
v_cvt_pk_bf16_f32 v125,v126,v127
M v[144:147],v[220:223],a[164:167],v[144:147]
ds_write2st64_b64 v254,v[120:121],v[124:125] offset0:93 offset1:97
M v[144:147],a[168:171],a[172:175],v[144:147]
v_add_u32 v248,0xfffece00,v248
v_add_u32 v249,0xfffece00,v249
M v[148:151],a[168:171],a[176:179],v[148:151]
v_cvt_pk_bf16_f32 v128,v128,v129
v_cvt_pk_bf16_f32 v129,v130,v131
M v[148:151],v[220:223],a[172:175],v[148:151]
ds_read_b128 a[96:99],v248 offset:0
v_cvt_pk_bf16_f32 v132,v132,v133
M v[148:151],a[240:243],a[164:167],v[148:151]
ds_read_b128 a[100:103],v249 offset:0
v_cvt_pk_bf16_f32 v133,v134,v135
M v[152:155],a[240:243],a[172:175],v[152:155]
s_waitcnt lgkmcnt(2)
s_barrier
ds_read_b128 v[96:99],v250 offset:34816
M v[152:155],v[220:223],a[176:179],v[152:155]
ds_read_b128 v[104:107],v250 offset:38912
ds_read_b128 v[112:115],v250 offset:43520
M v[152:155],a[168:171],a[180:183],v[152:155]
s_add_u32 s34,s32,393216
ds_read_b128 v[120:123],v250 offset:47616
buffer_load_dwordx4 a[108:111],v250,s[20:23],s47 offen offset:0 sc1
M v[156:159],a[168:171],a[184:187],v[156:159]
ds_read_b128 a[120:123],v248 offset:512
ds_read_b128 a[140:143],v249 offset:512
M v[156:159],v[220:223],a[180:183],v[156:159]
buffer_load_dwordx4 a[132:135],v250,s[20:23],s47 offen offset:1024 sc1
M v[156:159],a[240:243],a[176:179],v[156:159]
s_waitcnt vmcnt(27) lgkmcnt(7)
ds_write2st64_b64 v254,v[128:129],v[132:133] offset0:34 offset1:38
M v[32:35],a[112:115],a[96:99],v[32:35]
s_waitcnt vmcnt(26) lgkmcnt(7)
ds_read_b128 a[160:163],v248 offset:1024
v_cvt_pk_bf16_f32 v136,v136,v137
M v[32:35],a[124:127],a[100:103],v[32:35]
s_waitcnt vmcnt(25) lgkmcnt(3)
buffer_load_dwordx4 a[148:151],v250,s[20:23],s47 offen offset:2048 sc1
M v[32:35],a[144:147],a[120:123],v[32:35]
s_waitcnt lgkmcnt(2)
ds_read_b128 a[164:167],v249 offset:1024
v_cvt_pk_bf16_f32 v137,v138,v139
M v[36:39],a[144:147],a[140:143],v[36:39]
v_cvt_pk_bf16_f32 v140,v140,v141
v_cvt_pk_bf16_f32 v141,v142,v143
M v[36:39],a[124:127],a[120:123],v[36:39]
ds_write2st64_b64 v254,v[136:137],v[140:141] offset0:42 offset1:46
M v[36:39],a[112:115],a[100:103],v[36:39]
buffer_store_dwordx4 a[72:75],v253,s[24:27],s34 offen offset:640 nt
M v[40:43],a[112:115],a[120:123],v[40:43]
ds_read_b128 a[168:171],v248 offset:1536
v_cvt_pk_bf16_f32 v144,v144,v145
M v[40:43],a[124:127],a[140:143],v[40:43]
s_waitcnt lgkmcnt(3)
ds_read_b128 a[172:175],v249 offset:1536
v_cvt_pk_bf16_f32 v145,v146,v147
M v[40:43],a[144:147],a[160:163],v[40:43]
s_waitcnt lgkmcnt(3)
v_cvt_pk_bf16_f32 v148,v148,v149
v_cvt_pk_bf16_f32 v149,v150,v151
M v[44:47],a[144:147],a[164:167],v[44:47]
ds_write2st64_b64 v254,v[144:145],v[148:149] offset0:51 offset1:55
M v[44:47],a[124:127],a[160:163],v[44:47]
v_cvt_pk_bf16_f32 v152,v152,v153
v_cvt_pk_bf16_f32 v153,v154,v155
M v[44:47],a[112:115],a[140:143],v[44:47]
v_cvt_pk_bf16_f32 v156,v156,v157
v_cvt_pk_bf16_f32 v157,v158,v159
M v[48:51],a[112:115],a[160:163],v[48:51]
ds_read_b128 a[176:179],v249 offset:2048
ds_write2st64_b64 v254,v[152:153],v[156:157] offset0:59 offset1:63
M v[48:51],a[124:127],a[164:167],v[48:51]
s_waitcnt lgkmcnt(4)
ds_read_b128 a[180:183],v248 offset:2048
v_permlane32_swap_b32 v208,v210
M v[48:51],a[144:147],a[168:171],v[48:51]
s_waitcnt lgkmcnt(4)
s_add_u32 s34,s32,589824
buffer_store_dwordx4 a[76:79],v253,s[24:27],s34 offen offset:640 nt
M v[52:55],a[144:147],a[172:175],v[52:55]
v_permlane32_swap_b32 v204,v206
v_permlane32_swap_b32 v212,v214
M v[52:55],a[124:127],a[168:171],v[52:55]
v_lshlrev_b32 v234,16,v210
v_lshlrev_b32 v232,16,v204
M v[52:55],a[112:115],a[164:167],v[52:55]
v_lshlrev_b32 v233,16,v208
v_lshlrev_b32 v237,16,v206
M v[56:59],a[112:115],a[168:171],v[56:59]
global_load_dword a184,v250,s[64:65]
M v[56:59],a[124:127],a[172:175],v[56:59]
s_waitcnt lgkmcnt(2)
s_add_u32 s48,s75,6144
buffer_load_dwordx4 a[184:187],v250,s[20:23],s48 offen offset:0 sc1
M v[56:59],a[144:147],a[176:179],v[56:59]
s_waitcnt lgkmcnt(0)
v_lshlrev_b32 v236,16,v214
v_lshlrev_b32 v235,16,v212
M v[60:63],a[144:147],a[180:183],v[60:63]
v_fmac_f32 v232,s43,v234
M v[60:63],a[124:127],a[176:179],v[60:63]
s_barrier
ds_read_b128 v[128:131],v250 offset:17408
M v[60:63],a[112:115],a[172:175],v[60:63]
s_waitcnt vmcnt(27)
ds_read_b128 v[136:139],v250 offset:21504
ds_read_b128 v[144:147],v250 offset:26112
M v[64:67],a[200:203],a[96:99],v[64:67]
s_waitcnt vmcnt(26)
ds_read_b128 v[152:155],v250 offset:30208
v_fmac_f32 v237,4.0,v233
M v[64:67],a[192:195],a[100:103],v[64:67]
s_waitcnt vmcnt(25)
buffer_load_dwordx4 v[216:219],v250,s[20:23],s48 offen offset:1024 sc1
M v[64:67],a[204:207],a[120:123],v[64:67]
v_fma_f32 v238,-4.0,v234,v236
v_fmac_f32 v232,s45,v236
M v[68:71],a[204:207],a[140:143],v[68:71]
buffer_load_dwordx4 a[212:215],v250,s[20:23],s48 offen offset:2048 sc1
M v[68:71],a[192:195],a[120:123],v[68:71]
v_fmac_f32 v237,s41,v235
v_sub_f32 v236,v236,v234
M v[68:71],a[200:203],a[100:103],v[68:71]
v_fma_f32 v234,-4.0,v233,v235
v_sub_f32 v235,v235,v233
M v[72:75],a[200:203],a[120:123],v[72:75]
v_add_f32 v233,v238,v234
v_sub_f32 v238,v238,v234
M v[72:75],a[192:195],a[140:143],v[72:75]
v_fma_f32 v234,2.0,v235,v236
v_fmac_f32 v236,-2.0,v235
M v[72:75],a[204:207],a[160:163],v[72:75]
s_add_u32 s34,s32,786432
buffer_store_dwordx4 a[80:83],v253,s[24:27],s34 offen offset:640 nt
M v[76:79],a[204:207],a[164:167],v[76:79]
v_and_b32 v210,s42,v210
v_and_b32 v204,s42,v204
M v[76:79],a[192:195],a[160:163],v[76:79]
v_and_b32 v208,s42,v208
v_and_b32 v206,s42,v206
M v[76:79],a[200:203],a[140:143],v[76:79]
v_and_b32 v214,s42,v214
v_and_b32 v212,s42,v212
M v[80:83],a[200:203],a[160:163],v[80:83]
s_add_u32 s47,s76,3072
v_fmac_f32 v204,s43,v210
v_fmac_f32 v206,4.0,v208
M v[80:83],a[192:195],a[164:167],v[80:83]
v_add_u32 v248,0x15400,v248
v_add_u32 v249,0x15400,v249
M v[80:83],a[204:207],a[168:171],v[80:83]
v_fma_f32 v235,-4.0,v210,v214
v_fmac_f32 v204,s45,v214
M v[84:87],a[204:207],a[172:175],v[84:87]
v_fmac_f32 v206,s41,v212
v_sub_f32 v214,v214,v210
M v[84:87],a[192:195],a[168:171],v[84:87]
ds_read_b128 a[96:99],v248 offset:0
v_fma_f32 v210,-4.0,v208,v212
M v[84:87],a[200:203],a[164:167],v[84:87]
ds_read_b128 a[100:103],v249 offset:0
v_sub_f32 v212,v212,v208
M v[88:91],a[200:203],a[168:171],v[88:91]
buffer_load_dwordx4 a[112:115],v250,s[20:23],s47 offen offset:0 sc1
M v[88:91],a[192:195],a[172:175],v[88:91]
ds_read_b128 a[120:123],v248 offset:512
ds_read_b128 a[140:143],v249 offset:512
M v[88:91],a[204:207],a[176:179],v[88:91]
buffer_load_dwordx4 a[124:127],v250,s[20:23],s47 offen offset:1024 sc1
M v[92:95],a[204:207],a[180:183],v[92:95]
v_add_f32 v208,v235,v210
v_sub_f32 v235,v235,v210
M v[92:95],a[192:195],a[176:179],v[92:95]
v_fma_f32 v210,2.0,v212,v214
v_fmac_f32 v214,-2.0,v212
M v[92:95],a[200:203],a[172:175],v[92:95]
s_waitcnt vmcnt(28) lgkmcnt(3)
v_cvt_pk_bf16_f32 v204,v232,v204
v_cvt_pk_bf16_f32 v206,v237,v206
M v[32:35],a[104:107],a[96:99],v[32:35]
s_waitcnt vmcnt(27) lgkmcnt(2)
buffer_load_dwordx4 a[144:147],v250,s[20:23],s47 offen offset:2048 sc1
M v[32:35],a[128:131],a[100:103],v[32:35]
s_waitcnt vmcnt(27) lgkmcnt(1)
ds_read_b128 a[160:163],v248 offset:1024
ds_read_b128 a[164:167],v249 offset:1024
M v[32:35],a[152:155],a[120:123],v[32:35]
s_waitcnt lgkmcnt(2)
s_add_u32 s34,s32,983040
v_cvt_pk_bf16_f32 v208,v233,v208
v_cvt_pk_bf16_f32 v212,v234,v210
M v[36:39],a[152:155],a[140:143],v[36:39]
v_cvt_pk_bf16_f32 v210,v238,v235
v_cvt_pk_bf16_f32 v214,v236,v214
M v[36:39],a[128:131],a[120:123],v[36:39]
v_permlane32_swap_b32 v209,v211
v_permlane32_swap_b32 v205,v207
M v[36:39],a[104:107],a[100:103],v[36:39]
buffer_store_dwordx4 a[84:87],v253,s[24:27],s34 offen offset:640 nt
M v[40:43],a[104:107],a[120:123],v[40:43]
ds_read_b128 a[168:171],v248 offset:1536
v_permlane32_swap_b32 v213,v215
M v[40:43],a[128:131],a[140:143],v[40:43]
s_waitcnt lgkmcnt(2)
ds_read_b128 a[172:175],v249 offset:1536
v_lshlrev_b32 v234,16,v211
M v[40:43],a[152:155],a[160:163],v[40:43]
s_waitcnt lgkmcnt(2)
v_lshlrev_b32 v232,16,v205
v_lshlrev_b32 v233,16,v209
M v[44:47],a[152:155],a[164:167],v[44:47]
v_lshlrev_b32 v237,16,v207
v_lshlrev_b32 v236,16,v215
M v[44:47],a[128:131],a[160:163],v[44:47]
v_lshlrev_b32 v235,16,v213
v_fmac_f32 v232,s43,v234
M v[44:47],a[104:107],a[140:143],v[44:47]
v_fmac_f32 v237,4.0,v233
v_fma_f32 v238,-4.0,v234,v236
M v[48:51],a[104:107],a[160:163],v[48:51]
s_add_u32 s48,s76,6144
ds_read_b128 a[176:179],v249 offset:2048
v_fmac_f32 v232,s45,v236
M v[48:51],a[128:131],a[164:167],v[48:51]
s_waitcnt lgkmcnt(2)
ds_read_b128 a[180:183],v248 offset:2048
v_fmac_f32 v237,s41,v235
M v[48:51],a[152:155],a[168:171],v[48:51]
s_waitcnt lgkmcnt(2)
v_sub_f32 v236,v236,v234
v_fma_f32 v234,-4.0,v233,v235
M v[52:55],a[152:155],a[172:175],v[52:55]
v_sub_f32 v235,v235,v233
v_add_f32 v233,v238,v234
M v[52:55],a[128:131],a[168:171],v[52:55]
v_sub_f32 v238,v238,v234
v_fma_f32 v234,2.0,v235,v236
M v[52:55],a[104:107],a[164:167],v[52:55]
v_fmac_f32 v236,-2.0,v235
v_and_b32 v211,s42,v211
M v[56:59],a[104:107],a[168:171],v[56:59]
buffer_load_dwordx4 a[208:211],v250,s[20:23],s48 offen offset:0 sc1
M v[56:59],a[128:131],a[172:175],v[56:59]
s_waitcnt lgkmcnt(1)
v_and_b32 v205,s42,v205
v_and_b32 v209,s42,v209
M v[56:59],a[152:155],a[176:179],v[56:59]
s_waitcnt lgkmcnt(0)
s_add_u32 s34,s32,1179648
buffer_load_dwordx4 v[228:231],v250,s[20:23],s48 offen offset:1024 sc1
M v[60:63],a[152:155],a[180:183],v[60:63]
v_and_b32 v207,s42,v207
v_and_b32 v215,s42,v215
M v[60:63],a[128:131],a[176:179],v[60:63]
v_and_b32 v213,s42,v213
v_fmac_f32 v205,s43,v211
M v[60:63],a[104:107],a[172:175],v[60:63]
s_waitcnt vmcnt(28)
v_fmac_f32 v207,4.0,v209
v_fma_f32 v235,-4.0,v211,v215
M v[64:67],a[248:251],a[96:99],v[64:67]
s_waitcnt vmcnt(27)
buffer_load_dwordx4 v[224:227],v250,s[20:23],s48 offen offset:2048 sc1
M v[64:67],a[220:223],a[100:103],v[64:67]
s_waitcnt vmcnt(27)
v_fmac_f32 v205,s45,v215
v_fmac_f32 v207,s41,v213
M v[64:67],a[216:219],a[120:123],v[64:67]
v_sub_f32 v215,v215,v211
v_fma_f32 v211,-4.0,v209,v213
M v[68:71],a[216:219],a[140:143],v[68:71]
v_sub_f32 v213,v213,v209
v_add_f32 v209,v235,v211
M v[68:71],a[220:223],a[120:123],v[68:71]
v_sub_f32 v235,v235,v211
v_fma_f32 v211,2.0,v213,v215
M v[68:71],a[248:251],a[100:103],v[68:71]
buffer_store_dwordx4 a[88:91],v253,s[24:27],s34 offen offset:640 nt
M v[72:75],a[248:251],a[120:123],v[72:75]
v_fmac_f32 v215,-2.0,v213
v_cvt_pk_bf16_f32 v205,v232,v205
M v[72:75],a[220:223],a[140:143],v[72:75]
v_cvt_pk_bf16_f32 v207,v237,v207
v_cvt_pk_bf16_f32 v209,v233,v209
M v[72:75],a[216:219],a[160:163],v[72:75]
v_cvt_pk_bf16_f32 v213,v234,v211
v_cvt_pk_bf16_f32 v211,v238,v235
M v[76:79],a[216:219],a[164:167],v[76:79]
v_cvt_pk_bf16_f32 v215,v236,v215
M v[76:79],a[220:223],a[160:163],v[76:79]
s_barrier
v_fmac_f32 v239,s43,v241
M v[76:79],a[248:251],a[140:143],v[76:79]
ds_write2st64_b64 v247,v[192:193],v[194:195] offset0:102 offset1:119
M v[80:83],a[248:251],a[160:163],v[80:83]
s_add_u32 s28,s66,7077888
buffer_load_dwordx4 v[192:195],v251,s[88:91],s28 offen offset:0
M v[80:83],a[220:223],a[164:167],v[80:83]
s_add_u32 s47,s77,3072
v_fmac_f32 v244,4.0,v240
v_fma_f32 v232,-4.0,v241,v243
M v[80:83],a[216:219],a[168:171],v[80:83]
s_add_u32 s34,s32,1376256
ds_write2st64_b64 v247,v[196:197],v[198:199] offset0:34 offset1:51
M v[84:87],a[216:219],a[172:175],v[84:87]
buffer_load_dwordx4 v[196:199],v245,s[8:11],s28 offen offset:0
M v[84:87],a[220:223],a[168:171],v[84:87]
ds_read_b128 a[96:99],v248 offset:17408
v_fmac_f32 v239,s45,v243
M v[84:87],a[248:251],a[164:167],v[84:87]
ds_write2st64_b64 v247,v[200:201],v[202:203] offset0:68 offset1:85
M v[88:91],a[248:251],a[168:171],v[88:91]
buffer_load_dwordx4 v[200:203],v245,s[8:11],s28 offen offset:768
M v[88:91],a[220:223],a[172:175],v[88:91]
ds_read_b128 a[100:103],v249 offset:17408
ds_read_b128 a[120:123],v248 offset:17920
M v[88:91],a[216:219],a[176:179],v[88:91]
ds_write2st64_b64 v247,v[204:205],v[206:207] offset0:103 offset1:120
M v[92:95],a[216:219],a[180:183],v[92:95]
s_add_u32 s28,s66,7471104
buffer_load_dwordx4 v[204:207],v251,s[88:91],s28 offen offset:0
M v[92:95],a[220:223],a[176:179],v[92:95]
ds_read_b128 a[140:143],v249 offset:17920
v_fmac_f32 v244,s41,v242
M v[92:95],a[248:251],a[172:175],v[92:95]
s_waitcnt vmcnt(29) lgkmcnt(5)
ds_write2st64_b64 v247,v[208:209],v[210:211] offset0:35 offset1:52
M v[32:35],a[116:119],a[96:99],v[32:35]
s_waitcnt vmcnt(28) lgkmcnt(4)
buffer_load_dwordx4 v[208:211],v245,s[8:11],s28 offen offset:0
M v[32:35],a[136:139],a[100:103],v[32:35]
s_waitcnt vmcnt(28) lgkmcnt(3)
ds_read_b128 a[160:163],v248 offset:18432
ds_read_b128 a[164:167],v249 offset:18432
M v[32:35],a[156:159],a[120:123],v[32:35]
s_waitcnt lgkmcnt(3)
ds_write2st64_b64 v247,v[212:213],v[214:215] offset0:69 offset1:86
M v[36:39],a[156:159],a[140:143],v[36:39]
buffer_load_dwordx4 v[212:215],v245,s[8:11],s28 offen offset:768
M v[36:39],a[136:139],a[120:123],v[36:39]
v_sub_f32 v243,v243,v241
v_fma_f32 v241,-4.0,v240,v242
M v[36:39],a[116:119],a[100:103],v[36:39]
v_sub_f32 v242,v242,v240
v_add_f32 v240,v232,v241
M v[40:43],a[116:119],a[120:123],v[40:43]
ds_read_b128 a[168:171],v248 offset:18944
v_sub_f32 v232,v232,v241
M v[40:43],a[136:139],a[140:143],v[40:43]
s_waitcnt lgkmcnt(3)
buffer_load_dwordx4 a[104:107],v250,s[20:23],s47 offen offset:0 sc1
M v[40:43],a[156:159],a[160:163],v[40:43]
s_waitcnt lgkmcnt(2)
ds_read_b128 a[172:175],v249 offset:18944
v_fma_f32 v241,2.0,v242,v243
M v[44:47],a[156:159],a[164:167],v[44:47]
v_fmac_f32 v243,-2.0,v242
v_cvt_pk_bf16_f32 v233,v239,v244
M v[44:47],a[136:139],a[160:163],v[44:47]
v_cvt_pk_bf16_f32 v234,v240,v232
v_cvt_pk_bf16_f32 v235,v241,v243
M v[44:47],a[116:119],a[140:143],v[44:47]
s_add_u32 s29,s67,6291456
buffer_load_short_d16_hi v239,v246,s[12:15],s29 offen offset:0
M v[48:51],a[116:119],a[160:163],v[48:51]
ds_read_b128 a[176:179],v249 offset:19456
ds_write_b16 v252,v233 offset:52224
M v[48:51],a[136:139],a[164:167],v[48:51]
s_waitcnt lgkmcnt(3)
buffer_load_short_d16_hi v240,v246,s[8:11],s29 offen offset:0
M v[48:51],a[156:159],a[168:171],v[48:51]
s_waitcnt lgkmcnt(2)
buffer_load_short_d16_hi v241,v246,s[8:11],s29 offen offset:384
M v[52:55],a[156:159],a[172:175],v[52:55]
ds_read_b128 a[180:183],v248 offset:19456
ds_write_b16_d16_hi v252,v233 offset:60928
M v[52:55],a[136:139],a[168:171],v[52:55]
buffer_load_short_d16_hi v242,v246,s[8:11],s29 offen offset:768
M v[52:55],a[116:119],a[164:167],v[52:55]
ds_write_b16 v252,v234 offset:17408
M v[56:59],a[116:119],a[168:171],v[56:59]
buffer_load_short_d16_hi v243,v246,s[8:11],s29 offen offset:1152
M v[56:59],a[136:139],a[172:175],v[56:59]
s_waitcnt lgkmcnt(4)
ds_write_b16_d16_hi v252,v234 offset:26112
M v[56:59],a[156:159],a[176:179],v[56:59]
s_waitcnt lgkmcnt(3)
buffer_load_short_d16_hi v244,v246,s[16:19],s29 offen offset:1536
M v[60:63],a[156:159],a[180:183],v[60:63]
ds_write_b16 v252,v235 offset:34816
M v[60:63],a[136:139],a[176:179],v[60:63]
buffer_load_dwordx4 a[128:131],v250,s[20:23],s47 offen offset:1024 sc1
M v[60:63],a[116:119],a[172:175],v[60:63]
s_waitcnt vmcnt(35)
ds_write_b16_d16_hi v252,v235 offset:43520
M v[64:67],a[188:191],a[96:99],v[64:67]
s_waitcnt vmcnt(34)
M v[64:67],a[252:255],a[100:103],v[64:67]
s_waitcnt vmcnt(33)
M v[64:67],a[244:247],a[120:123],v[64:67]
buffer_store_dwordx4 a[92:95],v253,s[24:27],s34 offen offset:640 nt
M v[68:71],a[244:247],a[140:143],v[68:71]
s_add_u32 s34,s33,0
M v[68:71],a[252:255],a[120:123],v[68:71]
M v[68:71],a[188:191],a[100:103],v[68:71]
buffer_load_dwordx4 a[152:155],v250,s[20:23],s47 offen offset:2048 sc1
M v[72:75],a[188:191],a[120:123],v[72:75]
s_add_u32 s48,s77,6144
M v[72:75],a[252:255],a[140:143],v[72:75]
M v[72:75],a[244:247],a[160:163],v[72:75]
M v[76:79],a[244:247],a[164:167],v[76:79]
buffer_load_dwordx4 a[228:231],v250,s[20:23],s48 offen offset:0 sc1
M v[76:79],a[252:255],a[160:163],v[76:79]
M v[76:79],a[188:191],a[140:143],v[76:79]
M v[80:83],a[188:191],a[160:163],v[80:83]
M v[80:83],a[252:255],a[164:167],v[80:83]
buffer_load_dwordx4 a[224:227],v250,s[20:23],s48 offen offset:1024 sc1
M v[80:83],a[244:247],a[168:171],v[80:83]
M v[84:87],a[244:247],a[172:175],v[84:87]
M v[84:87],a[252:255],a[168:171],v[84:87]
ds_read_b128 a[96:99],v248 offset:34816
M v[84:87],a[188:191],a[164:167],v[84:87]
buffer_store_dwordx4 v[96:99],v253,s[24:27],s34 offen offset:1152 nt
M v[88:91],a[188:191],a[168:171],v[88:91]
s_add_u32 s34,s33,393216
ds_read_b128 a[100:103],v249 offset:34816
ds_read_b128 a[120:123],v248 offset:35328
M v[88:91],a[252:255],a[172:175],v[88:91]
ds_read_b128 a[140:143],v249 offset:35328
M v[88:91],a[244:247],a[176:179],v[88:91]
buffer_load_dwordx4 a[196:199],v250,s[20:23],s48 offen offset:2048 sc1
M v[92:95],a[244:247],a[180:183],v[92:95]
s_waitcnt vmcnt(18)
s_add_u32 s48,s72,52224
v_permlane32_swap_b32 v196,v198
v_permlane32_swap_b32 v192,v194
M v[92:95],a[252:255],a[176:179],v[92:95]
s_waitcnt vmcnt(17)
v_permlane32_swap_b32 v200,v202
v_lshlrev_b32 v234,16,v198
M v[92:95],a[188:191],a[172:175],v[92:95]
s_waitcnt lgkmcnt(3)
v_lshlrev_b32 v232,16,v192
v_lshlrev_b32 v233,16,v196
M v[32:35],a[108:111],a[96:99],v[32:35]
s_waitcnt lgkmcnt(2)
buffer_load_dwordx4 a[116:119],v250,s[20:23],s48 offen offset:0 sc1
M v[32:35],a[132:135],a[100:103],v[32:35]
s_waitcnt lgkmcnt(1)
ds_read_b128 a[160:163],v248 offset:35840
ds_read_b128 a[164:167],v249 offset:35840
M v[32:35],a[148:151],a[120:123],v[32:35]
s_waitcnt lgkmcnt(2)
v_lshlrev_b32 v237,16,v194
v_lshlrev_b32 v236,16,v202
M v[36:39],a[148:151],a[140:143],v[36:39]
v_lshlrev_b32 v235,16,v200
v_fmac_f32 v232,s43,v234
M v[36:39],a[132:135],a[120:123],v[36:39]
buffer_load_dwordx4 a[136:139],v250,s[20:23],s48 offen offset:1024 sc1
M v[36:39],a[108:111],a[100:103],v[36:39]
v_fmac_f32 v237,4.0,v233
v_fma_f32 v238,-4.0,v234,v236
M v[40:43],a[108:111],a[120:123],v[40:43]
ds_read_b128 a[168:171],v248 offset:36352
v_fmac_f32 v232,s45,v236
M v[40:43],a[132:135],a[140:143],v[40:43]
s_waitcnt lgkmcnt(2)
ds_read_b128 a[172:175],v249 offset:36352
v_fmac_f32 v237,s41,v235
M v[40:43],a[148:151],a[160:163],v[40:43]
s_waitcnt lgkmcnt(2)
buffer_store_dwordx4 v[104:107],v253,s[24:27],s34 offen offset:1152 nt
M v[44:47],a[148:151],a[164:167],v[44:47]
s_add_u32 s34,s33,786432
v_sub_f32 v236,v236,v234
v_fma_f32 v234,-4.0,v233,v235
M v[44:47],a[132:135],a[160:163],v[44:47]
v_sub_f32 v235,v235,v233
v_add_f32 v233,v238,v234
M v[44:47],a[108:111],a[140:143],v[44:47]
buffer_load_dwordx4 a[156:159],v250,s[20:23],s48 offen offset:2048 sc1
M v[48:51],a[108:111],a[160:163],v[48:51]
s_add_u32 s48,s73,52224
ds_read_b128 a[176:179],v249 offset:36864
v_sub_f32 v238,v238,v234
M v[48:51],a[132:135],a[164:167],v[48:51]
s_waitcnt lgkmcnt(2)
ds_read_b128 a[180:183],v248 offset:36864
v_fma_f32 v234,2.0,v235,v236
M v[48:51],a[148:151],a[168:171],v[48:51]
s_waitcnt lgkmcnt(2)
v_fmac_f32 v236,-2.0,v235
v_and_b32 v198,s42,v198
M v[52:55],a[148:151],a[172:175],v[52:55]
v_and_b32 v192,s42,v192
v_and_b32 v196,s42,v196
M v[52:55],a[132:135],a[168:171],v[52:55]
v_and_b32 v194,s42,v194
v_and_b32 v202,s42,v202
M v[52:55],a[108:111],a[164:167],v[52:55]
buffer_store_dwordx4 v[112:115],v253,s[24:27],s34 offen offset:1152 nt
M v[56:59],a[108:111],a[168:171],v[56:59]
s_add_u32 s34,s33,1179648
buffer_load_dwordx4 a[188:191],v250,s[20:23],s48 offen offset:0 sc1
M v[56:59],a[132:135],a[172:175],v[56:59]
s_waitcnt lgkmcnt(1)
v_and_b32 v200,s42,v200
v_fmac_f32 v192,s43,v198
M v[56:59],a[148:151],a[176:179],v[56:59]
s_waitcnt lgkmcnt(0)
v_fmac_f32 v194,4.0,v196
v_fma_f32 v235,-4.0,v198,v202
M v[60:63],a[148:151],a[180:183],v[60:63]
v_fmac_f32 v192,s45,v202
v_fmac_f32 v194,s41,v200
M v[60:63],a[132:135],a[176:179],v[60:63]
buffer_load_dwordx4 a[236:239],v250,s[20:23],s48 offen offset:1024 sc1
M v[60:63],a[108:111],a[172:175],v[60:63]
v_sub_f32 v202,v202,v198
v_fma_f32 v198,-4.0,v196,v200
M v[64:67],a[184:187],a[96:99],v[64:67]
v_sub_f32 v200,v200,v196
v_add_f32 v196,v235,v198
M v[64:67],v[216:219],a[100:103],v[64:67]
v_sub_f32 v235,v235,v198
v_fma_f32 v198,2.0,v200,v202
M v[64:67],a[212:215],a[120:123],v[64:67]
buffer_store_dwordx4 v[120:123],v253,s[24:27],s34 offen offset:1152 nt
M v[68:71],a[212:215],a[140:143],v[68:71]
v_fmac_f32 v202,-2.0,v200
v_cvt_pk_bf16_f32 v192,v232,v192
M v[68:71],v[216:219],a[120:123],v[68:71]
v_cvt_pk_bf16_f32 v194,v237,v194
v_cvt_pk_bf16_f32 v196,v233,v196
M v[68:71],a[184:187],a[100:103],v[68:71]
buffer_load_dwordx4 a[232:235],v250,s[20:23],s48 offen offset:2048 sc1
M v[72:75],a[184:187],a[120:123],v[72:75]
v_cvt_pk_bf16_f32 v200,v234,v198
v_cvt_pk_bf16_f32 v198,v238,v235
M v[72:75],v[216:219],a[140:143],v[72:75]
v_cvt_pk_bf16_f32 v202,v236,v202
v_permlane32_swap_b32 v197,v199
M v[72:75],a[212:215],a[160:163],v[72:75]
s_add_u32 s34,s33,0
v_permlane32_swap_b32 v193,v195
v_permlane32_swap_b32 v201,v203
M v[76:79],a[212:215],a[164:167],v[76:79]
v_lshlrev_b32 v234,16,v199
v_lshlrev_b32 v232,16,v193
M v[76:79],v[216:219],a[160:163],v[76:79]
v_lshlrev_b32 v233,16,v197
v_lshlrev_b32 v237,16,v195
M v[76:79],a[184:187],a[140:143],v[76:79]
buffer_store_dwordx4 v[128:131],v253,s[24:27],s34 offen offset:1280 nt
M v[80:83],a[184:187],a[160:163],v[80:83]
s_add_u32 s48,s74,52224
v_lshlrev_b32 v236,16,v203
v_lshlrev_b32 v235,16,v201
M v[80:83],v[216:219],a[164:167],v[80:83]
v_fmac_f32 v232,s43,v234
v_fmac_f32 v237,4.0,v233
M v[80:83],a[212:215],a[168:171],v[80:83]
v_fma_f32 v238,-4.0,v234,v236
v_fmac_f32 v232,s45,v236
M v[84:87],a[212:215],a[172:175],v[84:87]
v_fmac_f32 v237,s41,v235
v_sub_f32 v236,v236,v234
M v[84:87],v[216:219],a[168:171],v[84:87]
ds_read_b128 a[96:99],v248 offset:52224
v_fma_f32 v234,-4.0,v233,v235
M v[84:87],a[184:187],a[164:167],v[84:87]
ds_read_b128 a[100:103],v249 offset:52224
v_sub_f32 v235,v235,v233
M v[88:91],a[184:187],a[168:171],v[88:91]
buffer_load_dwordx4 a[108:111],v250,s[20:23],s48 offen offset:0 sc1
M v[88:91],v[216:219],a[172:175],v[88:91]
ds_read_b128 a[120:123],v248 offset:52736
ds_read_b128 a[140:143],v249 offset:52736
M v[88:91],a[212:215],a[176:179],v[88:91]
buffer_load_dwordx4 a[132:135],v250,s[20:23],s48 offen offset:1024 sc1
M v[92:95],a[212:215],a[180:183],v[92:95]
v_add_f32 v233,v238,v234
v_sub_f32 v238,v238,v234
M v[92:95],v[216:219],a[176:179],v[92:95]
v_fma_f32 v234,2.0,v235,v236
v_fmac_f32 v236,-2.0,v235
M v[92:95],a[184:187],a[172:175],v[92:95]
s_waitcnt lgkmcnt(3)
v_and_b32 v199,s42,v199
v_and_b32 v193,s42,v193
M v[32:35],a[112:115],a[96:99],v[32:35]
s_waitcnt lgkmcnt(2)
buffer_load_dwordx4 a[148:151],v250,s[20:23],s48 offen offset:2048 sc1
M v[32:35],a[124:127],a[100:103],v[32:35]
s_waitcnt lgkmcnt(1)
ds_read_b128 a[160:163],v248 offset:53248
ds_read_b128 a[164:167],v249 offset:53248
M v[32:35],a[144:147],a[120:123],v[32:35]
s_waitcnt lgkmcnt(2)
s_add_u32 s34,s33,393216
v_and_b32 v197,s42,v197
v_and_b32 v195,s42,v195
M v[36:39],a[144:147],a[140:143],v[36:39]
v_and_b32 v203,s42,v203
v_and_b32 v201,s42,v201
M v[36:39],a[124:127],a[120:123],v[36:39]
v_fmac_f32 v193,s43,v199
v_fmac_f32 v195,4.0,v197
M v[36:39],a[112:115],a[100:103],v[36:39]
buffer_store_dwordx4 v[136:139],v253,s[24:27],s34 offen offset:1280 nt
M v[40:43],a[112:115],a[120:123],v[40:43]
ds_read_b128 a[168:171],v248 offset:53760
v_fma_f32 v235,-4.0,v199,v203
M v[40:43],a[124:127],a[140:143],v[40:43]
s_waitcnt lgkmcnt(2)
ds_read_b128 a[172:175],v249 offset:53760
v_fmac_f32 v193,s45,v203
M v[40:43],a[144:147],a[160:163],v[40:43]
s_waitcnt lgkmcnt(2)
v_fmac_f32 v195,s41,v201
v_sub_f32 v203,v203,v199
M v[44:47],a[144:147],a[164:167],v[44:47]
v_fma_f32 v199,-4.0,v197,v201
v_sub_f32 v201,v201,v197
M v[44:47],a[124:127],a[160:163],v[44:47]
v_add_f32 v197,v235,v199
v_sub_f32 v235,v235,v199
M v[44:47],a[112:115],a[140:143],v[44:47]
v_fma_f32 v199,2.0,v201,v203
v_fmac_f32 v203,-2.0,v201
M v[48:51],a[112:115],a[160:163],v[48:51]
s_add_u32 s48,s75,52224
ds_read_b128 a[176:179],v249 offset:54272
v_cvt_pk_bf16_f32 v193,v232,v193
M v[48:51],a[124:127],a[164:167],v[48:51]
s_waitcnt lgkmcnt(2)
ds_read_b128 a[180:183],v248 offset:54272
v_cvt_pk_bf16_f32 v195,v237,v195
M v[48:51],a[144:147],a[168:171],v[48:51]
s_waitcnt lgkmcnt(2)
v_cvt_pk_bf16_f32 v197,v233,v197
v_cvt_pk_bf16_f32 v201,v234,v199
M v[52:55],a[144:147],a[172:175],v[52:55]
v_cvt_pk_bf16_f32 v199,v238,v235
v_cvt_pk_bf16_f32 v203,v236,v203
M v[52:55],a[124:127],a[168:171],v[52:55]
s_waitcnt vmcnt(29)
v_permlane32_swap_b32 v208,v210
v_permlane32_swap_b32 v204,v206
M v[52:55],a[112:115],a[164:167],v[52:55]
ds_write2st64_b64 v247,v[192:193],v[194:195] offset0:104 offset1:121
M v[56:59],a[112:115],a[168:171],v[56:59]
s_add_u32 s28,s67,6291456
buffer_load_dwordx4 v[192:195],v251,s[88:91],s28 offen offset:0
M v[56:59],a[124:127],a[172:175],v[56:59]
s_waitcnt vmcnt(29) lgkmcnt(2)
v_permlane32_swap_b32 v212,v214
v_lshlrev_b32 v234,16,v210
M v[56:59],a[144:147],a[176:179],v[56:59]
s_waitcnt lgkmcnt(1)
s_add_u32 s34,s33,786432
ds_write2st64_b64 v247,v[196:197],v[198:199] offset0:36 offset1:53
M v[60:63],a[144:147],a[180:183],v[60:63]
buffer_load_dwordx4 v[196:199],v245,s[8:11],s28 offen offset:0
M v[60:63],a[124:127],a[176:179],v[60:63]
v_lshlrev_b32 v232,16,v204
v_lshlrev_b32 v233,16,v208
M v[60:63],a[112:115],a[172:175],v[60:63]
ds_write2st64_b64 v247,v[200:201],v[202:203] offset0:70 offset1:87
M v[64:67],a[208:211],a[96:99],v[64:67]
buffer_load_dwordx4 v[200:203],v245,s[8:11],s28 offen offset:768
M v[64:67],v[228:231],a[100:103],v[64:67]
v_lshlrev_b32 v237,16,v206
v_lshlrev_b32 v236,16,v214
M v[64:67],v[224:227],a[120:123],v[64:67]
v_lshlrev_b32 v235,16,v212
v_fmac_f32 v232,s43,v234
M v[68:71],v[224:227],a[140:143],v[68:71]
buffer_load_dwordx4 a[184:187],v250,s[20:23],s48 offen offset:0 sc1
M v[68:71],v[228:231],a[120:123],v[68:71]
v_fmac_f32 v237,4.0,v233
v_fma_f32 v238,-4.0,v234,v236
M v[68:71],a[208:211],a[100:103],v[68:71]
v_fmac_f32 v232,s45,v236
v_fmac_f32 v237,s41,v235
M v[72:75],a[208:211],a[120:123],v[72:75]
v_sub_f32 v236,v236,v234
v_fma_f32 v234,-4.0,v233,v235
M v[72:75],v[228:231],a[140:143],v[72:75]
buffer_load_dwordx4 v[220:223],v250,s[20:23],s48 offen offset:1024 sc1
M v[72:75],v[224:227],a[160:163],v[72:75]
v_sub_f32 v235,v235,v233
v_add_f32 v233,v238,v234
M v[76:79],v[224:227],a[164:167],v[76:79]
v_sub_f32 v238,v238,v234
v_fma_f32 v234,2.0,v235,v236
M v[76:79],v[228:231],a[160:163],v[76:79]
v_fmac_f32 v236,-2.0,v235
v_and_b32 v210,s42,v210
M v[76:79],a[208:211],a[140:143],v[76:79]
buffer_load_dwordx4 a[240:243],v250,s[20:23],s48 offen offset:2048 sc1
M v[80:83],a[208:211],a[160:163],v[80:83]
s_add_u32 s48,s76,52224
v_and_b32 v204,s42,v204
v_and_b32 v208,s42,v208
M v[80:83],v[228:231],a[164:167],v[80:83]
v_add_u32 v248,0xfffece00,v248
v_add_u32 v249,0xfffece00,v249
M v[80:83],v[224:227],a[168:171],v[80:83]
v_and_b32 v206,s42,v206
v_and_b32 v214,s42,v214
M v[84:87],v[224:227],a[172:175],v[84:87]
v_and_b32 v212,s42,v212
v_fmac_f32 v204,s43,v210
M v[84:87],v[228:231],a[168:171],v[84:87]
ds_read_b128 a[96:99],v248 offset:60928
v_fmac_f32 v206,4.0,v208
M v[84:87],a[208:211],a[164:167],v[84:87]
buffer_store_dwordx4 v[144:147],v253,s[24:27],s34 offen offset:1280 nt
M v[88:91],a[208:211],a[168:171],v[88:91]
s_add_u32 s34,s33,1179648
buffer_load_dwordx4 a[112:115],v250,s[20:23],s48 offen offset:0 sc1
M v[88:91],v[228:231],a[172:175],v[88:91]
ds_read_b128 a[100:103],v249 offset:60928
ds_read_b128 a[120:123],v248 offset:61440
M v[88:91],v[224:227],a[176:179],v[88:91]
ds_read_b128 a[140:143],v249 offset:61440
v_fma_f32 v235,-4.0,v210,v214
M v[92:95],v[224:227],a[180:183],v[92:95]
v_fmac_f32 v204,s45,v214
v_fmac_f32 v206,s41,v212
M v[92:95],v[228:231],a[176:179],v[92:95]
buffer_load_dwordx4 a[124:127],v250,s[20:23],s48 offen offset:1024 sc1
M v[92:95],a[208:211],a[172:175],v[92:95]
s_waitcnt vmcnt(36) lgkmcnt(3)
v_sub_f32 v214,v214,v210
v_fma_f32 v210,-4.0,v208,v212
M v[32:35],a[104:107],a[96:99],v[32:35]
s_waitcnt vmcnt(29) lgkmcnt(2)
ds_read_b128 a[160:163],v248 offset:61952
v_sub_f32 v212,v212,v208
M v[32:35],a[128:131],a[100:103],v[32:35]
s_waitcnt vmcnt(27) lgkmcnt(2)
ds_read_b128 a[164:167],v249 offset:61952
v_add_f32 v208,v235,v210
M v[32:35],a[152:155],a[120:123],v[32:35]
s_waitcnt lgkmcnt(2)
buffer_store_dwordx4 v[152:155],v253,s[24:27],s34 offen offset:1280 nt
M v[36:39],a[152:155],a[140:143],v[36:39]
v_sub_f32 v235,v235,v210
v_fma_f32 v210,2.0,v212,v214
M v[36:39],a[128:131],a[120:123],v[36:39]
v_fmac_f32 v214,-2.0,v212
v_cvt_pk_bf16_f32 v204,v232,v204
M v[36:39],a[104:107],a[100:103],v[36:39]
buffer_load_dwordx4 a[144:147],v250,s[20:23],s48 offen offset:2048 sc1
M v[40:43],a[104:107],a[120:123],v[40:43]
ds_read_b128 a[168:171],v248 offset:62464
v_cvt_pk_bf16_f32 v206,v237,v206
M v[40:43],a[128:131],a[140:143],v[40:43]
s_waitcnt lgkmcnt(2)
ds_read_b128 a[172:175],v249 offset:62464
v_cvt_pk_bf16_f32 v208,v233,v208
M v[40:43],a[152:155],a[160:163],v[40:43]
s_waitcnt lgkmcnt(2)
v_cvt_pk_bf16_f32 v212,v234,v210
v_cvt_pk_bf16_f32 v210,v238,v235
M v[44:47],a[152:155],a[164:167],v[44:47]
v_cvt_pk_bf16_f32 v214,v236,v214
v_permlane32_swap_b32 v209,v211
M v[44:47],a[128:131],a[160:163],v[44:47]
v_permlane32_swap_b32 v205,v207
v_permlane32_swap_b32 v213,v215
M v[44:47],a[104:107],a[140:143],v[44:47]
v_lshlrev_b32 v234,16,v211
v_lshlrev_b32 v232,16,v205
M v[48:51],a[104:107],a[160:163],v[48:51]
s_add_u32 s48,s77,52224
ds_read_b128 a[176:179],v249 offset:62976
v_lshlrev_b32 v233,16,v209
M v[48:51],a[128:131],a[164:167],v[48:51]
s_waitcnt lgkmcnt(2)
ds_read_b128 a[180:183],v248 offset:62976
v_lshlrev_b32 v237,16,v207
M v[48:51],a[152:155],a[168:171],v[48:51]
s_waitcnt lgkmcnt(2)
v_lshlrev_b32 v236,16,v215
v_lshlrev_b32 v235,16,v213
M v[52:55],a[152:155],a[172:175],v[52:55]
v_fmac_f32 v232,s43,v234
v_fmac_f32 v237,4.0,v233
M v[52:55],a[128:131],a[168:171],v[52:55]
v_fma_f32 v238,-4.0,v234,v236
v_fmac_f32 v232,s45,v236
M v[52:55],a[104:107],a[164:167],v[52:55]
v_fmac_f32 v237,s41,v235
v_sub_f32 v236,v236,v234
M v[56:59],a[104:107],a[168:171],v[56:59]
buffer_load_dwordx4 a[204:207],v250,s[20:23],s48 offen offset:0 sc1
M v[56:59],a[128:131],a[172:175],v[56:59]
s_waitcnt lgkmcnt(1)
v_fma_f32 v234,-4.0,v233,v235
v_sub_f32 v235,v235,v233
M v[56:59],a[152:155],a[176:179],v[56:59]
s_waitcnt lgkmcnt(0)
buffer_load_dwordx4 a[192:195],v250,s[20:23],s48 offen offset:1024 sc1
M v[60:63],a[152:155],a[180:183],v[60:63]
v_add_f32 v233,v238,v234
v_sub_f32 v238,v238,v234
M v[60:63],a[128:131],a[176:179],v[60:63]
v_fma_f32 v234,2.0,v235,v236
v_fmac_f32 v236,-2.0,v235
M v[60:63],a[104:107],a[172:175],v[60:63]
s_waitcnt vmcnt(30)
v_and_b32 v211,s42,v211
v_and_b32 v205,s42,v205
M v[64:67],a[228:231],a[96:99],v[64:67]
s_waitcnt vmcnt(29)
buffer_load_dwordx4 a[200:203],v250,s[20:23],s48 offen offset:2048 sc1
M v[64:67],a[224:227],a[100:103],v[64:67]
s_waitcnt vmcnt(28)
v_and_b32 v209,s42,v209
v_and_b32 v207,s42,v207
M v[64:67],a[196:199],a[120:123],v[64:67]
v_and_b32 v215,s42,v215
v_and_b32 v213,s42,v213
M v[68:71],a[196:199],a[140:143],v[68:71]
v_fmac_f32 v205,s43,v211
v_fmac_f32 v207,4.0,v209
M v[68:71],a[224:227],a[120:123],v[68:71]
v_fma_f32 v235,-4.0,v211,v215
v_fmac_f32 v205,s45,v215
M v[68:71],a[228:231],a[100:103],v[68:71]
v_fmac_f32 v207,s41,v213
v_sub_f32 v215,v215,v211
M v[72:75],a[228:231],a[120:123],v[72:75]
v_fma_f32 v211,-4.0,v209,v213
v_sub_f32 v213,v213,v209
M v[72:75],a[224:227],a[140:143],v[72:75]
v_add_f32 v209,v235,v211
v_sub_f32 v235,v235,v211
M v[72:75],a[196:199],a[160:163],v[72:75]
v_fma_f32 v211,2.0,v213,v215
v_fmac_f32 v215,-2.0,v213
M v[76:79],a[196:199],a[164:167],v[76:79]
v_cvt_pk_bf16_f32 v205,v232,v205
v_cvt_pk_bf16_f32 v207,v237,v207
M v[76:79],a[224:227],a[160:163],v[76:79]
v_cvt_pk_bf16_f32 v209,v233,v209
v_cvt_pk_bf16_f32 v213,v234,v211
M v[76:79],a[228:231],a[140:143],v[76:79]
v_cvt_pk_bf16_f32 v211,v238,v235
v_cvt_pk_bf16_f32 v215,v236,v215
M v[80:83],a[228:231],a[160:163],v[80:83]
s_add_u32 s46,s72,9216
M v[80:83],a[224:227],a[164:167],v[80:83]
s_barrier
v_cvt_pk_bf16_f32 v32,v32,v33
M v[80:83],a[196:199],a[168:171],v[80:83]
ds_write2st64_b64 v247,v[204:205],v[206:207] offset0:105 offset1:122
M v[84:87],a[196:199],a[172:175],v[84:87]
s_add_u32 s28,s67,6684672
buffer_load_dwordx4 v[204:207],v251,s[88:91],s28 offen offset:0
M v[84:87],a[224:227],a[168:171],v[84:87]
ds_read_b128 a[96:99],v248 offset:0
v_cvt_pk_bf16_f32 v33,v34,v35
M v[84:87],a[228:231],a[164:167],v[84:87]
ds_write2st64_b64 v247,v[208:209],v[210:211] offset0:37 offset1:54
M v[88:91],a[228:231],a[168:171],v[88:91]
buffer_load_dwordx4 v[208:211],v245,s[8:11],s28 offen offset:0
M v[88:91],a[224:227],a[172:175],v[88:91]
ds_read_b128 a[100:103],v249 offset:0
ds_read_b128 a[120:123],v248 offset:512
M v[88:91],a[196:199],a[176:179],v[88:91]
ds_write2st64_b64 v247,v[212:213],v[214:215] offset0:71 offset1:88
M v[92:95],a[196:199],a[180:183],v[92:95]
buffer_load_dwordx4 v[212:215],v245,s[8:11],s28 offen offset:768
M v[92:95],a[224:227],a[176:179],v[92:95]
ds_read_b128 a[140:143],v249 offset:512
v_cvt_pk_bf16_f32 v36,v36,v37
M v[92:95],a[228:231],a[172:175],v[92:95]
s_waitcnt vmcnt(30) lgkmcnt(5)
v_cvt_pk_bf16_f32 v37,v38,v39
M v[160:163],a[116:119],a[96:99],v[160:163]
s_waitcnt vmcnt(29) lgkmcnt(3)
buffer_load_dwordx4 a[104:107],v250,s[20:23],s46 offen offset:0 sc1
M v[160:163],a[136:139],a[100:103],v[160:163]
s_waitcnt vmcnt(28) lgkmcnt(2)
ds_read_b128 a[96:99],v248 offset:1024
ds_read_b128 a[160:163],v249 offset:1024
M v[160:163],a[156:159],a[120:123],v[160:163]
s_waitcnt lgkmcnt(2)
ds_write2st64_b64 v254,v[32:33],v[36:37] offset0:0 offset1:4
M v[164:167],a[156:159],a[140:143],v[164:167]
buffer_load_dwordx4 a[128:131],v250,s[20:23],s46 offen offset:1024 sc1
M v[164:167],a[136:139],a[120:123],v[164:167]
v_cvt_pk_bf16_f32 v40,v40,v41
v_cvt_pk_bf16_f32 v41,v42,v43
M v[164:167],a[116:119],a[100:103],v[164:167]
v_cvt_pk_bf16_f32 v44,v44,v45
v_cvt_pk_bf16_f32 v45,v46,v47
M v[168:171],a[116:119],a[120:123],v[168:171]
ds_read_b128 a[100:103],v248 offset:1536
ds_write2st64_b64 v254,v[40:41],v[44:45] offset0:8 offset1:12
M v[168:171],a[136:139],a[140:143],v[168:171]
s_waitcnt lgkmcnt(4)
buffer_load_dwordx4 a[152:155],v250,s[20:23],s46 offen offset:2048 sc1
M v[168:171],a[156:159],a[96:99],v[168:171]
s_waitcnt lgkmcnt(3)
ds_read_b128 a[120:123],v249 offset:1536
v_cvt_pk_bf16_f32 v48,v48,v49
M v[172:175],a[156:159],a[160:163],v[172:175]
v_cvt_pk_bf16_f32 v49,v50,v51
v_cvt_pk_bf16_f32 v52,v52,v53
M v[172:175],a[136:139],a[96:99],v[172:175]
v_cvt_pk_bf16_f32 v53,v54,v55
M v[172:175],a[116:119],a[140:143],v[172:175]
ds_write2st64_b64 v254,v[48:49],v[52:53] offset0:136 offset1:140
M v[176:179],a[116:119],a[96:99],v[176:179]
s_add_u32 s47,s72,12288
ds_read_b128 a[96:99],v249 offset:2048
v_cvt_pk_bf16_f32 v56,v56,v57
M v[176:179],a[136:139],a[160:163],v[176:179]
s_waitcnt lgkmcnt(4)
ds_read_b128 a[140:143],v248 offset:2048
v_add_u32 v248,0x15400,v248
M v[176:179],a[156:159],a[100:103],v[176:179]
s_waitcnt lgkmcnt(3)
v_add_u32 v249,0x15400,v249
v_cvt_pk_bf16_f32 v57,v58,v59
M v[180:183],a[156:159],a[120:123],v[180:183]
v_cvt_pk_bf16_f32 v60,v60,v61
v_cvt_pk_bf16_f32 v61,v62,v63
M v[180:183],a[136:139],a[100:103],v[180:183]
ds_read_b128 a[164:167],v248 offset:0
ds_write2st64_b64 v254,v[56:57],v[60:61] offset0:144 offset1:148
M v[180:183],a[116:119],a[160:163],v[180:183]
ds_read_b128 a[160:163],v249 offset:0
v_cvt_pk_bf16_f32 v64,v64,v65
M v[184:187],a[116:119],a[100:103],v[184:187]
buffer_load_dwordx4 a[100:103],v250,s[20:23],s47 offen offset:0 sc1
M v[184:187],a[136:139],a[120:123],v[184:187]
s_waitcnt lgkmcnt(4)
ds_read_b128 a[168:171],v248 offset:512
ds_read_b128 a[176:179],v249 offset:512
M v[184:187],a[156:159],a[96:99],v[184:187]
s_waitcnt lgkmcnt(5)
buffer_load_dwordx4 a[172:175],v250,s[20:23],s47 offen offset:1024 sc1
M v[188:191],a[156:159],a[140:143],v[188:191]
v_cvt_pk_bf16_f32 v65,v66,v67
v_cvt_pk_bf16_f32 v68,v68,v69
M v[188:191],a[136:139],a[96:99],v[188:191]
v_cvt_pk_bf16_f32 v69,v70,v71
M v[188:191],a[116:119],a[120:123],v[188:191]
s_waitcnt vmcnt(30) lgkmcnt(4)
ds_write2st64_b64 v254,v[64:65],v[68:69] offset0:170 offset1:174
M v[160:163],a[188:191],a[164:167],v[160:163]
s_waitcnt vmcnt(29) lgkmcnt(3)
buffer_load_dwordx4 a[180:183],v250,s[20:23],s47 offen offset:2048 sc1
M v[160:163],a[236:239],a[160:163],v[160:163]
s_waitcnt vmcnt(28) lgkmcnt(2)
ds_read_b128 a[96:99],v248 offset:1024
ds_read_b128 a[116:119],v249 offset:1024
M v[160:163],a[232:235],a[168:171],v[160:163]
s_waitcnt lgkmcnt(3)
v_cvt_pk_bf16_f32 v72,v72,v73
v_cvt_pk_bf16_f32 v73,v74,v75
M v[164:167],a[232:235],a[176:179],v[164:167]
v_cvt_pk_bf16_f32 v76,v76,v77
v_cvt_pk_bf16_f32 v77,v78,v79
M v[164:167],a[236:239],a[168:171],v[164:167]
ds_write2st64_b64 v254,v[72:73],v[76:77] offset0:178 offset1:182
M v[164:167],a[188:191],a[160:163],v[164:167]
v_cvt_pk_bf16_f32 v80,v80,v81
v_cvt_pk_bf16_f32 v81,v82,v83
M v[168:171],a[188:191],a[168:171],v[168:171]
ds_read_b128 a[120:123],v248 offset:1536
v_cvt_pk_bf16_f32 v84,v84,v85
M v[168:171],a[236:239],a[176:179],v[168:171]
s_waitcnt lgkmcnt(3)
ds_read_b128 a[136:139],v249 offset:1536
v_cvt_pk_bf16_f32 v85,v86,v87
M v[168:171],a[232:235],a[96:99],v[168:171]
s_waitcnt lgkmcnt(3)
ds_write2st64_b64 v254,v[80:81],v[84:85] offset0:204 offset1:208
M v[172:175],a[232:235],a[116:119],v[172:175]
v_cvt_pk_bf16_f32 v88,v88,v89
v_cvt_pk_bf16_f32 v89,v90,v91
M v[172:175],a[236:239],a[96:99],v[172:175]
v_cvt_pk_bf16_f32 v92,v92,v93
v_cvt_pk_bf16_f32 v93,v94,v95
M v[172:175],a[188:191],a[176:179],v[172:175]
ds_write2st64_b64 v254,v[88:89],v[92:93] offset0:212 offset1:216
M v[176:179],a[188:191],a[96:99],v[176:179]
s_add_u32 s48,s72,15360
ds_read_b128 a[96:99],v249 offset:2048
M v[176:179],a[236:239],a[116:119],v[176:179]
s_waitcnt lgkmcnt(4)
ds_read_b128 a[140:143],v248 offset:2048
M v[176:179],a[232:235],a[120:123],v[176:179]
s_waitcnt lgkmcnt(2)
s_barrier
ds_read_b128 v[32:35],v250 offset:0
M v[180:183],a[232:235],a[136:139],v[180:183]
ds_read_b128 v[40:43],v250 offset:4096
ds_read_b128 v[48:51],v4 offset:0
M v[180:183],a[236:239],a[120:123],v[180:183]
ds_read_b128 v[56:59],v4 offset:4096
ds_read_b128 v[64:67],v4 offset:17408
M v[180:183],a[188:191],a[116:119],v[180:183]
ds_read_b128 v[72:75],v4 offset:21504
ds_read_b128 v[80:83],v4 offset:34816
M v[184:187],a[188:191],a[120:123],v[184:187]
ds_read_b128 v[88:91],v4 offset:38912
ds_read_b128 a[156:159],v248 offset:17408
M v[184:187],a[236:239],a[136:139],v[184:187]
s_waitcnt lgkmcnt(10)
s_add_u32 s34,s33,0
buffer_load_dwordx4 a[120:123],v250,s[20:23],s48 offen offset:0 sc1
M v[184:187],a[232:235],a[96:99],v[184:187]
s_waitcnt lgkmcnt(9)
ds_read_b128 a[116:119],v249 offset:17408
ds_read_b128 a[160:163],v248 offset:17920
M v[188:191],a[232:235],a[140:143],v[188:191]
buffer_load_dwordx4 a[164:167],v250,s[20:23],s48 offen offset:1024 sc1
M v[188:191],a[236:239],a[96:99],v[188:191]
ds_read_b128 a[168:171],v249 offset:17920
M v[188:191],a[188:191],a[136:139],v[188:191]
s_waitcnt vmcnt(28) lgkmcnt(3)
M v[160:163],a[108:111],a[156:159],v[160:163]
s_waitcnt vmcnt(27) lgkmcnt(2)
ds_read_b128 a[96:99],v248 offset:18432
M v[160:163],a[132:135],a[116:119],v[160:163]
s_waitcnt vmcnt(26) lgkmcnt(2)
buffer_load_dwordx4 a[176:179],v250,s[20:23],s48 offen offset:2048 sc1
M v[160:163],a[148:151],a[160:163],v[160:163]
s_waitcnt lgkmcnt(1)
ds_read_b128 a[136:139],v249 offset:18432
M v[164:167],a[148:151],a[168:171],v[164:167]
M v[164:167],a[132:135],a[160:163],v[164:167]
M v[164:167],a[108:111],a[116:119],v[164:167]
buffer_store_dwordx4 v[32:35],v253,s[24:27],s34 offen offset:128 nt
M v[168:171],a[108:111],a[160:163],v[168:171]
s_add_u32 s34,s33,393216
ds_read_b128 a[116:119],v248 offset:18944
M v[168:171],a[132:135],a[168:171],v[168:171]
s_waitcnt lgkmcnt(2)
ds_read_b128 a[140:143],v249 offset:18944
M v[168:171],a[148:151],a[96:99],v[168:171]
s_waitcnt lgkmcnt(2)
buffer_store_dwordx4 v[40:43],v253,s[24:27],s34 offen offset:128 nt
M v[172:175],a[148:151],a[136:139],v[172:175]
s_add_u32 s34,s33,786432
M v[172:175],a[132:135],a[96:99],v[172:175]
M v[172:175],a[108:111],a[168:171],v[172:175]
buffer_store_dwordx4 v[48:51],v253,s[24:27],s34 offen offset:128 nt
M v[176:179],a[108:111],a[96:99],v[176:179]
s_add_u32 s34,s33,1179648
ds_read_b128 a[96:99],v249 offset:19456
s_add_u32 s46,s72,18432
M v[176:179],a[132:135],a[136:139],v[176:179]
s_waitcnt lgkmcnt(2)
ds_read_b128 a[156:159],v248 offset:19456
M v[176:179],a[148:151],a[116:119],v[176:179]
s_waitcnt lgkmcnt(2)
buffer_store_dwordx4 v[56:59],v253,s[24:27],s34 offen offset:128 nt
M v[180:183],a[148:151],a[140:143],v[180:183]
s_add_u32 s34,s33,0
M v[180:183],a[132:135],a[116:119],v[180:183]
ds_read_b128 a[160:163],v248 offset:34816
M v[180:183],a[108:111],a[136:139],v[180:183]
buffer_store_dwordx4 v[64:67],v253,s[24:27],s34 offen offset:256 nt
M v[184:187],a[108:111],a[116:119],v[184:187]
s_add_u32 s34,s33,393216
ds_read_b128 a[136:139],v249 offset:34816
ds_read_b128 a[116:119],v248 offset:35328
M v[184:187],a[132:135],a[140:143],v[184:187]
s_waitcnt lgkmcnt(4)
ds_read_b128 a[216:219],v249 offset:35328
M v[184:187],a[148:151],a[96:99],v[184:187]
s_waitcnt lgkmcnt(4)
buffer_store_dwordx4 v[72:75],v253,s[24:27],s34 offen offset:256 nt
M v[188:191],a[148:151],a[156:159],v[188:191]
s_add_u32 s34,s33,786432
M v[188:191],a[132:135],a[96:99],v[188:191]
M v[188:191],a[108:111],a[140:143],v[188:191]
s_waitcnt vmcnt(28) lgkmcnt(3)
buffer_load_dwordx4 a[168:171],v250,s[20:23],s46 offen offset:0 sc1
M v[160:163],a[184:187],a[160:163],v[160:163]
s_waitcnt vmcnt(28) lgkmcnt(2)
ds_read_b128 a[96:99],v248 offset:35840
M v[160:163],v[220:223],a[136:139],v[160:163]
s_waitcnt vmcnt(27) lgkmcnt(2)
ds_read_b128 a[108:111],v249 offset:35840
M v[160:163],a[240:243],a[116:119],v[160:163]
s_waitcnt lgkmcnt(2)
M v[164:167],a[240:243],a[216:219],v[164:167]
buffer_load_dwordx4 a[188:191],v250,s[20:23],s46 offen offset:1024 sc1
M v[164:167],v[220:223],a[116:119],v[164:167]
M v[164:167],a[184:187],a[136:139],v[164:167]
M v[168:171],a[184:187],a[116:119],v[168:171]
ds_read_b128 a[116:119],v248 offset:36352
M v[168:171],v[220:223],a[216:219],v[168:171]
s_waitcnt lgkmcnt(2)
buffer_load_dwordx4 a[220:223],v250,s[20:23],s46 offen offset:2048 sc1
M v[168:171],a[240:243],a[96:99],v[168:171]
s_waitcnt lgkmcnt(1)
ds_read_b128 a[132:135],v249 offset:36352
M v[172:175],a[240:243],a[108:111],v[172:175]
M v[172:175],v[220:223],a[96:99],v[172:175]
M v[172:175],a[184:187],a[216:219],v[172:175]
buffer_store_dwordx4 v[80:83],v253,s[24:27],s34 offen offset:256 nt
M v[176:179],a[184:187],a[96:99],v[176:179]
s_add_u32 s47,s72,21504
ds_read_b128 a[96:99],v249 offset:36864
M v[176:179],v[220:223],a[108:111],v[176:179]
s_waitcnt lgkmcnt(2)
ds_read_b128 a[136:139],v248 offset:36864
M v[176:179],a[240:243],a[116:119],v[176:179]
s_waitcnt lgkmcnt(2)
s_add_u32 s34,s33,1179648
buffer_store_dwordx4 v[88:91],v253,s[24:27],s34 offen offset:256 nt
M v[180:183],a[240:243],a[132:135],v[180:183]
M v[180:183],v[220:223],a[116:119],v[180:183]
ds_read_b128 a[140:143],v248 offset:52224
M v[180:183],a[184:187],a[108:111],v[180:183]
ds_read_b128 a[108:111],v249 offset:52224
M v[184:187],a[184:187],a[116:119],v[184:187]
buffer_load_dwordx4 a[248:251],v250,s[20:23],s47 offen offset:0 sc1
M v[184:187],v[220:223],a[132:135],v[184:187]
s_waitcnt lgkmcnt(3)
ds_read_b128 a[116:119],v248 offset:52736
ds_read_b128 a[148:151],v249 offset:52736
M v[184:187],a[240:243],a[96:99],v[184:187]
s_waitcnt lgkmcnt(4)
M v[188:191],a[240:243],a[136:139],v[188:191]
buffer_load_dwordx4 a[160:163],v250,s[20:23],s47 offen offset:1024 sc1
M v[188:191],v[220:223],a[96:99],v[188:191]
M v[188:191],a[184:187],a[132:135],v[188:191]
s_waitcnt vmcnt(31) lgkmcnt(3)
M v[160:163],a[112:115],a[140:143],v[160:163]
s_waitcnt vmcnt(30) lgkmcnt(2)
ds_read_b128 a[96:99],v248 offset:53248
M v[160:163],a[124:127],a[108:111],v[160:163]
s_waitcnt vmcnt(28) lgkmcnt(2)
buffer_load_dwordx4 a[244:247],v250,s[20:23],s47 offen offset:2048 sc1
M v[160:163],a[144:147],a[116:119],v[160:163]
s_waitcnt lgkmcnt(1)
ds_read_b128 a[132:135],v249 offset:53248
M v[164:167],a[144:147],a[148:151],v[164:167]
M v[164:167],a[124:127],a[116:119],v[164:167]
M v[164:167],a[112:115],a[108:111],v[164:167]
M v[168:171],a[112:115],a[116:119],v[168:171]
ds_read_b128 a[108:111],v248 offset:53760
M v[168:171],a[124:127],a[148:151],v[168:171]
s_waitcnt lgkmcnt(2)
ds_read_b128 a[116:119],v249 offset:53760
M v[168:171],a[144:147],a[96:99],v[168:171]
s_waitcnt lgkmcnt(2)
M v[172:175],a[144:147],a[132:135],v[172:175]
M v[172:175],a[124:127],a[96:99],v[172:175]
M v[172:175],a[112:115],a[148:151],v[172:175]
M v[176:179],a[112:115],a[96:99],v[176:179]
s_add_u32 s48,s72,24576
ds_read_b128 a[96:99],v249 offset:54272
M v[176:179],a[124:127],a[132:135],v[176:179]
s_waitcnt lgkmcnt(2)
ds_read_b128 a[136:139],v248 offset:54272
v_add_u32 v248,0xfffece00,v248
M v[176:179],a[144:147],a[108:111],v[176:179]
s_waitcnt lgkmcnt(2)
v_add_u32 v249,0xfffece00,v249
M v[180:183],a[144:147],a[116:119],v[180:183]
M v[180:183],a[124:127],a[108:111],v[180:183]
ds_read_b128 a[140:143],v248 offset:60928
M v[180:183],a[112:115],a[132:135],v[180:183]
ds_read_b128 a[132:135],v249 offset:60928
M v[184:187],a[112:115],a[108:111],v[184:187]
buffer_load_dwordx4 a[252:255],v250,s[20:23],s48 offen offset:0 sc1
M v[184:187],a[124:127],a[116:119],v[184:187]
s_waitcnt lgkmcnt(3)
ds_read_b128 a[108:111],v248 offset:61440
ds_read_b128 a[148:151],v249 offset:61440
M v[184:187],a[144:147],a[96:99],v[184:187]
s_waitcnt lgkmcnt(4)
buffer_load_dwordx4 a[212:215],v250,s[20:23],s48 offen offset:1024 sc1
M v[188:191],a[144:147],a[136:139],v[188:191]
M v[188:191],a[124:127],a[96:99],v[188:191]
M v[188:191],a[112:115],a[116:119],v[188:191]
s_waitcnt vmcnt(30) lgkmcnt(3)
M v[160:163],a[204:207],a[140:143],v[160:163]
s_waitcnt vmcnt(29) lgkmcnt(2)
buffer_load_dwordx4 v[216:219],v250,s[20:23],s48 offen offset:2048 sc1
M v[160:163],a[192:195],a[132:135],v[160:163]
s_waitcnt vmcnt(29) lgkmcnt(1)
ds_read_b128 a[96:99],v248 offset:61952
ds_read_b128 a[112:115],v249 offset:61952
M v[160:163],a[200:203],a[108:111],v[160:163]
s_waitcnt lgkmcnt(2)
M v[164:167],a[200:203],a[148:151],v[164:167]
M v[164:167],a[192:195],a[108:111],v[164:167]
M v[164:167],a[204:207],a[132:135],v[164:167]
s_nop 3
v_cvt_pk_bf16_f32 v160,v160,v161
v_cvt_pk_bf16_f32 v161,v162,v163
M v[168:171],a[204:207],a[108:111],v[168:171]
ds_read_b128 a[108:111],v248 offset:62464
M v[168:171],a[192:195],a[148:151],v[168:171]
s_waitcnt lgkmcnt(2)
ds_read_b128 a[116:119],v249 offset:62464
M v[168:171],a[200:203],a[96:99],v[168:171]
s_waitcnt lgkmcnt(2)
v_cvt_pk_bf16_f32 v164,v164,v165
v_cvt_pk_bf16_f32 v165,v166,v167
M v[172:175],a[200:203],a[112:115],v[172:175]
M v[172:175],a[192:195],a[96:99],v[172:175]
ds_read_b128 a[124:127],v249 offset:62976
ds_read_b128 a[132:135],v248 offset:62976
M v[172:175],a[204:207],a[148:151],v[172:175]
M v[176:179],a[204:207],a[96:99],v[176:179]
s_add_u32 s46,s72,27648
M v[176:179],a[192:195],a[112:115],v[176:179]
s_waitcnt lgkmcnt(3)
M v[176:179],a[200:203],a[108:111],v[176:179]
s_waitcnt lgkmcnt(0)
s_barrier
ds_write2st64_b64 v254,v[160:161],v[164:165] offset0:221 offset1:225
M v[180:183],a[200:203],a[116:119],v[180:183]
v_cvt_pk_bf16_f32 v168,v168,v169
v_cvt_pk_bf16_f32 v169,v170,v171
M v[180:183],a[192:195],a[108:111],v[180:183]
ds_read_b128 a[96:99],v248 offset:0
v_cvt_pk_bf16_f32 v172,v172,v173
M v[180:183],a[204:207],a[112:115],v[180:183]
ds_read_b128 a[112:115],v249 offset:0
v_cvt_pk_bf16_f32 v173,v174,v175
M v[184:187],a[204:207],a[108:111],v[184:187]
buffer_load_dwordx4 v[224:227],v250,s[20:23],s46 offen offset:0 sc1
M v[184:187],a[192:195],a[116:119],v[184:187]
ds_read_b128 a[108:111],v248 offset:512
ds_read_b128 a[136:139],v249 offset:512
M v[184:187],a[200:203],a[124:127],v[184:187]
ds_write2st64_b64 v254,v[168:169],v[172:173] offset0:229 offset1:233
M v[188:191],a[200:203],a[132:135],v[188:191]
v_cvt_pk_bf16_f32 v176,v176,v177
v_cvt_pk_bf16_f32 v177,v178,v179
M v[188:191],a[192:195],a[124:127],v[188:191]
v_cvt_pk_bf16_f32 v180,v180,v181
v_cvt_pk_bf16_f32 v181,v182,v183
M v[188:191],a[204:207],a[116:119],v[188:191]
s_waitcnt vmcnt(26) lgkmcnt(4)
ds_write2st64_b64 v254,v[176:177],v[180:181] offset0:238 offset1:242
M a[0:3],a[104:107],a[96:99],0
s_waitcnt vmcnt(25) lgkmcnt(4)
ds_read_b128 a[116:119],v248 offset:1024
v_cvt_pk_bf16_f32 v184,v184,v185
M a[0:3],a[128:131],a[112:115],a[0:3]
s_waitcnt vmcnt(24) lgkmcnt(4)
ds_read_b128 a[124:127],v249 offset:1024
v_cvt_pk_bf16_f32 v185,v186,v187
M a[0:3],a[152:155],a[108:111],a[0:3]
s_waitcnt lgkmcnt(4)
v_cvt_pk_bf16_f32 v188,v188,v189
v_cvt_pk_bf16_f32 v189,v190,v191
M a[4:7],a[152:155],a[136:139],0
ds_write2st64_b64 v254,v[184:185],v[188:189] offset0:246 offset1:250
M a[4:7],a[128:131],a[108:111],a[4:7]
v_permlane32_swap_b32 v196,v198
v_permlane32_swap_b32 v192,v194
M a[4:7],a[104:107],a[112:115],a[4:7]
v_permlane32_swap_b32 v200,v202
v_lshlrev_b32 v234,16,v198
M a[8:11],a[104:107],a[108:111],0
ds_read_b128 a[132:135],v248 offset:1536
v_lshlrev_b32 v232,16,v192
M a[8:11],a[128:131],a[136:139],a[8:11]
s_waitcnt lgkmcnt(3)
ds_read_b128 a[140:143],v249 offset:1536
v_lshlrev_b32 v233,16,v196
M a[8:11],a[152:155],a[116:119],a[8:11]
s_waitcnt lgkmcnt(3)
v_lshlrev_b32 v237,16,v194
v_lshlrev_b32 v236,16,v202
M a[12:15],a[152:155],a[124:127],0
v_lshlrev_b32 v235,16,v200
v_fmac_f32 v232,s43,v234
M a[12:15],a[128:131],a[116:119],a[12:15]
s_waitcnt lgkmcnt(2)
s_barrier
ds_read_b128 v[160:163],v4 offset:43520
M a[12:15],a[104:107],a[136:139],a[12:15]
ds_read_b128 v[168:171],v4 offset:47616
ds_read_b128 v[176:179],v4 offset:52224
M a[16:19],a[104:107],a[116:119],0
ds_read_b128 v[184:187],v4 offset:56320
ds_read_b128 a[144:147],v249 offset:2048
M a[16:19],a[128:131],a[124:127],a[16:19]
s_waitcnt lgkmcnt(6)
ds_read_b128 a[148:151],v248 offset:2048
v_fmac_f32 v237,4.0,v233
M a[16:19],a[152:155],a[132:135],a[16:19]
s_waitcnt lgkmcnt(6)
v_fma_f32 v238,-4.0,v234,v236
v_fmac_f32 v232,s45,v236
M a[20:23],a[152:155],a[140:143],0
s_add_u32 s34,s33,0
v_fmac_f32 v237,s41,v235
v_sub_f32 v236,v236,v234
M a[20:23],a[128:131],a[132:135],a[20:23]
v_fma_f32 v234,-4.0,v233,v235
v_sub_f32 v235,v235,v233
M a[20:23],a[104:107],a[124:127],a[20:23]
s_waitcnt lgkmcnt(5)
buffer_store_dwordx4 v[160:163],v253,s[24:27],s34 offen offset:1408 nt
M a[24:27],a[104:107],a[132:135],0
s_add_u32 s34,s33,393216
v_add_f32 v233,v238,v234
v_sub_f32 v238,v238,v234
M a[24:27],a[128:131],a[140:143],a[24:27]
s_waitcnt lgkmcnt(1)
v_fma_f32 v234,2.0,v235,v236
v_fmac_f32 v236,-2.0,v235
M a[24:27],a[152:155],a[144:147],a[24:27]
s_waitcnt lgkmcnt(0)
buffer_store_dwordx4 v[168:171],v253,s[24:27],s34 offen offset:1408 nt
M a[28:31],a[152:155],a[148:151],0
s_add_u32 s34,s33,786432
v_and_b32 v198,s42,v198
v_and_b32 v192,s42,v192
M a[28:31],a[128:131],a[144:147],a[28:31]
v_and_b32 v196,s42,v196
v_and_b32 v194,s42,v194
M a[28:31],a[104:107],a[140:143],a[28:31]
s_waitcnt vmcnt(25)
buffer_store_dwordx4 v[176:179],v253,s[24:27],s34 offen offset:1408 nt
M a[32:35],a[100:103],a[96:99],0
s_waitcnt vmcnt(25)
s_add_u32 s34,s33,1179648
v_and_b32 v202,s42,v202
v_and_b32 v200,s42,v200
M a[32:35],a[172:175],a[112:115],a[32:35]
s_waitcnt vmcnt(24)
v_fmac_f32 v192,s43,v198
v_fmac_f32 v194,4.0,v196
M a[32:35],a[180:183],a[108:111],a[32:35]
buffer_store_dwordx4 v[184:187],v253,s[24:27],s34 offen offset:1408 nt
M a[36:39],a[180:183],a[136:139],0
v_fma_f32 v235,-4.0,v198,v202
v_fmac_f32 v192,s45,v202
M a[36:39],a[172:175],a[108:111],a[36:39]
v_fmac_f32 v194,s41,v200
v_sub_f32 v202,v202,v198
M a[36:39],a[100:103],a[112:115],a[36:39]
v_fma_f32 v198,-4.0,v196,v200
v_sub_f32 v200,v200,v196
M a[40:43],a[100:103],a[108:111],0
v_add_f32 v196,v235,v198
v_sub_f32 v235,v235,v198
M a[40:43],a[172:175],a[136:139],a[40:43]
v_fma_f32 v198,2.0,v200,v202
v_fmac_f32 v202,-2.0,v200
M a[40:43],a[180:183],a[116:119],a[40:43]
v_cvt_pk_bf16_f32 v192,v232,v192
v_cvt_pk_bf16_f32 v194,v237,v194
M a[44:47],a[180:183],a[124:127],0
v_cvt_pk_bf16_f32 v196,v233,v196
v_cvt_pk_bf16_f32 v200,v234,v198
M a[44:47],a[172:175],a[116:119],a[44:47]
v_cvt_pk_bf16_f32 v198,v238,v235
v_cvt_pk_bf16_f32 v202,v236,v202
M a[44:47],a[100:103],a[136:139],a[44:47]
v_permlane32_swap_b32 v197,v199
v_permlane32_swap_b32 v193,v195
M a[48:51],a[100:103],a[116:119],0
v_permlane32_swap_b32 v201,v203
v_lshlrev_b32 v234,16,v199
M a[48:51],a[172:175],a[124:127],a[48:51]
v_lshlrev_b32 v232,16,v193
v_lshlrev_b32 v233,16,v197
M a[48:51],a[180:183],a[132:135],a[48:51]
v_lshlrev_b32 v237,16,v195
v_lshlrev_b32 v236,16,v203
M a[52:55],a[180:183],a[140:143],0
v_lshlrev_b32 v235,16,v201
v_fmac_f32 v232,s43,v234
M a[52:55],a[172:175],a[132:135],a[52:55]
v_fmac_f32 v237,4.0,v233
v_fma_f32 v238,-4.0,v234,v236
M a[52:55],a[100:103],a[124:127],a[52:55]
v_fmac_f32 v232,s45,v236
v_fmac_f32 v237,s41,v235
M a[56:59],a[100:103],a[132:135],0
v_sub_f32 v236,v236,v234
v_fma_f32 v234,-4.0,v233,v235
M a[56:59],a[172:175],a[140:143],a[56:59]
v_sub_f32 v235,v235,v233
v_add_f32 v233,v238,v234
M a[56:59],a[180:183],a[144:147],a[56:59]
v_sub_f32 v238,v238,v234
v_fma_f32 v234,2.0,v235,v236
M a[60:63],a[180:183],a[148:151],0
v_fmac_f32 v236,-2.0,v235
v_and_b32 v199,s42,v199
M a[60:63],a[172:175],a[144:147],a[60:63]
v_and_b32 v193,s42,v193
v_and_b32 v197,s42,v197
M a[60:63],a[100:103],a[140:143],a[60:63]
s_waitcnt vmcnt(24)
v_and_b32 v195,s42,v195
v_and_b32 v203,s42,v203
M a[64:67],a[120:123],a[96:99],0
s_waitcnt vmcnt(23)
v_and_b32 v201,s42,v201
v_fmac_f32 v193,s43,v199
M a[64:67],a[164:167],a[112:115],a[64:67]
s_waitcnt vmcnt(22)
v_fmac_f32 v195,4.0,v197
v_fma_f32 v235,-4.0,v199,v203
M a[64:67],a[176:179],a[108:111],a[64:67]
v_fmac_f32 v193,s45,v203
v_fmac_f32 v195,s41,v201
M a[68:71],a[176:179],a[136:139],0
v_sub_f32 v203,v203,v199
v_fma_f32 v199,-4.0,v197,v201
M a[68:71],a[164:167],a[108:111],a[68:71]
v_sub_f32 v201,v201,v197
v_add_f32 v197,v235,v199
M a[68:71],a[120:123],a[112:115],a[68:71]
v_sub_f32 v235,v235,v199
v_fma_f32 v199,2.0,v201,v203
M a[72:75],a[120:123],a[108:111],0
v_fmac_f32 v203,-2.0,v201
v_cvt_pk_bf16_f32 v193,v232,v193
M a[72:75],a[164:167],a[136:139],a[72:75]
v_cvt_pk_bf16_f32 v195,v237,v195
v_cvt_pk_bf16_f32 v197,v233,v197
M a[72:75],a[176:179],a[116:119],a[72:75]
v_cvt_pk_bf16_f32 v201,v234,v199
v_cvt_pk_bf16_f32 v199,v238,v235
M a[76:79],a[176:179],a[124:127],0
v_cvt_pk_bf16_f32 v203,v236,v203
v_permlane32_swap_b32 v208,v210
M a[76:79],a[164:167],a[116:119],a[76:79]
v_permlane32_swap_b32 v204,v206
v_permlane32_swap_b32 v212,v214
M a[76:79],a[120:123],a[136:139],a[76:79]
ds_write2st64_b64 v247,v[192:193],v[194:195] offset0:170 offset1:187
M a[80:83],a[120:123],a[116:119],0
s_add_u32 s28,s67,7077888
buffer_load_dwordx4 v[192:195],v251,s[88:91],s28 offen offset:0
M a[80:83],a[164:167],a[124:127],a[80:83]
v_lshlrev_b32 v234,16,v210
v_lshlrev_b32 v232,16,v204
M a[80:83],a[176:179],a[132:135],a[80:83]
ds_write2st64_b64 v247,v[196:197],v[198:199] offset0:0 offset1:17
M a[84:87],a[176:179],a[140:143],0
buffer_load_dwordx4 v[196:199],v245,s[8:11],s28 offen offset:0
M a[84:87],a[164:167],a[132:135],a[84:87]
ds_read_b128 a[172:175],v248 offset:8704
v_lshlrev_b32 v233,16,v208
M a[84:87],a[120:123],a[124:127],a[84:87]
ds_write2st64_b64 v247,v[200:201],v[202:203] offset0:136 offset1:153
M a[88:91],a[120:123],a[132:135],0
buffer_load_dwordx4 v[200:203],v245,s[8:11],s28 offen offset:768
M a[88:91],a[164:167],a[140:143],a[88:91]
ds_read_b128 a[180:183],v249 offset:8704
ds_read_b128 a[184:187],v248 offset:9216
M a[88:91],a[176:179],a[144:147],a[88:91]
ds_read_b128 v[228:231],v249 offset:9216
v_lshlrev_b32 v237,16,v206
M a[92:95],a[176:179],a[148:151],0
v_lshlrev_b32 v236,16,v214
v_lshlrev_b32 v235,16,v212
M a[92:95],a[164:167],a[144:147],a[92:95]
v_fmac_f32 v232,s43,v234
v_fmac_f32 v237,4.0,v233
M a[92:95],a[120:123],a[140:143],a[92:95]
s_waitcnt vmcnt(18) lgkmcnt(4)
v_fma_f32 v238,-4.0,v234,v236
v_fmac_f32 v232,s45,v236
M a[96:99],a[168:171],a[172:175],0
s_waitcnt vmcnt(17) lgkmcnt(2)
ds_read_b128 a[208:211],v248 offset:9728
v_fmac_f32 v237,s41,v235
M a[96:99],a[188:191],a[180:183],a[96:99]
s_waitcnt vmcnt(16) lgkmcnt(2)
ds_read_b128 a[196:199],v249 offset:9728
v_sub_f32 v236,v236,v234
M a[96:99],a[220:223],a[184:187],a[96:99]
s_waitcnt lgkmcnt(2)
v_fma_f32 v234,-4.0,v233,v235
v_sub_f32 v235,v235,v233
M a[100:103],a[220:223],v[228:231],0
v_add_f32 v233,v238,v234
v_sub_f32 v238,v238,v234
M a[100:103],a[188:191],a[184:187],a[100:103]
v_fma_f32 v234,2.0,v235,v236
v_fmac_f32 v236,-2.0,v235
M a[100:103],a[168:171],a[180:183],a[100:103]
v_and_b32 v210,s42,v210
v_and_b32 v204,s42,v204
M a[104:107],a[168:171],a[184:187],0
ds_read_b128 a[224:227],v248 offset:10240
v_and_b32 v208,s42,v208
M a[104:107],a[188:191],v[228:231],a[104:107]
s_waitcnt lgkmcnt(2)
ds_read_b128 a[228:231],v249 offset:10240
v_and_b32 v206,s42,v206
M a[104:107],a[220:223],a[208:211],a[104:107]
s_waitcnt lgkmcnt(2)
v_and_b32 v214,s42,v214
v_and_b32 v212,s42,v212
M a[108:111],a[220:223],a[196:199],0
v_fmac_f32 v204,s43,v210
v_fmac_f32 v206,4.0,v208
M a[108:111],a[188:191],a[208:211],a[108:111]
v_fma_f32 v235,-4.0,v210,v214
v_fmac_f32 v204,s45,v214
M a[108:111],a[168:171],v[228:231],a[108:111]
v_fmac_f32 v206,s41,v212
v_sub_f32 v214,v214,v210
M a[112:115],a[168:171],a[208:211],0
ds_read_b128 a[232:235],v249 offset:10752
v_fma_f32 v210,-4.0,v208,v212
M a[112:115],a[188:191],a[196:199],a[112:115]
s_waitcnt lgkmcnt(2)
ds_read_b128 a[236:239],v248 offset:10752
v_sub_f32 v212,v212,v208
M a[112:115],a[220:223],a[224:227],a[112:115]
s_waitcnt lgkmcnt(2)
v_add_f32 v208,v235,v210
v_sub_f32 v235,v235,v210
M a[116:119],a[220:223],a[228:231],0
v_fma_f32 v210,2.0,v212,v214
v_fmac_f32 v214,-2.0,v212
M a[116:119],a[188:191],a[224:227],a[116:119]
v_cvt_pk_bf16_f32 v204,v232,v204
v_cvt_pk_bf16_f32 v206,v237,v206
M a[116:119],a[168:171],a[196:199],a[116:119]
v_cvt_pk_bf16_f32 v208,v233,v208
v_cvt_pk_bf16_f32 v212,v234,v210
M a[120:123],a[168:171],a[224:227],0
v_cvt_pk_bf16_f32 v210,v238,v235
v_cvt_pk_bf16_f32 v214,v236,v214
M a[120:123],a[188:191],a[228:231],a[120:123]
s_waitcnt lgkmcnt(1)
v_permlane32_swap_b32 v209,v211
v_permlane32_swap_b32 v205,v207
M a[120:123],a[220:223],a[232:235],a[120:123]
s_waitcnt lgkmcnt(0)
v_permlane32_swap_b32 v213,v215
v_lshlrev_b32 v234,16,v211
M a[124:127],a[220:223],a[236:239],0
buffer_load_dwordx4 a[216:219],v250,s[20:23],s46 offen offset:1024 sc1
M a[124:127],a[188:191],a[232:235],a[124:127]
v_lshlrev_b32 v232,16,v205
v_lshlrev_b32 v233,16,v209
M a[124:127],a[168:171],a[228:231],a[124:127]
s_waitcnt vmcnt(14)
buffer_load_dwordx4 a[240:243],v250,s[20:23],s46 offen offset:2048 sc1
M a[128:131],a[248:251],a[172:175],0
s_waitcnt vmcnt(14)
s_add_u32 s47,s72,30720
v_lshlrev_b32 v237,16,v207
v_lshlrev_b32 v236,16,v215
M a[128:131],a[160:163],a[180:183],a[128:131]
s_waitcnt vmcnt(13)
v_lshlrev_b32 v235,16,v213
v_fmac_f32 v232,s43,v234
M a[128:131],a[244:247],a[184:187],a[128:131]
v_fmac_f32 v237,4.0,v233
v_fma_f32 v238,-4.0,v234,v236
M a[132:135],a[244:247],v[228:231],0
buffer_load_dwordx4 v[220:223],v250,s[20:23],s47 offen offset:0 sc1
M a[132:135],a[160:163],a[184:187],a[132:135]
v_fmac_f32 v232,s45,v236
v_fmac_f32 v237,s41,v235
M a[132:135],a[248:251],a[180:183],a[132:135]
v_sub_f32 v236,v236,v234
v_fma_f32 v234,-4.0,v233,v235
M a[136:139],a[248:251],a[184:187],0
v_sub_f32 v235,v235,v233
v_add_f32 v233,v238,v234
M a[136:139],a[160:163],v[228:231],a[136:139]
v_sub_f32 v238,v238,v234
v_fma_f32 v234,2.0,v235,v236
M a[136:139],a[244:247],a[208:211],a[136:139]
v_fmac_f32 v236,-2.0,v235
v_and_b32 v211,s42,v211
M a[140:143],a[244:247],a[196:199],0
v_and_b32 v205,s42,v205
v_and_b32 v209,s42,v209
M a[140:143],a[160:163],a[208:211],a[140:143]
v_and_b32 v207,s42,v207
v_and_b32 v215,s42,v215
M a[140:143],a[248:251],v[228:231],a[140:143]
v_and_b32 v213,s42,v213
v_fmac_f32 v205,s43,v211
M a[144:147],a[248:251],a[208:211],0
v_fmac_f32 v207,4.0,v209
v_fma_f32 v235,-4.0,v211,v215
M a[144:147],a[160:163],a[196:199],a[144:147]
v_fmac_f32 v205,s45,v215
v_fmac_f32 v207,s41,v213
M a[144:147],a[244:247],a[224:227],a[144:147]
v_sub_f32 v215,v215,v211
v_fma_f32 v211,-4.0,v209,v213
M a[148:151],a[244:247],a[228:231],0
v_sub_f32 v213,v213,v209
v_add_f32 v209,v235,v211
M a[148:151],a[160:163],a[224:227],a[148:151]
v_sub_f32 v235,v235,v211
v_fma_f32 v211,2.0,v213,v215
M a[148:151],a[248:251],a[196:199],a[148:151]
v_fmac_f32 v215,-2.0,v213
v_cvt_pk_bf16_f32 v205,v232,v205
M a[152:155],a[248:251],a[224:227],0
v_cvt_pk_bf16_f32 v207,v237,v207
v_cvt_pk_bf16_f32 v209,v233,v209
M a[152:155],a[160:163],a[228:231],a[152:155]
v_cvt_pk_bf16_f32 v213,v234,v211
v_cvt_pk_bf16_f32 v211,v238,v235
M a[152:155],a[244:247],a[232:235],a[152:155]
v_cvt_pk_bf16_f32 v215,v236,v215
v_fmac_f32 v239,s43,v241
M a[156:159],a[244:247],a[236:239],0
buffer_load_dwordx4 a[200:203],v250,s[20:23],s47 offen offset:1024 sc1
M a[156:159],a[160:163],a[232:235],a[156:159]
v_fmac_f32 v244,4.0,v240
v_fma_f32 v232,-4.0,v241,v243
M a[156:159],a[248:251],a[228:231],a[156:159]
s_waitcnt vmcnt(14)
buffer_load_dwordx4 a[192:195],v250,s[20:23],s47 offen offset:2048 sc1
M a[160:163],a[252:255],a[172:175],0
s_waitcnt vmcnt(14)
s_add_u32 s48,s72,33792
v_fmac_f32 v239,s45,v243
v_fmac_f32 v244,s41,v242
M a[160:163],a[212:215],a[180:183],a[160:163]
s_waitcnt vmcnt(13)
v_sub_f32 v243,v243,v241
v_fma_f32 v241,-4.0,v240,v242
M a[160:163],v[216:219],a[184:187],a[160:163]
ds_write2st64_b64 v247,v[204:205],v[206:207] offset0:171 offset1:188
M a[164:167],v[216:219],v[228:231],0
s_add_u32 s28,s67,7471104
buffer_load_dwordx4 a[204:207],v250,s[20:23],s48 offen offset:0 sc1
M a[164:167],a[212:215],a[184:187],a[164:167]
v_sub_f32 v242,v242,v240
v_add_f32 v240,v232,v241
M a[164:167],a[252:255],a[180:183],a[164:167]
ds_write2st64_b64 v247,v[208:209],v[210:211] offset0:1 offset1:18
M a[168:171],a[252:255],a[184:187],0
buffer_load_dwordx4 a[220:223],v250,s[20:23],s48 offen offset:1024 sc1
M a[168:171],a[212:215],v[228:231],a[168:171]
v_sub_f32 v232,v232,v241
v_fma_f32 v241,2.0,v242,v243
M a[168:171],v[216:219],a[208:211],a[168:171]
ds_write2st64_b64 v247,v[212:213],v[214:215] offset0:137 offset1:154
M a[172:175],v[216:219],a[196:199],0
buffer_load_dwordx4 a[244:247],v250,s[20:23],s48 offen offset:2048 sc1
M a[172:175],a[212:215],a[208:211],a[172:175]
s_add_u32 s46,s72,36864
v_fmac_f32 v243,-2.0,v242
v_cvt_pk_bf16_f32 v233,v239,v244
M a[172:175],a[252:255],v[228:231],a[172:175]
v_cvt_pk_bf16_f32 v234,v240,v232
v_cvt_pk_bf16_f32 v235,v241,v243
M a[176:179],a[252:255],a[208:211],0
v_add_u32 v232,87040,v252
M a[176:179],a[212:215],a[196:199],a[176:179]
buffer_load_dwordx4 a[248:251],v250,s[20:23],s46 offen offset:0 sc1
M a[176:179],v[216:219],a[224:227],a[176:179]
ds_write_b16 v232,v233 offset:0
M a[180:183],v[216:219],a[228:231],0
ds_write_b16_d16_hi v232,v233 offset:8704
M a[180:183],a[212:215],a[224:227],a[180:183]
ds_read_b128 v[228:231],v248 offset:17408
ds_write_b16 v252,v234 offset:0
M a[180:183],a[252:255],a[196:199],a[180:183]
buffer_load_dwordx4 v[204:207],v251,s[88:91],s28 offen offset:0
M a[184:187],a[252:255],a[224:227],0
ds_read_b128 a[208:211],v249 offset:17408
ds_read_b128 a[196:199],v248 offset:17920
M a[184:187],a[212:215],a[228:231],a[184:187]
ds_read_b128 a[224:227],v249 offset:17920
ds_write_b16_d16_hi v252,v234 offset:8704
M a[184:187],v[216:219],a[232:235],a[184:187]
v_add_u32 v232,69632,v252
M a[188:191],v[216:219],a[236:239],0
buffer_load_dwordx4 v[208:211],v245,s[8:11],s28 offen offset:0
M a[188:191],a[212:215],a[232:235],a[188:191]
ds_write_b16 v232,v235 offset:0
M a[188:191],a[252:255],a[228:231],a[188:191]
s_waitcnt vmcnt(18) lgkmcnt(6)
ds_write_b16_d16_hi v232,v235 offset:8704
M v[0:3],v[224:227],v[228:231],0
s_waitcnt vmcnt(10) lgkmcnt(5)
ds_read_b128 a[236:239],v248 offset:18432
v_permlane32_swap_b32 v196,v198
M v[0:3],a[216:219],a[208:211],v[0:3]
s_waitcnt vmcnt(9) lgkmcnt(5)
buffer_load_dwordx4 v[212:215],v245,s[8:11],s28 offen offset:768
M v[0:3],a[240:243],a[196:199],v[0:3]
s_waitcnt lgkmcnt(4)
s_add_u32 s29,s68,6291456
ds_read_b128 v[216:219],v249 offset:18432
v_permlane32_swap_b32 v192,v194
M v[4:7],a[240:243],a[224:227],0
v_permlane32_swap_b32 v200,v202
v_lshlrev_b32 v234,16,v198
M v[4:7],a[216:219],a[196:199],v[4:7]
v_lshlrev_b32 v232,16,v192
v_lshlrev_b32 v233,16,v196
M v[4:7],v[224:227],a[208:211],v[4:7]
buffer_load_short_d16_hi v239,v246,s[12:15],s29 offen offset:0
M v[8:11],v[224:227],a[196:199],0
ds_read_b128 a[212:215],v248 offset:18944
v_lshlrev_b32 v237,16,v194
M v[8:11],a[216:219],a[224:227],v[8:11]
s_waitcnt lgkmcnt(2)
buffer_load_short_d16_hi v240,v246,s[8:11],s29 offen offset:0
M v[8:11],a[240:243],a[236:239],v[8:11]
s_waitcnt lgkmcnt(1)
ds_read_b128 a[232:235],v249 offset:18944
v_lshlrev_b32 v236,16,v202
M v[12:15],a[240:243],v[216:219],0
buffer_load_short_d16_hi v241,v246,s[8:11],s29 offen offset:384
M v[12:15],a[216:219],a[236:239],v[12:15]
v_lshlrev_b32 v235,16,v200
v_fmac_f32 v232,s43,v234
M v[12:15],v[224:227],a[224:227],v[12:15]
buffer_load_short_d16_hi v242,v246,s[8:11],s29 offen offset:768
M v[16:19],v[224:227],a[236:239],0
ds_read_b128 a[228:231],v249 offset:19456
v_fmac_f32 v237,4.0,v233
M v[16:19],a[216:219],v[216:219],v[16:19]
s_waitcnt lgkmcnt(2)
buffer_load_short_d16_hi v243,v246,s[8:11],s29 offen offset:1152
M v[16:19],a[240:243],a[212:215],v[16:19]
s_waitcnt lgkmcnt(1)
ds_read_b128 a[252:255],v248 offset:19456
v_fma_f32 v238,-4.0,v234,v236
M v[20:23],a[240:243],a[232:235],0
buffer_load_short_d16_hi v244,v246,s[16:19],s29 offen offset:1536
M v[20:23],a[216:219],a[212:215],v[20:23]
v_fmac_f32 v232,s45,v236
v_fmac_f32 v237,s41,v235
M v[20:23],v[224:227],v[216:219],v[20:23]
v_sub_f32 v236,v236,v234
v_fma_f32 v234,-4.0,v233,v235
M v[24:27],v[224:227],a[212:215],0
v_sub_f32 v235,v235,v233
v_add_f32 v233,v238,v234
M v[24:27],a[216:219],a[232:235],v[24:27]
s_waitcnt lgkmcnt(1)
v_sub_f32 v238,v238,v234
v_fma_f32 v234,2.0,v235,v236
M v[24:27],a[240:243],a[228:231],v[24:27]
s_waitcnt lgkmcnt(0)
v_fmac_f32 v236,-2.0,v235
v_and_b32 v198,s42,v198
M v[28:31],a[240:243],a[252:255],0
global_load_dword a240,v250,s[64:65]
M v[28:31],a[216:219],a[228:231],v[28:31]
buffer_load_dwordx4 a[240:243],v250,s[20:23],s46 offen offset:1024 sc1
M v[28:31],v[224:227],a[232:235],v[28:31]
s_waitcnt vmcnt(17)
v_and_b32 v192,s42,v192
v_and_b32 v196,s42,v196
M v[32:35],v[220:223],v[228:231],0
s_waitcnt vmcnt(16)
v_and_b32 v194,s42,v194
v_and_b32 v202,s42,v202
M v[32:35],a[200:203],a[208:211],v[32:35]
s_waitcnt vmcnt(15)
buffer_load_dwordx4 a[216:219],v250,s[20:23],s46 offen offset:2048 sc1
M v[32:35],a[192:195],a[196:199],v[32:35]
s_add_u32 s47,s72,39936
v_and_b32 v200,s42,v200
v_fmac_f32 v192,s43,v198
M v[36:39],a[192:195],a[224:227],0
v_fmac_f32 v194,4.0,v196
v_fma_f32 v235,-4.0,v198,v202
M v[36:39],a[200:203],a[196:199],v[36:39]
v_fmac_f32 v192,s45,v202
v_fmac_f32 v194,s41,v200
M v[36:39],v[220:223],a[208:211],v[36:39]
buffer_load_dwordx4 v[224:227],v250,s[20:23],s47 offen offset:0 sc1
M v[40:43],v[220:223],a[196:199],0
v_sub_f32 v202,v202,v198
v_fma_f32 v198,-4.0,v196,v200
M v[40:43],a[200:203],a[224:227],v[40:43]
v_sub_f32 v200,v200,v196
v_add_f32 v196,v235,v198
M v[40:43],a[192:195],a[236:239],v[40:43]
v_sub_f32 v235,v235,v198
v_fma_f32 v198,2.0,v200,v202
M v[44:47],a[192:195],v[216:219],0
v_fmac_f32 v202,-2.0,v200
v_cvt_pk_bf16_f32 v192,v232,v192
M v[44:47],a[200:203],a[236:239],v[44:47]
v_cvt_pk_bf16_f32 v194,v237,v194
v_cvt_pk_bf16_f32 v196,v233,v196
M v[44:47],v[220:223],a[224:227],v[44:47]
v_cvt_pk_bf16_f32 v200,v234,v198
v_cvt_pk_bf16_f32 v198,v238,v235
M v[48:51],v[220:223],a[236:239],0
v_cvt_pk_bf16_f32 v202,v236,v202
v_permlane32_swap_b32 v197,v199
M v[48:51],a[200:203],v[216:219],v[48:51]
v_permlane32_swap_b32 v193,v195
v_permlane32_swap_b32 v201,v203
M v[48:51],a[192:195],a[212:215],v[48:51]
v_lshlrev_b32 v234,16,v199
v_lshlrev_b32 v232,16,v193
M v[52:55],a[192:195],a[232:235],0
v_lshlrev_b32 v233,16,v197
v_lshlrev_b32 v237,16,v195
M v[52:55],a[200:203],a[212:215],v[52:55]
v_lshlrev_b32 v236,16,v203
v_lshlrev_b32 v235,16,v201
M v[52:55],v[220:223],v[216:219],v[52:55]
v_fmac_f32 v232,s43,v234
v_fmac_f32 v237,4.0,v233
M v[56:59],v[220:223],a[212:215],0
v_fma_f32 v238,-4.0,v234,v236
v_fmac_f32 v232,s45,v236
M v[56:59],a[200:203],a[232:235],v[56:59]
v_fmac_f32 v237,s41,v235
v_sub_f32 v236,v236,v234
M v[56:59],a[192:195],a[228:231],v[56:59]
v_fma_f32 v234,-4.0,v233,v235
v_sub_f32 v235,v235,v233
M v[60:63],a[192:195],a[252:255],0
buffer_load_dwordx4 a[192:195],v250,s[20:23],s47 offen offset:1024 sc1
M v[60:63],a[200:203],a[228:231],v[60:63]
v_add_f32 v233,v238,v234
v_sub_f32 v238,v238,v234
M v[60:63],v[220:223],a[232:235],v[60:63]
s_waitcnt vmcnt(17)
buffer_load_dwordx4 a[200:203],v250,s[20:23],s47 offen offset:2048 sc1
M v[64:67],a[204:207],v[228:231],0
s_waitcnt vmcnt(17)
s_add_u32 s48,s72,43008
v_fma_f32 v234,2.0,v235,v236
v_fmac_f32 v236,-2.0,v235
M v[64:67],a[220:223],a[208:211],v[64:67]
s_waitcnt vmcnt(16)
v_and_b32 v199,s42,v199
v_and_b32 v193,s42,v193
M v[64:67],a[244:247],a[196:199],v[64:67]
v_and_b32 v197,s42,v197
v_and_b32 v195,s42,v195
M v[68:71],a[244:247],a[224:227],0
buffer_load_dwordx4 v[220:223],v250,s[20:23],s48 offen offset:0 sc1
M v[68:71],a[220:223],a[196:199],v[68:71]
v_and_b32 v203,s42,v203
v_and_b32 v201,s42,v201
M v[68:71],a[204:207],a[208:211],v[68:71]
v_fmac_f32 v193,s43,v199
v_fmac_f32 v195,4.0,v197
M v[72:75],a[204:207],a[196:199],0
v_fma_f32 v235,-4.0,v199,v203
v_fmac_f32 v193,s45,v203
M v[72:75],a[220:223],a[224:227],v[72:75]
buffer_load_dwordx4 v[228:231],v250,s[20:23],s48 offen offset:1024 sc1
M v[72:75],a[244:247],a[236:239],v[72:75]
v_fmac_f32 v195,s41,v201
v_sub_f32 v203,v203,v199
M v[76:79],a[244:247],v[216:219],0
v_fma_f32 v199,-4.0,v197,v201
v_sub_f32 v201,v201,v197
M v[76:79],a[220:223],a[236:239],v[76:79]
v_add_f32 v197,v235,v199
v_sub_f32 v235,v235,v199
M v[76:79],a[204:207],a[224:227],v[76:79]
buffer_load_dwordx4 a[208:211],v250,s[20:23],s48 offen offset:2048 sc1
M v[80:83],a[204:207],a[236:239],0
s_add_u32 s46,s73,9216
v_fma_f32 v199,2.0,v201,v203
v_fmac_f32 v203,-2.0,v201
M v[80:83],a[220:223],v[216:219],v[80:83]
v_cvt_pk_bf16_f32 v193,v232,v193
v_cvt_pk_bf16_f32 v195,v237,v195
M v[80:83],a[244:247],a[212:215],v[80:83]
v_cvt_pk_bf16_f32 v197,v233,v197
v_cvt_pk_bf16_f32 v201,v234,v199
M v[84:87],a[244:247],a[232:235],0
buffer_load_dwordx4 a[196:199],v250,s[20:23],s46 offen offset:0 sc1
M v[84:87],a[220:223],a[212:215],v[84:87]
ds_read_b128 a[224:227],v248 offset:26112
v_cvt_pk_bf16_f32 v199,v238,v235
M v[84:87],a[204:207],v[216:219],v[84:87]
ds_read_b128 a[236:239],v249 offset:26112
v_cvt_pk_bf16_f32 v203,v236,v203
M v[88:91],a[204:207],a[212:215],0
s_waitcnt vmcnt(17)
ds_read_b128 v[216:219],v248 offset:26624
v_permlane32_swap_b32 v208,v210
M v[88:91],a[220:223],a[232:235],v[88:91]
ds_read_b128 a[212:215],v249 offset:26624
v_permlane32_swap_b32 v204,v206
M v[88:91],a[244:247],a[228:231],v[88:91]
ds_write2st64_b64 v247,v[192:193],v[194:195] offset0:172 offset1:189
M v[92:95],a[244:247],a[252:255],0
s_add_u32 s28,s68,6291456
buffer_load_dwordx4 v[192:195],v251,s[88:91],s28 offen offset:0
M v[92:95],a[220:223],a[228:231],v[92:95]
s_waitcnt vmcnt(17)
v_permlane32_swap_b32 v212,v214
v_lshlrev_b32 v234,16,v210
M v[92:95],a[204:207],a[232:235],v[92:95]
s_waitcnt lgkmcnt(4)
ds_write2st64_b64 v247,v[196:197],v[198:199] offset0:2 offset1:19
M v[96:99],a[248:251],a[224:227],0
s_waitcnt vmcnt(9) lgkmcnt(4)
buffer_load_dwordx4 v[196:199],v245,s[8:11],s28 offen offset:0
M v[96:99],a[240:243],a[236:239],v[96:99]
s_waitcnt vmcnt(9) lgkmcnt(3)
ds_read_b128 a[244:247],v248 offset:27136
ds_read_b128 a[252:255],v249 offset:27136
M v[96:99],a[216:219],v[216:219],v[96:99]
s_waitcnt lgkmcnt(4)
ds_write2st64_b64 v247,v[200:201],v[202:203] offset0:138 offset1:155
M v[100:103],a[216:219],a[212:215],0
buffer_load_dwordx4 v[200:203],v245,s[8:11],s28 offen offset:768
M v[100:103],a[240:243],v[216:219],v[100:103]
v_lshlrev_b32 v232,16,v204
v_lshlrev_b32 v233,16,v208
M v[100:103],a[248:251],a[236:239],v[100:103]
v_lshlrev_b32 v237,16,v206
v_lshlrev_b32 v236,16,v214
M v[104:107],a[248:251],v[216:219],0
ds_read_b128 a[220:223],v248 offset:27648
v_lshlrev_b32 v235,16,v212
M v[104:107],a[240:243],a[212:215],v[104:107]
s_waitcnt lgkmcnt(3)
ds_read_b128 a[228:231],v249 offset:27648
v_fmac_f32 v232,s43,v234
M v[104:107],a[216:219],a[244:247],v[104:107]
s_waitcnt lgkmcnt(3)
v_fmac_f32 v237,4.0,v233
v_fma_f32 v238,-4.0,v234,v236
M v[108:111],a[216:219],a[252:255],0
v_fmac_f32 v232,s45,v236
v_fmac_f32 v237,s41,v235
M v[108:111],a[240:243],a[244:247],v[108:111]
v_sub_f32 v236,v236,v234
v_fma_f32 v234,-4.0,v233,v235
M v[108:111],a[248:251],a[212:215],v[108:111]
v_sub_f32 v235,v235,v233
v_add_f32 v233,v238,v234
M v[112:115],a[248:251],a[244:247],0
ds_read_b128 a[204:207],v249 offset:28160
v_sub_f32 v238,v238,v234
M v[112:115],a[240:243],a[252:255],v[112:115]
s_waitcnt lgkmcnt(2)
ds_read_b128 a[232:235],v248 offset:28160
v_fma_f32 v234,2.0,v235,v236
M v[112:115],a[216:219],a[220:223],v[112:115]
s_waitcnt lgkmcnt(2)
v_fmac_f32 v236,-2.0,v235
v_and_b32 v210,s42,v210
M v[116:119],a[216:219],a[228:231],0
v_and_b32 v204,s42,v204
v_and_b32 v208,s42,v208
M v[116:119],a[240:243],a[220:223],v[116:119]
v_and_b32 v206,s42,v206
v_and_b32 v214,s42,v214
M v[116:119],a[248:251],a[252:255],v[116:119]
v_and_b32 v212,s42,v212
v_fmac_f32 v204,s43,v210
M v[120:123],a[248:251],a[220:223],0
v_fmac_f32 v206,4.0,v208
v_fma_f32 v235,-4.0,v210,v214
M v[120:123],a[240:243],a[228:231],v[120:123]
s_waitcnt lgkmcnt(1)
v_fmac_f32 v204,s45,v214
v_fmac_f32 v206,s41,v212
M v[120:123],a[216:219],a[204:207],v[120:123]
s_waitcnt lgkmcnt(0)
v_sub_f32 v214,v214,v210
v_fma_f32 v210,-4.0,v208,v212
M v[124:127],a[216:219],a[232:235],0
buffer_load_dwordx4 a[216:219],v250,s[20:23],s46 offen offset:1024 sc1
M v[124:127],a[240:243],a[204:207],v[124:127]
v_sub_f32 v212,v212,v208
v_add_f32 v208,v235,v210
M v[124:127],a[248:251],a[228:231],v[124:127]
s_waitcnt vmcnt(10)
buffer_load_dwordx4 a[240:243],v250,s[20:23],s46 offen offset:2048 sc1
M v[128:131],v[224:227],a[224:227],0
s_waitcnt vmcnt(10)
s_add_u32 s47,s73,12288
v_sub_f32 v235,v235,v210
v_fma_f32 v210,2.0,v212,v214
M v[128:131],a[192:195],a[236:239],v[128:131]
s_waitcnt vmcnt(9)
v_fmac_f32 v214,-2.0,v212
v_cvt_pk_bf16_f32 v204,v232,v204
M v[128:131],a[200:203],v[216:219],v[128:131]
v_cvt_pk_bf16_f32 v206,v237,v206
v_cvt_pk_bf16_f32 v208,v233,v208
M v[132:135],a[200:203],a[212:215],0
buffer_load_dwordx4 a[248:251],v250,s[20:23],s47 offen offset:0 sc1
M v[132:135],a[192:195],v[216:219],v[132:135]
v_cvt_pk_bf16_f32 v212,v234,v210
v_cvt_pk_bf16_f32 v210,v238,v235
M v[132:135],v[224:227],a[236:239],v[132:135]
v_cvt_pk_bf16_f32 v214,v236,v214
v_permlane32_swap_b32 v209,v211
M v[136:139],v[224:227],v[216:219],0
v_permlane32_swap_b32 v205,v207
v_permlane32_swap_b32 v213,v215
M v[136:139],a[192:195],a[212:215],v[136:139]
v_lshlrev_b32 v234,16,v211
v_lshlrev_b32 v232,16,v205
M v[136:139],a[200:203],a[244:247],v[136:139]
v_lshlrev_b32 v233,16,v209
v_lshlrev_b32 v237,16,v207
M v[140:143],a[200:203],a[252:255],0
v_lshlrev_b32 v236,16,v215
v_lshlrev_b32 v235,16,v213
M v[140:143],a[192:195],a[244:247],v[140:143]
v_fmac_f32 v232,s43,v234
v_fmac_f32 v237,4.0,v233
M v[140:143],v[224:227],a[212:215],v[140:143]
v_fma_f32 v238,-4.0,v234,v236
v_fmac_f32 v232,s45,v236
M v[144:147],v[224:227],a[244:247],0
v_fmac_f32 v237,s41,v235
v_sub_f32 v236,v236,v234
M v[144:147],a[192:195],a[252:255],v[144:147]
v_fma_f32 v234,-4.0,v233,v235
v_sub_f32 v235,v235,v233
M v[144:147],a[200:203],a[220:223],v[144:147]
v_add_f32 v233,v238,v234
v_sub_f32 v238,v238,v234
M v[148:151],a[200:203],a[228:231],0
v_fma_f32 v234,2.0,v235,v236
v_fmac_f32 v236,-2.0,v235
M v[148:151],a[192:195],a[220:223],v[148:151]
v_and_b32 v211,s42,v211
v_and_b32 v205,s42,v205
M v[148:151],v[224:227],a[252:255],v[148:151]
v_and_b32 v209,s42,v209
v_and_b32 v207,s42,v207
M v[152:155],v[224:227],a[220:223],0
v_and_b32 v215,s42,v215
v_and_b32 v213,s42,v213
M v[152:155],a[192:195],a[228:231],v[152:155]
v_fmac_f32 v205,s43,v211
v_fmac_f32 v207,4.0,v209
M v[152:155],a[200:203],a[204:207],v[152:155]
v_fma_f32 v235,-4.0,v211,v215
v_fmac_f32 v205,s45,v215
M v[156:159],a[200:203],a[232:235],0
buffer_load_dwordx4 a[200:203],v250,s[20:23],s47 offen offset:1024 sc1
M v[156:159],a[192:195],a[204:207],v[156:159]
v_fmac_f32 v207,s41,v213
v_sub_f32 v215,v215,v211
M v[156:159],v[224:227],a[228:231],v[156:159]
s_waitcnt vmcnt(10)
buffer_load_dwordx4 a[192:195],v250,s[20:23],s47 offen offset:2048 sc1
M v[160:163],v[220:223],a[224:227],0
s_waitcnt vmcnt(10)
s_add_u32 s48,s73,15360
v_fma_f32 v211,-4.0,v209,v213
v_sub_f32 v213,v213,v209
M v[160:163],v[228:231],a[236:239],v[160:163]
s_waitcnt vmcnt(9)
v_add_f32 v209,v235,v211
v_sub_f32 v235,v235,v211
M v[160:163],a[208:211],v[216:219],v[160:163]
v_fma_f32 v211,2.0,v213,v215
v_fmac_f32 v215,-2.0,v213
v_cvt_pk_bf16_f32 v205,v232,v205
M v[164:167],a[208:211],a[212:215],0
buffer_load_dwordx4 v[224:227],v250,s[20:23],s48 offen offset:0 sc1
v_cvt_pk_bf16_f32 v207,v237,v207
v_cvt_pk_bf16_f32 v209,v233,v209
v_cvt_pk_bf16_f32 v213,v234,v211
v_cvt_pk_bf16_f32 v211,v238,v235
M v[164:167],v[228:231],v[216:219],v[164:167]
v_cvt_pk_bf16_f32 v215,v236,v215
M v[164:167],v[220:223],a[236:239],v[164:167]
ds_write2st64_b64 v247,v[204:205],v[206:207] offset0:173 offset1:190
M v[168:171],v[220:223],v[216:219],0
s_add_u32 s28,s68,6684672
buffer_load_dwordx4 a[224:227],v250,s[20:23],s48 offen offset:1024 sc1
M v[168:171],v[228:231],a[212:215],v[168:171]
M v[168:171],a[208:211],a[244:247],v[168:171]
ds_write2st64_b64 v247,v[208:209],v[210:211] offset0:3 offset1:20
M v[172:175],a[208:211],a[252:255],0
buffer_load_dwordx4 a[236:239],v250,s[20:23],s48 offen offset:2048 sc1
M v[172:175],v[228:231],a[244:247],v[172:175]
s_add_u32 s46,s73,18432
M v[172:175],v[220:223],a[212:215],v[172:175]
ds_write2st64_b64 v247,v[212:213],v[214:215] offset0:139 offset1:156
M v[176:179],v[220:223],a[244:247],0
buffer_load_dwordx4 v[216:219],v250,s[20:23],s46 offen offset:0 sc1
M v[176:179],v[228:231],a[252:255],v[176:179]
v_add_u32 v248,0xffffbc00,v248
v_add_u32 v249,0xffffbc00,v249
M v[176:179],a[208:211],a[220:223],v[176:179]
s_waitcnt lgkmcnt(0)
s_barrier
M v[180:183],a[208:211],a[228:231],0
s_waitcnt vmcnt(10)
v_permlane32_swap_b32 v196,v198
v_permlane32_swap_b32 v192,v194
M v[180:183],v[228:231],a[220:223],v[180:183]
buffer_load_dwordx4 v[204:207],v251,s[88:91],s28 offen offset:0
M v[180:183],v[220:223],a[252:255],v[180:183]
ds_read_b128 a[212:215],v248 offset:0
ds_read_b128 a[244:247],v249 offset:0
M v[184:187],v[220:223],a[220:223],0
s_waitcnt vmcnt(10)
ds_read_b128 a[252:255],v248 offset:512
v_permlane32_swap_b32 v200,v202
M v[184:187],v[228:231],a[228:231],v[184:187]
ds_read_b128 a[220:223],v249 offset:512
v_lshlrev_b32 v234,16,v198
M v[184:187],a[208:211],a[204:207],v[184:187]
buffer_load_dwordx4 v[208:211],v245,s[8:11],s28 offen offset:0
M v[188:191],a[208:211],a[232:235],0
v_lshlrev_b32 v232,16,v192
v_lshlrev_b32 v233,16,v196
M v[188:191],v[228:231],a[204:207],v[188:191]
v_lshlrev_b32 v237,16,v194
v_lshlrev_b32 v236,16,v202
M v[188:191],v[220:223],a[228:231],v[188:191]
s_waitcnt lgkmcnt(3)
v_lshlrev_b32 v235,16,v200
v_fmac_f32 v232,s43,v234
M a[0:3],a[196:199],a[212:215],a[0:3]
s_waitcnt vmcnt(10) lgkmcnt(2)
buffer_load_dwordx4 v[212:215],v245,s[8:11],s28 offen offset:768
M a[0:3],a[216:219],a[244:247],a[0:3]
s_waitcnt vmcnt(10) lgkmcnt(1)
ds_read_b128 a[208:211],v248 offset:1024
ds_read_b128 a[232:235],v249 offset:1024
M a[0:3],a[240:243],a[252:255],a[0:3]
s_waitcnt lgkmcnt(2)
v_fmac_f32 v237,4.0,v233
v_fma_f32 v238,-4.0,v234,v236
M a[4:7],a[240:243],a[220:223],a[4:7]
v_fmac_f32 v232,s45,v236
v_fmac_f32 v237,s41,v235
M a[4:7],a[216:219],a[252:255],a[4:7]
v_sub_f32 v236,v236,v234
v_fma_f32 v234,-4.0,v233,v235
M a[4:7],a[196:199],a[244:247],a[4:7]
v_sub_f32 v235,v235,v233
v_add_f32 v233,v238,v234
M a[8:11],a[196:199],a[252:255],a[8:11]
ds_read_b128 a[204:207],v248 offset:1536
v_sub_f32 v238,v238,v234
M a[8:11],a[216:219],a[220:223],a[8:11]
s_waitcnt lgkmcnt(2)
ds_read_b128 v[228:231],v249 offset:1536
v_fma_f32 v234,2.0,v235,v236
M a[8:11],a[240:243],a[208:211],a[8:11]
s_waitcnt lgkmcnt(2)
v_fmac_f32 v236,-2.0,v235
v_and_b32 v198,s42,v198
M a[12:15],a[240:243],a[232:235],a[12:15]
v_and_b32 v192,s42,v192
v_and_b32 v196,s42,v196
M a[12:15],a[216:219],a[208:211],a[12:15]
v_and_b32 v194,s42,v194
v_and_b32 v202,s42,v202
M a[12:15],a[196:199],a[220:223],a[12:15]
v_and_b32 v200,s42,v200
v_fmac_f32 v192,s43,v198
M a[16:19],a[196:199],a[208:211],a[16:19]
ds_read_b128 a[228:231],v249 offset:2048
v_fmac_f32 v194,4.0,v196
M a[16:19],a[216:219],a[232:235],a[16:19]
s_waitcnt lgkmcnt(2)
ds_read_b128 v[220:223],v248 offset:2048
v_fma_f32 v235,-4.0,v198,v202
M a[16:19],a[240:243],a[204:207],a[16:19]
s_waitcnt lgkmcnt(2)
v_fmac_f32 v192,s45,v202
v_fmac_f32 v194,s41,v200
M a[20:23],a[240:243],v[228:231],a[20:23]
v_sub_f32 v202,v202,v198
v_fma_f32 v198,-4.0,v196,v200
M a[20:23],a[216:219],a[204:207],a[20:23]
v_sub_f32 v200,v200,v196
v_add_f32 v196,v235,v198
M a[20:23],a[196:199],a[232:235],a[20:23]
v_sub_f32 v235,v235,v198
v_fma_f32 v198,2.0,v200,v202
M a[24:27],a[196:199],a[204:207],a[24:27]
v_fmac_f32 v202,-2.0,v200
v_cvt_pk_bf16_f32 v192,v232,v192
M a[24:27],a[216:219],v[228:231],a[24:27]
s_waitcnt lgkmcnt(1)
v_cvt_pk_bf16_f32 v194,v237,v194
v_cvt_pk_bf16_f32 v196,v233,v196
M a[24:27],a[240:243],a[228:231],a[24:27]
s_waitcnt lgkmcnt(0)
v_cvt_pk_bf16_f32 v200,v234,v198
v_cvt_pk_bf16_f32 v198,v238,v235
M a[28:31],a[240:243],v[220:223],a[28:31]
buffer_load_dwordx4 a[240:243],v250,s[20:23],s46 offen offset:1024 sc1
M a[28:31],a[216:219],a[228:231],a[28:31]
v_cvt_pk_bf16_f32 v202,v236,v202
v_permlane32_swap_b32 v197,v199
M a[28:31],a[196:199],v[228:231],a[28:31]
s_waitcnt vmcnt(10)
buffer_load_dwordx4 a[216:219],v250,s[20:23],s46 offen offset:2048 sc1
M a[32:35],a[248:251],a[212:215],a[32:35]
s_waitcnt vmcnt(10)
s_add_u32 s47,s73,21504
v_permlane32_swap_b32 v193,v195
v_permlane32_swap_b32 v201,v203
M a[32:35],a[200:203],a[244:247],a[32:35]
s_waitcnt vmcnt(9)
v_lshlrev_b32 v234,16,v199
v_lshlrev_b32 v232,16,v193
M a[32:35],a[192:195],a[252:255],a[32:35]
v_lshlrev_b32 v233,16,v197
v_lshlrev_b32 v237,16,v195
M a[36:39],a[192:195],a[220:223],a[36:39]
buffer_load_dwordx4 a[196:199],v250,s[20:23],s47 offen offset:0 sc1
M a[36:39],a[200:203],a[252:255],a[36:39]
v_lshlrev_b32 v236,16,v203
v_lshlrev_b32 v235,16,v201
M a[36:39],a[248:251],a[244:247],a[36:39]
v_fmac_f32 v232,s43,v234
v_fmac_f32 v237,4.0,v233
M a[40:43],a[248:251],a[252:255],a[40:43]
v_fma_f32 v238,-4.0,v234,v236
v_fmac_f32 v232,s45,v236
M a[40:43],a[200:203],a[220:223],a[40:43]
v_fmac_f32 v237,s41,v235
v_sub_f32 v236,v236,v234
M a[40:43],a[192:195],a[208:211],a[40:43]
v_fma_f32 v234,-4.0,v233,v235
v_sub_f32 v235,v235,v233
M a[44:47],a[192:195],a[232:235],a[44:47]
v_add_f32 v233,v238,v234
v_sub_f32 v238,v238,v234
M a[44:47],a[200:203],a[208:211],a[44:47]
v_fma_f32 v234,2.0,v235,v236
v_fmac_f32 v236,-2.0,v235
M a[44:47],a[248:251],a[220:223],a[44:47]
v_and_b32 v199,s42,v199
v_and_b32 v193,s42,v193
M a[48:51],a[248:251],a[208:211],a[48:51]
v_and_b32 v197,s42,v197
v_and_b32 v195,s42,v195
M a[48:51],a[200:203],a[232:235],a[48:51]
v_and_b32 v203,s42,v203
v_and_b32 v201,s42,v201
M a[48:51],a[192:195],a[204:207],a[48:51]
v_fmac_f32 v193,s43,v199
v_fmac_f32 v195,4.0,v197
M a[52:55],a[192:195],v[228:231],a[52:55]
v_fma_f32 v235,-4.0,v199,v203
v_fmac_f32 v193,s45,v203
M a[52:55],a[200:203],a[204:207],a[52:55]
v_fmac_f32 v195,s41,v201
v_sub_f32 v203,v203,v199
M a[52:55],a[248:251],a[232:235],a[52:55]
v_fma_f32 v199,-4.0,v197,v201
v_sub_f32 v201,v201,v197
M a[56:59],a[248:251],a[204:207],a[56:59]
v_add_f32 v197,v235,v199
v_sub_f32 v235,v235,v199
M a[56:59],a[200:203],v[228:231],a[56:59]
v_fma_f32 v199,2.0,v201,v203
v_fmac_f32 v203,-2.0,v201
M a[56:59],a[192:195],a[228:231],a[56:59]
v_cvt_pk_bf16_f32 v193,v232,v193
v_cvt_pk_bf16_f32 v195,v237,v195
M a[60:63],a[192:195],v[220:223],a[60:63]
buffer_load_dwordx4 a[192:195],v250,s[20:23],s47 offen offset:1024 sc1
M a[60:63],a[200:203],a[228:231],a[60:63]
v_cvt_pk_bf16_f32 v197,v233,v197
v_cvt_pk_bf16_f32 v201,v234,v199
M a[60:63],a[248:251],v[228:231],a[60:63]
s_waitcnt vmcnt(10)
buffer_load_dwordx4 a[200:203],v250,s[20:23],s47 offen offset:2048 sc1
M a[64:67],v[224:227],a[212:215],a[64:67]
s_waitcnt vmcnt(10)
s_add_u32 s48,s73,24576
v_cvt_pk_bf16_f32 v199,v238,v235
v_cvt_pk_bf16_f32 v203,v236,v203
M a[64:67],a[224:227],a[244:247],a[64:67]
s_waitcnt vmcnt(9)
M a[64:67],a[236:239],a[252:255],a[64:67]
ds_write2st64_b64 v247,v[192:193],v[194:195] offset0:204 offset1:221
M a[68:71],a[236:239],a[220:223],a[68:71]
s_add_u32 s28,s68,7077888
buffer_load_dwordx4 a[248:251],v250,s[20:23],s48 offen offset:0 sc1
M a[68:71],a[224:227],a[252:255],a[68:71]
M a[68:71],v[224:227],a[244:247],a[68:71]
ds_write2st64_b64 v247,v[196:197],v[198:199] offset0:34 offset1:51
M a[72:75],v[224:227],a[252:255],a[72:75]
buffer_load_dwordx4 a[212:215],v250,s[20:23],s48 offen offset:1024 sc1
M a[72:75],a[224:227],a[220:223],a[72:75]
M a[72:75],a[236:239],a[208:211],a[72:75]
ds_write2st64_b64 v247,v[200:201],v[202:203] offset0:68 offset1:85
M a[76:79],a[236:239],a[232:235],a[76:79]
buffer_load_dwordx4 a[244:247],v250,s[20:23],s48 offen offset:2048 sc1
M a[76:79],a[224:227],a[208:211],a[76:79]
s_add_u32 s46,s73,27648
M a[76:79],v[224:227],a[220:223],a[76:79]
M a[80:83],v[224:227],a[208:211],a[80:83]
s_waitcnt vmcnt(9)
v_permlane32_swap_b32 v208,v210
v_permlane32_swap_b32 v204,v206
M a[80:83],a[224:227],a[232:235],a[80:83]
buffer_load_dwordx4 a[252:255],v250,s[20:23],s46 offen offset:0 sc1
M a[80:83],a[236:239],a[204:207],a[80:83]
s_waitcnt vmcnt(9)
v_permlane32_swap_b32 v212,v214
v_lshlrev_b32 v234,16,v210
M a[84:87],a[236:239],v[228:231],a[84:87]
v_lshlrev_b32 v232,16,v204
v_lshlrev_b32 v233,16,v208
M a[84:87],a[224:227],a[204:207],a[84:87]
ds_read_b128 a[220:223],v248 offset:8704
v_lshlrev_b32 v237,16,v206
M a[84:87],v[224:227],a[232:235],a[84:87]
buffer_load_dwordx4 v[192:195],v251,s[88:91],s28 offen offset:0
M a[88:91],v[224:227],a[204:207],a[88:91]
ds_read_b128 a[208:211],v249 offset:8704
ds_read_b128 a[232:235],v248 offset:9216
M a[88:91],a[224:227],v[228:231],a[88:91]
ds_read_b128 a[204:207],v249 offset:9216
v_lshlrev_b32 v236,16,v214
M a[88:91],a[236:239],a[228:231],a[88:91]
v_lshlrev_b32 v235,16,v212
v_fmac_f32 v232,s43,v234
M a[92:95],a[236:239],v[220:223],a[92:95]
buffer_load_dwordx4 v[196:199],v245,s[8:11],s28 offen offset:0
M a[92:95],a[224:227],a[228:231],a[92:95]
v_fmac_f32 v237,4.0,v233
v_fma_f32 v238,-4.0,v234,v236
M a[92:95],v[224:227],v[228:231],a[92:95]
s_waitcnt lgkmcnt(3)
v_fmac_f32 v232,s45,v236
v_fmac_f32 v237,s41,v235
M a[96:99],v[216:219],a[220:223],a[96:99]
s_waitcnt vmcnt(10) lgkmcnt(2)
ds_read_b128 a[236:239],v248 offset:9728
v_sub_f32 v236,v236,v234
M a[96:99],a[240:243],a[208:211],a[96:99]
s_waitcnt vmcnt(9) lgkmcnt(2)
buffer_load_dwordx4 v[200:203],v245,s[8:11],s28 offen offset:768
M a[96:99],a[216:219],a[232:235],a[96:99]
s_waitcnt lgkmcnt(1)
ds_read_b128 v[220:223],v249 offset:9728
v_fma_f32 v234,-4.0,v233,v235
M a[100:103],a[216:219],a[204:207],a[100:103]
v_sub_f32 v235,v235,v233
v_add_f32 v233,v238,v234
M a[100:103],a[240:243],a[232:235],a[100:103]
v_sub_f32 v238,v238,v234
v_fma_f32 v234,2.0,v235,v236
M a[100:103],v[216:219],a[208:211],a[100:103]
v_fmac_f32 v236,-2.0,v235
v_and_b32 v210,s42,v210
M a[104:107],v[216:219],a[232:235],a[104:107]
ds_read_b128 a[224:227],v248 offset:10240
v_and_b32 v204,s42,v204
M a[104:107],a[240:243],a[204:207],a[104:107]
s_waitcnt lgkmcnt(2)
ds_read_b128 a[228:231],v249 offset:10240
v_and_b32 v208,s42,v208
M a[104:107],a[216:219],a[236:239],a[104:107]
s_waitcnt lgkmcnt(2)
v_and_b32 v206,s42,v206
v_and_b32 v214,s42,v214
M a[108:111],a[216:219],v[220:223],a[108:111]
v_and_b32 v212,s42,v212
v_fmac_f32 v204,s43,v210
M a[108:111],a[240:243],a[236:239],a[108:111]
v_fmac_f32 v206,4.0,v208
v_fma_f32 v235,-4.0,v210,v214
M a[108:111],v[216:219],a[204:207],a[108:111]
v_fmac_f32 v204,s45,v214
v_fmac_f32 v206,s41,v212
M a[112:115],v[216:219],a[236:239],a[112:115]
ds_read_b128 v[224:227],v249 offset:10752
v_sub_f32 v214,v214,v210
M a[112:115],a[240:243],v[220:223],a[112:115]
s_waitcnt lgkmcnt(2)
ds_read_b128 v[228:231],v248 offset:10752
v_fma_f32 v210,-4.0,v208,v212
M a[112:115],a[216:219],a[224:227],a[112:115]
s_waitcnt lgkmcnt(2)
v_sub_f32 v212,v212,v208
v_add_f32 v208,v235,v210
M a[116:119],a[216:219],a[228:231],a[116:119]
v_sub_f32 v235,v235,v210
v_fma_f32 v210,2.0,v212,v214
M a[116:119],a[240:243],a[224:227],a[116:119]
v_fmac_f32 v214,-2.0,v212
v_cvt_pk_bf16_f32 v204,v232,v204
M a[116:119],v[216:219],v[220:223],a[116:119]
v_cvt_pk_bf16_f32 v206,v237,v206
v_cvt_pk_bf16_f32 v208,v233,v208
M a[120:123],v[216:219],a[224:227],a[120:123]
v_cvt_pk_bf16_f32 v212,v234,v210
v_cvt_pk_bf16_f32 v210,v238,v235
M a[120:123],a[240:243],a[228:231],a[120:123]
s_waitcnt lgkmcnt(1)
v_cvt_pk_bf16_f32 v214,v236,v214
v_permlane32_swap_b32 v209,v211
M a[120:123],a[216:219],v[224:227],a[120:123]
s_waitcnt lgkmcnt(0)
v_permlane32_swap_b32 v205,v207
v_permlane32_swap_b32 v213,v215
M a[124:127],a[216:219],v[228:231],a[124:127]
buffer_load_dwordx4 a[216:219],v250,s[20:23],s46 offen offset:1024 sc1
M a[124:127],a[240:243],v[224:227],a[124:127]
v_lshlrev_b32 v234,16,v211
v_lshlrev_b32 v232,16,v205
M a[124:127],v[216:219],a[228:231],a[124:127]
s_waitcnt vmcnt(10)
buffer_load_dwordx4 a[240:243],v250,s[20:23],s46 offen offset:2048 sc1
M a[128:131],a[196:199],a[220:223],a[128:131]
s_waitcnt vmcnt(10)
s_add_u32 s47,s73,30720
v_lshlrev_b32 v233,16,v209
v_lshlrev_b32 v237,16,v207
M a[128:131],a[192:195],a[208:211],a[128:131]
s_waitcnt vmcnt(9)
v_lshlrev_b32 v236,16,v215
v_lshlrev_b32 v235,16,v213
M a[128:131],a[200:203],a[232:235],a[128:131]
v_fmac_f32 v232,s43,v234
v_fmac_f32 v237,4.0,v233
M a[132:135],a[200:203],a[204:207],a[132:135]
buffer_load_dwordx4 v[216:219],v250,s[20:23],s47 offen offset:0 sc1
M a[132:135],a[192:195],a[232:235],a[132:135]
v_fma_f32 v238,-4.0,v234,v236
v_fmac_f32 v232,s45,v236
M a[132:135],a[196:199],a[208:211],a[132:135]
v_fmac_f32 v237,s41,v235
v_sub_f32 v236,v236,v234
M a[136:139],a[196:199],a[232:235],a[136:139]
v_fma_f32 v234,-4.0,v233,v235
v_sub_f32 v235,v235,v233
M a[136:139],a[192:195],a[204:207],a[136:139]
v_add_f32 v233,v238,v234
v_sub_f32 v238,v238,v234
M a[136:139],a[200:203],a[236:239],a[136:139]
v_fma_f32 v234,2.0,v235,v236
v_fmac_f32 v236,-2.0,v235
M a[140:143],a[200:203],v[220:223],a[140:143]
v_and_b32 v211,s42,v211
v_and_b32 v205,s42,v205
M a[140:143],a[192:195],a[236:239],a[140:143]
v_and_b32 v209,s42,v209
v_and_b32 v207,s42,v207
M a[140:143],a[196:199],a[204:207],a[140:143]
v_and_b32 v215,s42,v215
v_and_b32 v213,s42,v213
M a[144:147],a[196:199],a[236:239],a[144:147]
v_fmac_f32 v205,s43,v211
v_fmac_f32 v207,4.0,v209
M a[144:147],a[192:195],v[220:223],a[144:147]
v_fma_f32 v235,-4.0,v211,v215
v_fmac_f32 v205,s45,v215
M a[144:147],a[200:203],a[224:227],a[144:147]
v_fmac_f32 v207,s41,v213
v_sub_f32 v215,v215,v211
M a[148:151],a[200:203],a[228:231],a[148:151]
v_fma_f32 v211,-4.0,v209,v213
v_sub_f32 v213,v213,v209
M a[148:151],a[192:195],a[224:227],a[148:151]
v_add_f32 v209,v235,v211
v_sub_f32 v235,v235,v211
M a[148:151],a[196:199],v[220:223],a[148:151]
v_fma_f32 v211,2.0,v213,v215
v_fmac_f32 v215,-2.0,v213
M a[152:155],a[196:199],a[224:227],a[152:155]
v_cvt_pk_bf16_f32 v205,v232,v205
v_cvt_pk_bf16_f32 v207,v237,v207
M a[152:155],a[192:195],a[228:231],a[152:155]
v_cvt_pk_bf16_f32 v209,v233,v209
v_cvt_pk_bf16_f32 v213,v234,v211
M a[152:155],a[200:203],v[224:227],a[152:155]
v_cvt_pk_bf16_f32 v211,v238,v235
v_cvt_pk_bf16_f32 v215,v236,v215
M a[156:159],a[200:203],v[228:231],a[156:159]
buffer_load_dwordx4 a[200:203],v250,s[20:23],s47 offen offset:1024 sc1
M a[156:159],a[192:195],v[224:227],a[156:159]
v_fmac_f32 v239,s43,v241
v_fmac_f32 v244,4.0,v240
M a[156:159],a[196:199],a[228:231],a[156:159]
s_waitcnt vmcnt(10)
buffer_load_dwordx4 a[192:195],v250,s[20:23],s47 offen offset:2048 sc1
M a[160:163],a[248:251],a[220:223],a[160:163]
s_waitcnt vmcnt(10)
s_add_u32 s48,s73,33792
v_fma_f32 v232,-4.0,v241,v243
v_fmac_f32 v239,s45,v243
M a[160:163],a[212:215],a[208:211],a[160:163]
s_waitcnt vmcnt(9)
v_fmac_f32 v244,s41,v242
v_sub_f32 v243,v243,v241
M a[160:163],a[244:247],a[232:235],a[160:163]
ds_write2st64_b64 v247,v[204:205],v[206:207] offset0:205 offset1:222
M a[164:167],a[244:247],a[204:207],a[164:167]
s_add_u32 s28,s68,7471104
buffer_load_dwordx4 a[196:199],v250,s[20:23],s48 offen offset:0 sc1
M a[164:167],a[212:215],a[232:235],a[164:167]
v_fma_f32 v241,-4.0,v240,v242
v_sub_f32 v242,v242,v240
M a[164:167],a[248:251],a[208:211],a[164:167]
ds_write2st64_b64 v247,v[208:209],v[210:211] offset0:35 offset1:52
M a[168:171],a[248:251],a[232:235],a[168:171]
buffer_load_dwordx4 a[220:223],v250,s[20:23],s48 offen offset:1024 sc1
M a[168:171],a[212:215],a[204:207],a[168:171]
v_add_f32 v240,v232,v241
v_sub_f32 v232,v232,v241
M a[168:171],a[244:247],a[236:239],a[168:171]
ds_write2st64_b64 v247,v[212:213],v[214:215] offset0:69 offset1:86
M a[172:175],a[244:247],v[220:223],a[172:175]
buffer_load_dwordx4 a[208:211],v250,s[20:23],s48 offen offset:2048 sc1
M a[172:175],a[212:215],a[236:239],a[172:175]
s_add_u32 s46,s73,36864
v_fma_f32 v241,2.0,v242,v243
v_fmac_f32 v243,-2.0,v242
M a[172:175],a[248:251],a[204:207],a[172:175]
v_cvt_pk_bf16_f32 v233,v239,v244
v_cvt_pk_bf16_f32 v234,v240,v232
M a[176:179],a[248:251],a[236:239],a[176:179]
v_cvt_pk_bf16_f32 v235,v241,v243
v_add_u32 v232,104448,v252
M a[176:179],a[212:215],v[220:223],a[176:179]
buffer_load_dwordx4 a[232:235],v250,s[20:23],s46 offen offset:0 sc1
M a[176:179],a[244:247],a[224:227],a[176:179]
ds_write_b16 v232,v233 offset:0
M a[180:183],a[244:247],a[228:231],a[180:183]
ds_write_b16_d16_hi v232,v233 offset:8704
M a[180:183],a[212:215],a[224:227],a[180:183]
ds_write_b16 v252,v234 offset:17408
M a[180:183],a[248:251],v[220:223],a[180:183]
buffer_load_dwordx4 v[204:207],v251,s[88:91],s28 offen offset:0
v_add_u32 v248,0x4400,v248
v_add_u32 v249,0x4400,v249
M a[184:187],a[248:251],a[224:227],a[184:187]
ds_read_b128 a[204:207],v248 offset:52224
ds_read_b128 a[236:239],v249 offset:52224
M a[184:187],a[212:215],a[228:231],a[184:187]
ds_read_b128 v[220:223],v248 offset:52736
ds_read_b128 a[224:227],v249 offset:52736
M a[184:187],a[244:247],v[224:227],a[184:187]
ds_write_b16_d16_hi v252,v234 offset:26112
M a[188:191],a[244:247],v[228:231],a[188:191]
buffer_load_dwordx4 v[208:211],v245,s[8:11],s28 offen offset:0
M a[188:191],a[212:215],v[224:227],a[188:191]
ds_write_b16 v252,v235 offset:34816
M a[188:191],a[248:251],a[228:231],a[188:191]
s_waitcnt vmcnt(14) lgkmcnt(5)
ds_write_b16_d16_hi v252,v235 offset:43520
M v[0:3],a[252:255],a[204:207],v[0:3]
s_waitcnt vmcnt(10) lgkmcnt(5)
ds_read_b128 a[244:247],v248 offset:53248
v_permlane32_swap_b32 v196,v198
M v[0:3],a[216:219],a[236:239],v[0:3]
s_waitcnt vmcnt(9) lgkmcnt(5)
buffer_load_dwordx4 v[212:215],v245,s[8:11],s28 offen offset:768
M v[0:3],a[240:243],v[220:223],v[0:3]
s_waitcnt lgkmcnt(4)
s_add_u32 s29,s69,6291456
ds_read_b128 v[228:231],v249 offset:53248
v_permlane32_swap_b32 v192,v194
M v[4:7],a[240:243],a[224:227],v[4:7]
v_permlane32_swap_b32 v200,v202
v_lshlrev_b32 v234,16,v198
M v[4:7],a[216:219],v[220:223],v[4:7]
v_lshlrev_b32 v232,16,v192
v_lshlrev_b32 v233,16,v196
M v[4:7],a[252:255],a[236:239],v[4:7]
buffer_load_short_d16_hi v239,v246,s[12:15],s29 offen offset:0
M v[8:11],a[252:255],v[220:223],v[8:11]
ds_read_b128 a[212:215],v248 offset:53760
v_lshlrev_b32 v237,16,v194
M v[8:11],a[216:219],a[224:227],v[8:11]
s_waitcnt lgkmcnt(2)
buffer_load_short_d16_hi v240,v246,s[8:11],s29 offen offset:0
M v[8:11],a[240:243],a[244:247],v[8:11]
s_waitcnt lgkmcnt(1)
ds_read_b128 v[224:227],v249 offset:53760
v_lshlrev_b32 v236,16,v202
M v[12:15],a[240:243],v[228:231],v[12:15]
buffer_load_short_d16_hi v241,v246,s[8:11],s29 offen offset:384
M v[12:15],a[216:219],a[244:247],v[12:15]
v_lshlrev_b32 v235,16,v200
v_fmac_f32 v232,s43,v234
M v[12:15],a[252:255],a[224:227],v[12:15]
buffer_load_short_d16_hi v242,v246,s[8:11],s29 offen offset:768
M v[16:19],a[252:255],a[244:247],v[16:19]
ds_read_b128 a[228:231],v249 offset:54272
v_fmac_f32 v237,4.0,v233
M v[16:19],a[216:219],v[228:231],v[16:19]
s_waitcnt lgkmcnt(2)
buffer_load_short_d16_hi v243,v246,s[8:11],s29 offen offset:1152
M v[16:19],a[240:243],a[212:215],v[16:19]
s_waitcnt lgkmcnt(1)
ds_read_b128 a[248:251],v248 offset:54272
v_fma_f32 v238,-4.0,v234,v236
M v[20:23],a[240:243],v[224:227],v[20:23]
buffer_load_short_d16_hi v244,v246,s[16:19],s29 offen offset:1536
M v[20:23],a[216:219],a[212:215],v[20:23]
v_fmac_f32 v232,s45,v236
v_fmac_f32 v237,s41,v235
M v[20:23],a[252:255],v[228:231],v[20:23]
v_sub_f32 v236,v236,v234
v_fma_f32 v234,-4.0,v233,v235
M v[24:27],a[252:255],a[212:215],v[24:27]
v_sub_f32 v235,v235,v233
v_add_f32 v233,v238,v234
M v[24:27],a[216:219],v[224:227],v[24:27]
s_waitcnt lgkmcnt(1)
v_sub_f32 v238,v238,v234
v_fma_f32 v234,2.0,v235,v236
M v[24:27],a[240:243],a[228:231],v[24:27]
s_waitcnt lgkmcnt(0)
v_fmac_f32 v236,-2.0,v235
v_and_b32 v198,s42,v198
M v[28:31],a[240:243],a[248:251],v[28:31]
buffer_load_dwordx4 a[240:243],v250,s[20:23],s46 offen offset:1024 sc1
M v[28:31],a[216:219],a[228:231],v[28:31]
v_and_b32 v192,s42,v192
v_and_b32 v196,s42,v196
M v[28:31],a[252:255],v[224:227],v[28:31]
s_waitcnt vmcnt(16)
buffer_load_dwordx4 a[216:219],v250,s[20:23],s46 offen offset:2048 sc1
M v[32:35],v[216:219],a[204:207],v[32:35]
s_waitcnt vmcnt(16)
s_add_u32 s47,s73,39936
v_and_b32 v194,s42,v194
v_and_b32 v202,s42,v202
M v[32:35],a[200:203],a[236:239],v[32:35]
s_waitcnt vmcnt(15)
v_and_b32 v200,s42,v200
v_fmac_f32 v192,s43,v198
M v[32:35],a[192:195],v[220:223],v[32:35]
v_fmac_f32 v194,4.0,v196
v_fma_f32 v235,-4.0,v198,v202
M v[36:39],a[192:195],a[224:227],v[36:39]
buffer_load_dwordx4 a[252:255],v250,s[20:23],s47 offen offset:0 sc1
M v[36:39],a[200:203],v[220:223],v[36:39]
v_fmac_f32 v192,s45,v202
v_fmac_f32 v194,s41,v200
M v[36:39],v[216:219],a[236:239],v[36:39]
v_sub_f32 v202,v202,v198
v_fma_f32 v198,-4.0,v196,v200
M v[40:43],v[216:219],v[220:223],v[40:43]
v_sub_f32 v200,v200,v196
v_add_f32 v196,v235,v198
M v[40:43],a[200:203],a[224:227],v[40:43]
v_sub_f32 v235,v235,v198
v_fma_f32 v198,2.0,v200,v202
M v[40:43],a[192:195],a[244:247],v[40:43]
v_fmac_f32 v202,-2.0,v200
v_cvt_pk_bf16_f32 v192,v232,v192
M v[44:47],a[192:195],v[228:231],v[44:47]
v_cvt_pk_bf16_f32 v194,v237,v194
v_cvt_pk_bf16_f32 v196,v233,v196
M v[44:47],a[200:203],a[244:247],v[44:47]
v_cvt_pk_bf16_f32 v200,v234,v198
v_cvt_pk_bf16_f32 v198,v238,v235
M v[44:47],v[216:219],a[224:227],v[44:47]
v_cvt_pk_bf16_f32 v202,v236,v202
v_permlane32_swap_b32 v197,v199
M v[48:51],v[216:219],a[244:247],v[48:51]
v_permlane32_swap_b32 v193,v195
v_permlane32_swap_b32 v201,v203
M v[48:51],a[200:203],v[228:231],v[48:51]
v_lshlrev_b32 v234,16,v199
v_lshlrev_b32 v232,16,v193
M v[48:51],a[192:195],a[212:215],v[48:51]
v_lshlrev_b32 v233,16,v197
v_lshlrev_b32 v237,16,v195
M v[52:55],a[192:195],v[224:227],v[52:55]
v_lshlrev_b32 v236,16,v203
v_lshlrev_b32 v235,16,v201
M v[52:55],a[200:203],a[212:215],v[52:55]
v_fmac_f32 v232,s43,v234
v_fmac_f32 v237,4.0,v233
M v[52:55],v[216:219],v[228:231],v[52:55]
v_fma_f32 v238,-4.0,v234,v236
v_fmac_f32 v232,s45,v236
M v[56:59],v[216:219],a[212:215],v[56:59]
v_fmac_f32 v237,s41,v235
v_sub_f32 v236,v236,v234
M v[56:59],a[200:203],v[224:227],v[56:59]
v_fma_f32 v234,-4.0,v233,v235
v_sub_f32 v235,v235,v233
M v[56:59],a[192:195],a[228:231],v[56:59]
v_add_f32 v233,v238,v234
v_sub_f32 v238,v238,v234
M v[60:63],a[192:195],a[248:251],v[60:63]
buffer_load_dwordx4 a[192:195],v250,s[20:23],s47 offen offset:1024 sc1
M v[60:63],a[200:203],a[228:231],v[60:63]
v_fma_f32 v234,2.0,v235,v236
v_fmac_f32 v236,-2.0,v235
M v[60:63],v[216:219],v[224:227],v[60:63]
s_waitcnt vmcnt(16)
buffer_load_dwordx4 a[200:203],v250,s[20:23],s47 offen offset:2048 sc1
M v[64:67],a[196:199],a[204:207],v[64:67]
s_waitcnt vmcnt(16)
s_add_u32 s48,s73,43008
v_and_b32 v199,s42,v199
v_and_b32 v193,s42,v193
M v[64:67],a[220:223],a[236:239],v[64:67]
s_waitcnt vmcnt(15)
v_and_b32 v197,s42,v197
v_and_b32 v195,s42,v195
M v[64:67],a[208:211],v[220:223],v[64:67]
v_and_b32 v203,s42,v203
v_and_b32 v201,s42,v201
M v[68:71],a[208:211],a[224:227],v[68:71]
buffer_load_dwordx4 v[216:219],v250,s[20:23],s48 offen offset:0 sc1
M v[68:71],a[220:223],v[220:223],v[68:71]
v_fmac_f32 v193,s43,v199
v_fmac_f32 v195,4.0,v197
M v[68:71],a[196:199],a[236:239],v[68:71]
v_fma_f32 v235,-4.0,v199,v203
v_fmac_f32 v193,s45,v203
M v[72:75],a[196:199],v[220:223],v[72:75]
v_fmac_f32 v195,s41,v201
v_sub_f32 v203,v203,v199
M v[72:75],a[220:223],a[224:227],v[72:75]
buffer_load_dwordx4 a[204:207],v250,s[20:23],s48 offen offset:1024 sc1
M v[72:75],a[208:211],a[244:247],v[72:75]
v_fma_f32 v199,-4.0,v197,v201
v_sub_f32 v201,v201,v197
M v[76:79],a[208:211],v[228:231],v[76:79]
v_add_f32 v197,v235,v199
v_sub_f32 v235,v235,v199
M v[76:79],a[220:223],a[244:247],v[76:79]
v_fma_f32 v199,2.0,v201,v203
v_fmac_f32 v203,-2.0,v201
M v[76:79],a[196:199],a[224:227],v[76:79]
buffer_load_dwordx4 a[236:239],v250,s[20:23],s48 offen offset:2048 sc1
M v[80:83],a[196:199],a[244:247],v[80:83]
s_add_u32 s46,s74,9216
v_cvt_pk_bf16_f32 v193,v232,v193
v_cvt_pk_bf16_f32 v195,v237,v195
M v[80:83],a[220:223],v[228:231],v[80:83]
v_cvt_pk_bf16_f32 v197,v233,v197
v_cvt_pk_bf16_f32 v201,v234,v199
M v[80:83],a[208:211],a[212:215],v[80:83]
v_cvt_pk_bf16_f32 v199,v238,v235
v_cvt_pk_bf16_f32 v203,v236,v203
M v[84:87],a[208:211],v[224:227],v[84:87]
buffer_load_dwordx4 v[220:223],v250,s[20:23],s46 offen offset:0 sc1
M v[84:87],a[220:223],a[212:215],v[84:87]
s_waitcnt vmcnt(16)
ds_read_b128 a[224:227],v248 offset:60928
v_permlane32_swap_b32 v208,v210
M v[84:87],a[196:199],v[228:231],v[84:87]
ds_write2st64_b64 v247,v[192:193],v[194:195] offset0:206 offset1:223
M v[88:91],a[196:199],a[212:215],v[88:91]
s_add_u32 s28,s69,6291456
ds_read_b128 a[244:247],v249 offset:60928
ds_read_b128 v[228:231],v248 offset:61440
M v[88:91],a[220:223],v[224:227],v[88:91]
buffer_load_dwordx4 v[192:195],v251,s[88:91],s28 offen offset:0
M v[88:91],a[208:211],a[228:231],v[88:91]
ds_write2st64_b64 v247,v[196:197],v[198:199] offset0:36 offset1:53
M v[92:95],a[208:211],a[248:251],v[92:95]
ds_read_b128 a[212:215],v249 offset:61440
v_permlane32_swap_b32 v204,v206
M v[92:95],a[220:223],a[228:231],v[92:95]
buffer_load_dwordx4 v[196:199],v245,s[8:11],s28 offen offset:0
M v[92:95],a[196:199],v[224:227],v[92:95]
s_waitcnt lgkmcnt(5)
ds_write2st64_b64 v247,v[200:201],v[202:203] offset0:70 offset1:87
M v[96:99],a[232:235],a[224:227],v[96:99]
s_waitcnt vmcnt(10) lgkmcnt(4)
ds_read_b128 a[208:211],v248 offset:61952
v_permlane32_swap_b32 v212,v214
M v[96:99],a[240:243],a[244:247],v[96:99]
s_waitcnt vmcnt(9) lgkmcnt(4)
buffer_load_dwordx4 v[200:203],v245,s[8:11],s28 offen offset:768
M v[96:99],a[216:219],v[228:231],v[96:99]
s_waitcnt lgkmcnt(2)
ds_read_b128 a[248:251],v249 offset:61952
v_lshlrev_b32 v234,16,v210
M v[100:103],a[216:219],a[212:215],v[100:103]
v_lshlrev_b32 v232,16,v204
v_lshlrev_b32 v233,16,v208
M v[100:103],a[240:243],v[228:231],v[100:103]
v_lshlrev_b32 v237,16,v206
v_lshlrev_b32 v236,16,v214
M v[100:103],a[232:235],a[244:247],v[100:103]
v_lshlrev_b32 v235,16,v212
v_fmac_f32 v232,s43,v234
M v[104:107],a[232:235],v[228:231],v[104:107]
ds_read_b128 a[220:223],v248 offset:62464
v_fmac_f32 v237,4.0,v233
M v[104:107],a[240:243],a[212:215],v[104:107]
s_waitcnt lgkmcnt(2)
ds_read_b128 a[228:231],v249 offset:62464
v_fma_f32 v238,-4.0,v234,v236
M v[104:107],a[216:219],a[208:211],v[104:107]
s_waitcnt lgkmcnt(2)
v_fmac_f32 v232,s45,v236
v_fmac_f32 v237,s41,v235
M v[108:111],a[216:219],a[248:251],v[108:111]
v_sub_f32 v236,v236,v234
v_fma_f32 v234,-4.0,v233,v235
M v[108:111],a[240:243],a[208:211],v[108:111]
v_sub_f32 v235,v235,v233
v_add_f32 v233,v238,v234
M v[108:111],a[232:235],a[212:215],v[108:111]
v_sub_f32 v238,v238,v234
v_fma_f32 v234,2.0,v235,v236
M v[112:115],a[232:235],a[208:211],v[112:115]
ds_read_b128 a[196:199],v249 offset:62976
v_fmac_f32 v236,-2.0,v235
M v[112:115],a[240:243],a[248:251],v[112:115]
s_waitcnt lgkmcnt(2)
ds_read_b128 v[224:227],v248 offset:62976
v_and_b32 v210,s42,v210
M v[112:115],a[216:219],a[220:223],v[112:115]
s_waitcnt lgkmcnt(2)
v_and_b32 v204,s42,v204
v_and_b32 v208,s42,v208
M v[116:119],a[216:219],a[228:231],v[116:119]
v_and_b32 v206,s42,v206
v_and_b32 v214,s42,v214
M v[116:119],a[240:243],a[220:223],v[116:119]
v_and_b32 v212,s42,v212
v_fmac_f32 v204,s43,v210
M v[116:119],a[232:235],a[248:251],v[116:119]
v_fmac_f32 v206,4.0,v208
v_fma_f32 v235,-4.0,v210,v214
M v[120:123],a[232:235],a[220:223],v[120:123]
v_fmac_f32 v204,s45,v214
v_fmac_f32 v206,s41,v212
M v[120:123],a[240:243],a[228:231],v[120:123]
s_waitcnt lgkmcnt(1)
v_sub_f32 v214,v214,v210
v_fma_f32 v210,-4.0,v208,v212
M v[120:123],a[216:219],a[196:199],v[120:123]
s_waitcnt lgkmcnt(0)
v_sub_f32 v212,v212,v208
v_add_f32 v208,v235,v210
M v[124:127],a[216:219],v[224:227],v[124:127]
buffer_load_dwordx4 a[216:219],v250,s[20:23],s46 offen offset:1024 sc1
M v[124:127],a[240:243],a[196:199],v[124:127]
v_sub_f32 v235,v235,v210
v_fma_f32 v210,2.0,v212,v214
M v[124:127],a[232:235],a[228:231],v[124:127]
s_waitcnt vmcnt(10)
buffer_load_dwordx4 a[240:243],v250,s[20:23],s46 offen offset:2048 sc1
M v[128:131],a[252:255],a[224:227],v[128:131]
s_waitcnt vmcnt(10)
s_add_u32 s47,s74,12288
v_fmac_f32 v214,-2.0,v212
v_cvt_pk_bf16_f32 v204,v232,v204
M v[128:131],a[192:195],a[244:247],v[128:131]
s_waitcnt vmcnt(9)
v_cvt_pk_bf16_f32 v206,v237,v206
v_cvt_pk_bf16_f32 v208,v233,v208
M v[128:131],a[200:203],v[228:231],v[128:131]
v_cvt_pk_bf16_f32 v212,v234,v210
v_cvt_pk_bf16_f32 v210,v238,v235
M v[132:135],a[200:203],a[212:215],v[132:135]
buffer_load_dwordx4 a[232:235],v250,s[20:23],s47 offen offset:0 sc1
M v[132:135],a[192:195],v[228:231],v[132:135]
v_cvt_pk_bf16_f32 v214,v236,v214
v_permlane32_swap_b32 v209,v211
M v[132:135],a[252:255],a[244:247],v[132:135]
v_permlane32_swap_b32 v205,v207
v_permlane32_swap_b32 v213,v215
M v[136:139],a[252:255],v[228:231],v[136:139]
v_lshlrev_b32 v234,16,v211
v_lshlrev_b32 v232,16,v205
M v[136:139],a[192:195],a[212:215],v[136:139]
v_lshlrev_b32 v233,16,v209
v_lshlrev_b32 v237,16,v207
M v[136:139],a[200:203],a[208:211],v[136:139]
v_lshlrev_b32 v236,16,v215
v_lshlrev_b32 v235,16,v213
M v[140:143],a[200:203],a[248:251],v[140:143]
v_fmac_f32 v232,s43,v234
v_fmac_f32 v237,4.0,v233
M v[140:143],a[192:195],a[208:211],v[140:143]
v_fma_f32 v238,-4.0,v234,v236
v_fmac_f32 v232,s45,v236
M v[140:143],a[252:255],a[212:215],v[140:143]
v_fmac_f32 v237,s41,v235
v_sub_f32 v236,v236,v234
M v[144:147],a[252:255],a[208:211],v[144:147]
v_fma_f32 v234,-4.0,v233,v235
v_sub_f32 v235,v235,v233
M v[144:147],a[192:195],a[248:251],v[144:147]
v_add_f32 v233,v238,v234
v_sub_f32 v238,v238,v234
M v[144:147],a[200:203],a[220:223],v[144:147]
v_fma_f32 v234,2.0,v235,v236
v_fmac_f32 v236,-2.0,v235
M v[148:151],a[200:203],a[228:231],v[148:151]
v_and_b32 v211,s42,v211
v_and_b32 v205,s42,v205
M v[148:151],a[192:195],a[220:223],v[148:151]
v_and_b32 v209,s42,v209
v_and_b32 v207,s42,v207
M v[148:151],a[252:255],a[248:251],v[148:151]
v_and_b32 v215,s42,v215
v_and_b32 v213,s42,v213
M v[152:155],a[252:255],a[220:223],v[152:155]
v_fmac_f32 v205,s43,v211
v_fmac_f32 v207,4.0,v209
M v[152:155],a[192:195],a[228:231],v[152:155]
v_fma_f32 v235,-4.0,v211,v215
v_fmac_f32 v205,s45,v215
M v[152:155],a[200:203],a[196:199],v[152:155]
v_fmac_f32 v207,s41,v213
v_sub_f32 v215,v215,v211
M v[156:159],a[200:203],v[224:227],v[156:159]
buffer_load_dwordx4 a[200:203],v250,s[20:23],s47 offen offset:1024 sc1
M v[156:159],a[192:195],a[196:199],v[156:159]
v_fma_f32 v211,-4.0,v209,v213
v_sub_f32 v213,v213,v209
M v[156:159],a[252:255],a[228:231],v[156:159]
s_waitcnt vmcnt(10)
buffer_load_dwordx4 a[192:195],v250,s[20:23],s47 offen offset:2048 sc1
M v[160:163],v[216:219],a[224:227],v[160:163]
s_waitcnt vmcnt(10)
s_add_u32 s48,s74,15360
v_add_f32 v209,v235,v211
v_sub_f32 v235,v235,v211
M v[160:163],a[204:207],a[244:247],v[160:163]
s_waitcnt vmcnt(9)
v_fma_f32 v211,2.0,v213,v215
v_fmac_f32 v215,-2.0,v213
M v[160:163],a[236:239],v[228:231],v[160:163]
v_cvt_pk_bf16_f32 v205,v232,v205
v_cvt_pk_bf16_f32 v207,v237,v207
M v[164:167],a[236:239],a[212:215],v[164:167]
buffer_load_dwordx4 a[252:255],v250,s[20:23],s48 offen offset:0 sc1
v_cvt_pk_bf16_f32 v209,v233,v209
v_cvt_pk_bf16_f32 v213,v234,v211
v_cvt_pk_bf16_f32 v211,v238,v235
M v[164:167],a[204:207],v[228:231],v[164:167]
s_waitcnt vmcnt(7)
v_cvt_pk_bf16_f32 v215,v236,v215
v_permlane32_swap_b32 v196,v198
M v[164:167],v[216:219],a[244:247],v[164:167]
ds_write2st64_b64 v247,v[204:205],v[206:207] offset0:207 offset1:224
M v[168:171],v[216:219],v[228:231],v[168:171]
s_add_u32 s28,s69,6684672
buffer_load_dwordx4 a[224:227],v250,s[20:23],s48 offen offset:1024 sc1
M v[168:171],a[204:207],a[212:215],v[168:171]
s_waitcnt vmcnt(7)
v_permlane32_swap_b32 v192,v194
v_permlane32_swap_b32 v200,v202
M v[168:171],a[236:239],a[208:211],v[168:171]
ds_write2st64_b64 v247,v[208:209],v[210:211] offset0:37 offset1:54
M v[172:175],a[236:239],a[248:251],v[172:175]
buffer_load_dwordx4 a[244:247],v250,s[20:23],s48 offen offset:2048 sc1
M v[172:175],a[204:207],a[208:211],v[172:175]
s_add_u32 s46,s74,18432
v_lshlrev_b32 v234,16,v198
v_lshlrev_b32 v232,16,v192
M v[172:175],v[216:219],a[212:215],v[172:175]
ds_write2st64_b64 v247,v[212:213],v[214:215] offset0:71 offset1:88
M v[176:179],v[216:219],a[208:211],v[176:179]
buffer_load_dwordx4 v[228:231],v250,s[20:23],s46 offen offset:0 sc1
M v[176:179],a[204:207],a[248:251],v[176:179]
v_lshlrev_b32 v233,16,v196
v_lshlrev_b32 v237,16,v194
M v[176:179],a[236:239],a[220:223],v[176:179]
s_waitcnt lgkmcnt(0)
s_barrier
v_lshlrev_b32 v236,16,v202
M v[180:183],a[236:239],a[228:231],v[180:183]
v_lshlrev_b32 v235,16,v200
v_fmac_f32 v232,s43,v234
M v[180:183],a[204:207],a[220:223],v[180:183]
buffer_load_dwordx4 v[204:207],v251,s[88:91],s28 offen offset:0
M v[180:183],v[216:219],a[248:251],v[180:183]
ds_read_b128 a[212:215],v248 offset:0
ds_read_b128 a[208:211],v249 offset:0
M v[184:187],v[216:219],a[220:223],v[184:187]
ds_read_b128 a[248:251],v248 offset:512
v_fmac_f32 v237,4.0,v233
M v[184:187],a[204:207],a[228:231],v[184:187]
ds_read_b128 a[220:223],v249 offset:512
v_fma_f32 v238,-4.0,v234,v236
M v[184:187],a[236:239],a[196:199],v[184:187]
buffer_load_dwordx4 v[208:211],v245,s[8:11],s28 offen offset:0
M v[188:191],a[236:239],v[224:227],v[188:191]
v_fmac_f32 v232,s45,v236
v_fmac_f32 v237,s41,v235
M v[188:191],a[204:207],a[196:199],v[188:191]
v_sub_f32 v236,v236,v234
v_fma_f32 v234,-4.0,v233,v235
M v[188:191],v[216:219],a[228:231],v[188:191]
s_waitcnt lgkmcnt(3)
v_sub_f32 v235,v235,v233
v_add_f32 v233,v238,v234
M a[0:3],v[220:223],a[212:215],a[0:3]
s_waitcnt vmcnt(10) lgkmcnt(2)
buffer_load_dwordx4 v[212:215],v245,s[8:11],s28 offen offset:768
M a[0:3],a[216:219],a[208:211],a[0:3]
s_waitcnt vmcnt(10) lgkmcnt(1)
ds_read_b128 a[236:239],v248 offset:1024
ds_read_b128 v[224:227],v249 offset:1024
M a[0:3],a[240:243],a[248:251],a[0:3]
s_waitcnt lgkmcnt(2)
v_sub_f32 v238,v238,v234
v_fma_f32 v234,2.0,v235,v236
M a[4:7],a[240:243],a[220:223],a[4:7]
v_fmac_f32 v236,-2.0,v235
v_and_b32 v198,s42,v198
M a[4:7],a[216:219],a[248:251],a[4:7]
v_and_b32 v192,s42,v192
v_and_b32 v196,s42,v196
M a[4:7],v[220:223],a[208:211],a[4:7]
v_and_b32 v194,s42,v194
v_and_b32 v202,s42,v202
M a[8:11],v[220:223],a[248:251],a[8:11]
ds_read_b128 a[196:199],v248 offset:1536
v_and_b32 v200,s42,v200
M a[8:11],a[216:219],a[220:223],a[8:11]
s_waitcnt lgkmcnt(2)
ds_read_b128 a[204:207],v249 offset:1536
v_fmac_f32 v192,s43,v198
M a[8:11],a[240:243],a[236:239],a[8:11]
s_waitcnt lgkmcnt(2)
v_fmac_f32 v194,4.0,v196
v_fma_f32 v235,-4.0,v198,v202
M a[12:15],a[240:243],v[224:227],a[12:15]
v_fmac_f32 v192,s45,v202
v_fmac_f32 v194,s41,v200
M a[12:15],a[216:219],a[236:239],a[12:15]
v_sub_f32 v202,v202,v198
v_fma_f32 v198,-4.0,v196,v200
M a[12:15],v[220:223],a[220:223],a[12:15]
v_sub_f32 v200,v200,v196
v_add_f32 v196,v235,v198
M a[16:19],v[220:223],a[236:239],a[16:19]
ds_read_b128 a[228:231],v249 offset:2048
v_sub_f32 v235,v235,v198
M a[16:19],a[216:219],v[224:227],a[16:19]
s_waitcnt lgkmcnt(2)
ds_read_b128 v[216:219],v248 offset:2048
v_fma_f32 v198,2.0,v200,v202
M a[16:19],a[240:243],a[196:199],a[16:19]
s_waitcnt lgkmcnt(2)
v_fmac_f32 v202,-2.0,v200
v_cvt_pk_bf16_f32 v192,v232,v192
M a[20:23],a[240:243],a[204:207],a[20:23]
v_cvt_pk_bf16_f32 v194,v237,v194
v_cvt_pk_bf16_f32 v196,v233,v196
M a[20:23],a[216:219],a[196:199],a[20:23]
v_cvt_pk_bf16_f32 v200,v234,v198
v_cvt_pk_bf16_f32 v198,v238,v235
M a[20:23],v[220:223],v[224:227],a[20:23]
v_cvt_pk_bf16_f32 v202,v236,v202
v_permlane32_swap_b32 v197,v199
M a[24:27],v[220:223],a[196:199],a[24:27]
v_permlane32_swap_b32 v193,v195
v_permlane32_swap_b32 v201,v203
M a[24:27],a[216:219],a[204:207],a[24:27]
s_waitcnt lgkmcnt(1)
v_lshlrev_b32 v234,16,v199
v_lshlrev_b32 v232,16,v193
M a[24:27],a[240:243],a[228:231],a[24:27]
s_waitcnt lgkmcnt(0)
v_lshlrev_b32 v233,16,v197
v_lshlrev_b32 v237,16,v195
M a[28:31],a[240:243],v[216:219],a[28:31]
buffer_load_dwordx4 a[240:243],v250,s[20:23],s46 offen offset:1024 sc1
M a[28:31],a[216:219],a[228:231],a[28:31]
v_lshlrev_b32 v236,16,v203
v_lshlrev_b32 v235,16,v201
M a[28:31],v[220:223],a[204:207],a[28:31]
s_waitcnt vmcnt(10)
buffer_load_dwordx4 a[216:219],v250,s[20:23],s46 offen offset:2048 sc1
M a[32:35],a[232:235],a[212:215],a[32:35]
s_waitcnt vmcnt(10)
s_add_u32 s47,s74,21504
v_fmac_f32 v232,s43,v234
v_fmac_f32 v237,4.0,v233
M a[32:35],a[200:203],a[208:211],a[32:35]
s_waitcnt vmcnt(9)
v_fma_f32 v238,-4.0,v234,v236
v_fmac_f32 v232,s45,v236
M a[32:35],a[192:195],a[248:251],a[32:35]
v_fmac_f32 v237,s41,v235
v_sub_f32 v236,v236,v234
M a[36:39],a[192:195],a[220:223],a[36:39]
buffer_load_dwordx4 v[220:223],v250,s[20:23],s47 offen offset:0 sc1
M a[36:39],a[200:203],a[248:251],a[36:39]
v_fma_f32 v234,-4.0,v233,v235
v_sub_f32 v235,v235,v233
M a[36:39],a[232:235],a[208:211],a[36:39]
v_add_f32 v233,v238,v234
v_sub_f32 v238,v238,v234
M a[40:43],a[232:235],a[248:251],a[40:43]
v_fma_f32 v234,2.0,v235,v236
v_fmac_f32 v236,-2.0,v235
M a[40:43],a[200:203],a[220:223],a[40:43]
v_and_b32 v199,s42,v199
v_and_b32 v193,s42,v193
M a[40:43],a[192:195],a[236:239],a[40:43]
v_and_b32 v197,s42,v197
v_and_b32 v195,s42,v195
M a[44:47],a[192:195],v[224:227],a[44:47]
v_and_b32 v203,s42,v203
v_and_b32 v201,s42,v201
M a[44:47],a[200:203],a[236:239],a[44:47]
v_fmac_f32 v193,s43,v199
v_fmac_f32 v195,4.0,v197
M a[44:47],a[232:235],a[220:223],a[44:47]
v_fma_f32 v235,-4.0,v199,v203
v_fmac_f32 v193,s45,v203
M a[48:51],a[232:235],a[236:239],a[48:51]
v_fmac_f32 v195,s41,v201
v_sub_f32 v203,v203,v199
M a[48:51],a[200:203],v[224:227],a[48:51]
v_fma_f32 v199,-4.0,v197,v201
v_sub_f32 v201,v201,v197
M a[48:51],a[192:195],a[196:199],a[48:51]
v_add_f32 v197,v235,v199
v_sub_f32 v235,v235,v199
M a[52:55],a[192:195],a[204:207],a[52:55]
v_fma_f32 v199,2.0,v201,v203
v_fmac_f32 v203,-2.0,v201
M a[52:55],a[200:203],a[196:199],a[52:55]
v_cvt_pk_bf16_f32 v193,v232,v193
v_cvt_pk_bf16_f32 v195,v237,v195
M a[52:55],a[232:235],v[224:227],a[52:55]
v_cvt_pk_bf16_f32 v197,v233,v197
v_cvt_pk_bf16_f32 v201,v234,v199
M a[56:59],a[232:235],a[196:199],a[56:59]
v_cvt_pk_bf16_f32 v199,v238,v235
v_cvt_pk_bf16_f32 v203,v236,v203
M a[56:59],a[200:203],a[204:207],a[56:59]
s_waitcnt vmcnt(4)
v_permlane32_swap_b32 v208,v210
v_permlane32_swap_b32 v204,v206
M a[56:59],a[192:195],a[228:231],a[56:59]
ds_write2st64_b64 v247,v[192:193],v[194:195] offset0:238 offset1:255
M a[60:63],a[192:195],v[216:219],a[60:63]
s_add_u32 s28,s69,7077888
buffer_load_dwordx4 a[192:195],v250,s[20:23],s47 offen offset:1024 sc1
M a[60:63],a[200:203],a[228:231],a[60:63]
s_waitcnt vmcnt(4)
v_permlane32_swap_b32 v212,v214
v_lshlrev_b32 v234,16,v210
M a[60:63],a[232:235],a[204:207],a[60:63]
buffer_load_dwordx4 a[200:203],v250,s[20:23],s47 offen offset:2048 sc1
M a[64:67],a[252:255],a[212:215],a[64:67]
s_add_u32 s48,s74,24576
v_lshlrev_b32 v232,16,v204
v_lshlrev_b32 v233,16,v208
M a[64:67],a[224:227],a[208:211],a[64:67]
v_lshlrev_b32 v237,16,v206
v_lshlrev_b32 v236,16,v214
M a[64:67],a[244:247],a[248:251],a[64:67]
ds_write2st64_b64 v247,v[196:197],v[198:199] offset0:0 offset1:17
M a[68:71],a[244:247],a[220:223],a[68:71]
buffer_load_dwordx4 a[232:235],v250,s[20:23],s48 offen offset:0 sc1
M a[68:71],a[224:227],a[248:251],a[68:71]
v_lshlrev_b32 v235,16,v212
v_fmac_f32 v232,s43,v234
M a[68:71],a[252:255],a[208:211],a[68:71]
ds_write2st64_b64 v247,v[200:201],v[202:203] offset0:136 offset1:153
M a[72:75],a[252:255],a[248:251],a[72:75]
buffer_load_dwordx4 a[212:215],v250,s[20:23],s48 offen offset:1024 sc1
M a[72:75],a[224:227],a[220:223],a[72:75]
v_fmac_f32 v237,4.0,v233
v_fma_f32 v238,-4.0,v234,v236
M a[72:75],a[244:247],a[236:239],a[72:75]
v_fmac_f32 v232,s45,v236
v_fmac_f32 v237,s41,v235
M a[76:79],a[244:247],v[224:227],a[76:79]
v_sub_f32 v236,v236,v234
v_fma_f32 v234,-4.0,v233,v235
M a[76:79],a[224:227],a[236:239],a[76:79]
buffer_load_dwordx4 a[208:211],v250,s[20:23],s48 offen offset:2048 sc1
M a[76:79],a[252:255],a[220:223],a[76:79]
s_add_u32 s46,s74,27648
v_sub_f32 v235,v235,v233
v_add_f32 v233,v238,v234
M a[80:83],a[252:255],a[236:239],a[80:83]
v_sub_f32 v238,v238,v234
v_fma_f32 v234,2.0,v235,v236
M a[80:83],a[224:227],v[224:227],a[80:83]
v_fmac_f32 v236,-2.0,v235
v_and_b32 v210,s42,v210
M a[80:83],a[244:247],a[196:199],a[80:83]
buffer_load_dwordx4 a[248:251],v250,s[20:23],s46 offen offset:0 sc1
M a[84:87],a[244:247],a[204:207],a[84:87]
v_and_b32 v204,s42,v204
v_and_b32 v208,s42,v208
M a[84:87],a[224:227],a[196:199],a[84:87]
ds_read_b128 a[220:223],v248 offset:8704
v_and_b32 v206,s42,v206
M a[84:87],a[252:255],v[224:227],a[84:87]
ds_read_b128 a[236:239],v249 offset:8704
v_and_b32 v214,s42,v214
M a[88:91],a[252:255],a[196:199],a[88:91]
buffer_load_dwordx4 v[192:195],v251,s[88:91],s28 offen offset:0
M a[88:91],a[224:227],a[204:207],a[88:91]
ds_read_b128 v[224:227],v248 offset:9216
ds_read_b128 a[196:199],v249 offset:9216
M a[88:91],a[244:247],a[228:231],a[88:91]
v_and_b32 v212,s42,v212
v_fmac_f32 v204,s43,v210
M a[92:95],a[244:247],v[216:219],a[92:95]
v_fmac_f32 v206,4.0,v208
v_fma_f32 v235,-4.0,v210,v214
M a[92:95],a[224:227],a[228:231],a[92:95]
buffer_load_dwordx4 v[196:199],v245,s[8:11],s28 offen offset:0
M a[92:95],a[252:255],a[204:207],a[92:95]
s_waitcnt lgkmcnt(3)
v_fmac_f32 v204,s45,v214
v_fmac_f32 v206,s41,v212
M a[96:99],v[228:231],a[220:223],a[96:99]
s_waitcnt vmcnt(10) lgkmcnt(2)
ds_read_b128 a[244:247],v248 offset:9728
v_sub_f32 v214,v214,v210
M a[96:99],a[240:243],a[236:239],a[96:99]
s_waitcnt vmcnt(9) lgkmcnt(2)
ds_read_b128 v[216:219],v249 offset:9728
v_fma_f32 v210,-4.0,v208,v212
M a[96:99],a[216:219],v[224:227],a[96:99]
s_waitcnt lgkmcnt(2)
buffer_load_dwordx4 v[200:203],v245,s[8:11],s28 offen offset:768
M a[100:103],a[216:219],a[196:199],a[100:103]
v_sub_f32 v212,v212,v208
v_add_f32 v208,v235,v210
M a[100:103],a[240:243],v[224:227],a[100:103]
v_sub_f32 v235,v235,v210
v_fma_f32 v210,2.0,v212,v214
M a[100:103],v[228:231],a[236:239],a[100:103]
v_fmac_f32 v214,-2.0,v212
v_cvt_pk_bf16_f32 v204,v232,v204
M a[104:107],v[228:231],v[224:227],a[104:107]
ds_read_b128 a[224:227],v248 offset:10240
v_cvt_pk_bf16_f32 v206,v237,v206
M a[104:107],a[240:243],a[196:199],a[104:107]
s_waitcnt lgkmcnt(2)
ds_read_b128 a[228:231],v249 offset:10240
v_cvt_pk_bf16_f32 v208,v233,v208
M a[104:107],a[216:219],a[244:247],a[104:107]
s_waitcnt lgkmcnt(2)
v_cvt_pk_bf16_f32 v212,v234,v210
v_cvt_pk_bf16_f32 v210,v238,v235
M a[108:111],a[216:219],v[216:219],a[108:111]
v_cvt_pk_bf16_f32 v214,v236,v214
v_permlane32_swap_b32 v209,v211
M a[108:111],a[240:243],a[244:247],a[108:111]
v_permlane32_swap_b32 v205,v207
v_permlane32_swap_b32 v213,v215
M a[108:111],v[228:231],a[196:199],a[108:111]
v_lshlrev_b32 v234,16,v211
v_lshlrev_b32 v232,16,v205
M a[112:115],v[228:231],a[244:247],a[112:115]
ds_read_b128 a[204:207],v249 offset:10752
v_lshlrev_b32 v233,16,v209
M a[112:115],a[240:243],v[216:219],a[112:115]
s_waitcnt lgkmcnt(2)
ds_read_b128 a[252:255],v248 offset:10752
v_lshlrev_b32 v237,16,v207
M a[112:115],a[216:219],a[224:227],a[112:115]
s_waitcnt lgkmcnt(2)
v_lshlrev_b32 v236,16,v215
v_lshlrev_b32 v235,16,v213
M a[116:119],a[216:219],a[228:231],a[116:119]
v_fmac_f32 v232,s43,v234
v_fmac_f32 v237,4.0,v233
M a[116:119],a[240:243],a[224:227],a[116:119]
v_fma_f32 v238,-4.0,v234,v236
v_fmac_f32 v232,s45,v236
M a[116:119],v[228:231],v[216:219],a[116:119]
v_fmac_f32 v237,s41,v235
v_sub_f32 v236,v236,v234
M a[120:123],v[228:231],a[224:227],a[120:123]
v_fma_f32 v234,-4.0,v233,v235
v_sub_f32 v235,v235,v233
M a[120:123],a[240:243],a[228:231],a[120:123]
s_waitcnt lgkmcnt(1)
v_add_f32 v233,v238,v234
v_sub_f32 v238,v238,v234
M a[120:123],a[216:219],a[204:207],a[120:123]
s_waitcnt lgkmcnt(0)
v_fma_f32 v234,2.0,v235,v236
v_fmac_f32 v236,-2.0,v235
M a[124:127],a[216:219],a[252:255],a[124:127]
buffer_load_dwordx4 a[216:219],v250,s[20:23],s46 offen offset:1024 sc1
M a[124:127],a[240:243],a[204:207],a[124:127]
v_and_b32 v211,s42,v211
v_and_b32 v205,s42,v205
M a[124:127],v[228:231],a[228:231],a[124:127]
s_waitcnt vmcnt(10)
buffer_load_dwordx4 a[240:243],v250,s[20:23],s46 offen offset:2048 sc1
M a[128:131],v[220:223],a[220:223],a[128:131]
s_waitcnt vmcnt(10)
s_add_u32 s47,s74,30720
v_and_b32 v209,s42,v209
v_and_b32 v207,s42,v207
M a[128:131],a[192:195],a[236:239],a[128:131]
s_waitcnt vmcnt(9)
v_and_b32 v215,s42,v215
v_and_b32 v213,s42,v213
M a[128:131],a[200:203],v[224:227],a[128:131]
v_fmac_f32 v205,s43,v211
v_fmac_f32 v207,4.0,v209
M a[132:135],a[200:203],a[196:199],a[132:135]
buffer_load_dwordx4 v[228:231],v250,s[20:23],s47 offen offset:0 sc1
M a[132:135],a[192:195],v[224:227],a[132:135]
v_fma_f32 v235,-4.0,v211,v215
v_fmac_f32 v205,s45,v215
M a[132:135],v[220:223],a[236:239],a[132:135]
v_fmac_f32 v207,s41,v213
v_sub_f32 v215,v215,v211
M a[136:139],v[220:223],v[224:227],a[136:139]
v_fma_f32 v211,-4.0,v209,v213
v_sub_f32 v213,v213,v209
M a[136:139],a[192:195],a[196:199],a[136:139]
v_add_f32 v209,v235,v211
v_sub_f32 v235,v235,v211
M a[136:139],a[200:203],a[244:247],a[136:139]
v_fma_f32 v211,2.0,v213,v215
v_fmac_f32 v215,-2.0,v213
M a[140:143],a[200:203],v[216:219],a[140:143]
v_cvt_pk_bf16_f32 v205,v232,v205
v_cvt_pk_bf16_f32 v207,v237,v207
M a[140:143],a[192:195],a[244:247],a[140:143]
v_cvt_pk_bf16_f32 v209,v233,v209
v_cvt_pk_bf16_f32 v213,v234,v211
M a[140:143],v[220:223],a[196:199],a[140:143]
v_cvt_pk_bf16_f32 v211,v238,v235
v_cvt_pk_bf16_f32 v215,v236,v215
M a[144:147],v[220:223],a[244:247],a[144:147]
v_add_u32 v238,121856,v247
v_fmac_f32 v239,s43,v241
M a[144:147],a[192:195],v[216:219],a[144:147]
v_fmac_f32 v244,4.0,v240
v_fma_f32 v232,-4.0,v241,v243
M a[144:147],a[200:203],a[224:227],a[144:147]
ds_write2st64_b64 v238,v[204:205],v[206:207] offset0:1 offset1:18
M a[148:151],a[200:203],a[228:231],a[148:151]
s_add_u32 s28,s69,7471104
buffer_load_dwordx4 v[204:207],v251,s[88:91],s28 offen offset:0
M a[148:151],a[192:195],a[224:227],a[148:151]
v_fmac_f32 v239,s45,v243
v_fmac_f32 v244,s41,v242
M a[148:151],v[220:223],v[216:219],a[148:151]
ds_write2st64_b64 v247,v[208:209],v[210:211] offset0:1 offset1:18
M a[152:155],v[220:223],a[224:227],a[152:155]
buffer_load_dwordx4 v[208:211],v245,s[8:11],s28 offen offset:0
M a[152:155],a[192:195],a[228:231],a[152:155]
v_sub_f32 v243,v243,v241
v_fma_f32 v241,-4.0,v240,v242
M a[152:155],a[200:203],a[204:207],a[152:155]
ds_write2st64_b64 v247,v[212:213],v[214:215] offset0:137 offset1:154
M a[156:159],a[200:203],a[252:255],a[156:159]
buffer_load_dwordx4 a[200:203],v250,s[20:23],s47 offen offset:1024 sc1
M a[156:159],a[192:195],a[204:207],a[156:159]
v_sub_f32 v242,v242,v240
v_add_f32 v240,v232,v241
M a[156:159],v[220:223],a[228:231],a[156:159]
s_waitcnt vmcnt(12)
v_sub_f32 v232,v232,v241
v_fma_f32 v241,2.0,v242,v243
M a[160:163],a[232:235],a[220:223],a[160:163]
s_waitcnt vmcnt(11)
buffer_load_dwordx4 a[192:195],v250,s[20:23],s47 offen offset:2048 sc1
M a[160:163],a[212:215],a[236:239],a[160:163]
s_waitcnt vmcnt(11)
s_add_u32 s48,s74,33792
v_fmac_f32 v243,-2.0,v242
v_cvt_pk_bf16_f32 v233,v239,v244
M a[160:163],a[208:211],v[224:227],a[160:163]
v_cvt_pk_bf16_f32 v234,v240,v232
v_cvt_pk_bf16_f32 v235,v241,v243
M a[164:167],a[208:211],a[196:199],a[164:167]
v_add_u32 v232,121856,v252
M a[164:167],a[212:215],v[224:227],a[164:167]
buffer_load_dwordx4 v[220:223],v250,s[20:23],s48 offen offset:0 sc1
M a[164:167],a[232:235],a[236:239],a[164:167]
ds_write_b16 v232,v233 offset:0
M a[168:171],a[232:235],v[224:227],a[168:171]
ds_write_b16_d16_hi v232,v233 offset:8704
M a[168:171],a[212:215],a[196:199],a[168:171]
ds_write_b16 v252,v234 offset:0
M a[168:171],a[208:211],a[244:247],a[168:171]
buffer_load_dwordx4 a[220:223],v250,s[20:23],s48 offen offset:1024 sc1
M a[172:175],a[208:211],v[216:219],a[172:175]
ds_write_b16_d16_hi v252,v234 offset:8704
M a[172:175],a[212:215],a[244:247],a[172:175]
v_add_u32 v232,69632,v252
M a[172:175],a[232:235],a[196:199],a[172:175]
ds_write_b16 v232,v235 offset:0
M a[176:179],a[232:235],a[244:247],a[176:179]
buffer_load_dwordx4 a[236:239],v250,s[20:23],s48 offen offset:2048 sc1
M a[176:179],a[212:215],v[216:219],a[176:179]
s_add_u32 s46,s74,36864
ds_write_b16_d16_hi v232,v235 offset:8704
M a[176:179],a[208:211],a[224:227],a[176:179]
s_waitcnt vmcnt(11)
v_permlane32_swap_b32 v196,v198
v_permlane32_swap_b32 v192,v194
M a[180:183],a[208:211],a[228:231],a[180:183]
s_waitcnt vmcnt(10)
v_permlane32_swap_b32 v200,v202
v_lshlrev_b32 v234,16,v198
M a[180:183],a[212:215],a[224:227],a[180:183]
buffer_load_dwordx4 v[224:227],v250,s[20:23],s46 offen offset:0 sc1
M a[180:183],a[232:235],v[216:219],a[180:183]
ds_read_b128 a[196:199],v248 offset:17408
ds_read_b128 a[244:247],v249 offset:17408
M a[184:187],a[232:235],a[224:227],a[184:187]
ds_read_b128 v[216:219],v248 offset:17920
v_lshlrev_b32 v232,16,v192
M a[184:187],a[212:215],a[228:231],a[184:187]
ds_read_b128 a[224:227],v249 offset:17920
v_lshlrev_b32 v233,16,v196
M a[184:187],a[208:211],a[204:207],a[184:187]
buffer_load_dwordx4 v[212:215],v245,s[8:11],s28 offen offset:768
M a[188:191],a[208:211],a[252:255],a[188:191]
s_add_u32 s29,s70,6291456
v_lshlrev_b32 v237,16,v194
v_lshlrev_b32 v236,16,v202
M a[188:191],a[212:215],a[204:207],a[188:191]
v_lshlrev_b32 v235,16,v200
v_fmac_f32 v232,s43,v234
M a[188:191],a[232:235],a[228:231],a[188:191]
s_waitcnt lgkmcnt(3)
v_fmac_f32 v237,4.0,v233
v_fma_f32 v238,-4.0,v234,v236
M v[0:3],a[248:251],a[196:199],v[0:3]
s_waitcnt vmcnt(11) lgkmcnt(2)
buffer_load_short_d16_hi v239,v246,s[12:15],s29 offen offset:0
M v[0:3],a[216:219],a[244:247],v[0:3]
s_waitcnt vmcnt(11) lgkmcnt(1)
ds_read_b128 a[208:211],v248 offset:18432
ds_read_b128 a[252:255],v249 offset:18432
M v[0:3],a[240:243],v[216:219],v[0:3]
s_waitcnt lgkmcnt(2)
buffer_load_short_d16_hi v240,v246,s[8:11],s29 offen offset:0
M v[4:7],a[240:243],a[224:227],v[4:7]
v_fmac_f32 v232,s45,v236
v_fmac_f32 v237,s41,v235
M v[4:7],a[216:219],v[216:219],v[4:7]
buffer_load_short_d16_hi v241,v246,s[8:11],s29 offen offset:384
M v[4:7],a[248:251],a[244:247],v[4:7]
v_sub_f32 v236,v236,v234
v_fma_f32 v234,-4.0,v233,v235
M v[8:11],a[248:251],v[216:219],v[8:11]
buffer_load_short_d16_hi v242,v246,s[8:11],s29 offen offset:768
M v[8:11],a[216:219],a[224:227],v[8:11]
s_waitcnt lgkmcnt(1)
ds_read_b128 a[204:207],v248 offset:18944
ds_read_b128 a[212:215],v249 offset:18944
M v[8:11],a[240:243],a[208:211],v[8:11]
s_waitcnt lgkmcnt(2)
buffer_load_short_d16_hi v243,v246,s[8:11],s29 offen offset:1152
M v[12:15],a[240:243],a[252:255],v[12:15]
v_sub_f32 v235,v235,v233
v_add_f32 v233,v238,v234
M v[12:15],a[216:219],a[208:211],v[12:15]
buffer_load_short_d16_hi v244,v246,s[16:19],s29 offen offset:1536
M v[12:15],a[248:251],a[224:227],v[12:15]
v_sub_f32 v238,v238,v234
v_fma_f32 v234,2.0,v235,v236
M v[16:19],a[248:251],a[208:211],v[16:19]
ds_read_b128 a[228:231],v249 offset:19456
v_fmac_f32 v236,-2.0,v235
M v[16:19],a[216:219],a[252:255],v[16:19]
s_waitcnt lgkmcnt(2)
ds_read_b128 a[232:235],v248 offset:19456
v_and_b32 v198,s42,v198
M v[16:19],a[240:243],a[204:207],v[16:19]
s_waitcnt lgkmcnt(2)
v_and_b32 v192,s42,v192
v_and_b32 v196,s42,v196
M v[20:23],a[240:243],a[212:215],v[20:23]
v_and_b32 v194,s42,v194
v_and_b32 v202,s42,v202
M v[20:23],a[216:219],a[204:207],v[20:23]
v_and_b32 v200,s42,v200
v_fmac_f32 v192,s43,v198
M v[20:23],a[248:251],a[252:255],v[20:23]
v_fmac_f32 v194,4.0,v196
v_fma_f32 v235,-4.0,v198,v202
M v[24:27],a[248:251],a[204:207],v[24:27]
v_fmac_f32 v192,s45,v202
v_fmac_f32 v194,s41,v200
M v[24:27],a[216:219],a[212:215],v[24:27]
s_waitcnt lgkmcnt(1)
v_sub_f32 v202,v202,v198
v_fma_f32 v198,-4.0,v196,v200
M v[24:27],a[240:243],a[228:231],v[24:27]
s_waitcnt lgkmcnt(0)
v_sub_f32 v200,v200,v196
v_add_f32 v196,v235,v198
M v[28:31],a[240:243],a[232:235],v[28:31]
global_load_dword a240,v250,s[64:65]
M v[28:31],a[216:219],a[228:231],v[28:31]
buffer_load_dwordx4 a[240:243],v250,s[20:23],s46 offen offset:1024 sc1
M v[28:31],a[248:251],a[212:215],v[28:31]
s_waitcnt vmcnt(17)
v_sub_f32 v235,v235,v198
v_fma_f32 v198,2.0,v200,v202
M v[32:35],v[228:231],a[196:199],v[32:35]
s_waitcnt vmcnt(14)
v_fmac_f32 v202,-2.0,v200
v_cvt_pk_bf16_f32 v192,v232,v192
M v[32:35],a[200:203],a[244:247],v[32:35]
s_waitcnt vmcnt(13)
buffer_load_dwordx4 a[216:219],v250,s[20:23],s46 offen offset:2048 sc1
M v[32:35],a[192:195],v[216:219],v[32:35]
s_add_u32 s47,s74,39936
v_cvt_pk_bf16_f32 v194,v237,v194
v_cvt_pk_bf16_f32 v196,v233,v196
M v[36:39],a[192:195],a[224:227],v[36:39]
v_cvt_pk_bf16_f32 v200,v234,v198
v_cvt_pk_bf16_f32 v198,v238,v235
M v[36:39],a[200:203],v[216:219],v[36:39]
v_cvt_pk_bf16_f32 v202,v236,v202
v_permlane32_swap_b32 v197,v199
M v[36:39],v[228:231],a[244:247],v[36:39]
buffer_load_dwordx4 a[248:251],v250,s[20:23],s47 offen offset:0 sc1
M v[40:43],v[228:231],v[216:219],v[40:43]
v_permlane32_swap_b32 v193,v195
v_permlane32_swap_b32 v201,v203
M v[40:43],a[200:203],a[224:227],v[40:43]
v_lshlrev_b32 v234,16,v199
v_lshlrev_b32 v232,16,v193
M v[40:43],a[192:195],a[208:211],v[40:43]
v_lshlrev_b32 v233,16,v197
v_lshlrev_b32 v237,16,v195
M v[44:47],a[192:195],a[252:255],v[44:47]
v_lshlrev_b32 v236,16,v203
v_lshlrev_b32 v235,16,v201
M v[44:47],a[200:203],a[208:211],v[44:47]
v_fmac_f32 v232,s43,v234
v_fmac_f32 v237,4.0,v233
M v[44:47],v[228:231],a[224:227],v[44:47]
v_fma_f32 v238,-4.0,v234,v236
v_fmac_f32 v232,s45,v236
M v[48:51],v[228:231],a[208:211],v[48:51]
v_fmac_f32 v237,s41,v235
v_sub_f32 v236,v236,v234
M v[48:51],a[200:203],a[252:255],v[48:51]
v_fma_f32 v234,-4.0,v233,v235
v_sub_f32 v235,v235,v233
M v[48:51],a[192:195],a[204:207],v[48:51]
v_add_f32 v233,v238,v234
v_sub_f32 v238,v238,v234
M v[52:55],a[192:195],a[212:215],v[52:55]
v_fma_f32 v234,2.0,v235,v236
v_fmac_f32 v236,-2.0,v235
M v[52:55],a[200:203],a[204:207],v[52:55]
v_and_b32 v199,s42,v199
v_and_b32 v193,s42,v193
M v[52:55],v[228:231],a[252:255],v[52:55]
v_and_b32 v197,s42,v197
v_and_b32 v195,s42,v195
M v[56:59],v[228:231],a[204:207],v[56:59]
v_and_b32 v203,s42,v203
v_and_b32 v201,s42,v201
M v[56:59],a[200:203],a[212:215],v[56:59]
v_fmac_f32 v193,s43,v199
v_fmac_f32 v195,4.0,v197
M v[56:59],a[192:195],a[228:231],v[56:59]
v_fma_f32 v235,-4.0,v199,v203
v_fmac_f32 v193,s45,v203
M v[60:63],a[192:195],a[232:235],v[60:63]
buffer_load_dwordx4 a[192:195],v250,s[20:23],s47 offen offset:1024 sc1
M v[60:63],a[200:203],a[228:231],v[60:63]
v_fmac_f32 v195,s41,v201
v_sub_f32 v203,v203,v199
M v[60:63],v[228:231],a[212:215],v[60:63]
s_waitcnt vmcnt(15)
buffer_load_dwordx4 a[200:203],v250,s[20:23],s47 offen offset:2048 sc1
M v[64:67],v[220:223],a[196:199],v[64:67]
s_waitcnt vmcnt(15)
s_add_u32 s48,s74,43008
v_fma_f32 v199,-4.0,v197,v201
v_sub_f32 v201,v201,v197
M v[64:67],a[220:223],a[244:247],v[64:67]
s_waitcnt vmcnt(14)
v_add_f32 v197,v235,v199
v_sub_f32 v235,v235,v199
M v[64:67],a[236:239],v[216:219],v[64:67]
v_fma_f32 v199,2.0,v201,v203
v_fmac_f32 v203,-2.0,v201
M v[68:71],a[236:239],a[224:227],v[68:71]
buffer_load_dwordx4 v[228:231],v250,s[20:23],s48 offen offset:0 sc1
M v[68:71],a[220:223],v[216:219],v[68:71]
v_cvt_pk_bf16_f32 v193,v232,v193
v_cvt_pk_bf16_f32 v195,v237,v195
M v[68:71],v[220:223],a[244:247],v[68:71]
v_cvt_pk_bf16_f32 v197,v233,v197
v_cvt_pk_bf16_f32 v201,v234,v199
M v[72:75],v[220:223],v[216:219],v[72:75]
v_cvt_pk_bf16_f32 v199,v238,v235
v_cvt_pk_bf16_f32 v203,v236,v203
M v[72:75],a[220:223],a[224:227],v[72:75]
buffer_load_dwordx4 a[196:199],v250,s[20:23],s48 offen offset:1024 sc1
M v[72:75],a[236:239],a[208:211],v[72:75]
v_add_u32 v238,121856,v247
v_permlane32_swap_b32 v208,v210
M v[76:79],a[236:239],a[252:255],v[76:79]
s_waitcnt vmcnt(14)
v_permlane32_swap_b32 v204,v206
v_permlane32_swap_b32 v212,v214
M v[76:79],a[220:223],a[208:211],v[76:79]
v_lshlrev_b32 v234,16,v210
v_lshlrev_b32 v232,16,v204
M v[76:79],v[220:223],a[224:227],v[76:79]
buffer_load_dwordx4 a[244:247],v250,s[20:23],s48 offen offset:2048 sc1
M v[80:83],v[220:223],a[208:211],v[80:83]
s_add_u32 s46,s75,9216
v_lshlrev_b32 v233,16,v208
v_lshlrev_b32 v237,16,v206
M v[80:83],a[220:223],a[252:255],v[80:83]
v_lshlrev_b32 v236,16,v214
v_lshlrev_b32 v235,16,v212
M v[80:83],a[236:239],a[204:207],v[80:83]
ds_write2st64_b64 v238,v[192:193],v[194:195] offset0:2 offset1:19
M v[84:87],a[236:239],a[212:215],v[84:87]
s_add_u32 s28,s70,6291456
buffer_load_dwordx4 v[216:219],v250,s[20:23],s46 offen offset:0 sc1
M v[84:87],a[220:223],a[204:207],v[84:87]
ds_read_b128 a[224:227],v248 offset:26112
v_fmac_f32 v232,s43,v234
M v[84:87],v[220:223],a[252:255],v[84:87]
ds_write2st64_b64 v247,v[196:197],v[198:199] offset0:2 offset1:19
M v[88:91],v[220:223],a[204:207],v[88:91]
buffer_load_dwordx4 v[192:195],v251,s[88:91],s28 offen offset:0
M v[88:91],a[220:223],a[212:215],v[88:91]
ds_read_b128 a[208:211],v249 offset:26112
ds_read_b128 a[252:255],v248 offset:26624
M v[88:91],a[236:239],a[228:231],v[88:91]
ds_write2st64_b64 v247,v[200:201],v[202:203] offset0:138 offset1:155
M v[92:95],a[236:239],a[232:235],v[92:95]
buffer_load_dwordx4 v[196:199],v245,s[8:11],s28 offen offset:0
M v[92:95],a[220:223],a[228:231],v[92:95]
ds_read_b128 a[204:207],v249 offset:26624
v_fmac_f32 v237,4.0,v233
M v[92:95],v[220:223],a[212:215],v[92:95]
s_waitcnt lgkmcnt(5)
v_fma_f32 v238,-4.0,v234,v236
v_fmac_f32 v232,s45,v236
M v[96:99],v[224:227],a[224:227],v[96:99]
s_waitcnt vmcnt(10) lgkmcnt(3)
ds_read_b128 a[232:235],v248 offset:27136
v_fmac_f32 v237,s41,v235
M v[96:99],a[240:243],a[208:211],v[96:99]
s_waitcnt vmcnt(9) lgkmcnt(3)
buffer_load_dwordx4 v[200:203],v245,s[8:11],s28 offen offset:768
M v[96:99],a[216:219],a[252:255],v[96:99]
s_waitcnt lgkmcnt(1)
ds_read_b128 a[236:239],v249 offset:27136
v_sub_f32 v236,v236,v234
M v[100:103],a[216:219],a[204:207],v[100:103]
v_fma_f32 v234,-4.0,v233,v235
v_sub_f32 v235,v235,v233
M v[100:103],a[240:243],a[252:255],v[100:103]
v_add_f32 v233,v238,v234
v_sub_f32 v238,v238,v234
M v[100:103],v[224:227],a[208:211],v[100:103]
v_fma_f32 v234,2.0,v235,v236
v_fmac_f32 v236,-2.0,v235
M v[104:107],v[224:227],a[252:255],v[104:107]
ds_read_b128 a[220:223],v248 offset:27648
v_and_b32 v210,s42,v210
M v[104:107],a[240:243],a[204:207],v[104:107]
s_waitcnt lgkmcnt(2)
ds_read_b128 a[228:231],v249 offset:27648
v_and_b32 v204,s42,v204
M v[104:107],a[216:219],a[232:235],v[104:107]
s_waitcnt lgkmcnt(2)
v_and_b32 v208,s42,v208
v_and_b32 v206,s42,v206
M v[108:111],a[216:219],a[236:239],v[108:111]
v_and_b32 v214,s42,v214
v_and_b32 v212,s42,v212
M v[108:111],a[240:243],a[232:235],v[108:111]
v_fmac_f32 v204,s43,v210
v_fmac_f32 v206,4.0,v208
M v[108:111],v[224:227],a[204:207],v[108:111]
v_fma_f32 v235,-4.0,v210,v214
v_fmac_f32 v204,s45,v214
M v[112:115],v[224:227],a[232:235],v[112:115]
ds_read_b128 a[212:215],v249 offset:28160
v_fmac_f32 v206,s41,v212
M v[112:115],a[240:243],a[236:239],v[112:115]
s_waitcnt lgkmcnt(2)
ds_read_b128 v[220:223],v248 offset:28160
v_sub_f32 v214,v214,v210
M v[112:115],a[216:219],a[220:223],v[112:115]
s_waitcnt lgkmcnt(2)
v_fma_f32 v210,-4.0,v208,v212
v_sub_f32 v212,v212,v208
M v[116:119],a[216:219],a[228:231],v[116:119]
v_add_f32 v208,v235,v210
v_sub_f32 v235,v235,v210
M v[116:119],a[240:243],a[220:223],v[116:119]
v_fma_f32 v210,2.0,v212,v214
v_fmac_f32 v214,-2.0,v212
M v[116:119],v[224:227],a[236:239],v[116:119]
v_cvt_pk_bf16_f32 v204,v232,v204
v_cvt_pk_bf16_f32 v206,v237,v206
M v[120:123],v[224:227],a[220:223],v[120:123]
v_cvt_pk_bf16_f32 v208,v233,v208
v_cvt_pk_bf16_f32 v212,v234,v210
M v[120:123],a[240:243],a[228:231],v[120:123]
s_waitcnt lgkmcnt(1)
v_cvt_pk_bf16_f32 v210,v238,v235
v_cvt_pk_bf16_f32 v214,v236,v214
M v[120:123],a[216:219],a[212:215],v[120:123]
s_waitcnt lgkmcnt(0)
v_permlane32_swap_b32 v209,v211
v_permlane32_swap_b32 v205,v207
M v[124:127],a[216:219],v[220:223],v[124:127]
buffer_load_dwordx4 a[216:219],v250,s[20:23],s46 offen offset:1024 sc1
M v[124:127],a[240:243],a[212:215],v[124:127]
v_permlane32_swap_b32 v213,v215
v_lshlrev_b32 v234,16,v211
M v[124:127],v[224:227],a[228:231],v[124:127]
s_waitcnt vmcnt(10)
buffer_load_dwordx4 a[240:243],v250,s[20:23],s46 offen offset:2048 sc1
M v[128:131],a[248:251],a[224:227],v[128:131]
s_waitcnt vmcnt(10)
s_add_u32 s47,s75,12288
v_lshlrev_b32 v232,16,v205
v_lshlrev_b32 v233,16,v209
M v[128:131],a[192:195],a[208:211],v[128:131]
s_waitcnt vmcnt(9)
v_lshlrev_b32 v237,16,v207
v_lshlrev_b32 v236,16,v215
M v[128:131],a[200:203],a[252:255],v[128:131]
v_lshlrev_b32 v235,16,v213
v_fmac_f32 v232,s43,v234
M v[132:135],a[200:203],a[204:207],v[132:135]
buffer_load_dwordx4 v[224:227],v250,s[20:23],s47 offen offset:0 sc1
M v[132:135],a[192:195],a[252:255],v[132:135]
v_fmac_f32 v237,4.0,v233
v_fma_f32 v238,-4.0,v234,v236
M v[132:135],a[248:251],a[208:211],v[132:135]
v_fmac_f32 v232,s45,v236
v_fmac_f32 v237,s41,v235
M v[136:139],a[248:251],a[252:255],v[136:139]
v_sub_f32 v236,v236,v234
v_fma_f32 v234,-4.0,v233,v235
M v[136:139],a[192:195],a[204:207],v[136:139]
v_sub_f32 v235,v235,v233
v_add_f32 v233,v238,v234
M v[136:139],a[200:203],a[232:235],v[136:139]
v_sub_f32 v238,v238,v234
v_fma_f32 v234,2.0,v235,v236
M v[140:143],a[200:203],a[236:239],v[140:143]
v_fmac_f32 v236,-2.0,v235
v_and_b32 v211,s42,v211
M v[140:143],a[192:195],a[232:235],v[140:143]
v_and_b32 v205,s42,v205
v_and_b32 v209,s42,v209
M v[140:143],a[248:251],a[204:207],v[140:143]
v_and_b32 v207,s42,v207
v_and_b32 v215,s42,v215
M v[144:147],a[248:251],a[232:235],v[144:147]
v_and_b32 v213,s42,v213
v_fmac_f32 v205,s43,v211
M v[144:147],a[192:195],a[236:239],v[144:147]
v_fmac_f32 v207,4.0,v209
v_fma_f32 v235,-4.0,v211,v215
M v[144:147],a[200:203],a[220:223],v[144:147]
v_fmac_f32 v205,s45,v215
v_fmac_f32 v207,s41,v213
M v[148:151],a[200:203],a[228:231],v[148:151]
v_sub_f32 v215,v215,v211
v_fma_f32 v211,-4.0,v209,v213
M v[148:151],a[192:195],a[220:223],v[148:151]
v_sub_f32 v213,v213,v209
v_add_f32 v209,v235,v211
M v[148:151],a[248:251],a[236:239],v[148:151]
v_sub_f32 v235,v235,v211
v_fma_f32 v211,2.0,v213,v215
M v[152:155],a[248:251],a[220:223],v[152:155]
v_fmac_f32 v215,-2.0,v213
v_cvt_pk_bf16_f32 v205,v232,v205
M v[152:155],a[192:195],a[228:231],v[152:155]
v_cvt_pk_bf16_f32 v207,v237,v207
v_cvt_pk_bf16_f32 v209,v233,v209
M v[152:155],a[200:203],a[212:215],v[152:155]
v_cvt_pk_bf16_f32 v213,v234,v211
v_cvt_pk_bf16_f32 v211,v238,v235
M v[156:159],a[200:203],v[220:223],v[156:159]
buffer_load_dwordx4 a[200:203],v250,s[20:23],s47 offen offset:1024 sc1
M v[156:159],a[192:195],a[212:215],v[156:159]
v_cvt_pk_bf16_f32 v215,v236,v215
v_add_u32 v238,121856,v247
M v[156:159],a[248:251],a[228:231],v[156:159]
s_waitcnt vmcnt(10)
buffer_load_dwordx4 a[192:195],v250,s[20:23],s47 offen offset:2048 sc1
M v[160:163],v[228:231],a[224:227],v[160:163]
s_waitcnt vmcnt(10)
s_add_u32 s48,s75,15360
M v[160:163],a[196:199],a[208:211],v[160:163]
s_waitcnt vmcnt(9)
M v[160:163],a[244:247],a[252:255],v[160:163]
ds_write2st64_b64 v238,v[204:205],v[206:207] offset0:3 offset1:20
M v[164:167],a[244:247],a[204:207],v[164:167]
s_add_u32 s28,s70,6684672
buffer_load_dwordx4 a[248:251],v250,s[20:23],s48 offen offset:0 sc1
M v[164:167],a[196:199],a[252:255],v[164:167]
M v[164:167],v[228:231],a[208:211],v[164:167]
ds_write2st64_b64 v247,v[208:209],v[210:211] offset0:3 offset1:20
M v[168:171],v[228:231],a[252:255],v[168:171]
buffer_load_dwordx4 a[224:227],v250,s[20:23],s48 offen offset:1024 sc1
M v[168:171],a[196:199],a[204:207],v[168:171]
M v[168:171],a[244:247],a[232:235],v[168:171]
ds_write2st64_b64 v247,v[212:213],v[214:215] offset0:139 offset1:156
M v[172:175],a[244:247],a[236:239],v[172:175]
buffer_load_dwordx4 a[208:211],v250,s[20:23],s48 offen offset:2048 sc1
M v[172:175],a[196:199],a[232:235],v[172:175]
s_add_u32 s46,s75,18432
M v[172:175],v[228:231],a[204:207],v[172:175]
M v[176:179],v[228:231],a[232:235],v[176:179]
M v[176:179],a[196:199],a[236:239],v[176:179]
buffer_load_dwordx4 a[252:255],v250,s[20:23],s46 offen offset:0 sc1
M v[176:179],a[244:247],a[220:223],v[176:179]
s_waitcnt lgkmcnt(0)
s_barrier
v_add_u32 v248,0xffffbc00,v248
M v[180:183],a[244:247],a[228:231],v[180:183]
s_waitcnt vmcnt(10)
v_add_u32 v249,0xffffbc00,v249
v_permlane32_swap_b32 v196,v198
M v[180:183],a[196:199],a[220:223],v[180:183]
ds_read_b128 a[204:207],v248 offset:0
v_permlane32_swap_b32 v192,v194
M v[180:183],v[228:231],a[236:239],v[180:183]
buffer_load_dwordx4 v[204:207],v251,s[88:91],s28 offen offset:0
M v[184:187],v[228:231],a[220:223],v[184:187]
ds_read_b128 a[232:235],v249 offset:0
ds_read_b128 a[236:239],v248 offset:512
M v[184:187],a[196:199],a[228:231],v[184:187]
s_waitcnt vmcnt(10)
ds_read_b128 a[220:223],v249 offset:512
v_permlane32_swap_b32 v200,v202
M v[184:187],a[244:247],a[212:215],v[184:187]
v_lshlrev_b32 v234,16,v198
v_lshlrev_b32 v232,16,v192
M v[188:191],a[244:247],v[220:223],v[188:191]
buffer_load_dwordx4 v[208:211],v245,s[8:11],s28 offen offset:0
M v[188:191],a[196:199],a[212:215],v[188:191]
v_lshlrev_b32 v233,16,v196
v_lshlrev_b32 v237,16,v194
M v[188:191],v[228:231],a[228:231],v[188:191]
s_waitcnt lgkmcnt(3)
v_lshlrev_b32 v236,16,v202
v_lshlrev_b32 v235,16,v200
M a[0:3],v[216:219],a[204:207],a[0:3]
s_waitcnt vmcnt(10) lgkmcnt(2)
ds_read_b128 a[244:247],v248 offset:1024
v_fmac_f32 v232,s43,v234
M a[0:3],a[216:219],a[232:235],a[0:3]
s_waitcnt vmcnt(9) lgkmcnt(2)
buffer_load_dwordx4 v[212:215],v245,s[8:11],s28 offen offset:768
M a[0:3],a[240:243],a[236:239],a[0:3]
s_waitcnt lgkmcnt(1)
ds_read_b128 v[220:223],v249 offset:1024
v_fmac_f32 v237,4.0,v233
M a[4:7],a[240:243],a[220:223],a[4:7]
v_fma_f32 v238,-4.0,v234,v236
v_fmac_f32 v232,s45,v236
M a[4:7],a[216:219],a[236:239],a[4:7]
v_fmac_f32 v237,s41,v235
v_sub_f32 v236,v236,v234
M a[4:7],v[216:219],a[232:235],a[4:7]
v_fma_f32 v234,-4.0,v233,v235
v_sub_f32 v235,v235,v233
M a[8:11],v[216:219],a[236:239],a[8:11]
ds_read_b128 a[196:199],v248 offset:1536
v_add_f32 v233,v238,v234
M a[8:11],a[216:219],a[220:223],a[8:11]
s_waitcnt lgkmcnt(2)
ds_read_b128 a[212:215],v249 offset:1536
v_sub_f32 v238,v238,v234
M a[8:11],a[240:243],a[244:247],a[8:11]
s_waitcnt lgkmcnt(2)
v_fma_f32 v234,2.0,v235,v236
v_fmac_f32 v236,-2.0,v235
M a[12:15],a[240:243],v[220:223],a[12:15]
v_and_b32 v198,s42,v198
v_and_b32 v192,s42,v192
M a[12:15],a[216:219],a[244:247],a[12:15]
v_and_b32 v196,s42,v196
v_and_b32 v194,s42,v194
M a[12:15],v[216:219],a[220:223],a[12:15]
v_and_b32 v202,s42,v202
v_and_b32 v200,s42,v200
M a[16:19],v[216:219],a[244:247],a[16:19]
ds_read_b128 a[228:231],v249 offset:2048
v_fmac_f32 v192,s43,v198
M a[16:19],a[216:219],v[220:223],a[16:19]
s_waitcnt lgkmcnt(2)
ds_read_b128 v[228:231],v248 offset:2048
v_fmac_f32 v194,4.0,v196
M a[16:19],a[240:243],a[196:199],a[16:19]
s_waitcnt lgkmcnt(2)
v_fma_f32 v235,-4.0,v198,v202
v_fmac_f32 v192,s45,v202
M a[20:23],a[240:243],a[212:215],a[20:23]
v_fmac_f32 v194,s41,v200
v_sub_f32 v202,v202,v198
M a[20:23],a[216:219],a[196:199],a[20:23]
v_fma_f32 v198,-4.0,v196,v200
v_sub_f32 v200,v200,v196
M a[20:23],v[216:219],v[220:223],a[20:23]
v_add_f32 v196,v235,v198
v_sub_f32 v235,v235,v198
M a[24:27],v[216:219],a[196:199],a[24:27]
v_fma_f32 v198,2.0,v200,v202
v_fmac_f32 v202,-2.0,v200
M a[24:27],a[216:219],a[212:215],a[24:27]
s_waitcnt lgkmcnt(1)
v_cvt_pk_bf16_f32 v192,v232,v192
v_cvt_pk_bf16_f32 v194,v237,v194
M a[24:27],a[240:243],a[228:231],a[24:27]
s_waitcnt lgkmcnt(0)
v_cvt_pk_bf16_f32 v196,v233,v196
v_cvt_pk_bf16_f32 v200,v234,v198
M a[28:31],a[240:243],v[228:231],a[28:31]
buffer_load_dwordx4 a[240:243],v250,s[20:23],s46 offen offset:1024 sc1
M a[28:31],a[216:219],a[228:231],a[28:31]
v_cvt_pk_bf16_f32 v198,v238,v235
v_cvt_pk_bf16_f32 v202,v236,v202
M a[28:31],v[216:219],a[212:215],a[28:31]
s_waitcnt vmcnt(10)
buffer_load_dwordx4 a[216:219],v250,s[20:23],s46 offen offset:2048 sc1
M a[32:35],v[224:227],a[204:207],a[32:35]
s_waitcnt vmcnt(10)
s_add_u32 s47,s75,21504
v_permlane32_swap_b32 v197,v199
v_permlane32_swap_b32 v193,v195
M a[32:35],a[200:203],a[232:235],a[32:35]
s_waitcnt vmcnt(9)
v_permlane32_swap_b32 v201,v203
v_lshlrev_b32 v234,16,v199
M a[32:35],a[192:195],a[236:239],a[32:35]
v_lshlrev_b32 v232,16,v193
v_lshlrev_b32 v233,16,v197
M a[36:39],a[192:195],a[220:223],a[36:39]
buffer_load_dwordx4 v[216:219],v250,s[20:23],s47 offen offset:0 sc1
M a[36:39],a[200:203],a[236:239],a[36:39]
v_lshlrev_b32 v237,16,v195
v_lshlrev_b32 v236,16,v203
M a[36:39],v[224:227],a[232:235],a[36:39]
v_lshlrev_b32 v235,16,v201
v_fmac_f32 v232,s43,v234
M a[40:43],v[224:227],a[236:239],a[40:43]
v_fmac_f32 v237,4.0,v233
v_fma_f32 v238,-4.0,v234,v236
M a[40:43],a[200:203],a[220:223],a[40:43]
v_fmac_f32 v232,s45,v236
v_fmac_f32 v237,s41,v235
M a[40:43],a[192:195],a[244:247],a[40:43]
v_sub_f32 v236,v236,v234
v_fma_f32 v234,-4.0,v233,v235
M a[44:47],a[192:195],v[220:223],a[44:47]
v_sub_f32 v235,v235,v233
v_add_f32 v233,v238,v234
M a[44:47],a[200:203],a[244:247],a[44:47]
v_sub_f32 v238,v238,v234
v_fma_f32 v234,2.0,v235,v236
M a[44:47],v[224:227],a[220:223],a[44:47]
v_fmac_f32 v236,-2.0,v235
v_and_b32 v199,s42,v199
M a[48:51],v[224:227],a[244:247],a[48:51]
v_and_b32 v193,s42,v193
v_and_b32 v197,s42,v197
M a[48:51],a[200:203],v[220:223],a[48:51]
v_and_b32 v195,s42,v195
v_and_b32 v203,s42,v203
M a[48:51],a[192:195],a[196:199],a[48:51]
v_and_b32 v201,s42,v201
v_fmac_f32 v193,s43,v199
M a[52:55],a[192:195],a[212:215],a[52:55]
v_fmac_f32 v195,4.0,v197
v_fma_f32 v235,-4.0,v199,v203
M a[52:55],a[200:203],a[196:199],a[52:55]
v_fmac_f32 v193,s45,v203
v_fmac_f32 v195,s41,v201
M a[52:55],v[224:227],v[220:223],a[52:55]
v_sub_f32 v203,v203,v199
v_fma_f32 v199,-4.0,v197,v201
M a[56:59],v[224:227],a[196:199],a[56:59]
v_sub_f32 v201,v201,v197
v_add_f32 v197,v235,v199
M a[56:59],a[200:203],a[212:215],a[56:59]
v_sub_f32 v235,v235,v199
v_fma_f32 v199,2.0,v201,v203
M a[56:59],a[192:195],a[228:231],a[56:59]
v_fmac_f32 v203,-2.0,v201
v_cvt_pk_bf16_f32 v193,v232,v193
M a[60:63],a[192:195],v[228:231],a[60:63]
buffer_load_dwordx4 a[192:195],v250,s[20:23],s47 offen offset:1024 sc1
M a[60:63],a[200:203],a[228:231],a[60:63]
v_cvt_pk_bf16_f32 v195,v237,v195
v_cvt_pk_bf16_f32 v197,v233,v197
M a[60:63],v[224:227],a[212:215],a[60:63]
s_waitcnt vmcnt(10)
buffer_load_dwordx4 a[200:203],v250,s[20:23],s47 offen offset:2048 sc1
M a[64:67],a[248:251],a[204:207],a[64:67]
s_waitcnt vmcnt(10)
s_add_u32 s48,s75,24576
v_cvt_pk_bf16_f32 v201,v234,v199
v_cvt_pk_bf16_f32 v199,v238,v235
M a[64:67],a[224:227],a[232:235],a[64:67]
s_waitcnt vmcnt(9)
v_cvt_pk_bf16_f32 v203,v236,v203
v_add_u32 v238,139264,v247
M a[64:67],a[208:211],a[236:239],a[64:67]
ds_write2st64_b64 v238,v[192:193],v[194:195] offset0:0 offset1:17
M a[68:71],a[208:211],a[220:223],a[68:71]
s_add_u32 s28,s70,7077888
buffer_load_dwordx4 v[224:227],v250,s[20:23],s48 offen offset:0 sc1
M a[68:71],a[224:227],a[236:239],a[68:71]
M a[68:71],a[248:251],a[232:235],a[68:71]
ds_write2st64_b64 v247,v[196:197],v[198:199] offset0:34 offset1:51
M a[72:75],a[248:251],a[236:239],a[72:75]
buffer_load_dwordx4 a[204:207],v250,s[20:23],s48 offen offset:1024 sc1
M a[72:75],a[224:227],a[220:223],a[72:75]
M a[72:75],a[208:211],a[244:247],a[72:75]
ds_write2st64_b64 v247,v[200:201],v[202:203] offset0:68 offset1:85
M a[76:79],a[208:211],v[220:223],a[76:79]
buffer_load_dwordx4 a[232:235],v250,s[20:23],s48 offen offset:2048 sc1
M a[76:79],a[224:227],a[244:247],a[76:79]
s_add_u32 s46,s75,27648
M a[76:79],a[248:251],a[220:223],a[76:79]
M a[80:83],a[248:251],a[244:247],a[80:83]
M a[80:83],a[224:227],v[220:223],a[80:83]
buffer_load_dwordx4 a[236:239],v250,s[20:23],s46 offen offset:0 sc1
M a[80:83],a[208:211],a[196:199],a[80:83]
s_waitcnt vmcnt(10)
v_permlane32_swap_b32 v208,v210
v_permlane32_swap_b32 v204,v206
M a[84:87],a[208:211],a[212:215],a[84:87]
s_waitcnt vmcnt(9)
v_permlane32_swap_b32 v212,v214
v_lshlrev_b32 v234,16,v210
M a[84:87],a[224:227],a[196:199],a[84:87]
ds_read_b128 a[220:223],v248 offset:8704
v_lshlrev_b32 v232,16,v204
M a[84:87],a[248:251],v[220:223],a[84:87]
buffer_load_dwordx4 v[192:195],v251,s[88:91],s28 offen offset:0
M a[88:91],a[248:251],a[196:199],a[88:91]
ds_read_b128 a[244:247],v249 offset:8704
ds_read_b128 v[220:223],v248 offset:9216
M a[88:91],a[224:227],a[212:215],a[88:91]
ds_read_b128 a[196:199],v249 offset:9216
v_lshlrev_b32 v233,16,v208
M a[88:91],a[208:211],a[228:231],a[88:91]
v_lshlrev_b32 v237,16,v206
v_lshlrev_b32 v236,16,v214
M a[92:95],a[208:211],v[228:231],a[92:95]
buffer_load_dwordx4 v[196:199],v245,s[8:11],s28 offen offset:0
M a[92:95],a[224:227],a[228:231],a[92:95]
v_lshlrev_b32 v235,16,v212
v_fmac_f32 v232,s43,v234
M a[92:95],a[248:251],a[212:215],a[92:95]
s_waitcnt lgkmcnt(3)
v_fmac_f32 v237,4.0,v233
v_fma_f32 v238,-4.0,v234,v236
M a[96:99],a[252:255],a[220:223],a[96:99]
s_waitcnt vmcnt(10) lgkmcnt(2)
ds_read_b128 a[208:211],v248 offset:9728
v_fmac_f32 v232,s45,v236
M a[96:99],a[240:243],a[244:247],a[96:99]
s_waitcnt vmcnt(9) lgkmcnt(2)
buffer_load_dwordx4 v[200:203],v245,s[8:11],s28 offen offset:768
M a[96:99],a[216:219],v[220:223],a[96:99]
s_waitcnt lgkmcnt(1)
ds_read_b128 v[228:231],v249 offset:9728
v_fmac_f32 v237,s41,v235
M a[100:103],a[216:219],a[196:199],a[100:103]
v_sub_f32 v236,v236,v234
v_fma_f32 v234,-4.0,v233,v235
M a[100:103],a[240:243],v[220:223],a[100:103]
v_sub_f32 v235,v235,v233
v_add_f32 v233,v238,v234
M a[100:103],a[252:255],a[244:247],a[100:103]
v_sub_f32 v238,v238,v234
v_fma_f32 v234,2.0,v235,v236
M a[104:107],a[252:255],v[220:223],a[104:107]
ds_read_b128 a[224:227],v248 offset:10240
v_fmac_f32 v236,-2.0,v235
M a[104:107],a[240:243],a[196:199],a[104:107]
s_waitcnt lgkmcnt(2)
ds_read_b128 a[228:231],v249 offset:10240
v_and_b32 v210,s42,v210
M a[104:107],a[216:219],a[208:211],a[104:107]
s_waitcnt lgkmcnt(2)
v_and_b32 v204,s42,v204
v_and_b32 v208,s42,v208
M a[108:111],a[216:219],v[228:231],a[108:111]
v_and_b32 v206,s42,v206
v_and_b32 v214,s42,v214
M a[108:111],a[240:243],a[208:211],a[108:111]
v_and_b32 v212,s42,v212
v_fmac_f32 v204,s43,v210
M a[108:111],a[252:255],a[196:199],a[108:111]
v_fmac_f32 v206,4.0,v208
v_fma_f32 v235,-4.0,v210,v214
M a[112:115],a[252:255],a[208:211],a[112:115]
ds_read_b128 a[212:215],v249 offset:10752
v_fmac_f32 v204,s45,v214
M a[112:115],a[240:243],v[228:231],a[112:115]
s_waitcnt lgkmcnt(2)
ds_read_b128 a[248:251],v248 offset:10752
v_fmac_f32 v206,s41,v212
M a[112:115],a[216:219],a[224:227],a[112:115]
s_waitcnt lgkmcnt(2)
v_sub_f32 v214,v214,v210
v_fma_f32 v210,-4.0,v208,v212
M a[116:119],a[216:219],a[228:231],a[116:119]
v_sub_f32 v212,v212,v208
v_add_f32 v208,v235,v210
M a[116:119],a[240:243],a[224:227],a[116:119]
v_sub_f32 v235,v235,v210
v_fma_f32 v210,2.0,v212,v214
M a[116:119],a[252:255],v[228:231],a[116:119]
v_fmac_f32 v214,-2.0,v212
v_cvt_pk_bf16_f32 v204,v232,v204
M a[120:123],a[252:255],a[224:227],a[120:123]
v_cvt_pk_bf16_f32 v206,v237,v206
v_cvt_pk_bf16_f32 v208,v233,v208
M a[120:123],a[240:243],a[228:231],a[120:123]
s_waitcnt lgkmcnt(1)
v_cvt_pk_bf16_f32 v212,v234,v210
v_cvt_pk_bf16_f32 v210,v238,v235
M a[120:123],a[216:219],a[212:215],a[120:123]
s_waitcnt lgkmcnt(0)
v_cvt_pk_bf16_f32 v214,v236,v214
v_permlane32_swap_b32 v209,v211
M a[124:127],a[216:219],a[248:251],a[124:127]
buffer_load_dwordx4 a[216:219],v250,s[20:23],s46 offen offset:1024 sc1
M a[124:127],a[240:243],a[212:215],a[124:127]
v_permlane32_swap_b32 v205,v207
v_permlane32_swap_b32 v213,v215
M a[124:127],a[252:255],a[228:231],a[124:127]
s_waitcnt vmcnt(10)
buffer_load_dwordx4 a[240:243],v250,s[20:23],s46 offen offset:2048 sc1
M a[128:131],v[216:219],a[220:223],a[128:131]
s_waitcnt vmcnt(10)
s_add_u32 s47,s75,30720
v_lshlrev_b32 v234,16,v211
v_lshlrev_b32 v232,16,v205
M a[128:131],a[192:195],a[244:247],a[128:131]
s_waitcnt vmcnt(9)
v_lshlrev_b32 v233,16,v209
v_lshlrev_b32 v237,16,v207
M a[128:131],a[200:203],v[220:223],a[128:131]
v_lshlrev_b32 v236,16,v215
v_lshlrev_b32 v235,16,v213
M a[132:135],a[200:203],a[196:199],a[132:135]
buffer_load_dwordx4 a[252:255],v250,s[20:23],s47 offen offset:0 sc1
M a[132:135],a[192:195],v[220:223],a[132:135]
v_fmac_f32 v232,s43,v234
v_fmac_f32 v237,4.0,v233
M a[132:135],v[216:219],a[244:247],a[132:135]
v_fma_f32 v238,-4.0,v234,v236
v_fmac_f32 v232,s45,v236
M a[136:139],v[216:219],v[220:223],a[136:139]
v_fmac_f32 v237,s41,v235
v_sub_f32 v236,v236,v234
M a[136:139],a[192:195],a[196:199],a[136:139]
v_fma_f32 v234,-4.0,v233,v235
v_sub_f32 v235,v235,v233
M a[136:139],a[200:203],a[208:211],a[136:139]
v_add_f32 v233,v238,v234
v_sub_f32 v238,v238,v234
M a[140:143],a[200:203],v[228:231],a[140:143]
v_fma_f32 v234,2.0,v235,v236
v_fmac_f32 v236,-2.0,v235
M a[140:143],a[192:195],a[208:211],a[140:143]
v_and_b32 v211,s42,v211
v_and_b32 v205,s42,v205
M a[140:143],v[216:219],a[196:199],a[140:143]
v_and_b32 v209,s42,v209
v_and_b32 v207,s42,v207
M a[144:147],v[216:219],a[208:211],a[144:147]
v_and_b32 v215,s42,v215
v_and_b32 v213,s42,v213
M a[144:147],a[192:195],v[228:231],a[144:147]
v_fmac_f32 v205,s43,v211
v_fmac_f32 v207,4.0,v209
M a[144:147],a[200:203],a[224:227],a[144:147]
v_fma_f32 v235,-4.0,v211,v215
v_fmac_f32 v205,s45,v215
M a[148:151],a[200:203],a[228:231],a[148:151]
v_fmac_f32 v207,s41,v213
v_sub_f32 v215,v215,v211
M a[148:151],a[192:195],a[224:227],a[148:151]
v_fma_f32 v211,-4.0,v209,v213
v_sub_f32 v213,v213,v209
M a[148:151],v[216:219],v[228:231],a[148:151]
v_add_f32 v209,v235,v211
v_sub_f32 v235,v235,v211
M a[152:155],v[216:219],a[224:227],a[152:155]
v_fma_f32 v211,2.0,v213,v215
v_fmac_f32 v215,-2.0,v213
M a[152:155],a[192:195],a[228:231],a[152:155]
v_cvt_pk_bf16_f32 v205,v232,v205
v_cvt_pk_bf16_f32 v207,v237,v207
M a[152:155],a[200:203],a[212:215],a[152:155]
v_cvt_pk_bf16_f32 v209,v233,v209
v_cvt_pk_bf16_f32 v213,v234,v211
M a[156:159],a[200:203],a[248:251],a[156:159]
buffer_load_dwordx4 a[200:203],v250,s[20:23],s47 offen offset:1024 sc1
M a[156:159],a[192:195],a[212:215],a[156:159]
v_cvt_pk_bf16_f32 v211,v238,v235
v_cvt_pk_bf16_f32 v215,v236,v215
M a[156:159],v[216:219],a[228:231],a[156:159]
s_waitcnt vmcnt(10)
buffer_load_dwordx4 a[192:195],v250,s[20:23],s47 offen offset:2048 sc1
M a[160:163],v[224:227],a[220:223],a[160:163]
s_waitcnt vmcnt(10)
s_add_u32 s48,s75,33792
v_add_u32 v238,139264,v247
v_fmac_f32 v239,s43,v241
M a[160:163],a[204:207],a[244:247],a[160:163]
s_waitcnt vmcnt(9)
v_fmac_f32 v244,4.0,v240
v_fma_f32 v232,-4.0,v241,v243
M a[160:163],a[232:235],v[220:223],a[160:163]
ds_write2st64_b64 v238,v[204:205],v[206:207] offset0:1 offset1:18
M a[164:167],a[232:235],a[196:199],a[164:167]
s_add_u32 s28,s70,7471104
buffer_load_dwordx4 v[216:219],v250,s[20:23],s48 offen offset:0 sc1
M a[164:167],a[204:207],v[220:223],a[164:167]
v_fmac_f32 v239,s45,v243
v_fmac_f32 v244,s41,v242
M a[164:167],v[224:227],a[244:247],a[164:167]
ds_write2st64_b64 v247,v[208:209],v[210:211] offset0:35 offset1:52
M a[168:171],v[224:227],v[220:223],a[168:171]
buffer_load_dwordx4 a[220:223],v250,s[20:23],s48 offen offset:1024 sc1
M a[168:171],a[204:207],a[196:199],a[168:171]
v_sub_f32 v243,v243,v241
v_fma_f32 v241,-4.0,v240,v242
M a[168:171],a[232:235],a[208:211],a[168:171]
ds_write2st64_b64 v247,v[212:213],v[214:215] offset0:69 offset1:86
M a[172:175],a[232:235],v[228:231],a[172:175]
buffer_load_dwordx4 a[244:247],v250,s[20:23],s48 offen offset:2048 sc1
M a[172:175],a[204:207],a[208:211],a[172:175]
s_add_u32 s46,s75,36864
v_sub_f32 v242,v242,v240
v_add_f32 v240,v232,v241
M a[172:175],v[224:227],a[196:199],a[172:175]
v_sub_f32 v232,v232,v241
v_fma_f32 v241,2.0,v242,v243
M a[176:179],v[224:227],a[208:211],a[176:179]
v_fmac_f32 v243,-2.0,v242
v_cvt_pk_bf16_f32 v233,v239,v244
M a[176:179],a[204:207],v[228:231],a[176:179]
buffer_load_dwordx4 v[220:223],v250,s[20:23],s46 offen offset:0 sc1
M a[176:179],a[232:235],a[224:227],a[176:179]
v_add_u32 v248,0x4400,v248
v_add_u32 v249,0x4400,v249
M a[180:183],a[232:235],a[228:231],a[180:183]
v_cvt_pk_bf16_f32 v234,v240,v232
v_cvt_pk_bf16_f32 v235,v241,v243
M a[180:183],a[204:207],a[224:227],a[180:183]
ds_read_b128 a[196:199],v248 offset:52224
v_add_u32 v232,139264,v252
M a[180:183],v[224:227],v[228:231],a[180:183]
buffer_load_dwordx4 v[204:207],v251,s[88:91],s28 offen offset:0
M a[184:187],v[224:227],a[224:227],a[184:187]
ds_read_b128 a[208:211],v249 offset:52224
ds_read_b128 v[228:231],v248 offset:52736
M a[184:187],a[204:207],a[228:231],a[184:187]
ds_read_b128 a[224:227],v249 offset:52736
ds_write_b16 v232,v233 offset:0
M a[184:187],a[232:235],a[212:215],a[184:187]
ds_write_b16_d16_hi v232,v233 offset:8704
M a[188:191],a[232:235],a[248:251],a[188:191]
buffer_load_dwordx4 v[208:211],v245,s[8:11],s28 offen offset:0
M a[188:191],a[204:207],a[212:215],a[188:191]
ds_write_b16 v252,v234 offset:17408
M a[188:191],v[224:227],a[228:231],a[188:191]
s_waitcnt vmcnt(14) lgkmcnt(6)
ds_write_b16_d16_hi v252,v234 offset:26112
M v[0:3],a[236:239],a[196:199],v[0:3]
s_waitcnt vmcnt(10) lgkmcnt(6)
ds_read_b128 a[232:235],v248 offset:53248
ds_write_b16 v252,v235 offset:34816
M v[0:3],a[216:219],a[208:211],v[0:3]
s_waitcnt vmcnt(9) lgkmcnt(7)
buffer_load_dwordx4 v[212:215],v245,s[8:11],s28 offen offset:768
M v[0:3],a[240:243],v[228:231],v[0:3]
s_waitcnt lgkmcnt(6)
s_add_u32 s29,s71,6291456
ds_read_b128 a[248:251],v249 offset:53248
ds_write_b16_d16_hi v252,v235 offset:43520
M v[4:7],a[240:243],a[224:227],v[4:7]
v_permlane32_swap_b32 v196,v198
v_permlane32_swap_b32 v192,v194
M v[4:7],a[216:219],v[228:231],v[4:7]
buffer_load_short_d16_hi v239,v246,s[12:15],s29 offen offset:0
M v[4:7],a[236:239],a[208:211],v[4:7]
v_permlane32_swap_b32 v200,v202
v_lshlrev_b32 v234,16,v198
M v[8:11],a[236:239],v[228:231],v[8:11]
buffer_load_short_d16_hi v240,v246,s[8:11],s29 offen offset:0
M v[8:11],a[216:219],a[224:227],v[8:11]
s_waitcnt lgkmcnt(3)
ds_read_b128 a[204:207],v248 offset:53760
ds_read_b128 a[212:215],v249 offset:53760
M v[8:11],a[240:243],a[232:235],v[8:11]
s_waitcnt lgkmcnt(3)
buffer_load_short_d16_hi v241,v246,s[8:11],s29 offen offset:384
M v[12:15],a[240:243],a[248:251],v[12:15]
v_lshlrev_b32 v232,16,v192
v_lshlrev_b32 v233,16,v196
M v[12:15],a[216:219],a[232:235],v[12:15]
buffer_load_short_d16_hi v242,v246,s[8:11],s29 offen offset:768
M v[12:15],a[236:239],a[224:227],v[12:15]
v_lshlrev_b32 v237,16,v194
v_lshlrev_b32 v236,16,v202
M v[16:19],a[236:239],a[232:235],v[16:19]
buffer_load_short_d16_hi v243,v246,s[8:11],s29 offen offset:1152
M v[16:19],a[216:219],a[248:251],v[16:19]
s_waitcnt lgkmcnt(1)
ds_read_b128 a[228:231],v249 offset:54272
ds_read_b128 v[224:227],v248 offset:54272
M v[16:19],a[240:243],a[204:207],v[16:19]
s_waitcnt lgkmcnt(2)
buffer_load_short_d16_hi v244,v246,s[16:19],s29 offen offset:1536
M v[20:23],a[240:243],a[212:215],v[20:23]
v_lshlrev_b32 v235,16,v200
v_fmac_f32 v232,s43,v234
M v[20:23],a[216:219],a[204:207],v[20:23]
v_fmac_f32 v237,4.0,v233
v_fma_f32 v238,-4.0,v234,v236
M v[20:23],a[236:239],a[248:251],v[20:23]
v_fmac_f32 v232,s45,v236
v_fmac_f32 v237,s41,v235
M v[24:27],a[236:239],a[204:207],v[24:27]
v_sub_f32 v236,v236,v234
v_fma_f32 v234,-4.0,v233,v235
M v[24:27],a[216:219],a[212:215],v[24:27]
s_waitcnt lgkmcnt(1)
v_sub_f32 v235,v235,v233
v_add_f32 v233,v238,v234
M v[24:27],a[240:243],a[228:231],v[24:27]
s_waitcnt lgkmcnt(0)
v_sub_f32 v238,v238,v234
v_fma_f32 v234,2.0,v235,v236
M v[28:31],a[240:243],v[224:227],v[28:31]
buffer_load_dwordx4 a[240:243],v250,s[20:23],s46 offen offset:1024 sc1
M v[28:31],a[216:219],a[228:231],v[28:31]
v_fmac_f32 v236,-2.0,v235
v_and_b32 v198,s42,v198
M v[28:31],a[236:239],a[212:215],v[28:31]
s_waitcnt vmcnt(16)
buffer_load_dwordx4 a[216:219],v250,s[20:23],s46 offen offset:2048 sc1
M v[32:35],a[252:255],a[196:199],v[32:35]
s_waitcnt vmcnt(16)
s_add_u32 s47,s75,39936
v_and_b32 v192,s42,v192
v_and_b32 v196,s42,v196
M v[32:35],a[200:203],a[208:211],v[32:35]
s_waitcnt vmcnt(15)
v_and_b32 v194,s42,v194
v_and_b32 v202,s42,v202
M v[32:35],a[192:195],v[228:231],v[32:35]
v_and_b32 v200,s42,v200
v_fmac_f32 v192,s43,v198
M v[36:39],a[192:195],a[224:227],v[36:39]
buffer_load_dwordx4 a[236:239],v250,s[20:23],s47 offen offset:0 sc1
M v[36:39],a[200:203],v[228:231],v[36:39]
v_fmac_f32 v194,4.0,v196
v_fma_f32 v235,-4.0,v198,v202
M v[36:39],a[252:255],a[208:211],v[36:39]
v_fmac_f32 v192,s45,v202
v_fmac_f32 v194,s41,v200
M v[40:43],a[252:255],v[228:231],v[40:43]
v_sub_f32 v202,v202,v198
v_fma_f32 v198,-4.0,v196,v200
M v[40:43],a[200:203],a[224:227],v[40:43]
v_sub_f32 v200,v200,v196
v_add_f32 v196,v235,v198
M v[40:43],a[192:195],a[232:235],v[40:43]
v_sub_f32 v235,v235,v198
v_fma_f32 v198,2.0,v200,v202
M v[44:47],a[192:195],a[248:251],v[44:47]
v_fmac_f32 v202,-2.0,v200
v_cvt_pk_bf16_f32 v192,v232,v192
M v[44:47],a[200:203],a[232:235],v[44:47]
v_cvt_pk_bf16_f32 v194,v237,v194
v_cvt_pk_bf16_f32 v196,v233,v196
M v[44:47],a[252:255],a[224:227],v[44:47]
v_cvt_pk_bf16_f32 v200,v234,v198
v_cvt_pk_bf16_f32 v198,v238,v235
M v[48:51],a[252:255],a[232:235],v[48:51]
v_cvt_pk_bf16_f32 v202,v236,v202
v_permlane32_swap_b32 v197,v199
M v[48:51],a[200:203],a[248:251],v[48:51]
v_permlane32_swap_b32 v193,v195
v_permlane32_swap_b32 v201,v203
M v[48:51],a[192:195],a[204:207],v[48:51]
v_lshlrev_b32 v234,16,v199
v_lshlrev_b32 v232,16,v193
M v[52:55],a[192:195],a[212:215],v[52:55]
v_lshlrev_b32 v233,16,v197
v_lshlrev_b32 v237,16,v195
M v[52:55],a[200:203],a[204:207],v[52:55]
v_lshlrev_b32 v236,16,v203
v_lshlrev_b32 v235,16,v201
M v[52:55],a[252:255],a[248:251],v[52:55]
v_fmac_f32 v232,s43,v234
v_fmac_f32 v237,4.0,v233
M v[56:59],a[252:255],a[204:207],v[56:59]
v_fma_f32 v238,-4.0,v234,v236
v_fmac_f32 v232,s45,v236
M v[56:59],a[200:203],a[212:215],v[56:59]
v_fmac_f32 v237,s41,v235
v_sub_f32 v236,v236,v234
M v[56:59],a[192:195],a[228:231],v[56:59]
v_fma_f32 v234,-4.0,v233,v235
v_sub_f32 v235,v235,v233
M v[60:63],a[192:195],v[224:227],v[60:63]
buffer_load_dwordx4 a[192:195],v250,s[20:23],s47 offen offset:1024 sc1
M v[60:63],a[200:203],a[228:231],v[60:63]
v_add_f32 v233,v238,v234
v_sub_f32 v238,v238,v234
M v[60:63],a[252:255],a[212:215],v[60:63]
s_waitcnt vmcnt(16)
buffer_load_dwordx4 a[200:203],v250,s[20:23],s47 offen offset:2048 sc1
M v[64:67],v[216:219],a[196:199],v[64:67]
s_waitcnt vmcnt(16)
s_add_u32 s48,s75,43008
v_fma_f32 v234,2.0,v235,v236
v_fmac_f32 v236,-2.0,v235
M v[64:67],a[220:223],a[208:211],v[64:67]
s_waitcnt vmcnt(15)
v_and_b32 v199,s42,v199
v_and_b32 v193,s42,v193
M v[64:67],a[244:247],v[228:231],v[64:67]
v_and_b32 v197,s42,v197
v_and_b32 v195,s42,v195
M v[68:71],a[244:247],a[224:227],v[68:71]
buffer_load_dwordx4 a[252:255],v250,s[20:23],s48 offen offset:0 sc1
M v[68:71],a[220:223],v[228:231],v[68:71]
v_and_b32 v203,s42,v203
v_and_b32 v201,s42,v201
M v[68:71],v[216:219],a[208:211],v[68:71]
v_fmac_f32 v193,s43,v199
v_fmac_f32 v195,4.0,v197
M v[72:75],v[216:219],v[228:231],v[72:75]
v_fma_f32 v235,-4.0,v199,v203
v_fmac_f32 v193,s45,v203
M v[72:75],a[220:223],a[224:227],v[72:75]
buffer_load_dwordx4 a[196:199],v250,s[20:23],s48 offen offset:1024 sc1
M v[72:75],a[244:247],a[232:235],v[72:75]
v_fmac_f32 v195,s41,v201
v_sub_f32 v203,v203,v199
M v[76:79],a[244:247],a[248:251],v[76:79]
v_fma_f32 v199,-4.0,v197,v201
v_sub_f32 v201,v201,v197
M v[76:79],a[220:223],a[232:235],v[76:79]
v_add_f32 v197,v235,v199
v_sub_f32 v235,v235,v199
M v[76:79],v[216:219],a[224:227],v[76:79]
buffer_load_dwordx4 a[208:211],v250,s[20:23],s48 offen offset:2048 sc1
M v[80:83],v[216:219],a[232:235],v[80:83]
s_add_u32 s46,s76,9216
v_fma_f32 v199,2.0,v201,v203
v_fmac_f32 v203,-2.0,v201
M v[80:83],a[220:223],a[248:251],v[80:83]
v_cvt_pk_bf16_f32 v193,v232,v193
v_cvt_pk_bf16_f32 v195,v237,v195
M v[80:83],a[244:247],a[204:207],v[80:83]
v_cvt_pk_bf16_f32 v197,v233,v197
v_cvt_pk_bf16_f32 v201,v234,v199
M v[84:87],a[244:247],a[212:215],v[84:87]
buffer_load_dwordx4 v[228:231],v250,s[20:23],s46 offen offset:0 sc1
M v[84:87],a[220:223],a[204:207],v[84:87]
ds_read_b128 a[224:227],v248 offset:60928
v_cvt_pk_bf16_f32 v199,v238,v235
M v[84:87],v[216:219],a[248:251],v[84:87]
ds_read_b128 a[232:235],v249 offset:60928
v_cvt_pk_bf16_f32 v203,v236,v203
M v[88:91],v[216:219],a[204:207],v[88:91]
ds_read_b128 a[248:251],v248 offset:61440
v_add_u32 v238,139264,v247
M v[88:91],a[220:223],a[212:215],v[88:91]
s_waitcnt vmcnt(16)
ds_read_b128 a[204:207],v249 offset:61440
v_permlane32_swap_b32 v208,v210
M v[88:91],a[244:247],a[228:231],v[88:91]
ds_write2st64_b64 v238,v[192:193],v[194:195] offset0:2 offset1:19
M v[92:95],a[244:247],v[224:227],v[92:95]
s_add_u32 s28,s71,6291456
buffer_load_dwordx4 v[192:195],v251,s[88:91],s28 offen offset:0
M v[92:95],a[220:223],a[228:231],v[92:95]
s_waitcnt vmcnt(16)
v_permlane32_swap_b32 v204,v206
v_permlane32_swap_b32 v212,v214
M v[92:95],v[216:219],a[212:215],v[92:95]
s_waitcnt lgkmcnt(4)
ds_write2st64_b64 v247,v[196:197],v[198:199] offset0:36 offset1:53
M v[96:99],v[220:223],a[224:227],v[96:99]
s_waitcnt vmcnt(9) lgkmcnt(4)
buffer_load_dwordx4 v[196:199],v245,s[8:11],s28 offen offset:0
M v[96:99],a[240:243],a[232:235],v[96:99]
s_waitcnt vmcnt(9) lgkmcnt(3)
ds_read_b128 a[244:247],v248 offset:61952
ds_read_b128 v[224:227],v249 offset:61952
M v[96:99],a[216:219],a[248:251],v[96:99]
s_waitcnt lgkmcnt(4)
ds_write2st64_b64 v247,v[200:201],v[202:203] offset0:70 offset1:87
M v[100:103],a[216:219],a[204:207],v[100:103]
buffer_load_dwordx4 v[200:203],v245,s[8:11],s28 offen offset:768
M v[100:103],a[240:243],a[248:251],v[100:103]
v_lshlrev_b32 v234,16,v210
v_lshlrev_b32 v232,16,v204
M v[100:103],v[220:223],a[232:235],v[100:103]
v_lshlrev_b32 v233,16,v208
v_lshlrev_b32 v237,16,v206
M v[104:107],v[220:223],a[248:251],v[104:107]
ds_read_b128 a[220:223],v248 offset:62464
v_lshlrev_b32 v236,16,v214
M v[104:107],a[240:243],a[204:207],v[104:107]
s_waitcnt lgkmcnt(3)
ds_read_b128 a[228:231],v249 offset:62464
v_lshlrev_b32 v235,16,v212
M v[104:107],a[216:219],a[244:247],v[104:107]
s_waitcnt lgkmcnt(3)
v_fmac_f32 v232,s43,v234
v_fmac_f32 v237,4.0,v233
M v[108:111],a[216:219],v[224:227],v[108:111]
v_fma_f32 v238,-4.0,v234,v236
v_fmac_f32 v232,s45,v236
M v[108:111],a[240:243],a[244:247],v[108:111]
v_fmac_f32 v237,s41,v235
v_sub_f32 v236,v236,v234
M v[108:111],v[220:223],a[204:207],v[108:111]
v_fma_f32 v234,-4.0,v233,v235
v_sub_f32 v235,v235,v233
M v[112:115],v[220:223],a[244:247],v[112:115]
ds_read_b128 a[212:215],v249 offset:62976
v_add_f32 v233,v238,v234
M v[112:115],a[240:243],v[224:227],v[112:115]
s_waitcnt lgkmcnt(2)
ds_read_b128 v[216:219],v248 offset:62976
v_sub_f32 v238,v238,v234
M v[112:115],a[216:219],a[220:223],v[112:115]
s_waitcnt lgkmcnt(2)
v_fma_f32 v234,2.0,v235,v236
v_fmac_f32 v236,-2.0,v235
M v[116:119],a[216:219],a[228:231],v[116:119]
v_and_b32 v210,s42,v210
v_and_b32 v204,s42,v204
M v[116:119],a[240:243],a[220:223],v[116:119]
v_and_b32 v208,s42,v208
v_and_b32 v206,s42,v206
M v[116:119],v[220:223],v[224:227],v[116:119]
v_and_b32 v214,s42,v214
v_and_b32 v212,s42,v212
M v[120:123],v[220:223],a[220:223],v[120:123]
v_fmac_f32 v204,s43,v210
v_fmac_f32 v206,4.0,v208
M v[120:123],a[240:243],a[228:231],v[120:123]
s_waitcnt lgkmcnt(1)
v_fma_f32 v235,-4.0,v210,v214
v_fmac_f32 v204,s45,v214
M v[120:123],a[216:219],a[212:215],v[120:123]
s_waitcnt lgkmcnt(0)
v_fmac_f32 v206,s41,v212
v_sub_f32 v214,v214,v210
M v[124:127],a[216:219],v[216:219],v[124:127]
buffer_load_dwordx4 a[216:219],v250,s[20:23],s46 offen offset:1024 sc1
M v[124:127],a[240:243],a[212:215],v[124:127]
v_fma_f32 v210,-4.0,v208,v212
v_sub_f32 v212,v212,v208
M v[124:127],v[220:223],a[228:231],v[124:127]
s_waitcnt vmcnt(10)
buffer_load_dwordx4 a[240:243],v250,s[20:23],s46 offen offset:2048 sc1
M v[128:131],a[236:239],a[224:227],v[128:131]
s_waitcnt vmcnt(10)
s_add_u32 s47,s76,12288
v_add_f32 v208,v235,v210
v_sub_f32 v235,v235,v210
M v[128:131],a[192:195],a[232:235],v[128:131]
s_waitcnt vmcnt(9)
v_fma_f32 v210,2.0,v212,v214
v_fmac_f32 v214,-2.0,v212
M v[128:131],a[200:203],a[248:251],v[128:131]
v_cvt_pk_bf16_f32 v204,v232,v204
v_cvt_pk_bf16_f32 v206,v237,v206
M v[132:135],a[200:203],a[204:207],v[132:135]
buffer_load_dwordx4 v[220:223],v250,s[20:23],s47 offen offset:0 sc1
M v[132:135],a[192:195],a[248:251],v[132:135]
v_cvt_pk_bf16_f32 v208,v233,v208
v_cvt_pk_bf16_f32 v212,v234,v210
M v[132:135],a[236:239],a[232:235],v[132:135]
v_cvt_pk_bf16_f32 v210,v238,v235
v_cvt_pk_bf16_f32 v214,v236,v214
M v[136:139],a[236:239],a[248:251],v[136:139]
v_permlane32_swap_b32 v209,v211
v_permlane32_swap_b32 v205,v207
M v[136:139],a[192:195],a[204:207],v[136:139]
v_permlane32_swap_b32 v213,v215
v_lshlrev_b32 v234,16,v211
M v[136:139],a[200:203],a[244:247],v[136:139]
v_lshlrev_b32 v232,16,v205
v_lshlrev_b32 v233,16,v209
M v[140:143],a[200:203],v[224:227],v[140:143]
v_lshlrev_b32 v237,16,v207
v_lshlrev_b32 v236,16,v215
M v[140:143],a[192:195],a[244:247],v[140:143]
v_lshlrev_b32 v235,16,v213
v_fmac_f32 v232,s43,v234
M v[140:143],a[236:239],a[204:207],v[140:143]
v_fmac_f32 v237,4.0,v233
v_fma_f32 v238,-4.0,v234,v236
M v[144:147],a[236:239],a[244:247],v[144:147]
v_fmac_f32 v232,s45,v236
v_fmac_f32 v237,s41,v235
M v[144:147],a[192:195],v[224:227],v[144:147]
v_sub_f32 v236,v236,v234
v_fma_f32 v234,-4.0,v233,v235
M v[144:147],a[200:203],a[220:223],v[144:147]
v_sub_f32 v235,v235,v233
v_add_f32 v233,v238,v234
M v[148:151],a[200:203],a[228:231],v[148:151]
v_sub_f32 v238,v238,v234
v_fma_f32 v234,2.0,v235,v236
M v[148:151],a[192:195],a[220:223],v[148:151]
v_fmac_f32 v236,-2.0,v235
v_and_b32 v211,s42,v211
M v[148:151],a[236:239],v[224:227],v[148:151]
v_and_b32 v205,s42,v205
v_and_b32 v209,s42,v209
M v[152:155],a[236:239],a[220:223],v[152:155]
v_and_b32 v207,s42,v207
v_and_b32 v215,s42,v215
M v[152:155],a[192:195],a[228:231],v[152:155]
v_and_b32 v213,s42,v213
v_fmac_f32 v205,s43,v211
M v[152:155],a[200:203],a[212:215],v[152:155]
v_fmac_f32 v207,4.0,v209
v_fma_f32 v235,-4.0,v211,v215
M v[156:159],a[200:203],v[216:219],v[156:159]
buffer_load_dwordx4 a[200:203],v250,s[20:23],s47 offen offset:1024 sc1
M v[156:159],a[192:195],a[212:215],v[156:159]
v_fmac_f32 v205,s45,v215
v_fmac_f32 v207,s41,v213
M v[156:159],a[236:239],a[228:231],v[156:159]
s_waitcnt vmcnt(10)
buffer_load_dwordx4 a[192:195],v250,s[20:23],s47 offen offset:2048 sc1
M v[160:163],a[252:255],a[224:227],v[160:163]
s_waitcnt vmcnt(10)
s_add_u32 s48,s76,15360
v_sub_f32 v215,v215,v211
v_fma_f32 v211,-4.0,v209,v213
M v[160:163],a[196:199],a[232:235],v[160:163]
s_waitcnt vmcnt(9)
v_sub_f32 v213,v213,v209
v_add_f32 v209,v235,v211
v_sub_f32 v235,v235,v211
M v[160:163],a[208:211],a[248:251],v[160:163]
v_fma_f32 v211,2.0,v213,v215
v_fmac_f32 v215,-2.0,v213
v_cvt_pk_bf16_f32 v205,v232,v205
v_cvt_pk_bf16_f32 v207,v237,v207
M v[164:167],a[208:211],a[204:207],v[164:167]
buffer_load_dwordx4 a[236:239],v250,s[20:23],s48 offen offset:0 sc1
v_cvt_pk_bf16_f32 v209,v233,v209
v_cvt_pk_bf16_f32 v213,v234,v211
v_cvt_pk_bf16_f32 v211,v238,v235
v_cvt_pk_bf16_f32 v215,v236,v215
M v[164:167],a[196:199],a[248:251],v[164:167]
s_waitcnt vmcnt(7)
v_add_u32 v238,139264,v247
v_permlane32_swap_b32 v196,v198
M v[164:167],a[252:255],a[232:235],v[164:167]
ds_write2st64_b64 v238,v[204:205],v[206:207] offset0:3 offset1:20
M v[168:171],a[252:255],a[248:251],v[168:171]
s_add_u32 s28,s71,6684672
buffer_load_dwordx4 a[224:227],v250,s[20:23],s48 offen offset:1024 sc1
M v[168:171],a[196:199],a[204:207],v[168:171]
s_waitcnt vmcnt(7)
v_permlane32_swap_b32 v192,v194
v_permlane32_swap_b32 v200,v202
M v[168:171],a[208:211],a[244:247],v[168:171]
ds_write2st64_b64 v247,v[208:209],v[210:211] offset0:37 offset1:54
M v[172:175],a[208:211],v[224:227],v[172:175]
buffer_load_dwordx4 a[232:235],v250,s[20:23],s48 offen offset:2048 sc1
M v[172:175],a[196:199],a[244:247],v[172:175]
s_add_u32 s46,s76,18432
v_lshlrev_b32 v234,16,v198
v_lshlrev_b32 v232,16,v192
M v[172:175],a[252:255],a[204:207],v[172:175]
ds_write2st64_b64 v247,v[212:213],v[214:215] offset0:71 offset1:88
M v[176:179],a[252:255],a[244:247],v[176:179]
buffer_load_dwordx4 a[248:251],v250,s[20:23],s46 offen offset:0 sc1
M v[176:179],a[196:199],v[224:227],v[176:179]
v_lshlrev_b32 v233,16,v196
v_lshlrev_b32 v237,16,v194
M v[176:179],a[208:211],a[220:223],v[176:179]
s_waitcnt lgkmcnt(0)
s_barrier
v_lshlrev_b32 v236,16,v202
M v[180:183],a[208:211],a[228:231],v[180:183]
buffer_load_dwordx4 v[204:207],v251,s[88:91],s28 offen offset:0
M v[180:183],a[196:199],a[220:223],v[180:183]
ds_read_b128 a[204:207],v248 offset:0
v_lshlrev_b32 v235,16,v200
M v[180:183],a[252:255],v[224:227],v[180:183]
ds_read_b128 a[244:247],v249 offset:0
v_fmac_f32 v232,s43,v234
M v[184:187],a[252:255],a[220:223],v[184:187]
ds_read_b128 v[224:227],v248 offset:512
v_fmac_f32 v237,4.0,v233
M v[184:187],a[196:199],a[228:231],v[184:187]
buffer_load_dwordx4 v[208:211],v245,s[8:11],s28 offen offset:0
M v[184:187],a[208:211],a[212:215],v[184:187]
ds_read_b128 a[220:223],v249 offset:512
v_fma_f32 v238,-4.0,v234,v236
M v[188:191],a[208:211],v[216:219],v[188:191]
v_fmac_f32 v232,s45,v236
v_fmac_f32 v237,s41,v235
M v[188:191],a[196:199],a[212:215],v[188:191]
v_sub_f32 v236,v236,v234
v_fma_f32 v234,-4.0,v233,v235
M v[188:191],a[252:255],a[228:231],v[188:191]
s_waitcnt lgkmcnt(3)
buffer_load_dwordx4 v[212:215],v245,s[8:11],s28 offen offset:768
M a[0:3],v[228:231],a[204:207],a[0:3]
s_waitcnt vmcnt(11) lgkmcnt(2)
ds_read_b128 a[208:211],v248 offset:1024
v_sub_f32 v235,v235,v233
M a[0:3],a[216:219],a[244:247],a[0:3]
s_waitcnt vmcnt(10) lgkmcnt(2)
ds_read_b128 v[216:219],v249 offset:1024
v_add_f32 v233,v238,v234
M a[0:3],a[240:243],v[224:227],a[0:3]
s_waitcnt lgkmcnt(2)
v_sub_f32 v238,v238,v234
v_fma_f32 v234,2.0,v235,v236
M a[4:7],a[240:243],a[220:223],a[4:7]
v_fmac_f32 v236,-2.0,v235
v_and_b32 v198,s42,v198
M a[4:7],a[216:219],v[224:227],a[4:7]
v_and_b32 v192,s42,v192
v_and_b32 v196,s42,v196
M a[4:7],v[228:231],a[244:247],a[4:7]
v_and_b32 v194,s42,v194
v_and_b32 v202,s42,v202
M a[8:11],v[228:231],v[224:227],a[8:11]
ds_read_b128 a[196:199],v248 offset:1536
v_and_b32 v200,s42,v200
M a[8:11],a[216:219],a[220:223],a[8:11]
s_waitcnt lgkmcnt(2)
ds_read_b128 a[212:215],v249 offset:1536
v_fmac_f32 v192,s43,v198
M a[8:11],a[240:243],a[208:211],a[8:11]
s_waitcnt lgkmcnt(2)
v_fmac_f32 v194,4.0,v196
v_fma_f32 v235,-4.0,v198,v202
M a[12:15],a[240:243],v[216:219],a[12:15]
v_fmac_f32 v192,s45,v202
v_fmac_f32 v194,s41,v200
M a[12:15],a[216:219],a[208:211],a[12:15]
v_sub_f32 v202,v202,v198
v_fma_f32 v198,-4.0,v196,v200
M a[12:15],v[228:231],a[220:223],a[12:15]
v_sub_f32 v200,v200,v196
v_add_f32 v196,v235,v198
M a[16:19],v[228:231],a[208:211],a[16:19]
ds_read_b128 a[228:231],v249 offset:2048
v_sub_f32 v235,v235,v198
M a[16:19],a[216:219],v[216:219],a[16:19]
s_waitcnt lgkmcnt(2)
ds_read_b128 a[252:255],v248 offset:2048
v_fma_f32 v198,2.0,v200,v202
M a[16:19],a[240:243],a[196:199],a[16:19]
s_waitcnt lgkmcnt(2)
v_fmac_f32 v202,-2.0,v200
v_cvt_pk_bf16_f32 v192,v232,v192
M a[20:23],a[240:243],a[212:215],a[20:23]
v_cvt_pk_bf16_f32 v194,v237,v194
v_cvt_pk_bf16_f32 v196,v233,v196
M a[20:23],a[216:219],a[196:199],a[20:23]
v_cvt_pk_bf16_f32 v200,v234,v198
v_cvt_pk_bf16_f32 v198,v238,v235
M a[20:23],v[228:231],v[216:219],a[20:23]
v_cvt_pk_bf16_f32 v202,v236,v202
v_permlane32_swap_b32 v197,v199
M a[24:27],v[228:231],a[196:199],a[24:27]
v_permlane32_swap_b32 v193,v195
v_permlane32_swap_b32 v201,v203
M a[24:27],a[216:219],a[212:215],a[24:27]
s_waitcnt lgkmcnt(1)
v_lshlrev_b32 v234,16,v199
v_lshlrev_b32 v232,16,v193
M a[24:27],a[240:243],a[228:231],a[24:27]
s_waitcnt lgkmcnt(0)
v_lshlrev_b32 v233,16,v197
v_lshlrev_b32 v237,16,v195
M a[28:31],a[240:243],a[252:255],a[28:31]
buffer_load_dwordx4 a[240:243],v250,s[20:23],s46 offen offset:1024 sc1
M a[28:31],a[216:219],a[228:231],a[28:31]
v_lshlrev_b32 v236,16,v203
v_lshlrev_b32 v235,16,v201
M a[28:31],v[228:231],a[212:215],a[28:31]
s_waitcnt vmcnt(10)
buffer_load_dwordx4 a[216:219],v250,s[20:23],s46 offen offset:2048 sc1
M a[32:35],v[220:223],a[204:207],a[32:35]
s_waitcnt vmcnt(10)
s_add_u32 s47,s76,21504
v_fmac_f32 v232,s43,v234
v_fmac_f32 v237,4.0,v233
M a[32:35],a[200:203],a[244:247],a[32:35]
s_waitcnt vmcnt(9)
v_fma_f32 v238,-4.0,v234,v236
v_fmac_f32 v232,s45,v236
M a[32:35],a[192:195],v[224:227],a[32:35]
v_fmac_f32 v237,s41,v235
v_sub_f32 v236,v236,v234
M a[36:39],a[192:195],a[220:223],a[36:39]
buffer_load_dwordx4 v[228:231],v250,s[20:23],s47 offen offset:0 sc1
M a[36:39],a[200:203],v[224:227],a[36:39]
v_fma_f32 v234,-4.0,v233,v235
v_sub_f32 v235,v235,v233
M a[36:39],v[220:223],a[244:247],a[36:39]
v_add_f32 v233,v238,v234
v_sub_f32 v238,v238,v234
M a[40:43],v[220:223],v[224:227],a[40:43]
v_fma_f32 v234,2.0,v235,v236
v_fmac_f32 v236,-2.0,v235
M a[40:43],a[200:203],a[220:223],a[40:43]
v_and_b32 v199,s42,v199
v_and_b32 v193,s42,v193
M a[40:43],a[192:195],a[208:211],a[40:43]
v_and_b32 v197,s42,v197
v_and_b32 v195,s42,v195
M a[44:47],a[192:195],v[216:219],a[44:47]
v_and_b32 v203,s42,v203
v_and_b32 v201,s42,v201
M a[44:47],a[200:203],a[208:211],a[44:47]
v_fmac_f32 v193,s43,v199
v_fmac_f32 v195,4.0,v197
M a[44:47],v[220:223],a[220:223],a[44:47]
v_fma_f32 v235,-4.0,v199,v203
v_fmac_f32 v193,s45,v203
M a[48:51],v[220:223],a[208:211],a[48:51]
v_fmac_f32 v195,s41,v201
v_sub_f32 v203,v203,v199
M a[48:51],a[200:203],v[216:219],a[48:51]
v_fma_f32 v199,-4.0,v197,v201
v_sub_f32 v201,v201,v197
M a[48:51],a[192:195],a[196:199],a[48:51]
v_add_f32 v197,v235,v199
v_sub_f32 v235,v235,v199
M a[52:55],a[192:195],a[212:215],a[52:55]
v_fma_f32 v199,2.0,v201,v203
v_fmac_f32 v203,-2.0,v201
M a[52:55],a[200:203],a[196:199],a[52:55]
v_cvt_pk_bf16_f32 v193,v232,v193
v_cvt_pk_bf16_f32 v195,v237,v195
M a[52:55],v[220:223],v[216:219],a[52:55]
v_cvt_pk_bf16_f32 v197,v233,v197
v_cvt_pk_bf16_f32 v201,v234,v199
M a[56:59],v[220:223],a[196:199],a[56:59]
v_cvt_pk_bf16_f32 v199,v238,v235
v_cvt_pk_bf16_f32 v203,v236,v203
M a[56:59],a[200:203],a[212:215],a[56:59]
s_waitcnt vmcnt(4)
v_permlane32_swap_b32 v208,v210
v_permlane32_swap_b32 v204,v206
M a[56:59],a[192:195],a[228:231],a[56:59]
ds_write2st64_b64 v247,v[192:193],v[194:195] offset0:136 offset1:153
M a[60:63],a[192:195],a[252:255],a[60:63]
s_add_u32 s28,s71,7077888
buffer_load_dwordx4 a[192:195],v250,s[20:23],s47 offen offset:1024 sc1
M a[60:63],a[200:203],a[228:231],a[60:63]
s_waitcnt vmcnt(4)
v_permlane32_swap_b32 v212,v214
v_lshlrev_b32 v234,16,v210
M a[60:63],v[220:223],a[212:215],a[60:63]
buffer_load_dwordx4 a[200:203],v250,s[20:23],s47 offen offset:2048 sc1
M a[64:67],a[236:239],a[204:207],a[64:67]
s_add_u32 s48,s76,24576
v_lshlrev_b32 v232,16,v204
v_lshlrev_b32 v233,16,v208
M a[64:67],a[224:227],a[244:247],a[64:67]
v_lshlrev_b32 v237,16,v206
v_lshlrev_b32 v236,16,v214
M a[64:67],a[232:235],v[224:227],a[64:67]
ds_write2st64_b64 v247,v[196:197],v[198:199] offset0:0 offset1:17
M a[68:71],a[232:235],a[220:223],a[68:71]
buffer_load_dwordx4 v[220:223],v250,s[20:23],s48 offen offset:0 sc1
M a[68:71],a[224:227],v[224:227],a[68:71]
v_lshlrev_b32 v235,16,v212
v_fmac_f32 v232,s43,v234
M a[68:71],a[236:239],a[244:247],a[68:71]
v_fmac_f32 v237,4.0,v233
v_fma_f32 v238,-4.0,v234,v236
M a[72:75],a[236:239],v[224:227],a[72:75]
v_fmac_f32 v232,s45,v236
v_fmac_f32 v237,s41,v235
M a[72:75],a[224:227],a[220:223],a[72:75]
buffer_load_dwordx4 a[204:207],v250,s[20:23],s48 offen offset:1024 sc1
M a[72:75],a[232:235],a[208:211],a[72:75]
v_sub_f32 v236,v236,v234
v_fma_f32 v234,-4.0,v233,v235
M a[76:79],a[232:235],v[216:219],a[76:79]
v_sub_f32 v235,v235,v233
v_add_f32 v233,v238,v234
M a[76:79],a[224:227],a[208:211],a[76:79]
v_sub_f32 v238,v238,v234
v_fma_f32 v234,2.0,v235,v236
M a[76:79],a[236:239],a[220:223],a[76:79]
buffer_load_dwordx4 a[244:247],v250,s[20:23],s48 offen offset:2048 sc1
M a[80:83],a[236:239],a[208:211],a[80:83]
s_add_u32 s46,s76,27648
v_fmac_f32 v236,-2.0,v235
v_and_b32 v210,s42,v210
M a[80:83],a[224:227],v[216:219],a[80:83]
v_and_b32 v204,s42,v204
v_and_b32 v208,s42,v208
M a[80:83],a[232:235],a[196:199],a[80:83]
v_and_b32 v206,s42,v206
v_and_b32 v214,s42,v214
M a[84:87],a[232:235],a[212:215],a[84:87]
buffer_load_dwordx4 v[224:227],v250,s[20:23],s46 offen offset:0 sc1
M a[84:87],a[224:227],a[196:199],a[84:87]
ds_read_b128 a[220:223],v248 offset:8704
v_and_b32 v212,s42,v212
M a[84:87],a[236:239],v[216:219],a[84:87]
ds_read_b128 a[208:211],v249 offset:8704
v_fmac_f32 v204,s43,v210
M a[88:91],a[236:239],a[196:199],a[88:91]
ds_read_b128 v[216:219],v248 offset:9216
v_fmac_f32 v206,4.0,v208
M a[88:91],a[224:227],a[212:215],a[88:91]
buffer_load_dwordx4 v[192:195],v251,s[88:91],s28 offen offset:0
M a[88:91],a[232:235],a[228:231],a[88:91]
ds_read_b128 a[196:199],v249 offset:9216
v_fma_f32 v235,-4.0,v210,v214
M a[92:95],a[232:235],a[252:255],a[92:95]
v_fmac_f32 v204,s45,v214
v_fmac_f32 v206,s41,v212
M a[92:95],a[224:227],a[228:231],a[92:95]
v_sub_f32 v214,v214,v210
v_fma_f32 v210,-4.0,v208,v212
M a[92:95],a[236:239],a[212:215],a[92:95]
s_waitcnt lgkmcnt(3)
buffer_load_dwordx4 v[196:199],v245,s[8:11],s28 offen offset:0
M a[96:99],a[248:251],a[220:223],a[96:99]
s_waitcnt vmcnt(10) lgkmcnt(2)
ds_read_b128 a[232:235],v248 offset:9728
v_sub_f32 v212,v212,v208
M a[96:99],a[240:243],a[208:211],a[96:99]
s_waitcnt vmcnt(9) lgkmcnt(2)
ds_read_b128 a[252:255],v249 offset:9728
v_add_f32 v208,v235,v210
M a[96:99],a[216:219],v[216:219],a[96:99]
s_waitcnt lgkmcnt(2)
v_sub_f32 v235,v235,v210
v_fma_f32 v210,2.0,v212,v214
M a[100:103],a[216:219],a[196:199],a[100:103]
v_fmac_f32 v214,-2.0,v212
v_cvt_pk_bf16_f32 v204,v232,v204
M a[100:103],a[240:243],v[216:219],a[100:103]
v_cvt_pk_bf16_f32 v206,v237,v206
v_cvt_pk_bf16_f32 v208,v233,v208
M a[100:103],a[248:251],a[208:211],a[100:103]
v_cvt_pk_bf16_f32 v212,v234,v210
v_cvt_pk_bf16_f32 v210,v238,v235
M a[104:107],a[248:251],v[216:219],a[104:107]
ds_read_b128 a[224:227],v248 offset:10240
v_cvt_pk_bf16_f32 v214,v236,v214
M a[104:107],a[240:243],a[196:199],a[104:107]
s_waitcnt lgkmcnt(2)
ds_read_b128 a[228:231],v249 offset:10240
v_permlane32_swap_b32 v209,v211
M a[104:107],a[216:219],a[232:235],a[104:107]
s_waitcnt lgkmcnt(2)
v_permlane32_swap_b32 v205,v207
v_permlane32_swap_b32 v213,v215
M a[108:111],a[216:219],a[252:255],a[108:111]
v_lshlrev_b32 v234,16,v211
v_lshlrev_b32 v232,16,v205
M a[108:111],a[240:243],a[232:235],a[108:111]
v_lshlrev_b32 v233,16,v209
v_lshlrev_b32 v237,16,v207
M a[108:111],a[248:251],a[196:199],a[108:111]
v_lshlrev_b32 v236,16,v215
v_lshlrev_b32 v235,16,v213
M a[112:115],a[248:251],a[232:235],a[112:115]
ds_read_b128 a[212:215],v249 offset:10752
v_fmac_f32 v232,s43,v234
M a[112:115],a[240:243],a[252:255],a[112:115]
s_waitcnt lgkmcnt(2)
ds_read_b128 a[236:239],v248 offset:10752
v_fmac_f32 v237,4.0,v233
M a[112:115],a[216:219],a[224:227],a[112:115]
s_waitcnt lgkmcnt(2)
v_fma_f32 v238,-4.0,v234,v236
v_fmac_f32 v232,s45,v236
M a[116:119],a[216:219],a[228:231],a[116:119]
v_fmac_f32 v237,s41,v235
v_sub_f32 v236,v236,v234
M a[116:119],a[240:243],a[224:227],a[116:119]
v_fma_f32 v234,-4.0,v233,v235
v_sub_f32 v235,v235,v233
M a[116:119],a[248:251],a[252:255],a[116:119]
v_add_f32 v233,v238,v234
v_sub_f32 v238,v238,v234
M a[120:123],a[248:251],a[224:227],a[120:123]
v_fma_f32 v234,2.0,v235,v236
v_fmac_f32 v236,-2.0,v235
M a[120:123],a[240:243],a[228:231],a[120:123]
s_waitcnt lgkmcnt(1)
v_and_b32 v211,s42,v211
v_and_b32 v205,s42,v205
M a[120:123],a[216:219],a[212:215],a[120:123]
s_waitcnt lgkmcnt(0)
v_and_b32 v209,s42,v209
v_and_b32 v207,s42,v207
M a[124:127],a[216:219],a[236:239],a[124:127]
buffer_load_dwordx4 a[216:219],v250,s[20:23],s46 offen offset:1024 sc1
M a[124:127],a[240:243],a[212:215],a[124:127]
v_and_b32 v215,s42,v215
v_and_b32 v213,s42,v213
M a[124:127],a[248:251],a[228:231],a[124:127]
s_waitcnt vmcnt(9)
buffer_load_dwordx4 a[240:243],v250,s[20:23],s46 offen offset:2048 sc1
M a[128:131],v[228:231],a[220:223],a[128:131]
s_waitcnt vmcnt(9)
s_add_u32 s47,s76,30720
v_fmac_f32 v205,s43,v211
v_fmac_f32 v207,4.0,v209
M a[128:131],a[192:195],a[208:211],a[128:131]
s_waitcnt vmcnt(8)
v_fma_f32 v235,-4.0,v211,v215
v_fmac_f32 v205,s45,v215
M a[128:131],a[200:203],v[216:219],a[128:131]
v_fmac_f32 v207,s41,v213
v_sub_f32 v215,v215,v211
M a[132:135],a[200:203],a[196:199],a[132:135]
buffer_load_dwordx4 a[248:251],v250,s[20:23],s47 offen offset:0 sc1
M a[132:135],a[192:195],v[216:219],a[132:135]
v_fma_f32 v211,-4.0,v209,v213
v_sub_f32 v213,v213,v209
M a[132:135],v[228:231],a[208:211],a[132:135]
v_add_f32 v209,v235,v211
v_sub_f32 v235,v235,v211
M a[136:139],v[228:231],v[216:219],a[136:139]
s_barrier
v_fma_f32 v211,2.0,v213,v215
M a[136:139],a[192:195],a[196:199],a[136:139]
v_fmac_f32 v215,-2.0,v213
v_cvt_pk_bf16_f32 v205,v232,v205
M a[136:139],a[200:203],a[232:235],a[136:139]
ds_write2st64_b64 v247,v[200:201],v[202:203] offset0:34 offset1:51
M a[140:143],a[200:203],a[252:255],a[140:143]
buffer_load_dwordx4 v[200:203],v245,s[8:11],s28 offen offset:768
M a[140:143],a[192:195],a[232:235],a[140:143]
v_cvt_pk_bf16_f32 v207,v237,v207
v_cvt_pk_bf16_f32 v209,v233,v209
M a[140:143],v[228:231],a[196:199],a[140:143]
v_cvt_pk_bf16_f32 v213,v234,v211
v_cvt_pk_bf16_f32 v211,v238,v235
M a[144:147],v[228:231],a[232:235],a[144:147]
v_cvt_pk_bf16_f32 v215,v236,v215
v_fmac_f32 v239,s43,v241
M a[144:147],a[192:195],a[252:255],a[144:147]
v_fmac_f32 v244,4.0,v240
v_fma_f32 v232,-4.0,v241,v243
M a[144:147],a[200:203],a[224:227],a[144:147]
ds_write2st64_b64 v247,v[204:205],v[206:207] offset0:137 offset1:154
M a[148:151],a[200:203],a[228:231],a[148:151]
s_add_u32 s28,s71,7471104
buffer_load_dwordx4 v[204:207],v251,s[88:91],s28 offen offset:0
M a[148:151],a[192:195],a[224:227],a[148:151]
v_fmac_f32 v239,s45,v243
v_fmac_f32 v244,s41,v242
M a[148:151],v[228:231],a[252:255],a[148:151]
ds_write2st64_b64 v247,v[208:209],v[210:211] offset0:1 offset1:18
M a[152:155],v[228:231],a[224:227],a[152:155]
buffer_load_dwordx4 v[208:211],v245,s[8:11],s28 offen offset:0
M a[152:155],a[192:195],a[228:231],a[152:155]
v_sub_f32 v243,v243,v241
v_fma_f32 v241,-4.0,v240,v242
M a[152:155],a[200:203],a[212:215],a[152:155]
ds_write2st64_b64 v247,v[212:213],v[214:215] offset0:35 offset1:52
M a[156:159],a[200:203],a[236:239],a[156:159]
buffer_load_dwordx4 a[200:203],v250,s[20:23],s47 offen offset:1024 sc1
M a[156:159],a[192:195],a[212:215],a[156:159]
v_sub_f32 v242,v242,v240
v_add_f32 v240,v232,v241
M a[156:159],v[228:231],a[228:231],a[156:159]
s_waitcnt vmcnt(12)
v_sub_f32 v232,v232,v241
v_fma_f32 v241,2.0,v242,v243
M a[160:163],v[220:223],a[220:223],a[160:163]
s_waitcnt vmcnt(11)
buffer_load_dwordx4 a[192:195],v250,s[20:23],s47 offen offset:2048 sc1
M a[160:163],a[204:207],a[208:211],a[160:163]
s_waitcnt vmcnt(11)
s_add_u32 s48,s76,33792
v_fmac_f32 v243,-2.0,v242
v_cvt_pk_bf16_f32 v233,v239,v244
M a[160:163],a[244:247],v[216:219],a[160:163]
v_cvt_pk_bf16_f32 v234,v240,v232
v_cvt_pk_bf16_f32 v235,v241,v243
M a[164:167],a[244:247],a[196:199],a[164:167]
v_add_u32 v232,69632,v252
M a[164:167],a[204:207],v[216:219],a[164:167]
buffer_load_dwordx4 v[228:231],v250,s[20:23],s48 offen offset:0 sc1
M a[164:167],v[220:223],a[208:211],a[164:167]
ds_write_b16 v232,v233 offset:0
M a[168:171],v[220:223],v[216:219],a[168:171]
ds_write_b16_d16_hi v232,v233 offset:8704
M a[168:171],a[204:207],a[196:199],a[168:171]
ds_write_b16 v252,v234 offset:0
M a[168:171],a[244:247],a[232:235],a[168:171]
buffer_load_dwordx4 a[220:223],v250,s[20:23],s48 offen offset:1024 sc1
M a[172:175],a[244:247],a[252:255],a[172:175]
ds_write_b16_d16_hi v252,v234 offset:8704
M a[172:175],a[204:207],a[232:235],a[172:175]
ds_write_b16 v252,v235 offset:17408
M a[172:175],v[220:223],a[196:199],a[172:175]
ds_write_b16_d16_hi v252,v235 offset:26112
M a[176:179],v[220:223],a[232:235],a[176:179]
buffer_load_dwordx4 a[208:211],v250,s[20:23],s48 offen offset:2048 sc1
M a[176:179],a[204:207],a[252:255],a[176:179]
s_add_u32 s46,s76,36864
M a[176:179],a[244:247],a[224:227],a[176:179]
M a[180:183],a[244:247],a[228:231],a[180:183]
s_waitcnt vmcnt(11)
v_permlane32_swap_b32 v196,v198
v_permlane32_swap_b32 v192,v194
M a[180:183],a[204:207],a[224:227],a[180:183]
buffer_load_dwordx4 v[216:219],v250,s[20:23],s46 offen offset:0 sc1
M a[180:183],v[220:223],a[252:255],a[180:183]
ds_read_b128 a[196:199],v248 offset:17408
ds_read_b128 a[232:235],v249 offset:17408
M a[184:187],v[220:223],a[224:227],a[184:187]
s_waitcnt vmcnt(8)
ds_read_b128 a[252:255],v248 offset:17920
v_permlane32_swap_b32 v200,v202
M a[184:187],a[204:207],a[228:231],a[184:187]
ds_read_b128 a[224:227],v249 offset:17920
v_lshlrev_b32 v234,16,v198
M a[184:187],a[244:247],a[212:215],a[184:187]
buffer_load_dwordx4 v[212:215],v245,s[8:11],s28 offen offset:768
M a[188:191],a[244:247],a[236:239],a[188:191]
v_lshlrev_b32 v232,16,v192
v_lshlrev_b32 v233,16,v196
M a[188:191],a[204:207],a[212:215],a[188:191]
v_lshlrev_b32 v237,16,v194
v_lshlrev_b32 v236,16,v202
M a[188:191],v[220:223],a[228:231],a[188:191]
s_waitcnt lgkmcnt(3)
v_lshlrev_b32 v235,16,v200
v_fmac_f32 v232,s43,v234
M v[0:3],v[224:227],a[196:199],v[0:3]
s_waitcnt lgkmcnt(2)
ds_read_b128 a[236:239],v248 offset:18432
v_fmac_f32 v237,4.0,v233
M v[0:3],a[216:219],a[232:235],v[0:3]
s_waitcnt lgkmcnt(2)
ds_read_b128 a[244:247],v249 offset:18432
v_fma_f32 v238,-4.0,v234,v236
M v[0:3],a[240:243],a[252:255],v[0:3]
s_waitcnt lgkmcnt(2)
v_fmac_f32 v232,s45,v236
v_fmac_f32 v237,s41,v235
M v[4:7],a[240:243],a[224:227],v[4:7]
v_sub_f32 v236,v236,v234
v_fma_f32 v234,-4.0,v233,v235
M v[4:7],a[216:219],a[252:255],v[4:7]
v_sub_f32 v235,v235,v233
v_add_f32 v233,v238,v234
M v[4:7],v[224:227],a[232:235],v[4:7]
v_sub_f32 v238,v238,v234
v_fma_f32 v234,2.0,v235,v236
M v[8:11],v[224:227],a[252:255],v[8:11]
ds_read_b128 a[204:207],v248 offset:18944
v_fmac_f32 v236,-2.0,v235
M v[8:11],a[216:219],a[224:227],v[8:11]
s_waitcnt lgkmcnt(2)
ds_read_b128 a[212:215],v249 offset:18944
v_and_b32 v198,s42,v198
M v[8:11],a[240:243],a[236:239],v[8:11]
s_waitcnt lgkmcnt(2)
v_and_b32 v192,s42,v192
v_and_b32 v196,s42,v196
M v[12:15],a[240:243],a[244:247],v[12:15]
v_and_b32 v194,s42,v194
v_and_b32 v202,s42,v202
M v[12:15],a[216:219],a[236:239],v[12:15]
v_and_b32 v200,s42,v200
v_fmac_f32 v192,s43,v198
M v[12:15],v[224:227],a[224:227],v[12:15]
v_fmac_f32 v194,4.0,v196
v_fma_f32 v235,-4.0,v198,v202
M v[16:19],v[224:227],a[236:239],v[16:19]
ds_read_b128 a[228:231],v249 offset:19456
v_fmac_f32 v192,s45,v202
M v[16:19],a[216:219],a[244:247],v[16:19]
s_waitcnt lgkmcnt(2)
ds_read_b128 v[220:223],v248 offset:19456
v_fmac_f32 v194,s41,v200
M v[16:19],a[240:243],a[204:207],v[16:19]
s_waitcnt lgkmcnt(2)
v_sub_f32 v202,v202,v198
v_fma_f32 v198,-4.0,v196,v200
M v[20:23],a[240:243],a[212:215],v[20:23]
v_sub_f32 v200,v200,v196
v_add_f32 v196,v235,v198
M v[20:23],a[216:219],a[204:207],v[20:23]
v_sub_f32 v235,v235,v198
v_fma_f32 v198,2.0,v200,v202
M v[20:23],v[224:227],a[244:247],v[20:23]
v_fmac_f32 v202,-2.0,v200
v_cvt_pk_bf16_f32 v192,v232,v192
M v[24:27],v[224:227],a[204:207],v[24:27]
v_cvt_pk_bf16_f32 v194,v237,v194
v_cvt_pk_bf16_f32 v196,v233,v196
M v[24:27],a[216:219],a[212:215],v[24:27]
s_waitcnt lgkmcnt(1)
v_cvt_pk_bf16_f32 v200,v234,v198
v_cvt_pk_bf16_f32 v198,v238,v235
M v[24:27],a[240:243],a[228:231],v[24:27]
s_waitcnt lgkmcnt(0)
v_cvt_pk_bf16_f32 v202,v236,v202
v_permlane32_swap_b32 v197,v199
M v[28:31],a[240:243],v[220:223],v[28:31]
global_load_dword a240,v250,s[64:65]
M v[28:31],a[216:219],a[228:231],v[28:31]
buffer_load_dwordx4 a[240:243],v250,s[20:23],s46 offen offset:1024 sc1
M v[28:31],v[224:227],a[212:215],v[28:31]
v_permlane32_swap_b32 v193,v195
v_permlane32_swap_b32 v201,v203
M v[32:35],a[248:251],a[196:199],v[32:35]
s_waitcnt vmcnt(8)
v_lshlrev_b32 v234,16,v199
v_lshlrev_b32 v232,16,v193
M v[32:35],a[200:203],a[232:235],v[32:35]
s_waitcnt vmcnt(7)
buffer_load_dwordx4 a[216:219],v250,s[20:23],s46 offen offset:2048 sc1
M v[32:35],a[192:195],a[252:255],v[32:35]
s_add_u32 s47,s76,39936
v_lshlrev_b32 v233,16,v197
v_lshlrev_b32 v237,16,v195
M v[36:39],a[192:195],a[224:227],v[36:39]
v_lshlrev_b32 v236,16,v203
v_lshlrev_b32 v235,16,v201
M v[36:39],a[200:203],a[252:255],v[36:39]
v_fmac_f32 v232,s43,v234
v_fmac_f32 v237,4.0,v233
M v[36:39],a[248:251],a[232:235],v[36:39]
buffer_load_dwordx4 v[224:227],v250,s[20:23],s47 offen offset:0 sc1
M v[40:43],a[248:251],a[252:255],v[40:43]
v_fma_f32 v238,-4.0,v234,v236
v_fmac_f32 v232,s45,v236
M v[40:43],a[200:203],a[224:227],v[40:43]
v_fmac_f32 v237,s41,v235
v_sub_f32 v236,v236,v234
M v[40:43],a[192:195],a[236:239],v[40:43]
v_fma_f32 v234,-4.0,v233,v235
v_sub_f32 v235,v235,v233
M v[44:47],a[192:195],a[244:247],v[44:47]
v_add_f32 v233,v238,v234
v_sub_f32 v238,v238,v234
M v[44:47],a[200:203],a[236:239],v[44:47]
v_fma_f32 v234,2.0,v235,v236
v_fmac_f32 v236,-2.0,v235
M v[44:47],a[248:251],a[224:227],v[44:47]
v_and_b32 v199,s42,v199
v_and_b32 v193,s42,v193
M v[48:51],a[248:251],a[236:239],v[48:51]
v_and_b32 v197,s42,v197
v_and_b32 v195,s42,v195
M v[48:51],a[200:203],a[244:247],v[48:51]
v_and_b32 v203,s42,v203
v_and_b32 v201,s42,v201
M v[48:51],a[192:195],a[204:207],v[48:51]
v_fmac_f32 v193,s43,v199
v_fmac_f32 v195,4.0,v197
M v[52:55],a[192:195],a[212:215],v[52:55]
v_fma_f32 v235,-4.0,v199,v203
v_fmac_f32 v193,s45,v203
M v[52:55],a[200:203],a[204:207],v[52:55]
v_fmac_f32 v195,s41,v201
v_sub_f32 v203,v203,v199
M v[52:55],a[248:251],a[244:247],v[52:55]
v_fma_f32 v199,-4.0,v197,v201
v_sub_f32 v201,v201,v197
M v[56:59],a[248:251],a[204:207],v[56:59]
v_add_f32 v197,v235,v199
v_sub_f32 v235,v235,v199
M v[56:59],a[200:203],a[212:215],v[56:59]
v_fma_f32 v199,2.0,v201,v203
v_fmac_f32 v203,-2.0,v201
M v[56:59],a[192:195],a[228:231],v[56:59]
v_cvt_pk_bf16_f32 v193,v232,v193
v_cvt_pk_bf16_f32 v195,v237,v195
M v[60:63],a[192:195],v[220:223],v[60:63]
buffer_load_dwordx4 a[192:195],v250,s[20:23],s47 offen offset:1024 sc1
M v[60:63],a[200:203],a[228:231],v[60:63]
v_cvt_pk_bf16_f32 v197,v233,v197
v_cvt_pk_bf16_f32 v201,v234,v199
M v[60:63],a[248:251],a[212:215],v[60:63]
s_waitcnt vmcnt(9)
buffer_load_dwordx4 a[200:203],v250,s[20:23],s47 offen offset:2048 sc1
M v[64:67],v[228:231],a[196:199],v[64:67]
s_waitcnt vmcnt(9)
s_add_u32 s48,s76,43008
v_cvt_pk_bf16_f32 v199,v238,v235
v_cvt_pk_bf16_f32 v203,v236,v203
M v[64:67],a[220:223],a[232:235],v[64:67]
s_waitcnt vmcnt(8)
v_permlane32_swap_b32 v208,v210
v_permlane32_swap_b32 v204,v206
M v[64:67],a[208:211],a[252:255],v[64:67]
ds_write2st64_b64 v247,v[192:193],v[194:195] offset0:138 offset1:155
M v[68:71],a[208:211],a[224:227],v[68:71]
buffer_load_dwordx4 a[248:251],v250,s[20:23],s48 offen offset:0 sc1
M v[68:71],a[220:223],a[252:255],v[68:71]
s_waitcnt vmcnt(7)
v_permlane32_swap_b32 v212,v214
v_lshlrev_b32 v234,16,v210
M v[68:71],v[228:231],a[232:235],v[68:71]
ds_write2st64_b64 v247,v[196:197],v[198:199] offset0:2 offset1:19
M v[72:75],v[228:231],a[252:255],v[72:75]
buffer_load_dwordx4 a[196:199],v250,s[20:23],s48 offen offset:1024 sc1
M v[72:75],a[220:223],a[224:227],v[72:75]
v_lshlrev_b32 v232,16,v204
v_lshlrev_b32 v233,16,v208
M v[72:75],a[208:211],a[236:239],v[72:75]
ds_write2st64_b64 v247,v[200:201],v[202:203] offset0:36 offset1:53
M v[76:79],a[208:211],a[244:247],v[76:79]
buffer_load_dwordx4 a[232:235],v250,s[20:23],s48 offen offset:2048 sc1
M v[76:79],a[220:223],a[236:239],v[76:79]
s_add_u32 s46,s77,9216
v_lshlrev_b32 v237,16,v206
v_lshlrev_b32 v236,16,v214
M v[76:79],v[228:231],a[224:227],v[76:79]
v_lshlrev_b32 v235,16,v212
v_fmac_f32 v232,s43,v234
M v[80:83],v[228:231],a[236:239],v[80:83]
v_fmac_f32 v237,4.0,v233
v_fma_f32 v238,-4.0,v234,v236
M v[80:83],a[220:223],a[244:247],v[80:83]
buffer_load_dwordx4 a[252:255],v250,s[20:23],s46 offen offset:0 sc1
M v[80:83],a[208:211],a[204:207],v[80:83]
v_fmac_f32 v232,s45,v236
v_fmac_f32 v237,s41,v235
M v[84:87],a[208:211],a[212:215],v[84:87]
v_sub_f32 v236,v236,v234
v_fma_f32 v234,-4.0,v233,v235
M v[84:87],a[220:223],a[204:207],v[84:87]
ds_read_b128 a[224:227],v248 offset:26112
v_sub_f32 v235,v235,v233
M v[84:87],v[228:231],a[244:247],v[84:87]
ds_read_b128 a[236:239],v249 offset:26112
v_add_f32 v233,v238,v234
M v[88:91],v[228:231],a[204:207],v[88:91]
ds_read_b128 a[244:247],v248 offset:26624
v_sub_f32 v238,v238,v234
M v[88:91],a[220:223],a[212:215],v[88:91]
ds_read_b128 a[204:207],v249 offset:26624
v_fma_f32 v234,2.0,v235,v236
M v[88:91],a[208:211],a[228:231],v[88:91]
v_fmac_f32 v236,-2.0,v235
v_and_b32 v210,s42,v210
M v[92:95],a[208:211],v[220:223],v[92:95]
v_and_b32 v204,s42,v204
v_and_b32 v208,s42,v208
M v[92:95],a[220:223],a[228:231],v[92:95]
v_and_b32 v206,s42,v206
v_and_b32 v214,s42,v214
M v[92:95],v[228:231],a[212:215],v[92:95]
s_waitcnt lgkmcnt(3)
v_and_b32 v212,s42,v212
v_fmac_f32 v204,s43,v210
M v[96:99],v[216:219],a[224:227],v[96:99]
s_waitcnt vmcnt(8) lgkmcnt(2)
ds_read_b128 a[208:211],v248 offset:27136
v_fmac_f32 v206,4.0,v208
M v[96:99],a[240:243],a[236:239],v[96:99]
s_waitcnt vmcnt(7) lgkmcnt(2)
ds_read_b128 v[220:223],v249 offset:27136
v_fma_f32 v235,-4.0,v210,v214
M v[96:99],a[216:219],a[244:247],v[96:99]
s_waitcnt lgkmcnt(2)
v_fmac_f32 v204,s45,v214
v_fmac_f32 v206,s41,v212
M v[100:103],a[216:219],a[204:207],v[100:103]
v_sub_f32 v214,v214,v210
v_fma_f32 v210,-4.0,v208,v212
M v[100:103],a[240:243],a[244:247],v[100:103]
v_sub_f32 v212,v212,v208
v_add_f32 v208,v235,v210
M v[100:103],v[216:219],a[236:239],v[100:103]
v_sub_f32 v235,v235,v210
v_fma_f32 v210,2.0,v212,v214
M v[104:107],v[216:219],a[244:247],v[104:107]
ds_read_b128 a[220:223],v248 offset:27648
v_fmac_f32 v214,-2.0,v212
M v[104:107],a[240:243],a[204:207],v[104:107]
s_waitcnt lgkmcnt(2)
ds_read_b128 a[228:231],v249 offset:27648
v_cvt_pk_bf16_f32 v204,v232,v204
M v[104:107],a[216:219],a[208:211],v[104:107]
s_waitcnt lgkmcnt(2)
v_cvt_pk_bf16_f32 v206,v237,v206
v_cvt_pk_bf16_f32 v208,v233,v208
M v[108:111],a[216:219],v[220:223],v[108:111]
v_cvt_pk_bf16_f32 v212,v234,v210
v_cvt_pk_bf16_f32 v210,v238,v235
M v[108:111],a[240:243],a[208:211],v[108:111]
v_cvt_pk_bf16_f32 v214,v236,v214
v_permlane32_swap_b32 v209,v211
M v[108:111],v[216:219],a[204:207],v[108:111]
v_permlane32_swap_b32 v205,v207
v_permlane32_swap_b32 v213,v215
M v[112:115],v[216:219],a[208:211],v[112:115]
ds_read_b128 a[212:215],v249 offset:28160
v_lshlrev_b32 v234,16,v211
M v[112:115],a[240:243],v[220:223],v[112:115]
s_waitcnt lgkmcnt(2)
ds_read_b128 v[228:231],v248 offset:28160
v_lshlrev_b32 v232,16,v205
M v[112:115],a[216:219],a[220:223],v[112:115]
s_waitcnt lgkmcnt(2)
v_lshlrev_b32 v233,16,v209
v_lshlrev_b32 v237,16,v207
M v[116:119],a[216:219],a[228:231],v[116:119]
v_lshlrev_b32 v236,16,v215
v_lshlrev_b32 v235,16,v213
M v[116:119],a[240:243],a[220:223],v[116:119]
v_fmac_f32 v232,s43,v234
v_fmac_f32 v237,4.0,v233
M v[116:119],v[216:219],v[220:223],v[116:119]
v_fma_f32 v238,-4.0,v234,v236
v_fmac_f32 v232,s45,v236
M v[120:123],v[216:219],a[220:223],v[120:123]
v_fmac_f32 v237,s41,v235
v_sub_f32 v236,v236,v234
M v[120:123],a[240:243],a[228:231],v[120:123]
s_waitcnt lgkmcnt(1)
v_fma_f32 v234,-4.0,v233,v235
v_sub_f32 v235,v235,v233
M v[120:123],a[216:219],a[212:215],v[120:123]
s_waitcnt lgkmcnt(0)
v_add_f32 v233,v238,v234
v_sub_f32 v238,v238,v234
M v[124:127],a[216:219],v[228:231],v[124:127]
buffer_load_dwordx4 a[216:219],v250,s[20:23],s46 offen offset:1024 sc1
M v[124:127],a[240:243],a[212:215],v[124:127]
v_fma_f32 v234,2.0,v235,v236
v_fmac_f32 v236,-2.0,v235
M v[124:127],v[216:219],a[228:231],v[124:127]
s_waitcnt vmcnt(7)
buffer_load_dwordx4 a[240:243],v250,s[20:23],s46 offen offset:2048 sc1
M v[128:131],v[224:227],a[224:227],v[128:131]
s_waitcnt vmcnt(7)
s_add_u32 s46,s77,18432
v_and_b32 v211,s42,v211
v_and_b32 v205,s42,v205
M v[128:131],a[192:195],a[236:239],v[128:131]
s_waitcnt vmcnt(6)
v_and_b32 v209,s42,v209
v_and_b32 v207,s42,v207
M v[128:131],a[200:203],a[244:247],v[128:131]
v_and_b32 v215,s42,v215
v_and_b32 v213,s42,v213
M v[132:135],a[200:203],a[204:207],v[132:135]
buffer_load_dwordx4 v[216:219],v250,s[20:23],s46 offen offset:0 sc1
M v[132:135],a[192:195],a[244:247],v[132:135]
v_fmac_f32 v205,s43,v211
v_fmac_f32 v207,4.0,v209
M v[132:135],v[224:227],a[236:239],v[132:135]
v_fma_f32 v235,-4.0,v211,v215
v_fmac_f32 v205,s45,v215
M v[136:139],v[224:227],a[244:247],v[136:139]
v_fmac_f32 v207,s41,v213
v_sub_f32 v215,v215,v211
M v[136:139],a[192:195],a[204:207],v[136:139]
v_fma_f32 v211,-4.0,v209,v213
v_sub_f32 v213,v213,v209
M v[136:139],a[200:203],a[208:211],v[136:139]
v_add_f32 v209,v235,v211
v_sub_f32 v235,v235,v211
M v[140:143],a[200:203],v[220:223],v[140:143]
v_fma_f32 v211,2.0,v213,v215
v_fmac_f32 v215,-2.0,v213
M v[140:143],a[192:195],a[208:211],v[140:143]
v_cvt_pk_bf16_f32 v205,v232,v205
v_cvt_pk_bf16_f32 v207,v237,v207
M v[140:143],v[224:227],a[204:207],v[140:143]
v_cvt_pk_bf16_f32 v209,v233,v209
v_cvt_pk_bf16_f32 v213,v234,v211
M v[144:147],v[224:227],a[208:211],v[144:147]
v_cvt_pk_bf16_f32 v211,v238,v235
v_cvt_pk_bf16_f32 v215,v236,v215
M v[144:147],a[192:195],v[220:223],v[144:147]
M v[144:147],a[200:203],a[220:223],v[144:147]
ds_write2st64_b64 v247,v[204:205],v[206:207] offset0:139 offset1:156
M v[148:151],a[200:203],a[228:231],v[148:151]
M v[148:151],a[192:195],a[220:223],v[148:151]
M v[148:151],v[224:227],v[220:223],v[148:151]
ds_write2st64_b64 v247,v[208:209],v[210:211] offset0:3 offset1:20
M v[152:155],v[224:227],a[220:223],v[152:155]
M v[152:155],a[192:195],a[228:231],v[152:155]
M v[152:155],a[200:203],a[212:215],v[152:155]
ds_write2st64_b64 v247,v[212:213],v[214:215] offset0:37 offset1:54
M v[156:159],a[200:203],v[228:231],v[156:159]
buffer_load_dwordx4 a[200:203],v250,s[20:23],s46 offen offset:1024 sc1
M v[156:159],a[192:195],a[212:215],v[156:159]
M v[156:159],v[224:227],a[228:231],v[156:159]
s_waitcnt vmcnt(7)
buffer_load_dwordx4 a[192:195],v250,s[20:23],s46 offen offset:2048 sc1
M v[160:163],a[248:251],a[224:227],v[160:163]
s_waitcnt vmcnt(7)
s_add_u32 s46,s77,27648
M v[160:163],a[196:199],a[236:239],v[160:163]
s_waitcnt vmcnt(6)
M v[160:163],a[232:235],a[244:247],v[160:163]
M v[164:167],a[232:235],a[204:207],v[164:167]
buffer_load_dwordx4 v[224:227],v250,s[20:23],s46 offen offset:0 sc1
M v[164:167],a[196:199],a[244:247],v[164:167]
M v[164:167],a[248:251],a[236:239],v[164:167]
M v[168:171],a[248:251],a[244:247],v[168:171]
M v[168:171],a[196:199],a[204:207],v[168:171]
buffer_load_dwordx4 a[224:227],v250,s[20:23],s46 offen offset:1024 sc1
M v[168:171],a[232:235],a[208:211],v[168:171]
M v[172:175],a[232:235],v[220:223],v[172:175]
M v[172:175],a[196:199],a[208:211],v[172:175]
M v[172:175],a[248:251],a[204:207],v[172:175]
buffer_load_dwordx4 a[236:239],v250,s[20:23],s46 offen offset:2048 sc1
M v[176:179],a[248:251],a[208:211],v[176:179]
s_add_u32 s46,s77,36864
M v[176:179],a[196:199],v[220:223],v[176:179]
v_add_u32 v248,0xffffbc00,v248
v_add_u32 v249,0xffffbc00,v249
M v[176:179],a[232:235],a[220:223],v[176:179]
s_waitcnt lgkmcnt(0)
s_barrier
M v[180:183],a[232:235],a[228:231],v[180:183]
buffer_load_dwordx4 a[244:247],v250,s[20:23],s46 offen offset:0 sc1
M v[180:183],a[196:199],a[220:223],v[180:183]
ds_read_b128 a[204:207],v248 offset:0
M v[180:183],a[248:251],v[220:223],v[180:183]
ds_read_b128 a[208:211],v249 offset:0
M v[184:187],a[248:251],a[220:223],v[184:187]
ds_read_b128 v[220:223],v248 offset:512
M v[184:187],a[196:199],a[228:231],v[184:187]
ds_read_b128 a[220:223],v249 offset:512
M v[184:187],a[232:235],a[212:215],v[184:187]
M v[188:191],a[232:235],v[228:231],v[188:191]
buffer_load_dwordx4 a[232:235],v250,s[20:23],s46 offen offset:1024 sc1
M v[188:191],a[196:199],a[212:215],v[188:191]
M v[188:191],a[248:251],a[228:231],v[188:191]
s_waitcnt vmcnt(10) lgkmcnt(3)
buffer_load_dwordx4 v[228:231],v250,s[20:23],s46 offen offset:2048 sc1
M a[0:3],a[252:255],a[204:207],a[0:3]
s_waitcnt vmcnt(10) lgkmcnt(2)
s_add_u32 s47,s77,12288
ds_read_b128 a[212:215],v248 offset:1024
M a[0:3],a[216:219],a[208:211],a[0:3]
s_waitcnt vmcnt(9) lgkmcnt(2)
ds_read_b128 a[228:231],v249 offset:1024
M a[0:3],a[240:243],v[220:223],a[0:3]
s_waitcnt lgkmcnt(2)
M a[4:7],a[240:243],a[220:223],a[4:7]
buffer_load_dwordx4 a[196:199],v250,s[20:23],s47 offen offset:0 sc1
M a[4:7],a[216:219],v[220:223],a[4:7]
M a[4:7],a[252:255],a[208:211],a[4:7]
M a[8:11],a[252:255],v[220:223],a[8:11]
ds_read_b128 a[248:251],v248 offset:1536
M a[8:11],a[216:219],a[220:223],a[8:11]
s_waitcnt lgkmcnt(2)
ds_read_b128 a[204:207],v249 offset:1536
M a[8:11],a[240:243],a[212:215],a[8:11]
s_waitcnt lgkmcnt(2)
M a[12:15],a[240:243],a[228:231],a[12:15]
M a[12:15],a[216:219],a[212:215],a[12:15]
M a[12:15],a[252:255],a[220:223],a[12:15]
M a[16:19],a[252:255],a[212:215],a[16:19]
ds_read_b128 a[208:211],v249 offset:2048
M a[16:19],a[216:219],a[228:231],a[16:19]
s_waitcnt lgkmcnt(2)
ds_read_b128 v[220:223],v248 offset:2048
M a[16:19],a[240:243],a[248:251],a[16:19]
s_waitcnt lgkmcnt(2)
M a[20:23],a[240:243],a[204:207],a[20:23]
M a[20:23],a[216:219],a[248:251],a[20:23]
ds_read_b128 a[220:223],v248 offset:8704
M a[20:23],a[252:255],a[228:231],a[20:23]
ds_read_b128 a[212:215],v249 offset:8704
M a[24:27],a[252:255],a[248:251],a[24:27]
ds_read_b128 a[228:231],v248 offset:9216
M a[24:27],a[216:219],a[204:207],a[24:27]
s_waitcnt lgkmcnt(4)
ds_read_b128 a[248:251],v249 offset:9216
M a[24:27],a[240:243],a[208:211],a[24:27]
s_waitcnt lgkmcnt(4)
M a[28:31],a[240:243],v[220:223],a[28:31]
buffer_load_dwordx4 a[240:243],v250,s[20:23],s47 offen offset:1024 sc1
M a[28:31],a[216:219],a[208:211],a[28:31]
M a[28:31],a[252:255],a[204:207],a[28:31]
s_waitcnt vmcnt(10) lgkmcnt(3)
buffer_load_dwordx4 v[220:223],v250,s[20:23],s47 offen offset:2048 sc1
M a[96:99],v[216:219],a[220:223],a[96:99]
s_waitcnt vmcnt(10) lgkmcnt(2)
s_add_u32 s48,s77,15360
ds_read_b128 a[216:219],v248 offset:9728
M a[96:99],a[200:203],a[212:215],a[96:99]
s_waitcnt vmcnt(9) lgkmcnt(2)
ds_read_b128 a[204:207],v249 offset:9728
M a[96:99],a[192:195],a[228:231],a[96:99]
s_waitcnt lgkmcnt(2)
M a[100:103],a[192:195],a[248:251],a[100:103]
buffer_load_dwordx4 a[208:211],v250,s[20:23],s48 offen offset:0 sc1
M a[100:103],a[200:203],a[228:231],a[100:103]
M a[100:103],v[216:219],a[212:215],a[100:103]
M a[104:107],v[216:219],a[228:231],a[104:107]
ds_read_b128 a[252:255],v248 offset:10240
M a[104:107],a[200:203],a[248:251],a[104:107]
s_waitcnt lgkmcnt(2)
ds_read_b128 a[220:223],v249 offset:10240
M a[104:107],a[192:195],a[216:219],a[104:107]
s_waitcnt lgkmcnt(2)
M a[108:111],a[192:195],a[204:207],a[108:111]
M a[108:111],a[200:203],a[216:219],a[108:111]
M a[108:111],v[216:219],a[248:251],a[108:111]
M a[112:115],v[216:219],a[216:219],a[112:115]
ds_read_b128 a[212:215],v249 offset:10752
M a[112:115],a[200:203],a[204:207],a[112:115]
s_waitcnt lgkmcnt(2)
ds_read_b128 a[228:231],v248 offset:10752
M a[112:115],a[192:195],a[252:255],a[112:115]
s_waitcnt lgkmcnt(2)
M a[116:119],a[192:195],a[220:223],a[116:119]
M a[116:119],a[200:203],a[252:255],a[116:119]
ds_read_b128 a[248:251],v248 offset:17408
M a[116:119],v[216:219],a[204:207],a[116:119]
ds_read_b128 a[216:219],v249 offset:17408
M a[120:123],v[216:219],a[252:255],a[120:123]
ds_read_b128 a[204:207],v248 offset:17920
M a[120:123],a[200:203],a[220:223],a[120:123]
s_waitcnt lgkmcnt(4)
ds_read_b128 a[252:255],v249 offset:17920
M a[120:123],a[192:195],a[212:215],a[120:123]
s_waitcnt lgkmcnt(4)
M a[124:127],a[192:195],a[228:231],a[124:127]
buffer_load_dwordx4 a[192:195],v250,s[20:23],s48 offen offset:1024 sc1
M a[124:127],a[200:203],a[212:215],a[124:127]
M a[124:127],v[216:219],a[220:223],a[124:127]
s_waitcnt vmcnt(10) lgkmcnt(3)
buffer_load_dwordx4 a[228:231],v250,s[20:23],s48 offen offset:2048 sc1
M v[0:3],v[224:227],a[248:251],v[0:3]
s_waitcnt vmcnt(10) lgkmcnt(2)
s_add_u32 s47,s77,21504
ds_read_b128 a[212:215],v248 offset:18432
M v[0:3],a[224:227],a[216:219],v[0:3]
s_waitcnt vmcnt(9) lgkmcnt(2)
ds_read_b128 a[220:223],v249 offset:18432
M v[0:3],a[236:239],a[204:207],v[0:3]
s_waitcnt lgkmcnt(2)
M v[4:7],a[236:239],a[252:255],v[4:7]
buffer_load_dwordx4 a[200:203],v250,s[20:23],s47 offen offset:0 sc1
M v[4:7],a[224:227],a[204:207],v[4:7]
M v[4:7],v[224:227],a[216:219],v[4:7]
M v[8:11],v[224:227],a[204:207],v[8:11]
ds_read_b128 v[216:219],v248 offset:18944
M v[8:11],a[224:227],a[252:255],v[8:11]
s_waitcnt lgkmcnt(2)
ds_read_b128 a[248:251],v249 offset:18944
M v[8:11],a[236:239],a[212:215],v[8:11]
s_waitcnt lgkmcnt(2)
M v[12:15],a[236:239],a[220:223],v[12:15]
M v[12:15],a[224:227],a[212:215],v[12:15]
M v[12:15],v[224:227],a[252:255],v[12:15]
M v[16:19],v[224:227],a[212:215],v[16:19]
ds_read_b128 a[216:219],v249 offset:19456
M v[16:19],a[224:227],a[220:223],v[16:19]
s_waitcnt lgkmcnt(2)
ds_read_b128 a[204:207],v248 offset:19456
M v[16:19],a[236:239],v[216:219],v[16:19]
s_waitcnt lgkmcnt(2)
M v[20:23],a[236:239],a[248:251],v[20:23]
M v[20:23],a[224:227],v[216:219],v[20:23]
ds_read_b128 a[252:255],v248 offset:26112
M v[20:23],v[224:227],a[220:223],v[20:23]
ds_read_b128 a[212:215],v249 offset:26112
M v[24:27],v[224:227],v[216:219],v[24:27]
ds_read_b128 a[220:223],v248 offset:26624
M v[24:27],a[224:227],a[248:251],v[24:27]
s_waitcnt lgkmcnt(4)
ds_read_b128 v[216:219],v249 offset:26624
M v[24:27],a[236:239],a[216:219],v[24:27]
s_waitcnt lgkmcnt(4)
M v[28:31],a[236:239],a[204:207],v[28:31]
buffer_load_dwordx4 a[204:207],v250,s[20:23],s47 offen offset:1024 sc1
M v[28:31],a[224:227],a[216:219],v[28:31]
M v[28:31],v[224:227],a[248:251],v[28:31]
s_waitcnt vmcnt(10) lgkmcnt(3)
buffer_load_dwordx4 a[236:239],v250,s[20:23],s47 offen offset:2048 sc1
M v[96:99],a[244:247],a[252:255],v[96:99]
s_waitcnt vmcnt(10) lgkmcnt(2)
s_add_u32 s48,s77,24576
ds_read_b128 a[224:227],v248 offset:27136
M v[96:99],a[232:235],a[212:215],v[96:99]
s_waitcnt vmcnt(9) lgkmcnt(2)
ds_read_b128 a[248:251],v249 offset:27136
M v[96:99],v[228:231],a[220:223],v[96:99]
s_waitcnt lgkmcnt(2)
M v[100:103],v[228:231],v[216:219],v[100:103]
buffer_load_dwordx4 a[216:219],v250,s[20:23],s48 offen offset:0 sc1
M v[100:103],a[232:235],a[220:223],v[100:103]
M v[100:103],a[244:247],a[212:215],v[100:103]
v_accvgpr_read_b32 v238,a0
v_accvgpr_read_b32 v232,a96
M v[104:107],a[244:247],a[220:223],v[104:107]
ds_read_b128 v[224:227],v248 offset:27648
v_add_f32 v234,v238,v232
M v[104:107],a[232:235],v[216:219],v[104:107]
s_waitcnt lgkmcnt(2)
ds_read_b128 a[252:255],v249 offset:27648
v_sub_f32 v238,v238,v232
M v[104:107],v[228:231],a[224:227],v[104:107]
s_waitcnt lgkmcnt(2)
v_add_f32 v232,v0,v96
v_sub_f32 v96,v0,v96
M v[108:111],v[228:231],a[248:251],v[108:111]
v_add_f32 v0,v234,v232
v_fmac_f32 v234,4.0,v232
M v[108:111],a[232:235],a[224:227],v[108:111]
v_fma_f32 v232,2.0,v96,v238
v_fma_f32 v96,s40,v96,v238
M v[108:111],a[244:247],v[216:219],v[108:111]
v_accvgpr_read_b32 v238,a1
v_accvgpr_read_b32 v237,a97
M v[112:115],a[244:247],a[224:227],v[112:115]
ds_read_b128 a[212:215],v249 offset:28160
v_add_f32 v236,v238,v237
M v[112:115],a[232:235],a[248:251],v[112:115]
s_waitcnt lgkmcnt(2)
ds_read_b128 a[220:223],v248 offset:28160
v_sub_f32 v238,v238,v237
M v[112:115],v[228:231],v[224:227],v[112:115]
s_waitcnt lgkmcnt(2)
v_add_f32 v237,v1,v97
v_sub_f32 v97,v1,v97
M v[116:119],v[228:231],a[252:255],v[116:119]
v_add_f32 v1,v236,v237
v_fmac_f32 v236,4.0,v237
M v[116:119],a[232:235],v[224:227],v[116:119]
ds_read_b128 v[216:219],v248 offset:0
v_fma_f32 v237,2.0,v97,v238
M v[116:119],a[244:247],a[248:251],v[116:119]
ds_read_b128 a[224:227],v249 offset:0
v_fma_f32 v97,s40,v97,v238
M v[120:123],a[244:247],v[224:227],v[120:123]
ds_read_b128 a[248:251],v248 offset:512
v_cvt_pk_bf16_f32 v232,v232,v237
M v[120:123],a[232:235],a[252:255],v[120:123]
s_waitcnt lgkmcnt(4)
ds_read_b128 v[224:227],v249 offset:512
v_cvt_pk_bf16_f32 v234,v234,v236
M v[120:123],v[228:231],a[212:215],v[120:123]
s_waitcnt lgkmcnt(4)
v_accvgpr_read_b32 v238,a2
v_accvgpr_read_b32 v233,a98
M v[124:127],v[228:231],a[220:223],v[124:127]
buffer_load_dwordx4 a[220:223],v250,s[20:23],s48 offen offset:1024 sc1
M v[124:127],a[232:235],a[212:215],v[124:127]
v_add_f32 v235,v238,v233
v_sub_f32 v238,v238,v233
M v[124:127],a[244:247],a[252:255],v[124:127]
s_waitcnt vmcnt(10) lgkmcnt(3)
v_add_f32 v233,v2,v98
v_sub_f32 v98,v2,v98
M a[32:35],a[196:199],v[216:219],a[32:35]
s_waitcnt vmcnt(9) lgkmcnt(2)
ds_read_b128 v[228:231],v248 offset:1024
v_add_f32 v2,v235,v233
M a[32:35],a[240:243],a[224:227],a[32:35]
s_waitcnt vmcnt(8) lgkmcnt(2)
ds_read_b128 a[212:215],v249 offset:1024
v_fmac_f32 v235,4.0,v233
M a[32:35],v[220:223],a[248:251],a[32:35]
s_waitcnt lgkmcnt(2)
v_fma_f32 v233,2.0,v98,v238
v_fma_f32 v98,s40,v98,v238
M a[36:39],v[220:223],v[224:227],a[36:39]
v_accvgpr_read_b32 v238,a3
v_accvgpr_read_b32 v237,a99
M a[36:39],a[240:243],a[248:251],a[36:39]
v_add_f32 v236,v238,v237
v_sub_f32 v238,v238,v237
M a[36:39],a[196:199],a[224:227],a[36:39]
v_add_f32 v237,v3,v99
v_sub_f32 v99,v3,v99
M a[40:43],a[196:199],a[248:251],a[40:43]
ds_read_b128 a[96:99],v248 offset:1536
v_add_f32 v3,v236,v237
M a[40:43],a[240:243],v[224:227],a[40:43]
s_waitcnt lgkmcnt(2)
ds_read_b128 a[232:235],v249 offset:1536
v_fmac_f32 v236,4.0,v237
M a[40:43],v[220:223],v[228:231],a[40:43]
s_waitcnt lgkmcnt(2)
v_fma_f32 v237,2.0,v99,v238
v_fma_f32 v99,s40,v99,v238
M a[44:47],v[220:223],a[212:215],a[44:47]
v_cvt_pk_bf16_f32 v233,v233,v237
v_cvt_pk_bf16_f32 v235,v235,v236
M a[44:47],a[240:243],v[228:231],a[44:47]
ds_write2st64_b64 v254,v[232:233],v[234:235] offset0:68 offset1:72
M a[44:47],a[196:199],v[224:227],a[44:47]
v_accvgpr_read_b32 v238,a4
v_accvgpr_read_b32 v232,a100
M a[48:51],a[196:199],v[228:231],a[48:51]
ds_read_b128 a[244:247],v249 offset:2048
v_add_f32 v234,v238,v232
M a[48:51],a[240:243],a[212:215],a[48:51]
s_waitcnt lgkmcnt(3)
ds_read_b128 a[252:255],v248 offset:2048
v_sub_f32 v238,v238,v232
M a[48:51],v[220:223],a[96:99],a[48:51]
s_waitcnt lgkmcnt(3)
v_add_f32 v232,v4,v100
v_sub_f32 v100,v4,v100
M a[52:55],v[220:223],a[232:235],a[52:55]
v_add_f32 v4,v234,v232
v_fmac_f32 v234,4.0,v232
M a[52:55],a[240:243],a[96:99],a[52:55]
v_fma_f32 v232,2.0,v100,v238
v_fma_f32 v100,s40,v100,v238
M a[52:55],a[196:199],a[212:215],a[52:55]
v_accvgpr_read_b32 v238,a5
v_accvgpr_read_b32 v237,a101
M a[56:59],a[196:199],a[96:99],a[56:59]
v_add_f32 v236,v238,v237
v_sub_f32 v238,v238,v237
M a[56:59],a[240:243],a[232:235],a[56:59]
s_waitcnt lgkmcnt(1)
v_add_f32 v237,v5,v101
v_sub_f32 v101,v5,v101
M a[56:59],v[220:223],a[244:247],a[56:59]
s_waitcnt lgkmcnt(0)
v_add_f32 v5,v236,v237
v_fmac_f32 v236,4.0,v237
M a[60:63],v[220:223],a[252:255],a[60:63]
buffer_load_dwordx4 v[220:223],v250,s[20:23],s48 offen offset:2048 sc1
M a[60:63],a[240:243],a[244:247],a[60:63]
s_add_u32 s47,s77,30720
v_fma_f32 v237,2.0,v101,v238
v_fma_f32 v101,s40,v101,v238
M a[60:63],a[196:199],a[232:235],a[60:63]
s_waitcnt vmcnt(8)
buffer_load_dwordx4 a[240:243],v250,s[20:23],s47 offen offset:0 sc1
M a[64:67],a[208:211],v[216:219],a[64:67]
s_waitcnt vmcnt(8)
v_cvt_pk_bf16_f32 v232,v232,v237
v_cvt_pk_bf16_f32 v234,v234,v236
M a[64:67],a[192:195],a[224:227],a[64:67]
s_waitcnt vmcnt(7)
v_accvgpr_read_b32 v238,a6
v_accvgpr_read_b32 v233,a102
M a[64:67],a[228:231],a[248:251],a[64:67]
v_add_f32 v235,v238,v233
v_sub_f32 v238,v238,v233
M a[68:71],a[228:231],v[224:227],a[68:71]
buffer_load_dwordx4 a[196:199],v250,s[20:23],s47 offen offset:1024 sc1
M a[68:71],a[192:195],a[248:251],a[68:71]
v_add_f32 v233,v6,v102
v_sub_f32 v102,v6,v102
M a[68:71],a[208:211],a[224:227],a[68:71]
v_add_f32 v6,v235,v233
v_fmac_f32 v235,4.0,v233
M a[72:75],a[208:211],a[248:251],a[72:75]
v_fma_f32 v233,2.0,v102,v238
v_fma_f32 v102,s40,v102,v238
M a[72:75],a[192:195],v[224:227],a[72:75]
buffer_load_dwordx4 v[216:219],v250,s[20:23],s47 offen offset:2048 sc1
M a[72:75],a[228:231],v[228:231],a[72:75]
s_add_u32 s48,s77,33792
v_accvgpr_read_b32 v238,a7
v_accvgpr_read_b32 v237,a103
M a[76:79],a[228:231],a[212:215],a[76:79]
v_add_f32 v236,v238,v237
v_sub_f32 v238,v238,v237
M a[76:79],a[192:195],v[228:231],a[76:79]
v_add_f32 v237,v7,v103
v_sub_f32 v103,v7,v103
M a[76:79],a[208:211],v[224:227],a[76:79]
buffer_load_dwordx4 a[224:227],v250,s[20:23],s48 offen offset:0 sc1
M a[80:83],a[208:211],v[228:231],a[80:83]
v_add_f32 v7,v236,v237
v_fmac_f32 v236,4.0,v237
M a[80:83],a[192:195],a[212:215],a[80:83]
v_fma_f32 v237,2.0,v103,v238
v_fma_f32 v103,s40,v103,v238
M a[80:83],a[228:231],a[96:99],a[80:83]
v_cvt_pk_bf16_f32 v233,v233,v237
v_cvt_pk_bf16_f32 v235,v235,v236
M a[84:87],a[228:231],a[232:235],a[84:87]
buffer_load_dwordx4 a[248:251],v250,s[20:23],s48 offen offset:1024 sc1
M a[84:87],a[192:195],a[96:99],a[84:87]
ds_read_b128 v[224:227],v248 offset:8704
ds_write2st64_b64 v254,v[232:233],v[234:235] offset0:76 offset1:80
M a[84:87],a[208:211],a[212:215],a[84:87]
ds_read_b128 v[228:231],v249 offset:8704
v_accvgpr_read_b32 v238,a8
M a[88:91],a[208:211],a[96:99],a[88:91]
buffer_load_dwordx4 a[100:103],v250,s[20:23],s48 offen offset:2048 sc1
M a[88:91],a[192:195],a[232:235],a[88:91]
ds_read_b128 a[96:99],v248 offset:9216
ds_read_b128 a[212:215],v249 offset:9216
M a[88:91],a[228:231],a[244:247],a[88:91]
v_accvgpr_read_b32 v232,a104
v_add_f32 v234,v238,v232
M a[92:95],a[228:231],a[252:255],a[92:95]
v_sub_f32 v238,v238,v232
v_add_f32 v232,v8,v104
M a[92:95],a[192:195],a[244:247],a[92:95]
v_sub_f32 v104,v8,v104
v_add_f32 v8,v234,v232
M a[92:95],a[208:211],a[232:235],a[92:95]
s_waitcnt vmcnt(11) lgkmcnt(4)
v_fmac_f32 v234,4.0,v232
v_fma_f32 v232,2.0,v104,v238
M a[128:131],a[200:203],v[224:227],a[128:131]
s_waitcnt vmcnt(10) lgkmcnt(2)
ds_read_b128 a[228:231],v248 offset:9728
v_fma_f32 v104,s40,v104,v238
M a[128:131],a[204:207],v[228:231],a[128:131]
s_waitcnt vmcnt(9) lgkmcnt(2)
s_barrier
ds_read_b128 a[0:3],v250 offset:34816
M a[128:131],a[236:239],a[96:99],a[128:131]
s_waitcnt lgkmcnt(2)
ds_read_b128 a[4:7],v250 offset:38912
ds_read_b128 a[252:255],v249 offset:9728
M a[132:135],a[236:239],a[212:215],a[132:135]
v_accvgpr_read_b32 v238,a9
v_accvgpr_read_b32 v237,a105
M a[132:135],a[204:207],a[96:99],a[132:135]
v_add_f32 v236,v238,v237
v_sub_f32 v238,v238,v237
M a[132:135],a[200:203],v[228:231],a[132:135]
v_add_f32 v237,v9,v105
v_sub_f32 v105,v9,v105
M a[136:139],a[200:203],a[96:99],a[136:139]
s_add_u32 s34,s32,6291456
ds_read_b128 a[192:195],v248 offset:10240
v_add_f32 v9,v236,v237
M a[136:139],a[204:207],a[212:215],a[136:139]
s_waitcnt lgkmcnt(4)
ds_read_b128 a[244:247],v249 offset:10240
v_fmac_f32 v236,4.0,v237
M a[136:139],a[236:239],a[228:231],a[136:139]
s_waitcnt lgkmcnt(2)
buffer_store_dwordx4 a[0:3],v253,s[24:27],s34 offen offset:384 nt
M a[140:143],a[236:239],a[252:255],a[140:143]
v_fma_f32 v237,2.0,v105,v238
v_fma_f32 v105,s40,v105,v238
M a[140:143],a[204:207],a[228:231],a[140:143]
v_cvt_pk_bf16_f32 v232,v232,v237
v_cvt_pk_bf16_f32 v234,v234,v236
M a[140:143],a[200:203],a[212:215],a[140:143]
v_accvgpr_read_b32 v238,a10
v_accvgpr_read_b32 v233,a106
M a[144:147],a[200:203],a[228:231],a[144:147]
ds_read_b128 a[208:211],v249 offset:10752
v_add_f32 v235,v238,v233
M a[144:147],a[204:207],a[252:255],a[144:147]
s_waitcnt lgkmcnt(2)
ds_read_b128 a[232:235],v248 offset:10752
v_sub_f32 v238,v238,v233
M a[144:147],a[236:239],a[192:195],a[144:147]
s_waitcnt lgkmcnt(2)
v_add_f32 v233,v10,v106
v_sub_f32 v106,v10,v106
M a[148:151],a[236:239],a[244:247],a[148:151]
s_add_u32 s47,s77,39936
v_add_f32 v10,v235,v233
v_fmac_f32 v235,4.0,v233
M a[148:151],a[204:207],a[192:195],a[148:151]
v_fma_f32 v233,2.0,v106,v238
v_fma_f32 v106,s40,v106,v238
M a[148:151],a[200:203],a[252:255],a[148:151]
v_accvgpr_read_b32 v238,a11
v_accvgpr_read_b32 v237,a107
M a[152:155],a[200:203],a[192:195],a[152:155]
v_add_f32 v236,v238,v237
v_sub_f32 v238,v238,v237
M a[152:155],a[204:207],a[244:247],a[152:155]
s_waitcnt lgkmcnt(1)
v_add_f32 v237,v11,v107
v_sub_f32 v107,v11,v107
M a[152:155],a[236:239],a[208:211],a[152:155]
s_waitcnt lgkmcnt(0)
v_add_f32 v11,v236,v237
v_fmac_f32 v236,4.0,v237
M a[156:159],a[236:239],a[232:235],a[156:159]
buffer_load_dwordx4 a[104:107],v250,s[20:23],s47 offen offset:0 sc1
M a[156:159],a[204:207],a[208:211],a[156:159]
v_fma_f32 v237,2.0,v107,v238
v_fma_f32 v107,s40,v107,v238
M a[156:159],a[200:203],a[244:247],a[156:159]
s_waitcnt vmcnt(10)
buffer_load_dwordx4 a[236:239],v250,s[20:23],s47 offen offset:1024 sc1
M a[160:163],a[216:219],v[224:227],a[160:163]
s_waitcnt vmcnt(10)
v_cvt_pk_bf16_f32 v233,v233,v237
v_cvt_pk_bf16_f32 v235,v235,v236
M a[160:163],a[220:223],v[228:231],a[160:163]
s_waitcnt vmcnt(9)
ds_write2st64_b64 v254,v[232:233],v[234:235] offset0:85 offset1:89
M a[160:163],v[220:223],a[96:99],a[160:163]
v_accvgpr_read_b32 v204,a12
v_accvgpr_read_b32 v208,a108
M a[164:167],v[220:223],a[212:215],a[164:167]
buffer_load_dwordx4 a[204:207],v250,s[20:23],s47 offen offset:2048 sc1
M a[164:167],a[220:223],a[96:99],a[164:167]
s_add_u32 s48,s77,43008
s_add_u32 s34,s32,6488064
v_accvgpr_read_b32 v205,a13
M a[164:167],a[216:219],v[228:231],a[164:167]
v_accvgpr_read_b32 v209,a109
v_accvgpr_read_b32 v206,a14
M a[168:171],a[216:219],a[96:99],a[168:171]
v_accvgpr_read_b32 v210,a110
v_accvgpr_read_b32 v207,a15
v_accvgpr_read_b32 v211,a111
v_pk_add_f32 v[212:213],v[204:205],v[208:209]
v_pk_add_f32 v[214:215],v[206:207],v[210:211]
v_pk_add_f32 v[204:205],v[204:205],v[208:209] neg_lo:[0,1] neg_hi:[0,1]
v_pk_add_f32 v[206:207],v[206:207],v[210:211] neg_lo:[0,1] neg_hi:[0,1]
v_pk_add_f32 v[208:209],v[12:13],v[108:109]
v_pk_add_f32 v[210:211],v[14:15],v[110:111]
v_pk_add_f32 v[108:109],v[12:13],v[108:109] neg_lo:[0,1] neg_hi:[0,1]
v_pk_add_f32 v[110:111],v[14:15],v[110:111] neg_lo:[0,1] neg_hi:[0,1]
v_pk_add_f32 v[12:13],v[212:213],v[208:209]
v_pk_add_f32 v[14:15],v[214:215],v[210:211]
v_pk_fma_f32 v[212:213],v[208:209],4.0,v[212:213] op_sel_hi:[1,0,1]
v_pk_fma_f32 v[214:215],v[210:211],4.0,v[214:215] op_sel_hi:[1,0,1]
v_pk_fma_f32 v[208:209],v[108:109],2.0,v[204:205] op_sel_hi:[1,0,1]
v_pk_fma_f32 v[210:211],v[110:111],2.0,v[206:207] op_sel_hi:[1,0,1]
v_pk_fma_f32 v[108:109],v[108:109],s[40:41],v[204:205] op_sel_hi:[1,0,1]
v_pk_fma_f32 v[110:111],v[110:111],s[40:41],v[206:207] op_sel_hi:[1,0,1]
M a[168:171],a[220:223],a[212:215],a[168:171]
buffer_load_dwordx4 a[200:203],v250,s[20:23],s48 offen offset:0 sc1
M a[168:171],v[220:223],a[228:231],a[168:171]
v_cvt_pk_bf16_f32 v208,v208,v209
v_cvt_pk_bf16_f32 v209,v210,v211
M a[172:175],v[220:223],a[252:255],a[172:175]
buffer_load_dwordx4 v[224:227],v250,s[20:23],s48 offen offset:1024 sc1
M a[172:175],a[220:223],a[228:231],a[172:175]
v_cvt_pk_bf16_f32 v212,v212,v213
v_cvt_pk_bf16_f32 v213,v214,v215
M a[172:175],a[216:219],a[212:215],a[172:175]
ds_write2st64_b64 v254,v[208:209],v[212:213] offset0:93 offset1:97
M a[176:179],a[216:219],a[228:231],a[176:179]
v_accvgpr_read_b32 v238,a16
v_accvgpr_read_b32 v232,a112
M a[176:179],a[220:223],a[252:255],a[176:179]
buffer_load_dwordx4 v[228:231],v250,s[20:23],s48 offen offset:2048 sc1
M a[176:179],v[220:223],a[192:195],a[176:179]
s_add_u32 s46,s72,0
v_add_f32 v234,v238,v232
v_sub_f32 v238,v238,v232
M a[180:183],v[220:223],a[244:247],a[180:183]
v_add_f32 v232,v16,v112
v_sub_f32 v112,v16,v112
M a[180:183],a[220:223],a[192:195],a[180:183]
ds_read_b128 a[212:215],v248 offset:17408
v_add_f32 v16,v234,v232
M a[180:183],a[216:219],a[252:255],a[180:183]
buffer_store_dwordx4 a[4:7],v253,s[24:27],s34 offen offset:384 nt
M a[184:187],a[216:219],a[192:195],a[184:187]
ds_read_b128 a[228:231],v249 offset:17408
ds_read_b128 a[252:255],v248 offset:17920
M a[184:187],a[220:223],a[244:247],a[184:187]
ds_read_b128 a[192:195],v249 offset:17920
v_fmac_f32 v234,4.0,v232
M a[184:187],v[220:223],a[208:211],a[184:187]
buffer_load_dwordx4 a[96:99],v250,s[20:23],s46 offen offset:0 sc1
M a[188:191],v[220:223],a[232:235],a[188:191]
v_fma_f32 v232,2.0,v112,v238
v_fma_f32 v112,s40,v112,v238
M a[188:191],a[220:223],a[208:211],a[188:191]
s_waitcnt lgkmcnt(4)
s_barrier
ds_read_b128 a[8:11],v250 offset:43520
M a[188:191],a[216:219],a[244:247],a[188:191]
s_waitcnt vmcnt(14) lgkmcnt(4)
ds_read_b128 a[12:15],v250 offset:47616
v_accvgpr_read_b32 v238,a17
M v[32:35],a[240:243],a[212:215],v[32:35]
s_waitcnt vmcnt(13) lgkmcnt(4)
buffer_load_dwordx4 a[108:111],v250,s[20:23],s46 offen offset:1024 sc1
M v[32:35],a[196:199],a[228:231],v[32:35]
s_waitcnt vmcnt(13) lgkmcnt(3)
ds_read_b128 a[232:235],v248 offset:18432
ds_read_b128 v[220:223],v249 offset:18432
M v[32:35],v[216:219],a[252:255],v[32:35]
s_waitcnt lgkmcnt(4)
v_accvgpr_read_b32 v237,a113
v_add_f32 v236,v238,v237
M v[36:39],v[216:219],a[192:195],v[36:39]
s_add_u32 s34,s32,6684672
v_sub_f32 v238,v238,v237
v_add_f32 v237,v17,v113
M v[36:39],a[196:199],a[252:255],v[36:39]
v_sub_f32 v113,v17,v113
v_add_f32 v17,v236,v237
M v[36:39],a[240:243],a[228:231],v[36:39]
s_waitcnt lgkmcnt(3)
buffer_store_dwordx4 a[8:11],v253,s[24:27],s34 offen offset:384 nt
M v[40:43],a[240:243],a[252:255],v[40:43]
ds_read_b128 a[208:211],v248 offset:18944
v_fmac_f32 v236,4.0,v237
M v[40:43],a[196:199],a[192:195],v[40:43]
s_waitcnt lgkmcnt(2)
ds_read_b128 a[220:223],v249 offset:18944
v_fma_f32 v237,2.0,v113,v238
M v[40:43],v[216:219],a[232:235],v[40:43]
s_waitcnt lgkmcnt(2)
v_fma_f32 v113,s40,v113,v238
v_cvt_pk_bf16_f32 v232,v232,v237
M v[44:47],v[216:219],v[220:223],v[44:47]
v_cvt_pk_bf16_f32 v234,v234,v236
v_accvgpr_read_b32 v238,a18
M v[44:47],a[196:199],a[232:235],v[44:47]
v_accvgpr_read_b32 v233,a114
v_add_f32 v235,v238,v233
M v[44:47],a[240:243],a[192:195],v[44:47]
v_sub_f32 v238,v238,v233
v_add_f32 v233,v18,v114
M v[48:51],a[240:243],a[232:235],v[48:51]
ds_read_b128 a[216:219],v249 offset:19456
v_sub_f32 v114,v18,v114
M v[48:51],a[196:199],v[220:223],v[48:51]
s_waitcnt lgkmcnt(2)
ds_read_b128 a[244:247],v248 offset:19456
v_add_f32 v18,v235,v233
M v[48:51],v[216:219],a[208:211],v[48:51]
s_waitcnt lgkmcnt(2)
v_fmac_f32 v235,4.0,v233
v_fma_f32 v233,2.0,v114,v238
M v[52:55],v[216:219],a[220:223],v[52:55]
v_fma_f32 v114,s40,v114,v238
v_accvgpr_read_b32 v238,a19
M v[52:55],a[196:199],a[208:211],v[52:55]
v_accvgpr_read_b32 v237,a115
v_add_f32 v236,v238,v237
M v[52:55],a[240:243],v[220:223],v[52:55]
v_sub_f32 v238,v238,v237
v_add_f32 v237,v19,v115
M v[56:59],a[240:243],a[208:211],v[56:59]
v_sub_f32 v115,v19,v115
v_add_f32 v19,v236,v237
M v[56:59],a[196:199],a[220:223],v[56:59]
s_waitcnt lgkmcnt(1)
v_fmac_f32 v236,4.0,v237
v_fma_f32 v237,2.0,v115,v238
M v[56:59],v[216:219],a[216:219],v[56:59]
s_waitcnt lgkmcnt(0)
v_fma_f32 v115,s40,v115,v238
v_cvt_pk_bf16_f32 v233,v233,v237
M v[60:63],v[216:219],a[244:247],v[60:63]
buffer_load_dwordx4 a[112:115],v250,s[20:23],s46 offen offset:2048 sc1
M v[60:63],a[196:199],a[216:219],v[60:63]
s_add_u32 s46,s73,0
v_cvt_pk_bf16_f32 v235,v235,v236
M v[60:63],a[240:243],a[220:223],v[60:63]
s_waitcnt vmcnt(14)
buffer_load_dwordx4 v[216:219],v250,s[20:23],s46 offen offset:0 sc1
M v[64:67],a[224:227],a[212:215],v[64:67]
s_waitcnt vmcnt(14)
s_add_u32 s34,s32,6881280
ds_write2st64_b64 v254,v[232:233],v[234:235] offset0:68 offset1:72
M v[64:67],a[248:251],a[228:231],v[64:67]
s_waitcnt vmcnt(13)
v_accvgpr_read_b32 v238,a20
v_accvgpr_read_b32 v232,a116
M v[64:67],a[100:103],a[252:255],v[64:67]
v_add_f32 v234,v238,v232
v_sub_f32 v238,v238,v232
M v[68:71],a[100:103],a[192:195],v[68:71]
buffer_load_dwordx4 a[196:199],v250,s[20:23],s46 offen offset:1024 sc1
M v[68:71],a[248:251],a[252:255],v[68:71]
v_add_f32 v232,v20,v116
v_sub_f32 v116,v20,v116
M v[68:71],a[224:227],a[228:231],v[68:71]
v_add_f32 v20,v234,v232
v_fmac_f32 v234,4.0,v232
M v[72:75],a[224:227],a[252:255],v[72:75]
v_fma_f32 v232,2.0,v116,v238
v_fma_f32 v116,s40,v116,v238
M v[72:75],a[248:251],a[192:195],v[72:75]
buffer_load_dwordx4 a[240:243],v250,s[20:23],s46 offen offset:2048 sc1
M v[72:75],a[100:103],a[232:235],v[72:75]
s_add_u32 s46,s74,0
v_accvgpr_read_b32 v238,a21
v_accvgpr_read_b32 v237,a117
M v[76:79],a[100:103],v[220:223],v[76:79]
v_add_f32 v236,v238,v237
v_sub_f32 v238,v238,v237
M v[76:79],a[248:251],a[232:235],v[76:79]
v_add_f32 v237,v21,v117
v_sub_f32 v117,v21,v117
M v[76:79],a[224:227],a[192:195],v[76:79]
buffer_store_dwordx4 a[12:15],v253,s[24:27],s34 offen offset:384 nt
M v[80:83],a[224:227],a[232:235],v[80:83]
v_add_f32 v21,v236,v237
v_fmac_f32 v236,4.0,v237
M v[80:83],a[248:251],v[220:223],v[80:83]
v_fma_f32 v237,2.0,v117,v238
v_fma_f32 v117,s40,v117,v238
M v[80:83],a[100:103],a[208:211],v[80:83]
buffer_load_dwordx4 a[212:215],v250,s[20:23],s46 offen offset:0 sc1
M v[84:87],a[100:103],a[220:223],v[84:87]
v_cvt_pk_bf16_f32 v232,v232,v237
v_cvt_pk_bf16_f32 v234,v234,v236
M v[84:87],a[248:251],a[208:211],v[84:87]
ds_read_b128 a[192:195],v248 offset:26112
v_accvgpr_read_b32 v238,a22
M v[84:87],a[224:227],v[220:223],v[84:87]
ds_read_b128 a[232:235],v249 offset:26112
v_accvgpr_read_b32 v233,a118
M v[88:91],a[224:227],a[208:211],v[88:91]
buffer_load_dwordx4 a[228:231],v250,s[20:23],s46 offen offset:1024 sc1
M v[88:91],a[248:251],a[220:223],v[88:91]
ds_read_b128 v[220:223],v248 offset:26624
ds_read_b128 a[208:211],v249 offset:26624
M v[88:91],a[100:103],a[216:219],v[88:91]
v_add_f32 v235,v238,v233
v_sub_f32 v238,v238,v233
M v[92:95],a[100:103],a[244:247],v[92:95]
v_add_f32 v233,v22,v118
v_sub_f32 v118,v22,v118
M v[92:95],a[248:251],a[216:219],v[92:95]
buffer_load_dwordx4 a[252:255],v250,s[20:23],s46 offen offset:2048 sc1
M v[92:95],a[224:227],a[220:223],v[92:95]
s_waitcnt vmcnt(17) lgkmcnt(3)
s_add_u32 s46,s75,0
v_add_f32 v22,v235,v233
v_fmac_f32 v235,4.0,v233
M v[128:131],a[104:107],a[192:195],v[128:131]
s_waitcnt vmcnt(16) lgkmcnt(2)
ds_read_b128 a[244:247],v248 offset:27136
v_fma_f32 v233,2.0,v118,v238
M v[128:131],a[236:239],a[232:235],v[128:131]
s_waitcnt vmcnt(15) lgkmcnt(2)
ds_read_b128 a[216:219],v249 offset:27136
v_fma_f32 v118,s40,v118,v238
M v[128:131],a[204:207],v[220:223],v[128:131]
s_waitcnt lgkmcnt(2)
buffer_load_dwordx4 a[100:103],v250,s[20:23],s46 offen offset:0 sc1
M v[132:135],a[204:207],a[208:211],v[132:135]
v_accvgpr_read_b32 v238,a23
v_accvgpr_read_b32 v237,a119
M v[132:135],a[236:239],v[220:223],v[132:135]
v_add_f32 v236,v238,v237
v_sub_f32 v238,v238,v237
M v[132:135],a[104:107],a[232:235],v[132:135]
v_add_f32 v237,v23,v119
v_sub_f32 v119,v23,v119
M v[136:139],a[104:107],v[220:223],v[136:139]
ds_read_b128 a[116:119],v248 offset:27648
v_add_f32 v23,v236,v237
M v[136:139],a[236:239],a[208:211],v[136:139]
s_waitcnt lgkmcnt(2)
ds_read_b128 a[248:251],v249 offset:27648
v_fmac_f32 v236,4.0,v237
M v[136:139],a[204:207],a[244:247],v[136:139]
s_waitcnt lgkmcnt(2)
v_fma_f32 v237,2.0,v119,v238
v_fma_f32 v119,s40,v119,v238
M v[140:143],a[204:207],a[216:219],v[140:143]
v_cvt_pk_bf16_f32 v233,v233,v237
v_cvt_pk_bf16_f32 v235,v235,v236
M v[140:143],a[236:239],a[244:247],v[140:143]
ds_write2st64_b64 v254,v[232:233],v[234:235] offset0:76 offset1:80
M v[140:143],a[104:107],a[208:211],v[140:143]
v_accvgpr_read_b32 v238,a24
v_accvgpr_read_b32 v232,a120
M v[144:147],a[104:107],a[244:247],v[144:147]
ds_read_b128 a[220:223],v249 offset:28160
v_add_f32 v234,v238,v232
M v[144:147],a[236:239],a[216:219],v[144:147]
s_waitcnt lgkmcnt(3)
ds_read_b128 a[224:227],v248 offset:28160
v_sub_f32 v238,v238,v232
M v[144:147],a[204:207],a[116:119],v[144:147]
s_waitcnt lgkmcnt(3)
v_add_f32 v232,v24,v120
v_sub_f32 v120,v24,v120
M v[148:151],a[204:207],a[248:251],v[148:151]
v_add_f32 v24,v234,v232
v_fmac_f32 v234,4.0,v232
M v[148:151],a[236:239],a[116:119],v[148:151]
v_fma_f32 v232,2.0,v120,v238
v_fma_f32 v120,s40,v120,v238
M v[148:151],a[104:107],a[216:219],v[148:151]
s_waitcnt lgkmcnt(2)
s_barrier
ds_read_b128 a[16:19],v250 offset:34816
M v[152:155],a[104:107],a[116:119],v[152:155]
ds_read_b128 a[20:23],v250 offset:38912
v_accvgpr_read_b32 v238,a25
M v[152:155],a[236:239],a[248:251],v[152:155]
s_waitcnt lgkmcnt(3)
v_accvgpr_read_b32 v237,a121
v_add_f32 v236,v238,v237
M v[152:155],a[204:207],a[220:223],v[152:155]
s_waitcnt lgkmcnt(2)
v_sub_f32 v238,v238,v237
v_add_f32 v237,v25,v121
M v[156:159],a[204:207],a[224:227],v[156:159]
buffer_load_dwordx4 a[204:207],v250,s[20:23],s46 offen offset:1024 sc1
M v[156:159],a[236:239],a[220:223],v[156:159]
s_add_u32 s34,s32,7077888
v_sub_f32 v121,v25,v121
v_add_f32 v25,v236,v237
M v[156:159],a[104:107],a[248:251],v[156:159]
s_waitcnt vmcnt(16) lgkmcnt(1)
buffer_store_dwordx4 a[16:19],v253,s[24:27],s34 offen offset:384 nt
M v[160:163],a[200:203],a[192:195],v[160:163]
s_waitcnt vmcnt(16)
s_add_u32 s34,s32,7274496
v_fmac_f32 v236,4.0,v237
v_fma_f32 v237,2.0,v121,v238
M v[160:163],v[224:227],a[232:235],v[160:163]
s_waitcnt vmcnt(15)
v_fma_f32 v121,s40,v121,v238
v_cvt_pk_bf16_f32 v232,v232,v237
M v[160:163],v[228:231],v[220:223],v[160:163]
s_waitcnt lgkmcnt(0)
buffer_store_dwordx4 a[20:23],v253,s[24:27],s34 offen offset:384 nt
M v[164:167],v[228:231],a[208:211],v[164:167]
v_cvt_pk_bf16_f32 v234,v234,v236
v_accvgpr_read_b32 v238,a26
M v[164:167],v[224:227],v[220:223],v[164:167]
v_accvgpr_read_b32 v233,a122
v_add_f32 v235,v238,v233
M v[164:167],a[200:203],a[232:235],v[164:167]
buffer_load_dwordx4 a[236:239],v250,s[20:23],s46 offen offset:2048 sc1
M v[168:171],a[200:203],v[220:223],v[168:171]
s_add_u32 s46,s76,0
v_sub_f32 v238,v238,v233
v_add_f32 v233,v26,v122
M v[168:171],v[224:227],a[208:211],v[168:171]
v_sub_f32 v122,v26,v122
v_add_f32 v26,v235,v233
M v[168:171],v[228:231],a[244:247],v[168:171]
v_fmac_f32 v235,4.0,v233
v_fma_f32 v233,2.0,v122,v238
M v[172:175],v[228:231],a[216:219],v[172:175]
buffer_load_dwordx4 a[104:107],v250,s[20:23],s46 offen offset:0 sc1
M v[172:175],v[224:227],a[244:247],v[172:175]
v_fma_f32 v122,s40,v122,v238
v_accvgpr_read_b32 v238,a27
M v[172:175],a[200:203],a[208:211],v[172:175]
v_accvgpr_read_b32 v237,a123
v_add_f32 v236,v238,v237
M v[176:179],a[200:203],a[244:247],v[176:179]
v_sub_f32 v238,v238,v237
v_add_f32 v237,v27,v123
M v[176:179],v[224:227],a[216:219],v[176:179]
buffer_load_dwordx4 a[192:195],v250,s[20:23],s46 offen offset:1024 sc1
M v[176:179],v[228:231],a[116:119],v[176:179]
v_sub_f32 v123,v27,v123
v_add_f32 v27,v236,v237
M v[180:183],v[228:231],a[248:251],v[180:183]
v_fmac_f32 v236,4.0,v237
v_fma_f32 v237,2.0,v123,v238
M v[180:183],v[224:227],a[116:119],v[180:183]
ds_read_b128 a[120:123],v248 offset:52224
v_fma_f32 v123,s40,v123,v238
M v[180:183],a[200:203],a[216:219],v[180:183]
buffer_load_dwordx4 a[232:235],v250,s[20:23],s46 offen offset:2048 sc1
M v[184:187],a[200:203],a[116:119],v[184:187]
s_add_u32 s46,s77,0
ds_read_b128 a[208:211],v249 offset:52224
ds_read_b128 a[116:119],v248 offset:52736
M v[184:187],v[224:227],a[248:251],v[184:187]
ds_read_b128 a[244:247],v249 offset:52736
v_cvt_pk_bf16_f32 v233,v233,v237
M v[184:187],v[228:231],a[220:223],v[184:187]
v_cvt_pk_bf16_f32 v235,v235,v236
M v[188:191],v[228:231],a[224:227],v[188:191]
buffer_load_dwordx4 v[220:223],v250,s[20:23],s46 offen offset:0 sc1
M v[188:191],v[224:227],a[220:223],v[188:191]
ds_write2st64_b64 v254,v[232:233],v[234:235] offset0:85 offset1:89
M v[188:191],a[200:203],a[248:251],v[188:191]
s_waitcnt vmcnt(19) lgkmcnt(4)
v_accvgpr_read_b32 v204,a28
v_accvgpr_read_b32 v208,a124
M v[0:3],a[96:99],a[120:123],v[0:3]
s_waitcnt vmcnt(18) lgkmcnt(3)
ds_read_b128 a[120:123],v248 offset:53248
v_accvgpr_read_b32 v205,a29
M v[0:3],a[108:111],a[208:211],v[0:3]
s_waitcnt vmcnt(16) lgkmcnt(3)
buffer_load_dwordx4 a[216:219],v250,s[20:23],s46 offen offset:1024 sc1
M v[0:3],a[112:115],a[116:119],v[0:3]
s_waitcnt lgkmcnt(2)
ds_read_b128 a[200:203],v249 offset:53248
v_accvgpr_read_b32 v209,a125
M v[4:7],a[112:115],a[244:247],v[4:7]
v_accvgpr_read_b32 v206,a30
v_accvgpr_read_b32 v210,a126
v_accvgpr_read_b32 v207,a31
v_accvgpr_read_b32 v211,a127
v_pk_add_f32 v[212:213],v[204:205],v[208:209]
v_pk_add_f32 v[214:215],v[206:207],v[210:211]
v_pk_add_f32 v[204:205],v[204:205],v[208:209] neg_lo:[0,1] neg_hi:[0,1]
v_pk_add_f32 v[206:207],v[206:207],v[210:211] neg_lo:[0,1] neg_hi:[0,1]
v_pk_add_f32 v[208:209],v[28:29],v[124:125]
v_pk_add_f32 v[210:211],v[30:31],v[126:127]
v_pk_add_f32 v[124:125],v[28:29],v[124:125] neg_lo:[0,1] neg_hi:[0,1]
v_pk_add_f32 v[126:127],v[30:31],v[126:127] neg_lo:[0,1] neg_hi:[0,1]
v_pk_add_f32 v[28:29],v[212:213],v[208:209]
v_pk_add_f32 v[30:31],v[214:215],v[210:211]
v_pk_fma_f32 v[212:213],v[208:209],4.0,v[212:213] op_sel_hi:[1,0,1]
v_pk_fma_f32 v[214:215],v[210:211],4.0,v[214:215] op_sel_hi:[1,0,1]
v_pk_fma_f32 v[208:209],v[124:125],2.0,v[204:205] op_sel_hi:[1,0,1]
v_pk_fma_f32 v[210:211],v[126:127],2.0,v[206:207] op_sel_hi:[1,0,1]
v_pk_fma_f32 v[124:125],v[124:125],s[40:41],v[204:205] op_sel_hi:[1,0,1]
v_pk_fma_f32 v[126:127],v[126:127],s[40:41],v[206:207] op_sel_hi:[1,0,1]
M v[4:7],a[108:111],a[116:119],v[4:7]
buffer_load_dwordx4 a[224:227],v250,s[20:23],s46 offen offset:2048 sc1
M v[4:7],a[96:99],a[208:211],v[4:7]
s_add_u32 s46,s72,46080
v_cvt_pk_bf16_f32 v208,v208,v209
v_cvt_pk_bf16_f32 v209,v210,v211
M v[8:11],a[96:99],a[116:119],v[8:11]
buffer_load_dwordx4 v[228:231],v250,s[20:23],s46 offen offset:0 sc1
M v[8:11],a[108:111],a[244:247],v[8:11]
s_waitcnt lgkmcnt(1)
ds_read_b128 a[124:127],v248 offset:53760
ds_read_b128 a[116:119],v249 offset:53760
M v[8:11],a[112:115],a[120:123],v[8:11]
s_waitcnt lgkmcnt(2)
v_cvt_pk_bf16_f32 v212,v212,v213
v_cvt_pk_bf16_f32 v213,v214,v215
M v[12:15],a[112:115],a[200:203],v[12:15]
ds_write2st64_b64 v254,v[208:209],v[212:213] offset0:93 offset1:97
M v[12:15],a[108:111],a[120:123],v[12:15]
buffer_load_dwordx4 a[220:223],v250,s[20:23],s46 offen offset:1024 sc1
M v[12:15],a[96:99],a[244:247],v[12:15]
v_accvgpr_read_b32 v238,a32
v_accvgpr_read_b32 v232,a128
M v[16:19],a[96:99],a[120:123],v[16:19]
ds_read_b128 a[120:123],v249 offset:54272
v_add_f32 v234,v238,v232
M v[16:19],a[108:111],a[200:203],v[16:19]
s_waitcnt lgkmcnt(3)
ds_read_b128 a[248:251],v248 offset:54272
v_add_u32 v248,0x15400,v248
M v[16:19],a[112:115],a[124:127],v[16:19]
s_waitcnt lgkmcnt(3)
buffer_load_dwordx4 v[224:227],v250,s[20:23],s46 offen offset:2048 sc1
M v[20:23],a[112:115],a[116:119],v[20:23]
s_add_u32 s47,s72,49152
v_add_u32 v249,0x15400,v249
v_sub_f32 v238,v238,v232
M v[20:23],a[108:111],a[124:127],v[20:23]
ds_read_b128 a[208:211],v248 offset:0
v_add_f32 v232,v32,v128
M v[20:23],a[96:99],a[200:203],v[20:23]
ds_read_b128 a[244:247],v249 offset:0
v_sub_f32 v128,v32,v128
M v[24:27],a[96:99],a[124:127],v[24:27]
ds_read_b128 a[124:127],v248 offset:512
v_add_f32 v32,v234,v232
M v[24:27],a[108:111],a[116:119],v[24:27]
s_waitcnt lgkmcnt(4)
ds_read_b128 a[200:203],v249 offset:512
v_fmac_f32 v234,4.0,v232
M v[24:27],a[112:115],a[120:123],v[24:27]
s_waitcnt lgkmcnt(4)
v_fma_f32 v232,2.0,v128,v238
v_fma_f32 v128,s40,v128,v238
M v[28:31],a[112:115],a[248:251],v[28:31]
s_barrier
ds_read_b128 a[24:27],v250 offset:43520
M v[28:31],a[108:111],a[120:123],v[28:31]
ds_read_b128 a[28:31],v250 offset:47616
v_accvgpr_read_b32 v238,a33
M v[28:31],a[96:99],a[116:119],v[28:31]
s_waitcnt vmcnt(20) lgkmcnt(5)
buffer_load_dwordx4 a[112:115],v250,s[20:23],s47 offen offset:0 sc1
M v[0:3],v[216:219],a[208:211],v[0:3]
s_waitcnt vmcnt(20) lgkmcnt(4)
ds_read_b128 a[120:123],v248 offset:1024
v_accvgpr_read_b32 v237,a129
M v[0:3],a[196:199],a[244:247],v[0:3]
s_waitcnt vmcnt(19) lgkmcnt(4)
buffer_load_dwordx4 a[248:251],v250,s[20:23],s47 offen offset:1024 sc1
M v[0:3],a[240:243],a[124:127],v[0:3]
s_waitcnt lgkmcnt(3)
s_add_u32 s34,s32,7471104
ds_read_b128 a[96:99],v249 offset:1024
v_add_f32 v236,v238,v237
M v[4:7],a[240:243],a[200:203],v[4:7]
v_sub_f32 v238,v238,v237
v_add_f32 v237,v33,v129
M v[4:7],a[196:199],a[124:127],v[4:7]
v_sub_f32 v129,v33,v129
v_add_f32 v33,v236,v237
M v[4:7],v[216:219],a[244:247],v[4:7]
s_waitcnt lgkmcnt(3)
buffer_store_dwordx4 a[24:27],v253,s[24:27],s34 offen offset:384 nt
M v[8:11],v[216:219],a[124:127],v[8:11]
s_add_u32 s34,s32,7667712
ds_read_b128 a[116:119],v248 offset:1536
v_fmac_f32 v236,4.0,v237
M v[8:11],a[196:199],a[200:203],v[8:11]
s_waitcnt lgkmcnt(2)
ds_read_b128 a[124:127],v249 offset:1536
v_fma_f32 v237,2.0,v129,v238
M v[8:11],a[240:243],a[120:123],v[8:11]
s_waitcnt lgkmcnt(2)
buffer_store_dwordx4 a[28:31],v253,s[24:27],s34 offen offset:384 nt
M v[12:15],a[240:243],a[96:99],v[12:15]
v_fma_f32 v129,s40,v129,v238
v_cvt_pk_bf16_f32 v232,v232,v237
M v[12:15],a[196:199],a[120:123],v[12:15]
v_cvt_pk_bf16_f32 v234,v234,v236
v_accvgpr_read_b32 v238,a34
M v[12:15],v[216:219],a[200:203],v[12:15]
buffer_load_dwordx4 a[108:111],v250,s[20:23],s47 offen offset:2048 sc1
M v[16:19],v[216:219],a[120:123],v[16:19]
ds_read_b128 a[120:123],v249 offset:2048
v_accvgpr_read_b32 v233,a130
M v[16:19],a[196:199],a[96:99],v[16:19]
s_waitcnt lgkmcnt(2)
ds_read_b128 a[208:211],v248 offset:2048
v_add_f32 v235,v238,v233
M v[16:19],a[240:243],a[116:119],v[16:19]
s_waitcnt lgkmcnt(2)
v_sub_f32 v238,v238,v233
v_add_f32 v233,v34,v130
M v[20:23],a[240:243],a[124:127],v[20:23]
s_add_u32 s46,s73,46080
v_sub_f32 v130,v34,v130
v_add_f32 v34,v235,v233
M v[20:23],a[196:199],a[116:119],v[20:23]
ds_read_b128 a[244:247],v248 offset:17408
v_fmac_f32 v235,4.0,v233
M v[20:23],v[216:219],a[96:99],v[20:23]
ds_read_b128 a[96:99],v249 offset:17408
v_fma_f32 v233,2.0,v130,v238
M v[24:27],v[216:219],a[116:119],v[24:27]
ds_read_b128 a[116:119],v248 offset:17920
v_fma_f32 v130,s40,v130,v238
M v[24:27],a[196:199],a[124:127],v[24:27]
s_waitcnt lgkmcnt(4)
v_accvgpr_read_b32 v238,a35
v_accvgpr_read_b32 v237,a131
M v[24:27],a[240:243],a[120:123],v[24:27]
s_waitcnt lgkmcnt(3)
ds_read_b128 a[128:131],v249 offset:17920
v_add_f32 v236,v238,v237
M v[28:31],a[240:243],a[208:211],v[28:31]
buffer_load_dwordx4 a[200:203],v250,s[20:23],s46 offen offset:0 sc1
M v[28:31],a[196:199],a[120:123],v[28:31]
v_sub_f32 v238,v238,v237
v_add_f32 v237,v35,v131
M v[28:31],v[216:219],a[124:127],v[28:31]
s_waitcnt vmcnt(22) lgkmcnt(3)
buffer_load_dwordx4 a[208:211],v250,s[20:23],s46 offen offset:1024 sc1
M v[0:3],a[212:215],a[244:247],v[0:3]
s_waitcnt vmcnt(22) lgkmcnt(2)
ds_read_b128 a[124:127],v248 offset:18432
v_sub_f32 v131,v35,v131
M v[0:3],a[228:231],a[96:99],v[0:3]
s_waitcnt vmcnt(21) lgkmcnt(2)
ds_read_b128 a[240:243],v249 offset:18432
v_add_f32 v35,v236,v237
M v[0:3],a[252:255],a[116:119],v[0:3]
s_waitcnt lgkmcnt(2)
v_fmac_f32 v236,4.0,v237
v_fma_f32 v237,2.0,v131,v238
M v[4:7],a[252:255],a[128:131],v[4:7]
buffer_load_dwordx4 a[120:123],v250,s[20:23],s46 offen offset:2048 sc1
M v[4:7],a[228:231],a[116:119],v[4:7]
v_fma_f32 v131,s40,v131,v238
v_cvt_pk_bf16_f32 v233,v233,v237
M v[4:7],a[212:215],a[96:99],v[4:7]
v_cvt_pk_bf16_f32 v235,v235,v236
M v[8:11],a[212:215],a[116:119],v[8:11]
ds_read_b128 a[96:99],v248 offset:18944
ds_write2st64_b64 v254,v[232:233],v[234:235] offset0:34 offset1:38
M v[8:11],a[228:231],a[128:131],v[8:11]
s_waitcnt lgkmcnt(3)
ds_read_b128 a[116:119],v249 offset:18944
v_accvgpr_read_b32 v204,a36
M v[8:11],a[252:255],a[124:127],v[8:11]
s_waitcnt lgkmcnt(3)
v_accvgpr_read_b32 v208,a132
v_accvgpr_read_b32 v205,a37
M v[12:15],a[252:255],a[240:243],v[12:15]
v_accvgpr_read_b32 v209,a133
v_accvgpr_read_b32 v206,a38
M v[12:15],a[228:231],a[124:127],v[12:15]
v_accvgpr_read_b32 v210,a134
v_accvgpr_read_b32 v207,a39
v_accvgpr_read_b32 v211,a135
v_pk_add_f32 v[212:213],v[204:205],v[208:209]
v_pk_add_f32 v[214:215],v[206:207],v[210:211]
v_pk_add_f32 v[204:205],v[204:205],v[208:209] neg_lo:[0,1] neg_hi:[0,1]
v_pk_add_f32 v[206:207],v[206:207],v[210:211] neg_lo:[0,1] neg_hi:[0,1]
v_pk_add_f32 v[208:209],v[36:37],v[132:133]
v_pk_add_f32 v[210:211],v[38:39],v[134:135]
v_pk_add_f32 v[132:133],v[36:37],v[132:133] neg_lo:[0,1] neg_hi:[0,1]
v_pk_add_f32 v[134:135],v[38:39],v[134:135] neg_lo:[0,1] neg_hi:[0,1]
v_pk_add_f32 v[36:37],v[212:213],v[208:209]
v_pk_add_f32 v[38:39],v[214:215],v[210:211]
v_pk_fma_f32 v[212:213],v[208:209],4.0,v[212:213] op_sel_hi:[1,0,1]
v_pk_fma_f32 v[214:215],v[210:211],4.0,v[214:215] op_sel_hi:[1,0,1]
v_pk_fma_f32 v[208:209],v[132:133],2.0,v[204:205] op_sel_hi:[1,0,1]
v_pk_fma_f32 v[210:211],v[134:135],2.0,v[206:207] op_sel_hi:[1,0,1]
v_pk_fma_f32 v[132:133],v[132:133],s[40:41],v[204:205] op_sel_hi:[1,0,1]
v_pk_fma_f32 v[134:135],v[134:135],s[40:41],v[206:207] op_sel_hi:[1,0,1]
M v[12:15],a[212:215],a[128:131],v[12:15]
v_cvt_pk_bf16_f32 v208,v208,v209
v_cvt_pk_bf16_f32 v209,v210,v211
M v[16:19],a[212:215],a[124:127],v[16:19]
s_add_u32 s47,s73,49152
ds_read_b128 a[128:131],v249 offset:19456
v_cvt_pk_bf16_f32 v212,v212,v213
M v[16:19],a[228:231],a[240:243],v[16:19]
s_waitcnt lgkmcnt(3)
ds_read_b128 a[132:135],v248 offset:19456
v_cvt_pk_bf16_f32 v213,v214,v215
M v[16:19],a[252:255],a[96:99],v[16:19]
s_waitcnt lgkmcnt(2)
ds_write2st64_b64 v254,v[208:209],v[212:213] offset0:42 offset1:46
M v[20:23],a[252:255],a[116:119],v[20:23]
v_accvgpr_read_b32 v204,a40
v_accvgpr_read_b32 v208,a136
M v[20:23],a[228:231],a[96:99],v[20:23]
ds_read_b128 a[124:127],v248 offset:34816
v_accvgpr_read_b32 v205,a41
M v[20:23],a[212:215],a[240:243],v[20:23]
ds_read_b128 a[196:199],v249 offset:34816
v_accvgpr_read_b32 v209,a137
M v[24:27],a[212:215],a[96:99],v[24:27]
buffer_load_dwordx4 a[96:99],v250,s[20:23],s47 offen offset:0 sc1
M v[24:27],a[228:231],a[116:119],v[24:27]
s_waitcnt lgkmcnt(4)
v_accvgpr_read_b32 v206,a42
v_accvgpr_read_b32 v210,a138
v_accvgpr_read_b32 v207,a43
v_accvgpr_read_b32 v211,a139
v_pk_add_f32 v[212:213],v[204:205],v[208:209]
v_pk_add_f32 v[214:215],v[206:207],v[210:211]
v_pk_add_f32 v[204:205],v[204:205],v[208:209] neg_lo:[0,1] neg_hi:[0,1]
v_pk_add_f32 v[206:207],v[206:207],v[210:211] neg_lo:[0,1] neg_hi:[0,1]
v_pk_add_f32 v[208:209],v[40:41],v[136:137]
v_pk_add_f32 v[210:211],v[42:43],v[138:139]
v_pk_add_f32 v[136:137],v[40:41],v[136:137] neg_lo:[0,1] neg_hi:[0,1]
v_pk_add_f32 v[138:139],v[42:43],v[138:139] neg_lo:[0,1] neg_hi:[0,1]
v_pk_add_f32 v[40:41],v[212:213],v[208:209]
v_pk_add_f32 v[42:43],v[214:215],v[210:211]
v_pk_fma_f32 v[212:213],v[208:209],4.0,v[212:213] op_sel_hi:[1,0,1]
v_pk_fma_f32 v[214:215],v[210:211],4.0,v[214:215] op_sel_hi:[1,0,1]
v_pk_fma_f32 v[208:209],v[136:137],2.0,v[204:205] op_sel_hi:[1,0,1]
v_pk_fma_f32 v[210:211],v[138:139],2.0,v[206:207] op_sel_hi:[1,0,1]
v_pk_fma_f32 v[136:137],v[136:137],s[40:41],v[204:205] op_sel_hi:[1,0,1]
v_pk_fma_f32 v[138:139],v[138:139],s[40:41],v[206:207] op_sel_hi:[1,0,1]
M v[24:27],a[252:255],a[128:131],v[24:27]
s_waitcnt lgkmcnt(3)
ds_read_b128 a[136:139],v248 offset:35328
ds_read_b128 v[216:219],v249 offset:35328
M v[28:31],a[252:255],a[132:135],v[28:31]
buffer_load_dwordx4 a[244:247],v250,s[20:23],s47 offen offset:1024 sc1
M v[28:31],a[228:231],a[128:131],v[28:31]
v_cvt_pk_bf16_f32 v208,v208,v209
v_cvt_pk_bf16_f32 v209,v210,v211
M v[28:31],a[212:215],a[116:119],v[28:31]
s_waitcnt vmcnt(23) lgkmcnt(3)
buffer_load_dwordx4 a[132:135],v250,s[20:23],s47 offen offset:2048 sc1
M v[0:3],a[100:103],a[124:127],v[0:3]
s_waitcnt vmcnt(23) lgkmcnt(2)
ds_read_b128 a[128:131],v248 offset:35840
v_cvt_pk_bf16_f32 v212,v212,v213
M v[0:3],a[204:207],a[196:199],v[0:3]
s_waitcnt vmcnt(20) lgkmcnt(2)
ds_read_b128 a[116:119],v249 offset:35840
v_cvt_pk_bf16_f32 v213,v214,v215
M v[0:3],a[236:239],a[136:139],v[0:3]
s_waitcnt lgkmcnt(2)
ds_write2st64_b64 v254,v[208:209],v[212:213] offset0:51 offset1:55
M v[4:7],a[236:239],v[216:219],v[4:7]
v_accvgpr_read_b32 v204,a44
v_accvgpr_read_b32 v208,a140
M v[4:7],a[204:207],a[136:139],v[4:7]
v_accvgpr_read_b32 v205,a45
v_accvgpr_read_b32 v209,a141
M v[4:7],a[100:103],a[196:199],v[4:7]
v_accvgpr_read_b32 v206,a46
v_accvgpr_read_b32 v210,a142
v_accvgpr_read_b32 v207,a47
v_accvgpr_read_b32 v211,a143
v_pk_add_f32 v[212:213],v[204:205],v[208:209]
v_pk_add_f32 v[214:215],v[206:207],v[210:211]
v_pk_add_f32 v[204:205],v[204:205],v[208:209] neg_lo:[0,1] neg_hi:[0,1]
v_pk_add_f32 v[206:207],v[206:207],v[210:211] neg_lo:[0,1] neg_hi:[0,1]
v_pk_add_f32 v[208:209],v[44:45],v[140:141]
v_pk_add_f32 v[210:211],v[46:47],v[142:143]
v_pk_add_f32 v[140:141],v[44:45],v[140:141] neg_lo:[0,1] neg_hi:[0,1]
v_pk_add_f32 v[142:143],v[46:47],v[142:143] neg_lo:[0,1] neg_hi:[0,1]
v_pk_add_f32 v[44:45],v[212:213],v[208:209]
v_pk_add_f32 v[46:47],v[214:215],v[210:211]
v_pk_fma_f32 v[212:213],v[208:209],4.0,v[212:213] op_sel_hi:[1,0,1]
v_pk_fma_f32 v[214:215],v[210:211],4.0,v[214:215] op_sel_hi:[1,0,1]
v_pk_fma_f32 v[208:209],v[140:141],2.0,v[204:205] op_sel_hi:[1,0,1]
v_pk_fma_f32 v[210:211],v[142:143],2.0,v[206:207] op_sel_hi:[1,0,1]
v_pk_fma_f32 v[140:141],v[140:141],s[40:41],v[204:205] op_sel_hi:[1,0,1]
v_pk_fma_f32 v[142:143],v[142:143],s[40:41],v[206:207] op_sel_hi:[1,0,1]
M v[8:11],a[100:103],a[136:139],v[8:11]
ds_read_b128 a[124:127],v248 offset:36352
v_cvt_pk_bf16_f32 v208,v208,v209
M v[8:11],a[204:207],v[216:219],v[8:11]
s_waitcnt lgkmcnt(3)
ds_read_b128 a[136:139],v249 offset:36352
v_cvt_pk_bf16_f32 v209,v210,v211
M v[8:11],a[236:239],a[128:131],v[8:11]
s_waitcnt lgkmcnt(3)
v_cvt_pk_bf16_f32 v212,v212,v213
v_cvt_pk_bf16_f32 v213,v214,v215
M v[12:15],a[236:239],a[116:119],v[12:15]
ds_write2st64_b64 v254,v[208:209],v[212:213] offset0:59 offset1:63
M v[12:15],a[204:207],a[128:131],v[12:15]
v_accvgpr_read_b32 v238,a48
v_accvgpr_read_b32 v232,a144
M v[12:15],a[100:103],v[216:219],v[12:15]
v_add_f32 v234,v238,v232
v_sub_f32 v238,v238,v232
M v[16:19],a[100:103],a[128:131],v[16:19]
s_add_u32 s46,s74,46080
ds_read_b128 a[140:143],v249 offset:36864
v_add_f32 v232,v48,v144
M v[16:19],a[204:207],a[116:119],v[16:19]
s_waitcnt lgkmcnt(3)
ds_read_b128 a[128:131],v248 offset:36864
v_sub_f32 v144,v48,v144
M v[16:19],a[236:239],a[124:127],v[16:19]
s_waitcnt lgkmcnt(3)
v_add_f32 v48,v234,v232
v_fmac_f32 v234,4.0,v232
M v[20:23],a[236:239],a[136:139],v[20:23]
v_fma_f32 v232,2.0,v144,v238
v_fma_f32 v144,s40,v144,v238
M v[20:23],a[204:207],a[124:127],v[20:23]
ds_read_b128 a[240:243],v248 offset:52224
v_accvgpr_read_b32 v238,a49
M v[20:23],a[100:103],a[116:119],v[20:23]
ds_read_b128 a[116:119],v249 offset:52224
v_accvgpr_read_b32 v237,a145
M v[24:27],a[100:103],a[124:127],v[24:27]
buffer_load_dwordx4 a[124:127],v250,s[20:23],s46 offen offset:0 sc1
M v[24:27],a[204:207],a[136:139],v[24:27]
s_waitcnt lgkmcnt(3)
ds_read_b128 a[252:255],v248 offset:52736
ds_read_b128 a[212:215],v249 offset:52736
M v[24:27],a[236:239],a[140:143],v[24:27]
s_waitcnt lgkmcnt(4)
buffer_load_dwordx4 a[228:231],v250,s[20:23],s46 offen offset:1024 sc1
M v[28:31],a[236:239],a[128:131],v[28:31]
v_add_f32 v236,v238,v237
v_sub_f32 v238,v238,v237
M v[28:31],a[204:207],a[140:143],v[28:31]
v_add_f32 v237,v49,v145
v_sub_f32 v145,v49,v145
M v[28:31],a[100:103],a[136:139],v[28:31]
s_waitcnt vmcnt(21) lgkmcnt(3)
v_add_f32 v49,v236,v237
v_fmac_f32 v236,4.0,v237
M v[0:3],a[104:107],a[240:243],v[0:3]
s_waitcnt vmcnt(20) lgkmcnt(2)
buffer_load_dwordx4 a[196:199],v250,s[20:23],s46 offen offset:2048 sc1
M v[0:3],a[192:195],a[116:119],v[0:3]
s_waitcnt vmcnt(20) lgkmcnt(1)
ds_read_b128 a[128:131],v248 offset:53248
ds_read_b128 a[140:143],v249 offset:53248
M v[0:3],a[232:235],a[252:255],v[0:3]
s_waitcnt lgkmcnt(2)
v_fma_f32 v237,2.0,v145,v238
v_fma_f32 v145,s40,v145,v238
M v[4:7],a[232:235],a[212:215],v[4:7]
v_cvt_pk_bf16_f32 v232,v232,v237
v_cvt_pk_bf16_f32 v234,v234,v236
M v[4:7],a[192:195],a[252:255],v[4:7]
v_accvgpr_read_b32 v238,a50
v_accvgpr_read_b32 v233,a146
M v[4:7],a[104:107],a[116:119],v[4:7]
v_add_f32 v235,v238,v233
v_sub_f32 v238,v238,v233
M v[8:11],a[104:107],a[252:255],v[8:11]
ds_read_b128 a[100:103],v248 offset:53760
v_add_f32 v233,v50,v146
M v[8:11],a[192:195],a[212:215],v[8:11]
s_waitcnt lgkmcnt(2)
ds_read_b128 a[136:139],v249 offset:53760
v_sub_f32 v146,v50,v146
M v[8:11],a[232:235],a[128:131],v[8:11]
s_waitcnt lgkmcnt(2)
v_add_f32 v50,v235,v233
v_fmac_f32 v235,4.0,v233
M v[12:15],a[232:235],a[140:143],v[12:15]
v_fma_f32 v233,2.0,v146,v238
v_fma_f32 v146,s40,v146,v238
M v[12:15],a[192:195],a[128:131],v[12:15]
v_accvgpr_read_b32 v238,a51
v_accvgpr_read_b32 v237,a147
M v[12:15],a[104:107],a[212:215],v[12:15]
v_add_f32 v236,v238,v237
v_sub_f32 v238,v238,v237
M v[16:19],a[104:107],a[128:131],v[16:19]
s_add_u32 s47,s74,49152
ds_read_b128 a[116:119],v249 offset:54272
v_add_f32 v237,v51,v147
M v[16:19],a[192:195],a[140:143],v[16:19]
s_waitcnt lgkmcnt(2)
ds_read_b128 a[144:147],v248 offset:54272
v_add_u32 v248,0xffff9a00,v248
M v[16:19],a[232:235],a[100:103],v[16:19]
s_waitcnt lgkmcnt(2)
v_add_u32 v249,0xffff9a00,v249
v_sub_f32 v147,v51,v147
M v[20:23],a[232:235],a[136:139],v[20:23]
v_add_f32 v51,v236,v237
v_fmac_f32 v236,4.0,v237
M v[20:23],a[192:195],a[100:103],v[20:23]
ds_read_b128 a[128:131],v248 offset:8704
v_fma_f32 v237,2.0,v147,v238
M v[20:23],a[104:107],a[140:143],v[20:23]
ds_read_b128 a[140:143],v249 offset:8704
v_fma_f32 v147,s40,v147,v238
M v[24:27],a[104:107],a[100:103],v[24:27]
buffer_load_dwordx4 a[100:103],v250,s[20:23],s47 offen offset:0 sc1
M v[24:27],a[192:195],a[136:139],v[24:27]
s_waitcnt lgkmcnt(3)
ds_read_b128 v[216:219],v248 offset:9216
ds_read_b128 a[204:207],v249 offset:9216
M v[24:27],a[232:235],a[116:119],v[24:27]
s_waitcnt lgkmcnt(4)
buffer_load_dwordx4 a[236:239],v250,s[20:23],s47 offen offset:1024 sc1
M v[28:31],a[232:235],a[144:147],v[28:31]
v_cvt_pk_bf16_f32 v233,v233,v237
v_cvt_pk_bf16_f32 v235,v235,v236
M v[28:31],a[192:195],a[116:119],v[28:31]
ds_write2st64_b64 v254,v[232:233],v[234:235] offset0:0 offset1:4
M v[28:31],a[104:107],a[136:139],v[28:31]
s_waitcnt vmcnt(21) lgkmcnt(4)
v_accvgpr_read_b32 v204,a52
v_accvgpr_read_b32 v208,a148
M v[0:3],v[220:223],a[128:131],v[0:3]
s_waitcnt vmcnt(20) lgkmcnt(3)
buffer_load_dwordx4 a[240:243],v250,s[20:23],s47 offen offset:2048 sc1
M v[0:3],a[216:219],a[140:143],v[0:3]
s_waitcnt vmcnt(20) lgkmcnt(2)
ds_read_b128 a[144:147],v248 offset:9728
ds_read_b128 a[116:119],v249 offset:9728
M v[0:3],a[224:227],v[216:219],v[0:3]
s_waitcnt lgkmcnt(3)
v_accvgpr_read_b32 v205,a53
v_accvgpr_read_b32 v209,a149
M v[4:7],a[224:227],a[204:207],v[4:7]
v_accvgpr_read_b32 v206,a54
v_accvgpr_read_b32 v210,a150
v_accvgpr_read_b32 v207,a55
v_accvgpr_read_b32 v211,a151
v_pk_add_f32 v[212:213],v[204:205],v[208:209]
v_pk_add_f32 v[214:215],v[206:207],v[210:211]
v_pk_add_f32 v[204:205],v[204:205],v[208:209] neg_lo:[0,1] neg_hi:[0,1]
v_pk_add_f32 v[206:207],v[206:207],v[210:211] neg_lo:[0,1] neg_hi:[0,1]
v_pk_add_f32 v[208:209],v[52:53],v[148:149]
v_pk_add_f32 v[210:211],v[54:55],v[150:151]
v_pk_add_f32 v[148:149],v[52:53],v[148:149] neg_lo:[0,1] neg_hi:[0,1]
v_pk_add_f32 v[150:151],v[54:55],v[150:151] neg_lo:[0,1] neg_hi:[0,1]
v_pk_add_f32 v[52:53],v[212:213],v[208:209]
v_pk_add_f32 v[54:55],v[214:215],v[210:211]
v_pk_fma_f32 v[212:213],v[208:209],4.0,v[212:213] op_sel_hi:[1,0,1]
v_pk_fma_f32 v[214:215],v[210:211],4.0,v[214:215] op_sel_hi:[1,0,1]
v_pk_fma_f32 v[208:209],v[148:149],2.0,v[204:205] op_sel_hi:[1,0,1]
v_pk_fma_f32 v[210:211],v[150:151],2.0,v[206:207] op_sel_hi:[1,0,1]
v_pk_fma_f32 v[148:149],v[148:149],s[40:41],v[204:205] op_sel_hi:[1,0,1]
v_pk_fma_f32 v[150:151],v[150:151],s[40:41],v[206:207] op_sel_hi:[1,0,1]
M v[4:7],a[216:219],v[216:219],v[4:7]
v_cvt_pk_bf16_f32 v208,v208,v209
v_cvt_pk_bf16_f32 v209,v210,v211
M v[4:7],v[220:223],a[140:143],v[4:7]
v_cvt_pk_bf16_f32 v212,v212,v213
v_cvt_pk_bf16_f32 v213,v214,v215
M v[8:11],v[220:223],v[216:219],v[8:11]
ds_read_b128 a[104:107],v248 offset:10240
ds_write2st64_b64 v254,v[208:209],v[212:213] offset0:8 offset1:12
M v[8:11],a[216:219],a[204:207],v[8:11]
s_waitcnt lgkmcnt(3)
ds_read_b128 a[136:139],v249 offset:10240
v_accvgpr_read_b32 v204,a56
M v[8:11],a[224:227],a[144:147],v[8:11]
s_waitcnt lgkmcnt(3)
v_accvgpr_read_b32 v208,a152
v_accvgpr_read_b32 v205,a57
M v[12:15],a[224:227],a[116:119],v[12:15]
v_accvgpr_read_b32 v209,a153
v_accvgpr_read_b32 v206,a58
M v[12:15],a[216:219],a[144:147],v[12:15]
v_accvgpr_read_b32 v210,a154
v_accvgpr_read_b32 v207,a59
v_accvgpr_read_b32 v211,a155
v_pk_add_f32 v[212:213],v[204:205],v[208:209]
v_pk_add_f32 v[214:215],v[206:207],v[210:211]
v_pk_add_f32 v[204:205],v[204:205],v[208:209] neg_lo:[0,1] neg_hi:[0,1]
v_pk_add_f32 v[206:207],v[206:207],v[210:211] neg_lo:[0,1] neg_hi:[0,1]
v_pk_add_f32 v[208:209],v[56:57],v[152:153]
v_pk_add_f32 v[210:211],v[58:59],v[154:155]
v_pk_add_f32 v[152:153],v[56:57],v[152:153] neg_lo:[0,1] neg_hi:[0,1]
v_pk_add_f32 v[154:155],v[58:59],v[154:155] neg_lo:[0,1] neg_hi:[0,1]
v_pk_add_f32 v[56:57],v[212:213],v[208:209]
v_pk_add_f32 v[58:59],v[214:215],v[210:211]
v_pk_fma_f32 v[212:213],v[208:209],4.0,v[212:213] op_sel_hi:[1,0,1]
v_pk_fma_f32 v[214:215],v[210:211],4.0,v[214:215] op_sel_hi:[1,0,1]
v_pk_fma_f32 v[208:209],v[152:153],2.0,v[204:205] op_sel_hi:[1,0,1]
v_pk_fma_f32 v[210:211],v[154:155],2.0,v[206:207] op_sel_hi:[1,0,1]
v_pk_fma_f32 v[152:153],v[152:153],s[40:41],v[204:205] op_sel_hi:[1,0,1]
v_pk_fma_f32 v[154:155],v[154:155],s[40:41],v[206:207] op_sel_hi:[1,0,1]
M v[12:15],v[220:223],a[204:207],v[12:15]
v_cvt_pk_bf16_f32 v208,v208,v209
v_cvt_pk_bf16_f32 v209,v210,v211
M v[16:19],v[220:223],a[144:147],v[16:19]
s_add_u32 s46,s75,46080
ds_read_b128 a[128:131],v249 offset:10752
v_cvt_pk_bf16_f32 v212,v212,v213
M v[16:19],a[216:219],a[116:119],v[16:19]
s_waitcnt lgkmcnt(3)
ds_read_b128 a[148:151],v248 offset:10752
v_cvt_pk_bf16_f32 v213,v214,v215
M v[16:19],a[224:227],a[104:107],v[16:19]
s_waitcnt lgkmcnt(2)
ds_write2st64_b64 v254,v[208:209],v[212:213] offset0:17 offset1:21
M v[20:23],a[224:227],a[136:139],v[20:23]
v_accvgpr_read_b32 v204,a60
v_accvgpr_read_b32 v208,a156
M v[20:23],a[216:219],a[104:107],v[20:23]
ds_read_b128 a[140:143],v248 offset:0
v_accvgpr_read_b32 v205,a61
M v[20:23],v[220:223],a[116:119],v[20:23]
ds_read_b128 a[152:155],v249 offset:0
v_accvgpr_read_b32 v209,a157
M v[24:27],v[220:223],a[104:107],v[24:27]
buffer_load_dwordx4 a[144:147],v250,s[20:23],s46 offen offset:0 sc1
M v[24:27],a[216:219],a[136:139],v[24:27]
s_waitcnt lgkmcnt(4)
ds_read_b128 a[116:119],v248 offset:512
ds_read_b128 a[252:255],v249 offset:512
M v[24:27],a[224:227],a[128:131],v[24:27]
s_waitcnt lgkmcnt(5)
buffer_load_dwordx4 a[104:107],v250,s[20:23],s46 offen offset:1024 sc1
M v[28:31],a[224:227],a[148:151],v[28:31]
v_accvgpr_read_b32 v206,a62
v_accvgpr_read_b32 v210,a158
v_accvgpr_read_b32 v207,a63
v_accvgpr_read_b32 v211,a159
v_pk_add_f32 v[212:213],v[204:205],v[208:209]
v_pk_add_f32 v[214:215],v[206:207],v[210:211]
v_pk_add_f32 v[204:205],v[204:205],v[208:209] neg_lo:[0,1] neg_hi:[0,1]
v_pk_add_f32 v[206:207],v[206:207],v[210:211] neg_lo:[0,1] neg_hi:[0,1]
v_pk_add_f32 v[208:209],v[60:61],v[156:157]
v_pk_add_f32 v[210:211],v[62:63],v[158:159]
v_pk_add_f32 v[156:157],v[60:61],v[156:157] neg_lo:[0,1] neg_hi:[0,1]
v_pk_add_f32 v[158:159],v[62:63],v[158:159] neg_lo:[0,1] neg_hi:[0,1]
v_pk_add_f32 v[60:61],v[212:213],v[208:209]
v_pk_add_f32 v[62:63],v[214:215],v[210:211]
v_pk_fma_f32 v[212:213],v[208:209],4.0,v[212:213] op_sel_hi:[1,0,1]
v_pk_fma_f32 v[214:215],v[210:211],4.0,v[214:215] op_sel_hi:[1,0,1]
v_pk_fma_f32 v[208:209],v[156:157],2.0,v[204:205] op_sel_hi:[1,0,1]
v_pk_fma_f32 v[210:211],v[158:159],2.0,v[206:207] op_sel_hi:[1,0,1]
v_pk_fma_f32 v[156:157],v[156:157],s[40:41],v[204:205] op_sel_hi:[1,0,1]
v_pk_fma_f32 v[158:159],v[158:159],s[40:41],v[206:207] op_sel_hi:[1,0,1]
M v[28:31],a[216:219],a[128:131],v[28:31]
buffer_load_dwordx4 a[156:159],v250,s[20:23],s46 offen offset:2048 sc1
M v[28:31],v[220:223],a[136:139],v[28:31]
s_waitcnt vmcnt(22) lgkmcnt(3)
v_cvt_pk_bf16_f32 v208,v208,v209
v_cvt_pk_bf16_f32 v209,v210,v211
M v[96:99],v[228:231],a[140:143],v[96:99]
s_waitcnt vmcnt(21) lgkmcnt(2)
ds_read_b128 a[148:151],v248 offset:1024
v_cvt_pk_bf16_f32 v212,v212,v213
M v[96:99],a[220:223],a[152:155],v[96:99]
s_waitcnt vmcnt(20) lgkmcnt(2)
ds_read_b128 a[128:131],v249 offset:1024
v_cvt_pk_bf16_f32 v213,v214,v215
M v[96:99],v[224:227],a[116:119],v[96:99]
s_waitcnt lgkmcnt(2)
ds_write2st64_b64 v254,v[208:209],v[212:213] offset0:25 offset1:29
M v[100:103],v[224:227],a[252:255],v[100:103]
v_cvt_pk_bf16_f32 v0,v0,v1
v_cvt_pk_bf16_f32 v1,v2,v3
M v[100:103],a[220:223],a[116:119],v[100:103]
v_cvt_pk_bf16_f32 v4,v4,v5
v_cvt_pk_bf16_f32 v5,v6,v7
M v[100:103],v[228:231],a[152:155],v[100:103]
s_waitcnt lgkmcnt(0)
s_barrier
ds_read_b128 a[32:35],v250 offset:17408
M v[104:107],v[228:231],a[116:119],v[104:107]
ds_read_b128 a[36:39],v250 offset:21504
ds_read_b128 a[40:43],v250 offset:26112
M v[104:107],a[220:223],a[252:255],v[104:107]
ds_read_b128 a[44:47],v250 offset:30208
ds_read_b128 a[48:51],v250 offset:0
M v[104:107],v[224:227],a[148:151],v[104:107]
ds_read_b128 a[52:55],v250 offset:4096
ds_read_b128 a[56:59],v250 offset:8704
M v[108:111],v[224:227],a[128:131],v[108:111]
ds_read_b128 a[60:63],v250 offset:12800
ds_read_b128 a[136:139],v248 offset:1536
M v[108:111],a[220:223],a[148:151],v[108:111]
s_add_u32 s34,s32,6291456
ds_read_b128 a[212:215],v249 offset:1536
ds_write2st64_b64 v254,v[0:1],v[4:5] offset0:68 offset1:72
M v[108:111],v[228:231],a[252:255],v[108:111]
s_waitcnt lgkmcnt(10)
buffer_store_dwordx4 a[32:35],v253,s[24:27],s34 offen offset:512 nt
M v[112:115],v[228:231],a[148:151],v[112:115]
s_add_u32 s34,s32,6488064
ds_read_b128 a[232:235],v249 offset:2048
v_cvt_pk_bf16_f32 v8,v8,v9
M v[112:115],a[220:223],a[128:131],v[112:115]
s_waitcnt lgkmcnt(3)
ds_read_b128 a[192:195],v248 offset:2048
v_cvt_pk_bf16_f32 v9,v10,v11
M v[112:115],v[224:227],a[136:139],v[112:115]
s_waitcnt lgkmcnt(3)
buffer_store_dwordx4 a[36:39],v253,s[24:27],s34 offen offset:512 nt
M v[116:119],v[224:227],a[212:215],v[116:119]
s_add_u32 s34,s32,6684672
v_cvt_pk_bf16_f32 v12,v12,v13
v_cvt_pk_bf16_f32 v13,v14,v15
M v[116:119],a[220:223],a[136:139],v[116:119]
ds_write2st64_b64 v254,v[8:9],v[12:13] offset0:76 offset1:80
M v[116:119],v[228:231],a[128:131],v[116:119]
buffer_store_dwordx4 a[40:43],v253,s[24:27],s34 offen offset:512 nt
M v[120:123],v[228:231],a[136:139],v[120:123]
s_add_u32 s34,s32,6881280
global_load_dword v216,v250,s[64:65]
M v[120:123],a[220:223],a[212:215],v[120:123]
s_waitcnt lgkmcnt(2)
s_add_u32 s47,s75,49152
v_cvt_pk_bf16_f32 v16,v16,v17
v_cvt_pk_bf16_f32 v17,v18,v19
M v[120:123],v[224:227],a[232:235],v[120:123]
s_waitcnt lgkmcnt(1)
buffer_store_dwordx4 a[44:47],v253,s[24:27],s34 offen offset:512 nt
M v[124:127],v[224:227],a[192:195],v[124:127]
s_add_u32 s34,s32,7077888
v_cvt_pk_bf16_f32 v20,v20,v21
v_cvt_pk_bf16_f32 v21,v22,v23
M v[124:127],a[220:223],a[232:235],v[124:127]
ds_write2st64_b64 v254,v[16:17],v[20:21] offset0:85 offset1:89
M v[124:127],v[228:231],a[212:215],v[124:127]
s_waitcnt vmcnt(24)
buffer_store_dwordx4 a[48:51],v253,s[24:27],s34 offen offset:512 nt
M v[128:131],a[112:115],a[140:143],v[128:131]
s_waitcnt vmcnt(24)
s_add_u32 s34,s32,7274496
v_cvt_pk_bf16_f32 v24,v24,v25
v_cvt_pk_bf16_f32 v25,v26,v27
M v[128:131],a[248:251],a[152:155],v[128:131]
s_waitcnt vmcnt(21)
v_cvt_pk_bf16_f32 v28,v28,v29
v_cvt_pk_bf16_f32 v29,v30,v31
M v[128:131],a[108:111],a[116:119],v[128:131]
buffer_store_dwordx4 a[52:55],v253,s[24:27],s34 offen offset:512 nt
M v[132:135],a[108:111],a[252:255],v[132:135]
s_add_u32 s34,s32,7471104
ds_write2st64_b64 v254,v[24:25],v[28:29] offset0:93 offset1:97
M v[132:135],a[248:251],a[116:119],v[132:135]
buffer_load_dwordx4 v[216:219],v250,s[20:23],s47 offen offset:0 sc1
M v[132:135],a[112:115],a[152:155],v[132:135]
v_accvgpr_read_b32 v238,a64
v_accvgpr_read_b32 v232,a160
M v[136:139],a[112:115],a[116:119],v[136:139]
v_add_f32 v234,v238,v232
v_sub_f32 v238,v238,v232
M v[136:139],a[248:251],a[252:255],v[136:139]
v_add_f32 v232,v64,v160
v_sub_f32 v160,v64,v160
M v[136:139],a[108:111],a[148:151],v[136:139]
buffer_load_dwordx4 a[204:207],v250,s[20:23],s47 offen offset:1024 sc1
M v[140:143],a[108:111],a[128:131],v[140:143]
v_add_f32 v64,v234,v232
v_fmac_f32 v234,4.0,v232
M v[140:143],a[248:251],a[148:151],v[140:143]
v_fma_f32 v232,2.0,v160,v238
v_fma_f32 v160,s40,v160,v238
M v[140:143],a[112:115],a[252:255],v[140:143]
s_waitcnt lgkmcnt(0)
s_barrier
ds_read_b128 v[0:3],v250 offset:34816
M v[144:147],a[112:115],a[148:151],v[144:147]
ds_read_b128 v[8:11],v250 offset:38912
ds_read_b128 v[16:19],v250 offset:43520
M v[144:147],a[248:251],a[128:131],v[144:147]
ds_read_b128 v[24:27],v250 offset:47616
v_accvgpr_read_b32 v238,a65
M v[144:147],a[108:111],a[136:139],v[144:147]
buffer_load_dwordx4 a[224:227],v250,s[20:23],s47 offen offset:2048 sc1
M v[148:151],a[108:111],a[212:215],v[148:151]
s_add_u32 s46,s76,46080
v_accvgpr_read_b32 v237,a161
v_add_f32 v236,v238,v237
M v[148:151],a[248:251],a[136:139],v[148:151]
ds_read_b128 a[140:143],v248 offset:34816
v_sub_f32 v238,v238,v237
M v[148:151],a[112:115],a[128:131],v[148:151]
buffer_store_dwordx4 a[56:59],v253,s[24:27],s34 offen offset:512 nt
M v[152:155],a[112:115],a[136:139],v[152:155]
ds_read_b128 a[152:155],v249 offset:34816
ds_read_b128 a[148:151],v248 offset:35328
M v[152:155],a[248:251],a[212:215],v[152:155]
buffer_load_dwordx4 a[116:119],v250,s[20:23],s46 offen offset:0 sc1
M v[152:155],a[108:111],a[232:235],v[152:155]
ds_read_b128 a[136:139],v249 offset:35328
v_add_f32 v237,v65,v161
M v[156:159],a[108:111],a[192:195],v[156:159]
v_sub_f32 v161,v65,v161
v_add_f32 v65,v236,v237
M v[156:159],a[248:251],a[232:235],v[156:159]
v_fmac_f32 v236,4.0,v237
v_fma_f32 v237,2.0,v161,v238
M v[156:159],a[112:115],a[212:215],v[156:159]
s_waitcnt vmcnt(26) lgkmcnt(3)
buffer_load_dwordx4 a[128:131],v250,s[20:23],s46 offen offset:1024 sc1
M v[96:99],a[200:203],a[140:143],v[96:99]
s_waitcnt vmcnt(26) lgkmcnt(2)
ds_read_b128 a[108:111],v248 offset:35840
v_fma_f32 v161,s40,v161,v238
M v[96:99],a[208:211],a[152:155],v[96:99]
s_waitcnt vmcnt(25) lgkmcnt(2)
s_add_u32 s34,s32,7667712
ds_read_b128 a[112:115],v249 offset:35840
v_cvt_pk_bf16_f32 v232,v232,v237
M v[96:99],a[120:123],a[148:151],v[96:99]
s_waitcnt lgkmcnt(2)
v_cvt_pk_bf16_f32 v234,v234,v236
v_accvgpr_read_b32 v238,a66
M v[100:103],a[120:123],a[136:139],v[100:103]
buffer_load_dwordx4 a[216:219],v250,s[20:23],s46 offen offset:2048 sc1
M v[100:103],a[208:211],a[148:151],v[100:103]
v_accvgpr_read_b32 v233,a162
v_add_f32 v235,v238,v233
M v[100:103],a[200:203],a[152:155],v[100:103]
v_sub_f32 v238,v238,v233
v_add_f32 v233,v66,v162
M v[104:107],a[200:203],a[148:151],v[104:107]
ds_read_b128 v[220:223],v248 offset:36352
v_sub_f32 v162,v66,v162
M v[104:107],a[208:211],a[136:139],v[104:107]
s_waitcnt lgkmcnt(2)
ds_read_b128 v[224:227],v249 offset:36352
v_add_f32 v66,v235,v233
M v[104:107],a[120:123],a[108:111],v[104:107]
s_waitcnt lgkmcnt(2)
buffer_store_dwordx4 a[60:63],v253,s[24:27],s34 offen offset:512 nt
M v[108:111],a[120:123],a[112:115],v[108:111]
v_fmac_f32 v235,4.0,v233
v_fma_f32 v233,2.0,v162,v238
M v[108:111],a[208:211],a[108:111],v[108:111]
v_fma_f32 v162,s40,v162,v238
v_accvgpr_read_b32 v238,a67
M v[108:111],a[200:203],a[136:139],v[108:111]
v_accvgpr_read_b32 v237,a163
v_add_f32 v236,v238,v237
M v[112:115],a[200:203],a[108:111],v[112:115]
s_add_u32 s47,s76,49152
ds_read_b128 a[160:163],v249 offset:36864
v_sub_f32 v238,v238,v237
M v[112:115],a[208:211],a[112:115],v[112:115]
s_waitcnt lgkmcnt(2)
ds_read_b128 a[220:223],v248 offset:36864
v_add_f32 v237,v67,v163
M v[112:115],a[120:123],v[220:223],v[112:115]
s_waitcnt lgkmcnt(2)
v_sub_f32 v163,v67,v163
v_add_f32 v67,v236,v237
M v[116:119],a[120:123],v[224:227],v[116:119]
v_fmac_f32 v236,4.0,v237
v_fma_f32 v237,2.0,v163,v238
M v[116:119],a[208:211],v[220:223],v[116:119]
v_fma_f32 v163,s40,v163,v238
v_cvt_pk_bf16_f32 v233,v233,v237
M v[116:119],a[200:203],a[112:115],v[116:119]
v_cvt_pk_bf16_f32 v235,v235,v236
M v[120:123],a[200:203],v[220:223],v[120:123]
buffer_load_dwordx4 v[228:231],v250,s[20:23],s47 offen offset:0 sc1
M v[120:123],a[208:211],v[224:227],v[120:123]
s_waitcnt lgkmcnt(1)
ds_write2st64_b64 v254,v[232:233],v[234:235] offset0:34 offset1:38
M v[120:123],a[120:123],a[160:163],v[120:123]
s_waitcnt lgkmcnt(1)
buffer_load_dwordx4 a[252:255],v250,s[20:23],s47 offen offset:1024 sc1
M v[124:127],a[120:123],a[220:223],v[124:127]
v_accvgpr_read_b32 v238,a68
v_accvgpr_read_b32 v232,a164
M v[124:127],a[208:211],a[160:163],v[124:127]
v_add_f32 v234,v238,v232
v_sub_f32 v238,v238,v232
M v[124:127],a[200:203],v[224:227],v[124:127]
s_waitcnt vmcnt(28)
s_add_u32 s34,s33,6291456
v_add_f32 v232,v68,v164
v_sub_f32 v164,v68,v164
M v[128:131],a[96:99],a[140:143],v[128:131]
s_waitcnt vmcnt(27)
buffer_load_dwordx4 a[192:195],v250,s[20:23],s47 offen offset:2048 sc1
M v[128:131],a[244:247],a[152:155],v[128:131]
s_waitcnt vmcnt(27)
v_add_f32 v68,v234,v232
v_fmac_f32 v234,4.0,v232
M v[128:131],a[132:135],a[148:151],v[128:131]
v_fma_f32 v232,2.0,v164,v238
v_fma_f32 v164,s40,v164,v238
M v[132:135],a[132:135],a[136:139],v[132:135]
v_accvgpr_read_b32 v238,a69
v_accvgpr_read_b32 v237,a165
M v[132:135],a[244:247],a[148:151],v[132:135]
v_add_f32 v236,v238,v237
v_sub_f32 v238,v238,v237
M v[132:135],a[96:99],a[152:155],v[132:135]
buffer_store_dwordx4 v[0:3],v253,s[24:27],s34 offen offset:0 nt
M v[136:139],a[96:99],a[148:151],v[136:139]
v_add_f32 v237,v69,v165
v_sub_f32 v165,v69,v165
M v[136:139],a[244:247],a[136:139],v[136:139]
v_add_f32 v69,v236,v237
v_fmac_f32 v236,4.0,v237
M v[136:139],a[132:135],a[108:111],v[136:139]
v_fma_f32 v237,2.0,v165,v238
v_fma_f32 v165,s40,v165,v238
M v[140:143],a[132:135],a[112:115],v[140:143]
v_cvt_pk_bf16_f32 v232,v232,v237
v_cvt_pk_bf16_f32 v234,v234,v236
M v[140:143],a[244:247],a[108:111],v[140:143]
v_accvgpr_read_b32 v238,a70
v_accvgpr_read_b32 v233,a166
M v[140:143],a[96:99],a[136:139],v[140:143]
v_add_f32 v235,v238,v233
v_sub_f32 v238,v238,v233
M v[144:147],a[96:99],a[108:111],v[144:147]
s_add_u32 s46,s77,46080
v_add_f32 v233,v70,v166
v_sub_f32 v166,v70,v166
M v[144:147],a[244:247],a[112:115],v[144:147]
v_add_f32 v70,v235,v233
v_fmac_f32 v235,4.0,v233
M v[144:147],a[132:135],v[220:223],v[144:147]
v_fma_f32 v233,2.0,v166,v238
v_fma_f32 v166,s40,v166,v238
M v[148:151],a[132:135],v[224:227],v[148:151]
v_accvgpr_read_b32 v238,a71
v_accvgpr_read_b32 v237,a167
M v[148:151],a[244:247],v[220:223],v[148:151]
ds_read_b128 a[120:123],v248 offset:52224
v_add_f32 v236,v238,v237
M v[148:151],a[96:99],a[112:115],v[148:151]
ds_read_b128 a[140:143],v249 offset:52224
v_sub_f32 v238,v238,v237
M v[152:155],a[96:99],v[220:223],v[152:155]
buffer_load_dwordx4 a[152:155],v250,s[20:23],s46 offen offset:0 sc1
M v[152:155],a[244:247],v[224:227],v[152:155]
ds_read_b128 a[148:151],v248 offset:52736
ds_read_b128 a[108:111],v249 offset:52736
M v[152:155],a[132:135],a[160:163],v[152:155]
buffer_load_dwordx4 a[136:139],v250,s[20:23],s46 offen offset:1024 sc1
M v[156:159],a[132:135],a[220:223],v[156:159]
s_add_u32 s34,s33,6684672
v_add_f32 v237,v71,v167
v_sub_f32 v167,v71,v167
M v[156:159],a[244:247],a[160:163],v[156:159]
v_add_f32 v71,v236,v237
v_fmac_f32 v236,4.0,v237
M v[156:159],a[96:99],v[224:227],v[156:159]
s_waitcnt vmcnt(29) lgkmcnt(3)
v_fma_f32 v237,2.0,v167,v238
v_fma_f32 v167,s40,v167,v238
M v[96:99],a[124:127],a[120:123],v[96:99]
s_waitcnt vmcnt(28) lgkmcnt(2)
buffer_load_dwordx4 a[164:167],v250,s[20:23],s46 offen offset:2048 sc1
M v[96:99],a[228:231],a[140:143],v[96:99]
s_waitcnt vmcnt(28) lgkmcnt(1)
ds_read_b128 a[112:115],v248 offset:53248
ds_read_b128 a[132:135],v249 offset:53248
M v[96:99],a[196:199],a[148:151],v[96:99]
s_waitcnt lgkmcnt(2)
v_cvt_pk_bf16_f32 v233,v233,v237
v_cvt_pk_bf16_f32 v235,v235,v236
M v[100:103],a[196:199],a[108:111],v[100:103]
ds_write2st64_b64 v254,v[232:233],v[234:235] offset0:42 offset1:46
M v[100:103],a[228:231],a[148:151],v[100:103]
v_accvgpr_read_b32 v238,a72
v_accvgpr_read_b32 v232,a168
M v[100:103],a[124:127],a[140:143],v[100:103]
buffer_store_dwordx4 v[8:11],v253,s[24:27],s34 offen offset:0 nt
M v[104:107],a[124:127],a[148:151],v[104:107]
ds_read_b128 a[160:163],v248 offset:53760
v_add_f32 v234,v238,v232
M v[104:107],a[228:231],a[108:111],v[104:107]
s_waitcnt lgkmcnt(3)
ds_read_b128 a[96:99],v249 offset:53760
v_sub_f32 v238,v238,v232
M v[104:107],a[196:199],a[112:115],v[104:107]
s_waitcnt lgkmcnt(3)
v_add_f32 v232,v72,v168
v_sub_f32 v168,v72,v168
M v[108:111],a[196:199],a[132:135],v[108:111]
v_add_f32 v72,v234,v232
v_fmac_f32 v234,4.0,v232
M v[108:111],a[228:231],a[112:115],v[108:111]
v_fma_f32 v232,2.0,v168,v238
v_fma_f32 v168,s40,v168,v238
M v[108:111],a[124:127],a[108:111],v[108:111]
v_accvgpr_read_b32 v238,a73
v_accvgpr_read_b32 v237,a169
M v[112:115],a[124:127],a[112:115],v[112:115]
s_add_u32 s47,s77,49152
ds_read_b128 a[232:235],v249 offset:54272
v_add_f32 v236,v238,v237
M v[112:115],a[228:231],a[132:135],v[112:115]
s_waitcnt lgkmcnt(2)
ds_read_b128 a[248:251],v248 offset:54272
v_sub_f32 v238,v238,v237
M v[112:115],a[196:199],a[160:163],v[112:115]
s_waitcnt lgkmcnt(2)
v_add_f32 v237,v73,v169
v_sub_f32 v169,v73,v169
M v[116:119],a[196:199],a[96:99],v[116:119]
v_add_f32 v73,v236,v237
v_fmac_f32 v236,4.0,v237
M v[116:119],a[228:231],a[160:163],v[116:119]
v_fma_f32 v237,2.0,v169,v238
v_fma_f32 v169,s40,v169,v238
M v[116:119],a[124:127],a[132:135],v[116:119]
v_cvt_pk_bf16_f32 v232,v232,v237
v_cvt_pk_bf16_f32 v234,v234,v236
M v[120:123],a[124:127],a[160:163],v[120:123]
buffer_load_dwordx4 a[212:215],v250,s[20:23],s47 offen offset:0 sc1
M v[120:123],a[228:231],a[96:99],v[120:123]
s_waitcnt lgkmcnt(1)
s_add_u32 s34,s33,7077888
v_accvgpr_read_b32 v238,a74
v_accvgpr_read_b32 v233,a170
M v[120:123],a[196:199],a[232:235],v[120:123]
s_waitcnt lgkmcnt(0)
buffer_load_dwordx4 a[208:211],v250,s[20:23],s47 offen offset:1024 sc1
M v[124:127],a[196:199],a[248:251],v[124:127]
v_add_f32 v235,v238,v233
v_sub_f32 v238,v238,v233
M v[124:127],a[228:231],a[232:235],v[124:127]
v_add_f32 v233,v74,v170
v_sub_f32 v170,v74,v170
M v[124:127],a[124:127],a[96:99],v[124:127]
s_waitcnt vmcnt(30)
v_add_f32 v74,v235,v233
v_fmac_f32 v235,4.0,v233
M v[128:131],a[100:103],a[120:123],v[128:131]
s_waitcnt vmcnt(29)
buffer_load_dwordx4 a[200:203],v250,s[20:23],s47 offen offset:2048 sc1
M v[128:131],a[236:239],a[140:143],v[128:131]
s_waitcnt vmcnt(29)
v_fma_f32 v233,2.0,v170,v238
v_fma_f32 v170,s40,v170,v238
M v[128:131],a[240:243],a[148:151],v[128:131]
v_accvgpr_read_b32 v238,a75
v_accvgpr_read_b32 v237,a171
M v[132:135],a[240:243],a[108:111],v[132:135]
v_add_f32 v236,v238,v237
v_sub_f32 v238,v238,v237
M v[132:135],a[236:239],a[148:151],v[132:135]
v_add_f32 v237,v75,v171
v_sub_f32 v171,v75,v171
M v[132:135],a[100:103],a[140:143],v[132:135]
buffer_store_dwordx4 v[16:19],v253,s[24:27],s34 offen offset:0 nt
M v[136:139],a[100:103],a[148:151],v[136:139]
v_add_f32 v75,v236,v237
v_fmac_f32 v236,4.0,v237
M v[136:139],a[236:239],a[108:111],v[136:139]
v_fma_f32 v237,2.0,v171,v238
v_fma_f32 v171,s40,v171,v238
M v[136:139],a[240:243],a[112:115],v[136:139]
v_cvt_pk_bf16_f32 v233,v233,v237
v_cvt_pk_bf16_f32 v235,v235,v236
M v[140:143],a[240:243],a[132:135],v[140:143]
ds_write2st64_b64 v254,v[232:233],v[234:235] offset0:51 offset1:55
M v[140:143],a[236:239],a[112:115],v[140:143]
v_accvgpr_read_b32 v238,a76
v_accvgpr_read_b32 v232,a172
M v[140:143],a[100:103],a[108:111],v[140:143]
v_add_f32 v234,v238,v232
v_sub_f32 v238,v238,v232
M v[144:147],a[100:103],a[112:115],v[144:147]
s_add_u32 s47,s72,3072
v_add_f32 v232,v76,v172
v_sub_f32 v172,v76,v172
M v[144:147],a[236:239],a[132:135],v[144:147]
v_add_u32 v248,0x11000,v248
v_add_u32 v249,0x11000,v249
M v[144:147],a[240:243],a[160:163],v[144:147]
v_add_f32 v76,v234,v232
v_fmac_f32 v234,4.0,v232
M v[148:151],a[240:243],a[96:99],v[148:151]
v_fma_f32 v232,2.0,v172,v238
v_fma_f32 v172,s40,v172,v238
M v[148:151],a[236:239],a[160:163],v[148:151]
ds_read_b128 a[124:127],v248 offset:0
v_accvgpr_read_b32 v238,a77
M v[148:151],a[100:103],a[132:135],v[148:151]
s_add_u32 s34,s33,7471104
buffer_store_dwordx4 v[24:27],v253,s[24:27],s34 offen offset:0 nt
M v[152:155],a[100:103],a[160:163],v[152:155]
buffer_load_dwordx4 a[168:171],v250,s[20:23],s47 offen offset:0 sc1
M v[152:155],a[236:239],a[96:99],v[152:155]
ds_read_b128 a[120:123],v249 offset:0
ds_read_b128 a[140:143],v248 offset:512
M v[152:155],a[240:243],a[232:235],v[152:155]
ds_read_b128 a[108:111],v249 offset:512
v_accvgpr_read_b32 v237,a173
M v[156:159],a[240:243],a[248:251],v[156:159]
v_add_f32 v236,v238,v237
v_sub_f32 v238,v238,v237
M v[156:159],a[236:239],a[232:235],v[156:159]
buffer_load_dwordx4 a[148:151],v250,s[20:23],s47 offen offset:1024 sc1
M v[156:159],a[100:103],a[96:99],v[156:159]
s_waitcnt vmcnt(32) lgkmcnt(3)
v_add_f32 v237,v77,v173
v_sub_f32 v173,v77,v173
M v[96:99],a[144:147],a[124:127],v[96:99]
s_waitcnt vmcnt(31) lgkmcnt(2)
ds_read_b128 a[132:135],v248 offset:1024
v_add_f32 v77,v236,v237
M v[96:99],a[104:107],a[120:123],v[96:99]
s_waitcnt vmcnt(30) lgkmcnt(2)
ds_read_b128 a[160:163],v249 offset:1024
v_fmac_f32 v236,4.0,v237
M v[96:99],a[156:159],a[140:143],v[96:99]
s_waitcnt lgkmcnt(2)
buffer_load_dwordx4 a[112:115],v250,s[20:23],s47 offen offset:2048 sc1
M v[100:103],a[156:159],a[108:111],v[100:103]
v_fma_f32 v237,2.0,v173,v238
v_fma_f32 v173,s40,v173,v238
M v[100:103],a[104:107],a[140:143],v[100:103]
v_cvt_pk_bf16_f32 v232,v232,v237
v_cvt_pk_bf16_f32 v234,v234,v236
M v[100:103],a[144:147],a[120:123],v[100:103]
v_accvgpr_read_b32 v238,a78
v_accvgpr_read_b32 v233,a174
M v[104:107],a[144:147],a[140:143],v[104:107]
ds_read_b128 a[96:99],v248 offset:1536
v_add_f32 v235,v238,v233
M v[104:107],a[104:107],a[108:111],v[104:107]
s_waitcnt lgkmcnt(2)
ds_read_b128 a[100:103],v249 offset:1536
v_sub_f32 v238,v238,v233
M v[104:107],a[156:159],a[132:135],v[104:107]
s_waitcnt lgkmcnt(2)
v_add_f32 v233,v78,v174
v_sub_f32 v174,v78,v174
M v[108:111],a[156:159],a[160:163],v[108:111]
v_add_f32 v78,v235,v233
v_fmac_f32 v235,4.0,v233
M v[108:111],a[104:107],a[132:135],v[108:111]
v_fma_f32 v233,2.0,v174,v238
v_fma_f32 v174,s40,v174,v238
M v[108:111],a[144:147],a[108:111],v[108:111]
v_accvgpr_read_b32 v238,a79
v_accvgpr_read_b32 v237,a175
M v[112:115],a[144:147],a[132:135],v[112:115]
s_add_u32 s48,s72,6144
ds_read_b128 a[172:175],v249 offset:2048
v_add_f32 v236,v238,v237
M v[112:115],a[104:107],a[160:163],v[112:115]
s_waitcnt lgkmcnt(2)
ds_read_b128 v[220:223],v248 offset:2048
v_sub_f32 v238,v238,v237
M v[112:115],a[156:159],a[96:99],v[112:115]
s_waitcnt lgkmcnt(2)
v_add_f32 v237,v79,v175
v_sub_f32 v175,v79,v175
M v[116:119],a[156:159],a[100:103],v[116:119]
v_add_f32 v79,v236,v237
v_fmac_f32 v236,4.0,v237
M v[116:119],a[104:107],a[96:99],v[116:119]
v_fma_f32 v237,2.0,v175,v238
v_fma_f32 v175,s40,v175,v238
M v[116:119],a[144:147],a[160:163],v[116:119]
v_cvt_pk_bf16_f32 v233,v233,v237
v_cvt_pk_bf16_f32 v235,v235,v236
M v[120:123],a[144:147],a[96:99],v[120:123]
buffer_load_dwordx4 a[220:223],v250,s[20:23],s48 offen offset:0 sc1
M v[120:123],a[104:107],a[100:103],v[120:123]
s_waitcnt lgkmcnt(1)
ds_write2st64_b64 v254,v[232:233],v[234:235] offset0:59 offset1:63
M v[120:123],a[156:159],a[172:175],v[120:123]
s_waitcnt lgkmcnt(1)
buffer_load_dwordx4 a[244:247],v250,s[20:23],s48 offen offset:1024 sc1
M v[124:127],a[156:159],v[220:223],v[124:127]
v_accvgpr_read_b32 v238,a80
v_accvgpr_read_b32 v232,a176
M v[124:127],a[104:107],a[172:175],v[124:127]
v_add_f32 v234,v238,v232
v_sub_f32 v238,v238,v232
M v[124:127],a[144:147],a[100:103],v[124:127]
s_waitcnt vmcnt(25)
v_add_f32 v232,v80,v176
v_sub_f32 v176,v80,v176
M v[128:131],v[216:219],a[124:127],v[128:131]
s_waitcnt vmcnt(24)
buffer_load_dwordx4 v[224:227],v250,s[20:23],s48 offen offset:2048 sc1
M v[128:131],a[204:207],a[120:123],v[128:131]
s_waitcnt vmcnt(24)
v_add_f32 v80,v234,v232
v_fmac_f32 v234,4.0,v232
M v[128:131],a[224:227],a[140:143],v[128:131]
v_fma_f32 v232,2.0,v176,v238
v_fma_f32 v176,s40,v176,v238
M v[132:135],a[224:227],a[108:111],v[132:135]
v_accvgpr_read_b32 v238,a81
v_accvgpr_read_b32 v237,a177
M v[132:135],a[204:207],a[140:143],v[132:135]
v_add_f32 v236,v238,v237
v_sub_f32 v238,v238,v237
M v[132:135],v[216:219],a[120:123],v[132:135]
v_add_f32 v237,v81,v177
v_sub_f32 v177,v81,v177
M v[136:139],v[216:219],a[140:143],v[136:139]
v_add_f32 v81,v236,v237
v_fmac_f32 v236,4.0,v237
M v[136:139],a[204:207],a[108:111],v[136:139]
v_fma_f32 v237,2.0,v177,v238
v_fma_f32 v177,s40,v177,v238
M v[136:139],a[224:227],a[132:135],v[136:139]
v_cvt_pk_bf16_f32 v232,v232,v237
v_cvt_pk_bf16_f32 v234,v234,v236
M v[140:143],a[224:227],a[160:163],v[140:143]
v_accvgpr_read_b32 v238,a82
v_accvgpr_read_b32 v233,a178
M v[140:143],a[204:207],a[132:135],v[140:143]
v_add_f32 v235,v238,v233
v_sub_f32 v238,v238,v233
M v[140:143],v[216:219],a[108:111],v[140:143]
v_add_f32 v233,v82,v178
v_sub_f32 v178,v82,v178
M v[144:147],v[216:219],a[132:135],v[144:147]
s_add_u32 s47,s73,3072
v_add_f32 v82,v235,v233
v_fmac_f32 v235,4.0,v233
M v[144:147],a[204:207],a[160:163],v[144:147]
v_fma_f32 v233,2.0,v178,v238
v_fma_f32 v178,s40,v178,v238
M v[144:147],a[224:227],a[96:99],v[144:147]
v_accvgpr_read_b32 v238,a83
v_accvgpr_read_b32 v237,a179
M v[148:151],a[224:227],a[100:103],v[148:151]
v_add_f32 v236,v238,v237
v_sub_f32 v238,v238,v237
M v[148:151],a[204:207],a[96:99],v[148:151]
ds_read_b128 a[156:159],v248 offset:17408
v_add_f32 v237,v83,v179
M v[148:151],v[216:219],a[160:163],v[148:151]
ds_read_b128 a[104:107],v249 offset:17408
v_sub_f32 v179,v83,v179
M v[152:155],v[216:219],a[96:99],v[152:155]
buffer_load_dwordx4 a[144:147],v250,s[20:23],s47 offen offset:0 sc1
M v[152:155],a[204:207],a[100:103],v[152:155]
ds_read_b128 a[124:127],v248 offset:17920
ds_read_b128 a[140:143],v249 offset:17920
M v[152:155],a[224:227],a[172:175],v[152:155]
buffer_load_dwordx4 a[120:123],v250,s[20:23],s47 offen offset:1024 sc1
M v[156:159],a[224:227],v[220:223],v[156:159]
v_add_f32 v83,v236,v237
v_fmac_f32 v236,4.0,v237
M v[156:159],a[204:207],a[172:175],v[156:159]
v_fma_f32 v237,2.0,v179,v238
v_fma_f32 v179,s40,v179,v238
M v[156:159],v[216:219],a[100:103],v[156:159]
s_waitcnt vmcnt(24) lgkmcnt(3)
v_cvt_pk_bf16_f32 v233,v233,v237
v_cvt_pk_bf16_f32 v235,v235,v236
M v[96:99],a[116:119],a[156:159],v[96:99]
s_waitcnt vmcnt(23) lgkmcnt(2)
buffer_load_dwordx4 a[108:111],v250,s[20:23],s47 offen offset:2048 sc1
M v[96:99],a[128:131],a[104:107],v[96:99]
s_waitcnt vmcnt(23) lgkmcnt(1)
ds_read_b128 a[132:135],v248 offset:18432
ds_read_b128 a[176:179],v249 offset:18432
M v[96:99],a[216:219],a[124:127],v[96:99]
s_waitcnt lgkmcnt(2)
ds_write2st64_b64 v254,v[232:233],v[234:235] offset0:0 offset1:4
M v[100:103],a[216:219],a[140:143],v[100:103]
v_accvgpr_read_b32 v238,a84
v_accvgpr_read_b32 v232,a180
M v[100:103],a[128:131],a[124:127],v[100:103]
v_add_f32 v234,v238,v232
v_sub_f32 v238,v238,v232
M v[100:103],a[116:119],a[104:107],v[100:103]
v_add_f32 v232,v84,v180
v_sub_f32 v180,v84,v180
M v[104:107],a[116:119],a[124:127],v[104:107]
ds_read_b128 a[160:163],v248 offset:18944
v_add_f32 v84,v234,v232
M v[104:107],a[128:131],a[140:143],v[104:107]
s_waitcnt lgkmcnt(3)
ds_read_b128 a[96:99],v249 offset:18944
v_fmac_f32 v234,4.0,v232
M v[104:107],a[216:219],a[132:135],v[104:107]
s_waitcnt lgkmcnt(3)
v_fma_f32 v232,2.0,v180,v238
v_fma_f32 v180,s40,v180,v238
M v[108:111],a[216:219],a[176:179],v[108:111]
v_accvgpr_read_b32 v238,a85
v_accvgpr_read_b32 v237,a181
M v[108:111],a[128:131],a[132:135],v[108:111]
v_add_f32 v236,v238,v237
v_sub_f32 v238,v238,v237
M v[108:111],a[116:119],a[140:143],v[108:111]
v_add_f32 v237,v85,v181
v_sub_f32 v181,v85,v181
M v[112:115],a[116:119],a[132:135],v[112:115]
s_add_u32 s48,s73,6144
ds_read_b128 a[172:175],v249 offset:19456
v_add_f32 v85,v236,v237
M v[112:115],a[128:131],a[176:179],v[112:115]
s_waitcnt lgkmcnt(2)
ds_read_b128 a[100:103],v248 offset:19456
v_fmac_f32 v236,4.0,v237
M v[112:115],a[216:219],a[160:163],v[112:115]
s_waitcnt lgkmcnt(2)
v_fma_f32 v237,2.0,v181,v238
v_fma_f32 v181,s40,v181,v238
M v[116:119],a[216:219],a[96:99],v[116:119]
v_cvt_pk_bf16_f32 v232,v232,v237
v_cvt_pk_bf16_f32 v234,v234,v236
M v[116:119],a[128:131],a[160:163],v[116:119]
v_accvgpr_read_b32 v238,a86
v_accvgpr_read_b32 v233,a182
M v[116:119],a[116:119],a[176:179],v[116:119]
v_add_f32 v235,v238,v233
v_sub_f32 v238,v238,v233
M v[120:123],a[116:119],a[160:163],v[120:123]
buffer_load_dwordx4 a[196:199],v250,s[20:23],s48 offen offset:0 sc1
M v[120:123],a[128:131],a[96:99],v[120:123]
s_waitcnt lgkmcnt(1)
v_add_f32 v233,v86,v182
v_sub_f32 v182,v86,v182
M v[120:123],a[216:219],a[172:175],v[120:123]
s_waitcnt lgkmcnt(0)
buffer_load_dwordx4 a[228:231],v250,s[20:23],s48 offen offset:1024 sc1
M v[124:127],a[216:219],a[100:103],v[124:127]
v_add_f32 v86,v235,v233
v_fmac_f32 v235,4.0,v233
M v[124:127],a[128:131],a[172:175],v[124:127]
v_fma_f32 v233,2.0,v182,v238
v_fma_f32 v182,s40,v182,v238
M v[124:127],a[116:119],a[96:99],v[124:127]
s_waitcnt vmcnt(23)
v_accvgpr_read_b32 v238,a87
v_accvgpr_read_b32 v237,a183
M v[128:131],v[228:231],a[156:159],v[128:131]
s_waitcnt vmcnt(22)
buffer_load_dwordx4 a[240:243],v250,s[20:23],s48 offen offset:2048 sc1
M v[128:131],a[252:255],a[104:107],v[128:131]
s_waitcnt vmcnt(22)
v_add_f32 v236,v238,v237
v_sub_f32 v238,v238,v237
M v[128:131],a[192:195],a[124:127],v[128:131]
v_add_f32 v237,v87,v183
v_sub_f32 v183,v87,v183
M v[132:135],a[192:195],a[140:143],v[132:135]
v_add_f32 v87,v236,v237
v_fmac_f32 v236,4.0,v237
M v[132:135],a[252:255],a[124:127],v[132:135]
v_fma_f32 v237,2.0,v183,v238
v_fma_f32 v183,s40,v183,v238
M v[132:135],v[228:231],a[104:107],v[132:135]
v_cvt_pk_bf16_f32 v233,v233,v237
v_cvt_pk_bf16_f32 v235,v235,v236
M v[136:139],v[228:231],a[124:127],v[136:139]
ds_write2st64_b64 v254,v[232:233],v[234:235] offset0:8 offset1:12
M v[136:139],a[252:255],a[140:143],v[136:139]
v_accvgpr_read_b32 v238,a88
v_accvgpr_read_b32 v232,a184
M v[136:139],a[192:195],a[132:135],v[136:139]
v_add_f32 v234,v238,v232
v_sub_f32 v238,v238,v232
M v[140:143],a[192:195],a[176:179],v[140:143]
v_add_f32 v232,v88,v184
v_sub_f32 v184,v88,v184
M v[140:143],a[252:255],a[132:135],v[140:143]
v_add_f32 v88,v234,v232
v_fmac_f32 v234,4.0,v232
M v[140:143],v[228:231],a[140:143],v[140:143]
v_fma_f32 v232,2.0,v184,v238
v_fma_f32 v184,s40,v184,v238
M v[144:147],v[228:231],a[132:135],v[144:147]
s_add_u32 s47,s74,3072
v_accvgpr_read_b32 v238,a89
v_accvgpr_read_b32 v237,a185
M v[144:147],a[252:255],a[176:179],v[144:147]
v_add_u32 v248,0xfffece00,v248
v_add_u32 v249,0xfffece00,v249
M v[144:147],a[192:195],a[160:163],v[144:147]
v_add_f32 v236,v238,v237
v_sub_f32 v238,v238,v237
M v[148:151],a[192:195],a[96:99],v[148:151]
v_add_f32 v237,v89,v185
v_sub_f32 v185,v89,v185
M v[148:151],a[252:255],a[160:163],v[148:151]
ds_read_b128 a[128:131],v248 offset:26112
v_add_f32 v89,v236,v237
M v[148:151],v[228:231],a[176:179],v[148:151]
ds_read_b128 a[116:119],v249 offset:26112
v_fmac_f32 v236,4.0,v237
M v[152:155],v[228:231],a[160:163],v[152:155]
buffer_load_dwordx4 a[156:159],v250,s[20:23],s47 offen offset:0 sc1
M v[152:155],a[252:255],a[96:99],v[152:155]
ds_read_b128 a[180:183],v248 offset:26624
ds_read_b128 a[124:127],v249 offset:26624
M v[152:155],a[192:195],a[172:175],v[152:155]
buffer_load_dwordx4 a[104:107],v250,s[20:23],s47 offen offset:1024 sc1
M v[156:159],a[192:195],a[100:103],v[156:159]
v_fma_f32 v237,2.0,v185,v238
v_fma_f32 v185,s40,v185,v238
M v[156:159],a[252:255],a[172:175],v[156:159]
v_cvt_pk_bf16_f32 v232,v232,v237
v_cvt_pk_bf16_f32 v234,v234,v236
M v[156:159],v[228:231],a[96:99],v[156:159]
s_waitcnt vmcnt(22) lgkmcnt(3)
v_accvgpr_read_b32 v238,a90
v_accvgpr_read_b32 v233,a186
M v[96:99],a[152:155],a[128:131],v[96:99]
s_waitcnt vmcnt(21) lgkmcnt(2)
buffer_load_dwordx4 a[140:143],v250,s[20:23],s47 offen offset:2048 sc1
M v[96:99],a[136:139],a[116:119],v[96:99]
s_waitcnt vmcnt(21) lgkmcnt(1)
ds_read_b128 a[132:135],v248 offset:27136
ds_read_b128 a[176:179],v249 offset:27136
M v[96:99],a[164:167],a[180:183],v[96:99]
s_waitcnt lgkmcnt(2)
v_add_f32 v235,v238,v233
v_sub_f32 v238,v238,v233
M v[100:103],a[164:167],a[124:127],v[100:103]
v_add_f32 v233,v90,v186
v_sub_f32 v186,v90,v186
M v[100:103],a[136:139],a[180:183],v[100:103]
v_add_f32 v90,v235,v233
v_fmac_f32 v235,4.0,v233
M v[100:103],a[152:155],a[116:119],v[100:103]
v_fma_f32 v233,2.0,v186,v238
v_fma_f32 v186,s40,v186,v238
M v[104:107],a[152:155],a[180:183],v[104:107]
ds_read_b128 a[160:163],v248 offset:27648
v_accvgpr_read_b32 v238,a91
M v[104:107],a[136:139],a[124:127],v[104:107]
s_waitcnt lgkmcnt(2)
ds_read_b128 a[100:103],v249 offset:27648
v_accvgpr_read_b32 v237,a187
M v[104:107],a[164:167],a[132:135],v[104:107]
s_waitcnt lgkmcnt(2)
v_add_f32 v236,v238,v237
v_sub_f32 v238,v238,v237
M v[108:111],a[164:167],a[176:179],v[108:111]
v_add_f32 v237,v91,v187
v_sub_f32 v187,v91,v187
M v[108:111],a[136:139],a[132:135],v[108:111]
v_add_f32 v91,v236,v237
v_fmac_f32 v236,4.0,v237
M v[108:111],a[152:155],a[124:127],v[108:111]
v_fma_f32 v237,2.0,v187,v238
v_fma_f32 v187,s40,v187,v238
M v[112:115],a[152:155],a[132:135],v[112:115]
s_add_u32 s48,s74,6144
ds_read_b128 a[172:175],v249 offset:28160
v_cvt_pk_bf16_f32 v233,v233,v237
M v[112:115],a[136:139],a[176:179],v[112:115]
s_waitcnt lgkmcnt(2)
ds_read_b128 a[96:99],v248 offset:28160
v_cvt_pk_bf16_f32 v235,v235,v236
M v[112:115],a[164:167],a[160:163],v[112:115]
s_waitcnt lgkmcnt(2)
ds_write2st64_b64 v254,v[232:233],v[234:235] offset0:17 offset1:21
M v[116:119],a[164:167],a[100:103],v[116:119]
v_accvgpr_read_b32 v238,a92
v_accvgpr_read_b32 v232,a188
M v[116:119],a[136:139],a[160:163],v[116:119]
v_add_f32 v234,v238,v232
v_sub_f32 v238,v238,v232
M v[116:119],a[152:155],a[176:179],v[116:119]
v_add_f32 v232,v92,v188
v_sub_f32 v188,v92,v188
M v[120:123],a[152:155],a[160:163],v[120:123]
buffer_load_dwordx4 a[184:187],v250,s[20:23],s48 offen offset:0 sc1
M v[120:123],a[136:139],a[100:103],v[120:123]
s_waitcnt lgkmcnt(2)
v_add_f32 v92,v234,v232
v_fmac_f32 v234,4.0,v232
M v[120:123],a[164:167],a[172:175],v[120:123]
s_waitcnt lgkmcnt(1)
buffer_load_dwordx4 a[248:251],v250,s[20:23],s48 offen offset:1024 sc1
M v[124:127],a[164:167],a[96:99],v[124:127]
v_fma_f32 v232,2.0,v188,v238
v_fma_f32 v188,s40,v188,v238
M v[124:127],a[136:139],a[172:175],v[124:127]
v_accvgpr_read_b32 v238,a93
v_accvgpr_read_b32 v237,a189
M v[124:127],a[152:155],a[100:103],v[124:127]
s_waitcnt vmcnt(21)
v_add_f32 v236,v238,v237
v_sub_f32 v238,v238,v237
M v[128:131],a[212:215],a[128:131],v[128:131]
s_waitcnt vmcnt(20)
buffer_load_dwordx4 a[232:235],v250,s[20:23],s48 offen offset:2048 sc1
M v[128:131],a[208:211],a[116:119],v[128:131]
s_waitcnt vmcnt(20)
v_add_f32 v237,v93,v189
v_sub_f32 v189,v93,v189
M v[128:131],a[200:203],a[180:183],v[128:131]
v_add_f32 v93,v236,v237
v_fmac_f32 v236,4.0,v237
M v[132:135],a[200:203],a[124:127],v[132:135]
v_fma_f32 v237,2.0,v189,v238
v_fma_f32 v189,s40,v189,v238
M v[132:135],a[208:211],a[180:183],v[132:135]
v_cvt_pk_bf16_f32 v232,v232,v237
v_cvt_pk_bf16_f32 v234,v234,v236
M v[132:135],a[212:215],a[116:119],v[132:135]
v_accvgpr_read_b32 v238,a94
v_accvgpr_read_b32 v233,a190
M v[136:139],a[212:215],a[180:183],v[136:139]
v_add_f32 v235,v238,v233
v_sub_f32 v238,v238,v233
M v[136:139],a[208:211],a[124:127],v[136:139]
v_add_f32 v233,v94,v190
v_sub_f32 v190,v94,v190
M v[136:139],a[200:203],a[132:135],v[136:139]
v_add_f32 v94,v235,v233
v_fmac_f32 v235,4.0,v233
M v[140:143],a[200:203],a[176:179],v[140:143]
v_fma_f32 v233,2.0,v190,v238
v_fma_f32 v190,s40,v190,v238
M v[140:143],a[208:211],a[132:135],v[140:143]
v_accvgpr_read_b32 v238,a95
v_accvgpr_read_b32 v237,a191
M v[140:143],a[212:215],a[124:127],v[140:143]
v_add_f32 v236,v238,v237
v_sub_f32 v238,v238,v237
M v[144:147],a[212:215],a[132:135],v[144:147]
s_add_u32 s47,s75,3072
v_add_f32 v237,v95,v191
v_sub_f32 v191,v95,v191
M v[144:147],a[208:211],a[176:179],v[144:147]
v_add_f32 v95,v236,v237
v_fmac_f32 v236,4.0,v237
M v[144:147],a[200:203],a[160:163],v[144:147]
v_fma_f32 v237,2.0,v191,v238
v_fma_f32 v191,s40,v191,v238
M v[148:151],a[200:203],a[100:103],v[148:151]
v_cvt_pk_bf16_f32 v233,v233,v237
v_cvt_pk_bf16_f32 v235,v235,v236
M v[148:151],a[208:211],a[160:163],v[148:151]
ds_read_b128 a[164:167],v248 offset:0
ds_write2st64_b64 v254,v[232:233],v[234:235] offset0:25 offset1:29
M v[148:151],a[212:215],a[176:179],v[148:151]
ds_read_b128 a[136:139],v249 offset:0
v_cvt_pk_bf16_f32 v96,v96,v97
M v[152:155],a[212:215],a[160:163],v[152:155]
buffer_load_dwordx4 a[152:155],v250,s[20:23],s47 offen offset:0 sc1
M v[152:155],a[208:211],a[100:103],v[152:155]
ds_read_b128 a[128:131],v248 offset:512
ds_read_b128 a[180:183],v249 offset:512
M v[152:155],a[200:203],a[172:175],v[152:155]
buffer_load_dwordx4 a[116:119],v250,s[20:23],s47 offen offset:1024 sc1
M v[156:159],a[200:203],a[96:99],v[156:159]
v_cvt_pk_bf16_f32 v97,v98,v99
v_cvt_pk_bf16_f32 v100,v100,v101
M v[156:159],a[208:211],a[172:175],v[156:159]
v_cvt_pk_bf16_f32 v101,v102,v103
M v[156:159],a[212:215],a[100:103],v[156:159]
s_waitcnt vmcnt(19) lgkmcnt(3)
s_barrier
ds_read_b128 a[64:67],v250 offset:17408
M v[32:35],a[168:171],a[164:167],v[32:35]
s_waitcnt vmcnt(18) lgkmcnt(3)
ds_read_b128 a[68:71],v250 offset:21504
ds_read_b128 a[72:75],v250 offset:26112
M v[32:35],a[148:151],a[136:139],v[32:35]
s_waitcnt vmcnt(17) lgkmcnt(4)
ds_read_b128 a[76:79],v250 offset:30208
ds_read_b128 a[80:83],v250 offset:0
M v[32:35],a[112:115],a[128:131],v[32:35]
s_waitcnt lgkmcnt(5)
ds_read_b128 a[84:87],v250 offset:4096
ds_read_b128 a[88:91],v250 offset:8704
M v[36:39],a[112:115],a[180:183],v[36:39]
ds_read_b128 a[92:95],v250 offset:12800
ds_read_b128 a[188:191],v248 offset:1024
M v[36:39],a[148:151],a[128:131],v[36:39]
s_add_u32 s34,s32,6291456
buffer_load_dwordx4 a[124:127],v250,s[20:23],s47 offen offset:2048 sc1
ds_read_b128 a[132:135],v249 offset:1024
M v[36:39],a[168:171],a[136:139],v[36:39]
ds_write2st64_b64 v254,v[96:97],v[100:101] offset0:68 offset1:72
M v[40:43],a[168:171],a[128:131],v[40:43]
ds_read_b128 a[176:179],v248 offset:1536
v_cvt_pk_bf16_f32 v104,v104,v105
M v[40:43],a[148:151],a[180:183],v[40:43]
s_waitcnt lgkmcnt(3)
ds_read_b128 a[160:163],v249 offset:1536
v_cvt_pk_bf16_f32 v105,v106,v107
M v[40:43],a[112:115],a[188:191],v[40:43]
s_waitcnt lgkmcnt(3)
buffer_store_dwordx4 a[64:67],v253,s[24:27],s34 offen offset:640 nt
M v[44:47],a[112:115],a[132:135],v[44:47]
s_add_u32 s34,s32,6488064
v_cvt_pk_bf16_f32 v108,v108,v109
v_cvt_pk_bf16_f32 v109,v110,v111
M v[44:47],a[148:151],a[188:191],v[44:47]
ds_write2st64_b64 v254,v[104:105],v[108:109] offset0:76 offset1:80
M v[44:47],a[168:171],a[180:183],v[44:47]
buffer_store_dwordx4 a[68:71],v253,s[24:27],s34 offen offset:640 nt
M v[48:51],a[168:171],a[188:191],v[48:51]
s_add_u32 s34,s32,6684672
ds_read_b128 a[96:99],v249 offset:2048
s_add_u32 s48,s75,6144
M v[48:51],a[148:151],a[132:135],v[48:51]
s_waitcnt lgkmcnt(3)
ds_read_b128 a[172:175],v248 offset:2048
v_cvt_pk_bf16_f32 v112,v112,v113
M v[48:51],a[112:115],a[176:179],v[48:51]
s_waitcnt lgkmcnt(3)
buffer_store_dwordx4 a[72:75],v253,s[24:27],s34 offen offset:640 nt
M v[52:55],a[112:115],a[160:163],v[52:55]
s_add_u32 s34,s32,6881280
v_cvt_pk_bf16_f32 v113,v114,v115
v_cvt_pk_bf16_f32 v116,v116,v117
M v[52:55],a[148:151],a[176:179],v[52:55]
v_cvt_pk_bf16_f32 v117,v118,v119
M v[52:55],a[168:171],a[132:135],v[52:55]
buffer_store_dwordx4 a[76:79],v253,s[24:27],s34 offen offset:640 nt
M v[56:59],a[168:171],a[176:179],v[56:59]
s_add_u32 s34,s32,7077888
buffer_load_dwordx4 a[100:103],v250,s[20:23],s48 offen offset:0 sc1
M v[56:59],a[148:151],a[160:163],v[56:59]
s_waitcnt lgkmcnt(1)
ds_write2st64_b64 v254,v[112:113],v[116:117] offset0:85 offset1:89
M v[56:59],a[112:115],a[96:99],v[56:59]
s_waitcnt lgkmcnt(1)
v_cvt_pk_bf16_f32 v120,v120,v121
v_cvt_pk_bf16_f32 v121,v122,v123
M v[60:63],a[112:115],a[172:175],v[60:63]
v_cvt_pk_bf16_f32 v124,v124,v125
v_cvt_pk_bf16_f32 v125,v126,v127
M v[60:63],a[148:151],a[96:99],v[60:63]
buffer_load_dwordx4 a[236:239],v250,s[20:23],s48 offen offset:1024 sc1
M v[60:63],a[168:171],a[160:163],v[60:63]
s_waitcnt vmcnt(23)
ds_write2st64_b64 v254,v[120:121],v[124:125] offset0:93 offset1:97
M v[64:67],a[220:223],a[164:167],v[64:67]
s_waitcnt vmcnt(22)
v_cvt_pk_bf16_f32 v128,v128,v129
v_cvt_pk_bf16_f32 v129,v130,v131
M v[64:67],a[244:247],a[136:139],v[64:67]
s_waitcnt vmcnt(21)
buffer_load_dwordx4 a[224:227],v250,s[20:23],s48 offen offset:2048 sc1
M v[64:67],v[224:227],a[128:131],v[64:67]
v_cvt_pk_bf16_f32 v132,v132,v133
v_cvt_pk_bf16_f32 v133,v134,v135
M v[68:71],v[224:227],a[180:183],v[68:71]
s_waitcnt lgkmcnt(0)
s_barrier
ds_read_b128 v[96:99],v250 offset:34816
M v[68:71],a[244:247],a[128:131],v[68:71]
ds_read_b128 v[104:107],v250 offset:38912
ds_read_b128 v[112:115],v250 offset:43520
M v[68:71],a[220:223],a[136:139],v[68:71]
ds_read_b128 v[120:123],v250 offset:47616
buffer_store_dwordx4 a[80:83],v253,s[24:27],s34 offen offset:640 nt
M v[72:75],a[220:223],a[128:131],v[72:75]
s_add_u32 s34,s32,7274496
ds_write2st64_b64 v254,v[128:129],v[132:133] offset0:34 offset1:38
M v[72:75],a[244:247],a[180:183],v[72:75]
v_cvt_pk_bf16_f32 v136,v136,v137
v_cvt_pk_bf16_f32 v137,v138,v139
M v[72:75],v[224:227],a[188:191],v[72:75]
buffer_store_dwordx4 a[84:87],v253,s[24:27],s34 offen offset:640 nt
M v[76:79],v[224:227],a[132:135],v[76:79]
s_add_u32 s34,s32,7471104
v_cvt_pk_bf16_f32 v140,v140,v141
v_cvt_pk_bf16_f32 v141,v142,v143
M v[76:79],a[244:247],a[188:191],v[76:79]
ds_write2st64_b64 v254,v[136:137],v[140:141] offset0:42 offset1:46
M v[76:79],a[220:223],a[180:183],v[76:79]
buffer_store_dwordx4 a[88:91],v253,s[24:27],s34 offen offset:640 nt
M v[80:83],a[220:223],a[188:191],v[80:83]
s_add_u32 s34,s32,7667712
s_add_u32 s47,s76,3072
v_cvt_pk_bf16_f32 v144,v144,v145
M v[80:83],a[244:247],a[132:135],v[80:83]
v_cvt_pk_bf16_f32 v145,v146,v147
v_cvt_pk_bf16_f32 v148,v148,v149
M v[80:83],v[224:227],a[176:179],v[80:83]
buffer_store_dwordx4 a[92:95],v253,s[24:27],s34 offen offset:640 nt
M v[84:87],v[224:227],a[160:163],v[84:87]
v_cvt_pk_bf16_f32 v149,v150,v151
M v[84:87],a[244:247],a[176:179],v[84:87]
ds_read_b128 a[112:115],v248 offset:34816
ds_write2st64_b64 v254,v[144:145],v[148:149] offset0:51 offset1:55
M v[84:87],a[220:223],a[132:135],v[84:87]
ds_read_b128 a[148:151],v249 offset:34816
v_cvt_pk_bf16_f32 v152,v152,v153
M v[88:91],a[220:223],a[176:179],v[88:91]
buffer_load_dwordx4 a[168:171],v250,s[20:23],s47 offen offset:0 sc1
M v[88:91],a[244:247],a[160:163],v[88:91]
ds_read_b128 a[164:167],v248 offset:35328
ds_read_b128 a[128:131],v249 offset:35328
M v[88:91],v[224:227],a[96:99],v[88:91]
buffer_load_dwordx4 a[136:139],v250,s[20:23],s47 offen offset:1024 sc1
M v[92:95],v[224:227],a[172:175],v[92:95]
v_cvt_pk_bf16_f32 v153,v154,v155
v_cvt_pk_bf16_f32 v156,v156,v157
M v[92:95],a[244:247],a[96:99],v[92:95]
v_cvt_pk_bf16_f32 v157,v158,v159
M v[92:95],a[220:223],a[160:163],v[92:95]
s_waitcnt vmcnt(27) lgkmcnt(4)
ds_write2st64_b64 v254,v[152:153],v[156:157] offset0:59 offset1:63
M v[32:35],a[144:147],a[112:115],v[32:35]
s_waitcnt vmcnt(26) lgkmcnt(3)
s_add_u32 s34,s33,6291456
buffer_load_dwordx4 a[180:183],v250,s[20:23],s47 offen offset:2048 sc1
M v[32:35],a[120:123],a[148:151],v[32:35]
s_waitcnt vmcnt(26) lgkmcnt(2)
ds_read_b128 a[188:191],v248 offset:35840
ds_read_b128 a[132:135],v249 offset:35840
M v[32:35],a[108:111],a[164:167],v[32:35]
s_waitcnt lgkmcnt(2)
s_barrier
ds_read_b128 v[128:131],v250 offset:17408
M v[36:39],a[108:111],a[128:131],v[36:39]
ds_read_b128 v[136:139],v250 offset:21504
ds_read_b128 v[144:147],v250 offset:26112
M v[36:39],a[120:123],a[164:167],v[36:39]
ds_read_b128 v[152:155],v250 offset:30208
M v[36:39],a[144:147],a[148:151],v[36:39]
buffer_store_dwordx4 v[96:99],v253,s[24:27],s34 offen offset:1152 nt
M v[40:43],a[144:147],a[164:167],v[40:43]
ds_read_b128 a[176:179],v248 offset:36352
M v[40:43],a[120:123],a[128:131],v[40:43]
s_waitcnt lgkmcnt(6)
ds_read_b128 a[172:175],v249 offset:36352
M v[40:43],a[108:111],a[188:191],v[40:43]
s_waitcnt lgkmcnt(2)
s_barrier
M v[44:47],a[108:111],a[132:135],v[44:47]
M v[44:47],a[120:123],a[188:191],v[44:47]
M v[44:47],a[144:147],a[128:131],v[44:47]
M v[48:51],a[144:147],a[188:191],v[48:51]
s_add_u32 s48,s76,6144
ds_read_b128 a[96:99],v249 offset:36864
M v[48:51],a[120:123],a[132:135],v[48:51]
s_waitcnt lgkmcnt(2)
ds_read_b128 a[160:163],v248 offset:36864
M v[48:51],a[108:111],a[176:179],v[48:51]
s_waitcnt lgkmcnt(2)
M v[52:55],a[108:111],a[172:175],v[52:55]
M v[52:55],a[120:123],a[176:179],v[52:55]
M v[52:55],a[144:147],a[132:135],v[52:55]
M v[56:59],a[144:147],a[176:179],v[56:59]
buffer_load_dwordx4 v[220:223],v250,s[20:23],s48 offen offset:0 sc1
M v[56:59],a[120:123],a[172:175],v[56:59]
s_waitcnt lgkmcnt(1)
M v[56:59],a[108:111],a[96:99],v[56:59]
s_waitcnt lgkmcnt(0)
buffer_load_dwordx4 a[204:207],v250,s[20:23],s48 offen offset:1024 sc1
M v[60:63],a[108:111],a[160:163],v[60:63]
M v[60:63],a[120:123],a[96:99],v[60:63]
s_add_u32 s34,s33,6684672
M v[60:63],a[144:147],a[172:175],v[60:63]
s_waitcnt vmcnt(28)
M v[64:67],a[196:199],a[112:115],v[64:67]
s_waitcnt vmcnt(27)
buffer_load_dwordx4 v[216:219],v250,s[20:23],s48 offen offset:2048 sc1
M v[64:67],a[228:231],a[148:151],v[64:67]
s_waitcnt vmcnt(27)
M v[64:67],a[240:243],a[164:167],v[64:67]
M v[68:71],a[240:243],a[128:131],v[68:71]
M v[68:71],a[228:231],a[164:167],v[68:71]
M v[68:71],a[196:199],a[148:151],v[68:71]
buffer_store_dwordx4 v[104:107],v253,s[24:27],s34 offen offset:1152 nt
M v[72:75],a[196:199],a[164:167],v[72:75]
M v[72:75],a[228:231],a[128:131],v[72:75]
M v[72:75],a[240:243],a[188:191],v[72:75]
M v[76:79],a[240:243],a[132:135],v[76:79]
M v[76:79],a[228:231],a[188:191],v[76:79]
M v[76:79],a[196:199],a[128:131],v[76:79]
M v[80:83],a[196:199],a[188:191],v[80:83]
s_add_u32 s47,s77,3072
M v[80:83],a[228:231],a[132:135],v[80:83]
M v[80:83],a[240:243],a[176:179],v[80:83]
M v[84:87],a[240:243],a[172:175],v[84:87]
M v[84:87],a[228:231],a[176:179],v[84:87]
ds_read_b128 a[108:111],v248 offset:52224
M v[84:87],a[196:199],a[132:135],v[84:87]
ds_read_b128 a[120:123],v249 offset:52224
M v[88:91],a[196:199],a[176:179],v[88:91]
buffer_load_dwordx4 a[144:147],v250,s[20:23],s47 offen offset:0 sc1
M v[88:91],a[228:231],a[172:175],v[88:91]
ds_read_b128 a[112:115],v248 offset:52736
ds_read_b128 a[164:167],v249 offset:52736
M v[88:91],a[240:243],a[96:99],v[88:91]
s_add_u32 s34,s33,7077888
buffer_load_dwordx4 a[148:151],v250,s[20:23],s47 offen offset:1024 sc1
M v[92:95],a[240:243],a[160:163],v[92:95]
M v[92:95],a[228:231],a[96:99],v[92:95]
M v[92:95],a[196:199],a[172:175],v[92:95]
s_waitcnt vmcnt(29) lgkmcnt(3)
M v[32:35],a[156:159],a[108:111],v[32:35]
s_waitcnt vmcnt(28) lgkmcnt(2)
buffer_load_dwordx4 a[128:131],v250,s[20:23],s47 offen offset:2048 sc1
M v[32:35],a[104:107],a[120:123],v[32:35]
s_waitcnt vmcnt(28) lgkmcnt(1)
ds_read_b128 a[188:191],v248 offset:53248
ds_read_b128 a[132:135],v249 offset:53248
M v[32:35],a[140:143],a[112:115],v[32:35]
s_waitcnt lgkmcnt(2)
M v[36:39],a[140:143],a[164:167],v[36:39]
M v[36:39],a[104:107],a[112:115],v[36:39]
M v[36:39],a[156:159],a[120:123],v[36:39]
buffer_store_dwordx4 v[112:115],v253,s[24:27],s34 offen offset:1152 nt
M v[40:43],a[156:159],a[112:115],v[40:43]
ds_read_b128 a[176:179],v248 offset:53760
M v[40:43],a[104:107],a[164:167],v[40:43]
s_waitcnt lgkmcnt(2)
ds_read_b128 a[160:163],v249 offset:53760
M v[40:43],a[140:143],a[188:191],v[40:43]
s_waitcnt lgkmcnt(2)
M v[44:47],a[140:143],a[132:135],v[44:47]
M v[44:47],a[104:107],a[188:191],v[44:47]
M v[44:47],a[156:159],a[164:167],v[44:47]
M v[48:51],a[156:159],a[188:191],v[48:51]
s_add_u32 s48,s77,6144
ds_read_b128 a[96:99],v249 offset:54272
M v[48:51],a[104:107],a[132:135],v[48:51]
s_waitcnt lgkmcnt(2)
ds_read_b128 a[172:175],v248 offset:54272
M v[48:51],a[140:143],a[176:179],v[48:51]
s_waitcnt lgkmcnt(2)
M v[52:55],a[140:143],a[160:163],v[52:55]
M v[52:55],a[104:107],a[176:179],v[52:55]
M v[52:55],a[156:159],a[132:135],v[52:55]
M v[56:59],a[156:159],a[176:179],v[56:59]
s_add_u32 s34,s33,7471104
buffer_load_dwordx4 a[216:219],v250,s[20:23],s48 offen offset:0 sc1
M v[56:59],a[104:107],a[160:163],v[56:59]
s_waitcnt lgkmcnt(1)
M v[56:59],a[140:143],a[96:99],v[56:59]
s_waitcnt lgkmcnt(0)
buffer_store_dwordx4 v[120:123],v253,s[24:27],s34 offen offset:1152 nt
M v[60:63],a[140:143],a[172:175],v[60:63]
M v[60:63],a[104:107],a[96:99],v[60:63]
M v[60:63],a[156:159],a[160:163],v[60:63]
s_waitcnt vmcnt(30)
buffer_load_dwordx4 a[192:195],v250,s[20:23],s48 offen offset:1024 sc1
M v[64:67],a[184:187],a[108:111],v[64:67]
s_waitcnt vmcnt(30)
M v[64:67],a[248:251],a[120:123],v[64:67]
s_waitcnt vmcnt(29)
M v[64:67],a[232:235],a[112:115],v[64:67]
M v[68:71],a[232:235],a[164:167],v[68:71]
buffer_load_dwordx4 a[252:255],v250,s[20:23],s48 offen offset:2048 sc1
M v[68:71],a[248:251],a[112:115],v[68:71]
M v[68:71],a[184:187],a[120:123],v[68:71]
M v[72:75],a[184:187],a[112:115],v[72:75]
M v[72:75],a[248:251],a[164:167],v[72:75]
M v[72:75],a[232:235],a[188:191],v[72:75]
M v[76:79],a[232:235],a[132:135],v[76:79]
M v[76:79],a[248:251],a[188:191],v[76:79]
M v[76:79],a[184:187],a[164:167],v[76:79]
M v[80:83],a[184:187],a[188:191],v[80:83]
s_add_u32 s48,s72,52224
M v[80:83],a[248:251],a[132:135],v[80:83]
v_add_u32 v248,0x11000,v248
v_add_u32 v249,0x11000,v249
M v[80:83],a[232:235],a[176:179],v[80:83]
M v[84:87],a[232:235],a[160:163],v[84:87]
M v[84:87],a[248:251],a[176:179],v[84:87]
s_add_u32 s34,s33,6291456
ds_read_b128 a[140:143],v248 offset:0
M v[84:87],a[184:187],a[132:135],v[84:87]
buffer_store_dwordx4 v[128:131],v253,s[24:27],s34 offen offset:1280 nt
M v[88:91],a[184:187],a[176:179],v[88:91]
buffer_load_dwordx4 a[156:159],v250,s[20:23],s48 offen offset:0 sc1
M v[88:91],a[248:251],a[160:163],v[88:91]
ds_read_b128 a[104:107],v249 offset:0
ds_read_b128 a[108:111],v248 offset:512
M v[88:91],a[232:235],a[96:99],v[88:91]
ds_read_b128 a[112:115],v249 offset:512
M v[92:95],a[232:235],a[172:175],v[92:95]
M v[92:95],a[248:251],a[96:99],v[92:95]
buffer_load_dwordx4 a[120:123],v250,s[20:23],s48 offen offset:1024 sc1
M v[92:95],a[184:187],a[160:163],v[92:95]
s_waitcnt vmcnt(32) lgkmcnt(3)
M v[32:35],a[152:155],a[140:143],v[32:35]
s_waitcnt vmcnt(31) lgkmcnt(2)
ds_read_b128 a[188:191],v248 offset:1024
M v[32:35],a[116:119],a[104:107],v[32:35]
s_waitcnt vmcnt(30) lgkmcnt(2)
ds_read_b128 a[132:135],v249 offset:1024
M v[32:35],a[124:127],a[108:111],v[32:35]
s_waitcnt lgkmcnt(2)
buffer_load_dwordx4 a[164:167],v250,s[20:23],s48 offen offset:2048 sc1
M v[36:39],a[124:127],a[112:115],v[36:39]
M v[36:39],a[116:119],a[108:111],v[36:39]
M v[36:39],a[152:155],a[104:107],v[36:39]
M v[40:43],a[152:155],a[108:111],v[40:43]
ds_read_b128 a[176:179],v248 offset:1536
M v[40:43],a[116:119],a[112:115],v[40:43]
s_waitcnt lgkmcnt(2)
ds_read_b128 a[172:175],v249 offset:1536
M v[40:43],a[124:127],a[188:191],v[40:43]
s_waitcnt lgkmcnt(2)
M v[44:47],a[124:127],a[132:135],v[44:47]
M v[44:47],a[116:119],a[188:191],v[44:47]
M v[44:47],a[152:155],a[112:115],v[44:47]
M v[48:51],a[152:155],a[188:191],v[48:51]
s_add_u32 s48,s73,52224
ds_read_b128 a[96:99],v249 offset:2048
M v[48:51],a[116:119],a[132:135],v[48:51]
s_waitcnt lgkmcnt(2)
ds_read_b128 a[160:163],v248 offset:2048
M v[48:51],a[124:127],a[176:179],v[48:51]
s_waitcnt lgkmcnt(2)
M v[52:55],a[124:127],a[172:175],v[52:55]
s_add_u32 s34,s33,6684672
M v[52:55],a[116:119],a[176:179],v[52:55]
M v[52:55],a[152:155],a[132:135],v[52:55]
buffer_store_dwordx4 v[136:139],v253,s[24:27],s34 offen offset:1280 nt
M v[56:59],a[152:155],a[176:179],v[56:59]
buffer_load_dwordx4 a[184:187],v250,s[20:23],s48 offen offset:0 sc1
M v[56:59],a[116:119],a[172:175],v[56:59]
s_waitcnt lgkmcnt(1)
M v[56:59],a[124:127],a[96:99],v[56:59]
s_waitcnt lgkmcnt(0)
M v[60:63],a[124:127],a[160:163],v[60:63]
M v[60:63],a[116:119],a[96:99],v[60:63]
buffer_load_dwordx4 v[228:231],v250,s[20:23],s48 offen offset:1024 sc1
M v[60:63],a[152:155],a[172:175],v[60:63]
s_waitcnt vmcnt(29)
M v[64:67],a[100:103],a[140:143],v[64:67]
s_waitcnt vmcnt(28)
M v[64:67],a[236:239],a[104:107],v[64:67]
s_waitcnt vmcnt(27)
M v[64:67],a[224:227],a[108:111],v[64:67]
buffer_load_dwordx4 a[200:203],v250,s[20:23],s48 offen offset:2048 sc1
M v[68:71],a[224:227],a[112:115],v[68:71]
M v[68:71],a[236:239],a[108:111],v[68:71]
M v[68:71],a[100:103],a[104:107],v[68:71]
M v[72:75],a[100:103],a[108:111],v[72:75]
M v[72:75],a[236:239],a[112:115],v[72:75]
M v[72:75],a[224:227],a[188:191],v[72:75]
M v[76:79],a[224:227],a[132:135],v[76:79]
M v[76:79],a[236:239],a[188:191],v[76:79]
M v[76:79],a[100:103],a[112:115],v[76:79]
M v[80:83],a[100:103],a[188:191],v[80:83]
s_add_u32 s48,s74,52224
M v[80:83],a[236:239],a[132:135],v[80:83]
s_add_u32 s34,s33,7077888
M v[80:83],a[224:227],a[176:179],v[80:83]
buffer_store_dwordx4 v[144:147],v253,s[24:27],s34 offen offset:1280 nt
M v[84:87],a[224:227],a[172:175],v[84:87]
M v[84:87],a[236:239],a[176:179],v[84:87]
ds_read_b128 a[124:127],v248 offset:17408
M v[84:87],a[100:103],a[132:135],v[84:87]
ds_read_b128 a[116:119],v249 offset:17408
M v[88:91],a[100:103],a[176:179],v[88:91]
buffer_load_dwordx4 a[152:155],v250,s[20:23],s48 offen offset:0 sc1
M v[88:91],a[236:239],a[172:175],v[88:91]
ds_read_b128 a[140:143],v248 offset:17920
ds_read_b128 a[108:111],v249 offset:17920
M v[88:91],a[224:227],a[96:99],v[88:91]
buffer_load_dwordx4 a[104:107],v250,s[20:23],s48 offen offset:1024 sc1
M v[92:95],a[224:227],a[160:163],v[92:95]
M v[92:95],a[236:239],a[96:99],v[92:95]
M v[92:95],a[100:103],a[172:175],v[92:95]
s_waitcnt vmcnt(26) lgkmcnt(3)
M v[32:35],a[168:171],a[124:127],v[32:35]
s_waitcnt vmcnt(25) lgkmcnt(2)
buffer_load_dwordx4 a[112:115],v250,s[20:23],s48 offen offset:2048 sc1
M v[32:35],a[136:139],a[116:119],v[32:35]
s_waitcnt vmcnt(25) lgkmcnt(1)
ds_read_b128 a[188:191],v248 offset:18432
ds_read_b128 a[132:135],v249 offset:18432
M v[32:35],a[180:183],a[140:143],v[32:35]
s_waitcnt lgkmcnt(2)
M v[36:39],a[180:183],a[108:111],v[36:39]
M v[36:39],a[136:139],a[140:143],v[36:39]
M v[36:39],a[168:171],a[116:119],v[36:39]
M v[40:43],a[168:171],a[140:143],v[40:43]
ds_read_b128 a[176:179],v248 offset:18944
M v[40:43],a[136:139],a[108:111],v[40:43]
s_waitcnt lgkmcnt(2)
ds_read_b128 a[160:163],v249 offset:18944
M v[40:43],a[180:183],a[188:191],v[40:43]
s_waitcnt lgkmcnt(2)
M v[44:47],a[180:183],a[132:135],v[44:47]
M v[44:47],a[136:139],a[188:191],v[44:47]
M v[44:47],a[168:171],a[108:111],v[44:47]
s_add_u32 s34,s33,7471104
buffer_store_dwordx4 v[152:155],v253,s[24:27],s34 offen offset:1280 nt
M v[48:51],a[168:171],a[188:191],v[48:51]
s_add_u32 s48,s75,52224
ds_read_b128 a[96:99],v249 offset:19456
M v[48:51],a[136:139],a[132:135],v[48:51]
s_waitcnt lgkmcnt(2)
ds_read_b128 a[100:103],v248 offset:19456
M v[48:51],a[180:183],a[176:179],v[48:51]
s_waitcnt lgkmcnt(2)
M v[52:55],a[180:183],a[160:163],v[52:55]
M v[52:55],a[136:139],a[176:179],v[52:55]
M v[52:55],a[168:171],a[132:135],v[52:55]
M v[56:59],a[168:171],a[176:179],v[56:59]
buffer_load_dwordx4 a[172:175],v250,s[20:23],s48 offen offset:0 sc1
M v[56:59],a[136:139],a[160:163],v[56:59]
s_waitcnt lgkmcnt(1)
M v[56:59],a[180:183],a[96:99],v[56:59]
s_waitcnt lgkmcnt(0)
buffer_load_dwordx4 a[208:211],v250,s[20:23],s48 offen offset:1024 sc1
M v[60:63],a[180:183],a[100:103],v[60:63]
M v[60:63],a[136:139],a[96:99],v[60:63]
M v[60:63],a[168:171],a[160:163],v[60:63]
s_waitcnt vmcnt(26)
M v[64:67],v[220:223],a[124:127],v[64:67]
s_waitcnt vmcnt(25)
buffer_load_dwordx4 a[212:215],v250,s[20:23],s48 offen offset:2048 sc1
M v[64:67],a[204:207],a[116:119],v[64:67]
s_waitcnt vmcnt(25)
M v[64:67],v[216:219],a[140:143],v[64:67]
M v[68:71],v[216:219],a[108:111],v[68:71]
M v[68:71],a[204:207],a[140:143],v[68:71]
M v[68:71],v[220:223],a[116:119],v[68:71]
M v[72:75],v[220:223],a[140:143],v[72:75]
M v[72:75],a[204:207],a[108:111],v[72:75]
M v[72:75],v[216:219],a[188:191],v[72:75]
M v[76:79],v[216:219],a[132:135],v[76:79]
M v[76:79],a[204:207],a[188:191],v[76:79]
M v[76:79],v[220:223],a[108:111],v[76:79]
M v[80:83],v[220:223],a[188:191],v[80:83]
s_add_u32 s48,s76,52224
M v[80:83],a[204:207],a[132:135],v[80:83]
v_add_u32 v248,0xffff1200,v248
v_add_u32 v249,0xffff1200,v249
M v[80:83],v[216:219],a[176:179],v[80:83]
M v[84:87],v[216:219],a[160:163],v[84:87]
M v[84:87],a[204:207],a[176:179],v[84:87]
ds_read_b128 a[180:183],v248 offset:8704
M v[84:87],v[220:223],a[132:135],v[84:87]
ds_read_b128 a[136:139],v249 offset:8704
M v[88:91],v[220:223],a[176:179],v[88:91]
buffer_load_dwordx4 a[168:171],v250,s[20:23],s48 offen offset:0 sc1
M v[88:91],a[204:207],a[160:163],v[88:91]
ds_read_b128 a[124:127],v248 offset:9216
ds_read_b128 a[140:143],v249 offset:9216
M v[88:91],v[216:219],a[96:99],v[88:91]
buffer_load_dwordx4 a[116:119],v250,s[20:23],s48 offen offset:1024 sc1
M v[92:95],v[216:219],a[100:103],v[92:95]
M v[92:95],a[204:207],a[96:99],v[92:95]
M v[92:95],v[220:223],a[160:163],v[92:95]
s_waitcnt vmcnt(25) lgkmcnt(3)
M v[32:35],a[144:147],a[180:183],v[32:35]
s_waitcnt vmcnt(24) lgkmcnt(2)
buffer_load_dwordx4 a[108:111],v250,s[20:23],s48 offen offset:2048 sc1
M v[32:35],a[148:151],a[136:139],v[32:35]
s_waitcnt vmcnt(24) lgkmcnt(1)
s_add_u32 s48,s77,52224
ds_read_b128 a[100:103],v248 offset:9728
ds_read_b128 a[96:99],v249 offset:9728
M v[32:35],a[128:131],a[124:127],v[32:35]
s_waitcnt lgkmcnt(2)
M v[36:39],a[128:131],a[140:143],v[36:39]
M v[36:39],a[148:151],a[124:127],v[36:39]
buffer_load_dwordx4 a[188:191],v250,s[20:23],s48 offen offset:0 sc1
M v[36:39],a[144:147],a[136:139],v[36:39]
s_nop 2
v_cvt_pk_bf16_f32 v32,v32,v33
v_cvt_pk_bf16_f32 v33,v34,v35
M v[40:43],a[144:147],a[124:127],v[40:43]
ds_read_b128 a[160:163],v248 offset:10240
M v[40:43],a[148:151],a[140:143],v[40:43]
s_waitcnt lgkmcnt(2)
ds_read_b128 v[224:227],v249 offset:10240
M v[40:43],a[128:131],a[100:103],v[40:43]
s_waitcnt lgkmcnt(2)
buffer_load_dwordx4 a[132:135],v250,s[20:23],s48 offen offset:1024 sc1
M v[44:47],a[128:131],a[96:99],v[44:47]
v_cvt_pk_bf16_f32 v36,v36,v37
v_cvt_pk_bf16_f32 v37,v38,v39
M v[44:47],a[148:151],a[100:103],v[44:47]
ds_write2st64_b64 v254,v[32:33],v[36:37] offset0:34 offset1:38
M v[44:47],a[144:147],a[140:143],v[44:47]
v_cvt_pk_bf16_f32 v40,v40,v41
v_cvt_pk_bf16_f32 v41,v42,v43
M v[48:51],a[144:147],a[100:103],v[48:51]
buffer_load_dwordx4 a[176:179],v250,s[20:23],s48 offen offset:2048 sc1
M v[48:51],a[148:151],a[96:99],v[48:51]
s_waitcnt lgkmcnt(2)
ds_read_b128 a[244:247],v249 offset:10752
ds_read_b128 a[220:223],v248 offset:10752
M v[48:51],a[128:131],a[160:163],v[48:51]
s_waitcnt lgkmcnt(3)
v_cvt_pk_bf16_f32 v44,v44,v45
v_cvt_pk_bf16_f32 v45,v46,v47
M v[52:55],a[128:131],v[224:227],v[52:55]
ds_write2st64_b64 v254,v[40:41],v[44:45] offset0:42 offset1:46
M v[52:55],a[148:151],a[160:163],v[52:55]
M v[52:55],a[144:147],a[96:99],v[52:55]
s_nop 0
v_cvt_pk_bf16_f32 v48,v48,v49
v_cvt_pk_bf16_f32 v49,v50,v51
M v[56:59],a[144:147],a[160:163],v[56:59]
M v[56:59],a[148:151],v[224:227],v[56:59]
s_waitcnt lgkmcnt(2)
M v[56:59],a[128:131],a[244:247],v[56:59]
s_waitcnt lgkmcnt(1)
v_cvt_pk_bf16_f32 v52,v52,v53
v_cvt_pk_bf16_f32 v53,v54,v55
M v[60:63],a[128:131],a[220:223],v[60:63]
ds_write2st64_b64 v254,v[48:49],v[52:53] offset0:51 offset1:55
M v[60:63],a[148:151],a[244:247],v[60:63]
M v[60:63],a[144:147],v[224:227],v[60:63]
s_waitcnt vmcnt(25)
v_cvt_pk_bf16_f32 v56,v56,v57
v_cvt_pk_bf16_f32 v57,v58,v59
M v[64:67],a[216:219],a[180:183],v[64:67]
s_waitcnt vmcnt(23)
M v[64:67],a[192:195],a[136:139],v[64:67]
s_waitcnt vmcnt(22)
M v[64:67],a[252:255],a[124:127],v[64:67]
v_cvt_pk_bf16_f32 v60,v60,v61
v_cvt_pk_bf16_f32 v61,v62,v63
M v[68:71],a[252:255],a[140:143],v[68:71]
ds_write2st64_b64 v254,v[56:57],v[60:61] offset0:59 offset1:63
M v[68:71],a[192:195],a[124:127],v[68:71]
M v[68:71],a[216:219],a[136:139],v[68:71]
s_nop 1
v_cvt_pk_bf16_f32 v64,v64,v65
v_cvt_pk_bf16_f32 v65,v66,v67
M v[72:75],a[216:219],a[124:127],v[72:75]
M v[72:75],a[192:195],a[140:143],v[72:75]
M v[72:75],a[252:255],a[100:103],v[72:75]
s_nop 0
v_cvt_pk_bf16_f32 v68,v68,v69
v_cvt_pk_bf16_f32 v69,v70,v71
M v[76:79],a[252:255],a[96:99],v[76:79]
ds_write2st64_b64 v254,v[64:65],v[68:69] offset0:0 offset1:4
M v[76:79],a[192:195],a[100:103],v[76:79]
M v[76:79],a[216:219],a[140:143],v[76:79]
s_nop 0
v_cvt_pk_bf16_f32 v72,v72,v73
v_cvt_pk_bf16_f32 v73,v74,v75
M v[80:83],a[216:219],a[100:103],v[80:83]
M v[80:83],a[192:195],a[96:99],v[80:83]
M v[80:83],a[252:255],a[160:163],v[80:83]
s_nop 1
v_cvt_pk_bf16_f32 v76,v76,v77
v_cvt_pk_bf16_f32 v77,v78,v79
M v[84:87],a[252:255],v[224:227],v[84:87]
ds_write2st64_b64 v254,v[72:73],v[76:77] offset0:8 offset1:12
M v[84:87],a[192:195],a[160:163],v[84:87]
ds_read_b128 a[128:131],v248 offset:0
M v[84:87],a[216:219],a[96:99],v[84:87]
ds_read_b128 a[148:151],v249 offset:0
v_cvt_pk_bf16_f32 v80,v80,v81
M v[88:91],a[216:219],a[160:163],v[88:91]
ds_read_b128 a[144:147],v248 offset:512
v_cvt_pk_bf16_f32 v81,v82,v83
M v[88:91],a[192:195],v[224:227],v[88:91]
ds_read_b128 a[180:183],v249 offset:512
M v[88:91],a[252:255],a[244:247],v[88:91]
v_cvt_pk_bf16_f32 v84,v84,v85
v_cvt_pk_bf16_f32 v85,v86,v87
M v[92:95],a[252:255],a[220:223],v[92:95]
ds_write2st64_b64 v254,v[80:81],v[84:85] offset0:17 offset1:21
M v[92:95],a[192:195],a[244:247],v[92:95]
M v[92:95],a[216:219],v[224:227],v[92:95]
s_waitcnt vmcnt(20) lgkmcnt(4)
s_nop 0
v_cvt_pk_bf16_f32 v88,v88,v89
v_cvt_pk_bf16_f32 v89,v90,v91
M v[160:163],a[156:159],a[128:131],v[160:163]
s_waitcnt vmcnt(19) lgkmcnt(3)
ds_read_b128 a[136:139],v248 offset:1024
M v[160:163],a[120:123],a[148:151],v[160:163]
s_waitcnt vmcnt(18) lgkmcnt(3)
ds_read_b128 a[124:127],v249 offset:1024
M v[160:163],a[164:167],a[144:147],v[160:163]
s_waitcnt lgkmcnt(3)
v_cvt_pk_bf16_f32 v92,v92,v93
v_cvt_pk_bf16_f32 v93,v94,v95
M v[164:167],a[164:167],a[180:183],v[164:167]
ds_write2st64_b64 v254,v[88:89],v[92:93] offset0:25 offset1:29
M v[164:167],a[120:123],a[144:147],v[164:167]
M v[164:167],a[156:159],a[148:151],v[164:167]
M v[168:171],a[156:159],a[144:147],v[168:171]
s_waitcnt lgkmcnt(0)
s_barrier
ds_read_b128 v[32:35],v250 offset:17408
M v[168:171],a[120:123],a[180:183],v[168:171]
ds_read_b128 v[40:43],v250 offset:21504
ds_read_b128 v[48:51],v250 offset:26112
M v[168:171],a[164:167],a[136:139],v[168:171]
ds_read_b128 v[56:59],v250 offset:30208
ds_read_b128 v[64:67],v250 offset:0
M v[172:175],a[164:167],a[124:127],v[172:175]
ds_read_b128 v[72:75],v250 offset:4096
ds_read_b128 v[80:83],v250 offset:8704
ds_read_b128 a[140:143],v248 offset:1536
M v[172:175],a[120:123],a[136:139],v[172:175]
ds_read_b128 v[88:91],v250 offset:12800
ds_read_b128 a[100:103],v249 offset:1536
M v[172:175],a[156:159],a[180:183],v[172:175]
s_waitcnt lgkmcnt(9)
s_add_u32 s34,s33,6291456
buffer_store_dwordx4 v[32:35],v253,s[24:27],s34 offen offset:128 nt
M v[176:179],a[156:159],a[136:139],v[176:179]
s_add_u32 s34,s33,6684672
ds_read_b128 a[96:99],v249 offset:2048
M v[176:179],a[120:123],a[124:127],v[176:179]
s_waitcnt lgkmcnt(3)
ds_read_b128 a[160:163],v248 offset:2048
M v[176:179],a[164:167],a[140:143],v[176:179]
s_waitcnt lgkmcnt(2)
buffer_store_dwordx4 v[40:43],v253,s[24:27],s34 offen offset:128 nt
M v[180:183],a[164:167],a[100:103],v[180:183]
s_add_u32 s34,s33,7077888
M v[180:183],a[120:123],a[140:143],v[180:183]
ds_read_b128 a[128:131],v248 offset:34816
M v[180:183],a[156:159],a[124:127],v[180:183]
buffer_store_dwordx4 v[48:51],v253,s[24:27],s34 offen offset:128 nt
M v[184:187],a[156:159],a[140:143],v[184:187]
s_add_u32 s34,s33,7471104
ds_read_b128 a[148:151],v249 offset:34816
ds_read_b128 a[144:147],v248 offset:35328
M v[184:187],a[120:123],a[100:103],v[184:187]
s_waitcnt lgkmcnt(4)
ds_read_b128 a[180:183],v249 offset:35328
M v[184:187],a[164:167],a[96:99],v[184:187]
s_waitcnt lgkmcnt(4)
buffer_store_dwordx4 v[56:59],v253,s[24:27],s34 offen offset:128 nt
M v[188:191],a[164:167],a[160:163],v[188:191]
M v[188:191],a[120:123],a[96:99],v[188:191]
M v[188:191],a[156:159],a[100:103],v[188:191]
s_waitcnt vmcnt(20) lgkmcnt(3)
M v[160:163],a[184:187],a[128:131],v[160:163]
s_waitcnt vmcnt(19) lgkmcnt(2)
ds_read_b128 a[136:139],v248 offset:35840
M v[160:163],v[228:231],a[148:151],v[160:163]
s_waitcnt vmcnt(18) lgkmcnt(2)
s_add_u32 s34,s33,6291456
ds_read_b128 a[124:127],v249 offset:35840
M v[160:163],a[200:203],a[144:147],v[160:163]
s_waitcnt lgkmcnt(2)
buffer_store_dwordx4 v[64:67],v253,s[24:27],s34 offen offset:256 nt
M v[164:167],a[200:203],a[180:183],v[164:167]
M v[164:167],v[228:231],a[144:147],v[164:167]
M v[164:167],a[184:187],a[148:151],v[164:167]
M v[168:171],a[184:187],a[144:147],v[168:171]
ds_read_b128 a[140:143],v248 offset:36352
M v[168:171],v[228:231],a[180:183],v[168:171]
s_waitcnt lgkmcnt(2)
ds_read_b128 a[160:163],v249 offset:36352
M v[168:171],a[200:203],a[136:139],v[168:171]
s_waitcnt lgkmcnt(2)
M v[172:175],a[200:203],a[124:127],v[172:175]
M v[172:175],v[228:231],a[136:139],v[172:175]
M v[172:175],a[184:187],a[180:183],v[172:175]
M v[176:179],a[184:187],a[136:139],v[176:179]
ds_read_b128 a[164:167],v249 offset:36864
M v[176:179],v[228:231],a[124:127],v[176:179]
s_waitcnt lgkmcnt(2)
ds_read_b128 a[96:99],v248 offset:36864
M v[176:179],a[200:203],a[140:143],v[176:179]
s_waitcnt lgkmcnt(2)
M v[180:183],a[200:203],a[160:163],v[180:183]
M v[180:183],v[228:231],a[140:143],v[180:183]
ds_read_b128 a[120:123],v248 offset:52224
M v[180:183],a[184:187],a[124:127],v[180:183]
ds_read_b128 a[100:103],v249 offset:52224
M v[184:187],a[184:187],a[140:143],v[184:187]
ds_read_b128 a[156:159],v248 offset:52736
M v[184:187],v[228:231],a[160:163],v[184:187]
s_waitcnt lgkmcnt(4)
ds_read_b128 a[128:131],v249 offset:52736
M v[184:187],a[200:203],a[164:167],v[184:187]
s_waitcnt lgkmcnt(4)
M v[188:191],a[200:203],a[96:99],v[188:191]
M v[188:191],v[228:231],a[164:167],v[188:191]
M v[188:191],a[184:187],a[160:163],v[188:191]
s_waitcnt vmcnt(17) lgkmcnt(3)
s_add_u32 s34,s33,6684672
buffer_store_dwordx4 v[72:75],v253,s[24:27],s34 offen offset:256 nt
M v[160:163],a[152:155],a[120:123],v[160:163]
s_waitcnt vmcnt(17) lgkmcnt(2)
ds_read_b128 a[148:151],v248 offset:53248
M v[160:163],a[104:107],a[100:103],v[160:163]
s_waitcnt vmcnt(16) lgkmcnt(2)
ds_read_b128 a[144:147],v249 offset:53248
M v[160:163],a[112:115],a[156:159],v[160:163]
s_waitcnt lgkmcnt(2)
M v[164:167],a[112:115],a[128:131],v[164:167]
M v[164:167],a[104:107],a[156:159],v[164:167]
M v[164:167],a[152:155],a[100:103],v[164:167]
M v[168:171],a[152:155],a[156:159],v[168:171]
ds_read_b128 a[180:183],v248 offset:53760
M v[168:171],a[104:107],a[128:131],v[168:171]
s_waitcnt lgkmcnt(2)
ds_read_b128 a[136:139],v249 offset:53760
M v[168:171],a[112:115],a[148:151],v[168:171]
s_waitcnt lgkmcnt(2)
M v[172:175],a[112:115],a[144:147],v[172:175]
M v[172:175],a[104:107],a[148:151],v[172:175]
M v[172:175],a[152:155],a[128:131],v[172:175]
M v[176:179],a[152:155],a[148:151],v[176:179]
ds_read_b128 a[124:127],v249 offset:54272
M v[176:179],a[104:107],a[144:147],v[176:179]
s_waitcnt lgkmcnt(2)
ds_read_b128 a[140:143],v248 offset:54272
v_add_u32 v248,0x11000,v248
M v[176:179],a[112:115],a[180:183],v[176:179]
s_waitcnt lgkmcnt(2)
v_add_u32 v249,0x11000,v249
M v[180:183],a[112:115],a[136:139],v[180:183]
M v[180:183],a[104:107],a[180:183],v[180:183]
ds_read_b128 a[96:99],v248 offset:0
M v[180:183],a[152:155],a[144:147],v[180:183]
ds_read_b128 a[164:167],v249 offset:0
M v[184:187],a[152:155],a[180:183],v[184:187]
ds_read_b128 a[160:163],v248 offset:512
M v[184:187],a[104:107],a[136:139],v[184:187]
s_waitcnt lgkmcnt(4)
ds_read_b128 a[184:187],v249 offset:512
M v[184:187],a[112:115],a[124:127],v[184:187]
s_waitcnt lgkmcnt(4)
M v[188:191],a[112:115],a[140:143],v[188:191]
s_add_u32 s34,s33,7077888
M v[188:191],a[104:107],a[124:127],v[188:191]
M v[188:191],a[152:155],a[136:139],v[188:191]
s_waitcnt vmcnt(14) lgkmcnt(3)
buffer_store_dwordx4 v[80:83],v253,s[24:27],s34 offen offset:256 nt
M v[160:163],a[172:175],a[96:99],v[160:163]
s_waitcnt vmcnt(14) lgkmcnt(2)
ds_read_b128 a[120:123],v248 offset:1024
M v[160:163],a[208:211],a[164:167],v[160:163]
s_waitcnt vmcnt(13) lgkmcnt(2)
ds_read_b128 a[100:103],v249 offset:1024
M v[160:163],a[212:215],a[160:163],v[160:163]
s_waitcnt lgkmcnt(2)
M v[164:167],a[212:215],a[184:187],v[164:167]
M v[164:167],a[208:211],a[160:163],v[164:167]
M v[164:167],a[172:175],a[164:167],v[164:167]
M v[168:171],a[172:175],a[160:163],v[168:171]
ds_read_b128 a[156:159],v248 offset:1536
M v[168:171],a[208:211],a[184:187],v[168:171]
s_waitcnt lgkmcnt(2)
ds_read_b128 a[128:131],v249 offset:1536
M v[168:171],a[212:215],a[120:123],v[168:171]
s_waitcnt lgkmcnt(2)
M v[172:175],a[212:215],a[100:103],v[172:175]
M v[172:175],a[208:211],a[120:123],v[172:175]
M v[172:175],a[172:175],a[184:187],v[172:175]
M v[176:179],a[172:175],a[120:123],v[176:179]
ds_read_b128 a[148:151],v249 offset:2048
M v[176:179],a[208:211],a[100:103],v[176:179]
s_waitcnt lgkmcnt(2)
ds_read_b128 a[144:147],v248 offset:2048
M v[176:179],a[212:215],a[156:159],v[176:179]
s_waitcnt lgkmcnt(2)
M v[180:183],a[212:215],a[128:131],v[180:183]
M v[180:183],a[208:211],a[156:159],v[180:183]
ds_read_b128 a[180:183],v248 offset:17408
M v[180:183],a[172:175],a[100:103],v[180:183]
ds_read_b128 a[112:115],v249 offset:17408
M v[184:187],a[172:175],a[156:159],v[184:187]
ds_read_b128 a[140:143],v248 offset:17920
v_add_u32 v248,0xffff3400,v248
M v[184:187],a[208:211],a[128:131],v[184:187]
s_waitcnt lgkmcnt(4)
s_add_u32 s34,s33,7471104
v_add_u32 v249,0xffff3400,v249
M v[184:187],a[212:215],a[148:151],v[184:187]
s_waitcnt lgkmcnt(3)
buffer_store_dwordx4 v[88:91],v253,s[24:27],s34 offen offset:256 nt
M v[188:191],a[212:215],a[144:147],v[188:191]
ds_read_b128 a[104:107],v248 offset:0
ds_read_b128 a[124:127],v249 offset:0
M v[188:191],a[208:211],a[148:151],v[188:191]
ds_read_b128 a[136:139],v248 offset:512
ds_read_b128 a[152:155],v249 offset:512
M v[188:191],a[172:175],a[128:131],v[188:191]
s_waitcnt vmcnt(13) lgkmcnt(6)
v_add_u32 v248,0x11200,v248
v_add_u32 v249,0x11200,v249
M v[160:163],a[168:171],a[180:183],v[160:163]
s_waitcnt vmcnt(12) lgkmcnt(5)
M v[160:163],a[116:119],a[112:115],v[160:163]
s_waitcnt vmcnt(11) lgkmcnt(4)
ds_read_b128 a[96:99],v249 offset:0
M v[160:163],a[108:111],a[140:143],v[160:163]
s_waitcnt vmcnt(10) lgkmcnt(4)
M v[160:163],a[188:191],a[104:107],v[160:163]
s_waitcnt vmcnt(9) lgkmcnt(3)
M v[160:163],a[132:135],a[124:127],v[160:163]
s_waitcnt vmcnt(8) lgkmcnt(2)
M v[160:163],a[176:179],a[136:139],v[160:163]
s_waitcnt lgkmcnt(1)
M v[164:167],a[176:179],a[152:155],v[164:167]
ds_read_b128 a[164:167],v248 offset:512
v_add_u32 v248,0xfffef200,v248
M v[164:167],a[132:135],a[136:139],v[164:167]
v_add_u32 v249,0xfffef200,v249
M v[164:167],a[188:191],a[124:127],v[164:167]
s_waitcnt lgkmcnt(1)
v_cvt_pk_bf16_f32 v160,v160,v161
v_cvt_pk_bf16_f32 v161,v162,v163
M v[164:167],a[108:111],a[96:99],v[164:167]
ds_read_b128 a[160:163],v248 offset:0
M v[164:167],a[116:119],a[140:143],v[164:167]
ds_read_b128 a[184:187],v249 offset:0
v_add_u32 v248,0x11000,v248
M v[164:167],a[168:171],a[112:115],v[164:167]
v_add_u32 v249,0x11000,v249
M v[168:171],a[168:171],a[140:143],v[168:171]
M v[168:171],a[116:119],a[96:99],v[168:171]
s_waitcnt lgkmcnt(2)
ds_read_b128 a[120:123],v249 offset:0
M v[168:171],a[108:111],a[164:167],v[168:171]
s_nop 1
v_cvt_pk_bf16_f32 v164,v164,v165
v_cvt_pk_bf16_f32 v165,v166,v167
M v[168:171],a[188:191],a[136:139],v[168:171]
ds_write2st64_b64 v254,v[160:161],v[164:165] offset0:68 offset1:72
M v[168:171],a[132:135],a[152:155],v[168:171]
s_waitcnt lgkmcnt(3)
M v[168:171],a[176:179],a[160:163],v[168:171]
s_waitcnt lgkmcnt(2)
M v[172:175],a[176:179],a[184:187],v[172:175]
ds_read_b128 a[100:103],v248 offset:512
v_add_u32 v248,0xfffef200,v248
M v[172:175],a[132:135],a[160:163],v[172:175]
v_add_u32 v249,0xfffef200,v249
M v[172:175],a[188:191],a[152:155],v[172:175]
s_waitcnt lgkmcnt(2)
v_cvt_pk_bf16_f32 v168,v168,v169
v_cvt_pk_bf16_f32 v169,v170,v171
M v[172:175],a[108:111],a[120:123],v[172:175]
ds_read_b128 a[156:159],v248 offset:0
M v[172:175],a[116:119],a[164:167],v[172:175]
ds_read_b128 a[144:147],v249 offset:0
v_add_u32 v248,0x11000,v248
M v[172:175],a[168:171],a[96:99],v[172:175]
v_add_u32 v249,0x11000,v249
M v[176:179],a[168:171],a[164:167],v[176:179]
M v[176:179],a[116:119],a[120:123],v[176:179]
s_waitcnt lgkmcnt(2)
ds_read_b128 a[148:151],v249 offset:0
M v[176:179],a[108:111],a[100:103],v[176:179]
s_nop 1
v_cvt_pk_bf16_f32 v172,v172,v173
v_cvt_pk_bf16_f32 v173,v174,v175
M v[176:179],a[188:191],a[160:163],v[176:179]
ds_write2st64_b64 v254,v[168:169],v[172:173] offset0:76 offset1:80
M v[176:179],a[132:135],a[184:187],v[176:179]
s_waitcnt lgkmcnt(3)
M v[176:179],a[176:179],a[156:159],v[176:179]
s_waitcnt lgkmcnt(2)
M v[180:183],a[176:179],a[144:147],v[180:183]
s_waitcnt lgkmcnt(0)
s_barrier
ds_read_b128 v[160:163],v250 offset:34816
M v[180:183],a[132:135],a[156:159],v[180:183]
ds_read_b128 v[168:171],v250 offset:38912
ds_read_b128 a[128:131],v249 offset:512
M v[180:183],a[188:191],a[184:187],v[180:183]
v_add_u32 v248,0xfffef200,v248
v_add_u32 v249,0xfffef200,v249
M v[180:183],a[108:111],a[148:151],v[180:183]
ds_read_b128 a[172:175],v249 offset:0
v_cvt_pk_bf16_f32 v176,v176,v177
M v[180:183],a[116:119],a[100:103],v[180:183]
ds_read_b128 a[180:183],v248 offset:0
v_add_u32 v248,0x11000,v248
M v[180:183],a[168:171],a[120:123],v[180:183]
s_waitcnt lgkmcnt(4)
s_add_u32 s34,s33,6291456
buffer_store_dwordx4 v[160:163],v253,s[24:27],s34 offen offset:1408 nt
M v[184:187],a[168:171],a[100:103],v[184:187]
s_add_u32 s34,s33,6684672
v_add_u32 v249,0x11000,v249
v_cvt_pk_bf16_f32 v177,v178,v179
M v[184:187],a[116:119],a[148:151],v[184:187]
s_waitcnt lgkmcnt(2)
ds_read_b128 a[104:107],v248 offset:0
M v[184:187],a[108:111],a[128:131],v[184:187]
v_cvt_pk_bf16_f32 v180,v180,v181
v_cvt_pk_bf16_f32 v181,v182,v183
M v[184:187],a[188:191],a[156:159],v[184:187]
ds_write2st64_b64 v254,v[176:177],v[180:181] offset0:85 offset1:89
M v[184:187],a[132:135],a[144:147],v[184:187]
s_waitcnt lgkmcnt(3)
M v[184:187],a[176:179],a[172:175],v[184:187]
s_waitcnt lgkmcnt(2)
buffer_store_dwordx4 v[168:171],v253,s[24:27],s34 offen offset:1408 nt
M v[188:191],a[176:179],a[180:183],v[188:191]
s_waitcnt lgkmcnt(0)
s_barrier
ds_read_b128 v[176:179],v250 offset:43520
M v[188:191],a[132:135],a[172:175],v[188:191]
M v[188:191],a[188:191],a[144:147],v[188:191]
v_cvt_pk_bf16_f32 v184,v184,v185
v_cvt_pk_bf16_f32 v185,v186,v187
M v[188:191],a[108:111],a[104:107],v[188:191]
M v[188:191],a[116:119],a[128:131],v[188:191]
M v[188:191],a[168:171],a[148:151],v[188:191]
s_add_u32 s34,s33,7077888
s_waitcnt lgkmcnt(0)
buffer_store_dwordx4 v[176:179],v253,s[24:27],s34 offen offset:1408 nt
s_nop 4
v_cvt_pk_bf16_f32 v188,v188,v189
v_cvt_pk_bf16_f32 v189,v190,v191
ds_write2st64_b64 v254,v[184:185],v[188:189] offset0:93 offset1:97
s_waitcnt lgkmcnt(0)
s_barrier
ds_read_b128 v[184:187],v250 offset:47616
s_add_u32 s34,s33,7471104
s_waitcnt lgkmcnt(0)
buffer_store_dwordx4 v[184:187],v253,s[24:27],s34 offen offset:1408 nt
s_endpgm
L_code_end:
L_fallback:
s_mov_b32 s84,0
L_itemF:
s_and_b32 s85,s84,3
s_lshr_b32 s86,s84,2
s_mul_hi_u32 s87,s86,0x55555556
s_mul_i32 s88,s87,3
s_sub_u32 s86,s86,s88
s_mul_hi_u32 s88,s87,0x2aaaaaab
s_mul_i32 s89,s88,6
s_sub_u32 s87,s87,s89
s_mul_i32 s89,s86,221184
s_mul_i32 s90,s87,12288
s_add_u32 s89,s89,s90
s_mul_i32 s90,s85,3072
s_add_u32 s89,s89,s90
s_lshl_b32 s90,s88,7
s_add_u32 s89,s89,s90
s_add_u32 s90,s89,73728
s_add_u32 s91,s90,73728
v_lshlrev_b32 v149,1,v164
buffer_load_short_d16_hi v68,v149,s[36:39],s89 offen offset:0
buffer_load_short_d16_hi v69,v149,s[36:39],s89 offen offset:384
buffer_load_short_d16_hi v70,v149,s[36:39],s89 offen offset:768
buffer_load_short_d16_hi v71,v149,s[36:39],s89 offen offset:1152
buffer_load_short_d16_hi v72,v149,s[36:39],s89 offen offset:1536
buffer_load_short_d16_hi v73,v149,s[36:39],s89 offen offset:1920
buffer_load_short_d16_hi v74,v149,s[36:39],s89 offen offset:2304
buffer_load_short_d16_hi v75,v149,s[36:39],s89 offen offset:2688
buffer_load_short_d16_hi v76,v149,s[36:39],s90 offen offset:0
buffer_load_short_d16_hi v77,v149,s[36:39],s90 offen offset:384
buffer_load_short_d16_hi v78,v149,s[36:39],s90 offen offset:768
buffer_load_short_d16_hi v79,v149,s[36:39],s90 offen offset:1152
buffer_load_short_d16_hi v80,v149,s[36:39],s90 offen offset:1536
buffer_load_short_d16_hi v81,v149,s[36:39],s90 offen offset:1920
buffer_load_short_d16_hi v82,v149,s[36:39],s90 offen offset:2304
buffer_load_short_d16_hi v83,v149,s[36:39],s90 offen offset:2688
buffer_load_short_d16_hi v84,v149,s[36:39],s91 offen offset:0
buffer_load_short_d16_hi v85,v149,s[36:39],s91 offen offset:384
buffer_load_short_d16_hi v86,v149,s[36:39],s91 offen offset:768
buffer_load_short_d16_hi v87,v149,s[36:39],s91 offen offset:1152
buffer_load_short_d16_hi v88,v149,s[36:39],s91 offen offset:1536
buffer_load_short_d16_hi v89,v149,s[36:39],s91 offen offset:1920
buffer_load_short_d16_hi v90,v149,s[36:39],s91 offen offset:2304
buffer_load_short_d16_hi v91,v149,s[36:39],s91 offen offset:2688
s_and_b32 s92,s85,1
s_lshl_b32 s92,s92,2
s_lshr_b32 s85,s85,1
s_lshl_b32 s85,s85,2
v_bfe_u32 v148,v164,2,2
v_or_b32 v148,s92,v148
v_and_b32 v151,3,v164
v_or_b32 v151,s85,v151
v_xor_b32 v151,v151,v148
v_lshrrev_b32 v150,4,v164
v_mul_u32_u24 v150,331776,v150
v_lshl_add_u32 v150,v148,7,v150
v_lshl_add_u32 v150,v151,4,v150
s_mul_i32 s87,s87,55296
s_mul_i32 s88,s88,3072
s_add_u32 s87,s87,s88
s_lshl_b32 s86,s86,10
s_add_u32 s87,s87,s86
s_mov_b32 s85,0xbe2aaaab
s_mov_b32 s86,0x3d2aaaab
s_mov_b32 s88,0x3e2aaaab
s_mov_b32 s92,0x3daaaaab
s_waitcnt vmcnt(0)
v_add_f32 v148,v68,v84
v_add_f32 v92,v148,v76
v_sub_f32 v100,v148,v76
v_mul_f32 v92,s85,v92
v_mul_f32 v100,s85,v100
v_mul_f32 v148,s86,v68
v_fmac_f32 v148,s88,v84
v_fma_f32 v108,s92,v76,v148
v_fma_f32 v116,-s92,v76,v148
v_add_f32 v148,v69,v85
v_add_f32 v93,v148,v77
v_sub_f32 v101,v148,v77
v_mul_f32 v93,s85,v93
v_mul_f32 v101,s85,v101
v_mul_f32 v148,s86,v69
v_fmac_f32 v148,s88,v85
v_fma_f32 v109,s92,v77,v148
v_fma_f32 v117,-s92,v77,v148
v_add_f32 v148,v70,v86
v_add_f32 v94,v148,v78
v_sub_f32 v102,v148,v78
v_mul_f32 v94,s85,v94
v_mul_f32 v102,s85,v102
v_mul_f32 v148,s86,v70
v_fmac_f32 v148,s88,v86
v_fma_f32 v110,s92,v78,v148
v_fma_f32 v118,-s92,v78,v148
v_add_f32 v148,v71,v87
v_add_f32 v95,v148,v79
v_sub_f32 v103,v148,v79
v_mul_f32 v95,s85,v95
v_mul_f32 v103,s85,v103
v_mul_f32 v148,s86,v71
v_fmac_f32 v148,s88,v87
v_fma_f32 v111,s92,v79,v148
v_fma_f32 v119,-s92,v79,v148
v_add_f32 v148,v72,v88
v_add_f32 v96,v148,v80
v_sub_f32 v104,v148,v80
v_mul_f32 v96,s85,v96
v_mul_f32 v104,s85,v104
v_mul_f32 v148,s86,v72
v_fmac_f32 v148,s88,v88
v_fma_f32 v112,s92,v80,v148
v_fma_f32 v120,-s92,v80,v148
v_add_f32 v148,v73,v89
v_add_f32 v97,v148,v81
v_sub_f32 v105,v148,v81
v_mul_f32 v97,s85,v97
v_mul_f32 v105,s85,v105
v_mul_f32 v148,s86,v73
v_fmac_f32 v148,s88,v89
v_fma_f32 v113,s92,v81,v148
v_fma_f32 v121,-s92,v81,v148
v_add_f32 v148,v74,v90
v_add_f32 v98,v148,v82
v_sub_f32 v106,v148,v82
v_mul_f32 v98,s85,v98
v_mul_f32 v106,s85,v106
v_mul_f32 v148,s86,v74
v_fmac_f32 v148,s88,v90
v_fma_f32 v114,s92,v82,v148
v_fma_f32 v122,-s92,v82,v148
v_add_f32 v148,v75,v91
v_add_f32 v99,v148,v83
v_sub_f32 v107,v148,v83
v_mul_f32 v99,s85,v99
v_mul_f32 v107,s85,v107
v_mul_f32 v148,s86,v75
v_fmac_f32 v148,s88,v91
v_fma_f32 v115,s92,v83,v148
v_fma_f32 v123,-s92,v83,v148
v_cvt_pk_bf16_f32 v124,v68,v69
v_cvt_pk_bf16_f32 v125,v70,v71
v_cvt_pk_bf16_f32 v126,v72,v73
v_cvt_pk_bf16_f32 v127,v74,v75
s_add_u32 s89,s87,0
buffer_store_dwordx4 v[124:127],v150,s[20:23],s89 offen sc1
v_cvt_pk_bf16_f32 v144,v84,v85
v_cvt_pk_bf16_f32 v145,v86,v87
v_cvt_pk_bf16_f32 v146,v88,v89
v_cvt_pk_bf16_f32 v147,v90,v91
s_add_u32 s89,s87,46080
buffer_store_dwordx4 v[144:147],v150,s[20:23],s89 offen sc1
v_cvt_pk_bf16_f32 v128,v92,v93
v_cvt_pk_bf16_f32 v129,v94,v95
v_cvt_pk_bf16_f32 v130,v96,v97
v_cvt_pk_bf16_f32 v131,v98,v99
s_add_u32 s89,s87,9216
buffer_store_dwordx4 v[128:131],v150,s[20:23],s89 offen sc1
v_cvt_pk_bf16_f32 v132,v100,v101
v_cvt_pk_bf16_f32 v133,v102,v103
v_cvt_pk_bf16_f32 v134,v104,v105
v_cvt_pk_bf16_f32 v135,v106,v107
s_add_u32 s89,s87,18432
buffer_store_dwordx4 v[132:135],v150,s[20:23],s89 offen sc1
v_cvt_pk_bf16_f32 v136,v108,v109
v_cvt_pk_bf16_f32 v137,v110,v111
v_cvt_pk_bf16_f32 v138,v112,v113
v_cvt_pk_bf16_f32 v139,v114,v115
s_add_u32 s89,s87,27648
buffer_store_dwordx4 v[136:139],v150,s[20:23],s89 offen sc1
v_cvt_pk_bf16_f32 v140,v116,v117
v_cvt_pk_bf16_f32 v141,v118,v119
v_cvt_pk_bf16_f32 v142,v120,v121
v_cvt_pk_bf16_f32 v143,v122,v123
s_add_u32 s89,s87,36864
buffer_store_dwordx4 v[140:143],v150,s[20:23],s89 offen sc1
s_waitcnt vmcnt(0)
s_add_u32 s84,s84,1
s_cmp_lt_u32 s84,216
s_cbranch_scc1 L_itemF
s_branch L_uready
.section .rodata,"a"
.p2align 6
.amdhsa_kernel standalone__winograd__vision_kernel
  .amdhsa_next_free_vgpr 512
  .amdhsa_next_free_sgpr 96
  .amdhsa_accum_offset 256
  .amdhsa_group_segment_fixed_size 0
  .amdhsa_kernarg_size 40
  .amdhsa_user_sgpr_count 2
  .amdhsa_user_sgpr_kernarg_segment_ptr 1
  .amdhsa_system_sgpr_workgroup_id_x 1
  .amdhsa_float_denorm_mode_32 3
.end_amdhsa_kernel
```

```asm
; @launch grid=(256,1,1) block=(256,1,1) lds=156672
.amdgcn_target "amdgcn-amd-amdhsa--gfx950"
.macro M d,a,b,c
v_mfma_f32_16x16x32_bf16 \d,\a,\b,\c
.endm
.text
.globl standalone__winograd__vision_kernel
.p2align 8
.type standalone__winograd__vision_kernel,@function
standalone__winograd__vision_kernel:
s_cmp_ge_u32 s2,256
s_cbranch_scc0 L_go
s_endpgm
L_go:
s_load_dwordx4 s[4:7],s[0:1],0
s_load_dwordx4 s[24:27],s[0:1],16
s_load_dwordx2 s[20:21],s[0:1],32
v_lshlrev_b32 v165,4,v0
s_getpc_b64 s[64:65]
L_pc:
s_lshr_b32 s58,s2,3
s_lshl_b32 s58,s58,12
s_min_u32 s58,s58,L_code_end-L_pc-4096
s_add_u32 s64,s64,s58
s_addc_u32 s65,s65,0
global_load_dword v167,v165,s[64:65]
v_lshrrev_b32 v160,6,v0
v_and_b32 v164,63,v0
v_readfirstlane_b32 s50,v160
v_bfe_u32 v160,v164,3,2
v_bfe_u32 v161,v164,2,1
v_lshl_add_u32 v161,v160,3,v161
v_lshrrev_b32 v162,5,v164
v_xor_b32 v162,v162,v160
v_and_b32 v162,1,v162
v_and_b32 v163,3,v164
v_lshl_add_u32 v162,v162,2,v163
v_mul_u32_u24 v245,196608,v161
v_lshl_add_u32 v245,v162,3,v245
s_and_b32 s54,s2,7
s_lshr_b32 s55,s2,3
s_lshl_b32 s49,s54,6
s_lshl_b32 s55,s55,4
s_lshl_b32 s56,s50,2
s_add_u32 s56,s56,s55
s_mul_i32 s30,s56,384
s_mul_i32 s57,s49,196608
s_add_u32 s30,s30,s57
s_mul_i32 s44,s50,330752
s_mov_b32 s58,0
s_add_u32 s59,s58,0
s_lshl_b32 s84,s59,6
s_add_u32 s66,s30,s84
s_mul_i32 s84,s59,55296
s_add_u32 s72,s44,s84
s_add_u32 s59,s58,1
s_lshl_b32 s84,s59,6
s_add_u32 s67,s30,s84
s_mul_i32 s84,s59,55296
s_add_u32 s73,s44,s84
s_add_u32 s59,s58,2
s_lshl_b32 s84,s59,6
s_add_u32 s68,s30,s84
s_mul_i32 s84,s59,55296
s_add_u32 s74,s44,s84
s_add_u32 s59,s58,3
s_lshl_b32 s84,s59,6
s_add_u32 s69,s30,s84
s_mul_i32 s84,s59,55296
s_add_u32 s75,s44,s84
s_add_u32 s59,s58,4
s_lshl_b32 s84,s59,6
s_add_u32 s70,s30,s84
s_mul_i32 s84,s59,55296
s_add_u32 s76,s44,s84
s_add_u32 s59,s58,5
s_cmp_eq_u32 s59,6
s_cselect_b32 s59,0,s59
s_lshl_b32 s84,s59,6
s_add_u32 s71,s30,s84
s_mul_i32 s84,s59,55296
s_add_u32 s77,s44,s84
s_cmp_eq_u32 s49,0
s_cselect_b32 s58,1,0
v_cmp_gt_u32 vcc,s58,v161
v_lshrrev_b32 v163,5,v164
v_add_u32 v163,32,v163
v_mul_u32_u24 v246,196608,v163
v_bfrev_b32 v163,1
v_cndmask_b32 v251,v245,v163,vcc
v_lshl_add_u32 v168,v162,3,v245
v_cndmask_b32 v169,v168,v163,vcc
v_and_b32 v163,31,v164
v_lshlrev_b32 v163,1,v163
v_lshl_add_u32 v170,v163,1,v246
v_add_u32 v246,v246,v163
v_mov_b32 v166,1
s_mov_b32 s38,663552
s_mov_b32 s39,0x20000
s_mov_b32 s62,0
s_mov_b32 s63,0x20000
s_mov_b32 s22,1327104
s_mov_b32 s23,0x20000
s_waitcnt lgkmcnt(0)
s_and_b32 s21,s21,0xffff
s_mov_b32 s36,s6
s_and_b32 s37,s7,0xffff
s_mov_b32 s60,s26
s_and_b32 s61,s27,0xffff
s_mov_b32 s52,s26
s_mov_b32 s53,s27
s_cmp_lt_u32 s2,54
s_cbranch_scc0 L_noitem
s_lshl_b32 s84,s2,2
s_add_u32 s84,s84,s50
L_itemP:
s_and_b32 s85,s84,3
s_lshr_b32 s86,s84,2
s_mul_hi_u32 s87,s86,0x55555556
s_mul_i32 s88,s87,3
s_sub_u32 s86,s86,s88
s_mul_hi_u32 s88,s87,0x2aaaaaab
s_mul_i32 s89,s88,6
s_sub_u32 s87,s87,s89
s_mul_i32 s89,s86,221184
s_mul_i32 s90,s87,12288
s_add_u32 s89,s89,s90
s_mul_i32 s90,s85,3072
s_add_u32 s89,s89,s90
s_lshl_b32 s90,s88,7
s_add_u32 s89,s89,s90
s_add_u32 s90,s89,73728
s_add_u32 s91,s90,73728
v_lshlrev_b32 v149,1,v164
buffer_load_short_d16_hi v68,v149,s[36:39],s89 offen offset:0
buffer_load_short_d16_hi v69,v149,s[36:39],s89 offen offset:384
buffer_load_short_d16_hi v70,v149,s[36:39],s89 offen offset:768
buffer_load_short_d16_hi v71,v149,s[36:39],s89 offen offset:1152
buffer_load_short_d16_hi v72,v149,s[36:39],s89 offen offset:1536
buffer_load_short_d16_hi v73,v149,s[36:39],s89 offen offset:1920
buffer_load_short_d16_hi v74,v149,s[36:39],s89 offen offset:2304
buffer_load_short_d16_hi v75,v149,s[36:39],s89 offen offset:2688
buffer_load_short_d16_hi v76,v149,s[36:39],s90 offen offset:0
buffer_load_short_d16_hi v77,v149,s[36:39],s90 offen offset:384
buffer_load_short_d16_hi v78,v149,s[36:39],s90 offen offset:768
buffer_load_short_d16_hi v79,v149,s[36:39],s90 offen offset:1152
buffer_load_short_d16_hi v80,v149,s[36:39],s90 offen offset:1536
buffer_load_short_d16_hi v81,v149,s[36:39],s90 offen offset:1920
buffer_load_short_d16_hi v82,v149,s[36:39],s90 offen offset:2304
buffer_load_short_d16_hi v83,v149,s[36:39],s90 offen offset:2688
buffer_load_short_d16_hi v84,v149,s[36:39],s91 offen offset:0
buffer_load_short_d16_hi v85,v149,s[36:39],s91 offen offset:384
buffer_load_short_d16_hi v86,v149,s[36:39],s91 offen offset:768
buffer_load_short_d16_hi v87,v149,s[36:39],s91 offen offset:1152
buffer_load_short_d16_hi v88,v149,s[36:39],s91 offen offset:1536
buffer_load_short_d16_hi v89,v149,s[36:39],s91 offen offset:1920
buffer_load_short_d16_hi v90,v149,s[36:39],s91 offen offset:2304
buffer_load_short_d16_hi v91,v149,s[36:39],s91 offen offset:2688
s_and_b32 s92,s85,1
s_lshl_b32 s92,s92,2
s_lshr_b32 s85,s85,1
s_lshl_b32 s85,s85,2
v_bfe_u32 v148,v164,2,2
v_or_b32 v148,s92,v148
v_and_b32 v151,3,v164
v_or_b32 v151,s85,v151
v_xor_b32 v151,v151,v148
v_lshrrev_b32 v150,4,v164
v_mul_u32_u24 v150,331776,v150
v_lshl_add_u32 v150,v148,7,v150
v_lshl_add_u32 v150,v151,4,v150
s_mul_i32 s87,s87,55296
s_mul_i32 s88,s88,3072
s_add_u32 s87,s87,s88
s_lshl_b32 s86,s86,10
s_add_u32 s87,s87,s86
s_mov_b32 s85,0xbe2aaaab
s_mov_b32 s86,0x3d2aaaab
s_mov_b32 s88,0x3e2aaaab
s_mov_b32 s92,0x3daaaaab
s_waitcnt vmcnt(0)
v_add_f32 v148,v68,v84
v_add_f32 v92,v148,v76
v_sub_f32 v100,v148,v76
v_mul_f32 v92,s85,v92
v_mul_f32 v100,s85,v100
v_mul_f32 v148,s86,v68
v_fmac_f32 v148,s88,v84
v_fma_f32 v108,s92,v76,v148
v_fma_f32 v116,-s92,v76,v148
v_add_f32 v148,v69,v85
v_add_f32 v93,v148,v77
v_sub_f32 v101,v148,v77
v_mul_f32 v93,s85,v93
v_mul_f32 v101,s85,v101
v_mul_f32 v148,s86,v69
v_fmac_f32 v148,s88,v85
v_fma_f32 v109,s92,v77,v148
v_fma_f32 v117,-s92,v77,v148
v_add_f32 v148,v70,v86
v_add_f32 v94,v148,v78
v_sub_f32 v102,v148,v78
v_mul_f32 v94,s85,v94
v_mul_f32 v102,s85,v102
v_mul_f32 v148,s86,v70
v_fmac_f32 v148,s88,v86
v_fma_f32 v110,s92,v78,v148
v_fma_f32 v118,-s92,v78,v148
v_add_f32 v148,v71,v87
v_add_f32 v95,v148,v79
v_sub_f32 v103,v148,v79
v_mul_f32 v95,s85,v95
v_mul_f32 v103,s85,v103
v_mul_f32 v148,s86,v71
v_fmac_f32 v148,s88,v87
v_fma_f32 v111,s92,v79,v148
v_fma_f32 v119,-s92,v79,v148
v_add_f32 v148,v72,v88
v_add_f32 v96,v148,v80
v_sub_f32 v104,v148,v80
v_mul_f32 v96,s85,v96
v_mul_f32 v104,s85,v104
v_mul_f32 v148,s86,v72
v_fmac_f32 v148,s88,v88
v_fma_f32 v112,s92,v80,v148
v_fma_f32 v120,-s92,v80,v148
v_add_f32 v148,v73,v89
v_add_f32 v97,v148,v81
v_sub_f32 v105,v148,v81
v_mul_f32 v97,s85,v97
v_mul_f32 v105,s85,v105
v_mul_f32 v148,s86,v73
v_fmac_f32 v148,s88,v89
v_fma_f32 v113,s92,v81,v148
v_fma_f32 v121,-s92,v81,v148
v_add_f32 v148,v74,v90
v_add_f32 v98,v148,v82
v_sub_f32 v106,v148,v82
v_mul_f32 v98,s85,v98
v_mul_f32 v106,s85,v106
v_mul_f32 v148,s86,v74
v_fmac_f32 v148,s88,v90
v_fma_f32 v114,s92,v82,v148
v_fma_f32 v122,-s92,v82,v148
v_add_f32 v148,v75,v91
v_add_f32 v99,v148,v83
v_sub_f32 v107,v148,v83
v_mul_f32 v99,s85,v99
v_mul_f32 v107,s85,v107
v_mul_f32 v148,s86,v75
v_fmac_f32 v148,s88,v91
v_fma_f32 v115,s92,v83,v148
v_fma_f32 v123,-s92,v83,v148
v_cvt_pk_bf16_f32 v124,v68,v69
v_cvt_pk_bf16_f32 v125,v70,v71
v_cvt_pk_bf16_f32 v126,v72,v73
v_cvt_pk_bf16_f32 v127,v74,v75
s_add_u32 s89,s87,0
buffer_store_dwordx4 v[124:127],v150,s[20:23],s89 offen sc1
v_cvt_pk_bf16_f32 v144,v84,v85
v_cvt_pk_bf16_f32 v145,v86,v87
v_cvt_pk_bf16_f32 v146,v88,v89
v_cvt_pk_bf16_f32 v147,v90,v91
s_add_u32 s89,s87,46080
buffer_store_dwordx4 v[144:147],v150,s[20:23],s89 offen sc1
v_cvt_pk_bf16_f32 v128,v92,v93
v_cvt_pk_bf16_f32 v129,v94,v95
v_cvt_pk_bf16_f32 v130,v96,v97
v_cvt_pk_bf16_f32 v131,v98,v99
s_add_u32 s89,s87,9216
buffer_store_dwordx4 v[128:131],v150,s[20:23],s89 offen sc1
v_cvt_pk_bf16_f32 v132,v100,v101
v_cvt_pk_bf16_f32 v133,v102,v103
v_cvt_pk_bf16_f32 v134,v104,v105
v_cvt_pk_bf16_f32 v135,v106,v107
s_add_u32 s89,s87,18432
buffer_store_dwordx4 v[132:135],v150,s[20:23],s89 offen sc1
v_cvt_pk_bf16_f32 v136,v108,v109
v_cvt_pk_bf16_f32 v137,v110,v111
v_cvt_pk_bf16_f32 v138,v112,v113
v_cvt_pk_bf16_f32 v139,v114,v115
s_add_u32 s89,s87,27648
buffer_store_dwordx4 v[136:139],v150,s[20:23],s89 offen sc1
v_cvt_pk_bf16_f32 v140,v116,v117
v_cvt_pk_bf16_f32 v141,v118,v119
v_cvt_pk_bf16_f32 v142,v120,v121
v_cvt_pk_bf16_f32 v143,v122,v123
s_add_u32 s89,s87,36864
buffer_store_dwordx4 v[140:143],v150,s[20:23],s89 offen sc1
s_waitcnt vmcnt(0)
s_barrier
s_cmp_eq_u32 s50,0
s_cselect_b32 s62,256,0
L_noitem:
s_and_b32 s84,s2,1
s_lshl_b32 s59,s84,6
s_lshl_b32 s84,s84,2
s_mov_b64 exec,1
buffer_atomic_add v166,off,s[60:63],s59 sc0 sc1
s_mov_b64 exec,-1
s_and_b32 s5,s5,0xffff
s_sub_u32 s8,s4,196608
s_subb_u32 s9,s5,0
s_mov_b32 s10,100859904
s_mov_b32 s11,0x20000
s_sub_u32 s12,s4,196992
s_subb_u32 s13,s5,0
s_cmp_eq_u32 s56,0
s_cselect_b32 s14,0,100860288
s_mov_b32 s15,0x20000
s_mov_b32 s16,s8
s_mov_b32 s17,s9
s_cmp_eq_u32 s56,508
s_cselect_b32 s18,0,100859904
s_mov_b32 s19,0x20000
s_add_u32 s28,s30,0
buffer_load_dwordx4 v[8:11],v169,s[8:11],s28 offen offset:384
buffer_load_dwordx4 v[0:3],v169,s[12:15],s28 offen offset:0
buffer_load_dwordx4 v[4:7],v169,s[8:11],s28 offen offset:0
buffer_load_dwordx4 v[20:23],v169,s[16:19],s28 offen offset:1536
buffer_load_dwordx4 v[16:19],v169,s[8:11],s28 offen offset:1152
buffer_load_dwordx4 v[12:15],v169,s[8:11],s28 offen offset:768
s_mov_b64 exec,1
s_waitcnt vmcnt(6)
v_cmp_eq_u32 vcc,26,v166
v_mov_b32 v165,1
s_nop 2
s_and_b64 exec,exec,vcc
s_cselect_b32 s62,s62,0
s_mov_b64 exec,1
buffer_store_dword v165,off,s[60:63],s84 offset:128 sc1
s_mov_b64 exec,-1
s_add_u32 s28,s30,393216
buffer_load_dwordx4 v[32:35],v168,s[8:11],s28 offen offset:384
buffer_load_dwordx4 v[24:27],v168,s[12:15],s28 offen offset:0
buffer_load_dwordx4 v[28:31],v168,s[8:11],s28 offen offset:0
buffer_load_dwordx4 v[44:47],v168,s[16:19],s28 offen offset:1536
buffer_load_dwordx4 v[40:43],v168,s[8:11],s28 offen offset:1152
buffer_load_dwordx4 v[36:39],v168,s[8:11],s28 offen offset:768
v_bfe_u32 v165,v164,2,3
v_lshrrev_b32 v159,5,v164
v_and_b32 v163,3,v164
v_lshl_add_u32 v159,v159,2,v163
v_xor_b32 v163,v159,v165
v_lshlrev_b32 v163,4,v163
v_lshl_add_u32 v163,v165,7,v163
v_lshl_add_u32 v250,s50,10,v163
s_and_b32 s25,s25,0xffff
s_mov_b32 s26,100663296
s_mov_b32 s27,0x20000
s_mov_b32 s41,0xc0a00000
s_mov_b32 s40,0x41000000
s_mov_b32 s42,0xffff0000
s_mov_b32 s43,0xbfa00000
s_mov_b32 s45,0x3e800000
s_mul_i32 s58,s55,384
s_add_u32 s58,s57,s58
s_lshr_b32 s59,s50,1
s_mul_i32 s32,s59,384
s_mul_i32 s33,s59,196608
s_add_u32 s32,s32,s58
s_add_u32 s33,s33,s58
s_lshl_b32 s58,s59,5
s_lshl_b32 s59,s50,7
v_lshlrev_b32 v247,11,v160
v_xor_b32 v163,v160,v161
v_and_b32 v163,1,v163
v_lshl_add_u32 v247,v163,6,v247
v_lshlrev_b32 v163,3,v162
v_xor_b32 v163,s58,v163
v_add3_u32 v247,v247,v163,s59
v_and_b32 v171,0xffffffc0,v247
v_and_b32 v163,3,v162
v_lshlrev_b32 v163,4,v163
v_xor_b32 v163,s58,v163
v_add_u32 v171,v171,v163
v_lshrrev_b32 v163,2,v162
v_mul_u32_u24 v163,17408,v163
v_mad_u32_u24 v172,v163,5,v171
v_lshl_add_u32 v171,v163,1,v171
v_and_b32 v163,15,v164
v_lshlrev_b32 v163,2,v163
v_xor_b32 v163,s58,v163
v_lshrrev_b32 v173,5,v164
v_lshl_add_u32 v173,v173,6,v163
v_add_u32 v173,s59,v173
v_add_u32 v173,8192,v173
v_bfe_u32 v163,v164,4,1
v_mul_u32_u24 v163,17408,v163
v_mad_u32_u24 v174,v163,5,v173
v_lshl_add_u32 v173,v163,1,v173
v_and_b32 v163,3,v164
v_lshlrev_b32 v163,4,v163
v_and_or_b32 v245,v245,s42,v163
v_xor_b32 v163,s58,v163
v_and_b32 v247,0xffffffc0,v247
v_add_u32 v247,v247,v163
v_lshrrev_b32 v163,5,v164
v_lshl_add_u32 v247,v163,3,v247
v_mul_u32_u24 v163,384,v163
v_mad_u32_u24 v251,v163,5,v245
v_add_u32 v245,v245,v163
s_cmp_eq_u32 s56,0
s_cselect_b32 exec_lo,-1,0
s_cmp_eq_u32 s56,508
s_cselect_b32 exec_hi,-1,0
v_or_b32 v251,0x40000000,v251
s_mov_b64 exec,-1
v_lshrrev_b32 v160,5,v164
v_lshlrev_b32 v160,6,v160
v_and_b32 v161,63,v246
v_xor_b32 v161,s58,v161
v_add3_u32 v252,v160,v161,s59
v_add_u32 v252,8192,v252
v_bfe_u32 v160,v164,2,2
v_and_b32 v161,3,v164
v_lshrrev_b32 v162,4,v164
v_lshlrev_b32 v248,11,v160
v_lshl_add_u32 v248,v161,7,v248
v_and_b32 v163,1,v160
v_lshl_add_u32 v248,v163,6,v248
v_and_b32 v163,2,v161
v_xor_b32 v163,v163,v162
v_lshl_add_u32 v248,v163,4,v248
v_xor_b32 v249,64,v248
v_lshrrev_b32 v160,1,v162
v_lshl_add_u32 v160,s50,1,v160
v_and_b32 v161,7,v164
v_xor_b32 v160,v160,v161
v_and_b32 v163,15,v164
v_lshlrev_b32 v254,7,v163
v_lshl_add_u32 v254,v160,4,v254
v_and_b32 v163,1,v162
v_lshl_add_u32 v254,v163,3,v254
v_bfe_u32 v160,v250,7,4
v_lshrrev_b32 v162,2,v160
v_mul_u32_u24 v253,1572864,v162
v_and_b32 v162,3,v160
v_mul_u32_u24 v162,1536,v162
v_lshl_add_u32 v160,v159,4,v162
v_add_u32 v253,v253,v160
s_waitcnt vmcnt(12)
v_lshlrev_b32 v180,16,v8
v_and_b32 v181,s42,v8
s_waitcnt vmcnt(11)
v_lshlrev_b32 v176,16,v0
v_and_b32 v177,s42,v0
s_waitcnt vmcnt(10)
v_lshlrev_b32 v178,16,v4
v_and_b32 v179,s42,v4
s_add_u32 s28,s30,786432
buffer_load_dwordx4 v[56:59],v168,s[8:11],s28 offen offset:384
s_waitcnt vmcnt(10)
v_lshlrev_b32 v186,16,v20
v_and_b32 v187,s42,v20
s_waitcnt vmcnt(9)
v_lshlrev_b32 v184,16,v16
v_and_b32 v185,s42,v16
s_waitcnt vmcnt(8)
v_lshlrev_b32 v182,16,v12
v_and_b32 v183,s42,v12
v_pk_fma_f32 v[176:177],v[180:181],s[42:43],v[176:177] op_sel:[0,1,0] op_sel_hi:[1,1,1]
v_pk_fma_f32 v[186:187],v[178:179],4.0,v[186:187] op_sel_hi:[1,0,1]
v_pk_fma_f32 v[188:189],v[180:181],-4.0,v[184:185] op_sel_hi:[1,0,1]
v_pk_fma_f32 v[176:177],v[184:185],s[44:45],v[176:177] op_sel:[0,1,0] op_sel_hi:[1,1,1]
v_pk_fma_f32 v[186:187],v[182:183],s[40:41],v[186:187] op_sel:[0,1,0] op_sel_hi:[1,1,1]
v_pk_add_f32 v[184:185],v[184:185],v[180:181] neg_lo:[0,1] neg_hi:[0,1]
buffer_load_dwordx4 v[48:51],v168,s[12:15],s28 offen offset:0
v_pk_fma_f32 v[180:181],v[178:179],-4.0,v[182:183] op_sel_hi:[1,0,1]
v_pk_add_f32 v[182:183],v[182:183],v[178:179] neg_lo:[0,1] neg_hi:[0,1]
v_pk_add_f32 v[178:179],v[188:189],v[180:181]
v_pk_add_f32 v[188:189],v[188:189],v[180:181] neg_lo:[0,1] neg_hi:[0,1]
v_pk_fma_f32 v[180:181],v[182:183],2.0,v[184:185] op_sel_hi:[1,0,1]
v_pk_fma_f32 v[184:185],v[182:183],-2.0,v[184:185] op_sel_hi:[1,0,1]
v_cvt_pk_bf16_f32 v0,v176,v177
v_cvt_pk_bf16_f32 v4,v178,v179
v_cvt_pk_bf16_f32 v8,v188,v189
v_cvt_pk_bf16_f32 v12,v180,v181
v_cvt_pk_bf16_f32 v16,v184,v185
v_cvt_pk_bf16_f32 v20,v186,v187
buffer_load_dwordx4 v[52:55],v168,s[8:11],s28 offen offset:0
v_lshlrev_b32 v180,16,v9
v_and_b32 v181,s42,v9
v_lshlrev_b32 v176,16,v1
v_and_b32 v177,s42,v1
v_lshlrev_b32 v178,16,v5
v_and_b32 v179,s42,v5
v_lshlrev_b32 v186,16,v21
v_and_b32 v187,s42,v21
v_lshlrev_b32 v184,16,v17
v_and_b32 v185,s42,v17
v_lshlrev_b32 v182,16,v13
v_and_b32 v183,s42,v13
buffer_load_dwordx4 v[68:71],v168,s[16:19],s28 offen offset:1536
v_pk_fma_f32 v[176:177],v[180:181],s[42:43],v[176:177] op_sel:[0,1,0] op_sel_hi:[1,1,1]
v_pk_fma_f32 v[186:187],v[178:179],4.0,v[186:187] op_sel_hi:[1,0,1]
v_pk_fma_f32 v[188:189],v[180:181],-4.0,v[184:185] op_sel_hi:[1,0,1]
v_pk_fma_f32 v[176:177],v[184:185],s[44:45],v[176:177] op_sel:[0,1,0] op_sel_hi:[1,1,1]
v_pk_fma_f32 v[186:187],v[182:183],s[40:41],v[186:187] op_sel:[0,1,0] op_sel_hi:[1,1,1]
v_pk_add_f32 v[184:185],v[184:185],v[180:181] neg_lo:[0,1] neg_hi:[0,1]
v_pk_fma_f32 v[180:181],v[178:179],-4.0,v[182:183] op_sel_hi:[1,0,1]
v_pk_add_f32 v[182:183],v[182:183],v[178:179] neg_lo:[0,1] neg_hi:[0,1]
v_pk_add_f32 v[178:179],v[188:189],v[180:181]
v_pk_add_f32 v[188:189],v[188:189],v[180:181] neg_lo:[0,1] neg_hi:[0,1]
v_pk_fma_f32 v[180:181],v[182:183],2.0,v[184:185] op_sel_hi:[1,0,1]
v_pk_fma_f32 v[184:185],v[182:183],-2.0,v[184:185] op_sel_hi:[1,0,1]
buffer_load_dwordx4 v[64:67],v168,s[8:11],s28 offen offset:1152
v_cvt_pk_bf16_f32 v1,v176,v177
v_cvt_pk_bf16_f32 v5,v178,v179
v_cvt_pk_bf16_f32 v9,v188,v189
v_cvt_pk_bf16_f32 v13,v180,v181
v_cvt_pk_bf16_f32 v17,v184,v185
v_cvt_pk_bf16_f32 v21,v186,v187
v_lshlrev_b32 v180,16,v10
v_and_b32 v181,s42,v10
v_lshlrev_b32 v176,16,v2
v_and_b32 v177,s42,v2
v_lshlrev_b32 v178,16,v6
v_and_b32 v179,s42,v6
buffer_load_dwordx4 v[60:63],v168,s[8:11],s28 offen offset:768
v_lshlrev_b32 v186,16,v22
v_and_b32 v187,s42,v22
v_lshlrev_b32 v184,16,v18
v_and_b32 v185,s42,v18
v_lshlrev_b32 v182,16,v14
v_and_b32 v183,s42,v14
v_pk_fma_f32 v[176:177],v[180:181],s[42:43],v[176:177] op_sel:[0,1,0] op_sel_hi:[1,1,1]
v_pk_fma_f32 v[186:187],v[178:179],4.0,v[186:187] op_sel_hi:[1,0,1]
v_pk_fma_f32 v[188:189],v[180:181],-4.0,v[184:185] op_sel_hi:[1,0,1]
v_pk_fma_f32 v[176:177],v[184:185],s[44:45],v[176:177] op_sel:[0,1,0] op_sel_hi:[1,1,1]
v_pk_fma_f32 v[186:187],v[182:183],s[40:41],v[186:187] op_sel:[0,1,0] op_sel_hi:[1,1,1]
v_pk_add_f32 v[184:185],v[184:185],v[180:181] neg_lo:[0,1] neg_hi:[0,1]
s_add_u32 s28,s30,1179648
buffer_load_dwordx4 v[80:83],v168,s[8:11],s28 offen offset:384
v_pk_fma_f32 v[180:181],v[178:179],-4.0,v[182:183] op_sel_hi:[1,0,1]
v_pk_add_f32 v[182:183],v[182:183],v[178:179] neg_lo:[0,1] neg_hi:[0,1]
v_pk_add_f32 v[178:179],v[188:189],v[180:181]
v_pk_add_f32 v[188:189],v[188:189],v[180:181] neg_lo:[0,1] neg_hi:[0,1]
v_pk_fma_f32 v[180:181],v[182:183],2.0,v[184:185] op_sel_hi:[1,0,1]
v_pk_fma_f32 v[184:185],v[182:183],-2.0,v[184:185] op_sel_hi:[1,0,1]
v_cvt_pk_bf16_f32 v2,v176,v177
v_cvt_pk_bf16_f32 v6,v178,v179
v_cvt_pk_bf16_f32 v10,v188,v189
v_cvt_pk_bf16_f32 v14,v180,v181
v_cvt_pk_bf16_f32 v18,v184,v185
v_cvt_pk_bf16_f32 v22,v186,v187
buffer_load_dwordx4 v[72:75],v168,s[12:15],s28 offen offset:0
v_lshlrev_b32 v180,16,v11
v_and_b32 v181,s42,v11
v_lshlrev_b32 v176,16,v3
v_and_b32 v177,s42,v3
v_lshlrev_b32 v178,16,v7
v_and_b32 v179,s42,v7
v_lshlrev_b32 v186,16,v23
v_and_b32 v187,s42,v23
v_lshlrev_b32 v184,16,v19
v_and_b32 v185,s42,v19
v_lshlrev_b32 v182,16,v15
v_and_b32 v183,s42,v15
buffer_load_dwordx4 v[76:79],v168,s[8:11],s28 offen offset:0
v_pk_fma_f32 v[176:177],v[180:181],s[42:43],v[176:177] op_sel:[0,1,0] op_sel_hi:[1,1,1]
v_pk_fma_f32 v[186:187],v[178:179],4.0,v[186:187] op_sel_hi:[1,0,1]
v_pk_fma_f32 v[188:189],v[180:181],-4.0,v[184:185] op_sel_hi:[1,0,1]
v_pk_fma_f32 v[176:177],v[184:185],s[44:45],v[176:177] op_sel:[0,1,0] op_sel_hi:[1,1,1]
v_pk_fma_f32 v[186:187],v[182:183],s[40:41],v[186:187] op_sel:[0,1,0] op_sel_hi:[1,1,1]
v_pk_add_f32 v[184:185],v[184:185],v[180:181] neg_lo:[0,1] neg_hi:[0,1]
v_pk_fma_f32 v[180:181],v[178:179],-4.0,v[182:183] op_sel_hi:[1,0,1]
v_pk_add_f32 v[182:183],v[182:183],v[178:179] neg_lo:[0,1] neg_hi:[0,1]
v_pk_add_f32 v[178:179],v[188:189],v[180:181]
v_pk_add_f32 v[188:189],v[188:189],v[180:181] neg_lo:[0,1] neg_hi:[0,1]
v_pk_fma_f32 v[180:181],v[182:183],2.0,v[184:185] op_sel_hi:[1,0,1]
v_pk_fma_f32 v[184:185],v[182:183],-2.0,v[184:185] op_sel_hi:[1,0,1]
buffer_load_dwordx4 v[92:95],v168,s[16:19],s28 offen offset:1536
v_cvt_pk_bf16_f32 v3,v176,v177
v_cvt_pk_bf16_f32 v7,v178,v179
v_cvt_pk_bf16_f32 v11,v188,v189
v_cvt_pk_bf16_f32 v15,v180,v181
v_cvt_pk_bf16_f32 v19,v184,v185
v_cvt_pk_bf16_f32 v23,v186,v187
ds_write_b128 v172,v[0:3] offset:0
ds_write_b128 v171,v[4:7] offset:17408
ds_write_b128 v171,v[8:11] offset:26112
ds_write_b128 v171,v[12:15] offset:34816
ds_write_b128 v171,v[16:19] offset:43520
ds_write_b128 v172,v[20:23] offset:8704
buffer_load_dwordx4 v[88:91],v168,s[8:11],s28 offen offset:1152
s_waitcnt vmcnt(16)
v_lshlrev_b32 v180,16,v32
v_and_b32 v181,s42,v32
s_waitcnt vmcnt(15)
v_lshlrev_b32 v176,16,v24
v_and_b32 v177,s42,v24
s_waitcnt vmcnt(14)
v_lshlrev_b32 v178,16,v28
v_and_b32 v179,s42,v28
buffer_load_dwordx4 v[84:87],v168,s[8:11],s28 offen offset:768
s_waitcnt vmcnt(14)
v_lshlrev_b32 v186,16,v44
v_and_b32 v187,s42,v44
s_waitcnt vmcnt(13)
v_lshlrev_b32 v184,16,v40
v_and_b32 v185,s42,v40
s_waitcnt vmcnt(12)
v_lshlrev_b32 v182,16,v36
v_and_b32 v183,s42,v36
v_pk_fma_f32 v[176:177],v[180:181],s[42:43],v[176:177] op_sel:[0,1,0] op_sel_hi:[1,1,1]
v_pk_fma_f32 v[186:187],v[178:179],4.0,v[186:187] op_sel_hi:[1,0,1]
v_pk_fma_f32 v[188:189],v[180:181],-4.0,v[184:185] op_sel_hi:[1,0,1]
v_pk_fma_f32 v[176:177],v[184:185],s[44:45],v[176:177] op_sel:[0,1,0] op_sel_hi:[1,1,1]
v_pk_fma_f32 v[186:187],v[182:183],s[40:41],v[186:187] op_sel:[0,1,0] op_sel_hi:[1,1,1]
v_pk_add_f32 v[184:185],v[184:185],v[180:181] neg_lo:[0,1] neg_hi:[0,1]
buffer_load_dword v96,v170,s[12:15],s30 offen offset:0
v_pk_fma_f32 v[180:181],v[178:179],-4.0,v[182:183] op_sel_hi:[1,0,1]
v_pk_add_f32 v[182:183],v[182:183],v[178:179] neg_lo:[0,1] neg_hi:[0,1]
v_pk_add_f32 v[178:179],v[188:189],v[180:181]
v_pk_add_f32 v[188:189],v[188:189],v[180:181] neg_lo:[0,1] neg_hi:[0,1]
v_pk_fma_f32 v[180:181],v[182:183],2.0,v[184:185] op_sel_hi:[1,0,1]
v_pk_fma_f32 v[184:185],v[182:183],-2.0,v[184:185] op_sel_hi:[1,0,1]
v_cvt_pk_bf16_f32 v24,v176,v177
v_cvt_pk_bf16_f32 v28,v178,v179
v_cvt_pk_bf16_f32 v32,v188,v189
v_cvt_pk_bf16_f32 v36,v180,v181
v_cvt_pk_bf16_f32 v40,v184,v185
v_cvt_pk_bf16_f32 v44,v186,v187
buffer_load_dword v97,v170,s[8:11],s30 offen offset:0
v_lshlrev_b32 v180,16,v33
v_and_b32 v181,s42,v33
v_lshlrev_b32 v176,16,v25
v_and_b32 v177,s42,v25
v_lshlrev_b32 v178,16,v29
v_and_b32 v179,s42,v29
v_lshlrev_b32 v186,16,v45
v_and_b32 v187,s42,v45
v_lshlrev_b32 v184,16,v41
v_and_b32 v185,s42,v41
v_lshlrev_b32 v182,16,v37
v_and_b32 v183,s42,v37
buffer_load_dword v98,v170,s[8:11],s30 offen offset:384
v_pk_fma_f32 v[176:177],v[180:181],s[42:43],v[176:177] op_sel:[0,1,0] op_sel_hi:[1,1,1]
v_pk_fma_f32 v[186:187],v[178:179],4.0,v[186:187] op_sel_hi:[1,0,1]
v_pk_fma_f32 v[188:189],v[180:181],-4.0,v[184:185] op_sel_hi:[1,0,1]
v_pk_fma_f32 v[176:177],v[184:185],s[44:45],v[176:177] op_sel:[0,1,0] op_sel_hi:[1,1,1]
v_pk_fma_f32 v[186:187],v[182:183],s[40:41],v[186:187] op_sel:[0,1,0] op_sel_hi:[1,1,1]
v_pk_add_f32 v[184:185],v[184:185],v[180:181] neg_lo:[0,1] neg_hi:[0,1]
v_pk_fma_f32 v[180:181],v[178:179],-4.0,v[182:183] op_sel_hi:[1,0,1]
v_pk_add_f32 v[182:183],v[182:183],v[178:179] neg_lo:[0,1] neg_hi:[0,1]
v_pk_add_f32 v[178:179],v[188:189],v[180:181]
v_pk_add_f32 v[188:189],v[188:189],v[180:181] neg_lo:[0,1] neg_hi:[0,1]
v_pk_fma_f32 v[180:181],v[182:183],2.0,v[184:185] op_sel_hi:[1,0,1]
v_pk_fma_f32 v[184:185],v[182:183],-2.0,v[184:185] op_sel_hi:[1,0,1]
buffer_load_dword v99,v170,s[8:11],s30 offen offset:768
v_cvt_pk_bf16_f32 v25,v176,v177
v_cvt_pk_bf16_f32 v29,v178,v179
v_cvt_pk_bf16_f32 v33,v188,v189
v_cvt_pk_bf16_f32 v37,v180,v181
v_cvt_pk_bf16_f32 v41,v184,v185
v_cvt_pk_bf16_f32 v45,v186,v187
v_lshlrev_b32 v180,16,v34
v_and_b32 v181,s42,v34
v_lshlrev_b32 v176,16,v26
v_and_b32 v177,s42,v26
v_lshlrev_b32 v178,16,v30
v_and_b32 v179,s42,v30
buffer_load_dword v100,v170,s[8:11],s30 offen offset:1152
v_lshlrev_b32 v186,16,v46
v_and_b32 v187,s42,v46
v_lshlrev_b32 v184,16,v42
v_and_b32 v185,s42,v42
v_lshlrev_b32 v182,16,v38
v_and_b32 v183,s42,v38
v_pk_fma_f32 v[176:177],v[180:181],s[42:43],v[176:177] op_sel:[0,1,0] op_sel_hi:[1,1,1]
v_pk_fma_f32 v[186:187],v[178:179],4.0,v[186:187] op_sel_hi:[1,0,1]
v_pk_fma_f32 v[188:189],v[180:181],-4.0,v[184:185] op_sel_hi:[1,0,1]
v_pk_fma_f32 v[176:177],v[184:185],s[44:45],v[176:177] op_sel:[0,1,0] op_sel_hi:[1,1,1]
v_pk_fma_f32 v[186:187],v[182:183],s[40:41],v[186:187] op_sel:[0,1,0] op_sel_hi:[1,1,1]
v_pk_add_f32 v[184:185],v[184:185],v[180:181] neg_lo:[0,1] neg_hi:[0,1]
buffer_load_dword v101,v170,s[16:19],s30 offen offset:1536
v_pk_fma_f32 v[180:181],v[178:179],-4.0,v[182:183] op_sel_hi:[1,0,1]
v_pk_add_f32 v[182:183],v[182:183],v[178:179] neg_lo:[0,1] neg_hi:[0,1]
v_pk_add_f32 v[178:179],v[188:189],v[180:181]
v_pk_add_f32 v[188:189],v[188:189],v[180:181] neg_lo:[0,1] neg_hi:[0,1]
v_pk_fma_f32 v[180:181],v[182:183],2.0,v[184:185] op_sel_hi:[1,0,1]
v_pk_fma_f32 v[184:185],v[182:183],-2.0,v[184:185] op_sel_hi:[1,0,1]
v_cvt_pk_bf16_f32 v26,v176,v177
v_cvt_pk_bf16_f32 v30,v178,v179
v_cvt_pk_bf16_f32 v34,v188,v189
v_cvt_pk_bf16_f32 v38,v180,v181
v_cvt_pk_bf16_f32 v42,v184,v185
v_cvt_pk_bf16_f32 v46,v186,v187
v_lshlrev_b32 v180,16,v35
v_and_b32 v181,s42,v35
v_lshlrev_b32 v176,16,v27
v_and_b32 v177,s42,v27
v_lshlrev_b32 v178,16,v31
v_and_b32 v179,s42,v31
v_lshlrev_b32 v186,16,v47
v_and_b32 v187,s42,v47
v_lshlrev_b32 v184,16,v43
v_and_b32 v185,s42,v43
v_lshlrev_b32 v182,16,v39
v_and_b32 v183,s42,v39
v_pk_fma_f32 v[176:177],v[180:181],s[42:43],v[176:177] op_sel:[0,1,0] op_sel_hi:[1,1,1]
v_pk_fma_f32 v[186:187],v[178:179],4.0,v[186:187] op_sel_hi:[1,0,1]
v_pk_fma_f32 v[188:189],v[180:181],-4.0,v[184:185] op_sel_hi:[1,0,1]
v_pk_fma_f32 v[176:177],v[184:185],s[44:45],v[176:177] op_sel:[0,1,0] op_sel_hi:[1,1,1]
v_pk_fma_f32 v[186:187],v[182:183],s[40:41],v[186:187] op_sel:[0,1,0] op_sel_hi:[1,1,1]
v_pk_add_f32 v[184:185],v[184:185],v[180:181] neg_lo:[0,1] neg_hi:[0,1]
v_pk_fma_f32 v[180:181],v[178:179],-4.0,v[182:183] op_sel_hi:[1,0,1]
v_pk_add_f32 v[182:183],v[182:183],v[178:179] neg_lo:[0,1] neg_hi:[0,1]
v_pk_add_f32 v[178:179],v[188:189],v[180:181]
v_pk_add_f32 v[188:189],v[188:189],v[180:181] neg_lo:[0,1] neg_hi:[0,1]
v_pk_fma_f32 v[180:181],v[182:183],2.0,v[184:185] op_sel_hi:[1,0,1]
v_pk_fma_f32 v[184:185],v[182:183],-2.0,v[184:185] op_sel_hi:[1,0,1]
v_cvt_pk_bf16_f32 v27,v176,v177
v_cvt_pk_bf16_f32 v31,v178,v179
v_cvt_pk_bf16_f32 v35,v188,v189
v_cvt_pk_bf16_f32 v39,v180,v181
v_cvt_pk_bf16_f32 v43,v184,v185
v_cvt_pk_bf16_f32 v47,v186,v187
ds_write_b128 v172,v[24:27] offset:512
ds_write_b128 v171,v[28:31] offset:17920
ds_write_b128 v171,v[32:35] offset:26624
ds_write_b128 v171,v[36:39] offset:35328
ds_write_b128 v171,v[40:43] offset:44032
ds_write_b128 v172,v[44:47] offset:9216
s_waitcnt vmcnt(17)
v_lshlrev_b32 v180,16,v56
v_and_b32 v181,s42,v56
s_waitcnt vmcnt(16)
v_lshlrev_b32 v176,16,v48
v_and_b32 v177,s42,v48
s_waitcnt vmcnt(15)
v_lshlrev_b32 v178,16,v52
v_and_b32 v179,s42,v52
s_waitcnt vmcnt(14)
v_lshlrev_b32 v186,16,v68
v_and_b32 v187,s42,v68
s_waitcnt vmcnt(13)
v_lshlrev_b32 v184,16,v64
v_and_b32 v185,s42,v64
s_waitcnt vmcnt(12)
v_lshlrev_b32 v182,16,v60
v_and_b32 v183,s42,v60
v_pk_fma_f32 v[176:177],v[180:181],s[42:43],v[176:177] op_sel:[0,1,0] op_sel_hi:[1,1,1]
v_pk_fma_f32 v[186:187],v[178:179],4.0,v[186:187] op_sel_hi:[1,0,1]
v_pk_fma_f32 v[188:189],v[180:181],-4.0,v[184:185] op_sel_hi:[1,0,1]
v_pk_fma_f32 v[176:177],v[184:185],s[44:45],v[176:177] op_sel:[0,1,0] op_sel_hi:[1,1,1]
v_pk_fma_f32 v[186:187],v[182:183],s[40:41],v[186:187] op_sel:[0,1,0] op_sel_hi:[1,1,1]
v_pk_add_f32 v[184:185],v[184:185],v[180:181] neg_lo:[0,1] neg_hi:[0,1]
v_pk_fma_f32 v[180:181],v[178:179],-4.0,v[182:183] op_sel_hi:[1,0,1]
v_pk_add_f32 v[182:183],v[182:183],v[178:179] neg_lo:[0,1] neg_hi:[0,1]
v_pk_add_f32 v[178:179],v[188:189],v[180:181]
v_pk_add_f32 v[188:189],v[188:189],v[180:181] neg_lo:[0,1] neg_hi:[0,1]
v_pk_fma_f32 v[180:181],v[182:183],2.0,v[184:185] op_sel_hi:[1,0,1]
v_pk_fma_f32 v[184:185],v[182:183],-2.0,v[184:185] op_sel_hi:[1,0,1]
v_cvt_pk_bf16_f32 v48,v176,v177
v_cvt_pk_bf16_f32 v52,v178,v179
v_cvt_pk_bf16_f32 v56,v188,v189
v_cvt_pk_bf16_f32 v60,v180,v181
v_cvt_pk_bf16_f32 v64,v184,v185
v_cvt_pk_bf16_f32 v68,v186,v187
v_lshlrev_b32 v180,16,v57
v_and_b32 v181,s42,v57
v_lshlrev_b32 v176,16,v49
v_and_b32 v177,s42,v49
v_lshlrev_b32 v178,16,v53
v_and_b32 v179,s42,v53
v_lshlrev_b32 v186,16,v69
v_and_b32 v187,s42,v69
v_lshlrev_b32 v184,16,v65
v_and_b32 v185,s42,v65
v_lshlrev_b32 v182,16,v61
v_and_b32 v183,s42,v61
v_pk_fma_f32 v[176:177],v[180:181],s[42:43],v[176:177] op_sel:[0,1,0] op_sel_hi:[1,1,1]
v_pk_fma_f32 v[186:187],v[178:179],4.0,v[186:187] op_sel_hi:[1,0,1]
v_pk_fma_f32 v[188:189],v[180:181],-4.0,v[184:185] op_sel_hi:[1,0,1]
v_pk_fma_f32 v[176:177],v[184:185],s[44:45],v[176:177] op_sel:[0,1,0] op_sel_hi:[1,1,1]
v_pk_fma_f32 v[186:187],v[182:183],s[40:41],v[186:187] op_sel:[0,1,0] op_sel_hi:[1,1,1]
v_pk_add_f32 v[184:185],v[184:185],v[180:181] neg_lo:[0,1] neg_hi:[0,1]
v_pk_fma_f32 v[180:181],v[178:179],-4.0,v[182:183] op_sel_hi:[1,0,1]
v_pk_add_f32 v[182:183],v[182:183],v[178:179] neg_lo:[0,1] neg_hi:[0,1]
v_pk_add_f32 v[178:179],v[188:189],v[180:181]
v_pk_add_f32 v[188:189],v[188:189],v[180:181] neg_lo:[0,1] neg_hi:[0,1]
v_pk_fma_f32 v[180:181],v[182:183],2.0,v[184:185] op_sel_hi:[1,0,1]
v_pk_fma_f32 v[184:185],v[182:183],-2.0,v[184:185] op_sel_hi:[1,0,1]
v_cvt_pk_bf16_f32 v49,v176,v177
v_cvt_pk_bf16_f32 v53,v178,v179
v_cvt_pk_bf16_f32 v57,v188,v189
v_cvt_pk_bf16_f32 v61,v180,v181
v_cvt_pk_bf16_f32 v65,v184,v185
v_cvt_pk_bf16_f32 v69,v186,v187
v_lshlrev_b32 v180,16,v58
v_and_b32 v181,s42,v58
v_lshlrev_b32 v176,16,v50
v_and_b32 v177,s42,v50
v_lshlrev_b32 v178,16,v54
v_and_b32 v179,s42,v54
v_lshlrev_b32 v186,16,v70
v_and_b32 v187,s42,v70
v_lshlrev_b32 v184,16,v66
v_and_b32 v185,s42,v66
v_lshlrev_b32 v182,16,v62
v_and_b32 v183,s42,v62
v_pk_fma_f32 v[176:177],v[180:181],s[42:43],v[176:177] op_sel:[0,1,0] op_sel_hi:[1,1,1]
v_pk_fma_f32 v[186:187],v[178:179],4.0,v[186:187] op_sel_hi:[1,0,1]
v_pk_fma_f32 v[188:189],v[180:181],-4.0,v[184:185] op_sel_hi:[1,0,1]
v_pk_fma_f32 v[176:177],v[184:185],s[44:45],v[176:177] op_sel:[0,1,0] op_sel_hi:[1,1,1]
v_pk_fma_f32 v[186:187],v[182:183],s[40:41],v[186:187] op_sel:[0,1,0] op_sel_hi:[1,1,1]
v_pk_add_f32 v[184:185],v[184:185],v[180:181] neg_lo:[0,1] neg_hi:[0,1]
v_pk_fma_f32 v[180:181],v[178:179],-4.0,v[182:183] op_sel_hi:[1,0,1]
v_pk_add_f32 v[182:183],v[182:183],v[178:179] neg_lo:[0,1] neg_hi:[0,1]
v_pk_add_f32 v[178:179],v[188:189],v[180:181]
v_pk_add_f32 v[188:189],v[188:189],v[180:181] neg_lo:[0,1] neg_hi:[0,1]
v_pk_fma_f32 v[180:181],v[182:183],2.0,v[184:185] op_sel_hi:[1,0,1]
v_pk_fma_f32 v[184:185],v[182:183],-2.0,v[184:185] op_sel_hi:[1,0,1]
v_cvt_pk_bf16_f32 v50,v176,v177
v_cvt_pk_bf16_f32 v54,v178,v179
v_cvt_pk_bf16_f32 v58,v188,v189
v_cvt_pk_bf16_f32 v62,v180,v181
v_cvt_pk_bf16_f32 v66,v184,v185
v_cvt_pk_bf16_f32 v70,v186,v187
v_lshlrev_b32 v180,16,v59
v_and_b32 v181,s42,v59
v_lshlrev_b32 v176,16,v51
v_and_b32 v177,s42,v51
v_lshlrev_b32 v178,16,v55
v_and_b32 v179,s42,v55
v_lshlrev_b32 v186,16,v71
v_and_b32 v187,s42,v71
v_lshlrev_b32 v184,16,v67
v_and_b32 v185,s42,v67
v_lshlrev_b32 v182,16,v63
v_and_b32 v183,s42,v63
v_pk_fma_f32 v[176:177],v[180:181],s[42:43],v[176:177] op_sel:[0,1,0] op_sel_hi:[1,1,1]
v_pk_fma_f32 v[186:187],v[178:179],4.0,v[186:187] op_sel_hi:[1,0,1]
v_pk_fma_f32 v[188:189],v[180:181],-4.0,v[184:185] op_sel_hi:[1,0,1]
v_pk_fma_f32 v[176:177],v[184:185],s[44:45],v[176:177] op_sel:[0,1,0] op_sel_hi:[1,1,1]
v_pk_fma_f32 v[186:187],v[182:183],s[40:41],v[186:187] op_sel:[0,1,0] op_sel_hi:[1,1,1]
v_pk_add_f32 v[184:185],v[184:185],v[180:181] neg_lo:[0,1] neg_hi:[0,1]
v_pk_fma_f32 v[180:181],v[178:179],-4.0,v[182:183] op_sel_hi:[1,0,1]
v_pk_add_f32 v[182:183],v[182:183],v[178:179] neg_lo:[0,1] neg_hi:[0,1]
v_pk_add_f32 v[178:179],v[188:189],v[180:181]
v_pk_add_f32 v[188:189],v[188:189],v[180:181] neg_lo:[0,1] neg_hi:[0,1]
v_pk_fma_f32 v[180:181],v[182:183],2.0,v[184:185] op_sel_hi:[1,0,1]
v_pk_fma_f32 v[184:185],v[182:183],-2.0,v[184:185] op_sel_hi:[1,0,1]
v_cvt_pk_bf16_f32 v51,v176,v177
v_cvt_pk_bf16_f32 v55,v178,v179
v_cvt_pk_bf16_f32 v59,v188,v189
v_cvt_pk_bf16_f32 v63,v180,v181
v_cvt_pk_bf16_f32 v67,v184,v185
v_cvt_pk_bf16_f32 v71,v186,v187
ds_write_b128 v172,v[48:51] offset:1024
ds_write_b128 v171,v[52:55] offset:18432
ds_write_b128 v171,v[56:59] offset:27136
ds_write_b128 v171,v[60:63] offset:35840
ds_write_b128 v171,v[64:67] offset:44544
ds_write_b128 v172,v[68:71] offset:9728
s_waitcnt vmcnt(11)
v_lshlrev_b32 v180,16,v80
v_and_b32 v181,s42,v80
s_waitcnt vmcnt(10)
v_lshlrev_b32 v176,16,v72
v_and_b32 v177,s42,v72
s_waitcnt vmcnt(9)
v_lshlrev_b32 v178,16,v76
v_and_b32 v179,s42,v76
s_waitcnt vmcnt(8)
v_lshlrev_b32 v186,16,v92
v_and_b32 v187,s42,v92
s_waitcnt vmcnt(7)
v_lshlrev_b32 v184,16,v88
v_and_b32 v185,s42,v88
s_waitcnt vmcnt(6)
v_lshlrev_b32 v182,16,v84
v_and_b32 v183,s42,v84
v_pk_fma_f32 v[176:177],v[180:181],s[42:43],v[176:177] op_sel:[0,1,0] op_sel_hi:[1,1,1]
v_pk_fma_f32 v[186:187],v[178:179],4.0,v[186:187] op_sel_hi:[1,0,1]
v_pk_fma_f32 v[188:189],v[180:181],-4.0,v[184:185] op_sel_hi:[1,0,1]
v_pk_fma_f32 v[176:177],v[184:185],s[44:45],v[176:177] op_sel:[0,1,0] op_sel_hi:[1,1,1]
v_pk_fma_f32 v[186:187],v[182:183],s[40:41],v[186:187] op_sel:[0,1,0] op_sel_hi:[1,1,1]
v_pk_add_f32 v[184:185],v[184:185],v[180:181] neg_lo:[0,1] neg_hi:[0,1]
v_pk_fma_f32 v[180:181],v[178:179],-4.0,v[182:183] op_sel_hi:[1,0,1]
v_pk_add_f32 v[182:183],v[182:183],v[178:179] neg_lo:[0,1] neg_hi:[0,1]
v_pk_add_f32 v[178:179],v[188:189],v[180:181]
v_pk_add_f32 v[188:189],v[188:189],v[180:181] neg_lo:[0,1] neg_hi:[0,1]
v_pk_fma_f32 v[180:181],v[182:183],2.0,v[184:185] op_sel_hi:[1,0,1]
v_pk_fma_f32 v[184:185],v[182:183],-2.0,v[184:185] op_sel_hi:[1,0,1]
v_cvt_pk_bf16_f32 v72,v176,v177
v_cvt_pk_bf16_f32 v76,v178,v179
v_cvt_pk_bf16_f32 v80,v188,v189
v_cvt_pk_bf16_f32 v84,v180,v181
v_cvt_pk_bf16_f32 v88,v184,v185
v_cvt_pk_bf16_f32 v92,v186,v187
v_lshlrev_b32 v180,16,v81
v_and_b32 v181,s42,v81
v_lshlrev_b32 v176,16,v73
v_and_b32 v177,s42,v73
v_lshlrev_b32 v178,16,v77
v_and_b32 v179,s42,v77
v_lshlrev_b32 v186,16,v93
v_and_b32 v187,s42,v93
v_lshlrev_b32 v184,16,v89
v_and_b32 v185,s42,v89
v_lshlrev_b32 v182,16,v85
v_and_b32 v183,s42,v85
v_pk_fma_f32 v[176:177],v[180:181],s[42:43],v[176:177] op_sel:[0,1,0] op_sel_hi:[1,1,1]
v_pk_fma_f32 v[186:187],v[178:179],4.0,v[186:187] op_sel_hi:[1,0,1]
v_pk_fma_f32 v[188:189],v[180:181],-4.0,v[184:185] op_sel_hi:[1,0,1]
v_pk_fma_f32 v[176:177],v[184:185],s[44:45],v[176:177] op_sel:[0,1,0] op_sel_hi:[1,1,1]
v_pk_fma_f32 v[186:187],v[182:183],s[40:41],v[186:187] op_sel:[0,1,0] op_sel_hi:[1,1,1]
v_pk_add_f32 v[184:185],v[184:185],v[180:181] neg_lo:[0,1] neg_hi:[0,1]
v_pk_fma_f32 v[180:181],v[178:179],-4.0,v[182:183] op_sel_hi:[1,0,1]
v_pk_add_f32 v[182:183],v[182:183],v[178:179] neg_lo:[0,1] neg_hi:[0,1]
v_pk_add_f32 v[178:179],v[188:189],v[180:181]
v_pk_add_f32 v[188:189],v[188:189],v[180:181] neg_lo:[0,1] neg_hi:[0,1]
v_pk_fma_f32 v[180:181],v[182:183],2.0,v[184:185] op_sel_hi:[1,0,1]
v_pk_fma_f32 v[184:185],v[182:183],-2.0,v[184:185] op_sel_hi:[1,0,1]
v_cvt_pk_bf16_f32 v73,v176,v177
v_cvt_pk_bf16_f32 v77,v178,v179
v_cvt_pk_bf16_f32 v81,v188,v189
v_cvt_pk_bf16_f32 v85,v180,v181
v_cvt_pk_bf16_f32 v89,v184,v185
v_cvt_pk_bf16_f32 v93,v186,v187
v_lshlrev_b32 v180,16,v82
v_and_b32 v181,s42,v82
v_lshlrev_b32 v176,16,v74
v_and_b32 v177,s42,v74
v_lshlrev_b32 v178,16,v78
v_and_b32 v179,s42,v78
v_lshlrev_b32 v186,16,v94
v_and_b32 v187,s42,v94
v_lshlrev_b32 v184,16,v90
v_and_b32 v185,s42,v90
v_lshlrev_b32 v182,16,v86
v_and_b32 v183,s42,v86
v_pk_fma_f32 v[176:177],v[180:181],s[42:43],v[176:177] op_sel:[0,1,0] op_sel_hi:[1,1,1]
v_pk_fma_f32 v[186:187],v[178:179],4.0,v[186:187] op_sel_hi:[1,0,1]
v_pk_fma_f32 v[188:189],v[180:181],-4.0,v[184:185] op_sel_hi:[1,0,1]
v_pk_fma_f32 v[176:177],v[184:185],s[44:45],v[176:177] op_sel:[0,1,0] op_sel_hi:[1,1,1]
v_pk_fma_f32 v[186:187],v[182:183],s[40:41],v[186:187] op_sel:[0,1,0] op_sel_hi:[1,1,1]
v_pk_add_f32 v[184:185],v[184:185],v[180:181] neg_lo:[0,1] neg_hi:[0,1]
v_pk_fma_f32 v[180:181],v[178:179],-4.0,v[182:183] op_sel_hi:[1,0,1]
v_pk_add_f32 v[182:183],v[182:183],v[178:179] neg_lo:[0,1] neg_hi:[0,1]
v_pk_add_f32 v[178:179],v[188:189],v[180:181]
v_pk_add_f32 v[188:189],v[188:189],v[180:181] neg_lo:[0,1] neg_hi:[0,1]
v_pk_fma_f32 v[180:181],v[182:183],2.0,v[184:185] op_sel_hi:[1,0,1]
v_pk_fma_f32 v[184:185],v[182:183],-2.0,v[184:185] op_sel_hi:[1,0,1]
v_cvt_pk_bf16_f32 v74,v176,v177
v_cvt_pk_bf16_f32 v78,v178,v179
v_cvt_pk_bf16_f32 v82,v188,v189
v_cvt_pk_bf16_f32 v86,v180,v181
v_cvt_pk_bf16_f32 v90,v184,v185
v_cvt_pk_bf16_f32 v94,v186,v187
v_lshlrev_b32 v180,16,v83
v_and_b32 v181,s42,v83
v_lshlrev_b32 v176,16,v75
v_and_b32 v177,s42,v75
v_lshlrev_b32 v178,16,v79
v_and_b32 v179,s42,v79
v_lshlrev_b32 v186,16,v95
v_and_b32 v187,s42,v95
v_lshlrev_b32 v184,16,v91
v_and_b32 v185,s42,v91
v_lshlrev_b32 v182,16,v87
v_and_b32 v183,s42,v87
v_pk_fma_f32 v[176:177],v[180:181],s[42:43],v[176:177] op_sel:[0,1,0] op_sel_hi:[1,1,1]
v_pk_fma_f32 v[186:187],v[178:179],4.0,v[186:187] op_sel_hi:[1,0,1]
v_pk_fma_f32 v[188:189],v[180:181],-4.0,v[184:185] op_sel_hi:[1,0,1]
v_pk_fma_f32 v[176:177],v[184:185],s[44:45],v[176:177] op_sel:[0,1,0] op_sel_hi:[1,1,1]
v_pk_fma_f32 v[186:187],v[182:183],s[40:41],v[186:187] op_sel:[0,1,0] op_sel_hi:[1,1,1]
v_pk_add_f32 v[184:185],v[184:185],v[180:181] neg_lo:[0,1] neg_hi:[0,1]
v_pk_fma_f32 v[180:181],v[178:179],-4.0,v[182:183] op_sel_hi:[1,0,1]
v_pk_add_f32 v[182:183],v[182:183],v[178:179] neg_lo:[0,1] neg_hi:[0,1]
v_pk_add_f32 v[178:179],v[188:189],v[180:181]
v_pk_add_f32 v[188:189],v[188:189],v[180:181] neg_lo:[0,1] neg_hi:[0,1]
v_pk_fma_f32 v[180:181],v[182:183],2.0,v[184:185] op_sel_hi:[1,0,1]
v_pk_fma_f32 v[184:185],v[182:183],-2.0,v[184:185] op_sel_hi:[1,0,1]
v_cvt_pk_bf16_f32 v75,v176,v177
v_cvt_pk_bf16_f32 v79,v178,v179
v_cvt_pk_bf16_f32 v83,v188,v189
v_cvt_pk_bf16_f32 v87,v180,v181
v_cvt_pk_bf16_f32 v91,v184,v185
v_cvt_pk_bf16_f32 v95,v186,v187
ds_write_b128 v172,v[72:75] offset:1536
ds_write_b128 v171,v[76:79] offset:18944
ds_write_b128 v171,v[80:83] offset:27648
ds_write_b128 v171,v[84:87] offset:36352
ds_write_b128 v171,v[88:91] offset:45056
ds_write_b128 v172,v[92:95] offset:10240
s_waitcnt vmcnt(3)
v_lshlrev_b32 v180,16,v98
v_and_b32 v181,s42,v98
v_lshlrev_b32 v176,16,v96
v_and_b32 v177,s42,v96
v_lshlrev_b32 v178,16,v97
v_and_b32 v179,s42,v97
s_waitcnt vmcnt(0)
v_lshlrev_b32 v186,16,v101
v_and_b32 v187,s42,v101
v_lshlrev_b32 v184,16,v100
v_and_b32 v185,s42,v100
v_lshlrev_b32 v182,16,v99
v_and_b32 v183,s42,v99
v_pk_fma_f32 v[176:177],v[180:181],s[42:43],v[176:177] op_sel:[0,1,0] op_sel_hi:[1,1,1]
v_pk_fma_f32 v[186:187],v[178:179],4.0,v[186:187] op_sel_hi:[1,0,1]
v_pk_fma_f32 v[188:189],v[180:181],-4.0,v[184:185] op_sel_hi:[1,0,1]
v_pk_fma_f32 v[176:177],v[184:185],s[44:45],v[176:177] op_sel:[0,1,0] op_sel_hi:[1,1,1]
v_pk_fma_f32 v[186:187],v[182:183],s[40:41],v[186:187] op_sel:[0,1,0] op_sel_hi:[1,1,1]
v_pk_add_f32 v[184:185],v[184:185],v[180:181] neg_lo:[0,1] neg_hi:[0,1]
v_pk_fma_f32 v[180:181],v[178:179],-4.0,v[182:183] op_sel_hi:[1,0,1]
v_pk_add_f32 v[182:183],v[182:183],v[178:179] neg_lo:[0,1] neg_hi:[0,1]
v_pk_add_f32 v[178:179],v[188:189],v[180:181]
v_pk_add_f32 v[188:189],v[188:189],v[180:181] neg_lo:[0,1] neg_hi:[0,1]
v_pk_fma_f32 v[180:181],v[182:183],2.0,v[184:185] op_sel_hi:[1,0,1]
v_pk_fma_f32 v[184:185],v[182:183],-2.0,v[184:185] op_sel_hi:[1,0,1]
v_cvt_pk_bf16_f32 v96,v176,v177
v_cvt_pk_bf16_f32 v97,v178,v179
v_cvt_pk_bf16_f32 v98,v188,v189
v_cvt_pk_bf16_f32 v99,v180,v181
v_cvt_pk_bf16_f32 v100,v184,v185
v_cvt_pk_bf16_f32 v101,v186,v187
ds_write_b32 v174,v96 offset:0
ds_write_b32 v173,v97 offset:17408
ds_write_b32 v173,v98 offset:26112
ds_write_b32 v173,v99 offset:34816
ds_write_b32 v173,v100 offset:43520
ds_write_b32 v174,v101 offset:8704
s_waitcnt lgkmcnt(0)
s_barrier
ds_read_b128 a[192:195],v248 offset:17408
ds_read_b128 a[196:199],v249 offset:17408
ds_read_b128 a[200:203],v248 offset:17920
ds_read_b128 a[204:207],v249 offset:17920
v_and_b32 v165,1,v164
v_lshlrev_b32 v165,2,v165
s_mov_b32 s84,0
L_poll:
global_load_dword v166,v165,s[52:53] offset:128 sc1
s_add_u32 s84,s84,1
s_waitcnt vmcnt(0)
v_cmp_eq_u32 vcc,0,v166
s_cmp_gt_u32 s84,0x4000
s_cbranch_scc1 L_fallback
s_cbranch_vccnz L_poll
L_uready:
s_add_u32 s46,s72,9216
buffer_load_dwordx4 a[96:99],v250,s[20:23],s46 offen offset:0 sc1
buffer_load_dwordx4 a[100:103],v250,s[20:23],s46 offen offset:1024 sc1
buffer_load_dwordx4 a[104:107],v250,s[20:23],s46 offen offset:2048 sc1
s_add_u32 s47,s72,12288
buffer_load_dwordx4 a[108:111],v250,s[20:23],s47 offen offset:0 sc1
buffer_load_dwordx4 a[112:115],v250,s[20:23],s47 offen offset:1024 sc1
buffer_load_dwordx4 a[116:119],v250,s[20:23],s47 offen offset:2048 sc1
s_add_u32 s48,s72,15360
buffer_load_dwordx4 a[120:123],v250,s[20:23],s48 offen offset:0 sc1
buffer_load_dwordx4 a[124:127],v250,s[20:23],s48 offen offset:1024 sc1
buffer_load_dwordx4 a[128:131],v250,s[20:23],s48 offen offset:2048 sc1
s_lshr_b32 s85,s2,3
s_mul_i32 s85,s85,1152
s_add_u32 s85,s85,9216
s_mov_b32 s88,s12
s_mov_b32 s89,s13
s_mov_b32 s90,100860288
s_mov_b32 s91,0x20000
s_cmp_eq_u32 s49,0
s_cselect_b32 s86,15,0
s_mov_b32 s87,s86
s_getpc_b64 s[62:63]
L_pc2:
s_sub_u32 s62,s62,L_pc2-L_pc
s_subb_u32 s63,s63,0
s_lshr_b32 s61,s2,3
s_waitcnt vmcnt(8) lgkmcnt(3)
M a[0:3],a[96:99],a[192:195],0
s_waitcnt vmcnt(7) lgkmcnt(2)
s_add_u32 s46,s72,18432
buffer_load_dwordx4 a[132:135],v250,s[20:23],s46 offen offset:0 sc1
M a[0:3],a[100:103],a[196:199],a[0:3]
s_waitcnt vmcnt(7) lgkmcnt(1)
ds_read_b128 a[208:211],v248 offset:18432
ds_read_b128 a[212:215],v249 offset:18432
M a[0:3],a[104:107],a[200:203],a[0:3]
s_waitcnt lgkmcnt(2)
buffer_load_dwordx4 a[136:139],v250,s[20:23],s46 offen offset:1024 sc1
M a[4:7],a[104:107],a[204:207],0
M a[4:7],a[100:103],a[200:203],a[4:7]
M a[4:7],a[96:99],a[196:199],a[4:7]
M a[8:11],a[96:99],a[200:203],0
buffer_load_dwordx4 a[140:143],v250,s[20:23],s46 offen offset:2048 sc1
M a[8:11],a[100:103],a[204:207],a[8:11]
s_waitcnt lgkmcnt(1)
s_add_u32 s47,s72,21504
ds_read_b128 a[216:219],v248 offset:18944
ds_read_b128 a[220:223],v249 offset:18944
M a[8:11],a[104:107],a[208:211],a[8:11]
s_waitcnt lgkmcnt(2)
M a[12:15],a[104:107],a[212:215],0
M a[12:15],a[100:103],a[208:211],a[12:15]
buffer_load_dwordx4 a[164:167],v250,s[20:23],s47 offen offset:0 sc1
M a[12:15],a[96:99],a[204:207],a[12:15]
M a[16:19],a[96:99],a[208:211],0
ds_read_b128 a[224:227],v249 offset:19456
M a[16:19],a[100:103],a[212:215],a[16:19]
s_waitcnt lgkmcnt(2)
ds_read_b128 a[228:231],v248 offset:19456
M a[16:19],a[104:107],a[216:219],a[16:19]
s_waitcnt lgkmcnt(2)
buffer_load_dwordx4 a[160:163],v250,s[20:23],s47 offen offset:1024 sc1
M a[20:23],a[104:107],a[220:223],0
M a[20:23],a[100:103],a[216:219],a[20:23]
M a[20:23],a[96:99],a[212:215],a[20:23]
M a[24:27],a[96:99],a[216:219],0
buffer_load_dwordx4 a[168:171],v250,s[20:23],s47 offen offset:2048 sc1
M a[24:27],a[100:103],a[220:223],a[24:27]
s_waitcnt lgkmcnt(1)
s_add_u32 s48,s72,24576
M a[24:27],a[104:107],a[224:227],a[24:27]
s_waitcnt lgkmcnt(0)
M a[28:31],a[104:107],a[228:231],0
M a[28:31],a[100:103],a[224:227],a[28:31]
buffer_load_dwordx4 v[4:7],v250,s[20:23],s48 offen offset:0 sc1
M a[28:31],a[96:99],a[220:223],a[28:31]
s_waitcnt vmcnt(12)
M a[32:35],a[108:111],a[192:195],0
s_waitcnt vmcnt(11)
M a[32:35],a[112:115],a[196:199],a[32:35]
s_waitcnt vmcnt(10)
M a[32:35],a[116:119],a[200:203],a[32:35]
buffer_load_dwordx4 v[0:3],v250,s[20:23],s48 offen offset:1024 sc1
M a[36:39],a[116:119],a[204:207],0
M a[36:39],a[112:115],a[200:203],a[36:39]
M a[36:39],a[108:111],a[196:199],a[36:39]
M a[40:43],a[108:111],a[200:203],0
buffer_load_dwordx4 v[8:11],v250,s[20:23],s48 offen offset:2048 sc1
M a[40:43],a[112:115],a[204:207],a[40:43]
s_add_u32 s46,s72,27648
M a[40:43],a[116:119],a[208:211],a[40:43]
M a[44:47],a[116:119],a[212:215],0
M a[44:47],a[112:115],a[208:211],a[44:47]
buffer_load_dwordx4 v[36:39],v250,s[20:23],s46 offen offset:0 sc1
M a[44:47],a[108:111],a[204:207],a[44:47]
s_add_u32 s31,s73,s85
M a[48:51],a[108:111],a[208:211],0
M a[48:51],a[112:115],a[212:215],a[48:51]
M a[48:51],a[116:119],a[216:219],a[48:51]
buffer_load_dword v32,v250,s[20:23],s31 offen offset:0 sc1
M a[52:55],a[116:119],a[220:223],0
M a[52:55],a[112:115],a[216:219],a[52:55]
M a[52:55],a[108:111],a[212:215],a[52:55]
M a[56:59],a[108:111],a[216:219],0
buffer_load_dword v32,v250,s[20:23],s31 offen offset:128 sc1
M a[56:59],a[112:115],a[220:223],a[56:59]
M a[56:59],a[116:119],a[224:227],a[56:59]
M a[60:63],a[116:119],a[228:231],0
M a[60:63],a[112:115],a[224:227],a[60:63]
buffer_load_dwordx4 v[32:35],v250,s[20:23],s46 offen offset:1024 sc1
M a[60:63],a[108:111],a[220:223],a[60:63]
s_waitcnt vmcnt(15)
M a[64:67],a[120:123],a[192:195],0
s_waitcnt vmcnt(14)
M a[64:67],a[124:127],a[196:199],a[64:67]
s_waitcnt vmcnt(13)
M a[64:67],a[128:131],a[200:203],a[64:67]
buffer_load_dwordx4 v[40:43],v250,s[20:23],s46 offen offset:2048 sc1
M a[68:71],a[128:131],a[204:207],0
s_add_u32 s47,s72,30720
M a[68:71],a[124:127],a[200:203],a[68:71]
M a[68:71],a[120:123],a[196:199],a[68:71]
M a[72:75],a[120:123],a[200:203],0
buffer_load_dwordx4 v[68:71],v250,s[20:23],s47 offen offset:0 sc1
M a[72:75],a[124:127],a[204:207],a[72:75]
M a[72:75],a[128:131],a[208:211],a[72:75]
M a[76:79],a[128:131],a[212:215],0
M a[76:79],a[124:127],a[208:211],a[76:79]
buffer_load_dwordx4 v[64:67],v250,s[20:23],s47 offen offset:1024 sc1
M a[76:79],a[120:123],a[204:207],a[76:79]
M a[80:83],a[120:123],a[208:211],0
M a[80:83],a[124:127],a[212:215],a[80:83]
M a[80:83],a[128:131],a[216:219],a[80:83]
buffer_load_dwordx4 v[72:75],v250,s[20:23],s47 offen offset:2048 sc1
M a[84:87],a[128:131],a[220:223],0
s_add_u32 s48,s72,33792
M a[84:87],a[124:127],a[216:219],a[84:87]
ds_read_b128 a[232:235],v248 offset:26112
M a[84:87],a[120:123],a[212:215],a[84:87]
ds_read_b128 a[236:239],v249 offset:26112
M a[88:91],a[120:123],a[216:219],0
buffer_load_dwordx4 v[100:103],v250,s[20:23],s48 offen offset:0 sc1
M a[88:91],a[124:127],a[220:223],a[88:91]
ds_read_b128 a[240:243],v248 offset:26624
ds_read_b128 a[244:247],v249 offset:26624
M a[88:91],a[128:131],a[224:227],a[88:91]
M a[92:95],a[128:131],a[228:231],0
M a[92:95],a[124:127],a[224:227],a[92:95]
s_add_u32 s28,s68,0
buffer_load_dwordx4 v[96:99],v250,s[20:23],s48 offen offset:1024 sc1
M a[92:95],a[120:123],a[220:223],a[92:95]
s_waitcnt vmcnt(18) lgkmcnt(3)
s_mov_b64 exec,s[86:87]
v_xor_b32 v245,0x80000000,v245
v_xor_b32 v251,0x80000000,v251
s_mov_b64 exec,-1
M a[96:99],a[132:135],a[232:235],0
s_waitcnt vmcnt(17) lgkmcnt(2)
ds_read_b128 a[248:251],v248 offset:27136
M a[96:99],a[136:139],a[236:239],a[96:99]
s_waitcnt vmcnt(16) lgkmcnt(2)
ds_read_b128 a[252:255],v249 offset:27136
M a[96:99],a[140:143],a[240:243],a[96:99]
s_waitcnt lgkmcnt(2)
buffer_load_dwordx4 v[104:107],v250,s[20:23],s48 offen offset:2048 sc1
M a[100:103],a[140:143],a[244:247],0
s_add_u32 s46,s72,36864
M a[100:103],a[136:139],a[240:243],a[100:103]
M a[100:103],a[132:135],a[236:239],a[100:103]
M a[104:107],a[132:135],a[240:243],0
buffer_load_dwordx4 v[132:135],v250,s[20:23],s46 offen offset:0 sc1
M a[104:107],a[136:139],a[244:247],a[104:107]
s_waitcnt lgkmcnt(1)
ds_read_b128 v[216:219],v248 offset:27648
ds_read_b128 v[220:223],v249 offset:27648
M a[104:107],a[140:143],a[248:251],a[104:107]
s_waitcnt lgkmcnt(2)
M a[108:111],a[140:143],a[252:255],0
M a[108:111],a[136:139],a[248:251],a[108:111]
buffer_load_dwordx4 v[128:131],v250,s[20:23],s46 offen offset:1024 sc1
M a[108:111],a[132:135],a[244:247],a[108:111]
M a[112:115],a[132:135],a[248:251],0
ds_read_b128 v[224:227],v249 offset:28160
M a[112:115],a[136:139],a[252:255],a[112:115]
s_waitcnt lgkmcnt(2)
ds_read_b128 v[228:231],v248 offset:28160
M a[112:115],a[140:143],v[216:219],a[112:115]
s_waitcnt lgkmcnt(2)
buffer_load_dwordx4 v[136:139],v250,s[20:23],s46 offen offset:2048 sc1
M a[116:119],a[140:143],v[220:223],0
M a[116:119],a[136:139],v[216:219],a[116:119]
M a[116:119],a[132:135],a[252:255],a[116:119]
M a[120:123],a[132:135],v[216:219],0
buffer_load_dwordx4 v[192:195],v251,s[88:91],s28 offen offset:0
M a[120:123],a[136:139],v[220:223],a[120:123]
s_waitcnt lgkmcnt(1)
M a[120:123],a[140:143],v[224:227],a[120:123]
s_waitcnt lgkmcnt(0)
M a[124:127],a[140:143],v[228:231],0
M a[124:127],a[136:139],v[224:227],a[124:127]
buffer_load_dwordx4 v[196:199],v245,s[8:11],s28 offen offset:0
M a[124:127],a[132:135],v[220:223],a[124:127]
s_waitcnt vmcnt(21)
M a[128:131],a[164:167],a[232:235],0
s_waitcnt vmcnt(20)
M a[128:131],a[160:163],a[236:239],a[128:131]
s_waitcnt vmcnt(19)
M a[128:131],a[168:171],a[240:243],a[128:131]
buffer_load_dwordx4 v[200:203],v245,s[8:11],s28 offen offset:768
M a[132:135],a[168:171],a[244:247],0
s_mov_b64 exec,s[86:87]
v_xor_b32 v245,0x80000000,v245
v_xor_b32 v251,0x80000000,v251
s_mov_b64 exec,-1
M a[132:135],a[160:163],a[240:243],a[132:135]
M a[132:135],a[164:167],a[236:239],a[132:135]
M a[136:139],a[164:167],a[240:243],0
M a[136:139],a[160:163],a[244:247],a[136:139]
M a[136:139],a[168:171],a[248:251],a[136:139]
M a[140:143],a[168:171],a[252:255],0
M a[140:143],a[160:163],a[248:251],a[140:143]
M a[140:143],a[164:167],a[244:247],a[140:143]
M a[144:147],a[164:167],a[248:251],0
M a[144:147],a[160:163],a[252:255],a[144:147]
M a[144:147],a[168:171],v[216:219],a[144:147]
M a[148:151],a[168:171],v[220:223],0
M a[148:151],a[160:163],v[216:219],a[148:151]
M a[148:151],a[164:167],a[252:255],a[148:151]
M a[152:155],a[164:167],v[216:219],0
M a[152:155],a[160:163],v[220:223],a[152:155]
M a[152:155],a[168:171],v[224:227],a[152:155]
M a[156:159],a[168:171],v[228:231],0
M a[156:159],a[160:163],v[224:227],a[156:159]
s_add_u32 s47,s72,39936
M a[156:159],a[164:167],v[220:223],a[156:159]
s_waitcnt vmcnt(19)
M a[160:163],v[4:7],a[232:235],0
s_waitcnt vmcnt(18)
M a[160:163],v[0:3],a[236:239],a[160:163]
s_waitcnt vmcnt(17)
M a[160:163],v[8:11],a[240:243],a[160:163]
M a[164:167],v[8:11],a[244:247],0
M a[164:167],v[0:3],a[240:243],a[164:167]
buffer_load_dwordx4 v[164:167],v250,s[20:23],s47 offen offset:0 sc1
M a[164:167],v[4:7],a[236:239],a[164:167]
M a[168:171],v[4:7],a[240:243],0
buffer_load_dwordx4 v[160:163],v250,s[20:23],s47 offen offset:1024 sc1
M a[168:171],v[0:3],a[244:247],a[168:171]
M a[168:171],v[8:11],a[248:251],a[168:171]
M a[172:175],v[8:11],a[252:255],0
M a[172:175],v[0:3],a[248:251],a[172:175]
buffer_load_dwordx4 v[168:171],v250,s[20:23],s47 offen offset:2048 sc1
M a[172:175],v[4:7],a[244:247],a[172:175]
s_add_u32 s48,s72,43008
M a[176:179],v[4:7],a[248:251],0
M a[176:179],v[0:3],a[252:255],a[176:179]
M a[176:179],v[8:11],v[216:219],a[176:179]
buffer_load_dwordx4 a[192:195],v250,s[20:23],s48 offen offset:0 sc1
M a[180:183],v[8:11],v[220:223],0
M a[180:183],v[0:3],v[216:219],a[180:183]
ds_read_b128 a[204:207],v248 offset:34816
M a[180:183],v[4:7],a[252:255],a[180:183]
ds_read_b128 a[208:211],v249 offset:34816
M a[184:187],v[4:7],v[216:219],0
buffer_load_dwordx4 a[196:199],v250,s[20:23],s48 offen offset:1024 sc1
M a[184:187],v[0:3],v[220:223],a[184:187]
ds_read_b128 a[216:219],v248 offset:35328
ds_read_b128 a[228:231],v249 offset:35328
M a[184:187],v[8:11],v[224:227],a[184:187]
M a[188:191],v[8:11],v[228:231],0
M a[188:191],v[0:3],v[224:227],a[188:191]
buffer_load_dwordx4 a[200:203],v250,s[20:23],s48 offen offset:2048 sc1
M a[188:191],v[4:7],v[220:223],a[188:191]
s_waitcnt vmcnt(22) lgkmcnt(3)
s_add_u32 s46,s73,9216
M v[0:3],v[36:39],a[204:207],0
s_waitcnt vmcnt(19) lgkmcnt(2)
ds_read_b128 a[224:227],v248 offset:35840
M v[0:3],v[32:35],a[208:211],v[0:3]
s_waitcnt vmcnt(18) lgkmcnt(2)
ds_read_b128 a[220:223],v249 offset:35840
M v[0:3],v[40:43],a[216:219],v[0:3]
s_waitcnt lgkmcnt(2)
buffer_load_dwordx4 a[212:215],v250,s[20:23],s46 offen offset:0 sc1
M v[4:7],v[40:43],a[228:231],0
M v[4:7],v[32:35],a[216:219],v[4:7]
M v[4:7],v[36:39],a[208:211],v[4:7]
M v[8:11],v[36:39],a[216:219],0
ds_read_b128 a[232:235],v248 offset:36352
M v[8:11],v[32:35],a[228:231],v[8:11]
s_waitcnt lgkmcnt(2)
ds_read_b128 a[236:239],v249 offset:36352
M v[8:11],v[40:43],a[224:227],v[8:11]
s_waitcnt lgkmcnt(2)
M v[12:15],v[40:43],a[220:223],0
M v[12:15],v[32:35],a[224:227],v[12:15]
M v[12:15],v[36:39],a[228:231],v[12:15]
s_add_u32 s28,s68,393216
buffer_load_dwordx4 v[204:207],v251,s[88:91],s28 offen offset:0
M v[16:19],v[36:39],a[224:227],0
ds_read_b128 a[240:243],v249 offset:36864
M v[16:19],v[32:35],a[220:223],v[16:19]
s_waitcnt lgkmcnt(2)
buffer_load_dwordx4 v[208:211],v245,s[8:11],s28 offen offset:0
M v[16:19],v[40:43],a[232:235],v[16:19]
s_waitcnt lgkmcnt(1)
ds_read_b128 a[244:247],v248 offset:36864
M v[20:23],v[40:43],a[236:239],0
M v[20:23],v[32:35],a[232:235],v[20:23]
M v[20:23],v[36:39],a[220:223],v[20:23]
buffer_load_dwordx4 v[212:215],v245,s[8:11],s28 offen offset:768
M v[24:27],v[36:39],a[232:235],0
s_add_u32 s29,s68,0
M v[24:27],v[32:35],a[236:239],v[24:27]
s_waitcnt lgkmcnt(1)
M v[24:27],v[40:43],a[240:243],v[24:27]
s_waitcnt lgkmcnt(0)
M v[28:31],v[40:43],a[244:247],0
buffer_load_short_d16_hi v239,v246,s[12:15],s29 offen offset:0
M v[28:31],v[32:35],a[240:243],v[28:31]
M v[28:31],v[36:39],a[236:239],v[28:31]
s_waitcnt vmcnt(22)
buffer_load_short_d16_hi v240,v246,s[8:11],s29 offen offset:0
M v[32:35],v[68:71],a[204:207],0
s_waitcnt vmcnt(22)
M v[32:35],v[64:67],a[208:211],v[32:35]
s_waitcnt vmcnt(21)
buffer_load_short_d16_hi v241,v246,s[8:11],s29 offen offset:384
M v[32:35],v[72:75],a[216:219],v[32:35]
M v[36:39],v[72:75],a[228:231],0
buffer_load_short_d16_hi v242,v246,s[8:11],s29 offen offset:768
M v[36:39],v[64:67],a[216:219],v[36:39]
M v[36:39],v[68:71],a[208:211],v[36:39]
buffer_load_short_d16_hi v243,v246,s[8:11],s29 offen offset:1152
M v[40:43],v[68:71],a[216:219],0
M v[40:43],v[64:67],a[228:231],v[40:43]
buffer_load_short_d16_hi v244,v246,s[16:19],s29 offen offset:1536
M v[40:43],v[72:75],a[224:227],v[40:43]
M v[44:47],v[72:75],a[220:223],0
M v[44:47],v[64:67],a[224:227],v[44:47]
M v[44:47],v[68:71],a[228:231],v[44:47]
M v[48:51],v[68:71],a[224:227],0
M v[48:51],v[64:67],a[220:223],v[48:51]
M v[48:51],v[72:75],a[232:235],v[48:51]
M v[52:55],v[72:75],a[236:239],0
M v[52:55],v[64:67],a[232:235],v[52:55]
M v[52:55],v[68:71],a[220:223],v[52:55]
M v[56:59],v[68:71],a[232:235],0
M v[56:59],v[64:67],a[236:239],v[56:59]
M v[56:59],v[72:75],a[240:243],v[56:59]
M v[60:63],v[72:75],a[244:247],0
M v[60:63],v[64:67],a[240:243],v[60:63]
M v[60:63],v[68:71],a[236:239],v[60:63]
s_waitcnt vmcnt(24)
M v[64:67],v[100:103],a[204:207],0
s_waitcnt vmcnt(23)
M v[64:67],v[96:99],a[208:211],v[64:67]
s_waitcnt vmcnt(22)
M v[64:67],v[104:107],a[216:219],v[64:67]
M v[68:71],v[104:107],a[228:231],0
M v[68:71],v[96:99],a[216:219],v[68:71]
M v[68:71],v[100:103],a[208:211],v[68:71]
M v[72:75],v[100:103],a[216:219],0
M v[72:75],v[96:99],a[228:231],v[72:75]
M v[72:75],v[104:107],a[224:227],v[72:75]
M v[76:79],v[104:107],a[220:223],0
M v[76:79],v[96:99],a[224:227],v[76:79]
M v[76:79],v[100:103],a[228:231],v[76:79]
M v[80:83],v[100:103],a[224:227],0
M v[80:83],v[96:99],a[220:223],v[80:83]
M v[80:83],v[104:107],a[232:235],v[80:83]
M v[84:87],v[104:107],a[236:239],0
M v[84:87],v[96:99],a[232:235],v[84:87]
ds_read_b128 a[248:251],v248 offset:43520
M v[84:87],v[100:103],a[220:223],v[84:87]
ds_read_b128 a[252:255],v249 offset:43520
M v[88:91],v[100:103],a[232:235],0
ds_read_b128 v[216:219],v248 offset:44032
M v[88:91],v[96:99],a[236:239],v[88:91]
ds_read_b128 v[228:231],v249 offset:44032
M v[88:91],v[104:107],a[240:243],v[88:91]
M v[92:95],v[104:107],a[244:247],0
M v[92:95],v[96:99],a[240:243],v[92:95]
M v[92:95],v[100:103],a[236:239],v[92:95]
s_waitcnt vmcnt(21) lgkmcnt(3)
M v[96:99],v[132:135],a[248:251],0
s_waitcnt vmcnt(20) lgkmcnt(2)
ds_read_b128 v[224:227],v248 offset:44544
M v[96:99],v[128:131],a[252:255],v[96:99]
s_waitcnt vmcnt(19) lgkmcnt(2)
ds_read_b128 v[220:223],v249 offset:44544
M v[96:99],v[136:139],v[216:219],v[96:99]
s_waitcnt lgkmcnt(2)
M v[100:103],v[136:139],v[228:231],0
M v[100:103],v[128:131],v[216:219],v[100:103]
M v[100:103],v[132:135],a[252:255],v[100:103]
M v[104:107],v[132:135],v[216:219],0
ds_read_b128 a[204:207],v248 offset:45056
M v[104:107],v[128:131],v[228:231],v[104:107]
s_waitcnt lgkmcnt(2)
ds_read_b128 a[208:211],v249 offset:45056
M v[104:107],v[136:139],v[224:227],v[104:107]
s_waitcnt lgkmcnt(2)
M v[108:111],v[136:139],v[220:223],0
s_waitcnt vmcnt(17)
v_permlane32_swap_b32 v196,v198
v_permlane32_swap_b32 v192,v194
M v[108:111],v[128:131],v[224:227],v[108:111]
s_waitcnt vmcnt(16)
v_permlane32_swap_b32 v200,v202
v_lshlrev_b32 v234,16,v198
M v[108:111],v[132:135],v[228:231],v[108:111]
v_lshlrev_b32 v232,16,v192
v_lshlrev_b32 v233,16,v196
M v[112:115],v[132:135],v[224:227],0
ds_read_b128 a[216:219],v249 offset:45568
v_lshlrev_b32 v237,16,v194
M v[112:115],v[128:131],v[220:223],v[112:115]
s_waitcnt lgkmcnt(2)
ds_read_b128 a[228:231],v248 offset:45568
v_lshlrev_b32 v236,16,v202
M v[112:115],v[136:139],a[204:207],v[112:115]
s_waitcnt lgkmcnt(2)
v_lshlrev_b32 v235,16,v200
v_fmac_f32 v232,s43,v234
M v[116:119],v[136:139],a[208:211],0
v_fmac_f32 v237,4.0,v233
v_fma_f32 v238,-4.0,v234,v236
M v[116:119],v[128:131],a[204:207],v[116:119]
v_fmac_f32 v232,s45,v236
v_fmac_f32 v237,s41,v235
M v[116:119],v[132:135],v[220:223],v[116:119]
v_sub_f32 v236,v236,v234
v_fma_f32 v234,-4.0,v233,v235
M v[120:123],v[132:135],a[204:207],0
v_sub_f32 v235,v235,v233
v_add_f32 v233,v238,v234
M v[120:123],v[128:131],a[208:211],v[120:123]
s_waitcnt lgkmcnt(1)
v_sub_f32 v238,v238,v234
v_fma_f32 v234,2.0,v235,v236
M v[120:123],v[136:139],a[216:219],v[120:123]
s_waitcnt lgkmcnt(0)
v_fmac_f32 v236,-2.0,v235
v_and_b32 v198,s42,v198
M v[124:127],v[136:139],a[228:231],0
buffer_load_dwordx4 a[224:227],v250,s[20:23],s46 offen offset:1024 sc1
M v[124:127],v[128:131],a[216:219],v[124:127]
v_and_b32 v192,s42,v192
v_and_b32 v196,s42,v196
M v[124:127],v[132:135],a[208:211],v[124:127]
s_waitcnt vmcnt(16)
buffer_load_dwordx4 a[220:223],v250,s[20:23],s46 offen offset:2048 sc1
M v[128:131],v[164:167],a[248:251],0
s_waitcnt vmcnt(16)
s_add_u32 s47,s73,12288
v_and_b32 v194,s42,v194
v_and_b32 v202,s42,v202
M v[128:131],v[160:163],a[252:255],v[128:131]
s_waitcnt vmcnt(15)
v_and_b32 v200,s42,v200
v_fmac_f32 v192,s43,v198
M v[128:131],v[168:171],v[216:219],v[128:131]
v_fmac_f32 v194,4.0,v196
v_fma_f32 v235,-4.0,v198,v202
M v[132:135],v[168:171],v[228:231],0
buffer_load_dwordx4 a[232:235],v250,s[20:23],s47 offen offset:0 sc1
M v[132:135],v[160:163],v[216:219],v[132:135]
v_fmac_f32 v192,s45,v202
v_fmac_f32 v194,s41,v200
M v[132:135],v[164:167],a[252:255],v[132:135]
v_sub_f32 v202,v202,v198
v_fma_f32 v198,-4.0,v196,v200
M v[136:139],v[164:167],v[216:219],0
v_sub_f32 v200,v200,v196
v_add_f32 v196,v235,v198
M v[136:139],v[160:163],v[228:231],v[136:139]
v_sub_f32 v235,v235,v198
v_fma_f32 v198,2.0,v200,v202
M v[136:139],v[168:171],v[224:227],v[136:139]
v_fmac_f32 v202,-2.0,v200
v_cvt_pk_bf16_f32 v192,v232,v192
M v[140:143],v[168:171],v[220:223],0
v_cvt_pk_bf16_f32 v194,v237,v194
v_cvt_pk_bf16_f32 v196,v233,v196
M v[140:143],v[160:163],v[224:227],v[140:143]
v_cvt_pk_bf16_f32 v200,v234,v198
v_cvt_pk_bf16_f32 v198,v238,v235
M v[140:143],v[164:167],v[228:231],v[140:143]
v_cvt_pk_bf16_f32 v202,v236,v202
v_permlane32_swap_b32 v197,v199
M v[144:147],v[164:167],v[224:227],0
v_permlane32_swap_b32 v193,v195
v_permlane32_swap_b32 v201,v203
M v[144:147],v[160:163],v[220:223],v[144:147]
v_lshlrev_b32 v234,16,v199
v_lshlrev_b32 v232,16,v193
M v[144:147],v[168:171],a[204:207],v[144:147]
v_lshlrev_b32 v233,16,v197
v_lshlrev_b32 v237,16,v195
M v[148:151],v[168:171],a[208:211],0
v_lshlrev_b32 v236,16,v203
v_lshlrev_b32 v235,16,v201
M v[148:151],v[160:163],a[204:207],v[148:151]
v_fmac_f32 v232,s43,v234
v_fmac_f32 v237,4.0,v233
M v[148:151],v[164:167],v[220:223],v[148:151]
v_fma_f32 v238,-4.0,v234,v236
v_fmac_f32 v232,s45,v236
M v[152:155],v[164:167],a[204:207],0
v_fmac_f32 v237,s41,v235
v_sub_f32 v236,v236,v234
M v[152:155],v[160:163],a[208:211],v[152:155]
v_fma_f32 v234,-4.0,v233,v235
v_sub_f32 v235,v235,v233
M v[152:155],v[168:171],a[216:219],v[152:155]
v_add_f32 v233,v238,v234
v_sub_f32 v238,v238,v234
M v[156:159],v[168:171],a[228:231],0
buffer_load_dwordx4 a[244:247],v250,s[20:23],s47 offen offset:1024 sc1
M v[156:159],v[160:163],a[216:219],v[156:159]
v_fma_f32 v234,2.0,v235,v236
v_fmac_f32 v236,-2.0,v235
M v[156:159],v[164:167],a[208:211],v[156:159]
s_waitcnt vmcnt(16)
buffer_load_dwordx4 a[240:243],v250,s[20:23],s47 offen offset:2048 sc1
M v[160:163],a[192:195],a[248:251],0
s_waitcnt vmcnt(16)
s_add_u32 s48,s73,15360
v_and_b32 v199,s42,v199
v_and_b32 v193,s42,v193
M v[160:163],a[196:199],a[252:255],v[160:163]
s_waitcnt vmcnt(15)
v_and_b32 v197,s42,v197
v_and_b32 v195,s42,v195
M v[160:163],a[200:203],v[216:219],v[160:163]
v_and_b32 v203,s42,v203
v_and_b32 v201,s42,v201
M v[164:167],a[200:203],v[228:231],0
buffer_load_dwordx4 a[236:239],v250,s[20:23],s48 offen offset:0 sc1
M v[164:167],a[196:199],v[216:219],v[164:167]
v_fmac_f32 v193,s43,v199
v_fmac_f32 v195,4.0,v197
M v[164:167],a[192:195],a[252:255],v[164:167]
v_fma_f32 v235,-4.0,v199,v203
v_fmac_f32 v193,s45,v203
M v[168:171],a[192:195],v[216:219],0
v_fmac_f32 v195,s41,v201
v_sub_f32 v203,v203,v199
M v[168:171],a[196:199],v[228:231],v[168:171]
buffer_load_dwordx4 a[248:251],v250,s[20:23],s48 offen offset:1024 sc1
M v[168:171],a[200:203],v[224:227],v[168:171]
v_fma_f32 v199,-4.0,v197,v201
v_sub_f32 v201,v201,v197
M v[172:175],a[200:203],v[220:223],0
v_add_f32 v197,v235,v199
v_sub_f32 v235,v235,v199
M v[172:175],a[196:199],v[224:227],v[172:175]
v_fma_f32 v199,2.0,v201,v203
v_fmac_f32 v203,-2.0,v201
M v[172:175],a[192:195],v[228:231],v[172:175]
buffer_load_dwordx4 a[252:255],v250,s[20:23],s48 offen offset:2048 sc1
M v[176:179],a[192:195],v[224:227],0
s_add_u32 s46,s73,18432
v_cvt_pk_bf16_f32 v193,v232,v193
v_cvt_pk_bf16_f32 v195,v237,v195
M v[176:179],a[196:199],v[220:223],v[176:179]
v_cvt_pk_bf16_f32 v197,v233,v197
v_cvt_pk_bf16_f32 v201,v234,v199
M v[176:179],a[200:203],a[204:207],v[176:179]
s_barrier
v_cvt_pk_bf16_f32 v199,v238,v235
M v[180:183],a[200:203],a[208:211],0
buffer_load_dwordx4 v[216:219],v250,s[20:23],s46 offen offset:0 sc1
M v[180:183],a[196:199],a[204:207],v[180:183]
ds_read_b128 v[228:231],v248 offset:52224
v_cvt_pk_bf16_f32 v203,v236,v203
M v[180:183],a[192:195],v[220:223],v[180:183]
ds_write2st64_b64 v247,v[192:193],v[194:195] offset0:204 offset1:221
M v[184:187],a[192:195],a[204:207],0
s_add_u32 s28,s68,786432
ds_read_b128 v[224:227],v249 offset:52224
ds_read_b128 v[220:223],v248 offset:52736
M v[184:187],a[196:199],a[208:211],v[184:187]
buffer_load_dwordx4 v[192:195],v251,s[88:91],s28 offen offset:0
M v[184:187],a[200:203],a[216:219],v[184:187]
ds_write2st64_b64 v247,v[196:197],v[198:199] offset0:34 offset1:51
M v[188:191],a[200:203],a[228:231],0
s_waitcnt vmcnt(17)
ds_read_b128 a[204:207],v249 offset:52736
v_permlane32_swap_b32 v208,v210
M v[188:191],a[196:199],a[216:219],v[188:191]
buffer_load_dwordx4 v[196:199],v245,s[8:11],s28 offen offset:0
M v[188:191],a[192:195],a[208:211],v[188:191]
s_waitcnt lgkmcnt(5)
ds_write2st64_b64 v247,v[200:201],v[202:203] offset0:68 offset1:85
M a[0:3],a[212:215],v[228:231],a[0:3]
s_waitcnt vmcnt(10) lgkmcnt(4)
ds_read_b128 a[200:203],v248 offset:53248
v_permlane32_swap_b32 v204,v206
M a[0:3],a[224:227],v[224:227],a[0:3]
s_waitcnt vmcnt(9) lgkmcnt(4)
buffer_load_dwordx4 v[200:203],v245,s[8:11],s28 offen offset:768
M a[0:3],a[220:223],v[220:223],a[0:3]
s_waitcnt lgkmcnt(2)
ds_read_b128 a[228:231],v249 offset:53248
v_permlane32_swap_b32 v212,v214
M a[4:7],a[220:223],a[204:207],a[4:7]
v_lshlrev_b32 v234,16,v210
v_lshlrev_b32 v232,16,v204
M a[4:7],a[224:227],v[220:223],a[4:7]
v_lshlrev_b32 v233,16,v208
v_lshlrev_b32 v237,16,v206
M a[4:7],a[212:215],v[224:227],a[4:7]
v_lshlrev_b32 v236,16,v214
v_lshlrev_b32 v235,16,v212
M a[8:11],a[212:215],v[220:223],a[8:11]
ds_read_b128 a[196:199],v248 offset:53760
v_fmac_f32 v232,s43,v234
M a[8:11],a[224:227],a[204:207],a[8:11]
s_waitcnt lgkmcnt(2)
ds_read_b128 a[216:219],v249 offset:53760
v_fmac_f32 v237,4.0,v233
M a[8:11],a[220:223],a[200:203],a[8:11]
s_waitcnt lgkmcnt(2)
v_fma_f32 v238,-4.0,v234,v236
v_fmac_f32 v232,s45,v236
M a[12:15],a[220:223],a[228:231],a[12:15]
v_fmac_f32 v237,s41,v235
v_sub_f32 v236,v236,v234
M a[12:15],a[224:227],a[200:203],a[12:15]
v_fma_f32 v234,-4.0,v233,v235
v_sub_f32 v235,v235,v233
M a[12:15],a[212:215],a[204:207],a[12:15]
v_add_f32 v233,v238,v234
v_sub_f32 v238,v238,v234
M a[16:19],a[212:215],a[200:203],a[16:19]
ds_read_b128 a[192:195],v249 offset:54272
v_fma_f32 v234,2.0,v235,v236
M a[16:19],a[224:227],a[228:231],a[16:19]
s_waitcnt lgkmcnt(2)
ds_read_b128 a[208:211],v248 offset:54272
v_fmac_f32 v236,-2.0,v235
M a[16:19],a[220:223],a[196:199],a[16:19]
s_waitcnt lgkmcnt(2)
v_and_b32 v210,s42,v210
v_and_b32 v204,s42,v204
M a[20:23],a[220:223],a[216:219],a[20:23]
v_and_b32 v208,s42,v208
v_and_b32 v206,s42,v206
M a[20:23],a[224:227],a[196:199],a[20:23]
v_and_b32 v214,s42,v214
v_and_b32 v212,s42,v212
M a[20:23],a[212:215],a[228:231],a[20:23]
v_fmac_f32 v204,s43,v210
v_fmac_f32 v206,4.0,v208
M a[24:27],a[212:215],a[196:199],a[24:27]
v_fma_f32 v235,-4.0,v210,v214
v_fmac_f32 v204,s45,v214
M a[24:27],a[224:227],a[216:219],a[24:27]
s_waitcnt lgkmcnt(1)
v_fmac_f32 v206,s41,v212
v_sub_f32 v214,v214,v210
M a[24:27],a[220:223],a[192:195],a[24:27]
s_waitcnt lgkmcnt(0)
v_fma_f32 v210,-4.0,v208,v212
v_sub_f32 v212,v212,v208
M a[28:31],a[220:223],a[208:211],a[28:31]
buffer_load_dwordx4 a[220:223],v250,s[20:23],s46 offen offset:1024 sc1
M a[28:31],a[224:227],a[192:195],a[28:31]
v_add_f32 v208,v235,v210
v_sub_f32 v235,v235,v210
M a[28:31],a[212:215],a[216:219],a[28:31]
s_waitcnt vmcnt(10)
buffer_load_dwordx4 a[224:227],v250,s[20:23],s46 offen offset:2048 sc1
M a[32:35],a[232:235],v[228:231],a[32:35]
s_waitcnt vmcnt(10)
s_add_u32 s47,s73,21504
v_fma_f32 v210,2.0,v212,v214
v_fmac_f32 v214,-2.0,v212
M a[32:35],a[244:247],v[224:227],a[32:35]
s_waitcnt vmcnt(9)
v_cvt_pk_bf16_f32 v204,v232,v204
v_cvt_pk_bf16_f32 v206,v237,v206
M a[32:35],a[240:243],v[220:223],a[32:35]
v_cvt_pk_bf16_f32 v208,v233,v208
v_cvt_pk_bf16_f32 v212,v234,v210
M a[36:39],a[240:243],a[204:207],a[36:39]
buffer_load_dwordx4 a[212:215],v250,s[20:23],s47 offen offset:0 sc1
M a[36:39],a[244:247],v[220:223],a[36:39]
v_cvt_pk_bf16_f32 v210,v238,v235
v_cvt_pk_bf16_f32 v214,v236,v214
M a[36:39],a[232:235],v[224:227],a[36:39]
v_permlane32_swap_b32 v209,v211
v_permlane32_swap_b32 v205,v207
M a[40:43],a[232:235],v[220:223],a[40:43]
v_permlane32_swap_b32 v213,v215
v_lshlrev_b32 v234,16,v211
M a[40:43],a[244:247],a[204:207],a[40:43]
v_lshlrev_b32 v232,16,v205
v_lshlrev_b32 v233,16,v209
M a[40:43],a[240:243],a[200:203],a[40:43]
v_lshlrev_b32 v237,16,v207
v_lshlrev_b32 v236,16,v215
M a[44:47],a[240:243],a[228:231],a[44:47]
v_lshlrev_b32 v235,16,v213
v_fmac_f32 v232,s43,v234
M a[44:47],a[244:247],a[200:203],a[44:47]
v_fmac_f32 v237,4.0,v233
v_fma_f32 v238,-4.0,v234,v236
M a[44:47],a[232:235],a[204:207],a[44:47]
v_fmac_f32 v232,s45,v236
v_fmac_f32 v237,s41,v235
M a[48:51],a[232:235],a[200:203],a[48:51]
v_sub_f32 v236,v236,v234
v_fma_f32 v234,-4.0,v233,v235
M a[48:51],a[244:247],a[228:231],a[48:51]
v_sub_f32 v235,v235,v233
v_add_f32 v233,v238,v234
M a[48:51],a[240:243],a[196:199],a[48:51]
v_sub_f32 v238,v238,v234
v_fma_f32 v234,2.0,v235,v236
M a[52:55],a[240:243],a[216:219],a[52:55]
v_fmac_f32 v236,-2.0,v235
v_and_b32 v211,s42,v211
M a[52:55],a[244:247],a[196:199],a[52:55]
v_and_b32 v205,s42,v205
v_and_b32 v209,s42,v209
M a[52:55],a[232:235],a[228:231],a[52:55]
v_and_b32 v207,s42,v207
v_and_b32 v215,s42,v215
M a[56:59],a[232:235],a[196:199],a[56:59]
v_and_b32 v213,s42,v213
v_fmac_f32 v205,s43,v211
M a[56:59],a[244:247],a[216:219],a[56:59]
v_fmac_f32 v207,4.0,v209
v_fma_f32 v235,-4.0,v211,v215
M a[56:59],a[240:243],a[192:195],a[56:59]
v_fmac_f32 v205,s45,v215
v_fmac_f32 v207,s41,v213
M a[60:63],a[240:243],a[208:211],a[60:63]
buffer_load_dwordx4 a[240:243],v250,s[20:23],s47 offen offset:1024 sc1
M a[60:63],a[244:247],a[192:195],a[60:63]
v_sub_f32 v215,v215,v211
v_fma_f32 v211,-4.0,v209,v213
M a[60:63],a[232:235],a[216:219],a[60:63]
s_waitcnt vmcnt(10)
buffer_load_dwordx4 a[244:247],v250,s[20:23],s47 offen offset:2048 sc1
M a[64:67],a[236:239],v[228:231],a[64:67]
s_waitcnt vmcnt(10)
s_add_u32 s48,s73,24576
v_sub_f32 v213,v213,v209
v_add_f32 v209,v235,v211
M a[64:67],a[248:251],v[224:227],a[64:67]
s_waitcnt vmcnt(9)
v_sub_f32 v235,v235,v211
v_fma_f32 v211,2.0,v213,v215
M a[64:67],a[252:255],v[220:223],a[64:67]
v_fmac_f32 v215,-2.0,v213
v_cvt_pk_bf16_f32 v205,v232,v205
M a[68:71],a[252:255],a[204:207],a[68:71]
buffer_load_dwordx4 a[232:235],v250,s[20:23],s48 offen offset:0 sc1
M a[68:71],a[248:251],v[220:223],a[68:71]
v_cvt_pk_bf16_f32 v207,v237,v207
v_cvt_pk_bf16_f32 v209,v233,v209
M a[68:71],a[236:239],v[224:227],a[68:71]
v_cvt_pk_bf16_f32 v213,v234,v211
v_cvt_pk_bf16_f32 v211,v238,v235
M a[72:75],a[236:239],v[220:223],a[72:75]
v_cvt_pk_bf16_f32 v215,v236,v215
v_fmac_f32 v239,s43,v241
M a[72:75],a[248:251],a[204:207],a[72:75]
buffer_load_dwordx4 v[228:231],v250,s[20:23],s48 offen offset:1024 sc1
M a[72:75],a[252:255],a[200:203],a[72:75]
ds_write2st64_b64 v247,v[204:205],v[206:207] offset0:205 offset1:222
M a[76:79],a[252:255],a[228:231],a[76:79]
s_add_u32 s28,s68,1179648
v_fmac_f32 v244,4.0,v240
v_fma_f32 v232,-4.0,v241,v243
M a[76:79],a[248:251],a[200:203],a[76:79]
v_fmac_f32 v239,s45,v243
v_fmac_f32 v244,s41,v242
M a[76:79],a[236:239],a[204:207],a[76:79]
buffer_load_dwordx4 v[224:227],v250,s[20:23],s48 offen offset:2048 sc1
M a[80:83],a[236:239],a[200:203],a[80:83]
s_add_u32 s46,s73,27648
v_sub_f32 v243,v243,v241
v_fma_f32 v241,-4.0,v240,v242
M a[80:83],a[248:251],a[228:231],a[80:83]
v_sub_f32 v242,v242,v240
v_add_f32 v240,v232,v241
M a[80:83],a[252:255],a[196:199],a[80:83]
ds_write2st64_b64 v247,v[208:209],v[210:211] offset0:35 offset1:52
M a[84:87],a[252:255],a[216:219],a[84:87]
buffer_load_dwordx4 v[220:223],v250,s[20:23],s46 offen offset:0 sc1
M a[84:87],a[248:251],a[196:199],a[84:87]
ds_read_b128 a[204:207],v248 offset:60928
v_sub_f32 v232,v232,v241
M a[84:87],a[236:239],a[228:231],a[84:87]
ds_write2st64_b64 v247,v[212:213],v[214:215] offset0:69 offset1:86
M a[88:91],a[236:239],a[196:199],a[88:91]
buffer_load_dwordx4 v[204:207],v251,s[88:91],s28 offen offset:0
M a[88:91],a[248:251],a[216:219],a[88:91]
ds_read_b128 a[200:203],v249 offset:60928
ds_read_b128 a[228:231],v248 offset:61440
M a[88:91],a[252:255],a[192:195],a[88:91]
ds_read_b128 a[196:199],v249 offset:61440
v_fma_f32 v241,2.0,v242,v243
M a[92:95],a[252:255],a[208:211],a[92:95]
buffer_load_dwordx4 v[208:211],v245,s[8:11],s28 offen offset:0
M a[92:95],a[248:251],a[192:195],a[92:95]
v_fmac_f32 v243,-2.0,v242
v_cvt_pk_bf16_f32 v233,v239,v244
M a[92:95],a[236:239],a[216:219],a[92:95]
s_waitcnt vmcnt(14) lgkmcnt(4)
v_cvt_pk_bf16_f32 v234,v240,v232
v_cvt_pk_bf16_f32 v235,v241,v243
M a[96:99],v[216:219],a[204:207],a[96:99]
s_waitcnt vmcnt(10) lgkmcnt(2)
ds_read_b128 a[208:211],v248 offset:61952
v_add_u32 v232,104448,v252
M a[96:99],a[220:223],a[200:203],a[96:99]
s_waitcnt vmcnt(9) lgkmcnt(2)
buffer_load_dwordx4 v[212:215],v245,s[8:11],s28 offen offset:768
M a[96:99],a[224:227],a[228:231],a[96:99]
s_waitcnt lgkmcnt(1)
s_add_u32 s29,s69,0
ds_read_b128 a[252:255],v249 offset:61952
ds_write_b16 v232,v233 offset:0
M a[100:103],a[224:227],a[196:199],a[100:103]
ds_write_b16_d16_hi v232,v233 offset:8704
M a[100:103],a[220:223],a[228:231],a[100:103]
ds_write_b16 v252,v234 offset:17408
M a[100:103],v[216:219],a[200:203],a[100:103]
buffer_load_short_d16_hi v239,v246,s[12:15],s29 offen offset:0
M a[104:107],v[216:219],a[228:231],a[104:107]
ds_read_b128 a[192:195],v248 offset:62464
ds_write_b16_d16_hi v252,v234 offset:26112
M a[104:107],a[220:223],a[196:199],a[104:107]
s_waitcnt lgkmcnt(6)
buffer_load_short_d16_hi v240,v246,s[8:11],s29 offen offset:0
M a[104:107],a[224:227],a[208:211],a[104:107]
s_waitcnt lgkmcnt(5)
ds_read_b128 a[248:251],v249 offset:62464
ds_write_b16 v252,v235 offset:34816
M a[108:111],a[224:227],a[252:255],a[108:111]
buffer_load_short_d16_hi v241,v246,s[8:11],s29 offen offset:384
M a[108:111],a[220:223],a[208:211],a[108:111]
buffer_load_short_d16_hi v242,v246,s[8:11],s29 offen offset:768
M a[108:111],v[216:219],a[196:199],a[108:111]
ds_write_b16_d16_hi v252,v235 offset:43520
M a[112:115],v[216:219],a[208:211],a[112:115]
buffer_load_short_d16_hi v243,v246,s[8:11],s29 offen offset:1152
M a[112:115],a[220:223],a[252:255],a[112:115]
s_waitcnt lgkmcnt(4)
ds_read_b128 a[216:219],v249 offset:62976
ds_read_b128 a[236:239],v248 offset:62976
M a[112:115],a[224:227],a[192:195],a[112:115]
s_waitcnt lgkmcnt(4)
buffer_load_short_d16_hi v244,v246,s[16:19],s29 offen offset:1536
M a[116:119],a[224:227],a[248:251],a[116:119]
v_permlane32_swap_b32 v196,v198
v_permlane32_swap_b32 v192,v194
M a[116:119],a[220:223],a[192:195],a[116:119]
v_permlane32_swap_b32 v200,v202
v_lshlrev_b32 v234,16,v198
M a[116:119],v[216:219],a[252:255],a[116:119]
v_lshlrev_b32 v232,16,v192
v_lshlrev_b32 v233,16,v196
M a[120:123],v[216:219],a[192:195],a[120:123]
v_lshlrev_b32 v237,16,v194
v_lshlrev_b32 v236,16,v202
M a[120:123],a[220:223],a[248:251],a[120:123]
s_waitcnt lgkmcnt(1)
v_lshlrev_b32 v235,16,v200
v_fmac_f32 v232,s43,v234
M a[120:123],a[224:227],a[216:219],a[120:123]
s_waitcnt lgkmcnt(0)
v_fmac_f32 v237,4.0,v233
v_fma_f32 v238,-4.0,v234,v236
M a[124:127],a[224:227],a[236:239],a[124:127]
buffer_load_dwordx4 a[224:227],v250,s[20:23],s46 offen offset:1024 sc1
M a[124:127],a[220:223],a[216:219],a[124:127]
v_fmac_f32 v232,s45,v236
v_fmac_f32 v237,s41,v235
M a[124:127],v[216:219],a[248:251],a[124:127]
s_waitcnt vmcnt(16)
buffer_load_dwordx4 a[220:223],v250,s[20:23],s46 offen offset:2048 sc1
M a[128:131],a[212:215],a[204:207],a[128:131]
s_waitcnt vmcnt(16)
s_add_u32 s47,s73,30720
v_sub_f32 v236,v236,v234
v_fma_f32 v234,-4.0,v233,v235
M a[128:131],a[240:243],a[200:203],a[128:131]
s_waitcnt vmcnt(15)
v_sub_f32 v235,v235,v233
v_add_f32 v233,v238,v234
M a[128:131],a[244:247],a[228:231],a[128:131]
v_sub_f32 v238,v238,v234
v_fma_f32 v234,2.0,v235,v236
M a[132:135],a[244:247],a[196:199],a[132:135]
buffer_load_dwordx4 v[216:219],v250,s[20:23],s47 offen offset:0 sc1
M a[132:135],a[240:243],a[228:231],a[132:135]
v_fmac_f32 v236,-2.0,v235
v_and_b32 v198,s42,v198
M a[132:135],a[212:215],a[200:203],a[132:135]
v_and_b32 v192,s42,v192
v_and_b32 v196,s42,v196
M a[136:139],a[212:215],a[228:231],a[136:139]
v_and_b32 v194,s42,v194
v_and_b32 v202,s42,v202
M a[136:139],a[240:243],a[196:199],a[136:139]
v_and_b32 v200,s42,v200
v_fmac_f32 v192,s43,v198
M a[136:139],a[244:247],a[208:211],a[136:139]
v_fmac_f32 v194,4.0,v196
v_fma_f32 v235,-4.0,v198,v202
M a[140:143],a[244:247],a[252:255],a[140:143]
v_fmac_f32 v192,s45,v202
v_fmac_f32 v194,s41,v200
M a[140:143],a[240:243],a[208:211],a[140:143]
v_sub_f32 v202,v202,v198
v_fma_f32 v198,-4.0,v196,v200
M a[140:143],a[212:215],a[196:199],a[140:143]
v_sub_f32 v200,v200,v196
v_add_f32 v196,v235,v198
M a[144:147],a[212:215],a[208:211],a[144:147]
v_sub_f32 v235,v235,v198
v_fma_f32 v198,2.0,v200,v202
M a[144:147],a[240:243],a[252:255],a[144:147]
v_fmac_f32 v202,-2.0,v200
v_cvt_pk_bf16_f32 v192,v232,v192
M a[144:147],a[244:247],a[192:195],a[144:147]
v_cvt_pk_bf16_f32 v194,v237,v194
v_cvt_pk_bf16_f32 v196,v233,v196
M a[148:151],a[244:247],a[248:251],a[148:151]
v_cvt_pk_bf16_f32 v200,v234,v198
v_cvt_pk_bf16_f32 v198,v238,v235
M a[148:151],a[240:243],a[192:195],a[148:151]
v_cvt_pk_bf16_f32 v202,v236,v202
v_permlane32_swap_b32 v197,v199
M a[148:151],a[212:215],a[252:255],a[148:151]
v_permlane32_swap_b32 v193,v195
v_permlane32_swap_b32 v201,v203
M a[152:155],a[212:215],a[192:195],a[152:155]
v_lshlrev_b32 v234,16,v199
v_lshlrev_b32 v232,16,v193
M a[152:155],a[240:243],a[248:251],a[152:155]
v_lshlrev_b32 v233,16,v197
v_lshlrev_b32 v237,16,v195
M a[152:155],a[244:247],a[216:219],a[152:155]
v_lshlrev_b32 v236,16,v203
v_lshlrev_b32 v235,16,v201
M a[156:159],a[244:247],a[236:239],a[156:159]
buffer_load_dwordx4 a[244:247],v250,s[20:23],s47 offen offset:1024 sc1
M a[156:159],a[240:243],a[216:219],a[156:159]
v_fmac_f32 v232,s43,v234
v_fmac_f32 v237,4.0,v233
M a[156:159],a[212:215],a[248:251],a[156:159]
s_waitcnt vmcnt(16)
buffer_load_dwordx4 a[240:243],v250,s[20:23],s47 offen offset:2048 sc1
M a[160:163],a[232:235],a[204:207],a[160:163]
s_waitcnt vmcnt(16)
s_add_u32 s48,s73,33792
v_fma_f32 v238,-4.0,v234,v236
v_fmac_f32 v232,s45,v236
M a[160:163],v[228:231],a[200:203],a[160:163]
s_waitcnt vmcnt(15)
v_fmac_f32 v237,s41,v235
v_sub_f32 v236,v236,v234
M a[160:163],v[224:227],a[228:231],a[160:163]
v_fma_f32 v234,-4.0,v233,v235
v_sub_f32 v235,v235,v233
M a[164:167],v[224:227],a[196:199],a[164:167]
buffer_load_dwordx4 a[212:215],v250,s[20:23],s48 offen offset:0 sc1
M a[164:167],v[228:231],a[228:231],a[164:167]
v_add_f32 v233,v238,v234
v_sub_f32 v238,v238,v234
M a[164:167],a[232:235],a[200:203],a[164:167]
v_fma_f32 v234,2.0,v235,v236
v_fmac_f32 v236,-2.0,v235
M a[168:171],a[232:235],a[228:231],a[168:171]
v_and_b32 v199,s42,v199
v_and_b32 v193,s42,v193
M a[168:171],v[228:231],a[196:199],a[168:171]
buffer_load_dwordx4 a[204:207],v250,s[20:23],s48 offen offset:1024 sc1
M a[168:171],v[224:227],a[208:211],a[168:171]
v_and_b32 v197,s42,v197
v_and_b32 v195,s42,v195
M a[172:175],v[224:227],a[252:255],a[172:175]
v_and_b32 v203,s42,v203
v_and_b32 v201,s42,v201
M a[172:175],v[228:231],a[208:211],a[172:175]
v_fmac_f32 v193,s43,v199
v_fmac_f32 v195,4.0,v197
M a[172:175],a[232:235],a[196:199],a[172:175]
buffer_load_dwordx4 a[200:203],v250,s[20:23],s48 offen offset:2048 sc1
M a[176:179],a[232:235],a[208:211],a[176:179]
s_add_u32 s46,s73,36864
v_fma_f32 v235,-4.0,v199,v203
v_fmac_f32 v193,s45,v203
M a[176:179],v[228:231],a[252:255],a[176:179]
v_add_u32 v248,0x4400,v248
v_add_u32 v249,0x4400,v249
M a[176:179],v[224:227],a[192:195],a[176:179]
v_fmac_f32 v195,s41,v201
v_sub_f32 v203,v203,v199
M a[180:183],v[224:227],a[248:251],a[180:183]
buffer_load_dwordx4 a[228:231],v250,s[20:23],s46 offen offset:0 sc1
M a[180:183],v[228:231],a[192:195],a[180:183]
ds_read_b128 a[196:199],v248 offset:52224
v_fma_f32 v199,-4.0,v197,v201
M a[180:183],a[232:235],a[252:255],a[180:183]
ds_read_b128 a[208:211],v249 offset:52224
v_sub_f32 v201,v201,v197
M a[184:187],a[232:235],a[192:195],a[184:187]
ds_read_b128 a[252:255],v248 offset:52736
v_add_f32 v197,v235,v199
M a[184:187],v[228:231],a[248:251],a[184:187]
ds_read_b128 a[192:195],v249 offset:52736
v_sub_f32 v235,v235,v199
M a[184:187],v[224:227],a[216:219],a[184:187]
v_fma_f32 v199,2.0,v201,v203
v_fmac_f32 v203,-2.0,v201
M a[188:191],v[224:227],a[236:239],a[188:191]
v_cvt_pk_bf16_f32 v193,v232,v193
v_cvt_pk_bf16_f32 v195,v237,v195
M a[188:191],v[228:231],a[216:219],a[188:191]
v_cvt_pk_bf16_f32 v197,v233,v197
v_cvt_pk_bf16_f32 v201,v234,v199
M a[188:191],a[232:235],a[248:251],a[188:191]
s_waitcnt vmcnt(18) lgkmcnt(3)
v_cvt_pk_bf16_f32 v199,v238,v235
v_cvt_pk_bf16_f32 v203,v236,v203
M v[0:3],v[220:223],a[196:199],v[0:3]
s_waitcnt vmcnt(8) lgkmcnt(2)
ds_read_b128 a[236:239],v248 offset:53248
v_permlane32_swap_b32 v208,v210
M v[0:3],a[224:227],a[208:211],v[0:3]
s_waitcnt vmcnt(7) lgkmcnt(2)
ds_read_b128 v[224:227],v249 offset:53248
v_permlane32_swap_b32 v204,v206
M v[0:3],a[220:223],a[252:255],v[0:3]
s_waitcnt lgkmcnt(2)
ds_write2st64_b64 v247,v[192:193],v[194:195] offset0:206 offset1:223
M v[4:7],a[220:223],a[192:195],v[4:7]
s_add_u32 s28,s69,0
s_mov_b64 exec,s[86:87]
v_xor_b32 v245,0x80000000,v245
v_xor_b32 v251,0x80000000,v251
s_mov_b64 exec,-1
v_permlane32_swap_b32 v212,v214
M v[4:7],a[224:227],a[252:255],v[4:7]
buffer_load_dwordx4 v[192:195],v251,s[88:91],s28 offen offset:0
M v[4:7],v[220:223],a[208:211],v[4:7]
ds_write2st64_b64 v247,v[196:197],v[198:199] offset0:36 offset1:53
M v[8:11],v[220:223],a[252:255],v[8:11]
buffer_load_dwordx4 v[196:199],v245,s[8:11],s28 offen offset:0
M v[8:11],a[224:227],a[192:195],v[8:11]
s_waitcnt lgkmcnt(3)
ds_read_b128 a[216:219],v248 offset:53760
ds_read_b128 v[228:231],v249 offset:53760
M v[8:11],a[220:223],a[236:239],v[8:11]
s_waitcnt lgkmcnt(4)
ds_write2st64_b64 v247,v[200:201],v[202:203] offset0:70 offset1:87
M v[12:15],a[220:223],v[224:227],v[12:15]
buffer_load_dwordx4 v[200:203],v245,s[8:11],s28 offen offset:768
M v[12:15],a[224:227],a[236:239],v[12:15]
s_mov_b64 exec,s[86:87]
v_xor_b32 v245,0x80000000,v245
v_xor_b32 v251,0x80000000,v251
s_mov_b64 exec,-1
v_lshlrev_b32 v234,16,v210
M v[12:15],v[220:223],a[192:195],v[12:15]
v_lshlrev_b32 v232,16,v204
v_lshlrev_b32 v233,16,v208
M v[16:19],v[220:223],a[236:239],v[16:19]
ds_read_b128 a[232:235],v249 offset:54272
v_lshlrev_b32 v237,16,v206
M v[16:19],a[224:227],v[224:227],v[16:19]
s_waitcnt lgkmcnt(3)
ds_read_b128 a[248:251],v248 offset:54272
v_lshlrev_b32 v236,16,v214
M v[16:19],a[220:223],a[216:219],v[16:19]
s_waitcnt lgkmcnt(3)
v_lshlrev_b32 v235,16,v212
v_fmac_f32 v232,s43,v234
M v[20:23],a[220:223],v[228:231],v[20:23]
v_fmac_f32 v237,4.0,v233
v_fma_f32 v238,-4.0,v234,v236
M v[20:23],a[224:227],a[216:219],v[20:23]
v_fmac_f32 v232,s45,v236
v_fmac_f32 v237,s41,v235
M v[20:23],v[220:223],v[224:227],v[20:23]
v_sub_f32 v236,v236,v234
v_fma_f32 v234,-4.0,v233,v235
M v[24:27],v[220:223],a[216:219],v[24:27]
v_sub_f32 v235,v235,v233
v_add_f32 v233,v238,v234
M v[24:27],a[224:227],v[228:231],v[24:27]
s_waitcnt lgkmcnt(1)
v_sub_f32 v238,v238,v234
v_fma_f32 v234,2.0,v235,v236
M v[24:27],a[220:223],a[232:235],v[24:27]
s_waitcnt lgkmcnt(0)
v_fmac_f32 v236,-2.0,v235
v_and_b32 v210,s42,v210
M v[28:31],a[220:223],a[248:251],v[28:31]
global_load_dword a220,v250,s[64:65]
M v[28:31],a[224:227],a[232:235],v[28:31]
buffer_load_dwordx4 a[220:223],v250,s[20:23],s46 offen offset:1024 sc1
M v[28:31],v[220:223],v[228:231],v[28:31]
s_waitcnt vmcnt(11)
v_and_b32 v204,s42,v204
v_and_b32 v208,s42,v208
M v[32:35],v[216:219],a[196:199],v[32:35]
s_waitcnt vmcnt(10)
v_and_b32 v206,s42,v206
v_and_b32 v214,s42,v214
M v[32:35],a[244:247],a[208:211],v[32:35]
s_waitcnt vmcnt(9)
buffer_load_dwordx4 a[224:227],v250,s[20:23],s46 offen offset:2048 sc1
M v[32:35],a[240:243],a[252:255],v[32:35]
s_add_u32 s47,s73,39936
v_and_b32 v212,s42,v212
v_fmac_f32 v204,s43,v210
M v[36:39],a[240:243],a[192:195],v[36:39]
v_fmac_f32 v206,4.0,v208
v_fma_f32 v235,-4.0,v210,v214
M v[36:39],a[244:247],a[252:255],v[36:39]
v_fmac_f32 v204,s45,v214
v_fmac_f32 v206,s41,v212
M v[36:39],v[216:219],a[208:211],v[36:39]
buffer_load_dwordx4 v[220:223],v250,s[20:23],s47 offen offset:0 sc1
M v[40:43],v[216:219],a[252:255],v[40:43]
v_sub_f32 v214,v214,v210
v_fma_f32 v210,-4.0,v208,v212
M v[40:43],a[244:247],a[192:195],v[40:43]
v_sub_f32 v212,v212,v208
v_add_f32 v208,v235,v210
M v[40:43],a[240:243],a[236:239],v[40:43]
v_sub_f32 v235,v235,v210
v_fma_f32 v210,2.0,v212,v214
M v[44:47],a[240:243],v[224:227],v[44:47]
v_fmac_f32 v214,-2.0,v212
v_cvt_pk_bf16_f32 v204,v232,v204
M v[44:47],a[244:247],a[236:239],v[44:47]
v_cvt_pk_bf16_f32 v206,v237,v206
v_cvt_pk_bf16_f32 v208,v233,v208
M v[44:47],v[216:219],a[192:195],v[44:47]
v_cvt_pk_bf16_f32 v212,v234,v210
v_cvt_pk_bf16_f32 v210,v238,v235
M v[48:51],v[216:219],a[236:239],v[48:51]
v_cvt_pk_bf16_f32 v214,v236,v214
v_permlane32_swap_b32 v209,v211
M v[48:51],a[244:247],v[224:227],v[48:51]
v_permlane32_swap_b32 v205,v207
v_permlane32_swap_b32 v213,v215
M v[48:51],a[240:243],a[216:219],v[48:51]
v_lshlrev_b32 v234,16,v211
v_lshlrev_b32 v232,16,v205
M v[52:55],a[240:243],v[228:231],v[52:55]
v_lshlrev_b32 v233,16,v209
v_lshlrev_b32 v237,16,v207
M v[52:55],a[244:247],a[216:219],v[52:55]
v_lshlrev_b32 v236,16,v215
v_lshlrev_b32 v235,16,v213
M v[52:55],v[216:219],v[224:227],v[52:55]
v_fmac_f32 v232,s43,v234
v_fmac_f32 v237,4.0,v233
M v[56:59],v[216:219],a[216:219],v[56:59]
v_fma_f32 v238,-4.0,v234,v236
v_fmac_f32 v232,s45,v236
M v[56:59],a[244:247],v[228:231],v[56:59]
v_fmac_f32 v237,s41,v235
v_sub_f32 v236,v236,v234
M v[56:59],a[240:243],a[232:235],v[56:59]
v_fma_f32 v234,-4.0,v233,v235
v_sub_f32 v235,v235,v233
M v[60:63],a[240:243],a[248:251],v[60:63]
buffer_load_dwordx4 a[240:243],v250,s[20:23],s47 offen offset:1024 sc1
M v[60:63],a[244:247],a[232:235],v[60:63]
v_add_f32 v233,v238,v234
v_sub_f32 v238,v238,v234
M v[60:63],v[216:219],v[228:231],v[60:63]
s_waitcnt vmcnt(11)
buffer_load_dwordx4 a[244:247],v250,s[20:23],s47 offen offset:2048 sc1
M v[64:67],a[212:215],a[196:199],v[64:67]
s_waitcnt vmcnt(11)
s_add_u32 s48,s73,43008
v_fma_f32 v234,2.0,v235,v236
v_fmac_f32 v236,-2.0,v235
M v[64:67],a[204:207],a[208:211],v[64:67]
s_waitcnt vmcnt(10)
v_and_b32 v211,s42,v211
v_and_b32 v205,s42,v205
M v[64:67],a[200:203],a[252:255],v[64:67]
v_and_b32 v209,s42,v209
v_and_b32 v207,s42,v207
M v[68:71],a[200:203],a[192:195],v[68:71]
buffer_load_dwordx4 v[216:219],v250,s[20:23],s48 offen offset:0 sc1
M v[68:71],a[204:207],a[252:255],v[68:71]
v_and_b32 v215,s42,v215
v_and_b32 v213,s42,v213
M v[68:71],a[212:215],a[208:211],v[68:71]
v_fmac_f32 v205,s43,v211
v_fmac_f32 v207,4.0,v209
M v[72:75],a[212:215],a[252:255],v[72:75]
v_fma_f32 v235,-4.0,v211,v215
v_fmac_f32 v205,s45,v215
M v[72:75],a[204:207],a[192:195],v[72:75]
buffer_load_dwordx4 a[196:199],v250,s[20:23],s48 offen offset:1024 sc1
M v[72:75],a[200:203],a[236:239],v[72:75]
v_fmac_f32 v207,s41,v213
v_sub_f32 v215,v215,v211
M v[76:79],a[200:203],v[224:227],v[76:79]
v_fma_f32 v211,-4.0,v209,v213
v_sub_f32 v213,v213,v209
M v[76:79],a[204:207],a[236:239],v[76:79]
v_add_f32 v209,v235,v211
v_sub_f32 v235,v235,v211
M v[76:79],a[212:215],a[192:195],v[76:79]
buffer_load_dwordx4 a[208:211],v250,s[20:23],s48 offen offset:2048 sc1
M v[80:83],a[212:215],a[236:239],v[80:83]
s_add_u32 s46,s74,9216
v_fma_f32 v211,2.0,v213,v215
v_fmac_f32 v215,-2.0,v213
M v[80:83],a[204:207],v[224:227],v[80:83]
v_cvt_pk_bf16_f32 v205,v232,v205
v_cvt_pk_bf16_f32 v207,v237,v207
M v[80:83],a[200:203],a[216:219],v[80:83]
v_cvt_pk_bf16_f32 v209,v233,v209
v_cvt_pk_bf16_f32 v213,v234,v211
M v[84:87],a[200:203],v[228:231],v[84:87]
buffer_load_dwordx4 a[252:255],v250,s[20:23],s46 offen offset:0 sc1
M v[84:87],a[204:207],a[216:219],v[84:87]
ds_read_b128 a[192:195],v248 offset:60928
v_cvt_pk_bf16_f32 v211,v238,v235
M v[84:87],a[212:215],v[224:227],v[84:87]
ds_read_b128 a[236:239],v249 offset:60928
v_cvt_pk_bf16_f32 v215,v236,v215
M v[88:91],a[212:215],a[216:219],v[88:91]
s_waitcnt vmcnt(11)
ds_read_b128 v[224:227],v248 offset:61440
v_permlane32_swap_b32 v196,v198
M v[88:91],a[204:207],v[228:231],v[88:91]
ds_read_b128 a[216:219],v249 offset:61440
v_permlane32_swap_b32 v192,v194
M v[88:91],a[200:203],a[232:235],v[88:91]
ds_write2st64_b64 v247,v[204:205],v[206:207] offset0:207 offset1:224
M v[92:95],a[200:203],a[248:251],v[92:95]
s_add_u32 s28,s69,393216
buffer_load_dwordx4 v[204:207],v251,s[88:91],s28 offen offset:0
M v[92:95],a[204:207],a[232:235],v[92:95]
s_waitcnt vmcnt(11)
v_permlane32_swap_b32 v200,v202
v_lshlrev_b32 v234,16,v198
M v[92:95],a[212:215],v[228:231],v[92:95]
s_waitcnt lgkmcnt(4)
ds_write2st64_b64 v247,v[208:209],v[210:211] offset0:37 offset1:54
M v[96:99],a[228:231],a[192:195],v[96:99]
s_waitcnt vmcnt(9) lgkmcnt(4)
buffer_load_dwordx4 v[208:211],v245,s[8:11],s28 offen offset:0
M v[96:99],a[220:223],a[236:239],v[96:99]
s_waitcnt vmcnt(9) lgkmcnt(3)
ds_read_b128 a[200:203],v248 offset:61952
ds_read_b128 a[248:251],v249 offset:61952
M v[96:99],a[224:227],v[224:227],v[96:99]
s_waitcnt lgkmcnt(4)
ds_write2st64_b64 v247,v[212:213],v[214:215] offset0:71 offset1:88
M v[100:103],a[224:227],a[216:219],v[100:103]
buffer_load_dwordx4 v[212:215],v245,s[8:11],s28 offen offset:768
M v[100:103],a[220:223],v[224:227],v[100:103]
v_lshlrev_b32 v232,16,v192
v_lshlrev_b32 v233,16,v196
M v[100:103],a[228:231],a[236:239],v[100:103]
v_lshlrev_b32 v237,16,v194
v_lshlrev_b32 v236,16,v202
M v[104:107],a[228:231],v[224:227],v[104:107]
ds_read_b128 a[204:207],v248 offset:62464
v_lshlrev_b32 v235,16,v200
M v[104:107],a[220:223],a[216:219],v[104:107]
s_waitcnt lgkmcnt(3)
ds_read_b128 a[232:235],v249 offset:62464
v_fmac_f32 v232,s43,v234
M v[104:107],a[224:227],a[200:203],v[104:107]
s_waitcnt lgkmcnt(3)
v_fmac_f32 v237,4.0,v233
v_fma_f32 v238,-4.0,v234,v236
M v[108:111],a[224:227],a[248:251],v[108:111]
v_fmac_f32 v232,s45,v236
v_fmac_f32 v237,s41,v235
M v[108:111],a[220:223],a[200:203],v[108:111]
v_sub_f32 v236,v236,v234
v_fma_f32 v234,-4.0,v233,v235
M v[108:111],a[228:231],a[216:219],v[108:111]
v_sub_f32 v235,v235,v233
v_add_f32 v233,v238,v234
M v[112:115],a[228:231],a[200:203],v[112:115]
ds_read_b128 a[212:215],v249 offset:62976
v_sub_f32 v238,v238,v234
M v[112:115],a[220:223],a[248:251],v[112:115]
s_waitcnt lgkmcnt(2)
ds_read_b128 v[228:231],v248 offset:62976
v_fma_f32 v234,2.0,v235,v236
M v[112:115],a[224:227],a[204:207],v[112:115]
s_waitcnt lgkmcnt(2)
v_fmac_f32 v236,-2.0,v235
v_and_b32 v198,s42,v198
M v[116:119],a[224:227],a[232:235],v[116:119]
v_and_b32 v192,s42,v192
v_and_b32 v196,s42,v196
M v[116:119],a[220:223],a[204:207],v[116:119]
v_and_b32 v194,s42,v194
v_and_b32 v202,s42,v202
M v[116:119],a[228:231],a[248:251],v[116:119]
v_and_b32 v200,s42,v200
v_fmac_f32 v192,s43,v198
M v[120:123],a[228:231],a[204:207],v[120:123]
v_fmac_f32 v194,4.0,v196
v_fma_f32 v235,-4.0,v198,v202
M v[120:123],a[220:223],a[232:235],v[120:123]
s_waitcnt lgkmcnt(1)
v_fmac_f32 v192,s45,v202
v_fmac_f32 v194,s41,v200
M v[120:123],a[224:227],a[212:215],v[120:123]
s_waitcnt lgkmcnt(0)
v_sub_f32 v202,v202,v198
v_fma_f32 v198,-4.0,v196,v200
M v[124:127],a[224:227],v[228:231],v[124:127]
buffer_load_dwordx4 a[224:227],v250,s[20:23],s46 offen offset:1024 sc1
M v[124:127],a[220:223],a[212:215],v[124:127]
v_sub_f32 v200,v200,v196
v_add_f32 v196,v235,v198
M v[124:127],a[228:231],a[232:235],v[124:127]
s_waitcnt vmcnt(10)
buffer_load_dwordx4 a[220:223],v250,s[20:23],s46 offen offset:2048 sc1
M v[128:131],v[220:223],a[192:195],v[128:131]
s_waitcnt vmcnt(10)
s_add_u32 s47,s74,12288
v_sub_f32 v235,v235,v198
v_fma_f32 v198,2.0,v200,v202
M v[128:131],a[240:243],a[236:239],v[128:131]
s_waitcnt vmcnt(9)
v_fmac_f32 v202,-2.0,v200
v_cvt_pk_bf16_f32 v192,v232,v192
M v[128:131],a[244:247],v[224:227],v[128:131]
v_cvt_pk_bf16_f32 v194,v237,v194
v_cvt_pk_bf16_f32 v196,v233,v196
M v[132:135],a[244:247],a[216:219],v[132:135]
buffer_load_dwordx4 a[228:231],v250,s[20:23],s47 offen offset:0 sc1
M v[132:135],a[240:243],v[224:227],v[132:135]
v_cvt_pk_bf16_f32 v200,v234,v198
v_cvt_pk_bf16_f32 v198,v238,v235
M v[132:135],v[220:223],a[236:239],v[132:135]
v_cvt_pk_bf16_f32 v202,v236,v202
v_permlane32_swap_b32 v197,v199
M v[136:139],v[220:223],v[224:227],v[136:139]
v_permlane32_swap_b32 v193,v195
v_permlane32_swap_b32 v201,v203
M v[136:139],a[240:243],a[216:219],v[136:139]
v_lshlrev_b32 v234,16,v199
v_lshlrev_b32 v232,16,v193
M v[136:139],a[244:247],a[200:203],v[136:139]
v_lshlrev_b32 v233,16,v197
v_lshlrev_b32 v237,16,v195
M v[140:143],a[244:247],a[248:251],v[140:143]
v_lshlrev_b32 v236,16,v203
v_lshlrev_b32 v235,16,v201
M v[140:143],a[240:243],a[200:203],v[140:143]
v_fmac_f32 v232,s43,v234
v_fmac_f32 v237,4.0,v233
M v[140:143],v[220:223],a[216:219],v[140:143]
v_fma_f32 v238,-4.0,v234,v236
v_fmac_f32 v232,s45,v236
M v[144:147],v[220:223],a[200:203],v[144:147]
v_fmac_f32 v237,s41,v235
v_sub_f32 v236,v236,v234
M v[144:147],a[240:243],a[248:251],v[144:147]
v_fma_f32 v234,-4.0,v233,v235
v_sub_f32 v235,v235,v233
M v[144:147],a[244:247],a[204:207],v[144:147]
v_add_f32 v233,v238,v234
v_sub_f32 v238,v238,v234
M v[148:151],a[244:247],a[232:235],v[148:151]
v_fma_f32 v234,2.0,v235,v236
v_fmac_f32 v236,-2.0,v235
M v[148:151],a[240:243],a[204:207],v[148:151]
v_and_b32 v199,s42,v199
v_and_b32 v193,s42,v193
M v[148:151],v[220:223],a[248:251],v[148:151]
v_and_b32 v197,s42,v197
v_and_b32 v195,s42,v195
M v[152:155],v[220:223],a[204:207],v[152:155]
v_and_b32 v203,s42,v203
v_and_b32 v201,s42,v201
M v[152:155],a[240:243],a[232:235],v[152:155]
v_fmac_f32 v193,s43,v199
v_fmac_f32 v195,4.0,v197
M v[152:155],a[244:247],a[212:215],v[152:155]
v_fma_f32 v235,-4.0,v199,v203
v_fmac_f32 v193,s45,v203
M v[156:159],a[244:247],v[228:231],v[156:159]
buffer_load_dwordx4 a[244:247],v250,s[20:23],s47 offen offset:1024 sc1
M v[156:159],a[240:243],a[212:215],v[156:159]
v_fmac_f32 v195,s41,v201
v_sub_f32 v203,v203,v199
M v[156:159],v[220:223],a[232:235],v[156:159]
s_waitcnt vmcnt(10)
buffer_load_dwordx4 a[240:243],v250,s[20:23],s47 offen offset:2048 sc1
M v[160:163],v[216:219],a[192:195],v[160:163]
s_waitcnt vmcnt(10)
s_add_u32 s48,s74,15360
v_fma_f32 v199,-4.0,v197,v201
v_sub_f32 v201,v201,v197
M v[160:163],a[196:199],a[236:239],v[160:163]
s_waitcnt vmcnt(9)
v_add_f32 v197,v235,v199
v_sub_f32 v235,v235,v199
M v[160:163],a[208:211],v[224:227],v[160:163]
v_fma_f32 v199,2.0,v201,v203
v_fmac_f32 v203,-2.0,v201
M v[164:167],a[208:211],a[216:219],v[164:167]
buffer_load_dwordx4 v[220:223],v250,s[20:23],s48 offen offset:0 sc1
M v[164:167],a[196:199],v[224:227],v[164:167]
v_cvt_pk_bf16_f32 v193,v232,v193
v_cvt_pk_bf16_f32 v195,v237,v195
M v[164:167],v[216:219],a[236:239],v[164:167]
v_cvt_pk_bf16_f32 v197,v233,v197
v_cvt_pk_bf16_f32 v201,v234,v199
M v[168:171],v[216:219],v[224:227],v[168:171]
v_cvt_pk_bf16_f32 v199,v238,v235
v_cvt_pk_bf16_f32 v203,v236,v203
M v[168:171],a[196:199],a[216:219],v[168:171]
buffer_load_dwordx4 a[192:195],v250,s[20:23],s48 offen offset:1024 sc1
M v[168:171],a[208:211],a[200:203],v[168:171]
s_waitcnt vmcnt(8)
v_permlane32_swap_b32 v208,v210
v_permlane32_swap_b32 v204,v206
M v[172:175],a[208:211],a[248:251],v[172:175]
s_waitcnt vmcnt(7)
v_permlane32_swap_b32 v212,v214
v_lshlrev_b32 v234,16,v210
M v[172:175],a[196:199],a[200:203],v[172:175]
v_lshlrev_b32 v232,16,v204
v_lshlrev_b32 v233,16,v208
M v[172:175],v[216:219],a[216:219],v[172:175]
buffer_load_dwordx4 a[236:239],v250,s[20:23],s48 offen offset:2048 sc1
M v[176:179],v[216:219],a[200:203],v[176:179]
s_add_u32 s46,s74,18432
v_lshlrev_b32 v237,16,v206
v_lshlrev_b32 v236,16,v214
M v[176:179],a[196:199],a[248:251],v[176:179]
v_lshlrev_b32 v235,16,v212
v_fmac_f32 v232,s43,v234
M v[176:179],a[208:211],a[204:207],v[176:179]
s_barrier
v_fmac_f32 v237,4.0,v233
M v[180:183],a[208:211],a[232:235],v[180:183]
buffer_load_dwordx4 v[224:227],v250,s[20:23],s46 offen offset:0 sc1
M v[180:183],a[196:199],a[204:207],v[180:183]
ds_read_b128 a[216:219],v248 offset:0
v_fma_f32 v238,-4.0,v234,v236
M v[180:183],v[216:219],a[248:251],v[180:183]
ds_write2st64_b64 v247,v[192:193],v[194:195] offset0:238 offset1:255
M v[184:187],v[216:219],a[204:207],v[184:187]
s_add_u32 s28,s69,786432
ds_read_b128 a[200:203],v249 offset:0
ds_read_b128 a[248:251],v248 offset:512
M v[184:187],a[196:199],a[232:235],v[184:187]
buffer_load_dwordx4 v[192:195],v251,s[88:91],s28 offen offset:0
M v[184:187],a[208:211],a[212:215],v[184:187]
ds_write2st64_b64 v247,v[196:197],v[198:199] offset0:102 offset1:119
M v[188:191],a[208:211],v[228:231],v[188:191]
ds_read_b128 a[204:207],v249 offset:512
v_fmac_f32 v232,s45,v236
M v[188:191],a[196:199],a[212:215],v[188:191]
buffer_load_dwordx4 v[196:199],v245,s[8:11],s28 offen offset:0
M v[188:191],v[216:219],a[232:235],v[188:191]
s_waitcnt lgkmcnt(5)
ds_write2st64_b64 v247,v[200:201],v[202:203] offset0:136 offset1:153
M a[0:3],a[252:255],a[216:219],a[0:3]
s_waitcnt vmcnt(10) lgkmcnt(4)
ds_read_b128 a[208:211],v248 offset:1024
v_fmac_f32 v237,s41,v235
M a[0:3],a[224:227],a[200:203],a[0:3]
s_waitcnt vmcnt(9) lgkmcnt(4)
buffer_load_dwordx4 v[200:203],v245,s[8:11],s28 offen offset:768
M a[0:3],a[220:223],a[248:251],a[0:3]
s_waitcnt lgkmcnt(2)
ds_read_b128 v[228:231],v249 offset:1024
v_sub_f32 v236,v236,v234
M a[4:7],a[220:223],a[204:207],a[4:7]
v_fma_f32 v234,-4.0,v233,v235
v_sub_f32 v235,v235,v233
M a[4:7],a[224:227],a[248:251],a[4:7]
v_add_f32 v233,v238,v234
v_sub_f32 v238,v238,v234
M a[4:7],a[252:255],a[200:203],a[4:7]
v_fma_f32 v234,2.0,v235,v236
v_fmac_f32 v236,-2.0,v235
M a[8:11],a[252:255],a[248:251],a[8:11]
ds_read_b128 a[196:199],v248 offset:1536
v_and_b32 v210,s42,v210
M a[8:11],a[224:227],a[204:207],a[8:11]
s_waitcnt lgkmcnt(2)
ds_read_b128 a[212:215],v249 offset:1536
v_and_b32 v204,s42,v204
M a[8:11],a[220:223],a[208:211],a[8:11]
s_waitcnt lgkmcnt(2)
v_and_b32 v208,s42,v208
v_and_b32 v206,s42,v206
M a[12:15],a[220:223],v[228:231],a[12:15]
v_and_b32 v214,s42,v214
v_and_b32 v212,s42,v212
M a[12:15],a[224:227],a[208:211],a[12:15]
v_fmac_f32 v204,s43,v210
v_fmac_f32 v206,4.0,v208
M a[12:15],a[252:255],a[204:207],a[12:15]
v_fma_f32 v235,-4.0,v210,v214
v_fmac_f32 v204,s45,v214
M a[16:19],a[252:255],a[208:211],a[16:19]
ds_read_b128 a[232:235],v249 offset:2048
v_fmac_f32 v206,s41,v212
M a[16:19],a[224:227],v[228:231],a[16:19]
s_waitcnt lgkmcnt(2)
ds_read_b128 v[216:219],v248 offset:2048
v_sub_f32 v214,v214,v210
M a[16:19],a[220:223],a[196:199],a[16:19]
s_waitcnt lgkmcnt(2)
v_fma_f32 v210,-4.0,v208,v212
v_sub_f32 v212,v212,v208
M a[20:23],a[220:223],a[212:215],a[20:23]
v_add_f32 v208,v235,v210
v_sub_f32 v235,v235,v210
M a[20:23],a[224:227],a[196:199],a[20:23]
v_fma_f32 v210,2.0,v212,v214
v_fmac_f32 v214,-2.0,v212
M a[20:23],a[252:255],v[228:231],a[20:23]
v_cvt_pk_bf16_f32 v204,v232,v204
v_cvt_pk_bf16_f32 v206,v237,v206
M a[24:27],a[252:255],a[196:199],a[24:27]
v_cvt_pk_bf16_f32 v208,v233,v208
v_cvt_pk_bf16_f32 v212,v234,v210
M a[24:27],a[224:227],a[212:215],a[24:27]
s_waitcnt lgkmcnt(1)
v_cvt_pk_bf16_f32 v210,v238,v235
v_cvt_pk_bf16_f32 v214,v236,v214
M a[24:27],a[220:223],a[232:235],a[24:27]
s_waitcnt lgkmcnt(0)
v_permlane32_swap_b32 v209,v211
v_permlane32_swap_b32 v205,v207
M a[28:31],a[220:223],v[216:219],a[28:31]
buffer_load_dwordx4 a[220:223],v250,s[20:23],s46 offen offset:1024 sc1
M a[28:31],a[224:227],a[232:235],a[28:31]
v_permlane32_swap_b32 v213,v215
v_lshlrev_b32 v234,16,v211
M a[28:31],a[252:255],a[212:215],a[28:31]
s_waitcnt vmcnt(10)
buffer_load_dwordx4 a[224:227],v250,s[20:23],s46 offen offset:2048 sc1
M a[32:35],a[228:231],a[216:219],a[32:35]
s_waitcnt vmcnt(10)
s_add_u32 s47,s74,21504
v_lshlrev_b32 v232,16,v205
v_lshlrev_b32 v233,16,v209
M a[32:35],a[244:247],a[200:203],a[32:35]
s_waitcnt vmcnt(9)
v_lshlrev_b32 v237,16,v207
v_lshlrev_b32 v236,16,v215
M a[32:35],a[240:243],a[248:251],a[32:35]
v_lshlrev_b32 v235,16,v213
v_fmac_f32 v232,s43,v234
M a[36:39],a[240:243],a[204:207],a[36:39]
buffer_load_dwordx4 a[252:255],v250,s[20:23],s47 offen offset:0 sc1
M a[36:39],a[244:247],a[248:251],a[36:39]
v_fmac_f32 v237,4.0,v233
v_fma_f32 v238,-4.0,v234,v236
M a[36:39],a[228:231],a[200:203],a[36:39]
v_fmac_f32 v232,s45,v236
v_fmac_f32 v237,s41,v235
M a[40:43],a[228:231],a[248:251],a[40:43]
v_sub_f32 v236,v236,v234
v_fma_f32 v234,-4.0,v233,v235
M a[40:43],a[244:247],a[204:207],a[40:43]
v_sub_f32 v235,v235,v233
v_add_f32 v233,v238,v234
M a[40:43],a[240:243],a[208:211],a[40:43]
v_sub_f32 v238,v238,v234
v_fma_f32 v234,2.0,v235,v236
M a[44:47],a[240:243],v[228:231],a[44:47]
v_fmac_f32 v236,-2.0,v235
v_and_b32 v211,s42,v211
M a[44:47],a[244:247],a[208:211],a[44:47]
v_and_b32 v205,s42,v205
v_and_b32 v209,s42,v209
M a[44:47],a[228:231],a[204:207],a[44:47]
v_and_b32 v207,s42,v207
v_and_b32 v215,s42,v215
M a[48:51],a[228:231],a[208:211],a[48:51]
v_and_b32 v213,s42,v213
v_fmac_f32 v205,s43,v211
M a[48:51],a[244:247],v[228:231],a[48:51]
v_fmac_f32 v207,4.0,v209
v_fma_f32 v235,-4.0,v211,v215
M a[48:51],a[240:243],a[196:199],a[48:51]
v_fmac_f32 v205,s45,v215
v_fmac_f32 v207,s41,v213
M a[52:55],a[240:243],a[212:215],a[52:55]
v_sub_f32 v215,v215,v211
v_fma_f32 v211,-4.0,v209,v213
M a[52:55],a[244:247],a[196:199],a[52:55]
v_sub_f32 v213,v213,v209
v_add_f32 v209,v235,v211
M a[52:55],a[228:231],v[228:231],a[52:55]
s_add_u32 s31,s75,s85
v_sub_f32 v235,v235,v211
v_fma_f32 v211,2.0,v213,v215
M a[56:59],a[228:231],a[196:199],a[56:59]
v_fmac_f32 v215,-2.0,v213
v_cvt_pk_bf16_f32 v205,v232,v205
M a[56:59],a[244:247],a[212:215],a[56:59]
v_cvt_pk_bf16_f32 v207,v237,v207
v_cvt_pk_bf16_f32 v209,v233,v209
M a[56:59],a[240:243],a[232:235],a[56:59]
v_cvt_pk_bf16_f32 v213,v234,v211
v_cvt_pk_bf16_f32 v211,v238,v235
M a[60:63],a[240:243],v[216:219],a[60:63]
buffer_load_dword a240,v250,s[20:23],s31 offen offset:0 sc1
M a[60:63],a[244:247],a[232:235],a[60:63]
v_cvt_pk_bf16_f32 v215,v236,v215
v_add_u32 v238,121856,v247
M a[60:63],a[228:231],a[212:215],a[60:63]
s_waitcnt vmcnt(10)
ds_write2st64_b64 v238,v[204:205],v[206:207] offset0:1 offset1:18
M a[64:67],v[220:223],a[216:219],a[64:67]
s_waitcnt vmcnt(9)
s_add_u32 s28,s69,1179648
buffer_load_dwordx4 v[204:207],v251,s[88:91],s28 offen offset:0
M a[64:67],a[192:195],a[200:203],a[64:67]
s_waitcnt vmcnt(9)
v_fmac_f32 v239,s43,v241
v_fmac_f32 v244,4.0,v240
M a[64:67],a[236:239],a[248:251],a[64:67]
ds_write2st64_b64 v247,v[208:209],v[210:211] offset0:103 offset1:120
M a[68:71],a[236:239],a[204:207],a[68:71]
buffer_load_dwordx4 v[208:211],v245,s[8:11],s28 offen offset:0
M a[68:71],a[192:195],a[248:251],a[68:71]
v_fma_f32 v232,-4.0,v241,v243
v_fmac_f32 v239,s45,v243
M a[68:71],v[220:223],a[200:203],a[68:71]
ds_write2st64_b64 v247,v[212:213],v[214:215] offset0:137 offset1:154
M a[72:75],v[220:223],a[248:251],a[72:75]
buffer_load_dwordx4 v[212:215],v245,s[8:11],s28 offen offset:768
M a[72:75],a[192:195],a[204:207],a[72:75]
v_fmac_f32 v244,s41,v242
v_sub_f32 v243,v243,v241
M a[72:75],a[236:239],a[208:211],a[72:75]
buffer_load_dword a240,v250,s[20:23],s31 offen offset:128 sc1
M a[76:79],a[236:239],v[228:231],a[76:79]
buffer_load_dwordx4 a[240:243],v250,s[20:23],s47 offen offset:1024 sc1
M a[76:79],a[192:195],a[208:211],a[76:79]
buffer_load_dwordx4 a[244:247],v250,s[20:23],s47 offen offset:2048 sc1
M a[76:79],v[220:223],a[204:207],a[76:79]
s_add_u32 s48,s74,24576
v_fma_f32 v241,-4.0,v240,v242
v_sub_f32 v242,v242,v240
M a[80:83],v[220:223],a[208:211],a[80:83]
v_add_f32 v240,v232,v241
v_sub_f32 v232,v232,v241
M a[80:83],a[192:195],v[228:231],a[80:83]
v_fma_f32 v241,2.0,v242,v243
v_fmac_f32 v243,-2.0,v242
M a[80:83],a[236:239],a[196:199],a[80:83]
v_cvt_pk_bf16_f32 v233,v239,v244
v_cvt_pk_bf16_f32 v234,v240,v232
M a[84:87],a[236:239],a[212:215],a[84:87]
v_cvt_pk_bf16_f32 v235,v241,v243
v_add_u32 v232,121856,v252
M a[84:87],a[192:195],a[196:199],a[84:87]
s_add_u32 s29,s70,0
ds_read_b128 a[204:207],v248 offset:8704
ds_write_b16 v232,v233 offset:0
M a[84:87],v[220:223],v[228:231],a[84:87]
ds_read_b128 a[208:211],v249 offset:8704
ds_write_b16_d16_hi v232,v233 offset:8704
M a[88:91],v[220:223],a[196:199],a[88:91]
ds_read_b128 v[228:231],v248 offset:9216
ds_write_b16 v252,v234 offset:52224
M a[88:91],a[192:195],a[212:215],a[88:91]
ds_read_b128 a[196:199],v249 offset:9216
ds_write_b16_d16_hi v252,v234 offset:60928
M a[88:91],a[236:239],a[232:235],a[88:91]
buffer_load_dwordx4 a[228:231],v250,s[20:23],s48 offen offset:0 sc1
M a[92:95],a[236:239],v[216:219],a[92:95]
v_add_u32 v232,69632,v252
M a[92:95],a[192:195],a[232:235],a[92:95]
ds_write_b16 v232,v235 offset:0
M a[92:95],v[220:223],a[212:215],a[92:95]
s_waitcnt vmcnt(14) lgkmcnt(8)
ds_write_b16_d16_hi v232,v235 offset:8704
M a[96:99],v[224:227],a[204:207],a[96:99]
s_waitcnt vmcnt(10) lgkmcnt(7)
buffer_load_dwordx4 a[216:219],v250,s[20:23],s48 offen offset:1024 sc1
M a[96:99],a[220:223],a[208:211],a[96:99]
s_waitcnt vmcnt(10) lgkmcnt(5)
ds_read_b128 a[236:239],v248 offset:9728
ds_read_b128 v[216:219],v249 offset:9728
M a[96:99],a[224:227],v[228:231],a[96:99]
s_waitcnt lgkmcnt(5)
v_permlane32_swap_b32 v196,v198
v_permlane32_swap_b32 v192,v194
M a[100:103],a[224:227],a[196:199],a[100:103]
v_permlane32_swap_b32 v200,v202
v_lshlrev_b32 v234,16,v198
M a[100:103],a[220:223],v[228:231],a[100:103]
buffer_load_dwordx4 a[200:203],v250,s[20:23],s48 offen offset:2048 sc1
M a[100:103],v[224:227],a[208:211],a[100:103]
s_add_u32 s46,s74,27648
v_lshlrev_b32 v232,16,v192
v_lshlrev_b32 v233,16,v196
M a[104:107],v[224:227],v[228:231],a[104:107]
ds_read_b128 a[192:195],v248 offset:10240
v_lshlrev_b32 v237,16,v194
M a[104:107],a[220:223],a[196:199],a[104:107]
s_waitcnt lgkmcnt(2)
ds_read_b128 a[232:235],v249 offset:10240
v_lshlrev_b32 v236,16,v202
M a[104:107],a[224:227],a[236:239],a[104:107]
s_waitcnt lgkmcnt(2)
buffer_load_dwordx4 a[248:251],v250,s[20:23],s46 offen offset:0 sc1
M a[108:111],a[224:227],v[216:219],a[108:111]
v_lshlrev_b32 v235,16,v200
v_fmac_f32 v232,s43,v234
M a[108:111],a[220:223],a[236:239],a[108:111]
v_fmac_f32 v237,4.0,v233
v_fma_f32 v238,-4.0,v234,v236
M a[108:111],v[224:227],a[196:199],a[108:111]
v_fmac_f32 v232,s45,v236
v_fmac_f32 v237,s41,v235
M a[112:115],v[224:227],a[236:239],a[112:115]
buffer_load_short_d16_hi v239,v246,s[12:15],s29 offen offset:0
M a[112:115],a[220:223],v[216:219],a[112:115]
s_waitcnt lgkmcnt(1)
ds_read_b128 a[212:215],v249 offset:10752
ds_read_b128 v[220:223],v248 offset:10752
M a[112:115],a[224:227],a[192:195],a[112:115]
s_waitcnt lgkmcnt(2)
buffer_load_short_d16_hi v240,v246,s[8:11],s29 offen offset:0
M a[116:119],a[224:227],a[232:235],a[116:119]
v_sub_f32 v236,v236,v234
v_fma_f32 v234,-4.0,v233,v235
M a[116:119],a[220:223],a[192:195],a[116:119]
buffer_load_short_d16_hi v241,v246,s[8:11],s29 offen offset:384
M a[116:119],v[224:227],v[216:219],a[116:119]
v_sub_f32 v235,v235,v233
v_add_f32 v233,v238,v234
M a[120:123],v[224:227],a[192:195],a[120:123]
buffer_load_short_d16_hi v242,v246,s[8:11],s29 offen offset:768
M a[120:123],a[220:223],a[232:235],a[120:123]
s_waitcnt lgkmcnt(1)
v_sub_f32 v238,v238,v234
v_fma_f32 v234,2.0,v235,v236
M a[120:123],a[224:227],a[212:215],a[120:123]
s_waitcnt lgkmcnt(0)
buffer_load_short_d16_hi v243,v246,s[8:11],s29 offen offset:1152
M a[124:127],a[224:227],v[220:223],a[124:127]
v_fmac_f32 v236,-2.0,v235
v_and_b32 v198,s42,v198
M a[124:127],a[220:223],a[212:215],a[124:127]
buffer_load_dwordx4 a[224:227],v250,s[20:23],s46 offen offset:1024 sc1
M a[124:127],v[224:227],a[232:235],a[124:127]
s_waitcnt vmcnt(17)
v_and_b32 v192,s42,v192
v_and_b32 v196,s42,v196
M a[128:131],a[252:255],a[204:207],a[128:131]
s_waitcnt vmcnt(11)
v_and_b32 v194,s42,v194
v_and_b32 v202,s42,v202
M a[128:131],a[240:243],a[208:211],a[128:131]
s_waitcnt vmcnt(10)
v_and_b32 v200,s42,v200
v_fmac_f32 v192,s43,v198
M a[128:131],a[244:247],v[228:231],a[128:131]
buffer_load_dwordx4 a[220:223],v250,s[20:23],s46 offen offset:2048 sc1
M a[132:135],a[244:247],a[196:199],a[132:135]
s_add_u32 s47,s74,30720
v_fmac_f32 v194,4.0,v196
v_fma_f32 v235,-4.0,v198,v202
M a[132:135],a[240:243],v[228:231],a[132:135]
v_fmac_f32 v192,s45,v202
v_fmac_f32 v194,s41,v200
M a[132:135],a[252:255],a[208:211],a[132:135]
v_sub_f32 v202,v202,v198
v_fma_f32 v198,-4.0,v196,v200
M a[136:139],a[252:255],v[228:231],a[136:139]
buffer_load_dwordx4 v[224:227],v250,s[20:23],s47 offen offset:0 sc1
M a[136:139],a[240:243],a[196:199],a[136:139]
v_sub_f32 v200,v200,v196
v_add_f32 v196,v235,v198
M a[136:139],a[244:247],a[236:239],a[136:139]
v_sub_f32 v235,v235,v198
v_fma_f32 v198,2.0,v200,v202
M a[140:143],a[244:247],v[216:219],a[140:143]
v_fmac_f32 v202,-2.0,v200
v_cvt_pk_bf16_f32 v192,v232,v192
M a[140:143],a[240:243],a[236:239],a[140:143]
buffer_load_short_d16_hi v244,v246,s[16:19],s29 offen offset:1536
M a[140:143],a[252:255],a[196:199],a[140:143]
v_cvt_pk_bf16_f32 v194,v237,v194
v_cvt_pk_bf16_f32 v196,v233,v196
M a[144:147],a[252:255],a[236:239],a[144:147]
v_cvt_pk_bf16_f32 v200,v234,v198
v_cvt_pk_bf16_f32 v198,v238,v235
M a[144:147],a[240:243],v[216:219],a[144:147]
v_cvt_pk_bf16_f32 v202,v236,v202
v_permlane32_swap_b32 v197,v199
M a[144:147],a[244:247],a[192:195],a[144:147]
v_permlane32_swap_b32 v193,v195
v_permlane32_swap_b32 v201,v203
M a[148:151],a[244:247],a[232:235],a[148:151]
v_lshlrev_b32 v234,16,v199
v_lshlrev_b32 v232,16,v193
M a[148:151],a[240:243],a[192:195],a[148:151]
v_lshlrev_b32 v233,16,v197
v_lshlrev_b32 v237,16,v195
M a[148:151],a[252:255],v[216:219],a[148:151]
v_lshlrev_b32 v236,16,v203
v_lshlrev_b32 v235,16,v201
M a[152:155],a[252:255],a[192:195],a[152:155]
v_fmac_f32 v232,s43,v234
v_fmac_f32 v237,4.0,v233
M a[152:155],a[240:243],a[232:235],a[152:155]
v_fma_f32 v238,-4.0,v234,v236
v_fmac_f32 v232,s45,v236
M a[152:155],a[244:247],a[212:215],a[152:155]
v_fmac_f32 v237,s41,v235
v_sub_f32 v236,v236,v234
M a[156:159],a[244:247],v[220:223],a[156:159]
buffer_load_dwordx4 a[244:247],v250,s[20:23],s47 offen offset:1024 sc1
M a[156:159],a[240:243],a[212:215],a[156:159]
v_fma_f32 v234,-4.0,v233,v235
v_sub_f32 v235,v235,v233
M a[156:159],a[252:255],a[232:235],a[156:159]
s_waitcnt vmcnt(13)
buffer_load_dwordx4 a[240:243],v250,s[20:23],s47 offen offset:2048 sc1
M a[160:163],a[228:231],a[204:207],a[160:163]
s_waitcnt vmcnt(13)
s_add_u32 s48,s74,33792
v_add_f32 v233,v238,v234
v_sub_f32 v238,v238,v234
M a[160:163],a[216:219],a[208:211],a[160:163]
s_waitcnt vmcnt(12)
v_fma_f32 v234,2.0,v235,v236
v_fmac_f32 v236,-2.0,v235
M a[160:163],a[200:203],v[228:231],a[160:163]
v_and_b32 v199,s42,v199
v_and_b32 v193,s42,v193
M a[164:167],a[200:203],a[196:199],a[164:167]
buffer_load_dwordx4 a[252:255],v250,s[20:23],s48 offen offset:0 sc1
M a[164:167],a[216:219],v[228:231],a[164:167]
v_and_b32 v197,s42,v197
v_and_b32 v195,s42,v195
M a[164:167],a[228:231],a[208:211],a[164:167]
v_and_b32 v203,s42,v203
v_and_b32 v201,s42,v201
M a[168:171],a[228:231],v[228:231],a[168:171]
v_fmac_f32 v193,s43,v199
v_fmac_f32 v195,4.0,v197
M a[168:171],a[216:219],a[196:199],a[168:171]
buffer_load_dwordx4 a[204:207],v250,s[20:23],s48 offen offset:1024 sc1
M a[168:171],a[200:203],a[236:239],a[168:171]
v_fma_f32 v235,-4.0,v199,v203
v_fmac_f32 v193,s45,v203
M a[172:175],a[200:203],v[216:219],a[172:175]
v_fmac_f32 v195,s41,v201
v_sub_f32 v203,v203,v199
M a[172:175],a[216:219],a[236:239],a[172:175]
v_fma_f32 v199,-4.0,v197,v201
v_sub_f32 v201,v201,v197
M a[172:175],a[228:231],a[196:199],a[172:175]
buffer_load_dwordx4 a[208:211],v250,s[20:23],s48 offen offset:2048 sc1
M a[176:179],a[228:231],a[236:239],a[176:179]
s_add_u32 s46,s74,36864
v_add_f32 v197,v235,v199
v_sub_f32 v235,v235,v199
M a[176:179],a[216:219],v[216:219],a[176:179]
v_fma_f32 v199,2.0,v201,v203
v_fmac_f32 v203,-2.0,v201
M a[176:179],a[200:203],a[192:195],a[176:179]
v_cvt_pk_bf16_f32 v193,v232,v193
v_cvt_pk_bf16_f32 v195,v237,v195
M a[180:183],a[200:203],a[232:235],a[180:183]
buffer_load_dwordx4 v[228:231],v250,s[20:23],s46 offen offset:0 sc1
M a[180:183],a[216:219],a[192:195],a[180:183]
ds_read_b128 a[196:199],v248 offset:17408
v_cvt_pk_bf16_f32 v197,v233,v197
M a[180:183],a[228:231],v[216:219],a[180:183]
ds_read_b128 a[236:239],v249 offset:17408
v_cvt_pk_bf16_f32 v201,v234,v199
M a[184:187],a[228:231],a[192:195],a[184:187]
ds_read_b128 v[216:219],v248 offset:17920
v_cvt_pk_bf16_f32 v199,v238,v235
M a[184:187],a[216:219],a[232:235],a[184:187]
ds_read_b128 a[192:195],v249 offset:17920
v_cvt_pk_bf16_f32 v203,v236,v203
M a[184:187],a[200:203],a[212:215],a[184:187]
v_add_u32 v238,121856,v247
v_permlane32_swap_b32 v208,v210
M a[188:191],a[200:203],v[220:223],a[188:191]
v_permlane32_swap_b32 v204,v206
v_permlane32_swap_b32 v212,v214
M a[188:191],a[216:219],a[212:215],a[188:191]
v_lshlrev_b32 v234,16,v210
v_lshlrev_b32 v232,16,v204
M a[188:191],a[228:231],a[232:235],a[188:191]
s_waitcnt vmcnt(15) lgkmcnt(3)
ds_write2st64_b64 v238,v[192:193],v[194:195] offset0:2 offset1:19
M v[0:3],a[248:251],a[196:199],v[0:3]
s_waitcnt vmcnt(9) lgkmcnt(3)
s_add_u32 s28,s70,0
ds_read_b128 a[200:203],v248 offset:18432
s_mov_b64 exec,s[86:87]
v_xor_b32 v245,0x80000000,v245
v_xor_b32 v251,0x80000000,v251
s_mov_b64 exec,-1
M v[0:3],a[224:227],a[236:239],v[0:3]
s_waitcnt vmcnt(8) lgkmcnt(3)
buffer_load_dwordx4 v[192:195],v251,s[88:91],s28 offen offset:0
M v[0:3],a[220:223],v[216:219],v[0:3]
s_waitcnt lgkmcnt(2)
ds_write2st64_b64 v247,v[196:197],v[198:199] offset0:104 offset1:121
M v[4:7],a[220:223],a[192:195],v[4:7]
buffer_load_dwordx4 v[196:199],v245,s[8:11],s28 offen offset:0
M v[4:7],a[224:227],v[216:219],v[4:7]
ds_read_b128 v[220:223],v249 offset:18432
v_lshlrev_b32 v233,16,v208
M v[4:7],a[248:251],a[236:239],v[4:7]
ds_write2st64_b64 v247,v[200:201],v[202:203] offset0:138 offset1:155
M v[8:11],a[248:251],v[216:219],v[8:11]
buffer_load_dwordx4 v[200:203],v245,s[8:11],s28 offen offset:768
M v[8:11],a[224:227],a[192:195],v[8:11]
s_waitcnt lgkmcnt(3)
ds_read_b128 a[212:215],v248 offset:18944
ds_read_b128 a[216:219],v249 offset:18944
M v[8:11],a[220:223],a[200:203],v[8:11]
s_waitcnt lgkmcnt(3)
s_mov_b64 exec,s[86:87]
v_xor_b32 v245,0x80000000,v245
v_xor_b32 v251,0x80000000,v251
s_mov_b64 exec,-1
v_lshlrev_b32 v237,16,v206
M v[12:15],a[220:223],v[220:223],v[12:15]
v_lshlrev_b32 v236,16,v214
v_lshlrev_b32 v235,16,v212
M v[12:15],a[224:227],a[200:203],v[12:15]
v_fmac_f32 v232,s43,v234
v_fmac_f32 v237,4.0,v233
M v[12:15],a[248:251],a[192:195],v[12:15]
v_fma_f32 v238,-4.0,v234,v236
v_fmac_f32 v232,s45,v236
M v[16:19],a[248:251],a[200:203],v[16:19]
ds_read_b128 a[228:231],v249 offset:19456
v_fmac_f32 v237,s41,v235
M v[16:19],a[224:227],v[220:223],v[16:19]
s_waitcnt lgkmcnt(2)
ds_read_b128 a[232:235],v248 offset:19456
v_sub_f32 v236,v236,v234
M v[16:19],a[220:223],a[212:215],v[16:19]
s_waitcnt lgkmcnt(2)
v_fma_f32 v234,-4.0,v233,v235
v_sub_f32 v235,v235,v233
M v[20:23],a[220:223],a[216:219],v[20:23]
v_add_f32 v233,v238,v234
v_sub_f32 v238,v238,v234
M v[20:23],a[224:227],a[212:215],v[20:23]
v_fma_f32 v234,2.0,v235,v236
v_fmac_f32 v236,-2.0,v235
M v[20:23],a[248:251],v[220:223],v[20:23]
v_and_b32 v210,s42,v210
v_and_b32 v204,s42,v204
M v[24:27],a[248:251],a[212:215],v[24:27]
v_and_b32 v208,s42,v208
v_and_b32 v206,s42,v206
M v[24:27],a[224:227],a[216:219],v[24:27]
s_waitcnt lgkmcnt(1)
v_and_b32 v214,s42,v214
v_and_b32 v212,s42,v212
M v[24:27],a[220:223],a[228:231],v[24:27]
s_waitcnt lgkmcnt(0)
v_fmac_f32 v204,s43,v210
v_fmac_f32 v206,4.0,v208
M v[28:31],a[220:223],a[232:235],v[28:31]
buffer_load_dwordx4 a[220:223],v250,s[20:23],s46 offen offset:1024 sc1
M v[28:31],a[224:227],a[228:231],v[28:31]
v_fma_f32 v235,-4.0,v210,v214
v_fmac_f32 v204,s45,v214
M v[28:31],a[248:251],a[216:219],v[28:31]
s_waitcnt vmcnt(11)
buffer_load_dwordx4 a[224:227],v250,s[20:23],s46 offen offset:2048 sc1
M v[32:35],v[224:227],a[196:199],v[32:35]
s_waitcnt vmcnt(10)
s_add_u32 s47,s74,39936
v_fmac_f32 v206,s41,v212
v_sub_f32 v214,v214,v210
M v[32:35],a[244:247],a[236:239],v[32:35]
s_waitcnt vmcnt(9)
v_fma_f32 v210,-4.0,v208,v212
v_sub_f32 v212,v212,v208
M v[32:35],a[240:243],v[216:219],v[32:35]
v_add_f32 v208,v235,v210
v_sub_f32 v235,v235,v210
M v[36:39],a[240:243],a[192:195],v[36:39]
buffer_load_dwordx4 a[248:251],v250,s[20:23],s47 offen offset:0 sc1
M v[36:39],a[244:247],v[216:219],v[36:39]
v_fma_f32 v210,2.0,v212,v214
v_fmac_f32 v214,-2.0,v212
M v[36:39],v[224:227],a[236:239],v[36:39]
v_cvt_pk_bf16_f32 v204,v232,v204
v_cvt_pk_bf16_f32 v206,v237,v206
M v[40:43],v[224:227],v[216:219],v[40:43]
v_cvt_pk_bf16_f32 v208,v233,v208
v_cvt_pk_bf16_f32 v212,v234,v210
M v[40:43],a[244:247],a[192:195],v[40:43]
v_cvt_pk_bf16_f32 v210,v238,v235
v_cvt_pk_bf16_f32 v214,v236,v214
M v[40:43],a[240:243],a[200:203],v[40:43]
v_permlane32_swap_b32 v209,v211
v_permlane32_swap_b32 v205,v207
M v[44:47],a[240:243],v[220:223],v[44:47]
v_permlane32_swap_b32 v213,v215
v_lshlrev_b32 v234,16,v211
M v[44:47],a[244:247],a[200:203],v[44:47]
v_lshlrev_b32 v232,16,v205
v_lshlrev_b32 v233,16,v209
M v[44:47],v[224:227],a[192:195],v[44:47]
v_lshlrev_b32 v237,16,v207
v_lshlrev_b32 v236,16,v215
M v[48:51],v[224:227],a[200:203],v[48:51]
v_lshlrev_b32 v235,16,v213
v_fmac_f32 v232,s43,v234
M v[48:51],a[244:247],v[220:223],v[48:51]
v_fmac_f32 v237,4.0,v233
v_fma_f32 v238,-4.0,v234,v236
M v[48:51],a[240:243],a[212:215],v[48:51]
v_fmac_f32 v232,s45,v236
v_fmac_f32 v237,s41,v235
M v[52:55],a[240:243],a[216:219],v[52:55]
v_sub_f32 v236,v236,v234
v_fma_f32 v234,-4.0,v233,v235
M v[52:55],a[244:247],a[212:215],v[52:55]
v_sub_f32 v235,v235,v233
v_add_f32 v233,v238,v234
M v[52:55],v[224:227],v[220:223],v[52:55]
v_sub_f32 v238,v238,v234
v_fma_f32 v234,2.0,v235,v236
M v[56:59],v[224:227],a[212:215],v[56:59]
v_fmac_f32 v236,-2.0,v235
v_and_b32 v211,s42,v211
M v[56:59],a[244:247],a[216:219],v[56:59]
v_and_b32 v205,s42,v205
v_and_b32 v209,s42,v209
M v[56:59],a[240:243],a[228:231],v[56:59]
v_and_b32 v207,s42,v207
v_and_b32 v215,s42,v215
M v[60:63],a[240:243],a[232:235],v[60:63]
buffer_load_dwordx4 a[240:243],v250,s[20:23],s47 offen offset:1024 sc1
M v[60:63],a[244:247],a[228:231],v[60:63]
v_and_b32 v213,s42,v213
v_fmac_f32 v205,s43,v211
M v[60:63],v[224:227],a[216:219],v[60:63]
s_waitcnt vmcnt(10)
buffer_load_dwordx4 a[244:247],v250,s[20:23],s47 offen offset:2048 sc1
M v[64:67],a[252:255],a[196:199],v[64:67]
s_waitcnt vmcnt(10)
s_add_u32 s48,s74,43008
v_fmac_f32 v207,4.0,v209
v_fma_f32 v235,-4.0,v211,v215
M v[64:67],a[204:207],a[236:239],v[64:67]
s_waitcnt vmcnt(9)
v_fmac_f32 v205,s45,v215
v_fmac_f32 v207,s41,v213
M v[64:67],a[208:211],v[216:219],v[64:67]
v_sub_f32 v215,v215,v211
v_fma_f32 v211,-4.0,v209,v213
M v[68:71],a[208:211],a[192:195],v[68:71]
buffer_load_dwordx4 v[224:227],v250,s[20:23],s48 offen offset:0 sc1
M v[68:71],a[204:207],v[216:219],v[68:71]
v_sub_f32 v213,v213,v209
v_add_f32 v209,v235,v211
M v[68:71],a[252:255],a[236:239],v[68:71]
v_sub_f32 v235,v235,v211
v_fma_f32 v211,2.0,v213,v215
M v[72:75],a[252:255],v[216:219],v[72:75]
v_fmac_f32 v215,-2.0,v213
v_cvt_pk_bf16_f32 v205,v232,v205
M v[72:75],a[204:207],a[192:195],v[72:75]
buffer_load_dwordx4 a[196:199],v250,s[20:23],s48 offen offset:1024 sc1
M v[72:75],a[208:211],a[200:203],v[72:75]
v_cvt_pk_bf16_f32 v207,v237,v207
v_cvt_pk_bf16_f32 v209,v233,v209
M v[76:79],a[208:211],v[220:223],v[76:79]
v_cvt_pk_bf16_f32 v213,v234,v211
v_cvt_pk_bf16_f32 v211,v238,v235
M v[76:79],a[204:207],a[200:203],v[76:79]
v_cvt_pk_bf16_f32 v215,v236,v215
v_add_u32 v238,121856,v247
M v[76:79],a[252:255],a[192:195],v[76:79]
buffer_load_dwordx4 a[236:239],v250,s[20:23],s48 offen offset:2048 sc1
M v[80:83],a[252:255],a[200:203],v[80:83]
s_add_u32 s46,s75,9216
M v[80:83],a[204:207],v[220:223],v[80:83]
M v[80:83],a[208:211],a[212:215],v[80:83]
ds_write2st64_b64 v238,v[204:205],v[206:207] offset0:3 offset1:20
M v[84:87],a[208:211],a[216:219],v[84:87]
s_add_u32 s28,s70,393216
buffer_load_dwordx4 v[216:219],v250,s[20:23],s46 offen offset:0 sc1
M v[84:87],a[204:207],a[212:215],v[84:87]
ds_read_b128 a[192:195],v248 offset:26112
M v[84:87],a[252:255],v[220:223],v[84:87]
ds_write2st64_b64 v247,v[208:209],v[210:211] offset0:105 offset1:122
M v[88:91],a[252:255],a[212:215],v[88:91]
buffer_load_dwordx4 v[204:207],v251,s[88:91],s28 offen offset:0
M v[88:91],a[204:207],a[216:219],v[88:91]
ds_read_b128 a[200:203],v249 offset:26112
ds_read_b128 v[220:223],v248 offset:26624
M v[88:91],a[208:211],a[228:231],v[88:91]
ds_write2st64_b64 v247,v[212:213],v[214:215] offset0:139 offset1:156
M v[92:95],a[208:211],a[232:235],v[92:95]
buffer_load_dwordx4 v[208:211],v245,s[8:11],s28 offen offset:0
M v[92:95],a[204:207],a[228:231],v[92:95]
ds_read_b128 a[212:215],v249 offset:26624
M v[92:95],a[252:255],a[216:219],v[92:95]
s_waitcnt vmcnt(12) lgkmcnt(5)
v_permlane32_swap_b32 v196,v198
v_permlane32_swap_b32 v192,v194
M v[96:99],v[228:231],a[192:195],v[96:99]
s_waitcnt vmcnt(10) lgkmcnt(3)
ds_read_b128 a[208:211],v248 offset:27136
v_permlane32_swap_b32 v200,v202
M v[96:99],a[220:223],a[200:203],v[96:99]
s_waitcnt vmcnt(9) lgkmcnt(3)
buffer_load_dwordx4 v[212:215],v245,s[8:11],s28 offen offset:768
M v[96:99],a[224:227],v[220:223],v[96:99]
s_waitcnt lgkmcnt(1)
ds_read_b128 a[232:235],v249 offset:27136
v_lshlrev_b32 v234,16,v198
M v[100:103],a[224:227],a[212:215],v[100:103]
v_lshlrev_b32 v232,16,v192
v_lshlrev_b32 v233,16,v196
M v[100:103],a[220:223],v[220:223],v[100:103]
v_lshlrev_b32 v237,16,v194
v_lshlrev_b32 v236,16,v202
M v[100:103],v[228:231],a[200:203],v[100:103]
v_lshlrev_b32 v235,16,v200
v_fmac_f32 v232,s43,v234
M v[104:107],v[228:231],v[220:223],v[104:107]
ds_read_b128 a[204:207],v248 offset:27648
v_fmac_f32 v237,4.0,v233
M v[104:107],a[220:223],a[212:215],v[104:107]
s_waitcnt lgkmcnt(2)
ds_read_b128 a[228:231],v249 offset:27648
v_fma_f32 v238,-4.0,v234,v236
M v[104:107],a[224:227],a[208:211],v[104:107]
s_waitcnt lgkmcnt(2)
v_fmac_f32 v232,s45,v236
v_fmac_f32 v237,s41,v235
M v[108:111],a[224:227],a[232:235],v[108:111]
v_sub_f32 v236,v236,v234
v_fma_f32 v234,-4.0,v233,v235
M v[108:111],a[220:223],a[208:211],v[108:111]
v_sub_f32 v235,v235,v233
v_add_f32 v233,v238,v234
M v[108:111],v[228:231],a[212:215],v[108:111]
v_sub_f32 v238,v238,v234
v_fma_f32 v234,2.0,v235,v236
M v[112:115],v[228:231],a[208:211],v[112:115]
ds_read_b128 a[216:219],v249 offset:28160
v_fmac_f32 v236,-2.0,v235
M v[112:115],a[220:223],a[232:235],v[112:115]
s_waitcnt lgkmcnt(2)
ds_read_b128 a[252:255],v248 offset:28160
v_and_b32 v198,s42,v198
M v[112:115],a[224:227],a[204:207],v[112:115]
s_waitcnt lgkmcnt(2)
v_and_b32 v192,s42,v192
v_and_b32 v196,s42,v196
M v[116:119],a[224:227],a[228:231],v[116:119]
v_and_b32 v194,s42,v194
v_and_b32 v202,s42,v202
M v[116:119],a[220:223],a[204:207],v[116:119]
v_and_b32 v200,s42,v200
v_fmac_f32 v192,s43,v198
M v[116:119],v[228:231],a[232:235],v[116:119]
v_fmac_f32 v194,4.0,v196
v_fma_f32 v235,-4.0,v198,v202
M v[120:123],v[228:231],a[204:207],v[120:123]
v_fmac_f32 v192,s45,v202
v_fmac_f32 v194,s41,v200
M v[120:123],a[220:223],a[228:231],v[120:123]
s_waitcnt lgkmcnt(1)
v_sub_f32 v202,v202,v198
v_fma_f32 v198,-4.0,v196,v200
M v[120:123],a[224:227],a[216:219],v[120:123]
s_waitcnt lgkmcnt(0)
v_sub_f32 v200,v200,v196
v_add_f32 v196,v235,v198
M v[124:127],a[224:227],a[252:255],v[124:127]
buffer_load_dwordx4 a[224:227],v250,s[20:23],s46 offen offset:1024 sc1
M v[124:127],a[220:223],a[216:219],v[124:127]
v_sub_f32 v235,v235,v198
v_fma_f32 v198,2.0,v200,v202
M v[124:127],v[228:231],a[228:231],v[124:127]
s_waitcnt vmcnt(10)
buffer_load_dwordx4 a[220:223],v250,s[20:23],s46 offen offset:2048 sc1
M v[128:131],a[248:251],a[192:195],v[128:131]
s_waitcnt vmcnt(10)
s_add_u32 s47,s75,12288
v_fmac_f32 v202,-2.0,v200
v_cvt_pk_bf16_f32 v192,v232,v192
M v[128:131],a[240:243],a[200:203],v[128:131]
s_waitcnt vmcnt(9)
v_cvt_pk_bf16_f32 v194,v237,v194
v_cvt_pk_bf16_f32 v196,v233,v196
M v[128:131],a[244:247],v[220:223],v[128:131]
v_cvt_pk_bf16_f32 v200,v234,v198
v_cvt_pk_bf16_f32 v198,v238,v235
M v[132:135],a[244:247],a[212:215],v[132:135]
buffer_load_dwordx4 v[228:231],v250,s[20:23],s47 offen offset:0 sc1
M v[132:135],a[240:243],v[220:223],v[132:135]
v_cvt_pk_bf16_f32 v202,v236,v202
v_permlane32_swap_b32 v197,v199
M v[132:135],a[248:251],a[200:203],v[132:135]
v_permlane32_swap_b32 v193,v195
v_permlane32_swap_b32 v201,v203
M v[136:139],a[248:251],v[220:223],v[136:139]
v_lshlrev_b32 v234,16,v199
v_lshlrev_b32 v232,16,v193
M v[136:139],a[240:243],a[212:215],v[136:139]
v_lshlrev_b32 v233,16,v197
v_lshlrev_b32 v237,16,v195
M v[136:139],a[244:247],a[208:211],v[136:139]
v_lshlrev_b32 v236,16,v203
v_lshlrev_b32 v235,16,v201
M v[140:143],a[244:247],a[232:235],v[140:143]
v_fmac_f32 v232,s43,v234
v_fmac_f32 v237,4.0,v233
M v[140:143],a[240:243],a[208:211],v[140:143]
v_fma_f32 v238,-4.0,v234,v236
v_fmac_f32 v232,s45,v236
M v[140:143],a[248:251],a[212:215],v[140:143]
v_fmac_f32 v237,s41,v235
v_sub_f32 v236,v236,v234
M v[144:147],a[248:251],a[208:211],v[144:147]
v_fma_f32 v234,-4.0,v233,v235
v_sub_f32 v235,v235,v233
M v[144:147],a[240:243],a[232:235],v[144:147]
v_add_f32 v233,v238,v234
v_sub_f32 v238,v238,v234
M v[144:147],a[244:247],a[204:207],v[144:147]
v_fma_f32 v234,2.0,v235,v236
v_fmac_f32 v236,-2.0,v235
M v[148:151],a[244:247],a[228:231],v[148:151]
v_and_b32 v199,s42,v199
v_and_b32 v193,s42,v193
M v[148:151],a[240:243],a[204:207],v[148:151]
v_and_b32 v197,s42,v197
v_and_b32 v195,s42,v195
M v[148:151],a[248:251],a[232:235],v[148:151]
v_and_b32 v203,s42,v203
v_and_b32 v201,s42,v201
M v[152:155],a[248:251],a[204:207],v[152:155]
v_fmac_f32 v193,s43,v199
v_fmac_f32 v195,4.0,v197
M v[152:155],a[240:243],a[228:231],v[152:155]
v_fma_f32 v235,-4.0,v199,v203
v_fmac_f32 v193,s45,v203
M v[152:155],a[244:247],a[216:219],v[152:155]
v_fmac_f32 v195,s41,v201
v_sub_f32 v203,v203,v199
M v[156:159],a[244:247],a[252:255],v[156:159]
buffer_load_dwordx4 a[244:247],v250,s[20:23],s47 offen offset:1024 sc1
M v[156:159],a[240:243],a[216:219],v[156:159]
v_fma_f32 v199,-4.0,v197,v201
v_sub_f32 v201,v201,v197
M v[156:159],a[248:251],a[228:231],v[156:159]
s_waitcnt vmcnt(10)
buffer_load_dwordx4 a[240:243],v250,s[20:23],s47 offen offset:2048 sc1
M v[160:163],v[224:227],a[192:195],v[160:163]
s_waitcnt vmcnt(10)
s_add_u32 s48,s75,15360
v_add_f32 v197,v235,v199
v_sub_f32 v235,v235,v199
M v[160:163],a[196:199],a[200:203],v[160:163]
s_waitcnt vmcnt(9)
v_fma_f32 v199,2.0,v201,v203
v_fmac_f32 v203,-2.0,v201
M v[160:163],a[236:239],v[220:223],v[160:163]
v_cvt_pk_bf16_f32 v193,v232,v193
v_cvt_pk_bf16_f32 v195,v237,v195
M v[164:167],a[236:239],a[212:215],v[164:167]
buffer_load_dwordx4 a[248:251],v250,s[20:23],s48 offen offset:0 sc1
M v[164:167],a[196:199],v[220:223],v[164:167]
v_cvt_pk_bf16_f32 v197,v233,v197
v_cvt_pk_bf16_f32 v201,v234,v199
M v[164:167],v[224:227],a[200:203],v[164:167]
v_cvt_pk_bf16_f32 v199,v238,v235
v_cvt_pk_bf16_f32 v203,v236,v203
M v[168:171],v[224:227],v[220:223],v[168:171]
v_add_u32 v238,139264,v247
M v[168:171],a[196:199],a[212:215],v[168:171]
buffer_load_dwordx4 a[192:195],v250,s[20:23],s48 offen offset:1024 sc1
M v[168:171],a[236:239],a[208:211],v[168:171]
M v[172:175],a[236:239],a[232:235],v[172:175]
M v[172:175],a[196:199],a[208:211],v[172:175]
M v[172:175],v[224:227],a[212:215],v[172:175]
buffer_load_dwordx4 a[200:203],v250,s[20:23],s48 offen offset:2048 sc1
M v[176:179],v[224:227],a[208:211],v[176:179]
s_add_u32 s46,s75,18432
M v[176:179],a[196:199],a[232:235],v[176:179]
M v[176:179],a[236:239],a[204:207],v[176:179]
s_barrier
ds_write2st64_b64 v238,v[192:193],v[194:195] offset0:0 offset1:17
M v[180:183],a[236:239],a[228:231],v[180:183]
s_add_u32 s28,s70,786432
buffer_load_dwordx4 v[220:223],v250,s[20:23],s46 offen offset:0 sc1
M v[180:183],a[196:199],a[204:207],v[180:183]
ds_read_b128 a[212:215],v248 offset:34816
M v[180:183],v[224:227],a[232:235],v[180:183]
ds_write2st64_b64 v247,v[196:197],v[198:199] offset0:34 offset1:51
M v[184:187],v[224:227],a[204:207],v[184:187]
buffer_load_dwordx4 v[192:195],v251,s[88:91],s28 offen offset:0
M v[184:187],a[196:199],a[228:231],v[184:187]
ds_read_b128 a[208:211],v249 offset:34816
ds_read_b128 a[232:235],v248 offset:35328
M v[184:187],a[236:239],a[216:219],v[184:187]
ds_write2st64_b64 v247,v[200:201],v[202:203] offset0:68 offset1:85
M v[188:191],a[236:239],a[252:255],v[188:191]
buffer_load_dwordx4 v[196:199],v245,s[8:11],s28 offen offset:0
M v[188:191],a[196:199],a[216:219],v[188:191]
s_waitcnt vmcnt(12)
ds_read_b128 a[204:207],v249 offset:35328
v_permlane32_swap_b32 v208,v210
M v[188:191],v[224:227],a[228:231],v[188:191]
s_waitcnt vmcnt(11) lgkmcnt(5)
v_permlane32_swap_b32 v204,v206
v_permlane32_swap_b32 v212,v214
M a[0:3],v[216:219],a[212:215],a[0:3]
s_waitcnt vmcnt(10) lgkmcnt(3)
ds_read_b128 a[236:239],v248 offset:35840
v_lshlrev_b32 v234,16,v210
M a[0:3],a[224:227],a[208:211],a[0:3]
s_waitcnt vmcnt(9) lgkmcnt(3)
buffer_load_dwordx4 v[200:203],v245,s[8:11],s28 offen offset:768
M a[0:3],a[220:223],a[232:235],a[0:3]
s_waitcnt lgkmcnt(1)
ds_read_b128 a[252:255],v249 offset:35840
v_lshlrev_b32 v232,16,v204
M a[4:7],a[220:223],a[204:207],a[4:7]
v_lshlrev_b32 v233,16,v208
v_lshlrev_b32 v237,16,v206
M a[4:7],a[224:227],a[232:235],a[4:7]
v_lshlrev_b32 v236,16,v214
v_lshlrev_b32 v235,16,v212
M a[4:7],v[216:219],a[208:211],a[4:7]
v_fmac_f32 v232,s43,v234
v_fmac_f32 v237,4.0,v233
M a[8:11],v[216:219],a[232:235],a[8:11]
ds_read_b128 a[196:199],v248 offset:36352
v_fma_f32 v238,-4.0,v234,v236
M a[8:11],a[224:227],a[204:207],a[8:11]
s_waitcnt lgkmcnt(2)
ds_read_b128 a[216:219],v249 offset:36352
v_fmac_f32 v232,s45,v236
M a[8:11],a[220:223],a[236:239],a[8:11]
s_waitcnt lgkmcnt(2)
v_fmac_f32 v237,s41,v235
v_sub_f32 v236,v236,v234
M a[12:15],a[220:223],a[252:255],a[12:15]
v_fma_f32 v234,-4.0,v233,v235
v_sub_f32 v235,v235,v233
M a[12:15],a[224:227],a[236:239],a[12:15]
v_add_f32 v233,v238,v234
v_sub_f32 v238,v238,v234
M a[12:15],v[216:219],a[204:207],a[12:15]
v_fma_f32 v234,2.0,v235,v236
v_fmac_f32 v236,-2.0,v235
M a[16:19],v[216:219],a[236:239],a[16:19]
ds_read_b128 a[228:231],v249 offset:36864
v_and_b32 v210,s42,v210
M a[16:19],a[224:227],a[252:255],a[16:19]
s_waitcnt lgkmcnt(2)
ds_read_b128 v[224:227],v248 offset:36864
v_and_b32 v204,s42,v204
M a[16:19],a[220:223],a[196:199],a[16:19]
s_waitcnt lgkmcnt(2)
v_and_b32 v208,s42,v208
v_and_b32 v206,s42,v206
M a[20:23],a[220:223],a[216:219],a[20:23]
v_and_b32 v214,s42,v214
v_and_b32 v212,s42,v212
M a[20:23],a[224:227],a[196:199],a[20:23]
v_fmac_f32 v204,s43,v210
v_fmac_f32 v206,4.0,v208
M a[20:23],v[216:219],a[252:255],a[20:23]
v_fma_f32 v235,-4.0,v210,v214
v_fmac_f32 v204,s45,v214
M a[24:27],v[216:219],a[196:199],a[24:27]
v_fmac_f32 v206,s41,v212
v_sub_f32 v214,v214,v210
M a[24:27],a[224:227],a[216:219],a[24:27]
s_waitcnt lgkmcnt(1)
v_fma_f32 v210,-4.0,v208,v212
v_sub_f32 v212,v212,v208
M a[24:27],a[220:223],a[228:231],a[24:27]
s_waitcnt lgkmcnt(0)
v_add_f32 v208,v235,v210
v_sub_f32 v235,v235,v210
M a[28:31],a[220:223],v[224:227],a[28:31]
buffer_load_dwordx4 a[220:223],v250,s[20:23],s46 offen offset:1024 sc1
M a[28:31],a[224:227],a[228:231],a[28:31]
v_fma_f32 v210,2.0,v212,v214
v_fmac_f32 v214,-2.0,v212
M a[28:31],v[216:219],a[216:219],a[28:31]
s_waitcnt vmcnt(10)
buffer_load_dwordx4 a[224:227],v250,s[20:23],s46 offen offset:2048 sc1
M a[32:35],v[228:231],a[212:215],a[32:35]
s_waitcnt vmcnt(10)
s_add_u32 s47,s75,21504
v_cvt_pk_bf16_f32 v204,v232,v204
v_cvt_pk_bf16_f32 v206,v237,v206
M a[32:35],a[244:247],a[208:211],a[32:35]
s_waitcnt vmcnt(9)
v_cvt_pk_bf16_f32 v208,v233,v208
v_cvt_pk_bf16_f32 v212,v234,v210
M a[32:35],a[240:243],a[232:235],a[32:35]
v_cvt_pk_bf16_f32 v210,v238,v235
v_cvt_pk_bf16_f32 v214,v236,v214
M a[36:39],a[240:243],a[204:207],a[36:39]
buffer_load_dwordx4 v[216:219],v250,s[20:23],s47 offen offset:0 sc1
M a[36:39],a[244:247],a[232:235],a[36:39]
v_permlane32_swap_b32 v209,v211
v_permlane32_swap_b32 v205,v207
M a[36:39],v[228:231],a[208:211],a[36:39]
v_permlane32_swap_b32 v213,v215
v_lshlrev_b32 v234,16,v211
M a[40:43],v[228:231],a[232:235],a[40:43]
v_lshlrev_b32 v232,16,v205
v_lshlrev_b32 v233,16,v209
M a[40:43],a[244:247],a[204:207],a[40:43]
v_lshlrev_b32 v237,16,v207
v_lshlrev_b32 v236,16,v215
M a[40:43],a[240:243],a[236:239],a[40:43]
v_lshlrev_b32 v235,16,v213
v_fmac_f32 v232,s43,v234
M a[44:47],a[240:243],a[252:255],a[44:47]
v_fmac_f32 v237,4.0,v233
v_fma_f32 v238,-4.0,v234,v236
M a[44:47],a[244:247],a[236:239],a[44:47]
v_fmac_f32 v232,s45,v236
v_fmac_f32 v237,s41,v235
M a[44:47],v[228:231],a[204:207],a[44:47]
v_sub_f32 v236,v236,v234
v_fma_f32 v234,-4.0,v233,v235
M a[48:51],v[228:231],a[236:239],a[48:51]
v_sub_f32 v235,v235,v233
v_add_f32 v233,v238,v234
M a[48:51],a[244:247],a[252:255],a[48:51]
v_sub_f32 v238,v238,v234
v_fma_f32 v234,2.0,v235,v236
M a[48:51],a[240:243],a[196:199],a[48:51]
v_fmac_f32 v236,-2.0,v235
v_and_b32 v211,s42,v211
M a[52:55],a[240:243],a[216:219],a[52:55]
v_and_b32 v205,s42,v205
v_and_b32 v209,s42,v209
M a[52:55],a[244:247],a[196:199],a[52:55]
v_and_b32 v207,s42,v207
v_and_b32 v215,s42,v215
M a[52:55],v[228:231],a[252:255],a[52:55]
v_and_b32 v213,s42,v213
v_fmac_f32 v205,s43,v211
M a[56:59],v[228:231],a[196:199],a[56:59]
v_fmac_f32 v207,4.0,v209
v_fma_f32 v235,-4.0,v211,v215
M a[56:59],a[244:247],a[216:219],a[56:59]
v_fmac_f32 v205,s45,v215
v_fmac_f32 v207,s41,v213
M a[56:59],a[240:243],a[228:231],a[56:59]
v_sub_f32 v215,v215,v211
v_fma_f32 v211,-4.0,v209,v213
M a[60:63],a[240:243],v[224:227],a[60:63]
buffer_load_dwordx4 a[240:243],v250,s[20:23],s47 offen offset:1024 sc1
M a[60:63],a[244:247],a[228:231],a[60:63]
v_sub_f32 v213,v213,v209
v_add_f32 v209,v235,v211
M a[60:63],v[228:231],a[216:219],a[60:63]
s_waitcnt vmcnt(10)
buffer_load_dwordx4 a[244:247],v250,s[20:23],s47 offen offset:2048 sc1
M a[64:67],a[248:251],a[212:215],a[64:67]
s_waitcnt vmcnt(10)
s_add_u32 s48,s75,24576
v_sub_f32 v235,v235,v211
v_fma_f32 v211,2.0,v213,v215
M a[64:67],a[192:195],a[208:211],a[64:67]
s_waitcnt vmcnt(9)
v_fmac_f32 v215,-2.0,v213
v_cvt_pk_bf16_f32 v205,v232,v205
M a[64:67],a[200:203],a[232:235],a[64:67]
v_cvt_pk_bf16_f32 v207,v237,v207
v_cvt_pk_bf16_f32 v209,v233,v209
M a[68:71],a[200:203],a[204:207],a[68:71]
buffer_load_dwordx4 v[228:231],v250,s[20:23],s48 offen offset:0 sc1
M a[68:71],a[192:195],a[232:235],a[68:71]
v_cvt_pk_bf16_f32 v213,v234,v211
v_cvt_pk_bf16_f32 v211,v238,v235
M a[68:71],a[248:251],a[208:211],a[68:71]
v_cvt_pk_bf16_f32 v215,v236,v215
v_add_u32 v238,139264,v247
M a[72:75],a[248:251],a[232:235],a[72:75]
v_fmac_f32 v239,s43,v241
v_fmac_f32 v244,4.0,v240
M a[72:75],a[192:195],a[204:207],a[72:75]
buffer_load_dwordx4 a[212:215],v250,s[20:23],s48 offen offset:1024 sc1
M a[72:75],a[200:203],a[236:239],a[72:75]
ds_write2st64_b64 v238,v[204:205],v[206:207] offset0:1 offset1:18
M a[76:79],a[200:203],a[252:255],a[76:79]
s_add_u32 s28,s70,1179648
v_fma_f32 v232,-4.0,v241,v243
v_fmac_f32 v239,s45,v243
M a[76:79],a[192:195],a[236:239],a[76:79]
v_fmac_f32 v244,s41,v242
v_sub_f32 v243,v243,v241
M a[76:79],a[248:251],a[204:207],a[76:79]
buffer_load_dwordx4 a[208:211],v250,s[20:23],s48 offen offset:2048 sc1
M a[80:83],a[248:251],a[236:239],a[80:83]
s_add_u32 s46,s75,27648
v_fma_f32 v241,-4.0,v240,v242
v_sub_f32 v242,v242,v240
M a[80:83],a[192:195],a[252:255],a[80:83]
v_add_f32 v240,v232,v241
v_sub_f32 v232,v232,v241
M a[80:83],a[200:203],a[196:199],a[80:83]
ds_write2st64_b64 v247,v[208:209],v[210:211] offset0:35 offset1:52
M a[84:87],a[200:203],a[216:219],a[84:87]
buffer_load_dwordx4 a[232:235],v250,s[20:23],s46 offen offset:0 sc1
M a[84:87],a[192:195],a[196:199],a[84:87]
ds_read_b128 a[204:207],v248 offset:43520
v_fma_f32 v241,2.0,v242,v243
M a[84:87],a[248:251],a[252:255],a[84:87]
ds_write2st64_b64 v247,v[212:213],v[214:215] offset0:69 offset1:86
M a[88:91],a[248:251],a[196:199],a[88:91]
buffer_load_dwordx4 v[204:207],v251,s[88:91],s28 offen offset:0
M a[88:91],a[192:195],a[216:219],a[88:91]
ds_read_b128 a[236:239],v249 offset:43520
ds_read_b128 a[252:255],v248 offset:44032
M a[88:91],a[200:203],a[228:231],a[88:91]
ds_read_b128 a[196:199],v249 offset:44032
v_fmac_f32 v243,-2.0,v242
M a[92:95],a[200:203],v[224:227],a[92:95]
buffer_load_dwordx4 v[208:211],v245,s[8:11],s28 offen offset:0
M a[92:95],a[192:195],a[228:231],a[92:95]
v_cvt_pk_bf16_f32 v233,v239,v244
v_cvt_pk_bf16_f32 v234,v240,v232
M a[92:95],a[248:251],a[216:219],a[92:95]
s_waitcnt vmcnt(14) lgkmcnt(4)
v_cvt_pk_bf16_f32 v235,v241,v243
v_add_u32 v232,139264,v252
M a[96:99],v[220:223],a[204:207],a[96:99]
s_waitcnt vmcnt(10) lgkmcnt(2)
ds_read_b128 a[200:203],v248 offset:44544
ds_write_b16 v232,v233 offset:0
M a[96:99],a[220:223],a[236:239],a[96:99]
s_waitcnt vmcnt(9) lgkmcnt(3)
buffer_load_dwordx4 v[212:215],v245,s[8:11],s28 offen offset:768
M a[96:99],a[224:227],a[252:255],a[96:99]
s_waitcnt lgkmcnt(2)
s_add_u32 s29,s71,0
ds_read_b128 v[224:227],v249 offset:44544
ds_write_b16_d16_hi v232,v233 offset:8704
M a[100:103],a[224:227],a[196:199],a[100:103]
ds_write_b16 v252,v234 offset:17408
M a[100:103],a[220:223],a[252:255],a[100:103]
ds_write_b16_d16_hi v252,v234 offset:26112
M a[100:103],v[220:223],a[236:239],a[100:103]
buffer_load_short_d16_hi v239,v246,s[12:15],s29 offen offset:0
M a[104:107],v[220:223],a[252:255],a[104:107]
ds_read_b128 a[192:195],v248 offset:45056
ds_write_b16 v252,v235 offset:34816
M a[104:107],a[220:223],a[196:199],a[104:107]
s_waitcnt lgkmcnt(7)
buffer_load_short_d16_hi v240,v246,s[8:11],s29 offen offset:0
M a[104:107],a[224:227],a[200:203],a[104:107]
s_waitcnt lgkmcnt(5)
buffer_load_short_d16_hi v241,v246,s[8:11],s29 offen offset:384
M a[108:111],a[224:227],v[224:227],a[108:111]
ds_read_b128 a[228:231],v249 offset:45056
ds_write_b16_d16_hi v252,v235 offset:43520
M a[108:111],a[220:223],a[200:203],a[108:111]
buffer_load_short_d16_hi v242,v246,s[8:11],s29 offen offset:768
M a[108:111],v[220:223],a[196:199],a[108:111]
v_permlane32_swap_b32 v196,v198
v_permlane32_swap_b32 v192,v194
M a[112:115],v[220:223],a[200:203],a[112:115]
buffer_load_short_d16_hi v243,v246,s[8:11],s29 offen offset:1152
M a[112:115],a[220:223],v[224:227],a[112:115]
s_waitcnt lgkmcnt(3)
ds_read_b128 a[216:219],v249 offset:45568
ds_read_b128 a[248:251],v248 offset:45568
M a[112:115],a[224:227],a[192:195],a[112:115]
s_waitcnt lgkmcnt(3)
buffer_load_short_d16_hi v244,v246,s[16:19],s29 offen offset:1536
M a[116:119],a[224:227],a[228:231],a[116:119]
v_permlane32_swap_b32 v200,v202
v_lshlrev_b32 v234,16,v198
M a[116:119],a[220:223],a[192:195],a[116:119]
v_lshlrev_b32 v232,16,v192
v_lshlrev_b32 v233,16,v196
M a[116:119],v[220:223],v[224:227],a[116:119]
v_lshlrev_b32 v237,16,v194
v_lshlrev_b32 v236,16,v202
M a[120:123],v[220:223],a[192:195],a[120:123]
v_lshlrev_b32 v235,16,v200
v_fmac_f32 v232,s43,v234
M a[120:123],a[220:223],a[228:231],a[120:123]
s_waitcnt lgkmcnt(1)
v_fmac_f32 v237,4.0,v233
v_fma_f32 v238,-4.0,v234,v236
M a[120:123],a[224:227],a[216:219],a[120:123]
s_waitcnt lgkmcnt(0)
v_fmac_f32 v232,s45,v236
v_fmac_f32 v237,s41,v235
M a[124:127],a[224:227],a[248:251],a[124:127]
buffer_load_dwordx4 a[224:227],v250,s[20:23],s46 offen offset:1024 sc1
M a[124:127],a[220:223],a[216:219],a[124:127]
v_sub_f32 v236,v236,v234
v_fma_f32 v234,-4.0,v233,v235
M a[124:127],v[220:223],a[228:231],a[124:127]
s_waitcnt vmcnt(16)
buffer_load_dwordx4 a[220:223],v250,s[20:23],s46 offen offset:2048 sc1
M a[128:131],v[216:219],a[204:207],a[128:131]
s_waitcnt vmcnt(16)
s_add_u32 s47,s75,30720
v_sub_f32 v235,v235,v233
v_add_f32 v233,v238,v234
M a[128:131],a[240:243],a[236:239],a[128:131]
s_waitcnt vmcnt(15)
v_sub_f32 v238,v238,v234
v_fma_f32 v234,2.0,v235,v236
M a[128:131],a[244:247],a[252:255],a[128:131]
v_fmac_f32 v236,-2.0,v235
v_and_b32 v198,s42,v198
M a[132:135],a[244:247],a[196:199],a[132:135]
buffer_load_dwordx4 v[220:223],v250,s[20:23],s47 offen offset:0 sc1
M a[132:135],a[240:243],a[252:255],a[132:135]
v_and_b32 v192,s42,v192
v_and_b32 v196,s42,v196
M a[132:135],v[216:219],a[236:239],a[132:135]
v_and_b32 v194,s42,v194
v_and_b32 v202,s42,v202
M a[136:139],v[216:219],a[252:255],a[136:139]
v_and_b32 v200,s42,v200
v_fmac_f32 v192,s43,v198
M a[136:139],a[240:243],a[196:199],a[136:139]
v_fmac_f32 v194,4.0,v196
v_fma_f32 v235,-4.0,v198,v202
M a[136:139],a[244:247],a[200:203],a[136:139]
v_fmac_f32 v192,s45,v202
v_fmac_f32 v194,s41,v200
M a[140:143],a[244:247],v[224:227],a[140:143]
v_sub_f32 v202,v202,v198
v_fma_f32 v198,-4.0,v196,v200
M a[140:143],a[240:243],a[200:203],a[140:143]
v_sub_f32 v200,v200,v196
v_add_f32 v196,v235,v198
M a[140:143],v[216:219],a[196:199],a[140:143]
v_sub_f32 v235,v235,v198
v_fma_f32 v198,2.0,v200,v202
M a[144:147],v[216:219],a[200:203],a[144:147]
v_fmac_f32 v202,-2.0,v200
v_cvt_pk_bf16_f32 v192,v232,v192
M a[144:147],a[240:243],v[224:227],a[144:147]
v_cvt_pk_bf16_f32 v194,v237,v194
v_cvt_pk_bf16_f32 v196,v233,v196
M a[144:147],a[244:247],a[192:195],a[144:147]
v_cvt_pk_bf16_f32 v200,v234,v198
v_cvt_pk_bf16_f32 v198,v238,v235
M a[148:151],a[244:247],a[228:231],a[148:151]
v_cvt_pk_bf16_f32 v202,v236,v202
v_permlane32_swap_b32 v197,v199
M a[148:151],a[240:243],a[192:195],a[148:151]
v_permlane32_swap_b32 v193,v195
v_permlane32_swap_b32 v201,v203
M a[148:151],v[216:219],v[224:227],a[148:151]
v_lshlrev_b32 v234,16,v199
v_lshlrev_b32 v232,16,v193
M a[152:155],v[216:219],a[192:195],a[152:155]
v_lshlrev_b32 v233,16,v197
v_lshlrev_b32 v237,16,v195
M a[152:155],a[240:243],a[228:231],a[152:155]
v_lshlrev_b32 v236,16,v203
v_lshlrev_b32 v235,16,v201
M a[152:155],a[244:247],a[216:219],a[152:155]
v_fmac_f32 v232,s43,v234
v_fmac_f32 v237,4.0,v233
M a[156:159],a[244:247],a[248:251],a[156:159]
buffer_load_dwordx4 a[244:247],v250,s[20:23],s47 offen offset:1024 sc1
M a[156:159],a[240:243],a[216:219],a[156:159]
v_fma_f32 v238,-4.0,v234,v236
v_fmac_f32 v232,s45,v236
M a[156:159],v[216:219],a[228:231],a[156:159]
s_waitcnt vmcnt(16)
buffer_load_dwordx4 a[240:243],v250,s[20:23],s47 offen offset:2048 sc1
M a[160:163],v[228:231],a[204:207],a[160:163]
s_waitcnt vmcnt(16)
s_add_u32 s48,s75,33792
v_fmac_f32 v237,s41,v235
v_sub_f32 v236,v236,v234
M a[160:163],a[212:215],a[236:239],a[160:163]
s_waitcnt vmcnt(15)
v_fma_f32 v234,-4.0,v233,v235
v_sub_f32 v235,v235,v233
M a[160:163],a[208:211],a[252:255],a[160:163]
v_add_f32 v233,v238,v234
v_sub_f32 v238,v238,v234
M a[164:167],a[208:211],a[196:199],a[164:167]
buffer_load_dwordx4 v[216:219],v250,s[20:23],s48 offen offset:0 sc1
M a[164:167],a[212:215],a[252:255],a[164:167]
v_fma_f32 v234,2.0,v235,v236
v_fmac_f32 v236,-2.0,v235
M a[164:167],v[228:231],a[236:239],a[164:167]
v_and_b32 v199,s42,v199
v_and_b32 v193,s42,v193
M a[168:171],v[228:231],a[252:255],a[168:171]
v_and_b32 v197,s42,v197
v_and_b32 v195,s42,v195
M a[168:171],a[212:215],a[196:199],a[168:171]
buffer_load_dwordx4 a[204:207],v250,s[20:23],s48 offen offset:1024 sc1
M a[168:171],a[208:211],a[200:203],a[168:171]
v_and_b32 v203,s42,v203
v_and_b32 v201,s42,v201
M a[172:175],a[208:211],v[224:227],a[172:175]
v_fmac_f32 v193,s43,v199
v_fmac_f32 v195,4.0,v197
M a[172:175],a[212:215],a[200:203],a[172:175]
v_fma_f32 v235,-4.0,v199,v203
v_fmac_f32 v193,s45,v203
M a[172:175],v[228:231],a[196:199],a[172:175]
buffer_load_dwordx4 a[236:239],v250,s[20:23],s48 offen offset:2048 sc1
M a[176:179],v[228:231],a[200:203],a[176:179]
s_add_u32 s46,s75,36864
v_fmac_f32 v195,s41,v201
v_sub_f32 v203,v203,v199
M a[176:179],a[212:215],v[224:227],a[176:179]
v_fma_f32 v199,-4.0,v197,v201
v_sub_f32 v201,v201,v197
M a[176:179],a[208:211],a[192:195],a[176:179]
v_add_f32 v197,v235,v199
v_sub_f32 v235,v235,v199
M a[180:183],a[208:211],a[228:231],a[180:183]
buffer_load_dwordx4 a[252:255],v250,s[20:23],s46 offen offset:0 sc1
M a[180:183],a[212:215],a[192:195],a[180:183]
ds_read_b128 a[196:199],v248 offset:52224
v_fma_f32 v199,2.0,v201,v203
M a[180:183],v[228:231],v[224:227],a[180:183]
ds_read_b128 a[200:203],v249 offset:52224
v_fmac_f32 v203,-2.0,v201
M a[184:187],v[228:231],a[192:195],a[184:187]
ds_read_b128 v[224:227],v248 offset:52736
v_cvt_pk_bf16_f32 v193,v232,v193
M a[184:187],a[212:215],a[228:231],a[184:187]
ds_read_b128 a[192:195],v249 offset:52736
v_cvt_pk_bf16_f32 v195,v237,v195
M a[184:187],a[208:211],a[216:219],a[184:187]
v_cvt_pk_bf16_f32 v197,v233,v197
v_cvt_pk_bf16_f32 v201,v234,v199
M a[188:191],a[208:211],a[248:251],a[188:191]
v_cvt_pk_bf16_f32 v199,v238,v235
v_cvt_pk_bf16_f32 v203,v236,v203
M a[188:191],a[212:215],a[216:219],a[188:191]
s_waitcnt vmcnt(16)
v_add_u32 v238,139264,v247
v_permlane32_swap_b32 v208,v210
M a[188:191],v[228:231],a[228:231],a[188:191]
s_waitcnt lgkmcnt(3)
ds_write2st64_b64 v238,v[192:193],v[194:195] offset0:2 offset1:19
M v[0:3],a[232:235],a[196:199],v[0:3]
s_waitcnt vmcnt(8) lgkmcnt(3)
s_add_u32 s28,s71,0
ds_read_b128 a[208:211],v248 offset:53248
s_mov_b64 exec,s[86:87]
v_xor_b32 v245,0x80000000,v245
v_xor_b32 v251,0x80000000,v251
s_mov_b64 exec,-1
M v[0:3],a[224:227],a[200:203],v[0:3]
s_waitcnt vmcnt(7) lgkmcnt(3)
buffer_load_dwordx4 v[192:195],v251,s[88:91],s28 offen offset:0
M v[0:3],a[220:223],v[224:227],v[0:3]
s_waitcnt lgkmcnt(2)
ds_write2st64_b64 v247,v[196:197],v[198:199] offset0:36 offset1:53
M v[4:7],a[220:223],a[192:195],v[4:7]
buffer_load_dwordx4 v[196:199],v245,s[8:11],s28 offen offset:0
M v[4:7],a[224:227],v[224:227],v[4:7]
ds_read_b128 a[248:251],v249 offset:53248
v_permlane32_swap_b32 v204,v206
M v[4:7],a[232:235],a[200:203],v[4:7]
ds_write2st64_b64 v247,v[200:201],v[202:203] offset0:70 offset1:87
M v[8:11],a[232:235],v[224:227],v[8:11]
buffer_load_dwordx4 v[200:203],v245,s[8:11],s28 offen offset:768
M v[8:11],a[224:227],a[192:195],v[8:11]
s_waitcnt lgkmcnt(3)
ds_read_b128 a[212:215],v248 offset:53760
ds_read_b128 a[216:219],v249 offset:53760
M v[8:11],a[220:223],a[208:211],v[8:11]
s_waitcnt lgkmcnt(3)
s_mov_b64 exec,s[86:87]
v_xor_b32 v245,0x80000000,v245
v_xor_b32 v251,0x80000000,v251
s_mov_b64 exec,-1
v_permlane32_swap_b32 v212,v214
M v[12:15],a[220:223],a[248:251],v[12:15]
v_lshlrev_b32 v234,16,v210
v_lshlrev_b32 v232,16,v204
M v[12:15],a[224:227],a[208:211],v[12:15]
v_lshlrev_b32 v233,16,v208
v_lshlrev_b32 v237,16,v206
M v[12:15],a[232:235],a[192:195],v[12:15]
v_lshlrev_b32 v236,16,v214
v_lshlrev_b32 v235,16,v212
M v[16:19],a[232:235],a[208:211],v[16:19]
ds_read_b128 a[228:231],v249 offset:54272
v_fmac_f32 v232,s43,v234
M v[16:19],a[224:227],a[248:251],v[16:19]
s_waitcnt lgkmcnt(2)
ds_read_b128 v[228:231],v248 offset:54272
v_fmac_f32 v237,4.0,v233
M v[16:19],a[220:223],a[212:215],v[16:19]
s_waitcnt lgkmcnt(2)
v_fma_f32 v238,-4.0,v234,v236
v_fmac_f32 v232,s45,v236
M v[20:23],a[220:223],a[216:219],v[20:23]
v_fmac_f32 v237,s41,v235
v_sub_f32 v236,v236,v234
M v[20:23],a[224:227],a[212:215],v[20:23]
v_fma_f32 v234,-4.0,v233,v235
v_sub_f32 v235,v235,v233
M v[20:23],a[232:235],a[248:251],v[20:23]
v_add_f32 v233,v238,v234
v_sub_f32 v238,v238,v234
M v[24:27],a[232:235],a[212:215],v[24:27]
v_fma_f32 v234,2.0,v235,v236
v_fmac_f32 v236,-2.0,v235
M v[24:27],a[224:227],a[216:219],v[24:27]
s_waitcnt lgkmcnt(1)
v_and_b32 v210,s42,v210
v_and_b32 v204,s42,v204
M v[24:27],a[220:223],a[228:231],v[24:27]
s_waitcnt lgkmcnt(0)
v_and_b32 v208,s42,v208
v_and_b32 v206,s42,v206
M v[28:31],a[220:223],v[228:231],v[28:31]
global_load_dword a220,v250,s[64:65]
M v[28:31],a[224:227],a[228:231],v[28:31]
buffer_load_dwordx4 a[220:223],v250,s[20:23],s46 offen offset:1024 sc1
M v[28:31],a[232:235],a[216:219],v[28:31]
s_waitcnt vmcnt(11)
v_and_b32 v214,s42,v214
v_and_b32 v212,s42,v212
M v[32:35],v[220:223],a[196:199],v[32:35]
s_waitcnt vmcnt(10)
v_fmac_f32 v204,s43,v210
v_fmac_f32 v206,4.0,v208
M v[32:35],a[244:247],a[200:203],v[32:35]
s_waitcnt vmcnt(9)
buffer_load_dwordx4 a[224:227],v250,s[20:23],s46 offen offset:2048 sc1
M v[32:35],a[240:243],v[224:227],v[32:35]
s_add_u32 s47,s75,39936
v_fma_f32 v235,-4.0,v210,v214
v_fmac_f32 v204,s45,v214
M v[36:39],a[240:243],a[192:195],v[36:39]
v_fmac_f32 v206,s41,v212
v_sub_f32 v214,v214,v210
M v[36:39],a[244:247],v[224:227],v[36:39]
v_fma_f32 v210,-4.0,v208,v212
v_sub_f32 v212,v212,v208
M v[36:39],v[220:223],a[200:203],v[36:39]
buffer_load_dwordx4 a[232:235],v250,s[20:23],s47 offen offset:0 sc1
M v[40:43],v[220:223],v[224:227],v[40:43]
v_add_f32 v208,v235,v210
v_sub_f32 v235,v235,v210
M v[40:43],a[244:247],a[192:195],v[40:43]
v_fma_f32 v210,2.0,v212,v214
v_fmac_f32 v214,-2.0,v212
M v[40:43],a[240:243],a[208:211],v[40:43]
v_cvt_pk_bf16_f32 v204,v232,v204
v_cvt_pk_bf16_f32 v206,v237,v206
M v[44:47],a[240:243],a[248:251],v[44:47]
v_cvt_pk_bf16_f32 v208,v233,v208
v_cvt_pk_bf16_f32 v212,v234,v210
M v[44:47],a[244:247],a[208:211],v[44:47]
v_cvt_pk_bf16_f32 v210,v238,v235
v_cvt_pk_bf16_f32 v214,v236,v214
M v[44:47],v[220:223],a[192:195],v[44:47]
v_permlane32_swap_b32 v209,v211
v_permlane32_swap_b32 v205,v207
M v[48:51],v[220:223],a[208:211],v[48:51]
v_permlane32_swap_b32 v213,v215
v_lshlrev_b32 v234,16,v211
M v[48:51],a[244:247],a[248:251],v[48:51]
v_lshlrev_b32 v232,16,v205
v_lshlrev_b32 v233,16,v209
M v[48:51],a[240:243],a[212:215],v[48:51]
v_lshlrev_b32 v237,16,v207
v_lshlrev_b32 v236,16,v215
M v[52:55],a[240:243],a[216:219],v[52:55]
v_lshlrev_b32 v235,16,v213
v_fmac_f32 v232,s43,v234
M v[52:55],a[244:247],a[212:215],v[52:55]
v_fmac_f32 v237,4.0,v233
v_fma_f32 v238,-4.0,v234,v236
M v[52:55],v[220:223],a[248:251],v[52:55]
v_fmac_f32 v232,s45,v236
v_fmac_f32 v237,s41,v235
M v[56:59],v[220:223],a[212:215],v[56:59]
v_sub_f32 v236,v236,v234
v_fma_f32 v234,-4.0,v233,v235
M v[56:59],a[244:247],a[216:219],v[56:59]
v_sub_f32 v235,v235,v233
v_add_f32 v233,v238,v234
M v[56:59],a[240:243],a[228:231],v[56:59]
v_sub_f32 v238,v238,v234
v_fma_f32 v234,2.0,v235,v236
M v[60:63],a[240:243],v[228:231],v[60:63]
buffer_load_dwordx4 a[240:243],v250,s[20:23],s47 offen offset:1024 sc1
M v[60:63],a[244:247],a[228:231],v[60:63]
v_fmac_f32 v236,-2.0,v235
v_and_b32 v211,s42,v211
M v[60:63],v[220:223],a[216:219],v[60:63]
s_waitcnt vmcnt(11)
buffer_load_dwordx4 a[244:247],v250,s[20:23],s47 offen offset:2048 sc1
M v[64:67],v[216:219],a[196:199],v[64:67]
s_waitcnt vmcnt(11)
s_add_u32 s48,s75,43008
v_and_b32 v205,s42,v205
v_and_b32 v209,s42,v209
M v[64:67],a[204:207],a[200:203],v[64:67]
s_waitcnt vmcnt(10)
v_and_b32 v207,s42,v207
v_and_b32 v215,s42,v215
M v[64:67],a[236:239],v[224:227],v[64:67]
v_and_b32 v213,s42,v213
v_fmac_f32 v205,s43,v211
M v[68:71],a[236:239],a[192:195],v[68:71]
buffer_load_dwordx4 v[220:223],v250,s[20:23],s48 offen offset:0 sc1
M v[68:71],a[204:207],v[224:227],v[68:71]
v_fmac_f32 v207,4.0,v209
v_fma_f32 v235,-4.0,v211,v215
M v[68:71],v[216:219],a[200:203],v[68:71]
v_fmac_f32 v205,s45,v215
v_fmac_f32 v207,s41,v213
M v[72:75],v[216:219],v[224:227],v[72:75]
v_sub_f32 v215,v215,v211
v_fma_f32 v211,-4.0,v209,v213
M v[72:75],a[204:207],a[192:195],v[72:75]
buffer_load_dwordx4 a[196:199],v250,s[20:23],s48 offen offset:1024 sc1
M v[72:75],a[236:239],a[208:211],v[72:75]
v_sub_f32 v213,v213,v209
v_add_f32 v209,v235,v211
M v[76:79],a[236:239],a[248:251],v[76:79]
v_sub_f32 v235,v235,v211
v_fma_f32 v211,2.0,v213,v215
M v[76:79],a[204:207],a[208:211],v[76:79]
v_fmac_f32 v215,-2.0,v213
v_cvt_pk_bf16_f32 v205,v232,v205
M v[76:79],v[216:219],a[192:195],v[76:79]
buffer_load_dwordx4 a[200:203],v250,s[20:23],s48 offen offset:2048 sc1
M v[80:83],v[216:219],a[208:211],v[80:83]
s_add_u32 s46,s76,9216
v_cvt_pk_bf16_f32 v207,v237,v207
v_cvt_pk_bf16_f32 v209,v233,v209
M v[80:83],a[204:207],a[248:251],v[80:83]
v_cvt_pk_bf16_f32 v213,v234,v211
v_cvt_pk_bf16_f32 v211,v238,v235
M v[80:83],a[236:239],a[212:215],v[80:83]
v_cvt_pk_bf16_f32 v215,v236,v215
v_add_u32 v238,139264,v247
M v[84:87],a[236:239],a[216:219],v[84:87]
buffer_load_dwordx4 v[224:227],v250,s[20:23],s46 offen offset:0 sc1
M v[84:87],a[204:207],a[212:215],v[84:87]
s_waitcnt vmcnt(11)
ds_read_b128 a[192:195],v248 offset:60928
v_permlane32_swap_b32 v196,v198
M v[84:87],v[216:219],a[248:251],v[84:87]
ds_write2st64_b64 v238,v[204:205],v[206:207] offset0:3 offset1:20
M v[88:91],v[216:219],a[212:215],v[88:91]
s_add_u32 s28,s71,393216
ds_read_b128 a[208:211],v249 offset:60928
ds_read_b128 a[248:251],v248 offset:61440
M v[88:91],a[204:207],a[216:219],v[88:91]
buffer_load_dwordx4 v[204:207],v251,s[88:91],s28 offen offset:0
M v[88:91],a[236:239],a[228:231],v[88:91]
ds_write2st64_b64 v247,v[208:209],v[210:211] offset0:37 offset1:54
M v[92:95],a[236:239],v[228:231],v[92:95]
ds_read_b128 a[212:215],v249 offset:61440
v_permlane32_swap_b32 v192,v194
M v[92:95],a[204:207],a[228:231],v[92:95]
buffer_load_dwordx4 v[208:211],v245,s[8:11],s28 offen offset:0
M v[92:95],v[216:219],a[216:219],v[92:95]
s_waitcnt lgkmcnt(5)
ds_write2st64_b64 v247,v[212:213],v[214:215] offset0:71 offset1:88
M v[96:99],a[252:255],a[192:195],v[96:99]
s_waitcnt vmcnt(10) lgkmcnt(4)
ds_read_b128 a[236:239],v248 offset:61952
v_permlane32_swap_b32 v200,v202
M v[96:99],a[220:223],a[208:211],v[96:99]
s_waitcnt vmcnt(9) lgkmcnt(4)
buffer_load_dwordx4 v[212:215],v245,s[8:11],s28 offen offset:768
M v[96:99],a[224:227],a[248:251],v[96:99]
s_waitcnt lgkmcnt(2)
ds_read_b128 v[228:231],v249 offset:61952
v_lshlrev_b32 v234,16,v198
M v[100:103],a[224:227],a[212:215],v[100:103]
v_lshlrev_b32 v232,16,v192
v_lshlrev_b32 v233,16,v196
M v[100:103],a[220:223],a[248:251],v[100:103]
v_lshlrev_b32 v237,16,v194
v_lshlrev_b32 v236,16,v202
M v[100:103],a[252:255],a[208:211],v[100:103]
v_lshlrev_b32 v235,16,v200
v_fmac_f32 v232,s43,v234
M v[104:107],a[252:255],a[248:251],v[104:107]
ds_read_b128 a[204:207],v248 offset:62464
v_fmac_f32 v237,4.0,v233
M v[104:107],a[220:223],a[212:215],v[104:107]
s_waitcnt lgkmcnt(2)
ds_read_b128 a[228:231],v249 offset:62464
v_fma_f32 v238,-4.0,v234,v236
M v[104:107],a[224:227],a[236:239],v[104:107]
s_waitcnt lgkmcnt(2)
v_fmac_f32 v232,s45,v236
v_fmac_f32 v237,s41,v235
M v[108:111],a[224:227],v[228:231],v[108:111]
v_sub_f32 v236,v236,v234
v_fma_f32 v234,-4.0,v233,v235
M v[108:111],a[220:223],a[236:239],v[108:111]
v_sub_f32 v235,v235,v233
v_add_f32 v233,v238,v234
M v[108:111],a[252:255],a[212:215],v[108:111]
v_sub_f32 v238,v238,v234
v_fma_f32 v234,2.0,v235,v236
M v[112:115],a[252:255],a[236:239],v[112:115]
ds_read_b128 a[216:219],v249 offset:62976
v_fmac_f32 v236,-2.0,v235
M v[112:115],a[220:223],v[228:231],v[112:115]
s_waitcnt lgkmcnt(2)
ds_read_b128 v[216:219],v248 offset:62976
v_and_b32 v198,s42,v198
M v[112:115],a[224:227],a[204:207],v[112:115]
s_waitcnt lgkmcnt(2)
v_and_b32 v192,s42,v192
v_and_b32 v196,s42,v196
M v[116:119],a[224:227],a[228:231],v[116:119]
v_and_b32 v194,s42,v194
v_and_b32 v202,s42,v202
M v[116:119],a[220:223],a[204:207],v[116:119]
v_and_b32 v200,s42,v200
v_fmac_f32 v192,s43,v198
M v[116:119],a[252:255],v[228:231],v[116:119]
v_fmac_f32 v194,4.0,v196
v_fma_f32 v235,-4.0,v198,v202
M v[120:123],a[252:255],a[204:207],v[120:123]
v_fmac_f32 v192,s45,v202
v_fmac_f32 v194,s41,v200
M v[120:123],a[220:223],a[228:231],v[120:123]
s_waitcnt lgkmcnt(1)
v_sub_f32 v202,v202,v198
v_fma_f32 v198,-4.0,v196,v200
M v[120:123],a[224:227],a[216:219],v[120:123]
s_waitcnt lgkmcnt(0)
v_sub_f32 v200,v200,v196
v_add_f32 v196,v235,v198
M v[124:127],a[224:227],v[216:219],v[124:127]
buffer_load_dwordx4 a[224:227],v250,s[20:23],s46 offen offset:1024 sc1
M v[124:127],a[220:223],a[216:219],v[124:127]
v_sub_f32 v235,v235,v198
v_fma_f32 v198,2.0,v200,v202
M v[124:127],a[252:255],a[228:231],v[124:127]
s_waitcnt vmcnt(10)
buffer_load_dwordx4 a[220:223],v250,s[20:23],s46 offen offset:2048 sc1
M v[128:131],a[232:235],a[192:195],v[128:131]
s_waitcnt vmcnt(10)
s_add_u32 s47,s76,12288
v_fmac_f32 v202,-2.0,v200
v_cvt_pk_bf16_f32 v192,v232,v192
M v[128:131],a[240:243],a[208:211],v[128:131]
s_waitcnt vmcnt(9)
v_cvt_pk_bf16_f32 v194,v237,v194
v_cvt_pk_bf16_f32 v196,v233,v196
M v[128:131],a[244:247],a[248:251],v[128:131]
v_cvt_pk_bf16_f32 v200,v234,v198
v_cvt_pk_bf16_f32 v198,v238,v235
M v[132:135],a[244:247],a[212:215],v[132:135]
buffer_load_dwordx4 a[252:255],v250,s[20:23],s47 offen offset:0 sc1
M v[132:135],a[240:243],a[248:251],v[132:135]
v_cvt_pk_bf16_f32 v202,v236,v202
v_permlane32_swap_b32 v197,v199
M v[132:135],a[232:235],a[208:211],v[132:135]
v_permlane32_swap_b32 v193,v195
v_permlane32_swap_b32 v201,v203
M v[136:139],a[232:235],a[248:251],v[136:139]
v_lshlrev_b32 v234,16,v199
v_lshlrev_b32 v232,16,v193
M v[136:139],a[240:243],a[212:215],v[136:139]
v_lshlrev_b32 v233,16,v197
v_lshlrev_b32 v237,16,v195
M v[136:139],a[244:247],a[236:239],v[136:139]
v_lshlrev_b32 v236,16,v203
v_lshlrev_b32 v235,16,v201
M v[140:143],a[244:247],v[228:231],v[140:143]
v_fmac_f32 v232,s43,v234
v_fmac_f32 v237,4.0,v233
M v[140:143],a[240:243],a[236:239],v[140:143]
v_fma_f32 v238,-4.0,v234,v236
v_fmac_f32 v232,s45,v236
M v[140:143],a[232:235],a[212:215],v[140:143]
v_fmac_f32 v237,s41,v235
v_sub_f32 v236,v236,v234
M v[144:147],a[232:235],a[236:239],v[144:147]
v_fma_f32 v234,-4.0,v233,v235
v_sub_f32 v235,v235,v233
M v[144:147],a[240:243],v[228:231],v[144:147]
v_add_f32 v233,v238,v234
v_sub_f32 v238,v238,v234
M v[144:147],a[244:247],a[204:207],v[144:147]
v_fma_f32 v234,2.0,v235,v236
v_fmac_f32 v236,-2.0,v235
M v[148:151],a[244:247],a[228:231],v[148:151]
v_and_b32 v199,s42,v199
v_and_b32 v193,s42,v193
M v[148:151],a[240:243],a[204:207],v[148:151]
v_and_b32 v197,s42,v197
v_and_b32 v195,s42,v195
M v[148:151],a[232:235],v[228:231],v[148:151]
v_and_b32 v203,s42,v203
v_and_b32 v201,s42,v201
M v[152:155],a[232:235],a[204:207],v[152:155]
v_fmac_f32 v193,s43,v199
v_fmac_f32 v195,4.0,v197
M v[152:155],a[240:243],a[228:231],v[152:155]
v_fma_f32 v235,-4.0,v199,v203
v_fmac_f32 v193,s45,v203
M v[152:155],a[244:247],a[216:219],v[152:155]
v_fmac_f32 v195,s41,v201
v_sub_f32 v203,v203,v199
M v[156:159],a[244:247],v[216:219],v[156:159]
buffer_load_dwordx4 a[244:247],v250,s[20:23],s47 offen offset:1024 sc1
M v[156:159],a[240:243],a[216:219],v[156:159]
v_fma_f32 v199,-4.0,v197,v201
v_sub_f32 v201,v201,v197
M v[156:159],a[232:235],a[228:231],v[156:159]
s_waitcnt vmcnt(10)
buffer_load_dwordx4 a[240:243],v250,s[20:23],s47 offen offset:2048 sc1
M v[160:163],v[220:223],a[192:195],v[160:163]
s_waitcnt vmcnt(10)
s_add_u32 s48,s76,15360
v_add_f32 v197,v235,v199
v_sub_f32 v235,v235,v199
M v[160:163],a[196:199],a[208:211],v[160:163]
s_waitcnt vmcnt(9)
v_fma_f32 v199,2.0,v201,v203
v_fmac_f32 v203,-2.0,v201
M v[160:163],a[200:203],a[248:251],v[160:163]
v_cvt_pk_bf16_f32 v193,v232,v193
v_cvt_pk_bf16_f32 v195,v237,v195
M v[164:167],a[200:203],a[212:215],v[164:167]
buffer_load_dwordx4 a[232:235],v250,s[20:23],s48 offen offset:0 sc1
M v[164:167],a[196:199],a[248:251],v[164:167]
v_cvt_pk_bf16_f32 v197,v233,v197
v_cvt_pk_bf16_f32 v201,v234,v199
M v[164:167],v[220:223],a[208:211],v[164:167]
v_cvt_pk_bf16_f32 v199,v238,v235
v_cvt_pk_bf16_f32 v203,v236,v203
M v[168:171],v[220:223],a[248:251],v[168:171]
s_waitcnt vmcnt(7)
v_permlane32_swap_b32 v208,v210
v_permlane32_swap_b32 v204,v206
M v[168:171],a[196:199],a[212:215],v[168:171]
buffer_load_dwordx4 a[192:195],v250,s[20:23],s48 offen offset:1024 sc1
M v[168:171],a[200:203],a[236:239],v[168:171]
s_waitcnt vmcnt(7)
v_permlane32_swap_b32 v212,v214
v_lshlrev_b32 v234,16,v210
M v[172:175],a[200:203],v[228:231],v[172:175]
v_lshlrev_b32 v232,16,v204
v_lshlrev_b32 v233,16,v208
M v[172:175],a[196:199],a[236:239],v[172:175]
v_lshlrev_b32 v237,16,v206
v_lshlrev_b32 v236,16,v214
M v[172:175],v[220:223],a[212:215],v[172:175]
buffer_load_dwordx4 a[208:211],v250,s[20:23],s48 offen offset:2048 sc1
M v[176:179],v[220:223],a[236:239],v[176:179]
s_add_u32 s46,s76,18432
v_lshlrev_b32 v235,16,v212
v_fmac_f32 v232,s43,v234
M v[176:179],a[196:199],v[228:231],v[176:179]
v_fmac_f32 v237,4.0,v233
v_fma_f32 v238,-4.0,v234,v236
M v[176:179],a[200:203],a[204:207],v[176:179]
s_barrier
v_fmac_f32 v232,s45,v236
M v[180:183],a[200:203],a[228:231],v[180:183]
buffer_load_dwordx4 a[248:251],v250,s[20:23],s46 offen offset:0 sc1
M v[180:183],a[196:199],a[204:207],v[180:183]
ds_read_b128 a[212:215],v248 offset:0
v_fmac_f32 v237,s41,v235
M v[180:183],v[220:223],v[228:231],v[180:183]
ds_write2st64_b64 v247,v[192:193],v[194:195] offset0:136 offset1:153
M v[184:187],v[220:223],a[204:207],v[184:187]
s_add_u32 s28,s71,786432
ds_read_b128 a[236:239],v249 offset:0
ds_read_b128 v[228:231],v248 offset:512
M v[184:187],a[196:199],a[228:231],v[184:187]
buffer_load_dwordx4 v[192:195],v251,s[88:91],s28 offen offset:0
M v[184:187],a[200:203],a[216:219],v[184:187]
ds_write2st64_b64 v247,v[196:197],v[198:199] offset0:102 offset1:119
M v[188:191],a[200:203],v[216:219],v[188:191]
ds_read_b128 a[204:207],v249 offset:512
v_sub_f32 v236,v236,v234
M v[188:191],a[196:199],a[216:219],v[188:191]
buffer_load_dwordx4 v[196:199],v245,s[8:11],s28 offen offset:0
M v[188:191],v[220:223],a[228:231],v[188:191]
s_waitcnt lgkmcnt(5)
v_fma_f32 v234,-4.0,v233,v235
v_sub_f32 v235,v235,v233
M a[0:3],v[224:227],a[212:215],a[0:3]
s_waitcnt vmcnt(10) lgkmcnt(3)
ds_read_b128 a[200:203],v248 offset:1024
v_add_f32 v233,v238,v234
M a[0:3],a[224:227],a[236:239],a[0:3]
s_waitcnt vmcnt(9) lgkmcnt(3)
ds_read_b128 v[216:219],v249 offset:1024
v_sub_f32 v238,v238,v234
M a[0:3],a[220:223],v[228:231],a[0:3]
s_waitcnt lgkmcnt(2)
v_fma_f32 v234,2.0,v235,v236
v_fmac_f32 v236,-2.0,v235
M a[4:7],a[220:223],a[204:207],a[4:7]
v_and_b32 v210,s42,v210
v_and_b32 v204,s42,v204
M a[4:7],a[224:227],v[228:231],a[4:7]
v_and_b32 v208,s42,v208
v_and_b32 v206,s42,v206
M a[4:7],v[224:227],a[236:239],a[4:7]
v_and_b32 v214,s42,v214
v_and_b32 v212,s42,v212
M a[8:11],v[224:227],v[228:231],a[8:11]
ds_read_b128 a[196:199],v248 offset:1536
v_fmac_f32 v204,s43,v210
M a[8:11],a[224:227],a[204:207],a[8:11]
s_waitcnt lgkmcnt(2)
ds_read_b128 a[216:219],v249 offset:1536
v_fmac_f32 v206,4.0,v208
M a[8:11],a[220:223],a[200:203],a[8:11]
s_waitcnt lgkmcnt(2)
v_fma_f32 v235,-4.0,v210,v214
v_fmac_f32 v204,s45,v214
M a[12:15],a[220:223],v[216:219],a[12:15]
v_fmac_f32 v206,s41,v212
v_sub_f32 v214,v214,v210
M a[12:15],a[224:227],a[200:203],a[12:15]
v_fma_f32 v210,-4.0,v208,v212
v_sub_f32 v212,v212,v208
M a[12:15],v[224:227],a[204:207],a[12:15]
v_add_f32 v208,v235,v210
v_sub_f32 v235,v235,v210
M a[16:19],v[224:227],a[200:203],a[16:19]
ds_read_b128 a[228:231],v249 offset:2048
v_fma_f32 v210,2.0,v212,v214
M a[16:19],a[224:227],v[216:219],a[16:19]
s_waitcnt lgkmcnt(2)
ds_read_b128 v[220:223],v248 offset:2048
v_fmac_f32 v214,-2.0,v212
M a[16:19],a[220:223],a[196:199],a[16:19]
s_waitcnt lgkmcnt(2)
v_cvt_pk_bf16_f32 v204,v232,v204
v_cvt_pk_bf16_f32 v206,v237,v206
M a[20:23],a[220:223],a[216:219],a[20:23]
v_cvt_pk_bf16_f32 v208,v233,v208
v_cvt_pk_bf16_f32 v212,v234,v210
M a[20:23],a[224:227],a[196:199],a[20:23]
v_cvt_pk_bf16_f32 v210,v238,v235
v_cvt_pk_bf16_f32 v214,v236,v214
M a[20:23],v[224:227],v[216:219],a[20:23]
v_permlane32_swap_b32 v209,v211
v_permlane32_swap_b32 v205,v207
M a[24:27],v[224:227],a[196:199],a[24:27]
v_permlane32_swap_b32 v213,v215
v_lshlrev_b32 v234,16,v211
M a[24:27],a[224:227],a[216:219],a[24:27]
s_waitcnt lgkmcnt(1)
v_lshlrev_b32 v232,16,v205
v_lshlrev_b32 v233,16,v209
M a[24:27],a[220:223],a[228:231],a[24:27]
s_waitcnt lgkmcnt(0)
v_lshlrev_b32 v237,16,v207
v_lshlrev_b32 v236,16,v215
M a[28:31],a[220:223],v[220:223],a[28:31]
buffer_load_dwordx4 a[220:223],v250,s[20:23],s46 offen offset:1024 sc1
M a[28:31],a[224:227],a[228:231],a[28:31]
v_lshlrev_b32 v235,16,v213
v_fmac_f32 v232,s43,v234
M a[28:31],v[224:227],a[216:219],a[28:31]
s_waitcnt vmcnt(9)
buffer_load_dwordx4 a[224:227],v250,s[20:23],s46 offen offset:2048 sc1
M a[32:35],a[252:255],a[212:215],a[32:35]
s_waitcnt vmcnt(9)
s_add_u32 s47,s76,21504
v_fmac_f32 v237,4.0,v233
v_fma_f32 v238,-4.0,v234,v236
M a[32:35],a[244:247],a[236:239],a[32:35]
s_waitcnt vmcnt(8)
v_fmac_f32 v232,s45,v236
v_fmac_f32 v237,s41,v235
M a[32:35],a[240:243],v[228:231],a[32:35]
v_sub_f32 v236,v236,v234
v_fma_f32 v234,-4.0,v233,v235
M a[36:39],a[240:243],a[204:207],a[36:39]
buffer_load_dwordx4 v[224:227],v250,s[20:23],s47 offen offset:0 sc1
M a[36:39],a[244:247],v[228:231],a[36:39]
v_sub_f32 v235,v235,v233
v_add_f32 v233,v238,v234
M a[36:39],a[252:255],a[236:239],a[36:39]
v_sub_f32 v238,v238,v234
v_fma_f32 v234,2.0,v235,v236
M a[40:43],a[252:255],v[228:231],a[40:43]
v_fmac_f32 v236,-2.0,v235
v_and_b32 v211,s42,v211
M a[40:43],a[244:247],a[204:207],a[40:43]
v_and_b32 v205,s42,v205
v_and_b32 v209,s42,v209
M a[40:43],a[240:243],a[200:203],a[40:43]
v_and_b32 v207,s42,v207
v_and_b32 v215,s42,v215
M a[44:47],a[240:243],v[216:219],a[44:47]
v_and_b32 v213,s42,v213
v_fmac_f32 v205,s43,v211
M a[44:47],a[244:247],a[200:203],a[44:47]
v_fmac_f32 v207,4.0,v209
v_fma_f32 v235,-4.0,v211,v215
M a[44:47],a[252:255],a[204:207],a[44:47]
v_fmac_f32 v205,s45,v215
v_fmac_f32 v207,s41,v213
M a[48:51],a[252:255],a[200:203],a[48:51]
v_sub_f32 v215,v215,v211
v_fma_f32 v211,-4.0,v209,v213
M a[48:51],a[244:247],v[216:219],a[48:51]
v_sub_f32 v213,v213,v209
v_add_f32 v209,v235,v211
M a[48:51],a[240:243],a[196:199],a[48:51]
v_sub_f32 v235,v235,v211
v_fma_f32 v211,2.0,v213,v215
M a[52:55],a[240:243],a[216:219],a[52:55]
v_fmac_f32 v215,-2.0,v213
v_cvt_pk_bf16_f32 v205,v232,v205
M a[52:55],a[244:247],a[196:199],a[52:55]
v_cvt_pk_bf16_f32 v207,v237,v207
v_cvt_pk_bf16_f32 v209,v233,v209
M a[52:55],a[252:255],v[216:219],a[52:55]
v_cvt_pk_bf16_f32 v213,v234,v211
v_cvt_pk_bf16_f32 v211,v238,v235
M a[56:59],a[252:255],a[196:199],a[56:59]
v_cvt_pk_bf16_f32 v215,v236,v215
v_fmac_f32 v239,s43,v241
M a[56:59],a[244:247],a[216:219],a[56:59]
v_fmac_f32 v244,4.0,v240
v_fma_f32 v232,-4.0,v241,v243
M a[56:59],a[240:243],a[228:231],a[56:59]
v_fmac_f32 v239,s45,v243
v_fmac_f32 v244,s41,v242
M a[60:63],a[240:243],v[220:223],a[60:63]
buffer_load_dwordx4 a[240:243],v250,s[20:23],s47 offen offset:1024 sc1
M a[60:63],a[244:247],a[228:231],a[60:63]
v_sub_f32 v243,v243,v241
v_fma_f32 v241,-4.0,v240,v242
M a[60:63],a[252:255],a[216:219],a[60:63]
s_waitcnt vmcnt(9)
buffer_load_dwordx4 a[244:247],v250,s[20:23],s47 offen offset:2048 sc1
M a[64:67],a[232:235],a[212:215],a[64:67]
s_waitcnt vmcnt(9)
s_add_u32 s48,s76,24576
v_sub_f32 v242,v242,v240
v_add_f32 v240,v232,v241
M a[64:67],a[192:195],a[236:239],a[64:67]
s_waitcnt vmcnt(8)
v_sub_f32 v232,v232,v241
v_fma_f32 v241,2.0,v242,v243
M a[64:67],a[208:211],v[228:231],a[64:67]
v_fmac_f32 v243,-2.0,v242
v_cvt_pk_bf16_f32 v233,v239,v244
M a[68:71],a[208:211],a[204:207],a[68:71]
buffer_load_dwordx4 a[252:255],v250,s[20:23],s48 offen offset:0 sc1
M a[68:71],a[192:195],v[228:231],a[68:71]
v_cvt_pk_bf16_f32 v234,v240,v232
v_cvt_pk_bf16_f32 v235,v241,v243
M a[68:71],a[232:235],a[236:239],a[68:71]
v_add_u32 v232,69632,v252
M a[72:75],a[232:235],v[228:231],a[72:75]
ds_write_b16 v232,v233 offset:0
M a[72:75],a[192:195],a[204:207],a[72:75]
buffer_load_dwordx4 a[212:215],v250,s[20:23],s48 offen offset:1024 sc1
M a[72:75],a[208:211],a[200:203],a[72:75]
ds_write_b16_d16_hi v232,v233 offset:8704
M a[76:79],a[208:211],v[216:219],a[76:79]
ds_write_b16 v252,v234 offset:52224
M a[76:79],a[192:195],a[200:203],a[76:79]
ds_write_b16_d16_hi v252,v234 offset:60928
M a[76:79],a[232:235],a[204:207],a[76:79]
buffer_load_dwordx4 a[236:239],v250,s[20:23],s48 offen offset:2048 sc1
M a[80:83],a[232:235],a[200:203],a[80:83]
s_add_u32 s46,s76,27648
M a[80:83],a[192:195],v[216:219],a[80:83]
M a[80:83],a[208:211],a[196:199],a[80:83]
M a[84:87],a[208:211],a[216:219],a[84:87]
buffer_load_dwordx4 v[228:231],v250,s[20:23],s46 offen offset:0 sc1
M a[84:87],a[192:195],a[196:199],a[84:87]
ds_read_b128 a[204:207],v248 offset:8704
M a[84:87],a[232:235],v[216:219],a[84:87]
ds_read_b128 a[200:203],v249 offset:8704
M a[88:91],a[232:235],a[196:199],a[88:91]
ds_read_b128 v[216:219],v248 offset:9216
M a[88:91],a[192:195],a[216:219],a[88:91]
ds_read_b128 a[196:199],v249 offset:9216
M a[88:91],a[208:211],a[228:231],a[88:91]
M a[92:95],a[208:211],v[220:223],a[92:95]
M a[92:95],a[192:195],a[228:231],a[92:95]
M a[92:95],a[232:235],a[216:219],a[92:95]
s_waitcnt vmcnt(11) lgkmcnt(3)
M a[96:99],a[248:251],a[204:207],a[96:99]
s_waitcnt vmcnt(8) lgkmcnt(2)
ds_read_b128 a[208:211],v248 offset:9728
M a[96:99],a[220:223],a[200:203],a[96:99]
s_waitcnt vmcnt(7) lgkmcnt(2)
ds_read_b128 v[220:223],v249 offset:9728
M a[96:99],a[224:227],v[216:219],a[96:99]
s_waitcnt lgkmcnt(2)
M a[100:103],a[224:227],a[196:199],a[100:103]
M a[100:103],a[220:223],v[216:219],a[100:103]
M a[100:103],a[248:251],a[200:203],a[100:103]
M a[104:107],a[248:251],v[216:219],a[104:107]
ds_read_b128 a[192:195],v248 offset:10240
M a[104:107],a[220:223],a[196:199],a[104:107]
s_waitcnt lgkmcnt(2)
ds_read_b128 a[228:231],v249 offset:10240
M a[104:107],a[224:227],a[208:211],a[104:107]
s_waitcnt lgkmcnt(2)
M a[108:111],a[224:227],v[220:223],a[108:111]
M a[108:111],a[220:223],a[208:211],a[108:111]
M a[108:111],a[248:251],a[196:199],a[108:111]
M a[112:115],a[248:251],a[208:211],a[112:115]
ds_read_b128 a[216:219],v249 offset:10752
M a[112:115],a[220:223],v[220:223],a[112:115]
s_waitcnt lgkmcnt(2)
ds_read_b128 a[232:235],v248 offset:10752
M a[112:115],a[224:227],a[192:195],a[112:115]
s_waitcnt lgkmcnt(2)
M a[116:119],a[224:227],a[228:231],a[116:119]
M a[116:119],a[220:223],a[192:195],a[116:119]
M a[116:119],a[248:251],v[220:223],a[116:119]
M a[120:123],a[248:251],a[192:195],a[120:123]
M a[120:123],a[220:223],a[228:231],a[120:123]
s_waitcnt lgkmcnt(1)
M a[120:123],a[224:227],a[216:219],a[120:123]
s_waitcnt lgkmcnt(0)
M a[124:127],a[224:227],a[232:235],a[124:127]
buffer_load_dwordx4 a[224:227],v250,s[20:23],s46 offen offset:1024 sc1
M a[124:127],a[220:223],a[216:219],a[124:127]
M a[124:127],a[248:251],a[228:231],a[124:127]
s_waitcnt vmcnt(7)
buffer_load_dwordx4 a[220:223],v250,s[20:23],s46 offen offset:2048 sc1
M a[128:131],v[224:227],a[204:207],a[128:131]
s_waitcnt vmcnt(7)
s_add_u32 s47,s76,30720
M a[128:131],a[240:243],a[200:203],a[128:131]
s_waitcnt vmcnt(6)
M a[128:131],a[244:247],v[216:219],a[128:131]
M a[132:135],a[244:247],a[196:199],a[132:135]
buffer_load_dwordx4 a[248:251],v250,s[20:23],s47 offen offset:0 sc1
M a[132:135],a[240:243],v[216:219],a[132:135]
M a[132:135],v[224:227],a[200:203],a[132:135]
M a[136:139],v[224:227],v[216:219],a[136:139]
s_barrier
ds_write_b16 v252,v235 offset:17408
M a[136:139],a[240:243],a[196:199],a[136:139]
ds_write_b16_d16_hi v252,v235 offset:26112
M a[136:139],a[244:247],a[208:211],a[136:139]
ds_write2st64_b64 v247,v[200:201],v[202:203] offset0:34 offset1:51
M a[140:143],a[244:247],v[220:223],a[140:143]
buffer_load_dwordx4 v[200:203],v245,s[8:11],s28 offen offset:768
M a[140:143],a[240:243],a[208:211],a[140:143]
M a[140:143],v[224:227],a[196:199],a[140:143]
ds_write2st64_b64 v247,v[204:205],v[206:207] offset0:137 offset1:154
M a[144:147],v[224:227],a[208:211],a[144:147]
s_add_u32 s28,s71,1179648
buffer_load_dwordx4 v[204:207],v251,s[88:91],s28 offen offset:0
M a[144:147],a[240:243],v[220:223],a[144:147]
M a[144:147],a[244:247],a[192:195],a[144:147]
ds_write2st64_b64 v247,v[208:209],v[210:211] offset0:103 offset1:120
M a[148:151],a[244:247],a[228:231],a[148:151]
buffer_load_dwordx4 v[208:211],v245,s[8:11],s28 offen offset:0
M a[148:151],a[240:243],a[192:195],a[148:151]
M a[148:151],v[224:227],v[220:223],a[148:151]
ds_write2st64_b64 v247,v[212:213],v[214:215] offset0:35 offset1:52
M a[152:155],v[224:227],a[192:195],a[152:155]
buffer_load_dwordx4 v[212:215],v245,s[8:11],s28 offen offset:768
M a[152:155],a[240:243],a[228:231],a[152:155]
s_add_u32 s29,s66,6291456
M a[152:155],a[244:247],a[216:219],a[152:155]
M a[156:159],a[244:247],a[232:235],a[156:159]
buffer_load_dwordx4 a[244:247],v250,s[20:23],s47 offen offset:1024 sc1
M a[156:159],a[240:243],a[216:219],a[156:159]
M a[156:159],v[224:227],a[228:231],a[156:159]
s_waitcnt vmcnt(11)
M a[160:163],a[252:255],a[204:207],a[160:163]
s_waitcnt vmcnt(10)
M a[160:163],a[212:215],a[200:203],a[160:163]
s_waitcnt vmcnt(9)
buffer_load_dwordx4 a[240:243],v250,s[20:23],s47 offen offset:2048 sc1
M a[160:163],a[236:239],v[216:219],a[160:163]
s_add_u32 s48,s76,33792
M a[164:167],a[236:239],a[196:199],a[164:167]
M a[164:167],a[212:215],v[216:219],a[164:167]
M a[164:167],a[252:255],a[200:203],a[164:167]
buffer_load_dwordx4 v[224:227],v250,s[20:23],s48 offen offset:0 sc1
M a[168:171],a[252:255],v[216:219],a[168:171]
M a[168:171],a[212:215],a[196:199],a[168:171]
M a[168:171],a[236:239],a[208:211],a[168:171]
M a[172:175],a[236:239],v[220:223],a[172:175]
buffer_load_dwordx4 a[204:207],v250,s[20:23],s48 offen offset:1024 sc1
M a[172:175],a[212:215],a[208:211],a[172:175]
M a[172:175],a[252:255],a[196:199],a[172:175]
M a[176:179],a[252:255],a[208:211],a[176:179]
M a[176:179],a[212:215],v[220:223],a[176:179]
buffer_load_dwordx4 a[200:203],v250,s[20:23],s48 offen offset:2048 sc1
M a[176:179],a[236:239],a[192:195],a[176:179]
s_add_u32 s46,s76,36864
M a[180:183],a[236:239],a[228:231],a[180:183]
v_permlane32_swap_b32 v196,v198
v_permlane32_swap_b32 v192,v194
M a[180:183],a[212:215],a[192:195],a[180:183]
s_waitcnt vmcnt(8)
ds_read_b128 a[196:199],v248 offset:17408
v_permlane32_swap_b32 v200,v202
M a[180:183],a[252:255],v[220:223],a[180:183]
buffer_load_dwordx4 v[216:219],v250,s[20:23],s46 offen offset:0 sc1
M a[184:187],a[252:255],a[192:195],a[184:187]
ds_read_b128 a[208:211],v249 offset:17408
ds_read_b128 v[220:223],v248 offset:17920
M a[184:187],a[212:215],a[228:231],a[184:187]
ds_read_b128 a[192:195],v249 offset:17920
v_lshlrev_b32 v234,16,v198
M a[184:187],a[236:239],a[216:219],a[184:187]
v_lshlrev_b32 v232,16,v192
v_lshlrev_b32 v233,16,v196
M a[188:191],a[236:239],a[232:235],a[188:191]
buffer_load_short_d16_hi v239,v246,s[12:15],s29 offen offset:0
M a[188:191],a[212:215],a[216:219],a[188:191]
v_lshlrev_b32 v237,16,v194
v_lshlrev_b32 v236,16,v202
M a[188:191],a[252:255],a[228:231],a[188:191]
s_waitcnt lgkmcnt(3)
buffer_load_short_d16_hi v240,v246,s[8:11],s29 offen offset:0
M v[0:3],v[228:231],a[196:199],v[0:3]
s_waitcnt lgkmcnt(2)
ds_read_b128 a[232:235],v248 offset:18432
v_lshlrev_b32 v235,16,v200
M v[0:3],a[224:227],a[208:211],v[0:3]
s_waitcnt lgkmcnt(2)
buffer_load_short_d16_hi v241,v246,s[8:11],s29 offen offset:384
M v[0:3],a[220:223],v[220:223],v[0:3]
s_waitcnt lgkmcnt(1)
ds_read_b128 a[236:239],v249 offset:18432
v_fmac_f32 v232,s43,v234
M v[4:7],a[220:223],a[192:195],v[4:7]
buffer_load_short_d16_hi v242,v246,s[8:11],s29 offen offset:768
M v[4:7],a[224:227],v[220:223],v[4:7]
v_fmac_f32 v237,4.0,v233
v_fma_f32 v238,-4.0,v234,v236
M v[4:7],v[228:231],a[208:211],v[4:7]
buffer_load_short_d16_hi v243,v246,s[8:11],s29 offen offset:1152
M v[8:11],v[228:231],v[220:223],v[8:11]
ds_read_b128 a[212:215],v248 offset:18944
v_fmac_f32 v232,s45,v236
M v[8:11],a[224:227],a[192:195],v[8:11]
s_waitcnt lgkmcnt(2)
buffer_load_short_d16_hi v244,v246,s[16:19],s29 offen offset:1536
M v[8:11],a[220:223],a[232:235],v[8:11]
s_waitcnt lgkmcnt(1)
ds_read_b128 a[216:219],v249 offset:18944
v_fmac_f32 v237,s41,v235
M v[12:15],a[220:223],a[236:239],v[12:15]
v_sub_f32 v236,v236,v234
v_fma_f32 v234,-4.0,v233,v235
M v[12:15],a[224:227],a[232:235],v[12:15]
v_sub_f32 v235,v235,v233
v_add_f32 v233,v238,v234
M v[12:15],v[228:231],a[192:195],v[12:15]
v_sub_f32 v238,v238,v234
v_fma_f32 v234,2.0,v235,v236
M v[16:19],v[228:231],a[232:235],v[16:19]
ds_read_b128 a[228:231],v249 offset:19456
v_fmac_f32 v236,-2.0,v235
M v[16:19],a[224:227],a[236:239],v[16:19]
s_waitcnt lgkmcnt(2)
ds_read_b128 a[252:255],v248 offset:19456
v_and_b32 v198,s42,v198
M v[16:19],a[220:223],a[212:215],v[16:19]
s_waitcnt lgkmcnt(2)
v_and_b32 v192,s42,v192
v_and_b32 v196,s42,v196
M v[20:23],a[220:223],a[216:219],v[20:23]
v_and_b32 v194,s42,v194
v_and_b32 v202,s42,v202
M v[20:23],a[224:227],a[212:215],v[20:23]
v_and_b32 v200,s42,v200
v_fmac_f32 v192,s43,v198
M v[20:23],v[228:231],a[236:239],v[20:23]
v_fmac_f32 v194,4.0,v196
v_fma_f32 v235,-4.0,v198,v202
M v[24:27],v[228:231],a[212:215],v[24:27]
v_fmac_f32 v192,s45,v202
v_fmac_f32 v194,s41,v200
M v[24:27],a[224:227],a[216:219],v[24:27]
s_waitcnt lgkmcnt(1)
v_sub_f32 v202,v202,v198
v_fma_f32 v198,-4.0,v196,v200
M v[24:27],a[220:223],a[228:231],v[24:27]
s_waitcnt lgkmcnt(0)
v_sub_f32 v200,v200,v196
v_add_f32 v196,v235,v198
M v[28:31],a[220:223],a[252:255],v[28:31]
buffer_load_dwordx4 a[220:223],v250,s[20:23],s46 offen offset:1024 sc1
M v[28:31],a[224:227],a[228:231],v[28:31]
v_sub_f32 v235,v235,v198
v_fma_f32 v198,2.0,v200,v202
M v[28:31],v[228:231],a[216:219],v[28:31]
buffer_load_dwordx4 a[224:227],v250,s[20:23],s46 offen offset:2048 sc1
M v[32:35],a[248:251],a[196:199],v[32:35]
s_waitcnt vmcnt(13)
s_add_u32 s47,s76,39936
v_fmac_f32 v202,-2.0,v200
v_cvt_pk_bf16_f32 v192,v232,v192
M v[32:35],a[244:247],a[208:211],v[32:35]
s_waitcnt vmcnt(12)
v_cvt_pk_bf16_f32 v194,v237,v194
v_cvt_pk_bf16_f32 v196,v233,v196
M v[32:35],a[240:243],v[220:223],v[32:35]
v_cvt_pk_bf16_f32 v200,v234,v198
v_cvt_pk_bf16_f32 v198,v238,v235
M v[36:39],a[240:243],a[192:195],v[36:39]
buffer_load_dwordx4 v[228:231],v250,s[20:23],s47 offen offset:0 sc1
M v[36:39],a[244:247],v[220:223],v[36:39]
v_cvt_pk_bf16_f32 v202,v236,v202
v_permlane32_swap_b32 v197,v199
M v[36:39],a[248:251],a[208:211],v[36:39]
v_permlane32_swap_b32 v193,v195
v_permlane32_swap_b32 v201,v203
M v[40:43],a[248:251],v[220:223],v[40:43]
v_lshlrev_b32 v234,16,v199
v_lshlrev_b32 v232,16,v193
M v[40:43],a[244:247],a[192:195],v[40:43]
v_lshlrev_b32 v233,16,v197
v_lshlrev_b32 v237,16,v195
M v[40:43],a[240:243],a[232:235],v[40:43]
v_lshlrev_b32 v236,16,v203
v_lshlrev_b32 v235,16,v201
M v[44:47],a[240:243],a[236:239],v[44:47]
v_fmac_f32 v232,s43,v234
v_fmac_f32 v237,4.0,v233
M v[44:47],a[244:247],a[232:235],v[44:47]
v_fma_f32 v238,-4.0,v234,v236
v_fmac_f32 v232,s45,v236
M v[44:47],a[248:251],a[192:195],v[44:47]
v_fmac_f32 v237,s41,v235
v_sub_f32 v236,v236,v234
M v[48:51],a[248:251],a[232:235],v[48:51]
v_fma_f32 v234,-4.0,v233,v235
v_sub_f32 v235,v235,v233
M v[48:51],a[244:247],a[236:239],v[48:51]
v_add_f32 v233,v238,v234
v_sub_f32 v238,v238,v234
M v[48:51],a[240:243],a[212:215],v[48:51]
v_fma_f32 v234,2.0,v235,v236
v_fmac_f32 v236,-2.0,v235
M v[52:55],a[240:243],a[216:219],v[52:55]
v_and_b32 v199,s42,v199
v_and_b32 v193,s42,v193
M v[52:55],a[244:247],a[212:215],v[52:55]
v_and_b32 v197,s42,v197
v_and_b32 v195,s42,v195
M v[52:55],a[248:251],a[236:239],v[52:55]
v_and_b32 v203,s42,v203
v_and_b32 v201,s42,v201
M v[56:59],a[248:251],a[212:215],v[56:59]
v_fmac_f32 v193,s43,v199
v_fmac_f32 v195,4.0,v197
M v[56:59],a[244:247],a[216:219],v[56:59]
v_fma_f32 v235,-4.0,v199,v203
v_fmac_f32 v193,s45,v203
M v[56:59],a[240:243],a[228:231],v[56:59]
v_fmac_f32 v195,s41,v201
v_sub_f32 v203,v203,v199
M v[60:63],a[240:243],a[252:255],v[60:63]
buffer_load_dwordx4 a[240:243],v250,s[20:23],s47 offen offset:1024 sc1
M v[60:63],a[244:247],a[228:231],v[60:63]
v_fma_f32 v199,-4.0,v197,v201
v_sub_f32 v201,v201,v197
M v[60:63],a[248:251],a[216:219],v[60:63]
s_waitcnt vmcnt(13)
buffer_load_dwordx4 a[244:247],v250,s[20:23],s47 offen offset:2048 sc1
M v[64:67],v[224:227],a[196:199],v[64:67]
s_waitcnt vmcnt(13)
s_add_u32 s48,s76,43008
v_add_f32 v197,v235,v199
v_sub_f32 v235,v235,v199
M v[64:67],a[204:207],a[208:211],v[64:67]
s_waitcnt vmcnt(12)
v_fma_f32 v199,2.0,v201,v203
v_fmac_f32 v203,-2.0,v201
M v[64:67],a[200:203],v[220:223],v[64:67]
v_cvt_pk_bf16_f32 v193,v232,v193
v_cvt_pk_bf16_f32 v195,v237,v195
M v[68:71],a[200:203],a[192:195],v[68:71]
buffer_load_dwordx4 a[248:251],v250,s[20:23],s48 offen offset:0 sc1
M v[68:71],a[204:207],v[220:223],v[68:71]
v_cvt_pk_bf16_f32 v197,v233,v197
v_cvt_pk_bf16_f32 v201,v234,v199
M v[68:71],v[224:227],a[208:211],v[68:71]
v_cvt_pk_bf16_f32 v199,v238,v235
v_cvt_pk_bf16_f32 v203,v236,v203
M v[72:75],v[224:227],v[220:223],v[72:75]
v_permlane32_swap_b32 v208,v210
v_permlane32_swap_b32 v204,v206
M v[72:75],a[204:207],a[192:195],v[72:75]
buffer_load_dwordx4 a[196:199],v250,s[20:23],s48 offen offset:1024 sc1
M v[72:75],a[200:203],a[232:235],v[72:75]
ds_write2st64_b64 v247,v[192:193],v[194:195] offset0:138 offset1:155
M v[76:79],a[200:203],a[236:239],v[76:79]
s_add_u32 s28,s66,6291456
v_permlane32_swap_b32 v212,v214
v_lshlrev_b32 v234,16,v210
M v[76:79],a[204:207],a[232:235],v[76:79]
v_lshlrev_b32 v232,16,v204
v_lshlrev_b32 v233,16,v208
M v[76:79],v[224:227],a[192:195],v[76:79]
buffer_load_dwordx4 a[208:211],v250,s[20:23],s48 offen offset:2048 sc1
M v[80:83],v[224:227],a[232:235],v[80:83]
s_add_u32 s46,s77,9216
v_lshlrev_b32 v237,16,v206
v_lshlrev_b32 v236,16,v214
M v[80:83],a[204:207],a[236:239],v[80:83]
v_lshlrev_b32 v235,16,v212
v_fmac_f32 v232,s43,v234
M v[80:83],a[200:203],a[212:215],v[80:83]
ds_write2st64_b64 v247,v[196:197],v[198:199] offset0:104 offset1:121
M v[84:87],a[200:203],a[216:219],v[84:87]
buffer_load_dwordx4 v[220:223],v250,s[20:23],s46 offen offset:0 sc1
M v[84:87],a[204:207],a[212:215],v[84:87]
ds_read_b128 a[192:195],v248 offset:26112
v_fmac_f32 v237,4.0,v233
M v[84:87],v[224:227],a[236:239],v[84:87]
ds_write2st64_b64 v247,v[200:201],v[202:203] offset0:36 offset1:53
M v[88:91],v[224:227],a[212:215],v[88:91]
buffer_load_dwordx4 v[192:195],v251,s[88:91],s28 offen offset:0
M v[88:91],a[204:207],a[216:219],v[88:91]
ds_read_b128 a[232:235],v249 offset:26112
ds_read_b128 a[236:239],v248 offset:26624
M v[88:91],a[200:203],a[228:231],v[88:91]
ds_read_b128 a[212:215],v249 offset:26624
v_fma_f32 v238,-4.0,v234,v236
M v[92:95],a[200:203],a[252:255],v[92:95]
buffer_load_dwordx4 v[196:199],v245,s[8:11],s28 offen offset:0
M v[92:95],a[204:207],a[228:231],v[92:95]
v_fmac_f32 v232,s45,v236
v_fmac_f32 v237,s41,v235
M v[92:95],v[224:227],a[216:219],v[92:95]
s_waitcnt vmcnt(17) lgkmcnt(4)
v_sub_f32 v236,v236,v234
v_fma_f32 v234,-4.0,v233,v235
M v[96:99],v[216:219],a[192:195],v[96:99]
s_waitcnt vmcnt(10) lgkmcnt(2)
ds_read_b128 a[200:203],v248 offset:27136
v_sub_f32 v235,v235,v233
M v[96:99],a[220:223],a[232:235],v[96:99]
s_waitcnt vmcnt(9) lgkmcnt(2)
buffer_load_dwordx4 v[200:203],v245,s[8:11],s28 offen offset:768
M v[96:99],a[224:227],a[236:239],v[96:99]
s_waitcnt lgkmcnt(1)
ds_read_b128 a[252:255],v249 offset:27136
v_add_f32 v233,v238,v234
M v[100:103],a[224:227],a[212:215],v[100:103]
v_sub_f32 v238,v238,v234
v_fma_f32 v234,2.0,v235,v236
M v[100:103],a[220:223],a[236:239],v[100:103]
v_fmac_f32 v236,-2.0,v235
v_and_b32 v210,s42,v210
M v[100:103],v[216:219],a[232:235],v[100:103]
v_and_b32 v204,s42,v204
v_and_b32 v208,s42,v208
M v[104:107],v[216:219],a[236:239],v[104:107]
ds_read_b128 a[204:207],v248 offset:27648
v_and_b32 v206,s42,v206
M v[104:107],a[220:223],a[212:215],v[104:107]
s_waitcnt lgkmcnt(2)
ds_read_b128 a[228:231],v249 offset:27648
v_and_b32 v214,s42,v214
M v[104:107],a[224:227],a[200:203],v[104:107]
s_waitcnt lgkmcnt(2)
v_and_b32 v212,s42,v212
v_fmac_f32 v204,s43,v210
M v[108:111],a[224:227],a[252:255],v[108:111]
v_fmac_f32 v206,4.0,v208
v_fma_f32 v235,-4.0,v210,v214
M v[108:111],a[220:223],a[200:203],v[108:111]
v_fmac_f32 v204,s45,v214
v_fmac_f32 v206,s41,v212
M v[108:111],v[216:219],a[212:215],v[108:111]
v_sub_f32 v214,v214,v210
v_fma_f32 v210,-4.0,v208,v212
M v[112:115],v[216:219],a[200:203],v[112:115]
ds_read_b128 a[216:219],v249 offset:28160
v_sub_f32 v212,v212,v208
M v[112:115],a[220:223],a[252:255],v[112:115]
s_waitcnt lgkmcnt(2)
ds_read_b128 v[224:227],v248 offset:28160
v_add_f32 v208,v235,v210
M v[112:115],a[224:227],a[204:207],v[112:115]
s_waitcnt lgkmcnt(2)
v_sub_f32 v235,v235,v210
v_fma_f32 v210,2.0,v212,v214
M v[116:119],a[224:227],a[228:231],v[116:119]
v_fmac_f32 v214,-2.0,v212
v_cvt_pk_bf16_f32 v204,v232,v204
M v[116:119],a[220:223],a[204:207],v[116:119]
v_cvt_pk_bf16_f32 v206,v237,v206
v_cvt_pk_bf16_f32 v208,v233,v208
M v[116:119],v[216:219],a[252:255],v[116:119]
v_cvt_pk_bf16_f32 v212,v234,v210
v_cvt_pk_bf16_f32 v210,v238,v235
M v[120:123],v[216:219],a[204:207],v[120:123]
v_cvt_pk_bf16_f32 v214,v236,v214
v_permlane32_swap_b32 v209,v211
M v[120:123],a[220:223],a[228:231],v[120:123]
s_waitcnt lgkmcnt(1)
v_permlane32_swap_b32 v205,v207
v_permlane32_swap_b32 v213,v215
M v[120:123],a[224:227],a[216:219],v[120:123]
s_waitcnt lgkmcnt(0)
v_lshlrev_b32 v234,16,v211
v_lshlrev_b32 v232,16,v205
M v[124:127],a[224:227],v[224:227],v[124:127]
buffer_load_dwordx4 a[224:227],v250,s[20:23],s46 offen offset:1024 sc1
M v[124:127],a[220:223],a[216:219],v[124:127]
v_lshlrev_b32 v233,16,v209
v_lshlrev_b32 v237,16,v207
M v[124:127],v[216:219],a[228:231],v[124:127]
s_waitcnt vmcnt(10)
buffer_load_dwordx4 a[220:223],v250,s[20:23],s46 offen offset:2048 sc1
M v[128:131],v[228:231],a[192:195],v[128:131]
s_waitcnt vmcnt(10)
s_add_u32 s46,s77,18432
v_lshlrev_b32 v236,16,v215
v_lshlrev_b32 v235,16,v213
M v[128:131],a[240:243],a[232:235],v[128:131]
s_waitcnt vmcnt(9)
v_fmac_f32 v232,s43,v234
v_fmac_f32 v237,4.0,v233
M v[128:131],a[244:247],a[236:239],v[128:131]
v_fma_f32 v238,-4.0,v234,v236
v_fmac_f32 v232,s45,v236
M v[132:135],a[244:247],a[212:215],v[132:135]
buffer_load_dwordx4 v[216:219],v250,s[20:23],s46 offen offset:0 sc1
M v[132:135],a[240:243],a[236:239],v[132:135]
v_fmac_f32 v237,s41,v235
v_sub_f32 v236,v236,v234
M v[132:135],v[228:231],a[232:235],v[132:135]
v_fma_f32 v234,-4.0,v233,v235
v_sub_f32 v235,v235,v233
M v[136:139],v[228:231],a[236:239],v[136:139]
v_add_f32 v233,v238,v234
v_sub_f32 v238,v238,v234
M v[136:139],a[240:243],a[212:215],v[136:139]
v_fma_f32 v234,2.0,v235,v236
v_fmac_f32 v236,-2.0,v235
M v[136:139],a[244:247],a[200:203],v[136:139]
v_and_b32 v211,s42,v211
v_and_b32 v205,s42,v205
M v[140:143],a[244:247],a[252:255],v[140:143]
v_and_b32 v209,s42,v209
v_and_b32 v207,s42,v207
M v[140:143],a[240:243],a[200:203],v[140:143]
v_and_b32 v215,s42,v215
v_and_b32 v213,s42,v213
M v[140:143],v[228:231],a[212:215],v[140:143]
v_fmac_f32 v205,s43,v211
v_fmac_f32 v207,4.0,v209
M v[144:147],v[228:231],a[200:203],v[144:147]
v_fma_f32 v235,-4.0,v211,v215
v_fmac_f32 v205,s45,v215
M v[144:147],a[240:243],a[252:255],v[144:147]
v_fmac_f32 v207,s41,v213
v_sub_f32 v215,v215,v211
M v[144:147],a[244:247],a[204:207],v[144:147]
v_fma_f32 v211,-4.0,v209,v213
v_sub_f32 v213,v213,v209
M v[148:151],a[244:247],a[228:231],v[148:151]
v_add_f32 v209,v235,v211
v_sub_f32 v235,v235,v211
M v[148:151],a[240:243],a[204:207],v[148:151]
v_fma_f32 v211,2.0,v213,v215
v_fmac_f32 v215,-2.0,v213
M v[148:151],v[228:231],a[252:255],v[148:151]
v_cvt_pk_bf16_f32 v205,v232,v205
v_cvt_pk_bf16_f32 v207,v237,v207
M v[152:155],v[228:231],a[204:207],v[152:155]
v_cvt_pk_bf16_f32 v209,v233,v209
v_cvt_pk_bf16_f32 v213,v234,v211
M v[152:155],a[240:243],a[228:231],v[152:155]
v_cvt_pk_bf16_f32 v211,v238,v235
v_cvt_pk_bf16_f32 v215,v236,v215
M v[152:155],a[244:247],a[216:219],v[152:155]
ds_write2st64_b64 v247,v[204:205],v[206:207] offset0:139 offset1:156
M v[156:159],a[244:247],v[224:227],v[156:159]
buffer_load_dwordx4 a[244:247],v250,s[20:23],s46 offen offset:1024 sc1
M v[156:159],a[240:243],a[216:219],v[156:159]
M v[156:159],v[228:231],a[228:231],v[156:159]
s_waitcnt vmcnt(10)
buffer_load_dwordx4 a[240:243],v250,s[20:23],s46 offen offset:2048 sc1
M v[160:163],a[248:251],a[192:195],v[160:163]
s_waitcnt vmcnt(10)
s_add_u32 s46,s77,27648
M v[160:163],a[196:199],a[232:235],v[160:163]
s_waitcnt vmcnt(9)
M v[160:163],a[208:211],a[236:239],v[160:163]
ds_write2st64_b64 v247,v[208:209],v[210:211] offset0:105 offset1:122
M v[164:167],a[208:211],a[212:215],v[164:167]
buffer_load_dwordx4 v[228:231],v250,s[20:23],s46 offen offset:0 sc1
M v[164:167],a[196:199],a[236:239],v[164:167]
s_waitcnt vmcnt(7)
v_permlane32_swap_b32 v196,v198
v_permlane32_swap_b32 v192,v194
M v[164:167],a[248:251],a[232:235],v[164:167]
ds_write2st64_b64 v247,v[212:213],v[214:215] offset0:37 offset1:54
M v[168:171],a[248:251],a[236:239],v[168:171]
buffer_load_dwordx4 a[192:195],v250,s[20:23],s46 offen offset:1024 sc1
M v[168:171],a[196:199],a[212:215],v[168:171]
s_waitcnt vmcnt(7)
v_permlane32_swap_b32 v200,v202
v_lshlrev_b32 v234,16,v198
M v[168:171],a[208:211],a[200:203],v[168:171]
v_lshlrev_b32 v232,16,v192
v_lshlrev_b32 v233,16,v196
M v[172:175],a[208:211],a[252:255],v[172:175]
v_lshlrev_b32 v237,16,v194
v_lshlrev_b32 v236,16,v202
M v[172:175],a[196:199],a[200:203],v[172:175]
buffer_load_dwordx4 a[232:235],v250,s[20:23],s46 offen offset:2048 sc1
M v[172:175],a[248:251],a[212:215],v[172:175]
s_add_u32 s46,s77,36864
v_lshlrev_b32 v235,16,v200
v_fmac_f32 v232,s43,v234
M v[176:179],a[248:251],a[200:203],v[176:179]
v_fmac_f32 v237,4.0,v233
v_fma_f32 v238,-4.0,v234,v236
M v[176:179],a[196:199],a[252:255],v[176:179]
v_fmac_f32 v232,s45,v236
v_fmac_f32 v237,s41,v235
M v[176:179],a[208:211],a[204:207],v[176:179]
s_waitcnt lgkmcnt(0)
s_barrier
v_sub_f32 v236,v236,v234
M v[180:183],a[208:211],a[228:231],v[180:183]
buffer_load_dwordx4 a[236:239],v250,s[20:23],s46 offen offset:0 sc1
M v[180:183],a[196:199],a[204:207],v[180:183]
ds_read_b128 a[212:215],v248 offset:34816
v_fma_f32 v234,-4.0,v233,v235
M v[180:183],a[248:251],a[252:255],v[180:183]
ds_read_b128 a[200:203],v249 offset:34816
v_sub_f32 v235,v235,v233
M v[184:187],a[248:251],a[204:207],v[184:187]
ds_read_b128 a[252:255],v248 offset:35328
v_add_f32 v233,v238,v234
M v[184:187],a[196:199],a[228:231],v[184:187]
ds_read_b128 a[204:207],v249 offset:35328
v_sub_f32 v238,v238,v234
M v[184:187],a[208:211],a[216:219],v[184:187]
v_fma_f32 v234,2.0,v235,v236
v_fmac_f32 v236,-2.0,v235
M v[188:191],a[208:211],v[224:227],v[188:191]
buffer_load_dwordx4 a[208:211],v250,s[20:23],s46 offen offset:1024 sc1
M v[188:191],a[196:199],a[216:219],v[188:191]
v_and_b32 v198,s42,v198
v_and_b32 v192,s42,v192
M v[188:191],a[248:251],a[228:231],v[188:191]
s_waitcnt lgkmcnt(3)
buffer_load_dwordx4 v[224:227],v250,s[20:23],s46 offen offset:2048 sc1
M a[0:3],v[220:223],a[212:215],a[0:3]
s_waitcnt vmcnt(10) lgkmcnt(2)
s_add_u32 s47,s77,12288
ds_read_b128 a[216:219],v248 offset:35840
v_and_b32 v196,s42,v196
M a[0:3],a[224:227],a[200:203],a[0:3]
s_waitcnt vmcnt(9) lgkmcnt(2)
ds_read_b128 a[228:231],v249 offset:35840
v_and_b32 v194,s42,v194
M a[0:3],a[220:223],a[252:255],a[0:3]
s_waitcnt lgkmcnt(2)
v_and_b32 v202,s42,v202
v_and_b32 v200,s42,v200
M a[4:7],a[220:223],a[204:207],a[4:7]
buffer_load_dwordx4 a[196:199],v250,s[20:23],s47 offen offset:0 sc1
M a[4:7],a[224:227],a[252:255],a[4:7]
v_fmac_f32 v192,s43,v198
v_fmac_f32 v194,4.0,v196
M a[4:7],v[220:223],a[200:203],a[4:7]
v_fma_f32 v235,-4.0,v198,v202
v_fmac_f32 v192,s45,v202
M a[8:11],v[220:223],a[252:255],a[8:11]
ds_read_b128 a[248:251],v248 offset:36352
v_fmac_f32 v194,s41,v200
M a[8:11],a[224:227],a[204:207],a[8:11]
s_waitcnt lgkmcnt(2)
ds_read_b128 a[212:215],v249 offset:36352
v_sub_f32 v202,v202,v198
M a[8:11],a[220:223],a[216:219],a[8:11]
s_waitcnt lgkmcnt(2)
v_fma_f32 v198,-4.0,v196,v200
v_sub_f32 v200,v200,v196
M a[12:15],a[220:223],a[228:231],a[12:15]
v_add_f32 v196,v235,v198
v_sub_f32 v235,v235,v198
M a[12:15],a[224:227],a[216:219],a[12:15]
v_fma_f32 v198,2.0,v200,v202
v_fmac_f32 v202,-2.0,v200
M a[12:15],v[220:223],a[204:207],a[12:15]
v_cvt_pk_bf16_f32 v192,v232,v192
v_cvt_pk_bf16_f32 v194,v237,v194
M a[16:19],v[220:223],a[216:219],a[16:19]
ds_read_b128 a[200:203],v249 offset:36864
v_cvt_pk_bf16_f32 v196,v233,v196
M a[16:19],a[224:227],a[228:231],a[16:19]
s_waitcnt lgkmcnt(2)
ds_read_b128 a[252:255],v248 offset:36864
v_cvt_pk_bf16_f32 v200,v234,v198
M a[16:19],a[220:223],a[248:251],a[16:19]
s_waitcnt lgkmcnt(2)
v_cvt_pk_bf16_f32 v198,v238,v235
v_cvt_pk_bf16_f32 v202,v236,v202
M a[20:23],a[220:223],a[212:215],a[20:23]
v_permlane32_swap_b32 v197,v199
v_permlane32_swap_b32 v193,v195
M a[20:23],a[224:227],a[248:251],a[20:23]
ds_read_b128 a[204:207],v248 offset:43520
v_permlane32_swap_b32 v201,v203
M a[20:23],v[220:223],a[228:231],a[20:23]
ds_read_b128 a[216:219],v249 offset:43520
v_lshlrev_b32 v234,16,v199
M a[24:27],v[220:223],a[248:251],a[24:27]
ds_read_b128 a[228:231],v248 offset:44032
v_lshlrev_b32 v232,16,v193
M a[24:27],a[224:227],a[212:215],a[24:27]
s_waitcnt lgkmcnt(4)
ds_read_b128 a[248:251],v249 offset:44032
v_lshlrev_b32 v233,16,v197
M a[24:27],a[220:223],a[200:203],a[24:27]
s_waitcnt lgkmcnt(4)
v_lshlrev_b32 v237,16,v195
v_lshlrev_b32 v236,16,v203
M a[28:31],a[220:223],a[252:255],a[28:31]
buffer_load_dwordx4 a[220:223],v250,s[20:23],s47 offen offset:1024 sc1
M a[28:31],a[224:227],a[200:203],a[28:31]
v_lshlrev_b32 v235,16,v201
v_fmac_f32 v232,s43,v234
M a[28:31],v[220:223],a[212:215],a[28:31]
s_waitcnt vmcnt(10) lgkmcnt(3)
buffer_load_dwordx4 a[252:255],v250,s[20:23],s47 offen offset:2048 sc1
M a[96:99],v[216:219],a[204:207],a[96:99]
s_waitcnt vmcnt(10) lgkmcnt(2)
s_add_u32 s48,s77,15360
ds_read_b128 a[224:227],v248 offset:44544
v_fmac_f32 v237,4.0,v233
M a[96:99],a[244:247],a[216:219],a[96:99]
s_waitcnt vmcnt(9) lgkmcnt(2)
ds_read_b128 a[212:215],v249 offset:44544
v_fma_f32 v238,-4.0,v234,v236
M a[96:99],a[240:243],a[228:231],a[96:99]
s_waitcnt lgkmcnt(2)
v_fmac_f32 v232,s45,v236
v_fmac_f32 v237,s41,v235
M a[100:103],a[240:243],a[248:251],a[100:103]
buffer_load_dwordx4 a[200:203],v250,s[20:23],s48 offen offset:0 sc1
M a[100:103],a[244:247],a[228:231],a[100:103]
v_sub_f32 v236,v236,v234
v_fma_f32 v234,-4.0,v233,v235
M a[100:103],v[216:219],a[216:219],a[100:103]
v_sub_f32 v235,v235,v233
v_add_f32 v233,v238,v234
M a[104:107],v[216:219],a[228:231],a[104:107]
ds_read_b128 v[220:223],v248 offset:45056
v_sub_f32 v238,v238,v234
M a[104:107],a[244:247],a[248:251],a[104:107]
s_waitcnt lgkmcnt(2)
ds_read_b128 a[204:207],v249 offset:45056
v_fma_f32 v234,2.0,v235,v236
M a[104:107],a[240:243],a[224:227],a[104:107]
s_waitcnt lgkmcnt(2)
v_fmac_f32 v236,-2.0,v235
v_and_b32 v199,s42,v199
M a[108:111],a[240:243],a[212:215],a[108:111]
v_and_b32 v193,s42,v193
v_and_b32 v197,s42,v197
M a[108:111],a[244:247],a[224:227],a[108:111]
v_and_b32 v195,s42,v195
v_and_b32 v203,s42,v203
M a[108:111],v[216:219],a[248:251],a[108:111]
v_and_b32 v201,s42,v201
v_fmac_f32 v193,s43,v199
M a[112:115],v[216:219],a[224:227],a[112:115]
ds_read_b128 a[216:219],v249 offset:45568
v_fmac_f32 v195,4.0,v197
M a[112:115],a[244:247],a[212:215],a[112:115]
s_waitcnt lgkmcnt(2)
ds_read_b128 a[228:231],v248 offset:45568
v_and_b32 v255,256,v245
M a[112:115],a[240:243],v[220:223],a[112:115]
s_waitcnt lgkmcnt(2)
v_mul_u32_u24 v255,3,v255
v_and_or_b32 v255,v245,s42,v255
M a[116:119],a[240:243],a[204:207],a[116:119]
v_fma_f32 v235,-4.0,v199,v203
v_fmac_f32 v193,s45,v203
M a[116:119],a[244:247],v[220:223],a[116:119]
ds_read_b128 a[248:251],v248 offset:0
v_fmac_f32 v195,s41,v201
M a[116:119],v[216:219],a[212:215],a[116:119]
s_add_u32 s31,s66,6684672
ds_read_b128 a[224:227],v249 offset:0
v_sub_f32 v203,v203,v199
M a[120:123],v[216:219],v[220:223],a[120:123]
ds_read_b128 a[212:215],v248 offset:512
v_fma_f32 v199,-4.0,v197,v201
M a[120:123],a[244:247],a[204:207],a[120:123]
s_waitcnt lgkmcnt(4)
ds_read_b128 v[220:223],v249 offset:512
v_sub_f32 v201,v201,v197
M a[120:123],a[240:243],a[216:219],a[120:123]
s_waitcnt lgkmcnt(4)
v_add_f32 v197,v235,v199
v_sub_f32 v235,v235,v199
M a[124:127],a[240:243],a[228:231],a[124:127]
buffer_load_dword a228,v255,s[8:11],s31 offen offset:0
M a[124:127],a[244:247],a[216:219],a[124:127]
v_fma_f32 v199,2.0,v201,v203
v_fmac_f32 v203,-2.0,v201
M a[124:127],v[216:219],a[204:207],a[124:127]
s_waitcnt vmcnt(10) lgkmcnt(3)
v_cvt_pk_bf16_f32 v193,v232,v193
v_cvt_pk_bf16_f32 v195,v237,v195
M v[0:3],v[228:231],a[248:251],v[0:3]
s_waitcnt vmcnt(9) lgkmcnt(2)
ds_read_b128 a[240:243],v248 offset:1024
v_cvt_pk_bf16_f32 v197,v233,v197
M v[0:3],a[192:195],a[224:227],v[0:3]
s_waitcnt vmcnt(8) lgkmcnt(2)
buffer_load_dword a228,v255,s[8:11],s31 offen offset:384
M v[0:3],a[232:235],a[212:215],v[0:3]
s_waitcnt lgkmcnt(1)
ds_read_b128 a[216:219],v249 offset:1024
v_cvt_pk_bf16_f32 v201,v234,v199
M v[4:7],a[232:235],v[220:223],v[4:7]
v_cvt_pk_bf16_f32 v199,v238,v235
v_cvt_pk_bf16_f32 v203,v236,v203
M v[4:7],a[192:195],a[212:215],v[4:7]
M v[4:7],v[228:231],a[224:227],v[4:7]
M v[8:11],v[228:231],a[212:215],v[8:11]
ds_read_b128 a[244:247],v248 offset:1536
M v[8:11],a[192:195],v[220:223],v[8:11]
s_waitcnt lgkmcnt(2)
ds_read_b128 a[204:207],v249 offset:1536
M v[8:11],a[232:235],a[240:243],v[8:11]
s_waitcnt lgkmcnt(2)
M v[12:15],a[232:235],a[216:219],v[12:15]
M v[12:15],a[192:195],a[240:243],v[12:15]
M v[12:15],v[228:231],v[220:223],v[12:15]
M v[16:19],v[228:231],a[240:243],v[16:19]
ds_read_b128 v[216:219],v249 offset:2048
M v[16:19],a[192:195],a[216:219],v[16:19]
s_waitcnt lgkmcnt(2)
buffer_load_dwordx4 a[228:231],v250,s[20:23],s48 offen offset:1024 sc1
M v[16:19],a[232:235],a[244:247],v[16:19]
s_waitcnt lgkmcnt(1)
ds_read_b128 a[248:251],v248 offset:2048
M v[20:23],a[232:235],a[204:207],v[20:23]
buffer_load_dwordx4 a[224:227],v250,s[20:23],s48 offen offset:2048 sc1
M v[20:23],a[192:195],a[244:247],v[20:23]
ds_read_b128 a[212:215],v248 offset:8704
M v[20:23],v[228:231],a[216:219],v[20:23]
ds_read_b128 v[220:223],v249 offset:8704
M v[24:27],v[228:231],a[244:247],v[24:27]
ds_read_b128 a[240:243],v248 offset:9216
M v[24:27],a[192:195],a[204:207],v[24:27]
s_waitcnt lgkmcnt(4)
ds_read_b128 a[216:219],v249 offset:9216
M v[24:27],a[232:235],v[216:219],v[24:27]
s_waitcnt lgkmcnt(4)
M v[28:31],a[232:235],a[248:251],v[28:31]
s_add_u32 s47,s77,21504
M v[28:31],a[192:195],v[216:219],v[28:31]
M v[28:31],v[228:231],a[204:207],v[28:31]
s_waitcnt vmcnt(10) lgkmcnt(3)
M v[96:99],a[236:239],a[212:215],v[96:99]
s_waitcnt vmcnt(9) lgkmcnt(2)
ds_read_b128 a[244:247],v248 offset:9728
M v[96:99],a[208:211],v[220:223],v[96:99]
s_waitcnt vmcnt(8) lgkmcnt(2)
ds_read_b128 a[232:235],v249 offset:9728
M v[96:99],v[224:227],a[240:243],v[96:99]
s_waitcnt lgkmcnt(2)
M v[100:103],v[224:227],a[216:219],v[100:103]
buffer_load_dwordx4 a[248:251],v250,s[20:23],s47 offen offset:0 sc1
M v[100:103],a[208:211],a[240:243],v[100:103]
M v[100:103],a[236:239],v[220:223],v[100:103]
buffer_load_dwordx4 a[192:195],v250,s[20:23],s47 offen offset:1024 sc1
M v[104:107],a[236:239],a[240:243],v[104:107]
ds_read_b128 v[228:231],v248 offset:10240
v_accvgpr_read_b32 v238,a0
M v[104:107],a[208:211],a[216:219],v[104:107]
s_waitcnt lgkmcnt(2)
ds_read_b128 a[212:215],v249 offset:10240
v_accvgpr_read_b32 v232,a96
M v[104:107],v[224:227],a[244:247],v[104:107]
s_waitcnt lgkmcnt(2)
v_add_f32 v234,v238,v232
v_sub_f32 v238,v238,v232
M v[108:111],v[224:227],a[232:235],v[108:111]
buffer_load_dwordx4 v[216:219],v250,s[20:23],s47 offen offset:2048 sc1
M v[108:111],a[208:211],a[244:247],v[108:111]
s_add_u32 s48,s77,24576
v_add_f32 v232,v0,v96
v_sub_f32 v96,v0,v96
M v[108:111],a[236:239],a[216:219],v[108:111]
v_add_f32 v0,v234,v232
v_fmac_f32 v234,4.0,v232
M v[112:115],a[236:239],a[244:247],v[112:115]
ds_read_b128 v[220:223],v249 offset:10752
v_fma_f32 v232,2.0,v96,v238
M v[112:115],a[208:211],a[232:235],v[112:115]
s_waitcnt lgkmcnt(2)
buffer_load_dwordx4 a[204:207],v250,s[20:23],s48 offen offset:0 sc1
M v[112:115],v[224:227],v[228:231],v[112:115]
s_waitcnt lgkmcnt(1)
ds_read_b128 a[240:243],v248 offset:10752
v_fma_f32 v96,s40,v96,v238
M v[116:119],v[224:227],a[212:215],v[116:119]
v_accvgpr_read_b32 v238,a1
v_accvgpr_read_b32 v237,a97
M v[116:119],a[208:211],v[228:231],v[116:119]
ds_read_b128 a[216:219],v248 offset:34816
v_add_f32 v236,v238,v237
M v[116:119],a[236:239],a[232:235],v[116:119]
ds_read_b128 a[244:247],v249 offset:34816
v_sub_f32 v238,v238,v237
M v[120:123],a[236:239],v[228:231],v[120:123]
ds_read_b128 a[232:235],v248 offset:35328
v_add_f32 v237,v1,v97
M v[120:123],a[208:211],a[212:215],v[120:123]
s_waitcnt lgkmcnt(4)
ds_read_b128 v[228:231],v249 offset:35328
v_sub_f32 v97,v1,v97
M v[120:123],v[224:227],v[220:223],v[120:123]
s_waitcnt lgkmcnt(4)
v_add_f32 v1,v236,v237
v_fmac_f32 v236,4.0,v237
M v[124:127],v[224:227],a[240:243],v[124:127]
v_fma_f32 v237,2.0,v97,v238
v_fma_f32 v97,s40,v97,v238
M v[124:127],a[208:211],v[220:223],v[124:127]
v_cvt_pk_bf16_f32 v232,v232,v237
v_cvt_pk_bf16_f32 v234,v234,v236
M v[124:127],a[236:239],a[212:215],v[124:127]
s_waitcnt vmcnt(11) lgkmcnt(3)
v_accvgpr_read_b32 v238,a2
v_accvgpr_read_b32 v233,a98
M a[32:35],a[196:199],a[216:219],a[32:35]
s_waitcnt vmcnt(10) lgkmcnt(2)
ds_read_b128 a[240:243],v248 offset:35840
v_add_f32 v235,v238,v233
M a[32:35],a[220:223],a[244:247],a[32:35]
s_waitcnt vmcnt(9) lgkmcnt(2)
ds_read_b128 v[224:227],v249 offset:35840
v_sub_f32 v238,v238,v233
M a[32:35],a[252:255],a[232:235],a[32:35]
s_waitcnt lgkmcnt(2)
v_add_f32 v233,v2,v98
v_sub_f32 v98,v2,v98
M a[36:39],a[252:255],v[228:231],a[36:39]
v_add_f32 v2,v235,v233
v_fmac_f32 v235,4.0,v233
M a[36:39],a[220:223],a[232:235],a[36:39]
v_fma_f32 v233,2.0,v98,v238
v_fma_f32 v98,s40,v98,v238
M a[36:39],a[196:199],a[244:247],a[36:39]
v_accvgpr_read_b32 v238,a3
v_accvgpr_read_b32 v237,a99
M a[40:43],a[196:199],a[232:235],a[40:43]
ds_read_b128 a[96:99],v248 offset:36352
v_add_f32 v236,v238,v237
M a[40:43],a[220:223],v[228:231],a[40:43]
s_waitcnt lgkmcnt(2)
ds_read_b128 a[208:211],v249 offset:36352
v_sub_f32 v238,v238,v237
M a[40:43],a[252:255],a[240:243],a[40:43]
s_waitcnt lgkmcnt(2)
v_add_f32 v237,v3,v99
v_sub_f32 v99,v3,v99
M a[44:47],a[252:255],v[224:227],a[44:47]
v_add_f32 v3,v236,v237
v_fmac_f32 v236,4.0,v237
M a[44:47],a[220:223],a[240:243],a[44:47]
v_fma_f32 v237,2.0,v99,v238
v_fma_f32 v99,s40,v99,v238
M a[44:47],a[196:199],v[228:231],a[44:47]
v_cvt_pk_bf16_f32 v233,v233,v237
v_cvt_pk_bf16_f32 v235,v235,v236
M a[48:51],a[196:199],a[240:243],a[48:51]
ds_read_b128 v[220:223],v249 offset:36864
ds_write2st64_b64 v254,v[232:233],v[234:235] offset0:68 offset1:72
M a[48:51],a[220:223],v[224:227],a[48:51]
s_waitcnt lgkmcnt(3)
ds_read_b128 a[212:215],v248 offset:36864
v_accvgpr_read_b32 v238,a4
M a[48:51],a[252:255],a[96:99],a[48:51]
s_waitcnt lgkmcnt(3)
v_accvgpr_read_b32 v232,a100
v_add_f32 v234,v238,v232
M a[52:55],a[252:255],a[208:211],a[52:55]
buffer_load_dwordx4 a[236:239],v250,s[20:23],s48 offen offset:1024 sc1
M a[52:55],a[220:223],a[96:99],a[52:55]
v_sub_f32 v238,v238,v232
v_add_f32 v232,v4,v100
M a[52:55],a[196:199],v[224:227],a[52:55]
v_sub_f32 v100,v4,v100
v_add_f32 v4,v234,v232
M a[56:59],a[196:199],a[96:99],a[56:59]
v_fmac_f32 v234,4.0,v232
v_fma_f32 v232,2.0,v100,v238
M a[56:59],a[220:223],a[208:211],a[56:59]
s_waitcnt lgkmcnt(2)
v_fma_f32 v100,s40,v100,v238
v_accvgpr_read_b32 v238,a5
M a[56:59],a[252:255],v[220:223],a[56:59]
s_waitcnt lgkmcnt(0)
v_accvgpr_read_b32 v237,a101
v_add_f32 v236,v238,v237
M a[60:63],a[252:255],a[212:215],a[60:63]
buffer_load_dwordx4 a[252:255],v250,s[20:23],s48 offen offset:2048 sc1
M a[60:63],a[220:223],v[220:223],a[60:63]
s_add_u32 s47,s77,30720
v_sub_f32 v238,v238,v237
v_add_f32 v237,v5,v101
M a[60:63],a[196:199],a[208:211],a[60:63]
s_waitcnt vmcnt(10)
buffer_load_dwordx4 a[220:223],v250,s[20:23],s47 offen offset:0 sc1
M a[64:67],a[200:203],a[216:219],a[64:67]
s_waitcnt vmcnt(8)
v_sub_f32 v101,v5,v101
v_add_f32 v5,v236,v237
M a[64:67],a[228:231],a[244:247],a[64:67]
s_waitcnt vmcnt(7)
v_fmac_f32 v236,4.0,v237
v_fma_f32 v237,2.0,v101,v238
M a[64:67],a[224:227],a[232:235],a[64:67]
v_fma_f32 v101,s40,v101,v238
v_cvt_pk_bf16_f32 v232,v232,v237
M a[68:71],a[224:227],v[228:231],a[68:71]
buffer_load_dwordx4 a[196:199],v250,s[20:23],s47 offen offset:1024 sc1
M a[68:71],a[228:231],a[232:235],a[68:71]
v_cvt_pk_bf16_f32 v234,v234,v236
v_accvgpr_read_b32 v238,a6
M a[68:71],a[200:203],a[244:247],a[68:71]
v_accvgpr_read_b32 v233,a102
v_add_f32 v235,v238,v233
M a[72:75],a[200:203],a[232:235],a[72:75]
v_sub_f32 v238,v238,v233
v_add_f32 v233,v6,v102
M a[72:75],a[228:231],v[228:231],a[72:75]
buffer_load_dwordx4 a[216:219],v250,s[20:23],s47 offen offset:2048 sc1
M a[72:75],a[224:227],a[240:243],a[72:75]
s_add_u32 s48,s77,33792
v_sub_f32 v102,v6,v102
v_add_f32 v6,v235,v233
M a[76:79],a[224:227],v[224:227],a[76:79]
v_fmac_f32 v235,4.0,v233
v_fma_f32 v233,2.0,v102,v238
M a[76:79],a[228:231],a[240:243],a[76:79]
v_fma_f32 v102,s40,v102,v238
v_accvgpr_read_b32 v238,a7
M a[76:79],a[200:203],v[228:231],a[76:79]
buffer_load_dwordx4 a[244:247],v250,s[20:23],s48 offen offset:0 sc1
M a[80:83],a[200:203],a[240:243],a[80:83]
v_accvgpr_read_b32 v237,a103
v_add_f32 v236,v238,v237
M a[80:83],a[228:231],v[224:227],a[80:83]
v_sub_f32 v238,v238,v237
v_add_f32 v237,v7,v103
M a[80:83],a[224:227],a[96:99],a[80:83]
v_sub_f32 v103,v7,v103
v_add_f32 v7,v236,v237
M a[84:87],a[224:227],a[208:211],a[84:87]
buffer_load_dwordx4 a[232:235],v250,s[20:23],s48 offen offset:1024 sc1
M a[84:87],a[228:231],a[96:99],a[84:87]
ds_read_b128 a[100:103],v248 offset:43520
v_fmac_f32 v236,4.0,v237
M a[84:87],a[200:203],v[224:227],a[84:87]
s_add_u32 s31,s66,7077888
ds_read_b128 v[228:231],v249 offset:43520
v_fma_f32 v237,2.0,v103,v238
M a[88:91],a[200:203],a[96:99],a[88:91]
ds_read_b128 a[96:99],v248 offset:44032
v_fma_f32 v103,s40,v103,v238
M a[88:91],a[228:231],a[208:211],a[88:91]
ds_read_b128 a[240:243],v249 offset:44032
v_cvt_pk_bf16_f32 v233,v233,v237
M a[88:91],a[224:227],v[220:223],a[88:91]
v_cvt_pk_bf16_f32 v235,v235,v236
M a[92:95],a[224:227],a[212:215],a[92:95]
buffer_load_dword v224,v255,s[8:11],s31 offen offset:0
M a[92:95],a[228:231],v[220:223],a[92:95]
ds_write2st64_b64 v254,v[232:233],v[234:235] offset0:76 offset1:80
M a[92:95],a[200:203],a[208:211],a[92:95]
s_waitcnt vmcnt(11) lgkmcnt(4)
v_accvgpr_read_b32 v238,a8
v_accvgpr_read_b32 v232,a104
M a[128:131],a[248:251],a[100:103],a[128:131]
s_waitcnt vmcnt(10) lgkmcnt(3)
ds_read_b128 a[212:215],v248 offset:44544
v_add_f32 v234,v238,v232
M a[128:131],a[192:195],v[228:231],a[128:131]
s_waitcnt vmcnt(9) lgkmcnt(3)
buffer_load_dword v224,v255,s[8:11],s31 offen offset:384
M a[128:131],v[216:219],a[96:99],a[128:131]
s_waitcnt lgkmcnt(2)
ds_read_b128 a[224:227],v249 offset:44544
v_sub_f32 v238,v238,v232
M a[132:135],v[216:219],a[240:243],a[132:135]
v_add_f32 v232,v8,v104
v_sub_f32 v104,v8,v104
M a[132:135],a[192:195],a[96:99],a[132:135]
v_add_f32 v8,v234,v232
v_fmac_f32 v234,4.0,v232
M a[132:135],a[248:251],v[228:231],a[132:135]
v_fma_f32 v232,2.0,v104,v238
v_fma_f32 v104,s40,v104,v238
M a[136:139],a[248:251],a[96:99],a[136:139]
s_waitcnt lgkmcnt(2)
s_barrier
ds_read_b128 a[0:3],v250 offset:34816
M a[136:139],a[192:195],a[240:243],a[136:139]
s_waitcnt lgkmcnt(2)
ds_read_b128 a[4:7],v250 offset:38912
ds_read_b128 a[228:231],v248 offset:45056
M a[136:139],v[216:219],a[212:215],a[136:139]
s_waitcnt lgkmcnt(3)
ds_read_b128 v[220:223],v249 offset:45056
v_accvgpr_read_b32 v238,a9
M a[140:143],v[216:219],a[224:227],a[140:143]
v_accvgpr_read_b32 v237,a105
v_add_f32 v236,v238,v237
M a[140:143],a[192:195],a[212:215],a[140:143]
v_sub_f32 v238,v238,v237
v_add_f32 v237,v9,v105
M a[140:143],a[248:251],a[240:243],a[140:143]
v_sub_f32 v105,v9,v105
v_add_f32 v9,v236,v237
M a[144:147],a[248:251],a[212:215],a[144:147]
ds_read_b128 a[200:203],v249 offset:45568
v_fmac_f32 v236,4.0,v237
M a[144:147],a[192:195],a[224:227],a[144:147]
s_waitcnt lgkmcnt(2)
ds_read_b128 a[208:211],v248 offset:45568
v_fma_f32 v237,2.0,v105,v238
M a[144:147],v[216:219],a[228:231],a[144:147]
s_waitcnt lgkmcnt(2)
buffer_load_dwordx4 v[224:227],v250,s[20:23],s48 offen offset:2048 sc1
M a[148:151],v[216:219],v[220:223],a[148:151]
v_fma_f32 v105,s40,v105,v238
v_cvt_pk_bf16_f32 v232,v232,v237
M a[148:151],a[192:195],a[228:231],a[148:151]
v_cvt_pk_bf16_f32 v234,v234,v236
v_accvgpr_read_b32 v238,a10
M a[148:151],a[248:251],a[224:227],a[148:151]
v_accvgpr_read_b32 v233,a106
v_add_f32 v235,v238,v233
M a[152:155],a[248:251],a[228:231],a[152:155]
v_sub_f32 v238,v238,v233
v_add_f32 v233,v10,v106
M a[152:155],a[192:195],v[220:223],a[152:155]
s_waitcnt lgkmcnt(1)
v_sub_f32 v106,v10,v106
v_add_f32 v10,v235,v233
M a[152:155],v[216:219],a[200:203],a[152:155]
s_waitcnt lgkmcnt(0)
v_fmac_f32 v235,4.0,v233
v_fma_f32 v233,2.0,v106,v238
M a[156:159],v[216:219],a[208:211],a[156:159]
global_load_dword v216,v250,s[64:65]
M a[156:159],a[192:195],a[200:203],a[156:159]
s_add_u32 s47,s77,39936
v_fma_f32 v106,s40,v106,v238
v_accvgpr_read_b32 v238,a11
M a[156:159],a[248:251],v[220:223],a[156:159]
s_waitcnt vmcnt(11)
v_accvgpr_read_b32 v237,a107
v_add_f32 v236,v238,v237
M a[160:163],a[204:207],a[100:103],a[160:163]
s_waitcnt vmcnt(10)
v_sub_f32 v238,v238,v237
v_add_f32 v237,v11,v107
M a[160:163],a[236:239],v[228:231],a[160:163]
s_waitcnt vmcnt(9)
v_sub_f32 v107,v11,v107
v_add_f32 v11,v236,v237
M a[160:163],a[252:255],a[96:99],a[160:163]
v_fmac_f32 v236,4.0,v237
v_fma_f32 v237,2.0,v107,v238
M a[164:167],a[252:255],a[240:243],a[164:167]
buffer_load_dwordx4 v[216:219],v250,s[20:23],s47 offen offset:0 sc1
M a[164:167],a[236:239],a[96:99],a[164:167]
v_fma_f32 v107,s40,v107,v238
v_cvt_pk_bf16_f32 v233,v233,v237
M a[164:167],a[204:207],v[228:231],a[164:167]
buffer_load_dwordx4 a[100:103],v250,s[20:23],s47 offen offset:1024 sc1
M a[168:171],a[204:207],a[96:99],a[168:171]
v_cvt_pk_bf16_f32 v235,v235,v236
M a[168:171],a[236:239],a[240:243],a[168:171]
ds_write2st64_b64 v254,v[232:233],v[234:235] offset0:85 offset1:89
M a[168:171],a[252:255],a[212:215],a[168:171]
v_accvgpr_read_b32 v204,a12
v_accvgpr_read_b32 v208,a108
M a[172:175],a[252:255],a[224:227],a[172:175]
buffer_load_dwordx4 a[104:107],v250,s[20:23],s47 offen offset:2048 sc1
M a[172:175],a[236:239],a[212:215],a[172:175]
s_add_u32 s48,s77,43008
v_accvgpr_read_b32 v205,a13
v_accvgpr_read_b32 v209,a109
M a[172:175],a[204:207],a[240:243],a[172:175]
v_accvgpr_read_b32 v206,a14
v_accvgpr_read_b32 v210,a110
v_accvgpr_read_b32 v207,a15
v_accvgpr_read_b32 v211,a111
v_pk_add_f32 v[212:213],v[204:205],v[208:209]
v_pk_add_f32 v[214:215],v[206:207],v[210:211]
v_pk_add_f32 v[204:205],v[204:205],v[208:209] neg_lo:[0,1] neg_hi:[0,1]
v_pk_add_f32 v[206:207],v[206:207],v[210:211] neg_lo:[0,1] neg_hi:[0,1]
v_pk_add_f32 v[208:209],v[12:13],v[108:109]
v_pk_add_f32 v[210:211],v[14:15],v[110:111]
v_pk_add_f32 v[108:109],v[12:13],v[108:109] neg_lo:[0,1] neg_hi:[0,1]
v_pk_add_f32 v[110:111],v[14:15],v[110:111] neg_lo:[0,1] neg_hi:[0,1]
v_pk_add_f32 v[12:13],v[212:213],v[208:209]
v_pk_add_f32 v[14:15],v[214:215],v[210:211]
v_pk_fma_f32 v[212:213],v[208:209],4.0,v[212:213] op_sel_hi:[1,0,1]
v_pk_fma_f32 v[214:215],v[210:211],4.0,v[214:215] op_sel_hi:[1,0,1]
v_pk_fma_f32 v[208:209],v[108:109],2.0,v[204:205] op_sel_hi:[1,0,1]
v_pk_fma_f32 v[210:211],v[110:111],2.0,v[206:207] op_sel_hi:[1,0,1]
v_pk_fma_f32 v[108:109],v[108:109],s[40:41],v[204:205] op_sel_hi:[1,0,1]
v_pk_fma_f32 v[110:111],v[110:111],s[40:41],v[206:207] op_sel_hi:[1,0,1]
M a[176:179],a[204:207],a[212:215],a[176:179]
buffer_load_dwordx4 a[192:195],v250,s[20:23],s48 offen offset:0 sc1
M a[176:179],a[236:239],a[224:227],a[176:179]
v_cvt_pk_bf16_f32 v208,v208,v209
v_cvt_pk_bf16_f32 v209,v210,v211
M a[176:179],a[252:255],a[228:231],a[176:179]
buffer_load_dwordx4 a[248:251],v250,s[20:23],s48 offen offset:1024 sc1
M a[180:183],a[252:255],v[220:223],a[180:183]
v_cvt_pk_bf16_f32 v212,v212,v213
v_cvt_pk_bf16_f32 v213,v214,v215
M a[180:183],a[236:239],a[228:231],a[180:183]
ds_read_b128 a[108:111],v248 offset:0
ds_write2st64_b64 v254,v[208:209],v[212:213] offset0:93 offset1:97
M a[180:183],a[204:207],a[224:227],a[180:183]
buffer_load_dwordx4 a[96:99],v250,s[20:23],s48 offen offset:2048 sc1
M a[184:187],a[204:207],a[228:231],a[184:187]
s_add_u32 s46,s72,0
ds_read_b128 a[240:243],v249 offset:0
ds_read_b128 a[212:215],v248 offset:512
M a[184:187],a[236:239],v[220:223],a[184:187]
ds_read_b128 a[224:227],v249 offset:512
v_accvgpr_read_b32 v238,a16
M a[184:187],a[252:255],a[200:203],a[184:187]
v_accvgpr_read_b32 v232,a112
v_add_f32 v234,v238,v232
M a[188:191],a[252:255],a[208:211],a[188:191]
buffer_load_dwordx4 v[228:231],v250,s[20:23],s46 offen offset:0 sc1
M a[188:191],a[236:239],a[200:203],a[188:191]
v_sub_f32 v238,v238,v232
v_add_f32 v232,v16,v112
M a[188:191],a[204:207],v[220:223],a[188:191]
s_waitcnt vmcnt(15) lgkmcnt(4)
v_sub_f32 v112,v16,v112
v_add_f32 v16,v234,v232
M v[32:35],a[220:223],a[108:111],v[32:35]
s_waitcnt vmcnt(14) lgkmcnt(2)
ds_read_b128 a[208:211],v248 offset:1024
v_fmac_f32 v234,4.0,v232
M v[32:35],a[196:199],a[240:243],v[32:35]
s_waitcnt vmcnt(13) lgkmcnt(2)
buffer_load_dwordx4 a[228:231],v250,s[20:23],s46 offen offset:1024 sc1
M v[32:35],a[216:219],a[212:215],v[32:35]
s_waitcnt lgkmcnt(1)
ds_read_b128 a[252:255],v249 offset:1024
v_fma_f32 v232,2.0,v112,v238
M v[36:39],a[216:219],a[224:227],v[36:39]
v_fma_f32 v112,s40,v112,v238
M v[36:39],a[196:199],a[212:215],v[36:39]
s_barrier
ds_read_b128 a[8:11],v250 offset:43520
M v[36:39],a[220:223],a[240:243],v[36:39]
ds_read_b128 a[12:15],v250 offset:47616
v_accvgpr_read_b32 v238,a17
M v[40:43],a[220:223],a[212:215],v[40:43]
ds_read_b128 a[200:203],v248 offset:1536
v_accvgpr_read_b32 v237,a113
M v[40:43],a[196:199],a[224:227],v[40:43]
s_waitcnt lgkmcnt(4)
ds_read_b128 a[236:239],v249 offset:1536
v_add_f32 v236,v238,v237
M v[40:43],a[216:219],a[208:211],v[40:43]
s_waitcnt lgkmcnt(4)
v_sub_f32 v238,v238,v237
v_add_f32 v237,v17,v113
M v[44:47],a[216:219],a[252:255],v[44:47]
v_sub_f32 v113,v17,v113
v_add_f32 v17,v236,v237
M v[44:47],a[196:199],a[208:211],v[44:47]
v_fmac_f32 v236,4.0,v237
v_fma_f32 v237,2.0,v113,v238
M v[44:47],a[220:223],a[224:227],v[44:47]
v_fma_f32 v113,s40,v113,v238
v_cvt_pk_bf16_f32 v232,v232,v237
M v[48:51],a[220:223],a[208:211],v[48:51]
ds_read_b128 a[204:207],v249 offset:2048
v_cvt_pk_bf16_f32 v234,v234,v236
M v[48:51],a[196:199],a[252:255],v[48:51]
s_waitcnt lgkmcnt(2)
ds_read_b128 v[220:223],v248 offset:2048
v_accvgpr_read_b32 v238,a18
M v[48:51],a[216:219],a[200:203],v[48:51]
s_waitcnt lgkmcnt(2)
v_accvgpr_read_b32 v233,a114
v_add_f32 v235,v238,v233
M v[52:55],a[216:219],a[236:239],v[52:55]
v_sub_f32 v238,v238,v233
v_add_f32 v233,v18,v114
M v[52:55],a[196:199],a[200:203],v[52:55]
v_sub_f32 v114,v18,v114
v_add_f32 v18,v235,v233
M v[52:55],a[220:223],a[252:255],v[52:55]
v_fmac_f32 v235,4.0,v233
v_fma_f32 v233,2.0,v114,v238
M v[56:59],a[220:223],a[200:203],v[56:59]
v_fma_f32 v114,s40,v114,v238
v_accvgpr_read_b32 v238,a19
M v[56:59],a[196:199],a[236:239],v[56:59]
s_waitcnt lgkmcnt(1)
v_accvgpr_read_b32 v237,a115
v_add_f32 v236,v238,v237
M v[56:59],a[216:219],a[204:207],v[56:59]
s_waitcnt lgkmcnt(0)
v_sub_f32 v238,v238,v237
v_add_f32 v237,v19,v115
M v[60:63],a[216:219],v[220:223],v[60:63]
buffer_load_dwordx4 a[112:115],v250,s[20:23],s46 offen offset:2048 sc1
M v[60:63],a[196:199],a[204:207],v[60:63]
s_add_u32 s46,s73,0
v_sub_f32 v115,v19,v115
v_add_f32 v19,v236,v237
M v[60:63],a[220:223],a[236:239],v[60:63]
s_waitcnt vmcnt(14)
buffer_load_dwordx4 a[216:219],v250,s[20:23],s46 offen offset:0 sc1
M v[64:67],a[244:247],a[108:111],v[64:67]
s_waitcnt vmcnt(14)
v_fmac_f32 v236,4.0,v237
v_fma_f32 v237,2.0,v115,v238
M v[64:67],a[232:235],a[240:243],v[64:67]
s_waitcnt vmcnt(11)
v_fma_f32 v115,s40,v115,v238
v_cvt_pk_bf16_f32 v233,v233,v237
M v[64:67],v[224:227],a[212:215],v[64:67]
v_cvt_pk_bf16_f32 v235,v235,v236
M v[68:71],v[224:227],a[224:227],v[68:71]
buffer_load_dwordx4 a[196:199],v250,s[20:23],s46 offen offset:1024 sc1
M v[68:71],a[232:235],a[212:215],v[68:71]
ds_write2st64_b64 v254,v[232:233],v[234:235] offset0:68 offset1:72
M v[68:71],a[244:247],a[240:243],v[68:71]
v_accvgpr_read_b32 v238,a20
v_accvgpr_read_b32 v232,a116
M v[72:75],a[244:247],a[212:215],v[72:75]
v_add_f32 v234,v238,v232
v_sub_f32 v238,v238,v232
M v[72:75],a[232:235],a[224:227],v[72:75]
buffer_load_dwordx4 a[108:111],v250,s[20:23],s46 offen offset:2048 sc1
M v[72:75],v[224:227],a[208:211],v[72:75]
s_add_u32 s31,s66,7471104
v_add_f32 v232,v20,v116
v_sub_f32 v116,v20,v116
M v[76:79],v[224:227],a[252:255],v[76:79]
v_add_f32 v20,v234,v232
v_fmac_f32 v234,4.0,v232
M v[76:79],a[232:235],a[208:211],v[76:79]
v_fma_f32 v232,2.0,v116,v238
v_fma_f32 v116,s40,v116,v238
M v[76:79],a[244:247],a[224:227],v[76:79]
buffer_load_dword a220,v255,s[8:11],s31 offen offset:0
M v[80:83],a[244:247],a[208:211],v[80:83]
v_accvgpr_read_b32 v238,a21
v_accvgpr_read_b32 v237,a117
M v[80:83],a[232:235],a[252:255],v[80:83]
v_add_f32 v236,v238,v237
v_sub_f32 v238,v238,v237
M v[80:83],v[224:227],a[200:203],v[80:83]
v_add_f32 v237,v21,v117
v_sub_f32 v117,v21,v117
M v[84:87],v[224:227],a[236:239],v[84:87]
buffer_load_dword a220,v255,s[8:11],s31 offen offset:384
M v[84:87],a[232:235],a[200:203],v[84:87]
ds_read_b128 a[240:243],v248 offset:8704
v_add_f32 v21,v236,v237
M v[84:87],a[244:247],a[252:255],v[84:87]
ds_read_b128 a[212:215],v249 offset:8704
v_fmac_f32 v236,4.0,v237
M v[88:91],a[244:247],a[200:203],v[88:91]
ds_read_b128 a[224:227],v248 offset:9216
v_fma_f32 v237,2.0,v117,v238
M v[88:91],a[232:235],a[236:239],v[88:91]
ds_read_b128 a[208:211],v249 offset:9216
v_fma_f32 v117,s40,v117,v238
M v[88:91],v[224:227],a[204:207],v[88:91]
v_cvt_pk_bf16_f32 v232,v232,v237
v_cvt_pk_bf16_f32 v234,v234,v236
M v[92:95],v[224:227],v[220:223],v[92:95]
v_accvgpr_read_b32 v238,a22
v_accvgpr_read_b32 v233,a118
M v[92:95],a[232:235],a[204:207],v[92:95]
v_add_f32 v235,v238,v233
v_sub_f32 v238,v238,v233
M v[92:95],a[244:247],a[236:239],v[92:95]
s_waitcnt vmcnt(13) lgkmcnt(3)
v_add_f32 v233,v22,v118
v_sub_f32 v118,v22,v118
M v[128:131],v[216:219],a[240:243],v[128:131]
s_waitcnt vmcnt(12) lgkmcnt(2)
ds_read_b128 a[252:255],v248 offset:9728
v_add_f32 v22,v235,v233
M v[128:131],a[100:103],a[212:215],v[128:131]
s_waitcnt vmcnt(11) lgkmcnt(2)
ds_read_b128 a[200:203],v249 offset:9728
v_fmac_f32 v235,4.0,v233
M v[128:131],a[104:107],a[224:227],v[128:131]
s_waitcnt lgkmcnt(2)
v_fma_f32 v233,2.0,v118,v238
v_fma_f32 v118,s40,v118,v238
M v[132:135],a[104:107],a[208:211],v[132:135]
v_accvgpr_read_b32 v238,a23
v_accvgpr_read_b32 v237,a119
M v[132:135],a[100:103],a[224:227],v[132:135]
v_add_f32 v236,v238,v237
v_sub_f32 v238,v238,v237
M v[132:135],v[216:219],a[212:215],v[132:135]
s_add_u32 s46,s74,0
v_add_f32 v237,v23,v119
v_sub_f32 v119,v23,v119
M v[136:139],v[216:219],a[224:227],v[136:139]
ds_read_b128 a[116:119],v248 offset:10240
v_add_f32 v23,v236,v237
M v[136:139],a[100:103],a[208:211],v[136:139]
s_waitcnt lgkmcnt(2)
ds_read_b128 v[220:223],v249 offset:10240
v_fmac_f32 v236,4.0,v237
M v[136:139],a[104:107],a[252:255],v[136:139]
s_waitcnt lgkmcnt(2)
v_fma_f32 v237,2.0,v119,v238
v_fma_f32 v119,s40,v119,v238
M v[140:143],a[104:107],a[200:203],v[140:143]
v_cvt_pk_bf16_f32 v233,v233,v237
v_cvt_pk_bf16_f32 v235,v235,v236
M v[140:143],a[100:103],a[252:255],v[140:143]
ds_write2st64_b64 v254,v[232:233],v[234:235] offset0:76 offset1:80
M v[140:143],v[216:219],a[208:211],v[140:143]
buffer_load_dwordx4 a[220:223],v250,s[20:23],s46 offen offset:0 sc1
M v[144:147],v[216:219],a[252:255],v[144:147]
ds_read_b128 a[232:235],v249 offset:10752
v_accvgpr_read_b32 v238,a24
M v[144:147],a[100:103],a[200:203],v[144:147]
s_waitcnt lgkmcnt(3)
buffer_load_dwordx4 v[224:227],v250,s[20:23],s46 offen offset:1024 sc1
M v[144:147],a[104:107],a[116:119],v[144:147]
s_waitcnt lgkmcnt(2)
ds_read_b128 a[236:239],v248 offset:10752
v_accvgpr_read_b32 v232,a120
M v[148:151],a[104:107],v[220:223],v[148:151]
v_add_f32 v234,v238,v232
v_sub_f32 v238,v238,v232
M v[148:151],a[100:103],a[116:119],v[148:151]
v_add_f32 v232,v24,v120
v_sub_f32 v120,v24,v120
M v[148:151],v[216:219],a[200:203],v[148:151]
buffer_load_dwordx4 a[204:207],v250,s[20:23],s46 offen offset:2048 sc1
M v[152:155],v[216:219],a[116:119],v[152:155]
s_add_u32 s46,s75,0
v_add_f32 v24,v234,v232
v_fmac_f32 v234,4.0,v232
M v[152:155],a[100:103],v[220:223],v[152:155]
s_waitcnt lgkmcnt(1)
v_fma_f32 v232,2.0,v120,v238
v_fma_f32 v120,s40,v120,v238
M v[152:155],a[104:107],a[232:235],v[152:155]
s_waitcnt lgkmcnt(0)
s_barrier
ds_read_b128 a[16:19],v250 offset:34816
M v[156:159],a[104:107],a[236:239],v[156:159]
ds_read_b128 a[20:23],v250 offset:38912
v_accvgpr_read_b32 v238,a25
M v[156:159],a[100:103],a[232:235],v[156:159]
buffer_load_dwordx4 a[244:247],v250,s[20:23],s46 offen offset:0 sc1
M v[156:159],v[216:219],v[220:223],v[156:159]
s_waitcnt vmcnt(14)
v_accvgpr_read_b32 v237,a121
v_add_f32 v236,v238,v237
M v[160:163],a[192:195],a[240:243],v[160:163]
s_waitcnt vmcnt(13)
v_sub_f32 v238,v238,v237
v_add_f32 v237,v25,v121
M v[160:163],a[248:251],a[212:215],v[160:163]
s_waitcnt vmcnt(12)
buffer_load_dwordx4 a[104:107],v250,s[20:23],s46 offen offset:1024 sc1
M v[160:163],a[96:99],a[224:227],v[160:163]
v_sub_f32 v121,v25,v121
v_add_f32 v25,v236,v237
M v[164:167],a[96:99],a[208:211],v[164:167]
v_fmac_f32 v236,4.0,v237
v_fma_f32 v237,2.0,v121,v238
M v[164:167],a[248:251],a[224:227],v[164:167]
v_fma_f32 v121,s40,v121,v238
v_cvt_pk_bf16_f32 v232,v232,v237
M v[164:167],a[192:195],a[212:215],v[164:167]
buffer_load_dwordx4 a[100:103],v250,s[20:23],s46 offen offset:2048 sc1
M v[168:171],a[192:195],a[224:227],v[168:171]
s_add_u32 s46,s76,0
v_cvt_pk_bf16_f32 v234,v234,v236
v_accvgpr_read_b32 v238,a26
M v[168:171],a[248:251],a[208:211],v[168:171]
v_accvgpr_read_b32 v233,a122
v_add_f32 v235,v238,v233
M v[168:171],a[96:99],a[252:255],v[168:171]
v_sub_f32 v238,v238,v233
v_add_f32 v233,v26,v122
M v[172:175],a[96:99],a[200:203],v[172:175]
buffer_load_dwordx4 v[216:219],v250,s[20:23],s46 offen offset:0 sc1
M v[172:175],a[248:251],a[252:255],v[172:175]
v_sub_f32 v122,v26,v122
v_add_f32 v26,v235,v233
M v[172:175],a[192:195],a[208:211],v[172:175]
v_fmac_f32 v235,4.0,v233
v_fma_f32 v233,2.0,v122,v238
M v[176:179],a[192:195],a[252:255],v[176:179]
v_fma_f32 v122,s40,v122,v238
v_accvgpr_read_b32 v238,a27
M v[176:179],a[248:251],a[200:203],v[176:179]
buffer_load_dwordx4 a[240:243],v250,s[20:23],s46 offen offset:1024 sc1
M v[176:179],a[96:99],a[116:119],v[176:179]
v_add_u32 v248,0xffffbc00,v248
v_add_u32 v249,0xffffbc00,v249
M v[180:183],a[96:99],v[220:223],v[180:183]
v_accvgpr_read_b32 v237,a123
v_add_f32 v236,v238,v237
M v[180:183],a[248:251],a[116:119],v[180:183]
ds_read_b128 a[208:211],v248 offset:0
v_sub_f32 v238,v238,v237
M v[180:183],a[192:195],a[200:203],v[180:183]
buffer_load_dwordx4 a[212:215],v250,s[20:23],s46 offen offset:2048 sc1
M v[184:187],a[192:195],a[116:119],v[184:187]
s_add_u32 s46,s77,0
ds_read_b128 a[120:123],v249 offset:0
ds_read_b128 a[116:119],v248 offset:512
M v[184:187],a[248:251],v[220:223],v[184:187]
ds_read_b128 a[252:255],v249 offset:512
v_add_f32 v237,v27,v123
M v[184:187],a[96:99],a[232:235],v[184:187]
v_sub_f32 v123,v27,v123
v_add_f32 v27,v236,v237
M v[188:191],a[96:99],a[236:239],v[188:191]
buffer_load_dwordx4 a[224:227],v250,s[20:23],s46 offen offset:0 sc1
M v[188:191],a[248:251],a[232:235],v[188:191]
v_fmac_f32 v236,4.0,v237
v_fma_f32 v237,2.0,v123,v238
M v[188:191],a[192:195],v[220:223],v[188:191]
s_waitcnt vmcnt(17) lgkmcnt(3)
v_fma_f32 v123,s40,v123,v238
v_cvt_pk_bf16_f32 v233,v233,v237
M v[0:3],v[228:231],a[208:211],v[0:3]
s_waitcnt vmcnt(16) lgkmcnt(2)
ds_read_b128 a[248:251],v248 offset:1024
v_cvt_pk_bf16_f32 v235,v235,v236
M v[0:3],a[228:231],a[120:123],v[0:3]
s_waitcnt vmcnt(15) lgkmcnt(2)
buffer_load_dwordx4 a[96:99],v250,s[20:23],s46 offen offset:1024 sc1
M v[0:3],a[112:115],a[116:119],v[0:3]
s_waitcnt lgkmcnt(1)
ds_read_b128 a[192:195],v249 offset:1024
ds_write2st64_b64 v254,v[232:233],v[234:235] offset0:85 offset1:89
M v[4:7],a[112:115],a[252:255],v[4:7]
v_accvgpr_read_b32 v204,a28
v_accvgpr_read_b32 v208,a124
M v[4:7],a[228:231],a[116:119],v[4:7]
buffer_load_dwordx4 a[200:203],v250,s[20:23],s46 offen offset:2048 sc1
M v[4:7],v[228:231],a[120:123],v[4:7]
s_add_u32 s46,s72,46080
v_accvgpr_read_b32 v205,a29
v_accvgpr_read_b32 v209,a125
M v[8:11],v[228:231],a[116:119],v[8:11]
ds_read_b128 a[116:119],v248 offset:1536
v_accvgpr_read_b32 v206,a30
M v[8:11],a[228:231],a[252:255],v[8:11]
s_waitcnt lgkmcnt(3)
ds_read_b128 a[120:123],v249 offset:1536
v_accvgpr_read_b32 v210,a126
v_accvgpr_read_b32 v207,a31
v_accvgpr_read_b32 v211,a127
v_pk_add_f32 v[212:213],v[204:205],v[208:209]
v_pk_add_f32 v[214:215],v[206:207],v[210:211]
v_pk_add_f32 v[204:205],v[204:205],v[208:209] neg_lo:[0,1] neg_hi:[0,1]
v_pk_add_f32 v[206:207],v[206:207],v[210:211] neg_lo:[0,1] neg_hi:[0,1]
v_pk_add_f32 v[208:209],v[28:29],v[124:125]
v_pk_add_f32 v[210:211],v[30:31],v[126:127]
v_pk_add_f32 v[124:125],v[28:29],v[124:125] neg_lo:[0,1] neg_hi:[0,1]
v_pk_add_f32 v[126:127],v[30:31],v[126:127] neg_lo:[0,1] neg_hi:[0,1]
v_pk_add_f32 v[28:29],v[212:213],v[208:209]
v_pk_add_f32 v[30:31],v[214:215],v[210:211]
v_pk_fma_f32 v[212:213],v[208:209],4.0,v[212:213] op_sel_hi:[1,0,1]
v_pk_fma_f32 v[214:215],v[210:211],4.0,v[214:215] op_sel_hi:[1,0,1]
v_pk_fma_f32 v[208:209],v[124:125],2.0,v[204:205] op_sel_hi:[1,0,1]
v_pk_fma_f32 v[210:211],v[126:127],2.0,v[206:207] op_sel_hi:[1,0,1]
v_pk_fma_f32 v[124:125],v[124:125],s[40:41],v[204:205] op_sel_hi:[1,0,1]
v_pk_fma_f32 v[126:127],v[126:127],s[40:41],v[206:207] op_sel_hi:[1,0,1]
M v[8:11],a[112:115],a[248:251],v[8:11]
s_waitcnt lgkmcnt(3)
buffer_load_dwordx4 a[236:239],v250,s[20:23],s46 offen offset:0 sc1
M v[12:15],a[112:115],a[192:195],v[12:15]
v_cvt_pk_bf16_f32 v208,v208,v209
v_cvt_pk_bf16_f32 v209,v210,v211
M v[12:15],a[228:231],a[248:251],v[12:15]
buffer_load_dwordx4 a[232:235],v250,s[20:23],s46 offen offset:1024 sc1
M v[12:15],v[228:231],a[252:255],v[12:15]
v_cvt_pk_bf16_f32 v212,v212,v213
v_cvt_pk_bf16_f32 v213,v214,v215
M v[16:19],v[228:231],a[248:251],v[16:19]
ds_read_b128 a[124:127],v249 offset:2048
ds_write2st64_b64 v254,v[208:209],v[212:213] offset0:93 offset1:97
M v[16:19],a[228:231],a[192:195],v[16:19]
s_waitcnt lgkmcnt(3)
ds_read_b128 v[220:223],v248 offset:2048
v_add_u32 v248,0x15400,v248
M v[16:19],a[112:115],a[116:119],v[16:19]
s_waitcnt lgkmcnt(3)
v_add_u32 v249,0x15400,v249
v_accvgpr_read_b32 v238,a32
M v[20:23],a[112:115],a[120:123],v[20:23]
v_accvgpr_read_b32 v232,a128
v_add_f32 v234,v238,v232
M v[20:23],a[228:231],a[116:119],v[20:23]
ds_read_b128 a[208:211],v248 offset:0
v_sub_f32 v238,v238,v232
M v[20:23],v[228:231],a[192:195],v[20:23]
ds_read_b128 a[252:255],v249 offset:0
v_add_f32 v232,v32,v128
M v[24:27],v[228:231],a[116:119],v[24:27]
ds_read_b128 a[116:119],v248 offset:512
v_sub_f32 v128,v32,v128
M v[24:27],a[228:231],a[120:123],v[24:27]
s_waitcnt lgkmcnt(5)
ds_read_b128 a[248:251],v249 offset:512
v_add_f32 v32,v234,v232
M v[24:27],a[112:115],a[124:127],v[24:27]
s_waitcnt lgkmcnt(4)
buffer_load_dwordx4 a[192:195],v250,s[20:23],s46 offen offset:2048 sc1
M v[28:31],a[112:115],v[220:223],v[28:31]
s_add_u32 s47,s72,49152
v_fmac_f32 v234,4.0,v232
v_fma_f32 v232,2.0,v128,v238
M v[28:31],a[228:231],a[124:127],v[28:31]
buffer_load_dwordx4 a[112:115],v250,s[20:23],s47 offen offset:0 sc1
M v[28:31],v[228:231],a[120:123],v[28:31]
s_waitcnt vmcnt(20) lgkmcnt(3)
v_fma_f32 v128,s40,v128,v238
M v[0:3],a[216:219],a[208:211],v[0:3]
s_waitcnt vmcnt(19) lgkmcnt(2)
s_barrier
ds_read_b128 a[24:27],v250 offset:43520
M v[0:3],a[196:199],a[252:255],v[0:3]
s_waitcnt vmcnt(18) lgkmcnt(2)
ds_read_b128 a[28:31],v250 offset:47616
ds_read_b128 a[120:123],v248 offset:1024
M v[0:3],a[108:111],a[116:119],v[0:3]
s_waitcnt lgkmcnt(3)
buffer_load_dwordx4 v[220:223],v250,s[20:23],s47 offen offset:1024 sc1
M v[4:7],a[108:111],a[248:251],v[4:7]
ds_read_b128 a[228:231],v249 offset:1024
v_accvgpr_read_b32 v238,a33
M v[4:7],a[196:199],a[116:119],v[4:7]
v_accvgpr_read_b32 v237,a129
v_add_f32 v236,v238,v237
M v[4:7],a[216:219],a[252:255],v[4:7]
v_sub_f32 v238,v238,v237
v_add_f32 v237,v33,v129
M v[8:11],a[216:219],a[116:119],v[8:11]
buffer_load_dwordx4 a[124:127],v250,s[20:23],s47 offen offset:2048 sc1
M v[8:11],a[196:199],a[248:251],v[8:11]
s_waitcnt lgkmcnt(1)
ds_read_b128 a[116:119],v248 offset:1536
ds_read_b128 v[228:231],v249 offset:1536
M v[8:11],a[108:111],a[120:123],v[8:11]
s_waitcnt lgkmcnt(2)
s_add_u32 s34,s32,0
v_sub_f32 v129,v33,v129
v_add_f32 v33,v236,v237
M v[12:15],a[108:111],a[228:231],v[12:15]
v_fmac_f32 v236,4.0,v237
v_fma_f32 v237,2.0,v129,v238
M v[12:15],a[196:199],a[120:123],v[12:15]
v_fma_f32 v129,s40,v129,v238
v_cvt_pk_bf16_f32 v232,v232,v237
M v[12:15],a[216:219],a[248:251],v[12:15]
buffer_store_dwordx4 a[0:3],v253,s[24:27],s34 offen offset:384 nt
M v[16:19],a[216:219],a[120:123],v[16:19]
ds_read_b128 a[120:123],v249 offset:2048
v_cvt_pk_bf16_f32 v234,v234,v236
M v[16:19],a[196:199],a[228:231],v[16:19]
s_waitcnt lgkmcnt(2)
ds_read_b128 a[208:211],v248 offset:2048
v_accvgpr_read_b32 v238,a34
M v[16:19],a[108:111],a[116:119],v[16:19]
s_waitcnt lgkmcnt(2)
v_accvgpr_read_b32 v233,a130
v_add_f32 v235,v238,v233
M v[20:23],a[108:111],v[228:231],v[20:23]
s_add_u32 s46,s73,46080
v_sub_f32 v238,v238,v233
v_add_f32 v233,v34,v130
M v[20:23],a[196:199],a[116:119],v[20:23]
ds_read_b128 a[252:255],v248 offset:17408
v_sub_f32 v130,v34,v130
M v[20:23],a[216:219],a[228:231],v[20:23]
ds_read_b128 a[248:251],v249 offset:17408
v_add_f32 v34,v235,v233
M v[24:27],a[216:219],a[116:119],v[24:27]
ds_read_b128 a[116:119],v248 offset:17920
v_fmac_f32 v235,4.0,v233
M v[24:27],a[196:199],v[228:231],v[24:27]
s_waitcnt lgkmcnt(4)
ds_read_b128 a[228:231],v249 offset:17920
v_fma_f32 v233,2.0,v130,v238
M v[24:27],a[108:111],a[120:123],v[24:27]
s_waitcnt lgkmcnt(4)
v_fma_f32 v130,s40,v130,v238
v_accvgpr_read_b32 v238,a35
M v[28:31],a[108:111],a[208:211],v[28:31]
buffer_load_dwordx4 a[108:111],v250,s[20:23],s46 offen offset:0 sc1
M v[28:31],a[196:199],a[120:123],v[28:31]
v_accvgpr_read_b32 v237,a131
v_add_f32 v236,v238,v237
M v[28:31],a[216:219],v[228:231],v[28:31]
s_waitcnt vmcnt(19) lgkmcnt(3)
buffer_load_dwordx4 a[208:211],v250,s[20:23],s46 offen offset:1024 sc1
M v[0:3],a[220:223],a[252:255],v[0:3]
s_waitcnt vmcnt(19) lgkmcnt(2)
ds_read_b128 a[128:131],v248 offset:18432
v_sub_f32 v238,v238,v237
M v[0:3],v[224:227],a[248:251],v[0:3]
s_waitcnt vmcnt(18) lgkmcnt(2)
ds_read_b128 a[196:199],v249 offset:18432
v_add_f32 v237,v35,v131
M v[0:3],a[204:207],a[116:119],v[0:3]
s_waitcnt lgkmcnt(2)
s_add_u32 s34,s32,196608
v_sub_f32 v131,v35,v131
v_add_f32 v35,v236,v237
M v[4:7],a[204:207],a[228:231],v[4:7]
buffer_load_dwordx4 a[120:123],v250,s[20:23],s46 offen offset:2048 sc1
M v[4:7],v[224:227],a[116:119],v[4:7]
v_fmac_f32 v236,4.0,v237
v_fma_f32 v237,2.0,v131,v238
M v[4:7],a[220:223],a[248:251],v[4:7]
v_fma_f32 v131,s40,v131,v238
v_cvt_pk_bf16_f32 v233,v233,v237
M v[8:11],a[220:223],a[116:119],v[8:11]
ds_read_b128 a[116:119],v248 offset:18944
v_cvt_pk_bf16_f32 v235,v235,v236
M v[8:11],v[224:227],a[228:231],v[8:11]
s_waitcnt lgkmcnt(2)
ds_read_b128 a[216:219],v249 offset:18944
ds_write2st64_b64 v254,v[232:233],v[234:235] offset0:34 offset1:38
M v[8:11],a[204:207],a[128:131],v[8:11]
s_waitcnt lgkmcnt(3)
buffer_store_dwordx4 a[4:7],v253,s[24:27],s34 offen offset:384 nt
M v[12:15],a[204:207],a[196:199],v[12:15]
v_accvgpr_read_b32 v204,a36
v_accvgpr_read_b32 v208,a132
M v[12:15],v[224:227],a[128:131],v[12:15]
v_accvgpr_read_b32 v205,a37
v_accvgpr_read_b32 v209,a133
M v[12:15],a[220:223],a[228:231],v[12:15]
v_accvgpr_read_b32 v206,a38
v_accvgpr_read_b32 v210,a134
v_accvgpr_read_b32 v207,a39
v_accvgpr_read_b32 v211,a135
v_pk_add_f32 v[212:213],v[204:205],v[208:209]
v_pk_add_f32 v[214:215],v[206:207],v[210:211]
v_pk_add_f32 v[204:205],v[204:205],v[208:209] neg_lo:[0,1] neg_hi:[0,1]
v_pk_add_f32 v[206:207],v[206:207],v[210:211] neg_lo:[0,1] neg_hi:[0,1]
v_pk_add_f32 v[208:209],v[36:37],v[132:133]
v_pk_add_f32 v[210:211],v[38:39],v[134:135]
v_pk_add_f32 v[132:133],v[36:37],v[132:133] neg_lo:[0,1] neg_hi:[0,1]
v_pk_add_f32 v[134:135],v[38:39],v[134:135] neg_lo:[0,1] neg_hi:[0,1]
v_pk_add_f32 v[36:37],v[212:213],v[208:209]
v_pk_add_f32 v[38:39],v[214:215],v[210:211]
v_pk_fma_f32 v[212:213],v[208:209],4.0,v[212:213] op_sel_hi:[1,0,1]
v_pk_fma_f32 v[214:215],v[210:211],4.0,v[214:215] op_sel_hi:[1,0,1]
v_pk_fma_f32 v[208:209],v[132:133],2.0,v[204:205] op_sel_hi:[1,0,1]
v_pk_fma_f32 v[210:211],v[134:135],2.0,v[206:207] op_sel_hi:[1,0,1]
v_pk_fma_f32 v[132:133],v[132:133],s[40:41],v[204:205] op_sel_hi:[1,0,1]
v_pk_fma_f32 v[134:135],v[134:135],s[40:41],v[206:207] op_sel_hi:[1,0,1]
M v[16:19],a[220:223],a[128:131],v[16:19]
s_add_u32 s47,s73,49152
ds_read_b128 a[128:131],v249 offset:19456
v_cvt_pk_bf16_f32 v208,v208,v209
M v[16:19],v[224:227],a[196:199],v[16:19]
s_waitcnt lgkmcnt(3)
ds_read_b128 v[228:231],v248 offset:19456
v_cvt_pk_bf16_f32 v209,v210,v211
M v[16:19],a[204:207],a[116:119],v[16:19]
s_waitcnt lgkmcnt(3)
v_cvt_pk_bf16_f32 v212,v212,v213
v_cvt_pk_bf16_f32 v213,v214,v215
M v[20:23],a[204:207],a[216:219],v[20:23]
ds_write2st64_b64 v254,v[208:209],v[212:213] offset0:42 offset1:46
M v[20:23],v[224:227],a[116:119],v[20:23]
ds_read_b128 a[132:135],v248 offset:34816
v_accvgpr_read_b32 v204,a40
M v[20:23],a[220:223],a[196:199],v[20:23]
ds_read_b128 a[252:255],v249 offset:34816
v_accvgpr_read_b32 v208,a136
M v[24:27],a[220:223],a[116:119],v[24:27]
buffer_load_dwordx4 a[116:119],v250,s[20:23],s47 offen offset:0 sc1
M v[24:27],v[224:227],a[216:219],v[24:27]
s_waitcnt lgkmcnt(4)
ds_read_b128 a[248:251],v248 offset:35328
ds_read_b128 a[228:231],v249 offset:35328
M v[24:27],a[204:207],a[128:131],v[24:27]
s_waitcnt lgkmcnt(5)
s_add_u32 s34,s32,393216
buffer_store_dwordx4 a[8:11],v253,s[24:27],s34 offen offset:384 nt
M v[28:31],a[204:207],v[228:231],v[28:31]
v_accvgpr_read_b32 v205,a41
v_accvgpr_read_b32 v209,a137
M v[28:31],v[224:227],a[128:131],v[28:31]
v_accvgpr_read_b32 v206,a42
v_accvgpr_read_b32 v210,a138
v_accvgpr_read_b32 v207,a43
v_accvgpr_read_b32 v211,a139
v_pk_add_f32 v[212:213],v[204:205],v[208:209]
v_pk_add_f32 v[214:215],v[206:207],v[210:211]
v_pk_add_f32 v[204:205],v[204:205],v[208:209] neg_lo:[0,1] neg_hi:[0,1]
v_pk_add_f32 v[206:207],v[206:207],v[210:211] neg_lo:[0,1] neg_hi:[0,1]
v_pk_add_f32 v[208:209],v[40:41],v[136:137]
v_pk_add_f32 v[210:211],v[42:43],v[138:139]
v_pk_add_f32 v[136:137],v[40:41],v[136:137] neg_lo:[0,1] neg_hi:[0,1]
v_pk_add_f32 v[138:139],v[42:43],v[138:139] neg_lo:[0,1] neg_hi:[0,1]
v_pk_add_f32 v[40:41],v[212:213],v[208:209]
v_pk_add_f32 v[42:43],v[214:215],v[210:211]
v_pk_fma_f32 v[212:213],v[208:209],4.0,v[212:213] op_sel_hi:[1,0,1]
v_pk_fma_f32 v[214:215],v[210:211],4.0,v[214:215] op_sel_hi:[1,0,1]
v_pk_fma_f32 v[208:209],v[136:137],2.0,v[204:205] op_sel_hi:[1,0,1]
v_pk_fma_f32 v[210:211],v[138:139],2.0,v[206:207] op_sel_hi:[1,0,1]
v_pk_fma_f32 v[136:137],v[136:137],s[40:41],v[204:205] op_sel_hi:[1,0,1]
v_pk_fma_f32 v[138:139],v[138:139],s[40:41],v[206:207] op_sel_hi:[1,0,1]
M v[28:31],a[220:223],a[216:219],v[28:31]
s_waitcnt vmcnt(21) lgkmcnt(3)
buffer_load_dwordx4 a[196:199],v250,s[20:23],s47 offen offset:1024 sc1
M v[0:3],a[244:247],a[132:135],v[0:3]
s_waitcnt vmcnt(21) lgkmcnt(2)
ds_read_b128 a[128:131],v248 offset:35840
v_cvt_pk_bf16_f32 v208,v208,v209
M v[0:3],a[104:107],a[252:255],v[0:3]
s_waitcnt vmcnt(20) lgkmcnt(2)
buffer_load_dwordx4 a[204:207],v250,s[20:23],s47 offen offset:2048 sc1
M v[0:3],a[100:103],a[248:251],v[0:3]
s_waitcnt lgkmcnt(1)
ds_read_b128 a[132:135],v249 offset:35840
v_cvt_pk_bf16_f32 v209,v210,v211
M v[4:7],a[100:103],a[228:231],v[4:7]
v_cvt_pk_bf16_f32 v212,v212,v213
v_cvt_pk_bf16_f32 v213,v214,v215
M v[4:7],a[104:107],a[248:251],v[4:7]
ds_write2st64_b64 v254,v[208:209],v[212:213] offset0:51 offset1:55
M v[4:7],a[244:247],a[252:255],v[4:7]
v_accvgpr_read_b32 v204,a44
v_accvgpr_read_b32 v208,a140
M v[8:11],a[244:247],a[248:251],v[8:11]
ds_read_b128 a[136:139],v248 offset:36352
v_accvgpr_read_b32 v205,a45
M v[8:11],a[104:107],a[228:231],v[8:11]
s_waitcnt lgkmcnt(3)
ds_read_b128 v[228:231],v249 offset:36352
v_accvgpr_read_b32 v209,a141
M v[8:11],a[100:103],a[128:131],v[8:11]
s_waitcnt lgkmcnt(3)
v_accvgpr_read_b32 v206,a46
v_accvgpr_read_b32 v210,a142
v_accvgpr_read_b32 v207,a47
v_accvgpr_read_b32 v211,a143
v_pk_add_f32 v[212:213],v[204:205],v[208:209]
v_pk_add_f32 v[214:215],v[206:207],v[210:211]
v_pk_add_f32 v[204:205],v[204:205],v[208:209] neg_lo:[0,1] neg_hi:[0,1]
v_pk_add_f32 v[206:207],v[206:207],v[210:211] neg_lo:[0,1] neg_hi:[0,1]
v_pk_add_f32 v[208:209],v[44:45],v[140:141]
v_pk_add_f32 v[210:211],v[46:47],v[142:143]
v_pk_add_f32 v[140:141],v[44:45],v[140:141] neg_lo:[0,1] neg_hi:[0,1]
v_pk_add_f32 v[142:143],v[46:47],v[142:143] neg_lo:[0,1] neg_hi:[0,1]
v_pk_add_f32 v[44:45],v[212:213],v[208:209]
v_pk_add_f32 v[46:47],v[214:215],v[210:211]
v_pk_fma_f32 v[212:213],v[208:209],4.0,v[212:213] op_sel_hi:[1,0,1]
v_pk_fma_f32 v[214:215],v[210:211],4.0,v[214:215] op_sel_hi:[1,0,1]
v_pk_fma_f32 v[208:209],v[140:141],2.0,v[204:205] op_sel_hi:[1,0,1]
v_pk_fma_f32 v[210:211],v[142:143],2.0,v[206:207] op_sel_hi:[1,0,1]
v_pk_fma_f32 v[140:141],v[140:141],s[40:41],v[204:205] op_sel_hi:[1,0,1]
v_pk_fma_f32 v[142:143],v[142:143],s[40:41],v[206:207] op_sel_hi:[1,0,1]
M v[12:15],a[100:103],a[132:135],v[12:15]
v_cvt_pk_bf16_f32 v208,v208,v209
v_cvt_pk_bf16_f32 v209,v210,v211
M v[12:15],a[104:107],a[128:131],v[12:15]
v_cvt_pk_bf16_f32 v212,v212,v213
v_cvt_pk_bf16_f32 v213,v214,v215
M v[12:15],a[244:247],a[228:231],v[12:15]
ds_write2st64_b64 v254,v[208:209],v[212:213] offset0:59 offset1:63
M v[16:19],a[244:247],a[128:131],v[16:19]
s_add_u32 s46,s74,46080
ds_read_b128 a[128:131],v249 offset:36864
v_accvgpr_read_b32 v238,a48
M v[16:19],a[104:107],a[132:135],v[16:19]
s_waitcnt lgkmcnt(3)
ds_read_b128 v[224:227],v248 offset:36864
v_accvgpr_read_b32 v232,a144
M v[16:19],a[100:103],a[136:139],v[16:19]
s_waitcnt lgkmcnt(3)
s_add_u32 s34,s32,589824
buffer_store_dwordx4 a[12:15],v253,s[24:27],s34 offen offset:384 nt
M v[20:23],a[100:103],v[228:231],v[20:23]
v_add_f32 v234,v238,v232
v_sub_f32 v238,v238,v232
M v[20:23],a[104:107],a[136:139],v[20:23]
ds_read_b128 a[140:143],v248 offset:52224
v_add_f32 v232,v48,v144
M v[20:23],a[244:247],a[132:135],v[20:23]
ds_read_b128 a[132:135],v249 offset:52224
v_sub_f32 v144,v48,v144
M v[24:27],a[244:247],a[136:139],v[24:27]
buffer_load_dwordx4 a[136:139],v250,s[20:23],s46 offen offset:0 sc1
M v[24:27],a[104:107],v[228:231],v[24:27]
s_waitcnt lgkmcnt(3)
ds_read_b128 a[216:219],v248 offset:52736
ds_read_b128 a[252:255],v249 offset:52736
M v[24:27],a[100:103],a[128:131],v[24:27]
s_waitcnt lgkmcnt(4)
buffer_load_dwordx4 a[220:223],v250,s[20:23],s46 offen offset:1024 sc1
M v[28:31],a[100:103],v[224:227],v[28:31]
v_add_f32 v48,v234,v232
v_fmac_f32 v234,4.0,v232
M v[28:31],a[104:107],a[128:131],v[28:31]
v_fma_f32 v232,2.0,v144,v238
v_fma_f32 v144,s40,v144,v238
M v[28:31],a[244:247],v[228:231],v[28:31]
s_waitcnt vmcnt(23) lgkmcnt(3)
v_accvgpr_read_b32 v238,a49
v_accvgpr_read_b32 v237,a145
M v[0:3],v[216:219],a[140:143],v[0:3]
s_waitcnt vmcnt(22) lgkmcnt(2)
buffer_load_dwordx4 a[248:251],v250,s[20:23],s46 offen offset:2048 sc1
M v[0:3],a[240:243],a[132:135],v[0:3]
s_waitcnt vmcnt(22) lgkmcnt(1)
ds_read_b128 a[100:103],v248 offset:53248
ds_read_b128 a[104:107],v249 offset:53248
M v[0:3],a[212:215],a[216:219],v[0:3]
s_waitcnt lgkmcnt(2)
v_add_f32 v236,v238,v237
v_sub_f32 v238,v238,v237
M v[4:7],a[212:215],a[252:255],v[4:7]
v_add_f32 v237,v49,v145
v_sub_f32 v145,v49,v145
M v[4:7],a[240:243],a[216:219],v[4:7]
v_add_f32 v49,v236,v237
v_fmac_f32 v236,4.0,v237
M v[4:7],v[216:219],a[132:135],v[4:7]
v_fma_f32 v237,2.0,v145,v238
v_fma_f32 v145,s40,v145,v238
M v[8:11],v[216:219],a[216:219],v[8:11]
ds_read_b128 a[128:131],v248 offset:53760
v_cvt_pk_bf16_f32 v232,v232,v237
M v[8:11],a[240:243],a[252:255],v[8:11]
s_waitcnt lgkmcnt(2)
ds_read_b128 a[132:135],v249 offset:53760
v_cvt_pk_bf16_f32 v234,v234,v236
M v[8:11],a[212:215],a[100:103],v[8:11]
s_waitcnt lgkmcnt(2)
s_add_u32 s34,s32,786432
buffer_store_dwordx4 a[16:19],v253,s[24:27],s34 offen offset:384 nt
M v[12:15],a[212:215],a[104:107],v[12:15]
v_accvgpr_read_b32 v238,a50
v_accvgpr_read_b32 v233,a146
M v[12:15],a[240:243],a[100:103],v[12:15]
v_add_f32 v235,v238,v233
v_sub_f32 v238,v238,v233
M v[12:15],v[216:219],a[252:255],v[12:15]
v_add_f32 v233,v50,v146
v_sub_f32 v146,v50,v146
M v[16:19],v[216:219],a[100:103],v[16:19]
s_add_u32 s47,s74,49152
ds_read_b128 a[100:103],v249 offset:54272
v_add_f32 v50,v235,v233
M v[16:19],a[240:243],a[104:107],v[16:19]
s_waitcnt lgkmcnt(2)
ds_read_b128 a[140:143],v248 offset:54272
v_add_u32 v248,0xfffece00,v248
M v[16:19],a[212:215],a[128:131],v[16:19]
s_waitcnt lgkmcnt(2)
v_add_u32 v249,0xfffece00,v249
v_fmac_f32 v235,4.0,v233
M v[20:23],a[212:215],a[132:135],v[20:23]
v_fma_f32 v233,2.0,v146,v238
v_fma_f32 v146,s40,v146,v238
M v[20:23],a[240:243],a[128:131],v[20:23]
ds_read_b128 a[228:231],v248 offset:60928
v_accvgpr_read_b32 v238,a51
M v[20:23],v[216:219],a[104:107],v[20:23]
ds_read_b128 a[104:107],v249 offset:60928
v_accvgpr_read_b32 v237,a147
M v[24:27],v[216:219],a[128:131],v[24:27]
buffer_load_dwordx4 a[128:131],v250,s[20:23],s47 offen offset:0 sc1
M v[24:27],a[240:243],a[132:135],v[24:27]
s_waitcnt lgkmcnt(3)
ds_read_b128 v[224:227],v248 offset:61440
ds_read_b128 v[228:231],v249 offset:61440
M v[24:27],a[212:215],a[100:103],v[24:27]
s_waitcnt lgkmcnt(4)
buffer_load_dwordx4 a[244:247],v250,s[20:23],s47 offen offset:1024 sc1
M v[28:31],a[212:215],a[140:143],v[28:31]
v_add_f32 v236,v238,v237
v_sub_f32 v238,v238,v237
M v[28:31],a[240:243],a[100:103],v[28:31]
v_add_f32 v237,v51,v147
v_sub_f32 v147,v51,v147
M v[28:31],v[216:219],a[132:135],v[28:31]
s_waitcnt vmcnt(24) lgkmcnt(3)
v_add_f32 v51,v236,v237
v_fmac_f32 v236,4.0,v237
M v[0:3],a[224:227],a[228:231],v[0:3]
s_waitcnt vmcnt(23) lgkmcnt(2)
buffer_load_dwordx4 a[216:219],v250,s[20:23],s47 offen offset:2048 sc1
M v[0:3],a[96:99],a[104:107],v[0:3]
s_waitcnt vmcnt(23) lgkmcnt(1)
ds_read_b128 a[100:103],v248 offset:61952
ds_read_b128 a[132:135],v249 offset:61952
M v[0:3],a[200:203],v[224:227],v[0:3]
s_waitcnt lgkmcnt(2)
s_add_u32 s34,s32,983040
v_fma_f32 v237,2.0,v147,v238
v_fma_f32 v147,s40,v147,v238
M v[4:7],a[200:203],v[228:231],v[4:7]
v_cvt_pk_bf16_f32 v233,v233,v237
v_cvt_pk_bf16_f32 v235,v235,v236
M v[4:7],a[96:99],v[224:227],v[4:7]
ds_write2st64_b64 v254,v[232:233],v[234:235] offset0:102 offset1:106
M v[4:7],a[224:227],a[104:107],v[4:7]
buffer_store_dwordx4 a[20:23],v253,s[24:27],s34 offen offset:384 nt
M v[8:11],a[224:227],v[224:227],v[8:11]
ds_read_b128 a[104:107],v248 offset:62464
v_accvgpr_read_b32 v204,a52
M v[8:11],a[96:99],v[228:231],v[8:11]
s_waitcnt lgkmcnt(3)
ds_read_b128 a[140:143],v249 offset:62464
v_accvgpr_read_b32 v208,a148
M v[8:11],a[200:203],a[100:103],v[8:11]
s_waitcnt lgkmcnt(3)
v_accvgpr_read_b32 v205,a53
v_accvgpr_read_b32 v209,a149
M v[12:15],a[200:203],a[132:135],v[12:15]
v_accvgpr_read_b32 v206,a54
v_accvgpr_read_b32 v210,a150
v_accvgpr_read_b32 v207,a55
v_accvgpr_read_b32 v211,a151
v_pk_add_f32 v[212:213],v[204:205],v[208:209]
v_pk_add_f32 v[214:215],v[206:207],v[210:211]
v_pk_add_f32 v[204:205],v[204:205],v[208:209] neg_lo:[0,1] neg_hi:[0,1]
v_pk_add_f32 v[206:207],v[206:207],v[210:211] neg_lo:[0,1] neg_hi:[0,1]
v_pk_add_f32 v[208:209],v[52:53],v[148:149]
v_pk_add_f32 v[210:211],v[54:55],v[150:151]
v_pk_add_f32 v[148:149],v[52:53],v[148:149] neg_lo:[0,1] neg_hi:[0,1]
v_pk_add_f32 v[150:151],v[54:55],v[150:151] neg_lo:[0,1] neg_hi:[0,1]
v_pk_add_f32 v[52:53],v[212:213],v[208:209]
v_pk_add_f32 v[54:55],v[214:215],v[210:211]
v_pk_fma_f32 v[212:213],v[208:209],4.0,v[212:213] op_sel_hi:[1,0,1]
v_pk_fma_f32 v[214:215],v[210:211],4.0,v[214:215] op_sel_hi:[1,0,1]
v_pk_fma_f32 v[208:209],v[148:149],2.0,v[204:205] op_sel_hi:[1,0,1]
v_pk_fma_f32 v[210:211],v[150:151],2.0,v[206:207] op_sel_hi:[1,0,1]
v_pk_fma_f32 v[148:149],v[148:149],s[40:41],v[204:205] op_sel_hi:[1,0,1]
v_pk_fma_f32 v[150:151],v[150:151],s[40:41],v[206:207] op_sel_hi:[1,0,1]
M v[12:15],a[96:99],a[100:103],v[12:15]
v_cvt_pk_bf16_f32 v208,v208,v209
v_cvt_pk_bf16_f32 v209,v210,v211
M v[12:15],a[224:227],v[228:231],v[12:15]
v_cvt_pk_bf16_f32 v212,v212,v213
v_cvt_pk_bf16_f32 v213,v214,v215
M v[16:19],a[224:227],a[100:103],v[16:19]
s_add_u32 s46,s75,46080
ds_read_b128 a[100:103],v249 offset:62976
ds_write2st64_b64 v254,v[208:209],v[212:213] offset0:110 offset1:114
M v[16:19],a[96:99],a[132:135],v[16:19]
s_waitcnt lgkmcnt(3)
ds_read_b128 a[144:147],v248 offset:62976
v_accvgpr_read_b32 v204,a56
M v[16:19],a[200:203],a[104:107],v[16:19]
s_waitcnt lgkmcnt(3)
v_accvgpr_read_b32 v208,a152
v_accvgpr_read_b32 v205,a57
M v[20:23],a[200:203],a[140:143],v[20:23]
v_accvgpr_read_b32 v209,a153
v_accvgpr_read_b32 v206,a58
M v[20:23],a[96:99],a[104:107],v[20:23]
ds_read_b128 a[148:151],v248 offset:0
v_accvgpr_read_b32 v210,a154
v_accvgpr_read_b32 v207,a59
v_accvgpr_read_b32 v211,a155
v_pk_add_f32 v[212:213],v[204:205],v[208:209]
v_pk_add_f32 v[214:215],v[206:207],v[210:211]
v_pk_add_f32 v[204:205],v[204:205],v[208:209] neg_lo:[0,1] neg_hi:[0,1]
v_pk_add_f32 v[206:207],v[206:207],v[210:211] neg_lo:[0,1] neg_hi:[0,1]
v_pk_add_f32 v[208:209],v[56:57],v[152:153]
v_pk_add_f32 v[210:211],v[58:59],v[154:155]
v_pk_add_f32 v[152:153],v[56:57],v[152:153] neg_lo:[0,1] neg_hi:[0,1]
v_pk_add_f32 v[154:155],v[58:59],v[154:155] neg_lo:[0,1] neg_hi:[0,1]
v_pk_add_f32 v[56:57],v[212:213],v[208:209]
v_pk_add_f32 v[58:59],v[214:215],v[210:211]
v_pk_fma_f32 v[212:213],v[208:209],4.0,v[212:213] op_sel_hi:[1,0,1]
v_pk_fma_f32 v[214:215],v[210:211],4.0,v[214:215] op_sel_hi:[1,0,1]
v_pk_fma_f32 v[208:209],v[152:153],2.0,v[204:205] op_sel_hi:[1,0,1]
v_pk_fma_f32 v[210:211],v[154:155],2.0,v[206:207] op_sel_hi:[1,0,1]
v_pk_fma_f32 v[152:153],v[152:153],s[40:41],v[204:205] op_sel_hi:[1,0,1]
v_pk_fma_f32 v[154:155],v[154:155],s[40:41],v[206:207] op_sel_hi:[1,0,1]
M v[20:23],a[224:227],a[132:135],v[20:23]
ds_read_b128 a[132:135],v249 offset:0
v_cvt_pk_bf16_f32 v208,v208,v209
M v[24:27],a[224:227],a[104:107],v[24:27]
buffer_load_dwordx4 a[104:107],v250,s[20:23],s46 offen offset:0 sc1
M v[24:27],a[96:99],a[140:143],v[24:27]
s_waitcnt lgkmcnt(4)
ds_read_b128 a[252:255],v248 offset:512
ds_read_b128 a[240:243],v249 offset:512
M v[24:27],a[200:203],a[100:103],v[24:27]
s_waitcnt lgkmcnt(4)
s_add_u32 s34,s32,1179648
buffer_load_dwordx4 a[212:215],v250,s[20:23],s46 offen offset:1024 sc1
M v[28:31],a[200:203],a[144:147],v[28:31]
v_cvt_pk_bf16_f32 v209,v210,v211
v_cvt_pk_bf16_f32 v212,v212,v213
M v[28:31],a[96:99],a[100:103],v[28:31]
v_cvt_pk_bf16_f32 v213,v214,v215
M v[28:31],a[224:227],a[140:143],v[28:31]
s_waitcnt vmcnt(25) lgkmcnt(3)
ds_write2st64_b64 v254,v[208:209],v[212:213] offset0:119 offset1:123
M v[96:99],a[236:239],a[148:151],v[96:99]
s_waitcnt vmcnt(24) lgkmcnt(3)
buffer_load_dwordx4 v[216:219],v250,s[20:23],s46 offen offset:2048 sc1
M v[96:99],a[232:235],a[132:135],v[96:99]
s_waitcnt vmcnt(24) lgkmcnt(2)
ds_read_b128 a[96:99],v248 offset:1024
ds_read_b128 a[100:103],v249 offset:1024
M v[96:99],a[192:195],a[252:255],v[96:99]
s_waitcnt lgkmcnt(3)
v_accvgpr_read_b32 v204,a60
v_accvgpr_read_b32 v208,a156
M v[100:103],a[192:195],a[240:243],v[100:103]
v_accvgpr_read_b32 v205,a61
v_accvgpr_read_b32 v209,a157
M v[100:103],a[232:235],a[252:255],v[100:103]
v_accvgpr_read_b32 v206,a62
v_accvgpr_read_b32 v210,a158
v_accvgpr_read_b32 v207,a63
v_accvgpr_read_b32 v211,a159
v_pk_add_f32 v[212:213],v[204:205],v[208:209]
v_pk_add_f32 v[214:215],v[206:207],v[210:211]
v_pk_add_f32 v[204:205],v[204:205],v[208:209] neg_lo:[0,1] neg_hi:[0,1]
v_pk_add_f32 v[206:207],v[206:207],v[210:211] neg_lo:[0,1] neg_hi:[0,1]
v_pk_add_f32 v[208:209],v[60:61],v[156:157]
v_pk_add_f32 v[210:211],v[62:63],v[158:159]
v_pk_add_f32 v[156:157],v[60:61],v[156:157] neg_lo:[0,1] neg_hi:[0,1]
v_pk_add_f32 v[158:159],v[62:63],v[158:159] neg_lo:[0,1] neg_hi:[0,1]
v_pk_add_f32 v[60:61],v[212:213],v[208:209]
v_pk_add_f32 v[62:63],v[214:215],v[210:211]
v_pk_fma_f32 v[212:213],v[208:209],4.0,v[212:213] op_sel_hi:[1,0,1]
v_pk_fma_f32 v[214:215],v[210:211],4.0,v[214:215] op_sel_hi:[1,0,1]
v_pk_fma_f32 v[208:209],v[156:157],2.0,v[204:205] op_sel_hi:[1,0,1]
v_pk_fma_f32 v[210:211],v[158:159],2.0,v[206:207] op_sel_hi:[1,0,1]
v_pk_fma_f32 v[156:157],v[156:157],s[40:41],v[204:205] op_sel_hi:[1,0,1]
v_pk_fma_f32 v[158:159],v[158:159],s[40:41],v[206:207] op_sel_hi:[1,0,1]
M v[100:103],a[236:239],a[132:135],v[100:103]
buffer_store_dwordx4 a[24:27],v253,s[24:27],s34 offen offset:384 nt
M v[104:107],a[236:239],a[252:255],v[104:107]
ds_read_b128 a[140:143],v248 offset:1536
v_cvt_pk_bf16_f32 v208,v208,v209
M v[104:107],a[232:235],a[240:243],v[104:107]
s_waitcnt lgkmcnt(2)
ds_read_b128 a[144:147],v249 offset:1536
v_cvt_pk_bf16_f32 v209,v210,v211
M v[104:107],a[192:195],a[96:99],v[104:107]
s_waitcnt lgkmcnt(2)
v_cvt_pk_bf16_f32 v212,v212,v213
v_cvt_pk_bf16_f32 v213,v214,v215
M v[108:111],a[192:195],a[100:103],v[108:111]
ds_write2st64_b64 v254,v[208:209],v[212:213] offset0:127 offset1:131
M v[108:111],a[232:235],a[96:99],v[108:111]
s_add_u32 s28,s66,6684672
buffer_load_dwordx4 v[204:207],v251,s[88:91],s28 offen offset:0
M v[108:111],a[236:239],a[240:243],v[108:111]
v_cvt_pk_bf16_f32 v0,v0,v1
v_cvt_pk_bf16_f32 v1,v2,v3
M v[112:115],a[236:239],a[96:99],v[112:115]
s_add_u32 s47,s75,49152
buffer_load_dwordx4 v[208:211],v245,s[8:11],s28 offen offset:0
M v[112:115],a[232:235],a[100:103],v[112:115]
s_waitcnt lgkmcnt(2)
ds_read_b128 a[152:155],v249 offset:2048
ds_read_b128 a[156:159],v248 offset:2048
M v[112:115],a[192:195],a[140:143],v[112:115]
s_waitcnt lgkmcnt(3)
s_add_u32 s34,s32,1376256
v_cvt_pk_bf16_f32 v4,v4,v5
v_cvt_pk_bf16_f32 v5,v6,v7
M v[116:119],a[192:195],a[144:147],v[116:119]
s_waitcnt lgkmcnt(2)
s_barrier
ds_read_b128 a[32:35],v250 offset:17408
M v[116:119],a[232:235],a[140:143],v[116:119]
buffer_load_dwordx4 v[212:215],v245,s[8:11],s28 offen offset:768
M v[116:119],a[236:239],a[100:103],v[116:119]
ds_read_b128 a[36:39],v250 offset:21504
ds_read_b128 a[40:43],v250 offset:26112
M v[120:123],a[236:239],a[140:143],v[120:123]
ds_read_b128 a[44:47],v250 offset:30208
ds_read_b128 a[48:51],v250 offset:52224
M v[120:123],a[232:235],a[144:147],v[120:123]
s_waitcnt lgkmcnt(6)
ds_read_b128 a[52:55],v250 offset:56320
ds_read_b128 a[56:59],v250 offset:60928
M v[120:123],a[192:195],a[152:155],v[120:123]
s_waitcnt lgkmcnt(7)
ds_read_b128 a[60:63],v250 offset:65024
buffer_store_dwordx4 a[28:31],v253,s[24:27],s34 offen offset:384 nt
M v[124:127],a[192:195],a[156:159],v[124:127]
ds_write2st64_b64 v254,v[0:1],v[4:5] offset0:68 offset1:72
M v[124:127],a[232:235],a[152:155],v[124:127]
buffer_load_dwordx4 a[228:231],v250,s[20:23],s47 offen offset:0 sc1
M v[124:127],a[236:239],a[144:147],v[124:127]
s_waitcnt vmcnt(29)
v_cvt_pk_bf16_f32 v8,v8,v9
v_cvt_pk_bf16_f32 v9,v10,v11
M v[128:131],a[112:115],a[148:151],v[128:131]
s_waitcnt vmcnt(28)
v_cvt_pk_bf16_f32 v12,v12,v13
v_cvt_pk_bf16_f32 v13,v14,v15
M v[128:131],v[220:223],a[132:135],v[128:131]
s_waitcnt vmcnt(27)
ds_write2st64_b64 v254,v[8:9],v[12:13] offset0:76 offset1:80
M v[128:131],a[124:127],a[252:255],v[128:131]
buffer_load_dwordx4 v[224:227],v250,s[20:23],s47 offen offset:1024 sc1
M v[132:135],a[124:127],a[240:243],v[132:135]
v_cvt_pk_bf16_f32 v16,v16,v17
v_cvt_pk_bf16_f32 v17,v18,v19
M v[132:135],v[220:223],a[252:255],v[132:135]
v_cvt_pk_bf16_f32 v20,v20,v21
v_cvt_pk_bf16_f32 v21,v22,v23
M v[132:135],a[112:115],a[132:135],v[132:135]
ds_write2st64_b64 v254,v[16:17],v[20:21] offset0:85 offset1:89
M v[136:139],a[112:115],a[252:255],v[136:139]
buffer_load_dwordx4 v[228:231],v250,s[20:23],s47 offen offset:2048 sc1
M v[136:139],v[220:223],a[240:243],v[136:139]
v_cvt_pk_bf16_f32 v24,v24,v25
v_cvt_pk_bf16_f32 v25,v26,v27
M v[136:139],a[124:127],a[96:99],v[136:139]
s_add_u32 s34,s32,0
v_cvt_pk_bf16_f32 v28,v28,v29
v_cvt_pk_bf16_f32 v29,v30,v31
M v[140:143],a[124:127],a[100:103],v[140:143]
ds_write2st64_b64 v254,v[24:25],v[28:29] offset0:93 offset1:97
M v[140:143],v[220:223],a[96:99],v[140:143]
v_accvgpr_read_b32 v238,a64
v_accvgpr_read_b32 v232,a160
M v[140:143],a[112:115],a[240:243],v[140:143]
s_waitcnt lgkmcnt(11)
buffer_store_dwordx4 a[32:35],v253,s[24:27],s34 offen offset:512 nt
M v[144:147],a[112:115],a[96:99],v[144:147]
s_add_u32 s46,s76,46080
v_add_f32 v234,v238,v232
v_sub_f32 v238,v238,v232
M v[144:147],v[220:223],a[100:103],v[144:147]
v_add_u32 v248,0x15400,v248
v_add_u32 v249,0x15400,v249
M v[144:147],a[124:127],a[140:143],v[144:147]
v_add_f32 v232,v64,v160
v_sub_f32 v160,v64,v160
M v[148:151],a[124:127],a[144:147],v[148:151]
v_add_f32 v64,v234,v232
v_fmac_f32 v234,4.0,v232
M v[148:151],v[220:223],a[140:143],v[148:151]
ds_read_b128 a[96:99],v248 offset:0
v_fma_f32 v232,2.0,v160,v238
M v[148:151],a[112:115],a[100:103],v[148:151]
ds_read_b128 a[100:103],v249 offset:0
v_fma_f32 v160,s40,v160,v238
M v[152:155],a[112:115],a[140:143],v[152:155]
s_waitcnt lgkmcnt(2)
s_barrier
ds_read_b128 v[0:3],v250 offset:34816
M v[152:155],v[220:223],a[144:147],v[152:155]
ds_read_b128 v[8:11],v250 offset:38912
ds_read_b128 v[16:19],v250 offset:43520
M v[152:155],a[124:127],a[152:155],v[152:155]
ds_read_b128 v[24:27],v250 offset:47616
ds_read_b128 a[140:143],v248 offset:512
M v[156:159],a[124:127],a[156:159],v[156:159]
buffer_load_dwordx4 a[132:135],v250,s[20:23],s46 offen offset:0 sc1
M v[156:159],v[220:223],a[152:155],v[156:159]
ds_read_b128 a[200:203],v249 offset:512
v_accvgpr_read_b32 v238,a65
M v[156:159],a[112:115],a[144:147],v[156:159]
s_waitcnt vmcnt(29) lgkmcnt(7)
buffer_load_dwordx4 a[148:151],v250,s[20:23],s46 offen offset:1024 sc1
v_accvgpr_read_b32 v237,a161
v_add_f32 v236,v238,v237
M v[96:99],a[108:111],a[96:99],v[96:99]
s_waitcnt vmcnt(29) lgkmcnt(6)
ds_read_b128 a[112:115],v248 offset:1024
v_sub_f32 v238,v238,v237
M v[96:99],a[208:211],a[100:103],v[96:99]
s_waitcnt vmcnt(28) lgkmcnt(2)
ds_read_b128 a[124:127],v249 offset:1024
v_add_f32 v237,v65,v161
M v[96:99],a[120:123],a[140:143],v[96:99]
s_waitcnt lgkmcnt(2)
s_add_u32 s34,s32,196608
v_sub_f32 v161,v65,v161
v_add_f32 v65,v236,v237
v_fmac_f32 v236,4.0,v237
v_fma_f32 v237,2.0,v161,v238
M v[100:103],a[120:123],a[200:203],v[100:103]
buffer_load_dwordx4 a[224:227],v250,s[20:23],s46 offen offset:2048 sc1
M v[100:103],a[208:211],a[140:143],v[100:103]
v_fma_f32 v161,s40,v161,v238
v_cvt_pk_bf16_f32 v232,v232,v237
M v[100:103],a[108:111],a[100:103],v[100:103]
v_cvt_pk_bf16_f32 v234,v234,v236
v_accvgpr_read_b32 v238,a66
v_accvgpr_read_b32 v233,a162
v_add_f32 v235,v238,v233
v_sub_f32 v238,v238,v233
M v[104:107],a[108:111],a[140:143],v[104:107]
ds_read_b128 a[144:147],v248 offset:1536
v_add_f32 v233,v66,v162
M v[104:107],a[208:211],a[200:203],v[104:107]
s_waitcnt lgkmcnt(2)
ds_read_b128 a[152:155],v249 offset:1536
v_sub_f32 v162,v66,v162
M v[104:107],a[120:123],a[112:115],v[104:107]
s_waitcnt lgkmcnt(2)
buffer_store_dwordx4 a[36:39],v253,s[24:27],s34 offen offset:512 nt
M v[108:111],a[120:123],a[124:127],v[108:111]
v_add_f32 v66,v235,v233
v_fmac_f32 v235,4.0,v233
M v[108:111],a[208:211],a[112:115],v[108:111]
v_fma_f32 v233,2.0,v162,v238
v_fma_f32 v162,s40,v162,v238
M v[108:111],a[108:111],a[200:203],v[108:111]
v_accvgpr_read_b32 v238,a67
v_accvgpr_read_b32 v237,a163
v_add_f32 v236,v238,v237
M v[112:115],a[108:111],a[112:115],v[112:115]
s_add_u32 s47,s76,49152
ds_read_b128 a[156:159],v249 offset:2048
v_sub_f32 v238,v238,v237
M v[112:115],a[208:211],a[124:127],v[112:115]
s_waitcnt lgkmcnt(2)
ds_read_b128 a[192:195],v248 offset:2048
v_add_f32 v237,v67,v163
M v[112:115],a[120:123],a[144:147],v[112:115]
s_waitcnt lgkmcnt(2)
v_sub_f32 v163,v67,v163
v_add_f32 v67,v236,v237
v_fmac_f32 v236,4.0,v237
v_fma_f32 v237,2.0,v163,v238
v_fma_f32 v163,s40,v163,v238
M v[116:119],a[120:123],a[152:155],v[116:119]
v_cvt_pk_bf16_f32 v233,v233,v237
v_cvt_pk_bf16_f32 v235,v235,v236
M v[116:119],a[208:211],a[144:147],v[116:119]
ds_write2st64_b64 v254,v[232:233],v[234:235] offset0:34 offset1:38
M v[116:119],a[108:111],a[124:127],v[116:119]
v_accvgpr_read_b32 v238,a68
v_accvgpr_read_b32 v232,a164
M v[120:123],a[108:111],a[144:147],v[120:123]
buffer_load_dwordx4 a[160:163],v250,s[20:23],s47 offen offset:0 sc1
M v[120:123],a[208:211],a[152:155],v[120:123]
s_waitcnt lgkmcnt(2)
v_add_f32 v234,v238,v232
v_sub_f32 v238,v238,v232
M v[120:123],a[120:123],a[156:159],v[120:123]
s_waitcnt lgkmcnt(1)
s_add_u32 s34,s32,393216
buffer_load_dwordx4 a[232:235],v250,s[20:23],s47 offen offset:1024 sc1
v_add_f32 v232,v68,v164
v_sub_f32 v164,v68,v164
M v[124:127],a[120:123],a[192:195],v[124:127]
v_add_f32 v68,v234,v232
v_fmac_f32 v234,4.0,v232
M v[124:127],a[208:211],a[156:159],v[124:127]
v_fma_f32 v232,2.0,v164,v238
v_fma_f32 v164,s40,v164,v238
M v[124:127],a[108:111],a[152:155],v[124:127]
s_waitcnt vmcnt(30)
v_accvgpr_read_b32 v238,a69
v_accvgpr_read_b32 v237,a165
v_add_f32 v236,v238,v237
v_sub_f32 v238,v238,v237
M v[128:131],a[116:119],a[96:99],v[128:131]
s_waitcnt vmcnt(28)
buffer_load_dwordx4 a[236:239],v250,s[20:23],s47 offen offset:2048 sc1
M v[128:131],a[196:199],a[100:103],v[128:131]
s_waitcnt vmcnt(28)
v_add_f32 v237,v69,v165
v_sub_f32 v165,v69,v165
M v[128:131],a[204:207],a[140:143],v[128:131]
v_add_f32 v69,v236,v237
v_fmac_f32 v236,4.0,v237
v_fma_f32 v237,2.0,v165,v238
v_fma_f32 v165,s40,v165,v238
v_cvt_pk_bf16_f32 v232,v232,v237
M v[132:135],a[204:207],a[200:203],v[132:135]
v_cvt_pk_bf16_f32 v234,v234,v236
v_accvgpr_read_b32 v238,a70
M v[132:135],a[196:199],a[140:143],v[132:135]
v_accvgpr_read_b32 v233,a166
v_add_f32 v235,v238,v233
M v[132:135],a[116:119],a[100:103],v[132:135]
buffer_store_dwordx4 a[40:43],v253,s[24:27],s34 offen offset:512 nt
M v[136:139],a[116:119],a[140:143],v[136:139]
v_sub_f32 v238,v238,v233
v_add_f32 v233,v70,v166
M v[136:139],a[196:199],a[200:203],v[136:139]
v_sub_f32 v166,v70,v166
v_add_f32 v70,v235,v233
M v[136:139],a[204:207],a[112:115],v[136:139]
v_fmac_f32 v235,4.0,v233
v_fma_f32 v233,2.0,v166,v238
v_fma_f32 v166,s40,v166,v238
M v[140:143],a[204:207],a[124:127],v[140:143]
v_accvgpr_read_b32 v238,a71
v_accvgpr_read_b32 v237,a167
M v[140:143],a[196:199],a[112:115],v[140:143]
v_add_f32 v236,v238,v237
v_sub_f32 v238,v238,v237
M v[140:143],a[116:119],a[200:203],v[140:143]
v_add_f32 v237,v71,v167
v_sub_f32 v167,v71,v167
v_add_f32 v71,v236,v237
v_fmac_f32 v236,4.0,v237
v_fma_f32 v237,2.0,v167,v238
M v[144:147],a[116:119],a[112:115],v[144:147]
s_add_u32 s46,s77,46080
v_fma_f32 v167,s40,v167,v238
v_cvt_pk_bf16_f32 v233,v233,v237
M v[144:147],a[196:199],a[124:127],v[144:147]
v_cvt_pk_bf16_f32 v235,v235,v236
M v[144:147],a[204:207],a[144:147],v[144:147]
s_add_u32 s34,s32,589824
buffer_store_dwordx4 a[44:47],v253,s[24:27],s34 offen offset:512 nt
M v[148:151],a[204:207],a[152:155],v[148:151]
ds_write2st64_b64 v254,v[232:233],v[234:235] offset0:42 offset1:46
M v[148:151],a[196:199],a[144:147],v[148:151]
ds_read_b128 a[96:99],v248 offset:17408
v_accvgpr_read_b32 v238,a72
M v[148:151],a[116:119],a[124:127],v[148:151]
ds_read_b128 a[100:103],v249 offset:17408
v_accvgpr_read_b32 v232,a168
M v[152:155],a[116:119],a[144:147],v[152:155]
buffer_load_dwordx4 a[108:111],v250,s[20:23],s46 offen offset:0 sc1
M v[152:155],a[196:199],a[152:155],v[152:155]
ds_read_b128 a[112:115],v248 offset:17920
ds_read_b128 a[124:127],v249 offset:17920
M v[152:155],a[204:207],a[156:159],v[152:155]
buffer_load_dwordx4 a[120:123],v250,s[20:23],s46 offen offset:1024 sc1
v_add_f32 v234,v238,v232
M v[156:159],a[204:207],a[192:195],v[156:159]
v_sub_f32 v238,v238,v232
v_add_f32 v232,v72,v168
M v[156:159],a[196:199],a[156:159],v[156:159]
v_sub_f32 v168,v72,v168
v_add_f32 v72,v234,v232
M v[156:159],a[116:119],a[152:155],v[156:159]
s_waitcnt vmcnt(30) lgkmcnt(3)
v_fmac_f32 v234,4.0,v232
v_fma_f32 v232,2.0,v168,v238
v_fma_f32 v168,s40,v168,v238
v_accvgpr_read_b32 v238,a73
M v[96:99],a[136:139],a[96:99],v[96:99]
s_waitcnt vmcnt(29) lgkmcnt(2)
buffer_load_dwordx4 a[140:143],v250,s[20:23],s46 offen offset:2048 sc1
M v[96:99],a[220:223],a[100:103],v[96:99]
s_waitcnt vmcnt(29) lgkmcnt(1)
ds_read_b128 a[116:119],v248 offset:18432
ds_read_b128 a[144:147],v249 offset:18432
M v[96:99],a[248:251],a[112:115],v[96:99]
s_waitcnt lgkmcnt(2)
v_accvgpr_read_b32 v237,a169
v_add_f32 v236,v238,v237
v_sub_f32 v238,v238,v237
v_add_f32 v237,v73,v169
v_sub_f32 v169,v73,v169
M v[100:103],a[248:251],a[124:127],v[100:103]
v_add_f32 v73,v236,v237
v_fmac_f32 v236,4.0,v237
M v[100:103],a[220:223],a[112:115],v[100:103]
v_fma_f32 v237,2.0,v169,v238
v_fma_f32 v169,s40,v169,v238
M v[100:103],a[136:139],a[100:103],v[100:103]
v_cvt_pk_bf16_f32 v232,v232,v237
v_cvt_pk_bf16_f32 v234,v234,v236
v_accvgpr_read_b32 v238,a74
v_accvgpr_read_b32 v233,a170
M v[104:107],a[136:139],a[112:115],v[104:107]
ds_read_b128 a[152:155],v248 offset:18944
v_add_f32 v235,v238,v233
M v[104:107],a[220:223],a[124:127],v[104:107]
s_waitcnt lgkmcnt(2)
ds_read_b128 a[156:159],v249 offset:18944
v_sub_f32 v238,v238,v233
M v[104:107],a[248:251],a[116:119],v[104:107]
s_waitcnt lgkmcnt(2)
s_add_u32 s34,s32,786432
buffer_store_dwordx4 a[48:51],v253,s[24:27],s34 offen offset:512 nt
M v[108:111],a[248:251],a[144:147],v[108:111]
v_add_f32 v233,v74,v170
v_sub_f32 v170,v74,v170
M v[108:111],a[220:223],a[116:119],v[108:111]
v_add_f32 v74,v235,v233
v_fmac_f32 v235,4.0,v233
M v[108:111],a[136:139],a[124:127],v[108:111]
v_fma_f32 v233,2.0,v170,v238
v_fma_f32 v170,s40,v170,v238
v_accvgpr_read_b32 v238,a75
v_accvgpr_read_b32 v237,a171
M v[112:115],a[136:139],a[116:119],v[112:115]
s_add_u32 s47,s77,49152
ds_read_b128 a[164:167],v249 offset:19456
v_add_f32 v236,v238,v237
M v[112:115],a[220:223],a[144:147],v[112:115]
s_waitcnt lgkmcnt(2)
ds_read_b128 a[252:255],v248 offset:19456
v_sub_f32 v238,v238,v237
M v[112:115],a[248:251],a[152:155],v[112:115]
s_waitcnt lgkmcnt(2)
v_add_f32 v237,v75,v171
v_sub_f32 v171,v75,v171
v_add_f32 v75,v236,v237
v_fmac_f32 v236,4.0,v237
M v[116:119],a[248:251],a[156:159],v[116:119]
v_fma_f32 v237,2.0,v171,v238
v_fma_f32 v171,s40,v171,v238
M v[116:119],a[220:223],a[152:155],v[116:119]
v_cvt_pk_bf16_f32 v233,v233,v237
v_cvt_pk_bf16_f32 v235,v235,v236
M v[116:119],a[136:139],a[144:147],v[116:119]
ds_write2st64_b64 v254,v[232:233],v[234:235] offset0:51 offset1:55
M v[120:123],a[136:139],a[152:155],v[120:123]
buffer_load_dwordx4 a[240:243],v250,s[20:23],s47 offen offset:0 sc1
M v[120:123],a[220:223],a[156:159],v[120:123]
s_waitcnt lgkmcnt(2)
v_accvgpr_read_b32 v238,a76
v_accvgpr_read_b32 v232,a172
M v[120:123],a[248:251],a[164:167],v[120:123]
s_waitcnt lgkmcnt(1)
buffer_load_dwordx4 v[220:223],v250,s[20:23],s47 offen offset:1024 sc1
v_add_f32 v234,v238,v232
v_sub_f32 v238,v238,v232
M v[124:127],a[248:251],a[252:255],v[124:127]
v_add_f32 v232,v76,v172
v_sub_f32 v172,v76,v172
M v[124:127],a[220:223],a[164:167],v[124:127]
v_add_f32 v76,v234,v232
v_fmac_f32 v234,4.0,v232
M v[124:127],a[136:139],a[156:159],v[124:127]
s_waitcnt vmcnt(30)
v_fma_f32 v232,2.0,v172,v238
v_fma_f32 v172,s40,v172,v238
v_accvgpr_read_b32 v238,a77
v_accvgpr_read_b32 v237,a173
v_add_f32 v236,v238,v237
M v[128:131],a[128:131],a[96:99],v[128:131]
s_waitcnt vmcnt(29)
buffer_load_dwordx4 a[168:171],v250,s[20:23],s47 offen offset:2048 sc1
M v[128:131],a[244:247],a[100:103],v[128:131]
s_waitcnt vmcnt(29)
v_sub_f32 v238,v238,v237
v_add_f32 v237,v77,v173
M v[128:131],a[216:219],a[112:115],v[128:131]
s_add_u32 s34,s32,983040
v_sub_f32 v173,v77,v173
v_add_f32 v77,v236,v237
v_fmac_f32 v236,4.0,v237
v_fma_f32 v237,2.0,v173,v238
v_fma_f32 v173,s40,v173,v238
M v[132:135],a[216:219],a[124:127],v[132:135]
v_cvt_pk_bf16_f32 v232,v232,v237
v_cvt_pk_bf16_f32 v234,v234,v236
M v[132:135],a[244:247],a[112:115],v[132:135]
v_accvgpr_read_b32 v238,a78
v_accvgpr_read_b32 v233,a174
M v[132:135],a[128:131],a[100:103],v[132:135]
buffer_store_dwordx4 a[52:55],v253,s[24:27],s34 offen offset:512 nt
M v[136:139],a[128:131],a[112:115],v[136:139]
v_add_f32 v235,v238,v233
v_sub_f32 v238,v238,v233
M v[136:139],a[244:247],a[124:127],v[136:139]
v_add_f32 v233,v78,v174
v_sub_f32 v174,v78,v174
M v[136:139],a[216:219],a[116:119],v[136:139]
v_add_f32 v78,v235,v233
v_fmac_f32 v235,4.0,v233
v_fma_f32 v233,2.0,v174,v238
M v[140:143],a[216:219],a[144:147],v[140:143]
v_fma_f32 v174,s40,v174,v238
v_accvgpr_read_b32 v238,a79
M v[140:143],a[244:247],a[116:119],v[140:143]
v_accvgpr_read_b32 v237,a175
v_add_f32 v236,v238,v237
M v[140:143],a[128:131],a[124:127],v[140:143]
v_sub_f32 v238,v238,v237
v_add_f32 v237,v79,v175
v_sub_f32 v175,v79,v175
v_add_f32 v79,v236,v237
v_fmac_f32 v236,4.0,v237
M v[144:147],a[128:131],a[116:119],v[144:147]
s_add_u32 s47,s72,3072
v_fma_f32 v237,2.0,v175,v238
v_fma_f32 v175,s40,v175,v238
M v[144:147],a[244:247],a[144:147],v[144:147]
v_cvt_pk_bf16_f32 v233,v233,v237
v_cvt_pk_bf16_f32 v235,v235,v236
M v[144:147],a[216:219],a[152:155],v[144:147]
ds_write2st64_b64 v254,v[232:233],v[234:235] offset0:59 offset1:63
M v[148:151],a[216:219],a[156:159],v[148:151]
v_accvgpr_read_b32 v238,a80
v_accvgpr_read_b32 v232,a176
M v[148:151],a[244:247],a[152:155],v[148:151]
ds_read_b128 a[96:99],v248 offset:34816
v_add_f32 v234,v238,v232
M v[148:151],a[128:131],a[144:147],v[148:151]
ds_read_b128 a[100:103],v249 offset:34816
v_sub_f32 v238,v238,v232
v_add_f32 v232,v80,v176
v_sub_f32 v176,v80,v176
M v[152:155],a[128:131],a[152:155],v[152:155]
buffer_load_dwordx4 a[112:115],v250,s[20:23],s47 offen offset:0 sc1
M v[152:155],a[244:247],a[156:159],v[152:155]
ds_read_b128 a[116:119],v248 offset:35328
ds_read_b128 a[136:139],v249 offset:35328
M v[152:155],a[216:219],a[164:167],v[152:155]
s_add_u32 s34,s32,1179648
buffer_load_dwordx4 a[124:127],v250,s[20:23],s47 offen offset:1024 sc1
v_add_f32 v80,v234,v232
v_fmac_f32 v234,4.0,v232
M v[156:159],a[216:219],a[252:255],v[156:159]
v_fma_f32 v232,2.0,v176,v238
v_fma_f32 v176,s40,v176,v238
M v[156:159],a[244:247],a[164:167],v[156:159]
v_accvgpr_read_b32 v238,a81
v_accvgpr_read_b32 v237,a177
M v[156:159],a[128:131],a[156:159],v[156:159]
s_waitcnt vmcnt(30) lgkmcnt(3)
v_add_f32 v236,v238,v237
v_sub_f32 v238,v238,v237
v_add_f32 v237,v81,v177
v_sub_f32 v177,v81,v177
v_add_f32 v81,v236,v237
M v[96:99],a[104:107],a[96:99],v[96:99]
s_waitcnt vmcnt(29) lgkmcnt(2)
buffer_load_dwordx4 a[144:147],v250,s[20:23],s47 offen offset:2048 sc1
M v[96:99],a[212:215],a[100:103],v[96:99]
s_waitcnt vmcnt(29) lgkmcnt(1)
ds_read_b128 a[128:131],v248 offset:35840
ds_read_b128 a[152:155],v249 offset:35840
M v[96:99],v[216:219],a[116:119],v[96:99]
s_waitcnt lgkmcnt(2)
v_fmac_f32 v236,4.0,v237
v_fma_f32 v237,2.0,v177,v238
v_fma_f32 v177,s40,v177,v238
M v[100:103],v[216:219],a[136:139],v[100:103]
v_cvt_pk_bf16_f32 v232,v232,v237
v_cvt_pk_bf16_f32 v234,v234,v236
M v[100:103],a[212:215],a[116:119],v[100:103]
v_accvgpr_read_b32 v238,a82
v_accvgpr_read_b32 v233,a178
M v[100:103],a[104:107],a[100:103],v[100:103]
buffer_store_dwordx4 a[56:59],v253,s[24:27],s34 offen offset:512 nt
M v[104:107],a[104:107],a[116:119],v[104:107]
ds_read_b128 a[156:159],v248 offset:36352
v_add_f32 v235,v238,v233
M v[104:107],a[212:215],a[136:139],v[104:107]
s_waitcnt lgkmcnt(2)
ds_read_b128 a[164:167],v249 offset:36352
v_sub_f32 v238,v238,v233
M v[104:107],v[216:219],a[128:131],v[104:107]
s_waitcnt lgkmcnt(2)
v_add_f32 v233,v82,v178
v_sub_f32 v178,v82,v178
M v[108:111],v[216:219],a[152:155],v[108:111]
v_add_f32 v82,v235,v233
v_fmac_f32 v235,4.0,v233
M v[108:111],a[212:215],a[128:131],v[108:111]
v_fma_f32 v233,2.0,v178,v238
v_fma_f32 v178,s40,v178,v238
M v[108:111],a[104:107],a[136:139],v[108:111]
v_accvgpr_read_b32 v238,a83
v_accvgpr_read_b32 v237,a179
M v[112:115],a[104:107],a[128:131],v[112:115]
s_add_u32 s48,s72,6144
ds_read_b128 a[172:175],v249 offset:36864
v_add_f32 v236,v238,v237
M v[112:115],a[212:215],a[152:155],v[112:115]
s_waitcnt lgkmcnt(2)
ds_read_b128 a[208:211],v248 offset:36864
v_sub_f32 v238,v238,v237
M v[112:115],v[216:219],a[156:159],v[112:115]
s_waitcnt lgkmcnt(2)
s_add_u32 s34,s32,1376256
buffer_store_dwordx4 a[60:63],v253,s[24:27],s34 offen offset:512 nt
M v[116:119],v[216:219],a[164:167],v[116:119]
v_add_f32 v237,v83,v179
v_sub_f32 v179,v83,v179
M v[116:119],a[212:215],a[156:159],v[116:119]
v_add_f32 v83,v236,v237
v_fmac_f32 v236,4.0,v237
M v[116:119],a[104:107],a[152:155],v[116:119]
v_fma_f32 v237,2.0,v179,v238
v_fma_f32 v179,s40,v179,v238
M v[120:123],a[104:107],a[156:159],v[120:123]
buffer_load_dwordx4 a[200:203],v250,s[20:23],s48 offen offset:0 sc1
M v[120:123],a[212:215],a[164:167],v[120:123]
s_waitcnt lgkmcnt(1)
v_cvt_pk_bf16_f32 v233,v233,v237
v_cvt_pk_bf16_f32 v235,v235,v236
M v[120:123],v[216:219],a[172:175],v[120:123]
s_waitcnt lgkmcnt(0)
buffer_load_dwordx4 a[192:195],v250,s[20:23],s48 offen offset:1024 sc1
M v[124:127],v[216:219],a[208:211],v[124:127]
ds_write2st64_b64 v254,v[232:233],v[234:235] offset0:102 offset1:106
M v[124:127],a[212:215],a[172:175],v[124:127]
v_accvgpr_read_b32 v238,a84
v_accvgpr_read_b32 v232,a180
M v[124:127],a[104:107],a[164:167],v[124:127]
s_waitcnt vmcnt(27)
v_add_f32 v234,v238,v232
v_sub_f32 v238,v238,v232
M v[128:131],a[228:231],a[96:99],v[128:131]
s_waitcnt vmcnt(26)
buffer_load_dwordx4 a[204:207],v250,s[20:23],s48 offen offset:2048 sc1
M v[128:131],v[224:227],a[100:103],v[128:131]
s_waitcnt vmcnt(26)
v_add_f32 v232,v84,v180
v_sub_f32 v180,v84,v180
M v[128:131],v[228:231],a[116:119],v[128:131]
v_add_f32 v84,v234,v232
v_fmac_f32 v234,4.0,v232
M v[132:135],v[228:231],a[136:139],v[132:135]
v_fma_f32 v232,2.0,v180,v238
v_fma_f32 v180,s40,v180,v238
M v[132:135],v[224:227],a[116:119],v[132:135]
v_accvgpr_read_b32 v238,a85
v_accvgpr_read_b32 v237,a181
M v[132:135],a[228:231],a[100:103],v[132:135]
v_add_f32 v236,v238,v237
v_sub_f32 v238,v238,v237
M v[136:139],a[228:231],a[116:119],v[136:139]
v_add_f32 v237,v85,v181
v_sub_f32 v181,v85,v181
M v[136:139],v[224:227],a[136:139],v[136:139]
v_add_f32 v85,v236,v237
v_fmac_f32 v236,4.0,v237
M v[136:139],v[228:231],a[128:131],v[136:139]
s_add_u32 s34,s33,0
buffer_store_dwordx4 v[0:3],v253,s[24:27],s34 offen offset:0 nt
M v[140:143],v[228:231],a[152:155],v[140:143]
v_fma_f32 v237,2.0,v181,v238
v_fma_f32 v181,s40,v181,v238
M v[140:143],v[224:227],a[128:131],v[140:143]
v_cvt_pk_bf16_f32 v232,v232,v237
v_cvt_pk_bf16_f32 v234,v234,v236
M v[140:143],a[228:231],a[136:139],v[140:143]
v_accvgpr_read_b32 v238,a86
v_accvgpr_read_b32 v233,a182
M v[144:147],a[228:231],a[128:131],v[144:147]
s_add_u32 s47,s73,3072
v_add_f32 v235,v238,v233
v_sub_f32 v238,v238,v233
M v[144:147],v[224:227],a[152:155],v[144:147]
v_add_f32 v233,v86,v182
v_sub_f32 v182,v86,v182
M v[144:147],v[228:231],a[156:159],v[144:147]
v_add_f32 v86,v235,v233
v_fmac_f32 v235,4.0,v233
M v[148:151],v[228:231],a[164:167],v[148:151]
v_fma_f32 v233,2.0,v182,v238
v_fma_f32 v182,s40,v182,v238
M v[148:151],v[224:227],a[156:159],v[148:151]
ds_read_b128 a[96:99],v248 offset:52224
v_accvgpr_read_b32 v238,a87
M v[148:151],a[228:231],a[152:155],v[148:151]
ds_read_b128 a[100:103],v249 offset:52224
v_accvgpr_read_b32 v237,a183
v_add_f32 v236,v238,v237
M v[152:155],a[228:231],a[156:159],v[152:155]
buffer_load_dwordx4 a[104:107],v250,s[20:23],s47 offen offset:0 sc1
M v[152:155],v[224:227],a[164:167],v[152:155]
ds_read_b128 a[116:119],v248 offset:52736
ds_read_b128 a[136:139],v249 offset:52736
M v[152:155],v[228:231],a[172:175],v[152:155]
buffer_load_dwordx4 a[128:131],v250,s[20:23],s47 offen offset:1024 sc1
v_sub_f32 v238,v238,v237
M v[156:159],v[228:231],a[208:211],v[156:159]
v_add_f32 v237,v87,v183
v_sub_f32 v183,v87,v183
M v[156:159],v[224:227],a[172:175],v[156:159]
v_add_f32 v87,v236,v237
v_fmac_f32 v236,4.0,v237
M v[156:159],a[228:231],a[164:167],v[156:159]
s_waitcnt vmcnt(27) lgkmcnt(3)
v_fma_f32 v237,2.0,v183,v238
v_fma_f32 v183,s40,v183,v238
v_cvt_pk_bf16_f32 v233,v233,v237
M v[96:99],a[132:135],a[96:99],v[96:99]
s_waitcnt vmcnt(26) lgkmcnt(2)
buffer_load_dwordx4 a[152:155],v250,s[20:23],s47 offen offset:2048 sc1
M v[96:99],a[148:151],a[100:103],v[96:99]
s_waitcnt vmcnt(26) lgkmcnt(1)
ds_read_b128 a[156:159],v248 offset:53248
ds_read_b128 a[164:167],v249 offset:53248
M v[96:99],a[224:227],a[116:119],v[96:99]
s_waitcnt lgkmcnt(2)
s_add_u32 s34,s33,393216
v_cvt_pk_bf16_f32 v235,v235,v236
M v[100:103],a[224:227],a[136:139],v[100:103]
ds_write2st64_b64 v254,v[232:233],v[234:235] offset0:110 offset1:114
M v[100:103],a[148:151],a[116:119],v[100:103]
v_accvgpr_read_b32 v238,a88
v_accvgpr_read_b32 v232,a184
M v[100:103],a[132:135],a[100:103],v[100:103]
buffer_store_dwordx4 v[8:11],v253,s[24:27],s34 offen offset:0 nt
M v[104:107],a[132:135],a[116:119],v[104:107]
ds_read_b128 a[172:175],v248 offset:53760
v_add_f32 v234,v238,v232
M v[104:107],a[148:151],a[136:139],v[104:107]
s_waitcnt lgkmcnt(3)
ds_read_b128 a[176:179],v249 offset:53760
v_sub_f32 v238,v238,v232
M v[104:107],a[224:227],a[156:159],v[104:107]
s_waitcnt lgkmcnt(3)
v_add_f32 v232,v88,v184
v_sub_f32 v184,v88,v184
M v[108:111],a[224:227],a[164:167],v[108:111]
v_add_f32 v88,v234,v232
v_fmac_f32 v234,4.0,v232
M v[108:111],a[148:151],a[156:159],v[108:111]
v_fma_f32 v232,2.0,v184,v238
v_fma_f32 v184,s40,v184,v238
M v[108:111],a[132:135],a[136:139],v[108:111]
v_accvgpr_read_b32 v238,a89
v_accvgpr_read_b32 v237,a185
M v[112:115],a[132:135],a[156:159],v[112:115]
s_add_u32 s48,s73,6144
ds_read_b128 a[180:183],v249 offset:54272
v_add_f32 v236,v238,v237
M v[112:115],a[148:151],a[164:167],v[112:115]
s_waitcnt lgkmcnt(2)
ds_read_b128 a[196:199],v248 offset:54272
v_sub_f32 v238,v238,v237
M v[112:115],a[224:227],a[172:175],v[112:115]
s_waitcnt lgkmcnt(2)
v_add_f32 v237,v89,v185
v_sub_f32 v185,v89,v185
M v[116:119],a[224:227],a[176:179],v[116:119]
v_add_f32 v89,v236,v237
v_fmac_f32 v236,4.0,v237
M v[116:119],a[148:151],a[172:175],v[116:119]
v_fma_f32 v237,2.0,v185,v238
v_fma_f32 v185,s40,v185,v238
M v[116:119],a[132:135],a[164:167],v[116:119]
v_cvt_pk_bf16_f32 v232,v232,v237
v_cvt_pk_bf16_f32 v234,v234,v236
v_accvgpr_read_b32 v238,a90
M v[120:123],a[132:135],a[172:175],v[120:123]
buffer_load_dwordx4 a[248:251],v250,s[20:23],s48 offen offset:0 sc1
M v[120:123],a[148:151],a[176:179],v[120:123]
s_waitcnt lgkmcnt(1)
v_accvgpr_read_b32 v233,a186
v_add_f32 v235,v238,v233
M v[120:123],a[224:227],a[180:183],v[120:123]
s_waitcnt lgkmcnt(0)
s_add_u32 s34,s33,786432
buffer_load_dwordx4 a[220:223],v250,s[20:23],s48 offen offset:1024 sc1
v_sub_f32 v238,v238,v233
M v[124:127],a[224:227],a[196:199],v[124:127]
v_add_f32 v233,v90,v186
v_sub_f32 v186,v90,v186
M v[124:127],a[148:151],a[180:183],v[124:127]
v_add_f32 v90,v235,v233
v_fmac_f32 v235,4.0,v233
M v[124:127],a[132:135],a[176:179],v[124:127]
s_waitcnt vmcnt(27)
v_fma_f32 v233,2.0,v186,v238
v_fma_f32 v186,s40,v186,v238
v_accvgpr_read_b32 v238,a91
M v[128:131],a[160:163],a[96:99],v[128:131]
s_waitcnt vmcnt(26)
buffer_load_dwordx4 a[216:219],v250,s[20:23],s48 offen offset:2048 sc1
M v[128:131],a[232:235],a[100:103],v[128:131]
s_waitcnt vmcnt(26)
v_accvgpr_read_b32 v237,a187
v_add_f32 v236,v238,v237
M v[128:131],a[236:239],a[116:119],v[128:131]
v_sub_f32 v238,v238,v237
v_add_f32 v237,v91,v187
v_sub_f32 v187,v91,v187
M v[132:135],a[236:239],a[136:139],v[132:135]
v_add_f32 v91,v236,v237
v_fmac_f32 v236,4.0,v237
M v[132:135],a[232:235],a[116:119],v[132:135]
v_fma_f32 v237,2.0,v187,v238
v_fma_f32 v187,s40,v187,v238
M v[132:135],a[160:163],a[100:103],v[132:135]
buffer_store_dwordx4 v[16:19],v253,s[24:27],s34 offen offset:0 nt
M v[136:139],a[160:163],a[116:119],v[136:139]
v_cvt_pk_bf16_f32 v233,v233,v237
v_cvt_pk_bf16_f32 v235,v235,v236
M v[136:139],a[232:235],a[136:139],v[136:139]
ds_write2st64_b64 v254,v[232:233],v[234:235] offset0:119 offset1:123
M v[136:139],a[236:239],a[156:159],v[136:139]
v_accvgpr_read_b32 v238,a92
v_accvgpr_read_b32 v232,a188
M v[140:143],a[236:239],a[164:167],v[140:143]
v_add_f32 v234,v238,v232
v_sub_f32 v238,v238,v232
M v[140:143],a[232:235],a[156:159],v[140:143]
v_add_f32 v232,v92,v188
v_sub_f32 v188,v92,v188
M v[140:143],a[160:163],a[136:139],v[140:143]
v_add_f32 v92,v234,v232
v_fmac_f32 v234,4.0,v232
M v[144:147],a[160:163],a[156:159],v[144:147]
s_add_u32 s47,s74,3072
v_fma_f32 v232,2.0,v188,v238
v_fma_f32 v188,s40,v188,v238
M v[144:147],a[232:235],a[164:167],v[144:147]
v_add_u32 v248,0xffffbc00,v248
v_add_u32 v249,0xffffbc00,v249
M v[144:147],a[236:239],a[172:175],v[144:147]
s_add_u32 s34,s33,1179648
buffer_store_dwordx4 v[24:27],v253,s[24:27],s34 offen offset:0 nt
M v[148:151],a[236:239],a[176:179],v[148:151]
v_accvgpr_read_b32 v238,a93
v_accvgpr_read_b32 v237,a189
M v[148:151],a[232:235],a[172:175],v[148:151]
ds_read_b128 a[96:99],v248 offset:0
v_add_f32 v236,v238,v237
M v[148:151],a[160:163],a[164:167],v[148:151]
ds_read_b128 a[100:103],v249 offset:0
v_sub_f32 v238,v238,v237
M v[152:155],a[160:163],a[172:175],v[152:155]
buffer_load_dwordx4 a[116:119],v250,s[20:23],s47 offen offset:0 sc1
M v[152:155],a[232:235],a[176:179],v[152:155]
ds_read_b128 a[132:135],v248 offset:512
ds_read_b128 a[148:151],v249 offset:512
M v[152:155],a[236:239],a[180:183],v[152:155]
buffer_load_dwordx4 a[136:139],v250,s[20:23],s47 offen offset:1024 sc1
M v[156:159],a[236:239],a[196:199],v[156:159]
v_add_f32 v237,v93,v189
v_sub_f32 v189,v93,v189
M v[156:159],a[232:235],a[180:183],v[156:159]
v_add_f32 v93,v236,v237
v_fmac_f32 v236,4.0,v237
M v[156:159],a[160:163],a[176:179],v[156:159]
s_waitcnt vmcnt(27) lgkmcnt(3)
v_fma_f32 v237,2.0,v189,v238
v_fma_f32 v189,s40,v189,v238
M v[96:99],a[108:111],a[96:99],v[96:99]
s_waitcnt vmcnt(26) lgkmcnt(2)
buffer_load_dwordx4 a[156:159],v250,s[20:23],s47 offen offset:2048 sc1
M v[96:99],a[120:123],a[100:103],v[96:99]
s_waitcnt vmcnt(26) lgkmcnt(1)
ds_read_b128 a[160:163],v248 offset:1024
ds_read_b128 a[164:167],v249 offset:1024
M v[96:99],a[140:143],a[132:135],v[96:99]
s_waitcnt lgkmcnt(2)
v_cvt_pk_bf16_f32 v232,v232,v237
v_cvt_pk_bf16_f32 v234,v234,v236
M v[100:103],a[140:143],a[148:151],v[100:103]
v_accvgpr_read_b32 v238,a94
v_accvgpr_read_b32 v233,a190
M v[100:103],a[120:123],a[132:135],v[100:103]
v_add_f32 v235,v238,v233
v_sub_f32 v238,v238,v233
M v[100:103],a[108:111],a[100:103],v[100:103]
v_add_f32 v233,v94,v190
v_sub_f32 v190,v94,v190
M v[104:107],a[108:111],a[132:135],v[104:107]
ds_read_b128 a[172:175],v248 offset:1536
v_add_f32 v94,v235,v233
M v[104:107],a[120:123],a[148:151],v[104:107]
s_waitcnt lgkmcnt(2)
ds_read_b128 a[176:179],v249 offset:1536
v_fmac_f32 v235,4.0,v233
M v[104:107],a[140:143],a[160:163],v[104:107]
s_waitcnt lgkmcnt(2)
v_fma_f32 v233,2.0,v190,v238
v_fma_f32 v190,s40,v190,v238
v_accvgpr_read_b32 v238,a95
v_accvgpr_read_b32 v237,a191
M v[108:111],a[140:143],a[164:167],v[108:111]
v_add_f32 v236,v238,v237
v_sub_f32 v238,v238,v237
M v[108:111],a[120:123],a[160:163],v[108:111]
v_add_f32 v237,v95,v191
v_sub_f32 v191,v95,v191
M v[108:111],a[108:111],a[148:151],v[108:111]
v_add_f32 v95,v236,v237
v_fmac_f32 v236,4.0,v237
v_fma_f32 v237,2.0,v191,v238
M v[112:115],a[108:111],a[160:163],v[112:115]
s_add_u32 s48,s74,6144
ds_read_b128 a[180:183],v249 offset:2048
v_fma_f32 v191,s40,v191,v238
M v[112:115],a[120:123],a[164:167],v[112:115]
s_waitcnt lgkmcnt(2)
ds_read_b128 a[184:187],v248 offset:2048
v_cvt_pk_bf16_f32 v233,v233,v237
M v[112:115],a[140:143],a[172:175],v[112:115]
s_waitcnt lgkmcnt(2)
v_cvt_pk_bf16_f32 v235,v235,v236
M v[116:119],a[140:143],a[176:179],v[116:119]
ds_write2st64_b64 v254,v[232:233],v[234:235] offset0:127 offset1:131
M v[116:119],a[120:123],a[172:175],v[116:119]
v_cvt_pk_bf16_f32 v96,v96,v97
v_cvt_pk_bf16_f32 v97,v98,v99
M v[116:119],a[108:111],a[164:167],v[116:119]
v_cvt_pk_bf16_f32 v100,v100,v101
v_cvt_pk_bf16_f32 v101,v102,v103
M v[120:123],a[108:111],a[172:175],v[120:123]
s_waitcnt lgkmcnt(0)
s_barrier
ds_read_b128 a[64:67],v250 offset:17408
M v[120:123],a[120:123],a[176:179],v[120:123]
ds_read_b128 a[68:71],v250 offset:21504
ds_read_b128 a[72:75],v250 offset:26112
M v[120:123],a[140:143],a[180:183],v[120:123]
ds_read_b128 a[76:79],v250 offset:30208
ds_read_b128 a[80:83],v250 offset:52224
ds_read_b128 a[84:87],v250 offset:56320
M v[124:127],a[140:143],a[184:187],v[124:127]
ds_read_b128 a[88:91],v250 offset:60928
ds_read_b128 a[92:95],v250 offset:65024
M v[124:127],a[120:123],a[180:183],v[124:127]
buffer_load_dwordx4 a[188:191],v250,s[20:23],s48 offen offset:0 sc1
M v[124:127],a[108:111],a[176:179],v[124:127]
s_waitcnt vmcnt(25)
s_add_u32 s34,s32,0
ds_write2st64_b64 v254,v[96:97],v[100:101] offset0:68 offset1:72
M v[128:131],a[240:243],a[96:99],v[128:131]
s_waitcnt vmcnt(24)
buffer_load_dwordx4 a[252:255],v250,s[20:23],s48 offen offset:1024 sc1
M v[128:131],v[220:223],a[100:103],v[128:131]
s_waitcnt vmcnt(24)
v_cvt_pk_bf16_f32 v104,v104,v105
v_cvt_pk_bf16_f32 v105,v106,v107
M v[128:131],a[168:171],a[132:135],v[128:131]
v_cvt_pk_bf16_f32 v108,v108,v109
v_cvt_pk_bf16_f32 v109,v110,v111
M v[132:135],a[168:171],a[148:151],v[132:135]
ds_write2st64_b64 v254,v[104:105],v[108:109] offset0:76 offset1:80
M v[132:135],v[220:223],a[132:135],v[132:135]
buffer_load_dwordx4 a[244:247],v250,s[20:23],s48 offen offset:2048 sc1
M v[132:135],a[240:243],a[100:103],v[132:135]
v_cvt_pk_bf16_f32 v112,v112,v113
v_cvt_pk_bf16_f32 v113,v114,v115
M v[136:139],a[240:243],a[132:135],v[136:139]
v_cvt_pk_bf16_f32 v116,v116,v117
v_cvt_pk_bf16_f32 v117,v118,v119
M v[136:139],v[220:223],a[148:151],v[136:139]
ds_write2st64_b64 v254,v[112:113],v[116:117] offset0:85 offset1:89
M v[136:139],a[168:171],a[160:163],v[136:139]
s_waitcnt lgkmcnt(10)
buffer_store_dwordx4 a[64:67],v253,s[24:27],s34 offen offset:640 nt
M v[140:143],a[168:171],a[164:167],v[140:143]
s_add_u32 s34,s32,196608
v_cvt_pk_bf16_f32 v120,v120,v121
v_cvt_pk_bf16_f32 v121,v122,v123
M v[140:143],v[220:223],a[160:163],v[140:143]
v_cvt_pk_bf16_f32 v124,v124,v125
v_cvt_pk_bf16_f32 v125,v126,v127
M v[140:143],a[240:243],a[148:151],v[140:143]
s_waitcnt lgkmcnt(9)
buffer_store_dwordx4 a[68:71],v253,s[24:27],s34 offen offset:640 nt
M v[144:147],a[240:243],a[160:163],v[144:147]
s_add_u32 s47,s75,3072
ds_write2st64_b64 v254,v[120:121],v[124:125] offset0:93 offset1:97
M v[144:147],v[220:223],a[164:167],v[144:147]
v_add_u32 v248,0xfffece00,v248
v_add_u32 v249,0xfffece00,v249
M v[144:147],a[168:171],a[172:175],v[144:147]
v_cvt_pk_bf16_f32 v128,v128,v129
v_cvt_pk_bf16_f32 v129,v130,v131
M v[148:151],a[168:171],a[176:179],v[148:151]
v_cvt_pk_bf16_f32 v132,v132,v133
v_cvt_pk_bf16_f32 v133,v134,v135
M v[148:151],v[220:223],a[172:175],v[148:151]
s_waitcnt lgkmcnt(0)
s_barrier
ds_read_b128 a[96:99],v248 offset:0
M v[148:151],a[240:243],a[164:167],v[148:151]
ds_read_b128 a[100:103],v249 offset:0
v_add_u32 v4,69632,v250
M v[152:155],a[240:243],a[172:175],v[152:155]
ds_read_b128 v[96:99],v250 offset:34816
ds_read_b128 v[104:107],v250 offset:38912
M v[152:155],v[220:223],a[176:179],v[152:155]
ds_read_b128 v[112:115],v250 offset:43520
ds_read_b128 v[120:123],v250 offset:47616
M v[152:155],a[168:171],a[180:183],v[152:155]
s_add_u32 s34,s32,393216
buffer_load_dwordx4 a[108:111],v250,s[20:23],s47 offen offset:0 sc1
M v[156:159],a[168:171],a[184:187],v[156:159]
ds_read_b128 a[120:123],v248 offset:512
ds_read_b128 a[140:143],v249 offset:512
M v[156:159],v[220:223],a[180:183],v[156:159]
buffer_load_dwordx4 a[132:135],v250,s[20:23],s47 offen offset:1024 sc1
M v[156:159],a[240:243],a[176:179],v[156:159]
s_waitcnt vmcnt(27) lgkmcnt(7)
ds_write2st64_b64 v254,v[128:129],v[132:133] offset0:34 offset1:38
M v[32:35],a[112:115],a[96:99],v[32:35]
s_waitcnt vmcnt(26) lgkmcnt(7)
ds_read_b128 a[160:163],v248 offset:1024
v_cvt_pk_bf16_f32 v136,v136,v137
M v[32:35],a[124:127],a[100:103],v[32:35]
s_waitcnt vmcnt(25) lgkmcnt(3)
ds_read_b128 a[164:167],v249 offset:1024
v_cvt_pk_bf16_f32 v137,v138,v139
M v[32:35],a[144:147],a[120:123],v[32:35]
s_waitcnt lgkmcnt(3)
buffer_load_dwordx4 a[148:151],v250,s[20:23],s47 offen offset:2048 sc1
M v[36:39],a[144:147],a[140:143],v[36:39]
v_cvt_pk_bf16_f32 v140,v140,v141
v_cvt_pk_bf16_f32 v141,v142,v143
M v[36:39],a[124:127],a[120:123],v[36:39]
ds_write2st64_b64 v254,v[136:137],v[140:141] offset0:42 offset1:46
M v[36:39],a[112:115],a[100:103],v[36:39]
buffer_store_dwordx4 a[72:75],v253,s[24:27],s34 offen offset:640 nt
M v[40:43],a[112:115],a[120:123],v[40:43]
ds_read_b128 a[168:171],v248 offset:1536
v_cvt_pk_bf16_f32 v144,v144,v145
M v[40:43],a[124:127],a[140:143],v[40:43]
s_waitcnt lgkmcnt(3)
ds_read_b128 a[172:175],v249 offset:1536
v_cvt_pk_bf16_f32 v145,v146,v147
M v[40:43],a[144:147],a[160:163],v[40:43]
s_waitcnt lgkmcnt(3)
v_cvt_pk_bf16_f32 v148,v148,v149
v_cvt_pk_bf16_f32 v149,v150,v151
M v[44:47],a[144:147],a[164:167],v[44:47]
ds_write2st64_b64 v254,v[144:145],v[148:149] offset0:51 offset1:55
M v[44:47],a[124:127],a[160:163],v[44:47]
v_cvt_pk_bf16_f32 v152,v152,v153
v_cvt_pk_bf16_f32 v153,v154,v155
M v[44:47],a[112:115],a[140:143],v[44:47]
v_cvt_pk_bf16_f32 v156,v156,v157
v_cvt_pk_bf16_f32 v157,v158,v159
M v[48:51],a[112:115],a[160:163],v[48:51]
ds_read_b128 a[176:179],v249 offset:2048
ds_write2st64_b64 v254,v[152:153],v[156:157] offset0:59 offset1:63
M v[48:51],a[124:127],a[164:167],v[48:51]
s_waitcnt lgkmcnt(4)
ds_read_b128 a[180:183],v248 offset:2048
v_permlane32_swap_b32 v208,v210
M v[48:51],a[144:147],a[168:171],v[48:51]
s_waitcnt lgkmcnt(4)
s_add_u32 s34,s32,589824
buffer_store_dwordx4 a[76:79],v253,s[24:27],s34 offen offset:640 nt
M v[52:55],a[144:147],a[172:175],v[52:55]
v_permlane32_swap_b32 v204,v206
v_permlane32_swap_b32 v212,v214
M v[52:55],a[124:127],a[168:171],v[52:55]
v_lshlrev_b32 v234,16,v210
v_lshlrev_b32 v232,16,v204
M v[52:55],a[112:115],a[164:167],v[52:55]
v_lshlrev_b32 v233,16,v208
v_lshlrev_b32 v237,16,v206
M v[56:59],a[112:115],a[168:171],v[56:59]
global_load_dword a184,v250,s[64:65]
M v[56:59],a[124:127],a[172:175],v[56:59]
s_waitcnt lgkmcnt(2)
s_add_u32 s48,s75,6144
buffer_load_dwordx4 a[184:187],v250,s[20:23],s48 offen offset:0 sc1
M v[56:59],a[144:147],a[176:179],v[56:59]
s_waitcnt lgkmcnt(0)
v_lshlrev_b32 v236,16,v214
v_lshlrev_b32 v235,16,v212
M v[60:63],a[144:147],a[180:183],v[60:63]
v_fmac_f32 v232,s43,v234
M v[60:63],a[124:127],a[176:179],v[60:63]
s_barrier
ds_read_b128 v[128:131],v250 offset:17408
M v[60:63],a[112:115],a[172:175],v[60:63]
s_waitcnt vmcnt(27)
ds_read_b128 v[136:139],v250 offset:21504
ds_read_b128 v[144:147],v250 offset:26112
M v[64:67],a[200:203],a[96:99],v[64:67]
s_waitcnt vmcnt(26)
ds_read_b128 v[152:155],v250 offset:30208
v_fmac_f32 v237,4.0,v233
M v[64:67],a[192:195],a[100:103],v[64:67]
s_waitcnt vmcnt(25)
buffer_load_dwordx4 v[216:219],v250,s[20:23],s48 offen offset:1024 sc1
M v[64:67],a[204:207],a[120:123],v[64:67]
v_fma_f32 v238,-4.0,v234,v236
v_fmac_f32 v232,s45,v236
M v[68:71],a[204:207],a[140:143],v[68:71]
buffer_load_dwordx4 a[212:215],v250,s[20:23],s48 offen offset:2048 sc1
M v[68:71],a[192:195],a[120:123],v[68:71]
v_fmac_f32 v237,s41,v235
v_sub_f32 v236,v236,v234
M v[68:71],a[200:203],a[100:103],v[68:71]
v_fma_f32 v234,-4.0,v233,v235
v_sub_f32 v235,v235,v233
M v[72:75],a[200:203],a[120:123],v[72:75]
v_add_f32 v233,v238,v234
v_sub_f32 v238,v238,v234
M v[72:75],a[192:195],a[140:143],v[72:75]
v_fma_f32 v234,2.0,v235,v236
v_fmac_f32 v236,-2.0,v235
M v[72:75],a[204:207],a[160:163],v[72:75]
s_add_u32 s34,s32,786432
buffer_store_dwordx4 a[80:83],v253,s[24:27],s34 offen offset:640 nt
M v[76:79],a[204:207],a[164:167],v[76:79]
v_and_b32 v210,s42,v210
v_and_b32 v204,s42,v204
M v[76:79],a[192:195],a[160:163],v[76:79]
v_and_b32 v208,s42,v208
v_and_b32 v206,s42,v206
M v[76:79],a[200:203],a[140:143],v[76:79]
v_and_b32 v214,s42,v214
v_and_b32 v212,s42,v212
M v[80:83],a[200:203],a[160:163],v[80:83]
s_add_u32 s47,s76,3072
v_fmac_f32 v204,s43,v210
v_fmac_f32 v206,4.0,v208
M v[80:83],a[192:195],a[164:167],v[80:83]
v_add_u32 v248,0x15400,v248
v_add_u32 v249,0x15400,v249
M v[80:83],a[204:207],a[168:171],v[80:83]
v_fma_f32 v235,-4.0,v210,v214
v_fmac_f32 v204,s45,v214
M v[84:87],a[204:207],a[172:175],v[84:87]
v_fmac_f32 v206,s41,v212
v_sub_f32 v214,v214,v210
M v[84:87],a[192:195],a[168:171],v[84:87]
ds_read_b128 a[96:99],v248 offset:0
v_fma_f32 v210,-4.0,v208,v212
M v[84:87],a[200:203],a[164:167],v[84:87]
ds_read_b128 a[100:103],v249 offset:0
v_sub_f32 v212,v212,v208
M v[88:91],a[200:203],a[168:171],v[88:91]
buffer_load_dwordx4 a[112:115],v250,s[20:23],s47 offen offset:0 sc1
M v[88:91],a[192:195],a[172:175],v[88:91]
ds_read_b128 a[120:123],v248 offset:512
ds_read_b128 a[140:143],v249 offset:512
M v[88:91],a[204:207],a[176:179],v[88:91]
buffer_load_dwordx4 a[124:127],v250,s[20:23],s47 offen offset:1024 sc1
M v[92:95],a[204:207],a[180:183],v[92:95]
v_add_f32 v208,v235,v210
v_sub_f32 v235,v235,v210
M v[92:95],a[192:195],a[176:179],v[92:95]
v_fma_f32 v210,2.0,v212,v214
v_fmac_f32 v214,-2.0,v212
M v[92:95],a[200:203],a[172:175],v[92:95]
s_waitcnt vmcnt(28) lgkmcnt(3)
v_cvt_pk_bf16_f32 v204,v232,v204
v_cvt_pk_bf16_f32 v206,v237,v206
M v[32:35],a[104:107],a[96:99],v[32:35]
s_waitcnt vmcnt(27) lgkmcnt(2)
buffer_load_dwordx4 a[144:147],v250,s[20:23],s47 offen offset:2048 sc1
M v[32:35],a[128:131],a[100:103],v[32:35]
s_waitcnt vmcnt(27) lgkmcnt(1)
ds_read_b128 a[160:163],v248 offset:1024
ds_read_b128 a[164:167],v249 offset:1024
M v[32:35],a[152:155],a[120:123],v[32:35]
s_waitcnt lgkmcnt(2)
s_add_u32 s34,s32,983040
v_cvt_pk_bf16_f32 v208,v233,v208
v_cvt_pk_bf16_f32 v212,v234,v210
M v[36:39],a[152:155],a[140:143],v[36:39]
v_cvt_pk_bf16_f32 v210,v238,v235
v_cvt_pk_bf16_f32 v214,v236,v214
M v[36:39],a[128:131],a[120:123],v[36:39]
v_permlane32_swap_b32 v209,v211
v_permlane32_swap_b32 v205,v207
M v[36:39],a[104:107],a[100:103],v[36:39]
buffer_store_dwordx4 a[84:87],v253,s[24:27],s34 offen offset:640 nt
M v[40:43],a[104:107],a[120:123],v[40:43]
ds_read_b128 a[168:171],v248 offset:1536
v_permlane32_swap_b32 v213,v215
M v[40:43],a[128:131],a[140:143],v[40:43]
s_waitcnt lgkmcnt(2)
ds_read_b128 a[172:175],v249 offset:1536
v_lshlrev_b32 v234,16,v211
M v[40:43],a[152:155],a[160:163],v[40:43]
s_waitcnt lgkmcnt(2)
v_lshlrev_b32 v232,16,v205
v_lshlrev_b32 v233,16,v209
M v[44:47],a[152:155],a[164:167],v[44:47]
v_lshlrev_b32 v237,16,v207
v_lshlrev_b32 v236,16,v215
M v[44:47],a[128:131],a[160:163],v[44:47]
v_lshlrev_b32 v235,16,v213
v_fmac_f32 v232,s43,v234
M v[44:47],a[104:107],a[140:143],v[44:47]
v_fmac_f32 v237,4.0,v233
v_fma_f32 v238,-4.0,v234,v236
M v[48:51],a[104:107],a[160:163],v[48:51]
s_add_u32 s48,s76,6144
ds_read_b128 a[176:179],v249 offset:2048
v_fmac_f32 v232,s45,v236
M v[48:51],a[128:131],a[164:167],v[48:51]
s_waitcnt lgkmcnt(2)
ds_read_b128 a[180:183],v248 offset:2048
v_fmac_f32 v237,s41,v235
M v[48:51],a[152:155],a[168:171],v[48:51]
s_waitcnt lgkmcnt(2)
v_sub_f32 v236,v236,v234
v_fma_f32 v234,-4.0,v233,v235
M v[52:55],a[152:155],a[172:175],v[52:55]
v_sub_f32 v235,v235,v233
v_add_f32 v233,v238,v234
M v[52:55],a[128:131],a[168:171],v[52:55]
v_sub_f32 v238,v238,v234
v_fma_f32 v234,2.0,v235,v236
M v[52:55],a[104:107],a[164:167],v[52:55]
v_fmac_f32 v236,-2.0,v235
v_and_b32 v211,s42,v211
M v[56:59],a[104:107],a[168:171],v[56:59]
buffer_load_dwordx4 a[208:211],v250,s[20:23],s48 offen offset:0 sc1
M v[56:59],a[128:131],a[172:175],v[56:59]
s_waitcnt lgkmcnt(1)
v_and_b32 v205,s42,v205
v_and_b32 v209,s42,v209
M v[56:59],a[152:155],a[176:179],v[56:59]
s_waitcnt lgkmcnt(0)
s_add_u32 s34,s32,1179648
buffer_load_dwordx4 v[228:231],v250,s[20:23],s48 offen offset:1024 sc1
M v[60:63],a[152:155],a[180:183],v[60:63]
v_and_b32 v207,s42,v207
v_and_b32 v215,s42,v215
M v[60:63],a[128:131],a[176:179],v[60:63]
v_and_b32 v213,s42,v213
v_fmac_f32 v205,s43,v211
M v[60:63],a[104:107],a[172:175],v[60:63]
s_waitcnt vmcnt(28)
v_fmac_f32 v207,4.0,v209
v_fma_f32 v235,-4.0,v211,v215
M v[64:67],a[248:251],a[96:99],v[64:67]
s_waitcnt vmcnt(27)
buffer_load_dwordx4 v[224:227],v250,s[20:23],s48 offen offset:2048 sc1
M v[64:67],a[220:223],a[100:103],v[64:67]
s_waitcnt vmcnt(27)
v_fmac_f32 v205,s45,v215
v_fmac_f32 v207,s41,v213
M v[64:67],a[216:219],a[120:123],v[64:67]
v_sub_f32 v215,v215,v211
v_fma_f32 v211,-4.0,v209,v213
M v[68:71],a[216:219],a[140:143],v[68:71]
v_sub_f32 v213,v213,v209
v_add_f32 v209,v235,v211
M v[68:71],a[220:223],a[120:123],v[68:71]
v_sub_f32 v235,v235,v211
v_fma_f32 v211,2.0,v213,v215
M v[68:71],a[248:251],a[100:103],v[68:71]
buffer_store_dwordx4 a[88:91],v253,s[24:27],s34 offen offset:640 nt
M v[72:75],a[248:251],a[120:123],v[72:75]
v_fmac_f32 v215,-2.0,v213
v_cvt_pk_bf16_f32 v205,v232,v205
M v[72:75],a[220:223],a[140:143],v[72:75]
v_cvt_pk_bf16_f32 v207,v237,v207
v_cvt_pk_bf16_f32 v209,v233,v209
M v[72:75],a[216:219],a[160:163],v[72:75]
v_cvt_pk_bf16_f32 v213,v234,v211
v_cvt_pk_bf16_f32 v211,v238,v235
M v[76:79],a[216:219],a[164:167],v[76:79]
v_cvt_pk_bf16_f32 v215,v236,v215
M v[76:79],a[220:223],a[160:163],v[76:79]
s_barrier
v_fmac_f32 v239,s43,v241
M v[76:79],a[248:251],a[140:143],v[76:79]
ds_write2st64_b64 v247,v[192:193],v[194:195] offset0:102 offset1:119
M v[80:83],a[248:251],a[160:163],v[80:83]
s_add_u32 s28,s66,7077888
buffer_load_dwordx4 v[192:195],v251,s[88:91],s28 offen offset:0
M v[80:83],a[220:223],a[164:167],v[80:83]
s_add_u32 s47,s77,3072
v_fmac_f32 v244,4.0,v240
v_fma_f32 v232,-4.0,v241,v243
M v[80:83],a[216:219],a[168:171],v[80:83]
s_add_u32 s34,s32,1376256
ds_write2st64_b64 v247,v[196:197],v[198:199] offset0:34 offset1:51
M v[84:87],a[216:219],a[172:175],v[84:87]
buffer_load_dwordx4 v[196:199],v245,s[8:11],s28 offen offset:0
M v[84:87],a[220:223],a[168:171],v[84:87]
ds_read_b128 a[96:99],v248 offset:17408
v_fmac_f32 v239,s45,v243
M v[84:87],a[248:251],a[164:167],v[84:87]
ds_write2st64_b64 v247,v[200:201],v[202:203] offset0:68 offset1:85
M v[88:91],a[248:251],a[168:171],v[88:91]
buffer_load_dwordx4 v[200:203],v245,s[8:11],s28 offen offset:768
M v[88:91],a[220:223],a[172:175],v[88:91]
ds_read_b128 a[100:103],v249 offset:17408
ds_read_b128 a[120:123],v248 offset:17920
M v[88:91],a[216:219],a[176:179],v[88:91]
ds_write2st64_b64 v247,v[204:205],v[206:207] offset0:103 offset1:120
M v[92:95],a[216:219],a[180:183],v[92:95]
s_add_u32 s28,s66,7471104
buffer_load_dwordx4 v[204:207],v251,s[88:91],s28 offen offset:0
M v[92:95],a[220:223],a[176:179],v[92:95]
ds_read_b128 a[140:143],v249 offset:17920
v_fmac_f32 v244,s41,v242
M v[92:95],a[248:251],a[172:175],v[92:95]
s_waitcnt vmcnt(29) lgkmcnt(5)
ds_write2st64_b64 v247,v[208:209],v[210:211] offset0:35 offset1:52
M v[32:35],a[116:119],a[96:99],v[32:35]
s_waitcnt vmcnt(28) lgkmcnt(4)
buffer_load_dwordx4 v[208:211],v245,s[8:11],s28 offen offset:0
M v[32:35],a[136:139],a[100:103],v[32:35]
s_waitcnt vmcnt(28) lgkmcnt(3)
ds_read_b128 a[160:163],v248 offset:18432
ds_read_b128 a[164:167],v249 offset:18432
M v[32:35],a[156:159],a[120:123],v[32:35]
s_waitcnt lgkmcnt(3)
ds_write2st64_b64 v247,v[212:213],v[214:215] offset0:69 offset1:86
M v[36:39],a[156:159],a[140:143],v[36:39]
buffer_load_dwordx4 v[212:215],v245,s[8:11],s28 offen offset:768
M v[36:39],a[136:139],a[120:123],v[36:39]
v_sub_f32 v243,v243,v241
v_fma_f32 v241,-4.0,v240,v242
M v[36:39],a[116:119],a[100:103],v[36:39]
v_sub_f32 v242,v242,v240
v_add_f32 v240,v232,v241
M v[40:43],a[116:119],a[120:123],v[40:43]
ds_read_b128 a[168:171],v248 offset:18944
v_sub_f32 v232,v232,v241
M v[40:43],a[136:139],a[140:143],v[40:43]
s_waitcnt lgkmcnt(3)
buffer_load_dwordx4 a[104:107],v250,s[20:23],s47 offen offset:0 sc1
M v[40:43],a[156:159],a[160:163],v[40:43]
s_waitcnt lgkmcnt(2)
ds_read_b128 a[172:175],v249 offset:18944
v_fma_f32 v241,2.0,v242,v243
M v[44:47],a[156:159],a[164:167],v[44:47]
v_fmac_f32 v243,-2.0,v242
v_cvt_pk_bf16_f32 v233,v239,v244
M v[44:47],a[136:139],a[160:163],v[44:47]
v_cvt_pk_bf16_f32 v234,v240,v232
v_cvt_pk_bf16_f32 v235,v241,v243
M v[44:47],a[116:119],a[140:143],v[44:47]
s_add_u32 s29,s67,6291456
buffer_load_short_d16_hi v239,v246,s[12:15],s29 offen offset:0
M v[48:51],a[116:119],a[160:163],v[48:51]
ds_read_b128 a[176:179],v249 offset:19456
ds_write_b16 v252,v233 offset:52224
M v[48:51],a[136:139],a[164:167],v[48:51]
s_waitcnt lgkmcnt(3)
buffer_load_short_d16_hi v240,v246,s[8:11],s29 offen offset:0
M v[48:51],a[156:159],a[168:171],v[48:51]
s_waitcnt lgkmcnt(2)
buffer_load_short_d16_hi v241,v246,s[8:11],s29 offen offset:384
M v[52:55],a[156:159],a[172:175],v[52:55]
ds_read_b128 a[180:183],v248 offset:19456
ds_write_b16_d16_hi v252,v233 offset:60928
M v[52:55],a[136:139],a[168:171],v[52:55]
buffer_load_short_d16_hi v242,v246,s[8:11],s29 offen offset:768
M v[52:55],a[116:119],a[164:167],v[52:55]
ds_write_b16 v252,v234 offset:17408
M v[56:59],a[116:119],a[168:171],v[56:59]
buffer_load_short_d16_hi v243,v246,s[8:11],s29 offen offset:1152
M v[56:59],a[136:139],a[172:175],v[56:59]
s_waitcnt lgkmcnt(4)
ds_write_b16_d16_hi v252,v234 offset:26112
M v[56:59],a[156:159],a[176:179],v[56:59]
s_waitcnt lgkmcnt(3)
buffer_load_short_d16_hi v244,v246,s[16:19],s29 offen offset:1536
M v[60:63],a[156:159],a[180:183],v[60:63]
ds_write_b16 v252,v235 offset:34816
M v[60:63],a[136:139],a[176:179],v[60:63]
buffer_load_dwordx4 a[128:131],v250,s[20:23],s47 offen offset:1024 sc1
M v[60:63],a[116:119],a[172:175],v[60:63]
s_waitcnt vmcnt(36)
ds_write_b16_d16_hi v252,v235 offset:43520
M v[64:67],a[188:191],a[96:99],v[64:67]
s_waitcnt vmcnt(35)
M v[64:67],a[252:255],a[100:103],v[64:67]
s_waitcnt vmcnt(34)
M v[64:67],a[244:247],a[120:123],v[64:67]
buffer_store_dwordx4 a[92:95],v253,s[24:27],s34 offen offset:640 nt
M v[68:71],a[244:247],a[140:143],v[68:71]
s_add_u32 s34,s33,0
M v[68:71],a[252:255],a[120:123],v[68:71]
M v[68:71],a[188:191],a[100:103],v[68:71]
buffer_load_dwordx4 a[152:155],v250,s[20:23],s47 offen offset:2048 sc1
M v[72:75],a[188:191],a[120:123],v[72:75]
s_add_u32 s48,s77,6144
M v[72:75],a[252:255],a[140:143],v[72:75]
M v[72:75],a[244:247],a[160:163],v[72:75]
M v[76:79],a[244:247],a[164:167],v[76:79]
buffer_load_dwordx4 a[228:231],v250,s[20:23],s48 offen offset:0 sc1
M v[76:79],a[252:255],a[160:163],v[76:79]
M v[76:79],a[188:191],a[140:143],v[76:79]
M v[80:83],a[188:191],a[160:163],v[80:83]
M v[80:83],a[252:255],a[164:167],v[80:83]
buffer_load_dwordx4 a[224:227],v250,s[20:23],s48 offen offset:1024 sc1
M v[80:83],a[244:247],a[168:171],v[80:83]
M v[84:87],a[244:247],a[172:175],v[84:87]
M v[84:87],a[252:255],a[168:171],v[84:87]
ds_read_b128 a[96:99],v248 offset:34816
M v[84:87],a[188:191],a[164:167],v[84:87]
buffer_store_dwordx4 v[96:99],v253,s[24:27],s34 offen offset:1152 nt
M v[88:91],a[188:191],a[168:171],v[88:91]
s_add_u32 s34,s33,393216
ds_read_b128 a[100:103],v249 offset:34816
ds_read_b128 a[120:123],v248 offset:35328
M v[88:91],a[252:255],a[172:175],v[88:91]
ds_read_b128 a[140:143],v249 offset:35328
M v[88:91],a[244:247],a[176:179],v[88:91]
buffer_load_dwordx4 a[196:199],v250,s[20:23],s48 offen offset:2048 sc1
M v[92:95],a[244:247],a[180:183],v[92:95]
s_waitcnt vmcnt(18)
s_add_u32 s48,s72,52224
v_permlane32_swap_b32 v196,v198
v_permlane32_swap_b32 v192,v194
M v[92:95],a[252:255],a[176:179],v[92:95]
s_waitcnt vmcnt(17)
v_permlane32_swap_b32 v200,v202
v_lshlrev_b32 v234,16,v198
M v[92:95],a[188:191],a[172:175],v[92:95]
s_waitcnt lgkmcnt(3)
v_lshlrev_b32 v232,16,v192
v_lshlrev_b32 v233,16,v196
M v[32:35],a[108:111],a[96:99],v[32:35]
s_waitcnt lgkmcnt(2)
buffer_load_dwordx4 a[116:119],v250,s[20:23],s48 offen offset:0 sc1
M v[32:35],a[132:135],a[100:103],v[32:35]
s_waitcnt lgkmcnt(1)
ds_read_b128 a[160:163],v248 offset:35840
ds_read_b128 a[164:167],v249 offset:35840
M v[32:35],a[148:151],a[120:123],v[32:35]
s_waitcnt lgkmcnt(2)
v_lshlrev_b32 v237,16,v194
v_lshlrev_b32 v236,16,v202
M v[36:39],a[148:151],a[140:143],v[36:39]
v_lshlrev_b32 v235,16,v200
v_fmac_f32 v232,s43,v234
M v[36:39],a[132:135],a[120:123],v[36:39]
buffer_load_dwordx4 a[136:139],v250,s[20:23],s48 offen offset:1024 sc1
M v[36:39],a[108:111],a[100:103],v[36:39]
v_fmac_f32 v237,4.0,v233
v_fma_f32 v238,-4.0,v234,v236
M v[40:43],a[108:111],a[120:123],v[40:43]
ds_read_b128 a[168:171],v248 offset:36352
v_fmac_f32 v232,s45,v236
M v[40:43],a[132:135],a[140:143],v[40:43]
s_waitcnt lgkmcnt(2)
ds_read_b128 a[172:175],v249 offset:36352
v_fmac_f32 v237,s41,v235
M v[40:43],a[148:151],a[160:163],v[40:43]
s_waitcnt lgkmcnt(2)
buffer_store_dwordx4 v[104:107],v253,s[24:27],s34 offen offset:1152 nt
M v[44:47],a[148:151],a[164:167],v[44:47]
s_add_u32 s34,s33,786432
v_sub_f32 v236,v236,v234
v_fma_f32 v234,-4.0,v233,v235
M v[44:47],a[132:135],a[160:163],v[44:47]
v_sub_f32 v235,v235,v233
v_add_f32 v233,v238,v234
M v[44:47],a[108:111],a[140:143],v[44:47]
buffer_load_dwordx4 a[156:159],v250,s[20:23],s48 offen offset:2048 sc1
M v[48:51],a[108:111],a[160:163],v[48:51]
s_add_u32 s48,s73,52224
ds_read_b128 a[176:179],v249 offset:36864
v_sub_f32 v238,v238,v234
M v[48:51],a[132:135],a[164:167],v[48:51]
s_waitcnt lgkmcnt(2)
ds_read_b128 a[180:183],v248 offset:36864
v_fma_f32 v234,2.0,v235,v236
M v[48:51],a[148:151],a[168:171],v[48:51]
s_waitcnt lgkmcnt(2)
v_fmac_f32 v236,-2.0,v235
v_and_b32 v198,s42,v198
M v[52:55],a[148:151],a[172:175],v[52:55]
v_and_b32 v192,s42,v192
v_and_b32 v196,s42,v196
M v[52:55],a[132:135],a[168:171],v[52:55]
v_and_b32 v194,s42,v194
v_and_b32 v202,s42,v202
M v[52:55],a[108:111],a[164:167],v[52:55]
buffer_store_dwordx4 v[112:115],v253,s[24:27],s34 offen offset:1152 nt
M v[56:59],a[108:111],a[168:171],v[56:59]
s_add_u32 s34,s33,1179648
buffer_load_dwordx4 a[188:191],v250,s[20:23],s48 offen offset:0 sc1
M v[56:59],a[132:135],a[172:175],v[56:59]
s_waitcnt lgkmcnt(1)
v_and_b32 v200,s42,v200
v_fmac_f32 v192,s43,v198
M v[56:59],a[148:151],a[176:179],v[56:59]
s_waitcnt lgkmcnt(0)
v_fmac_f32 v194,4.0,v196
v_fma_f32 v235,-4.0,v198,v202
M v[60:63],a[148:151],a[180:183],v[60:63]
v_fmac_f32 v192,s45,v202
v_fmac_f32 v194,s41,v200
M v[60:63],a[132:135],a[176:179],v[60:63]
buffer_load_dwordx4 a[236:239],v250,s[20:23],s48 offen offset:1024 sc1
M v[60:63],a[108:111],a[172:175],v[60:63]
v_sub_f32 v202,v202,v198
v_fma_f32 v198,-4.0,v196,v200
M v[64:67],a[184:187],a[96:99],v[64:67]
v_sub_f32 v200,v200,v196
v_add_f32 v196,v235,v198
M v[64:67],v[216:219],a[100:103],v[64:67]
v_sub_f32 v235,v235,v198
v_fma_f32 v198,2.0,v200,v202
M v[64:67],a[212:215],a[120:123],v[64:67]
buffer_store_dwordx4 v[120:123],v253,s[24:27],s34 offen offset:1152 nt
M v[68:71],a[212:215],a[140:143],v[68:71]
v_fmac_f32 v202,-2.0,v200
v_cvt_pk_bf16_f32 v192,v232,v192
M v[68:71],v[216:219],a[120:123],v[68:71]
v_cvt_pk_bf16_f32 v194,v237,v194
v_cvt_pk_bf16_f32 v196,v233,v196
M v[68:71],a[184:187],a[100:103],v[68:71]
buffer_load_dwordx4 a[232:235],v250,s[20:23],s48 offen offset:2048 sc1
M v[72:75],a[184:187],a[120:123],v[72:75]
v_cvt_pk_bf16_f32 v200,v234,v198
v_cvt_pk_bf16_f32 v198,v238,v235
M v[72:75],v[216:219],a[140:143],v[72:75]
v_cvt_pk_bf16_f32 v202,v236,v202
v_permlane32_swap_b32 v197,v199
M v[72:75],a[212:215],a[160:163],v[72:75]
s_add_u32 s34,s33,0
v_permlane32_swap_b32 v193,v195
v_permlane32_swap_b32 v201,v203
M v[76:79],a[212:215],a[164:167],v[76:79]
v_lshlrev_b32 v234,16,v199
v_lshlrev_b32 v232,16,v193
M v[76:79],v[216:219],a[160:163],v[76:79]
v_lshlrev_b32 v233,16,v197
v_lshlrev_b32 v237,16,v195
M v[76:79],a[184:187],a[140:143],v[76:79]
buffer_store_dwordx4 v[128:131],v253,s[24:27],s34 offen offset:1280 nt
M v[80:83],a[184:187],a[160:163],v[80:83]
s_add_u32 s48,s74,52224
v_lshlrev_b32 v236,16,v203
v_lshlrev_b32 v235,16,v201
M v[80:83],v[216:219],a[164:167],v[80:83]
v_fmac_f32 v232,s43,v234
v_fmac_f32 v237,4.0,v233
M v[80:83],a[212:215],a[168:171],v[80:83]
v_fma_f32 v238,-4.0,v234,v236
v_fmac_f32 v232,s45,v236
M v[84:87],a[212:215],a[172:175],v[84:87]
v_fmac_f32 v237,s41,v235
v_sub_f32 v236,v236,v234
M v[84:87],v[216:219],a[168:171],v[84:87]
ds_read_b128 a[96:99],v248 offset:52224
v_fma_f32 v234,-4.0,v233,v235
M v[84:87],a[184:187],a[164:167],v[84:87]
ds_read_b128 a[100:103],v249 offset:52224
v_sub_f32 v235,v235,v233
M v[88:91],a[184:187],a[168:171],v[88:91]
buffer_load_dwordx4 a[108:111],v250,s[20:23],s48 offen offset:0 sc1
M v[88:91],v[216:219],a[172:175],v[88:91]
ds_read_b128 a[120:123],v248 offset:52736
ds_read_b128 a[140:143],v249 offset:52736
M v[88:91],a[212:215],a[176:179],v[88:91]
buffer_load_dwordx4 a[132:135],v250,s[20:23],s48 offen offset:1024 sc1
M v[92:95],a[212:215],a[180:183],v[92:95]
v_add_f32 v233,v238,v234
v_sub_f32 v238,v238,v234
M v[92:95],v[216:219],a[176:179],v[92:95]
v_fma_f32 v234,2.0,v235,v236
v_fmac_f32 v236,-2.0,v235
M v[92:95],a[184:187],a[172:175],v[92:95]
s_waitcnt lgkmcnt(3)
v_and_b32 v199,s42,v199
v_and_b32 v193,s42,v193
M v[32:35],a[112:115],a[96:99],v[32:35]
s_waitcnt lgkmcnt(2)
buffer_load_dwordx4 a[148:151],v250,s[20:23],s48 offen offset:2048 sc1
M v[32:35],a[124:127],a[100:103],v[32:35]
s_waitcnt lgkmcnt(1)
ds_read_b128 a[160:163],v248 offset:53248
ds_read_b128 a[164:167],v249 offset:53248
M v[32:35],a[144:147],a[120:123],v[32:35]
s_waitcnt lgkmcnt(2)
s_add_u32 s34,s33,393216
v_and_b32 v197,s42,v197
v_and_b32 v195,s42,v195
M v[36:39],a[144:147],a[140:143],v[36:39]
v_and_b32 v203,s42,v203
v_and_b32 v201,s42,v201
M v[36:39],a[124:127],a[120:123],v[36:39]
v_fmac_f32 v193,s43,v199
v_fmac_f32 v195,4.0,v197
M v[36:39],a[112:115],a[100:103],v[36:39]
buffer_store_dwordx4 v[136:139],v253,s[24:27],s34 offen offset:1280 nt
M v[40:43],a[112:115],a[120:123],v[40:43]
ds_read_b128 a[168:171],v248 offset:53760
v_fma_f32 v235,-4.0,v199,v203
M v[40:43],a[124:127],a[140:143],v[40:43]
s_waitcnt lgkmcnt(2)
ds_read_b128 a[172:175],v249 offset:53760
v_fmac_f32 v193,s45,v203
M v[40:43],a[144:147],a[160:163],v[40:43]
s_waitcnt lgkmcnt(2)
v_fmac_f32 v195,s41,v201
v_sub_f32 v203,v203,v199
M v[44:47],a[144:147],a[164:167],v[44:47]
v_fma_f32 v199,-4.0,v197,v201
v_sub_f32 v201,v201,v197
M v[44:47],a[124:127],a[160:163],v[44:47]
v_add_f32 v197,v235,v199
v_sub_f32 v235,v235,v199
M v[44:47],a[112:115],a[140:143],v[44:47]
v_fma_f32 v199,2.0,v201,v203
v_fmac_f32 v203,-2.0,v201
M v[48:51],a[112:115],a[160:163],v[48:51]
s_add_u32 s48,s75,52224
ds_read_b128 a[176:179],v249 offset:54272
v_cvt_pk_bf16_f32 v193,v232,v193
M v[48:51],a[124:127],a[164:167],v[48:51]
s_waitcnt lgkmcnt(2)
ds_read_b128 a[180:183],v248 offset:54272
v_cvt_pk_bf16_f32 v195,v237,v195
M v[48:51],a[144:147],a[168:171],v[48:51]
s_waitcnt lgkmcnt(2)
v_cvt_pk_bf16_f32 v197,v233,v197
v_cvt_pk_bf16_f32 v201,v234,v199
M v[52:55],a[144:147],a[172:175],v[52:55]
v_cvt_pk_bf16_f32 v199,v238,v235
v_cvt_pk_bf16_f32 v203,v236,v203
M v[52:55],a[124:127],a[168:171],v[52:55]
s_waitcnt vmcnt(29)
v_permlane32_swap_b32 v208,v210
v_permlane32_swap_b32 v204,v206
M v[52:55],a[112:115],a[164:167],v[52:55]
ds_write2st64_b64 v247,v[192:193],v[194:195] offset0:104 offset1:121
M v[56:59],a[112:115],a[168:171],v[56:59]
s_add_u32 s28,s67,6291456
buffer_load_dwordx4 v[192:195],v251,s[88:91],s28 offen offset:0
M v[56:59],a[124:127],a[172:175],v[56:59]
s_waitcnt vmcnt(29) lgkmcnt(2)
v_permlane32_swap_b32 v212,v214
v_lshlrev_b32 v234,16,v210
M v[56:59],a[144:147],a[176:179],v[56:59]
s_waitcnt lgkmcnt(1)
s_add_u32 s34,s33,786432
ds_write2st64_b64 v247,v[196:197],v[198:199] offset0:36 offset1:53
M v[60:63],a[144:147],a[180:183],v[60:63]
buffer_load_dwordx4 v[196:199],v245,s[8:11],s28 offen offset:0
M v[60:63],a[124:127],a[176:179],v[60:63]
v_lshlrev_b32 v232,16,v204
v_lshlrev_b32 v233,16,v208
M v[60:63],a[112:115],a[172:175],v[60:63]
ds_write2st64_b64 v247,v[200:201],v[202:203] offset0:70 offset1:87
M v[64:67],a[208:211],a[96:99],v[64:67]
buffer_load_dwordx4 v[200:203],v245,s[8:11],s28 offen offset:768
M v[64:67],v[228:231],a[100:103],v[64:67]
v_lshlrev_b32 v237,16,v206
v_lshlrev_b32 v236,16,v214
M v[64:67],v[224:227],a[120:123],v[64:67]
v_lshlrev_b32 v235,16,v212
v_fmac_f32 v232,s43,v234
M v[68:71],v[224:227],a[140:143],v[68:71]
buffer_load_dwordx4 a[184:187],v250,s[20:23],s48 offen offset:0 sc1
M v[68:71],v[228:231],a[120:123],v[68:71]
v_fmac_f32 v237,4.0,v233
v_fma_f32 v238,-4.0,v234,v236
M v[68:71],a[208:211],a[100:103],v[68:71]
v_fmac_f32 v232,s45,v236
v_fmac_f32 v237,s41,v235
M v[72:75],a[208:211],a[120:123],v[72:75]
v_sub_f32 v236,v236,v234
v_fma_f32 v234,-4.0,v233,v235
M v[72:75],v[228:231],a[140:143],v[72:75]
buffer_load_dwordx4 v[220:223],v250,s[20:23],s48 offen offset:1024 sc1
M v[72:75],v[224:227],a[160:163],v[72:75]
v_sub_f32 v235,v235,v233
v_add_f32 v233,v238,v234
M v[76:79],v[224:227],a[164:167],v[76:79]
v_sub_f32 v238,v238,v234
v_fma_f32 v234,2.0,v235,v236
M v[76:79],v[228:231],a[160:163],v[76:79]
v_fmac_f32 v236,-2.0,v235
v_and_b32 v210,s42,v210
M v[76:79],a[208:211],a[140:143],v[76:79]
buffer_load_dwordx4 a[240:243],v250,s[20:23],s48 offen offset:2048 sc1
M v[80:83],a[208:211],a[160:163],v[80:83]
s_add_u32 s48,s76,52224
v_and_b32 v204,s42,v204
v_and_b32 v208,s42,v208
M v[80:83],v[228:231],a[164:167],v[80:83]
v_add_u32 v248,0xfffece00,v248
v_add_u32 v249,0xfffece00,v249
M v[80:83],v[224:227],a[168:171],v[80:83]
v_and_b32 v206,s42,v206
v_and_b32 v214,s42,v214
M v[84:87],v[224:227],a[172:175],v[84:87]
v_and_b32 v212,s42,v212
v_fmac_f32 v204,s43,v210
M v[84:87],v[228:231],a[168:171],v[84:87]
ds_read_b128 a[96:99],v248 offset:60928
v_fmac_f32 v206,4.0,v208
M v[84:87],a[208:211],a[164:167],v[84:87]
buffer_store_dwordx4 v[144:147],v253,s[24:27],s34 offen offset:1280 nt
M v[88:91],a[208:211],a[168:171],v[88:91]
s_add_u32 s34,s33,1179648
buffer_load_dwordx4 a[112:115],v250,s[20:23],s48 offen offset:0 sc1
M v[88:91],v[228:231],a[172:175],v[88:91]
ds_read_b128 a[100:103],v249 offset:60928
ds_read_b128 a[120:123],v248 offset:61440
M v[88:91],v[224:227],a[176:179],v[88:91]
ds_read_b128 a[140:143],v249 offset:61440
v_fma_f32 v235,-4.0,v210,v214
M v[92:95],v[224:227],a[180:183],v[92:95]
v_fmac_f32 v204,s45,v214
v_fmac_f32 v206,s41,v212
M v[92:95],v[228:231],a[176:179],v[92:95]
buffer_load_dwordx4 a[124:127],v250,s[20:23],s48 offen offset:1024 sc1
M v[92:95],a[208:211],a[172:175],v[92:95]
s_waitcnt vmcnt(36) lgkmcnt(3)
v_sub_f32 v214,v214,v210
v_fma_f32 v210,-4.0,v208,v212
M v[32:35],a[104:107],a[96:99],v[32:35]
s_waitcnt vmcnt(29) lgkmcnt(2)
ds_read_b128 a[160:163],v248 offset:61952
v_sub_f32 v212,v212,v208
M v[32:35],a[128:131],a[100:103],v[32:35]
s_waitcnt vmcnt(27) lgkmcnt(2)
ds_read_b128 a[164:167],v249 offset:61952
v_add_f32 v208,v235,v210
M v[32:35],a[152:155],a[120:123],v[32:35]
s_waitcnt lgkmcnt(2)
buffer_store_dwordx4 v[152:155],v253,s[24:27],s34 offen offset:1280 nt
M v[36:39],a[152:155],a[140:143],v[36:39]
v_sub_f32 v235,v235,v210
v_fma_f32 v210,2.0,v212,v214
M v[36:39],a[128:131],a[120:123],v[36:39]
v_fmac_f32 v214,-2.0,v212
v_cvt_pk_bf16_f32 v204,v232,v204
M v[36:39],a[104:107],a[100:103],v[36:39]
buffer_load_dwordx4 a[144:147],v250,s[20:23],s48 offen offset:2048 sc1
M v[40:43],a[104:107],a[120:123],v[40:43]
ds_read_b128 a[168:171],v248 offset:62464
v_cvt_pk_bf16_f32 v206,v237,v206
M v[40:43],a[128:131],a[140:143],v[40:43]
s_waitcnt lgkmcnt(2)
ds_read_b128 a[172:175],v249 offset:62464
v_cvt_pk_bf16_f32 v208,v233,v208
M v[40:43],a[152:155],a[160:163],v[40:43]
s_waitcnt lgkmcnt(2)
v_cvt_pk_bf16_f32 v212,v234,v210
v_cvt_pk_bf16_f32 v210,v238,v235
M v[44:47],a[152:155],a[164:167],v[44:47]
v_cvt_pk_bf16_f32 v214,v236,v214
v_permlane32_swap_b32 v209,v211
M v[44:47],a[128:131],a[160:163],v[44:47]
v_permlane32_swap_b32 v205,v207
v_permlane32_swap_b32 v213,v215
M v[44:47],a[104:107],a[140:143],v[44:47]
v_lshlrev_b32 v234,16,v211
v_lshlrev_b32 v232,16,v205
M v[48:51],a[104:107],a[160:163],v[48:51]
s_add_u32 s48,s77,52224
ds_read_b128 a[176:179],v249 offset:62976
v_lshlrev_b32 v233,16,v209
M v[48:51],a[128:131],a[164:167],v[48:51]
s_waitcnt lgkmcnt(2)
ds_read_b128 a[180:183],v248 offset:62976
v_lshlrev_b32 v237,16,v207
M v[48:51],a[152:155],a[168:171],v[48:51]
s_waitcnt lgkmcnt(2)
v_lshlrev_b32 v236,16,v215
v_lshlrev_b32 v235,16,v213
M v[52:55],a[152:155],a[172:175],v[52:55]
v_fmac_f32 v232,s43,v234
v_fmac_f32 v237,4.0,v233
M v[52:55],a[128:131],a[168:171],v[52:55]
v_fma_f32 v238,-4.0,v234,v236
v_fmac_f32 v232,s45,v236
M v[52:55],a[104:107],a[164:167],v[52:55]
v_fmac_f32 v237,s41,v235
v_sub_f32 v236,v236,v234
M v[56:59],a[104:107],a[168:171],v[56:59]
buffer_load_dwordx4 a[204:207],v250,s[20:23],s48 offen offset:0 sc1
M v[56:59],a[128:131],a[172:175],v[56:59]
s_waitcnt lgkmcnt(1)
v_fma_f32 v234,-4.0,v233,v235
v_sub_f32 v235,v235,v233
M v[56:59],a[152:155],a[176:179],v[56:59]
s_waitcnt lgkmcnt(0)
buffer_load_dwordx4 a[192:195],v250,s[20:23],s48 offen offset:1024 sc1
M v[60:63],a[152:155],a[180:183],v[60:63]
v_add_f32 v233,v238,v234
v_sub_f32 v238,v238,v234
M v[60:63],a[128:131],a[176:179],v[60:63]
v_fma_f32 v234,2.0,v235,v236
v_fmac_f32 v236,-2.0,v235
M v[60:63],a[104:107],a[172:175],v[60:63]
s_waitcnt vmcnt(30)
v_and_b32 v211,s42,v211
v_and_b32 v205,s42,v205
M v[64:67],a[228:231],a[96:99],v[64:67]
s_waitcnt vmcnt(29)
buffer_load_dwordx4 a[200:203],v250,s[20:23],s48 offen offset:2048 sc1
M v[64:67],a[224:227],a[100:103],v[64:67]
s_waitcnt vmcnt(28)
v_and_b32 v209,s42,v209
v_and_b32 v207,s42,v207
M v[64:67],a[196:199],a[120:123],v[64:67]
v_and_b32 v215,s42,v215
v_and_b32 v213,s42,v213
M v[68:71],a[196:199],a[140:143],v[68:71]
v_fmac_f32 v205,s43,v211
v_fmac_f32 v207,4.0,v209
M v[68:71],a[224:227],a[120:123],v[68:71]
v_fma_f32 v235,-4.0,v211,v215
v_fmac_f32 v205,s45,v215
M v[68:71],a[228:231],a[100:103],v[68:71]
v_fmac_f32 v207,s41,v213
v_sub_f32 v215,v215,v211
M v[72:75],a[228:231],a[120:123],v[72:75]
v_fma_f32 v211,-4.0,v209,v213
v_sub_f32 v213,v213,v209
M v[72:75],a[224:227],a[140:143],v[72:75]
v_add_f32 v209,v235,v211
v_sub_f32 v235,v235,v211
M v[72:75],a[196:199],a[160:163],v[72:75]
v_fma_f32 v211,2.0,v213,v215
v_fmac_f32 v215,-2.0,v213
M v[76:79],a[196:199],a[164:167],v[76:79]
v_cvt_pk_bf16_f32 v205,v232,v205
v_cvt_pk_bf16_f32 v207,v237,v207
M v[76:79],a[224:227],a[160:163],v[76:79]
v_cvt_pk_bf16_f32 v209,v233,v209
v_cvt_pk_bf16_f32 v213,v234,v211
M v[76:79],a[228:231],a[140:143],v[76:79]
v_cvt_pk_bf16_f32 v211,v238,v235
v_cvt_pk_bf16_f32 v215,v236,v215
M v[80:83],a[228:231],a[160:163],v[80:83]
s_add_u32 s46,s72,9216
M v[80:83],a[224:227],a[164:167],v[80:83]
s_barrier
v_cvt_pk_bf16_f32 v32,v32,v33
M v[80:83],a[196:199],a[168:171],v[80:83]
ds_write2st64_b64 v247,v[204:205],v[206:207] offset0:105 offset1:122
M v[84:87],a[196:199],a[172:175],v[84:87]
s_add_u32 s28,s67,6684672
buffer_load_dwordx4 v[204:207],v251,s[88:91],s28 offen offset:0
M v[84:87],a[224:227],a[168:171],v[84:87]
ds_read_b128 a[96:99],v248 offset:0
v_cvt_pk_bf16_f32 v33,v34,v35
M v[84:87],a[228:231],a[164:167],v[84:87]
ds_write2st64_b64 v247,v[208:209],v[210:211] offset0:37 offset1:54
M v[88:91],a[228:231],a[168:171],v[88:91]
buffer_load_dwordx4 v[208:211],v245,s[8:11],s28 offen offset:0
M v[88:91],a[224:227],a[172:175],v[88:91]
ds_read_b128 a[100:103],v249 offset:0
ds_read_b128 a[120:123],v248 offset:512
M v[88:91],a[196:199],a[176:179],v[88:91]
ds_write2st64_b64 v247,v[212:213],v[214:215] offset0:71 offset1:88
M v[92:95],a[196:199],a[180:183],v[92:95]
buffer_load_dwordx4 v[212:215],v245,s[8:11],s28 offen offset:768
M v[92:95],a[224:227],a[176:179],v[92:95]
ds_read_b128 a[140:143],v249 offset:512
v_cvt_pk_bf16_f32 v36,v36,v37
M v[92:95],a[228:231],a[172:175],v[92:95]
s_waitcnt vmcnt(30) lgkmcnt(5)
v_cvt_pk_bf16_f32 v37,v38,v39
M v[160:163],a[116:119],a[96:99],v[160:163]
s_waitcnt vmcnt(29) lgkmcnt(3)
buffer_load_dwordx4 a[104:107],v250,s[20:23],s46 offen offset:0 sc1
M v[160:163],a[136:139],a[100:103],v[160:163]
s_waitcnt vmcnt(28) lgkmcnt(2)
ds_read_b128 a[96:99],v248 offset:1024
ds_read_b128 a[160:163],v249 offset:1024
M v[160:163],a[156:159],a[120:123],v[160:163]
s_waitcnt lgkmcnt(2)
ds_write2st64_b64 v254,v[32:33],v[36:37] offset0:0 offset1:4
M v[164:167],a[156:159],a[140:143],v[164:167]
buffer_load_dwordx4 a[128:131],v250,s[20:23],s46 offen offset:1024 sc1
M v[164:167],a[136:139],a[120:123],v[164:167]
v_cvt_pk_bf16_f32 v40,v40,v41
v_cvt_pk_bf16_f32 v41,v42,v43
M v[164:167],a[116:119],a[100:103],v[164:167]
v_cvt_pk_bf16_f32 v44,v44,v45
v_cvt_pk_bf16_f32 v45,v46,v47
M v[168:171],a[116:119],a[120:123],v[168:171]
ds_read_b128 a[100:103],v248 offset:1536
ds_write2st64_b64 v254,v[40:41],v[44:45] offset0:8 offset1:12
M v[168:171],a[136:139],a[140:143],v[168:171]
s_waitcnt lgkmcnt(4)
buffer_load_dwordx4 a[152:155],v250,s[20:23],s46 offen offset:2048 sc1
M v[168:171],a[156:159],a[96:99],v[168:171]
s_waitcnt lgkmcnt(3)
ds_read_b128 a[120:123],v249 offset:1536
v_cvt_pk_bf16_f32 v48,v48,v49
M v[172:175],a[156:159],a[160:163],v[172:175]
v_cvt_pk_bf16_f32 v49,v50,v51
v_cvt_pk_bf16_f32 v52,v52,v53
M v[172:175],a[136:139],a[96:99],v[172:175]
v_cvt_pk_bf16_f32 v53,v54,v55
M v[172:175],a[116:119],a[140:143],v[172:175]
ds_write2st64_b64 v254,v[48:49],v[52:53] offset0:136 offset1:140
M v[176:179],a[116:119],a[96:99],v[176:179]
s_add_u32 s47,s72,12288
ds_read_b128 a[96:99],v249 offset:2048
v_cvt_pk_bf16_f32 v56,v56,v57
M v[176:179],a[136:139],a[160:163],v[176:179]
s_waitcnt lgkmcnt(4)
ds_read_b128 a[140:143],v248 offset:2048
v_add_u32 v248,0x15400,v248
M v[176:179],a[156:159],a[100:103],v[176:179]
s_waitcnt lgkmcnt(3)
v_add_u32 v249,0x15400,v249
v_cvt_pk_bf16_f32 v57,v58,v59
M v[180:183],a[156:159],a[120:123],v[180:183]
v_cvt_pk_bf16_f32 v60,v60,v61
v_cvt_pk_bf16_f32 v61,v62,v63
M v[180:183],a[136:139],a[100:103],v[180:183]
ds_read_b128 a[164:167],v248 offset:0
ds_write2st64_b64 v254,v[56:57],v[60:61] offset0:144 offset1:148
M v[180:183],a[116:119],a[160:163],v[180:183]
ds_read_b128 a[160:163],v249 offset:0
v_cvt_pk_bf16_f32 v64,v64,v65
M v[184:187],a[116:119],a[100:103],v[184:187]
buffer_load_dwordx4 a[100:103],v250,s[20:23],s47 offen offset:0 sc1
M v[184:187],a[136:139],a[120:123],v[184:187]
s_waitcnt lgkmcnt(4)
ds_read_b128 a[168:171],v248 offset:512
ds_read_b128 a[176:179],v249 offset:512
M v[184:187],a[156:159],a[96:99],v[184:187]
s_waitcnt lgkmcnt(5)
buffer_load_dwordx4 a[172:175],v250,s[20:23],s47 offen offset:1024 sc1
M v[188:191],a[156:159],a[140:143],v[188:191]
v_cvt_pk_bf16_f32 v65,v66,v67
v_cvt_pk_bf16_f32 v68,v68,v69
M v[188:191],a[136:139],a[96:99],v[188:191]
v_cvt_pk_bf16_f32 v69,v70,v71
M v[188:191],a[116:119],a[120:123],v[188:191]
s_waitcnt vmcnt(30) lgkmcnt(4)
ds_write2st64_b64 v254,v[64:65],v[68:69] offset0:170 offset1:174
M v[160:163],a[188:191],a[164:167],v[160:163]
s_waitcnt vmcnt(29) lgkmcnt(3)
buffer_load_dwordx4 a[180:183],v250,s[20:23],s47 offen offset:2048 sc1
M v[160:163],a[236:239],a[160:163],v[160:163]
s_waitcnt vmcnt(28) lgkmcnt(2)
ds_read_b128 a[96:99],v248 offset:1024
ds_read_b128 a[116:119],v249 offset:1024
M v[160:163],a[232:235],a[168:171],v[160:163]
s_waitcnt lgkmcnt(3)
v_cvt_pk_bf16_f32 v72,v72,v73
v_cvt_pk_bf16_f32 v73,v74,v75
M v[164:167],a[232:235],a[176:179],v[164:167]
v_cvt_pk_bf16_f32 v76,v76,v77
v_cvt_pk_bf16_f32 v77,v78,v79
M v[164:167],a[236:239],a[168:171],v[164:167]
ds_write2st64_b64 v254,v[72:73],v[76:77] offset0:178 offset1:182
M v[164:167],a[188:191],a[160:163],v[164:167]
v_cvt_pk_bf16_f32 v80,v80,v81
v_cvt_pk_bf16_f32 v81,v82,v83
M v[168:171],a[188:191],a[168:171],v[168:171]
ds_read_b128 a[120:123],v248 offset:1536
v_cvt_pk_bf16_f32 v84,v84,v85
M v[168:171],a[236:239],a[176:179],v[168:171]
s_waitcnt lgkmcnt(3)
ds_read_b128 a[136:139],v249 offset:1536
v_cvt_pk_bf16_f32 v85,v86,v87
M v[168:171],a[232:235],a[96:99],v[168:171]
s_waitcnt lgkmcnt(3)
ds_write2st64_b64 v254,v[80:81],v[84:85] offset0:204 offset1:208
M v[172:175],a[232:235],a[116:119],v[172:175]
v_cvt_pk_bf16_f32 v88,v88,v89
v_cvt_pk_bf16_f32 v89,v90,v91
M v[172:175],a[236:239],a[96:99],v[172:175]
v_cvt_pk_bf16_f32 v92,v92,v93
v_cvt_pk_bf16_f32 v93,v94,v95
M v[172:175],a[188:191],a[176:179],v[172:175]
ds_write2st64_b64 v254,v[88:89],v[92:93] offset0:212 offset1:216
M v[176:179],a[188:191],a[96:99],v[176:179]
s_add_u32 s48,s72,15360
ds_read_b128 a[96:99],v249 offset:2048
M v[176:179],a[236:239],a[116:119],v[176:179]
s_waitcnt lgkmcnt(4)
ds_read_b128 a[140:143],v248 offset:2048
M v[176:179],a[232:235],a[120:123],v[176:179]
s_waitcnt lgkmcnt(2)
s_barrier
ds_read_b128 v[32:35],v250 offset:0
M v[180:183],a[232:235],a[136:139],v[180:183]
ds_read_b128 v[40:43],v250 offset:4096
ds_read_b128 v[48:51],v4 offset:0
M v[180:183],a[236:239],a[120:123],v[180:183]
ds_read_b128 v[56:59],v4 offset:4096
ds_read_b128 v[64:67],v4 offset:17408
M v[180:183],a[188:191],a[116:119],v[180:183]
ds_read_b128 v[72:75],v4 offset:21504
ds_read_b128 v[80:83],v4 offset:34816
M v[184:187],a[188:191],a[120:123],v[184:187]
ds_read_b128 v[88:91],v4 offset:38912
ds_read_b128 a[156:159],v248 offset:17408
M v[184:187],a[236:239],a[136:139],v[184:187]
s_waitcnt lgkmcnt(10)
s_add_u32 s34,s33,0
buffer_load_dwordx4 a[120:123],v250,s[20:23],s48 offen offset:0 sc1
M v[184:187],a[232:235],a[96:99],v[184:187]
s_waitcnt lgkmcnt(9)
ds_read_b128 a[116:119],v249 offset:17408
ds_read_b128 a[160:163],v248 offset:17920
M v[188:191],a[232:235],a[140:143],v[188:191]
buffer_load_dwordx4 a[164:167],v250,s[20:23],s48 offen offset:1024 sc1
M v[188:191],a[236:239],a[96:99],v[188:191]
ds_read_b128 a[168:171],v249 offset:17920
M v[188:191],a[188:191],a[136:139],v[188:191]
s_waitcnt vmcnt(28) lgkmcnt(3)
M v[160:163],a[108:111],a[156:159],v[160:163]
s_waitcnt vmcnt(27) lgkmcnt(2)
ds_read_b128 a[96:99],v248 offset:18432
M v[160:163],a[132:135],a[116:119],v[160:163]
s_waitcnt vmcnt(26) lgkmcnt(2)
buffer_load_dwordx4 a[176:179],v250,s[20:23],s48 offen offset:2048 sc1
M v[160:163],a[148:151],a[160:163],v[160:163]
s_waitcnt lgkmcnt(1)
ds_read_b128 a[136:139],v249 offset:18432
M v[164:167],a[148:151],a[168:171],v[164:167]
M v[164:167],a[132:135],a[160:163],v[164:167]
M v[164:167],a[108:111],a[116:119],v[164:167]
buffer_store_dwordx4 v[32:35],v253,s[24:27],s34 offen offset:128 nt
M v[168:171],a[108:111],a[160:163],v[168:171]
s_add_u32 s34,s33,393216
ds_read_b128 a[116:119],v248 offset:18944
M v[168:171],a[132:135],a[168:171],v[168:171]
s_waitcnt lgkmcnt(2)
ds_read_b128 a[140:143],v249 offset:18944
M v[168:171],a[148:151],a[96:99],v[168:171]
s_waitcnt lgkmcnt(2)
buffer_store_dwordx4 v[40:43],v253,s[24:27],s34 offen offset:128 nt
M v[172:175],a[148:151],a[136:139],v[172:175]
s_add_u32 s34,s33,786432
M v[172:175],a[132:135],a[96:99],v[172:175]
M v[172:175],a[108:111],a[168:171],v[172:175]
buffer_store_dwordx4 v[48:51],v253,s[24:27],s34 offen offset:128 nt
M v[176:179],a[108:111],a[96:99],v[176:179]
s_add_u32 s34,s33,1179648
ds_read_b128 a[96:99],v249 offset:19456
s_add_u32 s46,s72,18432
M v[176:179],a[132:135],a[136:139],v[176:179]
s_waitcnt lgkmcnt(2)
ds_read_b128 a[156:159],v248 offset:19456
M v[176:179],a[148:151],a[116:119],v[176:179]
s_waitcnt lgkmcnt(2)
buffer_store_dwordx4 v[56:59],v253,s[24:27],s34 offen offset:128 nt
M v[180:183],a[148:151],a[140:143],v[180:183]
s_add_u32 s34,s33,0
M v[180:183],a[132:135],a[116:119],v[180:183]
ds_read_b128 a[160:163],v248 offset:34816
M v[180:183],a[108:111],a[136:139],v[180:183]
buffer_store_dwordx4 v[64:67],v253,s[24:27],s34 offen offset:256 nt
M v[184:187],a[108:111],a[116:119],v[184:187]
s_add_u32 s34,s33,393216
ds_read_b128 a[136:139],v249 offset:34816
ds_read_b128 a[116:119],v248 offset:35328
M v[184:187],a[132:135],a[140:143],v[184:187]
s_waitcnt lgkmcnt(4)
ds_read_b128 a[216:219],v249 offset:35328
M v[184:187],a[148:151],a[96:99],v[184:187]
s_waitcnt lgkmcnt(4)
buffer_store_dwordx4 v[72:75],v253,s[24:27],s34 offen offset:256 nt
M v[188:191],a[148:151],a[156:159],v[188:191]
s_add_u32 s34,s33,786432
M v[188:191],a[132:135],a[96:99],v[188:191]
M v[188:191],a[108:111],a[140:143],v[188:191]
s_waitcnt vmcnt(28) lgkmcnt(3)
buffer_load_dwordx4 a[168:171],v250,s[20:23],s46 offen offset:0 sc1
M v[160:163],a[184:187],a[160:163],v[160:163]
s_waitcnt vmcnt(28) lgkmcnt(2)
ds_read_b128 a[96:99],v248 offset:35840
M v[160:163],v[220:223],a[136:139],v[160:163]
s_waitcnt vmcnt(27) lgkmcnt(2)
ds_read_b128 a[108:111],v249 offset:35840
M v[160:163],a[240:243],a[116:119],v[160:163]
s_waitcnt lgkmcnt(2)
M v[164:167],a[240:243],a[216:219],v[164:167]
buffer_load_dwordx4 a[188:191],v250,s[20:23],s46 offen offset:1024 sc1
M v[164:167],v[220:223],a[116:119],v[164:167]
M v[164:167],a[184:187],a[136:139],v[164:167]
M v[168:171],a[184:187],a[116:119],v[168:171]
ds_read_b128 a[116:119],v248 offset:36352
M v[168:171],v[220:223],a[216:219],v[168:171]
s_waitcnt lgkmcnt(2)
buffer_load_dwordx4 a[220:223],v250,s[20:23],s46 offen offset:2048 sc1
M v[168:171],a[240:243],a[96:99],v[168:171]
s_waitcnt lgkmcnt(1)
ds_read_b128 a[132:135],v249 offset:36352
M v[172:175],a[240:243],a[108:111],v[172:175]
M v[172:175],v[220:223],a[96:99],v[172:175]
M v[172:175],a[184:187],a[216:219],v[172:175]
buffer_store_dwordx4 v[80:83],v253,s[24:27],s34 offen offset:256 nt
M v[176:179],a[184:187],a[96:99],v[176:179]
s_add_u32 s47,s72,21504
ds_read_b128 a[96:99],v249 offset:36864
M v[176:179],v[220:223],a[108:111],v[176:179]
s_waitcnt lgkmcnt(2)
ds_read_b128 a[136:139],v248 offset:36864
M v[176:179],a[240:243],a[116:119],v[176:179]
s_waitcnt lgkmcnt(2)
s_add_u32 s34,s33,1179648
buffer_store_dwordx4 v[88:91],v253,s[24:27],s34 offen offset:256 nt
M v[180:183],a[240:243],a[132:135],v[180:183]
M v[180:183],v[220:223],a[116:119],v[180:183]
ds_read_b128 a[140:143],v248 offset:52224
M v[180:183],a[184:187],a[108:111],v[180:183]
ds_read_b128 a[108:111],v249 offset:52224
M v[184:187],a[184:187],a[116:119],v[184:187]
buffer_load_dwordx4 a[248:251],v250,s[20:23],s47 offen offset:0 sc1
M v[184:187],v[220:223],a[132:135],v[184:187]
s_waitcnt lgkmcnt(3)
ds_read_b128 a[116:119],v248 offset:52736
ds_read_b128 a[148:151],v249 offset:52736
M v[184:187],a[240:243],a[96:99],v[184:187]
s_waitcnt lgkmcnt(4)
M v[188:191],a[240:243],a[136:139],v[188:191]
buffer_load_dwordx4 a[160:163],v250,s[20:23],s47 offen offset:1024 sc1
M v[188:191],v[220:223],a[96:99],v[188:191]
M v[188:191],a[184:187],a[132:135],v[188:191]
s_waitcnt vmcnt(31) lgkmcnt(3)
M v[160:163],a[112:115],a[140:143],v[160:163]
s_waitcnt vmcnt(30) lgkmcnt(2)
ds_read_b128 a[96:99],v248 offset:53248
M v[160:163],a[124:127],a[108:111],v[160:163]
s_waitcnt vmcnt(28) lgkmcnt(2)
buffer_load_dwordx4 a[244:247],v250,s[20:23],s47 offen offset:2048 sc1
M v[160:163],a[144:147],a[116:119],v[160:163]
s_waitcnt lgkmcnt(1)
ds_read_b128 a[132:135],v249 offset:53248
M v[164:167],a[144:147],a[148:151],v[164:167]
M v[164:167],a[124:127],a[116:119],v[164:167]
M v[164:167],a[112:115],a[108:111],v[164:167]
M v[168:171],a[112:115],a[116:119],v[168:171]
ds_read_b128 a[108:111],v248 offset:53760
M v[168:171],a[124:127],a[148:151],v[168:171]
s_waitcnt lgkmcnt(2)
ds_read_b128 a[116:119],v249 offset:53760
M v[168:171],a[144:147],a[96:99],v[168:171]
s_waitcnt lgkmcnt(2)
M v[172:175],a[144:147],a[132:135],v[172:175]
M v[172:175],a[124:127],a[96:99],v[172:175]
M v[172:175],a[112:115],a[148:151],v[172:175]
M v[176:179],a[112:115],a[96:99],v[176:179]
s_add_u32 s48,s72,24576
ds_read_b128 a[96:99],v249 offset:54272
M v[176:179],a[124:127],a[132:135],v[176:179]
s_waitcnt lgkmcnt(2)
ds_read_b128 a[136:139],v248 offset:54272
v_add_u32 v248,0xfffece00,v248
M v[176:179],a[144:147],a[108:111],v[176:179]
s_waitcnt lgkmcnt(2)
v_add_u32 v249,0xfffece00,v249
M v[180:183],a[144:147],a[116:119],v[180:183]
M v[180:183],a[124:127],a[108:111],v[180:183]
ds_read_b128 a[140:143],v248 offset:60928
M v[180:183],a[112:115],a[132:135],v[180:183]
ds_read_b128 a[132:135],v249 offset:60928
M v[184:187],a[112:115],a[108:111],v[184:187]
buffer_load_dwordx4 a[252:255],v250,s[20:23],s48 offen offset:0 sc1
M v[184:187],a[124:127],a[116:119],v[184:187]
s_waitcnt lgkmcnt(3)
ds_read_b128 a[108:111],v248 offset:61440
ds_read_b128 a[148:151],v249 offset:61440
M v[184:187],a[144:147],a[96:99],v[184:187]
s_waitcnt lgkmcnt(4)
buffer_load_dwordx4 a[212:215],v250,s[20:23],s48 offen offset:1024 sc1
M v[188:191],a[144:147],a[136:139],v[188:191]
M v[188:191],a[124:127],a[96:99],v[188:191]
M v[188:191],a[112:115],a[116:119],v[188:191]
s_waitcnt vmcnt(30) lgkmcnt(3)
M v[160:163],a[204:207],a[140:143],v[160:163]
s_waitcnt vmcnt(29) lgkmcnt(2)
buffer_load_dwordx4 v[216:219],v250,s[20:23],s48 offen offset:2048 sc1
M v[160:163],a[192:195],a[132:135],v[160:163]
s_waitcnt vmcnt(29) lgkmcnt(1)
ds_read_b128 a[96:99],v248 offset:61952
ds_read_b128 a[112:115],v249 offset:61952
M v[160:163],a[200:203],a[108:111],v[160:163]
s_waitcnt lgkmcnt(2)
M v[164:167],a[200:203],a[148:151],v[164:167]
M v[164:167],a[192:195],a[108:111],v[164:167]
M v[164:167],a[204:207],a[132:135],v[164:167]
s_nop 3
v_cvt_pk_bf16_f32 v160,v160,v161
v_cvt_pk_bf16_f32 v161,v162,v163
M v[168:171],a[204:207],a[108:111],v[168:171]
ds_read_b128 a[108:111],v248 offset:62464
M v[168:171],a[192:195],a[148:151],v[168:171]
s_waitcnt lgkmcnt(2)
ds_read_b128 a[116:119],v249 offset:62464
M v[168:171],a[200:203],a[96:99],v[168:171]
s_waitcnt lgkmcnt(2)
v_cvt_pk_bf16_f32 v164,v164,v165
v_cvt_pk_bf16_f32 v165,v166,v167
M v[172:175],a[200:203],a[112:115],v[172:175]
M v[172:175],a[192:195],a[96:99],v[172:175]
ds_read_b128 a[124:127],v249 offset:62976
ds_read_b128 a[132:135],v248 offset:62976
M v[172:175],a[204:207],a[148:151],v[172:175]
M v[176:179],a[204:207],a[96:99],v[176:179]
s_add_u32 s46,s72,27648
M v[176:179],a[192:195],a[112:115],v[176:179]
s_waitcnt lgkmcnt(3)
M v[176:179],a[200:203],a[108:111],v[176:179]
s_waitcnt lgkmcnt(0)
s_barrier
ds_write2st64_b64 v254,v[160:161],v[164:165] offset0:221 offset1:225
M v[180:183],a[200:203],a[116:119],v[180:183]
v_cvt_pk_bf16_f32 v168,v168,v169
v_cvt_pk_bf16_f32 v169,v170,v171
M v[180:183],a[192:195],a[108:111],v[180:183]
ds_read_b128 a[96:99],v248 offset:0
v_cvt_pk_bf16_f32 v172,v172,v173
M v[180:183],a[204:207],a[112:115],v[180:183]
ds_read_b128 a[112:115],v249 offset:0
v_cvt_pk_bf16_f32 v173,v174,v175
M v[184:187],a[204:207],a[108:111],v[184:187]
buffer_load_dwordx4 v[224:227],v250,s[20:23],s46 offen offset:0 sc1
M v[184:187],a[192:195],a[116:119],v[184:187]
ds_read_b128 a[108:111],v248 offset:512
ds_read_b128 a[136:139],v249 offset:512
M v[184:187],a[200:203],a[124:127],v[184:187]
ds_write2st64_b64 v254,v[168:169],v[172:173] offset0:229 offset1:233
M v[188:191],a[200:203],a[132:135],v[188:191]
v_cvt_pk_bf16_f32 v176,v176,v177
v_cvt_pk_bf16_f32 v177,v178,v179
M v[188:191],a[192:195],a[124:127],v[188:191]
v_cvt_pk_bf16_f32 v180,v180,v181
v_cvt_pk_bf16_f32 v181,v182,v183
M v[188:191],a[204:207],a[116:119],v[188:191]
s_waitcnt vmcnt(26) lgkmcnt(4)
ds_write2st64_b64 v254,v[176:177],v[180:181] offset0:238 offset1:242
M a[0:3],a[104:107],a[96:99],0
s_waitcnt vmcnt(25) lgkmcnt(4)
ds_read_b128 a[116:119],v248 offset:1024
v_cvt_pk_bf16_f32 v184,v184,v185
M a[0:3],a[128:131],a[112:115],a[0:3]
s_waitcnt vmcnt(24) lgkmcnt(4)
ds_read_b128 a[124:127],v249 offset:1024
v_cvt_pk_bf16_f32 v185,v186,v187
M a[0:3],a[152:155],a[108:111],a[0:3]
s_waitcnt lgkmcnt(4)
v_cvt_pk_bf16_f32 v188,v188,v189
v_cvt_pk_bf16_f32 v189,v190,v191
M a[4:7],a[152:155],a[136:139],0
ds_write2st64_b64 v254,v[184:185],v[188:189] offset0:246 offset1:250
M a[4:7],a[128:131],a[108:111],a[4:7]
v_permlane32_swap_b32 v196,v198
v_permlane32_swap_b32 v192,v194
M a[4:7],a[104:107],a[112:115],a[4:7]
v_permlane32_swap_b32 v200,v202
v_lshlrev_b32 v234,16,v198
M a[8:11],a[104:107],a[108:111],0
ds_read_b128 a[132:135],v248 offset:1536
v_lshlrev_b32 v232,16,v192
M a[8:11],a[128:131],a[136:139],a[8:11]
s_waitcnt lgkmcnt(3)
ds_read_b128 a[140:143],v249 offset:1536
v_lshlrev_b32 v233,16,v196
M a[8:11],a[152:155],a[116:119],a[8:11]
s_waitcnt lgkmcnt(3)
v_lshlrev_b32 v237,16,v194
v_lshlrev_b32 v236,16,v202
M a[12:15],a[152:155],a[124:127],0
v_lshlrev_b32 v235,16,v200
v_fmac_f32 v232,s43,v234
M a[12:15],a[128:131],a[116:119],a[12:15]
s_waitcnt lgkmcnt(2)
s_barrier
ds_read_b128 v[160:163],v4 offset:43520
M a[12:15],a[104:107],a[136:139],a[12:15]
ds_read_b128 v[168:171],v4 offset:47616
ds_read_b128 v[176:179],v4 offset:52224
M a[16:19],a[104:107],a[116:119],0
ds_read_b128 v[184:187],v4 offset:56320
ds_read_b128 a[144:147],v249 offset:2048
M a[16:19],a[128:131],a[124:127],a[16:19]
s_waitcnt lgkmcnt(6)
ds_read_b128 a[148:151],v248 offset:2048
v_fmac_f32 v237,4.0,v233
M a[16:19],a[152:155],a[132:135],a[16:19]
s_waitcnt lgkmcnt(6)
v_fma_f32 v238,-4.0,v234,v236
v_fmac_f32 v232,s45,v236
M a[20:23],a[152:155],a[140:143],0
s_add_u32 s34,s33,0
v_fmac_f32 v237,s41,v235
v_sub_f32 v236,v236,v234
M a[20:23],a[128:131],a[132:135],a[20:23]
v_fma_f32 v234,-4.0,v233,v235
v_sub_f32 v235,v235,v233
M a[20:23],a[104:107],a[124:127],a[20:23]
s_waitcnt lgkmcnt(5)
buffer_store_dwordx4 v[160:163],v253,s[24:27],s34 offen offset:1408 nt
M a[24:27],a[104:107],a[132:135],0
s_add_u32 s34,s33,393216
v_add_f32 v233,v238,v234
v_sub_f32 v238,v238,v234
M a[24:27],a[128:131],a[140:143],a[24:27]
s_waitcnt lgkmcnt(1)
v_fma_f32 v234,2.0,v235,v236
v_fmac_f32 v236,-2.0,v235
M a[24:27],a[152:155],a[144:147],a[24:27]
s_waitcnt lgkmcnt(0)
buffer_store_dwordx4 v[168:171],v253,s[24:27],s34 offen offset:1408 nt
M a[28:31],a[152:155],a[148:151],0
s_add_u32 s34,s33,786432
v_and_b32 v198,s42,v198
v_and_b32 v192,s42,v192
M a[28:31],a[128:131],a[144:147],a[28:31]
v_and_b32 v196,s42,v196
v_and_b32 v194,s42,v194
M a[28:31],a[104:107],a[140:143],a[28:31]
s_waitcnt vmcnt(25)
buffer_store_dwordx4 v[176:179],v253,s[24:27],s34 offen offset:1408 nt
M a[32:35],a[100:103],a[96:99],0
s_waitcnt vmcnt(25)
s_add_u32 s34,s33,1179648
v_and_b32 v202,s42,v202
v_and_b32 v200,s42,v200
M a[32:35],a[172:175],a[112:115],a[32:35]
s_waitcnt vmcnt(24)
v_fmac_f32 v192,s43,v198
v_fmac_f32 v194,4.0,v196
M a[32:35],a[180:183],a[108:111],a[32:35]
buffer_store_dwordx4 v[184:187],v253,s[24:27],s34 offen offset:1408 nt
M a[36:39],a[180:183],a[136:139],0
v_fma_f32 v235,-4.0,v198,v202
v_fmac_f32 v192,s45,v202
M a[36:39],a[172:175],a[108:111],a[36:39]
v_fmac_f32 v194,s41,v200
v_sub_f32 v202,v202,v198
M a[36:39],a[100:103],a[112:115],a[36:39]
v_fma_f32 v198,-4.0,v196,v200
v_sub_f32 v200,v200,v196
M a[40:43],a[100:103],a[108:111],0
v_add_f32 v196,v235,v198
v_sub_f32 v235,v235,v198
M a[40:43],a[172:175],a[136:139],a[40:43]
v_fma_f32 v198,2.0,v200,v202
v_fmac_f32 v202,-2.0,v200
M a[40:43],a[180:183],a[116:119],a[40:43]
v_cvt_pk_bf16_f32 v192,v232,v192
v_cvt_pk_bf16_f32 v194,v237,v194
M a[44:47],a[180:183],a[124:127],0
v_cvt_pk_bf16_f32 v196,v233,v196
v_cvt_pk_bf16_f32 v200,v234,v198
M a[44:47],a[172:175],a[116:119],a[44:47]
v_cvt_pk_bf16_f32 v198,v238,v235
v_cvt_pk_bf16_f32 v202,v236,v202
M a[44:47],a[100:103],a[136:139],a[44:47]
v_permlane32_swap_b32 v197,v199
v_permlane32_swap_b32 v193,v195
M a[48:51],a[100:103],a[116:119],0
v_permlane32_swap_b32 v201,v203
v_lshlrev_b32 v234,16,v199
M a[48:51],a[172:175],a[124:127],a[48:51]
v_lshlrev_b32 v232,16,v193
v_lshlrev_b32 v233,16,v197
M a[48:51],a[180:183],a[132:135],a[48:51]
v_lshlrev_b32 v237,16,v195
v_lshlrev_b32 v236,16,v203
M a[52:55],a[180:183],a[140:143],0
v_lshlrev_b32 v235,16,v201
v_fmac_f32 v232,s43,v234
M a[52:55],a[172:175],a[132:135],a[52:55]
v_fmac_f32 v237,4.0,v233
v_fma_f32 v238,-4.0,v234,v236
M a[52:55],a[100:103],a[124:127],a[52:55]
v_fmac_f32 v232,s45,v236
v_fmac_f32 v237,s41,v235
M a[56:59],a[100:103],a[132:135],0
v_sub_f32 v236,v236,v234
v_fma_f32 v234,-4.0,v233,v235
M a[56:59],a[172:175],a[140:143],a[56:59]
v_sub_f32 v235,v235,v233
v_add_f32 v233,v238,v234
M a[56:59],a[180:183],a[144:147],a[56:59]
v_sub_f32 v238,v238,v234
v_fma_f32 v234,2.0,v235,v236
M a[60:63],a[180:183],a[148:151],0
v_fmac_f32 v236,-2.0,v235
v_and_b32 v199,s42,v199
M a[60:63],a[172:175],a[144:147],a[60:63]
v_and_b32 v193,s42,v193
v_and_b32 v197,s42,v197
M a[60:63],a[100:103],a[140:143],a[60:63]
s_waitcnt vmcnt(24)
v_and_b32 v195,s42,v195
v_and_b32 v203,s42,v203
M a[64:67],a[120:123],a[96:99],0
s_waitcnt vmcnt(23)
v_and_b32 v201,s42,v201
v_fmac_f32 v193,s43,v199
M a[64:67],a[164:167],a[112:115],a[64:67]
s_waitcnt vmcnt(22)
v_fmac_f32 v195,4.0,v197
v_fma_f32 v235,-4.0,v199,v203
M a[64:67],a[176:179],a[108:111],a[64:67]
v_fmac_f32 v193,s45,v203
v_fmac_f32 v195,s41,v201
M a[68:71],a[176:179],a[136:139],0
v_sub_f32 v203,v203,v199
v_fma_f32 v199,-4.0,v197,v201
M a[68:71],a[164:167],a[108:111],a[68:71]
v_sub_f32 v201,v201,v197
v_add_f32 v197,v235,v199
M a[68:71],a[120:123],a[112:115],a[68:71]
v_sub_f32 v235,v235,v199
v_fma_f32 v199,2.0,v201,v203
M a[72:75],a[120:123],a[108:111],0
v_fmac_f32 v203,-2.0,v201
v_cvt_pk_bf16_f32 v193,v232,v193
M a[72:75],a[164:167],a[136:139],a[72:75]
v_cvt_pk_bf16_f32 v195,v237,v195
v_cvt_pk_bf16_f32 v197,v233,v197
M a[72:75],a[176:179],a[116:119],a[72:75]
v_cvt_pk_bf16_f32 v201,v234,v199
v_cvt_pk_bf16_f32 v199,v238,v235
M a[76:79],a[176:179],a[124:127],0
v_cvt_pk_bf16_f32 v203,v236,v203
v_permlane32_swap_b32 v208,v210
M a[76:79],a[164:167],a[116:119],a[76:79]
v_permlane32_swap_b32 v204,v206
v_permlane32_swap_b32 v212,v214
M a[76:79],a[120:123],a[136:139],a[76:79]
ds_write2st64_b64 v247,v[192:193],v[194:195] offset0:170 offset1:187
M a[80:83],a[120:123],a[116:119],0
s_add_u32 s28,s67,7077888
buffer_load_dwordx4 v[192:195],v251,s[88:91],s28 offen offset:0
M a[80:83],a[164:167],a[124:127],a[80:83]
v_lshlrev_b32 v234,16,v210
v_lshlrev_b32 v232,16,v204
M a[80:83],a[176:179],a[132:135],a[80:83]
ds_write2st64_b64 v247,v[196:197],v[198:199] offset0:0 offset1:17
M a[84:87],a[176:179],a[140:143],0
buffer_load_dwordx4 v[196:199],v245,s[8:11],s28 offen offset:0
M a[84:87],a[164:167],a[132:135],a[84:87]
ds_read_b128 a[172:175],v248 offset:8704
v_lshlrev_b32 v233,16,v208
M a[84:87],a[120:123],a[124:127],a[84:87]
ds_write2st64_b64 v247,v[200:201],v[202:203] offset0:136 offset1:153
M a[88:91],a[120:123],a[132:135],0
buffer_load_dwordx4 v[200:203],v245,s[8:11],s28 offen offset:768
M a[88:91],a[164:167],a[140:143],a[88:91]
ds_read_b128 a[180:183],v249 offset:8704
ds_read_b128 a[184:187],v248 offset:9216
M a[88:91],a[176:179],a[144:147],a[88:91]
ds_read_b128 v[228:231],v249 offset:9216
v_lshlrev_b32 v237,16,v206
M a[92:95],a[176:179],a[148:151],0
v_lshlrev_b32 v236,16,v214
v_lshlrev_b32 v235,16,v212
M a[92:95],a[164:167],a[144:147],a[92:95]
v_fmac_f32 v232,s43,v234
v_fmac_f32 v237,4.0,v233
M a[92:95],a[120:123],a[140:143],a[92:95]
s_waitcnt vmcnt(18) lgkmcnt(4)
v_fma_f32 v238,-4.0,v234,v236
v_fmac_f32 v232,s45,v236
M a[96:99],a[168:171],a[172:175],0
s_waitcnt vmcnt(17) lgkmcnt(2)
ds_read_b128 a[208:211],v248 offset:9728
v_fmac_f32 v237,s41,v235
M a[96:99],a[188:191],a[180:183],a[96:99]
s_waitcnt vmcnt(16) lgkmcnt(2)
ds_read_b128 a[196:199],v249 offset:9728
v_sub_f32 v236,v236,v234
M a[96:99],a[220:223],a[184:187],a[96:99]
s_waitcnt lgkmcnt(2)
v_fma_f32 v234,-4.0,v233,v235
v_sub_f32 v235,v235,v233
M a[100:103],a[220:223],v[228:231],0
v_add_f32 v233,v238,v234
v_sub_f32 v238,v238,v234
M a[100:103],a[188:191],a[184:187],a[100:103]
v_fma_f32 v234,2.0,v235,v236
v_fmac_f32 v236,-2.0,v235
M a[100:103],a[168:171],a[180:183],a[100:103]
v_and_b32 v210,s42,v210
v_and_b32 v204,s42,v204
M a[104:107],a[168:171],a[184:187],0
ds_read_b128 a[224:227],v248 offset:10240
v_and_b32 v208,s42,v208
M a[104:107],a[188:191],v[228:231],a[104:107]
s_waitcnt lgkmcnt(2)
ds_read_b128 a[228:231],v249 offset:10240
v_and_b32 v206,s42,v206
M a[104:107],a[220:223],a[208:211],a[104:107]
s_waitcnt lgkmcnt(2)
v_and_b32 v214,s42,v214
v_and_b32 v212,s42,v212
M a[108:111],a[220:223],a[196:199],0
v_fmac_f32 v204,s43,v210
v_fmac_f32 v206,4.0,v208
M a[108:111],a[188:191],a[208:211],a[108:111]
v_fma_f32 v235,-4.0,v210,v214
v_fmac_f32 v204,s45,v214
M a[108:111],a[168:171],v[228:231],a[108:111]
v_fmac_f32 v206,s41,v212
v_sub_f32 v214,v214,v210
M a[112:115],a[168:171],a[208:211],0
ds_read_b128 a[232:235],v249 offset:10752
v_fma_f32 v210,-4.0,v208,v212
M a[112:115],a[188:191],a[196:199],a[112:115]
s_waitcnt lgkmcnt(2)
ds_read_b128 a[236:239],v248 offset:10752
v_sub_f32 v212,v212,v208
M a[112:115],a[220:223],a[224:227],a[112:115]
s_waitcnt lgkmcnt(2)
v_add_f32 v208,v235,v210
v_sub_f32 v235,v235,v210
M a[116:119],a[220:223],a[228:231],0
v_fma_f32 v210,2.0,v212,v214
v_fmac_f32 v214,-2.0,v212
M a[116:119],a[188:191],a[224:227],a[116:119]
v_cvt_pk_bf16_f32 v204,v232,v204
v_cvt_pk_bf16_f32 v206,v237,v206
M a[116:119],a[168:171],a[196:199],a[116:119]
s_add_u32 s31,s73,s85
v_cvt_pk_bf16_f32 v208,v233,v208
v_cvt_pk_bf16_f32 v212,v234,v210
M a[120:123],a[168:171],a[224:227],0
v_cvt_pk_bf16_f32 v210,v238,v235
v_cvt_pk_bf16_f32 v214,v236,v214
M a[120:123],a[188:191],a[228:231],a[120:123]
s_waitcnt lgkmcnt(1)
v_permlane32_swap_b32 v209,v211
v_permlane32_swap_b32 v205,v207
M a[120:123],a[220:223],a[232:235],a[120:123]
s_waitcnt lgkmcnt(0)
v_permlane32_swap_b32 v213,v215
v_lshlrev_b32 v234,16,v211
M a[124:127],a[220:223],a[236:239],0
buffer_load_dword a216,v250,s[20:23],s31 offen offset:0 sc1
M a[124:127],a[188:191],a[232:235],a[124:127]
v_lshlrev_b32 v232,16,v205
v_lshlrev_b32 v233,16,v209
M a[124:127],a[168:171],a[228:231],a[124:127]
s_waitcnt vmcnt(14)
buffer_load_dword a216,v250,s[20:23],s31 offen offset:128 sc1
M a[128:131],a[248:251],a[172:175],0
s_waitcnt vmcnt(14)
v_lshlrev_b32 v237,16,v207
v_lshlrev_b32 v236,16,v215
M a[128:131],a[160:163],a[180:183],a[128:131]
s_waitcnt vmcnt(13)
v_lshlrev_b32 v235,16,v213
v_fmac_f32 v232,s43,v234
M a[128:131],a[244:247],a[184:187],a[128:131]
v_fmac_f32 v237,4.0,v233
v_fma_f32 v238,-4.0,v234,v236
M a[132:135],a[244:247],v[228:231],0
buffer_load_dwordx4 a[216:219],v250,s[20:23],s46 offen offset:1024 sc1
M a[132:135],a[160:163],a[184:187],a[132:135]
v_fmac_f32 v232,s45,v236
v_fmac_f32 v237,s41,v235
M a[132:135],a[248:251],a[180:183],a[132:135]
v_sub_f32 v236,v236,v234
v_fma_f32 v234,-4.0,v233,v235
M a[136:139],a[248:251],a[184:187],0
v_sub_f32 v235,v235,v233
v_add_f32 v233,v238,v234
M a[136:139],a[160:163],v[228:231],a[136:139]
buffer_load_dwordx4 a[240:243],v250,s[20:23],s46 offen offset:2048 sc1
M a[136:139],a[244:247],a[208:211],a[136:139]
s_add_u32 s47,s72,30720
v_sub_f32 v238,v238,v234
v_fma_f32 v234,2.0,v235,v236
M a[140:143],a[244:247],a[196:199],0
v_fmac_f32 v236,-2.0,v235
v_and_b32 v211,s42,v211
M a[140:143],a[160:163],a[208:211],a[140:143]
v_and_b32 v205,s42,v205
v_and_b32 v209,s42,v209
M a[140:143],a[248:251],v[228:231],a[140:143]
buffer_load_dwordx4 v[220:223],v250,s[20:23],s47 offen offset:0 sc1
M a[144:147],a[248:251],a[208:211],0
v_and_b32 v207,s42,v207
v_and_b32 v215,s42,v215
M a[144:147],a[160:163],a[196:199],a[144:147]
v_and_b32 v213,s42,v213
v_fmac_f32 v205,s43,v211
M a[144:147],a[244:247],a[224:227],a[144:147]
v_fmac_f32 v207,4.0,v209
v_fma_f32 v235,-4.0,v211,v215
M a[148:151],a[244:247],a[228:231],0
v_fmac_f32 v205,s45,v215
v_fmac_f32 v207,s41,v213
M a[148:151],a[160:163],a[224:227],a[148:151]
v_sub_f32 v215,v215,v211
v_fma_f32 v211,-4.0,v209,v213
M a[148:151],a[248:251],a[196:199],a[148:151]
v_sub_f32 v213,v213,v209
v_add_f32 v209,v235,v211
M a[152:155],a[248:251],a[224:227],0
v_sub_f32 v235,v235,v211
v_fma_f32 v211,2.0,v213,v215
M a[152:155],a[160:163],a[228:231],a[152:155]
v_fmac_f32 v215,-2.0,v213
v_cvt_pk_bf16_f32 v205,v232,v205
M a[152:155],a[244:247],a[232:235],a[152:155]
v_cvt_pk_bf16_f32 v207,v237,v207
v_cvt_pk_bf16_f32 v209,v233,v209
M a[156:159],a[244:247],a[236:239],0
buffer_load_dwordx4 a[200:203],v250,s[20:23],s47 offen offset:1024 sc1
M a[156:159],a[160:163],a[232:235],a[156:159]
v_cvt_pk_bf16_f32 v213,v234,v211
v_cvt_pk_bf16_f32 v211,v238,v235
M a[156:159],a[248:251],a[228:231],a[156:159]
s_waitcnt vmcnt(16)
buffer_load_dwordx4 a[192:195],v250,s[20:23],s47 offen offset:2048 sc1
M a[160:163],a[252:255],a[172:175],0
s_waitcnt vmcnt(16)
s_add_u32 s48,s72,33792
v_cvt_pk_bf16_f32 v215,v236,v215
v_fmac_f32 v239,s43,v241
M a[160:163],a[212:215],a[180:183],a[160:163]
s_waitcnt vmcnt(15)
v_fmac_f32 v244,4.0,v240
v_fma_f32 v232,-4.0,v241,v243
M a[160:163],v[216:219],a[184:187],a[160:163]
ds_write2st64_b64 v247,v[204:205],v[206:207] offset0:171 offset1:188
M a[164:167],v[216:219],v[228:231],0
s_add_u32 s28,s67,7471104
buffer_load_dwordx4 a[204:207],v250,s[20:23],s48 offen offset:0 sc1
M a[164:167],a[212:215],a[184:187],a[164:167]
v_fmac_f32 v239,s45,v243
v_fmac_f32 v244,s41,v242
M a[164:167],a[252:255],a[180:183],a[164:167]
ds_write2st64_b64 v247,v[208:209],v[210:211] offset0:1 offset1:18
M a[168:171],a[252:255],a[184:187],0
buffer_load_dwordx4 a[220:223],v250,s[20:23],s48 offen offset:1024 sc1
M a[168:171],a[212:215],v[228:231],a[168:171]
v_sub_f32 v243,v243,v241
v_fma_f32 v241,-4.0,v240,v242
M a[168:171],v[216:219],a[208:211],a[168:171]
ds_write2st64_b64 v247,v[212:213],v[214:215] offset0:137 offset1:154
M a[172:175],v[216:219],a[196:199],0
buffer_load_dwordx4 a[244:247],v250,s[20:23],s48 offen offset:2048 sc1
M a[172:175],a[212:215],a[208:211],a[172:175]
s_add_u32 s46,s72,36864
v_sub_f32 v242,v242,v240
v_add_f32 v240,v232,v241
M a[172:175],a[252:255],v[228:231],a[172:175]
v_sub_f32 v232,v232,v241
v_fma_f32 v241,2.0,v242,v243
M a[176:179],a[252:255],a[208:211],0
v_fmac_f32 v243,-2.0,v242
v_cvt_pk_bf16_f32 v233,v239,v244
M a[176:179],a[212:215],a[196:199],a[176:179]
buffer_load_dwordx4 a[248:251],v250,s[20:23],s46 offen offset:0 sc1
M a[176:179],v[216:219],a[224:227],a[176:179]
v_cvt_pk_bf16_f32 v234,v240,v232
v_cvt_pk_bf16_f32 v235,v241,v243
M a[180:183],v[216:219],a[228:231],0
v_add_u32 v232,87040,v252
M a[180:183],a[212:215],a[224:227],a[180:183]
ds_read_b128 v[228:231],v248 offset:17408
ds_write_b16 v232,v233 offset:0
M a[180:183],a[252:255],a[196:199],a[180:183]
buffer_load_dwordx4 v[204:207],v251,s[88:91],s28 offen offset:0
M a[184:187],a[252:255],a[224:227],0
ds_read_b128 a[208:211],v249 offset:17408
ds_read_b128 a[196:199],v248 offset:17920
M a[184:187],a[212:215],a[228:231],a[184:187]
ds_read_b128 a[224:227],v249 offset:17920
ds_write_b16_d16_hi v232,v233 offset:8704
M a[184:187],v[216:219],a[232:235],a[184:187]
ds_write_b16 v252,v234 offset:0
M a[188:191],v[216:219],a[236:239],0
buffer_load_dwordx4 v[208:211],v245,s[8:11],s28 offen offset:0
M a[188:191],a[212:215],a[232:235],a[188:191]
ds_write_b16_d16_hi v252,v234 offset:8704
M a[188:191],a[252:255],a[228:231],a[188:191]
s_waitcnt vmcnt(20) lgkmcnt(7)
v_add_u32 v232,69632,v252
M v[0:3],v[224:227],v[228:231],0
s_waitcnt vmcnt(10) lgkmcnt(5)
ds_read_b128 a[236:239],v248 offset:18432
ds_write_b16 v232,v235 offset:0
M v[0:3],a[216:219],a[208:211],v[0:3]
s_waitcnt vmcnt(9) lgkmcnt(6)
buffer_load_dwordx4 v[212:215],v245,s[8:11],s28 offen offset:768
M v[0:3],a[240:243],a[196:199],v[0:3]
s_waitcnt lgkmcnt(5)
s_add_u32 s29,s68,6291456
ds_read_b128 v[216:219],v249 offset:18432
ds_write_b16_d16_hi v232,v235 offset:8704
M v[4:7],a[240:243],a[224:227],0
v_permlane32_swap_b32 v196,v198
v_permlane32_swap_b32 v192,v194
M v[4:7],a[216:219],a[196:199],v[4:7]
buffer_load_short_d16_hi v239,v246,s[12:15],s29 offen offset:0
M v[4:7],v[224:227],a[208:211],v[4:7]
v_permlane32_swap_b32 v200,v202
v_lshlrev_b32 v234,16,v198
M v[8:11],v[224:227],a[196:199],0
buffer_load_short_d16_hi v240,v246,s[8:11],s29 offen offset:0
M v[8:11],a[216:219],a[224:227],v[8:11]
s_waitcnt lgkmcnt(3)
ds_read_b128 a[212:215],v248 offset:18944
ds_read_b128 a[232:235],v249 offset:18944
M v[8:11],a[240:243],a[236:239],v[8:11]
s_waitcnt lgkmcnt(3)
buffer_load_short_d16_hi v241,v246,s[8:11],s29 offen offset:384
M v[12:15],a[240:243],v[216:219],0
v_lshlrev_b32 v232,16,v192
v_lshlrev_b32 v233,16,v196
M v[12:15],a[216:219],a[236:239],v[12:15]
buffer_load_short_d16_hi v242,v246,s[8:11],s29 offen offset:768
M v[12:15],v[224:227],a[224:227],v[12:15]
v_lshlrev_b32 v237,16,v194
v_lshlrev_b32 v236,16,v202
M v[16:19],v[224:227],a[236:239],0
buffer_load_short_d16_hi v243,v246,s[8:11],s29 offen offset:1152
M v[16:19],a[216:219],v[216:219],v[16:19]
s_waitcnt lgkmcnt(1)
ds_read_b128 a[228:231],v249 offset:19456
ds_read_b128 a[252:255],v248 offset:19456
M v[16:19],a[240:243],a[212:215],v[16:19]
s_waitcnt lgkmcnt(2)
buffer_load_short_d16_hi v244,v246,s[16:19],s29 offen offset:1536
M v[20:23],a[240:243],a[232:235],0
v_lshlrev_b32 v235,16,v200
v_fmac_f32 v232,s43,v234
M v[20:23],a[216:219],a[212:215],v[20:23]
v_fmac_f32 v237,4.0,v233
v_fma_f32 v238,-4.0,v234,v236
M v[20:23],v[224:227],v[216:219],v[20:23]
v_fmac_f32 v232,s45,v236
v_fmac_f32 v237,s41,v235
M v[24:27],v[224:227],a[212:215],0
v_sub_f32 v236,v236,v234
v_fma_f32 v234,-4.0,v233,v235
M v[24:27],a[216:219],a[232:235],v[24:27]
s_waitcnt lgkmcnt(1)
v_sub_f32 v235,v235,v233
v_add_f32 v233,v238,v234
M v[24:27],a[240:243],a[228:231],v[24:27]
s_waitcnt lgkmcnt(0)
v_sub_f32 v238,v238,v234
v_fma_f32 v234,2.0,v235,v236
M v[28:31],a[240:243],a[252:255],0
global_load_dword a240,v250,s[64:65]
M v[28:31],a[216:219],a[228:231],v[28:31]
buffer_load_dwordx4 a[240:243],v250,s[20:23],s46 offen offset:1024 sc1
M v[28:31],v[224:227],a[232:235],v[28:31]
s_waitcnt vmcnt(17)
v_fmac_f32 v236,-2.0,v235
v_and_b32 v198,s42,v198
M v[32:35],v[220:223],v[228:231],0
s_waitcnt vmcnt(16)
v_and_b32 v192,s42,v192
v_and_b32 v196,s42,v196
M v[32:35],a[200:203],a[208:211],v[32:35]
s_waitcnt vmcnt(15)
buffer_load_dwordx4 a[216:219],v250,s[20:23],s46 offen offset:2048 sc1
M v[32:35],a[192:195],a[196:199],v[32:35]
s_add_u32 s47,s72,39936
v_and_b32 v194,s42,v194
v_and_b32 v202,s42,v202
M v[36:39],a[192:195],a[224:227],0
v_and_b32 v200,s42,v200
v_fmac_f32 v192,s43,v198
M v[36:39],a[200:203],a[196:199],v[36:39]
v_fmac_f32 v194,4.0,v196
v_fma_f32 v235,-4.0,v198,v202
M v[36:39],v[220:223],a[208:211],v[36:39]
buffer_load_dwordx4 v[224:227],v250,s[20:23],s47 offen offset:0 sc1
M v[40:43],v[220:223],a[196:199],0
v_fmac_f32 v192,s45,v202
v_fmac_f32 v194,s41,v200
M v[40:43],a[200:203],a[224:227],v[40:43]
v_sub_f32 v202,v202,v198
v_fma_f32 v198,-4.0,v196,v200
M v[40:43],a[192:195],a[236:239],v[40:43]
v_sub_f32 v200,v200,v196
v_add_f32 v196,v235,v198
M v[44:47],a[192:195],v[216:219],0
v_sub_f32 v235,v235,v198
v_fma_f32 v198,2.0,v200,v202
M v[44:47],a[200:203],a[236:239],v[44:47]
v_fmac_f32 v202,-2.0,v200
v_cvt_pk_bf16_f32 v192,v232,v192
M v[44:47],v[220:223],a[224:227],v[44:47]
v_cvt_pk_bf16_f32 v194,v237,v194
v_cvt_pk_bf16_f32 v196,v233,v196
M v[48:51],v[220:223],a[236:239],0
v_cvt_pk_bf16_f32 v200,v234,v198
v_cvt_pk_bf16_f32 v198,v238,v235
M v[48:51],a[200:203],v[216:219],v[48:51]
v_cvt_pk_bf16_f32 v202,v236,v202
v_permlane32_swap_b32 v197,v199
M v[48:51],a[192:195],a[212:215],v[48:51]
v_permlane32_swap_b32 v193,v195
v_permlane32_swap_b32 v201,v203
M v[52:55],a[192:195],a[232:235],0
v_lshlrev_b32 v234,16,v199
v_lshlrev_b32 v232,16,v193
M v[52:55],a[200:203],a[212:215],v[52:55]
v_lshlrev_b32 v233,16,v197
v_lshlrev_b32 v237,16,v195
M v[52:55],v[220:223],v[216:219],v[52:55]
v_lshlrev_b32 v236,16,v203
v_lshlrev_b32 v235,16,v201
M v[56:59],v[220:223],a[212:215],0
v_fmac_f32 v232,s43,v234
v_fmac_f32 v237,4.0,v233
M v[56:59],a[200:203],a[232:235],v[56:59]
v_fma_f32 v238,-4.0,v234,v236
v_fmac_f32 v232,s45,v236
M v[56:59],a[192:195],a[228:231],v[56:59]
v_fmac_f32 v237,s41,v235
v_sub_f32 v236,v236,v234
M v[60:63],a[192:195],a[252:255],0
buffer_load_dwordx4 a[192:195],v250,s[20:23],s47 offen offset:1024 sc1
M v[60:63],a[200:203],a[228:231],v[60:63]
v_fma_f32 v234,-4.0,v233,v235
v_sub_f32 v235,v235,v233
M v[60:63],v[220:223],a[232:235],v[60:63]
s_waitcnt vmcnt(17)
buffer_load_dwordx4 a[200:203],v250,s[20:23],s47 offen offset:2048 sc1
M v[64:67],a[204:207],v[228:231],0
s_waitcnt vmcnt(17)
s_add_u32 s48,s72,43008
v_add_f32 v233,v238,v234
v_sub_f32 v238,v238,v234
M v[64:67],a[220:223],a[208:211],v[64:67]
s_waitcnt vmcnt(16)
v_fma_f32 v234,2.0,v235,v236
v_fmac_f32 v236,-2.0,v235
M v[64:67],a[244:247],a[196:199],v[64:67]
v_and_b32 v199,s42,v199
v_and_b32 v193,s42,v193
M v[68:71],a[244:247],a[224:227],0
buffer_load_dwordx4 v[220:223],v250,s[20:23],s48 offen offset:0 sc1
M v[68:71],a[220:223],a[196:199],v[68:71]
v_and_b32 v197,s42,v197
v_and_b32 v195,s42,v195
M v[68:71],a[204:207],a[208:211],v[68:71]
v_and_b32 v203,s42,v203
v_and_b32 v201,s42,v201
M v[72:75],a[204:207],a[196:199],0
v_fmac_f32 v193,s43,v199
v_fmac_f32 v195,4.0,v197
M v[72:75],a[220:223],a[224:227],v[72:75]
buffer_load_dwordx4 v[228:231],v250,s[20:23],s48 offen offset:1024 sc1
M v[72:75],a[244:247],a[236:239],v[72:75]
v_fma_f32 v235,-4.0,v199,v203
v_fmac_f32 v193,s45,v203
M v[76:79],a[244:247],v[216:219],0
v_fmac_f32 v195,s41,v201
v_sub_f32 v203,v203,v199
M v[76:79],a[220:223],a[236:239],v[76:79]
v_fma_f32 v199,-4.0,v197,v201
v_sub_f32 v201,v201,v197
M v[76:79],a[204:207],a[224:227],v[76:79]
buffer_load_dwordx4 a[208:211],v250,s[20:23],s48 offen offset:2048 sc1
M v[80:83],a[204:207],a[236:239],0
s_add_u32 s46,s73,9216
v_add_f32 v197,v235,v199
v_sub_f32 v235,v235,v199
M v[80:83],a[220:223],v[216:219],v[80:83]
v_fma_f32 v199,2.0,v201,v203
v_fmac_f32 v203,-2.0,v201
M v[80:83],a[244:247],a[212:215],v[80:83]
v_cvt_pk_bf16_f32 v193,v232,v193
v_cvt_pk_bf16_f32 v195,v237,v195
M v[84:87],a[244:247],a[232:235],0
buffer_load_dwordx4 a[196:199],v250,s[20:23],s46 offen offset:0 sc1
M v[84:87],a[220:223],a[212:215],v[84:87]
ds_read_b128 a[224:227],v248 offset:26112
v_cvt_pk_bf16_f32 v197,v233,v197
M v[84:87],a[204:207],v[216:219],v[84:87]
ds_read_b128 a[236:239],v249 offset:26112
v_cvt_pk_bf16_f32 v201,v234,v199
M v[88:91],a[204:207],a[212:215],0
ds_read_b128 v[216:219],v248 offset:26624
v_cvt_pk_bf16_f32 v199,v238,v235
M v[88:91],a[220:223],a[232:235],v[88:91]
ds_read_b128 a[212:215],v249 offset:26624
v_cvt_pk_bf16_f32 v203,v236,v203
M v[88:91],a[244:247],a[228:231],v[88:91]
ds_write2st64_b64 v247,v[192:193],v[194:195] offset0:172 offset1:189
M v[92:95],a[244:247],a[252:255],0
s_add_u32 s28,s68,6291456
buffer_load_dwordx4 v[192:195],v251,s[88:91],s28 offen offset:0
M v[92:95],a[220:223],a[228:231],v[92:95]
s_waitcnt vmcnt(18)
v_permlane32_swap_b32 v208,v210
v_permlane32_swap_b32 v204,v206
M v[92:95],a[204:207],a[232:235],v[92:95]
s_waitcnt lgkmcnt(4)
ds_write2st64_b64 v247,v[196:197],v[198:199] offset0:2 offset1:19
M v[96:99],a[248:251],a[224:227],0
s_waitcnt vmcnt(9) lgkmcnt(4)
buffer_load_dwordx4 v[196:199],v245,s[8:11],s28 offen offset:0
M v[96:99],a[240:243],a[236:239],v[96:99]
s_waitcnt vmcnt(9) lgkmcnt(3)
ds_read_b128 a[244:247],v248 offset:27136
ds_read_b128 a[252:255],v249 offset:27136
M v[96:99],a[216:219],v[216:219],v[96:99]
s_waitcnt lgkmcnt(4)
ds_write2st64_b64 v247,v[200:201],v[202:203] offset0:138 offset1:155
M v[100:103],a[216:219],a[212:215],0
buffer_load_dwordx4 v[200:203],v245,s[8:11],s28 offen offset:768
M v[100:103],a[240:243],v[216:219],v[100:103]
v_permlane32_swap_b32 v212,v214
v_lshlrev_b32 v234,16,v210
M v[100:103],a[248:251],a[236:239],v[100:103]
v_lshlrev_b32 v232,16,v204
v_lshlrev_b32 v233,16,v208
M v[104:107],a[248:251],v[216:219],0
ds_read_b128 a[220:223],v248 offset:27648
v_lshlrev_b32 v237,16,v206
M v[104:107],a[240:243],a[212:215],v[104:107]
s_waitcnt lgkmcnt(3)
ds_read_b128 a[228:231],v249 offset:27648
v_lshlrev_b32 v236,16,v214
M v[104:107],a[216:219],a[244:247],v[104:107]
s_waitcnt lgkmcnt(3)
v_lshlrev_b32 v235,16,v212
v_fmac_f32 v232,s43,v234
M v[108:111],a[216:219],a[252:255],0
v_fmac_f32 v237,4.0,v233
v_fma_f32 v238,-4.0,v234,v236
M v[108:111],a[240:243],a[244:247],v[108:111]
v_fmac_f32 v232,s45,v236
v_fmac_f32 v237,s41,v235
M v[108:111],a[248:251],a[212:215],v[108:111]
v_sub_f32 v236,v236,v234
v_fma_f32 v234,-4.0,v233,v235
M v[112:115],a[248:251],a[244:247],0
ds_read_b128 a[204:207],v249 offset:28160
v_sub_f32 v235,v235,v233
M v[112:115],a[240:243],a[252:255],v[112:115]
s_waitcnt lgkmcnt(2)
ds_read_b128 a[232:235],v248 offset:28160
v_add_f32 v233,v238,v234
M v[112:115],a[216:219],a[220:223],v[112:115]
s_waitcnt lgkmcnt(2)
v_sub_f32 v238,v238,v234
v_fma_f32 v234,2.0,v235,v236
M v[116:119],a[216:219],a[228:231],0
v_fmac_f32 v236,-2.0,v235
v_and_b32 v210,s42,v210
M v[116:119],a[240:243],a[220:223],v[116:119]
v_and_b32 v204,s42,v204
v_and_b32 v208,s42,v208
M v[116:119],a[248:251],a[252:255],v[116:119]
v_and_b32 v206,s42,v206
v_and_b32 v214,s42,v214
M v[120:123],a[248:251],a[220:223],0
v_and_b32 v212,s42,v212
v_fmac_f32 v204,s43,v210
M v[120:123],a[240:243],a[228:231],v[120:123]
s_waitcnt lgkmcnt(1)
v_fmac_f32 v206,4.0,v208
v_fma_f32 v235,-4.0,v210,v214
M v[120:123],a[216:219],a[204:207],v[120:123]
s_waitcnt lgkmcnt(0)
v_fmac_f32 v204,s45,v214
v_fmac_f32 v206,s41,v212
M v[124:127],a[216:219],a[232:235],0
buffer_load_dwordx4 a[216:219],v250,s[20:23],s46 offen offset:1024 sc1
M v[124:127],a[240:243],a[204:207],v[124:127]
v_sub_f32 v214,v214,v210
v_fma_f32 v210,-4.0,v208,v212
M v[124:127],a[248:251],a[228:231],v[124:127]
s_waitcnt vmcnt(10)
buffer_load_dwordx4 a[240:243],v250,s[20:23],s46 offen offset:2048 sc1
M v[128:131],v[224:227],a[224:227],0
s_waitcnt vmcnt(10)
s_add_u32 s47,s73,12288
v_sub_f32 v212,v212,v208
v_add_f32 v208,v235,v210
M v[128:131],a[192:195],a[236:239],v[128:131]
s_waitcnt vmcnt(9)
v_sub_f32 v235,v235,v210
v_fma_f32 v210,2.0,v212,v214
M v[128:131],a[200:203],v[216:219],v[128:131]
v_fmac_f32 v214,-2.0,v212
v_cvt_pk_bf16_f32 v204,v232,v204
M v[132:135],a[200:203],a[212:215],0
buffer_load_dwordx4 a[248:251],v250,s[20:23],s47 offen offset:0 sc1
M v[132:135],a[192:195],v[216:219],v[132:135]
v_cvt_pk_bf16_f32 v206,v237,v206
v_cvt_pk_bf16_f32 v208,v233,v208
M v[132:135],v[224:227],a[236:239],v[132:135]
v_cvt_pk_bf16_f32 v212,v234,v210
v_cvt_pk_bf16_f32 v210,v238,v235
M v[136:139],v[224:227],v[216:219],0
v_cvt_pk_bf16_f32 v214,v236,v214
v_permlane32_swap_b32 v209,v211
M v[136:139],a[192:195],a[212:215],v[136:139]
v_permlane32_swap_b32 v205,v207
v_permlane32_swap_b32 v213,v215
M v[136:139],a[200:203],a[244:247],v[136:139]
v_lshlrev_b32 v234,16,v211
v_lshlrev_b32 v232,16,v205
M v[140:143],a[200:203],a[252:255],0
v_lshlrev_b32 v233,16,v209
v_lshlrev_b32 v237,16,v207
M v[140:143],a[192:195],a[244:247],v[140:143]
v_lshlrev_b32 v236,16,v215
v_lshlrev_b32 v235,16,v213
M v[140:143],v[224:227],a[212:215],v[140:143]
v_fmac_f32 v232,s43,v234
v_fmac_f32 v237,4.0,v233
M v[144:147],v[224:227],a[244:247],0
v_fma_f32 v238,-4.0,v234,v236
v_fmac_f32 v232,s45,v236
M v[144:147],a[192:195],a[252:255],v[144:147]
v_fmac_f32 v237,s41,v235
v_sub_f32 v236,v236,v234
M v[144:147],a[200:203],a[220:223],v[144:147]
v_fma_f32 v234,-4.0,v233,v235
v_sub_f32 v235,v235,v233
M v[148:151],a[200:203],a[228:231],0
v_add_f32 v233,v238,v234
v_sub_f32 v238,v238,v234
M v[148:151],a[192:195],a[220:223],v[148:151]
v_fma_f32 v234,2.0,v235,v236
v_fmac_f32 v236,-2.0,v235
M v[148:151],v[224:227],a[252:255],v[148:151]
v_and_b32 v211,s42,v211
v_and_b32 v205,s42,v205
M v[152:155],v[224:227],a[220:223],0
v_and_b32 v209,s42,v209
v_and_b32 v207,s42,v207
M v[152:155],a[192:195],a[228:231],v[152:155]
v_and_b32 v215,s42,v215
v_and_b32 v213,s42,v213
M v[152:155],a[200:203],a[204:207],v[152:155]
v_fmac_f32 v205,s43,v211
v_fmac_f32 v207,4.0,v209
M v[156:159],a[200:203],a[232:235],0
buffer_load_dwordx4 a[200:203],v250,s[20:23],s47 offen offset:1024 sc1
M v[156:159],a[192:195],a[204:207],v[156:159]
v_fma_f32 v235,-4.0,v211,v215
v_fmac_f32 v205,s45,v215
M v[156:159],v[224:227],a[228:231],v[156:159]
s_waitcnt vmcnt(10)
buffer_load_dwordx4 a[192:195],v250,s[20:23],s47 offen offset:2048 sc1
M v[160:163],v[220:223],a[224:227],0
s_waitcnt vmcnt(10)
s_add_u32 s48,s73,15360
v_fmac_f32 v207,s41,v213
v_sub_f32 v215,v215,v211
M v[160:163],v[228:231],a[236:239],v[160:163]
s_waitcnt vmcnt(9)
v_fma_f32 v211,-4.0,v209,v213
v_sub_f32 v213,v213,v209
v_add_f32 v209,v235,v211
M v[160:163],a[208:211],v[216:219],v[160:163]
v_sub_f32 v235,v235,v211
v_fma_f32 v211,2.0,v213,v215
v_fmac_f32 v215,-2.0,v213
v_cvt_pk_bf16_f32 v205,v232,v205
M v[164:167],a[208:211],a[212:215],0
buffer_load_dwordx4 v[224:227],v250,s[20:23],s48 offen offset:0 sc1
v_cvt_pk_bf16_f32 v207,v237,v207
v_cvt_pk_bf16_f32 v209,v233,v209
v_cvt_pk_bf16_f32 v213,v234,v211
v_cvt_pk_bf16_f32 v211,v238,v235
M v[164:167],v[228:231],v[216:219],v[164:167]
v_cvt_pk_bf16_f32 v215,v236,v215
M v[164:167],v[220:223],a[236:239],v[164:167]
ds_write2st64_b64 v247,v[204:205],v[206:207] offset0:173 offset1:190
M v[168:171],v[220:223],v[216:219],0
s_add_u32 s28,s68,6684672
buffer_load_dwordx4 a[224:227],v250,s[20:23],s48 offen offset:1024 sc1
M v[168:171],v[228:231],a[212:215],v[168:171]
M v[168:171],a[208:211],a[244:247],v[168:171]
ds_write2st64_b64 v247,v[208:209],v[210:211] offset0:3 offset1:20
M v[172:175],a[208:211],a[252:255],0
buffer_load_dwordx4 a[236:239],v250,s[20:23],s48 offen offset:2048 sc1
M v[172:175],v[228:231],a[244:247],v[172:175]
s_add_u32 s46,s73,18432
M v[172:175],v[220:223],a[212:215],v[172:175]
ds_write2st64_b64 v247,v[212:213],v[214:215] offset0:139 offset1:156
M v[176:179],v[220:223],a[244:247],0
buffer_load_dwordx4 v[216:219],v250,s[20:23],s46 offen offset:0 sc1
M v[176:179],v[228:231],a[252:255],v[176:179]
v_add_u32 v248,0xffffbc00,v248
v_add_u32 v249,0xffffbc00,v249
M v[176:179],a[208:211],a[220:223],v[176:179]
s_waitcnt lgkmcnt(0)
s_barrier
M v[180:183],a[208:211],a[228:231],0
buffer_load_dwordx4 v[204:207],v251,s[88:91],s28 offen offset:0
M v[180:183],v[228:231],a[220:223],v[180:183]
ds_read_b128 a[212:215],v248 offset:0
M v[180:183],v[220:223],a[252:255],v[180:183]
ds_read_b128 a[244:247],v249 offset:0
M v[184:187],v[220:223],a[220:223],0
ds_read_b128 a[252:255],v248 offset:512
M v[184:187],v[228:231],a[228:231],v[184:187]
buffer_load_dwordx4 v[208:211],v245,s[8:11],s28 offen offset:0
M v[184:187],a[208:211],a[204:207],v[184:187]
s_waitcnt vmcnt(12)
ds_read_b128 a[220:223],v249 offset:512
v_permlane32_swap_b32 v196,v198
M v[188:191],a[208:211],a[232:235],0
s_waitcnt vmcnt(11)
v_permlane32_swap_b32 v192,v194
v_permlane32_swap_b32 v200,v202
M v[188:191],v[228:231],a[204:207],v[188:191]
v_lshlrev_b32 v234,16,v198
v_lshlrev_b32 v232,16,v192
M v[188:191],v[220:223],a[228:231],v[188:191]
s_waitcnt lgkmcnt(3)
buffer_load_dwordx4 v[212:215],v245,s[8:11],s28 offen offset:768
M a[0:3],a[196:199],a[212:215],a[0:3]
s_waitcnt vmcnt(11) lgkmcnt(2)
ds_read_b128 a[208:211],v248 offset:1024
v_lshlrev_b32 v233,16,v196
M a[0:3],a[216:219],a[244:247],a[0:3]
s_waitcnt vmcnt(10) lgkmcnt(2)
ds_read_b128 a[232:235],v249 offset:1024
v_lshlrev_b32 v237,16,v194
M a[0:3],a[240:243],a[252:255],a[0:3]
s_waitcnt lgkmcnt(2)
v_lshlrev_b32 v236,16,v202
v_lshlrev_b32 v235,16,v200
M a[4:7],a[240:243],a[220:223],a[4:7]
v_fmac_f32 v232,s43,v234
v_fmac_f32 v237,4.0,v233
M a[4:7],a[216:219],a[252:255],a[4:7]
v_fma_f32 v238,-4.0,v234,v236
v_fmac_f32 v232,s45,v236
M a[4:7],a[196:199],a[244:247],a[4:7]
v_fmac_f32 v237,s41,v235
v_sub_f32 v236,v236,v234
M a[8:11],a[196:199],a[252:255],a[8:11]
ds_read_b128 a[204:207],v248 offset:1536
v_fma_f32 v234,-4.0,v233,v235
M a[8:11],a[216:219],a[220:223],a[8:11]
s_waitcnt lgkmcnt(2)
ds_read_b128 v[228:231],v249 offset:1536
v_sub_f32 v235,v235,v233
M a[8:11],a[240:243],a[208:211],a[8:11]
s_waitcnt lgkmcnt(2)
v_add_f32 v233,v238,v234
v_sub_f32 v238,v238,v234
M a[12:15],a[240:243],a[232:235],a[12:15]
v_fma_f32 v234,2.0,v235,v236
v_fmac_f32 v236,-2.0,v235
M a[12:15],a[216:219],a[208:211],a[12:15]
v_and_b32 v198,s42,v198
v_and_b32 v192,s42,v192
M a[12:15],a[196:199],a[220:223],a[12:15]
v_and_b32 v196,s42,v196
v_and_b32 v194,s42,v194
M a[16:19],a[196:199],a[208:211],a[16:19]
ds_read_b128 a[228:231],v249 offset:2048
v_and_b32 v202,s42,v202
M a[16:19],a[216:219],a[232:235],a[16:19]
s_waitcnt lgkmcnt(2)
ds_read_b128 v[220:223],v248 offset:2048
v_and_b32 v200,s42,v200
M a[16:19],a[240:243],a[204:207],a[16:19]
s_waitcnt lgkmcnt(2)
v_fmac_f32 v192,s43,v198
v_fmac_f32 v194,4.0,v196
M a[20:23],a[240:243],v[228:231],a[20:23]
v_fma_f32 v235,-4.0,v198,v202
v_fmac_f32 v192,s45,v202
M a[20:23],a[216:219],a[204:207],a[20:23]
v_fmac_f32 v194,s41,v200
v_sub_f32 v202,v202,v198
M a[20:23],a[196:199],a[232:235],a[20:23]
v_fma_f32 v198,-4.0,v196,v200
v_sub_f32 v200,v200,v196
M a[24:27],a[196:199],a[204:207],a[24:27]
v_add_f32 v196,v235,v198
v_sub_f32 v235,v235,v198
M a[24:27],a[216:219],v[228:231],a[24:27]
s_waitcnt lgkmcnt(1)
v_fma_f32 v198,2.0,v200,v202
v_fmac_f32 v202,-2.0,v200
M a[24:27],a[240:243],a[228:231],a[24:27]
s_waitcnt lgkmcnt(0)
v_cvt_pk_bf16_f32 v192,v232,v192
v_cvt_pk_bf16_f32 v194,v237,v194
M a[28:31],a[240:243],v[220:223],a[28:31]
buffer_load_dwordx4 a[240:243],v250,s[20:23],s46 offen offset:1024 sc1
M a[28:31],a[216:219],a[228:231],a[28:31]
v_cvt_pk_bf16_f32 v196,v233,v196
v_cvt_pk_bf16_f32 v200,v234,v198
M a[28:31],a[196:199],v[228:231],a[28:31]
s_waitcnt vmcnt(10)
buffer_load_dwordx4 a[216:219],v250,s[20:23],s46 offen offset:2048 sc1
M a[32:35],a[248:251],a[212:215],a[32:35]
s_waitcnt vmcnt(10)
s_add_u32 s47,s73,21504
v_cvt_pk_bf16_f32 v198,v238,v235
v_cvt_pk_bf16_f32 v202,v236,v202
M a[32:35],a[200:203],a[244:247],a[32:35]
s_waitcnt vmcnt(9)
v_permlane32_swap_b32 v197,v199
v_permlane32_swap_b32 v193,v195
M a[32:35],a[192:195],a[252:255],a[32:35]
v_permlane32_swap_b32 v201,v203
v_lshlrev_b32 v234,16,v199
M a[36:39],a[192:195],a[220:223],a[36:39]
buffer_load_dwordx4 a[196:199],v250,s[20:23],s47 offen offset:0 sc1
M a[36:39],a[200:203],a[252:255],a[36:39]
v_lshlrev_b32 v232,16,v193
v_lshlrev_b32 v233,16,v197
M a[36:39],a[248:251],a[244:247],a[36:39]
v_lshlrev_b32 v237,16,v195
v_lshlrev_b32 v236,16,v203
M a[40:43],a[248:251],a[252:255],a[40:43]
v_lshlrev_b32 v235,16,v201
v_fmac_f32 v232,s43,v234
M a[40:43],a[200:203],a[220:223],a[40:43]
v_fmac_f32 v237,4.0,v233
v_fma_f32 v238,-4.0,v234,v236
M a[40:43],a[192:195],a[208:211],a[40:43]
v_fmac_f32 v232,s45,v236
v_fmac_f32 v237,s41,v235
M a[44:47],a[192:195],a[232:235],a[44:47]
v_sub_f32 v236,v236,v234
v_fma_f32 v234,-4.0,v233,v235
M a[44:47],a[200:203],a[208:211],a[44:47]
v_sub_f32 v235,v235,v233
v_add_f32 v233,v238,v234
M a[44:47],a[248:251],a[220:223],a[44:47]
v_sub_f32 v238,v238,v234
v_fma_f32 v234,2.0,v235,v236
M a[48:51],a[248:251],a[208:211],a[48:51]
v_fmac_f32 v236,-2.0,v235
v_and_b32 v199,s42,v199
M a[48:51],a[200:203],a[232:235],a[48:51]
v_and_b32 v193,s42,v193
v_and_b32 v197,s42,v197
M a[48:51],a[192:195],a[204:207],a[48:51]
v_and_b32 v195,s42,v195
v_and_b32 v203,s42,v203
M a[52:55],a[192:195],v[228:231],a[52:55]
v_and_b32 v201,s42,v201
v_fmac_f32 v193,s43,v199
M a[52:55],a[200:203],a[204:207],a[52:55]
v_fmac_f32 v195,4.0,v197
v_fma_f32 v235,-4.0,v199,v203
M a[52:55],a[248:251],a[232:235],a[52:55]
v_fmac_f32 v193,s45,v203
v_fmac_f32 v195,s41,v201
M a[56:59],a[248:251],a[204:207],a[56:59]
v_sub_f32 v203,v203,v199
v_fma_f32 v199,-4.0,v197,v201
M a[56:59],a[200:203],v[228:231],a[56:59]
v_sub_f32 v201,v201,v197
v_add_f32 v197,v235,v199
M a[56:59],a[192:195],a[228:231],a[56:59]
v_sub_f32 v235,v235,v199
v_fma_f32 v199,2.0,v201,v203
M a[60:63],a[192:195],v[220:223],a[60:63]
buffer_load_dwordx4 a[192:195],v250,s[20:23],s47 offen offset:1024 sc1
M a[60:63],a[200:203],a[228:231],a[60:63]
v_fmac_f32 v203,-2.0,v201
v_cvt_pk_bf16_f32 v193,v232,v193
M a[60:63],a[248:251],v[228:231],a[60:63]
s_waitcnt vmcnt(10)
buffer_load_dwordx4 a[200:203],v250,s[20:23],s47 offen offset:2048 sc1
M a[64:67],v[224:227],a[212:215],a[64:67]
s_waitcnt vmcnt(10)
s_add_u32 s48,s73,24576
v_cvt_pk_bf16_f32 v195,v237,v195
v_cvt_pk_bf16_f32 v197,v233,v197
M a[64:67],a[224:227],a[244:247],a[64:67]
s_waitcnt vmcnt(9)
v_cvt_pk_bf16_f32 v201,v234,v199
v_cvt_pk_bf16_f32 v199,v238,v235
M a[64:67],a[236:239],a[252:255],a[64:67]
v_cvt_pk_bf16_f32 v203,v236,v203
M a[68:71],a[236:239],a[220:223],a[68:71]
buffer_load_dwordx4 a[248:251],v250,s[20:23],s48 offen offset:0 sc1
M a[68:71],a[224:227],a[252:255],a[68:71]
M a[68:71],v[224:227],a[244:247],a[68:71]
ds_write2st64_b64 v247,v[192:193],v[194:195] offset0:204 offset1:221
M a[72:75],v[224:227],a[252:255],a[72:75]
s_add_u32 s28,s68,7077888
M a[72:75],a[224:227],a[220:223],a[72:75]
buffer_load_dwordx4 a[212:215],v250,s[20:23],s48 offen offset:1024 sc1
M a[72:75],a[236:239],a[208:211],a[72:75]
ds_write2st64_b64 v247,v[196:197],v[198:199] offset0:34 offset1:51
M a[76:79],a[236:239],a[232:235],a[76:79]
M a[76:79],a[224:227],a[208:211],a[76:79]
buffer_load_dwordx4 a[244:247],v250,s[20:23],s48 offen offset:2048 sc1
M a[76:79],v[224:227],a[220:223],a[76:79]
s_add_u32 s46,s73,27648
ds_write2st64_b64 v247,v[200:201],v[202:203] offset0:68 offset1:85
M a[80:83],v[224:227],a[208:211],a[80:83]
M a[80:83],a[224:227],a[232:235],a[80:83]
buffer_load_dwordx4 a[252:255],v250,s[20:23],s46 offen offset:0 sc1
M a[80:83],a[236:239],a[204:207],a[80:83]
M a[84:87],a[236:239],v[228:231],a[84:87]
M a[84:87],a[224:227],a[204:207],a[84:87]
s_waitcnt vmcnt(10)
ds_read_b128 a[220:223],v248 offset:8704
v_permlane32_swap_b32 v208,v210
M a[84:87],v[224:227],a[232:235],a[84:87]
buffer_load_dwordx4 v[192:195],v251,s[88:91],s28 offen offset:0
M a[88:91],v[224:227],a[204:207],a[88:91]
ds_read_b128 a[208:211],v249 offset:8704
ds_read_b128 a[232:235],v248 offset:9216
M a[88:91],a[224:227],v[228:231],a[88:91]
ds_read_b128 a[204:207],v249 offset:9216
v_permlane32_swap_b32 v204,v206
M a[88:91],a[236:239],a[228:231],a[88:91]
s_waitcnt vmcnt(10)
v_permlane32_swap_b32 v212,v214
v_lshlrev_b32 v234,16,v210
M a[92:95],a[236:239],v[220:223],a[92:95]
buffer_load_dwordx4 v[196:199],v245,s[8:11],s28 offen offset:0
M a[92:95],a[224:227],a[228:231],a[92:95]
v_lshlrev_b32 v232,16,v204
v_lshlrev_b32 v233,16,v208
M a[92:95],v[224:227],v[228:231],a[92:95]
s_waitcnt lgkmcnt(3)
v_lshlrev_b32 v237,16,v206
v_lshlrev_b32 v236,16,v214
M a[96:99],v[216:219],a[220:223],a[96:99]
s_waitcnt vmcnt(10) lgkmcnt(2)
ds_read_b128 a[236:239],v248 offset:9728
v_lshlrev_b32 v235,16,v212
M a[96:99],a[240:243],a[208:211],a[96:99]
s_waitcnt vmcnt(9) lgkmcnt(2)
buffer_load_dwordx4 v[200:203],v245,s[8:11],s28 offen offset:768
M a[96:99],a[216:219],a[232:235],a[96:99]
s_waitcnt lgkmcnt(1)
ds_read_b128 v[220:223],v249 offset:9728
v_fmac_f32 v232,s43,v234
M a[100:103],a[216:219],a[204:207],a[100:103]
v_fmac_f32 v237,4.0,v233
v_fma_f32 v238,-4.0,v234,v236
M a[100:103],a[240:243],a[232:235],a[100:103]
v_fmac_f32 v232,s45,v236
v_fmac_f32 v237,s41,v235
M a[100:103],v[216:219],a[208:211],a[100:103]
v_sub_f32 v236,v236,v234
v_fma_f32 v234,-4.0,v233,v235
M a[104:107],v[216:219],a[232:235],a[104:107]
ds_read_b128 a[224:227],v248 offset:10240
v_sub_f32 v235,v235,v233
M a[104:107],a[240:243],a[204:207],a[104:107]
s_waitcnt lgkmcnt(2)
ds_read_b128 a[228:231],v249 offset:10240
v_add_f32 v233,v238,v234
M a[104:107],a[216:219],a[236:239],a[104:107]
s_waitcnt lgkmcnt(2)
v_sub_f32 v238,v238,v234
v_fma_f32 v234,2.0,v235,v236
M a[108:111],a[216:219],v[220:223],a[108:111]
v_fmac_f32 v236,-2.0,v235
v_and_b32 v210,s42,v210
M a[108:111],a[240:243],a[236:239],a[108:111]
v_and_b32 v204,s42,v204
v_and_b32 v208,s42,v208
M a[108:111],v[216:219],a[204:207],a[108:111]
v_and_b32 v206,s42,v206
v_and_b32 v214,s42,v214
M a[112:115],v[216:219],a[236:239],a[112:115]
ds_read_b128 v[224:227],v249 offset:10752
v_and_b32 v212,s42,v212
M a[112:115],a[240:243],v[220:223],a[112:115]
s_waitcnt lgkmcnt(2)
ds_read_b128 v[228:231],v248 offset:10752
v_fmac_f32 v204,s43,v210
M a[112:115],a[216:219],a[224:227],a[112:115]
s_waitcnt lgkmcnt(2)
v_fmac_f32 v206,4.0,v208
v_fma_f32 v235,-4.0,v210,v214
M a[116:119],a[216:219],a[228:231],a[116:119]
v_fmac_f32 v204,s45,v214
v_fmac_f32 v206,s41,v212
M a[116:119],a[240:243],a[224:227],a[116:119]
v_sub_f32 v214,v214,v210
v_fma_f32 v210,-4.0,v208,v212
M a[116:119],v[216:219],v[220:223],a[116:119]
v_sub_f32 v212,v212,v208
v_add_f32 v208,v235,v210
M a[120:123],v[216:219],a[224:227],a[120:123]
v_sub_f32 v235,v235,v210
v_fma_f32 v210,2.0,v212,v214
M a[120:123],a[240:243],a[228:231],a[120:123]
s_waitcnt lgkmcnt(1)
v_fmac_f32 v214,-2.0,v212
v_cvt_pk_bf16_f32 v204,v232,v204
M a[120:123],a[216:219],v[224:227],a[120:123]
s_waitcnt lgkmcnt(0)
v_cvt_pk_bf16_f32 v206,v237,v206
v_cvt_pk_bf16_f32 v208,v233,v208
M a[124:127],a[216:219],v[228:231],a[124:127]
buffer_load_dwordx4 a[216:219],v250,s[20:23],s46 offen offset:1024 sc1
M a[124:127],a[240:243],v[224:227],a[124:127]
v_cvt_pk_bf16_f32 v212,v234,v210
v_cvt_pk_bf16_f32 v210,v238,v235
M a[124:127],v[216:219],a[228:231],a[124:127]
s_waitcnt vmcnt(10)
buffer_load_dwordx4 a[240:243],v250,s[20:23],s46 offen offset:2048 sc1
M a[128:131],a[196:199],a[220:223],a[128:131]
s_waitcnt vmcnt(10)
s_add_u32 s47,s73,30720
v_cvt_pk_bf16_f32 v214,v236,v214
v_permlane32_swap_b32 v209,v211
M a[128:131],a[192:195],a[208:211],a[128:131]
s_waitcnt vmcnt(9)
v_permlane32_swap_b32 v205,v207
v_permlane32_swap_b32 v213,v215
M a[128:131],a[200:203],a[232:235],a[128:131]
v_lshlrev_b32 v234,16,v211
v_lshlrev_b32 v232,16,v205
M a[132:135],a[200:203],a[204:207],a[132:135]
buffer_load_dwordx4 v[216:219],v250,s[20:23],s47 offen offset:0 sc1
M a[132:135],a[192:195],a[232:235],a[132:135]
v_lshlrev_b32 v233,16,v209
v_lshlrev_b32 v237,16,v207
M a[132:135],a[196:199],a[208:211],a[132:135]
v_lshlrev_b32 v236,16,v215
v_lshlrev_b32 v235,16,v213
M a[136:139],a[196:199],a[232:235],a[136:139]
v_fmac_f32 v232,s43,v234
v_fmac_f32 v237,4.0,v233
M a[136:139],a[192:195],a[204:207],a[136:139]
v_fma_f32 v238,-4.0,v234,v236
v_fmac_f32 v232,s45,v236
M a[136:139],a[200:203],a[236:239],a[136:139]
v_fmac_f32 v237,s41,v235
v_sub_f32 v236,v236,v234
M a[140:143],a[200:203],v[220:223],a[140:143]
v_fma_f32 v234,-4.0,v233,v235
v_sub_f32 v235,v235,v233
M a[140:143],a[192:195],a[236:239],a[140:143]
v_add_f32 v233,v238,v234
v_sub_f32 v238,v238,v234
M a[140:143],a[196:199],a[204:207],a[140:143]
v_fma_f32 v234,2.0,v235,v236
v_fmac_f32 v236,-2.0,v235
M a[144:147],a[196:199],a[236:239],a[144:147]
v_and_b32 v211,s42,v211
v_and_b32 v205,s42,v205
M a[144:147],a[192:195],v[220:223],a[144:147]
v_and_b32 v209,s42,v209
v_and_b32 v207,s42,v207
M a[144:147],a[200:203],a[224:227],a[144:147]
v_and_b32 v215,s42,v215
v_and_b32 v213,s42,v213
M a[148:151],a[200:203],a[228:231],a[148:151]
v_fmac_f32 v205,s43,v211
v_fmac_f32 v207,4.0,v209
M a[148:151],a[192:195],a[224:227],a[148:151]
v_fma_f32 v235,-4.0,v211,v215
v_fmac_f32 v205,s45,v215
M a[148:151],a[196:199],v[220:223],a[148:151]
v_fmac_f32 v207,s41,v213
v_sub_f32 v215,v215,v211
M a[152:155],a[196:199],a[224:227],a[152:155]
v_fma_f32 v211,-4.0,v209,v213
v_sub_f32 v213,v213,v209
M a[152:155],a[192:195],a[228:231],a[152:155]
v_add_f32 v209,v235,v211
v_sub_f32 v235,v235,v211
M a[152:155],a[200:203],v[224:227],a[152:155]
v_fma_f32 v211,2.0,v213,v215
v_fmac_f32 v215,-2.0,v213
M a[156:159],a[200:203],v[228:231],a[156:159]
buffer_load_dwordx4 a[200:203],v250,s[20:23],s47 offen offset:1024 sc1
M a[156:159],a[192:195],v[224:227],a[156:159]
v_cvt_pk_bf16_f32 v205,v232,v205
v_cvt_pk_bf16_f32 v207,v237,v207
M a[156:159],a[196:199],a[228:231],a[156:159]
s_waitcnt vmcnt(10)
buffer_load_dwordx4 a[192:195],v250,s[20:23],s47 offen offset:2048 sc1
M a[160:163],a[248:251],a[220:223],a[160:163]
s_waitcnt vmcnt(10)
s_add_u32 s48,s73,33792
v_cvt_pk_bf16_f32 v209,v233,v209
v_cvt_pk_bf16_f32 v213,v234,v211
M a[160:163],a[212:215],a[208:211],a[160:163]
s_waitcnt vmcnt(9)
v_cvt_pk_bf16_f32 v211,v238,v235
v_cvt_pk_bf16_f32 v215,v236,v215
M a[160:163],a[244:247],a[232:235],a[160:163]
ds_write2st64_b64 v247,v[204:205],v[206:207] offset0:205 offset1:222
M a[164:167],a[244:247],a[204:207],a[164:167]
s_add_u32 s28,s68,7471104
buffer_load_dwordx4 a[196:199],v250,s[20:23],s48 offen offset:0 sc1
M a[164:167],a[212:215],a[232:235],a[164:167]
v_fmac_f32 v239,s43,v241
v_fmac_f32 v244,4.0,v240
M a[164:167],a[248:251],a[208:211],a[164:167]
ds_write2st64_b64 v247,v[208:209],v[210:211] offset0:35 offset1:52
M a[168:171],a[248:251],a[232:235],a[168:171]
buffer_load_dwordx4 a[220:223],v250,s[20:23],s48 offen offset:1024 sc1
M a[168:171],a[212:215],a[204:207],a[168:171]
v_fma_f32 v232,-4.0,v241,v243
v_fmac_f32 v239,s45,v243
M a[168:171],a[244:247],a[236:239],a[168:171]
ds_write2st64_b64 v247,v[212:213],v[214:215] offset0:69 offset1:86
M a[172:175],a[244:247],v[220:223],a[172:175]
buffer_load_dwordx4 a[208:211],v250,s[20:23],s48 offen offset:2048 sc1
M a[172:175],a[212:215],a[236:239],a[172:175]
s_add_u32 s46,s73,36864
v_fmac_f32 v244,s41,v242
v_sub_f32 v243,v243,v241
M a[172:175],a[248:251],a[204:207],a[172:175]
v_fma_f32 v241,-4.0,v240,v242
v_sub_f32 v242,v242,v240
M a[176:179],a[248:251],a[236:239],a[176:179]
v_add_f32 v240,v232,v241
v_sub_f32 v232,v232,v241
M a[176:179],a[212:215],v[220:223],a[176:179]
buffer_load_dwordx4 a[232:235],v250,s[20:23],s46 offen offset:0 sc1
M a[176:179],a[244:247],a[224:227],a[176:179]
v_add_u32 v248,0x4400,v248
v_add_u32 v249,0x4400,v249
M a[180:183],a[244:247],a[228:231],a[180:183]
v_fma_f32 v241,2.0,v242,v243
v_fmac_f32 v243,-2.0,v242
M a[180:183],a[212:215],a[224:227],a[180:183]
ds_read_b128 a[204:207],v248 offset:52224
v_cvt_pk_bf16_f32 v233,v239,v244
M a[180:183],a[248:251],v[220:223],a[180:183]
buffer_load_dwordx4 v[204:207],v251,s[88:91],s28 offen offset:0
M a[184:187],a[248:251],a[224:227],a[184:187]
ds_read_b128 a[236:239],v249 offset:52224
ds_read_b128 v[220:223],v248 offset:52736
M a[184:187],a[212:215],a[228:231],a[184:187]
ds_read_b128 a[224:227],v249 offset:52736
v_cvt_pk_bf16_f32 v234,v240,v232
M a[184:187],a[244:247],v[224:227],a[184:187]
v_cvt_pk_bf16_f32 v235,v241,v243
v_add_u32 v232,104448,v252
M a[188:191],a[244:247],v[228:231],a[188:191]
buffer_load_dwordx4 v[208:211],v245,s[8:11],s28 offen offset:0
M a[188:191],a[212:215],v[224:227],a[188:191]
ds_write_b16 v232,v233 offset:0
M a[188:191],a[248:251],a[228:231],a[188:191]
s_waitcnt vmcnt(14) lgkmcnt(4)
ds_write_b16_d16_hi v232,v233 offset:8704
M v[0:3],a[252:255],a[204:207],v[0:3]
s_waitcnt vmcnt(10) lgkmcnt(4)
ds_read_b128 a[244:247],v248 offset:53248
ds_write_b16 v252,v234 offset:17408
M v[0:3],a[216:219],a[236:239],v[0:3]
s_waitcnt vmcnt(9) lgkmcnt(5)
buffer_load_dwordx4 v[212:215],v245,s[8:11],s28 offen offset:768
M v[0:3],a[240:243],v[220:223],v[0:3]
s_waitcnt lgkmcnt(4)
s_add_u32 s29,s69,6291456
ds_read_b128 v[228:231],v249 offset:53248
ds_write_b16_d16_hi v252,v234 offset:26112
M v[4:7],a[240:243],a[224:227],v[4:7]
ds_write_b16 v252,v235 offset:34816
M v[4:7],a[216:219],v[220:223],v[4:7]
ds_write_b16_d16_hi v252,v235 offset:43520
M v[4:7],a[252:255],a[236:239],v[4:7]
buffer_load_short_d16_hi v239,v246,s[12:15],s29 offen offset:0
M v[8:11],a[252:255],v[220:223],v[8:11]
ds_read_b128 a[212:215],v248 offset:53760
v_permlane32_swap_b32 v196,v198
M v[8:11],a[216:219],a[224:227],v[8:11]
s_waitcnt lgkmcnt(6)
buffer_load_short_d16_hi v240,v246,s[8:11],s29 offen offset:0
M v[8:11],a[240:243],a[244:247],v[8:11]
s_waitcnt lgkmcnt(4)
ds_read_b128 v[224:227],v249 offset:53760
v_permlane32_swap_b32 v192,v194
M v[12:15],a[240:243],v[228:231],v[12:15]
buffer_load_short_d16_hi v241,v246,s[8:11],s29 offen offset:384
M v[12:15],a[216:219],a[244:247],v[12:15]
v_permlane32_swap_b32 v200,v202
v_lshlrev_b32 v234,16,v198
M v[12:15],a[252:255],a[224:227],v[12:15]
buffer_load_short_d16_hi v242,v246,s[8:11],s29 offen offset:768
M v[16:19],a[252:255],a[244:247],v[16:19]
ds_read_b128 a[228:231],v249 offset:54272
v_lshlrev_b32 v232,16,v192
M v[16:19],a[216:219],v[228:231],v[16:19]
s_waitcnt lgkmcnt(2)
buffer_load_short_d16_hi v243,v246,s[8:11],s29 offen offset:1152
M v[16:19],a[240:243],a[212:215],v[16:19]
s_waitcnt lgkmcnt(1)
ds_read_b128 a[248:251],v248 offset:54272
v_lshlrev_b32 v233,16,v196
M v[20:23],a[240:243],v[224:227],v[20:23]
buffer_load_short_d16_hi v244,v246,s[16:19],s29 offen offset:1536
M v[20:23],a[216:219],a[212:215],v[20:23]
v_lshlrev_b32 v237,16,v194
v_lshlrev_b32 v236,16,v202
M v[20:23],a[252:255],v[228:231],v[20:23]
v_lshlrev_b32 v235,16,v200
v_fmac_f32 v232,s43,v234
M v[24:27],a[252:255],a[212:215],v[24:27]
v_fmac_f32 v237,4.0,v233
v_fma_f32 v238,-4.0,v234,v236
M v[24:27],a[216:219],v[224:227],v[24:27]
s_waitcnt lgkmcnt(1)
v_fmac_f32 v232,s45,v236
v_fmac_f32 v237,s41,v235
M v[24:27],a[240:243],a[228:231],v[24:27]
s_waitcnt lgkmcnt(0)
v_sub_f32 v236,v236,v234
v_fma_f32 v234,-4.0,v233,v235
M v[28:31],a[240:243],a[248:251],v[28:31]
buffer_load_dwordx4 a[240:243],v250,s[20:23],s46 offen offset:1024 sc1
M v[28:31],a[216:219],a[228:231],v[28:31]
v_sub_f32 v235,v235,v233
v_add_f32 v233,v238,v234
M v[28:31],a[252:255],v[224:227],v[28:31]
s_waitcnt vmcnt(16)
buffer_load_dwordx4 a[216:219],v250,s[20:23],s46 offen offset:2048 sc1
M v[32:35],v[216:219],a[204:207],v[32:35]
s_waitcnt vmcnt(16)
s_add_u32 s47,s73,39936
v_sub_f32 v238,v238,v234
v_fma_f32 v234,2.0,v235,v236
M v[32:35],a[200:203],a[236:239],v[32:35]
s_waitcnt vmcnt(15)
v_fmac_f32 v236,-2.0,v235
v_and_b32 v198,s42,v198
M v[32:35],a[192:195],v[220:223],v[32:35]
v_and_b32 v192,s42,v192
v_and_b32 v196,s42,v196
M v[36:39],a[192:195],a[224:227],v[36:39]
buffer_load_dwordx4 a[252:255],v250,s[20:23],s47 offen offset:0 sc1
M v[36:39],a[200:203],v[220:223],v[36:39]
v_and_b32 v194,s42,v194
v_and_b32 v202,s42,v202
M v[36:39],v[216:219],a[236:239],v[36:39]
v_and_b32 v200,s42,v200
v_fmac_f32 v192,s43,v198
M v[40:43],v[216:219],v[220:223],v[40:43]
v_fmac_f32 v194,4.0,v196
v_fma_f32 v235,-4.0,v198,v202
M v[40:43],a[200:203],a[224:227],v[40:43]
v_fmac_f32 v192,s45,v202
v_fmac_f32 v194,s41,v200
M v[40:43],a[192:195],a[244:247],v[40:43]
v_sub_f32 v202,v202,v198
v_fma_f32 v198,-4.0,v196,v200
M v[44:47],a[192:195],v[228:231],v[44:47]
v_sub_f32 v200,v200,v196
v_add_f32 v196,v235,v198
M v[44:47],a[200:203],a[244:247],v[44:47]
v_sub_f32 v235,v235,v198
v_fma_f32 v198,2.0,v200,v202
M v[44:47],v[216:219],a[224:227],v[44:47]
v_fmac_f32 v202,-2.0,v200
v_cvt_pk_bf16_f32 v192,v232,v192
M v[48:51],v[216:219],a[244:247],v[48:51]
v_cvt_pk_bf16_f32 v194,v237,v194
v_cvt_pk_bf16_f32 v196,v233,v196
M v[48:51],a[200:203],v[228:231],v[48:51]
v_cvt_pk_bf16_f32 v200,v234,v198
v_cvt_pk_bf16_f32 v198,v238,v235
M v[48:51],a[192:195],a[212:215],v[48:51]
v_cvt_pk_bf16_f32 v202,v236,v202
v_permlane32_swap_b32 v197,v199
M v[52:55],a[192:195],v[224:227],v[52:55]
v_permlane32_swap_b32 v193,v195
v_permlane32_swap_b32 v201,v203
M v[52:55],a[200:203],a[212:215],v[52:55]
v_lshlrev_b32 v234,16,v199
v_lshlrev_b32 v232,16,v193
M v[52:55],v[216:219],v[228:231],v[52:55]
v_lshlrev_b32 v233,16,v197
v_lshlrev_b32 v237,16,v195
M v[56:59],v[216:219],a[212:215],v[56:59]
v_lshlrev_b32 v236,16,v203
v_lshlrev_b32 v235,16,v201
M v[56:59],a[200:203],v[224:227],v[56:59]
v_fmac_f32 v232,s43,v234
v_fmac_f32 v237,4.0,v233
M v[56:59],a[192:195],a[228:231],v[56:59]
v_fma_f32 v238,-4.0,v234,v236
v_fmac_f32 v232,s45,v236
M v[60:63],a[192:195],a[248:251],v[60:63]
buffer_load_dwordx4 a[192:195],v250,s[20:23],s47 offen offset:1024 sc1
M v[60:63],a[200:203],a[228:231],v[60:63]
v_fmac_f32 v237,s41,v235
v_sub_f32 v236,v236,v234
M v[60:63],v[216:219],v[224:227],v[60:63]
s_waitcnt vmcnt(16)
buffer_load_dwordx4 a[200:203],v250,s[20:23],s47 offen offset:2048 sc1
M v[64:67],a[196:199],a[204:207],v[64:67]
s_waitcnt vmcnt(16)
s_add_u32 s48,s73,43008
v_fma_f32 v234,-4.0,v233,v235
v_sub_f32 v235,v235,v233
M v[64:67],a[220:223],a[236:239],v[64:67]
s_waitcnt vmcnt(15)
v_add_f32 v233,v238,v234
v_sub_f32 v238,v238,v234
M v[64:67],a[208:211],v[220:223],v[64:67]
v_fma_f32 v234,2.0,v235,v236
v_fmac_f32 v236,-2.0,v235
M v[68:71],a[208:211],a[224:227],v[68:71]
buffer_load_dwordx4 v[216:219],v250,s[20:23],s48 offen offset:0 sc1
M v[68:71],a[220:223],v[220:223],v[68:71]
v_and_b32 v199,s42,v199
v_and_b32 v193,s42,v193
M v[68:71],a[196:199],a[236:239],v[68:71]
v_and_b32 v197,s42,v197
v_and_b32 v195,s42,v195
M v[72:75],a[196:199],v[220:223],v[72:75]
v_and_b32 v203,s42,v203
v_and_b32 v201,s42,v201
M v[72:75],a[220:223],a[224:227],v[72:75]
buffer_load_dwordx4 a[204:207],v250,s[20:23],s48 offen offset:1024 sc1
M v[72:75],a[208:211],a[244:247],v[72:75]
v_fmac_f32 v193,s43,v199
v_fmac_f32 v195,4.0,v197
M v[76:79],a[208:211],v[228:231],v[76:79]
v_fma_f32 v235,-4.0,v199,v203
v_fmac_f32 v193,s45,v203
M v[76:79],a[220:223],a[244:247],v[76:79]
v_fmac_f32 v195,s41,v201
v_sub_f32 v203,v203,v199
M v[76:79],a[196:199],a[224:227],v[76:79]
buffer_load_dwordx4 a[236:239],v250,s[20:23],s48 offen offset:2048 sc1
M v[80:83],a[196:199],a[244:247],v[80:83]
s_add_u32 s46,s74,9216
v_fma_f32 v199,-4.0,v197,v201
v_sub_f32 v201,v201,v197
M v[80:83],a[220:223],v[228:231],v[80:83]
v_add_f32 v197,v235,v199
v_sub_f32 v235,v235,v199
M v[80:83],a[208:211],a[212:215],v[80:83]
v_fma_f32 v199,2.0,v201,v203
v_fmac_f32 v203,-2.0,v201
M v[84:87],a[208:211],v[224:227],v[84:87]
buffer_load_dwordx4 v[220:223],v250,s[20:23],s46 offen offset:0 sc1
M v[84:87],a[220:223],a[212:215],v[84:87]
ds_read_b128 a[224:227],v248 offset:60928
v_cvt_pk_bf16_f32 v193,v232,v193
M v[84:87],a[196:199],v[228:231],v[84:87]
ds_read_b128 a[244:247],v249 offset:60928
v_cvt_pk_bf16_f32 v195,v237,v195
M v[88:91],a[196:199],a[212:215],v[88:91]
ds_read_b128 v[228:231],v248 offset:61440
v_cvt_pk_bf16_f32 v197,v233,v197
M v[88:91],a[220:223],v[224:227],v[88:91]
ds_read_b128 a[212:215],v249 offset:61440
v_cvt_pk_bf16_f32 v201,v234,v199
M v[88:91],a[208:211],a[228:231],v[88:91]
v_cvt_pk_bf16_f32 v199,v238,v235
v_cvt_pk_bf16_f32 v203,v236,v203
M v[92:95],a[208:211],a[248:251],v[92:95]
s_waitcnt vmcnt(16)
v_permlane32_swap_b32 v208,v210
v_permlane32_swap_b32 v204,v206
M v[92:95],a[220:223],a[228:231],v[92:95]
s_waitcnt vmcnt(15)
v_permlane32_swap_b32 v212,v214
v_lshlrev_b32 v234,16,v210
M v[92:95],a[196:199],v[224:227],v[92:95]
s_waitcnt lgkmcnt(3)
ds_write2st64_b64 v247,v[192:193],v[194:195] offset0:206 offset1:223
M v[96:99],a[232:235],a[224:227],v[96:99]
s_waitcnt vmcnt(8) lgkmcnt(3)
s_add_u32 s28,s69,6291456
buffer_load_dwordx4 v[192:195],v251,s[88:91],s28 offen offset:0
M v[96:99],a[240:243],a[244:247],v[96:99]
s_waitcnt vmcnt(8) lgkmcnt(2)
ds_read_b128 a[208:211],v248 offset:61952
ds_read_b128 a[248:251],v249 offset:61952
M v[96:99],a[216:219],v[228:231],v[96:99]
s_waitcnt lgkmcnt(3)
ds_write2st64_b64 v247,v[196:197],v[198:199] offset0:36 offset1:53
M v[100:103],a[216:219],a[212:215],v[100:103]
buffer_load_dwordx4 v[196:199],v245,s[8:11],s28 offen offset:0
M v[100:103],a[240:243],v[228:231],v[100:103]
v_lshlrev_b32 v232,16,v204
v_lshlrev_b32 v233,16,v208
M v[100:103],a[232:235],a[244:247],v[100:103]
ds_write2st64_b64 v247,v[200:201],v[202:203] offset0:70 offset1:87
M v[104:107],a[232:235],v[228:231],v[104:107]
buffer_load_dwordx4 v[200:203],v245,s[8:11],s28 offen offset:768
M v[104:107],a[240:243],a[212:215],v[104:107]
s_waitcnt lgkmcnt(3)
ds_read_b128 a[220:223],v248 offset:62464
ds_read_b128 a[228:231],v249 offset:62464
M v[104:107],a[216:219],a[208:211],v[104:107]
s_waitcnt lgkmcnt(4)
v_lshlrev_b32 v237,16,v206
v_lshlrev_b32 v236,16,v214
M v[108:111],a[216:219],a[248:251],v[108:111]
v_lshlrev_b32 v235,16,v212
v_fmac_f32 v232,s43,v234
M v[108:111],a[240:243],a[208:211],v[108:111]
v_fmac_f32 v237,4.0,v233
v_fma_f32 v238,-4.0,v234,v236
M v[108:111],a[232:235],a[212:215],v[108:111]
v_fmac_f32 v232,s45,v236
v_fmac_f32 v237,s41,v235
M v[112:115],a[232:235],a[208:211],v[112:115]
ds_read_b128 a[196:199],v249 offset:62976
v_sub_f32 v236,v236,v234
M v[112:115],a[240:243],a[248:251],v[112:115]
s_waitcnt lgkmcnt(2)
ds_read_b128 v[224:227],v248 offset:62976
v_fma_f32 v234,-4.0,v233,v235
M v[112:115],a[216:219],a[220:223],v[112:115]
s_waitcnt lgkmcnt(2)
v_sub_f32 v235,v235,v233
v_add_f32 v233,v238,v234
M v[116:119],a[216:219],a[228:231],v[116:119]
v_sub_f32 v238,v238,v234
v_fma_f32 v234,2.0,v235,v236
M v[116:119],a[240:243],a[220:223],v[116:119]
v_fmac_f32 v236,-2.0,v235
v_and_b32 v210,s42,v210
M v[116:119],a[232:235],a[248:251],v[116:119]
v_and_b32 v204,s42,v204
v_and_b32 v208,s42,v208
M v[120:123],a[232:235],a[220:223],v[120:123]
v_and_b32 v206,s42,v206
v_and_b32 v214,s42,v214
M v[120:123],a[240:243],a[228:231],v[120:123]
s_waitcnt lgkmcnt(1)
v_and_b32 v212,s42,v212
v_fmac_f32 v204,s43,v210
M v[120:123],a[216:219],a[196:199],v[120:123]
s_waitcnt lgkmcnt(0)
v_fmac_f32 v206,4.0,v208
v_fma_f32 v235,-4.0,v210,v214
M v[124:127],a[216:219],v[224:227],v[124:127]
buffer_load_dwordx4 a[216:219],v250,s[20:23],s46 offen offset:1024 sc1
M v[124:127],a[240:243],a[196:199],v[124:127]
v_fmac_f32 v204,s45,v214
v_fmac_f32 v206,s41,v212
M v[124:127],a[232:235],a[228:231],v[124:127]
s_waitcnt vmcnt(10)
buffer_load_dwordx4 a[240:243],v250,s[20:23],s46 offen offset:2048 sc1
M v[128:131],a[252:255],a[224:227],v[128:131]
s_waitcnt vmcnt(10)
s_add_u32 s47,s74,12288
v_sub_f32 v214,v214,v210
v_fma_f32 v210,-4.0,v208,v212
M v[128:131],a[192:195],a[244:247],v[128:131]
s_waitcnt vmcnt(9)
v_sub_f32 v212,v212,v208
v_add_f32 v208,v235,v210
M v[128:131],a[200:203],v[228:231],v[128:131]
v_sub_f32 v235,v235,v210
v_fma_f32 v210,2.0,v212,v214
M v[132:135],a[200:203],a[212:215],v[132:135]
buffer_load_dwordx4 a[232:235],v250,s[20:23],s47 offen offset:0 sc1
M v[132:135],a[192:195],v[228:231],v[132:135]
v_fmac_f32 v214,-2.0,v212
v_cvt_pk_bf16_f32 v204,v232,v204
M v[132:135],a[252:255],a[244:247],v[132:135]
v_cvt_pk_bf16_f32 v206,v237,v206
v_cvt_pk_bf16_f32 v208,v233,v208
M v[136:139],a[252:255],v[228:231],v[136:139]
v_cvt_pk_bf16_f32 v212,v234,v210
v_cvt_pk_bf16_f32 v210,v238,v235
M v[136:139],a[192:195],a[212:215],v[136:139]
v_cvt_pk_bf16_f32 v214,v236,v214
v_permlane32_swap_b32 v209,v211
M v[136:139],a[200:203],a[208:211],v[136:139]
v_permlane32_swap_b32 v205,v207
v_permlane32_swap_b32 v213,v215
M v[140:143],a[200:203],a[248:251],v[140:143]
v_lshlrev_b32 v234,16,v211
v_lshlrev_b32 v232,16,v205
M v[140:143],a[192:195],a[208:211],v[140:143]
v_lshlrev_b32 v233,16,v209
v_lshlrev_b32 v237,16,v207
M v[140:143],a[252:255],a[212:215],v[140:143]
v_lshlrev_b32 v236,16,v215
v_lshlrev_b32 v235,16,v213
M v[144:147],a[252:255],a[208:211],v[144:147]
v_fmac_f32 v232,s43,v234
v_fmac_f32 v237,4.0,v233
M v[144:147],a[192:195],a[248:251],v[144:147]
v_fma_f32 v238,-4.0,v234,v236
v_fmac_f32 v232,s45,v236
M v[144:147],a[200:203],a[220:223],v[144:147]
v_fmac_f32 v237,s41,v235
v_sub_f32 v236,v236,v234
M v[148:151],a[200:203],a[228:231],v[148:151]
v_fma_f32 v234,-4.0,v233,v235
v_sub_f32 v235,v235,v233
M v[148:151],a[192:195],a[220:223],v[148:151]
v_add_f32 v233,v238,v234
v_sub_f32 v238,v238,v234
M v[148:151],a[252:255],a[248:251],v[148:151]
v_fma_f32 v234,2.0,v235,v236
v_fmac_f32 v236,-2.0,v235
M v[152:155],a[252:255],a[220:223],v[152:155]
v_and_b32 v211,s42,v211
v_and_b32 v205,s42,v205
M v[152:155],a[192:195],a[228:231],v[152:155]
v_and_b32 v209,s42,v209
v_and_b32 v207,s42,v207
M v[152:155],a[200:203],a[196:199],v[152:155]
v_and_b32 v215,s42,v215
v_and_b32 v213,s42,v213
M v[156:159],a[200:203],v[224:227],v[156:159]
buffer_load_dwordx4 a[200:203],v250,s[20:23],s47 offen offset:1024 sc1
M v[156:159],a[192:195],a[196:199],v[156:159]
v_fmac_f32 v205,s43,v211
v_fmac_f32 v207,4.0,v209
M v[156:159],a[252:255],a[228:231],v[156:159]
s_waitcnt vmcnt(10)
buffer_load_dwordx4 a[192:195],v250,s[20:23],s47 offen offset:2048 sc1
M v[160:163],v[216:219],a[224:227],v[160:163]
s_waitcnt vmcnt(10)
s_add_u32 s48,s74,15360
v_fma_f32 v235,-4.0,v211,v215
v_fmac_f32 v205,s45,v215
v_fmac_f32 v207,s41,v213
M v[160:163],a[204:207],a[244:247],v[160:163]
s_waitcnt vmcnt(9)
v_sub_f32 v215,v215,v211
v_fma_f32 v211,-4.0,v209,v213
v_sub_f32 v213,v213,v209
v_add_f32 v209,v235,v211
M v[160:163],a[236:239],v[228:231],v[160:163]
v_sub_f32 v235,v235,v211
v_fma_f32 v211,2.0,v213,v215
v_fmac_f32 v215,-2.0,v213
v_cvt_pk_bf16_f32 v205,v232,v205
M v[164:167],a[236:239],a[212:215],v[164:167]
buffer_load_dwordx4 a[252:255],v250,s[20:23],s48 offen offset:0 sc1
v_cvt_pk_bf16_f32 v207,v237,v207
v_cvt_pk_bf16_f32 v209,v233,v209
v_cvt_pk_bf16_f32 v213,v234,v211
v_cvt_pk_bf16_f32 v211,v238,v235
M v[164:167],a[204:207],v[228:231],v[164:167]
s_waitcnt vmcnt(7)
v_cvt_pk_bf16_f32 v215,v236,v215
v_permlane32_swap_b32 v196,v198
M v[164:167],v[216:219],a[244:247],v[164:167]
buffer_load_dwordx4 a[224:227],v250,s[20:23],s48 offen offset:1024 sc1
ds_write2st64_b64 v247,v[204:205],v[206:207] offset0:207 offset1:224
M v[168:171],v[216:219],v[228:231],v[168:171]
s_waitcnt vmcnt(7)
s_add_u32 s28,s69,6684672
v_permlane32_swap_b32 v192,v194
v_permlane32_swap_b32 v200,v202
M v[168:171],a[204:207],a[212:215],v[168:171]
v_lshlrev_b32 v234,16,v198
v_lshlrev_b32 v232,16,v192
M v[168:171],a[236:239],a[208:211],v[168:171]
buffer_load_dwordx4 a[244:247],v250,s[20:23],s48 offen offset:2048 sc1
ds_write2st64_b64 v247,v[208:209],v[210:211] offset0:37 offset1:54
M v[172:175],a[236:239],a[248:251],v[172:175]
s_add_u32 s46,s74,18432
v_lshlrev_b32 v233,16,v196
v_lshlrev_b32 v237,16,v194
M v[172:175],a[204:207],a[208:211],v[172:175]
v_lshlrev_b32 v236,16,v202
v_lshlrev_b32 v235,16,v200
M v[172:175],v[216:219],a[212:215],v[172:175]
buffer_load_dwordx4 v[228:231],v250,s[20:23],s46 offen offset:0 sc1
ds_write2st64_b64 v247,v[212:213],v[214:215] offset0:71 offset1:88
M v[176:179],v[216:219],a[208:211],v[176:179]
v_fmac_f32 v232,s43,v234
v_fmac_f32 v237,4.0,v233
M v[176:179],a[204:207],a[248:251],v[176:179]
buffer_load_dwordx4 v[204:207],v251,s[88:91],s28 offen offset:0
M v[176:179],a[236:239],a[220:223],v[176:179]
s_waitcnt lgkmcnt(0)
s_barrier
v_fma_f32 v238,-4.0,v234,v236
M v[180:183],a[236:239],a[228:231],v[180:183]
v_fmac_f32 v232,s45,v236
v_fmac_f32 v237,s41,v235
M v[180:183],a[204:207],a[220:223],v[180:183]
ds_read_b128 a[212:215],v248 offset:0
v_sub_f32 v236,v236,v234
M v[180:183],v[216:219],a[248:251],v[180:183]
buffer_load_dwordx4 v[208:211],v245,s[8:11],s28 offen offset:0
M v[184:187],v[216:219],a[220:223],v[184:187]
ds_read_b128 a[208:211],v249 offset:0
ds_read_b128 a[248:251],v248 offset:512
M v[184:187],a[204:207],a[228:231],v[184:187]
ds_read_b128 a[220:223],v249 offset:512
v_fma_f32 v234,-4.0,v233,v235
M v[184:187],a[236:239],a[196:199],v[184:187]
v_sub_f32 v235,v235,v233
v_add_f32 v233,v238,v234
M v[188:191],a[236:239],v[224:227],v[188:191]
buffer_load_dwordx4 v[212:215],v245,s[8:11],s28 offen offset:768
M v[188:191],a[204:207],a[196:199],v[188:191]
v_sub_f32 v238,v238,v234
v_fma_f32 v234,2.0,v235,v236
M v[188:191],v[216:219],a[228:231],v[188:191]
s_waitcnt lgkmcnt(3)
v_fmac_f32 v236,-2.0,v235
v_and_b32 v198,s42,v198
M a[0:3],v[220:223],a[212:215],a[0:3]
s_waitcnt vmcnt(11) lgkmcnt(2)
ds_read_b128 a[236:239],v248 offset:1024
v_and_b32 v192,s42,v192
M a[0:3],a[216:219],a[208:211],a[0:3]
s_waitcnt vmcnt(10) lgkmcnt(2)
ds_read_b128 v[224:227],v249 offset:1024
v_and_b32 v196,s42,v196
M a[0:3],a[240:243],a[248:251],a[0:3]
s_waitcnt lgkmcnt(2)
v_and_b32 v194,s42,v194
v_and_b32 v202,s42,v202
M a[4:7],a[240:243],a[220:223],a[4:7]
v_and_b32 v200,s42,v200
v_fmac_f32 v192,s43,v198
M a[4:7],a[216:219],a[248:251],a[4:7]
v_fmac_f32 v194,4.0,v196
v_fma_f32 v235,-4.0,v198,v202
M a[4:7],v[220:223],a[208:211],a[4:7]
v_fmac_f32 v192,s45,v202
v_fmac_f32 v194,s41,v200
M a[8:11],v[220:223],a[248:251],a[8:11]
ds_read_b128 a[196:199],v248 offset:1536
v_sub_f32 v202,v202,v198
M a[8:11],a[216:219],a[220:223],a[8:11]
s_waitcnt lgkmcnt(2)
ds_read_b128 a[204:207],v249 offset:1536
v_fma_f32 v198,-4.0,v196,v200
M a[8:11],a[240:243],a[236:239],a[8:11]
s_waitcnt lgkmcnt(2)
v_sub_f32 v200,v200,v196
v_add_f32 v196,v235,v198
M a[12:15],a[240:243],v[224:227],a[12:15]
v_sub_f32 v235,v235,v198
v_fma_f32 v198,2.0,v200,v202
M a[12:15],a[216:219],a[236:239],a[12:15]
v_fmac_f32 v202,-2.0,v200
v_cvt_pk_bf16_f32 v192,v232,v192
M a[12:15],v[220:223],a[220:223],a[12:15]
v_cvt_pk_bf16_f32 v194,v237,v194
v_cvt_pk_bf16_f32 v196,v233,v196
M a[16:19],v[220:223],a[236:239],a[16:19]
ds_read_b128 a[228:231],v249 offset:2048
v_cvt_pk_bf16_f32 v200,v234,v198
M a[16:19],a[216:219],v[224:227],a[16:19]
s_waitcnt lgkmcnt(2)
ds_read_b128 v[216:219],v248 offset:2048
v_cvt_pk_bf16_f32 v198,v238,v235
M a[16:19],a[240:243],a[196:199],a[16:19]
s_waitcnt lgkmcnt(2)
v_cvt_pk_bf16_f32 v202,v236,v202
v_permlane32_swap_b32 v197,v199
M a[20:23],a[240:243],a[204:207],a[20:23]
v_permlane32_swap_b32 v193,v195
v_permlane32_swap_b32 v201,v203
M a[20:23],a[216:219],a[196:199],a[20:23]
v_lshlrev_b32 v234,16,v199
v_lshlrev_b32 v232,16,v193
M a[20:23],v[220:223],v[224:227],a[20:23]
v_lshlrev_b32 v233,16,v197
v_lshlrev_b32 v237,16,v195
M a[24:27],v[220:223],a[196:199],a[24:27]
v_lshlrev_b32 v236,16,v203
v_lshlrev_b32 v235,16,v201
M a[24:27],a[216:219],a[204:207],a[24:27]
s_waitcnt lgkmcnt(1)
v_fmac_f32 v232,s43,v234
v_fmac_f32 v237,4.0,v233
M a[24:27],a[240:243],a[228:231],a[24:27]
s_waitcnt lgkmcnt(0)
v_fma_f32 v238,-4.0,v234,v236
v_fmac_f32 v232,s45,v236
M a[28:31],a[240:243],v[216:219],a[28:31]
buffer_load_dwordx4 a[240:243],v250,s[20:23],s46 offen offset:1024 sc1
M a[28:31],a[216:219],a[228:231],a[28:31]
v_fmac_f32 v237,s41,v235
v_sub_f32 v236,v236,v234
M a[28:31],v[220:223],a[204:207],a[28:31]
s_waitcnt vmcnt(10)
buffer_load_dwordx4 a[216:219],v250,s[20:23],s46 offen offset:2048 sc1
M a[32:35],a[232:235],a[212:215],a[32:35]
s_waitcnt vmcnt(10)
s_add_u32 s47,s74,21504
v_fma_f32 v234,-4.0,v233,v235
v_sub_f32 v235,v235,v233
M a[32:35],a[200:203],a[208:211],a[32:35]
s_waitcnt vmcnt(9)
v_add_f32 v233,v238,v234
v_sub_f32 v238,v238,v234
M a[32:35],a[192:195],a[248:251],a[32:35]
v_fma_f32 v234,2.0,v235,v236
v_fmac_f32 v236,-2.0,v235
M a[36:39],a[192:195],a[220:223],a[36:39]
buffer_load_dwordx4 v[220:223],v250,s[20:23],s47 offen offset:0 sc1
M a[36:39],a[200:203],a[248:251],a[36:39]
v_and_b32 v199,s42,v199
v_and_b32 v193,s42,v193
M a[36:39],a[232:235],a[208:211],a[36:39]
v_and_b32 v197,s42,v197
v_and_b32 v195,s42,v195
M a[40:43],a[232:235],a[248:251],a[40:43]
v_and_b32 v203,s42,v203
v_and_b32 v201,s42,v201
M a[40:43],a[200:203],a[220:223],a[40:43]
v_fmac_f32 v193,s43,v199
v_fmac_f32 v195,4.0,v197
M a[40:43],a[192:195],a[236:239],a[40:43]
v_fma_f32 v235,-4.0,v199,v203
v_fmac_f32 v193,s45,v203
M a[44:47],a[192:195],v[224:227],a[44:47]
v_fmac_f32 v195,s41,v201
v_sub_f32 v203,v203,v199
M a[44:47],a[200:203],a[236:239],a[44:47]
v_fma_f32 v199,-4.0,v197,v201
v_sub_f32 v201,v201,v197
M a[44:47],a[232:235],a[220:223],a[44:47]
v_add_f32 v197,v235,v199
v_sub_f32 v235,v235,v199
M a[48:51],a[232:235],a[236:239],a[48:51]
v_fma_f32 v199,2.0,v201,v203
v_fmac_f32 v203,-2.0,v201
M a[48:51],a[200:203],v[224:227],a[48:51]
v_cvt_pk_bf16_f32 v193,v232,v193
v_cvt_pk_bf16_f32 v195,v237,v195
M a[48:51],a[192:195],a[196:199],a[48:51]
v_cvt_pk_bf16_f32 v197,v233,v197
v_cvt_pk_bf16_f32 v201,v234,v199
M a[52:55],a[192:195],a[204:207],a[52:55]
v_cvt_pk_bf16_f32 v199,v238,v235
v_cvt_pk_bf16_f32 v203,v236,v203
M a[52:55],a[200:203],a[196:199],a[52:55]
s_waitcnt vmcnt(4)
v_permlane32_swap_b32 v208,v210
v_permlane32_swap_b32 v204,v206
M a[52:55],a[232:235],v[224:227],a[52:55]
s_add_u32 s31,s75,s85
ds_write2st64_b64 v247,v[192:193],v[194:195] offset0:238 offset1:255
M a[56:59],a[232:235],a[196:199],a[56:59]
s_add_u32 s28,s69,7077888
buffer_load_dwordx4 v[192:195],v251,s[88:91],s28 offen offset:0
M a[56:59],a[200:203],a[204:207],a[56:59]
s_waitcnt vmcnt(4)
v_permlane32_swap_b32 v212,v214
v_lshlrev_b32 v234,16,v210
M a[56:59],a[192:195],a[228:231],a[56:59]
ds_write2st64_b64 v247,v[196:197],v[198:199] offset0:0 offset1:17
M a[60:63],a[192:195],v[216:219],a[60:63]
buffer_load_dwordx4 v[196:199],v245,s[8:11],s28 offen offset:0
M a[60:63],a[200:203],a[228:231],a[60:63]
v_lshlrev_b32 v232,16,v204
v_lshlrev_b32 v233,16,v208
M a[60:63],a[232:235],a[204:207],a[60:63]
ds_write2st64_b64 v247,v[200:201],v[202:203] offset0:136 offset1:153
M a[64:67],a[252:255],a[212:215],a[64:67]
buffer_load_dwordx4 v[200:203],v245,s[8:11],s28 offen offset:768
M a[64:67],a[224:227],a[208:211],a[64:67]
v_lshlrev_b32 v237,16,v206
v_lshlrev_b32 v236,16,v214
M a[64:67],a[244:247],a[248:251],a[64:67]
v_lshlrev_b32 v235,16,v212
v_fmac_f32 v232,s43,v234
M a[68:71],a[244:247],a[220:223],a[68:71]
buffer_load_dword a192,v250,s[20:23],s31 offen offset:0 sc1
M a[68:71],a[224:227],a[248:251],a[68:71]
v_fmac_f32 v237,4.0,v233
v_fma_f32 v238,-4.0,v234,v236
M a[68:71],a[252:255],a[208:211],a[68:71]
v_fmac_f32 v232,s45,v236
v_fmac_f32 v237,s41,v235
M a[72:75],a[252:255],a[248:251],a[72:75]
v_sub_f32 v236,v236,v234
v_fma_f32 v234,-4.0,v233,v235
M a[72:75],a[224:227],a[220:223],a[72:75]
buffer_load_dword a192,v250,s[20:23],s31 offen offset:128 sc1
M a[72:75],a[244:247],a[236:239],a[72:75]
v_sub_f32 v235,v235,v233
v_add_f32 v233,v238,v234
M a[76:79],a[244:247],v[224:227],a[76:79]
buffer_load_dwordx4 a[192:195],v250,s[20:23],s47 offen offset:1024 sc1
M a[76:79],a[224:227],a[236:239],a[76:79]
buffer_load_dwordx4 a[200:203],v250,s[20:23],s47 offen offset:2048 sc1
M a[76:79],a[252:255],a[220:223],a[76:79]
s_add_u32 s48,s74,24576
v_sub_f32 v238,v238,v234
v_fma_f32 v234,2.0,v235,v236
M a[80:83],a[252:255],a[236:239],a[80:83]
v_fmac_f32 v236,-2.0,v235
v_and_b32 v210,s42,v210
M a[80:83],a[224:227],v[224:227],a[80:83]
v_and_b32 v204,s42,v204
v_and_b32 v208,s42,v208
M a[80:83],a[244:247],a[196:199],a[80:83]
v_and_b32 v206,s42,v206
v_and_b32 v214,s42,v214
M a[84:87],a[244:247],a[204:207],a[84:87]
v_and_b32 v212,s42,v212
v_fmac_f32 v204,s43,v210
M a[84:87],a[224:227],a[196:199],a[84:87]
ds_read_b128 a[220:223],v248 offset:8704
v_fmac_f32 v206,4.0,v208
M a[84:87],a[252:255],v[224:227],a[84:87]
ds_read_b128 a[236:239],v249 offset:8704
v_fma_f32 v235,-4.0,v210,v214
M a[88:91],a[252:255],a[196:199],a[88:91]
ds_read_b128 v[224:227],v248 offset:9216
v_fmac_f32 v204,s45,v214
M a[88:91],a[224:227],a[204:207],a[88:91]
buffer_load_dwordx4 a[232:235],v250,s[20:23],s48 offen offset:0 sc1
M a[88:91],a[244:247],a[228:231],a[88:91]
ds_read_b128 a[196:199],v249 offset:9216
v_fmac_f32 v206,s41,v212
M a[92:95],a[244:247],v[216:219],a[92:95]
v_sub_f32 v214,v214,v210
v_fma_f32 v210,-4.0,v208,v212
M a[92:95],a[224:227],a[228:231],a[92:95]
v_sub_f32 v212,v212,v208
v_add_f32 v208,v235,v210
M a[92:95],a[252:255],a[204:207],a[92:95]
s_waitcnt lgkmcnt(3)
buffer_load_dwordx4 a[212:215],v250,s[20:23],s48 offen offset:1024 sc1
M a[96:99],v[228:231],a[220:223],a[96:99]
s_waitcnt vmcnt(11) lgkmcnt(2)
ds_read_b128 a[244:247],v248 offset:9728
v_sub_f32 v235,v235,v210
M a[96:99],a[240:243],a[236:239],a[96:99]
s_waitcnt vmcnt(10) lgkmcnt(2)
ds_read_b128 v[216:219],v249 offset:9728
v_fma_f32 v210,2.0,v212,v214
M a[96:99],a[216:219],v[224:227],a[96:99]
s_waitcnt lgkmcnt(2)
v_fmac_f32 v214,-2.0,v212
v_cvt_pk_bf16_f32 v204,v232,v204
M a[100:103],a[216:219],a[196:199],a[100:103]
buffer_load_dwordx4 a[208:211],v250,s[20:23],s48 offen offset:2048 sc1
M a[100:103],a[240:243],v[224:227],a[100:103]
s_add_u32 s46,s74,27648
v_cvt_pk_bf16_f32 v206,v237,v206
v_cvt_pk_bf16_f32 v208,v233,v208
M a[100:103],v[228:231],a[236:239],a[100:103]
v_cvt_pk_bf16_f32 v212,v234,v210
v_cvt_pk_bf16_f32 v210,v238,v235
M a[104:107],v[228:231],v[224:227],a[104:107]
ds_read_b128 a[224:227],v248 offset:10240
v_cvt_pk_bf16_f32 v214,v236,v214
M a[104:107],a[240:243],a[196:199],a[104:107]
s_waitcnt lgkmcnt(2)
buffer_load_dwordx4 a[248:251],v250,s[20:23],s46 offen offset:0 sc1
M a[104:107],a[216:219],a[244:247],a[104:107]
s_waitcnt lgkmcnt(1)
ds_read_b128 a[228:231],v249 offset:10240
v_permlane32_swap_b32 v209,v211
M a[108:111],a[216:219],v[216:219],a[108:111]
v_permlane32_swap_b32 v205,v207
v_permlane32_swap_b32 v213,v215
M a[108:111],a[240:243],a[244:247],a[108:111]
v_lshlrev_b32 v234,16,v211
v_lshlrev_b32 v232,16,v205
M a[108:111],v[228:231],a[196:199],a[108:111]
v_lshlrev_b32 v233,16,v209
v_lshlrev_b32 v237,16,v207
M a[112:115],v[228:231],a[244:247],a[112:115]
ds_read_b128 a[204:207],v249 offset:10752
v_lshlrev_b32 v236,16,v215
M a[112:115],a[240:243],v[216:219],a[112:115]
s_waitcnt lgkmcnt(2)
ds_read_b128 a[252:255],v248 offset:10752
v_lshlrev_b32 v235,16,v213
M a[112:115],a[216:219],a[224:227],a[112:115]
s_waitcnt lgkmcnt(2)
v_fmac_f32 v232,s43,v234
v_fmac_f32 v237,4.0,v233
M a[116:119],a[216:219],a[228:231],a[116:119]
v_fma_f32 v238,-4.0,v234,v236
v_fmac_f32 v232,s45,v236
M a[116:119],a[240:243],a[224:227],a[116:119]
v_fmac_f32 v237,s41,v235
v_sub_f32 v236,v236,v234
M a[116:119],v[228:231],v[216:219],a[116:119]
v_fma_f32 v234,-4.0,v233,v235
v_sub_f32 v235,v235,v233
M a[120:123],v[228:231],a[224:227],a[120:123]
v_add_f32 v233,v238,v234
v_sub_f32 v238,v238,v234
M a[120:123],a[240:243],a[228:231],a[120:123]
s_waitcnt lgkmcnt(1)
v_fma_f32 v234,2.0,v235,v236
v_fmac_f32 v236,-2.0,v235
M a[120:123],a[216:219],a[204:207],a[120:123]
s_waitcnt lgkmcnt(0)
v_and_b32 v211,s42,v211
v_and_b32 v205,s42,v205
M a[124:127],a[216:219],a[252:255],a[124:127]
buffer_load_dwordx4 a[216:219],v250,s[20:23],s46 offen offset:1024 sc1
M a[124:127],a[240:243],a[204:207],a[124:127]
v_and_b32 v209,s42,v209
v_and_b32 v207,s42,v207
M a[124:127],v[228:231],a[228:231],a[124:127]
s_waitcnt vmcnt(12)
buffer_load_dwordx4 a[240:243],v250,s[20:23],s46 offen offset:2048 sc1
M a[128:131],v[220:223],a[220:223],a[128:131]
s_waitcnt vmcnt(7)
s_add_u32 s47,s74,30720
v_and_b32 v215,s42,v215
v_and_b32 v213,s42,v213
M a[128:131],a[192:195],a[236:239],a[128:131]
s_waitcnt vmcnt(6)
v_fmac_f32 v205,s43,v211
v_fmac_f32 v207,4.0,v209
M a[128:131],a[200:203],v[224:227],a[128:131]
v_fma_f32 v235,-4.0,v211,v215
v_fmac_f32 v205,s45,v215
M a[132:135],a[200:203],a[196:199],a[132:135]
buffer_load_dwordx4 v[228:231],v250,s[20:23],s47 offen offset:0 sc1
M a[132:135],a[192:195],v[224:227],a[132:135]
v_fmac_f32 v207,s41,v213
v_sub_f32 v215,v215,v211
M a[132:135],v[220:223],a[236:239],a[132:135]
v_fma_f32 v211,-4.0,v209,v213
v_sub_f32 v213,v213,v209
M a[136:139],v[220:223],v[224:227],a[136:139]
v_add_f32 v209,v235,v211
v_sub_f32 v235,v235,v211
M a[136:139],a[192:195],a[196:199],a[136:139]
v_fma_f32 v211,2.0,v213,v215
v_fmac_f32 v215,-2.0,v213
M a[136:139],a[200:203],a[244:247],a[136:139]
v_cvt_pk_bf16_f32 v205,v232,v205
v_cvt_pk_bf16_f32 v207,v237,v207
M a[140:143],a[200:203],v[216:219],a[140:143]
v_cvt_pk_bf16_f32 v209,v233,v209
v_cvt_pk_bf16_f32 v213,v234,v211
M a[140:143],a[192:195],a[244:247],a[140:143]
v_cvt_pk_bf16_f32 v211,v238,v235
v_cvt_pk_bf16_f32 v215,v236,v215
M a[140:143],v[220:223],a[196:199],a[140:143]
v_add_u32 v238,121856,v247
v_fmac_f32 v239,s43,v241
M a[144:147],v[220:223],a[244:247],a[144:147]
v_fmac_f32 v244,4.0,v240
v_fma_f32 v232,-4.0,v241,v243
M a[144:147],a[192:195],v[216:219],a[144:147]
v_fmac_f32 v239,s45,v243
v_fmac_f32 v244,s41,v242
M a[144:147],a[200:203],a[224:227],a[144:147]
ds_write2st64_b64 v238,v[204:205],v[206:207] offset0:1 offset1:18
M a[148:151],a[200:203],a[228:231],a[148:151]
s_add_u32 s28,s69,7471104
buffer_load_dwordx4 v[204:207],v251,s[88:91],s28 offen offset:0
M a[148:151],a[192:195],a[224:227],a[148:151]
v_sub_f32 v243,v243,v241
v_fma_f32 v241,-4.0,v240,v242
M a[148:151],v[220:223],v[216:219],a[148:151]
ds_write2st64_b64 v247,v[208:209],v[210:211] offset0:1 offset1:18
M a[152:155],v[220:223],a[224:227],a[152:155]
buffer_load_dwordx4 v[208:211],v245,s[8:11],s28 offen offset:0
M a[152:155],a[192:195],a[228:231],a[152:155]
v_sub_f32 v242,v242,v240
v_add_f32 v240,v232,v241
M a[152:155],a[200:203],a[204:207],a[152:155]
ds_write2st64_b64 v247,v[212:213],v[214:215] offset0:137 offset1:154
M a[156:159],a[200:203],a[252:255],a[156:159]
buffer_load_dwordx4 a[200:203],v250,s[20:23],s47 offen offset:1024 sc1
M a[156:159],a[192:195],a[204:207],a[156:159]
v_sub_f32 v232,v232,v241
v_fma_f32 v241,2.0,v242,v243
M a[156:159],v[220:223],a[228:231],a[156:159]
s_waitcnt vmcnt(9)
v_fmac_f32 v243,-2.0,v242
v_cvt_pk_bf16_f32 v233,v239,v244
M a[160:163],a[232:235],a[220:223],a[160:163]
s_waitcnt vmcnt(8)
buffer_load_dwordx4 a[192:195],v250,s[20:23],s47 offen offset:2048 sc1
M a[160:163],a[212:215],a[236:239],a[160:163]
s_waitcnt vmcnt(8)
s_add_u32 s48,s74,33792
v_cvt_pk_bf16_f32 v234,v240,v232
v_cvt_pk_bf16_f32 v235,v241,v243
M a[160:163],a[208:211],v[224:227],a[160:163]
v_add_u32 v232,121856,v252
M a[164:167],a[208:211],a[196:199],a[164:167]
ds_write_b16 v232,v233 offset:0
M a[164:167],a[212:215],v[224:227],a[164:167]
buffer_load_dwordx4 v[220:223],v250,s[20:23],s48 offen offset:0 sc1
M a[164:167],a[232:235],a[236:239],a[164:167]
ds_write_b16_d16_hi v232,v233 offset:8704
M a[168:171],a[232:235],v[224:227],a[168:171]
ds_write_b16 v252,v234 offset:0
M a[168:171],a[212:215],a[196:199],a[168:171]
ds_write_b16_d16_hi v252,v234 offset:8704
M a[168:171],a[208:211],a[244:247],a[168:171]
buffer_load_dwordx4 a[220:223],v250,s[20:23],s48 offen offset:1024 sc1
M a[172:175],a[208:211],v[216:219],a[172:175]
v_add_u32 v232,69632,v252
M a[172:175],a[212:215],a[244:247],a[172:175]
ds_write_b16 v232,v235 offset:0
M a[172:175],a[232:235],a[196:199],a[172:175]
ds_write_b16_d16_hi v232,v235 offset:8704
M a[176:179],a[232:235],a[244:247],a[176:179]
buffer_load_dwordx4 a[236:239],v250,s[20:23],s48 offen offset:2048 sc1
M a[176:179],a[212:215],v[216:219],a[176:179]
s_add_u32 s46,s74,36864
v_permlane32_swap_b32 v196,v198
v_permlane32_swap_b32 v192,v194
M a[176:179],a[208:211],a[224:227],a[176:179]
v_permlane32_swap_b32 v200,v202
v_lshlrev_b32 v234,16,v198
M a[180:183],a[208:211],a[228:231],a[180:183]
v_lshlrev_b32 v232,16,v192
v_lshlrev_b32 v233,16,v196
M a[180:183],a[212:215],a[224:227],a[180:183]
buffer_load_dwordx4 v[224:227],v250,s[20:23],s46 offen offset:0 sc1
M a[180:183],a[232:235],v[216:219],a[180:183]
ds_read_b128 a[196:199],v248 offset:17408
ds_read_b128 a[244:247],v249 offset:17408
M a[184:187],a[232:235],a[224:227],a[184:187]
ds_read_b128 v[216:219],v248 offset:17920
v_lshlrev_b32 v237,16,v194
M a[184:187],a[212:215],a[228:231],a[184:187]
ds_read_b128 a[224:227],v249 offset:17920
v_lshlrev_b32 v236,16,v202
M a[184:187],a[208:211],a[204:207],a[184:187]
buffer_load_dwordx4 v[212:215],v245,s[8:11],s28 offen offset:768
M a[188:191],a[208:211],a[252:255],a[188:191]
s_add_u32 s29,s70,6291456
v_lshlrev_b32 v235,16,v200
v_fmac_f32 v232,s43,v234
M a[188:191],a[212:215],a[204:207],a[188:191]
v_fmac_f32 v237,4.0,v233
v_fma_f32 v238,-4.0,v234,v236
M a[188:191],a[232:235],a[228:231],a[188:191]
s_waitcnt vmcnt(12) lgkmcnt(3)
v_fmac_f32 v232,s45,v236
v_fmac_f32 v237,s41,v235
M v[0:3],a[248:251],a[196:199],v[0:3]
s_waitcnt vmcnt(11) lgkmcnt(2)
buffer_load_short_d16_hi v239,v246,s[12:15],s29 offen offset:0
M v[0:3],a[216:219],a[244:247],v[0:3]
s_waitcnt vmcnt(11) lgkmcnt(1)
ds_read_b128 a[208:211],v248 offset:18432
ds_read_b128 a[252:255],v249 offset:18432
M v[0:3],a[240:243],v[216:219],v[0:3]
s_waitcnt lgkmcnt(2)
buffer_load_short_d16_hi v240,v246,s[8:11],s29 offen offset:0
M v[4:7],a[240:243],a[224:227],v[4:7]
v_sub_f32 v236,v236,v234
v_fma_f32 v234,-4.0,v233,v235
M v[4:7],a[216:219],v[216:219],v[4:7]
buffer_load_short_d16_hi v241,v246,s[8:11],s29 offen offset:384
M v[4:7],a[248:251],a[244:247],v[4:7]
v_sub_f32 v235,v235,v233
v_add_f32 v233,v238,v234
M v[8:11],a[248:251],v[216:219],v[8:11]
buffer_load_short_d16_hi v242,v246,s[8:11],s29 offen offset:768
M v[8:11],a[216:219],a[224:227],v[8:11]
s_waitcnt lgkmcnt(1)
ds_read_b128 a[204:207],v248 offset:18944
ds_read_b128 a[212:215],v249 offset:18944
M v[8:11],a[240:243],a[208:211],v[8:11]
s_waitcnt lgkmcnt(2)
buffer_load_short_d16_hi v243,v246,s[8:11],s29 offen offset:1152
M v[12:15],a[240:243],a[252:255],v[12:15]
v_sub_f32 v238,v238,v234
v_fma_f32 v234,2.0,v235,v236
M v[12:15],a[216:219],a[208:211],v[12:15]
buffer_load_short_d16_hi v244,v246,s[16:19],s29 offen offset:1536
M v[12:15],a[248:251],a[224:227],v[12:15]
v_fmac_f32 v236,-2.0,v235
v_and_b32 v198,s42,v198
M v[16:19],a[248:251],a[208:211],v[16:19]
ds_read_b128 a[228:231],v249 offset:19456
v_and_b32 v192,s42,v192
M v[16:19],a[216:219],a[252:255],v[16:19]
s_waitcnt lgkmcnt(2)
ds_read_b128 a[232:235],v248 offset:19456
v_and_b32 v196,s42,v196
M v[16:19],a[240:243],a[204:207],v[16:19]
s_waitcnt lgkmcnt(2)
v_and_b32 v194,s42,v194
v_and_b32 v202,s42,v202
M v[20:23],a[240:243],a[212:215],v[20:23]
v_and_b32 v200,s42,v200
v_fmac_f32 v192,s43,v198
M v[20:23],a[216:219],a[204:207],v[20:23]
v_fmac_f32 v194,4.0,v196
v_fma_f32 v235,-4.0,v198,v202
M v[20:23],a[248:251],a[252:255],v[20:23]
v_fmac_f32 v192,s45,v202
v_fmac_f32 v194,s41,v200
M v[24:27],a[248:251],a[204:207],v[24:27]
v_sub_f32 v202,v202,v198
v_fma_f32 v198,-4.0,v196,v200
M v[24:27],a[216:219],a[212:215],v[24:27]
s_waitcnt lgkmcnt(1)
v_sub_f32 v200,v200,v196
v_add_f32 v196,v235,v198
M v[24:27],a[240:243],a[228:231],v[24:27]
s_waitcnt lgkmcnt(0)
v_sub_f32 v235,v235,v198
v_fma_f32 v198,2.0,v200,v202
M v[28:31],a[240:243],a[232:235],v[28:31]
global_load_dword a240,v250,s[64:65]
M v[28:31],a[216:219],a[228:231],v[28:31]
buffer_load_dwordx4 a[240:243],v250,s[20:23],s46 offen offset:1024 sc1
M v[28:31],a[248:251],a[212:215],v[28:31]
s_waitcnt vmcnt(17)
v_fmac_f32 v202,-2.0,v200
v_cvt_pk_bf16_f32 v192,v232,v192
M v[32:35],v[228:231],a[196:199],v[32:35]
s_waitcnt vmcnt(14)
v_cvt_pk_bf16_f32 v194,v237,v194
v_cvt_pk_bf16_f32 v196,v233,v196
M v[32:35],a[200:203],a[244:247],v[32:35]
s_waitcnt vmcnt(13)
buffer_load_dwordx4 a[216:219],v250,s[20:23],s46 offen offset:2048 sc1
M v[32:35],a[192:195],v[216:219],v[32:35]
s_add_u32 s47,s74,39936
v_cvt_pk_bf16_f32 v200,v234,v198
v_cvt_pk_bf16_f32 v198,v238,v235
M v[36:39],a[192:195],a[224:227],v[36:39]
v_cvt_pk_bf16_f32 v202,v236,v202
v_permlane32_swap_b32 v197,v199
M v[36:39],a[200:203],v[216:219],v[36:39]
v_permlane32_swap_b32 v193,v195
v_permlane32_swap_b32 v201,v203
M v[36:39],v[228:231],a[244:247],v[36:39]
buffer_load_dwordx4 a[248:251],v250,s[20:23],s47 offen offset:0 sc1
M v[40:43],v[228:231],v[216:219],v[40:43]
v_lshlrev_b32 v234,16,v199
v_lshlrev_b32 v232,16,v193
M v[40:43],a[200:203],a[224:227],v[40:43]
v_lshlrev_b32 v233,16,v197
v_lshlrev_b32 v237,16,v195
M v[40:43],a[192:195],a[208:211],v[40:43]
v_lshlrev_b32 v236,16,v203
v_lshlrev_b32 v235,16,v201
M v[44:47],a[192:195],a[252:255],v[44:47]
v_fmac_f32 v232,s43,v234
v_fmac_f32 v237,4.0,v233
M v[44:47],a[200:203],a[208:211],v[44:47]
v_fma_f32 v238,-4.0,v234,v236
v_fmac_f32 v232,s45,v236
M v[44:47],v[228:231],a[224:227],v[44:47]
v_fmac_f32 v237,s41,v235
v_sub_f32 v236,v236,v234
M v[48:51],v[228:231],a[208:211],v[48:51]
v_fma_f32 v234,-4.0,v233,v235
v_sub_f32 v235,v235,v233
M v[48:51],a[200:203],a[252:255],v[48:51]
v_add_f32 v233,v238,v234
v_sub_f32 v238,v238,v234
M v[48:51],a[192:195],a[204:207],v[48:51]
v_fma_f32 v234,2.0,v235,v236
v_fmac_f32 v236,-2.0,v235
M v[52:55],a[192:195],a[212:215],v[52:55]
v_and_b32 v199,s42,v199
v_and_b32 v193,s42,v193
M v[52:55],a[200:203],a[204:207],v[52:55]
v_and_b32 v197,s42,v197
v_and_b32 v195,s42,v195
M v[52:55],v[228:231],a[252:255],v[52:55]
v_and_b32 v203,s42,v203
v_and_b32 v201,s42,v201
M v[56:59],v[228:231],a[204:207],v[56:59]
v_fmac_f32 v193,s43,v199
v_fmac_f32 v195,4.0,v197
M v[56:59],a[200:203],a[212:215],v[56:59]
v_fma_f32 v235,-4.0,v199,v203
v_fmac_f32 v193,s45,v203
M v[56:59],a[192:195],a[228:231],v[56:59]
v_fmac_f32 v195,s41,v201
v_sub_f32 v203,v203,v199
M v[60:63],a[192:195],a[232:235],v[60:63]
buffer_load_dwordx4 a[192:195],v250,s[20:23],s47 offen offset:1024 sc1
M v[60:63],a[200:203],a[228:231],v[60:63]
v_fma_f32 v199,-4.0,v197,v201
v_sub_f32 v201,v201,v197
M v[60:63],v[228:231],a[212:215],v[60:63]
s_waitcnt vmcnt(15)
buffer_load_dwordx4 a[200:203],v250,s[20:23],s47 offen offset:2048 sc1
M v[64:67],v[220:223],a[196:199],v[64:67]
s_waitcnt vmcnt(15)
s_add_u32 s48,s74,43008
v_add_f32 v197,v235,v199
v_sub_f32 v235,v235,v199
M v[64:67],a[220:223],a[244:247],v[64:67]
s_waitcnt vmcnt(14)
v_fma_f32 v199,2.0,v201,v203
v_fmac_f32 v203,-2.0,v201
M v[64:67],a[236:239],v[216:219],v[64:67]
v_cvt_pk_bf16_f32 v193,v232,v193
v_cvt_pk_bf16_f32 v195,v237,v195
M v[68:71],a[236:239],a[224:227],v[68:71]
buffer_load_dwordx4 v[228:231],v250,s[20:23],s48 offen offset:0 sc1
M v[68:71],a[220:223],v[216:219],v[68:71]
v_cvt_pk_bf16_f32 v197,v233,v197
v_cvt_pk_bf16_f32 v201,v234,v199
M v[68:71],v[220:223],a[244:247],v[68:71]
v_cvt_pk_bf16_f32 v199,v238,v235
v_cvt_pk_bf16_f32 v203,v236,v203
M v[72:75],v[220:223],v[216:219],v[72:75]
v_add_u32 v238,121856,v247
v_permlane32_swap_b32 v208,v210
M v[72:75],a[220:223],a[224:227],v[72:75]
buffer_load_dwordx4 a[196:199],v250,s[20:23],s48 offen offset:1024 sc1
M v[72:75],a[236:239],a[208:211],v[72:75]
ds_write2st64_b64 v238,v[192:193],v[194:195] offset0:2 offset1:19
M v[76:79],a[236:239],a[252:255],v[76:79]
s_waitcnt vmcnt(14)
s_add_u32 s28,s70,6291456
v_permlane32_swap_b32 v204,v206
v_permlane32_swap_b32 v212,v214
M v[76:79],a[220:223],a[208:211],v[76:79]
v_lshlrev_b32 v234,16,v210
v_lshlrev_b32 v232,16,v204
M v[76:79],v[220:223],a[224:227],v[76:79]
buffer_load_dwordx4 a[244:247],v250,s[20:23],s48 offen offset:2048 sc1
M v[80:83],v[220:223],a[208:211],v[80:83]
s_add_u32 s46,s75,9216
v_lshlrev_b32 v233,16,v208
v_lshlrev_b32 v237,16,v206
M v[80:83],a[220:223],a[252:255],v[80:83]
v_lshlrev_b32 v236,16,v214
v_lshlrev_b32 v235,16,v212
M v[80:83],a[236:239],a[204:207],v[80:83]
ds_write2st64_b64 v247,v[196:197],v[198:199] offset0:2 offset1:19
M v[84:87],a[236:239],a[212:215],v[84:87]
buffer_load_dwordx4 v[216:219],v250,s[20:23],s46 offen offset:0 sc1
M v[84:87],a[220:223],a[204:207],v[84:87]
ds_read_b128 a[224:227],v248 offset:26112
v_fmac_f32 v232,s43,v234
M v[84:87],v[220:223],a[252:255],v[84:87]
ds_write2st64_b64 v247,v[200:201],v[202:203] offset0:138 offset1:155
M v[88:91],v[220:223],a[204:207],v[88:91]
buffer_load_dwordx4 v[192:195],v251,s[88:91],s28 offen offset:0
M v[88:91],a[220:223],a[212:215],v[88:91]
ds_read_b128 a[208:211],v249 offset:26112
ds_read_b128 a[252:255],v248 offset:26624
M v[88:91],a[236:239],a[228:231],v[88:91]
ds_read_b128 a[204:207],v249 offset:26624
v_fmac_f32 v237,4.0,v233
M v[92:95],a[236:239],a[232:235],v[92:95]
buffer_load_dwordx4 v[196:199],v245,s[8:11],s28 offen offset:0
M v[92:95],a[220:223],a[228:231],v[92:95]
v_fma_f32 v238,-4.0,v234,v236
v_fmac_f32 v232,s45,v236
M v[92:95],v[220:223],a[212:215],v[92:95]
s_waitcnt lgkmcnt(4)
v_fmac_f32 v237,s41,v235
v_sub_f32 v236,v236,v234
M v[96:99],v[224:227],a[224:227],v[96:99]
s_waitcnt vmcnt(10) lgkmcnt(2)
ds_read_b128 a[232:235],v248 offset:27136
v_fma_f32 v234,-4.0,v233,v235
M v[96:99],a[240:243],a[208:211],v[96:99]
s_waitcnt vmcnt(9) lgkmcnt(2)
buffer_load_dwordx4 v[200:203],v245,s[8:11],s28 offen offset:768
M v[96:99],a[216:219],a[252:255],v[96:99]
s_waitcnt lgkmcnt(1)
ds_read_b128 a[236:239],v249 offset:27136
v_sub_f32 v235,v235,v233
M v[100:103],a[216:219],a[204:207],v[100:103]
v_add_f32 v233,v238,v234
v_sub_f32 v238,v238,v234
M v[100:103],a[240:243],a[252:255],v[100:103]
v_fma_f32 v234,2.0,v235,v236
v_fmac_f32 v236,-2.0,v235
M v[100:103],v[224:227],a[208:211],v[100:103]
v_and_b32 v210,s42,v210
v_and_b32 v204,s42,v204
M v[104:107],v[224:227],a[252:255],v[104:107]
ds_read_b128 a[220:223],v248 offset:27648
v_and_b32 v208,s42,v208
M v[104:107],a[240:243],a[204:207],v[104:107]
s_waitcnt lgkmcnt(2)
ds_read_b128 a[228:231],v249 offset:27648
v_and_b32 v206,s42,v206
M v[104:107],a[216:219],a[232:235],v[104:107]
s_waitcnt lgkmcnt(2)
v_and_b32 v214,s42,v214
v_and_b32 v212,s42,v212
M v[108:111],a[216:219],a[236:239],v[108:111]
v_fmac_f32 v204,s43,v210
v_fmac_f32 v206,4.0,v208
M v[108:111],a[240:243],a[232:235],v[108:111]
v_fma_f32 v235,-4.0,v210,v214
v_fmac_f32 v204,s45,v214
M v[108:111],v[224:227],a[204:207],v[108:111]
v_fmac_f32 v206,s41,v212
v_sub_f32 v214,v214,v210
M v[112:115],v[224:227],a[232:235],v[112:115]
ds_read_b128 a[212:215],v249 offset:28160
v_fma_f32 v210,-4.0,v208,v212
M v[112:115],a[240:243],a[236:239],v[112:115]
s_waitcnt lgkmcnt(2)
ds_read_b128 v[220:223],v248 offset:28160
v_sub_f32 v212,v212,v208
M v[112:115],a[216:219],a[220:223],v[112:115]
s_waitcnt lgkmcnt(2)
v_add_f32 v208,v235,v210
v_sub_f32 v235,v235,v210
M v[116:119],a[216:219],a[228:231],v[116:119]
v_fma_f32 v210,2.0,v212,v214
v_fmac_f32 v214,-2.0,v212
M v[116:119],a[240:243],a[220:223],v[116:119]
v_cvt_pk_bf16_f32 v204,v232,v204
v_cvt_pk_bf16_f32 v206,v237,v206
M v[116:119],v[224:227],a[236:239],v[116:119]
v_cvt_pk_bf16_f32 v208,v233,v208
v_cvt_pk_bf16_f32 v212,v234,v210
M v[120:123],v[224:227],a[220:223],v[120:123]
v_cvt_pk_bf16_f32 v210,v238,v235
v_cvt_pk_bf16_f32 v214,v236,v214
M v[120:123],a[240:243],a[228:231],v[120:123]
s_waitcnt lgkmcnt(1)
v_permlane32_swap_b32 v209,v211
v_permlane32_swap_b32 v205,v207
M v[120:123],a[216:219],a[212:215],v[120:123]
s_waitcnt lgkmcnt(0)
v_permlane32_swap_b32 v213,v215
v_lshlrev_b32 v234,16,v211
M v[124:127],a[216:219],v[220:223],v[124:127]
buffer_load_dwordx4 a[216:219],v250,s[20:23],s46 offen offset:1024 sc1
M v[124:127],a[240:243],a[212:215],v[124:127]
v_lshlrev_b32 v232,16,v205
v_lshlrev_b32 v233,16,v209
M v[124:127],v[224:227],a[228:231],v[124:127]
s_waitcnt vmcnt(10)
buffer_load_dwordx4 a[240:243],v250,s[20:23],s46 offen offset:2048 sc1
M v[128:131],a[248:251],a[224:227],v[128:131]
s_waitcnt vmcnt(10)
s_add_u32 s47,s75,12288
v_lshlrev_b32 v237,16,v207
v_lshlrev_b32 v236,16,v215
M v[128:131],a[192:195],a[208:211],v[128:131]
s_waitcnt vmcnt(9)
v_lshlrev_b32 v235,16,v213
v_fmac_f32 v232,s43,v234
M v[128:131],a[200:203],a[252:255],v[128:131]
v_fmac_f32 v237,4.0,v233
v_fma_f32 v238,-4.0,v234,v236
M v[132:135],a[200:203],a[204:207],v[132:135]
buffer_load_dwordx4 v[224:227],v250,s[20:23],s47 offen offset:0 sc1
M v[132:135],a[192:195],a[252:255],v[132:135]
v_fmac_f32 v232,s45,v236
v_fmac_f32 v237,s41,v235
M v[132:135],a[248:251],a[208:211],v[132:135]
v_sub_f32 v236,v236,v234
v_fma_f32 v234,-4.0,v233,v235
M v[136:139],a[248:251],a[252:255],v[136:139]
v_sub_f32 v235,v235,v233
v_add_f32 v233,v238,v234
M v[136:139],a[192:195],a[204:207],v[136:139]
v_sub_f32 v238,v238,v234
v_fma_f32 v234,2.0,v235,v236
M v[136:139],a[200:203],a[232:235],v[136:139]
v_fmac_f32 v236,-2.0,v235
v_and_b32 v211,s42,v211
M v[140:143],a[200:203],a[236:239],v[140:143]
v_and_b32 v205,s42,v205
v_and_b32 v209,s42,v209
M v[140:143],a[192:195],a[232:235],v[140:143]
v_and_b32 v207,s42,v207
v_and_b32 v215,s42,v215
M v[140:143],a[248:251],a[204:207],v[140:143]
v_and_b32 v213,s42,v213
v_fmac_f32 v205,s43,v211
M v[144:147],a[248:251],a[232:235],v[144:147]
v_fmac_f32 v207,4.0,v209
v_fma_f32 v235,-4.0,v211,v215
M v[144:147],a[192:195],a[236:239],v[144:147]
v_fmac_f32 v205,s45,v215
v_fmac_f32 v207,s41,v213
M v[144:147],a[200:203],a[220:223],v[144:147]
v_sub_f32 v215,v215,v211
v_fma_f32 v211,-4.0,v209,v213
M v[148:151],a[200:203],a[228:231],v[148:151]
v_sub_f32 v213,v213,v209
v_add_f32 v209,v235,v211
M v[148:151],a[192:195],a[220:223],v[148:151]
v_sub_f32 v235,v235,v211
v_fma_f32 v211,2.0,v213,v215
M v[148:151],a[248:251],a[236:239],v[148:151]
v_fmac_f32 v215,-2.0,v213
v_cvt_pk_bf16_f32 v205,v232,v205
M v[152:155],a[248:251],a[220:223],v[152:155]
v_cvt_pk_bf16_f32 v207,v237,v207
v_cvt_pk_bf16_f32 v209,v233,v209
M v[152:155],a[192:195],a[228:231],v[152:155]
v_cvt_pk_bf16_f32 v213,v234,v211
v_cvt_pk_bf16_f32 v211,v238,v235
M v[152:155],a[200:203],a[212:215],v[152:155]
v_cvt_pk_bf16_f32 v215,v236,v215
v_add_u32 v238,121856,v247
M v[156:159],a[200:203],v[220:223],v[156:159]
buffer_load_dwordx4 a[200:203],v250,s[20:23],s47 offen offset:1024 sc1
M v[156:159],a[192:195],a[212:215],v[156:159]
M v[156:159],a[248:251],a[228:231],v[156:159]
s_waitcnt vmcnt(10)
buffer_load_dwordx4 a[192:195],v250,s[20:23],s47 offen offset:2048 sc1
M v[160:163],v[228:231],a[224:227],v[160:163]
s_waitcnt vmcnt(10)
s_add_u32 s48,s75,15360
M v[160:163],a[196:199],a[208:211],v[160:163]
s_waitcnt vmcnt(9)
M v[160:163],a[244:247],a[252:255],v[160:163]
ds_write2st64_b64 v238,v[204:205],v[206:207] offset0:3 offset1:20
M v[164:167],a[244:247],a[204:207],v[164:167]
s_add_u32 s28,s70,6684672
buffer_load_dwordx4 a[248:251],v250,s[20:23],s48 offen offset:0 sc1
M v[164:167],a[196:199],a[252:255],v[164:167]
M v[164:167],v[228:231],a[208:211],v[164:167]
ds_write2st64_b64 v247,v[208:209],v[210:211] offset0:3 offset1:20
M v[168:171],v[228:231],a[252:255],v[168:171]
buffer_load_dwordx4 a[224:227],v250,s[20:23],s48 offen offset:1024 sc1
M v[168:171],a[196:199],a[204:207],v[168:171]
M v[168:171],a[244:247],a[232:235],v[168:171]
ds_write2st64_b64 v247,v[212:213],v[214:215] offset0:139 offset1:156
M v[172:175],a[244:247],a[236:239],v[172:175]
buffer_load_dwordx4 a[208:211],v250,s[20:23],s48 offen offset:2048 sc1
M v[172:175],a[196:199],a[232:235],v[172:175]
s_add_u32 s46,s75,18432
M v[172:175],v[228:231],a[204:207],v[172:175]
M v[176:179],v[228:231],a[232:235],v[176:179]
M v[176:179],a[196:199],a[236:239],v[176:179]
buffer_load_dwordx4 a[252:255],v250,s[20:23],s46 offen offset:0 sc1
M v[176:179],a[244:247],a[220:223],v[176:179]
s_waitcnt lgkmcnt(0)
s_barrier
v_add_u32 v248,0xffffbc00,v248
M v[180:183],a[244:247],a[228:231],v[180:183]
v_add_u32 v249,0xffffbc00,v249
M v[180:183],a[196:199],a[220:223],v[180:183]
ds_read_b128 a[204:207],v248 offset:0
M v[180:183],v[228:231],a[236:239],v[180:183]
buffer_load_dwordx4 v[204:207],v251,s[88:91],s28 offen offset:0
M v[184:187],v[228:231],a[220:223],v[184:187]
ds_read_b128 a[232:235],v249 offset:0
ds_read_b128 a[236:239],v248 offset:512
M v[184:187],a[196:199],a[228:231],v[184:187]
s_waitcnt vmcnt(11)
ds_read_b128 a[220:223],v249 offset:512
v_permlane32_swap_b32 v196,v198
M v[184:187],a[244:247],a[212:215],v[184:187]
s_waitcnt vmcnt(10)
v_permlane32_swap_b32 v192,v194
v_permlane32_swap_b32 v200,v202
M v[188:191],a[244:247],v[220:223],v[188:191]
buffer_load_dwordx4 v[208:211],v245,s[8:11],s28 offen offset:0
M v[188:191],a[196:199],a[212:215],v[188:191]
v_lshlrev_b32 v234,16,v198
v_lshlrev_b32 v232,16,v192
M v[188:191],v[228:231],a[228:231],v[188:191]
s_waitcnt lgkmcnt(3)
v_lshlrev_b32 v233,16,v196
v_lshlrev_b32 v237,16,v194
M a[0:3],v[216:219],a[204:207],a[0:3]
s_waitcnt vmcnt(10) lgkmcnt(2)
ds_read_b128 a[244:247],v248 offset:1024
v_lshlrev_b32 v236,16,v202
M a[0:3],a[216:219],a[232:235],a[0:3]
s_waitcnt vmcnt(9) lgkmcnt(2)
buffer_load_dwordx4 v[212:215],v245,s[8:11],s28 offen offset:768
M a[0:3],a[240:243],a[236:239],a[0:3]
s_waitcnt lgkmcnt(1)
ds_read_b128 v[220:223],v249 offset:1024
v_lshlrev_b32 v235,16,v200
M a[4:7],a[240:243],a[220:223],a[4:7]
v_fmac_f32 v232,s43,v234
v_fmac_f32 v237,4.0,v233
M a[4:7],a[216:219],a[236:239],a[4:7]
v_fma_f32 v238,-4.0,v234,v236
v_fmac_f32 v232,s45,v236
M a[4:7],v[216:219],a[232:235],a[4:7]
v_fmac_f32 v237,s41,v235
v_sub_f32 v236,v236,v234
M a[8:11],v[216:219],a[236:239],a[8:11]
ds_read_b128 a[196:199],v248 offset:1536
v_fma_f32 v234,-4.0,v233,v235
M a[8:11],a[216:219],a[220:223],a[8:11]
s_waitcnt lgkmcnt(2)
ds_read_b128 a[212:215],v249 offset:1536
v_sub_f32 v235,v235,v233
M a[8:11],a[240:243],a[244:247],a[8:11]
s_waitcnt lgkmcnt(2)
v_add_f32 v233,v238,v234
v_sub_f32 v238,v238,v234
M a[12:15],a[240:243],v[220:223],a[12:15]
v_fma_f32 v234,2.0,v235,v236
v_fmac_f32 v236,-2.0,v235
M a[12:15],a[216:219],a[244:247],a[12:15]
v_and_b32 v198,s42,v198
v_and_b32 v192,s42,v192
M a[12:15],v[216:219],a[220:223],a[12:15]
v_and_b32 v196,s42,v196
v_and_b32 v194,s42,v194
M a[16:19],v[216:219],a[244:247],a[16:19]
ds_read_b128 a[228:231],v249 offset:2048
v_and_b32 v202,s42,v202
M a[16:19],a[216:219],v[220:223],a[16:19]
s_waitcnt lgkmcnt(2)
ds_read_b128 v[228:231],v248 offset:2048
v_and_b32 v200,s42,v200
M a[16:19],a[240:243],a[196:199],a[16:19]
s_waitcnt lgkmcnt(2)
v_fmac_f32 v192,s43,v198
v_fmac_f32 v194,4.0,v196
M a[20:23],a[240:243],a[212:215],a[20:23]
v_fma_f32 v235,-4.0,v198,v202
v_fmac_f32 v192,s45,v202
M a[20:23],a[216:219],a[196:199],a[20:23]
v_fmac_f32 v194,s41,v200
v_sub_f32 v202,v202,v198
M a[20:23],v[216:219],v[220:223],a[20:23]
v_fma_f32 v198,-4.0,v196,v200
v_sub_f32 v200,v200,v196
M a[24:27],v[216:219],a[196:199],a[24:27]
v_add_f32 v196,v235,v198
v_sub_f32 v235,v235,v198
M a[24:27],a[216:219],a[212:215],a[24:27]
s_waitcnt lgkmcnt(1)
v_fma_f32 v198,2.0,v200,v202
v_fmac_f32 v202,-2.0,v200
M a[24:27],a[240:243],a[228:231],a[24:27]
s_waitcnt lgkmcnt(0)
v_cvt_pk_bf16_f32 v192,v232,v192
v_cvt_pk_bf16_f32 v194,v237,v194
M a[28:31],a[240:243],v[228:231],a[28:31]
buffer_load_dwordx4 a[240:243],v250,s[20:23],s46 offen offset:1024 sc1
M a[28:31],a[216:219],a[228:231],a[28:31]
v_cvt_pk_bf16_f32 v196,v233,v196
v_cvt_pk_bf16_f32 v200,v234,v198
M a[28:31],v[216:219],a[212:215],a[28:31]
s_waitcnt vmcnt(10)
buffer_load_dwordx4 a[216:219],v250,s[20:23],s46 offen offset:2048 sc1
M a[32:35],v[224:227],a[204:207],a[32:35]
s_waitcnt vmcnt(10)
s_add_u32 s47,s75,21504
v_cvt_pk_bf16_f32 v198,v238,v235
v_cvt_pk_bf16_f32 v202,v236,v202
M a[32:35],a[200:203],a[232:235],a[32:35]
s_waitcnt vmcnt(9)
v_permlane32_swap_b32 v197,v199
v_permlane32_swap_b32 v193,v195
M a[32:35],a[192:195],a[236:239],a[32:35]
v_permlane32_swap_b32 v201,v203
v_lshlrev_b32 v234,16,v199
M a[36:39],a[192:195],a[220:223],a[36:39]
buffer_load_dwordx4 v[216:219],v250,s[20:23],s47 offen offset:0 sc1
M a[36:39],a[200:203],a[236:239],a[36:39]
v_lshlrev_b32 v232,16,v193
v_lshlrev_b32 v233,16,v197
M a[36:39],v[224:227],a[232:235],a[36:39]
v_lshlrev_b32 v237,16,v195
v_lshlrev_b32 v236,16,v203
M a[40:43],v[224:227],a[236:239],a[40:43]
v_lshlrev_b32 v235,16,v201
v_fmac_f32 v232,s43,v234
M a[40:43],a[200:203],a[220:223],a[40:43]
v_fmac_f32 v237,4.0,v233
v_fma_f32 v238,-4.0,v234,v236
M a[40:43],a[192:195],a[244:247],a[40:43]
v_fmac_f32 v232,s45,v236
v_fmac_f32 v237,s41,v235
M a[44:47],a[192:195],v[220:223],a[44:47]
v_sub_f32 v236,v236,v234
v_fma_f32 v234,-4.0,v233,v235
M a[44:47],a[200:203],a[244:247],a[44:47]
v_sub_f32 v235,v235,v233
v_add_f32 v233,v238,v234
M a[44:47],v[224:227],a[220:223],a[44:47]
v_sub_f32 v238,v238,v234
v_fma_f32 v234,2.0,v235,v236
M a[48:51],v[224:227],a[244:247],a[48:51]
v_fmac_f32 v236,-2.0,v235
v_and_b32 v199,s42,v199
M a[48:51],a[200:203],v[220:223],a[48:51]
v_and_b32 v193,s42,v193
v_and_b32 v197,s42,v197
M a[48:51],a[192:195],a[196:199],a[48:51]
v_and_b32 v195,s42,v195
v_and_b32 v203,s42,v203
M a[52:55],a[192:195],a[212:215],a[52:55]
v_and_b32 v201,s42,v201
v_fmac_f32 v193,s43,v199
M a[52:55],a[200:203],a[196:199],a[52:55]
v_fmac_f32 v195,4.0,v197
v_fma_f32 v235,-4.0,v199,v203
M a[52:55],v[224:227],v[220:223],a[52:55]
v_fmac_f32 v193,s45,v203
v_fmac_f32 v195,s41,v201
M a[56:59],v[224:227],a[196:199],a[56:59]
v_sub_f32 v203,v203,v199
v_fma_f32 v199,-4.0,v197,v201
M a[56:59],a[200:203],a[212:215],a[56:59]
v_sub_f32 v201,v201,v197
v_add_f32 v197,v235,v199
M a[56:59],a[192:195],a[228:231],a[56:59]
v_sub_f32 v235,v235,v199
v_fma_f32 v199,2.0,v201,v203
M a[60:63],a[192:195],v[228:231],a[60:63]
buffer_load_dwordx4 a[192:195],v250,s[20:23],s47 offen offset:1024 sc1
M a[60:63],a[200:203],a[228:231],a[60:63]
v_fmac_f32 v203,-2.0,v201
v_cvt_pk_bf16_f32 v193,v232,v193
M a[60:63],v[224:227],a[212:215],a[60:63]
s_waitcnt vmcnt(10)
buffer_load_dwordx4 a[200:203],v250,s[20:23],s47 offen offset:2048 sc1
M a[64:67],a[248:251],a[204:207],a[64:67]
s_waitcnt vmcnt(10)
s_add_u32 s48,s75,24576
v_cvt_pk_bf16_f32 v195,v237,v195
v_cvt_pk_bf16_f32 v197,v233,v197
M a[64:67],a[224:227],a[232:235],a[64:67]
s_waitcnt vmcnt(9)
v_cvt_pk_bf16_f32 v201,v234,v199
v_cvt_pk_bf16_f32 v199,v238,v235
M a[64:67],a[208:211],a[236:239],a[64:67]
v_cvt_pk_bf16_f32 v203,v236,v203
v_add_u32 v238,139264,v247
M a[68:71],a[208:211],a[220:223],a[68:71]
buffer_load_dwordx4 v[224:227],v250,s[20:23],s48 offen offset:0 sc1
M a[68:71],a[224:227],a[236:239],a[68:71]
M a[68:71],a[248:251],a[232:235],a[68:71]
ds_write2st64_b64 v238,v[192:193],v[194:195] offset0:0 offset1:17
M a[72:75],a[248:251],a[236:239],a[72:75]
s_add_u32 s28,s70,7077888
M a[72:75],a[224:227],a[220:223],a[72:75]
buffer_load_dwordx4 a[204:207],v250,s[20:23],s48 offen offset:1024 sc1
M a[72:75],a[208:211],a[244:247],a[72:75]
ds_write2st64_b64 v247,v[196:197],v[198:199] offset0:34 offset1:51
M a[76:79],a[208:211],v[220:223],a[76:79]
M a[76:79],a[224:227],a[244:247],a[76:79]
buffer_load_dwordx4 a[232:235],v250,s[20:23],s48 offen offset:2048 sc1
M a[76:79],a[248:251],a[220:223],a[76:79]
s_add_u32 s46,s75,27648
ds_write2st64_b64 v247,v[200:201],v[202:203] offset0:68 offset1:85
M a[80:83],a[248:251],a[244:247],a[80:83]
M a[80:83],a[224:227],v[220:223],a[80:83]
buffer_load_dwordx4 a[236:239],v250,s[20:23],s46 offen offset:0 sc1
M a[80:83],a[208:211],a[196:199],a[80:83]
M a[84:87],a[208:211],a[212:215],a[84:87]
M a[84:87],a[224:227],a[196:199],a[84:87]
ds_read_b128 a[220:223],v248 offset:8704
M a[84:87],a[248:251],v[220:223],a[84:87]
buffer_load_dwordx4 v[192:195],v251,s[88:91],s28 offen offset:0
M a[88:91],a[248:251],a[196:199],a[88:91]
ds_read_b128 a[244:247],v249 offset:8704
ds_read_b128 v[220:223],v248 offset:9216
M a[88:91],a[224:227],a[212:215],a[88:91]
s_waitcnt vmcnt(11)
ds_read_b128 a[196:199],v249 offset:9216
v_permlane32_swap_b32 v208,v210
M a[88:91],a[208:211],a[228:231],a[88:91]
s_waitcnt vmcnt(10)
v_permlane32_swap_b32 v204,v206
v_permlane32_swap_b32 v212,v214
M a[92:95],a[208:211],v[228:231],a[92:95]
buffer_load_dwordx4 v[196:199],v245,s[8:11],s28 offen offset:0
M a[92:95],a[224:227],a[228:231],a[92:95]
v_lshlrev_b32 v234,16,v210
v_lshlrev_b32 v232,16,v204
M a[92:95],a[248:251],a[212:215],a[92:95]
s_waitcnt lgkmcnt(3)
v_lshlrev_b32 v233,16,v208
v_lshlrev_b32 v237,16,v206
M a[96:99],a[252:255],a[220:223],a[96:99]
s_waitcnt vmcnt(10) lgkmcnt(2)
ds_read_b128 a[208:211],v248 offset:9728
v_lshlrev_b32 v236,16,v214
M a[96:99],a[240:243],a[244:247],a[96:99]
s_waitcnt vmcnt(9) lgkmcnt(2)
buffer_load_dwordx4 v[200:203],v245,s[8:11],s28 offen offset:768
M a[96:99],a[216:219],v[220:223],a[96:99]
s_waitcnt lgkmcnt(1)
ds_read_b128 v[228:231],v249 offset:9728
v_lshlrev_b32 v235,16,v212
M a[100:103],a[216:219],a[196:199],a[100:103]
v_fmac_f32 v232,s43,v234
v_fmac_f32 v237,4.0,v233
M a[100:103],a[240:243],v[220:223],a[100:103]
v_fma_f32 v238,-4.0,v234,v236
v_fmac_f32 v232,s45,v236
M a[100:103],a[252:255],a[244:247],a[100:103]
v_fmac_f32 v237,s41,v235
v_sub_f32 v236,v236,v234
M a[104:107],a[252:255],v[220:223],a[104:107]
ds_read_b128 a[224:227],v248 offset:10240
v_fma_f32 v234,-4.0,v233,v235
M a[104:107],a[240:243],a[196:199],a[104:107]
s_waitcnt lgkmcnt(2)
ds_read_b128 a[228:231],v249 offset:10240
v_sub_f32 v235,v235,v233
M a[104:107],a[216:219],a[208:211],a[104:107]
s_waitcnt lgkmcnt(2)
v_add_f32 v233,v238,v234
v_sub_f32 v238,v238,v234
M a[108:111],a[216:219],v[228:231],a[108:111]
v_fma_f32 v234,2.0,v235,v236
v_fmac_f32 v236,-2.0,v235
M a[108:111],a[240:243],a[208:211],a[108:111]
v_and_b32 v210,s42,v210
v_and_b32 v204,s42,v204
M a[108:111],a[252:255],a[196:199],a[108:111]
v_and_b32 v208,s42,v208
v_and_b32 v206,s42,v206
M a[112:115],a[252:255],a[208:211],a[112:115]
ds_read_b128 a[212:215],v249 offset:10752
v_and_b32 v214,s42,v214
M a[112:115],a[240:243],v[228:231],a[112:115]
s_waitcnt lgkmcnt(2)
ds_read_b128 a[248:251],v248 offset:10752
v_and_b32 v212,s42,v212
M a[112:115],a[216:219],a[224:227],a[112:115]
s_waitcnt lgkmcnt(2)
v_fmac_f32 v204,s43,v210
v_fmac_f32 v206,4.0,v208
M a[116:119],a[216:219],a[228:231],a[116:119]
v_fma_f32 v235,-4.0,v210,v214
v_fmac_f32 v204,s45,v214
M a[116:119],a[240:243],a[224:227],a[116:119]
v_fmac_f32 v206,s41,v212
v_sub_f32 v214,v214,v210
M a[116:119],a[252:255],v[228:231],a[116:119]
v_fma_f32 v210,-4.0,v208,v212
v_sub_f32 v212,v212,v208
M a[120:123],a[252:255],a[224:227],a[120:123]
v_add_f32 v208,v235,v210
v_sub_f32 v235,v235,v210
M a[120:123],a[240:243],a[228:231],a[120:123]
s_waitcnt lgkmcnt(1)
v_fma_f32 v210,2.0,v212,v214
v_fmac_f32 v214,-2.0,v212
M a[120:123],a[216:219],a[212:215],a[120:123]
s_waitcnt lgkmcnt(0)
v_cvt_pk_bf16_f32 v204,v232,v204
v_cvt_pk_bf16_f32 v206,v237,v206
M a[124:127],a[216:219],a[248:251],a[124:127]
buffer_load_dwordx4 a[216:219],v250,s[20:23],s46 offen offset:1024 sc1
M a[124:127],a[240:243],a[212:215],a[124:127]
v_cvt_pk_bf16_f32 v208,v233,v208
v_cvt_pk_bf16_f32 v212,v234,v210
M a[124:127],a[252:255],a[228:231],a[124:127]
s_waitcnt vmcnt(10)
buffer_load_dwordx4 a[240:243],v250,s[20:23],s46 offen offset:2048 sc1
M a[128:131],v[216:219],a[220:223],a[128:131]
s_waitcnt vmcnt(10)
s_add_u32 s47,s75,30720
v_cvt_pk_bf16_f32 v210,v238,v235
v_cvt_pk_bf16_f32 v214,v236,v214
M a[128:131],a[192:195],a[244:247],a[128:131]
s_waitcnt vmcnt(9)
v_permlane32_swap_b32 v209,v211
v_permlane32_swap_b32 v205,v207
M a[128:131],a[200:203],v[220:223],a[128:131]
v_permlane32_swap_b32 v213,v215
v_lshlrev_b32 v234,16,v211
M a[132:135],a[200:203],a[196:199],a[132:135]
buffer_load_dwordx4 a[252:255],v250,s[20:23],s47 offen offset:0 sc1
M a[132:135],a[192:195],v[220:223],a[132:135]
v_lshlrev_b32 v232,16,v205
v_lshlrev_b32 v233,16,v209
M a[132:135],v[216:219],a[244:247],a[132:135]
v_lshlrev_b32 v237,16,v207
v_lshlrev_b32 v236,16,v215
M a[136:139],v[216:219],v[220:223],a[136:139]
v_lshlrev_b32 v235,16,v213
v_fmac_f32 v232,s43,v234
M a[136:139],a[192:195],a[196:199],a[136:139]
v_fmac_f32 v237,4.0,v233
v_fma_f32 v238,-4.0,v234,v236
M a[136:139],a[200:203],a[208:211],a[136:139]
v_fmac_f32 v232,s45,v236
v_fmac_f32 v237,s41,v235
M a[140:143],a[200:203],v[228:231],a[140:143]
v_sub_f32 v236,v236,v234
v_fma_f32 v234,-4.0,v233,v235
M a[140:143],a[192:195],a[208:211],a[140:143]
v_sub_f32 v235,v235,v233
v_add_f32 v233,v238,v234
M a[140:143],v[216:219],a[196:199],a[140:143]
v_sub_f32 v238,v238,v234
v_fma_f32 v234,2.0,v235,v236
M a[144:147],v[216:219],a[208:211],a[144:147]
v_fmac_f32 v236,-2.0,v235
v_and_b32 v211,s42,v211
M a[144:147],a[192:195],v[228:231],a[144:147]
v_and_b32 v205,s42,v205
v_and_b32 v209,s42,v209
M a[144:147],a[200:203],a[224:227],a[144:147]
v_and_b32 v207,s42,v207
v_and_b32 v215,s42,v215
M a[148:151],a[200:203],a[228:231],a[148:151]
v_and_b32 v213,s42,v213
v_fmac_f32 v205,s43,v211
M a[148:151],a[192:195],a[224:227],a[148:151]
v_fmac_f32 v207,4.0,v209
v_fma_f32 v235,-4.0,v211,v215
M a[148:151],v[216:219],v[228:231],a[148:151]
v_fmac_f32 v205,s45,v215
v_fmac_f32 v207,s41,v213
M a[152:155],v[216:219],a[224:227],a[152:155]
v_sub_f32 v215,v215,v211
v_fma_f32 v211,-4.0,v209,v213
M a[152:155],a[192:195],a[228:231],a[152:155]
v_sub_f32 v213,v213,v209
v_add_f32 v209,v235,v211
M a[152:155],a[200:203],a[212:215],a[152:155]
v_sub_f32 v235,v235,v211
v_fma_f32 v211,2.0,v213,v215
M a[156:159],a[200:203],a[248:251],a[156:159]
buffer_load_dwordx4 a[200:203],v250,s[20:23],s47 offen offset:1024 sc1
M a[156:159],a[192:195],a[212:215],a[156:159]
v_fmac_f32 v215,-2.0,v213
v_cvt_pk_bf16_f32 v205,v232,v205
M a[156:159],v[216:219],a[228:231],a[156:159]
s_waitcnt vmcnt(10)
buffer_load_dwordx4 a[192:195],v250,s[20:23],s47 offen offset:2048 sc1
M a[160:163],v[224:227],a[220:223],a[160:163]
s_waitcnt vmcnt(10)
s_add_u32 s48,s75,33792
v_cvt_pk_bf16_f32 v207,v237,v207
v_cvt_pk_bf16_f32 v209,v233,v209
M a[160:163],a[204:207],a[244:247],a[160:163]
s_waitcnt vmcnt(9)
v_cvt_pk_bf16_f32 v213,v234,v211
v_cvt_pk_bf16_f32 v211,v238,v235
M a[160:163],a[232:235],v[220:223],a[160:163]
v_cvt_pk_bf16_f32 v215,v236,v215
v_add_u32 v238,139264,v247
M a[164:167],a[232:235],a[196:199],a[164:167]
buffer_load_dwordx4 v[216:219],v250,s[20:23],s48 offen offset:0 sc1
M a[164:167],a[204:207],v[220:223],a[164:167]
v_fmac_f32 v239,s43,v241
v_fmac_f32 v244,4.0,v240
M a[164:167],v[224:227],a[244:247],a[164:167]
ds_write2st64_b64 v238,v[204:205],v[206:207] offset0:1 offset1:18
M a[168:171],v[224:227],v[220:223],a[168:171]
s_add_u32 s28,s70,7471104
v_fma_f32 v232,-4.0,v241,v243
v_fmac_f32 v239,s45,v243
M a[168:171],a[204:207],a[196:199],a[168:171]
buffer_load_dwordx4 a[220:223],v250,s[20:23],s48 offen offset:1024 sc1
M a[168:171],a[232:235],a[208:211],a[168:171]
ds_write2st64_b64 v247,v[208:209],v[210:211] offset0:35 offset1:52
M a[172:175],a[232:235],v[228:231],a[172:175]
v_fmac_f32 v244,s41,v242
v_sub_f32 v243,v243,v241
M a[172:175],a[204:207],a[208:211],a[172:175]
buffer_load_dwordx4 a[244:247],v250,s[20:23],s48 offen offset:2048 sc1
M a[172:175],v[224:227],a[196:199],a[172:175]
s_add_u32 s46,s75,36864
ds_write2st64_b64 v247,v[212:213],v[214:215] offset0:69 offset1:86
M a[176:179],v[224:227],a[208:211],a[176:179]
v_fma_f32 v241,-4.0,v240,v242
v_sub_f32 v242,v242,v240
M a[176:179],a[204:207],v[228:231],a[176:179]
buffer_load_dwordx4 v[220:223],v250,s[20:23],s46 offen offset:0 sc1
M a[176:179],a[232:235],a[224:227],a[176:179]
v_add_u32 v248,0x4400,v248
v_add_u32 v249,0x4400,v249
M a[180:183],a[232:235],a[228:231],a[180:183]
v_add_f32 v240,v232,v241
v_sub_f32 v232,v232,v241
M a[180:183],a[204:207],a[224:227],a[180:183]
ds_read_b128 a[196:199],v248 offset:52224
v_fma_f32 v241,2.0,v242,v243
M a[180:183],v[224:227],v[228:231],a[180:183]
buffer_load_dwordx4 v[204:207],v251,s[88:91],s28 offen offset:0
M a[184:187],v[224:227],a[224:227],a[184:187]
ds_read_b128 a[208:211],v249 offset:52224
ds_read_b128 v[228:231],v248 offset:52736
M a[184:187],a[204:207],a[228:231],a[184:187]
ds_read_b128 a[224:227],v249 offset:52736
v_fmac_f32 v243,-2.0,v242
M a[184:187],a[232:235],a[212:215],a[184:187]
v_cvt_pk_bf16_f32 v233,v239,v244
v_cvt_pk_bf16_f32 v234,v240,v232
M a[188:191],a[232:235],a[248:251],a[188:191]
buffer_load_dwordx4 v[208:211],v245,s[8:11],s28 offen offset:0
M a[188:191],a[204:207],a[212:215],a[188:191]
v_cvt_pk_bf16_f32 v235,v241,v243
v_add_u32 v232,139264,v252
M a[188:191],v[224:227],a[228:231],a[188:191]
s_waitcnt vmcnt(14) lgkmcnt(3)
ds_write_b16 v232,v233 offset:0
M v[0:3],a[236:239],a[196:199],v[0:3]
s_waitcnt vmcnt(10) lgkmcnt(3)
ds_read_b128 a[232:235],v248 offset:53248
ds_write_b16_d16_hi v232,v233 offset:8704
M v[0:3],a[216:219],a[208:211],v[0:3]
s_waitcnt vmcnt(9) lgkmcnt(4)
buffer_load_dwordx4 v[212:215],v245,s[8:11],s28 offen offset:768
M v[0:3],a[240:243],v[228:231],v[0:3]
s_waitcnt lgkmcnt(3)
s_add_u32 s29,s71,6291456
ds_read_b128 a[248:251],v249 offset:53248
ds_write_b16 v252,v234 offset:17408
M v[4:7],a[240:243],a[224:227],v[4:7]
ds_write_b16_d16_hi v252,v234 offset:26112
M v[4:7],a[216:219],v[228:231],v[4:7]
ds_write_b16 v252,v235 offset:34816
M v[4:7],a[236:239],a[208:211],v[4:7]
buffer_load_short_d16_hi v239,v246,s[12:15],s29 offen offset:0
M v[8:11],a[236:239],v[228:231],v[8:11]
ds_read_b128 a[204:207],v248 offset:53760
ds_write_b16_d16_hi v252,v235 offset:43520
M v[8:11],a[216:219],a[224:227],v[8:11]
s_waitcnt lgkmcnt(7)
buffer_load_short_d16_hi v240,v246,s[8:11],s29 offen offset:0
M v[8:11],a[240:243],a[232:235],v[8:11]
s_waitcnt lgkmcnt(5)
buffer_load_short_d16_hi v241,v246,s[8:11],s29 offen offset:384
M v[12:15],a[240:243],a[248:251],v[12:15]
ds_read_b128 a[212:215],v249 offset:53760
v_permlane32_swap_b32 v196,v198
M v[12:15],a[216:219],a[232:235],v[12:15]
buffer_load_short_d16_hi v242,v246,s[8:11],s29 offen offset:768
M v[12:15],a[236:239],a[224:227],v[12:15]
v_permlane32_swap_b32 v192,v194
v_permlane32_swap_b32 v200,v202
M v[16:19],a[236:239],a[232:235],v[16:19]
buffer_load_short_d16_hi v243,v246,s[8:11],s29 offen offset:1152
M v[16:19],a[216:219],a[248:251],v[16:19]
s_waitcnt lgkmcnt(2)
ds_read_b128 a[228:231],v249 offset:54272
ds_read_b128 v[224:227],v248 offset:54272
M v[16:19],a[240:243],a[204:207],v[16:19]
s_waitcnt lgkmcnt(2)
buffer_load_short_d16_hi v244,v246,s[16:19],s29 offen offset:1536
M v[20:23],a[240:243],a[212:215],v[20:23]
v_lshlrev_b32 v234,16,v198
v_lshlrev_b32 v232,16,v192
M v[20:23],a[216:219],a[204:207],v[20:23]
v_lshlrev_b32 v233,16,v196
v_lshlrev_b32 v237,16,v194
M v[20:23],a[236:239],a[248:251],v[20:23]
v_lshlrev_b32 v236,16,v202
v_lshlrev_b32 v235,16,v200
M v[24:27],a[236:239],a[204:207],v[24:27]
v_fmac_f32 v232,s43,v234
v_fmac_f32 v237,4.0,v233
M v[24:27],a[216:219],a[212:215],v[24:27]
s_waitcnt lgkmcnt(1)
v_fma_f32 v238,-4.0,v234,v236
v_fmac_f32 v232,s45,v236
M v[24:27],a[240:243],a[228:231],v[24:27]
s_waitcnt lgkmcnt(0)
v_fmac_f32 v237,s41,v235
v_sub_f32 v236,v236,v234
M v[28:31],a[240:243],v[224:227],v[28:31]
buffer_load_dwordx4 a[240:243],v250,s[20:23],s46 offen offset:1024 sc1
M v[28:31],a[216:219],a[228:231],v[28:31]
v_fma_f32 v234,-4.0,v233,v235
v_sub_f32 v235,v235,v233
M v[28:31],a[236:239],a[212:215],v[28:31]
s_waitcnt vmcnt(16)
buffer_load_dwordx4 a[216:219],v250,s[20:23],s46 offen offset:2048 sc1
M v[32:35],a[252:255],a[196:199],v[32:35]
s_waitcnt vmcnt(16)
s_add_u32 s47,s75,39936
v_add_f32 v233,v238,v234
v_sub_f32 v238,v238,v234
M v[32:35],a[200:203],a[208:211],v[32:35]
s_waitcnt vmcnt(15)
v_fma_f32 v234,2.0,v235,v236
v_fmac_f32 v236,-2.0,v235
M v[32:35],a[192:195],v[228:231],v[32:35]
v_and_b32 v198,s42,v198
v_and_b32 v192,s42,v192
M v[36:39],a[192:195],a[224:227],v[36:39]
buffer_load_dwordx4 a[236:239],v250,s[20:23],s47 offen offset:0 sc1
M v[36:39],a[200:203],v[228:231],v[36:39]
v_and_b32 v196,s42,v196
v_and_b32 v194,s42,v194
M v[36:39],a[252:255],a[208:211],v[36:39]
v_and_b32 v202,s42,v202
v_and_b32 v200,s42,v200
M v[40:43],a[252:255],v[228:231],v[40:43]
v_fmac_f32 v192,s43,v198
v_fmac_f32 v194,4.0,v196
M v[40:43],a[200:203],a[224:227],v[40:43]
v_fma_f32 v235,-4.0,v198,v202
v_fmac_f32 v192,s45,v202
M v[40:43],a[192:195],a[232:235],v[40:43]
v_fmac_f32 v194,s41,v200
v_sub_f32 v202,v202,v198
M v[44:47],a[192:195],a[248:251],v[44:47]
v_fma_f32 v198,-4.0,v196,v200
v_sub_f32 v200,v200,v196
M v[44:47],a[200:203],a[232:235],v[44:47]
v_add_f32 v196,v235,v198
v_sub_f32 v235,v235,v198
M v[44:47],a[252:255],a[224:227],v[44:47]
v_fma_f32 v198,2.0,v200,v202
v_fmac_f32 v202,-2.0,v200
M v[48:51],a[252:255],a[232:235],v[48:51]
v_cvt_pk_bf16_f32 v192,v232,v192
v_cvt_pk_bf16_f32 v194,v237,v194
M v[48:51],a[200:203],a[248:251],v[48:51]
v_cvt_pk_bf16_f32 v196,v233,v196
v_cvt_pk_bf16_f32 v200,v234,v198
M v[48:51],a[192:195],a[204:207],v[48:51]
v_cvt_pk_bf16_f32 v198,v238,v235
v_cvt_pk_bf16_f32 v202,v236,v202
M v[52:55],a[192:195],a[212:215],v[52:55]
v_permlane32_swap_b32 v197,v199
v_permlane32_swap_b32 v193,v195
M v[52:55],a[200:203],a[204:207],v[52:55]
v_permlane32_swap_b32 v201,v203
v_lshlrev_b32 v234,16,v199
M v[52:55],a[252:255],a[248:251],v[52:55]
v_lshlrev_b32 v232,16,v193
v_lshlrev_b32 v233,16,v197
M v[56:59],a[252:255],a[204:207],v[56:59]
v_lshlrev_b32 v237,16,v195
v_lshlrev_b32 v236,16,v203
M v[56:59],a[200:203],a[212:215],v[56:59]
v_lshlrev_b32 v235,16,v201
v_fmac_f32 v232,s43,v234
M v[56:59],a[192:195],a[228:231],v[56:59]
v_fmac_f32 v237,4.0,v233
v_fma_f32 v238,-4.0,v234,v236
M v[60:63],a[192:195],v[224:227],v[60:63]
buffer_load_dwordx4 a[192:195],v250,s[20:23],s47 offen offset:1024 sc1
M v[60:63],a[200:203],a[228:231],v[60:63]
v_fmac_f32 v232,s45,v236
v_fmac_f32 v237,s41,v235
M v[60:63],a[252:255],a[212:215],v[60:63]
s_waitcnt vmcnt(16)
buffer_load_dwordx4 a[200:203],v250,s[20:23],s47 offen offset:2048 sc1
M v[64:67],v[216:219],a[196:199],v[64:67]
s_waitcnt vmcnt(16)
s_add_u32 s48,s75,43008
v_sub_f32 v236,v236,v234
v_fma_f32 v234,-4.0,v233,v235
M v[64:67],a[220:223],a[208:211],v[64:67]
s_waitcnt vmcnt(15)
v_sub_f32 v235,v235,v233
v_add_f32 v233,v238,v234
M v[64:67],a[244:247],v[228:231],v[64:67]
v_sub_f32 v238,v238,v234
v_fma_f32 v234,2.0,v235,v236
M v[68:71],a[244:247],a[224:227],v[68:71]
buffer_load_dwordx4 a[252:255],v250,s[20:23],s48 offen offset:0 sc1
M v[68:71],a[220:223],v[228:231],v[68:71]
v_fmac_f32 v236,-2.0,v235
v_and_b32 v199,s42,v199
M v[68:71],v[216:219],a[208:211],v[68:71]
v_and_b32 v193,s42,v193
v_and_b32 v197,s42,v197
M v[72:75],v[216:219],v[228:231],v[72:75]
v_and_b32 v195,s42,v195
v_and_b32 v203,s42,v203
M v[72:75],a[220:223],a[224:227],v[72:75]
buffer_load_dwordx4 a[196:199],v250,s[20:23],s48 offen offset:1024 sc1
M v[72:75],a[244:247],a[232:235],v[72:75]
v_and_b32 v201,s42,v201
v_fmac_f32 v193,s43,v199
M v[76:79],a[244:247],a[248:251],v[76:79]
v_fmac_f32 v195,4.0,v197
v_fma_f32 v235,-4.0,v199,v203
M v[76:79],a[220:223],a[232:235],v[76:79]
v_fmac_f32 v193,s45,v203
v_fmac_f32 v195,s41,v201
M v[76:79],v[216:219],a[224:227],v[76:79]
buffer_load_dwordx4 a[208:211],v250,s[20:23],s48 offen offset:2048 sc1
M v[80:83],v[216:219],a[232:235],v[80:83]
s_add_u32 s46,s76,9216
v_sub_f32 v203,v203,v199
v_fma_f32 v199,-4.0,v197,v201
M v[80:83],a[220:223],a[248:251],v[80:83]
v_sub_f32 v201,v201,v197
v_add_f32 v197,v235,v199
M v[80:83],a[244:247],a[204:207],v[80:83]
v_sub_f32 v235,v235,v199
v_fma_f32 v199,2.0,v201,v203
M v[84:87],a[244:247],a[212:215],v[84:87]
buffer_load_dwordx4 v[228:231],v250,s[20:23],s46 offen offset:0 sc1
M v[84:87],a[220:223],a[204:207],v[84:87]
ds_read_b128 a[224:227],v248 offset:60928
v_fmac_f32 v203,-2.0,v201
M v[84:87],v[216:219],a[248:251],v[84:87]
ds_read_b128 a[232:235],v249 offset:60928
v_cvt_pk_bf16_f32 v193,v232,v193
M v[88:91],v[216:219],a[204:207],v[88:91]
ds_read_b128 a[248:251],v248 offset:61440
v_cvt_pk_bf16_f32 v195,v237,v195
M v[88:91],a[220:223],a[212:215],v[88:91]
ds_read_b128 a[204:207],v249 offset:61440
v_cvt_pk_bf16_f32 v197,v233,v197
M v[88:91],a[244:247],a[228:231],v[88:91]
v_cvt_pk_bf16_f32 v201,v234,v199
v_cvt_pk_bf16_f32 v199,v238,v235
M v[92:95],a[244:247],v[224:227],v[92:95]
v_cvt_pk_bf16_f32 v203,v236,v203
v_add_u32 v238,139264,v247
M v[92:95],a[220:223],a[228:231],v[92:95]
s_waitcnt vmcnt(16)
v_permlane32_swap_b32 v208,v210
v_permlane32_swap_b32 v204,v206
M v[92:95],v[216:219],a[212:215],v[92:95]
s_waitcnt lgkmcnt(3)
ds_write2st64_b64 v238,v[192:193],v[194:195] offset0:2 offset1:19
M v[96:99],v[220:223],a[224:227],v[96:99]
s_waitcnt vmcnt(8) lgkmcnt(3)
s_add_u32 s28,s71,6291456
buffer_load_dwordx4 v[192:195],v251,s[88:91],s28 offen offset:0
M v[96:99],a[240:243],a[232:235],v[96:99]
s_waitcnt vmcnt(8) lgkmcnt(2)
ds_read_b128 a[244:247],v248 offset:61952
ds_read_b128 v[224:227],v249 offset:61952
M v[96:99],a[216:219],a[248:251],v[96:99]
s_waitcnt lgkmcnt(3)
ds_write2st64_b64 v247,v[196:197],v[198:199] offset0:36 offset1:53
M v[100:103],a[216:219],a[204:207],v[100:103]
buffer_load_dwordx4 v[196:199],v245,s[8:11],s28 offen offset:0
M v[100:103],a[240:243],a[248:251],v[100:103]
v_permlane32_swap_b32 v212,v214
v_lshlrev_b32 v234,16,v210
M v[100:103],v[220:223],a[232:235],v[100:103]
ds_write2st64_b64 v247,v[200:201],v[202:203] offset0:70 offset1:87
M v[104:107],v[220:223],a[248:251],v[104:107]
buffer_load_dwordx4 v[200:203],v245,s[8:11],s28 offen offset:768
M v[104:107],a[240:243],a[204:207],v[104:107]
s_waitcnt lgkmcnt(3)
ds_read_b128 a[220:223],v248 offset:62464
ds_read_b128 a[228:231],v249 offset:62464
M v[104:107],a[216:219],a[244:247],v[104:107]
s_waitcnt lgkmcnt(4)
v_lshlrev_b32 v232,16,v204
v_lshlrev_b32 v233,16,v208
M v[108:111],a[216:219],v[224:227],v[108:111]
v_lshlrev_b32 v237,16,v206
v_lshlrev_b32 v236,16,v214
M v[108:111],a[240:243],a[244:247],v[108:111]
v_lshlrev_b32 v235,16,v212
v_fmac_f32 v232,s43,v234
M v[108:111],v[220:223],a[204:207],v[108:111]
v_fmac_f32 v237,4.0,v233
v_fma_f32 v238,-4.0,v234,v236
M v[112:115],v[220:223],a[244:247],v[112:115]
ds_read_b128 a[212:215],v249 offset:62976
v_fmac_f32 v232,s45,v236
M v[112:115],a[240:243],v[224:227],v[112:115]
s_waitcnt lgkmcnt(2)
ds_read_b128 v[216:219],v248 offset:62976
v_fmac_f32 v237,s41,v235
M v[112:115],a[216:219],a[220:223],v[112:115]
s_waitcnt lgkmcnt(2)
v_sub_f32 v236,v236,v234
v_fma_f32 v234,-4.0,v233,v235
M v[116:119],a[216:219],a[228:231],v[116:119]
v_sub_f32 v235,v235,v233
v_add_f32 v233,v238,v234
M v[116:119],a[240:243],a[220:223],v[116:119]
v_sub_f32 v238,v238,v234
v_fma_f32 v234,2.0,v235,v236
M v[116:119],v[220:223],v[224:227],v[116:119]
v_fmac_f32 v236,-2.0,v235
v_and_b32 v210,s42,v210
M v[120:123],v[220:223],a[220:223],v[120:123]
v_and_b32 v204,s42,v204
v_and_b32 v208,s42,v208
M v[120:123],a[240:243],a[228:231],v[120:123]
s_waitcnt lgkmcnt(1)
v_and_b32 v206,s42,v206
v_and_b32 v214,s42,v214
M v[120:123],a[216:219],a[212:215],v[120:123]
s_waitcnt lgkmcnt(0)
v_and_b32 v212,s42,v212
v_fmac_f32 v204,s43,v210
M v[124:127],a[216:219],v[216:219],v[124:127]
buffer_load_dwordx4 a[216:219],v250,s[20:23],s46 offen offset:1024 sc1
M v[124:127],a[240:243],a[212:215],v[124:127]
v_fmac_f32 v206,4.0,v208
v_fma_f32 v235,-4.0,v210,v214
M v[124:127],v[220:223],a[228:231],v[124:127]
s_waitcnt vmcnt(10)
buffer_load_dwordx4 a[240:243],v250,s[20:23],s46 offen offset:2048 sc1
M v[128:131],a[236:239],a[224:227],v[128:131]
s_waitcnt vmcnt(10)
s_add_u32 s47,s76,12288
v_fmac_f32 v204,s45,v214
v_fmac_f32 v206,s41,v212
M v[128:131],a[192:195],a[232:235],v[128:131]
s_waitcnt vmcnt(9)
v_sub_f32 v214,v214,v210
v_fma_f32 v210,-4.0,v208,v212
M v[128:131],a[200:203],a[248:251],v[128:131]
v_sub_f32 v212,v212,v208
v_add_f32 v208,v235,v210
M v[132:135],a[200:203],a[204:207],v[132:135]
buffer_load_dwordx4 v[220:223],v250,s[20:23],s47 offen offset:0 sc1
M v[132:135],a[192:195],a[248:251],v[132:135]
v_sub_f32 v235,v235,v210
v_fma_f32 v210,2.0,v212,v214
M v[132:135],a[236:239],a[232:235],v[132:135]
v_fmac_f32 v214,-2.0,v212
v_cvt_pk_bf16_f32 v204,v232,v204
M v[136:139],a[236:239],a[248:251],v[136:139]
v_cvt_pk_bf16_f32 v206,v237,v206
v_cvt_pk_bf16_f32 v208,v233,v208
M v[136:139],a[192:195],a[204:207],v[136:139]
v_cvt_pk_bf16_f32 v212,v234,v210
v_cvt_pk_bf16_f32 v210,v238,v235
M v[136:139],a[200:203],a[244:247],v[136:139]
v_cvt_pk_bf16_f32 v214,v236,v214
v_permlane32_swap_b32 v209,v211
M v[140:143],a[200:203],v[224:227],v[140:143]
v_permlane32_swap_b32 v205,v207
v_permlane32_swap_b32 v213,v215
M v[140:143],a[192:195],a[244:247],v[140:143]
v_lshlrev_b32 v234,16,v211
v_lshlrev_b32 v232,16,v205
M v[140:143],a[236:239],a[204:207],v[140:143]
v_lshlrev_b32 v233,16,v209
v_lshlrev_b32 v237,16,v207
M v[144:147],a[236:239],a[244:247],v[144:147]
v_lshlrev_b32 v236,16,v215
v_lshlrev_b32 v235,16,v213
M v[144:147],a[192:195],v[224:227],v[144:147]
v_fmac_f32 v232,s43,v234
v_fmac_f32 v237,4.0,v233
M v[144:147],a[200:203],a[220:223],v[144:147]
v_fma_f32 v238,-4.0,v234,v236
v_fmac_f32 v232,s45,v236
M v[148:151],a[200:203],a[228:231],v[148:151]
v_fmac_f32 v237,s41,v235
v_sub_f32 v236,v236,v234
M v[148:151],a[192:195],a[220:223],v[148:151]
v_fma_f32 v234,-4.0,v233,v235
v_sub_f32 v235,v235,v233
M v[148:151],a[236:239],v[224:227],v[148:151]
v_add_f32 v233,v238,v234
v_sub_f32 v238,v238,v234
M v[152:155],a[236:239],a[220:223],v[152:155]
v_fma_f32 v234,2.0,v235,v236
v_fmac_f32 v236,-2.0,v235
M v[152:155],a[192:195],a[228:231],v[152:155]
v_and_b32 v211,s42,v211
v_and_b32 v205,s42,v205
M v[152:155],a[200:203],a[212:215],v[152:155]
v_and_b32 v209,s42,v209
v_and_b32 v207,s42,v207
M v[156:159],a[200:203],v[216:219],v[156:159]
buffer_load_dwordx4 a[200:203],v250,s[20:23],s47 offen offset:1024 sc1
M v[156:159],a[192:195],a[212:215],v[156:159]
v_and_b32 v215,s42,v215
v_and_b32 v213,s42,v213
M v[156:159],a[236:239],a[228:231],v[156:159]
s_waitcnt vmcnt(10)
buffer_load_dwordx4 a[192:195],v250,s[20:23],s47 offen offset:2048 sc1
v_fmac_f32 v205,s43,v211
v_fmac_f32 v207,4.0,v209
M v[160:163],a[252:255],a[224:227],v[160:163]
s_waitcnt vmcnt(10)
s_add_u32 s48,s76,15360
v_fma_f32 v235,-4.0,v211,v215
v_fmac_f32 v205,s45,v215
v_fmac_f32 v207,s41,v213
v_sub_f32 v215,v215,v211
M v[160:163],a[196:199],a[232:235],v[160:163]
s_waitcnt vmcnt(9)
v_fma_f32 v211,-4.0,v209,v213
v_sub_f32 v213,v213,v209
v_add_f32 v209,v235,v211
v_sub_f32 v235,v235,v211
M v[160:163],a[208:211],a[248:251],v[160:163]
buffer_load_dwordx4 a[236:239],v250,s[20:23],s48 offen offset:0 sc1
v_fma_f32 v211,2.0,v213,v215
v_fmac_f32 v215,-2.0,v213
v_cvt_pk_bf16_f32 v205,v232,v205
v_cvt_pk_bf16_f32 v207,v237,v207
M v[164:167],a[208:211],a[204:207],v[164:167]
v_cvt_pk_bf16_f32 v209,v233,v209
v_cvt_pk_bf16_f32 v213,v234,v211
v_cvt_pk_bf16_f32 v211,v238,v235
v_cvt_pk_bf16_f32 v215,v236,v215
M v[164:167],a[196:199],a[248:251],v[164:167]
buffer_load_dwordx4 a[224:227],v250,s[20:23],s48 offen offset:1024 sc1
v_add_u32 v238,139264,v247
M v[164:167],a[252:255],a[232:235],v[164:167]
ds_write2st64_b64 v238,v[204:205],v[206:207] offset0:3 offset1:20
M v[168:171],a[252:255],a[248:251],v[168:171]
s_waitcnt vmcnt(8)
s_add_u32 s28,s71,6684672
v_permlane32_swap_b32 v196,v198
v_permlane32_swap_b32 v192,v194
M v[168:171],a[196:199],a[204:207],v[168:171]
buffer_load_dwordx4 a[232:235],v250,s[20:23],s48 offen offset:2048 sc1
M v[168:171],a[208:211],a[244:247],v[168:171]
s_add_u32 s46,s76,18432
ds_write2st64_b64 v247,v[208:209],v[210:211] offset0:37 offset1:54
M v[172:175],a[208:211],v[224:227],v[172:175]
s_waitcnt vmcnt(8)
v_permlane32_swap_b32 v200,v202
v_lshlrev_b32 v234,16,v198
M v[172:175],a[196:199],a[244:247],v[172:175]
v_lshlrev_b32 v232,16,v192
v_lshlrev_b32 v233,16,v196
M v[172:175],a[252:255],a[204:207],v[172:175]
buffer_load_dwordx4 a[248:251],v250,s[20:23],s46 offen offset:0 sc1
ds_write2st64_b64 v247,v[212:213],v[214:215] offset0:71 offset1:88
M v[176:179],a[252:255],a[244:247],v[176:179]
v_lshlrev_b32 v237,16,v194
v_lshlrev_b32 v236,16,v202
M v[176:179],a[196:199],v[224:227],v[176:179]
buffer_load_dwordx4 v[204:207],v251,s[88:91],s28 offen offset:0
M v[176:179],a[208:211],a[220:223],v[176:179]
s_waitcnt lgkmcnt(0)
s_barrier
v_lshlrev_b32 v235,16,v200
M v[180:183],a[208:211],a[228:231],v[180:183]
v_fmac_f32 v232,s43,v234
v_fmac_f32 v237,4.0,v233
M v[180:183],a[196:199],a[220:223],v[180:183]
ds_read_b128 a[204:207],v248 offset:0
v_fma_f32 v238,-4.0,v234,v236
M v[180:183],a[252:255],v[224:227],v[180:183]
buffer_load_dwordx4 v[208:211],v245,s[8:11],s28 offen offset:0
M v[184:187],a[252:255],a[220:223],v[184:187]
ds_read_b128 a[244:247],v249 offset:0
ds_read_b128 v[224:227],v248 offset:512
M v[184:187],a[196:199],a[228:231],v[184:187]
ds_read_b128 a[220:223],v249 offset:512
v_fmac_f32 v232,s45,v236
M v[184:187],a[208:211],a[212:215],v[184:187]
v_fmac_f32 v237,s41,v235
v_sub_f32 v236,v236,v234
M v[188:191],a[208:211],v[216:219],v[188:191]
buffer_load_dwordx4 v[212:215],v245,s[8:11],s28 offen offset:768
M v[188:191],a[196:199],a[212:215],v[188:191]
v_fma_f32 v234,-4.0,v233,v235
v_sub_f32 v235,v235,v233
M v[188:191],a[252:255],a[228:231],v[188:191]
s_waitcnt lgkmcnt(3)
v_add_f32 v233,v238,v234
v_sub_f32 v238,v238,v234
M a[0:3],v[228:231],a[204:207],a[0:3]
s_waitcnt vmcnt(11) lgkmcnt(2)
ds_read_b128 a[208:211],v248 offset:1024
v_fma_f32 v234,2.0,v235,v236
M a[0:3],a[216:219],a[244:247],a[0:3]
s_waitcnt vmcnt(10) lgkmcnt(2)
ds_read_b128 v[216:219],v249 offset:1024
v_fmac_f32 v236,-2.0,v235
M a[0:3],a[240:243],v[224:227],a[0:3]
s_waitcnt lgkmcnt(2)
v_and_b32 v198,s42,v198
v_and_b32 v192,s42,v192
M a[4:7],a[240:243],a[220:223],a[4:7]
v_and_b32 v196,s42,v196
v_and_b32 v194,s42,v194
M a[4:7],a[216:219],v[224:227],a[4:7]
v_and_b32 v202,s42,v202
v_and_b32 v200,s42,v200
M a[4:7],v[228:231],a[244:247],a[4:7]
v_fmac_f32 v192,s43,v198
v_fmac_f32 v194,4.0,v196
M a[8:11],v[228:231],v[224:227],a[8:11]
ds_read_b128 a[196:199],v248 offset:1536
v_fma_f32 v235,-4.0,v198,v202
M a[8:11],a[216:219],a[220:223],a[8:11]
s_waitcnt lgkmcnt(2)
ds_read_b128 a[212:215],v249 offset:1536
v_fmac_f32 v192,s45,v202
M a[8:11],a[240:243],a[208:211],a[8:11]
s_waitcnt lgkmcnt(2)
v_fmac_f32 v194,s41,v200
v_sub_f32 v202,v202,v198
M a[12:15],a[240:243],v[216:219],a[12:15]
v_fma_f32 v198,-4.0,v196,v200
v_sub_f32 v200,v200,v196
M a[12:15],a[216:219],a[208:211],a[12:15]
v_add_f32 v196,v235,v198
v_sub_f32 v235,v235,v198
M a[12:15],v[228:231],a[220:223],a[12:15]
v_fma_f32 v198,2.0,v200,v202
v_fmac_f32 v202,-2.0,v200
M a[16:19],v[228:231],a[208:211],a[16:19]
ds_read_b128 a[228:231],v249 offset:2048
v_cvt_pk_bf16_f32 v192,v232,v192
M a[16:19],a[216:219],v[216:219],a[16:19]
s_waitcnt lgkmcnt(2)
ds_read_b128 a[252:255],v248 offset:2048
v_cvt_pk_bf16_f32 v194,v237,v194
M a[16:19],a[240:243],a[196:199],a[16:19]
s_waitcnt lgkmcnt(2)
v_cvt_pk_bf16_f32 v196,v233,v196
v_cvt_pk_bf16_f32 v200,v234,v198
M a[20:23],a[240:243],a[212:215],a[20:23]
v_cvt_pk_bf16_f32 v198,v238,v235
v_cvt_pk_bf16_f32 v202,v236,v202
M a[20:23],a[216:219],a[196:199],a[20:23]
v_permlane32_swap_b32 v197,v199
v_permlane32_swap_b32 v193,v195
M a[20:23],v[228:231],v[216:219],a[20:23]
v_permlane32_swap_b32 v201,v203
v_lshlrev_b32 v234,16,v199
M a[24:27],v[228:231],a[196:199],a[24:27]
v_lshlrev_b32 v232,16,v193
v_lshlrev_b32 v233,16,v197
M a[24:27],a[216:219],a[212:215],a[24:27]
s_waitcnt lgkmcnt(1)
v_lshlrev_b32 v237,16,v195
v_lshlrev_b32 v236,16,v203
M a[24:27],a[240:243],a[228:231],a[24:27]
s_waitcnt lgkmcnt(0)
v_lshlrev_b32 v235,16,v201
v_fmac_f32 v232,s43,v234
M a[28:31],a[240:243],a[252:255],a[28:31]
buffer_load_dwordx4 a[240:243],v250,s[20:23],s46 offen offset:1024 sc1
M a[28:31],a[216:219],a[228:231],a[28:31]
v_fmac_f32 v237,4.0,v233
v_fma_f32 v238,-4.0,v234,v236
M a[28:31],v[228:231],a[212:215],a[28:31]
s_waitcnt vmcnt(10)
buffer_load_dwordx4 a[216:219],v250,s[20:23],s46 offen offset:2048 sc1
M a[32:35],v[220:223],a[204:207],a[32:35]
s_waitcnt vmcnt(10)
s_add_u32 s47,s76,21504
v_fmac_f32 v232,s45,v236
v_fmac_f32 v237,s41,v235
M a[32:35],a[200:203],a[244:247],a[32:35]
s_waitcnt vmcnt(9)
v_sub_f32 v236,v236,v234
v_fma_f32 v234,-4.0,v233,v235
M a[32:35],a[192:195],v[224:227],a[32:35]
v_sub_f32 v235,v235,v233
v_add_f32 v233,v238,v234
M a[36:39],a[192:195],a[220:223],a[36:39]
buffer_load_dwordx4 v[228:231],v250,s[20:23],s47 offen offset:0 sc1
M a[36:39],a[200:203],v[224:227],a[36:39]
v_sub_f32 v238,v238,v234
v_fma_f32 v234,2.0,v235,v236
M a[36:39],v[220:223],a[244:247],a[36:39]
v_fmac_f32 v236,-2.0,v235
v_and_b32 v199,s42,v199
M a[40:43],v[220:223],v[224:227],a[40:43]
v_and_b32 v193,s42,v193
v_and_b32 v197,s42,v197
M a[40:43],a[200:203],a[220:223],a[40:43]
v_and_b32 v195,s42,v195
v_and_b32 v203,s42,v203
M a[40:43],a[192:195],a[208:211],a[40:43]
v_and_b32 v201,s42,v201
v_fmac_f32 v193,s43,v199
M a[44:47],a[192:195],v[216:219],a[44:47]
v_fmac_f32 v195,4.0,v197
v_fma_f32 v235,-4.0,v199,v203
M a[44:47],a[200:203],a[208:211],a[44:47]
v_fmac_f32 v193,s45,v203
v_fmac_f32 v195,s41,v201
M a[44:47],v[220:223],a[220:223],a[44:47]
v_sub_f32 v203,v203,v199
v_fma_f32 v199,-4.0,v197,v201
M a[48:51],v[220:223],a[208:211],a[48:51]
v_sub_f32 v201,v201,v197
v_add_f32 v197,v235,v199
M a[48:51],a[200:203],v[216:219],a[48:51]
v_sub_f32 v235,v235,v199
v_fma_f32 v199,2.0,v201,v203
M a[48:51],a[192:195],a[196:199],a[48:51]
v_fmac_f32 v203,-2.0,v201
v_cvt_pk_bf16_f32 v193,v232,v193
M a[52:55],a[192:195],a[212:215],a[52:55]
v_cvt_pk_bf16_f32 v195,v237,v195
v_cvt_pk_bf16_f32 v197,v233,v197
M a[52:55],a[200:203],a[196:199],a[52:55]
v_cvt_pk_bf16_f32 v201,v234,v199
v_cvt_pk_bf16_f32 v199,v238,v235
M a[52:55],v[220:223],v[216:219],a[52:55]
s_waitcnt vmcnt(4)
v_cvt_pk_bf16_f32 v203,v236,v203
v_permlane32_swap_b32 v208,v210
M a[56:59],v[220:223],a[196:199],a[56:59]
s_waitcnt vmcnt(3)
v_permlane32_swap_b32 v204,v206
v_permlane32_swap_b32 v212,v214
M a[56:59],a[200:203],a[212:215],a[56:59]
v_lshlrev_b32 v234,16,v210
v_lshlrev_b32 v232,16,v204
M a[56:59],a[192:195],a[228:231],a[56:59]
ds_write2st64_b64 v247,v[192:193],v[194:195] offset0:136 offset1:153
M a[60:63],a[192:195],a[252:255],a[60:63]
s_add_u32 s28,s71,7077888
buffer_load_dwordx4 a[192:195],v250,s[20:23],s47 offen offset:1024 sc1
M a[60:63],a[200:203],a[228:231],a[60:63]
v_lshlrev_b32 v233,16,v208
v_lshlrev_b32 v237,16,v206
M a[60:63],v[220:223],a[212:215],a[60:63]
buffer_load_dwordx4 a[200:203],v250,s[20:23],s47 offen offset:2048 sc1
M a[64:67],a[236:239],a[204:207],a[64:67]
s_add_u32 s48,s76,24576
v_lshlrev_b32 v236,16,v214
v_lshlrev_b32 v235,16,v212
M a[64:67],a[224:227],a[244:247],a[64:67]
v_fmac_f32 v232,s43,v234
v_fmac_f32 v237,4.0,v233
M a[64:67],a[232:235],v[224:227],a[64:67]
ds_write2st64_b64 v247,v[196:197],v[198:199] offset0:0 offset1:17
M a[68:71],a[232:235],a[220:223],a[68:71]
buffer_load_dwordx4 v[220:223],v250,s[20:23],s48 offen offset:0 sc1
M a[68:71],a[224:227],v[224:227],a[68:71]
v_fma_f32 v238,-4.0,v234,v236
v_fmac_f32 v232,s45,v236
M a[68:71],a[236:239],a[244:247],a[68:71]
v_fmac_f32 v237,s41,v235
v_sub_f32 v236,v236,v234
M a[72:75],a[236:239],v[224:227],a[72:75]
v_fma_f32 v234,-4.0,v233,v235
v_sub_f32 v235,v235,v233
M a[72:75],a[224:227],a[220:223],a[72:75]
buffer_load_dwordx4 a[204:207],v250,s[20:23],s48 offen offset:1024 sc1
M a[72:75],a[232:235],a[208:211],a[72:75]
v_add_f32 v233,v238,v234
v_sub_f32 v238,v238,v234
M a[76:79],a[232:235],v[216:219],a[76:79]
v_fma_f32 v234,2.0,v235,v236
v_fmac_f32 v236,-2.0,v235
M a[76:79],a[224:227],a[208:211],a[76:79]
v_and_b32 v210,s42,v210
v_and_b32 v204,s42,v204
M a[76:79],a[236:239],a[220:223],a[76:79]
buffer_load_dwordx4 a[244:247],v250,s[20:23],s48 offen offset:2048 sc1
M a[80:83],a[236:239],a[208:211],a[80:83]
s_add_u32 s46,s76,27648
v_and_b32 v208,s42,v208
v_and_b32 v206,s42,v206
M a[80:83],a[224:227],v[216:219],a[80:83]
v_and_b32 v214,s42,v214
v_and_b32 v212,s42,v212
M a[80:83],a[232:235],a[196:199],a[80:83]
v_fmac_f32 v204,s43,v210
v_fmac_f32 v206,4.0,v208
M a[84:87],a[232:235],a[212:215],a[84:87]
buffer_load_dwordx4 v[224:227],v250,s[20:23],s46 offen offset:0 sc1
M a[84:87],a[224:227],a[196:199],a[84:87]
ds_read_b128 a[220:223],v248 offset:8704
v_fma_f32 v235,-4.0,v210,v214
M a[84:87],a[236:239],v[216:219],a[84:87]
ds_read_b128 a[208:211],v249 offset:8704
v_fmac_f32 v204,s45,v214
M a[88:91],a[236:239],a[196:199],a[88:91]
ds_read_b128 v[216:219],v248 offset:9216
v_fmac_f32 v206,s41,v212
M a[88:91],a[224:227],a[212:215],a[88:91]
buffer_load_dwordx4 v[192:195],v251,s[88:91],s28 offen offset:0
M a[88:91],a[232:235],a[228:231],a[88:91]
ds_read_b128 a[196:199],v249 offset:9216
v_sub_f32 v214,v214,v210
M a[92:95],a[232:235],a[252:255],a[92:95]
v_fma_f32 v210,-4.0,v208,v212
v_sub_f32 v212,v212,v208
M a[92:95],a[224:227],a[228:231],a[92:95]
v_add_f32 v208,v235,v210
v_sub_f32 v235,v235,v210
M a[92:95],a[236:239],a[212:215],a[92:95]
s_waitcnt lgkmcnt(3)
buffer_load_dwordx4 v[196:199],v245,s[8:11],s28 offen offset:0
M a[96:99],a[248:251],a[220:223],a[96:99]
s_waitcnt vmcnt(10) lgkmcnt(2)
ds_read_b128 a[232:235],v248 offset:9728
v_fma_f32 v210,2.0,v212,v214
M a[96:99],a[240:243],a[208:211],a[96:99]
s_waitcnt vmcnt(9) lgkmcnt(2)
ds_read_b128 a[252:255],v249 offset:9728
v_fmac_f32 v214,-2.0,v212
M a[96:99],a[216:219],v[216:219],a[96:99]
s_waitcnt lgkmcnt(2)
v_cvt_pk_bf16_f32 v204,v232,v204
v_cvt_pk_bf16_f32 v206,v237,v206
M a[100:103],a[216:219],a[196:199],a[100:103]
v_cvt_pk_bf16_f32 v208,v233,v208
v_cvt_pk_bf16_f32 v212,v234,v210
M a[100:103],a[240:243],v[216:219],a[100:103]
v_cvt_pk_bf16_f32 v210,v238,v235
v_cvt_pk_bf16_f32 v214,v236,v214
M a[100:103],a[248:251],a[208:211],a[100:103]
v_permlane32_swap_b32 v209,v211
v_permlane32_swap_b32 v205,v207
M a[104:107],a[248:251],v[216:219],a[104:107]
ds_read_b128 a[224:227],v248 offset:10240
v_permlane32_swap_b32 v213,v215
M a[104:107],a[240:243],a[196:199],a[104:107]
s_waitcnt lgkmcnt(2)
ds_read_b128 a[228:231],v249 offset:10240
v_lshlrev_b32 v234,16,v211
M a[104:107],a[216:219],a[232:235],a[104:107]
s_waitcnt lgkmcnt(2)
v_lshlrev_b32 v232,16,v205
v_lshlrev_b32 v233,16,v209
M a[108:111],a[216:219],a[252:255],a[108:111]
v_lshlrev_b32 v237,16,v207
v_lshlrev_b32 v236,16,v215
M a[108:111],a[240:243],a[232:235],a[108:111]
v_lshlrev_b32 v235,16,v213
v_fmac_f32 v232,s43,v234
M a[108:111],a[248:251],a[196:199],a[108:111]
v_fmac_f32 v237,4.0,v233
v_fma_f32 v238,-4.0,v234,v236
M a[112:115],a[248:251],a[232:235],a[112:115]
ds_read_b128 a[212:215],v249 offset:10752
v_fmac_f32 v232,s45,v236
M a[112:115],a[240:243],a[252:255],a[112:115]
s_waitcnt lgkmcnt(2)
ds_read_b128 a[236:239],v248 offset:10752
v_fmac_f32 v237,s41,v235
M a[112:115],a[216:219],a[224:227],a[112:115]
s_waitcnt lgkmcnt(2)
v_sub_f32 v236,v236,v234
v_fma_f32 v234,-4.0,v233,v235
M a[116:119],a[216:219],a[228:231],a[116:119]
v_sub_f32 v235,v235,v233
v_add_f32 v233,v238,v234
M a[116:119],a[240:243],a[224:227],a[116:119]
v_sub_f32 v238,v238,v234
v_fma_f32 v234,2.0,v235,v236
M a[116:119],a[248:251],a[252:255],a[116:119]
v_fmac_f32 v236,-2.0,v235
v_and_b32 v211,s42,v211
M a[120:123],a[248:251],a[224:227],a[120:123]
v_and_b32 v205,s42,v205
v_and_b32 v209,s42,v209
M a[120:123],a[240:243],a[228:231],a[120:123]
s_waitcnt lgkmcnt(1)
v_and_b32 v207,s42,v207
v_and_b32 v215,s42,v215
M a[120:123],a[216:219],a[212:215],a[120:123]
s_waitcnt lgkmcnt(0)
v_and_b32 v213,s42,v213
v_fmac_f32 v205,s43,v211
M a[124:127],a[216:219],a[236:239],a[124:127]
buffer_load_dwordx4 a[216:219],v250,s[20:23],s46 offen offset:1024 sc1
M a[124:127],a[240:243],a[212:215],a[124:127]
v_fmac_f32 v207,4.0,v209
v_fma_f32 v235,-4.0,v211,v215
M a[124:127],a[248:251],a[228:231],a[124:127]
s_waitcnt vmcnt(9)
buffer_load_dwordx4 a[240:243],v250,s[20:23],s46 offen offset:2048 sc1
M a[128:131],v[228:231],a[220:223],a[128:131]
s_waitcnt vmcnt(9)
s_add_u32 s47,s76,30720
v_fmac_f32 v205,s45,v215
v_fmac_f32 v207,s41,v213
M a[128:131],a[192:195],a[208:211],a[128:131]
s_waitcnt vmcnt(8)
v_sub_f32 v215,v215,v211
v_fma_f32 v211,-4.0,v209,v213
M a[128:131],a[200:203],v[216:219],a[128:131]
v_sub_f32 v213,v213,v209
v_add_f32 v209,v235,v211
M a[132:135],a[200:203],a[196:199],a[132:135]
buffer_load_dwordx4 a[248:251],v250,s[20:23],s47 offen offset:0 sc1
M a[132:135],a[192:195],v[216:219],a[132:135]
v_sub_f32 v235,v235,v211
v_fma_f32 v211,2.0,v213,v215
M a[132:135],v[228:231],a[208:211],a[132:135]
v_fmac_f32 v215,-2.0,v213
v_cvt_pk_bf16_f32 v205,v232,v205
M a[136:139],v[228:231],v[216:219],a[136:139]
s_barrier
v_cvt_pk_bf16_f32 v207,v237,v207
M a[136:139],a[192:195],a[196:199],a[136:139]
v_cvt_pk_bf16_f32 v209,v233,v209
v_cvt_pk_bf16_f32 v213,v234,v211
M a[136:139],a[200:203],a[232:235],a[136:139]
ds_write2st64_b64 v247,v[200:201],v[202:203] offset0:34 offset1:51
M a[140:143],a[200:203],a[252:255],a[140:143]
buffer_load_dwordx4 v[200:203],v245,s[8:11],s28 offen offset:768
M a[140:143],a[192:195],a[232:235],a[140:143]
v_cvt_pk_bf16_f32 v211,v238,v235
v_cvt_pk_bf16_f32 v215,v236,v215
M a[140:143],v[228:231],a[196:199],a[140:143]
ds_write2st64_b64 v247,v[204:205],v[206:207] offset0:137 offset1:154
M a[144:147],v[228:231],a[232:235],a[144:147]
s_add_u32 s28,s71,7471104
buffer_load_dwordx4 v[204:207],v251,s[88:91],s28 offen offset:0
M a[144:147],a[192:195],a[252:255],a[144:147]
v_fmac_f32 v239,s43,v241
v_fmac_f32 v244,4.0,v240
M a[144:147],a[200:203],a[224:227],a[144:147]
ds_write2st64_b64 v247,v[208:209],v[210:211] offset0:1 offset1:18
M a[148:151],a[200:203],a[228:231],a[148:151]
buffer_load_dwordx4 v[208:211],v245,s[8:11],s28 offen offset:0
M a[148:151],a[192:195],a[224:227],a[148:151]
v_fma_f32 v232,-4.0,v241,v243
v_fmac_f32 v239,s45,v243
M a[148:151],v[228:231],a[252:255],a[148:151]
ds_write2st64_b64 v247,v[212:213],v[214:215] offset0:35 offset1:52
M a[152:155],v[228:231],a[224:227],a[152:155]
buffer_load_dwordx4 v[212:215],v245,s[8:11],s28 offen offset:768
M a[152:155],a[192:195],a[228:231],a[152:155]
v_fmac_f32 v244,s41,v242
v_sub_f32 v243,v243,v241
M a[152:155],a[200:203],a[212:215],a[152:155]
v_fma_f32 v241,-4.0,v240,v242
v_sub_f32 v242,v242,v240
M a[156:159],a[200:203],a[236:239],a[156:159]
buffer_load_dwordx4 a[200:203],v250,s[20:23],s47 offen offset:1024 sc1
M a[156:159],a[192:195],a[212:215],a[156:159]
v_add_f32 v240,v232,v241
v_sub_f32 v232,v232,v241
M a[156:159],v[228:231],a[228:231],a[156:159]
s_waitcnt vmcnt(13)
v_fma_f32 v241,2.0,v242,v243
v_fmac_f32 v243,-2.0,v242
M a[160:163],v[220:223],a[220:223],a[160:163]
s_waitcnt vmcnt(12)
v_cvt_pk_bf16_f32 v233,v239,v244
v_cvt_pk_bf16_f32 v234,v240,v232
M a[160:163],a[204:207],a[208:211],a[160:163]
s_waitcnt vmcnt(11)
buffer_load_dwordx4 a[192:195],v250,s[20:23],s47 offen offset:2048 sc1
M a[160:163],a[244:247],v[216:219],a[160:163]
s_add_u32 s48,s76,33792
v_cvt_pk_bf16_f32 v235,v241,v243
v_add_u32 v232,69632,v252
M a[164:167],a[244:247],a[196:199],a[164:167]
ds_write_b16 v232,v233 offset:0
M a[164:167],a[204:207],v[216:219],a[164:167]
ds_write_b16_d16_hi v232,v233 offset:8704
M a[164:167],v[220:223],a[208:211],a[164:167]
buffer_load_dwordx4 v[228:231],v250,s[20:23],s48 offen offset:0 sc1
M a[168:171],v[220:223],v[216:219],a[168:171]
ds_write_b16 v252,v234 offset:0
M a[168:171],a[204:207],a[196:199],a[168:171]
ds_write_b16_d16_hi v252,v234 offset:8704
M a[168:171],a[244:247],a[232:235],a[168:171]
ds_write_b16 v252,v235 offset:17408
M a[172:175],a[244:247],a[252:255],a[172:175]
buffer_load_dwordx4 a[220:223],v250,s[20:23],s48 offen offset:1024 sc1
M a[172:175],a[204:207],a[232:235],a[172:175]
ds_write_b16_d16_hi v252,v235 offset:26112
M a[172:175],v[220:223],a[196:199],a[172:175]
M a[176:179],v[220:223],a[232:235],a[176:179]
M a[176:179],a[204:207],a[252:255],a[176:179]
buffer_load_dwordx4 a[208:211],v250,s[20:23],s48 offen offset:2048 sc1
M a[176:179],a[244:247],a[224:227],a[176:179]
s_add_u32 s46,s76,36864
M a[180:183],a[244:247],a[228:231],a[180:183]
s_waitcnt vmcnt(12)
v_permlane32_swap_b32 v196,v198
v_permlane32_swap_b32 v192,v194
M a[180:183],a[204:207],a[224:227],a[180:183]
s_waitcnt vmcnt(8)
ds_read_b128 a[196:199],v248 offset:17408
v_permlane32_swap_b32 v200,v202
M a[180:183],v[220:223],a[252:255],a[180:183]
buffer_load_dwordx4 v[216:219],v250,s[20:23],s46 offen offset:0 sc1
M a[184:187],v[220:223],a[224:227],a[184:187]
ds_read_b128 a[232:235],v249 offset:17408
ds_read_b128 a[252:255],v248 offset:17920
M a[184:187],a[204:207],a[228:231],a[184:187]
ds_read_b128 a[224:227],v249 offset:17920
v_lshlrev_b32 v234,16,v198
M a[184:187],a[244:247],a[212:215],a[184:187]
v_lshlrev_b32 v232,16,v192
v_lshlrev_b32 v233,16,v196
M a[188:191],a[244:247],a[236:239],a[188:191]
v_lshlrev_b32 v237,16,v194
v_lshlrev_b32 v236,16,v202
M a[188:191],a[204:207],a[212:215],a[188:191]
v_lshlrev_b32 v235,16,v200
v_fmac_f32 v232,s43,v234
M a[188:191],v[220:223],a[228:231],a[188:191]
s_waitcnt lgkmcnt(3)
v_fmac_f32 v237,4.0,v233
v_fma_f32 v238,-4.0,v234,v236
M v[0:3],v[224:227],a[196:199],v[0:3]
s_waitcnt lgkmcnt(2)
ds_read_b128 a[236:239],v248 offset:18432
v_fmac_f32 v232,s45,v236
M v[0:3],a[216:219],a[232:235],v[0:3]
s_waitcnt lgkmcnt(2)
ds_read_b128 a[244:247],v249 offset:18432
v_fmac_f32 v237,s41,v235
M v[0:3],a[240:243],a[252:255],v[0:3]
s_waitcnt lgkmcnt(2)
v_sub_f32 v236,v236,v234
v_fma_f32 v234,-4.0,v233,v235
M v[4:7],a[240:243],a[224:227],v[4:7]
v_sub_f32 v235,v235,v233
v_add_f32 v233,v238,v234
M v[4:7],a[216:219],a[252:255],v[4:7]
v_sub_f32 v238,v238,v234
v_fma_f32 v234,2.0,v235,v236
M v[4:7],v[224:227],a[232:235],v[4:7]
v_fmac_f32 v236,-2.0,v235
v_and_b32 v198,s42,v198
M v[8:11],v[224:227],a[252:255],v[8:11]
ds_read_b128 a[204:207],v248 offset:18944
v_and_b32 v192,s42,v192
M v[8:11],a[216:219],a[224:227],v[8:11]
s_waitcnt lgkmcnt(2)
ds_read_b128 a[212:215],v249 offset:18944
v_and_b32 v196,s42,v196
M v[8:11],a[240:243],a[236:239],v[8:11]
s_waitcnt lgkmcnt(2)
v_and_b32 v194,s42,v194
v_and_b32 v202,s42,v202
M v[12:15],a[240:243],a[244:247],v[12:15]
v_and_b32 v200,s42,v200
v_fmac_f32 v192,s43,v198
M v[12:15],a[216:219],a[236:239],v[12:15]
v_fmac_f32 v194,4.0,v196
v_fma_f32 v235,-4.0,v198,v202
M v[12:15],v[224:227],a[224:227],v[12:15]
v_fmac_f32 v192,s45,v202
v_fmac_f32 v194,s41,v200
M v[16:19],v[224:227],a[236:239],v[16:19]
ds_read_b128 a[228:231],v249 offset:19456
v_sub_f32 v202,v202,v198
M v[16:19],a[216:219],a[244:247],v[16:19]
s_waitcnt lgkmcnt(2)
ds_read_b128 v[220:223],v248 offset:19456
v_fma_f32 v198,-4.0,v196,v200
M v[16:19],a[240:243],a[204:207],v[16:19]
s_waitcnt lgkmcnt(2)
v_sub_f32 v200,v200,v196
v_add_f32 v196,v235,v198
M v[20:23],a[240:243],a[212:215],v[20:23]
v_sub_f32 v235,v235,v198
v_fma_f32 v198,2.0,v200,v202
M v[20:23],a[216:219],a[204:207],v[20:23]
v_fmac_f32 v202,-2.0,v200
v_cvt_pk_bf16_f32 v192,v232,v192
M v[20:23],v[224:227],a[244:247],v[20:23]
v_cvt_pk_bf16_f32 v194,v237,v194
v_cvt_pk_bf16_f32 v196,v233,v196
M v[24:27],v[224:227],a[204:207],v[24:27]
v_cvt_pk_bf16_f32 v200,v234,v198
v_cvt_pk_bf16_f32 v198,v238,v235
M v[24:27],a[216:219],a[212:215],v[24:27]
s_waitcnt lgkmcnt(1)
v_cvt_pk_bf16_f32 v202,v236,v202
v_permlane32_swap_b32 v197,v199
M v[24:27],a[240:243],a[228:231],v[24:27]
s_waitcnt lgkmcnt(0)
v_permlane32_swap_b32 v193,v195
v_permlane32_swap_b32 v201,v203
M v[28:31],a[240:243],v[220:223],v[28:31]
global_load_dword a240,v250,s[64:65]
M v[28:31],a[216:219],a[228:231],v[28:31]
buffer_load_dwordx4 a[240:243],v250,s[20:23],s46 offen offset:1024 sc1
M v[28:31],v[224:227],a[212:215],v[28:31]
v_lshlrev_b32 v234,16,v199
v_lshlrev_b32 v232,16,v193
M v[32:35],a[248:251],a[196:199],v[32:35]
s_waitcnt vmcnt(7)
v_lshlrev_b32 v233,16,v197
v_lshlrev_b32 v237,16,v195
M v[32:35],a[200:203],a[232:235],v[32:35]
s_waitcnt vmcnt(6)
buffer_load_dwordx4 a[216:219],v250,s[20:23],s46 offen offset:2048 sc1
M v[32:35],a[192:195],a[252:255],v[32:35]
s_add_u32 s47,s76,39936
v_lshlrev_b32 v236,16,v203
v_lshlrev_b32 v235,16,v201
M v[36:39],a[192:195],a[224:227],v[36:39]
v_fmac_f32 v232,s43,v234
v_fmac_f32 v237,4.0,v233
M v[36:39],a[200:203],a[252:255],v[36:39]
v_fma_f32 v238,-4.0,v234,v236
v_fmac_f32 v232,s45,v236
M v[36:39],a[248:251],a[232:235],v[36:39]
buffer_load_dwordx4 v[224:227],v250,s[20:23],s47 offen offset:0 sc1
M v[40:43],a[248:251],a[252:255],v[40:43]
v_fmac_f32 v237,s41,v235
v_sub_f32 v236,v236,v234
M v[40:43],a[200:203],a[224:227],v[40:43]
v_fma_f32 v234,-4.0,v233,v235
v_sub_f32 v235,v235,v233
M v[40:43],a[192:195],a[236:239],v[40:43]
v_add_f32 v233,v238,v234
v_sub_f32 v238,v238,v234
M v[44:47],a[192:195],a[244:247],v[44:47]
v_fma_f32 v234,2.0,v235,v236
v_fmac_f32 v236,-2.0,v235
M v[44:47],a[200:203],a[236:239],v[44:47]
v_and_b32 v199,s42,v199
v_and_b32 v193,s42,v193
M v[44:47],a[248:251],a[224:227],v[44:47]
v_and_b32 v197,s42,v197
v_and_b32 v195,s42,v195
M v[48:51],a[248:251],a[236:239],v[48:51]
v_and_b32 v203,s42,v203
v_and_b32 v201,s42,v201
M v[48:51],a[200:203],a[244:247],v[48:51]
v_fmac_f32 v193,s43,v199
v_fmac_f32 v195,4.0,v197
M v[48:51],a[192:195],a[204:207],v[48:51]
v_fma_f32 v235,-4.0,v199,v203
v_fmac_f32 v193,s45,v203
M v[52:55],a[192:195],a[212:215],v[52:55]
v_fmac_f32 v195,s41,v201
v_sub_f32 v203,v203,v199
M v[52:55],a[200:203],a[204:207],v[52:55]
v_fma_f32 v199,-4.0,v197,v201
v_sub_f32 v201,v201,v197
M v[52:55],a[248:251],a[244:247],v[52:55]
v_add_f32 v197,v235,v199
v_sub_f32 v235,v235,v199
M v[56:59],a[248:251],a[204:207],v[56:59]
v_fma_f32 v199,2.0,v201,v203
v_fmac_f32 v203,-2.0,v201
M v[56:59],a[200:203],a[212:215],v[56:59]
v_cvt_pk_bf16_f32 v193,v232,v193
v_cvt_pk_bf16_f32 v195,v237,v195
M v[56:59],a[192:195],a[228:231],v[56:59]
v_cvt_pk_bf16_f32 v197,v233,v197
v_cvt_pk_bf16_f32 v201,v234,v199
M v[60:63],a[192:195],v[220:223],v[60:63]
buffer_load_dwordx4 a[192:195],v250,s[20:23],s47 offen offset:1024 sc1
M v[60:63],a[200:203],a[228:231],v[60:63]
v_cvt_pk_bf16_f32 v199,v238,v235
v_cvt_pk_bf16_f32 v203,v236,v203
M v[60:63],a[248:251],a[212:215],v[60:63]
s_waitcnt vmcnt(8)
buffer_load_dwordx4 a[200:203],v250,s[20:23],s47 offen offset:2048 sc1
M v[64:67],v[228:231],a[196:199],v[64:67]
s_waitcnt vmcnt(8)
s_add_u32 s48,s76,43008
v_permlane32_swap_b32 v208,v210
v_permlane32_swap_b32 v204,v206
M v[64:67],a[220:223],a[232:235],v[64:67]
s_waitcnt vmcnt(7)
v_permlane32_swap_b32 v212,v214
v_lshlrev_b32 v234,16,v210
M v[64:67],a[208:211],a[252:255],v[64:67]
ds_write2st64_b64 v247,v[192:193],v[194:195] offset0:138 offset1:155
M v[68:71],a[208:211],a[224:227],v[68:71]
buffer_load_dwordx4 a[248:251],v250,s[20:23],s48 offen offset:0 sc1
M v[68:71],a[220:223],a[252:255],v[68:71]
v_lshlrev_b32 v232,16,v204
v_lshlrev_b32 v233,16,v208
M v[68:71],v[228:231],a[232:235],v[68:71]
ds_write2st64_b64 v247,v[196:197],v[198:199] offset0:2 offset1:19
M v[72:75],v[228:231],a[252:255],v[72:75]
buffer_load_dwordx4 a[196:199],v250,s[20:23],s48 offen offset:1024 sc1
M v[72:75],a[220:223],a[224:227],v[72:75]
v_lshlrev_b32 v237,16,v206
v_lshlrev_b32 v236,16,v214
M v[72:75],a[208:211],a[236:239],v[72:75]
ds_write2st64_b64 v247,v[200:201],v[202:203] offset0:36 offset1:53
M v[76:79],a[208:211],a[244:247],v[76:79]
buffer_load_dwordx4 a[232:235],v250,s[20:23],s48 offen offset:2048 sc1
M v[76:79],a[220:223],a[236:239],v[76:79]
s_add_u32 s46,s77,9216
v_lshlrev_b32 v235,16,v212
v_fmac_f32 v232,s43,v234
M v[76:79],v[228:231],a[224:227],v[76:79]
v_fmac_f32 v237,4.0,v233
v_fma_f32 v238,-4.0,v234,v236
M v[80:83],v[228:231],a[236:239],v[80:83]
v_fmac_f32 v232,s45,v236
v_fmac_f32 v237,s41,v235
M v[80:83],a[220:223],a[244:247],v[80:83]
buffer_load_dwordx4 a[252:255],v250,s[20:23],s46 offen offset:0 sc1
M v[80:83],a[208:211],a[204:207],v[80:83]
v_sub_f32 v236,v236,v234
v_fma_f32 v234,-4.0,v233,v235
M v[84:87],a[208:211],a[212:215],v[84:87]
v_sub_f32 v235,v235,v233
v_add_f32 v233,v238,v234
M v[84:87],a[220:223],a[204:207],v[84:87]
ds_read_b128 a[224:227],v248 offset:26112
v_sub_f32 v238,v238,v234
M v[84:87],v[228:231],a[244:247],v[84:87]
ds_read_b128 a[236:239],v249 offset:26112
v_fma_f32 v234,2.0,v235,v236
M v[88:91],v[228:231],a[204:207],v[88:91]
ds_read_b128 a[244:247],v248 offset:26624
v_fmac_f32 v236,-2.0,v235
M v[88:91],a[220:223],a[212:215],v[88:91]
ds_read_b128 a[204:207],v249 offset:26624
v_and_b32 v210,s42,v210
M v[88:91],a[208:211],a[228:231],v[88:91]
v_and_b32 v204,s42,v204
v_and_b32 v208,s42,v208
M v[92:95],a[208:211],v[220:223],v[92:95]
v_and_b32 v206,s42,v206
v_and_b32 v214,s42,v214
M v[92:95],a[220:223],a[228:231],v[92:95]
v_and_b32 v212,s42,v212
v_fmac_f32 v204,s43,v210
M v[92:95],v[228:231],a[212:215],v[92:95]
s_waitcnt vmcnt(10) lgkmcnt(3)
v_fmac_f32 v206,4.0,v208
v_fma_f32 v235,-4.0,v210,v214
M v[96:99],v[216:219],a[224:227],v[96:99]
s_waitcnt vmcnt(8) lgkmcnt(2)
ds_read_b128 a[208:211],v248 offset:27136
v_fmac_f32 v204,s45,v214
M v[96:99],a[240:243],a[236:239],v[96:99]
s_waitcnt vmcnt(7) lgkmcnt(2)
ds_read_b128 v[220:223],v249 offset:27136
v_fmac_f32 v206,s41,v212
M v[96:99],a[216:219],a[244:247],v[96:99]
s_waitcnt lgkmcnt(2)
v_sub_f32 v214,v214,v210
v_fma_f32 v210,-4.0,v208,v212
M v[100:103],a[216:219],a[204:207],v[100:103]
v_sub_f32 v212,v212,v208
v_add_f32 v208,v235,v210
M v[100:103],a[240:243],a[244:247],v[100:103]
v_sub_f32 v235,v235,v210
v_fma_f32 v210,2.0,v212,v214
M v[100:103],v[216:219],a[236:239],v[100:103]
v_fmac_f32 v214,-2.0,v212
v_cvt_pk_bf16_f32 v204,v232,v204
M v[104:107],v[216:219],a[244:247],v[104:107]
ds_read_b128 a[220:223],v248 offset:27648
v_cvt_pk_bf16_f32 v206,v237,v206
M v[104:107],a[240:243],a[204:207],v[104:107]
s_waitcnt lgkmcnt(2)
ds_read_b128 a[228:231],v249 offset:27648
v_cvt_pk_bf16_f32 v208,v233,v208
M v[104:107],a[216:219],a[208:211],v[104:107]
s_waitcnt lgkmcnt(2)
v_cvt_pk_bf16_f32 v212,v234,v210
v_cvt_pk_bf16_f32 v210,v238,v235
M v[108:111],a[216:219],v[220:223],v[108:111]
v_cvt_pk_bf16_f32 v214,v236,v214
v_permlane32_swap_b32 v209,v211
M v[108:111],a[240:243],a[208:211],v[108:111]
v_permlane32_swap_b32 v205,v207
v_permlane32_swap_b32 v213,v215
M v[108:111],v[216:219],a[204:207],v[108:111]
v_lshlrev_b32 v234,16,v211
v_lshlrev_b32 v232,16,v205
M v[112:115],v[216:219],a[208:211],v[112:115]
ds_read_b128 a[212:215],v249 offset:28160
v_lshlrev_b32 v233,16,v209
M v[112:115],a[240:243],v[220:223],v[112:115]
s_waitcnt lgkmcnt(2)
ds_read_b128 v[228:231],v248 offset:28160
v_lshlrev_b32 v237,16,v207
M v[112:115],a[216:219],a[220:223],v[112:115]
s_waitcnt lgkmcnt(2)
v_lshlrev_b32 v236,16,v215
v_lshlrev_b32 v235,16,v213
M v[116:119],a[216:219],a[228:231],v[116:119]
v_fmac_f32 v232,s43,v234
v_fmac_f32 v237,4.0,v233
M v[116:119],a[240:243],a[220:223],v[116:119]
v_fma_f32 v238,-4.0,v234,v236
v_fmac_f32 v232,s45,v236
M v[116:119],v[216:219],v[220:223],v[116:119]
v_fmac_f32 v237,s41,v235
v_sub_f32 v236,v236,v234
M v[120:123],v[216:219],a[220:223],v[120:123]
v_fma_f32 v234,-4.0,v233,v235
v_sub_f32 v235,v235,v233
M v[120:123],a[240:243],a[228:231],v[120:123]
s_waitcnt lgkmcnt(1)
v_add_f32 v233,v238,v234
v_sub_f32 v238,v238,v234
M v[120:123],a[216:219],a[212:215],v[120:123]
s_waitcnt lgkmcnt(0)
v_fma_f32 v234,2.0,v235,v236
v_fmac_f32 v236,-2.0,v235
M v[124:127],a[216:219],v[228:231],v[124:127]
buffer_load_dwordx4 a[216:219],v250,s[20:23],s46 offen offset:1024 sc1
M v[124:127],a[240:243],a[212:215],v[124:127]
v_and_b32 v211,s42,v211
v_and_b32 v205,s42,v205
M v[124:127],v[216:219],a[228:231],v[124:127]
s_waitcnt vmcnt(7)
buffer_load_dwordx4 a[240:243],v250,s[20:23],s46 offen offset:2048 sc1
M v[128:131],v[224:227],a[224:227],v[128:131]
s_waitcnt vmcnt(7)
s_add_u32 s46,s77,18432
v_and_b32 v209,s42,v209
v_and_b32 v207,s42,v207
M v[128:131],a[192:195],a[236:239],v[128:131]
s_waitcnt vmcnt(6)
v_and_b32 v215,s42,v215
v_and_b32 v213,s42,v213
M v[128:131],a[200:203],a[244:247],v[128:131]
v_fmac_f32 v205,s43,v211
v_fmac_f32 v207,4.0,v209
M v[132:135],a[200:203],a[204:207],v[132:135]
buffer_load_dwordx4 v[216:219],v250,s[20:23],s46 offen offset:0 sc1
M v[132:135],a[192:195],a[244:247],v[132:135]
v_fma_f32 v235,-4.0,v211,v215
v_fmac_f32 v205,s45,v215
M v[132:135],v[224:227],a[236:239],v[132:135]
v_fmac_f32 v207,s41,v213
v_sub_f32 v215,v215,v211
M v[136:139],v[224:227],a[244:247],v[136:139]
v_fma_f32 v211,-4.0,v209,v213
v_sub_f32 v213,v213,v209
M v[136:139],a[192:195],a[204:207],v[136:139]
v_add_f32 v209,v235,v211
v_sub_f32 v235,v235,v211
M v[136:139],a[200:203],a[208:211],v[136:139]
v_fma_f32 v211,2.0,v213,v215
v_fmac_f32 v215,-2.0,v213
M v[140:143],a[200:203],v[220:223],v[140:143]
v_cvt_pk_bf16_f32 v205,v232,v205
v_cvt_pk_bf16_f32 v207,v237,v207
M v[140:143],a[192:195],a[208:211],v[140:143]
v_cvt_pk_bf16_f32 v209,v233,v209
v_cvt_pk_bf16_f32 v213,v234,v211
M v[140:143],v[224:227],a[204:207],v[140:143]
v_cvt_pk_bf16_f32 v211,v238,v235
v_cvt_pk_bf16_f32 v215,v236,v215
M v[144:147],v[224:227],a[208:211],v[144:147]
M v[144:147],a[192:195],v[220:223],v[144:147]
M v[144:147],a[200:203],a[220:223],v[144:147]
ds_write2st64_b64 v247,v[204:205],v[206:207] offset0:139 offset1:156
M v[148:151],a[200:203],a[228:231],v[148:151]
M v[148:151],a[192:195],a[220:223],v[148:151]
M v[148:151],v[224:227],v[220:223],v[148:151]
ds_write2st64_b64 v247,v[208:209],v[210:211] offset0:3 offset1:20
M v[152:155],v[224:227],a[220:223],v[152:155]
M v[152:155],a[192:195],a[228:231],v[152:155]
M v[152:155],a[200:203],a[212:215],v[152:155]
ds_write2st64_b64 v247,v[212:213],v[214:215] offset0:37 offset1:54
M v[156:159],a[200:203],v[228:231],v[156:159]
buffer_load_dwordx4 a[200:203],v250,s[20:23],s46 offen offset:1024 sc1
M v[156:159],a[192:195],a[212:215],v[156:159]
M v[156:159],v[224:227],a[228:231],v[156:159]
s_waitcnt vmcnt(7)
buffer_load_dwordx4 a[192:195],v250,s[20:23],s46 offen offset:2048 sc1
M v[160:163],a[248:251],a[224:227],v[160:163]
s_waitcnt vmcnt(7)
s_add_u32 s46,s77,27648
M v[160:163],a[196:199],a[236:239],v[160:163]
s_waitcnt vmcnt(6)
M v[160:163],a[232:235],a[244:247],v[160:163]
M v[164:167],a[232:235],a[204:207],v[164:167]
buffer_load_dwordx4 v[224:227],v250,s[20:23],s46 offen offset:0 sc1
M v[164:167],a[196:199],a[244:247],v[164:167]
M v[164:167],a[248:251],a[236:239],v[164:167]
M v[168:171],a[248:251],a[244:247],v[168:171]
M v[168:171],a[196:199],a[204:207],v[168:171]
buffer_load_dwordx4 a[224:227],v250,s[20:23],s46 offen offset:1024 sc1
M v[168:171],a[232:235],a[208:211],v[168:171]
M v[172:175],a[232:235],v[220:223],v[172:175]
M v[172:175],a[196:199],a[208:211],v[172:175]
M v[172:175],a[248:251],a[204:207],v[172:175]
buffer_load_dwordx4 a[236:239],v250,s[20:23],s46 offen offset:2048 sc1
M v[176:179],a[248:251],a[208:211],v[176:179]
s_add_u32 s46,s77,36864
M v[176:179],a[196:199],v[220:223],v[176:179]
v_add_u32 v248,0xffffbc00,v248
v_add_u32 v249,0xffffbc00,v249
M v[176:179],a[232:235],a[220:223],v[176:179]
s_waitcnt lgkmcnt(0)
s_barrier
M v[180:183],a[232:235],a[228:231],v[180:183]
buffer_load_dwordx4 a[244:247],v250,s[20:23],s46 offen offset:0 sc1
M v[180:183],a[196:199],a[220:223],v[180:183]
ds_read_b128 a[204:207],v248 offset:0
M v[180:183],a[248:251],v[220:223],v[180:183]
ds_read_b128 a[208:211],v249 offset:0
M v[184:187],a[248:251],a[220:223],v[184:187]
ds_read_b128 v[220:223],v248 offset:512
M v[184:187],a[196:199],a[228:231],v[184:187]
ds_read_b128 a[220:223],v249 offset:512
M v[184:187],a[232:235],a[212:215],v[184:187]
M v[188:191],a[232:235],v[228:231],v[188:191]
buffer_load_dwordx4 a[232:235],v250,s[20:23],s46 offen offset:1024 sc1
M v[188:191],a[196:199],a[212:215],v[188:191]
M v[188:191],a[248:251],a[228:231],v[188:191]
s_waitcnt vmcnt(10) lgkmcnt(3)
buffer_load_dwordx4 v[228:231],v250,s[20:23],s46 offen offset:2048 sc1
M a[0:3],a[252:255],a[204:207],a[0:3]
s_waitcnt vmcnt(10) lgkmcnt(2)
s_add_u32 s47,s77,12288
ds_read_b128 a[212:215],v248 offset:1024
M a[0:3],a[216:219],a[208:211],a[0:3]
s_waitcnt vmcnt(9) lgkmcnt(2)
ds_read_b128 a[228:231],v249 offset:1024
M a[0:3],a[240:243],v[220:223],a[0:3]
s_waitcnt lgkmcnt(2)
M a[4:7],a[240:243],a[220:223],a[4:7]
buffer_load_dwordx4 a[196:199],v250,s[20:23],s47 offen offset:0 sc1
M a[4:7],a[216:219],v[220:223],a[4:7]
M a[4:7],a[252:255],a[208:211],a[4:7]
M a[8:11],a[252:255],v[220:223],a[8:11]
ds_read_b128 a[248:251],v248 offset:1536
M a[8:11],a[216:219],a[220:223],a[8:11]
s_waitcnt lgkmcnt(2)
ds_read_b128 a[204:207],v249 offset:1536
M a[8:11],a[240:243],a[212:215],a[8:11]
s_waitcnt lgkmcnt(2)
M a[12:15],a[240:243],a[228:231],a[12:15]
M a[12:15],a[216:219],a[212:215],a[12:15]
M a[12:15],a[252:255],a[220:223],a[12:15]
M a[16:19],a[252:255],a[212:215],a[16:19]
ds_read_b128 a[208:211],v249 offset:2048
M a[16:19],a[216:219],a[228:231],a[16:19]
s_waitcnt lgkmcnt(2)
ds_read_b128 v[220:223],v248 offset:2048
M a[16:19],a[240:243],a[248:251],a[16:19]
s_waitcnt lgkmcnt(2)
M a[20:23],a[240:243],a[204:207],a[20:23]
M a[20:23],a[216:219],a[248:251],a[20:23]
ds_read_b128 a[220:223],v248 offset:8704
M a[20:23],a[252:255],a[228:231],a[20:23]
ds_read_b128 a[212:215],v249 offset:8704
M a[24:27],a[252:255],a[248:251],a[24:27]
ds_read_b128 a[228:231],v248 offset:9216
M a[24:27],a[216:219],a[204:207],a[24:27]
s_waitcnt lgkmcnt(4)
ds_read_b128 a[248:251],v249 offset:9216
M a[24:27],a[240:243],a[208:211],a[24:27]
s_waitcnt lgkmcnt(4)
M a[28:31],a[240:243],v[220:223],a[28:31]
buffer_load_dwordx4 a[240:243],v250,s[20:23],s47 offen offset:1024 sc1
M a[28:31],a[216:219],a[208:211],a[28:31]
M a[28:31],a[252:255],a[204:207],a[28:31]
s_waitcnt vmcnt(10) lgkmcnt(3)
buffer_load_dwordx4 v[220:223],v250,s[20:23],s47 offen offset:2048 sc1
M a[96:99],v[216:219],a[220:223],a[96:99]
s_waitcnt vmcnt(10) lgkmcnt(2)
s_add_u32 s48,s77,15360
ds_read_b128 a[216:219],v248 offset:9728
M a[96:99],a[200:203],a[212:215],a[96:99]
s_waitcnt vmcnt(9) lgkmcnt(2)
ds_read_b128 a[204:207],v249 offset:9728
M a[96:99],a[192:195],a[228:231],a[96:99]
s_waitcnt lgkmcnt(2)
M a[100:103],a[192:195],a[248:251],a[100:103]
buffer_load_dwordx4 a[208:211],v250,s[20:23],s48 offen offset:0 sc1
M a[100:103],a[200:203],a[228:231],a[100:103]
M a[100:103],v[216:219],a[212:215],a[100:103]
M a[104:107],v[216:219],a[228:231],a[104:107]
ds_read_b128 a[252:255],v248 offset:10240
M a[104:107],a[200:203],a[248:251],a[104:107]
s_waitcnt lgkmcnt(2)
ds_read_b128 a[220:223],v249 offset:10240
M a[104:107],a[192:195],a[216:219],a[104:107]
s_waitcnt lgkmcnt(2)
M a[108:111],a[192:195],a[204:207],a[108:111]
M a[108:111],a[200:203],a[216:219],a[108:111]
M a[108:111],v[216:219],a[248:251],a[108:111]
M a[112:115],v[216:219],a[216:219],a[112:115]
ds_read_b128 a[212:215],v249 offset:10752
M a[112:115],a[200:203],a[204:207],a[112:115]
s_waitcnt lgkmcnt(2)
ds_read_b128 a[228:231],v248 offset:10752
M a[112:115],a[192:195],a[252:255],a[112:115]
s_waitcnt lgkmcnt(2)
M a[116:119],a[192:195],a[220:223],a[116:119]
M a[116:119],a[200:203],a[252:255],a[116:119]
ds_read_b128 a[248:251],v248 offset:17408
M a[116:119],v[216:219],a[204:207],a[116:119]
ds_read_b128 a[216:219],v249 offset:17408
M a[120:123],v[216:219],a[252:255],a[120:123]
ds_read_b128 a[204:207],v248 offset:17920
M a[120:123],a[200:203],a[220:223],a[120:123]
s_waitcnt lgkmcnt(4)
ds_read_b128 a[252:255],v249 offset:17920
M a[120:123],a[192:195],a[212:215],a[120:123]
s_waitcnt lgkmcnt(4)
M a[124:127],a[192:195],a[228:231],a[124:127]
buffer_load_dwordx4 a[192:195],v250,s[20:23],s48 offen offset:1024 sc1
M a[124:127],a[200:203],a[212:215],a[124:127]
M a[124:127],v[216:219],a[220:223],a[124:127]
s_waitcnt vmcnt(10) lgkmcnt(3)
buffer_load_dwordx4 a[228:231],v250,s[20:23],s48 offen offset:2048 sc1
M v[0:3],v[224:227],a[248:251],v[0:3]
s_waitcnt vmcnt(10) lgkmcnt(2)
s_add_u32 s47,s77,21504
ds_read_b128 a[212:215],v248 offset:18432
M v[0:3],a[224:227],a[216:219],v[0:3]
s_waitcnt vmcnt(9) lgkmcnt(2)
ds_read_b128 a[220:223],v249 offset:18432
M v[0:3],a[236:239],a[204:207],v[0:3]
s_waitcnt lgkmcnt(2)
M v[4:7],a[236:239],a[252:255],v[4:7]
buffer_load_dwordx4 a[200:203],v250,s[20:23],s47 offen offset:0 sc1
M v[4:7],a[224:227],a[204:207],v[4:7]
M v[4:7],v[224:227],a[216:219],v[4:7]
M v[8:11],v[224:227],a[204:207],v[8:11]
ds_read_b128 v[216:219],v248 offset:18944
M v[8:11],a[224:227],a[252:255],v[8:11]
s_waitcnt lgkmcnt(2)
ds_read_b128 a[248:251],v249 offset:18944
M v[8:11],a[236:239],a[212:215],v[8:11]
s_waitcnt lgkmcnt(2)
M v[12:15],a[236:239],a[220:223],v[12:15]
M v[12:15],a[224:227],a[212:215],v[12:15]
M v[12:15],v[224:227],a[252:255],v[12:15]
M v[16:19],v[224:227],a[212:215],v[16:19]
ds_read_b128 a[216:219],v249 offset:19456
M v[16:19],a[224:227],a[220:223],v[16:19]
s_waitcnt lgkmcnt(2)
ds_read_b128 a[204:207],v248 offset:19456
M v[16:19],a[236:239],v[216:219],v[16:19]
s_waitcnt lgkmcnt(2)
M v[20:23],a[236:239],a[248:251],v[20:23]
M v[20:23],a[224:227],v[216:219],v[20:23]
ds_read_b128 a[252:255],v248 offset:26112
M v[20:23],v[224:227],a[220:223],v[20:23]
ds_read_b128 a[212:215],v249 offset:26112
M v[24:27],v[224:227],v[216:219],v[24:27]
ds_read_b128 a[220:223],v248 offset:26624
M v[24:27],a[224:227],a[248:251],v[24:27]
s_waitcnt lgkmcnt(4)
ds_read_b128 v[216:219],v249 offset:26624
M v[24:27],a[236:239],a[216:219],v[24:27]
s_waitcnt lgkmcnt(4)
M v[28:31],a[236:239],a[204:207],v[28:31]
buffer_load_dwordx4 a[204:207],v250,s[20:23],s47 offen offset:1024 sc1
M v[28:31],a[224:227],a[216:219],v[28:31]
M v[28:31],v[224:227],a[248:251],v[28:31]
s_waitcnt vmcnt(10) lgkmcnt(3)
buffer_load_dwordx4 a[236:239],v250,s[20:23],s47 offen offset:2048 sc1
M v[96:99],a[244:247],a[252:255],v[96:99]
s_waitcnt vmcnt(10) lgkmcnt(2)
s_add_u32 s48,s77,24576
ds_read_b128 a[224:227],v248 offset:27136
M v[96:99],a[232:235],a[212:215],v[96:99]
s_waitcnt vmcnt(9) lgkmcnt(2)
ds_read_b128 a[248:251],v249 offset:27136
M v[96:99],v[228:231],a[220:223],v[96:99]
s_waitcnt lgkmcnt(2)
M v[100:103],v[228:231],v[216:219],v[100:103]
buffer_load_dwordx4 a[216:219],v250,s[20:23],s48 offen offset:0 sc1
M v[100:103],a[232:235],a[220:223],v[100:103]
M v[100:103],a[244:247],a[212:215],v[100:103]
v_accvgpr_read_b32 v238,a0
v_accvgpr_read_b32 v232,a96
M v[104:107],a[244:247],a[220:223],v[104:107]
ds_read_b128 v[224:227],v248 offset:27648
v_add_f32 v234,v238,v232
M v[104:107],a[232:235],v[216:219],v[104:107]
s_waitcnt lgkmcnt(2)
ds_read_b128 a[252:255],v249 offset:27648
v_sub_f32 v238,v238,v232
M v[104:107],v[228:231],a[224:227],v[104:107]
s_waitcnt lgkmcnt(2)
v_add_f32 v232,v0,v96
v_sub_f32 v96,v0,v96
M v[108:111],v[228:231],a[248:251],v[108:111]
v_add_f32 v0,v234,v232
v_fmac_f32 v234,4.0,v232
M v[108:111],a[232:235],a[224:227],v[108:111]
v_fma_f32 v232,2.0,v96,v238
v_fma_f32 v96,s40,v96,v238
M v[108:111],a[244:247],v[216:219],v[108:111]
v_accvgpr_read_b32 v238,a1
v_accvgpr_read_b32 v237,a97
M v[112:115],a[244:247],a[224:227],v[112:115]
ds_read_b128 a[212:215],v249 offset:28160
v_add_f32 v236,v238,v237
M v[112:115],a[232:235],a[248:251],v[112:115]
s_waitcnt lgkmcnt(2)
ds_read_b128 a[220:223],v248 offset:28160
v_sub_f32 v238,v238,v237
M v[112:115],v[228:231],v[224:227],v[112:115]
s_waitcnt lgkmcnt(2)
v_add_f32 v237,v1,v97
v_sub_f32 v97,v1,v97
M v[116:119],v[228:231],a[252:255],v[116:119]
v_add_f32 v1,v236,v237
v_fmac_f32 v236,4.0,v237
M v[116:119],a[232:235],v[224:227],v[116:119]
ds_read_b128 v[216:219],v248 offset:0
v_fma_f32 v237,2.0,v97,v238
M v[116:119],a[244:247],a[248:251],v[116:119]
ds_read_b128 a[224:227],v249 offset:0
v_fma_f32 v97,s40,v97,v238
M v[120:123],a[244:247],v[224:227],v[120:123]
ds_read_b128 a[248:251],v248 offset:512
v_cvt_pk_bf16_f32 v232,v232,v237
M v[120:123],a[232:235],a[252:255],v[120:123]
s_waitcnt lgkmcnt(4)
ds_read_b128 v[224:227],v249 offset:512
v_cvt_pk_bf16_f32 v234,v234,v236
M v[120:123],v[228:231],a[212:215],v[120:123]
s_waitcnt lgkmcnt(4)
v_accvgpr_read_b32 v238,a2
v_accvgpr_read_b32 v233,a98
M v[124:127],v[228:231],a[220:223],v[124:127]
buffer_load_dwordx4 a[220:223],v250,s[20:23],s48 offen offset:1024 sc1
M v[124:127],a[232:235],a[212:215],v[124:127]
v_add_f32 v235,v238,v233
v_sub_f32 v238,v238,v233
M v[124:127],a[244:247],a[252:255],v[124:127]
s_waitcnt vmcnt(10) lgkmcnt(3)
v_add_f32 v233,v2,v98
v_sub_f32 v98,v2,v98
M a[32:35],a[196:199],v[216:219],a[32:35]
s_waitcnt vmcnt(9) lgkmcnt(2)
ds_read_b128 v[228:231],v248 offset:1024
v_add_f32 v2,v235,v233
M a[32:35],a[240:243],a[224:227],a[32:35]
s_waitcnt vmcnt(8) lgkmcnt(2)
ds_read_b128 a[212:215],v249 offset:1024
v_fmac_f32 v235,4.0,v233
M a[32:35],v[220:223],a[248:251],a[32:35]
s_waitcnt lgkmcnt(2)
v_fma_f32 v233,2.0,v98,v238
v_fma_f32 v98,s40,v98,v238
M a[36:39],v[220:223],v[224:227],a[36:39]
v_accvgpr_read_b32 v238,a3
v_accvgpr_read_b32 v237,a99
M a[36:39],a[240:243],a[248:251],a[36:39]
v_add_f32 v236,v238,v237
v_sub_f32 v238,v238,v237
M a[36:39],a[196:199],a[224:227],a[36:39]
v_add_f32 v237,v3,v99
v_sub_f32 v99,v3,v99
M a[40:43],a[196:199],a[248:251],a[40:43]
ds_read_b128 a[96:99],v248 offset:1536
v_add_f32 v3,v236,v237
M a[40:43],a[240:243],v[224:227],a[40:43]
s_waitcnt lgkmcnt(2)
ds_read_b128 a[232:235],v249 offset:1536
v_fmac_f32 v236,4.0,v237
M a[40:43],v[220:223],v[228:231],a[40:43]
s_waitcnt lgkmcnt(2)
v_fma_f32 v237,2.0,v99,v238
v_fma_f32 v99,s40,v99,v238
M a[44:47],v[220:223],a[212:215],a[44:47]
v_cvt_pk_bf16_f32 v233,v233,v237
v_cvt_pk_bf16_f32 v235,v235,v236
M a[44:47],a[240:243],v[228:231],a[44:47]
ds_write2st64_b64 v254,v[232:233],v[234:235] offset0:68 offset1:72
M a[44:47],a[196:199],v[224:227],a[44:47]
v_accvgpr_read_b32 v238,a4
v_accvgpr_read_b32 v232,a100
M a[48:51],a[196:199],v[228:231],a[48:51]
ds_read_b128 a[244:247],v249 offset:2048
v_add_f32 v234,v238,v232
M a[48:51],a[240:243],a[212:215],a[48:51]
s_waitcnt lgkmcnt(3)
ds_read_b128 a[252:255],v248 offset:2048
v_sub_f32 v238,v238,v232
M a[48:51],v[220:223],a[96:99],a[48:51]
s_waitcnt lgkmcnt(3)
v_add_f32 v232,v4,v100
v_sub_f32 v100,v4,v100
M a[52:55],v[220:223],a[232:235],a[52:55]
v_add_f32 v4,v234,v232
v_fmac_f32 v234,4.0,v232
M a[52:55],a[240:243],a[96:99],a[52:55]
v_fma_f32 v232,2.0,v100,v238
v_fma_f32 v100,s40,v100,v238
M a[52:55],a[196:199],a[212:215],a[52:55]
v_accvgpr_read_b32 v238,a5
v_accvgpr_read_b32 v237,a101
M a[56:59],a[196:199],a[96:99],a[56:59]
v_add_f32 v236,v238,v237
v_sub_f32 v238,v238,v237
M a[56:59],a[240:243],a[232:235],a[56:59]
s_waitcnt lgkmcnt(1)
v_add_f32 v237,v5,v101
v_sub_f32 v101,v5,v101
M a[56:59],v[220:223],a[244:247],a[56:59]
s_waitcnt lgkmcnt(0)
v_add_f32 v5,v236,v237
v_fmac_f32 v236,4.0,v237
M a[60:63],v[220:223],a[252:255],a[60:63]
buffer_load_dwordx4 v[220:223],v250,s[20:23],s48 offen offset:2048 sc1
M a[60:63],a[240:243],a[244:247],a[60:63]
s_add_u32 s47,s77,30720
v_fma_f32 v237,2.0,v101,v238
v_fma_f32 v101,s40,v101,v238
M a[60:63],a[196:199],a[232:235],a[60:63]
s_waitcnt vmcnt(8)
buffer_load_dwordx4 a[240:243],v250,s[20:23],s47 offen offset:0 sc1
M a[64:67],a[208:211],v[216:219],a[64:67]
s_waitcnt vmcnt(8)
v_cvt_pk_bf16_f32 v232,v232,v237
v_cvt_pk_bf16_f32 v234,v234,v236
M a[64:67],a[192:195],a[224:227],a[64:67]
s_waitcnt vmcnt(7)
v_accvgpr_read_b32 v238,a6
v_accvgpr_read_b32 v233,a102
M a[64:67],a[228:231],a[248:251],a[64:67]
v_add_f32 v235,v238,v233
v_sub_f32 v238,v238,v233
M a[68:71],a[228:231],v[224:227],a[68:71]
buffer_load_dwordx4 a[196:199],v250,s[20:23],s47 offen offset:1024 sc1
M a[68:71],a[192:195],a[248:251],a[68:71]
v_add_f32 v233,v6,v102
v_sub_f32 v102,v6,v102
M a[68:71],a[208:211],a[224:227],a[68:71]
v_add_f32 v6,v235,v233
v_fmac_f32 v235,4.0,v233
M a[72:75],a[208:211],a[248:251],a[72:75]
v_fma_f32 v233,2.0,v102,v238
v_fma_f32 v102,s40,v102,v238
M a[72:75],a[192:195],v[224:227],a[72:75]
buffer_load_dwordx4 v[216:219],v250,s[20:23],s47 offen offset:2048 sc1
M a[72:75],a[228:231],v[228:231],a[72:75]
s_add_u32 s48,s77,33792
v_accvgpr_read_b32 v238,a7
v_accvgpr_read_b32 v237,a103
M a[76:79],a[228:231],a[212:215],a[76:79]
v_add_f32 v236,v238,v237
v_sub_f32 v238,v238,v237
M a[76:79],a[192:195],v[228:231],a[76:79]
v_add_f32 v237,v7,v103
v_sub_f32 v103,v7,v103
M a[76:79],a[208:211],v[224:227],a[76:79]
buffer_load_dwordx4 a[224:227],v250,s[20:23],s48 offen offset:0 sc1
M a[80:83],a[208:211],v[228:231],a[80:83]
v_add_f32 v7,v236,v237
v_fmac_f32 v236,4.0,v237
M a[80:83],a[192:195],a[212:215],a[80:83]
v_fma_f32 v237,2.0,v103,v238
v_fma_f32 v103,s40,v103,v238
M a[80:83],a[228:231],a[96:99],a[80:83]
v_cvt_pk_bf16_f32 v233,v233,v237
v_cvt_pk_bf16_f32 v235,v235,v236
M a[84:87],a[228:231],a[232:235],a[84:87]
buffer_load_dwordx4 a[248:251],v250,s[20:23],s48 offen offset:1024 sc1
M a[84:87],a[192:195],a[96:99],a[84:87]
ds_read_b128 v[224:227],v248 offset:8704
ds_write2st64_b64 v254,v[232:233],v[234:235] offset0:76 offset1:80
M a[84:87],a[208:211],a[212:215],a[84:87]
ds_read_b128 v[228:231],v249 offset:8704
v_accvgpr_read_b32 v238,a8
M a[88:91],a[208:211],a[96:99],a[88:91]
buffer_load_dwordx4 a[100:103],v250,s[20:23],s48 offen offset:2048 sc1
M a[88:91],a[192:195],a[232:235],a[88:91]
ds_read_b128 a[96:99],v248 offset:9216
ds_read_b128 a[212:215],v249 offset:9216
M a[88:91],a[228:231],a[244:247],a[88:91]
v_accvgpr_read_b32 v232,a104
v_add_f32 v234,v238,v232
M a[92:95],a[228:231],a[252:255],a[92:95]
v_sub_f32 v238,v238,v232
v_add_f32 v232,v8,v104
M a[92:95],a[192:195],a[244:247],a[92:95]
v_sub_f32 v104,v8,v104
v_add_f32 v8,v234,v232
M a[92:95],a[208:211],a[232:235],a[92:95]
s_waitcnt vmcnt(11) lgkmcnt(4)
v_fmac_f32 v234,4.0,v232
v_fma_f32 v232,2.0,v104,v238
M a[128:131],a[200:203],v[224:227],a[128:131]
s_waitcnt vmcnt(10) lgkmcnt(2)
ds_read_b128 a[228:231],v248 offset:9728
v_fma_f32 v104,s40,v104,v238
M a[128:131],a[204:207],v[228:231],a[128:131]
s_waitcnt vmcnt(9) lgkmcnt(2)
s_barrier
ds_read_b128 a[0:3],v250 offset:34816
M a[128:131],a[236:239],a[96:99],a[128:131]
s_waitcnt lgkmcnt(2)
ds_read_b128 a[4:7],v250 offset:38912
ds_read_b128 a[252:255],v249 offset:9728
M a[132:135],a[236:239],a[212:215],a[132:135]
v_accvgpr_read_b32 v238,a9
v_accvgpr_read_b32 v237,a105
M a[132:135],a[204:207],a[96:99],a[132:135]
v_add_f32 v236,v238,v237
v_sub_f32 v238,v238,v237
M a[132:135],a[200:203],v[228:231],a[132:135]
v_add_f32 v237,v9,v105
v_sub_f32 v105,v9,v105
M a[136:139],a[200:203],a[96:99],a[136:139]
s_add_u32 s34,s32,6291456
ds_read_b128 a[192:195],v248 offset:10240
v_add_f32 v9,v236,v237
M a[136:139],a[204:207],a[212:215],a[136:139]
s_waitcnt lgkmcnt(4)
ds_read_b128 a[244:247],v249 offset:10240
v_fmac_f32 v236,4.0,v237
M a[136:139],a[236:239],a[228:231],a[136:139]
s_waitcnt lgkmcnt(2)
buffer_store_dwordx4 a[0:3],v253,s[24:27],s34 offen offset:384 nt
M a[140:143],a[236:239],a[252:255],a[140:143]
v_fma_f32 v237,2.0,v105,v238
v_fma_f32 v105,s40,v105,v238
M a[140:143],a[204:207],a[228:231],a[140:143]
v_cvt_pk_bf16_f32 v232,v232,v237
v_cvt_pk_bf16_f32 v234,v234,v236
M a[140:143],a[200:203],a[212:215],a[140:143]
v_accvgpr_read_b32 v238,a10
v_accvgpr_read_b32 v233,a106
M a[144:147],a[200:203],a[228:231],a[144:147]
ds_read_b128 a[208:211],v249 offset:10752
v_add_f32 v235,v238,v233
M a[144:147],a[204:207],a[252:255],a[144:147]
s_waitcnt lgkmcnt(2)
ds_read_b128 a[232:235],v248 offset:10752
v_sub_f32 v238,v238,v233
M a[144:147],a[236:239],a[192:195],a[144:147]
s_waitcnt lgkmcnt(2)
v_add_f32 v233,v10,v106
v_sub_f32 v106,v10,v106
M a[148:151],a[236:239],a[244:247],a[148:151]
s_add_u32 s47,s77,39936
v_add_f32 v10,v235,v233
v_fmac_f32 v235,4.0,v233
M a[148:151],a[204:207],a[192:195],a[148:151]
v_fma_f32 v233,2.0,v106,v238
v_fma_f32 v106,s40,v106,v238
M a[148:151],a[200:203],a[252:255],a[148:151]
v_accvgpr_read_b32 v238,a11
v_accvgpr_read_b32 v237,a107
M a[152:155],a[200:203],a[192:195],a[152:155]
v_add_f32 v236,v238,v237
v_sub_f32 v238,v238,v237
M a[152:155],a[204:207],a[244:247],a[152:155]
s_waitcnt lgkmcnt(1)
v_add_f32 v237,v11,v107
v_sub_f32 v107,v11,v107
M a[152:155],a[236:239],a[208:211],a[152:155]
s_waitcnt lgkmcnt(0)
v_add_f32 v11,v236,v237
v_fmac_f32 v236,4.0,v237
M a[156:159],a[236:239],a[232:235],a[156:159]
buffer_load_dwordx4 a[104:107],v250,s[20:23],s47 offen offset:0 sc1
M a[156:159],a[204:207],a[208:211],a[156:159]
v_fma_f32 v237,2.0,v107,v238
v_fma_f32 v107,s40,v107,v238
M a[156:159],a[200:203],a[244:247],a[156:159]
s_waitcnt vmcnt(10)
buffer_load_dwordx4 a[236:239],v250,s[20:23],s47 offen offset:1024 sc1
M a[160:163],a[216:219],v[224:227],a[160:163]
s_waitcnt vmcnt(10)
v_cvt_pk_bf16_f32 v233,v233,v237
v_cvt_pk_bf16_f32 v235,v235,v236
M a[160:163],a[220:223],v[228:231],a[160:163]
s_waitcnt vmcnt(9)
ds_write2st64_b64 v254,v[232:233],v[234:235] offset0:85 offset1:89
M a[160:163],v[220:223],a[96:99],a[160:163]
v_accvgpr_read_b32 v204,a12
v_accvgpr_read_b32 v208,a108
M a[164:167],v[220:223],a[212:215],a[164:167]
buffer_load_dwordx4 a[204:207],v250,s[20:23],s47 offen offset:2048 sc1
M a[164:167],a[220:223],a[96:99],a[164:167]
s_add_u32 s48,s77,43008
s_add_u32 s34,s32,6488064
v_accvgpr_read_b32 v205,a13
M a[164:167],a[216:219],v[228:231],a[164:167]
v_accvgpr_read_b32 v209,a109
v_accvgpr_read_b32 v206,a14
M a[168:171],a[216:219],a[96:99],a[168:171]
v_accvgpr_read_b32 v210,a110
v_accvgpr_read_b32 v207,a15
v_accvgpr_read_b32 v211,a111
v_pk_add_f32 v[212:213],v[204:205],v[208:209]
v_pk_add_f32 v[214:215],v[206:207],v[210:211]
v_pk_add_f32 v[204:205],v[204:205],v[208:209] neg_lo:[0,1] neg_hi:[0,1]
v_pk_add_f32 v[206:207],v[206:207],v[210:211] neg_lo:[0,1] neg_hi:[0,1]
v_pk_add_f32 v[208:209],v[12:13],v[108:109]
v_pk_add_f32 v[210:211],v[14:15],v[110:111]
v_pk_add_f32 v[108:109],v[12:13],v[108:109] neg_lo:[0,1] neg_hi:[0,1]
v_pk_add_f32 v[110:111],v[14:15],v[110:111] neg_lo:[0,1] neg_hi:[0,1]
v_pk_add_f32 v[12:13],v[212:213],v[208:209]
v_pk_add_f32 v[14:15],v[214:215],v[210:211]
v_pk_fma_f32 v[212:213],v[208:209],4.0,v[212:213] op_sel_hi:[1,0,1]
v_pk_fma_f32 v[214:215],v[210:211],4.0,v[214:215] op_sel_hi:[1,0,1]
v_pk_fma_f32 v[208:209],v[108:109],2.0,v[204:205] op_sel_hi:[1,0,1]
v_pk_fma_f32 v[210:211],v[110:111],2.0,v[206:207] op_sel_hi:[1,0,1]
v_pk_fma_f32 v[108:109],v[108:109],s[40:41],v[204:205] op_sel_hi:[1,0,1]
v_pk_fma_f32 v[110:111],v[110:111],s[40:41],v[206:207] op_sel_hi:[1,0,1]
M a[168:171],a[220:223],a[212:215],a[168:171]
buffer_load_dwordx4 a[200:203],v250,s[20:23],s48 offen offset:0 sc1
M a[168:171],v[220:223],a[228:231],a[168:171]
v_cvt_pk_bf16_f32 v208,v208,v209
v_cvt_pk_bf16_f32 v209,v210,v211
M a[172:175],v[220:223],a[252:255],a[172:175]
buffer_load_dwordx4 v[224:227],v250,s[20:23],s48 offen offset:1024 sc1
M a[172:175],a[220:223],a[228:231],a[172:175]
v_cvt_pk_bf16_f32 v212,v212,v213
v_cvt_pk_bf16_f32 v213,v214,v215
M a[172:175],a[216:219],a[212:215],a[172:175]
ds_write2st64_b64 v254,v[208:209],v[212:213] offset0:93 offset1:97
M a[176:179],a[216:219],a[228:231],a[176:179]
v_accvgpr_read_b32 v238,a16
v_accvgpr_read_b32 v232,a112
M a[176:179],a[220:223],a[252:255],a[176:179]
buffer_load_dwordx4 v[228:231],v250,s[20:23],s48 offen offset:2048 sc1
M a[176:179],v[220:223],a[192:195],a[176:179]
s_add_u32 s46,s72,0
v_add_f32 v234,v238,v232
v_sub_f32 v238,v238,v232
M a[180:183],v[220:223],a[244:247],a[180:183]
v_add_f32 v232,v16,v112
v_sub_f32 v112,v16,v112
M a[180:183],a[220:223],a[192:195],a[180:183]
ds_read_b128 a[212:215],v248 offset:17408
v_add_f32 v16,v234,v232
M a[180:183],a[216:219],a[252:255],a[180:183]
buffer_store_dwordx4 a[4:7],v253,s[24:27],s34 offen offset:384 nt
M a[184:187],a[216:219],a[192:195],a[184:187]
ds_read_b128 a[228:231],v249 offset:17408
ds_read_b128 a[252:255],v248 offset:17920
M a[184:187],a[220:223],a[244:247],a[184:187]
ds_read_b128 a[192:195],v249 offset:17920
v_fmac_f32 v234,4.0,v232
M a[184:187],v[220:223],a[208:211],a[184:187]
buffer_load_dwordx4 a[96:99],v250,s[20:23],s46 offen offset:0 sc1
M a[188:191],v[220:223],a[232:235],a[188:191]
v_fma_f32 v232,2.0,v112,v238
v_fma_f32 v112,s40,v112,v238
M a[188:191],a[220:223],a[208:211],a[188:191]
s_waitcnt lgkmcnt(4)
s_barrier
ds_read_b128 a[8:11],v250 offset:43520
M a[188:191],a[216:219],a[244:247],a[188:191]
s_waitcnt vmcnt(14) lgkmcnt(4)
ds_read_b128 a[12:15],v250 offset:47616
v_accvgpr_read_b32 v238,a17
M v[32:35],a[240:243],a[212:215],v[32:35]
s_waitcnt vmcnt(13) lgkmcnt(4)
buffer_load_dwordx4 a[108:111],v250,s[20:23],s46 offen offset:1024 sc1
M v[32:35],a[196:199],a[228:231],v[32:35]
s_waitcnt vmcnt(13) lgkmcnt(3)
ds_read_b128 a[232:235],v248 offset:18432
ds_read_b128 v[220:223],v249 offset:18432
M v[32:35],v[216:219],a[252:255],v[32:35]
s_waitcnt lgkmcnt(4)
v_accvgpr_read_b32 v237,a113
v_add_f32 v236,v238,v237
M v[36:39],v[216:219],a[192:195],v[36:39]
s_add_u32 s34,s32,6684672
v_sub_f32 v238,v238,v237
v_add_f32 v237,v17,v113
M v[36:39],a[196:199],a[252:255],v[36:39]
v_sub_f32 v113,v17,v113
v_add_f32 v17,v236,v237
M v[36:39],a[240:243],a[228:231],v[36:39]
s_waitcnt lgkmcnt(3)
buffer_store_dwordx4 a[8:11],v253,s[24:27],s34 offen offset:384 nt
M v[40:43],a[240:243],a[252:255],v[40:43]
ds_read_b128 a[208:211],v248 offset:18944
v_fmac_f32 v236,4.0,v237
M v[40:43],a[196:199],a[192:195],v[40:43]
s_waitcnt lgkmcnt(2)
ds_read_b128 a[220:223],v249 offset:18944
v_fma_f32 v237,2.0,v113,v238
M v[40:43],v[216:219],a[232:235],v[40:43]
s_waitcnt lgkmcnt(2)
v_fma_f32 v113,s40,v113,v238
v_cvt_pk_bf16_f32 v232,v232,v237
M v[44:47],v[216:219],v[220:223],v[44:47]
v_cvt_pk_bf16_f32 v234,v234,v236
v_accvgpr_read_b32 v238,a18
M v[44:47],a[196:199],a[232:235],v[44:47]
v_accvgpr_read_b32 v233,a114
v_add_f32 v235,v238,v233
M v[44:47],a[240:243],a[192:195],v[44:47]
v_sub_f32 v238,v238,v233
v_add_f32 v233,v18,v114
M v[48:51],a[240:243],a[232:235],v[48:51]
ds_read_b128 a[216:219],v249 offset:19456
v_sub_f32 v114,v18,v114
M v[48:51],a[196:199],v[220:223],v[48:51]
s_waitcnt lgkmcnt(2)
ds_read_b128 a[244:247],v248 offset:19456
v_add_f32 v18,v235,v233
M v[48:51],v[216:219],a[208:211],v[48:51]
s_waitcnt lgkmcnt(2)
v_fmac_f32 v235,4.0,v233
v_fma_f32 v233,2.0,v114,v238
M v[52:55],v[216:219],a[220:223],v[52:55]
v_fma_f32 v114,s40,v114,v238
v_accvgpr_read_b32 v238,a19
M v[52:55],a[196:199],a[208:211],v[52:55]
v_accvgpr_read_b32 v237,a115
v_add_f32 v236,v238,v237
M v[52:55],a[240:243],v[220:223],v[52:55]
v_sub_f32 v238,v238,v237
v_add_f32 v237,v19,v115
M v[56:59],a[240:243],a[208:211],v[56:59]
v_sub_f32 v115,v19,v115
v_add_f32 v19,v236,v237
M v[56:59],a[196:199],a[220:223],v[56:59]
s_waitcnt lgkmcnt(1)
v_fmac_f32 v236,4.0,v237
v_fma_f32 v237,2.0,v115,v238
M v[56:59],v[216:219],a[216:219],v[56:59]
s_waitcnt lgkmcnt(0)
v_fma_f32 v115,s40,v115,v238
v_cvt_pk_bf16_f32 v233,v233,v237
M v[60:63],v[216:219],a[244:247],v[60:63]
buffer_load_dwordx4 a[112:115],v250,s[20:23],s46 offen offset:2048 sc1
M v[60:63],a[196:199],a[216:219],v[60:63]
s_add_u32 s46,s73,0
v_cvt_pk_bf16_f32 v235,v235,v236
M v[60:63],a[240:243],a[220:223],v[60:63]
s_waitcnt vmcnt(14)
buffer_load_dwordx4 v[216:219],v250,s[20:23],s46 offen offset:0 sc1
M v[64:67],a[224:227],a[212:215],v[64:67]
s_waitcnt vmcnt(14)
s_add_u32 s34,s32,6881280
ds_write2st64_b64 v254,v[232:233],v[234:235] offset0:68 offset1:72
M v[64:67],a[248:251],a[228:231],v[64:67]
s_waitcnt vmcnt(13)
v_accvgpr_read_b32 v238,a20
v_accvgpr_read_b32 v232,a116
M v[64:67],a[100:103],a[252:255],v[64:67]
v_add_f32 v234,v238,v232
v_sub_f32 v238,v238,v232
M v[68:71],a[100:103],a[192:195],v[68:71]
buffer_load_dwordx4 a[196:199],v250,s[20:23],s46 offen offset:1024 sc1
M v[68:71],a[248:251],a[252:255],v[68:71]
v_add_f32 v232,v20,v116
v_sub_f32 v116,v20,v116
M v[68:71],a[224:227],a[228:231],v[68:71]
v_add_f32 v20,v234,v232
v_fmac_f32 v234,4.0,v232
M v[72:75],a[224:227],a[252:255],v[72:75]
v_fma_f32 v232,2.0,v116,v238
v_fma_f32 v116,s40,v116,v238
M v[72:75],a[248:251],a[192:195],v[72:75]
buffer_load_dwordx4 a[240:243],v250,s[20:23],s46 offen offset:2048 sc1
M v[72:75],a[100:103],a[232:235],v[72:75]
s_add_u32 s46,s74,0
v_accvgpr_read_b32 v238,a21
v_accvgpr_read_b32 v237,a117
M v[76:79],a[100:103],v[220:223],v[76:79]
v_add_f32 v236,v238,v237
v_sub_f32 v238,v238,v237
M v[76:79],a[248:251],a[232:235],v[76:79]
v_add_f32 v237,v21,v117
v_sub_f32 v117,v21,v117
M v[76:79],a[224:227],a[192:195],v[76:79]
buffer_store_dwordx4 a[12:15],v253,s[24:27],s34 offen offset:384 nt
M v[80:83],a[224:227],a[232:235],v[80:83]
v_add_f32 v21,v236,v237
v_fmac_f32 v236,4.0,v237
M v[80:83],a[248:251],v[220:223],v[80:83]
v_fma_f32 v237,2.0,v117,v238
v_fma_f32 v117,s40,v117,v238
M v[80:83],a[100:103],a[208:211],v[80:83]
buffer_load_dwordx4 a[212:215],v250,s[20:23],s46 offen offset:0 sc1
M v[84:87],a[100:103],a[220:223],v[84:87]
v_cvt_pk_bf16_f32 v232,v232,v237
v_cvt_pk_bf16_f32 v234,v234,v236
M v[84:87],a[248:251],a[208:211],v[84:87]
ds_read_b128 a[192:195],v248 offset:26112
v_accvgpr_read_b32 v238,a22
M v[84:87],a[224:227],v[220:223],v[84:87]
ds_read_b128 a[232:235],v249 offset:26112
v_accvgpr_read_b32 v233,a118
M v[88:91],a[224:227],a[208:211],v[88:91]
buffer_load_dwordx4 a[228:231],v250,s[20:23],s46 offen offset:1024 sc1
M v[88:91],a[248:251],a[220:223],v[88:91]
ds_read_b128 v[220:223],v248 offset:26624
ds_read_b128 a[208:211],v249 offset:26624
M v[88:91],a[100:103],a[216:219],v[88:91]
v_add_f32 v235,v238,v233
v_sub_f32 v238,v238,v233
M v[92:95],a[100:103],a[244:247],v[92:95]
v_add_f32 v233,v22,v118
v_sub_f32 v118,v22,v118
M v[92:95],a[248:251],a[216:219],v[92:95]
buffer_load_dwordx4 a[252:255],v250,s[20:23],s46 offen offset:2048 sc1
M v[92:95],a[224:227],a[220:223],v[92:95]
s_waitcnt vmcnt(17) lgkmcnt(3)
s_add_u32 s46,s75,0
v_add_f32 v22,v235,v233
v_fmac_f32 v235,4.0,v233
M v[128:131],a[104:107],a[192:195],v[128:131]
s_waitcnt vmcnt(16) lgkmcnt(2)
ds_read_b128 a[244:247],v248 offset:27136
v_fma_f32 v233,2.0,v118,v238
M v[128:131],a[236:239],a[232:235],v[128:131]
s_waitcnt vmcnt(15) lgkmcnt(2)
ds_read_b128 a[216:219],v249 offset:27136
v_fma_f32 v118,s40,v118,v238
M v[128:131],a[204:207],v[220:223],v[128:131]
s_waitcnt lgkmcnt(2)
buffer_load_dwordx4 a[100:103],v250,s[20:23],s46 offen offset:0 sc1
M v[132:135],a[204:207],a[208:211],v[132:135]
v_accvgpr_read_b32 v238,a23
v_accvgpr_read_b32 v237,a119
M v[132:135],a[236:239],v[220:223],v[132:135]
v_add_f32 v236,v238,v237
v_sub_f32 v238,v238,v237
M v[132:135],a[104:107],a[232:235],v[132:135]
v_add_f32 v237,v23,v119
v_sub_f32 v119,v23,v119
M v[136:139],a[104:107],v[220:223],v[136:139]
ds_read_b128 a[116:119],v248 offset:27648
v_add_f32 v23,v236,v237
M v[136:139],a[236:239],a[208:211],v[136:139]
s_waitcnt lgkmcnt(2)
ds_read_b128 a[248:251],v249 offset:27648
v_fmac_f32 v236,4.0,v237
M v[136:139],a[204:207],a[244:247],v[136:139]
s_waitcnt lgkmcnt(2)
v_fma_f32 v237,2.0,v119,v238
v_fma_f32 v119,s40,v119,v238
M v[140:143],a[204:207],a[216:219],v[140:143]
v_cvt_pk_bf16_f32 v233,v233,v237
v_cvt_pk_bf16_f32 v235,v235,v236
M v[140:143],a[236:239],a[244:247],v[140:143]
ds_write2st64_b64 v254,v[232:233],v[234:235] offset0:76 offset1:80
M v[140:143],a[104:107],a[208:211],v[140:143]
v_accvgpr_read_b32 v238,a24
v_accvgpr_read_b32 v232,a120
M v[144:147],a[104:107],a[244:247],v[144:147]
ds_read_b128 a[220:223],v249 offset:28160
v_add_f32 v234,v238,v232
M v[144:147],a[236:239],a[216:219],v[144:147]
s_waitcnt lgkmcnt(3)
ds_read_b128 a[224:227],v248 offset:28160
v_sub_f32 v238,v238,v232
M v[144:147],a[204:207],a[116:119],v[144:147]
s_waitcnt lgkmcnt(3)
v_add_f32 v232,v24,v120
v_sub_f32 v120,v24,v120
M v[148:151],a[204:207],a[248:251],v[148:151]
v_add_f32 v24,v234,v232
v_fmac_f32 v234,4.0,v232
M v[148:151],a[236:239],a[116:119],v[148:151]
v_fma_f32 v232,2.0,v120,v238
v_fma_f32 v120,s40,v120,v238
M v[148:151],a[104:107],a[216:219],v[148:151]
s_waitcnt lgkmcnt(2)
s_barrier
ds_read_b128 a[16:19],v250 offset:34816
M v[152:155],a[104:107],a[116:119],v[152:155]
ds_read_b128 a[20:23],v250 offset:38912
v_accvgpr_read_b32 v238,a25
M v[152:155],a[236:239],a[248:251],v[152:155]
s_waitcnt lgkmcnt(3)
v_accvgpr_read_b32 v237,a121
v_add_f32 v236,v238,v237
M v[152:155],a[204:207],a[220:223],v[152:155]
s_waitcnt lgkmcnt(2)
v_sub_f32 v238,v238,v237
v_add_f32 v237,v25,v121
M v[156:159],a[204:207],a[224:227],v[156:159]
buffer_load_dwordx4 a[204:207],v250,s[20:23],s46 offen offset:1024 sc1
M v[156:159],a[236:239],a[220:223],v[156:159]
s_add_u32 s34,s32,7077888
v_sub_f32 v121,v25,v121
v_add_f32 v25,v236,v237
M v[156:159],a[104:107],a[248:251],v[156:159]
s_waitcnt vmcnt(16) lgkmcnt(1)
buffer_store_dwordx4 a[16:19],v253,s[24:27],s34 offen offset:384 nt
M v[160:163],a[200:203],a[192:195],v[160:163]
s_waitcnt vmcnt(16)
s_add_u32 s34,s32,7274496
v_fmac_f32 v236,4.0,v237
v_fma_f32 v237,2.0,v121,v238
M v[160:163],v[224:227],a[232:235],v[160:163]
s_waitcnt vmcnt(15)
v_fma_f32 v121,s40,v121,v238
v_cvt_pk_bf16_f32 v232,v232,v237
M v[160:163],v[228:231],v[220:223],v[160:163]
s_waitcnt lgkmcnt(0)
buffer_store_dwordx4 a[20:23],v253,s[24:27],s34 offen offset:384 nt
M v[164:167],v[228:231],a[208:211],v[164:167]
v_cvt_pk_bf16_f32 v234,v234,v236
v_accvgpr_read_b32 v238,a26
M v[164:167],v[224:227],v[220:223],v[164:167]
v_accvgpr_read_b32 v233,a122
v_add_f32 v235,v238,v233
M v[164:167],a[200:203],a[232:235],v[164:167]
buffer_load_dwordx4 a[236:239],v250,s[20:23],s46 offen offset:2048 sc1
M v[168:171],a[200:203],v[220:223],v[168:171]
s_add_u32 s46,s76,0
v_sub_f32 v238,v238,v233
v_add_f32 v233,v26,v122
M v[168:171],v[224:227],a[208:211],v[168:171]
v_sub_f32 v122,v26,v122
v_add_f32 v26,v235,v233
M v[168:171],v[228:231],a[244:247],v[168:171]
v_fmac_f32 v235,4.0,v233
v_fma_f32 v233,2.0,v122,v238
M v[172:175],v[228:231],a[216:219],v[172:175]
buffer_load_dwordx4 a[104:107],v250,s[20:23],s46 offen offset:0 sc1
M v[172:175],v[224:227],a[244:247],v[172:175]
v_fma_f32 v122,s40,v122,v238
v_accvgpr_read_b32 v238,a27
M v[172:175],a[200:203],a[208:211],v[172:175]
v_accvgpr_read_b32 v237,a123
v_add_f32 v236,v238,v237
M v[176:179],a[200:203],a[244:247],v[176:179]
v_sub_f32 v238,v238,v237
v_add_f32 v237,v27,v123
M v[176:179],v[224:227],a[216:219],v[176:179]
buffer_load_dwordx4 a[192:195],v250,s[20:23],s46 offen offset:1024 sc1
M v[176:179],v[228:231],a[116:119],v[176:179]
v_sub_f32 v123,v27,v123
v_add_f32 v27,v236,v237
M v[180:183],v[228:231],a[248:251],v[180:183]
v_fmac_f32 v236,4.0,v237
v_fma_f32 v237,2.0,v123,v238
M v[180:183],v[224:227],a[116:119],v[180:183]
ds_read_b128 a[120:123],v248 offset:52224
v_fma_f32 v123,s40,v123,v238
M v[180:183],a[200:203],a[216:219],v[180:183]
buffer_load_dwordx4 a[232:235],v250,s[20:23],s46 offen offset:2048 sc1
M v[184:187],a[200:203],a[116:119],v[184:187]
s_add_u32 s46,s77,0
ds_read_b128 a[208:211],v249 offset:52224
ds_read_b128 a[116:119],v248 offset:52736
M v[184:187],v[224:227],a[248:251],v[184:187]
ds_read_b128 a[244:247],v249 offset:52736
v_cvt_pk_bf16_f32 v233,v233,v237
M v[184:187],v[228:231],a[220:223],v[184:187]
v_cvt_pk_bf16_f32 v235,v235,v236
M v[188:191],v[228:231],a[224:227],v[188:191]
buffer_load_dwordx4 v[220:223],v250,s[20:23],s46 offen offset:0 sc1
M v[188:191],v[224:227],a[220:223],v[188:191]
ds_write2st64_b64 v254,v[232:233],v[234:235] offset0:85 offset1:89
M v[188:191],a[200:203],a[248:251],v[188:191]
s_waitcnt vmcnt(19) lgkmcnt(4)
v_accvgpr_read_b32 v204,a28
v_accvgpr_read_b32 v208,a124
M v[0:3],a[96:99],a[120:123],v[0:3]
s_waitcnt vmcnt(18) lgkmcnt(3)
ds_read_b128 a[120:123],v248 offset:53248
v_accvgpr_read_b32 v205,a29
M v[0:3],a[108:111],a[208:211],v[0:3]
s_waitcnt vmcnt(16) lgkmcnt(3)
buffer_load_dwordx4 a[216:219],v250,s[20:23],s46 offen offset:1024 sc1
M v[0:3],a[112:115],a[116:119],v[0:3]
s_waitcnt lgkmcnt(2)
ds_read_b128 a[200:203],v249 offset:53248
v_accvgpr_read_b32 v209,a125
M v[4:7],a[112:115],a[244:247],v[4:7]
v_accvgpr_read_b32 v206,a30
v_accvgpr_read_b32 v210,a126
v_accvgpr_read_b32 v207,a31
v_accvgpr_read_b32 v211,a127
v_pk_add_f32 v[212:213],v[204:205],v[208:209]
v_pk_add_f32 v[214:215],v[206:207],v[210:211]
v_pk_add_f32 v[204:205],v[204:205],v[208:209] neg_lo:[0,1] neg_hi:[0,1]
v_pk_add_f32 v[206:207],v[206:207],v[210:211] neg_lo:[0,1] neg_hi:[0,1]
v_pk_add_f32 v[208:209],v[28:29],v[124:125]
v_pk_add_f32 v[210:211],v[30:31],v[126:127]
v_pk_add_f32 v[124:125],v[28:29],v[124:125] neg_lo:[0,1] neg_hi:[0,1]
v_pk_add_f32 v[126:127],v[30:31],v[126:127] neg_lo:[0,1] neg_hi:[0,1]
v_pk_add_f32 v[28:29],v[212:213],v[208:209]
v_pk_add_f32 v[30:31],v[214:215],v[210:211]
v_pk_fma_f32 v[212:213],v[208:209],4.0,v[212:213] op_sel_hi:[1,0,1]
v_pk_fma_f32 v[214:215],v[210:211],4.0,v[214:215] op_sel_hi:[1,0,1]
v_pk_fma_f32 v[208:209],v[124:125],2.0,v[204:205] op_sel_hi:[1,0,1]
v_pk_fma_f32 v[210:211],v[126:127],2.0,v[206:207] op_sel_hi:[1,0,1]
v_pk_fma_f32 v[124:125],v[124:125],s[40:41],v[204:205] op_sel_hi:[1,0,1]
v_pk_fma_f32 v[126:127],v[126:127],s[40:41],v[206:207] op_sel_hi:[1,0,1]
M v[4:7],a[108:111],a[116:119],v[4:7]
buffer_load_dwordx4 a[224:227],v250,s[20:23],s46 offen offset:2048 sc1
M v[4:7],a[96:99],a[208:211],v[4:7]
s_add_u32 s46,s72,46080
v_cvt_pk_bf16_f32 v208,v208,v209
v_cvt_pk_bf16_f32 v209,v210,v211
M v[8:11],a[96:99],a[116:119],v[8:11]
buffer_load_dwordx4 v[228:231],v250,s[20:23],s46 offen offset:0 sc1
M v[8:11],a[108:111],a[244:247],v[8:11]
s_waitcnt lgkmcnt(1)
ds_read_b128 a[124:127],v248 offset:53760
ds_read_b128 a[116:119],v249 offset:53760
M v[8:11],a[112:115],a[120:123],v[8:11]
s_waitcnt lgkmcnt(2)
v_cvt_pk_bf16_f32 v212,v212,v213
v_cvt_pk_bf16_f32 v213,v214,v215
M v[12:15],a[112:115],a[200:203],v[12:15]
ds_write2st64_b64 v254,v[208:209],v[212:213] offset0:93 offset1:97
M v[12:15],a[108:111],a[120:123],v[12:15]
buffer_load_dwordx4 a[220:223],v250,s[20:23],s46 offen offset:1024 sc1
M v[12:15],a[96:99],a[244:247],v[12:15]
v_accvgpr_read_b32 v238,a32
v_accvgpr_read_b32 v232,a128
M v[16:19],a[96:99],a[120:123],v[16:19]
ds_read_b128 a[120:123],v249 offset:54272
v_add_f32 v234,v238,v232
M v[16:19],a[108:111],a[200:203],v[16:19]
s_waitcnt lgkmcnt(3)
ds_read_b128 a[248:251],v248 offset:54272
v_add_u32 v248,0x15400,v248
M v[16:19],a[112:115],a[124:127],v[16:19]
s_waitcnt lgkmcnt(3)
buffer_load_dwordx4 v[224:227],v250,s[20:23],s46 offen offset:2048 sc1
M v[20:23],a[112:115],a[116:119],v[20:23]
s_add_u32 s47,s72,49152
v_add_u32 v249,0x15400,v249
v_sub_f32 v238,v238,v232
M v[20:23],a[108:111],a[124:127],v[20:23]
ds_read_b128 a[208:211],v248 offset:0
v_add_f32 v232,v32,v128
M v[20:23],a[96:99],a[200:203],v[20:23]
ds_read_b128 a[244:247],v249 offset:0
v_sub_f32 v128,v32,v128
M v[24:27],a[96:99],a[124:127],v[24:27]
ds_read_b128 a[124:127],v248 offset:512
v_add_f32 v32,v234,v232
M v[24:27],a[108:111],a[116:119],v[24:27]
s_waitcnt lgkmcnt(4)
ds_read_b128 a[200:203],v249 offset:512
v_fmac_f32 v234,4.0,v232
M v[24:27],a[112:115],a[120:123],v[24:27]
s_waitcnt lgkmcnt(4)
v_fma_f32 v232,2.0,v128,v238
v_fma_f32 v128,s40,v128,v238
M v[28:31],a[112:115],a[248:251],v[28:31]
s_barrier
ds_read_b128 a[24:27],v250 offset:43520
M v[28:31],a[108:111],a[120:123],v[28:31]
ds_read_b128 a[28:31],v250 offset:47616
v_accvgpr_read_b32 v238,a33
M v[28:31],a[96:99],a[116:119],v[28:31]
s_waitcnt vmcnt(20) lgkmcnt(5)
buffer_load_dwordx4 a[112:115],v250,s[20:23],s47 offen offset:0 sc1
M v[0:3],v[216:219],a[208:211],v[0:3]
s_waitcnt vmcnt(20) lgkmcnt(4)
ds_read_b128 a[120:123],v248 offset:1024
v_accvgpr_read_b32 v237,a129
M v[0:3],a[196:199],a[244:247],v[0:3]
s_waitcnt vmcnt(19) lgkmcnt(4)
buffer_load_dwordx4 a[248:251],v250,s[20:23],s47 offen offset:1024 sc1
M v[0:3],a[240:243],a[124:127],v[0:3]
s_waitcnt lgkmcnt(3)
s_add_u32 s34,s32,7471104
ds_read_b128 a[96:99],v249 offset:1024
v_add_f32 v236,v238,v237
M v[4:7],a[240:243],a[200:203],v[4:7]
v_sub_f32 v238,v238,v237
v_add_f32 v237,v33,v129
M v[4:7],a[196:199],a[124:127],v[4:7]
v_sub_f32 v129,v33,v129
v_add_f32 v33,v236,v237
M v[4:7],v[216:219],a[244:247],v[4:7]
s_waitcnt lgkmcnt(3)
buffer_store_dwordx4 a[24:27],v253,s[24:27],s34 offen offset:384 nt
M v[8:11],v[216:219],a[124:127],v[8:11]
s_add_u32 s34,s32,7667712
ds_read_b128 a[116:119],v248 offset:1536
v_fmac_f32 v236,4.0,v237
M v[8:11],a[196:199],a[200:203],v[8:11]
s_waitcnt lgkmcnt(2)
ds_read_b128 a[124:127],v249 offset:1536
v_fma_f32 v237,2.0,v129,v238
M v[8:11],a[240:243],a[120:123],v[8:11]
s_waitcnt lgkmcnt(2)
buffer_store_dwordx4 a[28:31],v253,s[24:27],s34 offen offset:384 nt
M v[12:15],a[240:243],a[96:99],v[12:15]
v_fma_f32 v129,s40,v129,v238
v_cvt_pk_bf16_f32 v232,v232,v237
M v[12:15],a[196:199],a[120:123],v[12:15]
v_cvt_pk_bf16_f32 v234,v234,v236
v_accvgpr_read_b32 v238,a34
M v[12:15],v[216:219],a[200:203],v[12:15]
buffer_load_dwordx4 a[108:111],v250,s[20:23],s47 offen offset:2048 sc1
M v[16:19],v[216:219],a[120:123],v[16:19]
ds_read_b128 a[120:123],v249 offset:2048
v_accvgpr_read_b32 v233,a130
M v[16:19],a[196:199],a[96:99],v[16:19]
s_waitcnt lgkmcnt(2)
ds_read_b128 a[208:211],v248 offset:2048
v_add_f32 v235,v238,v233
M v[16:19],a[240:243],a[116:119],v[16:19]
s_waitcnt lgkmcnt(2)
v_sub_f32 v238,v238,v233
v_add_f32 v233,v34,v130
M v[20:23],a[240:243],a[124:127],v[20:23]
s_add_u32 s46,s73,46080
v_sub_f32 v130,v34,v130
v_add_f32 v34,v235,v233
M v[20:23],a[196:199],a[116:119],v[20:23]
ds_read_b128 a[244:247],v248 offset:17408
v_fmac_f32 v235,4.0,v233
M v[20:23],v[216:219],a[96:99],v[20:23]
ds_read_b128 a[96:99],v249 offset:17408
v_fma_f32 v233,2.0,v130,v238
M v[24:27],v[216:219],a[116:119],v[24:27]
ds_read_b128 a[116:119],v248 offset:17920
v_fma_f32 v130,s40,v130,v238
M v[24:27],a[196:199],a[124:127],v[24:27]
s_waitcnt lgkmcnt(4)
v_accvgpr_read_b32 v238,a35
v_accvgpr_read_b32 v237,a131
M v[24:27],a[240:243],a[120:123],v[24:27]
s_waitcnt lgkmcnt(3)
ds_read_b128 a[128:131],v249 offset:17920
v_add_f32 v236,v238,v237
M v[28:31],a[240:243],a[208:211],v[28:31]
buffer_load_dwordx4 a[200:203],v250,s[20:23],s46 offen offset:0 sc1
M v[28:31],a[196:199],a[120:123],v[28:31]
v_sub_f32 v238,v238,v237
v_add_f32 v237,v35,v131
M v[28:31],v[216:219],a[124:127],v[28:31]
s_waitcnt vmcnt(22) lgkmcnt(3)
buffer_load_dwordx4 a[208:211],v250,s[20:23],s46 offen offset:1024 sc1
M v[0:3],a[212:215],a[244:247],v[0:3]
s_waitcnt vmcnt(22) lgkmcnt(2)
ds_read_b128 a[124:127],v248 offset:18432
v_sub_f32 v131,v35,v131
M v[0:3],a[228:231],a[96:99],v[0:3]
s_waitcnt vmcnt(21) lgkmcnt(2)
ds_read_b128 a[240:243],v249 offset:18432
v_add_f32 v35,v236,v237
M v[0:3],a[252:255],a[116:119],v[0:3]
s_waitcnt lgkmcnt(2)
v_fmac_f32 v236,4.0,v237
v_fma_f32 v237,2.0,v131,v238
M v[4:7],a[252:255],a[128:131],v[4:7]
buffer_load_dwordx4 a[120:123],v250,s[20:23],s46 offen offset:2048 sc1
M v[4:7],a[228:231],a[116:119],v[4:7]
v_fma_f32 v131,s40,v131,v238
v_cvt_pk_bf16_f32 v233,v233,v237
M v[4:7],a[212:215],a[96:99],v[4:7]
v_cvt_pk_bf16_f32 v235,v235,v236
M v[8:11],a[212:215],a[116:119],v[8:11]
ds_read_b128 a[96:99],v248 offset:18944
ds_write2st64_b64 v254,v[232:233],v[234:235] offset0:34 offset1:38
M v[8:11],a[228:231],a[128:131],v[8:11]
s_waitcnt lgkmcnt(3)
ds_read_b128 a[116:119],v249 offset:18944
v_accvgpr_read_b32 v204,a36
M v[8:11],a[252:255],a[124:127],v[8:11]
s_waitcnt lgkmcnt(3)
v_accvgpr_read_b32 v208,a132
v_accvgpr_read_b32 v205,a37
M v[12:15],a[252:255],a[240:243],v[12:15]
v_accvgpr_read_b32 v209,a133
v_accvgpr_read_b32 v206,a38
M v[12:15],a[228:231],a[124:127],v[12:15]
v_accvgpr_read_b32 v210,a134
v_accvgpr_read_b32 v207,a39
v_accvgpr_read_b32 v211,a135
v_pk_add_f32 v[212:213],v[204:205],v[208:209]
v_pk_add_f32 v[214:215],v[206:207],v[210:211]
v_pk_add_f32 v[204:205],v[204:205],v[208:209] neg_lo:[0,1] neg_hi:[0,1]
v_pk_add_f32 v[206:207],v[206:207],v[210:211] neg_lo:[0,1] neg_hi:[0,1]
v_pk_add_f32 v[208:209],v[36:37],v[132:133]
v_pk_add_f32 v[210:211],v[38:39],v[134:135]
v_pk_add_f32 v[132:133],v[36:37],v[132:133] neg_lo:[0,1] neg_hi:[0,1]
v_pk_add_f32 v[134:135],v[38:39],v[134:135] neg_lo:[0,1] neg_hi:[0,1]
v_pk_add_f32 v[36:37],v[212:213],v[208:209]
v_pk_add_f32 v[38:39],v[214:215],v[210:211]
v_pk_fma_f32 v[212:213],v[208:209],4.0,v[212:213] op_sel_hi:[1,0,1]
v_pk_fma_f32 v[214:215],v[210:211],4.0,v[214:215] op_sel_hi:[1,0,1]
v_pk_fma_f32 v[208:209],v[132:133],2.0,v[204:205] op_sel_hi:[1,0,1]
v_pk_fma_f32 v[210:211],v[134:135],2.0,v[206:207] op_sel_hi:[1,0,1]
v_pk_fma_f32 v[132:133],v[132:133],s[40:41],v[204:205] op_sel_hi:[1,0,1]
v_pk_fma_f32 v[134:135],v[134:135],s[40:41],v[206:207] op_sel_hi:[1,0,1]
M v[12:15],a[212:215],a[128:131],v[12:15]
v_cvt_pk_bf16_f32 v208,v208,v209
v_cvt_pk_bf16_f32 v209,v210,v211
M v[16:19],a[212:215],a[124:127],v[16:19]
s_add_u32 s47,s73,49152
ds_read_b128 a[128:131],v249 offset:19456
v_cvt_pk_bf16_f32 v212,v212,v213
M v[16:19],a[228:231],a[240:243],v[16:19]
s_waitcnt lgkmcnt(3)
ds_read_b128 a[132:135],v248 offset:19456
v_cvt_pk_bf16_f32 v213,v214,v215
M v[16:19],a[252:255],a[96:99],v[16:19]
s_waitcnt lgkmcnt(2)
ds_write2st64_b64 v254,v[208:209],v[212:213] offset0:42 offset1:46
M v[20:23],a[252:255],a[116:119],v[20:23]
v_accvgpr_read_b32 v204,a40
v_accvgpr_read_b32 v208,a136
M v[20:23],a[228:231],a[96:99],v[20:23]
ds_read_b128 a[124:127],v248 offset:34816
v_accvgpr_read_b32 v205,a41
M v[20:23],a[212:215],a[240:243],v[20:23]
ds_read_b128 a[196:199],v249 offset:34816
v_accvgpr_read_b32 v209,a137
M v[24:27],a[212:215],a[96:99],v[24:27]
buffer_load_dwordx4 a[96:99],v250,s[20:23],s47 offen offset:0 sc1
M v[24:27],a[228:231],a[116:119],v[24:27]
s_waitcnt lgkmcnt(4)
v_accvgpr_read_b32 v206,a42
v_accvgpr_read_b32 v210,a138
v_accvgpr_read_b32 v207,a43
v_accvgpr_read_b32 v211,a139
v_pk_add_f32 v[212:213],v[204:205],v[208:209]
v_pk_add_f32 v[214:215],v[206:207],v[210:211]
v_pk_add_f32 v[204:205],v[204:205],v[208:209] neg_lo:[0,1] neg_hi:[0,1]
v_pk_add_f32 v[206:207],v[206:207],v[210:211] neg_lo:[0,1] neg_hi:[0,1]
v_pk_add_f32 v[208:209],v[40:41],v[136:137]
v_pk_add_f32 v[210:211],v[42:43],v[138:139]
v_pk_add_f32 v[136:137],v[40:41],v[136:137] neg_lo:[0,1] neg_hi:[0,1]
v_pk_add_f32 v[138:139],v[42:43],v[138:139] neg_lo:[0,1] neg_hi:[0,1]
v_pk_add_f32 v[40:41],v[212:213],v[208:209]
v_pk_add_f32 v[42:43],v[214:215],v[210:211]
v_pk_fma_f32 v[212:213],v[208:209],4.0,v[212:213] op_sel_hi:[1,0,1]
v_pk_fma_f32 v[214:215],v[210:211],4.0,v[214:215] op_sel_hi:[1,0,1]
v_pk_fma_f32 v[208:209],v[136:137],2.0,v[204:205] op_sel_hi:[1,0,1]
v_pk_fma_f32 v[210:211],v[138:139],2.0,v[206:207] op_sel_hi:[1,0,1]
v_pk_fma_f32 v[136:137],v[136:137],s[40:41],v[204:205] op_sel_hi:[1,0,1]
v_pk_fma_f32 v[138:139],v[138:139],s[40:41],v[206:207] op_sel_hi:[1,0,1]
M v[24:27],a[252:255],a[128:131],v[24:27]
s_waitcnt lgkmcnt(3)
ds_read_b128 a[136:139],v248 offset:35328
ds_read_b128 v[216:219],v249 offset:35328
M v[28:31],a[252:255],a[132:135],v[28:31]
buffer_load_dwordx4 a[244:247],v250,s[20:23],s47 offen offset:1024 sc1
M v[28:31],a[228:231],a[128:131],v[28:31]
v_cvt_pk_bf16_f32 v208,v208,v209
v_cvt_pk_bf16_f32 v209,v210,v211
M v[28:31],a[212:215],a[116:119],v[28:31]
s_waitcnt vmcnt(23) lgkmcnt(3)
buffer_load_dwordx4 a[132:135],v250,s[20:23],s47 offen offset:2048 sc1
M v[0:3],a[100:103],a[124:127],v[0:3]
s_waitcnt vmcnt(23) lgkmcnt(2)
ds_read_b128 a[128:131],v248 offset:35840
v_cvt_pk_bf16_f32 v212,v212,v213
M v[0:3],a[204:207],a[196:199],v[0:3]
s_waitcnt vmcnt(20) lgkmcnt(2)
ds_read_b128 a[116:119],v249 offset:35840
v_cvt_pk_bf16_f32 v213,v214,v215
M v[0:3],a[236:239],a[136:139],v[0:3]
s_waitcnt lgkmcnt(2)
ds_write2st64_b64 v254,v[208:209],v[212:213] offset0:51 offset1:55
M v[4:7],a[236:239],v[216:219],v[4:7]
v_accvgpr_read_b32 v204,a44
v_accvgpr_read_b32 v208,a140
M v[4:7],a[204:207],a[136:139],v[4:7]
v_accvgpr_read_b32 v205,a45
v_accvgpr_read_b32 v209,a141
M v[4:7],a[100:103],a[196:199],v[4:7]
v_accvgpr_read_b32 v206,a46
v_accvgpr_read_b32 v210,a142
v_accvgpr_read_b32 v207,a47
v_accvgpr_read_b32 v211,a143
v_pk_add_f32 v[212:213],v[204:205],v[208:209]
v_pk_add_f32 v[214:215],v[206:207],v[210:211]
v_pk_add_f32 v[204:205],v[204:205],v[208:209] neg_lo:[0,1] neg_hi:[0,1]
v_pk_add_f32 v[206:207],v[206:207],v[210:211] neg_lo:[0,1] neg_hi:[0,1]
v_pk_add_f32 v[208:209],v[44:45],v[140:141]
v_pk_add_f32 v[210:211],v[46:47],v[142:143]
v_pk_add_f32 v[140:141],v[44:45],v[140:141] neg_lo:[0,1] neg_hi:[0,1]
v_pk_add_f32 v[142:143],v[46:47],v[142:143] neg_lo:[0,1] neg_hi:[0,1]
v_pk_add_f32 v[44:45],v[212:213],v[208:209]
v_pk_add_f32 v[46:47],v[214:215],v[210:211]
v_pk_fma_f32 v[212:213],v[208:209],4.0,v[212:213] op_sel_hi:[1,0,1]
v_pk_fma_f32 v[214:215],v[210:211],4.0,v[214:215] op_sel_hi:[1,0,1]
v_pk_fma_f32 v[208:209],v[140:141],2.0,v[204:205] op_sel_hi:[1,0,1]
v_pk_fma_f32 v[210:211],v[142:143],2.0,v[206:207] op_sel_hi:[1,0,1]
v_pk_fma_f32 v[140:141],v[140:141],s[40:41],v[204:205] op_sel_hi:[1,0,1]
v_pk_fma_f32 v[142:143],v[142:143],s[40:41],v[206:207] op_sel_hi:[1,0,1]
M v[8:11],a[100:103],a[136:139],v[8:11]
ds_read_b128 a[124:127],v248 offset:36352
v_cvt_pk_bf16_f32 v208,v208,v209
M v[8:11],a[204:207],v[216:219],v[8:11]
s_waitcnt lgkmcnt(3)
ds_read_b128 a[136:139],v249 offset:36352
v_cvt_pk_bf16_f32 v209,v210,v211
M v[8:11],a[236:239],a[128:131],v[8:11]
s_waitcnt lgkmcnt(3)
v_cvt_pk_bf16_f32 v212,v212,v213
v_cvt_pk_bf16_f32 v213,v214,v215
M v[12:15],a[236:239],a[116:119],v[12:15]
ds_write2st64_b64 v254,v[208:209],v[212:213] offset0:59 offset1:63
M v[12:15],a[204:207],a[128:131],v[12:15]
v_accvgpr_read_b32 v238,a48
v_accvgpr_read_b32 v232,a144
M v[12:15],a[100:103],v[216:219],v[12:15]
v_add_f32 v234,v238,v232
v_sub_f32 v238,v238,v232
M v[16:19],a[100:103],a[128:131],v[16:19]
s_add_u32 s46,s74,46080
ds_read_b128 a[140:143],v249 offset:36864
v_add_f32 v232,v48,v144
M v[16:19],a[204:207],a[116:119],v[16:19]
s_waitcnt lgkmcnt(3)
ds_read_b128 a[128:131],v248 offset:36864
v_sub_f32 v144,v48,v144
M v[16:19],a[236:239],a[124:127],v[16:19]
s_waitcnt lgkmcnt(3)
v_add_f32 v48,v234,v232
v_fmac_f32 v234,4.0,v232
M v[20:23],a[236:239],a[136:139],v[20:23]
v_fma_f32 v232,2.0,v144,v238
v_fma_f32 v144,s40,v144,v238
M v[20:23],a[204:207],a[124:127],v[20:23]
ds_read_b128 a[240:243],v248 offset:52224
v_accvgpr_read_b32 v238,a49
M v[20:23],a[100:103],a[116:119],v[20:23]
ds_read_b128 a[116:119],v249 offset:52224
v_accvgpr_read_b32 v237,a145
M v[24:27],a[100:103],a[124:127],v[24:27]
buffer_load_dwordx4 a[124:127],v250,s[20:23],s46 offen offset:0 sc1
M v[24:27],a[204:207],a[136:139],v[24:27]
s_waitcnt lgkmcnt(3)
ds_read_b128 a[252:255],v248 offset:52736
ds_read_b128 a[212:215],v249 offset:52736
M v[24:27],a[236:239],a[140:143],v[24:27]
s_waitcnt lgkmcnt(4)
buffer_load_dwordx4 a[228:231],v250,s[20:23],s46 offen offset:1024 sc1
M v[28:31],a[236:239],a[128:131],v[28:31]
v_add_f32 v236,v238,v237
v_sub_f32 v238,v238,v237
M v[28:31],a[204:207],a[140:143],v[28:31]
v_add_f32 v237,v49,v145
v_sub_f32 v145,v49,v145
M v[28:31],a[100:103],a[136:139],v[28:31]
s_waitcnt vmcnt(21) lgkmcnt(3)
v_add_f32 v49,v236,v237
v_fmac_f32 v236,4.0,v237
M v[0:3],a[104:107],a[240:243],v[0:3]
s_waitcnt vmcnt(20) lgkmcnt(2)
buffer_load_dwordx4 a[196:199],v250,s[20:23],s46 offen offset:2048 sc1
M v[0:3],a[192:195],a[116:119],v[0:3]
s_waitcnt vmcnt(20) lgkmcnt(1)
ds_read_b128 a[128:131],v248 offset:53248
ds_read_b128 a[140:143],v249 offset:53248
M v[0:3],a[232:235],a[252:255],v[0:3]
s_waitcnt lgkmcnt(2)
v_fma_f32 v237,2.0,v145,v238
v_fma_f32 v145,s40,v145,v238
M v[4:7],a[232:235],a[212:215],v[4:7]
v_cvt_pk_bf16_f32 v232,v232,v237
v_cvt_pk_bf16_f32 v234,v234,v236
M v[4:7],a[192:195],a[252:255],v[4:7]
v_accvgpr_read_b32 v238,a50
v_accvgpr_read_b32 v233,a146
M v[4:7],a[104:107],a[116:119],v[4:7]
v_add_f32 v235,v238,v233
v_sub_f32 v238,v238,v233
M v[8:11],a[104:107],a[252:255],v[8:11]
ds_read_b128 a[100:103],v248 offset:53760
v_add_f32 v233,v50,v146
M v[8:11],a[192:195],a[212:215],v[8:11]
s_waitcnt lgkmcnt(2)
ds_read_b128 a[136:139],v249 offset:53760
v_sub_f32 v146,v50,v146
M v[8:11],a[232:235],a[128:131],v[8:11]
s_waitcnt lgkmcnt(2)
v_add_f32 v50,v235,v233
v_fmac_f32 v235,4.0,v233
M v[12:15],a[232:235],a[140:143],v[12:15]
v_fma_f32 v233,2.0,v146,v238
v_fma_f32 v146,s40,v146,v238
M v[12:15],a[192:195],a[128:131],v[12:15]
v_accvgpr_read_b32 v238,a51
v_accvgpr_read_b32 v237,a147
M v[12:15],a[104:107],a[212:215],v[12:15]
v_add_f32 v236,v238,v237
v_sub_f32 v238,v238,v237
M v[16:19],a[104:107],a[128:131],v[16:19]
s_add_u32 s47,s74,49152
ds_read_b128 a[116:119],v249 offset:54272
v_add_f32 v237,v51,v147
M v[16:19],a[192:195],a[140:143],v[16:19]
s_waitcnt lgkmcnt(2)
ds_read_b128 a[144:147],v248 offset:54272
v_add_u32 v248,0xffff9a00,v248
M v[16:19],a[232:235],a[100:103],v[16:19]
s_waitcnt lgkmcnt(2)
v_add_u32 v249,0xffff9a00,v249
v_sub_f32 v147,v51,v147
M v[20:23],a[232:235],a[136:139],v[20:23]
v_add_f32 v51,v236,v237
v_fmac_f32 v236,4.0,v237
M v[20:23],a[192:195],a[100:103],v[20:23]
ds_read_b128 a[128:131],v248 offset:8704
v_fma_f32 v237,2.0,v147,v238
M v[20:23],a[104:107],a[140:143],v[20:23]
ds_read_b128 a[140:143],v249 offset:8704
v_fma_f32 v147,s40,v147,v238
M v[24:27],a[104:107],a[100:103],v[24:27]
buffer_load_dwordx4 a[100:103],v250,s[20:23],s47 offen offset:0 sc1
M v[24:27],a[192:195],a[136:139],v[24:27]
s_waitcnt lgkmcnt(3)
ds_read_b128 v[216:219],v248 offset:9216
ds_read_b128 a[204:207],v249 offset:9216
M v[24:27],a[232:235],a[116:119],v[24:27]
s_waitcnt lgkmcnt(4)
buffer_load_dwordx4 a[236:239],v250,s[20:23],s47 offen offset:1024 sc1
M v[28:31],a[232:235],a[144:147],v[28:31]
v_cvt_pk_bf16_f32 v233,v233,v237
v_cvt_pk_bf16_f32 v235,v235,v236
M v[28:31],a[192:195],a[116:119],v[28:31]
ds_write2st64_b64 v254,v[232:233],v[234:235] offset0:0 offset1:4
M v[28:31],a[104:107],a[136:139],v[28:31]
s_waitcnt vmcnt(21) lgkmcnt(4)
v_accvgpr_read_b32 v204,a52
v_accvgpr_read_b32 v208,a148
M v[0:3],v[220:223],a[128:131],v[0:3]
s_waitcnt vmcnt(20) lgkmcnt(3)
buffer_load_dwordx4 a[240:243],v250,s[20:23],s47 offen offset:2048 sc1
M v[0:3],a[216:219],a[140:143],v[0:3]
s_waitcnt vmcnt(20) lgkmcnt(2)
ds_read_b128 a[144:147],v248 offset:9728
ds_read_b128 a[116:119],v249 offset:9728
M v[0:3],a[224:227],v[216:219],v[0:3]
s_waitcnt lgkmcnt(3)
v_accvgpr_read_b32 v205,a53
v_accvgpr_read_b32 v209,a149
M v[4:7],a[224:227],a[204:207],v[4:7]
v_accvgpr_read_b32 v206,a54
v_accvgpr_read_b32 v210,a150
v_accvgpr_read_b32 v207,a55
v_accvgpr_read_b32 v211,a151
v_pk_add_f32 v[212:213],v[204:205],v[208:209]
v_pk_add_f32 v[214:215],v[206:207],v[210:211]
v_pk_add_f32 v[204:205],v[204:205],v[208:209] neg_lo:[0,1] neg_hi:[0,1]
v_pk_add_f32 v[206:207],v[206:207],v[210:211] neg_lo:[0,1] neg_hi:[0,1]
v_pk_add_f32 v[208:209],v[52:53],v[148:149]
v_pk_add_f32 v[210:211],v[54:55],v[150:151]
v_pk_add_f32 v[148:149],v[52:53],v[148:149] neg_lo:[0,1] neg_hi:[0,1]
v_pk_add_f32 v[150:151],v[54:55],v[150:151] neg_lo:[0,1] neg_hi:[0,1]
v_pk_add_f32 v[52:53],v[212:213],v[208:209]
v_pk_add_f32 v[54:55],v[214:215],v[210:211]
v_pk_fma_f32 v[212:213],v[208:209],4.0,v[212:213] op_sel_hi:[1,0,1]
v_pk_fma_f32 v[214:215],v[210:211],4.0,v[214:215] op_sel_hi:[1,0,1]
v_pk_fma_f32 v[208:209],v[148:149],2.0,v[204:205] op_sel_hi:[1,0,1]
v_pk_fma_f32 v[210:211],v[150:151],2.0,v[206:207] op_sel_hi:[1,0,1]
v_pk_fma_f32 v[148:149],v[148:149],s[40:41],v[204:205] op_sel_hi:[1,0,1]
v_pk_fma_f32 v[150:151],v[150:151],s[40:41],v[206:207] op_sel_hi:[1,0,1]
M v[4:7],a[216:219],v[216:219],v[4:7]
v_cvt_pk_bf16_f32 v208,v208,v209
v_cvt_pk_bf16_f32 v209,v210,v211
M v[4:7],v[220:223],a[140:143],v[4:7]
v_cvt_pk_bf16_f32 v212,v212,v213
v_cvt_pk_bf16_f32 v213,v214,v215
M v[8:11],v[220:223],v[216:219],v[8:11]
ds_read_b128 a[104:107],v248 offset:10240
ds_write2st64_b64 v254,v[208:209],v[212:213] offset0:8 offset1:12
M v[8:11],a[216:219],a[204:207],v[8:11]
s_waitcnt lgkmcnt(3)
ds_read_b128 a[136:139],v249 offset:10240
v_accvgpr_read_b32 v204,a56
M v[8:11],a[224:227],a[144:147],v[8:11]
s_waitcnt lgkmcnt(3)
v_accvgpr_read_b32 v208,a152
v_accvgpr_read_b32 v205,a57
M v[12:15],a[224:227],a[116:119],v[12:15]
v_accvgpr_read_b32 v209,a153
v_accvgpr_read_b32 v206,a58
M v[12:15],a[216:219],a[144:147],v[12:15]
v_accvgpr_read_b32 v210,a154
v_accvgpr_read_b32 v207,a59
v_accvgpr_read_b32 v211,a155
v_pk_add_f32 v[212:213],v[204:205],v[208:209]
v_pk_add_f32 v[214:215],v[206:207],v[210:211]
v_pk_add_f32 v[204:205],v[204:205],v[208:209] neg_lo:[0,1] neg_hi:[0,1]
v_pk_add_f32 v[206:207],v[206:207],v[210:211] neg_lo:[0,1] neg_hi:[0,1]
v_pk_add_f32 v[208:209],v[56:57],v[152:153]
v_pk_add_f32 v[210:211],v[58:59],v[154:155]
v_pk_add_f32 v[152:153],v[56:57],v[152:153] neg_lo:[0,1] neg_hi:[0,1]
v_pk_add_f32 v[154:155],v[58:59],v[154:155] neg_lo:[0,1] neg_hi:[0,1]
v_pk_add_f32 v[56:57],v[212:213],v[208:209]
v_pk_add_f32 v[58:59],v[214:215],v[210:211]
v_pk_fma_f32 v[212:213],v[208:209],4.0,v[212:213] op_sel_hi:[1,0,1]
v_pk_fma_f32 v[214:215],v[210:211],4.0,v[214:215] op_sel_hi:[1,0,1]
v_pk_fma_f32 v[208:209],v[152:153],2.0,v[204:205] op_sel_hi:[1,0,1]
v_pk_fma_f32 v[210:211],v[154:155],2.0,v[206:207] op_sel_hi:[1,0,1]
v_pk_fma_f32 v[152:153],v[152:153],s[40:41],v[204:205] op_sel_hi:[1,0,1]
v_pk_fma_f32 v[154:155],v[154:155],s[40:41],v[206:207] op_sel_hi:[1,0,1]
M v[12:15],v[220:223],a[204:207],v[12:15]
v_cvt_pk_bf16_f32 v208,v208,v209
v_cvt_pk_bf16_f32 v209,v210,v211
M v[16:19],v[220:223],a[144:147],v[16:19]
s_add_u32 s46,s75,46080
ds_read_b128 a[128:131],v249 offset:10752
v_cvt_pk_bf16_f32 v212,v212,v213
M v[16:19],a[216:219],a[116:119],v[16:19]
s_waitcnt lgkmcnt(3)
ds_read_b128 a[148:151],v248 offset:10752
v_cvt_pk_bf16_f32 v213,v214,v215
M v[16:19],a[224:227],a[104:107],v[16:19]
s_waitcnt lgkmcnt(2)
ds_write2st64_b64 v254,v[208:209],v[212:213] offset0:17 offset1:21
M v[20:23],a[224:227],a[136:139],v[20:23]
v_accvgpr_read_b32 v204,a60
v_accvgpr_read_b32 v208,a156
M v[20:23],a[216:219],a[104:107],v[20:23]
ds_read_b128 a[140:143],v248 offset:0
v_accvgpr_read_b32 v205,a61
M v[20:23],v[220:223],a[116:119],v[20:23]
ds_read_b128 a[152:155],v249 offset:0
v_accvgpr_read_b32 v209,a157
M v[24:27],v[220:223],a[104:107],v[24:27]
buffer_load_dwordx4 a[144:147],v250,s[20:23],s46 offen offset:0 sc1
M v[24:27],a[216:219],a[136:139],v[24:27]
s_waitcnt lgkmcnt(4)
ds_read_b128 a[116:119],v248 offset:512
ds_read_b128 a[252:255],v249 offset:512
M v[24:27],a[224:227],a[128:131],v[24:27]
s_waitcnt lgkmcnt(5)
buffer_load_dwordx4 a[104:107],v250,s[20:23],s46 offen offset:1024 sc1
M v[28:31],a[224:227],a[148:151],v[28:31]
v_accvgpr_read_b32 v206,a62
v_accvgpr_read_b32 v210,a158
v_accvgpr_read_b32 v207,a63
v_accvgpr_read_b32 v211,a159
v_pk_add_f32 v[212:213],v[204:205],v[208:209]
v_pk_add_f32 v[214:215],v[206:207],v[210:211]
v_pk_add_f32 v[204:205],v[204:205],v[208:209] neg_lo:[0,1] neg_hi:[0,1]
v_pk_add_f32 v[206:207],v[206:207],v[210:211] neg_lo:[0,1] neg_hi:[0,1]
v_pk_add_f32 v[208:209],v[60:61],v[156:157]
v_pk_add_f32 v[210:211],v[62:63],v[158:159]
v_pk_add_f32 v[156:157],v[60:61],v[156:157] neg_lo:[0,1] neg_hi:[0,1]
v_pk_add_f32 v[158:159],v[62:63],v[158:159] neg_lo:[0,1] neg_hi:[0,1]
v_pk_add_f32 v[60:61],v[212:213],v[208:209]
v_pk_add_f32 v[62:63],v[214:215],v[210:211]
v_pk_fma_f32 v[212:213],v[208:209],4.0,v[212:213] op_sel_hi:[1,0,1]
v_pk_fma_f32 v[214:215],v[210:211],4.0,v[214:215] op_sel_hi:[1,0,1]
v_pk_fma_f32 v[208:209],v[156:157],2.0,v[204:205] op_sel_hi:[1,0,1]
v_pk_fma_f32 v[210:211],v[158:159],2.0,v[206:207] op_sel_hi:[1,0,1]
v_pk_fma_f32 v[156:157],v[156:157],s[40:41],v[204:205] op_sel_hi:[1,0,1]
v_pk_fma_f32 v[158:159],v[158:159],s[40:41],v[206:207] op_sel_hi:[1,0,1]
M v[28:31],a[216:219],a[128:131],v[28:31]
buffer_load_dwordx4 a[156:159],v250,s[20:23],s46 offen offset:2048 sc1
M v[28:31],v[220:223],a[136:139],v[28:31]
s_waitcnt vmcnt(22) lgkmcnt(3)
v_cvt_pk_bf16_f32 v208,v208,v209
v_cvt_pk_bf16_f32 v209,v210,v211
M v[96:99],v[228:231],a[140:143],v[96:99]
s_waitcnt vmcnt(21) lgkmcnt(2)
ds_read_b128 a[148:151],v248 offset:1024
v_cvt_pk_bf16_f32 v212,v212,v213
M v[96:99],a[220:223],a[152:155],v[96:99]
s_waitcnt vmcnt(20) lgkmcnt(2)
ds_read_b128 a[128:131],v249 offset:1024
v_cvt_pk_bf16_f32 v213,v214,v215
M v[96:99],v[224:227],a[116:119],v[96:99]
s_waitcnt lgkmcnt(2)
ds_write2st64_b64 v254,v[208:209],v[212:213] offset0:25 offset1:29
M v[100:103],v[224:227],a[252:255],v[100:103]
v_cvt_pk_bf16_f32 v0,v0,v1
v_cvt_pk_bf16_f32 v1,v2,v3
M v[100:103],a[220:223],a[116:119],v[100:103]
v_cvt_pk_bf16_f32 v4,v4,v5
v_cvt_pk_bf16_f32 v5,v6,v7
M v[100:103],v[228:231],a[152:155],v[100:103]
s_waitcnt lgkmcnt(0)
s_barrier
ds_read_b128 a[32:35],v250 offset:17408
M v[104:107],v[228:231],a[116:119],v[104:107]
ds_read_b128 a[36:39],v250 offset:21504
ds_read_b128 a[40:43],v250 offset:26112
M v[104:107],a[220:223],a[252:255],v[104:107]
ds_read_b128 a[44:47],v250 offset:30208
ds_read_b128 a[48:51],v250 offset:0
M v[104:107],v[224:227],a[148:151],v[104:107]
ds_read_b128 a[52:55],v250 offset:4096
ds_read_b128 a[56:59],v250 offset:8704
M v[108:111],v[224:227],a[128:131],v[108:111]
ds_read_b128 a[60:63],v250 offset:12800
ds_read_b128 a[136:139],v248 offset:1536
M v[108:111],a[220:223],a[148:151],v[108:111]
s_add_u32 s34,s32,6291456
ds_read_b128 a[212:215],v249 offset:1536
ds_write2st64_b64 v254,v[0:1],v[4:5] offset0:68 offset1:72
M v[108:111],v[228:231],a[252:255],v[108:111]
s_waitcnt lgkmcnt(10)
buffer_store_dwordx4 a[32:35],v253,s[24:27],s34 offen offset:512 nt
M v[112:115],v[228:231],a[148:151],v[112:115]
s_add_u32 s34,s32,6488064
ds_read_b128 a[232:235],v249 offset:2048
v_cvt_pk_bf16_f32 v8,v8,v9
M v[112:115],a[220:223],a[128:131],v[112:115]
s_waitcnt lgkmcnt(3)
ds_read_b128 a[192:195],v248 offset:2048
v_cvt_pk_bf16_f32 v9,v10,v11
M v[112:115],v[224:227],a[136:139],v[112:115]
s_waitcnt lgkmcnt(3)
buffer_store_dwordx4 a[36:39],v253,s[24:27],s34 offen offset:512 nt
M v[116:119],v[224:227],a[212:215],v[116:119]
s_add_u32 s34,s32,6684672
v_cvt_pk_bf16_f32 v12,v12,v13
v_cvt_pk_bf16_f32 v13,v14,v15
M v[116:119],a[220:223],a[136:139],v[116:119]
ds_write2st64_b64 v254,v[8:9],v[12:13] offset0:76 offset1:80
M v[116:119],v[228:231],a[128:131],v[116:119]
buffer_store_dwordx4 a[40:43],v253,s[24:27],s34 offen offset:512 nt
M v[120:123],v[228:231],a[136:139],v[120:123]
s_add_u32 s34,s32,6881280
global_load_dword v216,v250,s[64:65]
M v[120:123],a[220:223],a[212:215],v[120:123]
s_waitcnt lgkmcnt(2)
s_add_u32 s47,s75,49152
v_cvt_pk_bf16_f32 v16,v16,v17
v_cvt_pk_bf16_f32 v17,v18,v19
M v[120:123],v[224:227],a[232:235],v[120:123]
s_waitcnt lgkmcnt(1)
buffer_store_dwordx4 a[44:47],v253,s[24:27],s34 offen offset:512 nt
M v[124:127],v[224:227],a[192:195],v[124:127]
s_add_u32 s34,s32,7077888
v_cvt_pk_bf16_f32 v20,v20,v21
v_cvt_pk_bf16_f32 v21,v22,v23
M v[124:127],a[220:223],a[232:235],v[124:127]
ds_write2st64_b64 v254,v[16:17],v[20:21] offset0:85 offset1:89
M v[124:127],v[228:231],a[212:215],v[124:127]
s_waitcnt vmcnt(24)
buffer_store_dwordx4 a[48:51],v253,s[24:27],s34 offen offset:512 nt
M v[128:131],a[112:115],a[140:143],v[128:131]
s_waitcnt vmcnt(24)
s_add_u32 s34,s32,7274496
v_cvt_pk_bf16_f32 v24,v24,v25
v_cvt_pk_bf16_f32 v25,v26,v27
M v[128:131],a[248:251],a[152:155],v[128:131]
s_waitcnt vmcnt(21)
v_cvt_pk_bf16_f32 v28,v28,v29
v_cvt_pk_bf16_f32 v29,v30,v31
M v[128:131],a[108:111],a[116:119],v[128:131]
buffer_store_dwordx4 a[52:55],v253,s[24:27],s34 offen offset:512 nt
M v[132:135],a[108:111],a[252:255],v[132:135]
s_add_u32 s34,s32,7471104
ds_write2st64_b64 v254,v[24:25],v[28:29] offset0:93 offset1:97
M v[132:135],a[248:251],a[116:119],v[132:135]
buffer_load_dwordx4 v[216:219],v250,s[20:23],s47 offen offset:0 sc1
M v[132:135],a[112:115],a[152:155],v[132:135]
v_accvgpr_read_b32 v238,a64
v_accvgpr_read_b32 v232,a160
M v[136:139],a[112:115],a[116:119],v[136:139]
v_add_f32 v234,v238,v232
v_sub_f32 v238,v238,v232
M v[136:139],a[248:251],a[252:255],v[136:139]
v_add_f32 v232,v64,v160
v_sub_f32 v160,v64,v160
M v[136:139],a[108:111],a[148:151],v[136:139]
buffer_load_dwordx4 a[204:207],v250,s[20:23],s47 offen offset:1024 sc1
M v[140:143],a[108:111],a[128:131],v[140:143]
v_add_f32 v64,v234,v232
v_fmac_f32 v234,4.0,v232
M v[140:143],a[248:251],a[148:151],v[140:143]
v_fma_f32 v232,2.0,v160,v238
v_fma_f32 v160,s40,v160,v238
M v[140:143],a[112:115],a[252:255],v[140:143]
s_waitcnt lgkmcnt(0)
s_barrier
ds_read_b128 v[0:3],v250 offset:34816
M v[144:147],a[112:115],a[148:151],v[144:147]
ds_read_b128 v[8:11],v250 offset:38912
ds_read_b128 v[16:19],v250 offset:43520
M v[144:147],a[248:251],a[128:131],v[144:147]
ds_read_b128 v[24:27],v250 offset:47616
v_accvgpr_read_b32 v238,a65
M v[144:147],a[108:111],a[136:139],v[144:147]
buffer_load_dwordx4 a[224:227],v250,s[20:23],s47 offen offset:2048 sc1
M v[148:151],a[108:111],a[212:215],v[148:151]
s_add_u32 s46,s76,46080
v_accvgpr_read_b32 v237,a161
v_add_f32 v236,v238,v237
M v[148:151],a[248:251],a[136:139],v[148:151]
ds_read_b128 a[140:143],v248 offset:34816
v_sub_f32 v238,v238,v237
M v[148:151],a[112:115],a[128:131],v[148:151]
buffer_store_dwordx4 a[56:59],v253,s[24:27],s34 offen offset:512 nt
M v[152:155],a[112:115],a[136:139],v[152:155]
ds_read_b128 a[152:155],v249 offset:34816
ds_read_b128 a[148:151],v248 offset:35328
M v[152:155],a[248:251],a[212:215],v[152:155]
buffer_load_dwordx4 a[116:119],v250,s[20:23],s46 offen offset:0 sc1
M v[152:155],a[108:111],a[232:235],v[152:155]
ds_read_b128 a[136:139],v249 offset:35328
v_add_f32 v237,v65,v161
M v[156:159],a[108:111],a[192:195],v[156:159]
v_sub_f32 v161,v65,v161
v_add_f32 v65,v236,v237
M v[156:159],a[248:251],a[232:235],v[156:159]
v_fmac_f32 v236,4.0,v237
v_fma_f32 v237,2.0,v161,v238
M v[156:159],a[112:115],a[212:215],v[156:159]
s_waitcnt vmcnt(26) lgkmcnt(3)
buffer_load_dwordx4 a[128:131],v250,s[20:23],s46 offen offset:1024 sc1
M v[96:99],a[200:203],a[140:143],v[96:99]
s_waitcnt vmcnt(26) lgkmcnt(2)
ds_read_b128 a[108:111],v248 offset:35840
v_fma_f32 v161,s40,v161,v238
M v[96:99],a[208:211],a[152:155],v[96:99]
s_waitcnt vmcnt(25) lgkmcnt(2)
s_add_u32 s34,s32,7667712
ds_read_b128 a[112:115],v249 offset:35840
v_cvt_pk_bf16_f32 v232,v232,v237
M v[96:99],a[120:123],a[148:151],v[96:99]
s_waitcnt lgkmcnt(2)
v_cvt_pk_bf16_f32 v234,v234,v236
v_accvgpr_read_b32 v238,a66
M v[100:103],a[120:123],a[136:139],v[100:103]
buffer_load_dwordx4 a[216:219],v250,s[20:23],s46 offen offset:2048 sc1
M v[100:103],a[208:211],a[148:151],v[100:103]
v_accvgpr_read_b32 v233,a162
v_add_f32 v235,v238,v233
M v[100:103],a[200:203],a[152:155],v[100:103]
v_sub_f32 v238,v238,v233
v_add_f32 v233,v66,v162
M v[104:107],a[200:203],a[148:151],v[104:107]
ds_read_b128 v[220:223],v248 offset:36352
v_sub_f32 v162,v66,v162
M v[104:107],a[208:211],a[136:139],v[104:107]
s_waitcnt lgkmcnt(2)
ds_read_b128 v[224:227],v249 offset:36352
v_add_f32 v66,v235,v233
M v[104:107],a[120:123],a[108:111],v[104:107]
s_waitcnt lgkmcnt(2)
buffer_store_dwordx4 a[60:63],v253,s[24:27],s34 offen offset:512 nt
M v[108:111],a[120:123],a[112:115],v[108:111]
v_fmac_f32 v235,4.0,v233
v_fma_f32 v233,2.0,v162,v238
M v[108:111],a[208:211],a[108:111],v[108:111]
v_fma_f32 v162,s40,v162,v238
v_accvgpr_read_b32 v238,a67
M v[108:111],a[200:203],a[136:139],v[108:111]
v_accvgpr_read_b32 v237,a163
v_add_f32 v236,v238,v237
M v[112:115],a[200:203],a[108:111],v[112:115]
s_add_u32 s47,s76,49152
ds_read_b128 a[160:163],v249 offset:36864
v_sub_f32 v238,v238,v237
M v[112:115],a[208:211],a[112:115],v[112:115]
s_waitcnt lgkmcnt(2)
ds_read_b128 a[220:223],v248 offset:36864
v_add_f32 v237,v67,v163
M v[112:115],a[120:123],v[220:223],v[112:115]
s_waitcnt lgkmcnt(2)
v_sub_f32 v163,v67,v163
v_add_f32 v67,v236,v237
M v[116:119],a[120:123],v[224:227],v[116:119]
v_fmac_f32 v236,4.0,v237
v_fma_f32 v237,2.0,v163,v238
M v[116:119],a[208:211],v[220:223],v[116:119]
v_fma_f32 v163,s40,v163,v238
v_cvt_pk_bf16_f32 v233,v233,v237
M v[116:119],a[200:203],a[112:115],v[116:119]
v_cvt_pk_bf16_f32 v235,v235,v236
M v[120:123],a[200:203],v[220:223],v[120:123]
buffer_load_dwordx4 v[228:231],v250,s[20:23],s47 offen offset:0 sc1
M v[120:123],a[208:211],v[224:227],v[120:123]
s_waitcnt lgkmcnt(1)
ds_write2st64_b64 v254,v[232:233],v[234:235] offset0:34 offset1:38
M v[120:123],a[120:123],a[160:163],v[120:123]
s_waitcnt lgkmcnt(1)
buffer_load_dwordx4 a[252:255],v250,s[20:23],s47 offen offset:1024 sc1
M v[124:127],a[120:123],a[220:223],v[124:127]
v_accvgpr_read_b32 v238,a68
v_accvgpr_read_b32 v232,a164
M v[124:127],a[208:211],a[160:163],v[124:127]
v_add_f32 v234,v238,v232
v_sub_f32 v238,v238,v232
M v[124:127],a[200:203],v[224:227],v[124:127]
s_waitcnt vmcnt(28)
s_add_u32 s34,s33,6291456
v_add_f32 v232,v68,v164
v_sub_f32 v164,v68,v164
M v[128:131],a[96:99],a[140:143],v[128:131]
s_waitcnt vmcnt(27)
buffer_load_dwordx4 a[192:195],v250,s[20:23],s47 offen offset:2048 sc1
M v[128:131],a[244:247],a[152:155],v[128:131]
s_waitcnt vmcnt(27)
v_add_f32 v68,v234,v232
v_fmac_f32 v234,4.0,v232
M v[128:131],a[132:135],a[148:151],v[128:131]
v_fma_f32 v232,2.0,v164,v238
v_fma_f32 v164,s40,v164,v238
M v[132:135],a[132:135],a[136:139],v[132:135]
v_accvgpr_read_b32 v238,a69
v_accvgpr_read_b32 v237,a165
M v[132:135],a[244:247],a[148:151],v[132:135]
v_add_f32 v236,v238,v237
v_sub_f32 v238,v238,v237
M v[132:135],a[96:99],a[152:155],v[132:135]
buffer_store_dwordx4 v[0:3],v253,s[24:27],s34 offen offset:0 nt
M v[136:139],a[96:99],a[148:151],v[136:139]
v_add_f32 v237,v69,v165
v_sub_f32 v165,v69,v165
M v[136:139],a[244:247],a[136:139],v[136:139]
v_add_f32 v69,v236,v237
v_fmac_f32 v236,4.0,v237
M v[136:139],a[132:135],a[108:111],v[136:139]
v_fma_f32 v237,2.0,v165,v238
v_fma_f32 v165,s40,v165,v238
M v[140:143],a[132:135],a[112:115],v[140:143]
v_cvt_pk_bf16_f32 v232,v232,v237
v_cvt_pk_bf16_f32 v234,v234,v236
M v[140:143],a[244:247],a[108:111],v[140:143]
v_accvgpr_read_b32 v238,a70
v_accvgpr_read_b32 v233,a166
M v[140:143],a[96:99],a[136:139],v[140:143]
v_add_f32 v235,v238,v233
v_sub_f32 v238,v238,v233
M v[144:147],a[96:99],a[108:111],v[144:147]
s_add_u32 s46,s77,46080
v_add_f32 v233,v70,v166
v_sub_f32 v166,v70,v166
M v[144:147],a[244:247],a[112:115],v[144:147]
v_add_f32 v70,v235,v233
v_fmac_f32 v235,4.0,v233
M v[144:147],a[132:135],v[220:223],v[144:147]
v_fma_f32 v233,2.0,v166,v238
v_fma_f32 v166,s40,v166,v238
M v[148:151],a[132:135],v[224:227],v[148:151]
v_accvgpr_read_b32 v238,a71
v_accvgpr_read_b32 v237,a167
M v[148:151],a[244:247],v[220:223],v[148:151]
ds_read_b128 a[120:123],v248 offset:52224
v_add_f32 v236,v238,v237
M v[148:151],a[96:99],a[112:115],v[148:151]
ds_read_b128 a[140:143],v249 offset:52224
v_sub_f32 v238,v238,v237
M v[152:155],a[96:99],v[220:223],v[152:155]
buffer_load_dwordx4 a[152:155],v250,s[20:23],s46 offen offset:0 sc1
M v[152:155],a[244:247],v[224:227],v[152:155]
ds_read_b128 a[148:151],v248 offset:52736
ds_read_b128 a[108:111],v249 offset:52736
M v[152:155],a[132:135],a[160:163],v[152:155]
buffer_load_dwordx4 a[136:139],v250,s[20:23],s46 offen offset:1024 sc1
M v[156:159],a[132:135],a[220:223],v[156:159]
s_add_u32 s34,s33,6684672
v_add_f32 v237,v71,v167
v_sub_f32 v167,v71,v167
M v[156:159],a[244:247],a[160:163],v[156:159]
v_add_f32 v71,v236,v237
v_fmac_f32 v236,4.0,v237
M v[156:159],a[96:99],v[224:227],v[156:159]
s_waitcnt vmcnt(29) lgkmcnt(3)
v_fma_f32 v237,2.0,v167,v238
v_fma_f32 v167,s40,v167,v238
M v[96:99],a[124:127],a[120:123],v[96:99]
s_waitcnt vmcnt(28) lgkmcnt(2)
buffer_load_dwordx4 a[164:167],v250,s[20:23],s46 offen offset:2048 sc1
M v[96:99],a[228:231],a[140:143],v[96:99]
s_waitcnt vmcnt(28) lgkmcnt(1)
ds_read_b128 a[112:115],v248 offset:53248
ds_read_b128 a[132:135],v249 offset:53248
M v[96:99],a[196:199],a[148:151],v[96:99]
s_waitcnt lgkmcnt(2)
v_cvt_pk_bf16_f32 v233,v233,v237
v_cvt_pk_bf16_f32 v235,v235,v236
M v[100:103],a[196:199],a[108:111],v[100:103]
ds_write2st64_b64 v254,v[232:233],v[234:235] offset0:42 offset1:46
M v[100:103],a[228:231],a[148:151],v[100:103]
v_accvgpr_read_b32 v238,a72
v_accvgpr_read_b32 v232,a168
M v[100:103],a[124:127],a[140:143],v[100:103]
buffer_store_dwordx4 v[8:11],v253,s[24:27],s34 offen offset:0 nt
M v[104:107],a[124:127],a[148:151],v[104:107]
ds_read_b128 a[160:163],v248 offset:53760
v_add_f32 v234,v238,v232
M v[104:107],a[228:231],a[108:111],v[104:107]
s_waitcnt lgkmcnt(3)
ds_read_b128 a[96:99],v249 offset:53760
v_sub_f32 v238,v238,v232
M v[104:107],a[196:199],a[112:115],v[104:107]
s_waitcnt lgkmcnt(3)
v_add_f32 v232,v72,v168
v_sub_f32 v168,v72,v168
M v[108:111],a[196:199],a[132:135],v[108:111]
v_add_f32 v72,v234,v232
v_fmac_f32 v234,4.0,v232
M v[108:111],a[228:231],a[112:115],v[108:111]
v_fma_f32 v232,2.0,v168,v238
v_fma_f32 v168,s40,v168,v238
M v[108:111],a[124:127],a[108:111],v[108:111]
v_accvgpr_read_b32 v238,a73
v_accvgpr_read_b32 v237,a169
M v[112:115],a[124:127],a[112:115],v[112:115]
s_add_u32 s47,s77,49152
ds_read_b128 a[232:235],v249 offset:54272
v_add_f32 v236,v238,v237
M v[112:115],a[228:231],a[132:135],v[112:115]
s_waitcnt lgkmcnt(2)
ds_read_b128 a[248:251],v248 offset:54272
v_sub_f32 v238,v238,v237
M v[112:115],a[196:199],a[160:163],v[112:115]
s_waitcnt lgkmcnt(2)
v_add_f32 v237,v73,v169
v_sub_f32 v169,v73,v169
M v[116:119],a[196:199],a[96:99],v[116:119]
v_add_f32 v73,v236,v237
v_fmac_f32 v236,4.0,v237
M v[116:119],a[228:231],a[160:163],v[116:119]
v_fma_f32 v237,2.0,v169,v238
v_fma_f32 v169,s40,v169,v238
M v[116:119],a[124:127],a[132:135],v[116:119]
v_cvt_pk_bf16_f32 v232,v232,v237
v_cvt_pk_bf16_f32 v234,v234,v236
M v[120:123],a[124:127],a[160:163],v[120:123]
buffer_load_dwordx4 a[212:215],v250,s[20:23],s47 offen offset:0 sc1
M v[120:123],a[228:231],a[96:99],v[120:123]
s_waitcnt lgkmcnt(1)
s_add_u32 s34,s33,7077888
v_accvgpr_read_b32 v238,a74
v_accvgpr_read_b32 v233,a170
M v[120:123],a[196:199],a[232:235],v[120:123]
s_waitcnt lgkmcnt(0)
buffer_load_dwordx4 a[208:211],v250,s[20:23],s47 offen offset:1024 sc1
M v[124:127],a[196:199],a[248:251],v[124:127]
v_add_f32 v235,v238,v233
v_sub_f32 v238,v238,v233
M v[124:127],a[228:231],a[232:235],v[124:127]
v_add_f32 v233,v74,v170
v_sub_f32 v170,v74,v170
M v[124:127],a[124:127],a[96:99],v[124:127]
s_waitcnt vmcnt(30)
v_add_f32 v74,v235,v233
v_fmac_f32 v235,4.0,v233
M v[128:131],a[100:103],a[120:123],v[128:131]
s_waitcnt vmcnt(29)
buffer_load_dwordx4 a[200:203],v250,s[20:23],s47 offen offset:2048 sc1
M v[128:131],a[236:239],a[140:143],v[128:131]
s_waitcnt vmcnt(29)
v_fma_f32 v233,2.0,v170,v238
v_fma_f32 v170,s40,v170,v238
M v[128:131],a[240:243],a[148:151],v[128:131]
v_accvgpr_read_b32 v238,a75
v_accvgpr_read_b32 v237,a171
M v[132:135],a[240:243],a[108:111],v[132:135]
v_add_f32 v236,v238,v237
v_sub_f32 v238,v238,v237
M v[132:135],a[236:239],a[148:151],v[132:135]
v_add_f32 v237,v75,v171
v_sub_f32 v171,v75,v171
M v[132:135],a[100:103],a[140:143],v[132:135]
buffer_store_dwordx4 v[16:19],v253,s[24:27],s34 offen offset:0 nt
M v[136:139],a[100:103],a[148:151],v[136:139]
v_add_f32 v75,v236,v237
v_fmac_f32 v236,4.0,v237
M v[136:139],a[236:239],a[108:111],v[136:139]
v_fma_f32 v237,2.0,v171,v238
v_fma_f32 v171,s40,v171,v238
M v[136:139],a[240:243],a[112:115],v[136:139]
v_cvt_pk_bf16_f32 v233,v233,v237
v_cvt_pk_bf16_f32 v235,v235,v236
M v[140:143],a[240:243],a[132:135],v[140:143]
ds_write2st64_b64 v254,v[232:233],v[234:235] offset0:51 offset1:55
M v[140:143],a[236:239],a[112:115],v[140:143]
v_accvgpr_read_b32 v238,a76
v_accvgpr_read_b32 v232,a172
M v[140:143],a[100:103],a[108:111],v[140:143]
v_add_f32 v234,v238,v232
v_sub_f32 v238,v238,v232
M v[144:147],a[100:103],a[112:115],v[144:147]
s_add_u32 s47,s72,3072
v_add_f32 v232,v76,v172
v_sub_f32 v172,v76,v172
M v[144:147],a[236:239],a[132:135],v[144:147]
v_add_u32 v248,0x11000,v248
v_add_u32 v249,0x11000,v249
M v[144:147],a[240:243],a[160:163],v[144:147]
v_add_f32 v76,v234,v232
v_fmac_f32 v234,4.0,v232
M v[148:151],a[240:243],a[96:99],v[148:151]
v_fma_f32 v232,2.0,v172,v238
v_fma_f32 v172,s40,v172,v238
M v[148:151],a[236:239],a[160:163],v[148:151]
ds_read_b128 a[124:127],v248 offset:0
v_accvgpr_read_b32 v238,a77
M v[148:151],a[100:103],a[132:135],v[148:151]
s_add_u32 s34,s33,7471104
buffer_store_dwordx4 v[24:27],v253,s[24:27],s34 offen offset:0 nt
M v[152:155],a[100:103],a[160:163],v[152:155]
buffer_load_dwordx4 a[168:171],v250,s[20:23],s47 offen offset:0 sc1
M v[152:155],a[236:239],a[96:99],v[152:155]
ds_read_b128 a[120:123],v249 offset:0
ds_read_b128 a[140:143],v248 offset:512
M v[152:155],a[240:243],a[232:235],v[152:155]
ds_read_b128 a[108:111],v249 offset:512
v_accvgpr_read_b32 v237,a173
M v[156:159],a[240:243],a[248:251],v[156:159]
v_add_f32 v236,v238,v237
v_sub_f32 v238,v238,v237
M v[156:159],a[236:239],a[232:235],v[156:159]
buffer_load_dwordx4 a[148:151],v250,s[20:23],s47 offen offset:1024 sc1
M v[156:159],a[100:103],a[96:99],v[156:159]
s_waitcnt vmcnt(32) lgkmcnt(3)
v_add_f32 v237,v77,v173
v_sub_f32 v173,v77,v173
M v[96:99],a[144:147],a[124:127],v[96:99]
s_waitcnt vmcnt(31) lgkmcnt(2)
ds_read_b128 a[132:135],v248 offset:1024
v_add_f32 v77,v236,v237
M v[96:99],a[104:107],a[120:123],v[96:99]
s_waitcnt vmcnt(30) lgkmcnt(2)
ds_read_b128 a[160:163],v249 offset:1024
v_fmac_f32 v236,4.0,v237
M v[96:99],a[156:159],a[140:143],v[96:99]
s_waitcnt lgkmcnt(2)
buffer_load_dwordx4 a[112:115],v250,s[20:23],s47 offen offset:2048 sc1
M v[100:103],a[156:159],a[108:111],v[100:103]
v_fma_f32 v237,2.0,v173,v238
v_fma_f32 v173,s40,v173,v238
M v[100:103],a[104:107],a[140:143],v[100:103]
v_cvt_pk_bf16_f32 v232,v232,v237
v_cvt_pk_bf16_f32 v234,v234,v236
M v[100:103],a[144:147],a[120:123],v[100:103]
v_accvgpr_read_b32 v238,a78
v_accvgpr_read_b32 v233,a174
M v[104:107],a[144:147],a[140:143],v[104:107]
ds_read_b128 a[96:99],v248 offset:1536
v_add_f32 v235,v238,v233
M v[104:107],a[104:107],a[108:111],v[104:107]
s_waitcnt lgkmcnt(2)
ds_read_b128 a[100:103],v249 offset:1536
v_sub_f32 v238,v238,v233
M v[104:107],a[156:159],a[132:135],v[104:107]
s_waitcnt lgkmcnt(2)
v_add_f32 v233,v78,v174
v_sub_f32 v174,v78,v174
M v[108:111],a[156:159],a[160:163],v[108:111]
v_add_f32 v78,v235,v233
v_fmac_f32 v235,4.0,v233
M v[108:111],a[104:107],a[132:135],v[108:111]
v_fma_f32 v233,2.0,v174,v238
v_fma_f32 v174,s40,v174,v238
M v[108:111],a[144:147],a[108:111],v[108:111]
v_accvgpr_read_b32 v238,a79
v_accvgpr_read_b32 v237,a175
M v[112:115],a[144:147],a[132:135],v[112:115]
s_add_u32 s48,s72,6144
ds_read_b128 a[172:175],v249 offset:2048
v_add_f32 v236,v238,v237
M v[112:115],a[104:107],a[160:163],v[112:115]
s_waitcnt lgkmcnt(2)
ds_read_b128 v[220:223],v248 offset:2048
v_sub_f32 v238,v238,v237
M v[112:115],a[156:159],a[96:99],v[112:115]
s_waitcnt lgkmcnt(2)
v_add_f32 v237,v79,v175
v_sub_f32 v175,v79,v175
M v[116:119],a[156:159],a[100:103],v[116:119]
v_add_f32 v79,v236,v237
v_fmac_f32 v236,4.0,v237
M v[116:119],a[104:107],a[96:99],v[116:119]
v_fma_f32 v237,2.0,v175,v238
v_fma_f32 v175,s40,v175,v238
M v[116:119],a[144:147],a[160:163],v[116:119]
v_cvt_pk_bf16_f32 v233,v233,v237
v_cvt_pk_bf16_f32 v235,v235,v236
M v[120:123],a[144:147],a[96:99],v[120:123]
buffer_load_dwordx4 a[220:223],v250,s[20:23],s48 offen offset:0 sc1
M v[120:123],a[104:107],a[100:103],v[120:123]
s_waitcnt lgkmcnt(1)
ds_write2st64_b64 v254,v[232:233],v[234:235] offset0:59 offset1:63
M v[120:123],a[156:159],a[172:175],v[120:123]
s_waitcnt lgkmcnt(1)
buffer_load_dwordx4 a[244:247],v250,s[20:23],s48 offen offset:1024 sc1
M v[124:127],a[156:159],v[220:223],v[124:127]
v_accvgpr_read_b32 v238,a80
v_accvgpr_read_b32 v232,a176
M v[124:127],a[104:107],a[172:175],v[124:127]
v_add_f32 v234,v238,v232
v_sub_f32 v238,v238,v232
M v[124:127],a[144:147],a[100:103],v[124:127]
s_waitcnt vmcnt(25)
v_add_f32 v232,v80,v176
v_sub_f32 v176,v80,v176
M v[128:131],v[216:219],a[124:127],v[128:131]
s_waitcnt vmcnt(24)
buffer_load_dwordx4 v[224:227],v250,s[20:23],s48 offen offset:2048 sc1
M v[128:131],a[204:207],a[120:123],v[128:131]
s_waitcnt vmcnt(24)
v_add_f32 v80,v234,v232
v_fmac_f32 v234,4.0,v232
M v[128:131],a[224:227],a[140:143],v[128:131]
v_fma_f32 v232,2.0,v176,v238
v_fma_f32 v176,s40,v176,v238
M v[132:135],a[224:227],a[108:111],v[132:135]
v_accvgpr_read_b32 v238,a81
v_accvgpr_read_b32 v237,a177
M v[132:135],a[204:207],a[140:143],v[132:135]
v_add_f32 v236,v238,v237
v_sub_f32 v238,v238,v237
M v[132:135],v[216:219],a[120:123],v[132:135]
v_add_f32 v237,v81,v177
v_sub_f32 v177,v81,v177
M v[136:139],v[216:219],a[140:143],v[136:139]
v_add_f32 v81,v236,v237
v_fmac_f32 v236,4.0,v237
M v[136:139],a[204:207],a[108:111],v[136:139]
v_fma_f32 v237,2.0,v177,v238
v_fma_f32 v177,s40,v177,v238
M v[136:139],a[224:227],a[132:135],v[136:139]
v_cvt_pk_bf16_f32 v232,v232,v237
v_cvt_pk_bf16_f32 v234,v234,v236
M v[140:143],a[224:227],a[160:163],v[140:143]
v_accvgpr_read_b32 v238,a82
v_accvgpr_read_b32 v233,a178
M v[140:143],a[204:207],a[132:135],v[140:143]
v_add_f32 v235,v238,v233
v_sub_f32 v238,v238,v233
M v[140:143],v[216:219],a[108:111],v[140:143]
v_add_f32 v233,v82,v178
v_sub_f32 v178,v82,v178
M v[144:147],v[216:219],a[132:135],v[144:147]
s_add_u32 s47,s73,3072
v_add_f32 v82,v235,v233
v_fmac_f32 v235,4.0,v233
M v[144:147],a[204:207],a[160:163],v[144:147]
v_fma_f32 v233,2.0,v178,v238
v_fma_f32 v178,s40,v178,v238
M v[144:147],a[224:227],a[96:99],v[144:147]
v_accvgpr_read_b32 v238,a83
v_accvgpr_read_b32 v237,a179
M v[148:151],a[224:227],a[100:103],v[148:151]
v_add_f32 v236,v238,v237
v_sub_f32 v238,v238,v237
M v[148:151],a[204:207],a[96:99],v[148:151]
ds_read_b128 a[156:159],v248 offset:17408
v_add_f32 v237,v83,v179
M v[148:151],v[216:219],a[160:163],v[148:151]
ds_read_b128 a[104:107],v249 offset:17408
v_sub_f32 v179,v83,v179
M v[152:155],v[216:219],a[96:99],v[152:155]
buffer_load_dwordx4 a[144:147],v250,s[20:23],s47 offen offset:0 sc1
M v[152:155],a[204:207],a[100:103],v[152:155]
ds_read_b128 a[124:127],v248 offset:17920
ds_read_b128 a[140:143],v249 offset:17920
M v[152:155],a[224:227],a[172:175],v[152:155]
buffer_load_dwordx4 a[120:123],v250,s[20:23],s47 offen offset:1024 sc1
M v[156:159],a[224:227],v[220:223],v[156:159]
v_add_f32 v83,v236,v237
v_fmac_f32 v236,4.0,v237
M v[156:159],a[204:207],a[172:175],v[156:159]
v_fma_f32 v237,2.0,v179,v238
v_fma_f32 v179,s40,v179,v238
M v[156:159],v[216:219],a[100:103],v[156:159]
s_waitcnt vmcnt(24) lgkmcnt(3)
v_cvt_pk_bf16_f32 v233,v233,v237
v_cvt_pk_bf16_f32 v235,v235,v236
M v[96:99],a[116:119],a[156:159],v[96:99]
s_waitcnt vmcnt(23) lgkmcnt(2)
buffer_load_dwordx4 a[108:111],v250,s[20:23],s47 offen offset:2048 sc1
M v[96:99],a[128:131],a[104:107],v[96:99]
s_waitcnt vmcnt(23) lgkmcnt(1)
ds_read_b128 a[132:135],v248 offset:18432
ds_read_b128 a[176:179],v249 offset:18432
M v[96:99],a[216:219],a[124:127],v[96:99]
s_waitcnt lgkmcnt(2)
ds_write2st64_b64 v254,v[232:233],v[234:235] offset0:0 offset1:4
M v[100:103],a[216:219],a[140:143],v[100:103]
v_accvgpr_read_b32 v238,a84
v_accvgpr_read_b32 v232,a180
M v[100:103],a[128:131],a[124:127],v[100:103]
v_add_f32 v234,v238,v232
v_sub_f32 v238,v238,v232
M v[100:103],a[116:119],a[104:107],v[100:103]
v_add_f32 v232,v84,v180
v_sub_f32 v180,v84,v180
M v[104:107],a[116:119],a[124:127],v[104:107]
ds_read_b128 a[160:163],v248 offset:18944
v_add_f32 v84,v234,v232
M v[104:107],a[128:131],a[140:143],v[104:107]
s_waitcnt lgkmcnt(3)
ds_read_b128 a[96:99],v249 offset:18944
v_fmac_f32 v234,4.0,v232
M v[104:107],a[216:219],a[132:135],v[104:107]
s_waitcnt lgkmcnt(3)
v_fma_f32 v232,2.0,v180,v238
v_fma_f32 v180,s40,v180,v238
M v[108:111],a[216:219],a[176:179],v[108:111]
v_accvgpr_read_b32 v238,a85
v_accvgpr_read_b32 v237,a181
M v[108:111],a[128:131],a[132:135],v[108:111]
v_add_f32 v236,v238,v237
v_sub_f32 v238,v238,v237
M v[108:111],a[116:119],a[140:143],v[108:111]
v_add_f32 v237,v85,v181
v_sub_f32 v181,v85,v181
M v[112:115],a[116:119],a[132:135],v[112:115]
s_add_u32 s48,s73,6144
ds_read_b128 a[172:175],v249 offset:19456
v_add_f32 v85,v236,v237
M v[112:115],a[128:131],a[176:179],v[112:115]
s_waitcnt lgkmcnt(2)
ds_read_b128 a[100:103],v248 offset:19456
v_fmac_f32 v236,4.0,v237
M v[112:115],a[216:219],a[160:163],v[112:115]
s_waitcnt lgkmcnt(2)
v_fma_f32 v237,2.0,v181,v238
v_fma_f32 v181,s40,v181,v238
M v[116:119],a[216:219],a[96:99],v[116:119]
v_cvt_pk_bf16_f32 v232,v232,v237
v_cvt_pk_bf16_f32 v234,v234,v236
M v[116:119],a[128:131],a[160:163],v[116:119]
v_accvgpr_read_b32 v238,a86
v_accvgpr_read_b32 v233,a182
M v[116:119],a[116:119],a[176:179],v[116:119]
v_add_f32 v235,v238,v233
v_sub_f32 v238,v238,v233
M v[120:123],a[116:119],a[160:163],v[120:123]
buffer_load_dwordx4 a[196:199],v250,s[20:23],s48 offen offset:0 sc1
M v[120:123],a[128:131],a[96:99],v[120:123]
s_waitcnt lgkmcnt(1)
v_add_f32 v233,v86,v182
v_sub_f32 v182,v86,v182
M v[120:123],a[216:219],a[172:175],v[120:123]
s_waitcnt lgkmcnt(0)
buffer_load_dwordx4 a[228:231],v250,s[20:23],s48 offen offset:1024 sc1
M v[124:127],a[216:219],a[100:103],v[124:127]
v_add_f32 v86,v235,v233
v_fmac_f32 v235,4.0,v233
M v[124:127],a[128:131],a[172:175],v[124:127]
v_fma_f32 v233,2.0,v182,v238
v_fma_f32 v182,s40,v182,v238
M v[124:127],a[116:119],a[96:99],v[124:127]
s_waitcnt vmcnt(23)
v_accvgpr_read_b32 v238,a87
v_accvgpr_read_b32 v237,a183
M v[128:131],v[228:231],a[156:159],v[128:131]
s_waitcnt vmcnt(22)
buffer_load_dwordx4 a[240:243],v250,s[20:23],s48 offen offset:2048 sc1
M v[128:131],a[252:255],a[104:107],v[128:131]
s_waitcnt vmcnt(22)
v_add_f32 v236,v238,v237
v_sub_f32 v238,v238,v237
M v[128:131],a[192:195],a[124:127],v[128:131]
v_add_f32 v237,v87,v183
v_sub_f32 v183,v87,v183
M v[132:135],a[192:195],a[140:143],v[132:135]
v_add_f32 v87,v236,v237
v_fmac_f32 v236,4.0,v237
M v[132:135],a[252:255],a[124:127],v[132:135]
v_fma_f32 v237,2.0,v183,v238
v_fma_f32 v183,s40,v183,v238
M v[132:135],v[228:231],a[104:107],v[132:135]
v_cvt_pk_bf16_f32 v233,v233,v237
v_cvt_pk_bf16_f32 v235,v235,v236
M v[136:139],v[228:231],a[124:127],v[136:139]
ds_write2st64_b64 v254,v[232:233],v[234:235] offset0:8 offset1:12
M v[136:139],a[252:255],a[140:143],v[136:139]
v_accvgpr_read_b32 v238,a88
v_accvgpr_read_b32 v232,a184
M v[136:139],a[192:195],a[132:135],v[136:139]
v_add_f32 v234,v238,v232
v_sub_f32 v238,v238,v232
M v[140:143],a[192:195],a[176:179],v[140:143]
v_add_f32 v232,v88,v184
v_sub_f32 v184,v88,v184
M v[140:143],a[252:255],a[132:135],v[140:143]
v_add_f32 v88,v234,v232
v_fmac_f32 v234,4.0,v232
M v[140:143],v[228:231],a[140:143],v[140:143]
v_fma_f32 v232,2.0,v184,v238
v_fma_f32 v184,s40,v184,v238
M v[144:147],v[228:231],a[132:135],v[144:147]
s_add_u32 s47,s74,3072
v_accvgpr_read_b32 v238,a89
v_accvgpr_read_b32 v237,a185
M v[144:147],a[252:255],a[176:179],v[144:147]
v_add_u32 v248,0xfffece00,v248
v_add_u32 v249,0xfffece00,v249
M v[144:147],a[192:195],a[160:163],v[144:147]
v_add_f32 v236,v238,v237
v_sub_f32 v238,v238,v237
M v[148:151],a[192:195],a[96:99],v[148:151]
v_add_f32 v237,v89,v185
v_sub_f32 v185,v89,v185
M v[148:151],a[252:255],a[160:163],v[148:151]
ds_read_b128 a[128:131],v248 offset:26112
v_add_f32 v89,v236,v237
M v[148:151],v[228:231],a[176:179],v[148:151]
ds_read_b128 a[116:119],v249 offset:26112
v_fmac_f32 v236,4.0,v237
M v[152:155],v[228:231],a[160:163],v[152:155]
buffer_load_dwordx4 a[156:159],v250,s[20:23],s47 offen offset:0 sc1
M v[152:155],a[252:255],a[96:99],v[152:155]
ds_read_b128 a[180:183],v248 offset:26624
ds_read_b128 a[124:127],v249 offset:26624
M v[152:155],a[192:195],a[172:175],v[152:155]
buffer_load_dwordx4 a[104:107],v250,s[20:23],s47 offen offset:1024 sc1
M v[156:159],a[192:195],a[100:103],v[156:159]
v_fma_f32 v237,2.0,v185,v238
v_fma_f32 v185,s40,v185,v238
M v[156:159],a[252:255],a[172:175],v[156:159]
v_cvt_pk_bf16_f32 v232,v232,v237
v_cvt_pk_bf16_f32 v234,v234,v236
M v[156:159],v[228:231],a[96:99],v[156:159]
s_waitcnt vmcnt(22) lgkmcnt(3)
v_accvgpr_read_b32 v238,a90
v_accvgpr_read_b32 v233,a186
M v[96:99],a[152:155],a[128:131],v[96:99]
s_waitcnt vmcnt(21) lgkmcnt(2)
buffer_load_dwordx4 a[140:143],v250,s[20:23],s47 offen offset:2048 sc1
M v[96:99],a[136:139],a[116:119],v[96:99]
s_waitcnt vmcnt(21) lgkmcnt(1)
ds_read_b128 a[132:135],v248 offset:27136
ds_read_b128 a[176:179],v249 offset:27136
M v[96:99],a[164:167],a[180:183],v[96:99]
s_waitcnt lgkmcnt(2)
v_add_f32 v235,v238,v233
v_sub_f32 v238,v238,v233
M v[100:103],a[164:167],a[124:127],v[100:103]
v_add_f32 v233,v90,v186
v_sub_f32 v186,v90,v186
M v[100:103],a[136:139],a[180:183],v[100:103]
v_add_f32 v90,v235,v233
v_fmac_f32 v235,4.0,v233
M v[100:103],a[152:155],a[116:119],v[100:103]
v_fma_f32 v233,2.0,v186,v238
v_fma_f32 v186,s40,v186,v238
M v[104:107],a[152:155],a[180:183],v[104:107]
ds_read_b128 a[160:163],v248 offset:27648
v_accvgpr_read_b32 v238,a91
M v[104:107],a[136:139],a[124:127],v[104:107]
s_waitcnt lgkmcnt(2)
ds_read_b128 a[100:103],v249 offset:27648
v_accvgpr_read_b32 v237,a187
M v[104:107],a[164:167],a[132:135],v[104:107]
s_waitcnt lgkmcnt(2)
v_add_f32 v236,v238,v237
v_sub_f32 v238,v238,v237
M v[108:111],a[164:167],a[176:179],v[108:111]
v_add_f32 v237,v91,v187
v_sub_f32 v187,v91,v187
M v[108:111],a[136:139],a[132:135],v[108:111]
v_add_f32 v91,v236,v237
v_fmac_f32 v236,4.0,v237
M v[108:111],a[152:155],a[124:127],v[108:111]
v_fma_f32 v237,2.0,v187,v238
v_fma_f32 v187,s40,v187,v238
M v[112:115],a[152:155],a[132:135],v[112:115]
s_add_u32 s48,s74,6144
ds_read_b128 a[172:175],v249 offset:28160
v_cvt_pk_bf16_f32 v233,v233,v237
M v[112:115],a[136:139],a[176:179],v[112:115]
s_waitcnt lgkmcnt(2)
ds_read_b128 a[96:99],v248 offset:28160
v_cvt_pk_bf16_f32 v235,v235,v236
M v[112:115],a[164:167],a[160:163],v[112:115]
s_waitcnt lgkmcnt(2)
ds_write2st64_b64 v254,v[232:233],v[234:235] offset0:17 offset1:21
M v[116:119],a[164:167],a[100:103],v[116:119]
v_accvgpr_read_b32 v238,a92
v_accvgpr_read_b32 v232,a188
M v[116:119],a[136:139],a[160:163],v[116:119]
v_add_f32 v234,v238,v232
v_sub_f32 v238,v238,v232
M v[116:119],a[152:155],a[176:179],v[116:119]
v_add_f32 v232,v92,v188
v_sub_f32 v188,v92,v188
M v[120:123],a[152:155],a[160:163],v[120:123]
buffer_load_dwordx4 a[184:187],v250,s[20:23],s48 offen offset:0 sc1
M v[120:123],a[136:139],a[100:103],v[120:123]
s_waitcnt lgkmcnt(2)
v_add_f32 v92,v234,v232
v_fmac_f32 v234,4.0,v232
M v[120:123],a[164:167],a[172:175],v[120:123]
s_waitcnt lgkmcnt(1)
buffer_load_dwordx4 a[248:251],v250,s[20:23],s48 offen offset:1024 sc1
M v[124:127],a[164:167],a[96:99],v[124:127]
v_fma_f32 v232,2.0,v188,v238
v_fma_f32 v188,s40,v188,v238
M v[124:127],a[136:139],a[172:175],v[124:127]
v_accvgpr_read_b32 v238,a93
v_accvgpr_read_b32 v237,a189
M v[124:127],a[152:155],a[100:103],v[124:127]
s_waitcnt vmcnt(21)
v_add_f32 v236,v238,v237
v_sub_f32 v238,v238,v237
M v[128:131],a[212:215],a[128:131],v[128:131]
s_waitcnt vmcnt(20)
buffer_load_dwordx4 a[232:235],v250,s[20:23],s48 offen offset:2048 sc1
M v[128:131],a[208:211],a[116:119],v[128:131]
s_waitcnt vmcnt(20)
v_add_f32 v237,v93,v189
v_sub_f32 v189,v93,v189
M v[128:131],a[200:203],a[180:183],v[128:131]
v_add_f32 v93,v236,v237
v_fmac_f32 v236,4.0,v237
M v[132:135],a[200:203],a[124:127],v[132:135]
v_fma_f32 v237,2.0,v189,v238
v_fma_f32 v189,s40,v189,v238
M v[132:135],a[208:211],a[180:183],v[132:135]
v_cvt_pk_bf16_f32 v232,v232,v237
v_cvt_pk_bf16_f32 v234,v234,v236
M v[132:135],a[212:215],a[116:119],v[132:135]
v_accvgpr_read_b32 v238,a94
v_accvgpr_read_b32 v233,a190
M v[136:139],a[212:215],a[180:183],v[136:139]
v_add_f32 v235,v238,v233
v_sub_f32 v238,v238,v233
M v[136:139],a[208:211],a[124:127],v[136:139]
v_add_f32 v233,v94,v190
v_sub_f32 v190,v94,v190
M v[136:139],a[200:203],a[132:135],v[136:139]
v_add_f32 v94,v235,v233
v_fmac_f32 v235,4.0,v233
M v[140:143],a[200:203],a[176:179],v[140:143]
v_fma_f32 v233,2.0,v190,v238
v_fma_f32 v190,s40,v190,v238
M v[140:143],a[208:211],a[132:135],v[140:143]
v_accvgpr_read_b32 v238,a95
v_accvgpr_read_b32 v237,a191
M v[140:143],a[212:215],a[124:127],v[140:143]
v_add_f32 v236,v238,v237
v_sub_f32 v238,v238,v237
M v[144:147],a[212:215],a[132:135],v[144:147]
s_add_u32 s47,s75,3072
v_add_f32 v237,v95,v191
v_sub_f32 v191,v95,v191
M v[144:147],a[208:211],a[176:179],v[144:147]
v_add_f32 v95,v236,v237
v_fmac_f32 v236,4.0,v237
M v[144:147],a[200:203],a[160:163],v[144:147]
v_fma_f32 v237,2.0,v191,v238
v_fma_f32 v191,s40,v191,v238
M v[148:151],a[200:203],a[100:103],v[148:151]
v_cvt_pk_bf16_f32 v233,v233,v237
v_cvt_pk_bf16_f32 v235,v235,v236
M v[148:151],a[208:211],a[160:163],v[148:151]
ds_read_b128 a[164:167],v248 offset:0
ds_write2st64_b64 v254,v[232:233],v[234:235] offset0:25 offset1:29
M v[148:151],a[212:215],a[176:179],v[148:151]
ds_read_b128 a[136:139],v249 offset:0
v_cvt_pk_bf16_f32 v96,v96,v97
M v[152:155],a[212:215],a[160:163],v[152:155]
buffer_load_dwordx4 a[152:155],v250,s[20:23],s47 offen offset:0 sc1
M v[152:155],a[208:211],a[100:103],v[152:155]
ds_read_b128 a[128:131],v248 offset:512
ds_read_b128 a[180:183],v249 offset:512
M v[152:155],a[200:203],a[172:175],v[152:155]
buffer_load_dwordx4 a[116:119],v250,s[20:23],s47 offen offset:1024 sc1
M v[156:159],a[200:203],a[96:99],v[156:159]
v_cvt_pk_bf16_f32 v97,v98,v99
v_cvt_pk_bf16_f32 v100,v100,v101
M v[156:159],a[208:211],a[172:175],v[156:159]
v_cvt_pk_bf16_f32 v101,v102,v103
M v[156:159],a[212:215],a[100:103],v[156:159]
s_waitcnt vmcnt(19) lgkmcnt(3)
s_barrier
ds_read_b128 a[64:67],v250 offset:17408
M v[32:35],a[168:171],a[164:167],v[32:35]
s_waitcnt vmcnt(18) lgkmcnt(3)
ds_read_b128 a[68:71],v250 offset:21504
ds_read_b128 a[72:75],v250 offset:26112
M v[32:35],a[148:151],a[136:139],v[32:35]
s_waitcnt vmcnt(17) lgkmcnt(4)
ds_read_b128 a[76:79],v250 offset:30208
ds_read_b128 a[80:83],v250 offset:0
M v[32:35],a[112:115],a[128:131],v[32:35]
s_waitcnt lgkmcnt(5)
ds_read_b128 a[84:87],v250 offset:4096
ds_read_b128 a[88:91],v250 offset:8704
M v[36:39],a[112:115],a[180:183],v[36:39]
ds_read_b128 a[92:95],v250 offset:12800
ds_read_b128 a[188:191],v248 offset:1024
M v[36:39],a[148:151],a[128:131],v[36:39]
s_add_u32 s34,s32,6291456
buffer_load_dwordx4 a[124:127],v250,s[20:23],s47 offen offset:2048 sc1
ds_read_b128 a[132:135],v249 offset:1024
M v[36:39],a[168:171],a[136:139],v[36:39]
ds_write2st64_b64 v254,v[96:97],v[100:101] offset0:68 offset1:72
M v[40:43],a[168:171],a[128:131],v[40:43]
ds_read_b128 a[176:179],v248 offset:1536
v_cvt_pk_bf16_f32 v104,v104,v105
M v[40:43],a[148:151],a[180:183],v[40:43]
s_waitcnt lgkmcnt(3)
ds_read_b128 a[160:163],v249 offset:1536
v_cvt_pk_bf16_f32 v105,v106,v107
M v[40:43],a[112:115],a[188:191],v[40:43]
s_waitcnt lgkmcnt(3)
buffer_store_dwordx4 a[64:67],v253,s[24:27],s34 offen offset:640 nt
M v[44:47],a[112:115],a[132:135],v[44:47]
s_add_u32 s34,s32,6488064
v_cvt_pk_bf16_f32 v108,v108,v109
v_cvt_pk_bf16_f32 v109,v110,v111
M v[44:47],a[148:151],a[188:191],v[44:47]
ds_write2st64_b64 v254,v[104:105],v[108:109] offset0:76 offset1:80
M v[44:47],a[168:171],a[180:183],v[44:47]
buffer_store_dwordx4 a[68:71],v253,s[24:27],s34 offen offset:640 nt
M v[48:51],a[168:171],a[188:191],v[48:51]
s_add_u32 s34,s32,6684672
ds_read_b128 a[96:99],v249 offset:2048
s_add_u32 s48,s75,6144
M v[48:51],a[148:151],a[132:135],v[48:51]
s_waitcnt lgkmcnt(3)
ds_read_b128 a[172:175],v248 offset:2048
v_cvt_pk_bf16_f32 v112,v112,v113
M v[48:51],a[112:115],a[176:179],v[48:51]
s_waitcnt lgkmcnt(3)
buffer_store_dwordx4 a[72:75],v253,s[24:27],s34 offen offset:640 nt
M v[52:55],a[112:115],a[160:163],v[52:55]
s_add_u32 s34,s32,6881280
v_cvt_pk_bf16_f32 v113,v114,v115
v_cvt_pk_bf16_f32 v116,v116,v117
M v[52:55],a[148:151],a[176:179],v[52:55]
v_cvt_pk_bf16_f32 v117,v118,v119
M v[52:55],a[168:171],a[132:135],v[52:55]
buffer_store_dwordx4 a[76:79],v253,s[24:27],s34 offen offset:640 nt
M v[56:59],a[168:171],a[176:179],v[56:59]
s_add_u32 s34,s32,7077888
buffer_load_dwordx4 a[100:103],v250,s[20:23],s48 offen offset:0 sc1
M v[56:59],a[148:151],a[160:163],v[56:59]
s_waitcnt lgkmcnt(1)
ds_write2st64_b64 v254,v[112:113],v[116:117] offset0:85 offset1:89
M v[56:59],a[112:115],a[96:99],v[56:59]
s_waitcnt lgkmcnt(1)
v_cvt_pk_bf16_f32 v120,v120,v121
v_cvt_pk_bf16_f32 v121,v122,v123
M v[60:63],a[112:115],a[172:175],v[60:63]
v_cvt_pk_bf16_f32 v124,v124,v125
v_cvt_pk_bf16_f32 v125,v126,v127
M v[60:63],a[148:151],a[96:99],v[60:63]
buffer_load_dwordx4 a[236:239],v250,s[20:23],s48 offen offset:1024 sc1
M v[60:63],a[168:171],a[160:163],v[60:63]
s_waitcnt vmcnt(23)
ds_write2st64_b64 v254,v[120:121],v[124:125] offset0:93 offset1:97
M v[64:67],a[220:223],a[164:167],v[64:67]
s_waitcnt vmcnt(22)
v_cvt_pk_bf16_f32 v128,v128,v129
v_cvt_pk_bf16_f32 v129,v130,v131
M v[64:67],a[244:247],a[136:139],v[64:67]
s_waitcnt vmcnt(21)
buffer_load_dwordx4 a[224:227],v250,s[20:23],s48 offen offset:2048 sc1
M v[64:67],v[224:227],a[128:131],v[64:67]
v_cvt_pk_bf16_f32 v132,v132,v133
v_cvt_pk_bf16_f32 v133,v134,v135
M v[68:71],v[224:227],a[180:183],v[68:71]
s_waitcnt lgkmcnt(0)
s_barrier
ds_read_b128 v[96:99],v250 offset:34816
M v[68:71],a[244:247],a[128:131],v[68:71]
ds_read_b128 v[104:107],v250 offset:38912
ds_read_b128 v[112:115],v250 offset:43520
M v[68:71],a[220:223],a[136:139],v[68:71]
ds_read_b128 v[120:123],v250 offset:47616
buffer_store_dwordx4 a[80:83],v253,s[24:27],s34 offen offset:640 nt
M v[72:75],a[220:223],a[128:131],v[72:75]
s_add_u32 s34,s32,7274496
ds_write2st64_b64 v254,v[128:129],v[132:133] offset0:34 offset1:38
M v[72:75],a[244:247],a[180:183],v[72:75]
v_cvt_pk_bf16_f32 v136,v136,v137
v_cvt_pk_bf16_f32 v137,v138,v139
M v[72:75],v[224:227],a[188:191],v[72:75]
buffer_store_dwordx4 a[84:87],v253,s[24:27],s34 offen offset:640 nt
M v[76:79],v[224:227],a[132:135],v[76:79]
s_add_u32 s34,s32,7471104
v_cvt_pk_bf16_f32 v140,v140,v141
v_cvt_pk_bf16_f32 v141,v142,v143
M v[76:79],a[244:247],a[188:191],v[76:79]
ds_write2st64_b64 v254,v[136:137],v[140:141] offset0:42 offset1:46
M v[76:79],a[220:223],a[180:183],v[76:79]
buffer_store_dwordx4 a[88:91],v253,s[24:27],s34 offen offset:640 nt
M v[80:83],a[220:223],a[188:191],v[80:83]
s_add_u32 s34,s32,7667712
s_add_u32 s47,s76,3072
v_cvt_pk_bf16_f32 v144,v144,v145
M v[80:83],a[244:247],a[132:135],v[80:83]
v_cvt_pk_bf16_f32 v145,v146,v147
v_cvt_pk_bf16_f32 v148,v148,v149
M v[80:83],v[224:227],a[176:179],v[80:83]
buffer_store_dwordx4 a[92:95],v253,s[24:27],s34 offen offset:640 nt
M v[84:87],v[224:227],a[160:163],v[84:87]
v_cvt_pk_bf16_f32 v149,v150,v151
M v[84:87],a[244:247],a[176:179],v[84:87]
ds_read_b128 a[112:115],v248 offset:34816
ds_write2st64_b64 v254,v[144:145],v[148:149] offset0:51 offset1:55
M v[84:87],a[220:223],a[132:135],v[84:87]
ds_read_b128 a[148:151],v249 offset:34816
v_cvt_pk_bf16_f32 v152,v152,v153
M v[88:91],a[220:223],a[176:179],v[88:91]
buffer_load_dwordx4 a[168:171],v250,s[20:23],s47 offen offset:0 sc1
M v[88:91],a[244:247],a[160:163],v[88:91]
ds_read_b128 a[164:167],v248 offset:35328
ds_read_b128 a[128:131],v249 offset:35328
M v[88:91],v[224:227],a[96:99],v[88:91]
buffer_load_dwordx4 a[136:139],v250,s[20:23],s47 offen offset:1024 sc1
M v[92:95],v[224:227],a[172:175],v[92:95]
v_cvt_pk_bf16_f32 v153,v154,v155
v_cvt_pk_bf16_f32 v156,v156,v157
M v[92:95],a[244:247],a[96:99],v[92:95]
v_cvt_pk_bf16_f32 v157,v158,v159
M v[92:95],a[220:223],a[160:163],v[92:95]
s_waitcnt vmcnt(27) lgkmcnt(4)
ds_write2st64_b64 v254,v[152:153],v[156:157] offset0:59 offset1:63
M v[32:35],a[144:147],a[112:115],v[32:35]
s_waitcnt vmcnt(26) lgkmcnt(3)
s_add_u32 s34,s33,6291456
buffer_load_dwordx4 a[180:183],v250,s[20:23],s47 offen offset:2048 sc1
M v[32:35],a[120:123],a[148:151],v[32:35]
s_waitcnt vmcnt(26) lgkmcnt(2)
ds_read_b128 a[188:191],v248 offset:35840
ds_read_b128 a[132:135],v249 offset:35840
M v[32:35],a[108:111],a[164:167],v[32:35]
s_waitcnt lgkmcnt(2)
s_barrier
ds_read_b128 v[128:131],v250 offset:17408
M v[36:39],a[108:111],a[128:131],v[36:39]
ds_read_b128 v[136:139],v250 offset:21504
ds_read_b128 v[144:147],v250 offset:26112
M v[36:39],a[120:123],a[164:167],v[36:39]
ds_read_b128 v[152:155],v250 offset:30208
M v[36:39],a[144:147],a[148:151],v[36:39]
buffer_store_dwordx4 v[96:99],v253,s[24:27],s34 offen offset:1152 nt
M v[40:43],a[144:147],a[164:167],v[40:43]
ds_read_b128 a[176:179],v248 offset:36352
M v[40:43],a[120:123],a[128:131],v[40:43]
s_waitcnt lgkmcnt(6)
ds_read_b128 a[172:175],v249 offset:36352
M v[40:43],a[108:111],a[188:191],v[40:43]
s_waitcnt lgkmcnt(2)
s_barrier
M v[44:47],a[108:111],a[132:135],v[44:47]
M v[44:47],a[120:123],a[188:191],v[44:47]
M v[44:47],a[144:147],a[128:131],v[44:47]
M v[48:51],a[144:147],a[188:191],v[48:51]
s_add_u32 s48,s76,6144
ds_read_b128 a[96:99],v249 offset:36864
M v[48:51],a[120:123],a[132:135],v[48:51]
s_waitcnt lgkmcnt(2)
ds_read_b128 a[160:163],v248 offset:36864
M v[48:51],a[108:111],a[176:179],v[48:51]
s_waitcnt lgkmcnt(2)
M v[52:55],a[108:111],a[172:175],v[52:55]
M v[52:55],a[120:123],a[176:179],v[52:55]
M v[52:55],a[144:147],a[132:135],v[52:55]
M v[56:59],a[144:147],a[176:179],v[56:59]
buffer_load_dwordx4 v[220:223],v250,s[20:23],s48 offen offset:0 sc1
M v[56:59],a[120:123],a[172:175],v[56:59]
s_waitcnt lgkmcnt(1)
M v[56:59],a[108:111],a[96:99],v[56:59]
s_waitcnt lgkmcnt(0)
buffer_load_dwordx4 a[204:207],v250,s[20:23],s48 offen offset:1024 sc1
M v[60:63],a[108:111],a[160:163],v[60:63]
M v[60:63],a[120:123],a[96:99],v[60:63]
s_add_u32 s34,s33,6684672
M v[60:63],a[144:147],a[172:175],v[60:63]
s_waitcnt vmcnt(28)
M v[64:67],a[196:199],a[112:115],v[64:67]
s_waitcnt vmcnt(27)
buffer_load_dwordx4 v[216:219],v250,s[20:23],s48 offen offset:2048 sc1
M v[64:67],a[228:231],a[148:151],v[64:67]
s_waitcnt vmcnt(27)
M v[64:67],a[240:243],a[164:167],v[64:67]
M v[68:71],a[240:243],a[128:131],v[68:71]
M v[68:71],a[228:231],a[164:167],v[68:71]
M v[68:71],a[196:199],a[148:151],v[68:71]
buffer_store_dwordx4 v[104:107],v253,s[24:27],s34 offen offset:1152 nt
M v[72:75],a[196:199],a[164:167],v[72:75]
M v[72:75],a[228:231],a[128:131],v[72:75]
M v[72:75],a[240:243],a[188:191],v[72:75]
M v[76:79],a[240:243],a[132:135],v[76:79]
M v[76:79],a[228:231],a[188:191],v[76:79]
M v[76:79],a[196:199],a[128:131],v[76:79]
M v[80:83],a[196:199],a[188:191],v[80:83]
s_add_u32 s47,s77,3072
M v[80:83],a[228:231],a[132:135],v[80:83]
M v[80:83],a[240:243],a[176:179],v[80:83]
M v[84:87],a[240:243],a[172:175],v[84:87]
M v[84:87],a[228:231],a[176:179],v[84:87]
ds_read_b128 a[108:111],v248 offset:52224
M v[84:87],a[196:199],a[132:135],v[84:87]
ds_read_b128 a[120:123],v249 offset:52224
M v[88:91],a[196:199],a[176:179],v[88:91]
buffer_load_dwordx4 a[144:147],v250,s[20:23],s47 offen offset:0 sc1
M v[88:91],a[228:231],a[172:175],v[88:91]
ds_read_b128 a[112:115],v248 offset:52736
ds_read_b128 a[164:167],v249 offset:52736
M v[88:91],a[240:243],a[96:99],v[88:91]
s_add_u32 s34,s33,7077888
buffer_load_dwordx4 a[148:151],v250,s[20:23],s47 offen offset:1024 sc1
M v[92:95],a[240:243],a[160:163],v[92:95]
M v[92:95],a[228:231],a[96:99],v[92:95]
M v[92:95],a[196:199],a[172:175],v[92:95]
s_waitcnt vmcnt(29) lgkmcnt(3)
M v[32:35],a[156:159],a[108:111],v[32:35]
s_waitcnt vmcnt(28) lgkmcnt(2)
buffer_load_dwordx4 a[128:131],v250,s[20:23],s47 offen offset:2048 sc1
M v[32:35],a[104:107],a[120:123],v[32:35]
s_waitcnt vmcnt(28) lgkmcnt(1)
ds_read_b128 a[188:191],v248 offset:53248
ds_read_b128 a[132:135],v249 offset:53248
M v[32:35],a[140:143],a[112:115],v[32:35]
s_waitcnt lgkmcnt(2)
M v[36:39],a[140:143],a[164:167],v[36:39]
M v[36:39],a[104:107],a[112:115],v[36:39]
M v[36:39],a[156:159],a[120:123],v[36:39]
buffer_store_dwordx4 v[112:115],v253,s[24:27],s34 offen offset:1152 nt
M v[40:43],a[156:159],a[112:115],v[40:43]
ds_read_b128 a[176:179],v248 offset:53760
M v[40:43],a[104:107],a[164:167],v[40:43]
s_waitcnt lgkmcnt(2)
ds_read_b128 a[160:163],v249 offset:53760
M v[40:43],a[140:143],a[188:191],v[40:43]
s_waitcnt lgkmcnt(2)
M v[44:47],a[140:143],a[132:135],v[44:47]
M v[44:47],a[104:107],a[188:191],v[44:47]
M v[44:47],a[156:159],a[164:167],v[44:47]
M v[48:51],a[156:159],a[188:191],v[48:51]
s_add_u32 s48,s77,6144
ds_read_b128 a[96:99],v249 offset:54272
M v[48:51],a[104:107],a[132:135],v[48:51]
s_waitcnt lgkmcnt(2)
ds_read_b128 a[172:175],v248 offset:54272
M v[48:51],a[140:143],a[176:179],v[48:51]
s_waitcnt lgkmcnt(2)
M v[52:55],a[140:143],a[160:163],v[52:55]
M v[52:55],a[104:107],a[176:179],v[52:55]
M v[52:55],a[156:159],a[132:135],v[52:55]
M v[56:59],a[156:159],a[176:179],v[56:59]
s_add_u32 s34,s33,7471104
buffer_load_dwordx4 a[216:219],v250,s[20:23],s48 offen offset:0 sc1
M v[56:59],a[104:107],a[160:163],v[56:59]
s_waitcnt lgkmcnt(1)
M v[56:59],a[140:143],a[96:99],v[56:59]
s_waitcnt lgkmcnt(0)
buffer_store_dwordx4 v[120:123],v253,s[24:27],s34 offen offset:1152 nt
M v[60:63],a[140:143],a[172:175],v[60:63]
M v[60:63],a[104:107],a[96:99],v[60:63]
M v[60:63],a[156:159],a[160:163],v[60:63]
s_waitcnt vmcnt(30)
buffer_load_dwordx4 a[192:195],v250,s[20:23],s48 offen offset:1024 sc1
M v[64:67],a[184:187],a[108:111],v[64:67]
s_waitcnt vmcnt(30)
M v[64:67],a[248:251],a[120:123],v[64:67]
s_waitcnt vmcnt(29)
M v[64:67],a[232:235],a[112:115],v[64:67]
M v[68:71],a[232:235],a[164:167],v[68:71]
buffer_load_dwordx4 a[252:255],v250,s[20:23],s48 offen offset:2048 sc1
M v[68:71],a[248:251],a[112:115],v[68:71]
M v[68:71],a[184:187],a[120:123],v[68:71]
M v[72:75],a[184:187],a[112:115],v[72:75]
M v[72:75],a[248:251],a[164:167],v[72:75]
M v[72:75],a[232:235],a[188:191],v[72:75]
M v[76:79],a[232:235],a[132:135],v[76:79]
M v[76:79],a[248:251],a[188:191],v[76:79]
M v[76:79],a[184:187],a[164:167],v[76:79]
M v[80:83],a[184:187],a[188:191],v[80:83]
s_add_u32 s48,s72,52224
M v[80:83],a[248:251],a[132:135],v[80:83]
v_add_u32 v248,0x11000,v248
v_add_u32 v249,0x11000,v249
M v[80:83],a[232:235],a[176:179],v[80:83]
M v[84:87],a[232:235],a[160:163],v[84:87]
M v[84:87],a[248:251],a[176:179],v[84:87]
s_add_u32 s34,s33,6291456
ds_read_b128 a[140:143],v248 offset:0
M v[84:87],a[184:187],a[132:135],v[84:87]
buffer_store_dwordx4 v[128:131],v253,s[24:27],s34 offen offset:1280 nt
M v[88:91],a[184:187],a[176:179],v[88:91]
buffer_load_dwordx4 a[156:159],v250,s[20:23],s48 offen offset:0 sc1
M v[88:91],a[248:251],a[160:163],v[88:91]
ds_read_b128 a[104:107],v249 offset:0
ds_read_b128 a[108:111],v248 offset:512
M v[88:91],a[232:235],a[96:99],v[88:91]
ds_read_b128 a[112:115],v249 offset:512
M v[92:95],a[232:235],a[172:175],v[92:95]
M v[92:95],a[248:251],a[96:99],v[92:95]
buffer_load_dwordx4 a[120:123],v250,s[20:23],s48 offen offset:1024 sc1
M v[92:95],a[184:187],a[160:163],v[92:95]
s_waitcnt vmcnt(32) lgkmcnt(3)
M v[32:35],a[152:155],a[140:143],v[32:35]
s_waitcnt vmcnt(31) lgkmcnt(2)
ds_read_b128 a[188:191],v248 offset:1024
M v[32:35],a[116:119],a[104:107],v[32:35]
s_waitcnt vmcnt(30) lgkmcnt(2)
ds_read_b128 a[132:135],v249 offset:1024
M v[32:35],a[124:127],a[108:111],v[32:35]
s_waitcnt lgkmcnt(2)
buffer_load_dwordx4 a[164:167],v250,s[20:23],s48 offen offset:2048 sc1
M v[36:39],a[124:127],a[112:115],v[36:39]
M v[36:39],a[116:119],a[108:111],v[36:39]
M v[36:39],a[152:155],a[104:107],v[36:39]
M v[40:43],a[152:155],a[108:111],v[40:43]
ds_read_b128 a[176:179],v248 offset:1536
M v[40:43],a[116:119],a[112:115],v[40:43]
s_waitcnt lgkmcnt(2)
ds_read_b128 a[172:175],v249 offset:1536
M v[40:43],a[124:127],a[188:191],v[40:43]
s_waitcnt lgkmcnt(2)
M v[44:47],a[124:127],a[132:135],v[44:47]
M v[44:47],a[116:119],a[188:191],v[44:47]
M v[44:47],a[152:155],a[112:115],v[44:47]
M v[48:51],a[152:155],a[188:191],v[48:51]
s_add_u32 s48,s73,52224
ds_read_b128 a[96:99],v249 offset:2048
M v[48:51],a[116:119],a[132:135],v[48:51]
s_waitcnt lgkmcnt(2)
ds_read_b128 a[160:163],v248 offset:2048
M v[48:51],a[124:127],a[176:179],v[48:51]
s_waitcnt lgkmcnt(2)
M v[52:55],a[124:127],a[172:175],v[52:55]
s_add_u32 s34,s33,6684672
M v[52:55],a[116:119],a[176:179],v[52:55]
M v[52:55],a[152:155],a[132:135],v[52:55]
buffer_store_dwordx4 v[136:139],v253,s[24:27],s34 offen offset:1280 nt
M v[56:59],a[152:155],a[176:179],v[56:59]
buffer_load_dwordx4 a[184:187],v250,s[20:23],s48 offen offset:0 sc1
M v[56:59],a[116:119],a[172:175],v[56:59]
s_waitcnt lgkmcnt(1)
M v[56:59],a[124:127],a[96:99],v[56:59]
s_waitcnt lgkmcnt(0)
M v[60:63],a[124:127],a[160:163],v[60:63]
M v[60:63],a[116:119],a[96:99],v[60:63]
buffer_load_dwordx4 v[228:231],v250,s[20:23],s48 offen offset:1024 sc1
M v[60:63],a[152:155],a[172:175],v[60:63]
s_waitcnt vmcnt(29)
M v[64:67],a[100:103],a[140:143],v[64:67]
s_waitcnt vmcnt(28)
M v[64:67],a[236:239],a[104:107],v[64:67]
s_waitcnt vmcnt(27)
M v[64:67],a[224:227],a[108:111],v[64:67]
buffer_load_dwordx4 a[200:203],v250,s[20:23],s48 offen offset:2048 sc1
M v[68:71],a[224:227],a[112:115],v[68:71]
M v[68:71],a[236:239],a[108:111],v[68:71]
M v[68:71],a[100:103],a[104:107],v[68:71]
M v[72:75],a[100:103],a[108:111],v[72:75]
M v[72:75],a[236:239],a[112:115],v[72:75]
M v[72:75],a[224:227],a[188:191],v[72:75]
M v[76:79],a[224:227],a[132:135],v[76:79]
M v[76:79],a[236:239],a[188:191],v[76:79]
M v[76:79],a[100:103],a[112:115],v[76:79]
M v[80:83],a[100:103],a[188:191],v[80:83]
s_add_u32 s48,s74,52224
M v[80:83],a[236:239],a[132:135],v[80:83]
s_add_u32 s34,s33,7077888
M v[80:83],a[224:227],a[176:179],v[80:83]
buffer_store_dwordx4 v[144:147],v253,s[24:27],s34 offen offset:1280 nt
M v[84:87],a[224:227],a[172:175],v[84:87]
M v[84:87],a[236:239],a[176:179],v[84:87]
ds_read_b128 a[124:127],v248 offset:17408
M v[84:87],a[100:103],a[132:135],v[84:87]
ds_read_b128 a[116:119],v249 offset:17408
M v[88:91],a[100:103],a[176:179],v[88:91]
buffer_load_dwordx4 a[152:155],v250,s[20:23],s48 offen offset:0 sc1
M v[88:91],a[236:239],a[172:175],v[88:91]
ds_read_b128 a[140:143],v248 offset:17920
ds_read_b128 a[108:111],v249 offset:17920
M v[88:91],a[224:227],a[96:99],v[88:91]
buffer_load_dwordx4 a[104:107],v250,s[20:23],s48 offen offset:1024 sc1
M v[92:95],a[224:227],a[160:163],v[92:95]
M v[92:95],a[236:239],a[96:99],v[92:95]
M v[92:95],a[100:103],a[172:175],v[92:95]
s_waitcnt vmcnt(26) lgkmcnt(3)
M v[32:35],a[168:171],a[124:127],v[32:35]
s_waitcnt vmcnt(25) lgkmcnt(2)
buffer_load_dwordx4 a[112:115],v250,s[20:23],s48 offen offset:2048 sc1
M v[32:35],a[136:139],a[116:119],v[32:35]
s_waitcnt vmcnt(25) lgkmcnt(1)
ds_read_b128 a[188:191],v248 offset:18432
ds_read_b128 a[132:135],v249 offset:18432
M v[32:35],a[180:183],a[140:143],v[32:35]
s_waitcnt lgkmcnt(2)
M v[36:39],a[180:183],a[108:111],v[36:39]
M v[36:39],a[136:139],a[140:143],v[36:39]
M v[36:39],a[168:171],a[116:119],v[36:39]
M v[40:43],a[168:171],a[140:143],v[40:43]
ds_read_b128 a[176:179],v248 offset:18944
M v[40:43],a[136:139],a[108:111],v[40:43]
s_waitcnt lgkmcnt(2)
ds_read_b128 a[160:163],v249 offset:18944
M v[40:43],a[180:183],a[188:191],v[40:43]
s_waitcnt lgkmcnt(2)
M v[44:47],a[180:183],a[132:135],v[44:47]
M v[44:47],a[136:139],a[188:191],v[44:47]
M v[44:47],a[168:171],a[108:111],v[44:47]
s_add_u32 s34,s33,7471104
buffer_store_dwordx4 v[152:155],v253,s[24:27],s34 offen offset:1280 nt
M v[48:51],a[168:171],a[188:191],v[48:51]
s_add_u32 s48,s75,52224
ds_read_b128 a[96:99],v249 offset:19456
M v[48:51],a[136:139],a[132:135],v[48:51]
s_waitcnt lgkmcnt(2)
ds_read_b128 a[100:103],v248 offset:19456
M v[48:51],a[180:183],a[176:179],v[48:51]
s_waitcnt lgkmcnt(2)
M v[52:55],a[180:183],a[160:163],v[52:55]
M v[52:55],a[136:139],a[176:179],v[52:55]
M v[52:55],a[168:171],a[132:135],v[52:55]
M v[56:59],a[168:171],a[176:179],v[56:59]
buffer_load_dwordx4 a[172:175],v250,s[20:23],s48 offen offset:0 sc1
M v[56:59],a[136:139],a[160:163],v[56:59]
s_waitcnt lgkmcnt(1)
M v[56:59],a[180:183],a[96:99],v[56:59]
s_waitcnt lgkmcnt(0)
buffer_load_dwordx4 a[208:211],v250,s[20:23],s48 offen offset:1024 sc1
M v[60:63],a[180:183],a[100:103],v[60:63]
M v[60:63],a[136:139],a[96:99],v[60:63]
M v[60:63],a[168:171],a[160:163],v[60:63]
s_waitcnt vmcnt(26)
M v[64:67],v[220:223],a[124:127],v[64:67]
s_waitcnt vmcnt(25)
buffer_load_dwordx4 a[212:215],v250,s[20:23],s48 offen offset:2048 sc1
M v[64:67],a[204:207],a[116:119],v[64:67]
s_waitcnt vmcnt(25)
M v[64:67],v[216:219],a[140:143],v[64:67]
M v[68:71],v[216:219],a[108:111],v[68:71]
M v[68:71],a[204:207],a[140:143],v[68:71]
M v[68:71],v[220:223],a[116:119],v[68:71]
M v[72:75],v[220:223],a[140:143],v[72:75]
M v[72:75],a[204:207],a[108:111],v[72:75]
M v[72:75],v[216:219],a[188:191],v[72:75]
M v[76:79],v[216:219],a[132:135],v[76:79]
M v[76:79],a[204:207],a[188:191],v[76:79]
M v[76:79],v[220:223],a[108:111],v[76:79]
M v[80:83],v[220:223],a[188:191],v[80:83]
s_add_u32 s48,s76,52224
M v[80:83],a[204:207],a[132:135],v[80:83]
v_add_u32 v248,0xffff1200,v248
v_add_u32 v249,0xffff1200,v249
M v[80:83],v[216:219],a[176:179],v[80:83]
M v[84:87],v[216:219],a[160:163],v[84:87]
M v[84:87],a[204:207],a[176:179],v[84:87]
ds_read_b128 a[180:183],v248 offset:8704
M v[84:87],v[220:223],a[132:135],v[84:87]
ds_read_b128 a[136:139],v249 offset:8704
M v[88:91],v[220:223],a[176:179],v[88:91]
buffer_load_dwordx4 a[168:171],v250,s[20:23],s48 offen offset:0 sc1
M v[88:91],a[204:207],a[160:163],v[88:91]
ds_read_b128 a[124:127],v248 offset:9216
ds_read_b128 a[140:143],v249 offset:9216
M v[88:91],v[216:219],a[96:99],v[88:91]
buffer_load_dwordx4 a[116:119],v250,s[20:23],s48 offen offset:1024 sc1
M v[92:95],v[216:219],a[100:103],v[92:95]
M v[92:95],a[204:207],a[96:99],v[92:95]
M v[92:95],v[220:223],a[160:163],v[92:95]
s_waitcnt vmcnt(25) lgkmcnt(3)
M v[32:35],a[144:147],a[180:183],v[32:35]
s_waitcnt vmcnt(24) lgkmcnt(2)
buffer_load_dwordx4 a[108:111],v250,s[20:23],s48 offen offset:2048 sc1
M v[32:35],a[148:151],a[136:139],v[32:35]
s_waitcnt vmcnt(24) lgkmcnt(1)
s_add_u32 s48,s77,52224
ds_read_b128 a[100:103],v248 offset:9728
ds_read_b128 a[96:99],v249 offset:9728
M v[32:35],a[128:131],a[124:127],v[32:35]
s_waitcnt lgkmcnt(2)
M v[36:39],a[128:131],a[140:143],v[36:39]
M v[36:39],a[148:151],a[124:127],v[36:39]
buffer_load_dwordx4 a[188:191],v250,s[20:23],s48 offen offset:0 sc1
M v[36:39],a[144:147],a[136:139],v[36:39]
s_nop 2
v_cvt_pk_bf16_f32 v32,v32,v33
v_cvt_pk_bf16_f32 v33,v34,v35
M v[40:43],a[144:147],a[124:127],v[40:43]
ds_read_b128 a[160:163],v248 offset:10240
M v[40:43],a[148:151],a[140:143],v[40:43]
s_waitcnt lgkmcnt(2)
ds_read_b128 v[224:227],v249 offset:10240
M v[40:43],a[128:131],a[100:103],v[40:43]
s_waitcnt lgkmcnt(2)
buffer_load_dwordx4 a[132:135],v250,s[20:23],s48 offen offset:1024 sc1
M v[44:47],a[128:131],a[96:99],v[44:47]
v_cvt_pk_bf16_f32 v36,v36,v37
v_cvt_pk_bf16_f32 v37,v38,v39
M v[44:47],a[148:151],a[100:103],v[44:47]
ds_write2st64_b64 v254,v[32:33],v[36:37] offset0:34 offset1:38
M v[44:47],a[144:147],a[140:143],v[44:47]
v_cvt_pk_bf16_f32 v40,v40,v41
v_cvt_pk_bf16_f32 v41,v42,v43
M v[48:51],a[144:147],a[100:103],v[48:51]
buffer_load_dwordx4 a[176:179],v250,s[20:23],s48 offen offset:2048 sc1
M v[48:51],a[148:151],a[96:99],v[48:51]
s_waitcnt lgkmcnt(2)
ds_read_b128 a[244:247],v249 offset:10752
ds_read_b128 a[220:223],v248 offset:10752
M v[48:51],a[128:131],a[160:163],v[48:51]
s_waitcnt lgkmcnt(3)
v_cvt_pk_bf16_f32 v44,v44,v45
v_cvt_pk_bf16_f32 v45,v46,v47
M v[52:55],a[128:131],v[224:227],v[52:55]
ds_write2st64_b64 v254,v[40:41],v[44:45] offset0:42 offset1:46
M v[52:55],a[148:151],a[160:163],v[52:55]
M v[52:55],a[144:147],a[96:99],v[52:55]
s_nop 0
v_cvt_pk_bf16_f32 v48,v48,v49
v_cvt_pk_bf16_f32 v49,v50,v51
M v[56:59],a[144:147],a[160:163],v[56:59]
M v[56:59],a[148:151],v[224:227],v[56:59]
s_waitcnt lgkmcnt(2)
M v[56:59],a[128:131],a[244:247],v[56:59]
s_waitcnt lgkmcnt(1)
v_cvt_pk_bf16_f32 v52,v52,v53
v_cvt_pk_bf16_f32 v53,v54,v55
M v[60:63],a[128:131],a[220:223],v[60:63]
ds_write2st64_b64 v254,v[48:49],v[52:53] offset0:51 offset1:55
M v[60:63],a[148:151],a[244:247],v[60:63]
M v[60:63],a[144:147],v[224:227],v[60:63]
s_waitcnt vmcnt(25)
v_cvt_pk_bf16_f32 v56,v56,v57
v_cvt_pk_bf16_f32 v57,v58,v59
M v[64:67],a[216:219],a[180:183],v[64:67]
s_waitcnt vmcnt(23)
M v[64:67],a[192:195],a[136:139],v[64:67]
s_waitcnt vmcnt(22)
M v[64:67],a[252:255],a[124:127],v[64:67]
v_cvt_pk_bf16_f32 v60,v60,v61
v_cvt_pk_bf16_f32 v61,v62,v63
M v[68:71],a[252:255],a[140:143],v[68:71]
ds_write2st64_b64 v254,v[56:57],v[60:61] offset0:59 offset1:63
M v[68:71],a[192:195],a[124:127],v[68:71]
M v[68:71],a[216:219],a[136:139],v[68:71]
s_nop 1
v_cvt_pk_bf16_f32 v64,v64,v65
v_cvt_pk_bf16_f32 v65,v66,v67
M v[72:75],a[216:219],a[124:127],v[72:75]
M v[72:75],a[192:195],a[140:143],v[72:75]
M v[72:75],a[252:255],a[100:103],v[72:75]
s_nop 0
v_cvt_pk_bf16_f32 v68,v68,v69
v_cvt_pk_bf16_f32 v69,v70,v71
M v[76:79],a[252:255],a[96:99],v[76:79]
ds_write2st64_b64 v254,v[64:65],v[68:69] offset0:0 offset1:4
M v[76:79],a[192:195],a[100:103],v[76:79]
M v[76:79],a[216:219],a[140:143],v[76:79]
s_nop 0
v_cvt_pk_bf16_f32 v72,v72,v73
v_cvt_pk_bf16_f32 v73,v74,v75
M v[80:83],a[216:219],a[100:103],v[80:83]
M v[80:83],a[192:195],a[96:99],v[80:83]
M v[80:83],a[252:255],a[160:163],v[80:83]
s_nop 1
v_cvt_pk_bf16_f32 v76,v76,v77
v_cvt_pk_bf16_f32 v77,v78,v79
M v[84:87],a[252:255],v[224:227],v[84:87]
ds_write2st64_b64 v254,v[72:73],v[76:77] offset0:8 offset1:12
M v[84:87],a[192:195],a[160:163],v[84:87]
ds_read_b128 a[128:131],v248 offset:0
M v[84:87],a[216:219],a[96:99],v[84:87]
ds_read_b128 a[148:151],v249 offset:0
v_cvt_pk_bf16_f32 v80,v80,v81
M v[88:91],a[216:219],a[160:163],v[88:91]
ds_read_b128 a[144:147],v248 offset:512
v_cvt_pk_bf16_f32 v81,v82,v83
M v[88:91],a[192:195],v[224:227],v[88:91]
ds_read_b128 a[180:183],v249 offset:512
M v[88:91],a[252:255],a[244:247],v[88:91]
v_cvt_pk_bf16_f32 v84,v84,v85
v_cvt_pk_bf16_f32 v85,v86,v87
M v[92:95],a[252:255],a[220:223],v[92:95]
ds_write2st64_b64 v254,v[80:81],v[84:85] offset0:17 offset1:21
M v[92:95],a[192:195],a[244:247],v[92:95]
M v[92:95],a[216:219],v[224:227],v[92:95]
s_waitcnt vmcnt(20) lgkmcnt(4)
s_nop 0
v_cvt_pk_bf16_f32 v88,v88,v89
v_cvt_pk_bf16_f32 v89,v90,v91
M v[160:163],a[156:159],a[128:131],v[160:163]
s_waitcnt vmcnt(19) lgkmcnt(3)
ds_read_b128 a[136:139],v248 offset:1024
M v[160:163],a[120:123],a[148:151],v[160:163]
s_waitcnt vmcnt(18) lgkmcnt(3)
ds_read_b128 a[124:127],v249 offset:1024
M v[160:163],a[164:167],a[144:147],v[160:163]
s_waitcnt lgkmcnt(3)
v_cvt_pk_bf16_f32 v92,v92,v93
v_cvt_pk_bf16_f32 v93,v94,v95
M v[164:167],a[164:167],a[180:183],v[164:167]
ds_write2st64_b64 v254,v[88:89],v[92:93] offset0:25 offset1:29
M v[164:167],a[120:123],a[144:147],v[164:167]
M v[164:167],a[156:159],a[148:151],v[164:167]
M v[168:171],a[156:159],a[144:147],v[168:171]
s_waitcnt lgkmcnt(0)
s_barrier
ds_read_b128 v[32:35],v250 offset:17408
M v[168:171],a[120:123],a[180:183],v[168:171]
ds_read_b128 v[40:43],v250 offset:21504
ds_read_b128 v[48:51],v250 offset:26112
M v[168:171],a[164:167],a[136:139],v[168:171]
ds_read_b128 v[56:59],v250 offset:30208
ds_read_b128 v[64:67],v250 offset:0
M v[172:175],a[164:167],a[124:127],v[172:175]
ds_read_b128 v[72:75],v250 offset:4096
ds_read_b128 v[80:83],v250 offset:8704
ds_read_b128 a[140:143],v248 offset:1536
M v[172:175],a[120:123],a[136:139],v[172:175]
ds_read_b128 v[88:91],v250 offset:12800
ds_read_b128 a[100:103],v249 offset:1536
M v[172:175],a[156:159],a[180:183],v[172:175]
s_waitcnt lgkmcnt(9)
s_add_u32 s34,s33,6291456
buffer_store_dwordx4 v[32:35],v253,s[24:27],s34 offen offset:128 nt
M v[176:179],a[156:159],a[136:139],v[176:179]
s_add_u32 s34,s33,6684672
ds_read_b128 a[96:99],v249 offset:2048
M v[176:179],a[120:123],a[124:127],v[176:179]
s_waitcnt lgkmcnt(3)
ds_read_b128 a[160:163],v248 offset:2048
M v[176:179],a[164:167],a[140:143],v[176:179]
s_waitcnt lgkmcnt(2)
buffer_store_dwordx4 v[40:43],v253,s[24:27],s34 offen offset:128 nt
M v[180:183],a[164:167],a[100:103],v[180:183]
s_add_u32 s34,s33,7077888
M v[180:183],a[120:123],a[140:143],v[180:183]
ds_read_b128 a[128:131],v248 offset:34816
M v[180:183],a[156:159],a[124:127],v[180:183]
buffer_store_dwordx4 v[48:51],v253,s[24:27],s34 offen offset:128 nt
M v[184:187],a[156:159],a[140:143],v[184:187]
s_add_u32 s34,s33,7471104
ds_read_b128 a[148:151],v249 offset:34816
ds_read_b128 a[144:147],v248 offset:35328
M v[184:187],a[120:123],a[100:103],v[184:187]
s_waitcnt lgkmcnt(4)
ds_read_b128 a[180:183],v249 offset:35328
M v[184:187],a[164:167],a[96:99],v[184:187]
s_waitcnt lgkmcnt(4)
buffer_store_dwordx4 v[56:59],v253,s[24:27],s34 offen offset:128 nt
M v[188:191],a[164:167],a[160:163],v[188:191]
M v[188:191],a[120:123],a[96:99],v[188:191]
M v[188:191],a[156:159],a[100:103],v[188:191]
s_waitcnt vmcnt(20) lgkmcnt(3)
M v[160:163],a[184:187],a[128:131],v[160:163]
s_waitcnt vmcnt(19) lgkmcnt(2)
ds_read_b128 a[136:139],v248 offset:35840
M v[160:163],v[228:231],a[148:151],v[160:163]
s_waitcnt vmcnt(18) lgkmcnt(2)
s_add_u32 s34,s33,6291456
ds_read_b128 a[124:127],v249 offset:35840
M v[160:163],a[200:203],a[144:147],v[160:163]
s_waitcnt lgkmcnt(2)
buffer_store_dwordx4 v[64:67],v253,s[24:27],s34 offen offset:256 nt
M v[164:167],a[200:203],a[180:183],v[164:167]
M v[164:167],v[228:231],a[144:147],v[164:167]
M v[164:167],a[184:187],a[148:151],v[164:167]
M v[168:171],a[184:187],a[144:147],v[168:171]
ds_read_b128 a[140:143],v248 offset:36352
M v[168:171],v[228:231],a[180:183],v[168:171]
s_waitcnt lgkmcnt(2)
ds_read_b128 a[160:163],v249 offset:36352
M v[168:171],a[200:203],a[136:139],v[168:171]
s_waitcnt lgkmcnt(2)
M v[172:175],a[200:203],a[124:127],v[172:175]
M v[172:175],v[228:231],a[136:139],v[172:175]
M v[172:175],a[184:187],a[180:183],v[172:175]
M v[176:179],a[184:187],a[136:139],v[176:179]
ds_read_b128 a[164:167],v249 offset:36864
M v[176:179],v[228:231],a[124:127],v[176:179]
s_waitcnt lgkmcnt(2)
ds_read_b128 a[96:99],v248 offset:36864
M v[176:179],a[200:203],a[140:143],v[176:179]
s_waitcnt lgkmcnt(2)
M v[180:183],a[200:203],a[160:163],v[180:183]
M v[180:183],v[228:231],a[140:143],v[180:183]
ds_read_b128 a[120:123],v248 offset:52224
M v[180:183],a[184:187],a[124:127],v[180:183]
ds_read_b128 a[100:103],v249 offset:52224
M v[184:187],a[184:187],a[140:143],v[184:187]
ds_read_b128 a[156:159],v248 offset:52736
M v[184:187],v[228:231],a[160:163],v[184:187]
s_waitcnt lgkmcnt(4)
ds_read_b128 a[128:131],v249 offset:52736
M v[184:187],a[200:203],a[164:167],v[184:187]
s_waitcnt lgkmcnt(4)
M v[188:191],a[200:203],a[96:99],v[188:191]
M v[188:191],v[228:231],a[164:167],v[188:191]
M v[188:191],a[184:187],a[160:163],v[188:191]
s_waitcnt vmcnt(17) lgkmcnt(3)
s_add_u32 s34,s33,6684672
buffer_store_dwordx4 v[72:75],v253,s[24:27],s34 offen offset:256 nt
M v[160:163],a[152:155],a[120:123],v[160:163]
s_waitcnt vmcnt(17) lgkmcnt(2)
ds_read_b128 a[148:151],v248 offset:53248
M v[160:163],a[104:107],a[100:103],v[160:163]
s_waitcnt vmcnt(16) lgkmcnt(2)
ds_read_b128 a[144:147],v249 offset:53248
M v[160:163],a[112:115],a[156:159],v[160:163]
s_waitcnt lgkmcnt(2)
M v[164:167],a[112:115],a[128:131],v[164:167]
M v[164:167],a[104:107],a[156:159],v[164:167]
M v[164:167],a[152:155],a[100:103],v[164:167]
M v[168:171],a[152:155],a[156:159],v[168:171]
ds_read_b128 a[180:183],v248 offset:53760
M v[168:171],a[104:107],a[128:131],v[168:171]
s_waitcnt lgkmcnt(2)
ds_read_b128 a[136:139],v249 offset:53760
M v[168:171],a[112:115],a[148:151],v[168:171]
s_waitcnt lgkmcnt(2)
M v[172:175],a[112:115],a[144:147],v[172:175]
M v[172:175],a[104:107],a[148:151],v[172:175]
M v[172:175],a[152:155],a[128:131],v[172:175]
M v[176:179],a[152:155],a[148:151],v[176:179]
ds_read_b128 a[124:127],v249 offset:54272
M v[176:179],a[104:107],a[144:147],v[176:179]
s_waitcnt lgkmcnt(2)
ds_read_b128 a[140:143],v248 offset:54272
v_add_u32 v248,0x11000,v248
M v[176:179],a[112:115],a[180:183],v[176:179]
s_waitcnt lgkmcnt(2)
v_add_u32 v249,0x11000,v249
M v[180:183],a[112:115],a[136:139],v[180:183]
M v[180:183],a[104:107],a[180:183],v[180:183]
ds_read_b128 a[96:99],v248 offset:0
M v[180:183],a[152:155],a[144:147],v[180:183]
ds_read_b128 a[164:167],v249 offset:0
M v[184:187],a[152:155],a[180:183],v[184:187]
ds_read_b128 a[160:163],v248 offset:512
M v[184:187],a[104:107],a[136:139],v[184:187]
s_waitcnt lgkmcnt(4)
ds_read_b128 a[184:187],v249 offset:512
M v[184:187],a[112:115],a[124:127],v[184:187]
s_waitcnt lgkmcnt(4)
M v[188:191],a[112:115],a[140:143],v[188:191]
s_add_u32 s34,s33,7077888
M v[188:191],a[104:107],a[124:127],v[188:191]
M v[188:191],a[152:155],a[136:139],v[188:191]
s_waitcnt vmcnt(14) lgkmcnt(3)
buffer_store_dwordx4 v[80:83],v253,s[24:27],s34 offen offset:256 nt
M v[160:163],a[172:175],a[96:99],v[160:163]
s_waitcnt vmcnt(14) lgkmcnt(2)
ds_read_b128 a[120:123],v248 offset:1024
M v[160:163],a[208:211],a[164:167],v[160:163]
s_waitcnt vmcnt(13) lgkmcnt(2)
ds_read_b128 a[100:103],v249 offset:1024
M v[160:163],a[212:215],a[160:163],v[160:163]
s_waitcnt lgkmcnt(2)
M v[164:167],a[212:215],a[184:187],v[164:167]
M v[164:167],a[208:211],a[160:163],v[164:167]
M v[164:167],a[172:175],a[164:167],v[164:167]
M v[168:171],a[172:175],a[160:163],v[168:171]
ds_read_b128 a[156:159],v248 offset:1536
M v[168:171],a[208:211],a[184:187],v[168:171]
s_waitcnt lgkmcnt(2)
ds_read_b128 a[128:131],v249 offset:1536
M v[168:171],a[212:215],a[120:123],v[168:171]
s_waitcnt lgkmcnt(2)
M v[172:175],a[212:215],a[100:103],v[172:175]
M v[172:175],a[208:211],a[120:123],v[172:175]
M v[172:175],a[172:175],a[184:187],v[172:175]
M v[176:179],a[172:175],a[120:123],v[176:179]
ds_read_b128 a[148:151],v249 offset:2048
M v[176:179],a[208:211],a[100:103],v[176:179]
s_waitcnt lgkmcnt(2)
ds_read_b128 a[144:147],v248 offset:2048
M v[176:179],a[212:215],a[156:159],v[176:179]
s_waitcnt lgkmcnt(2)
M v[180:183],a[212:215],a[128:131],v[180:183]
M v[180:183],a[208:211],a[156:159],v[180:183]
ds_read_b128 a[180:183],v248 offset:17408
M v[180:183],a[172:175],a[100:103],v[180:183]
ds_read_b128 a[112:115],v249 offset:17408
M v[184:187],a[172:175],a[156:159],v[184:187]
ds_read_b128 a[140:143],v248 offset:17920
v_add_u32 v248,0xffff3400,v248
M v[184:187],a[208:211],a[128:131],v[184:187]
s_waitcnt lgkmcnt(4)
s_add_u32 s34,s33,7471104
v_add_u32 v249,0xffff3400,v249
M v[184:187],a[212:215],a[148:151],v[184:187]
s_waitcnt lgkmcnt(3)
buffer_store_dwordx4 v[88:91],v253,s[24:27],s34 offen offset:256 nt
M v[188:191],a[212:215],a[144:147],v[188:191]
ds_read_b128 a[104:107],v248 offset:0
ds_read_b128 a[124:127],v249 offset:0
M v[188:191],a[208:211],a[148:151],v[188:191]
ds_read_b128 a[136:139],v248 offset:512
ds_read_b128 a[152:155],v249 offset:512
M v[188:191],a[172:175],a[128:131],v[188:191]
s_waitcnt vmcnt(13) lgkmcnt(6)
v_add_u32 v248,0x11200,v248
v_add_u32 v249,0x11200,v249
M v[160:163],a[168:171],a[180:183],v[160:163]
s_waitcnt vmcnt(12) lgkmcnt(5)
M v[160:163],a[116:119],a[112:115],v[160:163]
s_waitcnt vmcnt(11) lgkmcnt(4)
ds_read_b128 a[96:99],v249 offset:0
M v[160:163],a[108:111],a[140:143],v[160:163]
s_waitcnt vmcnt(10) lgkmcnt(4)
M v[160:163],a[188:191],a[104:107],v[160:163]
s_waitcnt vmcnt(9) lgkmcnt(3)
M v[160:163],a[132:135],a[124:127],v[160:163]
s_waitcnt vmcnt(8) lgkmcnt(2)
M v[160:163],a[176:179],a[136:139],v[160:163]
s_waitcnt lgkmcnt(1)
M v[164:167],a[176:179],a[152:155],v[164:167]
ds_read_b128 a[164:167],v248 offset:512
v_add_u32 v248,0xfffef200,v248
M v[164:167],a[132:135],a[136:139],v[164:167]
v_add_u32 v249,0xfffef200,v249
M v[164:167],a[188:191],a[124:127],v[164:167]
s_waitcnt lgkmcnt(1)
v_cvt_pk_bf16_f32 v160,v160,v161
v_cvt_pk_bf16_f32 v161,v162,v163
M v[164:167],a[108:111],a[96:99],v[164:167]
ds_read_b128 a[160:163],v248 offset:0
M v[164:167],a[116:119],a[140:143],v[164:167]
ds_read_b128 a[184:187],v249 offset:0
v_add_u32 v248,0x11000,v248
M v[164:167],a[168:171],a[112:115],v[164:167]
v_add_u32 v249,0x11000,v249
M v[168:171],a[168:171],a[140:143],v[168:171]
M v[168:171],a[116:119],a[96:99],v[168:171]
s_waitcnt lgkmcnt(2)
ds_read_b128 a[120:123],v249 offset:0
M v[168:171],a[108:111],a[164:167],v[168:171]
s_nop 1
v_cvt_pk_bf16_f32 v164,v164,v165
v_cvt_pk_bf16_f32 v165,v166,v167
M v[168:171],a[188:191],a[136:139],v[168:171]
ds_write2st64_b64 v254,v[160:161],v[164:165] offset0:68 offset1:72
M v[168:171],a[132:135],a[152:155],v[168:171]
s_waitcnt lgkmcnt(3)
M v[168:171],a[176:179],a[160:163],v[168:171]
s_waitcnt lgkmcnt(2)
M v[172:175],a[176:179],a[184:187],v[172:175]
ds_read_b128 a[100:103],v248 offset:512
v_add_u32 v248,0xfffef200,v248
M v[172:175],a[132:135],a[160:163],v[172:175]
v_add_u32 v249,0xfffef200,v249
M v[172:175],a[188:191],a[152:155],v[172:175]
s_waitcnt lgkmcnt(2)
v_cvt_pk_bf16_f32 v168,v168,v169
v_cvt_pk_bf16_f32 v169,v170,v171
M v[172:175],a[108:111],a[120:123],v[172:175]
ds_read_b128 a[156:159],v248 offset:0
M v[172:175],a[116:119],a[164:167],v[172:175]
ds_read_b128 a[144:147],v249 offset:0
v_add_u32 v248,0x11000,v248
M v[172:175],a[168:171],a[96:99],v[172:175]
v_add_u32 v249,0x11000,v249
M v[176:179],a[168:171],a[164:167],v[176:179]
M v[176:179],a[116:119],a[120:123],v[176:179]
s_waitcnt lgkmcnt(2)
ds_read_b128 a[148:151],v249 offset:0
M v[176:179],a[108:111],a[100:103],v[176:179]
s_nop 1
v_cvt_pk_bf16_f32 v172,v172,v173
v_cvt_pk_bf16_f32 v173,v174,v175
M v[176:179],a[188:191],a[160:163],v[176:179]
ds_write2st64_b64 v254,v[168:169],v[172:173] offset0:76 offset1:80
M v[176:179],a[132:135],a[184:187],v[176:179]
s_waitcnt lgkmcnt(3)
M v[176:179],a[176:179],a[156:159],v[176:179]
s_waitcnt lgkmcnt(2)
M v[180:183],a[176:179],a[144:147],v[180:183]
s_waitcnt lgkmcnt(0)
s_barrier
ds_read_b128 v[160:163],v250 offset:34816
M v[180:183],a[132:135],a[156:159],v[180:183]
ds_read_b128 v[168:171],v250 offset:38912
ds_read_b128 a[128:131],v249 offset:512
M v[180:183],a[188:191],a[184:187],v[180:183]
v_add_u32 v248,0xfffef200,v248
v_add_u32 v249,0xfffef200,v249
M v[180:183],a[108:111],a[148:151],v[180:183]
ds_read_b128 a[172:175],v249 offset:0
v_cvt_pk_bf16_f32 v176,v176,v177
M v[180:183],a[116:119],a[100:103],v[180:183]
ds_read_b128 a[180:183],v248 offset:0
v_add_u32 v248,0x11000,v248
M v[180:183],a[168:171],a[120:123],v[180:183]
s_waitcnt lgkmcnt(4)
s_add_u32 s34,s33,6291456
buffer_store_dwordx4 v[160:163],v253,s[24:27],s34 offen offset:1408 nt
M v[184:187],a[168:171],a[100:103],v[184:187]
s_add_u32 s34,s33,6684672
v_add_u32 v249,0x11000,v249
v_cvt_pk_bf16_f32 v177,v178,v179
M v[184:187],a[116:119],a[148:151],v[184:187]
s_waitcnt lgkmcnt(2)
ds_read_b128 a[104:107],v248 offset:0
M v[184:187],a[108:111],a[128:131],v[184:187]
v_cvt_pk_bf16_f32 v180,v180,v181
v_cvt_pk_bf16_f32 v181,v182,v183
M v[184:187],a[188:191],a[156:159],v[184:187]
ds_write2st64_b64 v254,v[176:177],v[180:181] offset0:85 offset1:89
M v[184:187],a[132:135],a[144:147],v[184:187]
s_waitcnt lgkmcnt(3)
M v[184:187],a[176:179],a[172:175],v[184:187]
s_waitcnt lgkmcnt(2)
buffer_store_dwordx4 v[168:171],v253,s[24:27],s34 offen offset:1408 nt
M v[188:191],a[176:179],a[180:183],v[188:191]
s_waitcnt lgkmcnt(0)
s_barrier
ds_read_b128 v[176:179],v250 offset:43520
M v[188:191],a[132:135],a[172:175],v[188:191]
M v[188:191],a[188:191],a[144:147],v[188:191]
v_cvt_pk_bf16_f32 v184,v184,v185
v_cvt_pk_bf16_f32 v185,v186,v187
M v[188:191],a[108:111],a[104:107],v[188:191]
M v[188:191],a[116:119],a[128:131],v[188:191]
M v[188:191],a[168:171],a[148:151],v[188:191]
s_add_u32 s34,s33,7077888
s_waitcnt lgkmcnt(0)
buffer_store_dwordx4 v[176:179],v253,s[24:27],s34 offen offset:1408 nt
s_nop 4
v_cvt_pk_bf16_f32 v188,v188,v189
v_cvt_pk_bf16_f32 v189,v190,v191
ds_write2st64_b64 v254,v[184:185],v[188:189] offset0:93 offset1:97
s_waitcnt lgkmcnt(0)
s_barrier
ds_read_b128 v[184:187],v250 offset:47616
s_add_u32 s34,s33,7471104
s_waitcnt lgkmcnt(0)
buffer_store_dwordx4 v[184:187],v253,s[24:27],s34 offen offset:1408 nt
s_endpgm
L_code_end:
L_fallback:
s_mov_b32 s84,0
L_itemF:
s_and_b32 s85,s84,3
s_lshr_b32 s86,s84,2
s_mul_hi_u32 s87,s86,0x55555556
s_mul_i32 s88,s87,3
s_sub_u32 s86,s86,s88
s_mul_hi_u32 s88,s87,0x2aaaaaab
s_mul_i32 s89,s88,6
s_sub_u32 s87,s87,s89
s_mul_i32 s89,s86,221184
s_mul_i32 s90,s87,12288
s_add_u32 s89,s89,s90
s_mul_i32 s90,s85,3072
s_add_u32 s89,s89,s90
s_lshl_b32 s90,s88,7
s_add_u32 s89,s89,s90
s_add_u32 s90,s89,73728
s_add_u32 s91,s90,73728
v_lshlrev_b32 v149,1,v164
buffer_load_short_d16_hi v68,v149,s[36:39],s89 offen offset:0
buffer_load_short_d16_hi v69,v149,s[36:39],s89 offen offset:384
buffer_load_short_d16_hi v70,v149,s[36:39],s89 offen offset:768
buffer_load_short_d16_hi v71,v149,s[36:39],s89 offen offset:1152
buffer_load_short_d16_hi v72,v149,s[36:39],s89 offen offset:1536
buffer_load_short_d16_hi v73,v149,s[36:39],s89 offen offset:1920
buffer_load_short_d16_hi v74,v149,s[36:39],s89 offen offset:2304
buffer_load_short_d16_hi v75,v149,s[36:39],s89 offen offset:2688
buffer_load_short_d16_hi v76,v149,s[36:39],s90 offen offset:0
buffer_load_short_d16_hi v77,v149,s[36:39],s90 offen offset:384
buffer_load_short_d16_hi v78,v149,s[36:39],s90 offen offset:768
buffer_load_short_d16_hi v79,v149,s[36:39],s90 offen offset:1152
buffer_load_short_d16_hi v80,v149,s[36:39],s90 offen offset:1536
buffer_load_short_d16_hi v81,v149,s[36:39],s90 offen offset:1920
buffer_load_short_d16_hi v82,v149,s[36:39],s90 offen offset:2304
buffer_load_short_d16_hi v83,v149,s[36:39],s90 offen offset:2688
buffer_load_short_d16_hi v84,v149,s[36:39],s91 offen offset:0
buffer_load_short_d16_hi v85,v149,s[36:39],s91 offen offset:384
buffer_load_short_d16_hi v86,v149,s[36:39],s91 offen offset:768
buffer_load_short_d16_hi v87,v149,s[36:39],s91 offen offset:1152
buffer_load_short_d16_hi v88,v149,s[36:39],s91 offen offset:1536
buffer_load_short_d16_hi v89,v149,s[36:39],s91 offen offset:1920
buffer_load_short_d16_hi v90,v149,s[36:39],s91 offen offset:2304
buffer_load_short_d16_hi v91,v149,s[36:39],s91 offen offset:2688
s_and_b32 s92,s85,1
s_lshl_b32 s92,s92,2
s_lshr_b32 s85,s85,1
s_lshl_b32 s85,s85,2
v_bfe_u32 v148,v164,2,2
v_or_b32 v148,s92,v148
v_and_b32 v151,3,v164
v_or_b32 v151,s85,v151
v_xor_b32 v151,v151,v148
v_lshrrev_b32 v150,4,v164
v_mul_u32_u24 v150,331776,v150
v_lshl_add_u32 v150,v148,7,v150
v_lshl_add_u32 v150,v151,4,v150
s_mul_i32 s87,s87,55296
s_mul_i32 s88,s88,3072
s_add_u32 s87,s87,s88
s_lshl_b32 s86,s86,10
s_add_u32 s87,s87,s86
s_mov_b32 s85,0xbe2aaaab
s_mov_b32 s86,0x3d2aaaab
s_mov_b32 s88,0x3e2aaaab
s_mov_b32 s92,0x3daaaaab
s_waitcnt vmcnt(0)
v_add_f32 v148,v68,v84
v_add_f32 v92,v148,v76
v_sub_f32 v100,v148,v76
v_mul_f32 v92,s85,v92
v_mul_f32 v100,s85,v100
v_mul_f32 v148,s86,v68
v_fmac_f32 v148,s88,v84
v_fma_f32 v108,s92,v76,v148
v_fma_f32 v116,-s92,v76,v148
v_add_f32 v148,v69,v85
v_add_f32 v93,v148,v77
v_sub_f32 v101,v148,v77
v_mul_f32 v93,s85,v93
v_mul_f32 v101,s85,v101
v_mul_f32 v148,s86,v69
v_fmac_f32 v148,s88,v85
v_fma_f32 v109,s92,v77,v148
v_fma_f32 v117,-s92,v77,v148
v_add_f32 v148,v70,v86
v_add_f32 v94,v148,v78
v_sub_f32 v102,v148,v78
v_mul_f32 v94,s85,v94
v_mul_f32 v102,s85,v102
v_mul_f32 v148,s86,v70
v_fmac_f32 v148,s88,v86
v_fma_f32 v110,s92,v78,v148
v_fma_f32 v118,-s92,v78,v148
v_add_f32 v148,v71,v87
v_add_f32 v95,v148,v79
v_sub_f32 v103,v148,v79
v_mul_f32 v95,s85,v95
v_mul_f32 v103,s85,v103
v_mul_f32 v148,s86,v71
v_fmac_f32 v148,s88,v87
v_fma_f32 v111,s92,v79,v148
v_fma_f32 v119,-s92,v79,v148
v_add_f32 v148,v72,v88
v_add_f32 v96,v148,v80
v_sub_f32 v104,v148,v80
v_mul_f32 v96,s85,v96
v_mul_f32 v104,s85,v104
v_mul_f32 v148,s86,v72
v_fmac_f32 v148,s88,v88
v_fma_f32 v112,s92,v80,v148
v_fma_f32 v120,-s92,v80,v148
v_add_f32 v148,v73,v89
v_add_f32 v97,v148,v81
v_sub_f32 v105,v148,v81
v_mul_f32 v97,s85,v97
v_mul_f32 v105,s85,v105
v_mul_f32 v148,s86,v73
v_fmac_f32 v148,s88,v89
v_fma_f32 v113,s92,v81,v148
v_fma_f32 v121,-s92,v81,v148
v_add_f32 v148,v74,v90
v_add_f32 v98,v148,v82
v_sub_f32 v106,v148,v82
v_mul_f32 v98,s85,v98
v_mul_f32 v106,s85,v106
v_mul_f32 v148,s86,v74
v_fmac_f32 v148,s88,v90
v_fma_f32 v114,s92,v82,v148
v_fma_f32 v122,-s92,v82,v148
v_add_f32 v148,v75,v91
v_add_f32 v99,v148,v83
v_sub_f32 v107,v148,v83
v_mul_f32 v99,s85,v99
v_mul_f32 v107,s85,v107
v_mul_f32 v148,s86,v75
v_fmac_f32 v148,s88,v91
v_fma_f32 v115,s92,v83,v148
v_fma_f32 v123,-s92,v83,v148
v_cvt_pk_bf16_f32 v124,v68,v69
v_cvt_pk_bf16_f32 v125,v70,v71
v_cvt_pk_bf16_f32 v126,v72,v73
v_cvt_pk_bf16_f32 v127,v74,v75
s_add_u32 s89,s87,0
buffer_store_dwordx4 v[124:127],v150,s[20:23],s89 offen sc1
v_cvt_pk_bf16_f32 v144,v84,v85
v_cvt_pk_bf16_f32 v145,v86,v87
v_cvt_pk_bf16_f32 v146,v88,v89
v_cvt_pk_bf16_f32 v147,v90,v91
s_add_u32 s89,s87,46080
buffer_store_dwordx4 v[144:147],v150,s[20:23],s89 offen sc1
v_cvt_pk_bf16_f32 v128,v92,v93
v_cvt_pk_bf16_f32 v129,v94,v95
v_cvt_pk_bf16_f32 v130,v96,v97
v_cvt_pk_bf16_f32 v131,v98,v99
s_add_u32 s89,s87,9216
buffer_store_dwordx4 v[128:131],v150,s[20:23],s89 offen sc1
v_cvt_pk_bf16_f32 v132,v100,v101
v_cvt_pk_bf16_f32 v133,v102,v103
v_cvt_pk_bf16_f32 v134,v104,v105
v_cvt_pk_bf16_f32 v135,v106,v107
s_add_u32 s89,s87,18432
buffer_store_dwordx4 v[132:135],v150,s[20:23],s89 offen sc1
v_cvt_pk_bf16_f32 v136,v108,v109
v_cvt_pk_bf16_f32 v137,v110,v111
v_cvt_pk_bf16_f32 v138,v112,v113
v_cvt_pk_bf16_f32 v139,v114,v115
s_add_u32 s89,s87,27648
buffer_store_dwordx4 v[136:139],v150,s[20:23],s89 offen sc1
v_cvt_pk_bf16_f32 v140,v116,v117
v_cvt_pk_bf16_f32 v141,v118,v119
v_cvt_pk_bf16_f32 v142,v120,v121
v_cvt_pk_bf16_f32 v143,v122,v123
s_add_u32 s89,s87,36864
buffer_store_dwordx4 v[140:143],v150,s[20:23],s89 offen sc1
s_waitcnt vmcnt(0)
s_add_u32 s84,s84,1
s_cmp_lt_u32 s84,216
s_cbranch_scc1 L_itemF
s_branch L_uready
.section .rodata,"a"
.p2align 6
.amdhsa_kernel standalone__winograd__vision_kernel
  .amdhsa_next_free_vgpr 512
  .amdhsa_next_free_sgpr 96
  .amdhsa_accum_offset 256
  .amdhsa_group_segment_fixed_size 0
  .amdhsa_kernarg_size 40
  .amdhsa_user_sgpr_count 2
  .amdhsa_user_sgpr_kernarg_segment_ptr 1
  .amdhsa_system_sgpr_workgroup_id_x 1
  .amdhsa_float_denorm_mode_32 3
.end_amdhsa_kernel
```

```asm
; @launch grid=(256,1,1) block=(256,1,1) lds=156672
.amdgcn_target "amdgcn-amd-amdhsa--gfx950"
.macro M d,a,b,c
v_mfma_f32_16x16x32_bf16 \d,\a,\b,\c
.endm
.text
.globl standalone__winograd__vision_kernel
.p2align 8
.type standalone__winograd__vision_kernel,@function
standalone__winograd__vision_kernel:
s_cmp_ge_u32 s2,256
s_cbranch_scc0 L_go
s_endpgm
L_go:
s_load_dwordx4 s[4:7],s[0:1],0
s_load_dwordx4 s[24:27],s[0:1],16
s_load_dwordx2 s[20:21],s[0:1],32
v_lshlrev_b32 v165,4,v0
s_getpc_b64 s[64:65]
L_pc:
s_lshr_b32 s58,s2,3
s_lshl_b32 s58,s58,12
s_min_u32 s58,s58,L_code_end-L_pc-4096
s_add_u32 s64,s64,s58
s_addc_u32 s65,s65,0
global_load_dword v167,v165,s[64:65]
v_lshrrev_b32 v160,6,v0
v_and_b32 v164,63,v0
v_readfirstlane_b32 s50,v160
v_bfe_u32 v160,v164,3,2
v_bfe_u32 v161,v164,2,1
v_lshl_add_u32 v161,v160,3,v161
v_lshrrev_b32 v162,5,v164
v_xor_b32 v162,v162,v160
v_and_b32 v162,1,v162
v_and_b32 v163,3,v164
v_lshl_add_u32 v162,v162,2,v163
v_mul_u32_u24 v245,196608,v161
v_lshl_add_u32 v245,v162,3,v245
s_and_b32 s54,s2,7
s_lshr_b32 s55,s2,3
s_lshl_b32 s49,s54,6
s_lshl_b32 s55,s55,4
s_lshl_b32 s56,s50,2
s_add_u32 s56,s56,s55
s_mul_i32 s30,s56,384
s_mul_i32 s57,s49,196608
s_add_u32 s30,s30,s57
s_mul_i32 s44,s50,330752
s_mov_b32 s58,0
s_add_u32 s59,s58,0
s_lshl_b32 s84,s59,6
s_add_u32 s66,s30,s84
s_mul_i32 s84,s59,55296
s_add_u32 s72,s44,s84
s_add_u32 s59,s58,1
s_lshl_b32 s84,s59,6
s_add_u32 s67,s30,s84
s_mul_i32 s84,s59,55296
s_add_u32 s73,s44,s84
s_add_u32 s59,s58,2
s_lshl_b32 s84,s59,6
s_add_u32 s68,s30,s84
s_mul_i32 s84,s59,55296
s_add_u32 s74,s44,s84
s_add_u32 s59,s58,3
s_lshl_b32 s84,s59,6
s_add_u32 s69,s30,s84
s_mul_i32 s84,s59,55296
s_add_u32 s75,s44,s84
s_add_u32 s59,s58,4
s_lshl_b32 s84,s59,6
s_add_u32 s70,s30,s84
s_mul_i32 s84,s59,55296
s_add_u32 s76,s44,s84
s_add_u32 s59,s58,5
s_cmp_eq_u32 s59,6
s_cselect_b32 s59,0,s59
s_lshl_b32 s84,s59,6
s_add_u32 s71,s30,s84
s_mul_i32 s84,s59,55296
s_add_u32 s77,s44,s84
s_cmp_eq_u32 s49,0
s_cselect_b32 s58,1,0
v_cmp_gt_u32 vcc,s58,v161
v_lshrrev_b32 v163,5,v164
v_add_u32 v163,32,v163
v_mul_u32_u24 v246,196608,v163
v_bfrev_b32 v163,1
v_cndmask_b32 v251,v245,v163,vcc
v_lshl_add_u32 v168,v162,3,v245
v_cndmask_b32 v169,v168,v163,vcc
v_and_b32 v163,31,v164
v_lshlrev_b32 v163,1,v163
v_lshl_add_u32 v170,v163,1,v246
v_add_u32 v246,v246,v163
v_mov_b32 v166,1
s_mov_b32 s38,663552
s_mov_b32 s39,0x20000
s_mov_b32 s62,0
s_mov_b32 s63,0x20000
s_mov_b32 s22,1327104
s_mov_b32 s23,0x20000
s_waitcnt lgkmcnt(0)
s_and_b32 s21,s21,0xffff
s_mov_b32 s36,s6
s_and_b32 s37,s7,0xffff
s_mov_b32 s60,s26
s_and_b32 s61,s27,0xffff
s_mov_b32 s52,s26
s_mov_b32 s53,s27
s_cmp_lt_u32 s2,54
s_cbranch_scc0 L_noitem
s_lshl_b32 s84,s2,2
s_add_u32 s84,s84,s50
L_itemP:
s_and_b32 s85,s84,3
s_lshr_b32 s86,s84,2
s_mul_hi_u32 s87,s86,0x55555556
s_mul_i32 s88,s87,3
s_sub_u32 s86,s86,s88
s_mul_hi_u32 s88,s87,0x2aaaaaab
s_mul_i32 s89,s88,6
s_sub_u32 s87,s87,s89
s_mul_i32 s89,s86,221184
s_mul_i32 s90,s87,12288
s_add_u32 s89,s89,s90
s_mul_i32 s90,s85,3072
s_add_u32 s89,s89,s90
s_lshl_b32 s90,s88,7
s_add_u32 s89,s89,s90
s_add_u32 s90,s89,73728
s_add_u32 s91,s90,73728
v_lshlrev_b32 v149,1,v164
buffer_load_short_d16_hi v68,v149,s[36:39],s89 offen offset:0
buffer_load_short_d16_hi v69,v149,s[36:39],s89 offen offset:384
buffer_load_short_d16_hi v70,v149,s[36:39],s89 offen offset:768
buffer_load_short_d16_hi v71,v149,s[36:39],s89 offen offset:1152
buffer_load_short_d16_hi v72,v149,s[36:39],s89 offen offset:1536
buffer_load_short_d16_hi v73,v149,s[36:39],s89 offen offset:1920
buffer_load_short_d16_hi v74,v149,s[36:39],s89 offen offset:2304
buffer_load_short_d16_hi v75,v149,s[36:39],s89 offen offset:2688
buffer_load_short_d16_hi v76,v149,s[36:39],s90 offen offset:0
buffer_load_short_d16_hi v77,v149,s[36:39],s90 offen offset:384
buffer_load_short_d16_hi v78,v149,s[36:39],s90 offen offset:768
buffer_load_short_d16_hi v79,v149,s[36:39],s90 offen offset:1152
buffer_load_short_d16_hi v80,v149,s[36:39],s90 offen offset:1536
buffer_load_short_d16_hi v81,v149,s[36:39],s90 offen offset:1920
buffer_load_short_d16_hi v82,v149,s[36:39],s90 offen offset:2304
buffer_load_short_d16_hi v83,v149,s[36:39],s90 offen offset:2688
buffer_load_short_d16_hi v84,v149,s[36:39],s91 offen offset:0
buffer_load_short_d16_hi v85,v149,s[36:39],s91 offen offset:384
buffer_load_short_d16_hi v86,v149,s[36:39],s91 offen offset:768
buffer_load_short_d16_hi v87,v149,s[36:39],s91 offen offset:1152
buffer_load_short_d16_hi v88,v149,s[36:39],s91 offen offset:1536
buffer_load_short_d16_hi v89,v149,s[36:39],s91 offen offset:1920
buffer_load_short_d16_hi v90,v149,s[36:39],s91 offen offset:2304
buffer_load_short_d16_hi v91,v149,s[36:39],s91 offen offset:2688
s_and_b32 s92,s85,1
s_lshl_b32 s92,s92,2
s_lshr_b32 s85,s85,1
s_lshl_b32 s85,s85,2
v_bfe_u32 v148,v164,2,2
v_or_b32 v148,s92,v148
v_and_b32 v151,3,v164
v_or_b32 v151,s85,v151
v_xor_b32 v151,v151,v148
v_lshrrev_b32 v150,4,v164
v_mul_u32_u24 v150,331776,v150
v_lshl_add_u32 v150,v148,7,v150
v_lshl_add_u32 v150,v151,4,v150
s_mul_i32 s87,s87,55296
s_mul_i32 s88,s88,3072
s_add_u32 s87,s87,s88
s_lshl_b32 s86,s86,10
s_add_u32 s87,s87,s86
s_mov_b32 s85,0xbe2aaaab
s_mov_b32 s86,0x3d2aaaab
s_mov_b32 s88,0x3e2aaaab
s_mov_b32 s92,0x3daaaaab
s_waitcnt vmcnt(0)
v_add_f32 v148,v68,v84
v_add_f32 v92,v148,v76
v_sub_f32 v100,v148,v76
v_mul_f32 v92,s85,v92
v_mul_f32 v100,s85,v100
v_mul_f32 v148,s86,v68
v_fmac_f32 v148,s88,v84
v_fma_f32 v108,s92,v76,v148
v_fma_f32 v116,-s92,v76,v148
v_add_f32 v148,v69,v85
v_add_f32 v93,v148,v77
v_sub_f32 v101,v148,v77
v_mul_f32 v93,s85,v93
v_mul_f32 v101,s85,v101
v_mul_f32 v148,s86,v69
v_fmac_f32 v148,s88,v85
v_fma_f32 v109,s92,v77,v148
v_fma_f32 v117,-s92,v77,v148
v_add_f32 v148,v70,v86
v_add_f32 v94,v148,v78
v_sub_f32 v102,v148,v78
v_mul_f32 v94,s85,v94
v_mul_f32 v102,s85,v102
v_mul_f32 v148,s86,v70
v_fmac_f32 v148,s88,v86
v_fma_f32 v110,s92,v78,v148
v_fma_f32 v118,-s92,v78,v148
v_add_f32 v148,v71,v87
v_add_f32 v95,v148,v79
v_sub_f32 v103,v148,v79
v_mul_f32 v95,s85,v95
v_mul_f32 v103,s85,v103
v_mul_f32 v148,s86,v71
v_fmac_f32 v148,s88,v87
v_fma_f32 v111,s92,v79,v148
v_fma_f32 v119,-s92,v79,v148
v_add_f32 v148,v72,v88
v_add_f32 v96,v148,v80
v_sub_f32 v104,v148,v80
v_mul_f32 v96,s85,v96
v_mul_f32 v104,s85,v104
v_mul_f32 v148,s86,v72
v_fmac_f32 v148,s88,v88
v_fma_f32 v112,s92,v80,v148
v_fma_f32 v120,-s92,v80,v148
v_add_f32 v148,v73,v89
v_add_f32 v97,v148,v81
v_sub_f32 v105,v148,v81
v_mul_f32 v97,s85,v97
v_mul_f32 v105,s85,v105
v_mul_f32 v148,s86,v73
v_fmac_f32 v148,s88,v89
v_fma_f32 v113,s92,v81,v148
v_fma_f32 v121,-s92,v81,v148
v_add_f32 v148,v74,v90
v_add_f32 v98,v148,v82
v_sub_f32 v106,v148,v82
v_mul_f32 v98,s85,v98
v_mul_f32 v106,s85,v106
v_mul_f32 v148,s86,v74
v_fmac_f32 v148,s88,v90
v_fma_f32 v114,s92,v82,v148
v_fma_f32 v122,-s92,v82,v148
v_add_f32 v148,v75,v91
v_add_f32 v99,v148,v83
v_sub_f32 v107,v148,v83
v_mul_f32 v99,s85,v99
v_mul_f32 v107,s85,v107
v_mul_f32 v148,s86,v75
v_fmac_f32 v148,s88,v91
v_fma_f32 v115,s92,v83,v148
v_fma_f32 v123,-s92,v83,v148
v_cvt_pk_bf16_f32 v124,v68,v69
v_cvt_pk_bf16_f32 v125,v70,v71
v_cvt_pk_bf16_f32 v126,v72,v73
v_cvt_pk_bf16_f32 v127,v74,v75
s_add_u32 s89,s87,0
buffer_store_dwordx4 v[124:127],v150,s[20:23],s89 offen sc1
v_cvt_pk_bf16_f32 v144,v84,v85
v_cvt_pk_bf16_f32 v145,v86,v87
v_cvt_pk_bf16_f32 v146,v88,v89
v_cvt_pk_bf16_f32 v147,v90,v91
s_add_u32 s89,s87,46080
buffer_store_dwordx4 v[144:147],v150,s[20:23],s89 offen sc1
v_cvt_pk_bf16_f32 v128,v92,v93
v_cvt_pk_bf16_f32 v129,v94,v95
v_cvt_pk_bf16_f32 v130,v96,v97
v_cvt_pk_bf16_f32 v131,v98,v99
s_add_u32 s89,s87,9216
buffer_store_dwordx4 v[128:131],v150,s[20:23],s89 offen sc1
v_cvt_pk_bf16_f32 v132,v100,v101
v_cvt_pk_bf16_f32 v133,v102,v103
v_cvt_pk_bf16_f32 v134,v104,v105
v_cvt_pk_bf16_f32 v135,v106,v107
s_add_u32 s89,s87,18432
buffer_store_dwordx4 v[132:135],v150,s[20:23],s89 offen sc1
v_cvt_pk_bf16_f32 v136,v108,v109
v_cvt_pk_bf16_f32 v137,v110,v111
v_cvt_pk_bf16_f32 v138,v112,v113
v_cvt_pk_bf16_f32 v139,v114,v115
s_add_u32 s89,s87,27648
buffer_store_dwordx4 v[136:139],v150,s[20:23],s89 offen sc1
v_cvt_pk_bf16_f32 v140,v116,v117
v_cvt_pk_bf16_f32 v141,v118,v119
v_cvt_pk_bf16_f32 v142,v120,v121
v_cvt_pk_bf16_f32 v143,v122,v123
s_add_u32 s89,s87,36864
buffer_store_dwordx4 v[140:143],v150,s[20:23],s89 offen sc1
s_waitcnt vmcnt(0)
s_barrier
s_cmp_eq_u32 s50,0
s_cselect_b32 s62,256,0
L_noitem:
s_and_b32 s84,s2,1
s_lshl_b32 s59,s84,6
s_lshl_b32 s84,s84,2
s_mov_b64 exec,1
buffer_atomic_add v166,off,s[60:63],s59 sc0 sc1
s_mov_b64 exec,-1
s_and_b32 s5,s5,0xffff
s_sub_u32 s8,s4,196608
s_subb_u32 s9,s5,0
s_mov_b32 s10,100859904
s_mov_b32 s11,0x20000
s_sub_u32 s12,s4,196992
s_subb_u32 s13,s5,0
s_cmp_eq_u32 s56,0
s_cselect_b32 s14,0,100860288
s_mov_b32 s15,0x20000
s_mov_b32 s16,s8
s_mov_b32 s17,s9
s_cmp_eq_u32 s56,508
s_cselect_b32 s18,0,100859904
s_mov_b32 s19,0x20000
s_add_u32 s28,s30,0
buffer_load_dwordx4 v[8:11],v169,s[8:11],s28 offen offset:384
buffer_load_dwordx4 v[0:3],v169,s[12:15],s28 offen offset:0
buffer_load_dwordx4 v[4:7],v169,s[8:11],s28 offen offset:0
buffer_load_dwordx4 v[20:23],v169,s[16:19],s28 offen offset:1536
buffer_load_dwordx4 v[16:19],v169,s[8:11],s28 offen offset:1152
buffer_load_dwordx4 v[12:15],v169,s[8:11],s28 offen offset:768
s_mov_b64 exec,1
s_waitcnt vmcnt(6)
v_cmp_eq_u32 vcc,26,v166
v_mov_b32 v165,1
s_nop 2
s_and_b64 exec,exec,vcc
s_cselect_b32 s62,s62,0
s_mov_b64 exec,1
buffer_store_dword v165,off,s[60:63],s84 offset:128 sc1
s_mov_b64 exec,-1
s_add_u32 s28,s30,393216
buffer_load_dwordx4 v[32:35],v168,s[8:11],s28 offen offset:384
buffer_load_dwordx4 v[24:27],v168,s[12:15],s28 offen offset:0
buffer_load_dwordx4 v[28:31],v168,s[8:11],s28 offen offset:0
buffer_load_dwordx4 v[44:47],v168,s[16:19],s28 offen offset:1536
buffer_load_dwordx4 v[40:43],v168,s[8:11],s28 offen offset:1152
buffer_load_dwordx4 v[36:39],v168,s[8:11],s28 offen offset:768
v_bfe_u32 v165,v164,2,3
v_lshrrev_b32 v159,5,v164
v_and_b32 v163,3,v164
v_lshl_add_u32 v159,v159,2,v163
v_xor_b32 v163,v159,v165
v_lshlrev_b32 v163,4,v163
v_lshl_add_u32 v163,v165,7,v163
v_lshl_add_u32 v250,s50,10,v163
s_and_b32 s25,s25,0xffff
s_mov_b32 s26,100663296
s_mov_b32 s27,0x20000
s_mov_b32 s41,0xc0a00000
s_mov_b32 s40,0x41000000
s_mov_b32 s42,0xffff0000
s_mov_b32 s43,0xbfa00000
s_mov_b32 s45,0x3e800000
s_mul_i32 s58,s55,384
s_add_u32 s58,s57,s58
s_lshr_b32 s59,s50,1
s_mul_i32 s32,s59,384
s_mul_i32 s33,s59,196608
s_add_u32 s32,s32,s58
s_add_u32 s33,s33,s58
s_lshl_b32 s58,s59,5
s_lshl_b32 s59,s50,7
v_lshlrev_b32 v247,11,v160
v_xor_b32 v163,v160,v161
v_and_b32 v163,1,v163
v_lshl_add_u32 v247,v163,6,v247
v_lshlrev_b32 v163,3,v162
v_xor_b32 v163,s58,v163
v_add3_u32 v247,v247,v163,s59
v_and_b32 v171,0xffffffc0,v247
v_and_b32 v163,3,v162
v_lshlrev_b32 v163,4,v163
v_xor_b32 v163,s58,v163
v_add_u32 v171,v171,v163
v_lshrrev_b32 v163,2,v162
v_mul_u32_u24 v163,17408,v163
v_mad_u32_u24 v172,v163,5,v171
v_lshl_add_u32 v171,v163,1,v171
v_and_b32 v163,15,v164
v_lshlrev_b32 v163,2,v163
v_xor_b32 v163,s58,v163
v_lshrrev_b32 v173,5,v164
v_lshl_add_u32 v173,v173,6,v163
v_add_u32 v173,s59,v173
v_add_u32 v173,8192,v173
v_bfe_u32 v163,v164,4,1
v_mul_u32_u24 v163,17408,v163
v_mad_u32_u24 v174,v163,5,v173
v_lshl_add_u32 v173,v163,1,v173
v_and_b32 v163,3,v164
v_lshlrev_b32 v163,4,v163
v_and_or_b32 v245,v245,s42,v163
v_xor_b32 v163,s58,v163
v_and_b32 v247,0xffffffc0,v247
v_add_u32 v247,v247,v163
v_lshrrev_b32 v163,5,v164
v_lshl_add_u32 v247,v163,3,v247
v_mul_u32_u24 v163,384,v163
v_mad_u32_u24 v251,v163,5,v245
v_add_u32 v245,v245,v163
s_cmp_eq_u32 s56,0
s_cselect_b32 exec_lo,-1,0
s_cmp_eq_u32 s56,508
s_cselect_b32 exec_hi,-1,0
v_or_b32 v251,0x40000000,v251
s_mov_b64 exec,-1
v_lshrrev_b32 v160,5,v164
v_lshlrev_b32 v160,6,v160
v_and_b32 v161,63,v246
v_xor_b32 v161,s58,v161
v_add3_u32 v252,v160,v161,s59
v_add_u32 v252,8192,v252
v_bfe_u32 v160,v164,2,2
v_and_b32 v161,3,v164
v_lshrrev_b32 v162,4,v164
v_lshlrev_b32 v248,11,v160
v_lshl_add_u32 v248,v161,7,v248
v_and_b32 v163,1,v160
v_lshl_add_u32 v248,v163,6,v248
v_and_b32 v163,2,v161
v_xor_b32 v163,v163,v162
v_lshl_add_u32 v248,v163,4,v248
v_xor_b32 v249,64,v248
v_lshrrev_b32 v160,1,v162
v_lshl_add_u32 v160,s50,1,v160
v_and_b32 v161,7,v164
v_xor_b32 v160,v160,v161
v_and_b32 v163,15,v164
v_lshlrev_b32 v254,7,v163
v_lshl_add_u32 v254,v160,4,v254
v_and_b32 v163,1,v162
v_lshl_add_u32 v254,v163,3,v254
v_bfe_u32 v160,v250,7,4
v_lshrrev_b32 v162,2,v160
v_mul_u32_u24 v253,1572864,v162
v_and_b32 v162,3,v160
v_mul_u32_u24 v162,1536,v162
v_lshl_add_u32 v160,v159,4,v162
v_add_u32 v253,v253,v160
s_waitcnt vmcnt(12)
v_lshlrev_b32 v180,16,v8
v_and_b32 v181,s42,v8
s_waitcnt vmcnt(11)
v_lshlrev_b32 v176,16,v0
v_and_b32 v177,s42,v0
s_waitcnt vmcnt(10)
v_lshlrev_b32 v178,16,v4
v_and_b32 v179,s42,v4
s_add_u32 s28,s30,786432
buffer_load_dwordx4 v[56:59],v168,s[8:11],s28 offen offset:384
s_waitcnt vmcnt(10)
v_lshlrev_b32 v186,16,v20
v_and_b32 v187,s42,v20
s_waitcnt vmcnt(9)
v_lshlrev_b32 v184,16,v16
v_and_b32 v185,s42,v16
s_waitcnt vmcnt(8)
v_lshlrev_b32 v182,16,v12
v_and_b32 v183,s42,v12
v_pk_fma_f32 v[176:177],v[180:181],s[42:43],v[176:177] op_sel:[0,1,0] op_sel_hi:[1,1,1]
v_pk_fma_f32 v[186:187],v[178:179],4.0,v[186:187] op_sel_hi:[1,0,1]
v_pk_fma_f32 v[188:189],v[180:181],-4.0,v[184:185] op_sel_hi:[1,0,1]
v_pk_fma_f32 v[176:177],v[184:185],s[44:45],v[176:177] op_sel:[0,1,0] op_sel_hi:[1,1,1]
v_pk_fma_f32 v[186:187],v[182:183],s[40:41],v[186:187] op_sel:[0,1,0] op_sel_hi:[1,1,1]
v_pk_add_f32 v[184:185],v[184:185],v[180:181] neg_lo:[0,1] neg_hi:[0,1]
buffer_load_dwordx4 v[48:51],v168,s[12:15],s28 offen offset:0
v_pk_fma_f32 v[180:181],v[178:179],-4.0,v[182:183] op_sel_hi:[1,0,1]
v_pk_add_f32 v[182:183],v[182:183],v[178:179] neg_lo:[0,1] neg_hi:[0,1]
v_pk_add_f32 v[178:179],v[188:189],v[180:181]
v_pk_add_f32 v[188:189],v[188:189],v[180:181] neg_lo:[0,1] neg_hi:[0,1]
v_pk_fma_f32 v[180:181],v[182:183],2.0,v[184:185] op_sel_hi:[1,0,1]
v_pk_fma_f32 v[184:185],v[182:183],-2.0,v[184:185] op_sel_hi:[1,0,1]
v_cvt_pk_bf16_f32 v0,v176,v177
v_cvt_pk_bf16_f32 v4,v178,v179
v_cvt_pk_bf16_f32 v8,v188,v189
v_cvt_pk_bf16_f32 v12,v180,v181
v_cvt_pk_bf16_f32 v16,v184,v185
v_cvt_pk_bf16_f32 v20,v186,v187
buffer_load_dwordx4 v[52:55],v168,s[8:11],s28 offen offset:0
v_lshlrev_b32 v180,16,v9
v_and_b32 v181,s42,v9
v_lshlrev_b32 v176,16,v1
v_and_b32 v177,s42,v1
v_lshlrev_b32 v178,16,v5
v_and_b32 v179,s42,v5
v_lshlrev_b32 v186,16,v21
v_and_b32 v187,s42,v21
v_lshlrev_b32 v184,16,v17
v_and_b32 v185,s42,v17
v_lshlrev_b32 v182,16,v13
v_and_b32 v183,s42,v13
buffer_load_dwordx4 v[68:71],v168,s[16:19],s28 offen offset:1536
v_pk_fma_f32 v[176:177],v[180:181],s[42:43],v[176:177] op_sel:[0,1,0] op_sel_hi:[1,1,1]
v_pk_fma_f32 v[186:187],v[178:179],4.0,v[186:187] op_sel_hi:[1,0,1]
v_pk_fma_f32 v[188:189],v[180:181],-4.0,v[184:185] op_sel_hi:[1,0,1]
v_pk_fma_f32 v[176:177],v[184:185],s[44:45],v[176:177] op_sel:[0,1,0] op_sel_hi:[1,1,1]
v_pk_fma_f32 v[186:187],v[182:183],s[40:41],v[186:187] op_sel:[0,1,0] op_sel_hi:[1,1,1]
v_pk_add_f32 v[184:185],v[184:185],v[180:181] neg_lo:[0,1] neg_hi:[0,1]
v_pk_fma_f32 v[180:181],v[178:179],-4.0,v[182:183] op_sel_hi:[1,0,1]
v_pk_add_f32 v[182:183],v[182:183],v[178:179] neg_lo:[0,1] neg_hi:[0,1]
v_pk_add_f32 v[178:179],v[188:189],v[180:181]
v_pk_add_f32 v[188:189],v[188:189],v[180:181] neg_lo:[0,1] neg_hi:[0,1]
v_pk_fma_f32 v[180:181],v[182:183],2.0,v[184:185] op_sel_hi:[1,0,1]
v_pk_fma_f32 v[184:185],v[182:183],-2.0,v[184:185] op_sel_hi:[1,0,1]
buffer_load_dwordx4 v[64:67],v168,s[8:11],s28 offen offset:1152
v_cvt_pk_bf16_f32 v1,v176,v177
v_cvt_pk_bf16_f32 v5,v178,v179
v_cvt_pk_bf16_f32 v9,v188,v189
v_cvt_pk_bf16_f32 v13,v180,v181
v_cvt_pk_bf16_f32 v17,v184,v185
v_cvt_pk_bf16_f32 v21,v186,v187
v_lshlrev_b32 v180,16,v10
v_and_b32 v181,s42,v10
v_lshlrev_b32 v176,16,v2
v_and_b32 v177,s42,v2
v_lshlrev_b32 v178,16,v6
v_and_b32 v179,s42,v6
buffer_load_dwordx4 v[60:63],v168,s[8:11],s28 offen offset:768
v_lshlrev_b32 v186,16,v22
v_and_b32 v187,s42,v22
v_lshlrev_b32 v184,16,v18
v_and_b32 v185,s42,v18
v_lshlrev_b32 v182,16,v14
v_and_b32 v183,s42,v14
v_pk_fma_f32 v[176:177],v[180:181],s[42:43],v[176:177] op_sel:[0,1,0] op_sel_hi:[1,1,1]
v_pk_fma_f32 v[186:187],v[178:179],4.0,v[186:187] op_sel_hi:[1,0,1]
v_pk_fma_f32 v[188:189],v[180:181],-4.0,v[184:185] op_sel_hi:[1,0,1]
v_pk_fma_f32 v[176:177],v[184:185],s[44:45],v[176:177] op_sel:[0,1,0] op_sel_hi:[1,1,1]
v_pk_fma_f32 v[186:187],v[182:183],s[40:41],v[186:187] op_sel:[0,1,0] op_sel_hi:[1,1,1]
v_pk_add_f32 v[184:185],v[184:185],v[180:181] neg_lo:[0,1] neg_hi:[0,1]
s_add_u32 s28,s30,1179648
buffer_load_dwordx4 v[80:83],v168,s[8:11],s28 offen offset:384
v_pk_fma_f32 v[180:181],v[178:179],-4.0,v[182:183] op_sel_hi:[1,0,1]
v_pk_add_f32 v[182:183],v[182:183],v[178:179] neg_lo:[0,1] neg_hi:[0,1]
v_pk_add_f32 v[178:179],v[188:189],v[180:181]
v_pk_add_f32 v[188:189],v[188:189],v[180:181] neg_lo:[0,1] neg_hi:[0,1]
v_pk_fma_f32 v[180:181],v[182:183],2.0,v[184:185] op_sel_hi:[1,0,1]
v_pk_fma_f32 v[184:185],v[182:183],-2.0,v[184:185] op_sel_hi:[1,0,1]
v_cvt_pk_bf16_f32 v2,v176,v177
v_cvt_pk_bf16_f32 v6,v178,v179
v_cvt_pk_bf16_f32 v10,v188,v189
v_cvt_pk_bf16_f32 v14,v180,v181
v_cvt_pk_bf16_f32 v18,v184,v185
v_cvt_pk_bf16_f32 v22,v186,v187
buffer_load_dwordx4 v[72:75],v168,s[12:15],s28 offen offset:0
v_lshlrev_b32 v180,16,v11
v_and_b32 v181,s42,v11
v_lshlrev_b32 v176,16,v3
v_and_b32 v177,s42,v3
v_lshlrev_b32 v178,16,v7
v_and_b32 v179,s42,v7
v_lshlrev_b32 v186,16,v23
v_and_b32 v187,s42,v23
v_lshlrev_b32 v184,16,v19
v_and_b32 v185,s42,v19
v_lshlrev_b32 v182,16,v15
v_and_b32 v183,s42,v15
buffer_load_dwordx4 v[76:79],v168,s[8:11],s28 offen offset:0
v_pk_fma_f32 v[176:177],v[180:181],s[42:43],v[176:177] op_sel:[0,1,0] op_sel_hi:[1,1,1]
v_pk_fma_f32 v[186:187],v[178:179],4.0,v[186:187] op_sel_hi:[1,0,1]
v_pk_fma_f32 v[188:189],v[180:181],-4.0,v[184:185] op_sel_hi:[1,0,1]
v_pk_fma_f32 v[176:177],v[184:185],s[44:45],v[176:177] op_sel:[0,1,0] op_sel_hi:[1,1,1]
v_pk_fma_f32 v[186:187],v[182:183],s[40:41],v[186:187] op_sel:[0,1,0] op_sel_hi:[1,1,1]
v_pk_add_f32 v[184:185],v[184:185],v[180:181] neg_lo:[0,1] neg_hi:[0,1]
v_pk_fma_f32 v[180:181],v[178:179],-4.0,v[182:183] op_sel_hi:[1,0,1]
v_pk_add_f32 v[182:183],v[182:183],v[178:179] neg_lo:[0,1] neg_hi:[0,1]
v_pk_add_f32 v[178:179],v[188:189],v[180:181]
v_pk_add_f32 v[188:189],v[188:189],v[180:181] neg_lo:[0,1] neg_hi:[0,1]
v_pk_fma_f32 v[180:181],v[182:183],2.0,v[184:185] op_sel_hi:[1,0,1]
v_pk_fma_f32 v[184:185],v[182:183],-2.0,v[184:185] op_sel_hi:[1,0,1]
buffer_load_dwordx4 v[92:95],v168,s[16:19],s28 offen offset:1536
v_cvt_pk_bf16_f32 v3,v176,v177
v_cvt_pk_bf16_f32 v7,v178,v179
v_cvt_pk_bf16_f32 v11,v188,v189
v_cvt_pk_bf16_f32 v15,v180,v181
v_cvt_pk_bf16_f32 v19,v184,v185
v_cvt_pk_bf16_f32 v23,v186,v187
ds_write_b128 v172,v[0:3] offset:0
ds_write_b128 v171,v[4:7] offset:17408
ds_write_b128 v171,v[8:11] offset:26112
ds_write_b128 v171,v[12:15] offset:34816
ds_write_b128 v171,v[16:19] offset:43520
ds_write_b128 v172,v[20:23] offset:8704
buffer_load_dwordx4 v[88:91],v168,s[8:11],s28 offen offset:1152
s_waitcnt vmcnt(16)
v_lshlrev_b32 v180,16,v32
v_and_b32 v181,s42,v32
s_waitcnt vmcnt(15)
v_lshlrev_b32 v176,16,v24
v_and_b32 v177,s42,v24
s_waitcnt vmcnt(14)
v_lshlrev_b32 v178,16,v28
v_and_b32 v179,s42,v28
buffer_load_dwordx4 v[84:87],v168,s[8:11],s28 offen offset:768
s_waitcnt vmcnt(14)
v_lshlrev_b32 v186,16,v44
v_and_b32 v187,s42,v44
s_waitcnt vmcnt(13)
v_lshlrev_b32 v184,16,v40
v_and_b32 v185,s42,v40
s_waitcnt vmcnt(12)
v_lshlrev_b32 v182,16,v36
v_and_b32 v183,s42,v36
v_pk_fma_f32 v[176:177],v[180:181],s[42:43],v[176:177] op_sel:[0,1,0] op_sel_hi:[1,1,1]
v_pk_fma_f32 v[186:187],v[178:179],4.0,v[186:187] op_sel_hi:[1,0,1]
v_pk_fma_f32 v[188:189],v[180:181],-4.0,v[184:185] op_sel_hi:[1,0,1]
v_pk_fma_f32 v[176:177],v[184:185],s[44:45],v[176:177] op_sel:[0,1,0] op_sel_hi:[1,1,1]
v_pk_fma_f32 v[186:187],v[182:183],s[40:41],v[186:187] op_sel:[0,1,0] op_sel_hi:[1,1,1]
v_pk_add_f32 v[184:185],v[184:185],v[180:181] neg_lo:[0,1] neg_hi:[0,1]
buffer_load_dword v96,v170,s[12:15],s30 offen offset:0
v_pk_fma_f32 v[180:181],v[178:179],-4.0,v[182:183] op_sel_hi:[1,0,1]
v_pk_add_f32 v[182:183],v[182:183],v[178:179] neg_lo:[0,1] neg_hi:[0,1]
v_pk_add_f32 v[178:179],v[188:189],v[180:181]
v_pk_add_f32 v[188:189],v[188:189],v[180:181] neg_lo:[0,1] neg_hi:[0,1]
v_pk_fma_f32 v[180:181],v[182:183],2.0,v[184:185] op_sel_hi:[1,0,1]
v_pk_fma_f32 v[184:185],v[182:183],-2.0,v[184:185] op_sel_hi:[1,0,1]
v_cvt_pk_bf16_f32 v24,v176,v177
v_cvt_pk_bf16_f32 v28,v178,v179
v_cvt_pk_bf16_f32 v32,v188,v189
v_cvt_pk_bf16_f32 v36,v180,v181
v_cvt_pk_bf16_f32 v40,v184,v185
v_cvt_pk_bf16_f32 v44,v186,v187
buffer_load_dword v97,v170,s[8:11],s30 offen offset:0
v_lshlrev_b32 v180,16,v33
v_and_b32 v181,s42,v33
v_lshlrev_b32 v176,16,v25
v_and_b32 v177,s42,v25
v_lshlrev_b32 v178,16,v29
v_and_b32 v179,s42,v29
v_lshlrev_b32 v186,16,v45
v_and_b32 v187,s42,v45
v_lshlrev_b32 v184,16,v41
v_and_b32 v185,s42,v41
v_lshlrev_b32 v182,16,v37
v_and_b32 v183,s42,v37
buffer_load_dword v98,v170,s[8:11],s30 offen offset:384
v_pk_fma_f32 v[176:177],v[180:181],s[42:43],v[176:177] op_sel:[0,1,0] op_sel_hi:[1,1,1]
v_pk_fma_f32 v[186:187],v[178:179],4.0,v[186:187] op_sel_hi:[1,0,1]
v_pk_fma_f32 v[188:189],v[180:181],-4.0,v[184:185] op_sel_hi:[1,0,1]
v_pk_fma_f32 v[176:177],v[184:185],s[44:45],v[176:177] op_sel:[0,1,0] op_sel_hi:[1,1,1]
v_pk_fma_f32 v[186:187],v[182:183],s[40:41],v[186:187] op_sel:[0,1,0] op_sel_hi:[1,1,1]
v_pk_add_f32 v[184:185],v[184:185],v[180:181] neg_lo:[0,1] neg_hi:[0,1]
v_pk_fma_f32 v[180:181],v[178:179],-4.0,v[182:183] op_sel_hi:[1,0,1]
v_pk_add_f32 v[182:183],v[182:183],v[178:179] neg_lo:[0,1] neg_hi:[0,1]
v_pk_add_f32 v[178:179],v[188:189],v[180:181]
v_pk_add_f32 v[188:189],v[188:189],v[180:181] neg_lo:[0,1] neg_hi:[0,1]
v_pk_fma_f32 v[180:181],v[182:183],2.0,v[184:185] op_sel_hi:[1,0,1]
v_pk_fma_f32 v[184:185],v[182:183],-2.0,v[184:185] op_sel_hi:[1,0,1]
buffer_load_dword v99,v170,s[8:11],s30 offen offset:768
v_cvt_pk_bf16_f32 v25,v176,v177
v_cvt_pk_bf16_f32 v29,v178,v179
v_cvt_pk_bf16_f32 v33,v188,v189
v_cvt_pk_bf16_f32 v37,v180,v181
v_cvt_pk_bf16_f32 v41,v184,v185
v_cvt_pk_bf16_f32 v45,v186,v187
v_lshlrev_b32 v180,16,v34
v_and_b32 v181,s42,v34
v_lshlrev_b32 v176,16,v26
v_and_b32 v177,s42,v26
v_lshlrev_b32 v178,16,v30
v_and_b32 v179,s42,v30
buffer_load_dword v100,v170,s[8:11],s30 offen offset:1152
v_lshlrev_b32 v186,16,v46
v_and_b32 v187,s42,v46
v_lshlrev_b32 v184,16,v42
v_and_b32 v185,s42,v42
v_lshlrev_b32 v182,16,v38
v_and_b32 v183,s42,v38
v_pk_fma_f32 v[176:177],v[180:181],s[42:43],v[176:177] op_sel:[0,1,0] op_sel_hi:[1,1,1]
v_pk_fma_f32 v[186:187],v[178:179],4.0,v[186:187] op_sel_hi:[1,0,1]
v_pk_fma_f32 v[188:189],v[180:181],-4.0,v[184:185] op_sel_hi:[1,0,1]
v_pk_fma_f32 v[176:177],v[184:185],s[44:45],v[176:177] op_sel:[0,1,0] op_sel_hi:[1,1,1]
v_pk_fma_f32 v[186:187],v[182:183],s[40:41],v[186:187] op_sel:[0,1,0] op_sel_hi:[1,1,1]
v_pk_add_f32 v[184:185],v[184:185],v[180:181] neg_lo:[0,1] neg_hi:[0,1]
buffer_load_dword v101,v170,s[16:19],s30 offen offset:1536
v_pk_fma_f32 v[180:181],v[178:179],-4.0,v[182:183] op_sel_hi:[1,0,1]
v_pk_add_f32 v[182:183],v[182:183],v[178:179] neg_lo:[0,1] neg_hi:[0,1]
v_pk_add_f32 v[178:179],v[188:189],v[180:181]
v_pk_add_f32 v[188:189],v[188:189],v[180:181] neg_lo:[0,1] neg_hi:[0,1]
v_pk_fma_f32 v[180:181],v[182:183],2.0,v[184:185] op_sel_hi:[1,0,1]
v_pk_fma_f32 v[184:185],v[182:183],-2.0,v[184:185] op_sel_hi:[1,0,1]
v_cvt_pk_bf16_f32 v26,v176,v177
v_cvt_pk_bf16_f32 v30,v178,v179
v_cvt_pk_bf16_f32 v34,v188,v189
v_cvt_pk_bf16_f32 v38,v180,v181
v_cvt_pk_bf16_f32 v42,v184,v185
v_cvt_pk_bf16_f32 v46,v186,v187
v_lshlrev_b32 v180,16,v35
v_and_b32 v181,s42,v35
v_lshlrev_b32 v176,16,v27
v_and_b32 v177,s42,v27
v_lshlrev_b32 v178,16,v31
v_and_b32 v179,s42,v31
v_lshlrev_b32 v186,16,v47
v_and_b32 v187,s42,v47
v_lshlrev_b32 v184,16,v43
v_and_b32 v185,s42,v43
v_lshlrev_b32 v182,16,v39
v_and_b32 v183,s42,v39
v_pk_fma_f32 v[176:177],v[180:181],s[42:43],v[176:177] op_sel:[0,1,0] op_sel_hi:[1,1,1]
v_pk_fma_f32 v[186:187],v[178:179],4.0,v[186:187] op_sel_hi:[1,0,1]
v_pk_fma_f32 v[188:189],v[180:181],-4.0,v[184:185] op_sel_hi:[1,0,1]
v_pk_fma_f32 v[176:177],v[184:185],s[44:45],v[176:177] op_sel:[0,1,0] op_sel_hi:[1,1,1]
v_pk_fma_f32 v[186:187],v[182:183],s[40:41],v[186:187] op_sel:[0,1,0] op_sel_hi:[1,1,1]
v_pk_add_f32 v[184:185],v[184:185],v[180:181] neg_lo:[0,1] neg_hi:[0,1]
v_pk_fma_f32 v[180:181],v[178:179],-4.0,v[182:183] op_sel_hi:[1,0,1]
v_pk_add_f32 v[182:183],v[182:183],v[178:179] neg_lo:[0,1] neg_hi:[0,1]
v_pk_add_f32 v[178:179],v[188:189],v[180:181]
v_pk_add_f32 v[188:189],v[188:189],v[180:181] neg_lo:[0,1] neg_hi:[0,1]
v_pk_fma_f32 v[180:181],v[182:183],2.0,v[184:185] op_sel_hi:[1,0,1]
v_pk_fma_f32 v[184:185],v[182:183],-2.0,v[184:185] op_sel_hi:[1,0,1]
v_cvt_pk_bf16_f32 v27,v176,v177
v_cvt_pk_bf16_f32 v31,v178,v179
v_cvt_pk_bf16_f32 v35,v188,v189
v_cvt_pk_bf16_f32 v39,v180,v181
v_cvt_pk_bf16_f32 v43,v184,v185
v_cvt_pk_bf16_f32 v47,v186,v187
ds_write_b128 v172,v[24:27] offset:512
ds_write_b128 v171,v[28:31] offset:17920
ds_write_b128 v171,v[32:35] offset:26624
ds_write_b128 v171,v[36:39] offset:35328
ds_write_b128 v171,v[40:43] offset:44032
ds_write_b128 v172,v[44:47] offset:9216
s_waitcnt vmcnt(17)
v_lshlrev_b32 v180,16,v56
v_and_b32 v181,s42,v56
s_waitcnt vmcnt(16)
v_lshlrev_b32 v176,16,v48
v_and_b32 v177,s42,v48
s_waitcnt vmcnt(15)
v_lshlrev_b32 v178,16,v52
v_and_b32 v179,s42,v52
s_waitcnt vmcnt(14)
v_lshlrev_b32 v186,16,v68
v_and_b32 v187,s42,v68
s_waitcnt vmcnt(13)
v_lshlrev_b32 v184,16,v64
v_and_b32 v185,s42,v64
s_waitcnt vmcnt(12)
v_lshlrev_b32 v182,16,v60
v_and_b32 v183,s42,v60
v_pk_fma_f32 v[176:177],v[180:181],s[42:43],v[176:177] op_sel:[0,1,0] op_sel_hi:[1,1,1]
v_pk_fma_f32 v[186:187],v[178:179],4.0,v[186:187] op_sel_hi:[1,0,1]
v_pk_fma_f32 v[188:189],v[180:181],-4.0,v[184:185] op_sel_hi:[1,0,1]
v_pk_fma_f32 v[176:177],v[184:185],s[44:45],v[176:177] op_sel:[0,1,0] op_sel_hi:[1,1,1]
v_pk_fma_f32 v[186:187],v[182:183],s[40:41],v[186:187] op_sel:[0,1,0] op_sel_hi:[1,1,1]
v_pk_add_f32 v[184:185],v[184:185],v[180:181] neg_lo:[0,1] neg_hi:[0,1]
v_pk_fma_f32 v[180:181],v[178:179],-4.0,v[182:183] op_sel_hi:[1,0,1]
v_pk_add_f32 v[182:183],v[182:183],v[178:179] neg_lo:[0,1] neg_hi:[0,1]
v_pk_add_f32 v[178:179],v[188:189],v[180:181]
v_pk_add_f32 v[188:189],v[188:189],v[180:181] neg_lo:[0,1] neg_hi:[0,1]
v_pk_fma_f32 v[180:181],v[182:183],2.0,v[184:185] op_sel_hi:[1,0,1]
v_pk_fma_f32 v[184:185],v[182:183],-2.0,v[184:185] op_sel_hi:[1,0,1]
v_cvt_pk_bf16_f32 v48,v176,v177
v_cvt_pk_bf16_f32 v52,v178,v179
v_cvt_pk_bf16_f32 v56,v188,v189
v_cvt_pk_bf16_f32 v60,v180,v181
v_cvt_pk_bf16_f32 v64,v184,v185
v_cvt_pk_bf16_f32 v68,v186,v187
v_lshlrev_b32 v180,16,v57
v_and_b32 v181,s42,v57
v_lshlrev_b32 v176,16,v49
v_and_b32 v177,s42,v49
v_lshlrev_b32 v178,16,v53
v_and_b32 v179,s42,v53
v_lshlrev_b32 v186,16,v69
v_and_b32 v187,s42,v69
v_lshlrev_b32 v184,16,v65
v_and_b32 v185,s42,v65
v_lshlrev_b32 v182,16,v61
v_and_b32 v183,s42,v61
v_pk_fma_f32 v[176:177],v[180:181],s[42:43],v[176:177] op_sel:[0,1,0] op_sel_hi:[1,1,1]
v_pk_fma_f32 v[186:187],v[178:179],4.0,v[186:187] op_sel_hi:[1,0,1]
v_pk_fma_f32 v[188:189],v[180:181],-4.0,v[184:185] op_sel_hi:[1,0,1]
v_pk_fma_f32 v[176:177],v[184:185],s[44:45],v[176:177] op_sel:[0,1,0] op_sel_hi:[1,1,1]
v_pk_fma_f32 v[186:187],v[182:183],s[40:41],v[186:187] op_sel:[0,1,0] op_sel_hi:[1,1,1]
v_pk_add_f32 v[184:185],v[184:185],v[180:181] neg_lo:[0,1] neg_hi:[0,1]
v_pk_fma_f32 v[180:181],v[178:179],-4.0,v[182:183] op_sel_hi:[1,0,1]
v_pk_add_f32 v[182:183],v[182:183],v[178:179] neg_lo:[0,1] neg_hi:[0,1]
v_pk_add_f32 v[178:179],v[188:189],v[180:181]
v_pk_add_f32 v[188:189],v[188:189],v[180:181] neg_lo:[0,1] neg_hi:[0,1]
v_pk_fma_f32 v[180:181],v[182:183],2.0,v[184:185] op_sel_hi:[1,0,1]
v_pk_fma_f32 v[184:185],v[182:183],-2.0,v[184:185] op_sel_hi:[1,0,1]
v_cvt_pk_bf16_f32 v49,v176,v177
v_cvt_pk_bf16_f32 v53,v178,v179
v_cvt_pk_bf16_f32 v57,v188,v189
v_cvt_pk_bf16_f32 v61,v180,v181
v_cvt_pk_bf16_f32 v65,v184,v185
v_cvt_pk_bf16_f32 v69,v186,v187
v_lshlrev_b32 v180,16,v58
v_and_b32 v181,s42,v58
v_lshlrev_b32 v176,16,v50
v_and_b32 v177,s42,v50
v_lshlrev_b32 v178,16,v54
v_and_b32 v179,s42,v54
v_lshlrev_b32 v186,16,v70
v_and_b32 v187,s42,v70
v_lshlrev_b32 v184,16,v66
v_and_b32 v185,s42,v66
v_lshlrev_b32 v182,16,v62
v_and_b32 v183,s42,v62
v_pk_fma_f32 v[176:177],v[180:181],s[42:43],v[176:177] op_sel:[0,1,0] op_sel_hi:[1,1,1]
v_pk_fma_f32 v[186:187],v[178:179],4.0,v[186:187] op_sel_hi:[1,0,1]
v_pk_fma_f32 v[188:189],v[180:181],-4.0,v[184:185] op_sel_hi:[1,0,1]
v_pk_fma_f32 v[176:177],v[184:185],s[44:45],v[176:177] op_sel:[0,1,0] op_sel_hi:[1,1,1]
v_pk_fma_f32 v[186:187],v[182:183],s[40:41],v[186:187] op_sel:[0,1,0] op_sel_hi:[1,1,1]
v_pk_add_f32 v[184:185],v[184:185],v[180:181] neg_lo:[0,1] neg_hi:[0,1]
v_pk_fma_f32 v[180:181],v[178:179],-4.0,v[182:183] op_sel_hi:[1,0,1]
v_pk_add_f32 v[182:183],v[182:183],v[178:179] neg_lo:[0,1] neg_hi:[0,1]
v_pk_add_f32 v[178:179],v[188:189],v[180:181]
v_pk_add_f32 v[188:189],v[188:189],v[180:181] neg_lo:[0,1] neg_hi:[0,1]
v_pk_fma_f32 v[180:181],v[182:183],2.0,v[184:185] op_sel_hi:[1,0,1]
v_pk_fma_f32 v[184:185],v[182:183],-2.0,v[184:185] op_sel_hi:[1,0,1]
v_cvt_pk_bf16_f32 v50,v176,v177
v_cvt_pk_bf16_f32 v54,v178,v179
v_cvt_pk_bf16_f32 v58,v188,v189
v_cvt_pk_bf16_f32 v62,v180,v181
v_cvt_pk_bf16_f32 v66,v184,v185
v_cvt_pk_bf16_f32 v70,v186,v187
v_lshlrev_b32 v180,16,v59
v_and_b32 v181,s42,v59
v_lshlrev_b32 v176,16,v51
v_and_b32 v177,s42,v51
v_lshlrev_b32 v178,16,v55
v_and_b32 v179,s42,v55
v_lshlrev_b32 v186,16,v71
v_and_b32 v187,s42,v71
v_lshlrev_b32 v184,16,v67
v_and_b32 v185,s42,v67
v_lshlrev_b32 v182,16,v63
v_and_b32 v183,s42,v63
v_pk_fma_f32 v[176:177],v[180:181],s[42:43],v[176:177] op_sel:[0,1,0] op_sel_hi:[1,1,1]
v_pk_fma_f32 v[186:187],v[178:179],4.0,v[186:187] op_sel_hi:[1,0,1]
v_pk_fma_f32 v[188:189],v[180:181],-4.0,v[184:185] op_sel_hi:[1,0,1]
v_pk_fma_f32 v[176:177],v[184:185],s[44:45],v[176:177] op_sel:[0,1,0] op_sel_hi:[1,1,1]
v_pk_fma_f32 v[186:187],v[182:183],s[40:41],v[186:187] op_sel:[0,1,0] op_sel_hi:[1,1,1]
v_pk_add_f32 v[184:185],v[184:185],v[180:181] neg_lo:[0,1] neg_hi:[0,1]
v_pk_fma_f32 v[180:181],v[178:179],-4.0,v[182:183] op_sel_hi:[1,0,1]
v_pk_add_f32 v[182:183],v[182:183],v[178:179] neg_lo:[0,1] neg_hi:[0,1]
v_pk_add_f32 v[178:179],v[188:189],v[180:181]
v_pk_add_f32 v[188:189],v[188:189],v[180:181] neg_lo:[0,1] neg_hi:[0,1]
v_pk_fma_f32 v[180:181],v[182:183],2.0,v[184:185] op_sel_hi:[1,0,1]
v_pk_fma_f32 v[184:185],v[182:183],-2.0,v[184:185] op_sel_hi:[1,0,1]
v_cvt_pk_bf16_f32 v51,v176,v177
v_cvt_pk_bf16_f32 v55,v178,v179
v_cvt_pk_bf16_f32 v59,v188,v189
v_cvt_pk_bf16_f32 v63,v180,v181
v_cvt_pk_bf16_f32 v67,v184,v185
v_cvt_pk_bf16_f32 v71,v186,v187
ds_write_b128 v172,v[48:51] offset:1024
ds_write_b128 v171,v[52:55] offset:18432
ds_write_b128 v171,v[56:59] offset:27136
ds_write_b128 v171,v[60:63] offset:35840
ds_write_b128 v171,v[64:67] offset:44544
ds_write_b128 v172,v[68:71] offset:9728
s_waitcnt vmcnt(11)
v_lshlrev_b32 v180,16,v80
v_and_b32 v181,s42,v80
s_waitcnt vmcnt(10)
v_lshlrev_b32 v176,16,v72
v_and_b32 v177,s42,v72
s_waitcnt vmcnt(9)
v_lshlrev_b32 v178,16,v76
v_and_b32 v179,s42,v76
s_waitcnt vmcnt(8)
v_lshlrev_b32 v186,16,v92
v_and_b32 v187,s42,v92
s_waitcnt vmcnt(7)
v_lshlrev_b32 v184,16,v88
v_and_b32 v185,s42,v88
s_waitcnt vmcnt(6)
v_lshlrev_b32 v182,16,v84
v_and_b32 v183,s42,v84
v_pk_fma_f32 v[176:177],v[180:181],s[42:43],v[176:177] op_sel:[0,1,0] op_sel_hi:[1,1,1]
v_pk_fma_f32 v[186:187],v[178:179],4.0,v[186:187] op_sel_hi:[1,0,1]
v_pk_fma_f32 v[188:189],v[180:181],-4.0,v[184:185] op_sel_hi:[1,0,1]
v_pk_fma_f32 v[176:177],v[184:185],s[44:45],v[176:177] op_sel:[0,1,0] op_sel_hi:[1,1,1]
v_pk_fma_f32 v[186:187],v[182:183],s[40:41],v[186:187] op_sel:[0,1,0] op_sel_hi:[1,1,1]
v_pk_add_f32 v[184:185],v[184:185],v[180:181] neg_lo:[0,1] neg_hi:[0,1]
v_pk_fma_f32 v[180:181],v[178:179],-4.0,v[182:183] op_sel_hi:[1,0,1]
v_pk_add_f32 v[182:183],v[182:183],v[178:179] neg_lo:[0,1] neg_hi:[0,1]
v_pk_add_f32 v[178:179],v[188:189],v[180:181]
v_pk_add_f32 v[188:189],v[188:189],v[180:181] neg_lo:[0,1] neg_hi:[0,1]
v_pk_fma_f32 v[180:181],v[182:183],2.0,v[184:185] op_sel_hi:[1,0,1]
v_pk_fma_f32 v[184:185],v[182:183],-2.0,v[184:185] op_sel_hi:[1,0,1]
v_cvt_pk_bf16_f32 v72,v176,v177
v_cvt_pk_bf16_f32 v76,v178,v179
v_cvt_pk_bf16_f32 v80,v188,v189
v_cvt_pk_bf16_f32 v84,v180,v181
v_cvt_pk_bf16_f32 v88,v184,v185
v_cvt_pk_bf16_f32 v92,v186,v187
v_lshlrev_b32 v180,16,v81
v_and_b32 v181,s42,v81
v_lshlrev_b32 v176,16,v73
v_and_b32 v177,s42,v73
v_lshlrev_b32 v178,16,v77
v_and_b32 v179,s42,v77
v_lshlrev_b32 v186,16,v93
v_and_b32 v187,s42,v93
v_lshlrev_b32 v184,16,v89
v_and_b32 v185,s42,v89
v_lshlrev_b32 v182,16,v85
v_and_b32 v183,s42,v85
v_pk_fma_f32 v[176:177],v[180:181],s[42:43],v[176:177] op_sel:[0,1,0] op_sel_hi:[1,1,1]
v_pk_fma_f32 v[186:187],v[178:179],4.0,v[186:187] op_sel_hi:[1,0,1]
v_pk_fma_f32 v[188:189],v[180:181],-4.0,v[184:185] op_sel_hi:[1,0,1]
v_pk_fma_f32 v[176:177],v[184:185],s[44:45],v[176:177] op_sel:[0,1,0] op_sel_hi:[1,1,1]
v_pk_fma_f32 v[186:187],v[182:183],s[40:41],v[186:187] op_sel:[0,1,0] op_sel_hi:[1,1,1]
v_pk_add_f32 v[184:185],v[184:185],v[180:181] neg_lo:[0,1] neg_hi:[0,1]
v_pk_fma_f32 v[180:181],v[178:179],-4.0,v[182:183] op_sel_hi:[1,0,1]
v_pk_add_f32 v[182:183],v[182:183],v[178:179] neg_lo:[0,1] neg_hi:[0,1]
v_pk_add_f32 v[178:179],v[188:189],v[180:181]
v_pk_add_f32 v[188:189],v[188:189],v[180:181] neg_lo:[0,1] neg_hi:[0,1]
v_pk_fma_f32 v[180:181],v[182:183],2.0,v[184:185] op_sel_hi:[1,0,1]
v_pk_fma_f32 v[184:185],v[182:183],-2.0,v[184:185] op_sel_hi:[1,0,1]
v_cvt_pk_bf16_f32 v73,v176,v177
v_cvt_pk_bf16_f32 v77,v178,v179
v_cvt_pk_bf16_f32 v81,v188,v189
v_cvt_pk_bf16_f32 v85,v180,v181
v_cvt_pk_bf16_f32 v89,v184,v185
v_cvt_pk_bf16_f32 v93,v186,v187
v_lshlrev_b32 v180,16,v82
v_and_b32 v181,s42,v82
v_lshlrev_b32 v176,16,v74
v_and_b32 v177,s42,v74
v_lshlrev_b32 v178,16,v78
v_and_b32 v179,s42,v78
v_lshlrev_b32 v186,16,v94
v_and_b32 v187,s42,v94
v_lshlrev_b32 v184,16,v90
v_and_b32 v185,s42,v90
v_lshlrev_b32 v182,16,v86
v_and_b32 v183,s42,v86
v_pk_fma_f32 v[176:177],v[180:181],s[42:43],v[176:177] op_sel:[0,1,0] op_sel_hi:[1,1,1]
v_pk_fma_f32 v[186:187],v[178:179],4.0,v[186:187] op_sel_hi:[1,0,1]
v_pk_fma_f32 v[188:189],v[180:181],-4.0,v[184:185] op_sel_hi:[1,0,1]
v_pk_fma_f32 v[176:177],v[184:185],s[44:45],v[176:177] op_sel:[0,1,0] op_sel_hi:[1,1,1]
v_pk_fma_f32 v[186:187],v[182:183],s[40:41],v[186:187] op_sel:[0,1,0] op_sel_hi:[1,1,1]
v_pk_add_f32 v[184:185],v[184:185],v[180:181] neg_lo:[0,1] neg_hi:[0,1]
v_pk_fma_f32 v[180:181],v[178:179],-4.0,v[182:183] op_sel_hi:[1,0,1]
v_pk_add_f32 v[182:183],v[182:183],v[178:179] neg_lo:[0,1] neg_hi:[0,1]
v_pk_add_f32 v[178:179],v[188:189],v[180:181]
v_pk_add_f32 v[188:189],v[188:189],v[180:181] neg_lo:[0,1] neg_hi:[0,1]
v_pk_fma_f32 v[180:181],v[182:183],2.0,v[184:185] op_sel_hi:[1,0,1]
v_pk_fma_f32 v[184:185],v[182:183],-2.0,v[184:185] op_sel_hi:[1,0,1]
v_cvt_pk_bf16_f32 v74,v176,v177
v_cvt_pk_bf16_f32 v78,v178,v179
v_cvt_pk_bf16_f32 v82,v188,v189
v_cvt_pk_bf16_f32 v86,v180,v181
v_cvt_pk_bf16_f32 v90,v184,v185
v_cvt_pk_bf16_f32 v94,v186,v187
v_lshlrev_b32 v180,16,v83
v_and_b32 v181,s42,v83
v_lshlrev_b32 v176,16,v75
v_and_b32 v177,s42,v75
v_lshlrev_b32 v178,16,v79
v_and_b32 v179,s42,v79
v_lshlrev_b32 v186,16,v95
v_and_b32 v187,s42,v95
v_lshlrev_b32 v184,16,v91
v_and_b32 v185,s42,v91
v_lshlrev_b32 v182,16,v87
v_and_b32 v183,s42,v87
v_pk_fma_f32 v[176:177],v[180:181],s[42:43],v[176:177] op_sel:[0,1,0] op_sel_hi:[1,1,1]
v_pk_fma_f32 v[186:187],v[178:179],4.0,v[186:187] op_sel_hi:[1,0,1]
v_pk_fma_f32 v[188:189],v[180:181],-4.0,v[184:185] op_sel_hi:[1,0,1]
v_pk_fma_f32 v[176:177],v[184:185],s[44:45],v[176:177] op_sel:[0,1,0] op_sel_hi:[1,1,1]
v_pk_fma_f32 v[186:187],v[182:183],s[40:41],v[186:187] op_sel:[0,1,0] op_sel_hi:[1,1,1]
v_pk_add_f32 v[184:185],v[184:185],v[180:181] neg_lo:[0,1] neg_hi:[0,1]
v_pk_fma_f32 v[180:181],v[178:179],-4.0,v[182:183] op_sel_hi:[1,0,1]
v_pk_add_f32 v[182:183],v[182:183],v[178:179] neg_lo:[0,1] neg_hi:[0,1]
v_pk_add_f32 v[178:179],v[188:189],v[180:181]
v_pk_add_f32 v[188:189],v[188:189],v[180:181] neg_lo:[0,1] neg_hi:[0,1]
v_pk_fma_f32 v[180:181],v[182:183],2.0,v[184:185] op_sel_hi:[1,0,1]
v_pk_fma_f32 v[184:185],v[182:183],-2.0,v[184:185] op_sel_hi:[1,0,1]
v_cvt_pk_bf16_f32 v75,v176,v177
v_cvt_pk_bf16_f32 v79,v178,v179
v_cvt_pk_bf16_f32 v83,v188,v189
v_cvt_pk_bf16_f32 v87,v180,v181
v_cvt_pk_bf16_f32 v91,v184,v185
v_cvt_pk_bf16_f32 v95,v186,v187
ds_write_b128 v172,v[72:75] offset:1536
ds_write_b128 v171,v[76:79] offset:18944
ds_write_b128 v171,v[80:83] offset:27648
ds_write_b128 v171,v[84:87] offset:36352
ds_write_b128 v171,v[88:91] offset:45056
ds_write_b128 v172,v[92:95] offset:10240
s_waitcnt vmcnt(3)
v_lshlrev_b32 v180,16,v98
v_and_b32 v181,s42,v98
v_lshlrev_b32 v176,16,v96
v_and_b32 v177,s42,v96
v_lshlrev_b32 v178,16,v97
v_and_b32 v179,s42,v97
s_waitcnt vmcnt(0)
v_lshlrev_b32 v186,16,v101
v_and_b32 v187,s42,v101
v_lshlrev_b32 v184,16,v100
v_and_b32 v185,s42,v100
v_lshlrev_b32 v182,16,v99
v_and_b32 v183,s42,v99
v_pk_fma_f32 v[176:177],v[180:181],s[42:43],v[176:177] op_sel:[0,1,0] op_sel_hi:[1,1,1]
v_pk_fma_f32 v[186:187],v[178:179],4.0,v[186:187] op_sel_hi:[1,0,1]
v_pk_fma_f32 v[188:189],v[180:181],-4.0,v[184:185] op_sel_hi:[1,0,1]
v_pk_fma_f32 v[176:177],v[184:185],s[44:45],v[176:177] op_sel:[0,1,0] op_sel_hi:[1,1,1]
v_pk_fma_f32 v[186:187],v[182:183],s[40:41],v[186:187] op_sel:[0,1,0] op_sel_hi:[1,1,1]
v_pk_add_f32 v[184:185],v[184:185],v[180:181] neg_lo:[0,1] neg_hi:[0,1]
v_pk_fma_f32 v[180:181],v[178:179],-4.0,v[182:183] op_sel_hi:[1,0,1]
v_pk_add_f32 v[182:183],v[182:183],v[178:179] neg_lo:[0,1] neg_hi:[0,1]
v_pk_add_f32 v[178:179],v[188:189],v[180:181]
v_pk_add_f32 v[188:189],v[188:189],v[180:181] neg_lo:[0,1] neg_hi:[0,1]
v_pk_fma_f32 v[180:181],v[182:183],2.0,v[184:185] op_sel_hi:[1,0,1]
v_pk_fma_f32 v[184:185],v[182:183],-2.0,v[184:185] op_sel_hi:[1,0,1]
v_cvt_pk_bf16_f32 v96,v176,v177
v_cvt_pk_bf16_f32 v97,v178,v179
v_cvt_pk_bf16_f32 v98,v188,v189
v_cvt_pk_bf16_f32 v99,v180,v181
v_cvt_pk_bf16_f32 v100,v184,v185
v_cvt_pk_bf16_f32 v101,v186,v187
ds_write_b32 v174,v96 offset:0
ds_write_b32 v173,v97 offset:17408
ds_write_b32 v173,v98 offset:26112
ds_write_b32 v173,v99 offset:34816
ds_write_b32 v173,v100 offset:43520
ds_write_b32 v174,v101 offset:8704
s_waitcnt lgkmcnt(0)
s_barrier
ds_read_b128 a[192:195],v248 offset:17408
ds_read_b128 a[196:199],v249 offset:17408
ds_read_b128 a[200:203],v248 offset:17920
ds_read_b128 a[204:207],v249 offset:17920
v_and_b32 v165,1,v164
v_lshlrev_b32 v165,2,v165
s_mov_b32 s84,0
L_poll:
global_load_dword v166,v165,s[52:53] offset:128 sc1
s_add_u32 s84,s84,1
s_waitcnt vmcnt(0)
v_cmp_eq_u32 vcc,0,v166
s_cmp_gt_u32 s84,0x4000
s_cbranch_scc1 L_fallback
s_cbranch_vccnz L_poll
L_uready:
s_add_u32 s46,s72,9216
buffer_load_dwordx4 a[96:99],v250,s[20:23],s46 offen offset:0 sc1
buffer_load_dwordx4 a[100:103],v250,s[20:23],s46 offen offset:1024 sc1
buffer_load_dwordx4 a[104:107],v250,s[20:23],s46 offen offset:2048 sc1
s_add_u32 s47,s72,12288
buffer_load_dwordx4 a[108:111],v250,s[20:23],s47 offen offset:0 sc1
buffer_load_dwordx4 a[112:115],v250,s[20:23],s47 offen offset:1024 sc1
buffer_load_dwordx4 a[116:119],v250,s[20:23],s47 offen offset:2048 sc1
s_add_u32 s48,s72,15360
buffer_load_dwordx4 a[120:123],v250,s[20:23],s48 offen offset:0 sc1
buffer_load_dwordx4 a[124:127],v250,s[20:23],s48 offen offset:1024 sc1
buffer_load_dwordx4 a[128:131],v250,s[20:23],s48 offen offset:2048 sc1
s_lshr_b32 s85,s2,3
s_mul_i32 s85,s85,1152
s_add_u32 s85,s85,9216
s_mov_b32 s88,s12
s_mov_b32 s89,s13
s_mov_b32 s90,100860288
s_mov_b32 s91,0x20000
s_cmp_eq_u32 s49,0
s_cselect_b32 s86,15,0
s_mov_b32 s87,s86
s_getpc_b64 s[62:63]
L_pc2:
s_sub_u32 s62,s62,L_pc2-L_pc
s_subb_u32 s63,s63,0
s_lshr_b32 s61,s2,3
s_waitcnt vmcnt(8) lgkmcnt(3)
M a[0:3],a[96:99],a[192:195],0
s_waitcnt vmcnt(7) lgkmcnt(2)
s_add_u32 s46,s72,18432
buffer_load_dwordx4 a[132:135],v250,s[20:23],s46 offen offset:0 sc1
M a[0:3],a[100:103],a[196:199],a[0:3]
s_waitcnt vmcnt(7) lgkmcnt(1)
ds_read_b128 a[208:211],v248 offset:18432
ds_read_b128 a[212:215],v249 offset:18432
M a[0:3],a[104:107],a[200:203],a[0:3]
s_waitcnt lgkmcnt(2)
buffer_load_dwordx4 a[136:139],v250,s[20:23],s46 offen offset:1024 sc1
M a[4:7],a[104:107],a[204:207],0
M a[4:7],a[100:103],a[200:203],a[4:7]
M a[4:7],a[96:99],a[196:199],a[4:7]
M a[8:11],a[96:99],a[200:203],0
buffer_load_dwordx4 a[140:143],v250,s[20:23],s46 offen offset:2048 sc1
M a[8:11],a[100:103],a[204:207],a[8:11]
s_waitcnt lgkmcnt(1)
s_add_u32 s47,s72,21504
ds_read_b128 a[216:219],v248 offset:18944
ds_read_b128 a[220:223],v249 offset:18944
M a[8:11],a[104:107],a[208:211],a[8:11]
s_waitcnt lgkmcnt(2)
M a[12:15],a[104:107],a[212:215],0
M a[12:15],a[100:103],a[208:211],a[12:15]
buffer_load_dwordx4 a[164:167],v250,s[20:23],s47 offen offset:0 sc1
M a[12:15],a[96:99],a[204:207],a[12:15]
M a[16:19],a[96:99],a[208:211],0
ds_read_b128 a[224:227],v249 offset:19456
M a[16:19],a[100:103],a[212:215],a[16:19]
s_waitcnt lgkmcnt(2)
ds_read_b128 a[228:231],v248 offset:19456
M a[16:19],a[104:107],a[216:219],a[16:19]
s_waitcnt lgkmcnt(2)
buffer_load_dwordx4 a[160:163],v250,s[20:23],s47 offen offset:1024 sc1
M a[20:23],a[104:107],a[220:223],0
M a[20:23],a[100:103],a[216:219],a[20:23]
M a[20:23],a[96:99],a[212:215],a[20:23]
M a[24:27],a[96:99],a[216:219],0
buffer_load_dwordx4 a[168:171],v250,s[20:23],s47 offen offset:2048 sc1
M a[24:27],a[100:103],a[220:223],a[24:27]
s_waitcnt lgkmcnt(1)
s_add_u32 s48,s72,24576
M a[24:27],a[104:107],a[224:227],a[24:27]
s_waitcnt lgkmcnt(0)
M a[28:31],a[104:107],a[228:231],0
M a[28:31],a[100:103],a[224:227],a[28:31]
buffer_load_dwordx4 v[4:7],v250,s[20:23],s48 offen offset:0 sc1
M a[28:31],a[96:99],a[220:223],a[28:31]
s_waitcnt vmcnt(12)
M a[32:35],a[108:111],a[192:195],0
s_waitcnt vmcnt(11)
M a[32:35],a[112:115],a[196:199],a[32:35]
s_waitcnt vmcnt(10)
M a[32:35],a[116:119],a[200:203],a[32:35]
buffer_load_dwordx4 v[0:3],v250,s[20:23],s48 offen offset:1024 sc1
M a[36:39],a[116:119],a[204:207],0
M a[36:39],a[112:115],a[200:203],a[36:39]
M a[36:39],a[108:111],a[196:199],a[36:39]
M a[40:43],a[108:111],a[200:203],0
buffer_load_dwordx4 v[8:11],v250,s[20:23],s48 offen offset:2048 sc1
M a[40:43],a[112:115],a[204:207],a[40:43]
s_add_u32 s46,s72,27648
M a[40:43],a[116:119],a[208:211],a[40:43]
M a[44:47],a[116:119],a[212:215],0
M a[44:47],a[112:115],a[208:211],a[44:47]
buffer_load_dwordx4 v[36:39],v250,s[20:23],s46 offen offset:0 sc1
M a[44:47],a[108:111],a[204:207],a[44:47]
s_add_u32 s31,s73,s85
M a[48:51],a[108:111],a[208:211],0
M a[48:51],a[112:115],a[212:215],a[48:51]
M a[48:51],a[116:119],a[216:219],a[48:51]
buffer_load_dword v32,v250,s[20:23],s31 offen offset:0 sc1
M a[52:55],a[116:119],a[220:223],0
M a[52:55],a[112:115],a[216:219],a[52:55]
M a[52:55],a[108:111],a[212:215],a[52:55]
M a[56:59],a[108:111],a[216:219],0
buffer_load_dword v32,v250,s[20:23],s31 offen offset:128 sc1
M a[56:59],a[112:115],a[220:223],a[56:59]
M a[56:59],a[116:119],a[224:227],a[56:59]
M a[60:63],a[116:119],a[228:231],0
M a[60:63],a[112:115],a[224:227],a[60:63]
buffer_load_dwordx4 v[32:35],v250,s[20:23],s46 offen offset:1024 sc1
M a[60:63],a[108:111],a[220:223],a[60:63]
s_waitcnt vmcnt(15)
M a[64:67],a[120:123],a[192:195],0
s_waitcnt vmcnt(14)
M a[64:67],a[124:127],a[196:199],a[64:67]
s_waitcnt vmcnt(13)
M a[64:67],a[128:131],a[200:203],a[64:67]
buffer_load_dwordx4 v[40:43],v250,s[20:23],s46 offen offset:2048 sc1
M a[68:71],a[128:131],a[204:207],0
s_add_u32 s47,s72,30720
M a[68:71],a[124:127],a[200:203],a[68:71]
M a[68:71],a[120:123],a[196:199],a[68:71]
M a[72:75],a[120:123],a[200:203],0
buffer_load_dwordx4 v[68:71],v250,s[20:23],s47 offen offset:0 sc1
M a[72:75],a[124:127],a[204:207],a[72:75]
M a[72:75],a[128:131],a[208:211],a[72:75]
M a[76:79],a[128:131],a[212:215],0
M a[76:79],a[124:127],a[208:211],a[76:79]
buffer_load_dwordx4 v[64:67],v250,s[20:23],s47 offen offset:1024 sc1
M a[76:79],a[120:123],a[204:207],a[76:79]
M a[80:83],a[120:123],a[208:211],0
M a[80:83],a[124:127],a[212:215],a[80:83]
M a[80:83],a[128:131],a[216:219],a[80:83]
buffer_load_dwordx4 v[72:75],v250,s[20:23],s47 offen offset:2048 sc1
M a[84:87],a[128:131],a[220:223],0
s_add_u32 s48,s72,33792
M a[84:87],a[124:127],a[216:219],a[84:87]
ds_read_b128 a[232:235],v248 offset:26112
M a[84:87],a[120:123],a[212:215],a[84:87]
ds_read_b128 a[236:239],v249 offset:26112
M a[88:91],a[120:123],a[216:219],0
buffer_load_dwordx4 v[100:103],v250,s[20:23],s48 offen offset:0 sc1
M a[88:91],a[124:127],a[220:223],a[88:91]
ds_read_b128 a[240:243],v248 offset:26624
ds_read_b128 a[244:247],v249 offset:26624
M a[88:91],a[128:131],a[224:227],a[88:91]
M a[92:95],a[128:131],a[228:231],0
M a[92:95],a[124:127],a[224:227],a[92:95]
s_add_u32 s28,s68,0
buffer_load_dwordx4 v[96:99],v250,s[20:23],s48 offen offset:1024 sc1
M a[92:95],a[120:123],a[220:223],a[92:95]
s_waitcnt vmcnt(18) lgkmcnt(3)
s_mov_b64 exec,s[86:87]
v_xor_b32 v245,0x80000000,v245
v_xor_b32 v251,0x80000000,v251
s_mov_b64 exec,-1
M a[96:99],a[132:135],a[232:235],0
s_waitcnt vmcnt(17) lgkmcnt(2)
ds_read_b128 a[248:251],v248 offset:27136
M a[96:99],a[136:139],a[236:239],a[96:99]
s_waitcnt vmcnt(16) lgkmcnt(2)
ds_read_b128 a[252:255],v249 offset:27136
M a[96:99],a[140:143],a[240:243],a[96:99]
s_waitcnt lgkmcnt(2)
buffer_load_dwordx4 v[104:107],v250,s[20:23],s48 offen offset:2048 sc1
M a[100:103],a[140:143],a[244:247],0
s_add_u32 s46,s72,36864
M a[100:103],a[136:139],a[240:243],a[100:103]
M a[100:103],a[132:135],a[236:239],a[100:103]
M a[104:107],a[132:135],a[240:243],0
buffer_load_dwordx4 v[132:135],v250,s[20:23],s46 offen offset:0 sc1
M a[104:107],a[136:139],a[244:247],a[104:107]
s_waitcnt lgkmcnt(1)
ds_read_b128 v[216:219],v248 offset:27648
ds_read_b128 v[220:223],v249 offset:27648
M a[104:107],a[140:143],a[248:251],a[104:107]
s_waitcnt lgkmcnt(2)
M a[108:111],a[140:143],a[252:255],0
M a[108:111],a[136:139],a[248:251],a[108:111]
buffer_load_dwordx4 v[128:131],v250,s[20:23],s46 offen offset:1024 sc1
M a[108:111],a[132:135],a[244:247],a[108:111]
M a[112:115],a[132:135],a[248:251],0
ds_read_b128 v[224:227],v249 offset:28160
M a[112:115],a[136:139],a[252:255],a[112:115]
s_waitcnt lgkmcnt(2)
ds_read_b128 v[228:231],v248 offset:28160
M a[112:115],a[140:143],v[216:219],a[112:115]
s_waitcnt lgkmcnt(2)
buffer_load_dwordx4 v[136:139],v250,s[20:23],s46 offen offset:2048 sc1
M a[116:119],a[140:143],v[220:223],0
M a[116:119],a[136:139],v[216:219],a[116:119]
M a[116:119],a[132:135],a[252:255],a[116:119]
M a[120:123],a[132:135],v[216:219],0
buffer_load_dwordx4 v[192:195],v251,s[88:91],s28 offen offset:0
M a[120:123],a[136:139],v[220:223],a[120:123]
s_waitcnt lgkmcnt(1)
M a[120:123],a[140:143],v[224:227],a[120:123]
s_waitcnt lgkmcnt(0)
M a[124:127],a[140:143],v[228:231],0
M a[124:127],a[136:139],v[224:227],a[124:127]
buffer_load_dwordx4 v[196:199],v245,s[8:11],s28 offen offset:0
M a[124:127],a[132:135],v[220:223],a[124:127]
s_waitcnt vmcnt(21)
M a[128:131],a[164:167],a[232:235],0
s_waitcnt vmcnt(20)
M a[128:131],a[160:163],a[236:239],a[128:131]
s_waitcnt vmcnt(19)
M a[128:131],a[168:171],a[240:243],a[128:131]
buffer_load_dwordx4 v[200:203],v245,s[8:11],s28 offen offset:768
M a[132:135],a[168:171],a[244:247],0
s_mov_b64 exec,s[86:87]
v_xor_b32 v245,0x80000000,v245
v_xor_b32 v251,0x80000000,v251
s_mov_b64 exec,-1
M a[132:135],a[160:163],a[240:243],a[132:135]
M a[132:135],a[164:167],a[236:239],a[132:135]
M a[136:139],a[164:167],a[240:243],0
M a[136:139],a[160:163],a[244:247],a[136:139]
M a[136:139],a[168:171],a[248:251],a[136:139]
M a[140:143],a[168:171],a[252:255],0
M a[140:143],a[160:163],a[248:251],a[140:143]
M a[140:143],a[164:167],a[244:247],a[140:143]
M a[144:147],a[164:167],a[248:251],0
M a[144:147],a[160:163],a[252:255],a[144:147]
M a[144:147],a[168:171],v[216:219],a[144:147]
M a[148:151],a[168:171],v[220:223],0
M a[148:151],a[160:163],v[216:219],a[148:151]
M a[148:151],a[164:167],a[252:255],a[148:151]
M a[152:155],a[164:167],v[216:219],0
M a[152:155],a[160:163],v[220:223],a[152:155]
M a[152:155],a[168:171],v[224:227],a[152:155]
M a[156:159],a[168:171],v[228:231],0
M a[156:159],a[160:163],v[224:227],a[156:159]
s_add_u32 s47,s72,39936
M a[156:159],a[164:167],v[220:223],a[156:159]
s_waitcnt vmcnt(19)
M a[160:163],v[4:7],a[232:235],0
s_waitcnt vmcnt(18)
M a[160:163],v[0:3],a[236:239],a[160:163]
s_waitcnt vmcnt(17)
M a[160:163],v[8:11],a[240:243],a[160:163]
M a[164:167],v[8:11],a[244:247],0
M a[164:167],v[0:3],a[240:243],a[164:167]
buffer_load_dwordx4 v[164:167],v250,s[20:23],s47 offen offset:0 sc1
M a[164:167],v[4:7],a[236:239],a[164:167]
M a[168:171],v[4:7],a[240:243],0
buffer_load_dwordx4 v[160:163],v250,s[20:23],s47 offen offset:1024 sc1
M a[168:171],v[0:3],a[244:247],a[168:171]
M a[168:171],v[8:11],a[248:251],a[168:171]
M a[172:175],v[8:11],a[252:255],0
M a[172:175],v[0:3],a[248:251],a[172:175]
buffer_load_dwordx4 v[168:171],v250,s[20:23],s47 offen offset:2048 sc1
M a[172:175],v[4:7],a[244:247],a[172:175]
s_add_u32 s48,s72,43008
M a[176:179],v[4:7],a[248:251],0
M a[176:179],v[0:3],a[252:255],a[176:179]
M a[176:179],v[8:11],v[216:219],a[176:179]
buffer_load_dwordx4 a[192:195],v250,s[20:23],s48 offen offset:0 sc1
M a[180:183],v[8:11],v[220:223],0
M a[180:183],v[0:3],v[216:219],a[180:183]
ds_read_b128 a[204:207],v248 offset:34816
M a[180:183],v[4:7],a[252:255],a[180:183]
ds_read_b128 a[208:211],v249 offset:34816
M a[184:187],v[4:7],v[216:219],0
buffer_load_dwordx4 a[196:199],v250,s[20:23],s48 offen offset:1024 sc1
M a[184:187],v[0:3],v[220:223],a[184:187]
ds_read_b128 a[216:219],v248 offset:35328
ds_read_b128 a[228:231],v249 offset:35328
M a[184:187],v[8:11],v[224:227],a[184:187]
M a[188:191],v[8:11],v[228:231],0
M a[188:191],v[0:3],v[224:227],a[188:191]
buffer_load_dwordx4 a[200:203],v250,s[20:23],s48 offen offset:2048 sc1
M a[188:191],v[4:7],v[220:223],a[188:191]
s_waitcnt vmcnt(22) lgkmcnt(3)
s_add_u32 s46,s73,9216
M v[0:3],v[36:39],a[204:207],0
s_waitcnt vmcnt(19) lgkmcnt(2)
ds_read_b128 a[224:227],v248 offset:35840
M v[0:3],v[32:35],a[208:211],v[0:3]
s_waitcnt vmcnt(18) lgkmcnt(2)
ds_read_b128 a[220:223],v249 offset:35840
M v[0:3],v[40:43],a[216:219],v[0:3]
s_waitcnt lgkmcnt(2)
buffer_load_dwordx4 a[212:215],v250,s[20:23],s46 offen offset:0 sc1
M v[4:7],v[40:43],a[228:231],0
M v[4:7],v[32:35],a[216:219],v[4:7]
M v[4:7],v[36:39],a[208:211],v[4:7]
M v[8:11],v[36:39],a[216:219],0
ds_read_b128 a[232:235],v248 offset:36352
M v[8:11],v[32:35],a[228:231],v[8:11]
s_waitcnt lgkmcnt(2)
ds_read_b128 a[236:239],v249 offset:36352
M v[8:11],v[40:43],a[224:227],v[8:11]
s_waitcnt lgkmcnt(2)
M v[12:15],v[40:43],a[220:223],0
M v[12:15],v[32:35],a[224:227],v[12:15]
M v[12:15],v[36:39],a[228:231],v[12:15]
s_add_u32 s28,s68,393216
buffer_load_dwordx4 v[204:207],v251,s[88:91],s28 offen offset:0
M v[16:19],v[36:39],a[224:227],0
ds_read_b128 a[240:243],v249 offset:36864
M v[16:19],v[32:35],a[220:223],v[16:19]
s_waitcnt lgkmcnt(2)
buffer_load_dwordx4 v[208:211],v245,s[8:11],s28 offen offset:0
M v[16:19],v[40:43],a[232:235],v[16:19]
s_waitcnt lgkmcnt(1)
ds_read_b128 a[244:247],v248 offset:36864
M v[20:23],v[40:43],a[236:239],0
M v[20:23],v[32:35],a[232:235],v[20:23]
M v[20:23],v[36:39],a[220:223],v[20:23]
buffer_load_dwordx4 v[212:215],v245,s[8:11],s28 offen offset:768
M v[24:27],v[36:39],a[232:235],0
s_add_u32 s29,s68,0
M v[24:27],v[32:35],a[236:239],v[24:27]
s_waitcnt lgkmcnt(1)
M v[24:27],v[40:43],a[240:243],v[24:27]
s_waitcnt lgkmcnt(0)
M v[28:31],v[40:43],a[244:247],0
buffer_load_short_d16_hi v239,v246,s[12:15],s29 offen offset:0
M v[28:31],v[32:35],a[240:243],v[28:31]
M v[28:31],v[36:39],a[236:239],v[28:31]
s_waitcnt vmcnt(22)
buffer_load_short_d16_hi v240,v246,s[8:11],s29 offen offset:0
M v[32:35],v[68:71],a[204:207],0
s_waitcnt vmcnt(22)
M v[32:35],v[64:67],a[208:211],v[32:35]
s_waitcnt vmcnt(21)
buffer_load_short_d16_hi v241,v246,s[8:11],s29 offen offset:384
M v[32:35],v[72:75],a[216:219],v[32:35]
M v[36:39],v[72:75],a[228:231],0
buffer_load_short_d16_hi v242,v246,s[8:11],s29 offen offset:768
M v[36:39],v[64:67],a[216:219],v[36:39]
M v[36:39],v[68:71],a[208:211],v[36:39]
buffer_load_short_d16_hi v243,v246,s[8:11],s29 offen offset:1152
M v[40:43],v[68:71],a[216:219],0
M v[40:43],v[64:67],a[228:231],v[40:43]
buffer_load_short_d16_hi v244,v246,s[16:19],s29 offen offset:1536
M v[40:43],v[72:75],a[224:227],v[40:43]
M v[44:47],v[72:75],a[220:223],0
M v[44:47],v[64:67],a[224:227],v[44:47]
M v[44:47],v[68:71],a[228:231],v[44:47]
M v[48:51],v[68:71],a[224:227],0
M v[48:51],v[64:67],a[220:223],v[48:51]
M v[48:51],v[72:75],a[232:235],v[48:51]
M v[52:55],v[72:75],a[236:239],0
M v[52:55],v[64:67],a[232:235],v[52:55]
M v[52:55],v[68:71],a[220:223],v[52:55]
M v[56:59],v[68:71],a[232:235],0
M v[56:59],v[64:67],a[236:239],v[56:59]
M v[56:59],v[72:75],a[240:243],v[56:59]
M v[60:63],v[72:75],a[244:247],0
M v[60:63],v[64:67],a[240:243],v[60:63]
M v[60:63],v[68:71],a[236:239],v[60:63]
s_waitcnt vmcnt(24)
M v[64:67],v[100:103],a[204:207],0
s_waitcnt vmcnt(23)
M v[64:67],v[96:99],a[208:211],v[64:67]
s_waitcnt vmcnt(22)
M v[64:67],v[104:107],a[216:219],v[64:67]
M v[68:71],v[104:107],a[228:231],0
M v[68:71],v[96:99],a[216:219],v[68:71]
M v[68:71],v[100:103],a[208:211],v[68:71]
M v[72:75],v[100:103],a[216:219],0
M v[72:75],v[96:99],a[228:231],v[72:75]
M v[72:75],v[104:107],a[224:227],v[72:75]
M v[76:79],v[104:107],a[220:223],0
M v[76:79],v[96:99],a[224:227],v[76:79]
M v[76:79],v[100:103],a[228:231],v[76:79]
M v[80:83],v[100:103],a[224:227],0
M v[80:83],v[96:99],a[220:223],v[80:83]
M v[80:83],v[104:107],a[232:235],v[80:83]
M v[84:87],v[104:107],a[236:239],0
M v[84:87],v[96:99],a[232:235],v[84:87]
ds_read_b128 a[248:251],v248 offset:43520
M v[84:87],v[100:103],a[220:223],v[84:87]
ds_read_b128 a[252:255],v249 offset:43520
M v[88:91],v[100:103],a[232:235],0
ds_read_b128 v[216:219],v248 offset:44032
M v[88:91],v[96:99],a[236:239],v[88:91]
ds_read_b128 v[228:231],v249 offset:44032
M v[88:91],v[104:107],a[240:243],v[88:91]
M v[92:95],v[104:107],a[244:247],0
M v[92:95],v[96:99],a[240:243],v[92:95]
M v[92:95],v[100:103],a[236:239],v[92:95]
s_waitcnt vmcnt(21) lgkmcnt(3)
M v[96:99],v[132:135],a[248:251],0
s_waitcnt vmcnt(20) lgkmcnt(2)
ds_read_b128 v[224:227],v248 offset:44544
M v[96:99],v[128:131],a[252:255],v[96:99]
s_waitcnt vmcnt(19) lgkmcnt(2)
ds_read_b128 v[220:223],v249 offset:44544
M v[96:99],v[136:139],v[216:219],v[96:99]
s_waitcnt lgkmcnt(2)
M v[100:103],v[136:139],v[228:231],0
M v[100:103],v[128:131],v[216:219],v[100:103]
M v[100:103],v[132:135],a[252:255],v[100:103]
M v[104:107],v[132:135],v[216:219],0
ds_read_b128 a[204:207],v248 offset:45056
M v[104:107],v[128:131],v[228:231],v[104:107]
s_waitcnt lgkmcnt(2)
ds_read_b128 a[208:211],v249 offset:45056
M v[104:107],v[136:139],v[224:227],v[104:107]
s_waitcnt lgkmcnt(2)
M v[108:111],v[136:139],v[220:223],0
s_waitcnt vmcnt(17)
v_permlane32_swap_b32 v196,v198
v_permlane32_swap_b32 v192,v194
M v[108:111],v[128:131],v[224:227],v[108:111]
s_waitcnt vmcnt(16)
v_permlane32_swap_b32 v200,v202
v_lshlrev_b32 v234,16,v198
M v[108:111],v[132:135],v[228:231],v[108:111]
v_lshlrev_b32 v232,16,v192
v_lshlrev_b32 v233,16,v196
M v[112:115],v[132:135],v[224:227],0
ds_read_b128 a[216:219],v249 offset:45568
v_lshlrev_b32 v237,16,v194
M v[112:115],v[128:131],v[220:223],v[112:115]
s_waitcnt lgkmcnt(2)
ds_read_b128 a[228:231],v248 offset:45568
v_lshlrev_b32 v236,16,v202
M v[112:115],v[136:139],a[204:207],v[112:115]
s_waitcnt lgkmcnt(2)
v_lshlrev_b32 v235,16,v200
v_fmac_f32 v232,s43,v234
M v[116:119],v[136:139],a[208:211],0
v_fmac_f32 v237,4.0,v233
v_fma_f32 v238,-4.0,v234,v236
M v[116:119],v[128:131],a[204:207],v[116:119]
v_fmac_f32 v232,s45,v236
v_fmac_f32 v237,s41,v235
M v[116:119],v[132:135],v[220:223],v[116:119]
v_sub_f32 v236,v236,v234
v_fma_f32 v234,-4.0,v233,v235
M v[120:123],v[132:135],a[204:207],0
v_sub_f32 v235,v235,v233
v_add_f32 v233,v238,v234
M v[120:123],v[128:131],a[208:211],v[120:123]
s_waitcnt lgkmcnt(1)
v_sub_f32 v238,v238,v234
v_fma_f32 v234,2.0,v235,v236
M v[120:123],v[136:139],a[216:219],v[120:123]
s_waitcnt lgkmcnt(0)
v_fmac_f32 v236,-2.0,v235
v_and_b32 v198,s42,v198
M v[124:127],v[136:139],a[228:231],0
buffer_load_dwordx4 a[224:227],v250,s[20:23],s46 offen offset:1024 sc1
M v[124:127],v[128:131],a[216:219],v[124:127]
v_and_b32 v192,s42,v192
v_and_b32 v196,s42,v196
M v[124:127],v[132:135],a[208:211],v[124:127]
s_waitcnt vmcnt(16)
buffer_load_dwordx4 a[220:223],v250,s[20:23],s46 offen offset:2048 sc1
M v[128:131],v[164:167],a[248:251],0
s_waitcnt vmcnt(16)
s_add_u32 s47,s73,12288
v_and_b32 v194,s42,v194
v_and_b32 v202,s42,v202
M v[128:131],v[160:163],a[252:255],v[128:131]
s_waitcnt vmcnt(15)
v_and_b32 v200,s42,v200
v_fmac_f32 v192,s43,v198
M v[128:131],v[168:171],v[216:219],v[128:131]
v_fmac_f32 v194,4.0,v196
v_fma_f32 v235,-4.0,v198,v202
M v[132:135],v[168:171],v[228:231],0
buffer_load_dwordx4 a[232:235],v250,s[20:23],s47 offen offset:0 sc1
M v[132:135],v[160:163],v[216:219],v[132:135]
v_fmac_f32 v192,s45,v202
v_fmac_f32 v194,s41,v200
M v[132:135],v[164:167],a[252:255],v[132:135]
v_sub_f32 v202,v202,v198
v_fma_f32 v198,-4.0,v196,v200
M v[136:139],v[164:167],v[216:219],0
v_sub_f32 v200,v200,v196
v_add_f32 v196,v235,v198
M v[136:139],v[160:163],v[228:231],v[136:139]
v_sub_f32 v235,v235,v198
v_fma_f32 v198,2.0,v200,v202
M v[136:139],v[168:171],v[224:227],v[136:139]
v_fmac_f32 v202,-2.0,v200
v_cvt_pk_bf16_f32 v192,v232,v192
M v[140:143],v[168:171],v[220:223],0
v_cvt_pk_bf16_f32 v194,v237,v194
v_cvt_pk_bf16_f32 v196,v233,v196
M v[140:143],v[160:163],v[224:227],v[140:143]
v_cvt_pk_bf16_f32 v200,v234,v198
v_cvt_pk_bf16_f32 v198,v238,v235
M v[140:143],v[164:167],v[228:231],v[140:143]
v_cvt_pk_bf16_f32 v202,v236,v202
v_permlane32_swap_b32 v197,v199
M v[144:147],v[164:167],v[224:227],0
v_permlane32_swap_b32 v193,v195
v_permlane32_swap_b32 v201,v203
M v[144:147],v[160:163],v[220:223],v[144:147]
v_lshlrev_b32 v234,16,v199
v_lshlrev_b32 v232,16,v193
M v[144:147],v[168:171],a[204:207],v[144:147]
v_lshlrev_b32 v233,16,v197
v_lshlrev_b32 v237,16,v195
M v[148:151],v[168:171],a[208:211],0
v_lshlrev_b32 v236,16,v203
v_lshlrev_b32 v235,16,v201
M v[148:151],v[160:163],a[204:207],v[148:151]
v_fmac_f32 v232,s43,v234
v_fmac_f32 v237,4.0,v233
M v[148:151],v[164:167],v[220:223],v[148:151]
v_fma_f32 v238,-4.0,v234,v236
v_fmac_f32 v232,s45,v236
M v[152:155],v[164:167],a[204:207],0
v_fmac_f32 v237,s41,v235
v_sub_f32 v236,v236,v234
M v[152:155],v[160:163],a[208:211],v[152:155]
v_fma_f32 v234,-4.0,v233,v235
v_sub_f32 v235,v235,v233
M v[152:155],v[168:171],a[216:219],v[152:155]
v_add_f32 v233,v238,v234
v_sub_f32 v238,v238,v234
M v[156:159],v[168:171],a[228:231],0
buffer_load_dwordx4 a[244:247],v250,s[20:23],s47 offen offset:1024 sc1
M v[156:159],v[160:163],a[216:219],v[156:159]
v_fma_f32 v234,2.0,v235,v236
v_fmac_f32 v236,-2.0,v235
M v[156:159],v[164:167],a[208:211],v[156:159]
s_waitcnt vmcnt(16)
buffer_load_dwordx4 a[240:243],v250,s[20:23],s47 offen offset:2048 sc1
M v[160:163],a[192:195],a[248:251],0
s_waitcnt vmcnt(16)
s_add_u32 s48,s73,15360
v_and_b32 v199,s42,v199
v_and_b32 v193,s42,v193
M v[160:163],a[196:199],a[252:255],v[160:163]
s_waitcnt vmcnt(15)
v_and_b32 v197,s42,v197
v_and_b32 v195,s42,v195
M v[160:163],a[200:203],v[216:219],v[160:163]
v_and_b32 v203,s42,v203
v_and_b32 v201,s42,v201
M v[164:167],a[200:203],v[228:231],0
buffer_load_dwordx4 a[236:239],v250,s[20:23],s48 offen offset:0 sc1
M v[164:167],a[196:199],v[216:219],v[164:167]
v_fmac_f32 v193,s43,v199
v_fmac_f32 v195,4.0,v197
M v[164:167],a[192:195],a[252:255],v[164:167]
v_fma_f32 v235,-4.0,v199,v203
v_fmac_f32 v193,s45,v203
M v[168:171],a[192:195],v[216:219],0
v_fmac_f32 v195,s41,v201
v_sub_f32 v203,v203,v199
M v[168:171],a[196:199],v[228:231],v[168:171]
buffer_load_dwordx4 a[248:251],v250,s[20:23],s48 offen offset:1024 sc1
M v[168:171],a[200:203],v[224:227],v[168:171]
v_fma_f32 v199,-4.0,v197,v201
v_sub_f32 v201,v201,v197
M v[172:175],a[200:203],v[220:223],0
v_add_f32 v197,v235,v199
v_sub_f32 v235,v235,v199
M v[172:175],a[196:199],v[224:227],v[172:175]
v_fma_f32 v199,2.0,v201,v203
v_fmac_f32 v203,-2.0,v201
M v[172:175],a[192:195],v[228:231],v[172:175]
buffer_load_dwordx4 a[252:255],v250,s[20:23],s48 offen offset:2048 sc1
M v[176:179],a[192:195],v[224:227],0
s_add_u32 s46,s73,18432
v_cvt_pk_bf16_f32 v193,v232,v193
v_cvt_pk_bf16_f32 v195,v237,v195
M v[176:179],a[196:199],v[220:223],v[176:179]
v_cvt_pk_bf16_f32 v197,v233,v197
v_cvt_pk_bf16_f32 v201,v234,v199
M v[176:179],a[200:203],a[204:207],v[176:179]
s_barrier
v_cvt_pk_bf16_f32 v199,v238,v235
M v[180:183],a[200:203],a[208:211],0
buffer_load_dwordx4 v[216:219],v250,s[20:23],s46 offen offset:0 sc1
M v[180:183],a[196:199],a[204:207],v[180:183]
ds_read_b128 v[228:231],v248 offset:52224
v_cvt_pk_bf16_f32 v203,v236,v203
M v[180:183],a[192:195],v[220:223],v[180:183]
ds_write2st64_b64 v247,v[192:193],v[194:195] offset0:204 offset1:221
M v[184:187],a[192:195],a[204:207],0
s_add_u32 s28,s68,786432
ds_read_b128 v[224:227],v249 offset:52224
ds_read_b128 v[220:223],v248 offset:52736
M v[184:187],a[196:199],a[208:211],v[184:187]
buffer_load_dwordx4 v[192:195],v251,s[88:91],s28 offen offset:0
M v[184:187],a[200:203],a[216:219],v[184:187]
ds_write2st64_b64 v247,v[196:197],v[198:199] offset0:34 offset1:51
M v[188:191],a[200:203],a[228:231],0
s_waitcnt vmcnt(17)
ds_read_b128 a[204:207],v249 offset:52736
v_permlane32_swap_b32 v208,v210
M v[188:191],a[196:199],a[216:219],v[188:191]
buffer_load_dwordx4 v[196:199],v245,s[8:11],s28 offen offset:0
M v[188:191],a[192:195],a[208:211],v[188:191]
s_waitcnt lgkmcnt(5)
ds_write2st64_b64 v247,v[200:201],v[202:203] offset0:68 offset1:85
M a[0:3],a[212:215],v[228:231],a[0:3]
s_waitcnt vmcnt(10) lgkmcnt(4)
ds_read_b128 a[200:203],v248 offset:53248
v_permlane32_swap_b32 v204,v206
M a[0:3],a[224:227],v[224:227],a[0:3]
s_waitcnt vmcnt(9) lgkmcnt(4)
buffer_load_dwordx4 v[200:203],v245,s[8:11],s28 offen offset:768
M a[0:3],a[220:223],v[220:223],a[0:3]
s_waitcnt lgkmcnt(2)
ds_read_b128 a[228:231],v249 offset:53248
v_permlane32_swap_b32 v212,v214
M a[4:7],a[220:223],a[204:207],a[4:7]
v_lshlrev_b32 v234,16,v210
v_lshlrev_b32 v232,16,v204
M a[4:7],a[224:227],v[220:223],a[4:7]
v_lshlrev_b32 v233,16,v208
v_lshlrev_b32 v237,16,v206
M a[4:7],a[212:215],v[224:227],a[4:7]
v_lshlrev_b32 v236,16,v214
v_lshlrev_b32 v235,16,v212
M a[8:11],a[212:215],v[220:223],a[8:11]
ds_read_b128 a[196:199],v248 offset:53760
v_fmac_f32 v232,s43,v234
M a[8:11],a[224:227],a[204:207],a[8:11]
s_waitcnt lgkmcnt(2)
ds_read_b128 a[216:219],v249 offset:53760
v_fmac_f32 v237,4.0,v233
M a[8:11],a[220:223],a[200:203],a[8:11]
s_waitcnt lgkmcnt(2)
v_fma_f32 v238,-4.0,v234,v236
v_fmac_f32 v232,s45,v236
M a[12:15],a[220:223],a[228:231],a[12:15]
v_fmac_f32 v237,s41,v235
v_sub_f32 v236,v236,v234
M a[12:15],a[224:227],a[200:203],a[12:15]
v_fma_f32 v234,-4.0,v233,v235
v_sub_f32 v235,v235,v233
M a[12:15],a[212:215],a[204:207],a[12:15]
v_add_f32 v233,v238,v234
v_sub_f32 v238,v238,v234
M a[16:19],a[212:215],a[200:203],a[16:19]
ds_read_b128 a[192:195],v249 offset:54272
v_fma_f32 v234,2.0,v235,v236
M a[16:19],a[224:227],a[228:231],a[16:19]
s_waitcnt lgkmcnt(2)
ds_read_b128 a[208:211],v248 offset:54272
v_fmac_f32 v236,-2.0,v235
M a[16:19],a[220:223],a[196:199],a[16:19]
s_waitcnt lgkmcnt(2)
v_and_b32 v210,s42,v210
v_and_b32 v204,s42,v204
M a[20:23],a[220:223],a[216:219],a[20:23]
v_and_b32 v208,s42,v208
v_and_b32 v206,s42,v206
M a[20:23],a[224:227],a[196:199],a[20:23]
v_and_b32 v214,s42,v214
v_and_b32 v212,s42,v212
M a[20:23],a[212:215],a[228:231],a[20:23]
v_fmac_f32 v204,s43,v210
v_fmac_f32 v206,4.0,v208
M a[24:27],a[212:215],a[196:199],a[24:27]
v_fma_f32 v235,-4.0,v210,v214
v_fmac_f32 v204,s45,v214
M a[24:27],a[224:227],a[216:219],a[24:27]
s_waitcnt lgkmcnt(1)
v_fmac_f32 v206,s41,v212
v_sub_f32 v214,v214,v210
M a[24:27],a[220:223],a[192:195],a[24:27]
s_waitcnt lgkmcnt(0)
v_fma_f32 v210,-4.0,v208,v212
v_sub_f32 v212,v212,v208
M a[28:31],a[220:223],a[208:211],a[28:31]
buffer_load_dwordx4 a[220:223],v250,s[20:23],s46 offen offset:1024 sc1
M a[28:31],a[224:227],a[192:195],a[28:31]
v_add_f32 v208,v235,v210
v_sub_f32 v235,v235,v210
M a[28:31],a[212:215],a[216:219],a[28:31]
s_waitcnt vmcnt(10)
buffer_load_dwordx4 a[224:227],v250,s[20:23],s46 offen offset:2048 sc1
M a[32:35],a[232:235],v[228:231],a[32:35]
s_waitcnt vmcnt(10)
s_add_u32 s47,s73,21504
v_fma_f32 v210,2.0,v212,v214
v_fmac_f32 v214,-2.0,v212
M a[32:35],a[244:247],v[224:227],a[32:35]
s_waitcnt vmcnt(9)
v_cvt_pk_bf16_f32 v204,v232,v204
v_cvt_pk_bf16_f32 v206,v237,v206
M a[32:35],a[240:243],v[220:223],a[32:35]
v_cvt_pk_bf16_f32 v208,v233,v208
v_cvt_pk_bf16_f32 v212,v234,v210
M a[36:39],a[240:243],a[204:207],a[36:39]
buffer_load_dwordx4 a[212:215],v250,s[20:23],s47 offen offset:0 sc1
M a[36:39],a[244:247],v[220:223],a[36:39]
v_cvt_pk_bf16_f32 v210,v238,v235
v_cvt_pk_bf16_f32 v214,v236,v214
M a[36:39],a[232:235],v[224:227],a[36:39]
v_permlane32_swap_b32 v209,v211
v_permlane32_swap_b32 v205,v207
M a[40:43],a[232:235],v[220:223],a[40:43]
v_permlane32_swap_b32 v213,v215
v_lshlrev_b32 v234,16,v211
M a[40:43],a[244:247],a[204:207],a[40:43]
v_lshlrev_b32 v232,16,v205
v_lshlrev_b32 v233,16,v209
M a[40:43],a[240:243],a[200:203],a[40:43]
v_lshlrev_b32 v237,16,v207
v_lshlrev_b32 v236,16,v215
M a[44:47],a[240:243],a[228:231],a[44:47]
v_lshlrev_b32 v235,16,v213
v_fmac_f32 v232,s43,v234
M a[44:47],a[244:247],a[200:203],a[44:47]
v_fmac_f32 v237,4.0,v233
v_fma_f32 v238,-4.0,v234,v236
M a[44:47],a[232:235],a[204:207],a[44:47]
v_fmac_f32 v232,s45,v236
v_fmac_f32 v237,s41,v235
M a[48:51],a[232:235],a[200:203],a[48:51]
v_sub_f32 v236,v236,v234
v_fma_f32 v234,-4.0,v233,v235
M a[48:51],a[244:247],a[228:231],a[48:51]
v_sub_f32 v235,v235,v233
v_add_f32 v233,v238,v234
M a[48:51],a[240:243],a[196:199],a[48:51]
v_sub_f32 v238,v238,v234
v_fma_f32 v234,2.0,v235,v236
M a[52:55],a[240:243],a[216:219],a[52:55]
v_fmac_f32 v236,-2.0,v235
v_and_b32 v211,s42,v211
M a[52:55],a[244:247],a[196:199],a[52:55]
v_and_b32 v205,s42,v205
v_and_b32 v209,s42,v209
M a[52:55],a[232:235],a[228:231],a[52:55]
v_and_b32 v207,s42,v207
v_and_b32 v215,s42,v215
M a[56:59],a[232:235],a[196:199],a[56:59]
v_and_b32 v213,s42,v213
v_fmac_f32 v205,s43,v211
M a[56:59],a[244:247],a[216:219],a[56:59]
v_fmac_f32 v207,4.0,v209
v_fma_f32 v235,-4.0,v211,v215
M a[56:59],a[240:243],a[192:195],a[56:59]
v_fmac_f32 v205,s45,v215
v_fmac_f32 v207,s41,v213
M a[60:63],a[240:243],a[208:211],a[60:63]
buffer_load_dwordx4 a[240:243],v250,s[20:23],s47 offen offset:1024 sc1
M a[60:63],a[244:247],a[192:195],a[60:63]
v_sub_f32 v215,v215,v211
v_fma_f32 v211,-4.0,v209,v213
M a[60:63],a[232:235],a[216:219],a[60:63]
s_waitcnt vmcnt(10)
buffer_load_dwordx4 a[244:247],v250,s[20:23],s47 offen offset:2048 sc1
M a[64:67],a[236:239],v[228:231],a[64:67]
s_waitcnt vmcnt(10)
s_add_u32 s48,s73,24576
v_sub_f32 v213,v213,v209
v_add_f32 v209,v235,v211
M a[64:67],a[248:251],v[224:227],a[64:67]
s_waitcnt vmcnt(9)
v_sub_f32 v235,v235,v211
v_fma_f32 v211,2.0,v213,v215
M a[64:67],a[252:255],v[220:223],a[64:67]
v_fmac_f32 v215,-2.0,v213
v_cvt_pk_bf16_f32 v205,v232,v205
M a[68:71],a[252:255],a[204:207],a[68:71]
buffer_load_dwordx4 a[232:235],v250,s[20:23],s48 offen offset:0 sc1
M a[68:71],a[248:251],v[220:223],a[68:71]
v_cvt_pk_bf16_f32 v207,v237,v207
v_cvt_pk_bf16_f32 v209,v233,v209
M a[68:71],a[236:239],v[224:227],a[68:71]
v_cvt_pk_bf16_f32 v213,v234,v211
v_cvt_pk_bf16_f32 v211,v238,v235
M a[72:75],a[236:239],v[220:223],a[72:75]
v_cvt_pk_bf16_f32 v215,v236,v215
v_fmac_f32 v239,s43,v241
M a[72:75],a[248:251],a[204:207],a[72:75]
buffer_load_dwordx4 v[228:231],v250,s[20:23],s48 offen offset:1024 sc1
M a[72:75],a[252:255],a[200:203],a[72:75]
ds_write2st64_b64 v247,v[204:205],v[206:207] offset0:205 offset1:222
M a[76:79],a[252:255],a[228:231],a[76:79]
s_add_u32 s28,s68,1179648
v_fmac_f32 v244,4.0,v240
v_fma_f32 v232,-4.0,v241,v243
M a[76:79],a[248:251],a[200:203],a[76:79]
v_fmac_f32 v239,s45,v243
v_fmac_f32 v244,s41,v242
M a[76:79],a[236:239],a[204:207],a[76:79]
buffer_load_dwordx4 v[224:227],v250,s[20:23],s48 offen offset:2048 sc1
M a[80:83],a[236:239],a[200:203],a[80:83]
s_add_u32 s46,s73,27648
v_sub_f32 v243,v243,v241
v_fma_f32 v241,-4.0,v240,v242
M a[80:83],a[248:251],a[228:231],a[80:83]
v_sub_f32 v242,v242,v240
v_add_f32 v240,v232,v241
M a[80:83],a[252:255],a[196:199],a[80:83]
ds_write2st64_b64 v247,v[208:209],v[210:211] offset0:35 offset1:52
M a[84:87],a[252:255],a[216:219],a[84:87]
buffer_load_dwordx4 v[220:223],v250,s[20:23],s46 offen offset:0 sc1
M a[84:87],a[248:251],a[196:199],a[84:87]
ds_read_b128 a[204:207],v248 offset:60928
v_sub_f32 v232,v232,v241
M a[84:87],a[236:239],a[228:231],a[84:87]
ds_write2st64_b64 v247,v[212:213],v[214:215] offset0:69 offset1:86
M a[88:91],a[236:239],a[196:199],a[88:91]
buffer_load_dwordx4 v[204:207],v251,s[88:91],s28 offen offset:0
M a[88:91],a[248:251],a[216:219],a[88:91]
ds_read_b128 a[200:203],v249 offset:60928
ds_read_b128 a[228:231],v248 offset:61440
M a[88:91],a[252:255],a[192:195],a[88:91]
ds_read_b128 a[196:199],v249 offset:61440
v_fma_f32 v241,2.0,v242,v243
M a[92:95],a[252:255],a[208:211],a[92:95]
buffer_load_dwordx4 v[208:211],v245,s[8:11],s28 offen offset:0
M a[92:95],a[248:251],a[192:195],a[92:95]
v_fmac_f32 v243,-2.0,v242
v_cvt_pk_bf16_f32 v233,v239,v244
M a[92:95],a[236:239],a[216:219],a[92:95]
s_waitcnt vmcnt(14) lgkmcnt(4)
v_cvt_pk_bf16_f32 v234,v240,v232
v_cvt_pk_bf16_f32 v235,v241,v243
M a[96:99],v[216:219],a[204:207],a[96:99]
s_waitcnt vmcnt(10) lgkmcnt(2)
ds_read_b128 a[208:211],v248 offset:61952
v_add_u32 v232,104448,v252
M a[96:99],a[220:223],a[200:203],a[96:99]
s_waitcnt vmcnt(9) lgkmcnt(2)
buffer_load_dwordx4 v[212:215],v245,s[8:11],s28 offen offset:768
M a[96:99],a[224:227],a[228:231],a[96:99]
s_waitcnt lgkmcnt(1)
s_add_u32 s29,s69,0
ds_read_b128 a[252:255],v249 offset:61952
ds_write_b16 v232,v233 offset:0
M a[100:103],a[224:227],a[196:199],a[100:103]
ds_write_b16_d16_hi v232,v233 offset:8704
M a[100:103],a[220:223],a[228:231],a[100:103]
ds_write_b16 v252,v234 offset:17408
M a[100:103],v[216:219],a[200:203],a[100:103]
buffer_load_short_d16_hi v239,v246,s[12:15],s29 offen offset:0
M a[104:107],v[216:219],a[228:231],a[104:107]
ds_read_b128 a[192:195],v248 offset:62464
ds_write_b16_d16_hi v252,v234 offset:26112
M a[104:107],a[220:223],a[196:199],a[104:107]
s_waitcnt lgkmcnt(6)
buffer_load_short_d16_hi v240,v246,s[8:11],s29 offen offset:0
M a[104:107],a[224:227],a[208:211],a[104:107]
s_waitcnt lgkmcnt(5)
ds_read_b128 a[248:251],v249 offset:62464
ds_write_b16 v252,v235 offset:34816
M a[108:111],a[224:227],a[252:255],a[108:111]
buffer_load_short_d16_hi v241,v246,s[8:11],s29 offen offset:384
M a[108:111],a[220:223],a[208:211],a[108:111]
buffer_load_short_d16_hi v242,v246,s[8:11],s29 offen offset:768
M a[108:111],v[216:219],a[196:199],a[108:111]
ds_write_b16_d16_hi v252,v235 offset:43520
M a[112:115],v[216:219],a[208:211],a[112:115]
buffer_load_short_d16_hi v243,v246,s[8:11],s29 offen offset:1152
M a[112:115],a[220:223],a[252:255],a[112:115]
s_waitcnt lgkmcnt(4)
ds_read_b128 a[216:219],v249 offset:62976
ds_read_b128 a[236:239],v248 offset:62976
M a[112:115],a[224:227],a[192:195],a[112:115]
s_waitcnt lgkmcnt(4)
buffer_load_short_d16_hi v244,v246,s[16:19],s29 offen offset:1536
M a[116:119],a[224:227],a[248:251],a[116:119]
v_permlane32_swap_b32 v196,v198
v_permlane32_swap_b32 v192,v194
M a[116:119],a[220:223],a[192:195],a[116:119]
v_permlane32_swap_b32 v200,v202
v_lshlrev_b32 v234,16,v198
M a[116:119],v[216:219],a[252:255],a[116:119]
v_lshlrev_b32 v232,16,v192
v_lshlrev_b32 v233,16,v196
M a[120:123],v[216:219],a[192:195],a[120:123]
v_lshlrev_b32 v237,16,v194
v_lshlrev_b32 v236,16,v202
M a[120:123],a[220:223],a[248:251],a[120:123]
s_waitcnt lgkmcnt(1)
v_lshlrev_b32 v235,16,v200
v_fmac_f32 v232,s43,v234
M a[120:123],a[224:227],a[216:219],a[120:123]
s_waitcnt lgkmcnt(0)
v_fmac_f32 v237,4.0,v233
v_fma_f32 v238,-4.0,v234,v236
M a[124:127],a[224:227],a[236:239],a[124:127]
buffer_load_dwordx4 a[224:227],v250,s[20:23],s46 offen offset:1024 sc1
M a[124:127],a[220:223],a[216:219],a[124:127]
v_fmac_f32 v232,s45,v236
v_fmac_f32 v237,s41,v235
M a[124:127],v[216:219],a[248:251],a[124:127]
s_waitcnt vmcnt(16)
buffer_load_dwordx4 a[220:223],v250,s[20:23],s46 offen offset:2048 sc1
M a[128:131],a[212:215],a[204:207],a[128:131]
s_waitcnt vmcnt(16)
s_add_u32 s47,s73,30720
v_sub_f32 v236,v236,v234
v_fma_f32 v234,-4.0,v233,v235
M a[128:131],a[240:243],a[200:203],a[128:131]
s_waitcnt vmcnt(15)
v_sub_f32 v235,v235,v233
v_add_f32 v233,v238,v234
M a[128:131],a[244:247],a[228:231],a[128:131]
v_sub_f32 v238,v238,v234
v_fma_f32 v234,2.0,v235,v236
M a[132:135],a[244:247],a[196:199],a[132:135]
buffer_load_dwordx4 v[216:219],v250,s[20:23],s47 offen offset:0 sc1
M a[132:135],a[240:243],a[228:231],a[132:135]
v_fmac_f32 v236,-2.0,v235
v_and_b32 v198,s42,v198
M a[132:135],a[212:215],a[200:203],a[132:135]
v_and_b32 v192,s42,v192
v_and_b32 v196,s42,v196
M a[136:139],a[212:215],a[228:231],a[136:139]
v_and_b32 v194,s42,v194
v_and_b32 v202,s42,v202
M a[136:139],a[240:243],a[196:199],a[136:139]
v_and_b32 v200,s42,v200
v_fmac_f32 v192,s43,v198
M a[136:139],a[244:247],a[208:211],a[136:139]
v_fmac_f32 v194,4.0,v196
v_fma_f32 v235,-4.0,v198,v202
M a[140:143],a[244:247],a[252:255],a[140:143]
v_fmac_f32 v192,s45,v202
v_fmac_f32 v194,s41,v200
M a[140:143],a[240:243],a[208:211],a[140:143]
v_sub_f32 v202,v202,v198
v_fma_f32 v198,-4.0,v196,v200
M a[140:143],a[212:215],a[196:199],a[140:143]
v_sub_f32 v200,v200,v196
v_add_f32 v196,v235,v198
M a[144:147],a[212:215],a[208:211],a[144:147]
v_sub_f32 v235,v235,v198
v_fma_f32 v198,2.0,v200,v202
M a[144:147],a[240:243],a[252:255],a[144:147]
v_fmac_f32 v202,-2.0,v200
v_cvt_pk_bf16_f32 v192,v232,v192
M a[144:147],a[244:247],a[192:195],a[144:147]
v_cvt_pk_bf16_f32 v194,v237,v194
v_cvt_pk_bf16_f32 v196,v233,v196
M a[148:151],a[244:247],a[248:251],a[148:151]
v_cvt_pk_bf16_f32 v200,v234,v198
v_cvt_pk_bf16_f32 v198,v238,v235
M a[148:151],a[240:243],a[192:195],a[148:151]
v_cvt_pk_bf16_f32 v202,v236,v202
v_permlane32_swap_b32 v197,v199
M a[148:151],a[212:215],a[252:255],a[148:151]
v_permlane32_swap_b32 v193,v195
v_permlane32_swap_b32 v201,v203
M a[152:155],a[212:215],a[192:195],a[152:155]
v_lshlrev_b32 v234,16,v199
v_lshlrev_b32 v232,16,v193
M a[152:155],a[240:243],a[248:251],a[152:155]
v_lshlrev_b32 v233,16,v197
v_lshlrev_b32 v237,16,v195
M a[152:155],a[244:247],a[216:219],a[152:155]
v_lshlrev_b32 v236,16,v203
v_lshlrev_b32 v235,16,v201
M a[156:159],a[244:247],a[236:239],a[156:159]
buffer_load_dwordx4 a[244:247],v250,s[20:23],s47 offen offset:1024 sc1
M a[156:159],a[240:243],a[216:219],a[156:159]
v_fmac_f32 v232,s43,v234
v_fmac_f32 v237,4.0,v233
M a[156:159],a[212:215],a[248:251],a[156:159]
s_waitcnt vmcnt(16)
buffer_load_dwordx4 a[240:243],v250,s[20:23],s47 offen offset:2048 sc1
M a[160:163],a[232:235],a[204:207],a[160:163]
s_waitcnt vmcnt(16)
s_add_u32 s48,s73,33792
v_fma_f32 v238,-4.0,v234,v236
v_fmac_f32 v232,s45,v236
M a[160:163],v[228:231],a[200:203],a[160:163]
s_waitcnt vmcnt(15)
v_fmac_f32 v237,s41,v235
v_sub_f32 v236,v236,v234
M a[160:163],v[224:227],a[228:231],a[160:163]
v_fma_f32 v234,-4.0,v233,v235
v_sub_f32 v235,v235,v233
M a[164:167],v[224:227],a[196:199],a[164:167]
buffer_load_dwordx4 a[212:215],v250,s[20:23],s48 offen offset:0 sc1
M a[164:167],v[228:231],a[228:231],a[164:167]
v_add_f32 v233,v238,v234
v_sub_f32 v238,v238,v234
M a[164:167],a[232:235],a[200:203],a[164:167]
v_fma_f32 v234,2.0,v235,v236
v_fmac_f32 v236,-2.0,v235
M a[168:171],a[232:235],a[228:231],a[168:171]
v_and_b32 v199,s42,v199
v_and_b32 v193,s42,v193
M a[168:171],v[228:231],a[196:199],a[168:171]
buffer_load_dwordx4 a[204:207],v250,s[20:23],s48 offen offset:1024 sc1
M a[168:171],v[224:227],a[208:211],a[168:171]
v_and_b32 v197,s42,v197
v_and_b32 v195,s42,v195
M a[172:175],v[224:227],a[252:255],a[172:175]
v_and_b32 v203,s42,v203
v_and_b32 v201,s42,v201
M a[172:175],v[228:231],a[208:211],a[172:175]
v_fmac_f32 v193,s43,v199
v_fmac_f32 v195,4.0,v197
M a[172:175],a[232:235],a[196:199],a[172:175]
buffer_load_dwordx4 a[200:203],v250,s[20:23],s48 offen offset:2048 sc1
M a[176:179],a[232:235],a[208:211],a[176:179]
s_add_u32 s46,s73,36864
v_fma_f32 v235,-4.0,v199,v203
v_fmac_f32 v193,s45,v203
M a[176:179],v[228:231],a[252:255],a[176:179]
v_add_u32 v248,0x4400,v248
v_add_u32 v249,0x4400,v249
M a[176:179],v[224:227],a[192:195],a[176:179]
v_fmac_f32 v195,s41,v201
v_sub_f32 v203,v203,v199
M a[180:183],v[224:227],a[248:251],a[180:183]
buffer_load_dwordx4 a[228:231],v250,s[20:23],s46 offen offset:0 sc1
M a[180:183],v[228:231],a[192:195],a[180:183]
ds_read_b128 a[196:199],v248 offset:52224
v_fma_f32 v199,-4.0,v197,v201
M a[180:183],a[232:235],a[252:255],a[180:183]
ds_read_b128 a[208:211],v249 offset:52224
v_sub_f32 v201,v201,v197
M a[184:187],a[232:235],a[192:195],a[184:187]
ds_read_b128 a[252:255],v248 offset:52736
v_add_f32 v197,v235,v199
M a[184:187],v[228:231],a[248:251],a[184:187]
ds_read_b128 a[192:195],v249 offset:52736
v_sub_f32 v235,v235,v199
M a[184:187],v[224:227],a[216:219],a[184:187]
v_fma_f32 v199,2.0,v201,v203
v_fmac_f32 v203,-2.0,v201
M a[188:191],v[224:227],a[236:239],a[188:191]
v_cvt_pk_bf16_f32 v193,v232,v193
v_cvt_pk_bf16_f32 v195,v237,v195
M a[188:191],v[228:231],a[216:219],a[188:191]
v_cvt_pk_bf16_f32 v197,v233,v197
v_cvt_pk_bf16_f32 v201,v234,v199
M a[188:191],a[232:235],a[248:251],a[188:191]
s_waitcnt vmcnt(18) lgkmcnt(3)
v_cvt_pk_bf16_f32 v199,v238,v235
v_cvt_pk_bf16_f32 v203,v236,v203
M v[0:3],v[220:223],a[196:199],v[0:3]
s_waitcnt vmcnt(8) lgkmcnt(2)
ds_read_b128 a[236:239],v248 offset:53248
v_permlane32_swap_b32 v208,v210
M v[0:3],a[224:227],a[208:211],v[0:3]
s_waitcnt vmcnt(7) lgkmcnt(2)
ds_read_b128 v[224:227],v249 offset:53248
v_permlane32_swap_b32 v204,v206
M v[0:3],a[220:223],a[252:255],v[0:3]
s_waitcnt lgkmcnt(2)
ds_write2st64_b64 v247,v[192:193],v[194:195] offset0:206 offset1:223
M v[4:7],a[220:223],a[192:195],v[4:7]
s_add_u32 s28,s69,0
s_mov_b64 exec,s[86:87]
v_xor_b32 v245,0x80000000,v245
v_xor_b32 v251,0x80000000,v251
s_mov_b64 exec,-1
v_permlane32_swap_b32 v212,v214
M v[4:7],a[224:227],a[252:255],v[4:7]
buffer_load_dwordx4 v[192:195],v251,s[88:91],s28 offen offset:0
M v[4:7],v[220:223],a[208:211],v[4:7]
ds_write2st64_b64 v247,v[196:197],v[198:199] offset0:36 offset1:53
M v[8:11],v[220:223],a[252:255],v[8:11]
buffer_load_dwordx4 v[196:199],v245,s[8:11],s28 offen offset:0
M v[8:11],a[224:227],a[192:195],v[8:11]
s_waitcnt lgkmcnt(3)
ds_read_b128 a[216:219],v248 offset:53760
ds_read_b128 v[228:231],v249 offset:53760
M v[8:11],a[220:223],a[236:239],v[8:11]
s_waitcnt lgkmcnt(4)
ds_write2st64_b64 v247,v[200:201],v[202:203] offset0:70 offset1:87
M v[12:15],a[220:223],v[224:227],v[12:15]
buffer_load_dwordx4 v[200:203],v245,s[8:11],s28 offen offset:768
M v[12:15],a[224:227],a[236:239],v[12:15]
s_mov_b64 exec,s[86:87]
v_xor_b32 v245,0x80000000,v245
v_xor_b32 v251,0x80000000,v251
s_mov_b64 exec,-1
v_lshlrev_b32 v234,16,v210
M v[12:15],v[220:223],a[192:195],v[12:15]
v_lshlrev_b32 v232,16,v204
v_lshlrev_b32 v233,16,v208
M v[16:19],v[220:223],a[236:239],v[16:19]
ds_read_b128 a[232:235],v249 offset:54272
v_lshlrev_b32 v237,16,v206
M v[16:19],a[224:227],v[224:227],v[16:19]
s_waitcnt lgkmcnt(3)
ds_read_b128 a[248:251],v248 offset:54272
v_lshlrev_b32 v236,16,v214
M v[16:19],a[220:223],a[216:219],v[16:19]
s_waitcnt lgkmcnt(3)
v_lshlrev_b32 v235,16,v212
v_fmac_f32 v232,s43,v234
M v[20:23],a[220:223],v[228:231],v[20:23]
v_fmac_f32 v237,4.0,v233
v_fma_f32 v238,-4.0,v234,v236
M v[20:23],a[224:227],a[216:219],v[20:23]
v_fmac_f32 v232,s45,v236
v_fmac_f32 v237,s41,v235
M v[20:23],v[220:223],v[224:227],v[20:23]
v_sub_f32 v236,v236,v234
v_fma_f32 v234,-4.0,v233,v235
M v[24:27],v[220:223],a[216:219],v[24:27]
v_sub_f32 v235,v235,v233
v_add_f32 v233,v238,v234
M v[24:27],a[224:227],v[228:231],v[24:27]
s_waitcnt lgkmcnt(1)
v_sub_f32 v238,v238,v234
v_fma_f32 v234,2.0,v235,v236
M v[24:27],a[220:223],a[232:235],v[24:27]
s_waitcnt lgkmcnt(0)
v_fmac_f32 v236,-2.0,v235
v_and_b32 v210,s42,v210
M v[28:31],a[220:223],a[248:251],v[28:31]
global_load_dword a220,v250,s[64:65]
M v[28:31],a[224:227],a[232:235],v[28:31]
buffer_load_dwordx4 a[220:223],v250,s[20:23],s46 offen offset:1024 sc1
M v[28:31],v[220:223],v[228:231],v[28:31]
s_waitcnt vmcnt(11)
v_and_b32 v204,s42,v204
v_and_b32 v208,s42,v208
M v[32:35],v[216:219],a[196:199],v[32:35]
s_waitcnt vmcnt(10)
v_and_b32 v206,s42,v206
v_and_b32 v214,s42,v214
M v[32:35],a[244:247],a[208:211],v[32:35]
s_waitcnt vmcnt(9)
buffer_load_dwordx4 a[224:227],v250,s[20:23],s46 offen offset:2048 sc1
M v[32:35],a[240:243],a[252:255],v[32:35]
s_add_u32 s47,s73,39936
v_and_b32 v212,s42,v212
v_fmac_f32 v204,s43,v210
M v[36:39],a[240:243],a[192:195],v[36:39]
v_fmac_f32 v206,4.0,v208
v_fma_f32 v235,-4.0,v210,v214
M v[36:39],a[244:247],a[252:255],v[36:39]
v_fmac_f32 v204,s45,v214
v_fmac_f32 v206,s41,v212
M v[36:39],v[216:219],a[208:211],v[36:39]
buffer_load_dwordx4 v[220:223],v250,s[20:23],s47 offen offset:0 sc1
M v[40:43],v[216:219],a[252:255],v[40:43]
v_sub_f32 v214,v214,v210
v_fma_f32 v210,-4.0,v208,v212
M v[40:43],a[244:247],a[192:195],v[40:43]
v_sub_f32 v212,v212,v208
v_add_f32 v208,v235,v210
M v[40:43],a[240:243],a[236:239],v[40:43]
v_sub_f32 v235,v235,v210
v_fma_f32 v210,2.0,v212,v214
M v[44:47],a[240:243],v[224:227],v[44:47]
v_fmac_f32 v214,-2.0,v212
v_cvt_pk_bf16_f32 v204,v232,v204
M v[44:47],a[244:247],a[236:239],v[44:47]
v_cvt_pk_bf16_f32 v206,v237,v206
v_cvt_pk_bf16_f32 v208,v233,v208
M v[44:47],v[216:219],a[192:195],v[44:47]
v_cvt_pk_bf16_f32 v212,v234,v210
v_cvt_pk_bf16_f32 v210,v238,v235
M v[48:51],v[216:219],a[236:239],v[48:51]
v_cvt_pk_bf16_f32 v214,v236,v214
v_permlane32_swap_b32 v209,v211
M v[48:51],a[244:247],v[224:227],v[48:51]
v_permlane32_swap_b32 v205,v207
v_permlane32_swap_b32 v213,v215
M v[48:51],a[240:243],a[216:219],v[48:51]
v_lshlrev_b32 v234,16,v211
v_lshlrev_b32 v232,16,v205
M v[52:55],a[240:243],v[228:231],v[52:55]
v_lshlrev_b32 v233,16,v209
v_lshlrev_b32 v237,16,v207
M v[52:55],a[244:247],a[216:219],v[52:55]
v_lshlrev_b32 v236,16,v215
v_lshlrev_b32 v235,16,v213
M v[52:55],v[216:219],v[224:227],v[52:55]
v_fmac_f32 v232,s43,v234
v_fmac_f32 v237,4.0,v233
M v[56:59],v[216:219],a[216:219],v[56:59]
v_fma_f32 v238,-4.0,v234,v236
v_fmac_f32 v232,s45,v236
M v[56:59],a[244:247],v[228:231],v[56:59]
v_fmac_f32 v237,s41,v235
v_sub_f32 v236,v236,v234
M v[56:59],a[240:243],a[232:235],v[56:59]
v_fma_f32 v234,-4.0,v233,v235
v_sub_f32 v235,v235,v233
M v[60:63],a[240:243],a[248:251],v[60:63]
buffer_load_dwordx4 a[240:243],v250,s[20:23],s47 offen offset:1024 sc1
M v[60:63],a[244:247],a[232:235],v[60:63]
v_add_f32 v233,v238,v234
v_sub_f32 v238,v238,v234
M v[60:63],v[216:219],v[228:231],v[60:63]
s_waitcnt vmcnt(11)
buffer_load_dwordx4 a[244:247],v250,s[20:23],s47 offen offset:2048 sc1
M v[64:67],a[212:215],a[196:199],v[64:67]
s_waitcnt vmcnt(11)
s_add_u32 s48,s73,43008
v_fma_f32 v234,2.0,v235,v236
v_fmac_f32 v236,-2.0,v235
M v[64:67],a[204:207],a[208:211],v[64:67]
s_waitcnt vmcnt(10)
v_and_b32 v211,s42,v211
v_and_b32 v205,s42,v205
M v[64:67],a[200:203],a[252:255],v[64:67]
v_and_b32 v209,s42,v209
v_and_b32 v207,s42,v207
M v[68:71],a[200:203],a[192:195],v[68:71]
buffer_load_dwordx4 v[216:219],v250,s[20:23],s48 offen offset:0 sc1
M v[68:71],a[204:207],a[252:255],v[68:71]
v_and_b32 v215,s42,v215
v_and_b32 v213,s42,v213
M v[68:71],a[212:215],a[208:211],v[68:71]
v_fmac_f32 v205,s43,v211
v_fmac_f32 v207,4.0,v209
M v[72:75],a[212:215],a[252:255],v[72:75]
v_fma_f32 v235,-4.0,v211,v215
v_fmac_f32 v205,s45,v215
M v[72:75],a[204:207],a[192:195],v[72:75]
buffer_load_dwordx4 a[196:199],v250,s[20:23],s48 offen offset:1024 sc1
M v[72:75],a[200:203],a[236:239],v[72:75]
v_fmac_f32 v207,s41,v213
v_sub_f32 v215,v215,v211
M v[76:79],a[200:203],v[224:227],v[76:79]
v_fma_f32 v211,-4.0,v209,v213
v_sub_f32 v213,v213,v209
M v[76:79],a[204:207],a[236:239],v[76:79]
v_add_f32 v209,v235,v211
v_sub_f32 v235,v235,v211
M v[76:79],a[212:215],a[192:195],v[76:79]
buffer_load_dwordx4 a[208:211],v250,s[20:23],s48 offen offset:2048 sc1
M v[80:83],a[212:215],a[236:239],v[80:83]
s_add_u32 s46,s74,9216
v_fma_f32 v211,2.0,v213,v215
v_fmac_f32 v215,-2.0,v213
M v[80:83],a[204:207],v[224:227],v[80:83]
v_cvt_pk_bf16_f32 v205,v232,v205
v_cvt_pk_bf16_f32 v207,v237,v207
M v[80:83],a[200:203],a[216:219],v[80:83]
v_cvt_pk_bf16_f32 v209,v233,v209
v_cvt_pk_bf16_f32 v213,v234,v211
M v[84:87],a[200:203],v[228:231],v[84:87]
buffer_load_dwordx4 a[252:255],v250,s[20:23],s46 offen offset:0 sc1
M v[84:87],a[204:207],a[216:219],v[84:87]
ds_read_b128 a[192:195],v248 offset:60928
v_cvt_pk_bf16_f32 v211,v238,v235
M v[84:87],a[212:215],v[224:227],v[84:87]
ds_read_b128 a[236:239],v249 offset:60928
v_cvt_pk_bf16_f32 v215,v236,v215
M v[88:91],a[212:215],a[216:219],v[88:91]
s_waitcnt vmcnt(11)
ds_read_b128 v[224:227],v248 offset:61440
v_permlane32_swap_b32 v196,v198
M v[88:91],a[204:207],v[228:231],v[88:91]
ds_read_b128 a[216:219],v249 offset:61440
v_permlane32_swap_b32 v192,v194
M v[88:91],a[200:203],a[232:235],v[88:91]
ds_write2st64_b64 v247,v[204:205],v[206:207] offset0:207 offset1:224
M v[92:95],a[200:203],a[248:251],v[92:95]
s_add_u32 s28,s69,393216
buffer_load_dwordx4 v[204:207],v251,s[88:91],s28 offen offset:0
M v[92:95],a[204:207],a[232:235],v[92:95]
s_waitcnt vmcnt(11)
v_permlane32_swap_b32 v200,v202
v_lshlrev_b32 v234,16,v198
M v[92:95],a[212:215],v[228:231],v[92:95]
s_waitcnt lgkmcnt(4)
ds_write2st64_b64 v247,v[208:209],v[210:211] offset0:37 offset1:54
M v[96:99],a[228:231],a[192:195],v[96:99]
s_waitcnt vmcnt(9) lgkmcnt(4)
buffer_load_dwordx4 v[208:211],v245,s[8:11],s28 offen offset:0
M v[96:99],a[220:223],a[236:239],v[96:99]
s_waitcnt vmcnt(9) lgkmcnt(3)
ds_read_b128 a[200:203],v248 offset:61952
ds_read_b128 a[248:251],v249 offset:61952
M v[96:99],a[224:227],v[224:227],v[96:99]
s_waitcnt lgkmcnt(4)
ds_write2st64_b64 v247,v[212:213],v[214:215] offset0:71 offset1:88
M v[100:103],a[224:227],a[216:219],v[100:103]
buffer_load_dwordx4 v[212:215],v245,s[8:11],s28 offen offset:768
M v[100:103],a[220:223],v[224:227],v[100:103]
v_lshlrev_b32 v232,16,v192
v_lshlrev_b32 v233,16,v196
M v[100:103],a[228:231],a[236:239],v[100:103]
v_lshlrev_b32 v237,16,v194
v_lshlrev_b32 v236,16,v202
M v[104:107],a[228:231],v[224:227],v[104:107]
ds_read_b128 a[204:207],v248 offset:62464
v_lshlrev_b32 v235,16,v200
M v[104:107],a[220:223],a[216:219],v[104:107]
s_waitcnt lgkmcnt(3)
ds_read_b128 a[232:235],v249 offset:62464
v_fmac_f32 v232,s43,v234
M v[104:107],a[224:227],a[200:203],v[104:107]
s_waitcnt lgkmcnt(3)
v_fmac_f32 v237,4.0,v233
v_fma_f32 v238,-4.0,v234,v236
M v[108:111],a[224:227],a[248:251],v[108:111]
v_fmac_f32 v232,s45,v236
v_fmac_f32 v237,s41,v235
M v[108:111],a[220:223],a[200:203],v[108:111]
v_sub_f32 v236,v236,v234
v_fma_f32 v234,-4.0,v233,v235
M v[108:111],a[228:231],a[216:219],v[108:111]
v_sub_f32 v235,v235,v233
v_add_f32 v233,v238,v234
M v[112:115],a[228:231],a[200:203],v[112:115]
ds_read_b128 a[212:215],v249 offset:62976
v_sub_f32 v238,v238,v234
M v[112:115],a[220:223],a[248:251],v[112:115]
s_waitcnt lgkmcnt(2)
ds_read_b128 v[228:231],v248 offset:62976
v_fma_f32 v234,2.0,v235,v236
M v[112:115],a[224:227],a[204:207],v[112:115]
s_waitcnt lgkmcnt(2)
v_fmac_f32 v236,-2.0,v235
v_and_b32 v198,s42,v198
M v[116:119],a[224:227],a[232:235],v[116:119]
v_and_b32 v192,s42,v192
v_and_b32 v196,s42,v196
M v[116:119],a[220:223],a[204:207],v[116:119]
v_and_b32 v194,s42,v194
v_and_b32 v202,s42,v202
M v[116:119],a[228:231],a[248:251],v[116:119]
v_and_b32 v200,s42,v200
v_fmac_f32 v192,s43,v198
M v[120:123],a[228:231],a[204:207],v[120:123]
v_fmac_f32 v194,4.0,v196
v_fma_f32 v235,-4.0,v198,v202
M v[120:123],a[220:223],a[232:235],v[120:123]
s_waitcnt lgkmcnt(1)
v_fmac_f32 v192,s45,v202
v_fmac_f32 v194,s41,v200
M v[120:123],a[224:227],a[212:215],v[120:123]
s_waitcnt lgkmcnt(0)
v_sub_f32 v202,v202,v198
v_fma_f32 v198,-4.0,v196,v200
M v[124:127],a[224:227],v[228:231],v[124:127]
buffer_load_dwordx4 a[224:227],v250,s[20:23],s46 offen offset:1024 sc1
M v[124:127],a[220:223],a[212:215],v[124:127]
v_sub_f32 v200,v200,v196
v_add_f32 v196,v235,v198
M v[124:127],a[228:231],a[232:235],v[124:127]
s_waitcnt vmcnt(10)
buffer_load_dwordx4 a[220:223],v250,s[20:23],s46 offen offset:2048 sc1
M v[128:131],v[220:223],a[192:195],v[128:131]
s_waitcnt vmcnt(10)
s_add_u32 s47,s74,12288
v_sub_f32 v235,v235,v198
v_fma_f32 v198,2.0,v200,v202
M v[128:131],a[240:243],a[236:239],v[128:131]
s_waitcnt vmcnt(9)
v_fmac_f32 v202,-2.0,v200
v_cvt_pk_bf16_f32 v192,v232,v192
M v[128:131],a[244:247],v[224:227],v[128:131]
v_cvt_pk_bf16_f32 v194,v237,v194
v_cvt_pk_bf16_f32 v196,v233,v196
M v[132:135],a[244:247],a[216:219],v[132:135]
buffer_load_dwordx4 a[228:231],v250,s[20:23],s47 offen offset:0 sc1
M v[132:135],a[240:243],v[224:227],v[132:135]
v_cvt_pk_bf16_f32 v200,v234,v198
v_cvt_pk_bf16_f32 v198,v238,v235
M v[132:135],v[220:223],a[236:239],v[132:135]
v_cvt_pk_bf16_f32 v202,v236,v202
v_permlane32_swap_b32 v197,v199
M v[136:139],v[220:223],v[224:227],v[136:139]
v_permlane32_swap_b32 v193,v195
v_permlane32_swap_b32 v201,v203
M v[136:139],a[240:243],a[216:219],v[136:139]
v_lshlrev_b32 v234,16,v199
v_lshlrev_b32 v232,16,v193
M v[136:139],a[244:247],a[200:203],v[136:139]
v_lshlrev_b32 v233,16,v197
v_lshlrev_b32 v237,16,v195
M v[140:143],a[244:247],a[248:251],v[140:143]
v_lshlrev_b32 v236,16,v203
v_lshlrev_b32 v235,16,v201
M v[140:143],a[240:243],a[200:203],v[140:143]
v_fmac_f32 v232,s43,v234
v_fmac_f32 v237,4.0,v233
M v[140:143],v[220:223],a[216:219],v[140:143]
v_fma_f32 v238,-4.0,v234,v236
v_fmac_f32 v232,s45,v236
M v[144:147],v[220:223],a[200:203],v[144:147]
v_fmac_f32 v237,s41,v235
v_sub_f32 v236,v236,v234
M v[144:147],a[240:243],a[248:251],v[144:147]
v_fma_f32 v234,-4.0,v233,v235
v_sub_f32 v235,v235,v233
M v[144:147],a[244:247],a[204:207],v[144:147]
v_add_f32 v233,v238,v234
v_sub_f32 v238,v238,v234
M v[148:151],a[244:247],a[232:235],v[148:151]
v_fma_f32 v234,2.0,v235,v236
v_fmac_f32 v236,-2.0,v235
M v[148:151],a[240:243],a[204:207],v[148:151]
v_and_b32 v199,s42,v199
v_and_b32 v193,s42,v193
M v[148:151],v[220:223],a[248:251],v[148:151]
v_and_b32 v197,s42,v197
v_and_b32 v195,s42,v195
M v[152:155],v[220:223],a[204:207],v[152:155]
v_and_b32 v203,s42,v203
v_and_b32 v201,s42,v201
M v[152:155],a[240:243],a[232:235],v[152:155]
v_fmac_f32 v193,s43,v199
v_fmac_f32 v195,4.0,v197
M v[152:155],a[244:247],a[212:215],v[152:155]
v_fma_f32 v235,-4.0,v199,v203
v_fmac_f32 v193,s45,v203
M v[156:159],a[244:247],v[228:231],v[156:159]
buffer_load_dwordx4 a[244:247],v250,s[20:23],s47 offen offset:1024 sc1
M v[156:159],a[240:243],a[212:215],v[156:159]
v_fmac_f32 v195,s41,v201
v_sub_f32 v203,v203,v199
M v[156:159],v[220:223],a[232:235],v[156:159]
s_waitcnt vmcnt(10)
buffer_load_dwordx4 a[240:243],v250,s[20:23],s47 offen offset:2048 sc1
M v[160:163],v[216:219],a[192:195],v[160:163]
s_waitcnt vmcnt(10)
s_add_u32 s48,s74,15360
v_fma_f32 v199,-4.0,v197,v201
v_sub_f32 v201,v201,v197
M v[160:163],a[196:199],a[236:239],v[160:163]
s_waitcnt vmcnt(9)
v_add_f32 v197,v235,v199
v_sub_f32 v235,v235,v199
M v[160:163],a[208:211],v[224:227],v[160:163]
v_fma_f32 v199,2.0,v201,v203
v_fmac_f32 v203,-2.0,v201
M v[164:167],a[208:211],a[216:219],v[164:167]
buffer_load_dwordx4 v[220:223],v250,s[20:23],s48 offen offset:0 sc1
M v[164:167],a[196:199],v[224:227],v[164:167]
v_cvt_pk_bf16_f32 v193,v232,v193
v_cvt_pk_bf16_f32 v195,v237,v195
M v[164:167],v[216:219],a[236:239],v[164:167]
v_cvt_pk_bf16_f32 v197,v233,v197
v_cvt_pk_bf16_f32 v201,v234,v199
M v[168:171],v[216:219],v[224:227],v[168:171]
v_cvt_pk_bf16_f32 v199,v238,v235
v_cvt_pk_bf16_f32 v203,v236,v203
M v[168:171],a[196:199],a[216:219],v[168:171]
buffer_load_dwordx4 a[192:195],v250,s[20:23],s48 offen offset:1024 sc1
M v[168:171],a[208:211],a[200:203],v[168:171]
s_waitcnt vmcnt(8)
v_permlane32_swap_b32 v208,v210
v_permlane32_swap_b32 v204,v206
M v[172:175],a[208:211],a[248:251],v[172:175]
s_waitcnt vmcnt(7)
v_permlane32_swap_b32 v212,v214
v_lshlrev_b32 v234,16,v210
M v[172:175],a[196:199],a[200:203],v[172:175]
v_lshlrev_b32 v232,16,v204
v_lshlrev_b32 v233,16,v208
M v[172:175],v[216:219],a[216:219],v[172:175]
buffer_load_dwordx4 a[236:239],v250,s[20:23],s48 offen offset:2048 sc1
M v[176:179],v[216:219],a[200:203],v[176:179]
s_add_u32 s46,s74,18432
v_lshlrev_b32 v237,16,v206
v_lshlrev_b32 v236,16,v214
M v[176:179],a[196:199],a[248:251],v[176:179]
v_lshlrev_b32 v235,16,v212
v_fmac_f32 v232,s43,v234
M v[176:179],a[208:211],a[204:207],v[176:179]
s_barrier
v_fmac_f32 v237,4.0,v233
M v[180:183],a[208:211],a[232:235],v[180:183]
buffer_load_dwordx4 v[224:227],v250,s[20:23],s46 offen offset:0 sc1
M v[180:183],a[196:199],a[204:207],v[180:183]
ds_read_b128 a[216:219],v248 offset:0
v_fma_f32 v238,-4.0,v234,v236
M v[180:183],v[216:219],a[248:251],v[180:183]
ds_write2st64_b64 v247,v[192:193],v[194:195] offset0:238 offset1:255
M v[184:187],v[216:219],a[204:207],v[184:187]
s_add_u32 s28,s69,786432
ds_read_b128 a[200:203],v249 offset:0
ds_read_b128 a[248:251],v248 offset:512
M v[184:187],a[196:199],a[232:235],v[184:187]
buffer_load_dwordx4 v[192:195],v251,s[88:91],s28 offen offset:0
M v[184:187],a[208:211],a[212:215],v[184:187]
ds_write2st64_b64 v247,v[196:197],v[198:199] offset0:102 offset1:119
M v[188:191],a[208:211],v[228:231],v[188:191]
ds_read_b128 a[204:207],v249 offset:512
v_fmac_f32 v232,s45,v236
M v[188:191],a[196:199],a[212:215],v[188:191]
buffer_load_dwordx4 v[196:199],v245,s[8:11],s28 offen offset:0
M v[188:191],v[216:219],a[232:235],v[188:191]
s_waitcnt lgkmcnt(5)
ds_write2st64_b64 v247,v[200:201],v[202:203] offset0:136 offset1:153
M a[0:3],a[252:255],a[216:219],a[0:3]
s_waitcnt vmcnt(10) lgkmcnt(4)
ds_read_b128 a[208:211],v248 offset:1024
v_fmac_f32 v237,s41,v235
M a[0:3],a[224:227],a[200:203],a[0:3]
s_waitcnt vmcnt(9) lgkmcnt(4)
buffer_load_dwordx4 v[200:203],v245,s[8:11],s28 offen offset:768
M a[0:3],a[220:223],a[248:251],a[0:3]
s_waitcnt lgkmcnt(2)
ds_read_b128 v[228:231],v249 offset:1024
v_sub_f32 v236,v236,v234
M a[4:7],a[220:223],a[204:207],a[4:7]
v_fma_f32 v234,-4.0,v233,v235
v_sub_f32 v235,v235,v233
M a[4:7],a[224:227],a[248:251],a[4:7]
v_add_f32 v233,v238,v234
v_sub_f32 v238,v238,v234
M a[4:7],a[252:255],a[200:203],a[4:7]
v_fma_f32 v234,2.0,v235,v236
v_fmac_f32 v236,-2.0,v235
M a[8:11],a[252:255],a[248:251],a[8:11]
ds_read_b128 a[196:199],v248 offset:1536
v_and_b32 v210,s42,v210
M a[8:11],a[224:227],a[204:207],a[8:11]
s_waitcnt lgkmcnt(2)
ds_read_b128 a[212:215],v249 offset:1536
v_and_b32 v204,s42,v204
M a[8:11],a[220:223],a[208:211],a[8:11]
s_waitcnt lgkmcnt(2)
v_and_b32 v208,s42,v208
v_and_b32 v206,s42,v206
M a[12:15],a[220:223],v[228:231],a[12:15]
v_and_b32 v214,s42,v214
v_and_b32 v212,s42,v212
M a[12:15],a[224:227],a[208:211],a[12:15]
v_fmac_f32 v204,s43,v210
v_fmac_f32 v206,4.0,v208
M a[12:15],a[252:255],a[204:207],a[12:15]
v_fma_f32 v235,-4.0,v210,v214
v_fmac_f32 v204,s45,v214
M a[16:19],a[252:255],a[208:211],a[16:19]
ds_read_b128 a[232:235],v249 offset:2048
v_fmac_f32 v206,s41,v212
M a[16:19],a[224:227],v[228:231],a[16:19]
s_waitcnt lgkmcnt(2)
ds_read_b128 v[216:219],v248 offset:2048
v_sub_f32 v214,v214,v210
M a[16:19],a[220:223],a[196:199],a[16:19]
s_waitcnt lgkmcnt(2)
v_fma_f32 v210,-4.0,v208,v212
v_sub_f32 v212,v212,v208
M a[20:23],a[220:223],a[212:215],a[20:23]
v_add_f32 v208,v235,v210
v_sub_f32 v235,v235,v210
M a[20:23],a[224:227],a[196:199],a[20:23]
v_fma_f32 v210,2.0,v212,v214
v_fmac_f32 v214,-2.0,v212
M a[20:23],a[252:255],v[228:231],a[20:23]
v_cvt_pk_bf16_f32 v204,v232,v204
v_cvt_pk_bf16_f32 v206,v237,v206
M a[24:27],a[252:255],a[196:199],a[24:27]
v_cvt_pk_bf16_f32 v208,v233,v208
v_cvt_pk_bf16_f32 v212,v234,v210
M a[24:27],a[224:227],a[212:215],a[24:27]
s_waitcnt lgkmcnt(1)
v_cvt_pk_bf16_f32 v210,v238,v235
v_cvt_pk_bf16_f32 v214,v236,v214
M a[24:27],a[220:223],a[232:235],a[24:27]
s_waitcnt lgkmcnt(0)
v_permlane32_swap_b32 v209,v211
v_permlane32_swap_b32 v205,v207
M a[28:31],a[220:223],v[216:219],a[28:31]
buffer_load_dwordx4 a[220:223],v250,s[20:23],s46 offen offset:1024 sc1
M a[28:31],a[224:227],a[232:235],a[28:31]
v_permlane32_swap_b32 v213,v215
v_lshlrev_b32 v234,16,v211
M a[28:31],a[252:255],a[212:215],a[28:31]
s_waitcnt vmcnt(10)
buffer_load_dwordx4 a[224:227],v250,s[20:23],s46 offen offset:2048 sc1
M a[32:35],a[228:231],a[216:219],a[32:35]
s_waitcnt vmcnt(10)
s_add_u32 s47,s74,21504
v_lshlrev_b32 v232,16,v205
v_lshlrev_b32 v233,16,v209
M a[32:35],a[244:247],a[200:203],a[32:35]
s_waitcnt vmcnt(9)
v_lshlrev_b32 v237,16,v207
v_lshlrev_b32 v236,16,v215
M a[32:35],a[240:243],a[248:251],a[32:35]
v_lshlrev_b32 v235,16,v213
v_fmac_f32 v232,s43,v234
M a[36:39],a[240:243],a[204:207],a[36:39]
buffer_load_dwordx4 a[252:255],v250,s[20:23],s47 offen offset:0 sc1
M a[36:39],a[244:247],a[248:251],a[36:39]
v_fmac_f32 v237,4.0,v233
v_fma_f32 v238,-4.0,v234,v236
M a[36:39],a[228:231],a[200:203],a[36:39]
v_fmac_f32 v232,s45,v236
v_fmac_f32 v237,s41,v235
M a[40:43],a[228:231],a[248:251],a[40:43]
v_sub_f32 v236,v236,v234
v_fma_f32 v234,-4.0,v233,v235
M a[40:43],a[244:247],a[204:207],a[40:43]
v_sub_f32 v235,v235,v233
v_add_f32 v233,v238,v234
M a[40:43],a[240:243],a[208:211],a[40:43]
v_sub_f32 v238,v238,v234
v_fma_f32 v234,2.0,v235,v236
M a[44:47],a[240:243],v[228:231],a[44:47]
v_fmac_f32 v236,-2.0,v235
v_and_b32 v211,s42,v211
M a[44:47],a[244:247],a[208:211],a[44:47]
v_and_b32 v205,s42,v205
v_and_b32 v209,s42,v209
M a[44:47],a[228:231],a[204:207],a[44:47]
v_and_b32 v207,s42,v207
v_and_b32 v215,s42,v215
M a[48:51],a[228:231],a[208:211],a[48:51]
v_and_b32 v213,s42,v213
v_fmac_f32 v205,s43,v211
M a[48:51],a[244:247],v[228:231],a[48:51]
v_fmac_f32 v207,4.0,v209
v_fma_f32 v235,-4.0,v211,v215
M a[48:51],a[240:243],a[196:199],a[48:51]
v_fmac_f32 v205,s45,v215
v_fmac_f32 v207,s41,v213
M a[52:55],a[240:243],a[212:215],a[52:55]
v_sub_f32 v215,v215,v211
v_fma_f32 v211,-4.0,v209,v213
M a[52:55],a[244:247],a[196:199],a[52:55]
v_sub_f32 v213,v213,v209
v_add_f32 v209,v235,v211
M a[52:55],a[228:231],v[228:231],a[52:55]
s_add_u32 s31,s75,s85
v_sub_f32 v235,v235,v211
v_fma_f32 v211,2.0,v213,v215
M a[56:59],a[228:231],a[196:199],a[56:59]
v_fmac_f32 v215,-2.0,v213
v_cvt_pk_bf16_f32 v205,v232,v205
M a[56:59],a[244:247],a[212:215],a[56:59]
v_cvt_pk_bf16_f32 v207,v237,v207
v_cvt_pk_bf16_f32 v209,v233,v209
M a[56:59],a[240:243],a[232:235],a[56:59]
v_cvt_pk_bf16_f32 v213,v234,v211
v_cvt_pk_bf16_f32 v211,v238,v235
M a[60:63],a[240:243],v[216:219],a[60:63]
buffer_load_dword a240,v250,s[20:23],s31 offen offset:0 sc1
M a[60:63],a[244:247],a[232:235],a[60:63]
v_cvt_pk_bf16_f32 v215,v236,v215
v_add_u32 v238,121856,v247
M a[60:63],a[228:231],a[212:215],a[60:63]
s_waitcnt vmcnt(10)
ds_write2st64_b64 v238,v[204:205],v[206:207] offset0:1 offset1:18
M a[64:67],v[220:223],a[216:219],a[64:67]
s_waitcnt vmcnt(9)
s_add_u32 s28,s69,1179648
buffer_load_dwordx4 v[204:207],v251,s[88:91],s28 offen offset:0
M a[64:67],a[192:195],a[200:203],a[64:67]
s_waitcnt vmcnt(9)
v_fmac_f32 v239,s43,v241
v_fmac_f32 v244,4.0,v240
M a[64:67],a[236:239],a[248:251],a[64:67]
ds_write2st64_b64 v247,v[208:209],v[210:211] offset0:103 offset1:120
M a[68:71],a[236:239],a[204:207],a[68:71]
buffer_load_dwordx4 v[208:211],v245,s[8:11],s28 offen offset:0
M a[68:71],a[192:195],a[248:251],a[68:71]
v_fma_f32 v232,-4.0,v241,v243
v_fmac_f32 v239,s45,v243
M a[68:71],v[220:223],a[200:203],a[68:71]
ds_write2st64_b64 v247,v[212:213],v[214:215] offset0:137 offset1:154
M a[72:75],v[220:223],a[248:251],a[72:75]
buffer_load_dwordx4 v[212:215],v245,s[8:11],s28 offen offset:768
M a[72:75],a[192:195],a[204:207],a[72:75]
v_fmac_f32 v244,s41,v242
v_sub_f32 v243,v243,v241
M a[72:75],a[236:239],a[208:211],a[72:75]
buffer_load_dword a240,v250,s[20:23],s31 offen offset:128 sc1
M a[76:79],a[236:239],v[228:231],a[76:79]
buffer_load_dwordx4 a[240:243],v250,s[20:23],s47 offen offset:1024 sc1
M a[76:79],a[192:195],a[208:211],a[76:79]
buffer_load_dwordx4 a[244:247],v250,s[20:23],s47 offen offset:2048 sc1
M a[76:79],v[220:223],a[204:207],a[76:79]
s_add_u32 s48,s74,24576
v_fma_f32 v241,-4.0,v240,v242
v_sub_f32 v242,v242,v240
M a[80:83],v[220:223],a[208:211],a[80:83]
v_add_f32 v240,v232,v241
v_sub_f32 v232,v232,v241
M a[80:83],a[192:195],v[228:231],a[80:83]
v_fma_f32 v241,2.0,v242,v243
v_fmac_f32 v243,-2.0,v242
M a[80:83],a[236:239],a[196:199],a[80:83]
v_cvt_pk_bf16_f32 v233,v239,v244
v_cvt_pk_bf16_f32 v234,v240,v232
M a[84:87],a[236:239],a[212:215],a[84:87]
v_cvt_pk_bf16_f32 v235,v241,v243
v_add_u32 v232,121856,v252
M a[84:87],a[192:195],a[196:199],a[84:87]
ds_read_b128 a[204:207],v248 offset:8704
ds_write_b16 v232,v233 offset:0
M a[84:87],v[220:223],v[228:231],a[84:87]
ds_read_b128 a[208:211],v249 offset:8704
ds_write_b16_d16_hi v232,v233 offset:8704
M a[88:91],v[220:223],a[196:199],a[88:91]
ds_read_b128 v[228:231],v248 offset:9216
ds_write_b16 v252,v234 offset:52224
M a[88:91],a[192:195],a[212:215],a[88:91]
ds_read_b128 a[196:199],v249 offset:9216
ds_write_b16_d16_hi v252,v234 offset:60928
M a[88:91],a[236:239],a[232:235],a[88:91]
buffer_load_dwordx4 a[228:231],v250,s[20:23],s48 offen offset:0 sc1
M a[92:95],a[236:239],v[216:219],a[92:95]
v_add_u32 v232,69632,v252
M a[92:95],a[192:195],a[232:235],a[92:95]
ds_write_b16 v232,v235 offset:0
M a[92:95],v[220:223],a[212:215],a[92:95]
s_waitcnt vmcnt(14) lgkmcnt(8)
ds_write_b16_d16_hi v232,v235 offset:8704
M a[96:99],v[224:227],a[204:207],a[96:99]
s_waitcnt vmcnt(10) lgkmcnt(7)
buffer_load_dwordx4 a[216:219],v250,s[20:23],s48 offen offset:1024 sc1
M a[96:99],a[220:223],a[208:211],a[96:99]
s_waitcnt vmcnt(10) lgkmcnt(5)
ds_read_b128 a[236:239],v248 offset:9728
ds_read_b128 v[216:219],v249 offset:9728
M a[96:99],a[224:227],v[228:231],a[96:99]
s_waitcnt lgkmcnt(5)
v_permlane32_swap_b32 v196,v198
v_permlane32_swap_b32 v192,v194
M a[100:103],a[224:227],a[196:199],a[100:103]
v_permlane32_swap_b32 v200,v202
v_lshlrev_b32 v234,16,v198
M a[100:103],a[220:223],v[228:231],a[100:103]
buffer_load_dwordx4 a[200:203],v250,s[20:23],s48 offen offset:2048 sc1
M a[100:103],v[224:227],a[208:211],a[100:103]
s_add_u32 s46,s74,27648
v_lshlrev_b32 v232,16,v192
v_lshlrev_b32 v233,16,v196
M a[104:107],v[224:227],v[228:231],a[104:107]
ds_read_b128 a[192:195],v248 offset:10240
v_lshlrev_b32 v237,16,v194
M a[104:107],a[220:223],a[196:199],a[104:107]
s_waitcnt lgkmcnt(2)
ds_read_b128 a[232:235],v249 offset:10240
v_lshlrev_b32 v236,16,v202
M a[104:107],a[224:227],a[236:239],a[104:107]
s_waitcnt lgkmcnt(2)
buffer_load_dwordx4 a[248:251],v250,s[20:23],s46 offen offset:0 sc1
M a[108:111],a[224:227],v[216:219],a[108:111]
v_lshlrev_b32 v235,16,v200
v_fmac_f32 v232,s43,v234
M a[108:111],a[220:223],a[236:239],a[108:111]
v_fmac_f32 v237,4.0,v233
v_fma_f32 v238,-4.0,v234,v236
M a[108:111],v[224:227],a[196:199],a[108:111]
v_fmac_f32 v232,s45,v236
v_fmac_f32 v237,s41,v235
M a[112:115],v[224:227],a[236:239],a[112:115]
ds_read_b128 a[212:215],v249 offset:10752
v_sub_f32 v236,v236,v234
M a[112:115],a[220:223],v[216:219],a[112:115]
s_waitcnt lgkmcnt(2)
ds_read_b128 v[220:223],v248 offset:10752
v_fma_f32 v234,-4.0,v233,v235
M a[112:115],a[224:227],a[192:195],a[112:115]
s_waitcnt lgkmcnt(2)
v_sub_f32 v235,v235,v233
v_add_f32 v233,v238,v234
M a[116:119],a[224:227],a[232:235],a[116:119]
v_sub_f32 v238,v238,v234
v_fma_f32 v234,2.0,v235,v236
M a[116:119],a[220:223],a[192:195],a[116:119]
v_fmac_f32 v236,-2.0,v235
v_and_b32 v198,s42,v198
M a[116:119],v[224:227],v[216:219],a[116:119]
v_and_b32 v192,s42,v192
v_and_b32 v196,s42,v196
M a[120:123],v[224:227],a[192:195],a[120:123]
v_and_b32 v194,s42,v194
v_and_b32 v202,s42,v202
M a[120:123],a[220:223],a[232:235],a[120:123]
s_waitcnt lgkmcnt(1)
v_and_b32 v200,s42,v200
v_fmac_f32 v192,s43,v198
M a[120:123],a[224:227],a[212:215],a[120:123]
s_waitcnt lgkmcnt(0)
v_fmac_f32 v194,4.0,v196
v_fma_f32 v235,-4.0,v198,v202
M a[124:127],a[224:227],v[220:223],a[124:127]
buffer_load_dwordx4 a[224:227],v250,s[20:23],s46 offen offset:1024 sc1
M a[124:127],a[220:223],a[212:215],a[124:127]
v_fmac_f32 v192,s45,v202
v_fmac_f32 v194,s41,v200
M a[124:127],v[224:227],a[232:235],a[124:127]
s_waitcnt vmcnt(12)
buffer_load_dwordx4 a[220:223],v250,s[20:23],s46 offen offset:2048 sc1
M a[128:131],a[252:255],a[204:207],a[128:131]
s_waitcnt vmcnt(7)
s_add_u32 s47,s74,30720
v_sub_f32 v202,v202,v198
v_fma_f32 v198,-4.0,v196,v200
M a[128:131],a[240:243],a[208:211],a[128:131]
s_waitcnt vmcnt(6)
v_sub_f32 v200,v200,v196
v_add_f32 v196,v235,v198
M a[128:131],a[244:247],v[228:231],a[128:131]
v_sub_f32 v235,v235,v198
v_fma_f32 v198,2.0,v200,v202
M a[132:135],a[244:247],a[196:199],a[132:135]
buffer_load_dwordx4 v[224:227],v250,s[20:23],s47 offen offset:0 sc1
M a[132:135],a[240:243],v[228:231],a[132:135]
v_fmac_f32 v202,-2.0,v200
v_cvt_pk_bf16_f32 v192,v232,v192
M a[132:135],a[252:255],a[208:211],a[132:135]
v_cvt_pk_bf16_f32 v194,v237,v194
v_cvt_pk_bf16_f32 v196,v233,v196
M a[136:139],a[252:255],v[228:231],a[136:139]
v_cvt_pk_bf16_f32 v200,v234,v198
v_cvt_pk_bf16_f32 v198,v238,v235
M a[136:139],a[240:243],a[196:199],a[136:139]
v_cvt_pk_bf16_f32 v202,v236,v202
v_permlane32_swap_b32 v197,v199
M a[136:139],a[244:247],a[236:239],a[136:139]
v_permlane32_swap_b32 v193,v195
v_permlane32_swap_b32 v201,v203
M a[140:143],a[244:247],v[216:219],a[140:143]
v_lshlrev_b32 v234,16,v199
v_lshlrev_b32 v232,16,v193
M a[140:143],a[240:243],a[236:239],a[140:143]
v_lshlrev_b32 v233,16,v197
v_lshlrev_b32 v237,16,v195
M a[140:143],a[252:255],a[196:199],a[140:143]
v_lshlrev_b32 v236,16,v203
v_lshlrev_b32 v235,16,v201
M a[144:147],a[252:255],a[236:239],a[144:147]
v_fmac_f32 v232,s43,v234
v_fmac_f32 v237,4.0,v233
M a[144:147],a[240:243],v[216:219],a[144:147]
v_fma_f32 v238,-4.0,v234,v236
v_fmac_f32 v232,s45,v236
M a[144:147],a[244:247],a[192:195],a[144:147]
v_fmac_f32 v237,s41,v235
v_sub_f32 v236,v236,v234
M a[148:151],a[244:247],a[232:235],a[148:151]
v_fma_f32 v234,-4.0,v233,v235
v_sub_f32 v235,v235,v233
M a[148:151],a[240:243],a[192:195],a[148:151]
v_add_f32 v233,v238,v234
v_sub_f32 v238,v238,v234
M a[148:151],a[252:255],v[216:219],a[148:151]
v_fma_f32 v234,2.0,v235,v236
v_fmac_f32 v236,-2.0,v235
M a[152:155],a[252:255],a[192:195],a[152:155]
v_and_b32 v199,s42,v199
v_and_b32 v193,s42,v193
M a[152:155],a[240:243],a[232:235],a[152:155]
v_and_b32 v197,s42,v197
v_and_b32 v195,s42,v195
M a[152:155],a[244:247],a[212:215],a[152:155]
v_and_b32 v203,s42,v203
v_and_b32 v201,s42,v201
M a[156:159],a[244:247],v[220:223],a[156:159]
buffer_load_dwordx4 a[244:247],v250,s[20:23],s47 offen offset:1024 sc1
M a[156:159],a[240:243],a[212:215],a[156:159]
v_fmac_f32 v193,s43,v199
v_fmac_f32 v195,4.0,v197
M a[156:159],a[252:255],a[232:235],a[156:159]
s_waitcnt vmcnt(7)
buffer_load_dwordx4 a[240:243],v250,s[20:23],s47 offen offset:2048 sc1
M a[160:163],a[228:231],a[204:207],a[160:163]
s_waitcnt vmcnt(7)
s_add_u32 s48,s74,33792
v_fma_f32 v235,-4.0,v199,v203
v_fmac_f32 v193,s45,v203
M a[160:163],a[216:219],a[208:211],a[160:163]
s_waitcnt vmcnt(6)
v_fmac_f32 v195,s41,v201
v_sub_f32 v203,v203,v199
M a[160:163],a[200:203],v[228:231],a[160:163]
v_fma_f32 v199,-4.0,v197,v201
v_sub_f32 v201,v201,v197
M a[164:167],a[200:203],a[196:199],a[164:167]
buffer_load_dwordx4 a[252:255],v250,s[20:23],s48 offen offset:0 sc1
M a[164:167],a[216:219],v[228:231],a[164:167]
v_add_f32 v197,v235,v199
v_sub_f32 v235,v235,v199
M a[164:167],a[228:231],a[208:211],a[164:167]
v_fma_f32 v199,2.0,v201,v203
v_fmac_f32 v203,-2.0,v201
M a[168:171],a[228:231],v[228:231],a[168:171]
v_cvt_pk_bf16_f32 v193,v232,v193
v_cvt_pk_bf16_f32 v195,v237,v195
M a[168:171],a[216:219],a[196:199],a[168:171]
buffer_load_dwordx4 a[204:207],v250,s[20:23],s48 offen offset:1024 sc1
M a[168:171],a[200:203],a[236:239],a[168:171]
v_cvt_pk_bf16_f32 v197,v233,v197
v_cvt_pk_bf16_f32 v201,v234,v199
M a[172:175],a[200:203],v[216:219],a[172:175]
v_cvt_pk_bf16_f32 v199,v238,v235
v_cvt_pk_bf16_f32 v203,v236,v203
M a[172:175],a[216:219],a[236:239],a[172:175]
v_add_u32 v238,121856,v247
v_permlane32_swap_b32 v208,v210
M a[172:175],a[228:231],a[196:199],a[172:175]
buffer_load_dwordx4 a[208:211],v250,s[20:23],s48 offen offset:2048 sc1
M a[176:179],a[228:231],a[236:239],a[176:179]
s_add_u32 s46,s74,36864
v_permlane32_swap_b32 v204,v206
v_permlane32_swap_b32 v212,v214
M a[176:179],a[216:219],v[216:219],a[176:179]
v_lshlrev_b32 v234,16,v210
v_lshlrev_b32 v232,16,v204
M a[176:179],a[200:203],a[192:195],a[176:179]
ds_write2st64_b64 v238,v[192:193],v[194:195] offset0:2 offset1:19
M a[180:183],a[200:203],a[232:235],a[180:183]
s_add_u32 s28,s70,0
buffer_load_dwordx4 v[228:231],v250,s[20:23],s46 offen offset:0 sc1
M a[180:183],a[216:219],a[192:195],a[180:183]
ds_read_b128 a[196:199],v248 offset:17408
s_mov_b64 exec,s[86:87]
v_xor_b32 v245,0x80000000,v245
v_xor_b32 v251,0x80000000,v251
s_mov_b64 exec,-1
M a[180:183],a[228:231],v[216:219],a[180:183]
ds_write2st64_b64 v247,v[196:197],v[198:199] offset0:104 offset1:121
M a[184:187],a[228:231],a[192:195],a[184:187]
buffer_load_dwordx4 v[192:195],v251,s[88:91],s28 offen offset:0
M a[184:187],a[216:219],a[232:235],a[184:187]
ds_read_b128 a[236:239],v249 offset:17408
ds_read_b128 v[216:219],v248 offset:17920
M a[184:187],a[200:203],a[212:215],a[184:187]
ds_write2st64_b64 v247,v[200:201],v[202:203] offset0:138 offset1:155
M a[188:191],a[200:203],v[220:223],a[188:191]
buffer_load_dwordx4 v[196:199],v245,s[8:11],s28 offen offset:0
M a[188:191],a[216:219],a[212:215],a[188:191]
ds_read_b128 a[192:195],v249 offset:17920
v_lshlrev_b32 v233,16,v208
M a[188:191],a[228:231],a[232:235],a[188:191]
s_waitcnt vmcnt(11) lgkmcnt(5)
v_lshlrev_b32 v237,16,v206
v_lshlrev_b32 v236,16,v214
M v[0:3],a[248:251],a[196:199],v[0:3]
s_waitcnt vmcnt(10) lgkmcnt(3)
ds_read_b128 a[200:203],v248 offset:18432
v_lshlrev_b32 v235,16,v212
M v[0:3],a[224:227],a[236:239],v[0:3]
s_waitcnt vmcnt(9) lgkmcnt(3)
buffer_load_dwordx4 v[200:203],v245,s[8:11],s28 offen offset:768
M v[0:3],a[220:223],v[216:219],v[0:3]
s_waitcnt lgkmcnt(1)
ds_read_b128 v[220:223],v249 offset:18432
s_mov_b64 exec,s[86:87]
v_xor_b32 v245,0x80000000,v245
v_xor_b32 v251,0x80000000,v251
s_mov_b64 exec,-1
M v[4:7],a[220:223],a[192:195],v[4:7]
s_add_u32 s29,s70,0
v_fmac_f32 v232,s43,v234
v_fmac_f32 v237,4.0,v233
M v[4:7],a[224:227],v[216:219],v[4:7]
v_fma_f32 v238,-4.0,v234,v236
v_fmac_f32 v232,s45,v236
M v[4:7],a[248:251],a[236:239],v[4:7]
buffer_load_short_d16_hi v239,v246,s[12:15],s29 offen offset:0
M v[8:11],a[248:251],v[216:219],v[8:11]
ds_read_b128 a[212:215],v248 offset:18944
v_fmac_f32 v237,s41,v235
M v[8:11],a[224:227],a[192:195],v[8:11]
s_waitcnt lgkmcnt(2)
buffer_load_short_d16_hi v240,v246,s[8:11],s29 offen offset:0
M v[8:11],a[220:223],a[200:203],v[8:11]
s_waitcnt lgkmcnt(1)
ds_read_b128 a[216:219],v249 offset:18944
v_sub_f32 v236,v236,v234
M v[12:15],a[220:223],v[220:223],v[12:15]
buffer_load_short_d16_hi v241,v246,s[8:11],s29 offen offset:384
M v[12:15],a[224:227],a[200:203],v[12:15]
v_fma_f32 v234,-4.0,v233,v235
v_sub_f32 v235,v235,v233
M v[12:15],a[248:251],a[192:195],v[12:15]
buffer_load_short_d16_hi v242,v246,s[8:11],s29 offen offset:768
M v[16:19],a[248:251],a[200:203],v[16:19]
ds_read_b128 a[228:231],v249 offset:19456
v_add_f32 v233,v238,v234
M v[16:19],a[224:227],v[220:223],v[16:19]
s_waitcnt lgkmcnt(2)
buffer_load_short_d16_hi v243,v246,s[8:11],s29 offen offset:1152
M v[16:19],a[220:223],a[212:215],v[16:19]
s_waitcnt lgkmcnt(1)
ds_read_b128 a[232:235],v248 offset:19456
v_sub_f32 v238,v238,v234
M v[20:23],a[220:223],a[216:219],v[20:23]
buffer_load_short_d16_hi v244,v246,s[16:19],s29 offen offset:1536
M v[20:23],a[224:227],a[212:215],v[20:23]
v_fma_f32 v234,2.0,v235,v236
v_fmac_f32 v236,-2.0,v235
M v[20:23],a[248:251],v[220:223],v[20:23]
v_and_b32 v210,s42,v210
v_and_b32 v204,s42,v204
M v[24:27],a[248:251],a[212:215],v[24:27]
v_and_b32 v208,s42,v208
v_and_b32 v206,s42,v206
M v[24:27],a[224:227],a[216:219],v[24:27]
s_waitcnt lgkmcnt(1)
v_and_b32 v214,s42,v214
v_and_b32 v212,s42,v212
M v[24:27],a[220:223],a[228:231],v[24:27]
s_waitcnt lgkmcnt(0)
v_fmac_f32 v204,s43,v210
v_fmac_f32 v206,4.0,v208
M v[28:31],a[220:223],a[232:235],v[28:31]
buffer_load_dwordx4 a[220:223],v250,s[20:23],s46 offen offset:1024 sc1
M v[28:31],a[224:227],a[228:231],v[28:31]
v_fma_f32 v235,-4.0,v210,v214
v_fmac_f32 v204,s45,v214
M v[28:31],a[248:251],a[216:219],v[28:31]
s_waitcnt vmcnt(16)
buffer_load_dwordx4 a[224:227],v250,s[20:23],s46 offen offset:2048 sc1
M v[32:35],v[224:227],a[196:199],v[32:35]
s_waitcnt vmcnt(16)
s_add_u32 s47,s74,39936
v_fmac_f32 v206,s41,v212
v_sub_f32 v214,v214,v210
M v[32:35],a[244:247],a[236:239],v[32:35]
s_waitcnt vmcnt(15)
v_fma_f32 v210,-4.0,v208,v212
v_sub_f32 v212,v212,v208
M v[32:35],a[240:243],v[216:219],v[32:35]
v_add_f32 v208,v235,v210
v_sub_f32 v235,v235,v210
M v[36:39],a[240:243],a[192:195],v[36:39]
buffer_load_dwordx4 a[248:251],v250,s[20:23],s47 offen offset:0 sc1
M v[36:39],a[244:247],v[216:219],v[36:39]
v_fma_f32 v210,2.0,v212,v214
v_fmac_f32 v214,-2.0,v212
M v[36:39],v[224:227],a[236:239],v[36:39]
v_cvt_pk_bf16_f32 v204,v232,v204
v_cvt_pk_bf16_f32 v206,v237,v206
M v[40:43],v[224:227],v[216:219],v[40:43]
v_cvt_pk_bf16_f32 v208,v233,v208
v_cvt_pk_bf16_f32 v212,v234,v210
M v[40:43],a[244:247],a[192:195],v[40:43]
v_cvt_pk_bf16_f32 v210,v238,v235
v_cvt_pk_bf16_f32 v214,v236,v214
M v[40:43],a[240:243],a[200:203],v[40:43]
v_permlane32_swap_b32 v209,v211
v_permlane32_swap_b32 v205,v207
M v[44:47],a[240:243],v[220:223],v[44:47]
v_permlane32_swap_b32 v213,v215
v_lshlrev_b32 v234,16,v211
M v[44:47],a[244:247],a[200:203],v[44:47]
v_lshlrev_b32 v232,16,v205
v_lshlrev_b32 v233,16,v209
M v[44:47],v[224:227],a[192:195],v[44:47]
v_lshlrev_b32 v237,16,v207
v_lshlrev_b32 v236,16,v215
M v[48:51],v[224:227],a[200:203],v[48:51]
v_lshlrev_b32 v235,16,v213
v_fmac_f32 v232,s43,v234
M v[48:51],a[244:247],v[220:223],v[48:51]
v_fmac_f32 v237,4.0,v233
v_fma_f32 v238,-4.0,v234,v236
M v[48:51],a[240:243],a[212:215],v[48:51]
v_fmac_f32 v232,s45,v236
v_fmac_f32 v237,s41,v235
M v[52:55],a[240:243],a[216:219],v[52:55]
v_sub_f32 v236,v236,v234
v_fma_f32 v234,-4.0,v233,v235
M v[52:55],a[244:247],a[212:215],v[52:55]
v_sub_f32 v235,v235,v233
v_add_f32 v233,v238,v234
M v[52:55],v[224:227],v[220:223],v[52:55]
v_sub_f32 v238,v238,v234
v_fma_f32 v234,2.0,v235,v236
M v[56:59],v[224:227],a[212:215],v[56:59]
v_fmac_f32 v236,-2.0,v235
v_and_b32 v211,s42,v211
M v[56:59],a[244:247],a[216:219],v[56:59]
v_and_b32 v205,s42,v205
v_and_b32 v209,s42,v209
M v[56:59],a[240:243],a[228:231],v[56:59]
v_and_b32 v207,s42,v207
v_and_b32 v215,s42,v215
M v[60:63],a[240:243],a[232:235],v[60:63]
buffer_load_dwordx4 a[240:243],v250,s[20:23],s47 offen offset:1024 sc1
M v[60:63],a[244:247],a[228:231],v[60:63]
v_and_b32 v213,s42,v213
v_fmac_f32 v205,s43,v211
M v[60:63],v[224:227],a[216:219],v[60:63]
s_waitcnt vmcnt(16)
buffer_load_dwordx4 a[244:247],v250,s[20:23],s47 offen offset:2048 sc1
M v[64:67],a[252:255],a[196:199],v[64:67]
s_waitcnt vmcnt(16)
s_add_u32 s48,s74,43008
v_fmac_f32 v207,4.0,v209
v_fma_f32 v235,-4.0,v211,v215
M v[64:67],a[204:207],a[236:239],v[64:67]
s_waitcnt vmcnt(15)
v_fmac_f32 v205,s45,v215
v_fmac_f32 v207,s41,v213
M v[64:67],a[208:211],v[216:219],v[64:67]
v_sub_f32 v215,v215,v211
v_fma_f32 v211,-4.0,v209,v213
M v[68:71],a[208:211],a[192:195],v[68:71]
buffer_load_dwordx4 v[224:227],v250,s[20:23],s48 offen offset:0 sc1
M v[68:71],a[204:207],v[216:219],v[68:71]
v_sub_f32 v213,v213,v209
v_add_f32 v209,v235,v211
M v[68:71],a[252:255],a[236:239],v[68:71]
v_sub_f32 v235,v235,v211
v_fma_f32 v211,2.0,v213,v215
M v[72:75],a[252:255],v[216:219],v[72:75]
v_fmac_f32 v215,-2.0,v213
v_cvt_pk_bf16_f32 v205,v232,v205
M v[72:75],a[204:207],a[192:195],v[72:75]
buffer_load_dwordx4 a[196:199],v250,s[20:23],s48 offen offset:1024 sc1
M v[72:75],a[208:211],a[200:203],v[72:75]
v_cvt_pk_bf16_f32 v207,v237,v207
v_cvt_pk_bf16_f32 v209,v233,v209
M v[76:79],a[208:211],v[220:223],v[76:79]
v_cvt_pk_bf16_f32 v213,v234,v211
v_cvt_pk_bf16_f32 v211,v238,v235
M v[76:79],a[204:207],a[200:203],v[76:79]
v_cvt_pk_bf16_f32 v215,v236,v215
v_add_u32 v238,121856,v247
M v[76:79],a[252:255],a[192:195],v[76:79]
buffer_load_dwordx4 a[236:239],v250,s[20:23],s48 offen offset:2048 sc1
M v[80:83],a[252:255],a[200:203],v[80:83]
s_add_u32 s46,s75,9216
M v[80:83],a[204:207],v[220:223],v[80:83]
M v[80:83],a[208:211],a[212:215],v[80:83]
ds_write2st64_b64 v238,v[204:205],v[206:207] offset0:3 offset1:20
M v[84:87],a[208:211],a[216:219],v[84:87]
s_add_u32 s28,s70,393216
buffer_load_dwordx4 v[216:219],v250,s[20:23],s46 offen offset:0 sc1
M v[84:87],a[204:207],a[212:215],v[84:87]
ds_read_b128 a[192:195],v248 offset:26112
M v[84:87],a[252:255],v[220:223],v[84:87]
ds_write2st64_b64 v247,v[208:209],v[210:211] offset0:105 offset1:122
M v[88:91],a[252:255],a[212:215],v[88:91]
buffer_load_dwordx4 v[204:207],v251,s[88:91],s28 offen offset:0
M v[88:91],a[204:207],a[216:219],v[88:91]
ds_read_b128 a[200:203],v249 offset:26112
ds_read_b128 v[220:223],v248 offset:26624
M v[88:91],a[208:211],a[228:231],v[88:91]
ds_write2st64_b64 v247,v[212:213],v[214:215] offset0:139 offset1:156
M v[92:95],a[208:211],a[232:235],v[92:95]
buffer_load_dwordx4 v[208:211],v245,s[8:11],s28 offen offset:0
M v[92:95],a[204:207],a[228:231],v[92:95]
s_waitcnt vmcnt(18)
ds_read_b128 a[212:215],v249 offset:26624
v_permlane32_swap_b32 v196,v198
M v[92:95],a[252:255],a[216:219],v[92:95]
s_waitcnt vmcnt(17) lgkmcnt(5)
v_permlane32_swap_b32 v192,v194
v_permlane32_swap_b32 v200,v202
M v[96:99],v[228:231],a[192:195],v[96:99]
s_waitcnt vmcnt(10) lgkmcnt(3)
ds_read_b128 a[208:211],v248 offset:27136
v_lshlrev_b32 v234,16,v198
M v[96:99],a[220:223],a[200:203],v[96:99]
s_waitcnt vmcnt(9) lgkmcnt(3)
buffer_load_dwordx4 v[212:215],v245,s[8:11],s28 offen offset:768
M v[96:99],a[224:227],v[220:223],v[96:99]
s_waitcnt lgkmcnt(1)
ds_read_b128 a[232:235],v249 offset:27136
v_lshlrev_b32 v232,16,v192
M v[100:103],a[224:227],a[212:215],v[100:103]
v_lshlrev_b32 v233,16,v196
v_lshlrev_b32 v237,16,v194
M v[100:103],a[220:223],v[220:223],v[100:103]
v_lshlrev_b32 v236,16,v202
v_lshlrev_b32 v235,16,v200
M v[100:103],v[228:231],a[200:203],v[100:103]
v_fmac_f32 v232,s43,v234
v_fmac_f32 v237,4.0,v233
M v[104:107],v[228:231],v[220:223],v[104:107]
ds_read_b128 a[204:207],v248 offset:27648
v_fma_f32 v238,-4.0,v234,v236
M v[104:107],a[220:223],a[212:215],v[104:107]
s_waitcnt lgkmcnt(2)
ds_read_b128 a[228:231],v249 offset:27648
v_fmac_f32 v232,s45,v236
M v[104:107],a[224:227],a[208:211],v[104:107]
s_waitcnt lgkmcnt(2)
v_fmac_f32 v237,s41,v235
v_sub_f32 v236,v236,v234
M v[108:111],a[224:227],a[232:235],v[108:111]
v_fma_f32 v234,-4.0,v233,v235
v_sub_f32 v235,v235,v233
M v[108:111],a[220:223],a[208:211],v[108:111]
v_add_f32 v233,v238,v234
v_sub_f32 v238,v238,v234
M v[108:111],v[228:231],a[212:215],v[108:111]
v_fma_f32 v234,2.0,v235,v236
v_fmac_f32 v236,-2.0,v235
M v[112:115],v[228:231],a[208:211],v[112:115]
ds_read_b128 a[216:219],v249 offset:28160
v_and_b32 v198,s42,v198
M v[112:115],a[220:223],a[232:235],v[112:115]
s_waitcnt lgkmcnt(2)
ds_read_b128 a[252:255],v248 offset:28160
v_and_b32 v192,s42,v192
M v[112:115],a[224:227],a[204:207],v[112:115]
s_waitcnt lgkmcnt(2)
v_and_b32 v196,s42,v196
v_and_b32 v194,s42,v194
M v[116:119],a[224:227],a[228:231],v[116:119]
v_and_b32 v202,s42,v202
v_and_b32 v200,s42,v200
M v[116:119],a[220:223],a[204:207],v[116:119]
v_fmac_f32 v192,s43,v198
v_fmac_f32 v194,4.0,v196
M v[116:119],v[228:231],a[232:235],v[116:119]
v_fma_f32 v235,-4.0,v198,v202
v_fmac_f32 v192,s45,v202
M v[120:123],v[228:231],a[204:207],v[120:123]
v_fmac_f32 v194,s41,v200
v_sub_f32 v202,v202,v198
M v[120:123],a[220:223],a[228:231],v[120:123]
s_waitcnt lgkmcnt(1)
v_fma_f32 v198,-4.0,v196,v200
v_sub_f32 v200,v200,v196
M v[120:123],a[224:227],a[216:219],v[120:123]
s_waitcnt lgkmcnt(0)
v_add_f32 v196,v235,v198
v_sub_f32 v235,v235,v198
M v[124:127],a[224:227],a[252:255],v[124:127]
buffer_load_dwordx4 a[224:227],v250,s[20:23],s46 offen offset:1024 sc1
M v[124:127],a[220:223],a[216:219],v[124:127]
v_fma_f32 v198,2.0,v200,v202
v_fmac_f32 v202,-2.0,v200
M v[124:127],v[228:231],a[228:231],v[124:127]
s_waitcnt vmcnt(10)
buffer_load_dwordx4 a[220:223],v250,s[20:23],s46 offen offset:2048 sc1
M v[128:131],a[248:251],a[192:195],v[128:131]
s_waitcnt vmcnt(10)
s_add_u32 s47,s75,12288
v_cvt_pk_bf16_f32 v192,v232,v192
v_cvt_pk_bf16_f32 v194,v237,v194
M v[128:131],a[240:243],a[200:203],v[128:131]
s_waitcnt vmcnt(9)
v_cvt_pk_bf16_f32 v196,v233,v196
v_cvt_pk_bf16_f32 v200,v234,v198
M v[128:131],a[244:247],v[220:223],v[128:131]
v_cvt_pk_bf16_f32 v198,v238,v235
v_cvt_pk_bf16_f32 v202,v236,v202
M v[132:135],a[244:247],a[212:215],v[132:135]
buffer_load_dwordx4 v[228:231],v250,s[20:23],s47 offen offset:0 sc1
M v[132:135],a[240:243],v[220:223],v[132:135]
v_permlane32_swap_b32 v197,v199
v_permlane32_swap_b32 v193,v195
M v[132:135],a[248:251],a[200:203],v[132:135]
v_permlane32_swap_b32 v201,v203
v_lshlrev_b32 v234,16,v199
M v[136:139],a[248:251],v[220:223],v[136:139]
v_lshlrev_b32 v232,16,v193
v_lshlrev_b32 v233,16,v197
M v[136:139],a[240:243],a[212:215],v[136:139]
v_lshlrev_b32 v237,16,v195
v_lshlrev_b32 v236,16,v203
M v[136:139],a[244:247],a[208:211],v[136:139]
v_lshlrev_b32 v235,16,v201
v_fmac_f32 v232,s43,v234
M v[140:143],a[244:247],a[232:235],v[140:143]
v_fmac_f32 v237,4.0,v233
v_fma_f32 v238,-4.0,v234,v236
M v[140:143],a[240:243],a[208:211],v[140:143]
v_fmac_f32 v232,s45,v236
v_fmac_f32 v237,s41,v235
M v[140:143],a[248:251],a[212:215],v[140:143]
v_sub_f32 v236,v236,v234
v_fma_f32 v234,-4.0,v233,v235
M v[144:147],a[248:251],a[208:211],v[144:147]
v_sub_f32 v235,v235,v233
v_add_f32 v233,v238,v234
M v[144:147],a[240:243],a[232:235],v[144:147]
v_sub_f32 v238,v238,v234
v_fma_f32 v234,2.0,v235,v236
M v[144:147],a[244:247],a[204:207],v[144:147]
v_fmac_f32 v236,-2.0,v235
v_and_b32 v199,s42,v199
M v[148:151],a[244:247],a[228:231],v[148:151]
v_and_b32 v193,s42,v193
v_and_b32 v197,s42,v197
M v[148:151],a[240:243],a[204:207],v[148:151]
v_and_b32 v195,s42,v195
v_and_b32 v203,s42,v203
M v[148:151],a[248:251],a[232:235],v[148:151]
v_and_b32 v201,s42,v201
v_fmac_f32 v193,s43,v199
M v[152:155],a[248:251],a[204:207],v[152:155]
v_fmac_f32 v195,4.0,v197
v_fma_f32 v235,-4.0,v199,v203
M v[152:155],a[240:243],a[228:231],v[152:155]
v_fmac_f32 v193,s45,v203
v_fmac_f32 v195,s41,v201
M v[152:155],a[244:247],a[216:219],v[152:155]
v_sub_f32 v203,v203,v199
v_fma_f32 v199,-4.0,v197,v201
M v[156:159],a[244:247],a[252:255],v[156:159]
buffer_load_dwordx4 a[244:247],v250,s[20:23],s47 offen offset:1024 sc1
M v[156:159],a[240:243],a[216:219],v[156:159]
v_sub_f32 v201,v201,v197
v_add_f32 v197,v235,v199
M v[156:159],a[248:251],a[228:231],v[156:159]
s_waitcnt vmcnt(10)
buffer_load_dwordx4 a[240:243],v250,s[20:23],s47 offen offset:2048 sc1
M v[160:163],v[224:227],a[192:195],v[160:163]
s_waitcnt vmcnt(10)
s_add_u32 s48,s75,15360
v_sub_f32 v235,v235,v199
v_fma_f32 v199,2.0,v201,v203
M v[160:163],a[196:199],a[200:203],v[160:163]
s_waitcnt vmcnt(9)
v_fmac_f32 v203,-2.0,v201
v_cvt_pk_bf16_f32 v193,v232,v193
M v[160:163],a[236:239],v[220:223],v[160:163]
v_cvt_pk_bf16_f32 v195,v237,v195
v_cvt_pk_bf16_f32 v197,v233,v197
M v[164:167],a[236:239],a[212:215],v[164:167]
buffer_load_dwordx4 a[248:251],v250,s[20:23],s48 offen offset:0 sc1
M v[164:167],a[196:199],v[220:223],v[164:167]
v_cvt_pk_bf16_f32 v201,v234,v199
v_cvt_pk_bf16_f32 v199,v238,v235
M v[164:167],v[224:227],a[200:203],v[164:167]
v_cvt_pk_bf16_f32 v203,v236,v203
v_add_u32 v238,139264,v247
M v[168:171],v[224:227],v[220:223],v[168:171]
M v[168:171],a[196:199],a[212:215],v[168:171]
buffer_load_dwordx4 a[192:195],v250,s[20:23],s48 offen offset:1024 sc1
M v[168:171],a[236:239],a[208:211],v[168:171]
M v[172:175],a[236:239],a[232:235],v[172:175]
M v[172:175],a[196:199],a[208:211],v[172:175]
M v[172:175],v[224:227],a[212:215],v[172:175]
buffer_load_dwordx4 a[200:203],v250,s[20:23],s48 offen offset:2048 sc1
M v[176:179],v[224:227],a[208:211],v[176:179]
s_add_u32 s46,s75,18432
M v[176:179],a[196:199],a[232:235],v[176:179]
M v[176:179],a[236:239],a[204:207],v[176:179]
s_barrier
ds_write2st64_b64 v238,v[192:193],v[194:195] offset0:0 offset1:17
M v[180:183],a[236:239],a[228:231],v[180:183]
s_add_u32 s28,s70,786432
buffer_load_dwordx4 v[220:223],v250,s[20:23],s46 offen offset:0 sc1
M v[180:183],a[196:199],a[204:207],v[180:183]
ds_read_b128 a[212:215],v248 offset:34816
M v[180:183],v[224:227],a[232:235],v[180:183]
ds_write2st64_b64 v247,v[196:197],v[198:199] offset0:34 offset1:51
M v[184:187],v[224:227],a[204:207],v[184:187]
buffer_load_dwordx4 v[192:195],v251,s[88:91],s28 offen offset:0
M v[184:187],a[196:199],a[228:231],v[184:187]
ds_read_b128 a[208:211],v249 offset:34816
ds_read_b128 a[232:235],v248 offset:35328
M v[184:187],a[236:239],a[216:219],v[184:187]
ds_write2st64_b64 v247,v[200:201],v[202:203] offset0:68 offset1:85
M v[188:191],a[236:239],a[252:255],v[188:191]
buffer_load_dwordx4 v[196:199],v245,s[8:11],s28 offen offset:0
M v[188:191],a[196:199],a[216:219],v[188:191]
s_waitcnt vmcnt(12)
ds_read_b128 a[204:207],v249 offset:35328
v_permlane32_swap_b32 v208,v210
M v[188:191],v[224:227],a[228:231],v[188:191]
s_waitcnt vmcnt(11) lgkmcnt(5)
v_permlane32_swap_b32 v204,v206
v_permlane32_swap_b32 v212,v214
M a[0:3],v[216:219],a[212:215],a[0:3]
s_waitcnt vmcnt(10) lgkmcnt(3)
ds_read_b128 a[236:239],v248 offset:35840
v_lshlrev_b32 v234,16,v210
M a[0:3],a[224:227],a[208:211],a[0:3]
s_waitcnt vmcnt(9) lgkmcnt(3)
buffer_load_dwordx4 v[200:203],v245,s[8:11],s28 offen offset:768
M a[0:3],a[220:223],a[232:235],a[0:3]
s_waitcnt lgkmcnt(1)
ds_read_b128 a[252:255],v249 offset:35840
v_lshlrev_b32 v232,16,v204
M a[4:7],a[220:223],a[204:207],a[4:7]
v_lshlrev_b32 v233,16,v208
v_lshlrev_b32 v237,16,v206
M a[4:7],a[224:227],a[232:235],a[4:7]
v_lshlrev_b32 v236,16,v214
v_lshlrev_b32 v235,16,v212
M a[4:7],v[216:219],a[208:211],a[4:7]
v_fmac_f32 v232,s43,v234
v_fmac_f32 v237,4.0,v233
M a[8:11],v[216:219],a[232:235],a[8:11]
ds_read_b128 a[196:199],v248 offset:36352
v_fma_f32 v238,-4.0,v234,v236
M a[8:11],a[224:227],a[204:207],a[8:11]
s_waitcnt lgkmcnt(2)
ds_read_b128 a[216:219],v249 offset:36352
v_fmac_f32 v232,s45,v236
M a[8:11],a[220:223],a[236:239],a[8:11]
s_waitcnt lgkmcnt(2)
v_fmac_f32 v237,s41,v235
v_sub_f32 v236,v236,v234
M a[12:15],a[220:223],a[252:255],a[12:15]
v_fma_f32 v234,-4.0,v233,v235
v_sub_f32 v235,v235,v233
M a[12:15],a[224:227],a[236:239],a[12:15]
v_add_f32 v233,v238,v234
v_sub_f32 v238,v238,v234
M a[12:15],v[216:219],a[204:207],a[12:15]
v_fma_f32 v234,2.0,v235,v236
v_fmac_f32 v236,-2.0,v235
M a[16:19],v[216:219],a[236:239],a[16:19]
ds_read_b128 a[228:231],v249 offset:36864
v_and_b32 v210,s42,v210
M a[16:19],a[224:227],a[252:255],a[16:19]
s_waitcnt lgkmcnt(2)
ds_read_b128 v[224:227],v248 offset:36864
v_and_b32 v204,s42,v204
M a[16:19],a[220:223],a[196:199],a[16:19]
s_waitcnt lgkmcnt(2)
v_and_b32 v208,s42,v208
v_and_b32 v206,s42,v206
M a[20:23],a[220:223],a[216:219],a[20:23]
v_and_b32 v214,s42,v214
v_and_b32 v212,s42,v212
M a[20:23],a[224:227],a[196:199],a[20:23]
v_fmac_f32 v204,s43,v210
v_fmac_f32 v206,4.0,v208
M a[20:23],v[216:219],a[252:255],a[20:23]
v_fma_f32 v235,-4.0,v210,v214
v_fmac_f32 v204,s45,v214
M a[24:27],v[216:219],a[196:199],a[24:27]
v_fmac_f32 v206,s41,v212
v_sub_f32 v214,v214,v210
M a[24:27],a[224:227],a[216:219],a[24:27]
s_waitcnt lgkmcnt(1)
v_fma_f32 v210,-4.0,v208,v212
v_sub_f32 v212,v212,v208
M a[24:27],a[220:223],a[228:231],a[24:27]
s_waitcnt lgkmcnt(0)
v_add_f32 v208,v235,v210
v_sub_f32 v235,v235,v210
M a[28:31],a[220:223],v[224:227],a[28:31]
buffer_load_dwordx4 a[220:223],v250,s[20:23],s46 offen offset:1024 sc1
M a[28:31],a[224:227],a[228:231],a[28:31]
v_fma_f32 v210,2.0,v212,v214
v_fmac_f32 v214,-2.0,v212
M a[28:31],v[216:219],a[216:219],a[28:31]
s_waitcnt vmcnt(10)
buffer_load_dwordx4 a[224:227],v250,s[20:23],s46 offen offset:2048 sc1
M a[32:35],v[228:231],a[212:215],a[32:35]
s_waitcnt vmcnt(10)
s_add_u32 s47,s75,21504
v_cvt_pk_bf16_f32 v204,v232,v204
v_cvt_pk_bf16_f32 v206,v237,v206
M a[32:35],a[244:247],a[208:211],a[32:35]
s_waitcnt vmcnt(9)
v_cvt_pk_bf16_f32 v208,v233,v208
v_cvt_pk_bf16_f32 v212,v234,v210
M a[32:35],a[240:243],a[232:235],a[32:35]
v_cvt_pk_bf16_f32 v210,v238,v235
v_cvt_pk_bf16_f32 v214,v236,v214
M a[36:39],a[240:243],a[204:207],a[36:39]
buffer_load_dwordx4 v[216:219],v250,s[20:23],s47 offen offset:0 sc1
M a[36:39],a[244:247],a[232:235],a[36:39]
v_permlane32_swap_b32 v209,v211
v_permlane32_swap_b32 v205,v207
M a[36:39],v[228:231],a[208:211],a[36:39]
v_permlane32_swap_b32 v213,v215
v_lshlrev_b32 v234,16,v211
M a[40:43],v[228:231],a[232:235],a[40:43]
v_lshlrev_b32 v232,16,v205
v_lshlrev_b32 v233,16,v209
M a[40:43],a[244:247],a[204:207],a[40:43]
v_lshlrev_b32 v237,16,v207
v_lshlrev_b32 v236,16,v215
M a[40:43],a[240:243],a[236:239],a[40:43]
v_lshlrev_b32 v235,16,v213
v_fmac_f32 v232,s43,v234
M a[44:47],a[240:243],a[252:255],a[44:47]
v_fmac_f32 v237,4.0,v233
v_fma_f32 v238,-4.0,v234,v236
M a[44:47],a[244:247],a[236:239],a[44:47]
v_fmac_f32 v232,s45,v236
v_fmac_f32 v237,s41,v235
M a[44:47],v[228:231],a[204:207],a[44:47]
v_sub_f32 v236,v236,v234
v_fma_f32 v234,-4.0,v233,v235
M a[48:51],v[228:231],a[236:239],a[48:51]
v_sub_f32 v235,v235,v233
v_add_f32 v233,v238,v234
M a[48:51],a[244:247],a[252:255],a[48:51]
v_sub_f32 v238,v238,v234
v_fma_f32 v234,2.0,v235,v236
M a[48:51],a[240:243],a[196:199],a[48:51]
v_fmac_f32 v236,-2.0,v235
v_and_b32 v211,s42,v211
M a[52:55],a[240:243],a[216:219],a[52:55]
v_and_b32 v205,s42,v205
v_and_b32 v209,s42,v209
M a[52:55],a[244:247],a[196:199],a[52:55]
v_and_b32 v207,s42,v207
v_and_b32 v215,s42,v215
M a[52:55],v[228:231],a[252:255],a[52:55]
v_and_b32 v213,s42,v213
v_fmac_f32 v205,s43,v211
M a[56:59],v[228:231],a[196:199],a[56:59]
v_fmac_f32 v207,4.0,v209
v_fma_f32 v235,-4.0,v211,v215
M a[56:59],a[244:247],a[216:219],a[56:59]
v_fmac_f32 v205,s45,v215
v_fmac_f32 v207,s41,v213
M a[56:59],a[240:243],a[228:231],a[56:59]
v_sub_f32 v215,v215,v211
v_fma_f32 v211,-4.0,v209,v213
M a[60:63],a[240:243],v[224:227],a[60:63]
buffer_load_dwordx4 a[240:243],v250,s[20:23],s47 offen offset:1024 sc1
M a[60:63],a[244:247],a[228:231],a[60:63]
v_sub_f32 v213,v213,v209
v_add_f32 v209,v235,v211
M a[60:63],v[228:231],a[216:219],a[60:63]
s_waitcnt vmcnt(10)
buffer_load_dwordx4 a[244:247],v250,s[20:23],s47 offen offset:2048 sc1
M a[64:67],a[248:251],a[212:215],a[64:67]
s_waitcnt vmcnt(10)
s_add_u32 s48,s75,24576
v_sub_f32 v235,v235,v211
v_fma_f32 v211,2.0,v213,v215
M a[64:67],a[192:195],a[208:211],a[64:67]
s_waitcnt vmcnt(9)
v_fmac_f32 v215,-2.0,v213
v_cvt_pk_bf16_f32 v205,v232,v205
M a[64:67],a[200:203],a[232:235],a[64:67]
v_cvt_pk_bf16_f32 v207,v237,v207
v_cvt_pk_bf16_f32 v209,v233,v209
M a[68:71],a[200:203],a[204:207],a[68:71]
buffer_load_dwordx4 v[228:231],v250,s[20:23],s48 offen offset:0 sc1
M a[68:71],a[192:195],a[232:235],a[68:71]
v_cvt_pk_bf16_f32 v213,v234,v211
v_cvt_pk_bf16_f32 v211,v238,v235
M a[68:71],a[248:251],a[208:211],a[68:71]
v_cvt_pk_bf16_f32 v215,v236,v215
v_add_u32 v238,139264,v247
M a[72:75],a[248:251],a[232:235],a[72:75]
v_fmac_f32 v239,s43,v241
v_fmac_f32 v244,4.0,v240
M a[72:75],a[192:195],a[204:207],a[72:75]
buffer_load_dwordx4 a[212:215],v250,s[20:23],s48 offen offset:1024 sc1
M a[72:75],a[200:203],a[236:239],a[72:75]
ds_write2st64_b64 v238,v[204:205],v[206:207] offset0:1 offset1:18
M a[76:79],a[200:203],a[252:255],a[76:79]
s_add_u32 s28,s70,1179648
v_fma_f32 v232,-4.0,v241,v243
v_fmac_f32 v239,s45,v243
M a[76:79],a[192:195],a[236:239],a[76:79]
v_fmac_f32 v244,s41,v242
v_sub_f32 v243,v243,v241
M a[76:79],a[248:251],a[204:207],a[76:79]
buffer_load_dwordx4 a[208:211],v250,s[20:23],s48 offen offset:2048 sc1
M a[80:83],a[248:251],a[236:239],a[80:83]
s_add_u32 s46,s75,27648
v_fma_f32 v241,-4.0,v240,v242
v_sub_f32 v242,v242,v240
M a[80:83],a[192:195],a[252:255],a[80:83]
v_add_f32 v240,v232,v241
v_sub_f32 v232,v232,v241
M a[80:83],a[200:203],a[196:199],a[80:83]
ds_write2st64_b64 v247,v[208:209],v[210:211] offset0:35 offset1:52
M a[84:87],a[200:203],a[216:219],a[84:87]
buffer_load_dwordx4 a[232:235],v250,s[20:23],s46 offen offset:0 sc1
M a[84:87],a[192:195],a[196:199],a[84:87]
ds_read_b128 a[204:207],v248 offset:43520
v_fma_f32 v241,2.0,v242,v243
M a[84:87],a[248:251],a[252:255],a[84:87]
ds_write2st64_b64 v247,v[212:213],v[214:215] offset0:69 offset1:86
M a[88:91],a[248:251],a[196:199],a[88:91]
buffer_load_dwordx4 v[204:207],v251,s[88:91],s28 offen offset:0
M a[88:91],a[192:195],a[216:219],a[88:91]
ds_read_b128 a[236:239],v249 offset:43520
ds_read_b128 a[252:255],v248 offset:44032
M a[88:91],a[200:203],a[228:231],a[88:91]
ds_read_b128 a[196:199],v249 offset:44032
v_fmac_f32 v243,-2.0,v242
M a[92:95],a[200:203],v[224:227],a[92:95]
buffer_load_dwordx4 v[208:211],v245,s[8:11],s28 offen offset:0
M a[92:95],a[192:195],a[228:231],a[92:95]
v_cvt_pk_bf16_f32 v233,v239,v244
v_cvt_pk_bf16_f32 v234,v240,v232
M a[92:95],a[248:251],a[216:219],a[92:95]
s_waitcnt vmcnt(14) lgkmcnt(4)
v_cvt_pk_bf16_f32 v235,v241,v243
v_add_u32 v232,139264,v252
M a[96:99],v[220:223],a[204:207],a[96:99]
s_waitcnt vmcnt(10) lgkmcnt(2)
ds_read_b128 a[200:203],v248 offset:44544
ds_write_b16 v232,v233 offset:0
M a[96:99],a[220:223],a[236:239],a[96:99]
s_waitcnt vmcnt(9) lgkmcnt(3)
buffer_load_dwordx4 v[212:215],v245,s[8:11],s28 offen offset:768
M a[96:99],a[224:227],a[252:255],a[96:99]
s_waitcnt lgkmcnt(2)
s_add_u32 s29,s71,0
ds_read_b128 v[224:227],v249 offset:44544
ds_write_b16_d16_hi v232,v233 offset:8704
M a[100:103],a[224:227],a[196:199],a[100:103]
ds_write_b16 v252,v234 offset:17408
M a[100:103],a[220:223],a[252:255],a[100:103]
ds_write_b16_d16_hi v252,v234 offset:26112
M a[100:103],v[220:223],a[236:239],a[100:103]
buffer_load_short_d16_hi v239,v246,s[12:15],s29 offen offset:0
M a[104:107],v[220:223],a[252:255],a[104:107]
ds_read_b128 a[192:195],v248 offset:45056
ds_write_b16 v252,v235 offset:34816
M a[104:107],a[220:223],a[196:199],a[104:107]
s_waitcnt lgkmcnt(7)
buffer_load_short_d16_hi v240,v246,s[8:11],s29 offen offset:0
M a[104:107],a[224:227],a[200:203],a[104:107]
s_waitcnt lgkmcnt(5)
buffer_load_short_d16_hi v241,v246,s[8:11],s29 offen offset:384
M a[108:111],a[224:227],v[224:227],a[108:111]
ds_read_b128 a[228:231],v249 offset:45056
ds_write_b16_d16_hi v252,v235 offset:43520
M a[108:111],a[220:223],a[200:203],a[108:111]
buffer_load_short_d16_hi v242,v246,s[8:11],s29 offen offset:768
M a[108:111],v[220:223],a[196:199],a[108:111]
v_permlane32_swap_b32 v196,v198
v_permlane32_swap_b32 v192,v194
M a[112:115],v[220:223],a[200:203],a[112:115]
buffer_load_short_d16_hi v243,v246,s[8:11],s29 offen offset:1152
M a[112:115],a[220:223],v[224:227],a[112:115]
s_waitcnt lgkmcnt(3)
ds_read_b128 a[216:219],v249 offset:45568
ds_read_b128 a[248:251],v248 offset:45568
M a[112:115],a[224:227],a[192:195],a[112:115]
s_waitcnt lgkmcnt(3)
buffer_load_short_d16_hi v244,v246,s[16:19],s29 offen offset:1536
M a[116:119],a[224:227],a[228:231],a[116:119]
v_permlane32_swap_b32 v200,v202
v_lshlrev_b32 v234,16,v198
M a[116:119],a[220:223],a[192:195],a[116:119]
v_lshlrev_b32 v232,16,v192
v_lshlrev_b32 v233,16,v196
M a[116:119],v[220:223],v[224:227],a[116:119]
v_lshlrev_b32 v237,16,v194
v_lshlrev_b32 v236,16,v202
M a[120:123],v[220:223],a[192:195],a[120:123]
v_lshlrev_b32 v235,16,v200
v_fmac_f32 v232,s43,v234
M a[120:123],a[220:223],a[228:231],a[120:123]
s_waitcnt lgkmcnt(1)
v_fmac_f32 v237,4.0,v233
v_fma_f32 v238,-4.0,v234,v236
M a[120:123],a[224:227],a[216:219],a[120:123]
s_waitcnt lgkmcnt(0)
v_fmac_f32 v232,s45,v236
v_fmac_f32 v237,s41,v235
M a[124:127],a[224:227],a[248:251],a[124:127]
buffer_load_dwordx4 a[224:227],v250,s[20:23],s46 offen offset:1024 sc1
M a[124:127],a[220:223],a[216:219],a[124:127]
v_sub_f32 v236,v236,v234
v_fma_f32 v234,-4.0,v233,v235
M a[124:127],v[220:223],a[228:231],a[124:127]
s_waitcnt vmcnt(16)
buffer_load_dwordx4 a[220:223],v250,s[20:23],s46 offen offset:2048 sc1
M a[128:131],v[216:219],a[204:207],a[128:131]
s_waitcnt vmcnt(16)
s_add_u32 s47,s75,30720
v_sub_f32 v235,v235,v233
v_add_f32 v233,v238,v234
M a[128:131],a[240:243],a[236:239],a[128:131]
s_waitcnt vmcnt(15)
v_sub_f32 v238,v238,v234
v_fma_f32 v234,2.0,v235,v236
M a[128:131],a[244:247],a[252:255],a[128:131]
v_fmac_f32 v236,-2.0,v235
v_and_b32 v198,s42,v198
M a[132:135],a[244:247],a[196:199],a[132:135]
buffer_load_dwordx4 v[220:223],v250,s[20:23],s47 offen offset:0 sc1
M a[132:135],a[240:243],a[252:255],a[132:135]
v_and_b32 v192,s42,v192
v_and_b32 v196,s42,v196
M a[132:135],v[216:219],a[236:239],a[132:135]
v_and_b32 v194,s42,v194
v_and_b32 v202,s42,v202
M a[136:139],v[216:219],a[252:255],a[136:139]
v_and_b32 v200,s42,v200
v_fmac_f32 v192,s43,v198
M a[136:139],a[240:243],a[196:199],a[136:139]
v_fmac_f32 v194,4.0,v196
v_fma_f32 v235,-4.0,v198,v202
M a[136:139],a[244:247],a[200:203],a[136:139]
v_fmac_f32 v192,s45,v202
v_fmac_f32 v194,s41,v200
M a[140:143],a[244:247],v[224:227],a[140:143]
v_sub_f32 v202,v202,v198
v_fma_f32 v198,-4.0,v196,v200
M a[140:143],a[240:243],a[200:203],a[140:143]
v_sub_f32 v200,v200,v196
v_add_f32 v196,v235,v198
M a[140:143],v[216:219],a[196:199],a[140:143]
v_sub_f32 v235,v235,v198
v_fma_f32 v198,2.0,v200,v202
M a[144:147],v[216:219],a[200:203],a[144:147]
v_fmac_f32 v202,-2.0,v200
v_cvt_pk_bf16_f32 v192,v232,v192
M a[144:147],a[240:243],v[224:227],a[144:147]
v_cvt_pk_bf16_f32 v194,v237,v194
v_cvt_pk_bf16_f32 v196,v233,v196
M a[144:147],a[244:247],a[192:195],a[144:147]
v_cvt_pk_bf16_f32 v200,v234,v198
v_cvt_pk_bf16_f32 v198,v238,v235
M a[148:151],a[244:247],a[228:231],a[148:151]
v_cvt_pk_bf16_f32 v202,v236,v202
v_permlane32_swap_b32 v197,v199
M a[148:151],a[240:243],a[192:195],a[148:151]
v_permlane32_swap_b32 v193,v195
v_permlane32_swap_b32 v201,v203
M a[148:151],v[216:219],v[224:227],a[148:151]
v_lshlrev_b32 v234,16,v199
v_lshlrev_b32 v232,16,v193
M a[152:155],v[216:219],a[192:195],a[152:155]
v_lshlrev_b32 v233,16,v197
v_lshlrev_b32 v237,16,v195
M a[152:155],a[240:243],a[228:231],a[152:155]
v_lshlrev_b32 v236,16,v203
v_lshlrev_b32 v235,16,v201
M a[152:155],a[244:247],a[216:219],a[152:155]
v_fmac_f32 v232,s43,v234
v_fmac_f32 v237,4.0,v233
M a[156:159],a[244:247],a[248:251],a[156:159]
buffer_load_dwordx4 a[244:247],v250,s[20:23],s47 offen offset:1024 sc1
M a[156:159],a[240:243],a[216:219],a[156:159]
v_fma_f32 v238,-4.0,v234,v236
v_fmac_f32 v232,s45,v236
M a[156:159],v[216:219],a[228:231],a[156:159]
s_waitcnt vmcnt(16)
buffer_load_dwordx4 a[240:243],v250,s[20:23],s47 offen offset:2048 sc1
M a[160:163],v[228:231],a[204:207],a[160:163]
s_waitcnt vmcnt(16)
s_add_u32 s48,s75,33792
v_fmac_f32 v237,s41,v235
v_sub_f32 v236,v236,v234
M a[160:163],a[212:215],a[236:239],a[160:163]
s_waitcnt vmcnt(15)
v_fma_f32 v234,-4.0,v233,v235
v_sub_f32 v235,v235,v233
M a[160:163],a[208:211],a[252:255],a[160:163]
v_add_f32 v233,v238,v234
v_sub_f32 v238,v238,v234
M a[164:167],a[208:211],a[196:199],a[164:167]
buffer_load_dwordx4 v[216:219],v250,s[20:23],s48 offen offset:0 sc1
M a[164:167],a[212:215],a[252:255],a[164:167]
v_fma_f32 v234,2.0,v235,v236
v_fmac_f32 v236,-2.0,v235
M a[164:167],v[228:231],a[236:239],a[164:167]
v_and_b32 v199,s42,v199
v_and_b32 v193,s42,v193
M a[168:171],v[228:231],a[252:255],a[168:171]
v_and_b32 v197,s42,v197
v_and_b32 v195,s42,v195
M a[168:171],a[212:215],a[196:199],a[168:171]
buffer_load_dwordx4 a[204:207],v250,s[20:23],s48 offen offset:1024 sc1
M a[168:171],a[208:211],a[200:203],a[168:171]
v_and_b32 v203,s42,v203
v_and_b32 v201,s42,v201
M a[172:175],a[208:211],v[224:227],a[172:175]
v_fmac_f32 v193,s43,v199
v_fmac_f32 v195,4.0,v197
M a[172:175],a[212:215],a[200:203],a[172:175]
v_fma_f32 v235,-4.0,v199,v203
v_fmac_f32 v193,s45,v203
M a[172:175],v[228:231],a[196:199],a[172:175]
buffer_load_dwordx4 a[236:239],v250,s[20:23],s48 offen offset:2048 sc1
M a[176:179],v[228:231],a[200:203],a[176:179]
s_add_u32 s46,s75,36864
v_fmac_f32 v195,s41,v201
v_sub_f32 v203,v203,v199
M a[176:179],a[212:215],v[224:227],a[176:179]
v_fma_f32 v199,-4.0,v197,v201
v_sub_f32 v201,v201,v197
M a[176:179],a[208:211],a[192:195],a[176:179]
v_add_f32 v197,v235,v199
v_sub_f32 v235,v235,v199
M a[180:183],a[208:211],a[228:231],a[180:183]
buffer_load_dwordx4 a[252:255],v250,s[20:23],s46 offen offset:0 sc1
M a[180:183],a[212:215],a[192:195],a[180:183]
ds_read_b128 a[196:199],v248 offset:52224
v_fma_f32 v199,2.0,v201,v203
M a[180:183],v[228:231],v[224:227],a[180:183]
ds_read_b128 a[200:203],v249 offset:52224
v_fmac_f32 v203,-2.0,v201
M a[184:187],v[228:231],a[192:195],a[184:187]
ds_read_b128 v[224:227],v248 offset:52736
v_cvt_pk_bf16_f32 v193,v232,v193
M a[184:187],a[212:215],a[228:231],a[184:187]
ds_read_b128 a[192:195],v249 offset:52736
v_cvt_pk_bf16_f32 v195,v237,v195
M a[184:187],a[208:211],a[216:219],a[184:187]
v_cvt_pk_bf16_f32 v197,v233,v197
v_cvt_pk_bf16_f32 v201,v234,v199
M a[188:191],a[208:211],a[248:251],a[188:191]
v_cvt_pk_bf16_f32 v199,v238,v235
v_cvt_pk_bf16_f32 v203,v236,v203
M a[188:191],a[212:215],a[216:219],a[188:191]
s_waitcnt vmcnt(16)
v_add_u32 v238,139264,v247
v_permlane32_swap_b32 v208,v210
M a[188:191],v[228:231],a[228:231],a[188:191]
s_waitcnt lgkmcnt(3)
ds_write2st64_b64 v238,v[192:193],v[194:195] offset0:2 offset1:19
M v[0:3],a[232:235],a[196:199],v[0:3]
s_waitcnt vmcnt(8) lgkmcnt(3)
s_add_u32 s28,s71,0
ds_read_b128 a[208:211],v248 offset:53248
s_mov_b64 exec,s[86:87]
v_xor_b32 v245,0x80000000,v245
v_xor_b32 v251,0x80000000,v251
s_mov_b64 exec,-1
M v[0:3],a[224:227],a[200:203],v[0:3]
s_waitcnt vmcnt(7) lgkmcnt(3)
buffer_load_dwordx4 v[192:195],v251,s[88:91],s28 offen offset:0
M v[0:3],a[220:223],v[224:227],v[0:3]
s_waitcnt lgkmcnt(2)
ds_write2st64_b64 v247,v[196:197],v[198:199] offset0:36 offset1:53
M v[4:7],a[220:223],a[192:195],v[4:7]
buffer_load_dwordx4 v[196:199],v245,s[8:11],s28 offen offset:0
M v[4:7],a[224:227],v[224:227],v[4:7]
ds_read_b128 a[248:251],v249 offset:53248
v_permlane32_swap_b32 v204,v206
M v[4:7],a[232:235],a[200:203],v[4:7]
ds_write2st64_b64 v247,v[200:201],v[202:203] offset0:70 offset1:87
M v[8:11],a[232:235],v[224:227],v[8:11]
buffer_load_dwordx4 v[200:203],v245,s[8:11],s28 offen offset:768
M v[8:11],a[224:227],a[192:195],v[8:11]
s_waitcnt lgkmcnt(3)
ds_read_b128 a[212:215],v248 offset:53760
ds_read_b128 a[216:219],v249 offset:53760
M v[8:11],a[220:223],a[208:211],v[8:11]
s_waitcnt lgkmcnt(3)
s_mov_b64 exec,s[86:87]
v_xor_b32 v245,0x80000000,v245
v_xor_b32 v251,0x80000000,v251
s_mov_b64 exec,-1
v_permlane32_swap_b32 v212,v214
M v[12:15],a[220:223],a[248:251],v[12:15]
v_lshlrev_b32 v234,16,v210
v_lshlrev_b32 v232,16,v204
M v[12:15],a[224:227],a[208:211],v[12:15]
v_lshlrev_b32 v233,16,v208
v_lshlrev_b32 v237,16,v206
M v[12:15],a[232:235],a[192:195],v[12:15]
v_lshlrev_b32 v236,16,v214
v_lshlrev_b32 v235,16,v212
M v[16:19],a[232:235],a[208:211],v[16:19]
ds_read_b128 a[228:231],v249 offset:54272
v_fmac_f32 v232,s43,v234
M v[16:19],a[224:227],a[248:251],v[16:19]
s_waitcnt lgkmcnt(2)
ds_read_b128 v[228:231],v248 offset:54272
v_fmac_f32 v237,4.0,v233
M v[16:19],a[220:223],a[212:215],v[16:19]
s_waitcnt lgkmcnt(2)
v_fma_f32 v238,-4.0,v234,v236
v_fmac_f32 v232,s45,v236
M v[20:23],a[220:223],a[216:219],v[20:23]
v_fmac_f32 v237,s41,v235
v_sub_f32 v236,v236,v234
M v[20:23],a[224:227],a[212:215],v[20:23]
v_fma_f32 v234,-4.0,v233,v235
v_sub_f32 v235,v235,v233
M v[20:23],a[232:235],a[248:251],v[20:23]
v_add_f32 v233,v238,v234
v_sub_f32 v238,v238,v234
M v[24:27],a[232:235],a[212:215],v[24:27]
v_fma_f32 v234,2.0,v235,v236
v_fmac_f32 v236,-2.0,v235
M v[24:27],a[224:227],a[216:219],v[24:27]
s_waitcnt lgkmcnt(1)
v_and_b32 v210,s42,v210
v_and_b32 v204,s42,v204
M v[24:27],a[220:223],a[228:231],v[24:27]
s_waitcnt lgkmcnt(0)
v_and_b32 v208,s42,v208
v_and_b32 v206,s42,v206
M v[28:31],a[220:223],v[228:231],v[28:31]
global_load_dword a220,v250,s[64:65]
M v[28:31],a[224:227],a[228:231],v[28:31]
buffer_load_dwordx4 a[220:223],v250,s[20:23],s46 offen offset:1024 sc1
M v[28:31],a[232:235],a[216:219],v[28:31]
s_waitcnt vmcnt(11)
v_and_b32 v214,s42,v214
v_and_b32 v212,s42,v212
M v[32:35],v[220:223],a[196:199],v[32:35]
s_waitcnt vmcnt(10)
v_fmac_f32 v204,s43,v210
v_fmac_f32 v206,4.0,v208
M v[32:35],a[244:247],a[200:203],v[32:35]
s_waitcnt vmcnt(9)
buffer_load_dwordx4 a[224:227],v250,s[20:23],s46 offen offset:2048 sc1
M v[32:35],a[240:243],v[224:227],v[32:35]
s_add_u32 s47,s75,39936
v_fma_f32 v235,-4.0,v210,v214
v_fmac_f32 v204,s45,v214
M v[36:39],a[240:243],a[192:195],v[36:39]
v_fmac_f32 v206,s41,v212
v_sub_f32 v214,v214,v210
M v[36:39],a[244:247],v[224:227],v[36:39]
v_fma_f32 v210,-4.0,v208,v212
v_sub_f32 v212,v212,v208
M v[36:39],v[220:223],a[200:203],v[36:39]
buffer_load_dwordx4 a[232:235],v250,s[20:23],s47 offen offset:0 sc1
M v[40:43],v[220:223],v[224:227],v[40:43]
v_add_f32 v208,v235,v210
v_sub_f32 v235,v235,v210
M v[40:43],a[244:247],a[192:195],v[40:43]
v_fma_f32 v210,2.0,v212,v214
v_fmac_f32 v214,-2.0,v212
M v[40:43],a[240:243],a[208:211],v[40:43]
v_cvt_pk_bf16_f32 v204,v232,v204
v_cvt_pk_bf16_f32 v206,v237,v206
M v[44:47],a[240:243],a[248:251],v[44:47]
v_cvt_pk_bf16_f32 v208,v233,v208
v_cvt_pk_bf16_f32 v212,v234,v210
M v[44:47],a[244:247],a[208:211],v[44:47]
v_cvt_pk_bf16_f32 v210,v238,v235
v_cvt_pk_bf16_f32 v214,v236,v214
M v[44:47],v[220:223],a[192:195],v[44:47]
v_permlane32_swap_b32 v209,v211
v_permlane32_swap_b32 v205,v207
M v[48:51],v[220:223],a[208:211],v[48:51]
v_permlane32_swap_b32 v213,v215
v_lshlrev_b32 v234,16,v211
M v[48:51],a[244:247],a[248:251],v[48:51]
v_lshlrev_b32 v232,16,v205
v_lshlrev_b32 v233,16,v209
M v[48:51],a[240:243],a[212:215],v[48:51]
v_lshlrev_b32 v237,16,v207
v_lshlrev_b32 v236,16,v215
M v[52:55],a[240:243],a[216:219],v[52:55]
v_lshlrev_b32 v235,16,v213
v_fmac_f32 v232,s43,v234
M v[52:55],a[244:247],a[212:215],v[52:55]
v_fmac_f32 v237,4.0,v233
v_fma_f32 v238,-4.0,v234,v236
M v[52:55],v[220:223],a[248:251],v[52:55]
v_fmac_f32 v232,s45,v236
v_fmac_f32 v237,s41,v235
M v[56:59],v[220:223],a[212:215],v[56:59]
v_sub_f32 v236,v236,v234
v_fma_f32 v234,-4.0,v233,v235
M v[56:59],a[244:247],a[216:219],v[56:59]
v_sub_f32 v235,v235,v233
v_add_f32 v233,v238,v234
M v[56:59],a[240:243],a[228:231],v[56:59]
v_sub_f32 v238,v238,v234
v_fma_f32 v234,2.0,v235,v236
M v[60:63],a[240:243],v[228:231],v[60:63]
buffer_load_dwordx4 a[240:243],v250,s[20:23],s47 offen offset:1024 sc1
M v[60:63],a[244:247],a[228:231],v[60:63]
v_fmac_f32 v236,-2.0,v235
v_and_b32 v211,s42,v211
M v[60:63],v[220:223],a[216:219],v[60:63]
s_waitcnt vmcnt(11)
buffer_load_dwordx4 a[244:247],v250,s[20:23],s47 offen offset:2048 sc1
M v[64:67],v[216:219],a[196:199],v[64:67]
s_waitcnt vmcnt(11)
s_add_u32 s48,s75,43008
v_and_b32 v205,s42,v205
v_and_b32 v209,s42,v209
M v[64:67],a[204:207],a[200:203],v[64:67]
s_waitcnt vmcnt(10)
v_and_b32 v207,s42,v207
v_and_b32 v215,s42,v215
M v[64:67],a[236:239],v[224:227],v[64:67]
v_and_b32 v213,s42,v213
v_fmac_f32 v205,s43,v211
M v[68:71],a[236:239],a[192:195],v[68:71]
buffer_load_dwordx4 v[220:223],v250,s[20:23],s48 offen offset:0 sc1
M v[68:71],a[204:207],v[224:227],v[68:71]
v_fmac_f32 v207,4.0,v209
v_fma_f32 v235,-4.0,v211,v215
M v[68:71],v[216:219],a[200:203],v[68:71]
v_fmac_f32 v205,s45,v215
v_fmac_f32 v207,s41,v213
M v[72:75],v[216:219],v[224:227],v[72:75]
v_sub_f32 v215,v215,v211
v_fma_f32 v211,-4.0,v209,v213
M v[72:75],a[204:207],a[192:195],v[72:75]
buffer_load_dwordx4 a[196:199],v250,s[20:23],s48 offen offset:1024 sc1
M v[72:75],a[236:239],a[208:211],v[72:75]
v_sub_f32 v213,v213,v209
v_add_f32 v209,v235,v211
M v[76:79],a[236:239],a[248:251],v[76:79]
v_sub_f32 v235,v235,v211
v_fma_f32 v211,2.0,v213,v215
M v[76:79],a[204:207],a[208:211],v[76:79]
v_fmac_f32 v215,-2.0,v213
v_cvt_pk_bf16_f32 v205,v232,v205
M v[76:79],v[216:219],a[192:195],v[76:79]
buffer_load_dwordx4 a[200:203],v250,s[20:23],s48 offen offset:2048 sc1
M v[80:83],v[216:219],a[208:211],v[80:83]
s_add_u32 s46,s76,9216
v_cvt_pk_bf16_f32 v207,v237,v207
v_cvt_pk_bf16_f32 v209,v233,v209
M v[80:83],a[204:207],a[248:251],v[80:83]
v_cvt_pk_bf16_f32 v213,v234,v211
v_cvt_pk_bf16_f32 v211,v238,v235
M v[80:83],a[236:239],a[212:215],v[80:83]
v_cvt_pk_bf16_f32 v215,v236,v215
v_add_u32 v238,139264,v247
M v[84:87],a[236:239],a[216:219],v[84:87]
buffer_load_dwordx4 v[224:227],v250,s[20:23],s46 offen offset:0 sc1
M v[84:87],a[204:207],a[212:215],v[84:87]
s_waitcnt vmcnt(11)
ds_read_b128 a[192:195],v248 offset:60928
v_permlane32_swap_b32 v196,v198
M v[84:87],v[216:219],a[248:251],v[84:87]
ds_write2st64_b64 v238,v[204:205],v[206:207] offset0:3 offset1:20
M v[88:91],v[216:219],a[212:215],v[88:91]
s_add_u32 s28,s71,393216
ds_read_b128 a[208:211],v249 offset:60928
ds_read_b128 a[248:251],v248 offset:61440
M v[88:91],a[204:207],a[216:219],v[88:91]
buffer_load_dwordx4 v[204:207],v251,s[88:91],s28 offen offset:0
M v[88:91],a[236:239],a[228:231],v[88:91]
ds_write2st64_b64 v247,v[208:209],v[210:211] offset0:37 offset1:54
M v[92:95],a[236:239],v[228:231],v[92:95]
ds_read_b128 a[212:215],v249 offset:61440
v_permlane32_swap_b32 v192,v194
M v[92:95],a[204:207],a[228:231],v[92:95]
buffer_load_dwordx4 v[208:211],v245,s[8:11],s28 offen offset:0
M v[92:95],v[216:219],a[216:219],v[92:95]
s_waitcnt lgkmcnt(5)
ds_write2st64_b64 v247,v[212:213],v[214:215] offset0:71 offset1:88
M v[96:99],a[252:255],a[192:195],v[96:99]
s_waitcnt vmcnt(10) lgkmcnt(4)
ds_read_b128 a[236:239],v248 offset:61952
v_permlane32_swap_b32 v200,v202
M v[96:99],a[220:223],a[208:211],v[96:99]
s_waitcnt vmcnt(9) lgkmcnt(4)
buffer_load_dwordx4 v[212:215],v245,s[8:11],s28 offen offset:768
M v[96:99],a[224:227],a[248:251],v[96:99]
s_waitcnt lgkmcnt(2)
ds_read_b128 v[228:231],v249 offset:61952
v_lshlrev_b32 v234,16,v198
M v[100:103],a[224:227],a[212:215],v[100:103]
v_lshlrev_b32 v232,16,v192
v_lshlrev_b32 v233,16,v196
M v[100:103],a[220:223],a[248:251],v[100:103]
v_lshlrev_b32 v237,16,v194
v_lshlrev_b32 v236,16,v202
M v[100:103],a[252:255],a[208:211],v[100:103]
v_lshlrev_b32 v235,16,v200
v_fmac_f32 v232,s43,v234
M v[104:107],a[252:255],a[248:251],v[104:107]
ds_read_b128 a[204:207],v248 offset:62464
v_fmac_f32 v237,4.0,v233
M v[104:107],a[220:223],a[212:215],v[104:107]
s_waitcnt lgkmcnt(2)
ds_read_b128 a[228:231],v249 offset:62464
v_fma_f32 v238,-4.0,v234,v236
M v[104:107],a[224:227],a[236:239],v[104:107]
s_waitcnt lgkmcnt(2)
v_fmac_f32 v232,s45,v236
v_fmac_f32 v237,s41,v235
M v[108:111],a[224:227],v[228:231],v[108:111]
v_sub_f32 v236,v236,v234
v_fma_f32 v234,-4.0,v233,v235
M v[108:111],a[220:223],a[236:239],v[108:111]
v_sub_f32 v235,v235,v233
v_add_f32 v233,v238,v234
M v[108:111],a[252:255],a[212:215],v[108:111]
v_sub_f32 v238,v238,v234
v_fma_f32 v234,2.0,v235,v236
M v[112:115],a[252:255],a[236:239],v[112:115]
ds_read_b128 a[216:219],v249 offset:62976
v_fmac_f32 v236,-2.0,v235
M v[112:115],a[220:223],v[228:231],v[112:115]
s_waitcnt lgkmcnt(2)
ds_read_b128 v[216:219],v248 offset:62976
v_and_b32 v198,s42,v198
M v[112:115],a[224:227],a[204:207],v[112:115]
s_waitcnt lgkmcnt(2)
v_and_b32 v192,s42,v192
v_and_b32 v196,s42,v196
M v[116:119],a[224:227],a[228:231],v[116:119]
v_and_b32 v194,s42,v194
v_and_b32 v202,s42,v202
M v[116:119],a[220:223],a[204:207],v[116:119]
v_and_b32 v200,s42,v200
v_fmac_f32 v192,s43,v198
M v[116:119],a[252:255],v[228:231],v[116:119]
v_fmac_f32 v194,4.0,v196
v_fma_f32 v235,-4.0,v198,v202
M v[120:123],a[252:255],a[204:207],v[120:123]
v_fmac_f32 v192,s45,v202
v_fmac_f32 v194,s41,v200
M v[120:123],a[220:223],a[228:231],v[120:123]
s_waitcnt lgkmcnt(1)
v_sub_f32 v202,v202,v198
v_fma_f32 v198,-4.0,v196,v200
M v[120:123],a[224:227],a[216:219],v[120:123]
s_waitcnt lgkmcnt(0)
v_sub_f32 v200,v200,v196
v_add_f32 v196,v235,v198
M v[124:127],a[224:227],v[216:219],v[124:127]
buffer_load_dwordx4 a[224:227],v250,s[20:23],s46 offen offset:1024 sc1
M v[124:127],a[220:223],a[216:219],v[124:127]
v_sub_f32 v235,v235,v198
v_fma_f32 v198,2.0,v200,v202
M v[124:127],a[252:255],a[228:231],v[124:127]
s_waitcnt vmcnt(10)
buffer_load_dwordx4 a[220:223],v250,s[20:23],s46 offen offset:2048 sc1
M v[128:131],a[232:235],a[192:195],v[128:131]
s_waitcnt vmcnt(10)
s_add_u32 s47,s76,12288
v_fmac_f32 v202,-2.0,v200
v_cvt_pk_bf16_f32 v192,v232,v192
M v[128:131],a[240:243],a[208:211],v[128:131]
s_waitcnt vmcnt(9)
v_cvt_pk_bf16_f32 v194,v237,v194
v_cvt_pk_bf16_f32 v196,v233,v196
M v[128:131],a[244:247],a[248:251],v[128:131]
v_cvt_pk_bf16_f32 v200,v234,v198
v_cvt_pk_bf16_f32 v198,v238,v235
M v[132:135],a[244:247],a[212:215],v[132:135]
buffer_load_dwordx4 a[252:255],v250,s[20:23],s47 offen offset:0 sc1
M v[132:135],a[240:243],a[248:251],v[132:135]
v_cvt_pk_bf16_f32 v202,v236,v202
v_permlane32_swap_b32 v197,v199
M v[132:135],a[232:235],a[208:211],v[132:135]
v_permlane32_swap_b32 v193,v195
v_permlane32_swap_b32 v201,v203
M v[136:139],a[232:235],a[248:251],v[136:139]
v_lshlrev_b32 v234,16,v199
v_lshlrev_b32 v232,16,v193
M v[136:139],a[240:243],a[212:215],v[136:139]
v_lshlrev_b32 v233,16,v197
v_lshlrev_b32 v237,16,v195
M v[136:139],a[244:247],a[236:239],v[136:139]
v_lshlrev_b32 v236,16,v203
v_lshlrev_b32 v235,16,v201
M v[140:143],a[244:247],v[228:231],v[140:143]
v_fmac_f32 v232,s43,v234
v_fmac_f32 v237,4.0,v233
M v[140:143],a[240:243],a[236:239],v[140:143]
v_fma_f32 v238,-4.0,v234,v236
v_fmac_f32 v232,s45,v236
M v[140:143],a[232:235],a[212:215],v[140:143]
v_fmac_f32 v237,s41,v235
v_sub_f32 v236,v236,v234
M v[144:147],a[232:235],a[236:239],v[144:147]
v_fma_f32 v234,-4.0,v233,v235
v_sub_f32 v235,v235,v233
M v[144:147],a[240:243],v[228:231],v[144:147]
v_add_f32 v233,v238,v234
v_sub_f32 v238,v238,v234
M v[144:147],a[244:247],a[204:207],v[144:147]
v_fma_f32 v234,2.0,v235,v236
v_fmac_f32 v236,-2.0,v235
M v[148:151],a[244:247],a[228:231],v[148:151]
v_and_b32 v199,s42,v199
v_and_b32 v193,s42,v193
M v[148:151],a[240:243],a[204:207],v[148:151]
v_and_b32 v197,s42,v197
v_and_b32 v195,s42,v195
M v[148:151],a[232:235],v[228:231],v[148:151]
v_and_b32 v203,s42,v203
v_and_b32 v201,s42,v201
M v[152:155],a[232:235],a[204:207],v[152:155]
v_fmac_f32 v193,s43,v199
v_fmac_f32 v195,4.0,v197
M v[152:155],a[240:243],a[228:231],v[152:155]
v_fma_f32 v235,-4.0,v199,v203
v_fmac_f32 v193,s45,v203
M v[152:155],a[244:247],a[216:219],v[152:155]
v_fmac_f32 v195,s41,v201
v_sub_f32 v203,v203,v199
M v[156:159],a[244:247],v[216:219],v[156:159]
buffer_load_dwordx4 a[244:247],v250,s[20:23],s47 offen offset:1024 sc1
M v[156:159],a[240:243],a[216:219],v[156:159]
v_fma_f32 v199,-4.0,v197,v201
v_sub_f32 v201,v201,v197
M v[156:159],a[232:235],a[228:231],v[156:159]
s_waitcnt vmcnt(10)
buffer_load_dwordx4 a[240:243],v250,s[20:23],s47 offen offset:2048 sc1
M v[160:163],v[220:223],a[192:195],v[160:163]
s_waitcnt vmcnt(10)
s_add_u32 s48,s76,15360
v_add_f32 v197,v235,v199
v_sub_f32 v235,v235,v199
M v[160:163],a[196:199],a[208:211],v[160:163]
s_waitcnt vmcnt(9)
v_fma_f32 v199,2.0,v201,v203
v_fmac_f32 v203,-2.0,v201
M v[160:163],a[200:203],a[248:251],v[160:163]
v_cvt_pk_bf16_f32 v193,v232,v193
v_cvt_pk_bf16_f32 v195,v237,v195
M v[164:167],a[200:203],a[212:215],v[164:167]
buffer_load_dwordx4 a[232:235],v250,s[20:23],s48 offen offset:0 sc1
M v[164:167],a[196:199],a[248:251],v[164:167]
v_cvt_pk_bf16_f32 v197,v233,v197
v_cvt_pk_bf16_f32 v201,v234,v199
M v[164:167],v[220:223],a[208:211],v[164:167]
v_cvt_pk_bf16_f32 v199,v238,v235
v_cvt_pk_bf16_f32 v203,v236,v203
M v[168:171],v[220:223],a[248:251],v[168:171]
s_waitcnt vmcnt(7)
v_permlane32_swap_b32 v208,v210
v_permlane32_swap_b32 v204,v206
M v[168:171],a[196:199],a[212:215],v[168:171]
buffer_load_dwordx4 a[192:195],v250,s[20:23],s48 offen offset:1024 sc1
M v[168:171],a[200:203],a[236:239],v[168:171]
s_waitcnt vmcnt(7)
v_permlane32_swap_b32 v212,v214
v_lshlrev_b32 v234,16,v210
M v[172:175],a[200:203],v[228:231],v[172:175]
v_lshlrev_b32 v232,16,v204
v_lshlrev_b32 v233,16,v208
M v[172:175],a[196:199],a[236:239],v[172:175]
v_lshlrev_b32 v237,16,v206
v_lshlrev_b32 v236,16,v214
M v[172:175],v[220:223],a[212:215],v[172:175]
buffer_load_dwordx4 a[208:211],v250,s[20:23],s48 offen offset:2048 sc1
M v[176:179],v[220:223],a[236:239],v[176:179]
s_add_u32 s46,s76,18432
v_lshlrev_b32 v235,16,v212
v_fmac_f32 v232,s43,v234
M v[176:179],a[196:199],v[228:231],v[176:179]
v_fmac_f32 v237,4.0,v233
v_fma_f32 v238,-4.0,v234,v236
M v[176:179],a[200:203],a[204:207],v[176:179]
s_barrier
v_fmac_f32 v232,s45,v236
M v[180:183],a[200:203],a[228:231],v[180:183]
buffer_load_dwordx4 a[248:251],v250,s[20:23],s46 offen offset:0 sc1
M v[180:183],a[196:199],a[204:207],v[180:183]
ds_read_b128 a[212:215],v248 offset:0
v_fmac_f32 v237,s41,v235
M v[180:183],v[220:223],v[228:231],v[180:183]
ds_write2st64_b64 v247,v[192:193],v[194:195] offset0:136 offset1:153
M v[184:187],v[220:223],a[204:207],v[184:187]
s_add_u32 s28,s71,786432
ds_read_b128 a[236:239],v249 offset:0
ds_read_b128 v[228:231],v248 offset:512
M v[184:187],a[196:199],a[228:231],v[184:187]
buffer_load_dwordx4 v[192:195],v251,s[88:91],s28 offen offset:0
M v[184:187],a[200:203],a[216:219],v[184:187]
ds_write2st64_b64 v247,v[196:197],v[198:199] offset0:102 offset1:119
M v[188:191],a[200:203],v[216:219],v[188:191]
ds_read_b128 a[204:207],v249 offset:512
v_sub_f32 v236,v236,v234
M v[188:191],a[196:199],a[216:219],v[188:191]
buffer_load_dwordx4 v[196:199],v245,s[8:11],s28 offen offset:0
M v[188:191],v[220:223],a[228:231],v[188:191]
s_waitcnt lgkmcnt(5)
v_fma_f32 v234,-4.0,v233,v235
v_sub_f32 v235,v235,v233
M a[0:3],v[224:227],a[212:215],a[0:3]
s_waitcnt vmcnt(10) lgkmcnt(3)
ds_read_b128 a[200:203],v248 offset:1024
v_add_f32 v233,v238,v234
M a[0:3],a[224:227],a[236:239],a[0:3]
s_waitcnt vmcnt(9) lgkmcnt(3)
ds_read_b128 v[216:219],v249 offset:1024
v_sub_f32 v238,v238,v234
M a[0:3],a[220:223],v[228:231],a[0:3]
s_waitcnt lgkmcnt(2)
v_fma_f32 v234,2.0,v235,v236
v_fmac_f32 v236,-2.0,v235
M a[4:7],a[220:223],a[204:207],a[4:7]
v_and_b32 v210,s42,v210
v_and_b32 v204,s42,v204
M a[4:7],a[224:227],v[228:231],a[4:7]
v_and_b32 v208,s42,v208
v_and_b32 v206,s42,v206
M a[4:7],v[224:227],a[236:239],a[4:7]
v_and_b32 v214,s42,v214
v_and_b32 v212,s42,v212
M a[8:11],v[224:227],v[228:231],a[8:11]
ds_read_b128 a[196:199],v248 offset:1536
v_fmac_f32 v204,s43,v210
M a[8:11],a[224:227],a[204:207],a[8:11]
s_waitcnt lgkmcnt(2)
ds_read_b128 a[216:219],v249 offset:1536
v_fmac_f32 v206,4.0,v208
M a[8:11],a[220:223],a[200:203],a[8:11]
s_waitcnt lgkmcnt(2)
v_fma_f32 v235,-4.0,v210,v214
v_fmac_f32 v204,s45,v214
M a[12:15],a[220:223],v[216:219],a[12:15]
v_fmac_f32 v206,s41,v212
v_sub_f32 v214,v214,v210
M a[12:15],a[224:227],a[200:203],a[12:15]
v_fma_f32 v210,-4.0,v208,v212
v_sub_f32 v212,v212,v208
M a[12:15],v[224:227],a[204:207],a[12:15]
v_add_f32 v208,v235,v210
v_sub_f32 v235,v235,v210
M a[16:19],v[224:227],a[200:203],a[16:19]
ds_read_b128 a[228:231],v249 offset:2048
v_fma_f32 v210,2.0,v212,v214
M a[16:19],a[224:227],v[216:219],a[16:19]
s_waitcnt lgkmcnt(2)
ds_read_b128 v[220:223],v248 offset:2048
v_fmac_f32 v214,-2.0,v212
M a[16:19],a[220:223],a[196:199],a[16:19]
s_waitcnt lgkmcnt(2)
v_cvt_pk_bf16_f32 v204,v232,v204
v_cvt_pk_bf16_f32 v206,v237,v206
M a[20:23],a[220:223],a[216:219],a[20:23]
v_cvt_pk_bf16_f32 v208,v233,v208
v_cvt_pk_bf16_f32 v212,v234,v210
M a[20:23],a[224:227],a[196:199],a[20:23]
v_cvt_pk_bf16_f32 v210,v238,v235
v_cvt_pk_bf16_f32 v214,v236,v214
M a[20:23],v[224:227],v[216:219],a[20:23]
v_permlane32_swap_b32 v209,v211
v_permlane32_swap_b32 v205,v207
M a[24:27],v[224:227],a[196:199],a[24:27]
v_permlane32_swap_b32 v213,v215
v_lshlrev_b32 v234,16,v211
M a[24:27],a[224:227],a[216:219],a[24:27]
s_waitcnt lgkmcnt(1)
v_lshlrev_b32 v232,16,v205
v_lshlrev_b32 v233,16,v209
M a[24:27],a[220:223],a[228:231],a[24:27]
s_waitcnt lgkmcnt(0)
v_lshlrev_b32 v237,16,v207
v_lshlrev_b32 v236,16,v215
M a[28:31],a[220:223],v[220:223],a[28:31]
buffer_load_dwordx4 a[220:223],v250,s[20:23],s46 offen offset:1024 sc1
M a[28:31],a[224:227],a[228:231],a[28:31]
v_lshlrev_b32 v235,16,v213
v_fmac_f32 v232,s43,v234
M a[28:31],v[224:227],a[216:219],a[28:31]
s_waitcnt vmcnt(9)
buffer_load_dwordx4 a[224:227],v250,s[20:23],s46 offen offset:2048 sc1
M a[32:35],a[252:255],a[212:215],a[32:35]
s_waitcnt vmcnt(9)
s_add_u32 s47,s76,21504
v_fmac_f32 v237,4.0,v233
v_fma_f32 v238,-4.0,v234,v236
M a[32:35],a[244:247],a[236:239],a[32:35]
s_waitcnt vmcnt(8)
v_fmac_f32 v232,s45,v236
v_fmac_f32 v237,s41,v235
M a[32:35],a[240:243],v[228:231],a[32:35]
v_sub_f32 v236,v236,v234
v_fma_f32 v234,-4.0,v233,v235
M a[36:39],a[240:243],a[204:207],a[36:39]
buffer_load_dwordx4 v[224:227],v250,s[20:23],s47 offen offset:0 sc1
M a[36:39],a[244:247],v[228:231],a[36:39]
v_sub_f32 v235,v235,v233
v_add_f32 v233,v238,v234
M a[36:39],a[252:255],a[236:239],a[36:39]
v_sub_f32 v238,v238,v234
v_fma_f32 v234,2.0,v235,v236
M a[40:43],a[252:255],v[228:231],a[40:43]
v_fmac_f32 v236,-2.0,v235
v_and_b32 v211,s42,v211
M a[40:43],a[244:247],a[204:207],a[40:43]
v_and_b32 v205,s42,v205
v_and_b32 v209,s42,v209
M a[40:43],a[240:243],a[200:203],a[40:43]
v_and_b32 v207,s42,v207
v_and_b32 v215,s42,v215
M a[44:47],a[240:243],v[216:219],a[44:47]
v_and_b32 v213,s42,v213
v_fmac_f32 v205,s43,v211
M a[44:47],a[244:247],a[200:203],a[44:47]
v_fmac_f32 v207,4.0,v209
v_fma_f32 v235,-4.0,v211,v215
M a[44:47],a[252:255],a[204:207],a[44:47]
v_fmac_f32 v205,s45,v215
v_fmac_f32 v207,s41,v213
M a[48:51],a[252:255],a[200:203],a[48:51]
v_sub_f32 v215,v215,v211
v_fma_f32 v211,-4.0,v209,v213
M a[48:51],a[244:247],v[216:219],a[48:51]
v_sub_f32 v213,v213,v209
v_add_f32 v209,v235,v211
M a[48:51],a[240:243],a[196:199],a[48:51]
v_sub_f32 v235,v235,v211
v_fma_f32 v211,2.0,v213,v215
M a[52:55],a[240:243],a[216:219],a[52:55]
v_fmac_f32 v215,-2.0,v213
v_cvt_pk_bf16_f32 v205,v232,v205
M a[52:55],a[244:247],a[196:199],a[52:55]
v_cvt_pk_bf16_f32 v207,v237,v207
v_cvt_pk_bf16_f32 v209,v233,v209
M a[52:55],a[252:255],v[216:219],a[52:55]
v_cvt_pk_bf16_f32 v213,v234,v211
v_cvt_pk_bf16_f32 v211,v238,v235
M a[56:59],a[252:255],a[196:199],a[56:59]
v_cvt_pk_bf16_f32 v215,v236,v215
v_fmac_f32 v239,s43,v241
M a[56:59],a[244:247],a[216:219],a[56:59]
v_fmac_f32 v244,4.0,v240
v_fma_f32 v232,-4.0,v241,v243
M a[56:59],a[240:243],a[228:231],a[56:59]
v_fmac_f32 v239,s45,v243
v_fmac_f32 v244,s41,v242
M a[60:63],a[240:243],v[220:223],a[60:63]
buffer_load_dwordx4 a[240:243],v250,s[20:23],s47 offen offset:1024 sc1
M a[60:63],a[244:247],a[228:231],a[60:63]
v_sub_f32 v243,v243,v241
v_fma_f32 v241,-4.0,v240,v242
M a[60:63],a[252:255],a[216:219],a[60:63]
s_waitcnt vmcnt(9)
buffer_load_dwordx4 a[244:247],v250,s[20:23],s47 offen offset:2048 sc1
M a[64:67],a[232:235],a[212:215],a[64:67]
s_waitcnt vmcnt(9)
s_add_u32 s48,s76,24576
v_sub_f32 v242,v242,v240
v_add_f32 v240,v232,v241
M a[64:67],a[192:195],a[236:239],a[64:67]
s_waitcnt vmcnt(8)
v_sub_f32 v232,v232,v241
v_fma_f32 v241,2.0,v242,v243
M a[64:67],a[208:211],v[228:231],a[64:67]
v_fmac_f32 v243,-2.0,v242
v_cvt_pk_bf16_f32 v233,v239,v244
M a[68:71],a[208:211],a[204:207],a[68:71]
buffer_load_dwordx4 a[252:255],v250,s[20:23],s48 offen offset:0 sc1
M a[68:71],a[192:195],v[228:231],a[68:71]
v_cvt_pk_bf16_f32 v234,v240,v232
v_cvt_pk_bf16_f32 v235,v241,v243
M a[68:71],a[232:235],a[236:239],a[68:71]
v_add_u32 v232,69632,v252
M a[72:75],a[232:235],v[228:231],a[72:75]
ds_write_b16 v232,v233 offset:0
M a[72:75],a[192:195],a[204:207],a[72:75]
buffer_load_dwordx4 a[212:215],v250,s[20:23],s48 offen offset:1024 sc1
M a[72:75],a[208:211],a[200:203],a[72:75]
ds_write_b16_d16_hi v232,v233 offset:8704
M a[76:79],a[208:211],v[216:219],a[76:79]
ds_write_b16 v252,v234 offset:52224
M a[76:79],a[192:195],a[200:203],a[76:79]
ds_write_b16_d16_hi v252,v234 offset:60928
M a[76:79],a[232:235],a[204:207],a[76:79]
buffer_load_dwordx4 a[236:239],v250,s[20:23],s48 offen offset:2048 sc1
M a[80:83],a[232:235],a[200:203],a[80:83]
s_add_u32 s46,s76,27648
M a[80:83],a[192:195],v[216:219],a[80:83]
M a[80:83],a[208:211],a[196:199],a[80:83]
M a[84:87],a[208:211],a[216:219],a[84:87]
buffer_load_dwordx4 v[228:231],v250,s[20:23],s46 offen offset:0 sc1
M a[84:87],a[192:195],a[196:199],a[84:87]
ds_read_b128 a[204:207],v248 offset:8704
M a[84:87],a[232:235],v[216:219],a[84:87]
ds_read_b128 a[200:203],v249 offset:8704
M a[88:91],a[232:235],a[196:199],a[88:91]
ds_read_b128 v[216:219],v248 offset:9216
M a[88:91],a[192:195],a[216:219],a[88:91]
ds_read_b128 a[196:199],v249 offset:9216
M a[88:91],a[208:211],a[228:231],a[88:91]
M a[92:95],a[208:211],v[220:223],a[92:95]
M a[92:95],a[192:195],a[228:231],a[92:95]
M a[92:95],a[232:235],a[216:219],a[92:95]
s_waitcnt vmcnt(11) lgkmcnt(3)
M a[96:99],a[248:251],a[204:207],a[96:99]
s_waitcnt vmcnt(8) lgkmcnt(2)
ds_read_b128 a[208:211],v248 offset:9728
M a[96:99],a[220:223],a[200:203],a[96:99]
s_waitcnt vmcnt(7) lgkmcnt(2)
ds_read_b128 v[220:223],v249 offset:9728
M a[96:99],a[224:227],v[216:219],a[96:99]
s_waitcnt lgkmcnt(2)
M a[100:103],a[224:227],a[196:199],a[100:103]
M a[100:103],a[220:223],v[216:219],a[100:103]
M a[100:103],a[248:251],a[200:203],a[100:103]
M a[104:107],a[248:251],v[216:219],a[104:107]
ds_read_b128 a[192:195],v248 offset:10240
M a[104:107],a[220:223],a[196:199],a[104:107]
s_waitcnt lgkmcnt(2)
ds_read_b128 a[228:231],v249 offset:10240
M a[104:107],a[224:227],a[208:211],a[104:107]
s_waitcnt lgkmcnt(2)
M a[108:111],a[224:227],v[220:223],a[108:111]
M a[108:111],a[220:223],a[208:211],a[108:111]
M a[108:111],a[248:251],a[196:199],a[108:111]
M a[112:115],a[248:251],a[208:211],a[112:115]
ds_read_b128 a[216:219],v249 offset:10752
M a[112:115],a[220:223],v[220:223],a[112:115]
s_waitcnt lgkmcnt(2)
ds_read_b128 a[232:235],v248 offset:10752
M a[112:115],a[224:227],a[192:195],a[112:115]
s_waitcnt lgkmcnt(2)
M a[116:119],a[224:227],a[228:231],a[116:119]
M a[116:119],a[220:223],a[192:195],a[116:119]
M a[116:119],a[248:251],v[220:223],a[116:119]
M a[120:123],a[248:251],a[192:195],a[120:123]
M a[120:123],a[220:223],a[228:231],a[120:123]
s_waitcnt lgkmcnt(1)
M a[120:123],a[224:227],a[216:219],a[120:123]
s_waitcnt lgkmcnt(0)
M a[124:127],a[224:227],a[232:235],a[124:127]
buffer_load_dwordx4 a[224:227],v250,s[20:23],s46 offen offset:1024 sc1
M a[124:127],a[220:223],a[216:219],a[124:127]
M a[124:127],a[248:251],a[228:231],a[124:127]
s_waitcnt vmcnt(7)
buffer_load_dwordx4 a[220:223],v250,s[20:23],s46 offen offset:2048 sc1
M a[128:131],v[224:227],a[204:207],a[128:131]
s_waitcnt vmcnt(7)
s_add_u32 s47,s76,30720
M a[128:131],a[240:243],a[200:203],a[128:131]
s_waitcnt vmcnt(6)
M a[128:131],a[244:247],v[216:219],a[128:131]
M a[132:135],a[244:247],a[196:199],a[132:135]
buffer_load_dwordx4 a[248:251],v250,s[20:23],s47 offen offset:0 sc1
M a[132:135],a[240:243],v[216:219],a[132:135]
M a[132:135],v[224:227],a[200:203],a[132:135]
M a[136:139],v[224:227],v[216:219],a[136:139]
s_barrier
ds_write_b16 v252,v235 offset:17408
M a[136:139],a[240:243],a[196:199],a[136:139]
ds_write_b16_d16_hi v252,v235 offset:26112
M a[136:139],a[244:247],a[208:211],a[136:139]
ds_write2st64_b64 v247,v[200:201],v[202:203] offset0:34 offset1:51
M a[140:143],a[244:247],v[220:223],a[140:143]
buffer_load_dwordx4 v[200:203],v245,s[8:11],s28 offen offset:768
M a[140:143],a[240:243],a[208:211],a[140:143]
M a[140:143],v[224:227],a[196:199],a[140:143]
ds_write2st64_b64 v247,v[204:205],v[206:207] offset0:137 offset1:154
M a[144:147],v[224:227],a[208:211],a[144:147]
s_add_u32 s28,s71,1179648
buffer_load_dwordx4 v[204:207],v251,s[88:91],s28 offen offset:0
M a[144:147],a[240:243],v[220:223],a[144:147]
M a[144:147],a[244:247],a[192:195],a[144:147]
ds_write2st64_b64 v247,v[208:209],v[210:211] offset0:103 offset1:120
M a[148:151],a[244:247],a[228:231],a[148:151]
buffer_load_dwordx4 v[208:211],v245,s[8:11],s28 offen offset:0
M a[148:151],a[240:243],a[192:195],a[148:151]
M a[148:151],v[224:227],v[220:223],a[148:151]
ds_write2st64_b64 v247,v[212:213],v[214:215] offset0:35 offset1:52
M a[152:155],v[224:227],a[192:195],a[152:155]
buffer_load_dwordx4 v[212:215],v245,s[8:11],s28 offen offset:768
M a[152:155],a[240:243],a[228:231],a[152:155]
M a[152:155],a[244:247],a[216:219],a[152:155]
M a[156:159],a[244:247],a[232:235],a[156:159]
buffer_load_dwordx4 a[244:247],v250,s[20:23],s47 offen offset:1024 sc1
M a[156:159],a[240:243],a[216:219],a[156:159]
M a[156:159],v[224:227],a[228:231],a[156:159]
s_waitcnt vmcnt(11)
M a[160:163],a[252:255],a[204:207],a[160:163]
s_waitcnt vmcnt(10)
M a[160:163],a[212:215],a[200:203],a[160:163]
s_waitcnt vmcnt(9)
buffer_load_dwordx4 a[240:243],v250,s[20:23],s47 offen offset:2048 sc1
M a[160:163],a[236:239],v[216:219],a[160:163]
s_add_u32 s48,s76,33792
M a[164:167],a[236:239],a[196:199],a[164:167]
M a[164:167],a[212:215],v[216:219],a[164:167]
M a[164:167],a[252:255],a[200:203],a[164:167]
buffer_load_dwordx4 v[224:227],v250,s[20:23],s48 offen offset:0 sc1
M a[168:171],a[252:255],v[216:219],a[168:171]
M a[168:171],a[212:215],a[196:199],a[168:171]
M a[168:171],a[236:239],a[208:211],a[168:171]
M a[172:175],a[236:239],v[220:223],a[172:175]
buffer_load_dwordx4 a[204:207],v250,s[20:23],s48 offen offset:1024 sc1
M a[172:175],a[212:215],a[208:211],a[172:175]
M a[172:175],a[252:255],a[196:199],a[172:175]
M a[176:179],a[252:255],a[208:211],a[176:179]
M a[176:179],a[212:215],v[220:223],a[176:179]
buffer_load_dwordx4 a[200:203],v250,s[20:23],s48 offen offset:2048 sc1
M a[176:179],a[236:239],a[192:195],a[176:179]
s_add_u32 s46,s76,36864
M a[180:183],a[236:239],a[228:231],a[180:183]
v_permlane32_swap_b32 v196,v198
v_permlane32_swap_b32 v192,v194
M a[180:183],a[212:215],a[192:195],a[180:183]
s_waitcnt vmcnt(8)
ds_read_b128 a[196:199],v248 offset:17408
v_permlane32_swap_b32 v200,v202
M a[180:183],a[252:255],v[220:223],a[180:183]
buffer_load_dwordx4 v[216:219],v250,s[20:23],s46 offen offset:0 sc1
M a[184:187],a[252:255],a[192:195],a[184:187]
ds_read_b128 a[208:211],v249 offset:17408
ds_read_b128 v[220:223],v248 offset:17920
M a[184:187],a[212:215],a[228:231],a[184:187]
ds_read_b128 a[192:195],v249 offset:17920
v_lshlrev_b32 v234,16,v198
M a[184:187],a[236:239],a[216:219],a[184:187]
v_lshlrev_b32 v232,16,v192
v_lshlrev_b32 v233,16,v196
M a[188:191],a[236:239],a[232:235],a[188:191]
v_lshlrev_b32 v237,16,v194
v_lshlrev_b32 v236,16,v202
M a[188:191],a[212:215],a[216:219],a[188:191]
v_lshlrev_b32 v235,16,v200
v_fmac_f32 v232,s43,v234
M a[188:191],a[252:255],a[228:231],a[188:191]
s_waitcnt lgkmcnt(3)
v_fmac_f32 v237,4.0,v233
v_fma_f32 v238,-4.0,v234,v236
M v[0:3],v[228:231],a[196:199],v[0:3]
s_waitcnt lgkmcnt(2)
ds_read_b128 a[232:235],v248 offset:18432
v_fmac_f32 v232,s45,v236
M v[0:3],a[224:227],a[208:211],v[0:3]
s_waitcnt lgkmcnt(2)
ds_read_b128 a[236:239],v249 offset:18432
v_fmac_f32 v237,s41,v235
M v[0:3],a[220:223],v[220:223],v[0:3]
s_waitcnt lgkmcnt(2)
v_sub_f32 v236,v236,v234
v_fma_f32 v234,-4.0,v233,v235
M v[4:7],a[220:223],a[192:195],v[4:7]
v_sub_f32 v235,v235,v233
v_add_f32 v233,v238,v234
M v[4:7],a[224:227],v[220:223],v[4:7]
v_sub_f32 v238,v238,v234
v_fma_f32 v234,2.0,v235,v236
M v[4:7],v[228:231],a[208:211],v[4:7]
v_fmac_f32 v236,-2.0,v235
v_and_b32 v198,s42,v198
M v[8:11],v[228:231],v[220:223],v[8:11]
ds_read_b128 a[212:215],v248 offset:18944
v_and_b32 v192,s42,v192
M v[8:11],a[224:227],a[192:195],v[8:11]
s_waitcnt lgkmcnt(2)
ds_read_b128 a[216:219],v249 offset:18944
v_and_b32 v196,s42,v196
M v[8:11],a[220:223],a[232:235],v[8:11]
s_waitcnt lgkmcnt(2)
v_and_b32 v194,s42,v194
v_and_b32 v202,s42,v202
M v[12:15],a[220:223],a[236:239],v[12:15]
v_and_b32 v200,s42,v200
v_fmac_f32 v192,s43,v198
M v[12:15],a[224:227],a[232:235],v[12:15]
v_fmac_f32 v194,4.0,v196
v_fma_f32 v235,-4.0,v198,v202
M v[12:15],v[228:231],a[192:195],v[12:15]
v_fmac_f32 v192,s45,v202
v_fmac_f32 v194,s41,v200
M v[16:19],v[228:231],a[232:235],v[16:19]
ds_read_b128 a[228:231],v249 offset:19456
v_sub_f32 v202,v202,v198
M v[16:19],a[224:227],a[236:239],v[16:19]
s_waitcnt lgkmcnt(2)
ds_read_b128 a[252:255],v248 offset:19456
v_fma_f32 v198,-4.0,v196,v200
M v[16:19],a[220:223],a[212:215],v[16:19]
s_waitcnt lgkmcnt(2)
v_sub_f32 v200,v200,v196
v_add_f32 v196,v235,v198
M v[20:23],a[220:223],a[216:219],v[20:23]
v_sub_f32 v235,v235,v198
v_fma_f32 v198,2.0,v200,v202
M v[20:23],a[224:227],a[212:215],v[20:23]
v_fmac_f32 v202,-2.0,v200
v_cvt_pk_bf16_f32 v192,v232,v192
M v[20:23],v[228:231],a[236:239],v[20:23]
v_cvt_pk_bf16_f32 v194,v237,v194
v_cvt_pk_bf16_f32 v196,v233,v196
M v[24:27],v[228:231],a[212:215],v[24:27]
v_cvt_pk_bf16_f32 v200,v234,v198
v_cvt_pk_bf16_f32 v198,v238,v235
M v[24:27],a[224:227],a[216:219],v[24:27]
s_waitcnt lgkmcnt(1)
v_cvt_pk_bf16_f32 v202,v236,v202
v_permlane32_swap_b32 v197,v199
M v[24:27],a[220:223],a[228:231],v[24:27]
s_waitcnt lgkmcnt(0)
v_permlane32_swap_b32 v193,v195
v_permlane32_swap_b32 v201,v203
M v[28:31],a[220:223],a[252:255],v[28:31]
buffer_load_dwordx4 a[220:223],v250,s[20:23],s46 offen offset:1024 sc1
M v[28:31],a[224:227],a[228:231],v[28:31]
v_lshlrev_b32 v234,16,v199
v_lshlrev_b32 v232,16,v193
M v[28:31],v[228:231],a[216:219],v[28:31]
buffer_load_dwordx4 a[224:227],v250,s[20:23],s46 offen offset:2048 sc1
M v[32:35],a[248:251],a[196:199],v[32:35]
s_waitcnt vmcnt(7)
s_add_u32 s47,s76,39936
v_lshlrev_b32 v233,16,v197
v_lshlrev_b32 v237,16,v195
M v[32:35],a[244:247],a[208:211],v[32:35]
s_waitcnt vmcnt(6)
v_lshlrev_b32 v236,16,v203
v_lshlrev_b32 v235,16,v201
M v[32:35],a[240:243],v[220:223],v[32:35]
v_fmac_f32 v232,s43,v234
v_fmac_f32 v237,4.0,v233
M v[36:39],a[240:243],a[192:195],v[36:39]
buffer_load_dwordx4 v[228:231],v250,s[20:23],s47 offen offset:0 sc1
M v[36:39],a[244:247],v[220:223],v[36:39]
v_fma_f32 v238,-4.0,v234,v236
v_fmac_f32 v232,s45,v236
M v[36:39],a[248:251],a[208:211],v[36:39]
v_fmac_f32 v237,s41,v235
v_sub_f32 v236,v236,v234
M v[40:43],a[248:251],v[220:223],v[40:43]
v_fma_f32 v234,-4.0,v233,v235
v_sub_f32 v235,v235,v233
M v[40:43],a[244:247],a[192:195],v[40:43]
v_add_f32 v233,v238,v234
v_sub_f32 v238,v238,v234
M v[40:43],a[240:243],a[232:235],v[40:43]
v_fma_f32 v234,2.0,v235,v236
v_fmac_f32 v236,-2.0,v235
M v[44:47],a[240:243],a[236:239],v[44:47]
v_and_b32 v199,s42,v199
v_and_b32 v193,s42,v193
M v[44:47],a[244:247],a[232:235],v[44:47]
v_and_b32 v197,s42,v197
v_and_b32 v195,s42,v195
M v[44:47],a[248:251],a[192:195],v[44:47]
v_and_b32 v203,s42,v203
v_and_b32 v201,s42,v201
M v[48:51],a[248:251],a[232:235],v[48:51]
v_fmac_f32 v193,s43,v199
v_fmac_f32 v195,4.0,v197
M v[48:51],a[244:247],a[236:239],v[48:51]
v_fma_f32 v235,-4.0,v199,v203
v_fmac_f32 v193,s45,v203
M v[48:51],a[240:243],a[212:215],v[48:51]
v_fmac_f32 v195,s41,v201
v_sub_f32 v203,v203,v199
M v[52:55],a[240:243],a[216:219],v[52:55]
v_fma_f32 v199,-4.0,v197,v201
v_sub_f32 v201,v201,v197
M v[52:55],a[244:247],a[212:215],v[52:55]
v_add_f32 v197,v235,v199
v_sub_f32 v235,v235,v199
M v[52:55],a[248:251],a[236:239],v[52:55]
v_fma_f32 v199,2.0,v201,v203
v_fmac_f32 v203,-2.0,v201
M v[56:59],a[248:251],a[212:215],v[56:59]
v_cvt_pk_bf16_f32 v193,v232,v193
v_cvt_pk_bf16_f32 v195,v237,v195
M v[56:59],a[244:247],a[216:219],v[56:59]
v_cvt_pk_bf16_f32 v197,v233,v197
v_cvt_pk_bf16_f32 v201,v234,v199
M v[56:59],a[240:243],a[228:231],v[56:59]
v_cvt_pk_bf16_f32 v199,v238,v235
v_cvt_pk_bf16_f32 v203,v236,v203
M v[60:63],a[240:243],a[252:255],v[60:63]
buffer_load_dwordx4 a[240:243],v250,s[20:23],s47 offen offset:1024 sc1
M v[60:63],a[244:247],a[228:231],v[60:63]
v_permlane32_swap_b32 v208,v210
v_permlane32_swap_b32 v204,v206
M v[60:63],a[248:251],a[216:219],v[60:63]
s_waitcnt vmcnt(7)
buffer_load_dwordx4 a[244:247],v250,s[20:23],s47 offen offset:2048 sc1
M v[64:67],v[224:227],a[196:199],v[64:67]
s_waitcnt vmcnt(7)
s_add_u32 s48,s76,43008
v_permlane32_swap_b32 v212,v214
v_lshlrev_b32 v234,16,v210
M v[64:67],a[204:207],a[208:211],v[64:67]
s_waitcnt vmcnt(6)
v_lshlrev_b32 v232,16,v204
v_lshlrev_b32 v233,16,v208
M v[64:67],a[200:203],v[220:223],v[64:67]
ds_write2st64_b64 v247,v[192:193],v[194:195] offset0:138 offset1:155
M v[68:71],a[200:203],a[192:195],v[68:71]
s_add_u32 s28,s66,6291456
buffer_load_dwordx4 a[248:251],v250,s[20:23],s48 offen offset:0 sc1
M v[68:71],a[204:207],v[220:223],v[68:71]
v_lshlrev_b32 v237,16,v206
v_lshlrev_b32 v236,16,v214
M v[68:71],v[224:227],a[208:211],v[68:71]
ds_write2st64_b64 v247,v[196:197],v[198:199] offset0:104 offset1:121
M v[72:75],v[224:227],v[220:223],v[72:75]
buffer_load_dwordx4 a[196:199],v250,s[20:23],s48 offen offset:1024 sc1
M v[72:75],a[204:207],a[192:195],v[72:75]
v_lshlrev_b32 v235,16,v212
v_fmac_f32 v232,s43,v234
M v[72:75],a[200:203],a[232:235],v[72:75]
ds_write2st64_b64 v247,v[200:201],v[202:203] offset0:36 offset1:53
M v[76:79],a[200:203],a[236:239],v[76:79]
buffer_load_dwordx4 a[208:211],v250,s[20:23],s48 offen offset:2048 sc1
M v[76:79],a[204:207],a[232:235],v[76:79]
s_add_u32 s46,s77,9216
v_fmac_f32 v237,4.0,v233
v_fma_f32 v238,-4.0,v234,v236
M v[76:79],v[224:227],a[192:195],v[76:79]
v_fmac_f32 v232,s45,v236
v_fmac_f32 v237,s41,v235
M v[80:83],v[224:227],a[232:235],v[80:83]
v_sub_f32 v236,v236,v234
v_fma_f32 v234,-4.0,v233,v235
M v[80:83],a[204:207],a[236:239],v[80:83]
buffer_load_dwordx4 v[220:223],v250,s[20:23],s46 offen offset:0 sc1
M v[80:83],a[200:203],a[212:215],v[80:83]
v_sub_f32 v235,v235,v233
v_add_f32 v233,v238,v234
M v[84:87],a[200:203],a[216:219],v[84:87]
v_sub_f32 v238,v238,v234
v_fma_f32 v234,2.0,v235,v236
M v[84:87],a[204:207],a[212:215],v[84:87]
ds_read_b128 a[192:195],v248 offset:26112
v_fmac_f32 v236,-2.0,v235
M v[84:87],v[224:227],a[236:239],v[84:87]
buffer_load_dwordx4 v[192:195],v251,s[88:91],s28 offen offset:0
M v[88:91],v[224:227],a[212:215],v[88:91]
ds_read_b128 a[232:235],v249 offset:26112
ds_read_b128 a[236:239],v248 offset:26624
M v[88:91],a[204:207],a[216:219],v[88:91]
ds_read_b128 a[212:215],v249 offset:26624
v_and_b32 v210,s42,v210
M v[88:91],a[200:203],a[228:231],v[88:91]
v_and_b32 v204,s42,v204
v_and_b32 v208,s42,v208
M v[92:95],a[200:203],a[252:255],v[92:95]
buffer_load_dwordx4 v[196:199],v245,s[8:11],s28 offen offset:0
M v[92:95],a[204:207],a[228:231],v[92:95]
v_and_b32 v206,s42,v206
v_and_b32 v214,s42,v214
M v[92:95],v[224:227],a[216:219],v[92:95]
s_waitcnt vmcnt(11) lgkmcnt(3)
v_and_b32 v212,s42,v212
v_fmac_f32 v204,s43,v210
M v[96:99],v[216:219],a[192:195],v[96:99]
s_waitcnt vmcnt(10) lgkmcnt(2)
ds_read_b128 a[200:203],v248 offset:27136
v_fmac_f32 v206,4.0,v208
M v[96:99],a[220:223],a[232:235],v[96:99]
s_waitcnt vmcnt(9) lgkmcnt(2)
buffer_load_dwordx4 v[200:203],v245,s[8:11],s28 offen offset:768
M v[96:99],a[224:227],a[236:239],v[96:99]
s_waitcnt lgkmcnt(1)
s_add_u32 s29,s66,6291456
ds_read_b128 a[252:255],v249 offset:27136
v_fma_f32 v235,-4.0,v210,v214
M v[100:103],a[224:227],a[212:215],v[100:103]
v_fmac_f32 v204,s45,v214
v_fmac_f32 v206,s41,v212
M v[100:103],a[220:223],a[236:239],v[100:103]
v_sub_f32 v214,v214,v210
v_fma_f32 v210,-4.0,v208,v212
M v[100:103],v[216:219],a[232:235],v[100:103]
buffer_load_short_d16_hi v239,v246,s[12:15],s29 offen offset:0
M v[104:107],v[216:219],a[236:239],v[104:107]
ds_read_b128 a[204:207],v248 offset:27648
v_sub_f32 v212,v212,v208
M v[104:107],a[220:223],a[212:215],v[104:107]
s_waitcnt lgkmcnt(2)
buffer_load_short_d16_hi v240,v246,s[8:11],s29 offen offset:0
M v[104:107],a[224:227],a[200:203],v[104:107]
s_waitcnt lgkmcnt(1)
ds_read_b128 a[228:231],v249 offset:27648
v_add_f32 v208,v235,v210
M v[108:111],a[224:227],a[252:255],v[108:111]
buffer_load_short_d16_hi v241,v246,s[8:11],s29 offen offset:384
M v[108:111],a[220:223],a[200:203],v[108:111]
v_sub_f32 v235,v235,v210
v_fma_f32 v210,2.0,v212,v214
M v[108:111],v[216:219],a[212:215],v[108:111]
buffer_load_short_d16_hi v242,v246,s[8:11],s29 offen offset:768
M v[112:115],v[216:219],a[200:203],v[112:115]
ds_read_b128 a[216:219],v249 offset:28160
v_fmac_f32 v214,-2.0,v212
M v[112:115],a[220:223],a[252:255],v[112:115]
s_waitcnt lgkmcnt(2)
buffer_load_short_d16_hi v243,v246,s[8:11],s29 offen offset:1152
M v[112:115],a[224:227],a[204:207],v[112:115]
s_waitcnt lgkmcnt(1)
ds_read_b128 v[224:227],v248 offset:28160
v_cvt_pk_bf16_f32 v204,v232,v204
M v[116:119],a[224:227],a[228:231],v[116:119]
buffer_load_short_d16_hi v244,v246,s[16:19],s29 offen offset:1536
M v[116:119],a[220:223],a[204:207],v[116:119]
v_cvt_pk_bf16_f32 v206,v237,v206
v_cvt_pk_bf16_f32 v208,v233,v208
M v[116:119],v[216:219],a[252:255],v[116:119]
v_cvt_pk_bf16_f32 v212,v234,v210
v_cvt_pk_bf16_f32 v210,v238,v235
M v[120:123],v[216:219],a[204:207],v[120:123]
v_cvt_pk_bf16_f32 v214,v236,v214
v_permlane32_swap_b32 v209,v211
M v[120:123],a[220:223],a[228:231],v[120:123]
s_waitcnt lgkmcnt(1)
v_permlane32_swap_b32 v205,v207
v_permlane32_swap_b32 v213,v215
M v[120:123],a[224:227],a[216:219],v[120:123]
s_waitcnt lgkmcnt(0)
v_lshlrev_b32 v234,16,v211
v_lshlrev_b32 v232,16,v205
M v[124:127],a[224:227],v[224:227],v[124:127]
buffer_load_dwordx4 a[224:227],v250,s[20:23],s46 offen offset:1024 sc1
M v[124:127],a[220:223],a[216:219],v[124:127]
v_lshlrev_b32 v233,16,v209
v_lshlrev_b32 v237,16,v207
M v[124:127],v[216:219],a[228:231],v[124:127]
s_waitcnt vmcnt(16)
buffer_load_dwordx4 a[220:223],v250,s[20:23],s46 offen offset:2048 sc1
M v[128:131],v[228:231],a[192:195],v[128:131]
s_waitcnt vmcnt(16)
s_add_u32 s46,s77,18432
v_lshlrev_b32 v236,16,v215
v_lshlrev_b32 v235,16,v213
M v[128:131],a[240:243],a[232:235],v[128:131]
s_waitcnt vmcnt(15)
v_fmac_f32 v232,s43,v234
v_fmac_f32 v237,4.0,v233
M v[128:131],a[244:247],a[236:239],v[128:131]
v_fma_f32 v238,-4.0,v234,v236
v_fmac_f32 v232,s45,v236
M v[132:135],a[244:247],a[212:215],v[132:135]
buffer_load_dwordx4 v[216:219],v250,s[20:23],s46 offen offset:0 sc1
M v[132:135],a[240:243],a[236:239],v[132:135]
v_fmac_f32 v237,s41,v235
v_sub_f32 v236,v236,v234
M v[132:135],v[228:231],a[232:235],v[132:135]
v_fma_f32 v234,-4.0,v233,v235
v_sub_f32 v235,v235,v233
M v[136:139],v[228:231],a[236:239],v[136:139]
v_add_f32 v233,v238,v234
v_sub_f32 v238,v238,v234
M v[136:139],a[240:243],a[212:215],v[136:139]
v_fma_f32 v234,2.0,v235,v236
v_fmac_f32 v236,-2.0,v235
M v[136:139],a[244:247],a[200:203],v[136:139]
v_and_b32 v211,s42,v211
v_and_b32 v205,s42,v205
M v[140:143],a[244:247],a[252:255],v[140:143]
v_and_b32 v209,s42,v209
v_and_b32 v207,s42,v207
M v[140:143],a[240:243],a[200:203],v[140:143]
v_and_b32 v215,s42,v215
v_and_b32 v213,s42,v213
M v[140:143],v[228:231],a[212:215],v[140:143]
v_fmac_f32 v205,s43,v211
v_fmac_f32 v207,4.0,v209
M v[144:147],v[228:231],a[200:203],v[144:147]
v_fma_f32 v235,-4.0,v211,v215
v_fmac_f32 v205,s45,v215
M v[144:147],a[240:243],a[252:255],v[144:147]
v_fmac_f32 v207,s41,v213
v_sub_f32 v215,v215,v211
M v[144:147],a[244:247],a[204:207],v[144:147]
v_fma_f32 v211,-4.0,v209,v213
v_sub_f32 v213,v213,v209
M v[148:151],a[244:247],a[228:231],v[148:151]
v_add_f32 v209,v235,v211
v_sub_f32 v235,v235,v211
M v[148:151],a[240:243],a[204:207],v[148:151]
v_fma_f32 v211,2.0,v213,v215
v_fmac_f32 v215,-2.0,v213
M v[148:151],v[228:231],a[252:255],v[148:151]
v_cvt_pk_bf16_f32 v205,v232,v205
v_cvt_pk_bf16_f32 v207,v237,v207
M v[152:155],v[228:231],a[204:207],v[152:155]
v_cvt_pk_bf16_f32 v209,v233,v209
v_cvt_pk_bf16_f32 v213,v234,v211
M v[152:155],a[240:243],a[228:231],v[152:155]
v_cvt_pk_bf16_f32 v211,v238,v235
v_cvt_pk_bf16_f32 v215,v236,v215
M v[152:155],a[244:247],a[216:219],v[152:155]
ds_write2st64_b64 v247,v[204:205],v[206:207] offset0:139 offset1:156
M v[156:159],a[244:247],v[224:227],v[156:159]
buffer_load_dwordx4 a[244:247],v250,s[20:23],s46 offen offset:1024 sc1
M v[156:159],a[240:243],a[216:219],v[156:159]
M v[156:159],v[228:231],a[228:231],v[156:159]
s_waitcnt vmcnt(16)
buffer_load_dwordx4 a[240:243],v250,s[20:23],s46 offen offset:2048 sc1
M v[160:163],a[248:251],a[192:195],v[160:163]
s_waitcnt vmcnt(16)
s_add_u32 s46,s77,27648
M v[160:163],a[196:199],a[232:235],v[160:163]
s_waitcnt vmcnt(15)
M v[160:163],a[208:211],a[236:239],v[160:163]
ds_write2st64_b64 v247,v[208:209],v[210:211] offset0:105 offset1:122
M v[164:167],a[208:211],a[212:215],v[164:167]
buffer_load_dwordx4 v[228:231],v250,s[20:23],s46 offen offset:0 sc1
M v[164:167],a[196:199],a[236:239],v[164:167]
s_waitcnt vmcnt(13)
v_permlane32_swap_b32 v196,v198
v_permlane32_swap_b32 v192,v194
M v[164:167],a[248:251],a[232:235],v[164:167]
ds_write2st64_b64 v247,v[212:213],v[214:215] offset0:37 offset1:54
M v[168:171],a[248:251],a[236:239],v[168:171]
buffer_load_dwordx4 a[192:195],v250,s[20:23],s46 offen offset:1024 sc1
M v[168:171],a[196:199],a[212:215],v[168:171]
s_waitcnt vmcnt(13)
v_permlane32_swap_b32 v200,v202
v_lshlrev_b32 v234,16,v198
M v[168:171],a[208:211],a[200:203],v[168:171]
v_lshlrev_b32 v232,16,v192
v_lshlrev_b32 v233,16,v196
M v[172:175],a[208:211],a[252:255],v[172:175]
v_lshlrev_b32 v237,16,v194
v_lshlrev_b32 v236,16,v202
M v[172:175],a[196:199],a[200:203],v[172:175]
buffer_load_dwordx4 a[232:235],v250,s[20:23],s46 offen offset:2048 sc1
M v[172:175],a[248:251],a[212:215],v[172:175]
s_add_u32 s46,s77,36864
v_lshlrev_b32 v235,16,v200
v_fmac_f32 v232,s43,v234
M v[176:179],a[248:251],a[200:203],v[176:179]
v_fmac_f32 v237,4.0,v233
v_fma_f32 v238,-4.0,v234,v236
M v[176:179],a[196:199],a[252:255],v[176:179]
v_fmac_f32 v232,s45,v236
v_fmac_f32 v237,s41,v235
M v[176:179],a[208:211],a[204:207],v[176:179]
s_waitcnt lgkmcnt(0)
s_barrier
v_sub_f32 v236,v236,v234
M v[180:183],a[208:211],a[228:231],v[180:183]
buffer_load_dwordx4 a[236:239],v250,s[20:23],s46 offen offset:0 sc1
M v[180:183],a[196:199],a[204:207],v[180:183]
ds_read_b128 a[212:215],v248 offset:34816
v_fma_f32 v234,-4.0,v233,v235
M v[180:183],a[248:251],a[252:255],v[180:183]
ds_read_b128 a[200:203],v249 offset:34816
v_sub_f32 v235,v235,v233
M v[184:187],a[248:251],a[204:207],v[184:187]
ds_read_b128 a[252:255],v248 offset:35328
v_add_f32 v233,v238,v234
M v[184:187],a[196:199],a[228:231],v[184:187]
ds_read_b128 a[204:207],v249 offset:35328
v_sub_f32 v238,v238,v234
M v[184:187],a[208:211],a[216:219],v[184:187]
v_fma_f32 v234,2.0,v235,v236
v_fmac_f32 v236,-2.0,v235
M v[188:191],a[208:211],v[224:227],v[188:191]
buffer_load_dwordx4 a[208:211],v250,s[20:23],s46 offen offset:1024 sc1
M v[188:191],a[196:199],a[216:219],v[188:191]
v_and_b32 v198,s42,v198
v_and_b32 v192,s42,v192
M v[188:191],a[248:251],a[228:231],v[188:191]
s_waitcnt lgkmcnt(3)
buffer_load_dwordx4 v[224:227],v250,s[20:23],s46 offen offset:2048 sc1
M a[0:3],v[220:223],a[212:215],a[0:3]
s_waitcnt vmcnt(10) lgkmcnt(2)
s_add_u32 s47,s77,12288
ds_read_b128 a[216:219],v248 offset:35840
v_and_b32 v196,s42,v196
M a[0:3],a[224:227],a[200:203],a[0:3]
s_waitcnt vmcnt(9) lgkmcnt(2)
ds_read_b128 a[228:231],v249 offset:35840
v_and_b32 v194,s42,v194
M a[0:3],a[220:223],a[252:255],a[0:3]
s_waitcnt lgkmcnt(2)
v_and_b32 v202,s42,v202
v_and_b32 v200,s42,v200
M a[4:7],a[220:223],a[204:207],a[4:7]
buffer_load_dwordx4 a[196:199],v250,s[20:23],s47 offen offset:0 sc1
M a[4:7],a[224:227],a[252:255],a[4:7]
v_fmac_f32 v192,s43,v198
v_fmac_f32 v194,4.0,v196
M a[4:7],v[220:223],a[200:203],a[4:7]
v_fma_f32 v235,-4.0,v198,v202
v_fmac_f32 v192,s45,v202
M a[8:11],v[220:223],a[252:255],a[8:11]
ds_read_b128 a[248:251],v248 offset:36352
v_fmac_f32 v194,s41,v200
M a[8:11],a[224:227],a[204:207],a[8:11]
s_waitcnt lgkmcnt(2)
ds_read_b128 a[212:215],v249 offset:36352
v_sub_f32 v202,v202,v198
M a[8:11],a[220:223],a[216:219],a[8:11]
s_waitcnt lgkmcnt(2)
v_fma_f32 v198,-4.0,v196,v200
v_sub_f32 v200,v200,v196
M a[12:15],a[220:223],a[228:231],a[12:15]
v_add_f32 v196,v235,v198
v_sub_f32 v235,v235,v198
M a[12:15],a[224:227],a[216:219],a[12:15]
v_fma_f32 v198,2.0,v200,v202
v_fmac_f32 v202,-2.0,v200
M a[12:15],v[220:223],a[204:207],a[12:15]
v_cvt_pk_bf16_f32 v192,v232,v192
v_cvt_pk_bf16_f32 v194,v237,v194
M a[16:19],v[220:223],a[216:219],a[16:19]
ds_read_b128 a[200:203],v249 offset:36864
v_cvt_pk_bf16_f32 v196,v233,v196
M a[16:19],a[224:227],a[228:231],a[16:19]
s_waitcnt lgkmcnt(2)
ds_read_b128 a[252:255],v248 offset:36864
v_cvt_pk_bf16_f32 v200,v234,v198
M a[16:19],a[220:223],a[248:251],a[16:19]
s_waitcnt lgkmcnt(2)
v_cvt_pk_bf16_f32 v198,v238,v235
v_cvt_pk_bf16_f32 v202,v236,v202
M a[20:23],a[220:223],a[212:215],a[20:23]
v_permlane32_swap_b32 v197,v199
v_permlane32_swap_b32 v193,v195
M a[20:23],a[224:227],a[248:251],a[20:23]
ds_read_b128 a[204:207],v248 offset:43520
v_permlane32_swap_b32 v201,v203
M a[20:23],v[220:223],a[228:231],a[20:23]
ds_read_b128 a[216:219],v249 offset:43520
v_lshlrev_b32 v234,16,v199
M a[24:27],v[220:223],a[248:251],a[24:27]
ds_read_b128 a[228:231],v248 offset:44032
v_lshlrev_b32 v232,16,v193
M a[24:27],a[224:227],a[212:215],a[24:27]
s_waitcnt lgkmcnt(4)
ds_read_b128 a[248:251],v249 offset:44032
v_lshlrev_b32 v233,16,v197
M a[24:27],a[220:223],a[200:203],a[24:27]
s_waitcnt lgkmcnt(4)
v_lshlrev_b32 v237,16,v195
v_lshlrev_b32 v236,16,v203
M a[28:31],a[220:223],a[252:255],a[28:31]
buffer_load_dwordx4 a[220:223],v250,s[20:23],s47 offen offset:1024 sc1
M a[28:31],a[224:227],a[200:203],a[28:31]
v_lshlrev_b32 v235,16,v201
v_fmac_f32 v232,s43,v234
M a[28:31],v[220:223],a[212:215],a[28:31]
s_waitcnt vmcnt(10) lgkmcnt(3)
buffer_load_dwordx4 a[252:255],v250,s[20:23],s47 offen offset:2048 sc1
M a[96:99],v[216:219],a[204:207],a[96:99]
s_waitcnt vmcnt(10) lgkmcnt(2)
s_add_u32 s48,s77,15360
ds_read_b128 a[224:227],v248 offset:44544
v_fmac_f32 v237,4.0,v233
M a[96:99],a[244:247],a[216:219],a[96:99]
s_waitcnt vmcnt(9) lgkmcnt(2)
ds_read_b128 a[212:215],v249 offset:44544
v_fma_f32 v238,-4.0,v234,v236
M a[96:99],a[240:243],a[228:231],a[96:99]
s_waitcnt lgkmcnt(2)
v_fmac_f32 v232,s45,v236
v_fmac_f32 v237,s41,v235
M a[100:103],a[240:243],a[248:251],a[100:103]
buffer_load_dwordx4 a[200:203],v250,s[20:23],s48 offen offset:0 sc1
M a[100:103],a[244:247],a[228:231],a[100:103]
v_sub_f32 v236,v236,v234
v_fma_f32 v234,-4.0,v233,v235
M a[100:103],v[216:219],a[216:219],a[100:103]
v_sub_f32 v235,v235,v233
v_add_f32 v233,v238,v234
M a[104:107],v[216:219],a[228:231],a[104:107]
ds_read_b128 v[220:223],v248 offset:45056
v_sub_f32 v238,v238,v234
M a[104:107],a[244:247],a[248:251],a[104:107]
s_waitcnt lgkmcnt(2)
ds_read_b128 a[204:207],v249 offset:45056
v_fma_f32 v234,2.0,v235,v236
M a[104:107],a[240:243],a[224:227],a[104:107]
s_waitcnt lgkmcnt(2)
v_fmac_f32 v236,-2.0,v235
v_and_b32 v199,s42,v199
M a[108:111],a[240:243],a[212:215],a[108:111]
v_and_b32 v193,s42,v193
v_and_b32 v197,s42,v197
M a[108:111],a[244:247],a[224:227],a[108:111]
v_and_b32 v195,s42,v195
v_and_b32 v203,s42,v203
M a[108:111],v[216:219],a[248:251],a[108:111]
v_and_b32 v201,s42,v201
v_fmac_f32 v193,s43,v199
M a[112:115],v[216:219],a[224:227],a[112:115]
ds_read_b128 a[216:219],v249 offset:45568
v_fmac_f32 v195,4.0,v197
M a[112:115],a[244:247],a[212:215],a[112:115]
s_waitcnt lgkmcnt(2)
ds_read_b128 a[228:231],v248 offset:45568
v_and_b32 v255,256,v245
M a[112:115],a[240:243],v[220:223],a[112:115]
s_waitcnt lgkmcnt(2)
v_mul_u32_u24 v255,3,v255
v_and_or_b32 v255,v245,s42,v255
M a[116:119],a[240:243],a[204:207],a[116:119]
v_fma_f32 v235,-4.0,v199,v203
v_fmac_f32 v193,s45,v203
M a[116:119],a[244:247],v[220:223],a[116:119]
ds_read_b128 a[248:251],v248 offset:0
v_fmac_f32 v195,s41,v201
M a[116:119],v[216:219],a[212:215],a[116:119]
s_add_u32 s31,s66,6684672
ds_read_b128 a[224:227],v249 offset:0
v_sub_f32 v203,v203,v199
M a[120:123],v[216:219],v[220:223],a[120:123]
ds_read_b128 a[212:215],v248 offset:512
v_fma_f32 v199,-4.0,v197,v201
M a[120:123],a[244:247],a[204:207],a[120:123]
s_waitcnt lgkmcnt(4)
ds_read_b128 v[220:223],v249 offset:512
v_sub_f32 v201,v201,v197
M a[120:123],a[240:243],a[216:219],a[120:123]
s_waitcnt lgkmcnt(4)
v_add_f32 v197,v235,v199
v_sub_f32 v235,v235,v199
M a[124:127],a[240:243],a[228:231],a[124:127]
buffer_load_dword a228,v255,s[8:11],s31 offen offset:0
M a[124:127],a[244:247],a[216:219],a[124:127]
v_fma_f32 v199,2.0,v201,v203
v_fmac_f32 v203,-2.0,v201
M a[124:127],v[216:219],a[204:207],a[124:127]
s_waitcnt vmcnt(10) lgkmcnt(3)
v_cvt_pk_bf16_f32 v193,v232,v193
v_cvt_pk_bf16_f32 v195,v237,v195
M v[0:3],v[228:231],a[248:251],v[0:3]
s_waitcnt vmcnt(9) lgkmcnt(2)
ds_read_b128 a[240:243],v248 offset:1024
v_cvt_pk_bf16_f32 v197,v233,v197
M v[0:3],a[192:195],a[224:227],v[0:3]
s_waitcnt vmcnt(8) lgkmcnt(2)
buffer_load_dword a228,v255,s[8:11],s31 offen offset:384
M v[0:3],a[232:235],a[212:215],v[0:3]
s_waitcnt lgkmcnt(1)
ds_read_b128 a[216:219],v249 offset:1024
v_cvt_pk_bf16_f32 v201,v234,v199
M v[4:7],a[232:235],v[220:223],v[4:7]
v_cvt_pk_bf16_f32 v199,v238,v235
v_cvt_pk_bf16_f32 v203,v236,v203
M v[4:7],a[192:195],a[212:215],v[4:7]
M v[4:7],v[228:231],a[224:227],v[4:7]
M v[8:11],v[228:231],a[212:215],v[8:11]
ds_read_b128 a[244:247],v248 offset:1536
M v[8:11],a[192:195],v[220:223],v[8:11]
s_waitcnt lgkmcnt(2)
ds_read_b128 a[204:207],v249 offset:1536
M v[8:11],a[232:235],a[240:243],v[8:11]
s_waitcnt lgkmcnt(2)
M v[12:15],a[232:235],a[216:219],v[12:15]
M v[12:15],a[192:195],a[240:243],v[12:15]
M v[12:15],v[228:231],v[220:223],v[12:15]
M v[16:19],v[228:231],a[240:243],v[16:19]
ds_read_b128 v[216:219],v249 offset:2048
M v[16:19],a[192:195],a[216:219],v[16:19]
s_waitcnt lgkmcnt(2)
buffer_load_dwordx4 a[228:231],v250,s[20:23],s48 offen offset:1024 sc1
M v[16:19],a[232:235],a[244:247],v[16:19]
s_waitcnt lgkmcnt(1)
ds_read_b128 a[248:251],v248 offset:2048
M v[20:23],a[232:235],a[204:207],v[20:23]
buffer_load_dwordx4 a[224:227],v250,s[20:23],s48 offen offset:2048 sc1
M v[20:23],a[192:195],a[244:247],v[20:23]
ds_read_b128 a[212:215],v248 offset:8704
M v[20:23],v[228:231],a[216:219],v[20:23]
ds_read_b128 v[220:223],v249 offset:8704
M v[24:27],v[228:231],a[244:247],v[24:27]
ds_read_b128 a[240:243],v248 offset:9216
M v[24:27],a[192:195],a[204:207],v[24:27]
s_waitcnt lgkmcnt(4)
ds_read_b128 a[216:219],v249 offset:9216
M v[24:27],a[232:235],v[216:219],v[24:27]
s_waitcnt lgkmcnt(4)
M v[28:31],a[232:235],a[248:251],v[28:31]
s_add_u32 s47,s77,21504
M v[28:31],a[192:195],v[216:219],v[28:31]
M v[28:31],v[228:231],a[204:207],v[28:31]
s_waitcnt vmcnt(10) lgkmcnt(3)
M v[96:99],a[236:239],a[212:215],v[96:99]
s_waitcnt vmcnt(9) lgkmcnt(2)
ds_read_b128 a[244:247],v248 offset:9728
M v[96:99],a[208:211],v[220:223],v[96:99]
s_waitcnt vmcnt(8) lgkmcnt(2)
ds_read_b128 a[232:235],v249 offset:9728
M v[96:99],v[224:227],a[240:243],v[96:99]
s_waitcnt lgkmcnt(2)
M v[100:103],v[224:227],a[216:219],v[100:103]
buffer_load_dwordx4 a[248:251],v250,s[20:23],s47 offen offset:0 sc1
M v[100:103],a[208:211],a[240:243],v[100:103]
M v[100:103],a[236:239],v[220:223],v[100:103]
buffer_load_dwordx4 a[192:195],v250,s[20:23],s47 offen offset:1024 sc1
M v[104:107],a[236:239],a[240:243],v[104:107]
ds_read_b128 v[228:231],v248 offset:10240
v_accvgpr_read_b32 v238,a0
M v[104:107],a[208:211],a[216:219],v[104:107]
s_waitcnt lgkmcnt(2)
ds_read_b128 a[212:215],v249 offset:10240
v_accvgpr_read_b32 v232,a96
M v[104:107],v[224:227],a[244:247],v[104:107]
s_waitcnt lgkmcnt(2)
v_add_f32 v234,v238,v232
v_sub_f32 v238,v238,v232
M v[108:111],v[224:227],a[232:235],v[108:111]
buffer_load_dwordx4 v[216:219],v250,s[20:23],s47 offen offset:2048 sc1
M v[108:111],a[208:211],a[244:247],v[108:111]
s_add_u32 s48,s77,24576
v_add_f32 v232,v0,v96
v_sub_f32 v96,v0,v96
M v[108:111],a[236:239],a[216:219],v[108:111]
v_add_f32 v0,v234,v232
v_fmac_f32 v234,4.0,v232
M v[112:115],a[236:239],a[244:247],v[112:115]
ds_read_b128 v[220:223],v249 offset:10752
v_fma_f32 v232,2.0,v96,v238
M v[112:115],a[208:211],a[232:235],v[112:115]
s_waitcnt lgkmcnt(2)
buffer_load_dwordx4 a[204:207],v250,s[20:23],s48 offen offset:0 sc1
M v[112:115],v[224:227],v[228:231],v[112:115]
s_waitcnt lgkmcnt(1)
ds_read_b128 a[240:243],v248 offset:10752
v_fma_f32 v96,s40,v96,v238
M v[116:119],v[224:227],a[212:215],v[116:119]
v_accvgpr_read_b32 v238,a1
v_accvgpr_read_b32 v237,a97
M v[116:119],a[208:211],v[228:231],v[116:119]
ds_read_b128 a[216:219],v248 offset:34816
v_add_f32 v236,v238,v237
M v[116:119],a[236:239],a[232:235],v[116:119]
ds_read_b128 a[244:247],v249 offset:34816
v_sub_f32 v238,v238,v237
M v[120:123],a[236:239],v[228:231],v[120:123]
ds_read_b128 a[232:235],v248 offset:35328
v_add_f32 v237,v1,v97
M v[120:123],a[208:211],a[212:215],v[120:123]
s_waitcnt lgkmcnt(4)
ds_read_b128 v[228:231],v249 offset:35328
v_sub_f32 v97,v1,v97
M v[120:123],v[224:227],v[220:223],v[120:123]
s_waitcnt lgkmcnt(4)
v_add_f32 v1,v236,v237
v_fmac_f32 v236,4.0,v237
M v[124:127],v[224:227],a[240:243],v[124:127]
v_fma_f32 v237,2.0,v97,v238
v_fma_f32 v97,s40,v97,v238
M v[124:127],a[208:211],v[220:223],v[124:127]
v_cvt_pk_bf16_f32 v232,v232,v237
v_cvt_pk_bf16_f32 v234,v234,v236
M v[124:127],a[236:239],a[212:215],v[124:127]
s_waitcnt vmcnt(11) lgkmcnt(3)
v_accvgpr_read_b32 v238,a2
v_accvgpr_read_b32 v233,a98
M a[32:35],a[196:199],a[216:219],a[32:35]
s_waitcnt vmcnt(10) lgkmcnt(2)
ds_read_b128 a[240:243],v248 offset:35840
v_add_f32 v235,v238,v233
M a[32:35],a[220:223],a[244:247],a[32:35]
s_waitcnt vmcnt(9) lgkmcnt(2)
ds_read_b128 v[224:227],v249 offset:35840
v_sub_f32 v238,v238,v233
M a[32:35],a[252:255],a[232:235],a[32:35]
s_waitcnt lgkmcnt(2)
v_add_f32 v233,v2,v98
v_sub_f32 v98,v2,v98
M a[36:39],a[252:255],v[228:231],a[36:39]
v_add_f32 v2,v235,v233
v_fmac_f32 v235,4.0,v233
M a[36:39],a[220:223],a[232:235],a[36:39]
v_fma_f32 v233,2.0,v98,v238
v_fma_f32 v98,s40,v98,v238
M a[36:39],a[196:199],a[244:247],a[36:39]
v_accvgpr_read_b32 v238,a3
v_accvgpr_read_b32 v237,a99
M a[40:43],a[196:199],a[232:235],a[40:43]
ds_read_b128 a[96:99],v248 offset:36352
v_add_f32 v236,v238,v237
M a[40:43],a[220:223],v[228:231],a[40:43]
s_waitcnt lgkmcnt(2)
ds_read_b128 a[208:211],v249 offset:36352
v_sub_f32 v238,v238,v237
M a[40:43],a[252:255],a[240:243],a[40:43]
s_waitcnt lgkmcnt(2)
v_add_f32 v237,v3,v99
v_sub_f32 v99,v3,v99
M a[44:47],a[252:255],v[224:227],a[44:47]
v_add_f32 v3,v236,v237
v_fmac_f32 v236,4.0,v237
M a[44:47],a[220:223],a[240:243],a[44:47]
v_fma_f32 v237,2.0,v99,v238
v_fma_f32 v99,s40,v99,v238
M a[44:47],a[196:199],v[228:231],a[44:47]
v_cvt_pk_bf16_f32 v233,v233,v237
v_cvt_pk_bf16_f32 v235,v235,v236
M a[48:51],a[196:199],a[240:243],a[48:51]
ds_read_b128 v[220:223],v249 offset:36864
ds_write2st64_b64 v254,v[232:233],v[234:235] offset0:68 offset1:72
M a[48:51],a[220:223],v[224:227],a[48:51]
s_waitcnt lgkmcnt(3)
ds_read_b128 a[212:215],v248 offset:36864
v_accvgpr_read_b32 v238,a4
M a[48:51],a[252:255],a[96:99],a[48:51]
s_waitcnt lgkmcnt(3)
v_accvgpr_read_b32 v232,a100
v_add_f32 v234,v238,v232
M a[52:55],a[252:255],a[208:211],a[52:55]
buffer_load_dwordx4 a[236:239],v250,s[20:23],s48 offen offset:1024 sc1
M a[52:55],a[220:223],a[96:99],a[52:55]
v_sub_f32 v238,v238,v232
v_add_f32 v232,v4,v100
M a[52:55],a[196:199],v[224:227],a[52:55]
v_sub_f32 v100,v4,v100
v_add_f32 v4,v234,v232
M a[56:59],a[196:199],a[96:99],a[56:59]
v_fmac_f32 v234,4.0,v232
v_fma_f32 v232,2.0,v100,v238
M a[56:59],a[220:223],a[208:211],a[56:59]
s_waitcnt lgkmcnt(2)
v_fma_f32 v100,s40,v100,v238
v_accvgpr_read_b32 v238,a5
M a[56:59],a[252:255],v[220:223],a[56:59]
s_waitcnt lgkmcnt(0)
v_accvgpr_read_b32 v237,a101
v_add_f32 v236,v238,v237
M a[60:63],a[252:255],a[212:215],a[60:63]
buffer_load_dwordx4 a[252:255],v250,s[20:23],s48 offen offset:2048 sc1
M a[60:63],a[220:223],v[220:223],a[60:63]
s_add_u32 s47,s77,30720
v_sub_f32 v238,v238,v237
v_add_f32 v237,v5,v101
M a[60:63],a[196:199],a[208:211],a[60:63]
s_waitcnt vmcnt(10)
buffer_load_dwordx4 a[220:223],v250,s[20:23],s47 offen offset:0 sc1
M a[64:67],a[200:203],a[216:219],a[64:67]
s_waitcnt vmcnt(8)
v_sub_f32 v101,v5,v101
v_add_f32 v5,v236,v237
M a[64:67],a[228:231],a[244:247],a[64:67]
s_waitcnt vmcnt(7)
v_fmac_f32 v236,4.0,v237
v_fma_f32 v237,2.0,v101,v238
M a[64:67],a[224:227],a[232:235],a[64:67]
v_fma_f32 v101,s40,v101,v238
v_cvt_pk_bf16_f32 v232,v232,v237
M a[68:71],a[224:227],v[228:231],a[68:71]
buffer_load_dwordx4 a[196:199],v250,s[20:23],s47 offen offset:1024 sc1
M a[68:71],a[228:231],a[232:235],a[68:71]
v_cvt_pk_bf16_f32 v234,v234,v236
v_accvgpr_read_b32 v238,a6
M a[68:71],a[200:203],a[244:247],a[68:71]
v_accvgpr_read_b32 v233,a102
v_add_f32 v235,v238,v233
M a[72:75],a[200:203],a[232:235],a[72:75]
v_sub_f32 v238,v238,v233
v_add_f32 v233,v6,v102
M a[72:75],a[228:231],v[228:231],a[72:75]
buffer_load_dwordx4 a[216:219],v250,s[20:23],s47 offen offset:2048 sc1
M a[72:75],a[224:227],a[240:243],a[72:75]
s_add_u32 s48,s77,33792
v_sub_f32 v102,v6,v102
v_add_f32 v6,v235,v233
M a[76:79],a[224:227],v[224:227],a[76:79]
v_fmac_f32 v235,4.0,v233
v_fma_f32 v233,2.0,v102,v238
M a[76:79],a[228:231],a[240:243],a[76:79]
v_fma_f32 v102,s40,v102,v238
v_accvgpr_read_b32 v238,a7
M a[76:79],a[200:203],v[228:231],a[76:79]
buffer_load_dwordx4 a[244:247],v250,s[20:23],s48 offen offset:0 sc1
M a[80:83],a[200:203],a[240:243],a[80:83]
v_accvgpr_read_b32 v237,a103
v_add_f32 v236,v238,v237
M a[80:83],a[228:231],v[224:227],a[80:83]
v_sub_f32 v238,v238,v237
v_add_f32 v237,v7,v103
M a[80:83],a[224:227],a[96:99],a[80:83]
v_sub_f32 v103,v7,v103
v_add_f32 v7,v236,v237
M a[84:87],a[224:227],a[208:211],a[84:87]
buffer_load_dwordx4 a[232:235],v250,s[20:23],s48 offen offset:1024 sc1
M a[84:87],a[228:231],a[96:99],a[84:87]
ds_read_b128 a[100:103],v248 offset:43520
v_fmac_f32 v236,4.0,v237
M a[84:87],a[200:203],v[224:227],a[84:87]
s_add_u32 s31,s66,7077888
ds_read_b128 v[228:231],v249 offset:43520
v_fma_f32 v237,2.0,v103,v238
M a[88:91],a[200:203],a[96:99],a[88:91]
ds_read_b128 a[96:99],v248 offset:44032
v_fma_f32 v103,s40,v103,v238
M a[88:91],a[228:231],a[208:211],a[88:91]
ds_read_b128 a[240:243],v249 offset:44032
v_cvt_pk_bf16_f32 v233,v233,v237
M a[88:91],a[224:227],v[220:223],a[88:91]
v_cvt_pk_bf16_f32 v235,v235,v236
M a[92:95],a[224:227],a[212:215],a[92:95]
buffer_load_dword v224,v255,s[8:11],s31 offen offset:0
M a[92:95],a[228:231],v[220:223],a[92:95]
ds_write2st64_b64 v254,v[232:233],v[234:235] offset0:76 offset1:80
M a[92:95],a[200:203],a[208:211],a[92:95]
s_waitcnt vmcnt(11) lgkmcnt(4)
v_accvgpr_read_b32 v238,a8
v_accvgpr_read_b32 v232,a104
M a[128:131],a[248:251],a[100:103],a[128:131]
s_waitcnt vmcnt(10) lgkmcnt(3)
ds_read_b128 a[212:215],v248 offset:44544
v_add_f32 v234,v238,v232
M a[128:131],a[192:195],v[228:231],a[128:131]
s_waitcnt vmcnt(9) lgkmcnt(3)
buffer_load_dword v224,v255,s[8:11],s31 offen offset:384
M a[128:131],v[216:219],a[96:99],a[128:131]
s_waitcnt lgkmcnt(2)
ds_read_b128 a[224:227],v249 offset:44544
v_sub_f32 v238,v238,v232
M a[132:135],v[216:219],a[240:243],a[132:135]
v_add_f32 v232,v8,v104
v_sub_f32 v104,v8,v104
M a[132:135],a[192:195],a[96:99],a[132:135]
v_add_f32 v8,v234,v232
v_fmac_f32 v234,4.0,v232
M a[132:135],a[248:251],v[228:231],a[132:135]
v_fma_f32 v232,2.0,v104,v238
v_fma_f32 v104,s40,v104,v238
M a[136:139],a[248:251],a[96:99],a[136:139]
s_waitcnt lgkmcnt(2)
s_barrier
ds_read_b128 a[0:3],v250 offset:34816
M a[136:139],a[192:195],a[240:243],a[136:139]
s_waitcnt lgkmcnt(2)
ds_read_b128 a[4:7],v250 offset:38912
ds_read_b128 a[228:231],v248 offset:45056
M a[136:139],v[216:219],a[212:215],a[136:139]
s_waitcnt lgkmcnt(3)
ds_read_b128 v[220:223],v249 offset:45056
v_accvgpr_read_b32 v238,a9
M a[140:143],v[216:219],a[224:227],a[140:143]
v_accvgpr_read_b32 v237,a105
v_add_f32 v236,v238,v237
M a[140:143],a[192:195],a[212:215],a[140:143]
v_sub_f32 v238,v238,v237
v_add_f32 v237,v9,v105
M a[140:143],a[248:251],a[240:243],a[140:143]
v_sub_f32 v105,v9,v105
v_add_f32 v9,v236,v237
M a[144:147],a[248:251],a[212:215],a[144:147]
ds_read_b128 a[200:203],v249 offset:45568
v_fmac_f32 v236,4.0,v237
M a[144:147],a[192:195],a[224:227],a[144:147]
s_waitcnt lgkmcnt(2)
ds_read_b128 a[208:211],v248 offset:45568
v_fma_f32 v237,2.0,v105,v238
M a[144:147],v[216:219],a[228:231],a[144:147]
s_waitcnt lgkmcnt(2)
buffer_load_dwordx4 v[224:227],v250,s[20:23],s48 offen offset:2048 sc1
M a[148:151],v[216:219],v[220:223],a[148:151]
v_fma_f32 v105,s40,v105,v238
v_cvt_pk_bf16_f32 v232,v232,v237
M a[148:151],a[192:195],a[228:231],a[148:151]
v_cvt_pk_bf16_f32 v234,v234,v236
v_accvgpr_read_b32 v238,a10
M a[148:151],a[248:251],a[224:227],a[148:151]
v_accvgpr_read_b32 v233,a106
v_add_f32 v235,v238,v233
M a[152:155],a[248:251],a[228:231],a[152:155]
v_sub_f32 v238,v238,v233
v_add_f32 v233,v10,v106
M a[152:155],a[192:195],v[220:223],a[152:155]
s_waitcnt lgkmcnt(1)
v_sub_f32 v106,v10,v106
v_add_f32 v10,v235,v233
M a[152:155],v[216:219],a[200:203],a[152:155]
s_waitcnt lgkmcnt(0)
v_fmac_f32 v235,4.0,v233
v_fma_f32 v233,2.0,v106,v238
M a[156:159],v[216:219],a[208:211],a[156:159]
global_load_dword v216,v250,s[64:65]
M a[156:159],a[192:195],a[200:203],a[156:159]
s_add_u32 s47,s77,39936
v_fma_f32 v106,s40,v106,v238
v_accvgpr_read_b32 v238,a11
M a[156:159],a[248:251],v[220:223],a[156:159]
s_waitcnt vmcnt(11)
v_accvgpr_read_b32 v237,a107
v_add_f32 v236,v238,v237
M a[160:163],a[204:207],a[100:103],a[160:163]
s_waitcnt vmcnt(10)
v_sub_f32 v238,v238,v237
v_add_f32 v237,v11,v107
M a[160:163],a[236:239],v[228:231],a[160:163]
s_waitcnt vmcnt(9)
v_sub_f32 v107,v11,v107
v_add_f32 v11,v236,v237
M a[160:163],a[252:255],a[96:99],a[160:163]
v_fmac_f32 v236,4.0,v237
v_fma_f32 v237,2.0,v107,v238
M a[164:167],a[252:255],a[240:243],a[164:167]
buffer_load_dwordx4 v[216:219],v250,s[20:23],s47 offen offset:0 sc1
M a[164:167],a[236:239],a[96:99],a[164:167]
v_fma_f32 v107,s40,v107,v238
v_cvt_pk_bf16_f32 v233,v233,v237
M a[164:167],a[204:207],v[228:231],a[164:167]
buffer_load_dwordx4 a[100:103],v250,s[20:23],s47 offen offset:1024 sc1
M a[168:171],a[204:207],a[96:99],a[168:171]
v_cvt_pk_bf16_f32 v235,v235,v236
M a[168:171],a[236:239],a[240:243],a[168:171]
ds_write2st64_b64 v254,v[232:233],v[234:235] offset0:85 offset1:89
M a[168:171],a[252:255],a[212:215],a[168:171]
v_accvgpr_read_b32 v204,a12
v_accvgpr_read_b32 v208,a108
M a[172:175],a[252:255],a[224:227],a[172:175]
buffer_load_dwordx4 a[104:107],v250,s[20:23],s47 offen offset:2048 sc1
M a[172:175],a[236:239],a[212:215],a[172:175]
s_add_u32 s48,s77,43008
v_accvgpr_read_b32 v205,a13
v_accvgpr_read_b32 v209,a109
M a[172:175],a[204:207],a[240:243],a[172:175]
v_accvgpr_read_b32 v206,a14
v_accvgpr_read_b32 v210,a110
v_accvgpr_read_b32 v207,a15
v_accvgpr_read_b32 v211,a111
v_pk_add_f32 v[212:213],v[204:205],v[208:209]
v_pk_add_f32 v[214:215],v[206:207],v[210:211]
v_pk_add_f32 v[204:205],v[204:205],v[208:209] neg_lo:[0,1] neg_hi:[0,1]
v_pk_add_f32 v[206:207],v[206:207],v[210:211] neg_lo:[0,1] neg_hi:[0,1]
v_pk_add_f32 v[208:209],v[12:13],v[108:109]
v_pk_add_f32 v[210:211],v[14:15],v[110:111]
v_pk_add_f32 v[108:109],v[12:13],v[108:109] neg_lo:[0,1] neg_hi:[0,1]
v_pk_add_f32 v[110:111],v[14:15],v[110:111] neg_lo:[0,1] neg_hi:[0,1]
v_pk_add_f32 v[12:13],v[212:213],v[208:209]
v_pk_add_f32 v[14:15],v[214:215],v[210:211]
v_pk_fma_f32 v[212:213],v[208:209],4.0,v[212:213] op_sel_hi:[1,0,1]
v_pk_fma_f32 v[214:215],v[210:211],4.0,v[214:215] op_sel_hi:[1,0,1]
v_pk_fma_f32 v[208:209],v[108:109],2.0,v[204:205] op_sel_hi:[1,0,1]
v_pk_fma_f32 v[210:211],v[110:111],2.0,v[206:207] op_sel_hi:[1,0,1]
v_pk_fma_f32 v[108:109],v[108:109],s[40:41],v[204:205] op_sel_hi:[1,0,1]
v_pk_fma_f32 v[110:111],v[110:111],s[40:41],v[206:207] op_sel_hi:[1,0,1]
M a[176:179],a[204:207],a[212:215],a[176:179]
buffer_load_dwordx4 a[192:195],v250,s[20:23],s48 offen offset:0 sc1
M a[176:179],a[236:239],a[224:227],a[176:179]
v_cvt_pk_bf16_f32 v208,v208,v209
v_cvt_pk_bf16_f32 v209,v210,v211
M a[176:179],a[252:255],a[228:231],a[176:179]
buffer_load_dwordx4 a[248:251],v250,s[20:23],s48 offen offset:1024 sc1
M a[180:183],a[252:255],v[220:223],a[180:183]
v_cvt_pk_bf16_f32 v212,v212,v213
v_cvt_pk_bf16_f32 v213,v214,v215
M a[180:183],a[236:239],a[228:231],a[180:183]
ds_read_b128 a[108:111],v248 offset:0
ds_write2st64_b64 v254,v[208:209],v[212:213] offset0:93 offset1:97
M a[180:183],a[204:207],a[224:227],a[180:183]
buffer_load_dwordx4 a[96:99],v250,s[20:23],s48 offen offset:2048 sc1
M a[184:187],a[204:207],a[228:231],a[184:187]
s_add_u32 s46,s72,0
ds_read_b128 a[240:243],v249 offset:0
ds_read_b128 a[212:215],v248 offset:512
M a[184:187],a[236:239],v[220:223],a[184:187]
ds_read_b128 a[224:227],v249 offset:512
v_accvgpr_read_b32 v238,a16
M a[184:187],a[252:255],a[200:203],a[184:187]
v_accvgpr_read_b32 v232,a112
v_add_f32 v234,v238,v232
M a[188:191],a[252:255],a[208:211],a[188:191]
buffer_load_dwordx4 v[228:231],v250,s[20:23],s46 offen offset:0 sc1
M a[188:191],a[236:239],a[200:203],a[188:191]
v_sub_f32 v238,v238,v232
v_add_f32 v232,v16,v112
M a[188:191],a[204:207],v[220:223],a[188:191]
s_waitcnt vmcnt(15) lgkmcnt(4)
v_sub_f32 v112,v16,v112
v_add_f32 v16,v234,v232
M v[32:35],a[220:223],a[108:111],v[32:35]
s_waitcnt vmcnt(14) lgkmcnt(2)
ds_read_b128 a[208:211],v248 offset:1024
v_fmac_f32 v234,4.0,v232
M v[32:35],a[196:199],a[240:243],v[32:35]
s_waitcnt vmcnt(13) lgkmcnt(2)
buffer_load_dwordx4 a[228:231],v250,s[20:23],s46 offen offset:1024 sc1
M v[32:35],a[216:219],a[212:215],v[32:35]
s_waitcnt lgkmcnt(1)
ds_read_b128 a[252:255],v249 offset:1024
v_fma_f32 v232,2.0,v112,v238
M v[36:39],a[216:219],a[224:227],v[36:39]
v_fma_f32 v112,s40,v112,v238
M v[36:39],a[196:199],a[212:215],v[36:39]
s_barrier
ds_read_b128 a[8:11],v250 offset:43520
M v[36:39],a[220:223],a[240:243],v[36:39]
ds_read_b128 a[12:15],v250 offset:47616
v_accvgpr_read_b32 v238,a17
M v[40:43],a[220:223],a[212:215],v[40:43]
ds_read_b128 a[200:203],v248 offset:1536
v_accvgpr_read_b32 v237,a113
M v[40:43],a[196:199],a[224:227],v[40:43]
s_waitcnt lgkmcnt(4)
ds_read_b128 a[236:239],v249 offset:1536
v_add_f32 v236,v238,v237
M v[40:43],a[216:219],a[208:211],v[40:43]
s_waitcnt lgkmcnt(4)
v_sub_f32 v238,v238,v237
v_add_f32 v237,v17,v113
M v[44:47],a[216:219],a[252:255],v[44:47]
v_sub_f32 v113,v17,v113
v_add_f32 v17,v236,v237
M v[44:47],a[196:199],a[208:211],v[44:47]
v_fmac_f32 v236,4.0,v237
v_fma_f32 v237,2.0,v113,v238
M v[44:47],a[220:223],a[224:227],v[44:47]
v_fma_f32 v113,s40,v113,v238
v_cvt_pk_bf16_f32 v232,v232,v237
M v[48:51],a[220:223],a[208:211],v[48:51]
ds_read_b128 a[204:207],v249 offset:2048
v_cvt_pk_bf16_f32 v234,v234,v236
M v[48:51],a[196:199],a[252:255],v[48:51]
s_waitcnt lgkmcnt(2)
ds_read_b128 v[220:223],v248 offset:2048
v_accvgpr_read_b32 v238,a18
M v[48:51],a[216:219],a[200:203],v[48:51]
s_waitcnt lgkmcnt(2)
v_accvgpr_read_b32 v233,a114
v_add_f32 v235,v238,v233
M v[52:55],a[216:219],a[236:239],v[52:55]
v_sub_f32 v238,v238,v233
v_add_f32 v233,v18,v114
M v[52:55],a[196:199],a[200:203],v[52:55]
v_sub_f32 v114,v18,v114
v_add_f32 v18,v235,v233
M v[52:55],a[220:223],a[252:255],v[52:55]
v_fmac_f32 v235,4.0,v233
v_fma_f32 v233,2.0,v114,v238
M v[56:59],a[220:223],a[200:203],v[56:59]
v_fma_f32 v114,s40,v114,v238
v_accvgpr_read_b32 v238,a19
M v[56:59],a[196:199],a[236:239],v[56:59]
s_waitcnt lgkmcnt(1)
v_accvgpr_read_b32 v237,a115
v_add_f32 v236,v238,v237
M v[56:59],a[216:219],a[204:207],v[56:59]
s_waitcnt lgkmcnt(0)
v_sub_f32 v238,v238,v237
v_add_f32 v237,v19,v115
M v[60:63],a[216:219],v[220:223],v[60:63]
buffer_load_dwordx4 a[112:115],v250,s[20:23],s46 offen offset:2048 sc1
M v[60:63],a[196:199],a[204:207],v[60:63]
s_add_u32 s46,s73,0
v_sub_f32 v115,v19,v115
v_add_f32 v19,v236,v237
M v[60:63],a[220:223],a[236:239],v[60:63]
s_waitcnt vmcnt(14)
buffer_load_dwordx4 a[216:219],v250,s[20:23],s46 offen offset:0 sc1
M v[64:67],a[244:247],a[108:111],v[64:67]
s_waitcnt vmcnt(14)
v_fmac_f32 v236,4.0,v237
v_fma_f32 v237,2.0,v115,v238
M v[64:67],a[232:235],a[240:243],v[64:67]
s_waitcnt vmcnt(11)
v_fma_f32 v115,s40,v115,v238
v_cvt_pk_bf16_f32 v233,v233,v237
M v[64:67],v[224:227],a[212:215],v[64:67]
v_cvt_pk_bf16_f32 v235,v235,v236
M v[68:71],v[224:227],a[224:227],v[68:71]
buffer_load_dwordx4 a[196:199],v250,s[20:23],s46 offen offset:1024 sc1
M v[68:71],a[232:235],a[212:215],v[68:71]
ds_write2st64_b64 v254,v[232:233],v[234:235] offset0:68 offset1:72
M v[68:71],a[244:247],a[240:243],v[68:71]
v_accvgpr_read_b32 v238,a20
v_accvgpr_read_b32 v232,a116
M v[72:75],a[244:247],a[212:215],v[72:75]
v_add_f32 v234,v238,v232
v_sub_f32 v238,v238,v232
M v[72:75],a[232:235],a[224:227],v[72:75]
buffer_load_dwordx4 a[108:111],v250,s[20:23],s46 offen offset:2048 sc1
M v[72:75],v[224:227],a[208:211],v[72:75]
s_add_u32 s31,s66,7471104
v_add_f32 v232,v20,v116
v_sub_f32 v116,v20,v116
M v[76:79],v[224:227],a[252:255],v[76:79]
v_add_f32 v20,v234,v232
v_fmac_f32 v234,4.0,v232
M v[76:79],a[232:235],a[208:211],v[76:79]
v_fma_f32 v232,2.0,v116,v238
v_fma_f32 v116,s40,v116,v238
M v[76:79],a[244:247],a[224:227],v[76:79]
buffer_load_dword a220,v255,s[8:11],s31 offen offset:0
M v[80:83],a[244:247],a[208:211],v[80:83]
v_accvgpr_read_b32 v238,a21
v_accvgpr_read_b32 v237,a117
M v[80:83],a[232:235],a[252:255],v[80:83]
v_add_f32 v236,v238,v237
v_sub_f32 v238,v238,v237
M v[80:83],v[224:227],a[200:203],v[80:83]
v_add_f32 v237,v21,v117
v_sub_f32 v117,v21,v117
M v[84:87],v[224:227],a[236:239],v[84:87]
buffer_load_dword a220,v255,s[8:11],s31 offen offset:384
M v[84:87],a[232:235],a[200:203],v[84:87]
ds_read_b128 a[240:243],v248 offset:8704
v_add_f32 v21,v236,v237
M v[84:87],a[244:247],a[252:255],v[84:87]
ds_read_b128 a[212:215],v249 offset:8704
v_fmac_f32 v236,4.0,v237
M v[88:91],a[244:247],a[200:203],v[88:91]
ds_read_b128 a[224:227],v248 offset:9216
v_fma_f32 v237,2.0,v117,v238
M v[88:91],a[232:235],a[236:239],v[88:91]
ds_read_b128 a[208:211],v249 offset:9216
v_fma_f32 v117,s40,v117,v238
M v[88:91],v[224:227],a[204:207],v[88:91]
v_cvt_pk_bf16_f32 v232,v232,v237
v_cvt_pk_bf16_f32 v234,v234,v236
M v[92:95],v[224:227],v[220:223],v[92:95]
v_accvgpr_read_b32 v238,a22
v_accvgpr_read_b32 v233,a118
M v[92:95],a[232:235],a[204:207],v[92:95]
v_add_f32 v235,v238,v233
v_sub_f32 v238,v238,v233
M v[92:95],a[244:247],a[236:239],v[92:95]
s_waitcnt vmcnt(13) lgkmcnt(3)
v_add_f32 v233,v22,v118
v_sub_f32 v118,v22,v118
M v[128:131],v[216:219],a[240:243],v[128:131]
s_waitcnt vmcnt(12) lgkmcnt(2)
ds_read_b128 a[252:255],v248 offset:9728
v_add_f32 v22,v235,v233
M v[128:131],a[100:103],a[212:215],v[128:131]
s_waitcnt vmcnt(11) lgkmcnt(2)
ds_read_b128 a[200:203],v249 offset:9728
v_fmac_f32 v235,4.0,v233
M v[128:131],a[104:107],a[224:227],v[128:131]
s_waitcnt lgkmcnt(2)
v_fma_f32 v233,2.0,v118,v238
v_fma_f32 v118,s40,v118,v238
M v[132:135],a[104:107],a[208:211],v[132:135]
v_accvgpr_read_b32 v238,a23
v_accvgpr_read_b32 v237,a119
M v[132:135],a[100:103],a[224:227],v[132:135]
v_add_f32 v236,v238,v237
v_sub_f32 v238,v238,v237
M v[132:135],v[216:219],a[212:215],v[132:135]
s_add_u32 s46,s74,0
v_add_f32 v237,v23,v119
v_sub_f32 v119,v23,v119
M v[136:139],v[216:219],a[224:227],v[136:139]
ds_read_b128 a[116:119],v248 offset:10240
v_add_f32 v23,v236,v237
M v[136:139],a[100:103],a[208:211],v[136:139]
s_waitcnt lgkmcnt(2)
ds_read_b128 v[220:223],v249 offset:10240
v_fmac_f32 v236,4.0,v237
M v[136:139],a[104:107],a[252:255],v[136:139]
s_waitcnt lgkmcnt(2)
v_fma_f32 v237,2.0,v119,v238
v_fma_f32 v119,s40,v119,v238
M v[140:143],a[104:107],a[200:203],v[140:143]
v_cvt_pk_bf16_f32 v233,v233,v237
v_cvt_pk_bf16_f32 v235,v235,v236
M v[140:143],a[100:103],a[252:255],v[140:143]
ds_write2st64_b64 v254,v[232:233],v[234:235] offset0:76 offset1:80
M v[140:143],v[216:219],a[208:211],v[140:143]
buffer_load_dwordx4 a[220:223],v250,s[20:23],s46 offen offset:0 sc1
M v[144:147],v[216:219],a[252:255],v[144:147]
ds_read_b128 a[232:235],v249 offset:10752
v_accvgpr_read_b32 v238,a24
M v[144:147],a[100:103],a[200:203],v[144:147]
s_waitcnt lgkmcnt(3)
buffer_load_dwordx4 v[224:227],v250,s[20:23],s46 offen offset:1024 sc1
M v[144:147],a[104:107],a[116:119],v[144:147]
s_waitcnt lgkmcnt(2)
ds_read_b128 a[236:239],v248 offset:10752
v_accvgpr_read_b32 v232,a120
M v[148:151],a[104:107],v[220:223],v[148:151]
v_add_f32 v234,v238,v232
v_sub_f32 v238,v238,v232
M v[148:151],a[100:103],a[116:119],v[148:151]
v_add_f32 v232,v24,v120
v_sub_f32 v120,v24,v120
M v[148:151],v[216:219],a[200:203],v[148:151]
buffer_load_dwordx4 a[204:207],v250,s[20:23],s46 offen offset:2048 sc1
M v[152:155],v[216:219],a[116:119],v[152:155]
s_add_u32 s46,s75,0
v_add_f32 v24,v234,v232
v_fmac_f32 v234,4.0,v232
M v[152:155],a[100:103],v[220:223],v[152:155]
s_waitcnt lgkmcnt(1)
v_fma_f32 v232,2.0,v120,v238
v_fma_f32 v120,s40,v120,v238
M v[152:155],a[104:107],a[232:235],v[152:155]
s_waitcnt lgkmcnt(0)
s_barrier
ds_read_b128 a[16:19],v250 offset:34816
M v[156:159],a[104:107],a[236:239],v[156:159]
ds_read_b128 a[20:23],v250 offset:38912
v_accvgpr_read_b32 v238,a25
M v[156:159],a[100:103],a[232:235],v[156:159]
buffer_load_dwordx4 a[244:247],v250,s[20:23],s46 offen offset:0 sc1
M v[156:159],v[216:219],v[220:223],v[156:159]
s_waitcnt vmcnt(14)
v_accvgpr_read_b32 v237,a121
v_add_f32 v236,v238,v237
M v[160:163],a[192:195],a[240:243],v[160:163]
s_waitcnt vmcnt(13)
v_sub_f32 v238,v238,v237
v_add_f32 v237,v25,v121
M v[160:163],a[248:251],a[212:215],v[160:163]
s_waitcnt vmcnt(12)
buffer_load_dwordx4 a[104:107],v250,s[20:23],s46 offen offset:1024 sc1
M v[160:163],a[96:99],a[224:227],v[160:163]
v_sub_f32 v121,v25,v121
v_add_f32 v25,v236,v237
M v[164:167],a[96:99],a[208:211],v[164:167]
v_fmac_f32 v236,4.0,v237
v_fma_f32 v237,2.0,v121,v238
M v[164:167],a[248:251],a[224:227],v[164:167]
v_fma_f32 v121,s40,v121,v238
v_cvt_pk_bf16_f32 v232,v232,v237
M v[164:167],a[192:195],a[212:215],v[164:167]
buffer_load_dwordx4 a[100:103],v250,s[20:23],s46 offen offset:2048 sc1
M v[168:171],a[192:195],a[224:227],v[168:171]
s_add_u32 s46,s76,0
v_cvt_pk_bf16_f32 v234,v234,v236
v_accvgpr_read_b32 v238,a26
M v[168:171],a[248:251],a[208:211],v[168:171]
v_accvgpr_read_b32 v233,a122
v_add_f32 v235,v238,v233
M v[168:171],a[96:99],a[252:255],v[168:171]
v_sub_f32 v238,v238,v233
v_add_f32 v233,v26,v122
M v[172:175],a[96:99],a[200:203],v[172:175]
buffer_load_dwordx4 v[216:219],v250,s[20:23],s46 offen offset:0 sc1
M v[172:175],a[248:251],a[252:255],v[172:175]
v_sub_f32 v122,v26,v122
v_add_f32 v26,v235,v233
M v[172:175],a[192:195],a[208:211],v[172:175]
v_fmac_f32 v235,4.0,v233
v_fma_f32 v233,2.0,v122,v238
M v[176:179],a[192:195],a[252:255],v[176:179]
v_fma_f32 v122,s40,v122,v238
v_accvgpr_read_b32 v238,a27
M v[176:179],a[248:251],a[200:203],v[176:179]
buffer_load_dwordx4 a[240:243],v250,s[20:23],s46 offen offset:1024 sc1
M v[176:179],a[96:99],a[116:119],v[176:179]
v_add_u32 v248,0xffffbc00,v248
v_add_u32 v249,0xffffbc00,v249
M v[180:183],a[96:99],v[220:223],v[180:183]
v_accvgpr_read_b32 v237,a123
v_add_f32 v236,v238,v237
M v[180:183],a[248:251],a[116:119],v[180:183]
ds_read_b128 a[208:211],v248 offset:0
v_sub_f32 v238,v238,v237
M v[180:183],a[192:195],a[200:203],v[180:183]
buffer_load_dwordx4 a[212:215],v250,s[20:23],s46 offen offset:2048 sc1
M v[184:187],a[192:195],a[116:119],v[184:187]
s_add_u32 s46,s77,0
ds_read_b128 a[120:123],v249 offset:0
ds_read_b128 a[116:119],v248 offset:512
M v[184:187],a[248:251],v[220:223],v[184:187]
ds_read_b128 a[252:255],v249 offset:512
v_add_f32 v237,v27,v123
M v[184:187],a[96:99],a[232:235],v[184:187]
v_sub_f32 v123,v27,v123
v_add_f32 v27,v236,v237
M v[188:191],a[96:99],a[236:239],v[188:191]
buffer_load_dwordx4 a[224:227],v250,s[20:23],s46 offen offset:0 sc1
M v[188:191],a[248:251],a[232:235],v[188:191]
v_fmac_f32 v236,4.0,v237
v_fma_f32 v237,2.0,v123,v238
M v[188:191],a[192:195],v[220:223],v[188:191]
s_waitcnt vmcnt(17) lgkmcnt(3)
v_fma_f32 v123,s40,v123,v238
v_cvt_pk_bf16_f32 v233,v233,v237
M v[0:3],v[228:231],a[208:211],v[0:3]
s_waitcnt vmcnt(16) lgkmcnt(2)
ds_read_b128 a[248:251],v248 offset:1024
v_cvt_pk_bf16_f32 v235,v235,v236
M v[0:3],a[228:231],a[120:123],v[0:3]
s_waitcnt vmcnt(15) lgkmcnt(2)
buffer_load_dwordx4 a[96:99],v250,s[20:23],s46 offen offset:1024 sc1
M v[0:3],a[112:115],a[116:119],v[0:3]
s_waitcnt lgkmcnt(1)
ds_read_b128 a[192:195],v249 offset:1024
ds_write2st64_b64 v254,v[232:233],v[234:235] offset0:85 offset1:89
M v[4:7],a[112:115],a[252:255],v[4:7]
v_accvgpr_read_b32 v204,a28
v_accvgpr_read_b32 v208,a124
M v[4:7],a[228:231],a[116:119],v[4:7]
buffer_load_dwordx4 a[200:203],v250,s[20:23],s46 offen offset:2048 sc1
M v[4:7],v[228:231],a[120:123],v[4:7]
s_add_u32 s46,s72,46080
v_accvgpr_read_b32 v205,a29
v_accvgpr_read_b32 v209,a125
M v[8:11],v[228:231],a[116:119],v[8:11]
ds_read_b128 a[116:119],v248 offset:1536
v_accvgpr_read_b32 v206,a30
M v[8:11],a[228:231],a[252:255],v[8:11]
s_waitcnt lgkmcnt(3)
ds_read_b128 a[120:123],v249 offset:1536
v_accvgpr_read_b32 v210,a126
v_accvgpr_read_b32 v207,a31
v_accvgpr_read_b32 v211,a127
v_pk_add_f32 v[212:213],v[204:205],v[208:209]
v_pk_add_f32 v[214:215],v[206:207],v[210:211]
v_pk_add_f32 v[204:205],v[204:205],v[208:209] neg_lo:[0,1] neg_hi:[0,1]
v_pk_add_f32 v[206:207],v[206:207],v[210:211] neg_lo:[0,1] neg_hi:[0,1]
v_pk_add_f32 v[208:209],v[28:29],v[124:125]
v_pk_add_f32 v[210:211],v[30:31],v[126:127]
v_pk_add_f32 v[124:125],v[28:29],v[124:125] neg_lo:[0,1] neg_hi:[0,1]
v_pk_add_f32 v[126:127],v[30:31],v[126:127] neg_lo:[0,1] neg_hi:[0,1]
v_pk_add_f32 v[28:29],v[212:213],v[208:209]
v_pk_add_f32 v[30:31],v[214:215],v[210:211]
v_pk_fma_f32 v[212:213],v[208:209],4.0,v[212:213] op_sel_hi:[1,0,1]
v_pk_fma_f32 v[214:215],v[210:211],4.0,v[214:215] op_sel_hi:[1,0,1]
v_pk_fma_f32 v[208:209],v[124:125],2.0,v[204:205] op_sel_hi:[1,0,1]
v_pk_fma_f32 v[210:211],v[126:127],2.0,v[206:207] op_sel_hi:[1,0,1]
v_pk_fma_f32 v[124:125],v[124:125],s[40:41],v[204:205] op_sel_hi:[1,0,1]
v_pk_fma_f32 v[126:127],v[126:127],s[40:41],v[206:207] op_sel_hi:[1,0,1]
M v[8:11],a[112:115],a[248:251],v[8:11]
s_waitcnt lgkmcnt(3)
buffer_load_dwordx4 a[236:239],v250,s[20:23],s46 offen offset:0 sc1
M v[12:15],a[112:115],a[192:195],v[12:15]
v_cvt_pk_bf16_f32 v208,v208,v209
v_cvt_pk_bf16_f32 v209,v210,v211
M v[12:15],a[228:231],a[248:251],v[12:15]
buffer_load_dwordx4 a[232:235],v250,s[20:23],s46 offen offset:1024 sc1
M v[12:15],v[228:231],a[252:255],v[12:15]
v_cvt_pk_bf16_f32 v212,v212,v213
v_cvt_pk_bf16_f32 v213,v214,v215
M v[16:19],v[228:231],a[248:251],v[16:19]
ds_read_b128 a[124:127],v249 offset:2048
ds_write2st64_b64 v254,v[208:209],v[212:213] offset0:93 offset1:97
M v[16:19],a[228:231],a[192:195],v[16:19]
s_waitcnt lgkmcnt(3)
ds_read_b128 v[220:223],v248 offset:2048
v_add_u32 v248,0x15400,v248
M v[16:19],a[112:115],a[116:119],v[16:19]
s_waitcnt lgkmcnt(3)
v_add_u32 v249,0x15400,v249
v_accvgpr_read_b32 v238,a32
M v[20:23],a[112:115],a[120:123],v[20:23]
v_accvgpr_read_b32 v232,a128
v_add_f32 v234,v238,v232
M v[20:23],a[228:231],a[116:119],v[20:23]
ds_read_b128 a[208:211],v248 offset:0
v_sub_f32 v238,v238,v232
M v[20:23],v[228:231],a[192:195],v[20:23]
ds_read_b128 a[252:255],v249 offset:0
v_add_f32 v232,v32,v128
M v[24:27],v[228:231],a[116:119],v[24:27]
ds_read_b128 a[116:119],v248 offset:512
v_sub_f32 v128,v32,v128
M v[24:27],a[228:231],a[120:123],v[24:27]
s_waitcnt lgkmcnt(5)
ds_read_b128 a[248:251],v249 offset:512
v_add_f32 v32,v234,v232
M v[24:27],a[112:115],a[124:127],v[24:27]
s_waitcnt lgkmcnt(4)
buffer_load_dwordx4 a[192:195],v250,s[20:23],s46 offen offset:2048 sc1
M v[28:31],a[112:115],v[220:223],v[28:31]
s_add_u32 s47,s72,49152
v_fmac_f32 v234,4.0,v232
v_fma_f32 v232,2.0,v128,v238
M v[28:31],a[228:231],a[124:127],v[28:31]
buffer_load_dwordx4 a[112:115],v250,s[20:23],s47 offen offset:0 sc1
M v[28:31],v[228:231],a[120:123],v[28:31]
s_waitcnt vmcnt(20) lgkmcnt(3)
v_fma_f32 v128,s40,v128,v238
M v[0:3],a[216:219],a[208:211],v[0:3]
s_waitcnt vmcnt(19) lgkmcnt(2)
s_barrier
ds_read_b128 a[24:27],v250 offset:43520
M v[0:3],a[196:199],a[252:255],v[0:3]
s_waitcnt vmcnt(18) lgkmcnt(2)
ds_read_b128 a[28:31],v250 offset:47616
ds_read_b128 a[120:123],v248 offset:1024
M v[0:3],a[108:111],a[116:119],v[0:3]
s_waitcnt lgkmcnt(3)
buffer_load_dwordx4 v[220:223],v250,s[20:23],s47 offen offset:1024 sc1
M v[4:7],a[108:111],a[248:251],v[4:7]
ds_read_b128 a[228:231],v249 offset:1024
v_accvgpr_read_b32 v238,a33
M v[4:7],a[196:199],a[116:119],v[4:7]
v_accvgpr_read_b32 v237,a129
v_add_f32 v236,v238,v237
M v[4:7],a[216:219],a[252:255],v[4:7]
v_sub_f32 v238,v238,v237
v_add_f32 v237,v33,v129
M v[8:11],a[216:219],a[116:119],v[8:11]
buffer_load_dwordx4 a[124:127],v250,s[20:23],s47 offen offset:2048 sc1
M v[8:11],a[196:199],a[248:251],v[8:11]
s_waitcnt lgkmcnt(1)
ds_read_b128 a[116:119],v248 offset:1536
ds_read_b128 v[228:231],v249 offset:1536
M v[8:11],a[108:111],a[120:123],v[8:11]
s_waitcnt lgkmcnt(2)
s_add_u32 s34,s32,0
v_sub_f32 v129,v33,v129
v_add_f32 v33,v236,v237
M v[12:15],a[108:111],a[228:231],v[12:15]
v_fmac_f32 v236,4.0,v237
v_fma_f32 v237,2.0,v129,v238
M v[12:15],a[196:199],a[120:123],v[12:15]
v_fma_f32 v129,s40,v129,v238
v_cvt_pk_bf16_f32 v232,v232,v237
M v[12:15],a[216:219],a[248:251],v[12:15]
buffer_store_dwordx4 a[0:3],v253,s[24:27],s34 offen offset:384 nt
M v[16:19],a[216:219],a[120:123],v[16:19]
ds_read_b128 a[120:123],v249 offset:2048
v_cvt_pk_bf16_f32 v234,v234,v236
M v[16:19],a[196:199],a[228:231],v[16:19]
s_waitcnt lgkmcnt(2)
ds_read_b128 a[208:211],v248 offset:2048
v_accvgpr_read_b32 v238,a34
M v[16:19],a[108:111],a[116:119],v[16:19]
s_waitcnt lgkmcnt(2)
v_accvgpr_read_b32 v233,a130
v_add_f32 v235,v238,v233
M v[20:23],a[108:111],v[228:231],v[20:23]
s_add_u32 s46,s73,46080
v_sub_f32 v238,v238,v233
v_add_f32 v233,v34,v130
M v[20:23],a[196:199],a[116:119],v[20:23]
ds_read_b128 a[252:255],v248 offset:17408
v_sub_f32 v130,v34,v130
M v[20:23],a[216:219],a[228:231],v[20:23]
ds_read_b128 a[248:251],v249 offset:17408
v_add_f32 v34,v235,v233
M v[24:27],a[216:219],a[116:119],v[24:27]
ds_read_b128 a[116:119],v248 offset:17920
v_fmac_f32 v235,4.0,v233
M v[24:27],a[196:199],v[228:231],v[24:27]
s_waitcnt lgkmcnt(4)
ds_read_b128 a[228:231],v249 offset:17920
v_fma_f32 v233,2.0,v130,v238
M v[24:27],a[108:111],a[120:123],v[24:27]
s_waitcnt lgkmcnt(4)
v_fma_f32 v130,s40,v130,v238
v_accvgpr_read_b32 v238,a35
M v[28:31],a[108:111],a[208:211],v[28:31]
buffer_load_dwordx4 a[108:111],v250,s[20:23],s46 offen offset:0 sc1
M v[28:31],a[196:199],a[120:123],v[28:31]
v_accvgpr_read_b32 v237,a131
v_add_f32 v236,v238,v237
M v[28:31],a[216:219],v[228:231],v[28:31]
s_waitcnt vmcnt(19) lgkmcnt(3)
buffer_load_dwordx4 a[208:211],v250,s[20:23],s46 offen offset:1024 sc1
M v[0:3],a[220:223],a[252:255],v[0:3]
s_waitcnt vmcnt(19) lgkmcnt(2)
ds_read_b128 a[128:131],v248 offset:18432
v_sub_f32 v238,v238,v237
M v[0:3],v[224:227],a[248:251],v[0:3]
s_waitcnt vmcnt(18) lgkmcnt(2)
ds_read_b128 a[196:199],v249 offset:18432
v_add_f32 v237,v35,v131
M v[0:3],a[204:207],a[116:119],v[0:3]
s_waitcnt lgkmcnt(2)
s_add_u32 s34,s32,196608
v_sub_f32 v131,v35,v131
v_add_f32 v35,v236,v237
M v[4:7],a[204:207],a[228:231],v[4:7]
buffer_load_dwordx4 a[120:123],v250,s[20:23],s46 offen offset:2048 sc1
M v[4:7],v[224:227],a[116:119],v[4:7]
v_fmac_f32 v236,4.0,v237
v_fma_f32 v237,2.0,v131,v238
M v[4:7],a[220:223],a[248:251],v[4:7]
v_fma_f32 v131,s40,v131,v238
v_cvt_pk_bf16_f32 v233,v233,v237
M v[8:11],a[220:223],a[116:119],v[8:11]
ds_read_b128 a[116:119],v248 offset:18944
v_cvt_pk_bf16_f32 v235,v235,v236
M v[8:11],v[224:227],a[228:231],v[8:11]
s_waitcnt lgkmcnt(2)
ds_read_b128 a[216:219],v249 offset:18944
ds_write2st64_b64 v254,v[232:233],v[234:235] offset0:34 offset1:38
M v[8:11],a[204:207],a[128:131],v[8:11]
s_waitcnt lgkmcnt(3)
buffer_store_dwordx4 a[4:7],v253,s[24:27],s34 offen offset:384 nt
M v[12:15],a[204:207],a[196:199],v[12:15]
v_accvgpr_read_b32 v204,a36
v_accvgpr_read_b32 v208,a132
M v[12:15],v[224:227],a[128:131],v[12:15]
v_accvgpr_read_b32 v205,a37
v_accvgpr_read_b32 v209,a133
M v[12:15],a[220:223],a[228:231],v[12:15]
v_accvgpr_read_b32 v206,a38
v_accvgpr_read_b32 v210,a134
v_accvgpr_read_b32 v207,a39
v_accvgpr_read_b32 v211,a135
v_pk_add_f32 v[212:213],v[204:205],v[208:209]
v_pk_add_f32 v[214:215],v[206:207],v[210:211]
v_pk_add_f32 v[204:205],v[204:205],v[208:209] neg_lo:[0,1] neg_hi:[0,1]
v_pk_add_f32 v[206:207],v[206:207],v[210:211] neg_lo:[0,1] neg_hi:[0,1]
v_pk_add_f32 v[208:209],v[36:37],v[132:133]
v_pk_add_f32 v[210:211],v[38:39],v[134:135]
v_pk_add_f32 v[132:133],v[36:37],v[132:133] neg_lo:[0,1] neg_hi:[0,1]
v_pk_add_f32 v[134:135],v[38:39],v[134:135] neg_lo:[0,1] neg_hi:[0,1]
v_pk_add_f32 v[36:37],v[212:213],v[208:209]
v_pk_add_f32 v[38:39],v[214:215],v[210:211]
v_pk_fma_f32 v[212:213],v[208:209],4.0,v[212:213] op_sel_hi:[1,0,1]
v_pk_fma_f32 v[214:215],v[210:211],4.0,v[214:215] op_sel_hi:[1,0,1]
v_pk_fma_f32 v[208:209],v[132:133],2.0,v[204:205] op_sel_hi:[1,0,1]
v_pk_fma_f32 v[210:211],v[134:135],2.0,v[206:207] op_sel_hi:[1,0,1]
v_pk_fma_f32 v[132:133],v[132:133],s[40:41],v[204:205] op_sel_hi:[1,0,1]
v_pk_fma_f32 v[134:135],v[134:135],s[40:41],v[206:207] op_sel_hi:[1,0,1]
M v[16:19],a[220:223],a[128:131],v[16:19]
s_add_u32 s47,s73,49152
ds_read_b128 a[128:131],v249 offset:19456
v_cvt_pk_bf16_f32 v208,v208,v209
M v[16:19],v[224:227],a[196:199],v[16:19]
s_waitcnt lgkmcnt(3)
ds_read_b128 v[228:231],v248 offset:19456
v_cvt_pk_bf16_f32 v209,v210,v211
M v[16:19],a[204:207],a[116:119],v[16:19]
s_waitcnt lgkmcnt(3)
v_cvt_pk_bf16_f32 v212,v212,v213
v_cvt_pk_bf16_f32 v213,v214,v215
M v[20:23],a[204:207],a[216:219],v[20:23]
ds_write2st64_b64 v254,v[208:209],v[212:213] offset0:42 offset1:46
M v[20:23],v[224:227],a[116:119],v[20:23]
ds_read_b128 a[132:135],v248 offset:34816
v_accvgpr_read_b32 v204,a40
M v[20:23],a[220:223],a[196:199],v[20:23]
ds_read_b128 a[252:255],v249 offset:34816
v_accvgpr_read_b32 v208,a136
M v[24:27],a[220:223],a[116:119],v[24:27]
buffer_load_dwordx4 a[116:119],v250,s[20:23],s47 offen offset:0 sc1
M v[24:27],v[224:227],a[216:219],v[24:27]
s_waitcnt lgkmcnt(4)
ds_read_b128 a[248:251],v248 offset:35328
ds_read_b128 a[228:231],v249 offset:35328
M v[24:27],a[204:207],a[128:131],v[24:27]
s_waitcnt lgkmcnt(5)
s_add_u32 s34,s32,393216
buffer_store_dwordx4 a[8:11],v253,s[24:27],s34 offen offset:384 nt
M v[28:31],a[204:207],v[228:231],v[28:31]
v_accvgpr_read_b32 v205,a41
v_accvgpr_read_b32 v209,a137
M v[28:31],v[224:227],a[128:131],v[28:31]
v_accvgpr_read_b32 v206,a42
v_accvgpr_read_b32 v210,a138
v_accvgpr_read_b32 v207,a43
v_accvgpr_read_b32 v211,a139
v_pk_add_f32 v[212:213],v[204:205],v[208:209]
v_pk_add_f32 v[214:215],v[206:207],v[210:211]
v_pk_add_f32 v[204:205],v[204:205],v[208:209] neg_lo:[0,1] neg_hi:[0,1]
v_pk_add_f32 v[206:207],v[206:207],v[210:211] neg_lo:[0,1] neg_hi:[0,1]
v_pk_add_f32 v[208:209],v[40:41],v[136:137]
v_pk_add_f32 v[210:211],v[42:43],v[138:139]
v_pk_add_f32 v[136:137],v[40:41],v[136:137] neg_lo:[0,1] neg_hi:[0,1]
v_pk_add_f32 v[138:139],v[42:43],v[138:139] neg_lo:[0,1] neg_hi:[0,1]
v_pk_add_f32 v[40:41],v[212:213],v[208:209]
v_pk_add_f32 v[42:43],v[214:215],v[210:211]
v_pk_fma_f32 v[212:213],v[208:209],4.0,v[212:213] op_sel_hi:[1,0,1]
v_pk_fma_f32 v[214:215],v[210:211],4.0,v[214:215] op_sel_hi:[1,0,1]
v_pk_fma_f32 v[208:209],v[136:137],2.0,v[204:205] op_sel_hi:[1,0,1]
v_pk_fma_f32 v[210:211],v[138:139],2.0,v[206:207] op_sel_hi:[1,0,1]
v_pk_fma_f32 v[136:137],v[136:137],s[40:41],v[204:205] op_sel_hi:[1,0,1]
v_pk_fma_f32 v[138:139],v[138:139],s[40:41],v[206:207] op_sel_hi:[1,0,1]
M v[28:31],a[220:223],a[216:219],v[28:31]
s_waitcnt vmcnt(21) lgkmcnt(3)
buffer_load_dwordx4 a[196:199],v250,s[20:23],s47 offen offset:1024 sc1
M v[0:3],a[244:247],a[132:135],v[0:3]
s_waitcnt vmcnt(21) lgkmcnt(2)
ds_read_b128 a[128:131],v248 offset:35840
v_cvt_pk_bf16_f32 v208,v208,v209
M v[0:3],a[104:107],a[252:255],v[0:3]
s_waitcnt vmcnt(20) lgkmcnt(2)
buffer_load_dwordx4 a[204:207],v250,s[20:23],s47 offen offset:2048 sc1
M v[0:3],a[100:103],a[248:251],v[0:3]
s_waitcnt lgkmcnt(1)
ds_read_b128 a[132:135],v249 offset:35840
v_cvt_pk_bf16_f32 v209,v210,v211
M v[4:7],a[100:103],a[228:231],v[4:7]
v_cvt_pk_bf16_f32 v212,v212,v213
v_cvt_pk_bf16_f32 v213,v214,v215
M v[4:7],a[104:107],a[248:251],v[4:7]
ds_write2st64_b64 v254,v[208:209],v[212:213] offset0:51 offset1:55
M v[4:7],a[244:247],a[252:255],v[4:7]
v_accvgpr_read_b32 v204,a44
v_accvgpr_read_b32 v208,a140
M v[8:11],a[244:247],a[248:251],v[8:11]
ds_read_b128 a[136:139],v248 offset:36352
v_accvgpr_read_b32 v205,a45
M v[8:11],a[104:107],a[228:231],v[8:11]
s_waitcnt lgkmcnt(3)
ds_read_b128 v[228:231],v249 offset:36352
v_accvgpr_read_b32 v209,a141
M v[8:11],a[100:103],a[128:131],v[8:11]
s_waitcnt lgkmcnt(3)
v_accvgpr_read_b32 v206,a46
v_accvgpr_read_b32 v210,a142
v_accvgpr_read_b32 v207,a47
v_accvgpr_read_b32 v211,a143
v_pk_add_f32 v[212:213],v[204:205],v[208:209]
v_pk_add_f32 v[214:215],v[206:207],v[210:211]
v_pk_add_f32 v[204:205],v[204:205],v[208:209] neg_lo:[0,1] neg_hi:[0,1]
v_pk_add_f32 v[206:207],v[206:207],v[210:211] neg_lo:[0,1] neg_hi:[0,1]
v_pk_add_f32 v[208:209],v[44:45],v[140:141]
v_pk_add_f32 v[210:211],v[46:47],v[142:143]
v_pk_add_f32 v[140:141],v[44:45],v[140:141] neg_lo:[0,1] neg_hi:[0,1]
v_pk_add_f32 v[142:143],v[46:47],v[142:143] neg_lo:[0,1] neg_hi:[0,1]
v_pk_add_f32 v[44:45],v[212:213],v[208:209]
v_pk_add_f32 v[46:47],v[214:215],v[210:211]
v_pk_fma_f32 v[212:213],v[208:209],4.0,v[212:213] op_sel_hi:[1,0,1]
v_pk_fma_f32 v[214:215],v[210:211],4.0,v[214:215] op_sel_hi:[1,0,1]
v_pk_fma_f32 v[208:209],v[140:141],2.0,v[204:205] op_sel_hi:[1,0,1]
v_pk_fma_f32 v[210:211],v[142:143],2.0,v[206:207] op_sel_hi:[1,0,1]
v_pk_fma_f32 v[140:141],v[140:141],s[40:41],v[204:205] op_sel_hi:[1,0,1]
v_pk_fma_f32 v[142:143],v[142:143],s[40:41],v[206:207] op_sel_hi:[1,0,1]
M v[12:15],a[100:103],a[132:135],v[12:15]
v_cvt_pk_bf16_f32 v208,v208,v209
v_cvt_pk_bf16_f32 v209,v210,v211
M v[12:15],a[104:107],a[128:131],v[12:15]
v_cvt_pk_bf16_f32 v212,v212,v213
v_cvt_pk_bf16_f32 v213,v214,v215
M v[12:15],a[244:247],a[228:231],v[12:15]
ds_write2st64_b64 v254,v[208:209],v[212:213] offset0:59 offset1:63
M v[16:19],a[244:247],a[128:131],v[16:19]
s_add_u32 s46,s74,46080
ds_read_b128 a[128:131],v249 offset:36864
v_accvgpr_read_b32 v238,a48
M v[16:19],a[104:107],a[132:135],v[16:19]
s_waitcnt lgkmcnt(3)
ds_read_b128 v[224:227],v248 offset:36864
v_accvgpr_read_b32 v232,a144
M v[16:19],a[100:103],a[136:139],v[16:19]
s_waitcnt lgkmcnt(3)
s_add_u32 s34,s32,589824
buffer_store_dwordx4 a[12:15],v253,s[24:27],s34 offen offset:384 nt
M v[20:23],a[100:103],v[228:231],v[20:23]
v_add_f32 v234,v238,v232
v_sub_f32 v238,v238,v232
M v[20:23],a[104:107],a[136:139],v[20:23]
ds_read_b128 a[140:143],v248 offset:52224
v_add_f32 v232,v48,v144
M v[20:23],a[244:247],a[132:135],v[20:23]
ds_read_b128 a[132:135],v249 offset:52224
v_sub_f32 v144,v48,v144
M v[24:27],a[244:247],a[136:139],v[24:27]
buffer_load_dwordx4 a[136:139],v250,s[20:23],s46 offen offset:0 sc1
M v[24:27],a[104:107],v[228:231],v[24:27]
s_waitcnt lgkmcnt(3)
ds_read_b128 a[216:219],v248 offset:52736
ds_read_b128 a[252:255],v249 offset:52736
M v[24:27],a[100:103],a[128:131],v[24:27]
s_waitcnt lgkmcnt(4)
buffer_load_dwordx4 a[220:223],v250,s[20:23],s46 offen offset:1024 sc1
M v[28:31],a[100:103],v[224:227],v[28:31]
v_add_f32 v48,v234,v232
v_fmac_f32 v234,4.0,v232
M v[28:31],a[104:107],a[128:131],v[28:31]
v_fma_f32 v232,2.0,v144,v238
v_fma_f32 v144,s40,v144,v238
M v[28:31],a[244:247],v[228:231],v[28:31]
s_waitcnt vmcnt(23) lgkmcnt(3)
v_accvgpr_read_b32 v238,a49
v_accvgpr_read_b32 v237,a145
M v[0:3],v[216:219],a[140:143],v[0:3]
s_waitcnt vmcnt(22) lgkmcnt(2)
buffer_load_dwordx4 a[248:251],v250,s[20:23],s46 offen offset:2048 sc1
M v[0:3],a[240:243],a[132:135],v[0:3]
s_waitcnt vmcnt(22) lgkmcnt(1)
ds_read_b128 a[100:103],v248 offset:53248
ds_read_b128 a[104:107],v249 offset:53248
M v[0:3],a[212:215],a[216:219],v[0:3]
s_waitcnt lgkmcnt(2)
v_add_f32 v236,v238,v237
v_sub_f32 v238,v238,v237
M v[4:7],a[212:215],a[252:255],v[4:7]
v_add_f32 v237,v49,v145
v_sub_f32 v145,v49,v145
M v[4:7],a[240:243],a[216:219],v[4:7]
v_add_f32 v49,v236,v237
v_fmac_f32 v236,4.0,v237
M v[4:7],v[216:219],a[132:135],v[4:7]
v_fma_f32 v237,2.0,v145,v238
v_fma_f32 v145,s40,v145,v238
M v[8:11],v[216:219],a[216:219],v[8:11]
ds_read_b128 a[128:131],v248 offset:53760
v_cvt_pk_bf16_f32 v232,v232,v237
M v[8:11],a[240:243],a[252:255],v[8:11]
s_waitcnt lgkmcnt(2)
ds_read_b128 a[132:135],v249 offset:53760
v_cvt_pk_bf16_f32 v234,v234,v236
M v[8:11],a[212:215],a[100:103],v[8:11]
s_waitcnt lgkmcnt(2)
s_add_u32 s34,s32,786432
buffer_store_dwordx4 a[16:19],v253,s[24:27],s34 offen offset:384 nt
M v[12:15],a[212:215],a[104:107],v[12:15]
v_accvgpr_read_b32 v238,a50
v_accvgpr_read_b32 v233,a146
M v[12:15],a[240:243],a[100:103],v[12:15]
v_add_f32 v235,v238,v233
v_sub_f32 v238,v238,v233
M v[12:15],v[216:219],a[252:255],v[12:15]
v_add_f32 v233,v50,v146
v_sub_f32 v146,v50,v146
M v[16:19],v[216:219],a[100:103],v[16:19]
s_add_u32 s47,s74,49152
ds_read_b128 a[100:103],v249 offset:54272
v_add_f32 v50,v235,v233
M v[16:19],a[240:243],a[104:107],v[16:19]
s_waitcnt lgkmcnt(2)
ds_read_b128 a[140:143],v248 offset:54272
v_add_u32 v248,0xfffece00,v248
M v[16:19],a[212:215],a[128:131],v[16:19]
s_waitcnt lgkmcnt(2)
v_add_u32 v249,0xfffece00,v249
v_fmac_f32 v235,4.0,v233
M v[20:23],a[212:215],a[132:135],v[20:23]
v_fma_f32 v233,2.0,v146,v238
v_fma_f32 v146,s40,v146,v238
M v[20:23],a[240:243],a[128:131],v[20:23]
ds_read_b128 a[228:231],v248 offset:60928
v_accvgpr_read_b32 v238,a51
M v[20:23],v[216:219],a[104:107],v[20:23]
ds_read_b128 a[104:107],v249 offset:60928
v_accvgpr_read_b32 v237,a147
M v[24:27],v[216:219],a[128:131],v[24:27]
buffer_load_dwordx4 a[128:131],v250,s[20:23],s47 offen offset:0 sc1
M v[24:27],a[240:243],a[132:135],v[24:27]
s_waitcnt lgkmcnt(3)
ds_read_b128 v[224:227],v248 offset:61440
ds_read_b128 v[228:231],v249 offset:61440
M v[24:27],a[212:215],a[100:103],v[24:27]
s_waitcnt lgkmcnt(4)
buffer_load_dwordx4 a[244:247],v250,s[20:23],s47 offen offset:1024 sc1
M v[28:31],a[212:215],a[140:143],v[28:31]
v_add_f32 v236,v238,v237
v_sub_f32 v238,v238,v237
M v[28:31],a[240:243],a[100:103],v[28:31]
v_add_f32 v237,v51,v147
v_sub_f32 v147,v51,v147
M v[28:31],v[216:219],a[132:135],v[28:31]
s_waitcnt vmcnt(24) lgkmcnt(3)
v_add_f32 v51,v236,v237
v_fmac_f32 v236,4.0,v237
M v[0:3],a[224:227],a[228:231],v[0:3]
s_waitcnt vmcnt(23) lgkmcnt(2)
buffer_load_dwordx4 a[216:219],v250,s[20:23],s47 offen offset:2048 sc1
M v[0:3],a[96:99],a[104:107],v[0:3]
s_waitcnt vmcnt(23) lgkmcnt(1)
ds_read_b128 a[100:103],v248 offset:61952
ds_read_b128 a[132:135],v249 offset:61952
M v[0:3],a[200:203],v[224:227],v[0:3]
s_waitcnt lgkmcnt(2)
s_add_u32 s34,s32,983040
v_fma_f32 v237,2.0,v147,v238
v_fma_f32 v147,s40,v147,v238
M v[4:7],a[200:203],v[228:231],v[4:7]
v_cvt_pk_bf16_f32 v233,v233,v237
v_cvt_pk_bf16_f32 v235,v235,v236
M v[4:7],a[96:99],v[224:227],v[4:7]
ds_write2st64_b64 v254,v[232:233],v[234:235] offset0:102 offset1:106
M v[4:7],a[224:227],a[104:107],v[4:7]
buffer_store_dwordx4 a[20:23],v253,s[24:27],s34 offen offset:384 nt
M v[8:11],a[224:227],v[224:227],v[8:11]
ds_read_b128 a[104:107],v248 offset:62464
v_accvgpr_read_b32 v204,a52
M v[8:11],a[96:99],v[228:231],v[8:11]
s_waitcnt lgkmcnt(3)
ds_read_b128 a[140:143],v249 offset:62464
v_accvgpr_read_b32 v208,a148
M v[8:11],a[200:203],a[100:103],v[8:11]
s_waitcnt lgkmcnt(3)
v_accvgpr_read_b32 v205,a53
v_accvgpr_read_b32 v209,a149
M v[12:15],a[200:203],a[132:135],v[12:15]
v_accvgpr_read_b32 v206,a54
v_accvgpr_read_b32 v210,a150
v_accvgpr_read_b32 v207,a55
v_accvgpr_read_b32 v211,a151
v_pk_add_f32 v[212:213],v[204:205],v[208:209]
v_pk_add_f32 v[214:215],v[206:207],v[210:211]
v_pk_add_f32 v[204:205],v[204:205],v[208:209] neg_lo:[0,1] neg_hi:[0,1]
v_pk_add_f32 v[206:207],v[206:207],v[210:211] neg_lo:[0,1] neg_hi:[0,1]
v_pk_add_f32 v[208:209],v[52:53],v[148:149]
v_pk_add_f32 v[210:211],v[54:55],v[150:151]
v_pk_add_f32 v[148:149],v[52:53],v[148:149] neg_lo:[0,1] neg_hi:[0,1]
v_pk_add_f32 v[150:151],v[54:55],v[150:151] neg_lo:[0,1] neg_hi:[0,1]
v_pk_add_f32 v[52:53],v[212:213],v[208:209]
v_pk_add_f32 v[54:55],v[214:215],v[210:211]
v_pk_fma_f32 v[212:213],v[208:209],4.0,v[212:213] op_sel_hi:[1,0,1]
v_pk_fma_f32 v[214:215],v[210:211],4.0,v[214:215] op_sel_hi:[1,0,1]
v_pk_fma_f32 v[208:209],v[148:149],2.0,v[204:205] op_sel_hi:[1,0,1]
v_pk_fma_f32 v[210:211],v[150:151],2.0,v[206:207] op_sel_hi:[1,0,1]
v_pk_fma_f32 v[148:149],v[148:149],s[40:41],v[204:205] op_sel_hi:[1,0,1]
v_pk_fma_f32 v[150:151],v[150:151],s[40:41],v[206:207] op_sel_hi:[1,0,1]
M v[12:15],a[96:99],a[100:103],v[12:15]
v_cvt_pk_bf16_f32 v208,v208,v209
v_cvt_pk_bf16_f32 v209,v210,v211
M v[12:15],a[224:227],v[228:231],v[12:15]
v_cvt_pk_bf16_f32 v212,v212,v213
v_cvt_pk_bf16_f32 v213,v214,v215
M v[16:19],a[224:227],a[100:103],v[16:19]
s_add_u32 s46,s75,46080
ds_read_b128 a[100:103],v249 offset:62976
ds_write2st64_b64 v254,v[208:209],v[212:213] offset0:110 offset1:114
M v[16:19],a[96:99],a[132:135],v[16:19]
s_waitcnt lgkmcnt(3)
ds_read_b128 a[144:147],v248 offset:62976
v_accvgpr_read_b32 v204,a56
M v[16:19],a[200:203],a[104:107],v[16:19]
s_waitcnt lgkmcnt(3)
v_accvgpr_read_b32 v208,a152
v_accvgpr_read_b32 v205,a57
M v[20:23],a[200:203],a[140:143],v[20:23]
v_accvgpr_read_b32 v209,a153
v_accvgpr_read_b32 v206,a58
M v[20:23],a[96:99],a[104:107],v[20:23]
ds_read_b128 a[148:151],v248 offset:0
v_accvgpr_read_b32 v210,a154
v_accvgpr_read_b32 v207,a59
v_accvgpr_read_b32 v211,a155
v_pk_add_f32 v[212:213],v[204:205],v[208:209]
v_pk_add_f32 v[214:215],v[206:207],v[210:211]
v_pk_add_f32 v[204:205],v[204:205],v[208:209] neg_lo:[0,1] neg_hi:[0,1]
v_pk_add_f32 v[206:207],v[206:207],v[210:211] neg_lo:[0,1] neg_hi:[0,1]
v_pk_add_f32 v[208:209],v[56:57],v[152:153]
v_pk_add_f32 v[210:211],v[58:59],v[154:155]
v_pk_add_f32 v[152:153],v[56:57],v[152:153] neg_lo:[0,1] neg_hi:[0,1]
v_pk_add_f32 v[154:155],v[58:59],v[154:155] neg_lo:[0,1] neg_hi:[0,1]
v_pk_add_f32 v[56:57],v[212:213],v[208:209]
v_pk_add_f32 v[58:59],v[214:215],v[210:211]
v_pk_fma_f32 v[212:213],v[208:209],4.0,v[212:213] op_sel_hi:[1,0,1]
v_pk_fma_f32 v[214:215],v[210:211],4.0,v[214:215] op_sel_hi:[1,0,1]
v_pk_fma_f32 v[208:209],v[152:153],2.0,v[204:205] op_sel_hi:[1,0,1]
v_pk_fma_f32 v[210:211],v[154:155],2.0,v[206:207] op_sel_hi:[1,0,1]
v_pk_fma_f32 v[152:153],v[152:153],s[40:41],v[204:205] op_sel_hi:[1,0,1]
v_pk_fma_f32 v[154:155],v[154:155],s[40:41],v[206:207] op_sel_hi:[1,0,1]
M v[20:23],a[224:227],a[132:135],v[20:23]
ds_read_b128 a[132:135],v249 offset:0
v_cvt_pk_bf16_f32 v208,v208,v209
M v[24:27],a[224:227],a[104:107],v[24:27]
buffer_load_dwordx4 a[104:107],v250,s[20:23],s46 offen offset:0 sc1
M v[24:27],a[96:99],a[140:143],v[24:27]
s_waitcnt lgkmcnt(4)
ds_read_b128 a[252:255],v248 offset:512
ds_read_b128 a[240:243],v249 offset:512
M v[24:27],a[200:203],a[100:103],v[24:27]
s_waitcnt lgkmcnt(4)
s_add_u32 s34,s32,1179648
buffer_load_dwordx4 a[212:215],v250,s[20:23],s46 offen offset:1024 sc1
M v[28:31],a[200:203],a[144:147],v[28:31]
v_cvt_pk_bf16_f32 v209,v210,v211
v_cvt_pk_bf16_f32 v212,v212,v213
M v[28:31],a[96:99],a[100:103],v[28:31]
v_cvt_pk_bf16_f32 v213,v214,v215
M v[28:31],a[224:227],a[140:143],v[28:31]
s_waitcnt vmcnt(25) lgkmcnt(3)
ds_write2st64_b64 v254,v[208:209],v[212:213] offset0:119 offset1:123
M v[96:99],a[236:239],a[148:151],v[96:99]
s_waitcnt vmcnt(24) lgkmcnt(3)
buffer_load_dwordx4 v[216:219],v250,s[20:23],s46 offen offset:2048 sc1
M v[96:99],a[232:235],a[132:135],v[96:99]
s_waitcnt vmcnt(24) lgkmcnt(2)
ds_read_b128 a[96:99],v248 offset:1024
ds_read_b128 a[100:103],v249 offset:1024
M v[96:99],a[192:195],a[252:255],v[96:99]
s_waitcnt lgkmcnt(3)
v_accvgpr_read_b32 v204,a60
v_accvgpr_read_b32 v208,a156
M v[100:103],a[192:195],a[240:243],v[100:103]
v_accvgpr_read_b32 v205,a61
v_accvgpr_read_b32 v209,a157
M v[100:103],a[232:235],a[252:255],v[100:103]
v_accvgpr_read_b32 v206,a62
v_accvgpr_read_b32 v210,a158
v_accvgpr_read_b32 v207,a63
v_accvgpr_read_b32 v211,a159
v_pk_add_f32 v[212:213],v[204:205],v[208:209]
v_pk_add_f32 v[214:215],v[206:207],v[210:211]
v_pk_add_f32 v[204:205],v[204:205],v[208:209] neg_lo:[0,1] neg_hi:[0,1]
v_pk_add_f32 v[206:207],v[206:207],v[210:211] neg_lo:[0,1] neg_hi:[0,1]
v_pk_add_f32 v[208:209],v[60:61],v[156:157]
v_pk_add_f32 v[210:211],v[62:63],v[158:159]
v_pk_add_f32 v[156:157],v[60:61],v[156:157] neg_lo:[0,1] neg_hi:[0,1]
v_pk_add_f32 v[158:159],v[62:63],v[158:159] neg_lo:[0,1] neg_hi:[0,1]
v_pk_add_f32 v[60:61],v[212:213],v[208:209]
v_pk_add_f32 v[62:63],v[214:215],v[210:211]
v_pk_fma_f32 v[212:213],v[208:209],4.0,v[212:213] op_sel_hi:[1,0,1]
v_pk_fma_f32 v[214:215],v[210:211],4.0,v[214:215] op_sel_hi:[1,0,1]
v_pk_fma_f32 v[208:209],v[156:157],2.0,v[204:205] op_sel_hi:[1,0,1]
v_pk_fma_f32 v[210:211],v[158:159],2.0,v[206:207] op_sel_hi:[1,0,1]
v_pk_fma_f32 v[156:157],v[156:157],s[40:41],v[204:205] op_sel_hi:[1,0,1]
v_pk_fma_f32 v[158:159],v[158:159],s[40:41],v[206:207] op_sel_hi:[1,0,1]
M v[100:103],a[236:239],a[132:135],v[100:103]
buffer_store_dwordx4 a[24:27],v253,s[24:27],s34 offen offset:384 nt
M v[104:107],a[236:239],a[252:255],v[104:107]
ds_read_b128 a[140:143],v248 offset:1536
v_cvt_pk_bf16_f32 v208,v208,v209
M v[104:107],a[232:235],a[240:243],v[104:107]
s_waitcnt lgkmcnt(2)
ds_read_b128 a[144:147],v249 offset:1536
v_cvt_pk_bf16_f32 v209,v210,v211
M v[104:107],a[192:195],a[96:99],v[104:107]
s_waitcnt lgkmcnt(2)
v_cvt_pk_bf16_f32 v212,v212,v213
v_cvt_pk_bf16_f32 v213,v214,v215
M v[108:111],a[192:195],a[100:103],v[108:111]
ds_write2st64_b64 v254,v[208:209],v[212:213] offset0:127 offset1:131
M v[108:111],a[232:235],a[96:99],v[108:111]
s_add_u32 s28,s66,6684672
buffer_load_dwordx4 v[204:207],v251,s[88:91],s28 offen offset:0
M v[108:111],a[236:239],a[240:243],v[108:111]
v_cvt_pk_bf16_f32 v0,v0,v1
v_cvt_pk_bf16_f32 v1,v2,v3
M v[112:115],a[236:239],a[96:99],v[112:115]
s_add_u32 s47,s75,49152
buffer_load_dwordx4 v[208:211],v245,s[8:11],s28 offen offset:0
M v[112:115],a[232:235],a[100:103],v[112:115]
s_waitcnt lgkmcnt(2)
ds_read_b128 a[152:155],v249 offset:2048
ds_read_b128 a[156:159],v248 offset:2048
M v[112:115],a[192:195],a[140:143],v[112:115]
s_waitcnt lgkmcnt(3)
s_add_u32 s34,s32,1376256
v_cvt_pk_bf16_f32 v4,v4,v5
v_cvt_pk_bf16_f32 v5,v6,v7
M v[116:119],a[192:195],a[144:147],v[116:119]
s_waitcnt lgkmcnt(2)
s_barrier
ds_read_b128 a[32:35],v250 offset:17408
M v[116:119],a[232:235],a[140:143],v[116:119]
buffer_load_dwordx4 v[212:215],v245,s[8:11],s28 offen offset:768
M v[116:119],a[236:239],a[100:103],v[116:119]
ds_read_b128 a[36:39],v250 offset:21504
ds_read_b128 a[40:43],v250 offset:26112
M v[120:123],a[236:239],a[140:143],v[120:123]
ds_read_b128 a[44:47],v250 offset:30208
ds_read_b128 a[48:51],v250 offset:52224
M v[120:123],a[232:235],a[144:147],v[120:123]
s_waitcnt lgkmcnt(6)
ds_read_b128 a[52:55],v250 offset:56320
ds_read_b128 a[56:59],v250 offset:60928
M v[120:123],a[192:195],a[152:155],v[120:123]
s_waitcnt lgkmcnt(7)
ds_read_b128 a[60:63],v250 offset:65024
buffer_store_dwordx4 a[28:31],v253,s[24:27],s34 offen offset:384 nt
M v[124:127],a[192:195],a[156:159],v[124:127]
ds_write2st64_b64 v254,v[0:1],v[4:5] offset0:68 offset1:72
M v[124:127],a[232:235],a[152:155],v[124:127]
buffer_load_dwordx4 a[228:231],v250,s[20:23],s47 offen offset:0 sc1
M v[124:127],a[236:239],a[144:147],v[124:127]
s_waitcnt vmcnt(29)
v_cvt_pk_bf16_f32 v8,v8,v9
v_cvt_pk_bf16_f32 v9,v10,v11
M v[128:131],a[112:115],a[148:151],v[128:131]
s_waitcnt vmcnt(28)
v_cvt_pk_bf16_f32 v12,v12,v13
v_cvt_pk_bf16_f32 v13,v14,v15
M v[128:131],v[220:223],a[132:135],v[128:131]
s_waitcnt vmcnt(27)
ds_write2st64_b64 v254,v[8:9],v[12:13] offset0:76 offset1:80
M v[128:131],a[124:127],a[252:255],v[128:131]
buffer_load_dwordx4 v[224:227],v250,s[20:23],s47 offen offset:1024 sc1
M v[132:135],a[124:127],a[240:243],v[132:135]
v_cvt_pk_bf16_f32 v16,v16,v17
v_cvt_pk_bf16_f32 v17,v18,v19
M v[132:135],v[220:223],a[252:255],v[132:135]
v_cvt_pk_bf16_f32 v20,v20,v21
v_cvt_pk_bf16_f32 v21,v22,v23
M v[132:135],a[112:115],a[132:135],v[132:135]
ds_write2st64_b64 v254,v[16:17],v[20:21] offset0:85 offset1:89
M v[136:139],a[112:115],a[252:255],v[136:139]
buffer_load_dwordx4 v[228:231],v250,s[20:23],s47 offen offset:2048 sc1
M v[136:139],v[220:223],a[240:243],v[136:139]
v_cvt_pk_bf16_f32 v24,v24,v25
v_cvt_pk_bf16_f32 v25,v26,v27
M v[136:139],a[124:127],a[96:99],v[136:139]
s_add_u32 s34,s32,0
v_cvt_pk_bf16_f32 v28,v28,v29
v_cvt_pk_bf16_f32 v29,v30,v31
M v[140:143],a[124:127],a[100:103],v[140:143]
ds_write2st64_b64 v254,v[24:25],v[28:29] offset0:93 offset1:97
M v[140:143],v[220:223],a[96:99],v[140:143]
v_accvgpr_read_b32 v238,a64
v_accvgpr_read_b32 v232,a160
M v[140:143],a[112:115],a[240:243],v[140:143]
s_waitcnt lgkmcnt(11)
buffer_store_dwordx4 a[32:35],v253,s[24:27],s34 offen offset:512 nt
M v[144:147],a[112:115],a[96:99],v[144:147]
s_add_u32 s46,s76,46080
v_add_f32 v234,v238,v232
v_sub_f32 v238,v238,v232
M v[144:147],v[220:223],a[100:103],v[144:147]
v_add_u32 v248,0x15400,v248
v_add_u32 v249,0x15400,v249
M v[144:147],a[124:127],a[140:143],v[144:147]
v_add_f32 v232,v64,v160
v_sub_f32 v160,v64,v160
M v[148:151],a[124:127],a[144:147],v[148:151]
v_add_f32 v64,v234,v232
v_fmac_f32 v234,4.0,v232
M v[148:151],v[220:223],a[140:143],v[148:151]
ds_read_b128 a[96:99],v248 offset:0
v_fma_f32 v232,2.0,v160,v238
M v[148:151],a[112:115],a[100:103],v[148:151]
ds_read_b128 a[100:103],v249 offset:0
v_fma_f32 v160,s40,v160,v238
M v[152:155],a[112:115],a[140:143],v[152:155]
s_waitcnt lgkmcnt(2)
s_barrier
ds_read_b128 v[0:3],v250 offset:34816
M v[152:155],v[220:223],a[144:147],v[152:155]
ds_read_b128 v[8:11],v250 offset:38912
ds_read_b128 v[16:19],v250 offset:43520
M v[152:155],a[124:127],a[152:155],v[152:155]
ds_read_b128 v[24:27],v250 offset:47616
ds_read_b128 a[140:143],v248 offset:512
M v[156:159],a[124:127],a[156:159],v[156:159]
buffer_load_dwordx4 a[132:135],v250,s[20:23],s46 offen offset:0 sc1
M v[156:159],v[220:223],a[152:155],v[156:159]
ds_read_b128 a[200:203],v249 offset:512
v_accvgpr_read_b32 v238,a65
M v[156:159],a[112:115],a[144:147],v[156:159]
s_waitcnt vmcnt(29) lgkmcnt(7)
buffer_load_dwordx4 a[148:151],v250,s[20:23],s46 offen offset:1024 sc1
v_accvgpr_read_b32 v237,a161
v_add_f32 v236,v238,v237
M v[96:99],a[108:111],a[96:99],v[96:99]
s_waitcnt vmcnt(29) lgkmcnt(6)
ds_read_b128 a[112:115],v248 offset:1024
v_sub_f32 v238,v238,v237
M v[96:99],a[208:211],a[100:103],v[96:99]
s_waitcnt vmcnt(28) lgkmcnt(2)
ds_read_b128 a[124:127],v249 offset:1024
v_add_f32 v237,v65,v161
M v[96:99],a[120:123],a[140:143],v[96:99]
s_waitcnt lgkmcnt(2)
s_add_u32 s34,s32,196608
v_sub_f32 v161,v65,v161
v_add_f32 v65,v236,v237
v_fmac_f32 v236,4.0,v237
v_fma_f32 v237,2.0,v161,v238
M v[100:103],a[120:123],a[200:203],v[100:103]
buffer_load_dwordx4 a[224:227],v250,s[20:23],s46 offen offset:2048 sc1
M v[100:103],a[208:211],a[140:143],v[100:103]
v_fma_f32 v161,s40,v161,v238
v_cvt_pk_bf16_f32 v232,v232,v237
M v[100:103],a[108:111],a[100:103],v[100:103]
v_cvt_pk_bf16_f32 v234,v234,v236
v_accvgpr_read_b32 v238,a66
v_accvgpr_read_b32 v233,a162
v_add_f32 v235,v238,v233
v_sub_f32 v238,v238,v233
M v[104:107],a[108:111],a[140:143],v[104:107]
ds_read_b128 a[144:147],v248 offset:1536
v_add_f32 v233,v66,v162
M v[104:107],a[208:211],a[200:203],v[104:107]
s_waitcnt lgkmcnt(2)
ds_read_b128 a[152:155],v249 offset:1536
v_sub_f32 v162,v66,v162
M v[104:107],a[120:123],a[112:115],v[104:107]
s_waitcnt lgkmcnt(2)
buffer_store_dwordx4 a[36:39],v253,s[24:27],s34 offen offset:512 nt
M v[108:111],a[120:123],a[124:127],v[108:111]
v_add_f32 v66,v235,v233
v_fmac_f32 v235,4.0,v233
M v[108:111],a[208:211],a[112:115],v[108:111]
v_fma_f32 v233,2.0,v162,v238
v_fma_f32 v162,s40,v162,v238
M v[108:111],a[108:111],a[200:203],v[108:111]
v_accvgpr_read_b32 v238,a67
v_accvgpr_read_b32 v237,a163
v_add_f32 v236,v238,v237
M v[112:115],a[108:111],a[112:115],v[112:115]
s_add_u32 s47,s76,49152
ds_read_b128 a[156:159],v249 offset:2048
v_sub_f32 v238,v238,v237
M v[112:115],a[208:211],a[124:127],v[112:115]
s_waitcnt lgkmcnt(2)
ds_read_b128 a[192:195],v248 offset:2048
v_add_f32 v237,v67,v163
M v[112:115],a[120:123],a[144:147],v[112:115]
s_waitcnt lgkmcnt(2)
v_sub_f32 v163,v67,v163
v_add_f32 v67,v236,v237
v_fmac_f32 v236,4.0,v237
v_fma_f32 v237,2.0,v163,v238
v_fma_f32 v163,s40,v163,v238
M v[116:119],a[120:123],a[152:155],v[116:119]
v_cvt_pk_bf16_f32 v233,v233,v237
v_cvt_pk_bf16_f32 v235,v235,v236
M v[116:119],a[208:211],a[144:147],v[116:119]
ds_write2st64_b64 v254,v[232:233],v[234:235] offset0:34 offset1:38
M v[116:119],a[108:111],a[124:127],v[116:119]
v_accvgpr_read_b32 v238,a68
v_accvgpr_read_b32 v232,a164
M v[120:123],a[108:111],a[144:147],v[120:123]
buffer_load_dwordx4 a[160:163],v250,s[20:23],s47 offen offset:0 sc1
M v[120:123],a[208:211],a[152:155],v[120:123]
s_waitcnt lgkmcnt(2)
v_add_f32 v234,v238,v232
v_sub_f32 v238,v238,v232
M v[120:123],a[120:123],a[156:159],v[120:123]
s_waitcnt lgkmcnt(1)
s_add_u32 s34,s32,393216
buffer_load_dwordx4 a[232:235],v250,s[20:23],s47 offen offset:1024 sc1
v_add_f32 v232,v68,v164
v_sub_f32 v164,v68,v164
M v[124:127],a[120:123],a[192:195],v[124:127]
v_add_f32 v68,v234,v232
v_fmac_f32 v234,4.0,v232
M v[124:127],a[208:211],a[156:159],v[124:127]
v_fma_f32 v232,2.0,v164,v238
v_fma_f32 v164,s40,v164,v238
M v[124:127],a[108:111],a[152:155],v[124:127]
s_waitcnt vmcnt(30)
v_accvgpr_read_b32 v238,a69
v_accvgpr_read_b32 v237,a165
v_add_f32 v236,v238,v237
v_sub_f32 v238,v238,v237
M v[128:131],a[116:119],a[96:99],v[128:131]
s_waitcnt vmcnt(28)
buffer_load_dwordx4 a[236:239],v250,s[20:23],s47 offen offset:2048 sc1
M v[128:131],a[196:199],a[100:103],v[128:131]
s_waitcnt vmcnt(28)
v_add_f32 v237,v69,v165
v_sub_f32 v165,v69,v165
M v[128:131],a[204:207],a[140:143],v[128:131]
v_add_f32 v69,v236,v237
v_fmac_f32 v236,4.0,v237
v_fma_f32 v237,2.0,v165,v238
v_fma_f32 v165,s40,v165,v238
v_cvt_pk_bf16_f32 v232,v232,v237
M v[132:135],a[204:207],a[200:203],v[132:135]
v_cvt_pk_bf16_f32 v234,v234,v236
v_accvgpr_read_b32 v238,a70
M v[132:135],a[196:199],a[140:143],v[132:135]
v_accvgpr_read_b32 v233,a166
v_add_f32 v235,v238,v233
M v[132:135],a[116:119],a[100:103],v[132:135]
buffer_store_dwordx4 a[40:43],v253,s[24:27],s34 offen offset:512 nt
M v[136:139],a[116:119],a[140:143],v[136:139]
v_sub_f32 v238,v238,v233
v_add_f32 v233,v70,v166
M v[136:139],a[196:199],a[200:203],v[136:139]
v_sub_f32 v166,v70,v166
v_add_f32 v70,v235,v233
M v[136:139],a[204:207],a[112:115],v[136:139]
v_fmac_f32 v235,4.0,v233
v_fma_f32 v233,2.0,v166,v238
v_fma_f32 v166,s40,v166,v238
M v[140:143],a[204:207],a[124:127],v[140:143]
v_accvgpr_read_b32 v238,a71
v_accvgpr_read_b32 v237,a167
M v[140:143],a[196:199],a[112:115],v[140:143]
v_add_f32 v236,v238,v237
v_sub_f32 v238,v238,v237
M v[140:143],a[116:119],a[200:203],v[140:143]
v_add_f32 v237,v71,v167
v_sub_f32 v167,v71,v167
v_add_f32 v71,v236,v237
v_fmac_f32 v236,4.0,v237
v_fma_f32 v237,2.0,v167,v238
M v[144:147],a[116:119],a[112:115],v[144:147]
s_add_u32 s46,s77,46080
v_fma_f32 v167,s40,v167,v238
v_cvt_pk_bf16_f32 v233,v233,v237
M v[144:147],a[196:199],a[124:127],v[144:147]
v_cvt_pk_bf16_f32 v235,v235,v236
M v[144:147],a[204:207],a[144:147],v[144:147]
s_add_u32 s34,s32,589824
buffer_store_dwordx4 a[44:47],v253,s[24:27],s34 offen offset:512 nt
M v[148:151],a[204:207],a[152:155],v[148:151]
ds_write2st64_b64 v254,v[232:233],v[234:235] offset0:42 offset1:46
M v[148:151],a[196:199],a[144:147],v[148:151]
ds_read_b128 a[96:99],v248 offset:17408
v_accvgpr_read_b32 v238,a72
M v[148:151],a[116:119],a[124:127],v[148:151]
ds_read_b128 a[100:103],v249 offset:17408
v_accvgpr_read_b32 v232,a168
M v[152:155],a[116:119],a[144:147],v[152:155]
buffer_load_dwordx4 a[108:111],v250,s[20:23],s46 offen offset:0 sc1
M v[152:155],a[196:199],a[152:155],v[152:155]
ds_read_b128 a[112:115],v248 offset:17920
ds_read_b128 a[124:127],v249 offset:17920
M v[152:155],a[204:207],a[156:159],v[152:155]
buffer_load_dwordx4 a[120:123],v250,s[20:23],s46 offen offset:1024 sc1
v_add_f32 v234,v238,v232
M v[156:159],a[204:207],a[192:195],v[156:159]
v_sub_f32 v238,v238,v232
v_add_f32 v232,v72,v168
M v[156:159],a[196:199],a[156:159],v[156:159]
v_sub_f32 v168,v72,v168
v_add_f32 v72,v234,v232
M v[156:159],a[116:119],a[152:155],v[156:159]
s_waitcnt vmcnt(30) lgkmcnt(3)
v_fmac_f32 v234,4.0,v232
v_fma_f32 v232,2.0,v168,v238
v_fma_f32 v168,s40,v168,v238
v_accvgpr_read_b32 v238,a73
M v[96:99],a[136:139],a[96:99],v[96:99]
s_waitcnt vmcnt(29) lgkmcnt(2)
buffer_load_dwordx4 a[140:143],v250,s[20:23],s46 offen offset:2048 sc1
M v[96:99],a[220:223],a[100:103],v[96:99]
s_waitcnt vmcnt(29) lgkmcnt(1)
ds_read_b128 a[116:119],v248 offset:18432
ds_read_b128 a[144:147],v249 offset:18432
M v[96:99],a[248:251],a[112:115],v[96:99]
s_waitcnt lgkmcnt(2)
v_accvgpr_read_b32 v237,a169
v_add_f32 v236,v238,v237
v_sub_f32 v238,v238,v237
v_add_f32 v237,v73,v169
v_sub_f32 v169,v73,v169
M v[100:103],a[248:251],a[124:127],v[100:103]
v_add_f32 v73,v236,v237
v_fmac_f32 v236,4.0,v237
M v[100:103],a[220:223],a[112:115],v[100:103]
v_fma_f32 v237,2.0,v169,v238
v_fma_f32 v169,s40,v169,v238
M v[100:103],a[136:139],a[100:103],v[100:103]
v_cvt_pk_bf16_f32 v232,v232,v237
v_cvt_pk_bf16_f32 v234,v234,v236
v_accvgpr_read_b32 v238,a74
v_accvgpr_read_b32 v233,a170
M v[104:107],a[136:139],a[112:115],v[104:107]
ds_read_b128 a[152:155],v248 offset:18944
v_add_f32 v235,v238,v233
M v[104:107],a[220:223],a[124:127],v[104:107]
s_waitcnt lgkmcnt(2)
ds_read_b128 a[156:159],v249 offset:18944
v_sub_f32 v238,v238,v233
M v[104:107],a[248:251],a[116:119],v[104:107]
s_waitcnt lgkmcnt(2)
s_add_u32 s34,s32,786432
buffer_store_dwordx4 a[48:51],v253,s[24:27],s34 offen offset:512 nt
M v[108:111],a[248:251],a[144:147],v[108:111]
v_add_f32 v233,v74,v170
v_sub_f32 v170,v74,v170
M v[108:111],a[220:223],a[116:119],v[108:111]
v_add_f32 v74,v235,v233
v_fmac_f32 v235,4.0,v233
M v[108:111],a[136:139],a[124:127],v[108:111]
v_fma_f32 v233,2.0,v170,v238
v_fma_f32 v170,s40,v170,v238
v_accvgpr_read_b32 v238,a75
v_accvgpr_read_b32 v237,a171
M v[112:115],a[136:139],a[116:119],v[112:115]
s_add_u32 s47,s77,49152
ds_read_b128 a[164:167],v249 offset:19456
v_add_f32 v236,v238,v237
M v[112:115],a[220:223],a[144:147],v[112:115]
s_waitcnt lgkmcnt(2)
ds_read_b128 a[252:255],v248 offset:19456
v_sub_f32 v238,v238,v237
M v[112:115],a[248:251],a[152:155],v[112:115]
s_waitcnt lgkmcnt(2)
v_add_f32 v237,v75,v171
v_sub_f32 v171,v75,v171
v_add_f32 v75,v236,v237
v_fmac_f32 v236,4.0,v237
M v[116:119],a[248:251],a[156:159],v[116:119]
v_fma_f32 v237,2.0,v171,v238
v_fma_f32 v171,s40,v171,v238
M v[116:119],a[220:223],a[152:155],v[116:119]
v_cvt_pk_bf16_f32 v233,v233,v237
v_cvt_pk_bf16_f32 v235,v235,v236
M v[116:119],a[136:139],a[144:147],v[116:119]
ds_write2st64_b64 v254,v[232:233],v[234:235] offset0:51 offset1:55
M v[120:123],a[136:139],a[152:155],v[120:123]
buffer_load_dwordx4 a[240:243],v250,s[20:23],s47 offen offset:0 sc1
M v[120:123],a[220:223],a[156:159],v[120:123]
s_waitcnt lgkmcnt(2)
v_accvgpr_read_b32 v238,a76
v_accvgpr_read_b32 v232,a172
M v[120:123],a[248:251],a[164:167],v[120:123]
s_waitcnt lgkmcnt(1)
buffer_load_dwordx4 v[220:223],v250,s[20:23],s47 offen offset:1024 sc1
v_add_f32 v234,v238,v232
v_sub_f32 v238,v238,v232
M v[124:127],a[248:251],a[252:255],v[124:127]
v_add_f32 v232,v76,v172
v_sub_f32 v172,v76,v172
M v[124:127],a[220:223],a[164:167],v[124:127]
v_add_f32 v76,v234,v232
v_fmac_f32 v234,4.0,v232
M v[124:127],a[136:139],a[156:159],v[124:127]
s_waitcnt vmcnt(30)
v_fma_f32 v232,2.0,v172,v238
v_fma_f32 v172,s40,v172,v238
v_accvgpr_read_b32 v238,a77
v_accvgpr_read_b32 v237,a173
v_add_f32 v236,v238,v237
M v[128:131],a[128:131],a[96:99],v[128:131]
s_waitcnt vmcnt(29)
buffer_load_dwordx4 a[168:171],v250,s[20:23],s47 offen offset:2048 sc1
M v[128:131],a[244:247],a[100:103],v[128:131]
s_waitcnt vmcnt(29)
v_sub_f32 v238,v238,v237
v_add_f32 v237,v77,v173
M v[128:131],a[216:219],a[112:115],v[128:131]
s_add_u32 s34,s32,983040
v_sub_f32 v173,v77,v173
v_add_f32 v77,v236,v237
v_fmac_f32 v236,4.0,v237
v_fma_f32 v237,2.0,v173,v238
v_fma_f32 v173,s40,v173,v238
M v[132:135],a[216:219],a[124:127],v[132:135]
v_cvt_pk_bf16_f32 v232,v232,v237
v_cvt_pk_bf16_f32 v234,v234,v236
M v[132:135],a[244:247],a[112:115],v[132:135]
v_accvgpr_read_b32 v238,a78
v_accvgpr_read_b32 v233,a174
M v[132:135],a[128:131],a[100:103],v[132:135]
buffer_store_dwordx4 a[52:55],v253,s[24:27],s34 offen offset:512 nt
M v[136:139],a[128:131],a[112:115],v[136:139]
v_add_f32 v235,v238,v233
v_sub_f32 v238,v238,v233
M v[136:139],a[244:247],a[124:127],v[136:139]
v_add_f32 v233,v78,v174
v_sub_f32 v174,v78,v174
M v[136:139],a[216:219],a[116:119],v[136:139]
v_add_f32 v78,v235,v233
v_fmac_f32 v235,4.0,v233
v_fma_f32 v233,2.0,v174,v238
M v[140:143],a[216:219],a[144:147],v[140:143]
v_fma_f32 v174,s40,v174,v238
v_accvgpr_read_b32 v238,a79
M v[140:143],a[244:247],a[116:119],v[140:143]
v_accvgpr_read_b32 v237,a175
v_add_f32 v236,v238,v237
M v[140:143],a[128:131],a[124:127],v[140:143]
v_sub_f32 v238,v238,v237
v_add_f32 v237,v79,v175
v_sub_f32 v175,v79,v175
v_add_f32 v79,v236,v237
v_fmac_f32 v236,4.0,v237
M v[144:147],a[128:131],a[116:119],v[144:147]
s_add_u32 s47,s72,3072
v_fma_f32 v237,2.0,v175,v238
v_fma_f32 v175,s40,v175,v238
M v[144:147],a[244:247],a[144:147],v[144:147]
v_cvt_pk_bf16_f32 v233,v233,v237
v_cvt_pk_bf16_f32 v235,v235,v236
M v[144:147],a[216:219],a[152:155],v[144:147]
ds_write2st64_b64 v254,v[232:233],v[234:235] offset0:59 offset1:63
M v[148:151],a[216:219],a[156:159],v[148:151]
v_accvgpr_read_b32 v238,a80
v_accvgpr_read_b32 v232,a176
M v[148:151],a[244:247],a[152:155],v[148:151]
ds_read_b128 a[96:99],v248 offset:34816
v_add_f32 v234,v238,v232
M v[148:151],a[128:131],a[144:147],v[148:151]
ds_read_b128 a[100:103],v249 offset:34816
v_sub_f32 v238,v238,v232
v_add_f32 v232,v80,v176
v_sub_f32 v176,v80,v176
M v[152:155],a[128:131],a[152:155],v[152:155]
buffer_load_dwordx4 a[112:115],v250,s[20:23],s47 offen offset:0 sc1
M v[152:155],a[244:247],a[156:159],v[152:155]
ds_read_b128 a[116:119],v248 offset:35328
ds_read_b128 a[136:139],v249 offset:35328
M v[152:155],a[216:219],a[164:167],v[152:155]
s_add_u32 s34,s32,1179648
buffer_load_dwordx4 a[124:127],v250,s[20:23],s47 offen offset:1024 sc1
v_add_f32 v80,v234,v232
v_fmac_f32 v234,4.0,v232
M v[156:159],a[216:219],a[252:255],v[156:159]
v_fma_f32 v232,2.0,v176,v238
v_fma_f32 v176,s40,v176,v238
M v[156:159],a[244:247],a[164:167],v[156:159]
v_accvgpr_read_b32 v238,a81
v_accvgpr_read_b32 v237,a177
M v[156:159],a[128:131],a[156:159],v[156:159]
s_waitcnt vmcnt(30) lgkmcnt(3)
v_add_f32 v236,v238,v237
v_sub_f32 v238,v238,v237
v_add_f32 v237,v81,v177
v_sub_f32 v177,v81,v177
v_add_f32 v81,v236,v237
M v[96:99],a[104:107],a[96:99],v[96:99]
s_waitcnt vmcnt(29) lgkmcnt(2)
buffer_load_dwordx4 a[144:147],v250,s[20:23],s47 offen offset:2048 sc1
M v[96:99],a[212:215],a[100:103],v[96:99]
s_waitcnt vmcnt(29) lgkmcnt(1)
ds_read_b128 a[128:131],v248 offset:35840
ds_read_b128 a[152:155],v249 offset:35840
M v[96:99],v[216:219],a[116:119],v[96:99]
s_waitcnt lgkmcnt(2)
v_fmac_f32 v236,4.0,v237
v_fma_f32 v237,2.0,v177,v238
v_fma_f32 v177,s40,v177,v238
M v[100:103],v[216:219],a[136:139],v[100:103]
v_cvt_pk_bf16_f32 v232,v232,v237
v_cvt_pk_bf16_f32 v234,v234,v236
M v[100:103],a[212:215],a[116:119],v[100:103]
v_accvgpr_read_b32 v238,a82
v_accvgpr_read_b32 v233,a178
M v[100:103],a[104:107],a[100:103],v[100:103]
buffer_store_dwordx4 a[56:59],v253,s[24:27],s34 offen offset:512 nt
M v[104:107],a[104:107],a[116:119],v[104:107]
ds_read_b128 a[156:159],v248 offset:36352
v_add_f32 v235,v238,v233
M v[104:107],a[212:215],a[136:139],v[104:107]
s_waitcnt lgkmcnt(2)
ds_read_b128 a[164:167],v249 offset:36352
v_sub_f32 v238,v238,v233
M v[104:107],v[216:219],a[128:131],v[104:107]
s_waitcnt lgkmcnt(2)
v_add_f32 v233,v82,v178
v_sub_f32 v178,v82,v178
M v[108:111],v[216:219],a[152:155],v[108:111]
v_add_f32 v82,v235,v233
v_fmac_f32 v235,4.0,v233
M v[108:111],a[212:215],a[128:131],v[108:111]
v_fma_f32 v233,2.0,v178,v238
v_fma_f32 v178,s40,v178,v238
M v[108:111],a[104:107],a[136:139],v[108:111]
v_accvgpr_read_b32 v238,a83
v_accvgpr_read_b32 v237,a179
M v[112:115],a[104:107],a[128:131],v[112:115]
s_add_u32 s48,s72,6144
ds_read_b128 a[172:175],v249 offset:36864
v_add_f32 v236,v238,v237
M v[112:115],a[212:215],a[152:155],v[112:115]
s_waitcnt lgkmcnt(2)
ds_read_b128 a[208:211],v248 offset:36864
v_sub_f32 v238,v238,v237
M v[112:115],v[216:219],a[156:159],v[112:115]
s_waitcnt lgkmcnt(2)
s_add_u32 s34,s32,1376256
buffer_store_dwordx4 a[60:63],v253,s[24:27],s34 offen offset:512 nt
M v[116:119],v[216:219],a[164:167],v[116:119]
v_add_f32 v237,v83,v179
v_sub_f32 v179,v83,v179
M v[116:119],a[212:215],a[156:159],v[116:119]
v_add_f32 v83,v236,v237
v_fmac_f32 v236,4.0,v237
M v[116:119],a[104:107],a[152:155],v[116:119]
v_fma_f32 v237,2.0,v179,v238
v_fma_f32 v179,s40,v179,v238
M v[120:123],a[104:107],a[156:159],v[120:123]
buffer_load_dwordx4 a[200:203],v250,s[20:23],s48 offen offset:0 sc1
M v[120:123],a[212:215],a[164:167],v[120:123]
s_waitcnt lgkmcnt(1)
v_cvt_pk_bf16_f32 v233,v233,v237
v_cvt_pk_bf16_f32 v235,v235,v236
M v[120:123],v[216:219],a[172:175],v[120:123]
s_waitcnt lgkmcnt(0)
buffer_load_dwordx4 a[192:195],v250,s[20:23],s48 offen offset:1024 sc1
M v[124:127],v[216:219],a[208:211],v[124:127]
ds_write2st64_b64 v254,v[232:233],v[234:235] offset0:102 offset1:106
M v[124:127],a[212:215],a[172:175],v[124:127]
v_accvgpr_read_b32 v238,a84
v_accvgpr_read_b32 v232,a180
M v[124:127],a[104:107],a[164:167],v[124:127]
s_waitcnt vmcnt(27)
v_add_f32 v234,v238,v232
v_sub_f32 v238,v238,v232
M v[128:131],a[228:231],a[96:99],v[128:131]
s_waitcnt vmcnt(26)
buffer_load_dwordx4 a[204:207],v250,s[20:23],s48 offen offset:2048 sc1
M v[128:131],v[224:227],a[100:103],v[128:131]
s_waitcnt vmcnt(26)
v_add_f32 v232,v84,v180
v_sub_f32 v180,v84,v180
M v[128:131],v[228:231],a[116:119],v[128:131]
v_add_f32 v84,v234,v232
v_fmac_f32 v234,4.0,v232
M v[132:135],v[228:231],a[136:139],v[132:135]
v_fma_f32 v232,2.0,v180,v238
v_fma_f32 v180,s40,v180,v238
M v[132:135],v[224:227],a[116:119],v[132:135]
v_accvgpr_read_b32 v238,a85
v_accvgpr_read_b32 v237,a181
M v[132:135],a[228:231],a[100:103],v[132:135]
v_add_f32 v236,v238,v237
v_sub_f32 v238,v238,v237
M v[136:139],a[228:231],a[116:119],v[136:139]
v_add_f32 v237,v85,v181
v_sub_f32 v181,v85,v181
M v[136:139],v[224:227],a[136:139],v[136:139]
v_add_f32 v85,v236,v237
v_fmac_f32 v236,4.0,v237
M v[136:139],v[228:231],a[128:131],v[136:139]
s_add_u32 s34,s33,0
buffer_store_dwordx4 v[0:3],v253,s[24:27],s34 offen offset:0 nt
M v[140:143],v[228:231],a[152:155],v[140:143]
v_fma_f32 v237,2.0,v181,v238
v_fma_f32 v181,s40,v181,v238
M v[140:143],v[224:227],a[128:131],v[140:143]
v_cvt_pk_bf16_f32 v232,v232,v237
v_cvt_pk_bf16_f32 v234,v234,v236
M v[140:143],a[228:231],a[136:139],v[140:143]
v_accvgpr_read_b32 v238,a86
v_accvgpr_read_b32 v233,a182
M v[144:147],a[228:231],a[128:131],v[144:147]
s_add_u32 s47,s73,3072
v_add_f32 v235,v238,v233
v_sub_f32 v238,v238,v233
M v[144:147],v[224:227],a[152:155],v[144:147]
v_add_f32 v233,v86,v182
v_sub_f32 v182,v86,v182
M v[144:147],v[228:231],a[156:159],v[144:147]
v_add_f32 v86,v235,v233
v_fmac_f32 v235,4.0,v233
M v[148:151],v[228:231],a[164:167],v[148:151]
v_fma_f32 v233,2.0,v182,v238
v_fma_f32 v182,s40,v182,v238
M v[148:151],v[224:227],a[156:159],v[148:151]
ds_read_b128 a[96:99],v248 offset:52224
v_accvgpr_read_b32 v238,a87
M v[148:151],a[228:231],a[152:155],v[148:151]
ds_read_b128 a[100:103],v249 offset:52224
v_accvgpr_read_b32 v237,a183
v_add_f32 v236,v238,v237
M v[152:155],a[228:231],a[156:159],v[152:155]
buffer_load_dwordx4 a[104:107],v250,s[20:23],s47 offen offset:0 sc1
M v[152:155],v[224:227],a[164:167],v[152:155]
ds_read_b128 a[116:119],v248 offset:52736
ds_read_b128 a[136:139],v249 offset:52736
M v[152:155],v[228:231],a[172:175],v[152:155]
buffer_load_dwordx4 a[128:131],v250,s[20:23],s47 offen offset:1024 sc1
v_sub_f32 v238,v238,v237
M v[156:159],v[228:231],a[208:211],v[156:159]
v_add_f32 v237,v87,v183
v_sub_f32 v183,v87,v183
M v[156:159],v[224:227],a[172:175],v[156:159]
v_add_f32 v87,v236,v237
v_fmac_f32 v236,4.0,v237
M v[156:159],a[228:231],a[164:167],v[156:159]
s_waitcnt vmcnt(27) lgkmcnt(3)
v_fma_f32 v237,2.0,v183,v238
v_fma_f32 v183,s40,v183,v238
v_cvt_pk_bf16_f32 v233,v233,v237
M v[96:99],a[132:135],a[96:99],v[96:99]
s_waitcnt vmcnt(26) lgkmcnt(2)
buffer_load_dwordx4 a[152:155],v250,s[20:23],s47 offen offset:2048 sc1
M v[96:99],a[148:151],a[100:103],v[96:99]
s_waitcnt vmcnt(26) lgkmcnt(1)
ds_read_b128 a[156:159],v248 offset:53248
ds_read_b128 a[164:167],v249 offset:53248
M v[96:99],a[224:227],a[116:119],v[96:99]
s_waitcnt lgkmcnt(2)
s_add_u32 s34,s33,393216
v_cvt_pk_bf16_f32 v235,v235,v236
M v[100:103],a[224:227],a[136:139],v[100:103]
ds_write2st64_b64 v254,v[232:233],v[234:235] offset0:110 offset1:114
M v[100:103],a[148:151],a[116:119],v[100:103]
v_accvgpr_read_b32 v238,a88
v_accvgpr_read_b32 v232,a184
M v[100:103],a[132:135],a[100:103],v[100:103]
buffer_store_dwordx4 v[8:11],v253,s[24:27],s34 offen offset:0 nt
M v[104:107],a[132:135],a[116:119],v[104:107]
ds_read_b128 a[172:175],v248 offset:53760
v_add_f32 v234,v238,v232
M v[104:107],a[148:151],a[136:139],v[104:107]
s_waitcnt lgkmcnt(3)
ds_read_b128 a[176:179],v249 offset:53760
v_sub_f32 v238,v238,v232
M v[104:107],a[224:227],a[156:159],v[104:107]
s_waitcnt lgkmcnt(3)
v_add_f32 v232,v88,v184
v_sub_f32 v184,v88,v184
M v[108:111],a[224:227],a[164:167],v[108:111]
v_add_f32 v88,v234,v232
v_fmac_f32 v234,4.0,v232
M v[108:111],a[148:151],a[156:159],v[108:111]
v_fma_f32 v232,2.0,v184,v238
v_fma_f32 v184,s40,v184,v238
M v[108:111],a[132:135],a[136:139],v[108:111]
v_accvgpr_read_b32 v238,a89
v_accvgpr_read_b32 v237,a185
M v[112:115],a[132:135],a[156:159],v[112:115]
s_add_u32 s48,s73,6144
ds_read_b128 a[180:183],v249 offset:54272
v_add_f32 v236,v238,v237
M v[112:115],a[148:151],a[164:167],v[112:115]
s_waitcnt lgkmcnt(2)
ds_read_b128 a[196:199],v248 offset:54272
v_sub_f32 v238,v238,v237
M v[112:115],a[224:227],a[172:175],v[112:115]
s_waitcnt lgkmcnt(2)
v_add_f32 v237,v89,v185
v_sub_f32 v185,v89,v185
M v[116:119],a[224:227],a[176:179],v[116:119]
v_add_f32 v89,v236,v237
v_fmac_f32 v236,4.0,v237
M v[116:119],a[148:151],a[172:175],v[116:119]
v_fma_f32 v237,2.0,v185,v238
v_fma_f32 v185,s40,v185,v238
M v[116:119],a[132:135],a[164:167],v[116:119]
v_cvt_pk_bf16_f32 v232,v232,v237
v_cvt_pk_bf16_f32 v234,v234,v236
v_accvgpr_read_b32 v238,a90
M v[120:123],a[132:135],a[172:175],v[120:123]
buffer_load_dwordx4 a[248:251],v250,s[20:23],s48 offen offset:0 sc1
M v[120:123],a[148:151],a[176:179],v[120:123]
s_waitcnt lgkmcnt(1)
v_accvgpr_read_b32 v233,a186
v_add_f32 v235,v238,v233
M v[120:123],a[224:227],a[180:183],v[120:123]
s_waitcnt lgkmcnt(0)
s_add_u32 s34,s33,786432
buffer_load_dwordx4 a[220:223],v250,s[20:23],s48 offen offset:1024 sc1
v_sub_f32 v238,v238,v233
M v[124:127],a[224:227],a[196:199],v[124:127]
v_add_f32 v233,v90,v186
v_sub_f32 v186,v90,v186
M v[124:127],a[148:151],a[180:183],v[124:127]
v_add_f32 v90,v235,v233
v_fmac_f32 v235,4.0,v233
M v[124:127],a[132:135],a[176:179],v[124:127]
s_waitcnt vmcnt(27)
v_fma_f32 v233,2.0,v186,v238
v_fma_f32 v186,s40,v186,v238
v_accvgpr_read_b32 v238,a91
M v[128:131],a[160:163],a[96:99],v[128:131]
s_waitcnt vmcnt(26)
buffer_load_dwordx4 a[216:219],v250,s[20:23],s48 offen offset:2048 sc1
M v[128:131],a[232:235],a[100:103],v[128:131]
s_waitcnt vmcnt(26)
v_accvgpr_read_b32 v237,a187
v_add_f32 v236,v238,v237
M v[128:131],a[236:239],a[116:119],v[128:131]
v_sub_f32 v238,v238,v237
v_add_f32 v237,v91,v187
v_sub_f32 v187,v91,v187
M v[132:135],a[236:239],a[136:139],v[132:135]
v_add_f32 v91,v236,v237
v_fmac_f32 v236,4.0,v237
M v[132:135],a[232:235],a[116:119],v[132:135]
v_fma_f32 v237,2.0,v187,v238
v_fma_f32 v187,s40,v187,v238
M v[132:135],a[160:163],a[100:103],v[132:135]
buffer_store_dwordx4 v[16:19],v253,s[24:27],s34 offen offset:0 nt
M v[136:139],a[160:163],a[116:119],v[136:139]
v_cvt_pk_bf16_f32 v233,v233,v237
v_cvt_pk_bf16_f32 v235,v235,v236
M v[136:139],a[232:235],a[136:139],v[136:139]
ds_write2st64_b64 v254,v[232:233],v[234:235] offset0:119 offset1:123
M v[136:139],a[236:239],a[156:159],v[136:139]
v_accvgpr_read_b32 v238,a92
v_accvgpr_read_b32 v232,a188
M v[140:143],a[236:239],a[164:167],v[140:143]
v_add_f32 v234,v238,v232
v_sub_f32 v238,v238,v232
M v[140:143],a[232:235],a[156:159],v[140:143]
v_add_f32 v232,v92,v188
v_sub_f32 v188,v92,v188
M v[140:143],a[160:163],a[136:139],v[140:143]
v_add_f32 v92,v234,v232
v_fmac_f32 v234,4.0,v232
M v[144:147],a[160:163],a[156:159],v[144:147]
s_add_u32 s47,s74,3072
v_fma_f32 v232,2.0,v188,v238
v_fma_f32 v188,s40,v188,v238
M v[144:147],a[232:235],a[164:167],v[144:147]
v_add_u32 v248,0xffffbc00,v248
v_add_u32 v249,0xffffbc00,v249
M v[144:147],a[236:239],a[172:175],v[144:147]
s_add_u32 s34,s33,1179648
buffer_store_dwordx4 v[24:27],v253,s[24:27],s34 offen offset:0 nt
M v[148:151],a[236:239],a[176:179],v[148:151]
v_accvgpr_read_b32 v238,a93
v_accvgpr_read_b32 v237,a189
M v[148:151],a[232:235],a[172:175],v[148:151]
ds_read_b128 a[96:99],v248 offset:0
v_add_f32 v236,v238,v237
M v[148:151],a[160:163],a[164:167],v[148:151]
ds_read_b128 a[100:103],v249 offset:0
v_sub_f32 v238,v238,v237
M v[152:155],a[160:163],a[172:175],v[152:155]
buffer_load_dwordx4 a[116:119],v250,s[20:23],s47 offen offset:0 sc1
M v[152:155],a[232:235],a[176:179],v[152:155]
ds_read_b128 a[132:135],v248 offset:512
ds_read_b128 a[148:151],v249 offset:512
M v[152:155],a[236:239],a[180:183],v[152:155]
buffer_load_dwordx4 a[136:139],v250,s[20:23],s47 offen offset:1024 sc1
M v[156:159],a[236:239],a[196:199],v[156:159]
v_add_f32 v237,v93,v189
v_sub_f32 v189,v93,v189
M v[156:159],a[232:235],a[180:183],v[156:159]
v_add_f32 v93,v236,v237
v_fmac_f32 v236,4.0,v237
M v[156:159],a[160:163],a[176:179],v[156:159]
s_waitcnt vmcnt(27) lgkmcnt(3)
v_fma_f32 v237,2.0,v189,v238
v_fma_f32 v189,s40,v189,v238
M v[96:99],a[108:111],a[96:99],v[96:99]
s_waitcnt vmcnt(26) lgkmcnt(2)
buffer_load_dwordx4 a[156:159],v250,s[20:23],s47 offen offset:2048 sc1
M v[96:99],a[120:123],a[100:103],v[96:99]
s_waitcnt vmcnt(26) lgkmcnt(1)
ds_read_b128 a[160:163],v248 offset:1024
ds_read_b128 a[164:167],v249 offset:1024
M v[96:99],a[140:143],a[132:135],v[96:99]
s_waitcnt lgkmcnt(2)
v_cvt_pk_bf16_f32 v232,v232,v237
v_cvt_pk_bf16_f32 v234,v234,v236
M v[100:103],a[140:143],a[148:151],v[100:103]
v_accvgpr_read_b32 v238,a94
v_accvgpr_read_b32 v233,a190
M v[100:103],a[120:123],a[132:135],v[100:103]
v_add_f32 v235,v238,v233
v_sub_f32 v238,v238,v233
M v[100:103],a[108:111],a[100:103],v[100:103]
v_add_f32 v233,v94,v190
v_sub_f32 v190,v94,v190
M v[104:107],a[108:111],a[132:135],v[104:107]
ds_read_b128 a[172:175],v248 offset:1536
v_add_f32 v94,v235,v233
M v[104:107],a[120:123],a[148:151],v[104:107]
s_waitcnt lgkmcnt(2)
ds_read_b128 a[176:179],v249 offset:1536
v_fmac_f32 v235,4.0,v233
M v[104:107],a[140:143],a[160:163],v[104:107]
s_waitcnt lgkmcnt(2)
v_fma_f32 v233,2.0,v190,v238
v_fma_f32 v190,s40,v190,v238
v_accvgpr_read_b32 v238,a95
v_accvgpr_read_b32 v237,a191
M v[108:111],a[140:143],a[164:167],v[108:111]
v_add_f32 v236,v238,v237
v_sub_f32 v238,v238,v237
M v[108:111],a[120:123],a[160:163],v[108:111]
v_add_f32 v237,v95,v191
v_sub_f32 v191,v95,v191
M v[108:111],a[108:111],a[148:151],v[108:111]
v_add_f32 v95,v236,v237
v_fmac_f32 v236,4.0,v237
v_fma_f32 v237,2.0,v191,v238
M v[112:115],a[108:111],a[160:163],v[112:115]
s_add_u32 s48,s74,6144
ds_read_b128 a[180:183],v249 offset:2048
v_fma_f32 v191,s40,v191,v238
M v[112:115],a[120:123],a[164:167],v[112:115]
s_waitcnt lgkmcnt(2)
ds_read_b128 a[184:187],v248 offset:2048
v_cvt_pk_bf16_f32 v233,v233,v237
M v[112:115],a[140:143],a[172:175],v[112:115]
s_waitcnt lgkmcnt(2)
v_cvt_pk_bf16_f32 v235,v235,v236
M v[116:119],a[140:143],a[176:179],v[116:119]
ds_write2st64_b64 v254,v[232:233],v[234:235] offset0:127 offset1:131
M v[116:119],a[120:123],a[172:175],v[116:119]
v_cvt_pk_bf16_f32 v96,v96,v97
v_cvt_pk_bf16_f32 v97,v98,v99
M v[116:119],a[108:111],a[164:167],v[116:119]
v_cvt_pk_bf16_f32 v100,v100,v101
v_cvt_pk_bf16_f32 v101,v102,v103
M v[120:123],a[108:111],a[172:175],v[120:123]
s_waitcnt lgkmcnt(0)
s_barrier
ds_read_b128 a[64:67],v250 offset:17408
M v[120:123],a[120:123],a[176:179],v[120:123]
ds_read_b128 a[68:71],v250 offset:21504
ds_read_b128 a[72:75],v250 offset:26112
M v[120:123],a[140:143],a[180:183],v[120:123]
ds_read_b128 a[76:79],v250 offset:30208
ds_read_b128 a[80:83],v250 offset:52224
ds_read_b128 a[84:87],v250 offset:56320
M v[124:127],a[140:143],a[184:187],v[124:127]
ds_read_b128 a[88:91],v250 offset:60928
ds_read_b128 a[92:95],v250 offset:65024
M v[124:127],a[120:123],a[180:183],v[124:127]
buffer_load_dwordx4 a[188:191],v250,s[20:23],s48 offen offset:0 sc1
M v[124:127],a[108:111],a[176:179],v[124:127]
s_waitcnt vmcnt(25)
s_add_u32 s34,s32,0
ds_write2st64_b64 v254,v[96:97],v[100:101] offset0:68 offset1:72
M v[128:131],a[240:243],a[96:99],v[128:131]
s_waitcnt vmcnt(24)
buffer_load_dwordx4 a[252:255],v250,s[20:23],s48 offen offset:1024 sc1
M v[128:131],v[220:223],a[100:103],v[128:131]
s_waitcnt vmcnt(24)
v_cvt_pk_bf16_f32 v104,v104,v105
v_cvt_pk_bf16_f32 v105,v106,v107
M v[128:131],a[168:171],a[132:135],v[128:131]
v_cvt_pk_bf16_f32 v108,v108,v109
v_cvt_pk_bf16_f32 v109,v110,v111
M v[132:135],a[168:171],a[148:151],v[132:135]
ds_write2st64_b64 v254,v[104:105],v[108:109] offset0:76 offset1:80
M v[132:135],v[220:223],a[132:135],v[132:135]
buffer_load_dwordx4 a[244:247],v250,s[20:23],s48 offen offset:2048 sc1
M v[132:135],a[240:243],a[100:103],v[132:135]
v_cvt_pk_bf16_f32 v112,v112,v113
v_cvt_pk_bf16_f32 v113,v114,v115
M v[136:139],a[240:243],a[132:135],v[136:139]
v_cvt_pk_bf16_f32 v116,v116,v117
v_cvt_pk_bf16_f32 v117,v118,v119
M v[136:139],v[220:223],a[148:151],v[136:139]
ds_write2st64_b64 v254,v[112:113],v[116:117] offset0:85 offset1:89
M v[136:139],a[168:171],a[160:163],v[136:139]
s_waitcnt lgkmcnt(10)
buffer_store_dwordx4 a[64:67],v253,s[24:27],s34 offen offset:640 nt
M v[140:143],a[168:171],a[164:167],v[140:143]
s_add_u32 s34,s32,196608
v_cvt_pk_bf16_f32 v120,v120,v121
v_cvt_pk_bf16_f32 v121,v122,v123
M v[140:143],v[220:223],a[160:163],v[140:143]
v_cvt_pk_bf16_f32 v124,v124,v125
v_cvt_pk_bf16_f32 v125,v126,v127
M v[140:143],a[240:243],a[148:151],v[140:143]
s_waitcnt lgkmcnt(9)
buffer_store_dwordx4 a[68:71],v253,s[24:27],s34 offen offset:640 nt
M v[144:147],a[240:243],a[160:163],v[144:147]
s_add_u32 s47,s75,3072
ds_write2st64_b64 v254,v[120:121],v[124:125] offset0:93 offset1:97
M v[144:147],v[220:223],a[164:167],v[144:147]
v_add_u32 v248,0xfffece00,v248
v_add_u32 v249,0xfffece00,v249
M v[144:147],a[168:171],a[172:175],v[144:147]
v_cvt_pk_bf16_f32 v128,v128,v129
v_cvt_pk_bf16_f32 v129,v130,v131
M v[148:151],a[168:171],a[176:179],v[148:151]
v_cvt_pk_bf16_f32 v132,v132,v133
v_cvt_pk_bf16_f32 v133,v134,v135
M v[148:151],v[220:223],a[172:175],v[148:151]
s_waitcnt lgkmcnt(0)
s_barrier
ds_read_b128 a[96:99],v248 offset:0
M v[148:151],a[240:243],a[164:167],v[148:151]
ds_read_b128 a[100:103],v249 offset:0
v_add_u32 v4,69632,v250
M v[152:155],a[240:243],a[172:175],v[152:155]
ds_read_b128 v[96:99],v250 offset:34816
ds_read_b128 v[104:107],v250 offset:38912
M v[152:155],v[220:223],a[176:179],v[152:155]
ds_read_b128 v[112:115],v250 offset:43520
ds_read_b128 v[120:123],v250 offset:47616
M v[152:155],a[168:171],a[180:183],v[152:155]
s_add_u32 s34,s32,393216
buffer_load_dwordx4 a[108:111],v250,s[20:23],s47 offen offset:0 sc1
M v[156:159],a[168:171],a[184:187],v[156:159]
ds_read_b128 a[120:123],v248 offset:512
ds_read_b128 a[140:143],v249 offset:512
M v[156:159],v[220:223],a[180:183],v[156:159]
buffer_load_dwordx4 a[132:135],v250,s[20:23],s47 offen offset:1024 sc1
M v[156:159],a[240:243],a[176:179],v[156:159]
s_waitcnt vmcnt(27) lgkmcnt(7)
ds_write2st64_b64 v254,v[128:129],v[132:133] offset0:34 offset1:38
M v[32:35],a[112:115],a[96:99],v[32:35]
s_waitcnt vmcnt(26) lgkmcnt(7)
ds_read_b128 a[160:163],v248 offset:1024
v_cvt_pk_bf16_f32 v136,v136,v137
M v[32:35],a[124:127],a[100:103],v[32:35]
s_waitcnt vmcnt(25) lgkmcnt(3)
ds_read_b128 a[164:167],v249 offset:1024
v_cvt_pk_bf16_f32 v137,v138,v139
M v[32:35],a[144:147],a[120:123],v[32:35]
s_waitcnt lgkmcnt(3)
buffer_load_dwordx4 a[148:151],v250,s[20:23],s47 offen offset:2048 sc1
M v[36:39],a[144:147],a[140:143],v[36:39]
v_cvt_pk_bf16_f32 v140,v140,v141
v_cvt_pk_bf16_f32 v141,v142,v143
M v[36:39],a[124:127],a[120:123],v[36:39]
ds_write2st64_b64 v254,v[136:137],v[140:141] offset0:42 offset1:46
M v[36:39],a[112:115],a[100:103],v[36:39]
buffer_store_dwordx4 a[72:75],v253,s[24:27],s34 offen offset:640 nt
M v[40:43],a[112:115],a[120:123],v[40:43]
ds_read_b128 a[168:171],v248 offset:1536
v_cvt_pk_bf16_f32 v144,v144,v145
M v[40:43],a[124:127],a[140:143],v[40:43]
s_waitcnt lgkmcnt(3)
ds_read_b128 a[172:175],v249 offset:1536
v_cvt_pk_bf16_f32 v145,v146,v147
M v[40:43],a[144:147],a[160:163],v[40:43]
s_waitcnt lgkmcnt(3)
v_cvt_pk_bf16_f32 v148,v148,v149
v_cvt_pk_bf16_f32 v149,v150,v151
M v[44:47],a[144:147],a[164:167],v[44:47]
ds_write2st64_b64 v254,v[144:145],v[148:149] offset0:51 offset1:55
M v[44:47],a[124:127],a[160:163],v[44:47]
v_cvt_pk_bf16_f32 v152,v152,v153
v_cvt_pk_bf16_f32 v153,v154,v155
M v[44:47],a[112:115],a[140:143],v[44:47]
v_cvt_pk_bf16_f32 v156,v156,v157
v_cvt_pk_bf16_f32 v157,v158,v159
M v[48:51],a[112:115],a[160:163],v[48:51]
ds_read_b128 a[176:179],v249 offset:2048
ds_write2st64_b64 v254,v[152:153],v[156:157] offset0:59 offset1:63
M v[48:51],a[124:127],a[164:167],v[48:51]
s_waitcnt lgkmcnt(4)
ds_read_b128 a[180:183],v248 offset:2048
v_permlane32_swap_b32 v208,v210
M v[48:51],a[144:147],a[168:171],v[48:51]
s_waitcnt lgkmcnt(4)
s_add_u32 s34,s32,589824
buffer_store_dwordx4 a[76:79],v253,s[24:27],s34 offen offset:640 nt
M v[52:55],a[144:147],a[172:175],v[52:55]
v_permlane32_swap_b32 v204,v206
v_permlane32_swap_b32 v212,v214
M v[52:55],a[124:127],a[168:171],v[52:55]
v_lshlrev_b32 v234,16,v210
v_lshlrev_b32 v232,16,v204
M v[52:55],a[112:115],a[164:167],v[52:55]
v_lshlrev_b32 v233,16,v208
v_lshlrev_b32 v237,16,v206
M v[56:59],a[112:115],a[168:171],v[56:59]
global_load_dword a184,v250,s[64:65]
M v[56:59],a[124:127],a[172:175],v[56:59]
s_waitcnt lgkmcnt(2)
s_add_u32 s48,s75,6144
buffer_load_dwordx4 a[184:187],v250,s[20:23],s48 offen offset:0 sc1
M v[56:59],a[144:147],a[176:179],v[56:59]
s_waitcnt lgkmcnt(0)
v_lshlrev_b32 v236,16,v214
v_lshlrev_b32 v235,16,v212
M v[60:63],a[144:147],a[180:183],v[60:63]
v_fmac_f32 v232,s43,v234
M v[60:63],a[124:127],a[176:179],v[60:63]
s_barrier
ds_read_b128 v[128:131],v250 offset:17408
M v[60:63],a[112:115],a[172:175],v[60:63]
s_waitcnt vmcnt(27)
ds_read_b128 v[136:139],v250 offset:21504
ds_read_b128 v[144:147],v250 offset:26112
M v[64:67],a[200:203],a[96:99],v[64:67]
s_waitcnt vmcnt(26)
ds_read_b128 v[152:155],v250 offset:30208
v_fmac_f32 v237,4.0,v233
M v[64:67],a[192:195],a[100:103],v[64:67]
s_waitcnt vmcnt(25)
buffer_load_dwordx4 v[216:219],v250,s[20:23],s48 offen offset:1024 sc1
M v[64:67],a[204:207],a[120:123],v[64:67]
v_fma_f32 v238,-4.0,v234,v236
v_fmac_f32 v232,s45,v236
M v[68:71],a[204:207],a[140:143],v[68:71]
buffer_load_dwordx4 a[212:215],v250,s[20:23],s48 offen offset:2048 sc1
M v[68:71],a[192:195],a[120:123],v[68:71]
v_fmac_f32 v237,s41,v235
v_sub_f32 v236,v236,v234
M v[68:71],a[200:203],a[100:103],v[68:71]
v_fma_f32 v234,-4.0,v233,v235
v_sub_f32 v235,v235,v233
M v[72:75],a[200:203],a[120:123],v[72:75]
v_add_f32 v233,v238,v234
v_sub_f32 v238,v238,v234
M v[72:75],a[192:195],a[140:143],v[72:75]
v_fma_f32 v234,2.0,v235,v236
v_fmac_f32 v236,-2.0,v235
M v[72:75],a[204:207],a[160:163],v[72:75]
s_add_u32 s34,s32,786432
buffer_store_dwordx4 a[80:83],v253,s[24:27],s34 offen offset:640 nt
M v[76:79],a[204:207],a[164:167],v[76:79]
v_and_b32 v210,s42,v210
v_and_b32 v204,s42,v204
M v[76:79],a[192:195],a[160:163],v[76:79]
v_and_b32 v208,s42,v208
v_and_b32 v206,s42,v206
M v[76:79],a[200:203],a[140:143],v[76:79]
v_and_b32 v214,s42,v214
v_and_b32 v212,s42,v212
M v[80:83],a[200:203],a[160:163],v[80:83]
s_add_u32 s47,s76,3072
v_fmac_f32 v204,s43,v210
v_fmac_f32 v206,4.0,v208
M v[80:83],a[192:195],a[164:167],v[80:83]
v_add_u32 v248,0x15400,v248
v_add_u32 v249,0x15400,v249
M v[80:83],a[204:207],a[168:171],v[80:83]
v_fma_f32 v235,-4.0,v210,v214
v_fmac_f32 v204,s45,v214
M v[84:87],a[204:207],a[172:175],v[84:87]
v_fmac_f32 v206,s41,v212
v_sub_f32 v214,v214,v210
M v[84:87],a[192:195],a[168:171],v[84:87]
ds_read_b128 a[96:99],v248 offset:0
v_fma_f32 v210,-4.0,v208,v212
M v[84:87],a[200:203],a[164:167],v[84:87]
ds_read_b128 a[100:103],v249 offset:0
v_sub_f32 v212,v212,v208
M v[88:91],a[200:203],a[168:171],v[88:91]
buffer_load_dwordx4 a[112:115],v250,s[20:23],s47 offen offset:0 sc1
M v[88:91],a[192:195],a[172:175],v[88:91]
ds_read_b128 a[120:123],v248 offset:512
ds_read_b128 a[140:143],v249 offset:512
M v[88:91],a[204:207],a[176:179],v[88:91]
buffer_load_dwordx4 a[124:127],v250,s[20:23],s47 offen offset:1024 sc1
M v[92:95],a[204:207],a[180:183],v[92:95]
v_add_f32 v208,v235,v210
v_sub_f32 v235,v235,v210
M v[92:95],a[192:195],a[176:179],v[92:95]
v_fma_f32 v210,2.0,v212,v214
v_fmac_f32 v214,-2.0,v212
M v[92:95],a[200:203],a[172:175],v[92:95]
s_waitcnt vmcnt(28) lgkmcnt(3)
v_cvt_pk_bf16_f32 v204,v232,v204
v_cvt_pk_bf16_f32 v206,v237,v206
M v[32:35],a[104:107],a[96:99],v[32:35]
s_waitcnt vmcnt(27) lgkmcnt(2)
buffer_load_dwordx4 a[144:147],v250,s[20:23],s47 offen offset:2048 sc1
M v[32:35],a[128:131],a[100:103],v[32:35]
s_waitcnt vmcnt(27) lgkmcnt(1)
ds_read_b128 a[160:163],v248 offset:1024
ds_read_b128 a[164:167],v249 offset:1024
M v[32:35],a[152:155],a[120:123],v[32:35]
s_waitcnt lgkmcnt(2)
s_add_u32 s34,s32,983040
v_cvt_pk_bf16_f32 v208,v233,v208
v_cvt_pk_bf16_f32 v212,v234,v210
M v[36:39],a[152:155],a[140:143],v[36:39]
v_cvt_pk_bf16_f32 v210,v238,v235
v_cvt_pk_bf16_f32 v214,v236,v214
M v[36:39],a[128:131],a[120:123],v[36:39]
v_permlane32_swap_b32 v209,v211
v_permlane32_swap_b32 v205,v207
M v[36:39],a[104:107],a[100:103],v[36:39]
buffer_store_dwordx4 a[84:87],v253,s[24:27],s34 offen offset:640 nt
M v[40:43],a[104:107],a[120:123],v[40:43]
ds_read_b128 a[168:171],v248 offset:1536
v_permlane32_swap_b32 v213,v215
M v[40:43],a[128:131],a[140:143],v[40:43]
s_waitcnt lgkmcnt(2)
ds_read_b128 a[172:175],v249 offset:1536
v_lshlrev_b32 v234,16,v211
M v[40:43],a[152:155],a[160:163],v[40:43]
s_waitcnt lgkmcnt(2)
v_lshlrev_b32 v232,16,v205
v_lshlrev_b32 v233,16,v209
M v[44:47],a[152:155],a[164:167],v[44:47]
v_lshlrev_b32 v237,16,v207
v_lshlrev_b32 v236,16,v215
M v[44:47],a[128:131],a[160:163],v[44:47]
v_lshlrev_b32 v235,16,v213
v_fmac_f32 v232,s43,v234
M v[44:47],a[104:107],a[140:143],v[44:47]
v_fmac_f32 v237,4.0,v233
v_fma_f32 v238,-4.0,v234,v236
M v[48:51],a[104:107],a[160:163],v[48:51]
s_add_u32 s48,s76,6144
ds_read_b128 a[176:179],v249 offset:2048
v_fmac_f32 v232,s45,v236
M v[48:51],a[128:131],a[164:167],v[48:51]
s_waitcnt lgkmcnt(2)
ds_read_b128 a[180:183],v248 offset:2048
v_fmac_f32 v237,s41,v235
M v[48:51],a[152:155],a[168:171],v[48:51]
s_waitcnt lgkmcnt(2)
v_sub_f32 v236,v236,v234
v_fma_f32 v234,-4.0,v233,v235
M v[52:55],a[152:155],a[172:175],v[52:55]
v_sub_f32 v235,v235,v233
v_add_f32 v233,v238,v234
M v[52:55],a[128:131],a[168:171],v[52:55]
v_sub_f32 v238,v238,v234
v_fma_f32 v234,2.0,v235,v236
M v[52:55],a[104:107],a[164:167],v[52:55]
v_fmac_f32 v236,-2.0,v235
v_and_b32 v211,s42,v211
M v[56:59],a[104:107],a[168:171],v[56:59]
buffer_load_dwordx4 a[208:211],v250,s[20:23],s48 offen offset:0 sc1
M v[56:59],a[128:131],a[172:175],v[56:59]
s_waitcnt lgkmcnt(1)
v_and_b32 v205,s42,v205
v_and_b32 v209,s42,v209
M v[56:59],a[152:155],a[176:179],v[56:59]
s_waitcnt lgkmcnt(0)
s_add_u32 s34,s32,1179648
buffer_load_dwordx4 v[228:231],v250,s[20:23],s48 offen offset:1024 sc1
M v[60:63],a[152:155],a[180:183],v[60:63]
v_and_b32 v207,s42,v207
v_and_b32 v215,s42,v215
M v[60:63],a[128:131],a[176:179],v[60:63]
v_and_b32 v213,s42,v213
v_fmac_f32 v205,s43,v211
M v[60:63],a[104:107],a[172:175],v[60:63]
s_waitcnt vmcnt(28)
v_fmac_f32 v207,4.0,v209
v_fma_f32 v235,-4.0,v211,v215
M v[64:67],a[248:251],a[96:99],v[64:67]
s_waitcnt vmcnt(27)
buffer_load_dwordx4 v[224:227],v250,s[20:23],s48 offen offset:2048 sc1
M v[64:67],a[220:223],a[100:103],v[64:67]
s_waitcnt vmcnt(27)
v_fmac_f32 v205,s45,v215
v_fmac_f32 v207,s41,v213
M v[64:67],a[216:219],a[120:123],v[64:67]
v_sub_f32 v215,v215,v211
v_fma_f32 v211,-4.0,v209,v213
M v[68:71],a[216:219],a[140:143],v[68:71]
v_sub_f32 v213,v213,v209
v_add_f32 v209,v235,v211
M v[68:71],a[220:223],a[120:123],v[68:71]
v_sub_f32 v235,v235,v211
v_fma_f32 v211,2.0,v213,v215
M v[68:71],a[248:251],a[100:103],v[68:71]
buffer_store_dwordx4 a[88:91],v253,s[24:27],s34 offen offset:640 nt
M v[72:75],a[248:251],a[120:123],v[72:75]
v_fmac_f32 v215,-2.0,v213
v_cvt_pk_bf16_f32 v205,v232,v205
M v[72:75],a[220:223],a[140:143],v[72:75]
v_cvt_pk_bf16_f32 v207,v237,v207
v_cvt_pk_bf16_f32 v209,v233,v209
M v[72:75],a[216:219],a[160:163],v[72:75]
v_cvt_pk_bf16_f32 v213,v234,v211
v_cvt_pk_bf16_f32 v211,v238,v235
M v[76:79],a[216:219],a[164:167],v[76:79]
v_cvt_pk_bf16_f32 v215,v236,v215
M v[76:79],a[220:223],a[160:163],v[76:79]
s_barrier
v_fmac_f32 v239,s43,v241
M v[76:79],a[248:251],a[140:143],v[76:79]
ds_write2st64_b64 v247,v[192:193],v[194:195] offset0:102 offset1:119
M v[80:83],a[248:251],a[160:163],v[80:83]
s_add_u32 s28,s66,7077888
buffer_load_dwordx4 v[192:195],v251,s[88:91],s28 offen offset:0
M v[80:83],a[220:223],a[164:167],v[80:83]
s_add_u32 s47,s77,3072
v_fmac_f32 v244,4.0,v240
v_fma_f32 v232,-4.0,v241,v243
M v[80:83],a[216:219],a[168:171],v[80:83]
s_add_u32 s34,s32,1376256
ds_write2st64_b64 v247,v[196:197],v[198:199] offset0:34 offset1:51
M v[84:87],a[216:219],a[172:175],v[84:87]
buffer_load_dwordx4 v[196:199],v245,s[8:11],s28 offen offset:0
M v[84:87],a[220:223],a[168:171],v[84:87]
ds_read_b128 a[96:99],v248 offset:17408
v_fmac_f32 v239,s45,v243
M v[84:87],a[248:251],a[164:167],v[84:87]
ds_write2st64_b64 v247,v[200:201],v[202:203] offset0:68 offset1:85
M v[88:91],a[248:251],a[168:171],v[88:91]
buffer_load_dwordx4 v[200:203],v245,s[8:11],s28 offen offset:768
M v[88:91],a[220:223],a[172:175],v[88:91]
ds_read_b128 a[100:103],v249 offset:17408
ds_read_b128 a[120:123],v248 offset:17920
M v[88:91],a[216:219],a[176:179],v[88:91]
ds_write2st64_b64 v247,v[204:205],v[206:207] offset0:103 offset1:120
M v[92:95],a[216:219],a[180:183],v[92:95]
s_add_u32 s28,s66,7471104
buffer_load_dwordx4 v[204:207],v251,s[88:91],s28 offen offset:0
M v[92:95],a[220:223],a[176:179],v[92:95]
ds_read_b128 a[140:143],v249 offset:17920
v_fmac_f32 v244,s41,v242
M v[92:95],a[248:251],a[172:175],v[92:95]
s_waitcnt vmcnt(29) lgkmcnt(5)
ds_write2st64_b64 v247,v[208:209],v[210:211] offset0:35 offset1:52
M v[32:35],a[116:119],a[96:99],v[32:35]
s_waitcnt vmcnt(28) lgkmcnt(4)
buffer_load_dwordx4 v[208:211],v245,s[8:11],s28 offen offset:0
M v[32:35],a[136:139],a[100:103],v[32:35]
s_waitcnt vmcnt(28) lgkmcnt(3)
ds_read_b128 a[160:163],v248 offset:18432
ds_read_b128 a[164:167],v249 offset:18432
M v[32:35],a[156:159],a[120:123],v[32:35]
s_waitcnt lgkmcnt(3)
ds_write2st64_b64 v247,v[212:213],v[214:215] offset0:69 offset1:86
M v[36:39],a[156:159],a[140:143],v[36:39]
buffer_load_dwordx4 v[212:215],v245,s[8:11],s28 offen offset:768
M v[36:39],a[136:139],a[120:123],v[36:39]
v_sub_f32 v243,v243,v241
v_fma_f32 v241,-4.0,v240,v242
M v[36:39],a[116:119],a[100:103],v[36:39]
v_sub_f32 v242,v242,v240
v_add_f32 v240,v232,v241
M v[40:43],a[116:119],a[120:123],v[40:43]
ds_read_b128 a[168:171],v248 offset:18944
v_sub_f32 v232,v232,v241
M v[40:43],a[136:139],a[140:143],v[40:43]
s_waitcnt lgkmcnt(3)
buffer_load_dwordx4 a[104:107],v250,s[20:23],s47 offen offset:0 sc1
M v[40:43],a[156:159],a[160:163],v[40:43]
s_waitcnt lgkmcnt(2)
ds_read_b128 a[172:175],v249 offset:18944
v_fma_f32 v241,2.0,v242,v243
M v[44:47],a[156:159],a[164:167],v[44:47]
v_fmac_f32 v243,-2.0,v242
v_cvt_pk_bf16_f32 v233,v239,v244
M v[44:47],a[136:139],a[160:163],v[44:47]
v_cvt_pk_bf16_f32 v234,v240,v232
v_cvt_pk_bf16_f32 v235,v241,v243
M v[44:47],a[116:119],a[140:143],v[44:47]
s_add_u32 s29,s67,6291456
buffer_load_short_d16_hi v239,v246,s[12:15],s29 offen offset:0
M v[48:51],a[116:119],a[160:163],v[48:51]
ds_read_b128 a[176:179],v249 offset:19456
ds_write_b16 v252,v233 offset:52224
M v[48:51],a[136:139],a[164:167],v[48:51]
s_waitcnt lgkmcnt(3)
buffer_load_short_d16_hi v240,v246,s[8:11],s29 offen offset:0
M v[48:51],a[156:159],a[168:171],v[48:51]
s_waitcnt lgkmcnt(2)
buffer_load_short_d16_hi v241,v246,s[8:11],s29 offen offset:384
M v[52:55],a[156:159],a[172:175],v[52:55]
ds_read_b128 a[180:183],v248 offset:19456
ds_write_b16_d16_hi v252,v233 offset:60928
M v[52:55],a[136:139],a[168:171],v[52:55]
buffer_load_short_d16_hi v242,v246,s[8:11],s29 offen offset:768
M v[52:55],a[116:119],a[164:167],v[52:55]
ds_write_b16 v252,v234 offset:17408
M v[56:59],a[116:119],a[168:171],v[56:59]
buffer_load_short_d16_hi v243,v246,s[8:11],s29 offen offset:1152
M v[56:59],a[136:139],a[172:175],v[56:59]
s_waitcnt lgkmcnt(4)
ds_write_b16_d16_hi v252,v234 offset:26112
M v[56:59],a[156:159],a[176:179],v[56:59]
s_waitcnt lgkmcnt(3)
buffer_load_short_d16_hi v244,v246,s[16:19],s29 offen offset:1536
M v[60:63],a[156:159],a[180:183],v[60:63]
ds_write_b16 v252,v235 offset:34816
M v[60:63],a[136:139],a[176:179],v[60:63]
buffer_load_dwordx4 a[128:131],v250,s[20:23],s47 offen offset:1024 sc1
M v[60:63],a[116:119],a[172:175],v[60:63]
s_waitcnt vmcnt(36)
ds_write_b16_d16_hi v252,v235 offset:43520
M v[64:67],a[188:191],a[96:99],v[64:67]
s_waitcnt vmcnt(35)
M v[64:67],a[252:255],a[100:103],v[64:67]
s_waitcnt vmcnt(34)
M v[64:67],a[244:247],a[120:123],v[64:67]
buffer_store_dwordx4 a[92:95],v253,s[24:27],s34 offen offset:640 nt
M v[68:71],a[244:247],a[140:143],v[68:71]
s_add_u32 s34,s33,0
M v[68:71],a[252:255],a[120:123],v[68:71]
M v[68:71],a[188:191],a[100:103],v[68:71]
buffer_load_dwordx4 a[152:155],v250,s[20:23],s47 offen offset:2048 sc1
M v[72:75],a[188:191],a[120:123],v[72:75]
s_add_u32 s48,s77,6144
M v[72:75],a[252:255],a[140:143],v[72:75]
M v[72:75],a[244:247],a[160:163],v[72:75]
M v[76:79],a[244:247],a[164:167],v[76:79]
buffer_load_dwordx4 a[228:231],v250,s[20:23],s48 offen offset:0 sc1
M v[76:79],a[252:255],a[160:163],v[76:79]
M v[76:79],a[188:191],a[140:143],v[76:79]
M v[80:83],a[188:191],a[160:163],v[80:83]
M v[80:83],a[252:255],a[164:167],v[80:83]
buffer_load_dwordx4 a[224:227],v250,s[20:23],s48 offen offset:1024 sc1
M v[80:83],a[244:247],a[168:171],v[80:83]
M v[84:87],a[244:247],a[172:175],v[84:87]
M v[84:87],a[252:255],a[168:171],v[84:87]
ds_read_b128 a[96:99],v248 offset:34816
M v[84:87],a[188:191],a[164:167],v[84:87]
buffer_store_dwordx4 v[96:99],v253,s[24:27],s34 offen offset:1152 nt
M v[88:91],a[188:191],a[168:171],v[88:91]
s_add_u32 s34,s33,393216
ds_read_b128 a[100:103],v249 offset:34816
ds_read_b128 a[120:123],v248 offset:35328
M v[88:91],a[252:255],a[172:175],v[88:91]
ds_read_b128 a[140:143],v249 offset:35328
M v[88:91],a[244:247],a[176:179],v[88:91]
buffer_load_dwordx4 a[196:199],v250,s[20:23],s48 offen offset:2048 sc1
M v[92:95],a[244:247],a[180:183],v[92:95]
s_waitcnt vmcnt(18)
s_add_u32 s48,s72,52224
v_permlane32_swap_b32 v196,v198
v_permlane32_swap_b32 v192,v194
M v[92:95],a[252:255],a[176:179],v[92:95]
s_waitcnt vmcnt(17)
v_permlane32_swap_b32 v200,v202
v_lshlrev_b32 v234,16,v198
M v[92:95],a[188:191],a[172:175],v[92:95]
s_waitcnt lgkmcnt(3)
v_lshlrev_b32 v232,16,v192
v_lshlrev_b32 v233,16,v196
M v[32:35],a[108:111],a[96:99],v[32:35]
s_waitcnt lgkmcnt(2)
buffer_load_dwordx4 a[116:119],v250,s[20:23],s48 offen offset:0 sc1
M v[32:35],a[132:135],a[100:103],v[32:35]
s_waitcnt lgkmcnt(1)
ds_read_b128 a[160:163],v248 offset:35840
ds_read_b128 a[164:167],v249 offset:35840
M v[32:35],a[148:151],a[120:123],v[32:35]
s_waitcnt lgkmcnt(2)
v_lshlrev_b32 v237,16,v194
v_lshlrev_b32 v236,16,v202
M v[36:39],a[148:151],a[140:143],v[36:39]
v_lshlrev_b32 v235,16,v200
v_fmac_f32 v232,s43,v234
M v[36:39],a[132:135],a[120:123],v[36:39]
buffer_load_dwordx4 a[136:139],v250,s[20:23],s48 offen offset:1024 sc1
M v[36:39],a[108:111],a[100:103],v[36:39]
v_fmac_f32 v237,4.0,v233
v_fma_f32 v238,-4.0,v234,v236
M v[40:43],a[108:111],a[120:123],v[40:43]
ds_read_b128 a[168:171],v248 offset:36352
v_fmac_f32 v232,s45,v236
M v[40:43],a[132:135],a[140:143],v[40:43]
s_waitcnt lgkmcnt(2)
ds_read_b128 a[172:175],v249 offset:36352
v_fmac_f32 v237,s41,v235
M v[40:43],a[148:151],a[160:163],v[40:43]
s_waitcnt lgkmcnt(2)
buffer_store_dwordx4 v[104:107],v253,s[24:27],s34 offen offset:1152 nt
M v[44:47],a[148:151],a[164:167],v[44:47]
s_add_u32 s34,s33,786432
v_sub_f32 v236,v236,v234
v_fma_f32 v234,-4.0,v233,v235
M v[44:47],a[132:135],a[160:163],v[44:47]
v_sub_f32 v235,v235,v233
v_add_f32 v233,v238,v234
M v[44:47],a[108:111],a[140:143],v[44:47]
buffer_load_dwordx4 a[156:159],v250,s[20:23],s48 offen offset:2048 sc1
M v[48:51],a[108:111],a[160:163],v[48:51]
s_add_u32 s48,s73,52224
ds_read_b128 a[176:179],v249 offset:36864
v_sub_f32 v238,v238,v234
M v[48:51],a[132:135],a[164:167],v[48:51]
s_waitcnt lgkmcnt(2)
ds_read_b128 a[180:183],v248 offset:36864
v_fma_f32 v234,2.0,v235,v236
M v[48:51],a[148:151],a[168:171],v[48:51]
s_waitcnt lgkmcnt(2)
v_fmac_f32 v236,-2.0,v235
v_and_b32 v198,s42,v198
M v[52:55],a[148:151],a[172:175],v[52:55]
v_and_b32 v192,s42,v192
v_and_b32 v196,s42,v196
M v[52:55],a[132:135],a[168:171],v[52:55]
v_and_b32 v194,s42,v194
v_and_b32 v202,s42,v202
M v[52:55],a[108:111],a[164:167],v[52:55]
buffer_store_dwordx4 v[112:115],v253,s[24:27],s34 offen offset:1152 nt
M v[56:59],a[108:111],a[168:171],v[56:59]
s_add_u32 s34,s33,1179648
buffer_load_dwordx4 a[188:191],v250,s[20:23],s48 offen offset:0 sc1
M v[56:59],a[132:135],a[172:175],v[56:59]
s_waitcnt lgkmcnt(1)
v_and_b32 v200,s42,v200
v_fmac_f32 v192,s43,v198
M v[56:59],a[148:151],a[176:179],v[56:59]
s_waitcnt lgkmcnt(0)
v_fmac_f32 v194,4.0,v196
v_fma_f32 v235,-4.0,v198,v202
M v[60:63],a[148:151],a[180:183],v[60:63]
v_fmac_f32 v192,s45,v202
v_fmac_f32 v194,s41,v200
M v[60:63],a[132:135],a[176:179],v[60:63]
buffer_load_dwordx4 a[236:239],v250,s[20:23],s48 offen offset:1024 sc1
M v[60:63],a[108:111],a[172:175],v[60:63]
v_sub_f32 v202,v202,v198
v_fma_f32 v198,-4.0,v196,v200
M v[64:67],a[184:187],a[96:99],v[64:67]
v_sub_f32 v200,v200,v196
v_add_f32 v196,v235,v198
M v[64:67],v[216:219],a[100:103],v[64:67]
v_sub_f32 v235,v235,v198
v_fma_f32 v198,2.0,v200,v202
M v[64:67],a[212:215],a[120:123],v[64:67]
buffer_store_dwordx4 v[120:123],v253,s[24:27],s34 offen offset:1152 nt
M v[68:71],a[212:215],a[140:143],v[68:71]
v_fmac_f32 v202,-2.0,v200
v_cvt_pk_bf16_f32 v192,v232,v192
M v[68:71],v[216:219],a[120:123],v[68:71]
v_cvt_pk_bf16_f32 v194,v237,v194
v_cvt_pk_bf16_f32 v196,v233,v196
M v[68:71],a[184:187],a[100:103],v[68:71]
buffer_load_dwordx4 a[232:235],v250,s[20:23],s48 offen offset:2048 sc1
M v[72:75],a[184:187],a[120:123],v[72:75]
v_cvt_pk_bf16_f32 v200,v234,v198
v_cvt_pk_bf16_f32 v198,v238,v235
M v[72:75],v[216:219],a[140:143],v[72:75]
v_cvt_pk_bf16_f32 v202,v236,v202
v_permlane32_swap_b32 v197,v199
M v[72:75],a[212:215],a[160:163],v[72:75]
s_add_u32 s34,s33,0
v_permlane32_swap_b32 v193,v195
v_permlane32_swap_b32 v201,v203
M v[76:79],a[212:215],a[164:167],v[76:79]
v_lshlrev_b32 v234,16,v199
v_lshlrev_b32 v232,16,v193
M v[76:79],v[216:219],a[160:163],v[76:79]
v_lshlrev_b32 v233,16,v197
v_lshlrev_b32 v237,16,v195
M v[76:79],a[184:187],a[140:143],v[76:79]
buffer_store_dwordx4 v[128:131],v253,s[24:27],s34 offen offset:1280 nt
M v[80:83],a[184:187],a[160:163],v[80:83]
s_add_u32 s48,s74,52224
v_lshlrev_b32 v236,16,v203
v_lshlrev_b32 v235,16,v201
M v[80:83],v[216:219],a[164:167],v[80:83]
v_fmac_f32 v232,s43,v234
v_fmac_f32 v237,4.0,v233
M v[80:83],a[212:215],a[168:171],v[80:83]
v_fma_f32 v238,-4.0,v234,v236
v_fmac_f32 v232,s45,v236
M v[84:87],a[212:215],a[172:175],v[84:87]
v_fmac_f32 v237,s41,v235
v_sub_f32 v236,v236,v234
M v[84:87],v[216:219],a[168:171],v[84:87]
ds_read_b128 a[96:99],v248 offset:52224
v_fma_f32 v234,-4.0,v233,v235
M v[84:87],a[184:187],a[164:167],v[84:87]
ds_read_b128 a[100:103],v249 offset:52224
v_sub_f32 v235,v235,v233
M v[88:91],a[184:187],a[168:171],v[88:91]
buffer_load_dwordx4 a[108:111],v250,s[20:23],s48 offen offset:0 sc1
M v[88:91],v[216:219],a[172:175],v[88:91]
ds_read_b128 a[120:123],v248 offset:52736
ds_read_b128 a[140:143],v249 offset:52736
M v[88:91],a[212:215],a[176:179],v[88:91]
buffer_load_dwordx4 a[132:135],v250,s[20:23],s48 offen offset:1024 sc1
M v[92:95],a[212:215],a[180:183],v[92:95]
v_add_f32 v233,v238,v234
v_sub_f32 v238,v238,v234
M v[92:95],v[216:219],a[176:179],v[92:95]
v_fma_f32 v234,2.0,v235,v236
v_fmac_f32 v236,-2.0,v235
M v[92:95],a[184:187],a[172:175],v[92:95]
s_waitcnt lgkmcnt(3)
v_and_b32 v199,s42,v199
v_and_b32 v193,s42,v193
M v[32:35],a[112:115],a[96:99],v[32:35]
s_waitcnt lgkmcnt(2)
buffer_load_dwordx4 a[148:151],v250,s[20:23],s48 offen offset:2048 sc1
M v[32:35],a[124:127],a[100:103],v[32:35]
s_waitcnt lgkmcnt(1)
ds_read_b128 a[160:163],v248 offset:53248
ds_read_b128 a[164:167],v249 offset:53248
M v[32:35],a[144:147],a[120:123],v[32:35]
s_waitcnt lgkmcnt(2)
s_add_u32 s34,s33,393216
v_and_b32 v197,s42,v197
v_and_b32 v195,s42,v195
M v[36:39],a[144:147],a[140:143],v[36:39]
v_and_b32 v203,s42,v203
v_and_b32 v201,s42,v201
M v[36:39],a[124:127],a[120:123],v[36:39]
v_fmac_f32 v193,s43,v199
v_fmac_f32 v195,4.0,v197
M v[36:39],a[112:115],a[100:103],v[36:39]
buffer_store_dwordx4 v[136:139],v253,s[24:27],s34 offen offset:1280 nt
M v[40:43],a[112:115],a[120:123],v[40:43]
ds_read_b128 a[168:171],v248 offset:53760
v_fma_f32 v235,-4.0,v199,v203
M v[40:43],a[124:127],a[140:143],v[40:43]
s_waitcnt lgkmcnt(2)
ds_read_b128 a[172:175],v249 offset:53760
v_fmac_f32 v193,s45,v203
M v[40:43],a[144:147],a[160:163],v[40:43]
s_waitcnt lgkmcnt(2)
v_fmac_f32 v195,s41,v201
v_sub_f32 v203,v203,v199
M v[44:47],a[144:147],a[164:167],v[44:47]
v_fma_f32 v199,-4.0,v197,v201
v_sub_f32 v201,v201,v197
M v[44:47],a[124:127],a[160:163],v[44:47]
v_add_f32 v197,v235,v199
v_sub_f32 v235,v235,v199
M v[44:47],a[112:115],a[140:143],v[44:47]
v_fma_f32 v199,2.0,v201,v203
v_fmac_f32 v203,-2.0,v201
M v[48:51],a[112:115],a[160:163],v[48:51]
s_add_u32 s48,s75,52224
ds_read_b128 a[176:179],v249 offset:54272
v_cvt_pk_bf16_f32 v193,v232,v193
M v[48:51],a[124:127],a[164:167],v[48:51]
s_waitcnt lgkmcnt(2)
ds_read_b128 a[180:183],v248 offset:54272
v_cvt_pk_bf16_f32 v195,v237,v195
M v[48:51],a[144:147],a[168:171],v[48:51]
s_waitcnt lgkmcnt(2)
v_cvt_pk_bf16_f32 v197,v233,v197
v_cvt_pk_bf16_f32 v201,v234,v199
M v[52:55],a[144:147],a[172:175],v[52:55]
v_cvt_pk_bf16_f32 v199,v238,v235
v_cvt_pk_bf16_f32 v203,v236,v203
M v[52:55],a[124:127],a[168:171],v[52:55]
s_waitcnt vmcnt(29)
v_permlane32_swap_b32 v208,v210
v_permlane32_swap_b32 v204,v206
M v[52:55],a[112:115],a[164:167],v[52:55]
ds_write2st64_b64 v247,v[192:193],v[194:195] offset0:104 offset1:121
M v[56:59],a[112:115],a[168:171],v[56:59]
s_add_u32 s28,s67,6291456
buffer_load_dwordx4 v[192:195],v251,s[88:91],s28 offen offset:0
M v[56:59],a[124:127],a[172:175],v[56:59]
s_waitcnt vmcnt(29) lgkmcnt(2)
v_permlane32_swap_b32 v212,v214
v_lshlrev_b32 v234,16,v210
M v[56:59],a[144:147],a[176:179],v[56:59]
s_waitcnt lgkmcnt(1)
s_add_u32 s34,s33,786432
ds_write2st64_b64 v247,v[196:197],v[198:199] offset0:36 offset1:53
M v[60:63],a[144:147],a[180:183],v[60:63]
buffer_load_dwordx4 v[196:199],v245,s[8:11],s28 offen offset:0
M v[60:63],a[124:127],a[176:179],v[60:63]
v_lshlrev_b32 v232,16,v204
v_lshlrev_b32 v233,16,v208
M v[60:63],a[112:115],a[172:175],v[60:63]
ds_write2st64_b64 v247,v[200:201],v[202:203] offset0:70 offset1:87
M v[64:67],a[208:211],a[96:99],v[64:67]
buffer_load_dwordx4 v[200:203],v245,s[8:11],s28 offen offset:768
M v[64:67],v[228:231],a[100:103],v[64:67]
v_lshlrev_b32 v237,16,v206
v_lshlrev_b32 v236,16,v214
M v[64:67],v[224:227],a[120:123],v[64:67]
v_lshlrev_b32 v235,16,v212
v_fmac_f32 v232,s43,v234
M v[68:71],v[224:227],a[140:143],v[68:71]
buffer_load_dwordx4 a[184:187],v250,s[20:23],s48 offen offset:0 sc1
M v[68:71],v[228:231],a[120:123],v[68:71]
v_fmac_f32 v237,4.0,v233
v_fma_f32 v238,-4.0,v234,v236
M v[68:71],a[208:211],a[100:103],v[68:71]
v_fmac_f32 v232,s45,v236
v_fmac_f32 v237,s41,v235
M v[72:75],a[208:211],a[120:123],v[72:75]
v_sub_f32 v236,v236,v234
v_fma_f32 v234,-4.0,v233,v235
M v[72:75],v[228:231],a[140:143],v[72:75]
buffer_load_dwordx4 v[220:223],v250,s[20:23],s48 offen offset:1024 sc1
M v[72:75],v[224:227],a[160:163],v[72:75]
v_sub_f32 v235,v235,v233
v_add_f32 v233,v238,v234
M v[76:79],v[224:227],a[164:167],v[76:79]
v_sub_f32 v238,v238,v234
v_fma_f32 v234,2.0,v235,v236
M v[76:79],v[228:231],a[160:163],v[76:79]
v_fmac_f32 v236,-2.0,v235
v_and_b32 v210,s42,v210
M v[76:79],a[208:211],a[140:143],v[76:79]
buffer_load_dwordx4 a[240:243],v250,s[20:23],s48 offen offset:2048 sc1
M v[80:83],a[208:211],a[160:163],v[80:83]
s_add_u32 s48,s76,52224
v_and_b32 v204,s42,v204
v_and_b32 v208,s42,v208
M v[80:83],v[228:231],a[164:167],v[80:83]
v_add_u32 v248,0xfffece00,v248
v_add_u32 v249,0xfffece00,v249
M v[80:83],v[224:227],a[168:171],v[80:83]
v_and_b32 v206,s42,v206
v_and_b32 v214,s42,v214
M v[84:87],v[224:227],a[172:175],v[84:87]
v_and_b32 v212,s42,v212
v_fmac_f32 v204,s43,v210
M v[84:87],v[228:231],a[168:171],v[84:87]
ds_read_b128 a[96:99],v248 offset:60928
v_fmac_f32 v206,4.0,v208
M v[84:87],a[208:211],a[164:167],v[84:87]
buffer_store_dwordx4 v[144:147],v253,s[24:27],s34 offen offset:1280 nt
M v[88:91],a[208:211],a[168:171],v[88:91]
s_add_u32 s34,s33,1179648
buffer_load_dwordx4 a[112:115],v250,s[20:23],s48 offen offset:0 sc1
M v[88:91],v[228:231],a[172:175],v[88:91]
ds_read_b128 a[100:103],v249 offset:60928
ds_read_b128 a[120:123],v248 offset:61440
M v[88:91],v[224:227],a[176:179],v[88:91]
ds_read_b128 a[140:143],v249 offset:61440
v_fma_f32 v235,-4.0,v210,v214
M v[92:95],v[224:227],a[180:183],v[92:95]
v_fmac_f32 v204,s45,v214
v_fmac_f32 v206,s41,v212
M v[92:95],v[228:231],a[176:179],v[92:95]
buffer_load_dwordx4 a[124:127],v250,s[20:23],s48 offen offset:1024 sc1
M v[92:95],a[208:211],a[172:175],v[92:95]
s_waitcnt vmcnt(36) lgkmcnt(3)
v_sub_f32 v214,v214,v210
v_fma_f32 v210,-4.0,v208,v212
M v[32:35],a[104:107],a[96:99],v[32:35]
s_waitcnt vmcnt(29) lgkmcnt(2)
ds_read_b128 a[160:163],v248 offset:61952
v_sub_f32 v212,v212,v208
M v[32:35],a[128:131],a[100:103],v[32:35]
s_waitcnt vmcnt(27) lgkmcnt(2)
ds_read_b128 a[164:167],v249 offset:61952
v_add_f32 v208,v235,v210
M v[32:35],a[152:155],a[120:123],v[32:35]
s_waitcnt lgkmcnt(2)
buffer_store_dwordx4 v[152:155],v253,s[24:27],s34 offen offset:1280 nt
M v[36:39],a[152:155],a[140:143],v[36:39]
v_sub_f32 v235,v235,v210
v_fma_f32 v210,2.0,v212,v214
M v[36:39],a[128:131],a[120:123],v[36:39]
v_fmac_f32 v214,-2.0,v212
v_cvt_pk_bf16_f32 v204,v232,v204
M v[36:39],a[104:107],a[100:103],v[36:39]
buffer_load_dwordx4 a[144:147],v250,s[20:23],s48 offen offset:2048 sc1
M v[40:43],a[104:107],a[120:123],v[40:43]
ds_read_b128 a[168:171],v248 offset:62464
v_cvt_pk_bf16_f32 v206,v237,v206
M v[40:43],a[128:131],a[140:143],v[40:43]
s_waitcnt lgkmcnt(2)
ds_read_b128 a[172:175],v249 offset:62464
v_cvt_pk_bf16_f32 v208,v233,v208
M v[40:43],a[152:155],a[160:163],v[40:43]
s_waitcnt lgkmcnt(2)
v_cvt_pk_bf16_f32 v212,v234,v210
v_cvt_pk_bf16_f32 v210,v238,v235
M v[44:47],a[152:155],a[164:167],v[44:47]
v_cvt_pk_bf16_f32 v214,v236,v214
v_permlane32_swap_b32 v209,v211
M v[44:47],a[128:131],a[160:163],v[44:47]
v_permlane32_swap_b32 v205,v207
v_permlane32_swap_b32 v213,v215
M v[44:47],a[104:107],a[140:143],v[44:47]
v_lshlrev_b32 v234,16,v211
v_lshlrev_b32 v232,16,v205
M v[48:51],a[104:107],a[160:163],v[48:51]
s_add_u32 s48,s77,52224
ds_read_b128 a[176:179],v249 offset:62976
v_lshlrev_b32 v233,16,v209
M v[48:51],a[128:131],a[164:167],v[48:51]
s_waitcnt lgkmcnt(2)
ds_read_b128 a[180:183],v248 offset:62976
v_lshlrev_b32 v237,16,v207
M v[48:51],a[152:155],a[168:171],v[48:51]
s_waitcnt lgkmcnt(2)
v_lshlrev_b32 v236,16,v215
v_lshlrev_b32 v235,16,v213
M v[52:55],a[152:155],a[172:175],v[52:55]
v_fmac_f32 v232,s43,v234
v_fmac_f32 v237,4.0,v233
M v[52:55],a[128:131],a[168:171],v[52:55]
v_fma_f32 v238,-4.0,v234,v236
v_fmac_f32 v232,s45,v236
M v[52:55],a[104:107],a[164:167],v[52:55]
v_fmac_f32 v237,s41,v235
v_sub_f32 v236,v236,v234
M v[56:59],a[104:107],a[168:171],v[56:59]
buffer_load_dwordx4 a[204:207],v250,s[20:23],s48 offen offset:0 sc1
M v[56:59],a[128:131],a[172:175],v[56:59]
s_waitcnt lgkmcnt(1)
v_fma_f32 v234,-4.0,v233,v235
v_sub_f32 v235,v235,v233
M v[56:59],a[152:155],a[176:179],v[56:59]
s_waitcnt lgkmcnt(0)
buffer_load_dwordx4 a[192:195],v250,s[20:23],s48 offen offset:1024 sc1
M v[60:63],a[152:155],a[180:183],v[60:63]
v_add_f32 v233,v238,v234
v_sub_f32 v238,v238,v234
M v[60:63],a[128:131],a[176:179],v[60:63]
v_fma_f32 v234,2.0,v235,v236
v_fmac_f32 v236,-2.0,v235
M v[60:63],a[104:107],a[172:175],v[60:63]
s_waitcnt vmcnt(30)
v_and_b32 v211,s42,v211
v_and_b32 v205,s42,v205
M v[64:67],a[228:231],a[96:99],v[64:67]
s_waitcnt vmcnt(29)
buffer_load_dwordx4 a[200:203],v250,s[20:23],s48 offen offset:2048 sc1
M v[64:67],a[224:227],a[100:103],v[64:67]
s_waitcnt vmcnt(28)
v_and_b32 v209,s42,v209
v_and_b32 v207,s42,v207
M v[64:67],a[196:199],a[120:123],v[64:67]
v_and_b32 v215,s42,v215
v_and_b32 v213,s42,v213
M v[68:71],a[196:199],a[140:143],v[68:71]
v_fmac_f32 v205,s43,v211
v_fmac_f32 v207,4.0,v209
M v[68:71],a[224:227],a[120:123],v[68:71]
v_fma_f32 v235,-4.0,v211,v215
v_fmac_f32 v205,s45,v215
M v[68:71],a[228:231],a[100:103],v[68:71]
v_fmac_f32 v207,s41,v213
v_sub_f32 v215,v215,v211
M v[72:75],a[228:231],a[120:123],v[72:75]
v_fma_f32 v211,-4.0,v209,v213
v_sub_f32 v213,v213,v209
M v[72:75],a[224:227],a[140:143],v[72:75]
v_add_f32 v209,v235,v211
v_sub_f32 v235,v235,v211
M v[72:75],a[196:199],a[160:163],v[72:75]
v_fma_f32 v211,2.0,v213,v215
v_fmac_f32 v215,-2.0,v213
M v[76:79],a[196:199],a[164:167],v[76:79]
v_cvt_pk_bf16_f32 v205,v232,v205
v_cvt_pk_bf16_f32 v207,v237,v207
M v[76:79],a[224:227],a[160:163],v[76:79]
v_cvt_pk_bf16_f32 v209,v233,v209
v_cvt_pk_bf16_f32 v213,v234,v211
M v[76:79],a[228:231],a[140:143],v[76:79]
v_cvt_pk_bf16_f32 v211,v238,v235
v_cvt_pk_bf16_f32 v215,v236,v215
M v[80:83],a[228:231],a[160:163],v[80:83]
s_add_u32 s46,s72,9216
M v[80:83],a[224:227],a[164:167],v[80:83]
s_barrier
v_cvt_pk_bf16_f32 v32,v32,v33
M v[80:83],a[196:199],a[168:171],v[80:83]
ds_write2st64_b64 v247,v[204:205],v[206:207] offset0:105 offset1:122
M v[84:87],a[196:199],a[172:175],v[84:87]
s_add_u32 s28,s67,6684672
buffer_load_dwordx4 v[204:207],v251,s[88:91],s28 offen offset:0
M v[84:87],a[224:227],a[168:171],v[84:87]
ds_read_b128 a[96:99],v248 offset:0
v_cvt_pk_bf16_f32 v33,v34,v35
M v[84:87],a[228:231],a[164:167],v[84:87]
ds_write2st64_b64 v247,v[208:209],v[210:211] offset0:37 offset1:54
M v[88:91],a[228:231],a[168:171],v[88:91]
buffer_load_dwordx4 v[208:211],v245,s[8:11],s28 offen offset:0
M v[88:91],a[224:227],a[172:175],v[88:91]
ds_read_b128 a[100:103],v249 offset:0
ds_read_b128 a[120:123],v248 offset:512
M v[88:91],a[196:199],a[176:179],v[88:91]
ds_write2st64_b64 v247,v[212:213],v[214:215] offset0:71 offset1:88
M v[92:95],a[196:199],a[180:183],v[92:95]
buffer_load_dwordx4 v[212:215],v245,s[8:11],s28 offen offset:768
M v[92:95],a[224:227],a[176:179],v[92:95]
ds_read_b128 a[140:143],v249 offset:512
v_cvt_pk_bf16_f32 v36,v36,v37
M v[92:95],a[228:231],a[172:175],v[92:95]
s_waitcnt vmcnt(30) lgkmcnt(5)
v_cvt_pk_bf16_f32 v37,v38,v39
M v[160:163],a[116:119],a[96:99],v[160:163]
s_waitcnt vmcnt(29) lgkmcnt(3)
buffer_load_dwordx4 a[104:107],v250,s[20:23],s46 offen offset:0 sc1
M v[160:163],a[136:139],a[100:103],v[160:163]
s_waitcnt vmcnt(28) lgkmcnt(2)
ds_read_b128 a[96:99],v248 offset:1024
ds_read_b128 a[160:163],v249 offset:1024
M v[160:163],a[156:159],a[120:123],v[160:163]
s_waitcnt lgkmcnt(2)
ds_write2st64_b64 v254,v[32:33],v[36:37] offset0:0 offset1:4
M v[164:167],a[156:159],a[140:143],v[164:167]
buffer_load_dwordx4 a[128:131],v250,s[20:23],s46 offen offset:1024 sc1
M v[164:167],a[136:139],a[120:123],v[164:167]
v_cvt_pk_bf16_f32 v40,v40,v41
v_cvt_pk_bf16_f32 v41,v42,v43
M v[164:167],a[116:119],a[100:103],v[164:167]
v_cvt_pk_bf16_f32 v44,v44,v45
v_cvt_pk_bf16_f32 v45,v46,v47
M v[168:171],a[116:119],a[120:123],v[168:171]
ds_read_b128 a[100:103],v248 offset:1536
ds_write2st64_b64 v254,v[40:41],v[44:45] offset0:8 offset1:12
M v[168:171],a[136:139],a[140:143],v[168:171]
s_waitcnt lgkmcnt(4)
buffer_load_dwordx4 a[152:155],v250,s[20:23],s46 offen offset:2048 sc1
M v[168:171],a[156:159],a[96:99],v[168:171]
s_waitcnt lgkmcnt(3)
ds_read_b128 a[120:123],v249 offset:1536
v_cvt_pk_bf16_f32 v48,v48,v49
M v[172:175],a[156:159],a[160:163],v[172:175]
v_cvt_pk_bf16_f32 v49,v50,v51
v_cvt_pk_bf16_f32 v52,v52,v53
M v[172:175],a[136:139],a[96:99],v[172:175]
v_cvt_pk_bf16_f32 v53,v54,v55
M v[172:175],a[116:119],a[140:143],v[172:175]
ds_write2st64_b64 v254,v[48:49],v[52:53] offset0:136 offset1:140
M v[176:179],a[116:119],a[96:99],v[176:179]
s_add_u32 s47,s72,12288
ds_read_b128 a[96:99],v249 offset:2048
v_cvt_pk_bf16_f32 v56,v56,v57
M v[176:179],a[136:139],a[160:163],v[176:179]
s_waitcnt lgkmcnt(4)
ds_read_b128 a[140:143],v248 offset:2048
v_add_u32 v248,0x15400,v248
M v[176:179],a[156:159],a[100:103],v[176:179]
s_waitcnt lgkmcnt(3)
v_add_u32 v249,0x15400,v249
v_cvt_pk_bf16_f32 v57,v58,v59
M v[180:183],a[156:159],a[120:123],v[180:183]
v_cvt_pk_bf16_f32 v60,v60,v61
v_cvt_pk_bf16_f32 v61,v62,v63
M v[180:183],a[136:139],a[100:103],v[180:183]
ds_read_b128 a[164:167],v248 offset:0
ds_write2st64_b64 v254,v[56:57],v[60:61] offset0:144 offset1:148
M v[180:183],a[116:119],a[160:163],v[180:183]
ds_read_b128 a[160:163],v249 offset:0
v_cvt_pk_bf16_f32 v64,v64,v65
M v[184:187],a[116:119],a[100:103],v[184:187]
buffer_load_dwordx4 a[100:103],v250,s[20:23],s47 offen offset:0 sc1
M v[184:187],a[136:139],a[120:123],v[184:187]
s_waitcnt lgkmcnt(4)
ds_read_b128 a[168:171],v248 offset:512
ds_read_b128 a[176:179],v249 offset:512
M v[184:187],a[156:159],a[96:99],v[184:187]
s_waitcnt lgkmcnt(5)
buffer_load_dwordx4 a[172:175],v250,s[20:23],s47 offen offset:1024 sc1
M v[188:191],a[156:159],a[140:143],v[188:191]
v_cvt_pk_bf16_f32 v65,v66,v67
v_cvt_pk_bf16_f32 v68,v68,v69
M v[188:191],a[136:139],a[96:99],v[188:191]
v_cvt_pk_bf16_f32 v69,v70,v71
M v[188:191],a[116:119],a[120:123],v[188:191]
s_waitcnt vmcnt(30) lgkmcnt(4)
ds_write2st64_b64 v254,v[64:65],v[68:69] offset0:170 offset1:174
M v[160:163],a[188:191],a[164:167],v[160:163]
s_waitcnt vmcnt(29) lgkmcnt(3)
buffer_load_dwordx4 a[180:183],v250,s[20:23],s47 offen offset:2048 sc1
M v[160:163],a[236:239],a[160:163],v[160:163]
s_waitcnt vmcnt(28) lgkmcnt(2)
ds_read_b128 a[96:99],v248 offset:1024
ds_read_b128 a[116:119],v249 offset:1024
M v[160:163],a[232:235],a[168:171],v[160:163]
s_waitcnt lgkmcnt(3)
v_cvt_pk_bf16_f32 v72,v72,v73
v_cvt_pk_bf16_f32 v73,v74,v75
M v[164:167],a[232:235],a[176:179],v[164:167]
v_cvt_pk_bf16_f32 v76,v76,v77
v_cvt_pk_bf16_f32 v77,v78,v79
M v[164:167],a[236:239],a[168:171],v[164:167]
ds_write2st64_b64 v254,v[72:73],v[76:77] offset0:178 offset1:182
M v[164:167],a[188:191],a[160:163],v[164:167]
v_cvt_pk_bf16_f32 v80,v80,v81
v_cvt_pk_bf16_f32 v81,v82,v83
M v[168:171],a[188:191],a[168:171],v[168:171]
ds_read_b128 a[120:123],v248 offset:1536
v_cvt_pk_bf16_f32 v84,v84,v85
M v[168:171],a[236:239],a[176:179],v[168:171]
s_waitcnt lgkmcnt(3)
ds_read_b128 a[136:139],v249 offset:1536
v_cvt_pk_bf16_f32 v85,v86,v87
M v[168:171],a[232:235],a[96:99],v[168:171]
s_waitcnt lgkmcnt(3)
ds_write2st64_b64 v254,v[80:81],v[84:85] offset0:204 offset1:208
M v[172:175],a[232:235],a[116:119],v[172:175]
v_cvt_pk_bf16_f32 v88,v88,v89
v_cvt_pk_bf16_f32 v89,v90,v91
M v[172:175],a[236:239],a[96:99],v[172:175]
v_cvt_pk_bf16_f32 v92,v92,v93
v_cvt_pk_bf16_f32 v93,v94,v95
M v[172:175],a[188:191],a[176:179],v[172:175]
ds_write2st64_b64 v254,v[88:89],v[92:93] offset0:212 offset1:216
M v[176:179],a[188:191],a[96:99],v[176:179]
s_add_u32 s48,s72,15360
ds_read_b128 a[96:99],v249 offset:2048
M v[176:179],a[236:239],a[116:119],v[176:179]
s_waitcnt lgkmcnt(4)
ds_read_b128 a[140:143],v248 offset:2048
M v[176:179],a[232:235],a[120:123],v[176:179]
s_waitcnt lgkmcnt(2)
s_barrier
ds_read_b128 v[32:35],v250 offset:0
M v[180:183],a[232:235],a[136:139],v[180:183]
ds_read_b128 v[40:43],v250 offset:4096
ds_read_b128 v[48:51],v4 offset:0
M v[180:183],a[236:239],a[120:123],v[180:183]
ds_read_b128 v[56:59],v4 offset:4096
ds_read_b128 v[64:67],v4 offset:17408
M v[180:183],a[188:191],a[116:119],v[180:183]
ds_read_b128 v[72:75],v4 offset:21504
ds_read_b128 v[80:83],v4 offset:34816
M v[184:187],a[188:191],a[120:123],v[184:187]
ds_read_b128 v[88:91],v4 offset:38912
ds_read_b128 a[156:159],v248 offset:17408
M v[184:187],a[236:239],a[136:139],v[184:187]
s_waitcnt lgkmcnt(10)
s_add_u32 s34,s33,0
buffer_load_dwordx4 a[120:123],v250,s[20:23],s48 offen offset:0 sc1
M v[184:187],a[232:235],a[96:99],v[184:187]
s_waitcnt lgkmcnt(9)
ds_read_b128 a[116:119],v249 offset:17408
ds_read_b128 a[160:163],v248 offset:17920
M v[188:191],a[232:235],a[140:143],v[188:191]
buffer_load_dwordx4 a[164:167],v250,s[20:23],s48 offen offset:1024 sc1
M v[188:191],a[236:239],a[96:99],v[188:191]
ds_read_b128 a[168:171],v249 offset:17920
M v[188:191],a[188:191],a[136:139],v[188:191]
s_waitcnt vmcnt(28) lgkmcnt(3)
M v[160:163],a[108:111],a[156:159],v[160:163]
s_waitcnt vmcnt(27) lgkmcnt(2)
ds_read_b128 a[96:99],v248 offset:18432
M v[160:163],a[132:135],a[116:119],v[160:163]
s_waitcnt vmcnt(26) lgkmcnt(2)
buffer_load_dwordx4 a[176:179],v250,s[20:23],s48 offen offset:2048 sc1
M v[160:163],a[148:151],a[160:163],v[160:163]
s_waitcnt lgkmcnt(1)
ds_read_b128 a[136:139],v249 offset:18432
M v[164:167],a[148:151],a[168:171],v[164:167]
M v[164:167],a[132:135],a[160:163],v[164:167]
M v[164:167],a[108:111],a[116:119],v[164:167]
buffer_store_dwordx4 v[32:35],v253,s[24:27],s34 offen offset:128 nt
M v[168:171],a[108:111],a[160:163],v[168:171]
s_add_u32 s34,s33,393216
ds_read_b128 a[116:119],v248 offset:18944
M v[168:171],a[132:135],a[168:171],v[168:171]
s_waitcnt lgkmcnt(2)
ds_read_b128 a[140:143],v249 offset:18944
M v[168:171],a[148:151],a[96:99],v[168:171]
s_waitcnt lgkmcnt(2)
buffer_store_dwordx4 v[40:43],v253,s[24:27],s34 offen offset:128 nt
M v[172:175],a[148:151],a[136:139],v[172:175]
s_add_u32 s34,s33,786432
M v[172:175],a[132:135],a[96:99],v[172:175]
M v[172:175],a[108:111],a[168:171],v[172:175]
buffer_store_dwordx4 v[48:51],v253,s[24:27],s34 offen offset:128 nt
M v[176:179],a[108:111],a[96:99],v[176:179]
s_add_u32 s34,s33,1179648
ds_read_b128 a[96:99],v249 offset:19456
s_add_u32 s46,s72,18432
M v[176:179],a[132:135],a[136:139],v[176:179]
s_waitcnt lgkmcnt(2)
ds_read_b128 a[156:159],v248 offset:19456
M v[176:179],a[148:151],a[116:119],v[176:179]
s_waitcnt lgkmcnt(2)
buffer_store_dwordx4 v[56:59],v253,s[24:27],s34 offen offset:128 nt
M v[180:183],a[148:151],a[140:143],v[180:183]
s_add_u32 s34,s33,0
M v[180:183],a[132:135],a[116:119],v[180:183]
ds_read_b128 a[160:163],v248 offset:34816
M v[180:183],a[108:111],a[136:139],v[180:183]
buffer_store_dwordx4 v[64:67],v253,s[24:27],s34 offen offset:256 nt
M v[184:187],a[108:111],a[116:119],v[184:187]
s_add_u32 s34,s33,393216
ds_read_b128 a[136:139],v249 offset:34816
ds_read_b128 a[116:119],v248 offset:35328
M v[184:187],a[132:135],a[140:143],v[184:187]
s_waitcnt lgkmcnt(4)
ds_read_b128 a[216:219],v249 offset:35328
M v[184:187],a[148:151],a[96:99],v[184:187]
s_waitcnt lgkmcnt(4)
buffer_store_dwordx4 v[72:75],v253,s[24:27],s34 offen offset:256 nt
M v[188:191],a[148:151],a[156:159],v[188:191]
s_add_u32 s34,s33,786432
M v[188:191],a[132:135],a[96:99],v[188:191]
M v[188:191],a[108:111],a[140:143],v[188:191]
s_waitcnt vmcnt(28) lgkmcnt(3)
buffer_load_dwordx4 a[168:171],v250,s[20:23],s46 offen offset:0 sc1
M v[160:163],a[184:187],a[160:163],v[160:163]
s_waitcnt vmcnt(28) lgkmcnt(2)
ds_read_b128 a[96:99],v248 offset:35840
M v[160:163],v[220:223],a[136:139],v[160:163]
s_waitcnt vmcnt(27) lgkmcnt(2)
ds_read_b128 a[108:111],v249 offset:35840
M v[160:163],a[240:243],a[116:119],v[160:163]
s_waitcnt lgkmcnt(2)
M v[164:167],a[240:243],a[216:219],v[164:167]
buffer_load_dwordx4 a[188:191],v250,s[20:23],s46 offen offset:1024 sc1
M v[164:167],v[220:223],a[116:119],v[164:167]
M v[164:167],a[184:187],a[136:139],v[164:167]
M v[168:171],a[184:187],a[116:119],v[168:171]
ds_read_b128 a[116:119],v248 offset:36352
M v[168:171],v[220:223],a[216:219],v[168:171]
s_waitcnt lgkmcnt(2)
buffer_load_dwordx4 a[220:223],v250,s[20:23],s46 offen offset:2048 sc1
M v[168:171],a[240:243],a[96:99],v[168:171]
s_waitcnt lgkmcnt(1)
ds_read_b128 a[132:135],v249 offset:36352
M v[172:175],a[240:243],a[108:111],v[172:175]
M v[172:175],v[220:223],a[96:99],v[172:175]
M v[172:175],a[184:187],a[216:219],v[172:175]
buffer_store_dwordx4 v[80:83],v253,s[24:27],s34 offen offset:256 nt
M v[176:179],a[184:187],a[96:99],v[176:179]
s_add_u32 s47,s72,21504
ds_read_b128 a[96:99],v249 offset:36864
M v[176:179],v[220:223],a[108:111],v[176:179]
s_waitcnt lgkmcnt(2)
ds_read_b128 a[136:139],v248 offset:36864
M v[176:179],a[240:243],a[116:119],v[176:179]
s_waitcnt lgkmcnt(2)
s_add_u32 s34,s33,1179648
buffer_store_dwordx4 v[88:91],v253,s[24:27],s34 offen offset:256 nt
M v[180:183],a[240:243],a[132:135],v[180:183]
M v[180:183],v[220:223],a[116:119],v[180:183]
ds_read_b128 a[140:143],v248 offset:52224
M v[180:183],a[184:187],a[108:111],v[180:183]
ds_read_b128 a[108:111],v249 offset:52224
M v[184:187],a[184:187],a[116:119],v[184:187]
buffer_load_dwordx4 a[248:251],v250,s[20:23],s47 offen offset:0 sc1
M v[184:187],v[220:223],a[132:135],v[184:187]
s_waitcnt lgkmcnt(3)
ds_read_b128 a[116:119],v248 offset:52736
ds_read_b128 a[148:151],v249 offset:52736
M v[184:187],a[240:243],a[96:99],v[184:187]
s_waitcnt lgkmcnt(4)
M v[188:191],a[240:243],a[136:139],v[188:191]
buffer_load_dwordx4 a[160:163],v250,s[20:23],s47 offen offset:1024 sc1
M v[188:191],v[220:223],a[96:99],v[188:191]
M v[188:191],a[184:187],a[132:135],v[188:191]
s_waitcnt vmcnt(31) lgkmcnt(3)
M v[160:163],a[112:115],a[140:143],v[160:163]
s_waitcnt vmcnt(30) lgkmcnt(2)
ds_read_b128 a[96:99],v248 offset:53248
M v[160:163],a[124:127],a[108:111],v[160:163]
s_waitcnt vmcnt(28) lgkmcnt(2)
buffer_load_dwordx4 a[244:247],v250,s[20:23],s47 offen offset:2048 sc1
M v[160:163],a[144:147],a[116:119],v[160:163]
s_waitcnt lgkmcnt(1)
ds_read_b128 a[132:135],v249 offset:53248
M v[164:167],a[144:147],a[148:151],v[164:167]
M v[164:167],a[124:127],a[116:119],v[164:167]
M v[164:167],a[112:115],a[108:111],v[164:167]
M v[168:171],a[112:115],a[116:119],v[168:171]
ds_read_b128 a[108:111],v248 offset:53760
M v[168:171],a[124:127],a[148:151],v[168:171]
s_waitcnt lgkmcnt(2)
ds_read_b128 a[116:119],v249 offset:53760
M v[168:171],a[144:147],a[96:99],v[168:171]
s_waitcnt lgkmcnt(2)
M v[172:175],a[144:147],a[132:135],v[172:175]
M v[172:175],a[124:127],a[96:99],v[172:175]
M v[172:175],a[112:115],a[148:151],v[172:175]
M v[176:179],a[112:115],a[96:99],v[176:179]
s_add_u32 s48,s72,24576
ds_read_b128 a[96:99],v249 offset:54272
M v[176:179],a[124:127],a[132:135],v[176:179]
s_waitcnt lgkmcnt(2)
ds_read_b128 a[136:139],v248 offset:54272
v_add_u32 v248,0xfffece00,v248
M v[176:179],a[144:147],a[108:111],v[176:179]
s_waitcnt lgkmcnt(2)
v_add_u32 v249,0xfffece00,v249
M v[180:183],a[144:147],a[116:119],v[180:183]
M v[180:183],a[124:127],a[108:111],v[180:183]
ds_read_b128 a[140:143],v248 offset:60928
M v[180:183],a[112:115],a[132:135],v[180:183]
ds_read_b128 a[132:135],v249 offset:60928
M v[184:187],a[112:115],a[108:111],v[184:187]
buffer_load_dwordx4 a[252:255],v250,s[20:23],s48 offen offset:0 sc1
M v[184:187],a[124:127],a[116:119],v[184:187]
s_waitcnt lgkmcnt(3)
ds_read_b128 a[108:111],v248 offset:61440
ds_read_b128 a[148:151],v249 offset:61440
M v[184:187],a[144:147],a[96:99],v[184:187]
s_waitcnt lgkmcnt(4)
buffer_load_dwordx4 a[212:215],v250,s[20:23],s48 offen offset:1024 sc1
M v[188:191],a[144:147],a[136:139],v[188:191]
M v[188:191],a[124:127],a[96:99],v[188:191]
M v[188:191],a[112:115],a[116:119],v[188:191]
s_waitcnt vmcnt(30) lgkmcnt(3)
M v[160:163],a[204:207],a[140:143],v[160:163]
s_waitcnt vmcnt(29) lgkmcnt(2)
buffer_load_dwordx4 v[216:219],v250,s[20:23],s48 offen offset:2048 sc1
M v[160:163],a[192:195],a[132:135],v[160:163]
s_waitcnt vmcnt(29) lgkmcnt(1)
ds_read_b128 a[96:99],v248 offset:61952
ds_read_b128 a[112:115],v249 offset:61952
M v[160:163],a[200:203],a[108:111],v[160:163]
s_waitcnt lgkmcnt(2)
M v[164:167],a[200:203],a[148:151],v[164:167]
M v[164:167],a[192:195],a[108:111],v[164:167]
M v[164:167],a[204:207],a[132:135],v[164:167]
s_nop 3
v_cvt_pk_bf16_f32 v160,v160,v161
v_cvt_pk_bf16_f32 v161,v162,v163
M v[168:171],a[204:207],a[108:111],v[168:171]
ds_read_b128 a[108:111],v248 offset:62464
M v[168:171],a[192:195],a[148:151],v[168:171]
s_waitcnt lgkmcnt(2)
ds_read_b128 a[116:119],v249 offset:62464
M v[168:171],a[200:203],a[96:99],v[168:171]
s_waitcnt lgkmcnt(2)
v_cvt_pk_bf16_f32 v164,v164,v165
v_cvt_pk_bf16_f32 v165,v166,v167
M v[172:175],a[200:203],a[112:115],v[172:175]
M v[172:175],a[192:195],a[96:99],v[172:175]
ds_read_b128 a[124:127],v249 offset:62976
ds_read_b128 a[132:135],v248 offset:62976
M v[172:175],a[204:207],a[148:151],v[172:175]
M v[176:179],a[204:207],a[96:99],v[176:179]
s_add_u32 s46,s72,27648
M v[176:179],a[192:195],a[112:115],v[176:179]
s_waitcnt lgkmcnt(3)
M v[176:179],a[200:203],a[108:111],v[176:179]
s_waitcnt lgkmcnt(0)
s_barrier
ds_write2st64_b64 v254,v[160:161],v[164:165] offset0:221 offset1:225
M v[180:183],a[200:203],a[116:119],v[180:183]
v_cvt_pk_bf16_f32 v168,v168,v169
v_cvt_pk_bf16_f32 v169,v170,v171
M v[180:183],a[192:195],a[108:111],v[180:183]
ds_read_b128 a[96:99],v248 offset:0
v_cvt_pk_bf16_f32 v172,v172,v173
M v[180:183],a[204:207],a[112:115],v[180:183]
ds_read_b128 a[112:115],v249 offset:0
v_cvt_pk_bf16_f32 v173,v174,v175
M v[184:187],a[204:207],a[108:111],v[184:187]
buffer_load_dwordx4 v[224:227],v250,s[20:23],s46 offen offset:0 sc1
M v[184:187],a[192:195],a[116:119],v[184:187]
ds_read_b128 a[108:111],v248 offset:512
ds_read_b128 a[136:139],v249 offset:512
M v[184:187],a[200:203],a[124:127],v[184:187]
ds_write2st64_b64 v254,v[168:169],v[172:173] offset0:229 offset1:233
M v[188:191],a[200:203],a[132:135],v[188:191]
v_cvt_pk_bf16_f32 v176,v176,v177
v_cvt_pk_bf16_f32 v177,v178,v179
M v[188:191],a[192:195],a[124:127],v[188:191]
v_cvt_pk_bf16_f32 v180,v180,v181
v_cvt_pk_bf16_f32 v181,v182,v183
M v[188:191],a[204:207],a[116:119],v[188:191]
s_waitcnt vmcnt(26) lgkmcnt(4)
ds_write2st64_b64 v254,v[176:177],v[180:181] offset0:238 offset1:242
M a[0:3],a[104:107],a[96:99],0
s_waitcnt vmcnt(25) lgkmcnt(4)
ds_read_b128 a[116:119],v248 offset:1024
v_cvt_pk_bf16_f32 v184,v184,v185
M a[0:3],a[128:131],a[112:115],a[0:3]
s_waitcnt vmcnt(24) lgkmcnt(4)
ds_read_b128 a[124:127],v249 offset:1024
v_cvt_pk_bf16_f32 v185,v186,v187
M a[0:3],a[152:155],a[108:111],a[0:3]
s_waitcnt lgkmcnt(4)
v_cvt_pk_bf16_f32 v188,v188,v189
v_cvt_pk_bf16_f32 v189,v190,v191
M a[4:7],a[152:155],a[136:139],0
ds_write2st64_b64 v254,v[184:185],v[188:189] offset0:246 offset1:250
M a[4:7],a[128:131],a[108:111],a[4:7]
v_permlane32_swap_b32 v196,v198
v_permlane32_swap_b32 v192,v194
M a[4:7],a[104:107],a[112:115],a[4:7]
v_permlane32_swap_b32 v200,v202
v_lshlrev_b32 v234,16,v198
M a[8:11],a[104:107],a[108:111],0
ds_read_b128 a[132:135],v248 offset:1536
v_lshlrev_b32 v232,16,v192
M a[8:11],a[128:131],a[136:139],a[8:11]
s_waitcnt lgkmcnt(3)
ds_read_b128 a[140:143],v249 offset:1536
v_lshlrev_b32 v233,16,v196
M a[8:11],a[152:155],a[116:119],a[8:11]
s_waitcnt lgkmcnt(3)
v_lshlrev_b32 v237,16,v194
v_lshlrev_b32 v236,16,v202
M a[12:15],a[152:155],a[124:127],0
v_lshlrev_b32 v235,16,v200
v_fmac_f32 v232,s43,v234
M a[12:15],a[128:131],a[116:119],a[12:15]
s_waitcnt lgkmcnt(2)
s_barrier
ds_read_b128 v[160:163],v4 offset:43520
M a[12:15],a[104:107],a[136:139],a[12:15]
ds_read_b128 v[168:171],v4 offset:47616
ds_read_b128 v[176:179],v4 offset:52224
M a[16:19],a[104:107],a[116:119],0
ds_read_b128 v[184:187],v4 offset:56320
ds_read_b128 a[144:147],v249 offset:2048
M a[16:19],a[128:131],a[124:127],a[16:19]
s_waitcnt lgkmcnt(6)
ds_read_b128 a[148:151],v248 offset:2048
v_fmac_f32 v237,4.0,v233
M a[16:19],a[152:155],a[132:135],a[16:19]
s_waitcnt lgkmcnt(6)
v_fma_f32 v238,-4.0,v234,v236
v_fmac_f32 v232,s45,v236
M a[20:23],a[152:155],a[140:143],0
s_add_u32 s34,s33,0
v_fmac_f32 v237,s41,v235
v_sub_f32 v236,v236,v234
M a[20:23],a[128:131],a[132:135],a[20:23]
v_fma_f32 v234,-4.0,v233,v235
v_sub_f32 v235,v235,v233
M a[20:23],a[104:107],a[124:127],a[20:23]
s_waitcnt lgkmcnt(5)
buffer_store_dwordx4 v[160:163],v253,s[24:27],s34 offen offset:1408 nt
M a[24:27],a[104:107],a[132:135],0
s_add_u32 s34,s33,393216
v_add_f32 v233,v238,v234
v_sub_f32 v238,v238,v234
M a[24:27],a[128:131],a[140:143],a[24:27]
s_waitcnt lgkmcnt(1)
v_fma_f32 v234,2.0,v235,v236
v_fmac_f32 v236,-2.0,v235
M a[24:27],a[152:155],a[144:147],a[24:27]
s_waitcnt lgkmcnt(0)
buffer_store_dwordx4 v[168:171],v253,s[24:27],s34 offen offset:1408 nt
M a[28:31],a[152:155],a[148:151],0
s_add_u32 s34,s33,786432
v_and_b32 v198,s42,v198
v_and_b32 v192,s42,v192
M a[28:31],a[128:131],a[144:147],a[28:31]
v_and_b32 v196,s42,v196
v_and_b32 v194,s42,v194
M a[28:31],a[104:107],a[140:143],a[28:31]
s_waitcnt vmcnt(25)
buffer_store_dwordx4 v[176:179],v253,s[24:27],s34 offen offset:1408 nt
M a[32:35],a[100:103],a[96:99],0
s_waitcnt vmcnt(25)
s_add_u32 s34,s33,1179648
v_and_b32 v202,s42,v202
v_and_b32 v200,s42,v200
M a[32:35],a[172:175],a[112:115],a[32:35]
s_waitcnt vmcnt(24)
v_fmac_f32 v192,s43,v198
v_fmac_f32 v194,4.0,v196
M a[32:35],a[180:183],a[108:111],a[32:35]
buffer_store_dwordx4 v[184:187],v253,s[24:27],s34 offen offset:1408 nt
M a[36:39],a[180:183],a[136:139],0
v_fma_f32 v235,-4.0,v198,v202
v_fmac_f32 v192,s45,v202
M a[36:39],a[172:175],a[108:111],a[36:39]
v_fmac_f32 v194,s41,v200
v_sub_f32 v202,v202,v198
M a[36:39],a[100:103],a[112:115],a[36:39]
v_fma_f32 v198,-4.0,v196,v200
v_sub_f32 v200,v200,v196
M a[40:43],a[100:103],a[108:111],0
v_add_f32 v196,v235,v198
v_sub_f32 v235,v235,v198
M a[40:43],a[172:175],a[136:139],a[40:43]
v_fma_f32 v198,2.0,v200,v202
v_fmac_f32 v202,-2.0,v200
M a[40:43],a[180:183],a[116:119],a[40:43]
v_cvt_pk_bf16_f32 v192,v232,v192
v_cvt_pk_bf16_f32 v194,v237,v194
M a[44:47],a[180:183],a[124:127],0
v_cvt_pk_bf16_f32 v196,v233,v196
v_cvt_pk_bf16_f32 v200,v234,v198
M a[44:47],a[172:175],a[116:119],a[44:47]
v_cvt_pk_bf16_f32 v198,v238,v235
v_cvt_pk_bf16_f32 v202,v236,v202
M a[44:47],a[100:103],a[136:139],a[44:47]
v_permlane32_swap_b32 v197,v199
v_permlane32_swap_b32 v193,v195
M a[48:51],a[100:103],a[116:119],0
v_permlane32_swap_b32 v201,v203
v_lshlrev_b32 v234,16,v199
M a[48:51],a[172:175],a[124:127],a[48:51]
v_lshlrev_b32 v232,16,v193
v_lshlrev_b32 v233,16,v197
M a[48:51],a[180:183],a[132:135],a[48:51]
v_lshlrev_b32 v237,16,v195
v_lshlrev_b32 v236,16,v203
M a[52:55],a[180:183],a[140:143],0
v_lshlrev_b32 v235,16,v201
v_fmac_f32 v232,s43,v234
M a[52:55],a[172:175],a[132:135],a[52:55]
v_fmac_f32 v237,4.0,v233
v_fma_f32 v238,-4.0,v234,v236
M a[52:55],a[100:103],a[124:127],a[52:55]
v_fmac_f32 v232,s45,v236
v_fmac_f32 v237,s41,v235
M a[56:59],a[100:103],a[132:135],0
v_sub_f32 v236,v236,v234
v_fma_f32 v234,-4.0,v233,v235
M a[56:59],a[172:175],a[140:143],a[56:59]
v_sub_f32 v235,v235,v233
v_add_f32 v233,v238,v234
M a[56:59],a[180:183],a[144:147],a[56:59]
v_sub_f32 v238,v238,v234
v_fma_f32 v234,2.0,v235,v236
M a[60:63],a[180:183],a[148:151],0
v_fmac_f32 v236,-2.0,v235
v_and_b32 v199,s42,v199
M a[60:63],a[172:175],a[144:147],a[60:63]
v_and_b32 v193,s42,v193
v_and_b32 v197,s42,v197
M a[60:63],a[100:103],a[140:143],a[60:63]
s_waitcnt vmcnt(24)
v_and_b32 v195,s42,v195
v_and_b32 v203,s42,v203
M a[64:67],a[120:123],a[96:99],0
s_waitcnt vmcnt(23)
v_and_b32 v201,s42,v201
v_fmac_f32 v193,s43,v199
M a[64:67],a[164:167],a[112:115],a[64:67]
s_waitcnt vmcnt(22)
v_fmac_f32 v195,4.0,v197
v_fma_f32 v235,-4.0,v199,v203
M a[64:67],a[176:179],a[108:111],a[64:67]
v_fmac_f32 v193,s45,v203
v_fmac_f32 v195,s41,v201
M a[68:71],a[176:179],a[136:139],0
v_sub_f32 v203,v203,v199
v_fma_f32 v199,-4.0,v197,v201
M a[68:71],a[164:167],a[108:111],a[68:71]
v_sub_f32 v201,v201,v197
v_add_f32 v197,v235,v199
M a[68:71],a[120:123],a[112:115],a[68:71]
v_sub_f32 v235,v235,v199
v_fma_f32 v199,2.0,v201,v203
M a[72:75],a[120:123],a[108:111],0
v_fmac_f32 v203,-2.0,v201
v_cvt_pk_bf16_f32 v193,v232,v193
M a[72:75],a[164:167],a[136:139],a[72:75]
v_cvt_pk_bf16_f32 v195,v237,v195
v_cvt_pk_bf16_f32 v197,v233,v197
M a[72:75],a[176:179],a[116:119],a[72:75]
v_cvt_pk_bf16_f32 v201,v234,v199
v_cvt_pk_bf16_f32 v199,v238,v235
M a[76:79],a[176:179],a[124:127],0
v_cvt_pk_bf16_f32 v203,v236,v203
v_permlane32_swap_b32 v208,v210
M a[76:79],a[164:167],a[116:119],a[76:79]
v_permlane32_swap_b32 v204,v206
v_permlane32_swap_b32 v212,v214
M a[76:79],a[120:123],a[136:139],a[76:79]
ds_write2st64_b64 v247,v[192:193],v[194:195] offset0:170 offset1:187
M a[80:83],a[120:123],a[116:119],0
s_add_u32 s28,s67,7077888
buffer_load_dwordx4 v[192:195],v251,s[88:91],s28 offen offset:0
M a[80:83],a[164:167],a[124:127],a[80:83]
v_lshlrev_b32 v234,16,v210
v_lshlrev_b32 v232,16,v204
M a[80:83],a[176:179],a[132:135],a[80:83]
ds_write2st64_b64 v247,v[196:197],v[198:199] offset0:0 offset1:17
M a[84:87],a[176:179],a[140:143],0
buffer_load_dwordx4 v[196:199],v245,s[8:11],s28 offen offset:0
M a[84:87],a[164:167],a[132:135],a[84:87]
ds_read_b128 a[172:175],v248 offset:8704
v_lshlrev_b32 v233,16,v208
M a[84:87],a[120:123],a[124:127],a[84:87]
ds_write2st64_b64 v247,v[200:201],v[202:203] offset0:136 offset1:153
M a[88:91],a[120:123],a[132:135],0
buffer_load_dwordx4 v[200:203],v245,s[8:11],s28 offen offset:768
M a[88:91],a[164:167],a[140:143],a[88:91]
ds_read_b128 a[180:183],v249 offset:8704
ds_read_b128 a[184:187],v248 offset:9216
M a[88:91],a[176:179],a[144:147],a[88:91]
ds_read_b128 v[228:231],v249 offset:9216
v_lshlrev_b32 v237,16,v206
M a[92:95],a[176:179],a[148:151],0
v_lshlrev_b32 v236,16,v214
v_lshlrev_b32 v235,16,v212
M a[92:95],a[164:167],a[144:147],a[92:95]
v_fmac_f32 v232,s43,v234
v_fmac_f32 v237,4.0,v233
M a[92:95],a[120:123],a[140:143],a[92:95]
s_waitcnt vmcnt(18) lgkmcnt(4)
v_fma_f32 v238,-4.0,v234,v236
v_fmac_f32 v232,s45,v236
M a[96:99],a[168:171],a[172:175],0
s_waitcnt vmcnt(17) lgkmcnt(2)
ds_read_b128 a[208:211],v248 offset:9728
v_fmac_f32 v237,s41,v235
M a[96:99],a[188:191],a[180:183],a[96:99]
s_waitcnt vmcnt(16) lgkmcnt(2)
ds_read_b128 a[196:199],v249 offset:9728
v_sub_f32 v236,v236,v234
M a[96:99],a[220:223],a[184:187],a[96:99]
s_waitcnt lgkmcnt(2)
v_fma_f32 v234,-4.0,v233,v235
v_sub_f32 v235,v235,v233
M a[100:103],a[220:223],v[228:231],0
v_add_f32 v233,v238,v234
v_sub_f32 v238,v238,v234
M a[100:103],a[188:191],a[184:187],a[100:103]
v_fma_f32 v234,2.0,v235,v236
v_fmac_f32 v236,-2.0,v235
M a[100:103],a[168:171],a[180:183],a[100:103]
v_and_b32 v210,s42,v210
v_and_b32 v204,s42,v204
M a[104:107],a[168:171],a[184:187],0
ds_read_b128 a[224:227],v248 offset:10240
v_and_b32 v208,s42,v208
M a[104:107],a[188:191],v[228:231],a[104:107]
s_waitcnt lgkmcnt(2)
ds_read_b128 a[228:231],v249 offset:10240
v_and_b32 v206,s42,v206
M a[104:107],a[220:223],a[208:211],a[104:107]
s_waitcnt lgkmcnt(2)
v_and_b32 v214,s42,v214
v_and_b32 v212,s42,v212
M a[108:111],a[220:223],a[196:199],0
v_fmac_f32 v204,s43,v210
v_fmac_f32 v206,4.0,v208
M a[108:111],a[188:191],a[208:211],a[108:111]
v_fma_f32 v235,-4.0,v210,v214
v_fmac_f32 v204,s45,v214
M a[108:111],a[168:171],v[228:231],a[108:111]
v_fmac_f32 v206,s41,v212
v_sub_f32 v214,v214,v210
M a[112:115],a[168:171],a[208:211],0
ds_read_b128 a[232:235],v249 offset:10752
v_fma_f32 v210,-4.0,v208,v212
M a[112:115],a[188:191],a[196:199],a[112:115]
s_waitcnt lgkmcnt(2)
ds_read_b128 a[236:239],v248 offset:10752
v_sub_f32 v212,v212,v208
M a[112:115],a[220:223],a[224:227],a[112:115]
s_waitcnt lgkmcnt(2)
v_add_f32 v208,v235,v210
v_sub_f32 v235,v235,v210
M a[116:119],a[220:223],a[228:231],0
v_fma_f32 v210,2.0,v212,v214
v_fmac_f32 v214,-2.0,v212
M a[116:119],a[188:191],a[224:227],a[116:119]
v_cvt_pk_bf16_f32 v204,v232,v204
v_cvt_pk_bf16_f32 v206,v237,v206
M a[116:119],a[168:171],a[196:199],a[116:119]
s_add_u32 s31,s73,s85
v_cvt_pk_bf16_f32 v208,v233,v208
v_cvt_pk_bf16_f32 v212,v234,v210
M a[120:123],a[168:171],a[224:227],0
v_cvt_pk_bf16_f32 v210,v238,v235
v_cvt_pk_bf16_f32 v214,v236,v214
M a[120:123],a[188:191],a[228:231],a[120:123]
s_waitcnt lgkmcnt(1)
v_permlane32_swap_b32 v209,v211
v_permlane32_swap_b32 v205,v207
M a[120:123],a[220:223],a[232:235],a[120:123]
s_waitcnt lgkmcnt(0)
v_permlane32_swap_b32 v213,v215
v_lshlrev_b32 v234,16,v211
M a[124:127],a[220:223],a[236:239],0
buffer_load_dword a216,v250,s[20:23],s31 offen offset:0 sc1
M a[124:127],a[188:191],a[232:235],a[124:127]
v_lshlrev_b32 v232,16,v205
v_lshlrev_b32 v233,16,v209
M a[124:127],a[168:171],a[228:231],a[124:127]
s_waitcnt vmcnt(14)
buffer_load_dword a216,v250,s[20:23],s31 offen offset:128 sc1
M a[128:131],a[248:251],a[172:175],0
s_waitcnt vmcnt(14)
v_lshlrev_b32 v237,16,v207
v_lshlrev_b32 v236,16,v215
M a[128:131],a[160:163],a[180:183],a[128:131]
s_waitcnt vmcnt(13)
v_lshlrev_b32 v235,16,v213
v_fmac_f32 v232,s43,v234
M a[128:131],a[244:247],a[184:187],a[128:131]
v_fmac_f32 v237,4.0,v233
v_fma_f32 v238,-4.0,v234,v236
M a[132:135],a[244:247],v[228:231],0
buffer_load_dwordx4 a[216:219],v250,s[20:23],s46 offen offset:1024 sc1
M a[132:135],a[160:163],a[184:187],a[132:135]
v_fmac_f32 v232,s45,v236
v_fmac_f32 v237,s41,v235
M a[132:135],a[248:251],a[180:183],a[132:135]
v_sub_f32 v236,v236,v234
v_fma_f32 v234,-4.0,v233,v235
M a[136:139],a[248:251],a[184:187],0
v_sub_f32 v235,v235,v233
v_add_f32 v233,v238,v234
M a[136:139],a[160:163],v[228:231],a[136:139]
buffer_load_dwordx4 a[240:243],v250,s[20:23],s46 offen offset:2048 sc1
M a[136:139],a[244:247],a[208:211],a[136:139]
s_add_u32 s47,s72,30720
v_sub_f32 v238,v238,v234
v_fma_f32 v234,2.0,v235,v236
M a[140:143],a[244:247],a[196:199],0
v_fmac_f32 v236,-2.0,v235
v_and_b32 v211,s42,v211
M a[140:143],a[160:163],a[208:211],a[140:143]
v_and_b32 v205,s42,v205
v_and_b32 v209,s42,v209
M a[140:143],a[248:251],v[228:231],a[140:143]
buffer_load_dwordx4 v[220:223],v250,s[20:23],s47 offen offset:0 sc1
M a[144:147],a[248:251],a[208:211],0
v_and_b32 v207,s42,v207
v_and_b32 v215,s42,v215
M a[144:147],a[160:163],a[196:199],a[144:147]
v_and_b32 v213,s42,v213
v_fmac_f32 v205,s43,v211
M a[144:147],a[244:247],a[224:227],a[144:147]
v_fmac_f32 v207,4.0,v209
v_fma_f32 v235,-4.0,v211,v215
M a[148:151],a[244:247],a[228:231],0
v_fmac_f32 v205,s45,v215
v_fmac_f32 v207,s41,v213
M a[148:151],a[160:163],a[224:227],a[148:151]
v_sub_f32 v215,v215,v211
v_fma_f32 v211,-4.0,v209,v213
M a[148:151],a[248:251],a[196:199],a[148:151]
v_sub_f32 v213,v213,v209
v_add_f32 v209,v235,v211
M a[152:155],a[248:251],a[224:227],0
v_sub_f32 v235,v235,v211
v_fma_f32 v211,2.0,v213,v215
M a[152:155],a[160:163],a[228:231],a[152:155]
v_fmac_f32 v215,-2.0,v213
v_cvt_pk_bf16_f32 v205,v232,v205
M a[152:155],a[244:247],a[232:235],a[152:155]
v_cvt_pk_bf16_f32 v207,v237,v207
v_cvt_pk_bf16_f32 v209,v233,v209
M a[156:159],a[244:247],a[236:239],0
buffer_load_dwordx4 a[200:203],v250,s[20:23],s47 offen offset:1024 sc1
M a[156:159],a[160:163],a[232:235],a[156:159]
v_cvt_pk_bf16_f32 v213,v234,v211
v_cvt_pk_bf16_f32 v211,v238,v235
M a[156:159],a[248:251],a[228:231],a[156:159]
s_waitcnt vmcnt(16)
buffer_load_dwordx4 a[192:195],v250,s[20:23],s47 offen offset:2048 sc1
M a[160:163],a[252:255],a[172:175],0
s_waitcnt vmcnt(16)
s_add_u32 s48,s72,33792
v_cvt_pk_bf16_f32 v215,v236,v215
v_fmac_f32 v239,s43,v241
M a[160:163],a[212:215],a[180:183],a[160:163]
s_waitcnt vmcnt(15)
v_fmac_f32 v244,4.0,v240
v_fma_f32 v232,-4.0,v241,v243
M a[160:163],v[216:219],a[184:187],a[160:163]
ds_write2st64_b64 v247,v[204:205],v[206:207] offset0:171 offset1:188
M a[164:167],v[216:219],v[228:231],0
s_add_u32 s28,s67,7471104
buffer_load_dwordx4 a[204:207],v250,s[20:23],s48 offen offset:0 sc1
M a[164:167],a[212:215],a[184:187],a[164:167]
v_fmac_f32 v239,s45,v243
v_fmac_f32 v244,s41,v242
M a[164:167],a[252:255],a[180:183],a[164:167]
ds_write2st64_b64 v247,v[208:209],v[210:211] offset0:1 offset1:18
M a[168:171],a[252:255],a[184:187],0
buffer_load_dwordx4 a[220:223],v250,s[20:23],s48 offen offset:1024 sc1
M a[168:171],a[212:215],v[228:231],a[168:171]
v_sub_f32 v243,v243,v241
v_fma_f32 v241,-4.0,v240,v242
M a[168:171],v[216:219],a[208:211],a[168:171]
ds_write2st64_b64 v247,v[212:213],v[214:215] offset0:137 offset1:154
M a[172:175],v[216:219],a[196:199],0
buffer_load_dwordx4 a[244:247],v250,s[20:23],s48 offen offset:2048 sc1
M a[172:175],a[212:215],a[208:211],a[172:175]
s_add_u32 s46,s72,36864
v_sub_f32 v242,v242,v240
v_add_f32 v240,v232,v241
M a[172:175],a[252:255],v[228:231],a[172:175]
v_sub_f32 v232,v232,v241
v_fma_f32 v241,2.0,v242,v243
M a[176:179],a[252:255],a[208:211],0
v_fmac_f32 v243,-2.0,v242
v_cvt_pk_bf16_f32 v233,v239,v244
M a[176:179],a[212:215],a[196:199],a[176:179]
buffer_load_dwordx4 a[248:251],v250,s[20:23],s46 offen offset:0 sc1
M a[176:179],v[216:219],a[224:227],a[176:179]
v_cvt_pk_bf16_f32 v234,v240,v232
v_cvt_pk_bf16_f32 v235,v241,v243
M a[180:183],v[216:219],a[228:231],0
v_add_u32 v232,87040,v252
M a[180:183],a[212:215],a[224:227],a[180:183]
ds_read_b128 v[228:231],v248 offset:17408
ds_write_b16 v232,v233 offset:0
M a[180:183],a[252:255],a[196:199],a[180:183]
buffer_load_dwordx4 v[204:207],v251,s[88:91],s28 offen offset:0
M a[184:187],a[252:255],a[224:227],0
ds_read_b128 a[208:211],v249 offset:17408
ds_read_b128 a[196:199],v248 offset:17920
M a[184:187],a[212:215],a[228:231],a[184:187]
ds_read_b128 a[224:227],v249 offset:17920
ds_write_b16_d16_hi v232,v233 offset:8704
M a[184:187],v[216:219],a[232:235],a[184:187]
ds_write_b16 v252,v234 offset:0
M a[188:191],v[216:219],a[236:239],0
buffer_load_dwordx4 v[208:211],v245,s[8:11],s28 offen offset:0
M a[188:191],a[212:215],a[232:235],a[188:191]
ds_write_b16_d16_hi v252,v234 offset:8704
M a[188:191],a[252:255],a[228:231],a[188:191]
s_waitcnt vmcnt(20) lgkmcnt(7)
v_add_u32 v232,69632,v252
M v[0:3],v[224:227],v[228:231],0
s_waitcnt vmcnt(10) lgkmcnt(5)
ds_read_b128 a[236:239],v248 offset:18432
ds_write_b16 v232,v235 offset:0
M v[0:3],a[216:219],a[208:211],v[0:3]
s_waitcnt vmcnt(9) lgkmcnt(6)
buffer_load_dwordx4 v[212:215],v245,s[8:11],s28 offen offset:768
M v[0:3],a[240:243],a[196:199],v[0:3]
s_waitcnt lgkmcnt(5)
ds_read_b128 v[216:219],v249 offset:18432
ds_write_b16_d16_hi v232,v235 offset:8704
M v[4:7],a[240:243],a[224:227],0
v_permlane32_swap_b32 v196,v198
v_permlane32_swap_b32 v192,v194
M v[4:7],a[216:219],a[196:199],v[4:7]
v_permlane32_swap_b32 v200,v202
v_lshlrev_b32 v234,16,v198
M v[4:7],v[224:227],a[208:211],v[4:7]
v_lshlrev_b32 v232,16,v192
v_lshlrev_b32 v233,16,v196
M v[8:11],v[224:227],a[196:199],0
ds_read_b128 a[212:215],v248 offset:18944
v_lshlrev_b32 v237,16,v194
M v[8:11],a[216:219],a[224:227],v[8:11]
s_waitcnt lgkmcnt(4)
ds_read_b128 a[232:235],v249 offset:18944
v_lshlrev_b32 v236,16,v202
M v[8:11],a[240:243],a[236:239],v[8:11]
s_waitcnt lgkmcnt(3)
v_lshlrev_b32 v235,16,v200
v_fmac_f32 v232,s43,v234
M v[12:15],a[240:243],v[216:219],0
v_fmac_f32 v237,4.0,v233
v_fma_f32 v238,-4.0,v234,v236
M v[12:15],a[216:219],a[236:239],v[12:15]
v_fmac_f32 v232,s45,v236
v_fmac_f32 v237,s41,v235
M v[12:15],v[224:227],a[224:227],v[12:15]
v_sub_f32 v236,v236,v234
v_fma_f32 v234,-4.0,v233,v235
M v[16:19],v[224:227],a[236:239],0
ds_read_b128 a[228:231],v249 offset:19456
v_sub_f32 v235,v235,v233
M v[16:19],a[216:219],v[216:219],v[16:19]
s_waitcnt lgkmcnt(2)
ds_read_b128 a[252:255],v248 offset:19456
v_add_f32 v233,v238,v234
M v[16:19],a[240:243],a[212:215],v[16:19]
s_waitcnt lgkmcnt(2)
v_sub_f32 v238,v238,v234
v_fma_f32 v234,2.0,v235,v236
M v[20:23],a[240:243],a[232:235],0
v_fmac_f32 v236,-2.0,v235
v_and_b32 v198,s42,v198
M v[20:23],a[216:219],a[212:215],v[20:23]
v_and_b32 v192,s42,v192
v_and_b32 v196,s42,v196
M v[20:23],v[224:227],v[216:219],v[20:23]
v_and_b32 v194,s42,v194
v_and_b32 v202,s42,v202
M v[24:27],v[224:227],a[212:215],0
v_and_b32 v200,s42,v200
v_fmac_f32 v192,s43,v198
M v[24:27],a[216:219],a[232:235],v[24:27]
s_waitcnt lgkmcnt(1)
v_fmac_f32 v194,4.0,v196
v_fma_f32 v235,-4.0,v198,v202
M v[24:27],a[240:243],a[228:231],v[24:27]
s_waitcnt lgkmcnt(0)
v_fmac_f32 v192,s45,v202
v_fmac_f32 v194,s41,v200
M v[28:31],a[240:243],a[252:255],0
global_load_dword a240,v250,s[64:65]
M v[28:31],a[216:219],a[228:231],v[28:31]
buffer_load_dwordx4 a[240:243],v250,s[20:23],s46 offen offset:1024 sc1
M v[28:31],v[224:227],a[232:235],v[28:31]
s_waitcnt vmcnt(11)
v_sub_f32 v202,v202,v198
v_fma_f32 v198,-4.0,v196,v200
M v[32:35],v[220:223],v[228:231],0
s_waitcnt vmcnt(10)
v_sub_f32 v200,v200,v196
v_add_f32 v196,v235,v198
M v[32:35],a[200:203],a[208:211],v[32:35]
s_waitcnt vmcnt(9)
buffer_load_dwordx4 a[216:219],v250,s[20:23],s46 offen offset:2048 sc1
M v[32:35],a[192:195],a[196:199],v[32:35]
s_add_u32 s47,s72,39936
v_sub_f32 v235,v235,v198
v_fma_f32 v198,2.0,v200,v202
M v[36:39],a[192:195],a[224:227],0
v_fmac_f32 v202,-2.0,v200
v_cvt_pk_bf16_f32 v192,v232,v192
M v[36:39],a[200:203],a[196:199],v[36:39]
v_cvt_pk_bf16_f32 v194,v237,v194
v_cvt_pk_bf16_f32 v196,v233,v196
M v[36:39],v[220:223],a[208:211],v[36:39]
buffer_load_dwordx4 v[224:227],v250,s[20:23],s47 offen offset:0 sc1
M v[40:43],v[220:223],a[196:199],0
v_cvt_pk_bf16_f32 v200,v234,v198
v_cvt_pk_bf16_f32 v198,v238,v235
M v[40:43],a[200:203],a[224:227],v[40:43]
v_cvt_pk_bf16_f32 v202,v236,v202
v_permlane32_swap_b32 v197,v199
M v[40:43],a[192:195],a[236:239],v[40:43]
v_permlane32_swap_b32 v193,v195
v_permlane32_swap_b32 v201,v203
M v[44:47],a[192:195],v[216:219],0
v_lshlrev_b32 v234,16,v199
v_lshlrev_b32 v232,16,v193
M v[44:47],a[200:203],a[236:239],v[44:47]
v_lshlrev_b32 v233,16,v197
v_lshlrev_b32 v237,16,v195
M v[44:47],v[220:223],a[224:227],v[44:47]
v_lshlrev_b32 v236,16,v203
v_lshlrev_b32 v235,16,v201
M v[48:51],v[220:223],a[236:239],0
v_fmac_f32 v232,s43,v234
v_fmac_f32 v237,4.0,v233
M v[48:51],a[200:203],v[216:219],v[48:51]
v_fma_f32 v238,-4.0,v234,v236
v_fmac_f32 v232,s45,v236
M v[48:51],a[192:195],a[212:215],v[48:51]
v_fmac_f32 v237,s41,v235
v_sub_f32 v236,v236,v234
M v[52:55],a[192:195],a[232:235],0
v_fma_f32 v234,-4.0,v233,v235
v_sub_f32 v235,v235,v233
M v[52:55],a[200:203],a[212:215],v[52:55]
v_add_f32 v233,v238,v234
v_sub_f32 v238,v238,v234
M v[52:55],v[220:223],v[216:219],v[52:55]
v_fma_f32 v234,2.0,v235,v236
v_fmac_f32 v236,-2.0,v235
M v[56:59],v[220:223],a[212:215],0
v_and_b32 v199,s42,v199
v_and_b32 v193,s42,v193
M v[56:59],a[200:203],a[232:235],v[56:59]
v_and_b32 v197,s42,v197
v_and_b32 v195,s42,v195
M v[56:59],a[192:195],a[228:231],v[56:59]
v_and_b32 v203,s42,v203
v_and_b32 v201,s42,v201
M v[60:63],a[192:195],a[252:255],0
buffer_load_dwordx4 a[192:195],v250,s[20:23],s47 offen offset:1024 sc1
M v[60:63],a[200:203],a[228:231],v[60:63]
v_fmac_f32 v193,s43,v199
v_fmac_f32 v195,4.0,v197
M v[60:63],v[220:223],a[232:235],v[60:63]
s_waitcnt vmcnt(11)
buffer_load_dwordx4 a[200:203],v250,s[20:23],s47 offen offset:2048 sc1
M v[64:67],a[204:207],v[228:231],0
s_waitcnt vmcnt(11)
s_add_u32 s48,s72,43008
v_fma_f32 v235,-4.0,v199,v203
v_fmac_f32 v193,s45,v203
M v[64:67],a[220:223],a[208:211],v[64:67]
s_waitcnt vmcnt(10)
v_fmac_f32 v195,s41,v201
v_sub_f32 v203,v203,v199
M v[64:67],a[244:247],a[196:199],v[64:67]
v_fma_f32 v199,-4.0,v197,v201
v_sub_f32 v201,v201,v197
M v[68:71],a[244:247],a[224:227],0
buffer_load_dwordx4 v[220:223],v250,s[20:23],s48 offen offset:0 sc1
M v[68:71],a[220:223],a[196:199],v[68:71]
v_add_f32 v197,v235,v199
v_sub_f32 v235,v235,v199
M v[68:71],a[204:207],a[208:211],v[68:71]
v_fma_f32 v199,2.0,v201,v203
v_fmac_f32 v203,-2.0,v201
M v[72:75],a[204:207],a[196:199],0
v_cvt_pk_bf16_f32 v193,v232,v193
v_cvt_pk_bf16_f32 v195,v237,v195
M v[72:75],a[220:223],a[224:227],v[72:75]
buffer_load_dwordx4 v[228:231],v250,s[20:23],s48 offen offset:1024 sc1
M v[72:75],a[244:247],a[236:239],v[72:75]
v_cvt_pk_bf16_f32 v197,v233,v197
v_cvt_pk_bf16_f32 v201,v234,v199
M v[76:79],a[244:247],v[216:219],0
v_cvt_pk_bf16_f32 v199,v238,v235
v_cvt_pk_bf16_f32 v203,v236,v203
M v[76:79],a[220:223],a[236:239],v[76:79]
s_waitcnt vmcnt(9)
v_permlane32_swap_b32 v208,v210
v_permlane32_swap_b32 v204,v206
M v[76:79],a[204:207],a[224:227],v[76:79]
buffer_load_dwordx4 a[208:211],v250,s[20:23],s48 offen offset:2048 sc1
M v[80:83],a[204:207],a[236:239],0
s_waitcnt vmcnt(9)
s_add_u32 s46,s73,9216
v_permlane32_swap_b32 v212,v214
v_lshlrev_b32 v234,16,v210
M v[80:83],a[220:223],v[216:219],v[80:83]
v_lshlrev_b32 v232,16,v204
v_lshlrev_b32 v233,16,v208
M v[80:83],a[244:247],a[212:215],v[80:83]
ds_write2st64_b64 v247,v[192:193],v[194:195] offset0:172 offset1:189
M v[84:87],a[244:247],a[232:235],0
s_add_u32 s28,s68,6291456
buffer_load_dwordx4 a[196:199],v250,s[20:23],s46 offen offset:0 sc1
M v[84:87],a[220:223],a[212:215],v[84:87]
ds_read_b128 a[224:227],v248 offset:26112
v_lshlrev_b32 v237,16,v206
M v[84:87],a[204:207],v[216:219],v[84:87]
ds_write2st64_b64 v247,v[196:197],v[198:199] offset0:2 offset1:19
M v[88:91],a[204:207],a[212:215],0
buffer_load_dwordx4 v[192:195],v251,s[88:91],s28 offen offset:0
M v[88:91],a[220:223],a[232:235],v[88:91]
ds_read_b128 a[236:239],v249 offset:26112
ds_read_b128 v[216:219],v248 offset:26624
M v[88:91],a[244:247],a[228:231],v[88:91]
ds_write2st64_b64 v247,v[200:201],v[202:203] offset0:138 offset1:155
M v[92:95],a[244:247],a[252:255],0
buffer_load_dwordx4 v[196:199],v245,s[8:11],s28 offen offset:0
M v[92:95],a[220:223],a[228:231],v[92:95]
ds_read_b128 a[212:215],v249 offset:26624
v_lshlrev_b32 v236,16,v214
M v[92:95],a[204:207],a[232:235],v[92:95]
s_waitcnt lgkmcnt(5)
v_lshlrev_b32 v235,16,v212
v_fmac_f32 v232,s43,v234
M v[96:99],a[248:251],a[224:227],0
s_waitcnt vmcnt(10) lgkmcnt(3)
ds_read_b128 a[244:247],v248 offset:27136
v_fmac_f32 v237,4.0,v233
M v[96:99],a[240:243],a[236:239],v[96:99]
s_waitcnt vmcnt(9) lgkmcnt(3)
buffer_load_dwordx4 v[200:203],v245,s[8:11],s28 offen offset:768
M v[96:99],a[216:219],v[216:219],v[96:99]
s_waitcnt lgkmcnt(1)
s_add_u32 s29,s68,6291456
ds_read_b128 a[252:255],v249 offset:27136
v_fma_f32 v238,-4.0,v234,v236
M v[100:103],a[216:219],a[212:215],0
v_fmac_f32 v232,s45,v236
v_fmac_f32 v237,s41,v235
M v[100:103],a[240:243],v[216:219],v[100:103]
v_sub_f32 v236,v236,v234
v_fma_f32 v234,-4.0,v233,v235
M v[100:103],a[248:251],a[236:239],v[100:103]
buffer_load_short_d16_hi v239,v246,s[12:15],s29 offen offset:0
M v[104:107],a[248:251],v[216:219],0
ds_read_b128 a[220:223],v248 offset:27648
v_sub_f32 v235,v235,v233
M v[104:107],a[240:243],a[212:215],v[104:107]
s_waitcnt lgkmcnt(2)
buffer_load_short_d16_hi v240,v246,s[8:11],s29 offen offset:0
M v[104:107],a[216:219],a[244:247],v[104:107]
s_waitcnt lgkmcnt(1)
ds_read_b128 a[228:231],v249 offset:27648
v_add_f32 v233,v238,v234
M v[108:111],a[216:219],a[252:255],0
buffer_load_short_d16_hi v241,v246,s[8:11],s29 offen offset:384
M v[108:111],a[240:243],a[244:247],v[108:111]
v_sub_f32 v238,v238,v234
v_fma_f32 v234,2.0,v235,v236
M v[108:111],a[248:251],a[212:215],v[108:111]
buffer_load_short_d16_hi v242,v246,s[8:11],s29 offen offset:768
M v[112:115],a[248:251],a[244:247],0
ds_read_b128 a[204:207],v249 offset:28160
v_fmac_f32 v236,-2.0,v235
M v[112:115],a[240:243],a[252:255],v[112:115]
s_waitcnt lgkmcnt(2)
buffer_load_short_d16_hi v243,v246,s[8:11],s29 offen offset:1152
M v[112:115],a[216:219],a[220:223],v[112:115]
s_waitcnt lgkmcnt(1)
ds_read_b128 a[232:235],v248 offset:28160
v_and_b32 v210,s42,v210
M v[116:119],a[216:219],a[228:231],0
buffer_load_short_d16_hi v244,v246,s[16:19],s29 offen offset:1536
M v[116:119],a[240:243],a[220:223],v[116:119]
v_and_b32 v204,s42,v204
v_and_b32 v208,s42,v208
M v[116:119],a[248:251],a[252:255],v[116:119]
v_and_b32 v206,s42,v206
v_and_b32 v214,s42,v214
M v[120:123],a[248:251],a[220:223],0
v_and_b32 v212,s42,v212
v_fmac_f32 v204,s43,v210
M v[120:123],a[240:243],a[228:231],v[120:123]
s_waitcnt lgkmcnt(1)
v_fmac_f32 v206,4.0,v208
v_fma_f32 v235,-4.0,v210,v214
M v[120:123],a[216:219],a[204:207],v[120:123]
s_waitcnt lgkmcnt(0)
v_fmac_f32 v204,s45,v214
v_fmac_f32 v206,s41,v212
M v[124:127],a[216:219],a[232:235],0
buffer_load_dwordx4 a[216:219],v250,s[20:23],s46 offen offset:1024 sc1
M v[124:127],a[240:243],a[204:207],v[124:127]
v_sub_f32 v214,v214,v210
v_fma_f32 v210,-4.0,v208,v212
M v[124:127],a[248:251],a[228:231],v[124:127]
s_waitcnt vmcnt(16)
buffer_load_dwordx4 a[240:243],v250,s[20:23],s46 offen offset:2048 sc1
M v[128:131],v[224:227],a[224:227],0
s_waitcnt vmcnt(16)
s_add_u32 s47,s73,12288
v_sub_f32 v212,v212,v208
v_add_f32 v208,v235,v210
M v[128:131],a[192:195],a[236:239],v[128:131]
s_waitcnt vmcnt(15)
v_sub_f32 v235,v235,v210
v_fma_f32 v210,2.0,v212,v214
M v[128:131],a[200:203],v[216:219],v[128:131]
v_fmac_f32 v214,-2.0,v212
v_cvt_pk_bf16_f32 v204,v232,v204
M v[132:135],a[200:203],a[212:215],0
buffer_load_dwordx4 a[248:251],v250,s[20:23],s47 offen offset:0 sc1
M v[132:135],a[192:195],v[216:219],v[132:135]
v_cvt_pk_bf16_f32 v206,v237,v206
v_cvt_pk_bf16_f32 v208,v233,v208
M v[132:135],v[224:227],a[236:239],v[132:135]
v_cvt_pk_bf16_f32 v212,v234,v210
v_cvt_pk_bf16_f32 v210,v238,v235
M v[136:139],v[224:227],v[216:219],0
v_cvt_pk_bf16_f32 v214,v236,v214
v_permlane32_swap_b32 v209,v211
M v[136:139],a[192:195],a[212:215],v[136:139]
v_permlane32_swap_b32 v205,v207
v_permlane32_swap_b32 v213,v215
M v[136:139],a[200:203],a[244:247],v[136:139]
v_lshlrev_b32 v234,16,v211
v_lshlrev_b32 v232,16,v205
M v[140:143],a[200:203],a[252:255],0
v_lshlrev_b32 v233,16,v209
v_lshlrev_b32 v237,16,v207
M v[140:143],a[192:195],a[244:247],v[140:143]
v_lshlrev_b32 v236,16,v215
v_lshlrev_b32 v235,16,v213
M v[140:143],v[224:227],a[212:215],v[140:143]
v_fmac_f32 v232,s43,v234
v_fmac_f32 v237,4.0,v233
M v[144:147],v[224:227],a[244:247],0
v_fma_f32 v238,-4.0,v234,v236
v_fmac_f32 v232,s45,v236
M v[144:147],a[192:195],a[252:255],v[144:147]
v_fmac_f32 v237,s41,v235
v_sub_f32 v236,v236,v234
M v[144:147],a[200:203],a[220:223],v[144:147]
v_fma_f32 v234,-4.0,v233,v235
v_sub_f32 v235,v235,v233
M v[148:151],a[200:203],a[228:231],0
v_add_f32 v233,v238,v234
v_sub_f32 v238,v238,v234
M v[148:151],a[192:195],a[220:223],v[148:151]
v_fma_f32 v234,2.0,v235,v236
v_fmac_f32 v236,-2.0,v235
M v[148:151],v[224:227],a[252:255],v[148:151]
v_and_b32 v211,s42,v211
v_and_b32 v205,s42,v205
M v[152:155],v[224:227],a[220:223],0
v_and_b32 v209,s42,v209
v_and_b32 v207,s42,v207
M v[152:155],a[192:195],a[228:231],v[152:155]
v_and_b32 v215,s42,v215
v_and_b32 v213,s42,v213
M v[152:155],a[200:203],a[204:207],v[152:155]
v_fmac_f32 v205,s43,v211
v_fmac_f32 v207,4.0,v209
M v[156:159],a[200:203],a[232:235],0
buffer_load_dwordx4 a[200:203],v250,s[20:23],s47 offen offset:1024 sc1
M v[156:159],a[192:195],a[204:207],v[156:159]
v_fma_f32 v235,-4.0,v211,v215
v_fmac_f32 v205,s45,v215
M v[156:159],v[224:227],a[228:231],v[156:159]
s_waitcnt vmcnt(16)
buffer_load_dwordx4 a[192:195],v250,s[20:23],s47 offen offset:2048 sc1
M v[160:163],v[220:223],a[224:227],0
s_waitcnt vmcnt(16)
s_add_u32 s48,s73,15360
v_fmac_f32 v207,s41,v213
v_sub_f32 v215,v215,v211
M v[160:163],v[228:231],a[236:239],v[160:163]
s_waitcnt vmcnt(15)
v_fma_f32 v211,-4.0,v209,v213
v_sub_f32 v213,v213,v209
v_add_f32 v209,v235,v211
M v[160:163],a[208:211],v[216:219],v[160:163]
v_sub_f32 v235,v235,v211
v_fma_f32 v211,2.0,v213,v215
v_fmac_f32 v215,-2.0,v213
v_cvt_pk_bf16_f32 v205,v232,v205
M v[164:167],a[208:211],a[212:215],0
buffer_load_dwordx4 v[224:227],v250,s[20:23],s48 offen offset:0 sc1
v_cvt_pk_bf16_f32 v207,v237,v207
v_cvt_pk_bf16_f32 v209,v233,v209
v_cvt_pk_bf16_f32 v213,v234,v211
v_cvt_pk_bf16_f32 v211,v238,v235
M v[164:167],v[228:231],v[216:219],v[164:167]
v_cvt_pk_bf16_f32 v215,v236,v215
M v[164:167],v[220:223],a[236:239],v[164:167]
ds_write2st64_b64 v247,v[204:205],v[206:207] offset0:173 offset1:190
M v[168:171],v[220:223],v[216:219],0
s_add_u32 s28,s68,6684672
buffer_load_dwordx4 a[224:227],v250,s[20:23],s48 offen offset:1024 sc1
M v[168:171],v[228:231],a[212:215],v[168:171]
M v[168:171],a[208:211],a[244:247],v[168:171]
ds_write2st64_b64 v247,v[208:209],v[210:211] offset0:3 offset1:20
M v[172:175],a[208:211],a[252:255],0
buffer_load_dwordx4 a[236:239],v250,s[20:23],s48 offen offset:2048 sc1
M v[172:175],v[228:231],a[244:247],v[172:175]
s_add_u32 s46,s73,18432
M v[172:175],v[220:223],a[212:215],v[172:175]
ds_write2st64_b64 v247,v[212:213],v[214:215] offset0:139 offset1:156
M v[176:179],v[220:223],a[244:247],0
buffer_load_dwordx4 v[216:219],v250,s[20:23],s46 offen offset:0 sc1
M v[176:179],v[228:231],a[252:255],v[176:179]
v_add_u32 v248,0xffffbc00,v248
v_add_u32 v249,0xffffbc00,v249
M v[176:179],a[208:211],a[220:223],v[176:179]
s_waitcnt lgkmcnt(0)
s_barrier
M v[180:183],a[208:211],a[228:231],0
buffer_load_dwordx4 v[204:207],v251,s[88:91],s28 offen offset:0
M v[180:183],v[228:231],a[220:223],v[180:183]
ds_read_b128 a[212:215],v248 offset:0
M v[180:183],v[220:223],a[252:255],v[180:183]
ds_read_b128 a[244:247],v249 offset:0
M v[184:187],v[220:223],a[220:223],0
s_waitcnt vmcnt(17)
ds_read_b128 a[252:255],v248 offset:512
v_permlane32_swap_b32 v196,v198
M v[184:187],v[228:231],a[228:231],v[184:187]
buffer_load_dwordx4 v[208:211],v245,s[8:11],s28 offen offset:0
M v[184:187],a[208:211],a[204:207],v[184:187]
ds_read_b128 a[220:223],v249 offset:512
v_permlane32_swap_b32 v192,v194
M v[188:191],a[208:211],a[232:235],0
s_waitcnt vmcnt(17)
v_permlane32_swap_b32 v200,v202
v_lshlrev_b32 v234,16,v198
M v[188:191],v[228:231],a[204:207],v[188:191]
v_lshlrev_b32 v232,16,v192
v_lshlrev_b32 v233,16,v196
M v[188:191],v[220:223],a[228:231],v[188:191]
s_waitcnt lgkmcnt(3)
buffer_load_dwordx4 v[212:215],v245,s[8:11],s28 offen offset:768
M a[0:3],a[196:199],a[212:215],a[0:3]
s_waitcnt vmcnt(11) lgkmcnt(2)
ds_read_b128 a[208:211],v248 offset:1024
v_lshlrev_b32 v237,16,v194
M a[0:3],a[216:219],a[244:247],a[0:3]
s_waitcnt vmcnt(10) lgkmcnt(2)
ds_read_b128 a[232:235],v249 offset:1024
v_lshlrev_b32 v236,16,v202
M a[0:3],a[240:243],a[252:255],a[0:3]
s_waitcnt lgkmcnt(2)
v_lshlrev_b32 v235,16,v200
v_fmac_f32 v232,s43,v234
M a[4:7],a[240:243],a[220:223],a[4:7]
v_fmac_f32 v237,4.0,v233
v_fma_f32 v238,-4.0,v234,v236
M a[4:7],a[216:219],a[252:255],a[4:7]
v_fmac_f32 v232,s45,v236
v_fmac_f32 v237,s41,v235
M a[4:7],a[196:199],a[244:247],a[4:7]
v_sub_f32 v236,v236,v234
v_fma_f32 v234,-4.0,v233,v235
M a[8:11],a[196:199],a[252:255],a[8:11]
ds_read_b128 a[204:207],v248 offset:1536
v_sub_f32 v235,v235,v233
M a[8:11],a[216:219],a[220:223],a[8:11]
s_waitcnt lgkmcnt(2)
ds_read_b128 v[228:231],v249 offset:1536
v_add_f32 v233,v238,v234
M a[8:11],a[240:243],a[208:211],a[8:11]
s_waitcnt lgkmcnt(2)
v_sub_f32 v238,v238,v234
v_fma_f32 v234,2.0,v235,v236
M a[12:15],a[240:243],a[232:235],a[12:15]
v_fmac_f32 v236,-2.0,v235
v_and_b32 v198,s42,v198
M a[12:15],a[216:219],a[208:211],a[12:15]
v_and_b32 v192,s42,v192
v_and_b32 v196,s42,v196
M a[12:15],a[196:199],a[220:223],a[12:15]
v_and_b32 v194,s42,v194
v_and_b32 v202,s42,v202
M a[16:19],a[196:199],a[208:211],a[16:19]
ds_read_b128 a[228:231],v249 offset:2048
v_and_b32 v200,s42,v200
M a[16:19],a[216:219],a[232:235],a[16:19]
s_waitcnt lgkmcnt(2)
ds_read_b128 v[220:223],v248 offset:2048
v_fmac_f32 v192,s43,v198
M a[16:19],a[240:243],a[204:207],a[16:19]
s_waitcnt lgkmcnt(2)
v_fmac_f32 v194,4.0,v196
v_fma_f32 v235,-4.0,v198,v202
M a[20:23],a[240:243],v[228:231],a[20:23]
v_fmac_f32 v192,s45,v202
v_fmac_f32 v194,s41,v200
M a[20:23],a[216:219],a[204:207],a[20:23]
v_sub_f32 v202,v202,v198
v_fma_f32 v198,-4.0,v196,v200
M a[20:23],a[196:199],a[232:235],a[20:23]
v_sub_f32 v200,v200,v196
v_add_f32 v196,v235,v198
M a[24:27],a[196:199],a[204:207],a[24:27]
v_sub_f32 v235,v235,v198
v_fma_f32 v198,2.0,v200,v202
M a[24:27],a[216:219],v[228:231],a[24:27]
s_waitcnt lgkmcnt(1)
v_fmac_f32 v202,-2.0,v200
v_cvt_pk_bf16_f32 v192,v232,v192
M a[24:27],a[240:243],a[228:231],a[24:27]
s_waitcnt lgkmcnt(0)
v_cvt_pk_bf16_f32 v194,v237,v194
v_cvt_pk_bf16_f32 v196,v233,v196
M a[28:31],a[240:243],v[220:223],a[28:31]
buffer_load_dwordx4 a[240:243],v250,s[20:23],s46 offen offset:1024 sc1
M a[28:31],a[216:219],a[228:231],a[28:31]
v_cvt_pk_bf16_f32 v200,v234,v198
v_cvt_pk_bf16_f32 v198,v238,v235
M a[28:31],a[196:199],v[228:231],a[28:31]
s_waitcnt vmcnt(10)
buffer_load_dwordx4 a[216:219],v250,s[20:23],s46 offen offset:2048 sc1
M a[32:35],a[248:251],a[212:215],a[32:35]
s_waitcnt vmcnt(10)
s_add_u32 s47,s73,21504
v_cvt_pk_bf16_f32 v202,v236,v202
v_permlane32_swap_b32 v197,v199
M a[32:35],a[200:203],a[244:247],a[32:35]
s_waitcnt vmcnt(9)
v_permlane32_swap_b32 v193,v195
v_permlane32_swap_b32 v201,v203
M a[32:35],a[192:195],a[252:255],a[32:35]
v_lshlrev_b32 v234,16,v199
v_lshlrev_b32 v232,16,v193
M a[36:39],a[192:195],a[220:223],a[36:39]
buffer_load_dwordx4 a[196:199],v250,s[20:23],s47 offen offset:0 sc1
M a[36:39],a[200:203],a[252:255],a[36:39]
v_lshlrev_b32 v233,16,v197
v_lshlrev_b32 v237,16,v195
M a[36:39],a[248:251],a[244:247],a[36:39]
v_lshlrev_b32 v236,16,v203
v_lshlrev_b32 v235,16,v201
M a[40:43],a[248:251],a[252:255],a[40:43]
v_fmac_f32 v232,s43,v234
v_fmac_f32 v237,4.0,v233
M a[40:43],a[200:203],a[220:223],a[40:43]
v_fma_f32 v238,-4.0,v234,v236
v_fmac_f32 v232,s45,v236
M a[40:43],a[192:195],a[208:211],a[40:43]
v_fmac_f32 v237,s41,v235
v_sub_f32 v236,v236,v234
M a[44:47],a[192:195],a[232:235],a[44:47]
v_fma_f32 v234,-4.0,v233,v235
v_sub_f32 v235,v235,v233
M a[44:47],a[200:203],a[208:211],a[44:47]
v_add_f32 v233,v238,v234
v_sub_f32 v238,v238,v234
M a[44:47],a[248:251],a[220:223],a[44:47]
v_fma_f32 v234,2.0,v235,v236
v_fmac_f32 v236,-2.0,v235
M a[48:51],a[248:251],a[208:211],a[48:51]
v_and_b32 v199,s42,v199
v_and_b32 v193,s42,v193
M a[48:51],a[200:203],a[232:235],a[48:51]
v_and_b32 v197,s42,v197
v_and_b32 v195,s42,v195
M a[48:51],a[192:195],a[204:207],a[48:51]
v_and_b32 v203,s42,v203
v_and_b32 v201,s42,v201
M a[52:55],a[192:195],v[228:231],a[52:55]
v_fmac_f32 v193,s43,v199
v_fmac_f32 v195,4.0,v197
M a[52:55],a[200:203],a[204:207],a[52:55]
v_fma_f32 v235,-4.0,v199,v203
v_fmac_f32 v193,s45,v203
M a[52:55],a[248:251],a[232:235],a[52:55]
v_fmac_f32 v195,s41,v201
v_sub_f32 v203,v203,v199
M a[56:59],a[248:251],a[204:207],a[56:59]
v_fma_f32 v199,-4.0,v197,v201
v_sub_f32 v201,v201,v197
M a[56:59],a[200:203],v[228:231],a[56:59]
v_add_f32 v197,v235,v199
v_sub_f32 v235,v235,v199
M a[56:59],a[192:195],a[228:231],a[56:59]
v_fma_f32 v199,2.0,v201,v203
v_fmac_f32 v203,-2.0,v201
M a[60:63],a[192:195],v[220:223],a[60:63]
buffer_load_dwordx4 a[192:195],v250,s[20:23],s47 offen offset:1024 sc1
M a[60:63],a[200:203],a[228:231],a[60:63]
v_cvt_pk_bf16_f32 v193,v232,v193
v_cvt_pk_bf16_f32 v195,v237,v195
M a[60:63],a[248:251],v[228:231],a[60:63]
s_waitcnt vmcnt(10)
buffer_load_dwordx4 a[200:203],v250,s[20:23],s47 offen offset:2048 sc1
M a[64:67],v[224:227],a[212:215],a[64:67]
s_waitcnt vmcnt(10)
s_add_u32 s48,s73,24576
v_cvt_pk_bf16_f32 v197,v233,v197
v_cvt_pk_bf16_f32 v201,v234,v199
M a[64:67],a[224:227],a[244:247],a[64:67]
s_waitcnt vmcnt(9)
v_cvt_pk_bf16_f32 v199,v238,v235
v_cvt_pk_bf16_f32 v203,v236,v203
M a[64:67],a[236:239],a[252:255],a[64:67]
ds_write2st64_b64 v247,v[192:193],v[194:195] offset0:204 offset1:221
M a[68:71],a[236:239],a[220:223],a[68:71]
s_add_u32 s28,s68,7077888
buffer_load_dwordx4 a[248:251],v250,s[20:23],s48 offen offset:0 sc1
M a[68:71],a[224:227],a[252:255],a[68:71]
M a[68:71],v[224:227],a[244:247],a[68:71]
ds_write2st64_b64 v247,v[196:197],v[198:199] offset0:34 offset1:51
M a[72:75],v[224:227],a[252:255],a[72:75]
buffer_load_dwordx4 a[212:215],v250,s[20:23],s48 offen offset:1024 sc1
M a[72:75],a[224:227],a[220:223],a[72:75]
M a[72:75],a[236:239],a[208:211],a[72:75]
ds_write2st64_b64 v247,v[200:201],v[202:203] offset0:68 offset1:85
M a[76:79],a[236:239],a[232:235],a[76:79]
buffer_load_dwordx4 a[244:247],v250,s[20:23],s48 offen offset:2048 sc1
M a[76:79],a[224:227],a[208:211],a[76:79]
s_add_u32 s46,s73,27648
M a[76:79],v[224:227],a[220:223],a[76:79]
M a[80:83],v[224:227],a[208:211],a[80:83]
M a[80:83],a[224:227],a[232:235],a[80:83]
buffer_load_dwordx4 a[252:255],v250,s[20:23],s46 offen offset:0 sc1
M a[80:83],a[236:239],a[204:207],a[80:83]
M a[84:87],a[236:239],v[228:231],a[84:87]
M a[84:87],a[224:227],a[204:207],a[84:87]
s_waitcnt vmcnt(10)
ds_read_b128 a[220:223],v248 offset:8704
v_permlane32_swap_b32 v208,v210
M a[84:87],v[224:227],a[232:235],a[84:87]
buffer_load_dwordx4 v[192:195],v251,s[88:91],s28 offen offset:0
M a[88:91],v[224:227],a[204:207],a[88:91]
ds_read_b128 a[208:211],v249 offset:8704
ds_read_b128 a[232:235],v248 offset:9216
M a[88:91],a[224:227],v[228:231],a[88:91]
ds_read_b128 a[204:207],v249 offset:9216
v_permlane32_swap_b32 v204,v206
M a[88:91],a[236:239],a[228:231],a[88:91]
s_waitcnt vmcnt(10)
v_permlane32_swap_b32 v212,v214
v_lshlrev_b32 v234,16,v210
M a[92:95],a[236:239],v[220:223],a[92:95]
buffer_load_dwordx4 v[196:199],v245,s[8:11],s28 offen offset:0
M a[92:95],a[224:227],a[228:231],a[92:95]
v_lshlrev_b32 v232,16,v204
v_lshlrev_b32 v233,16,v208
M a[92:95],v[224:227],v[228:231],a[92:95]
s_waitcnt lgkmcnt(3)
v_lshlrev_b32 v237,16,v206
v_lshlrev_b32 v236,16,v214
M a[96:99],v[216:219],a[220:223],a[96:99]
s_waitcnt vmcnt(10) lgkmcnt(2)
ds_read_b128 a[236:239],v248 offset:9728
v_lshlrev_b32 v235,16,v212
M a[96:99],a[240:243],a[208:211],a[96:99]
s_waitcnt vmcnt(9) lgkmcnt(2)
buffer_load_dwordx4 v[200:203],v245,s[8:11],s28 offen offset:768
M a[96:99],a[216:219],a[232:235],a[96:99]
s_waitcnt lgkmcnt(1)
ds_read_b128 v[220:223],v249 offset:9728
v_fmac_f32 v232,s43,v234
M a[100:103],a[216:219],a[204:207],a[100:103]
v_fmac_f32 v237,4.0,v233
v_fma_f32 v238,-4.0,v234,v236
M a[100:103],a[240:243],a[232:235],a[100:103]
v_fmac_f32 v232,s45,v236
v_fmac_f32 v237,s41,v235
M a[100:103],v[216:219],a[208:211],a[100:103]
v_sub_f32 v236,v236,v234
v_fma_f32 v234,-4.0,v233,v235
M a[104:107],v[216:219],a[232:235],a[104:107]
ds_read_b128 a[224:227],v248 offset:10240
v_sub_f32 v235,v235,v233
M a[104:107],a[240:243],a[204:207],a[104:107]
s_waitcnt lgkmcnt(2)
ds_read_b128 a[228:231],v249 offset:10240
v_add_f32 v233,v238,v234
M a[104:107],a[216:219],a[236:239],a[104:107]
s_waitcnt lgkmcnt(2)
v_sub_f32 v238,v238,v234
v_fma_f32 v234,2.0,v235,v236
M a[108:111],a[216:219],v[220:223],a[108:111]
v_fmac_f32 v236,-2.0,v235
v_and_b32 v210,s42,v210
M a[108:111],a[240:243],a[236:239],a[108:111]
v_and_b32 v204,s42,v204
v_and_b32 v208,s42,v208
M a[108:111],v[216:219],a[204:207],a[108:111]
v_and_b32 v206,s42,v206
v_and_b32 v214,s42,v214
M a[112:115],v[216:219],a[236:239],a[112:115]
ds_read_b128 v[224:227],v249 offset:10752
v_and_b32 v212,s42,v212
M a[112:115],a[240:243],v[220:223],a[112:115]
s_waitcnt lgkmcnt(2)
ds_read_b128 v[228:231],v248 offset:10752
v_fmac_f32 v204,s43,v210
M a[112:115],a[216:219],a[224:227],a[112:115]
s_waitcnt lgkmcnt(2)
v_fmac_f32 v206,4.0,v208
v_fma_f32 v235,-4.0,v210,v214
M a[116:119],a[216:219],a[228:231],a[116:119]
v_fmac_f32 v204,s45,v214
v_fmac_f32 v206,s41,v212
M a[116:119],a[240:243],a[224:227],a[116:119]
v_sub_f32 v214,v214,v210
v_fma_f32 v210,-4.0,v208,v212
M a[116:119],v[216:219],v[220:223],a[116:119]
v_sub_f32 v212,v212,v208
v_add_f32 v208,v235,v210
M a[120:123],v[216:219],a[224:227],a[120:123]
v_sub_f32 v235,v235,v210
v_fma_f32 v210,2.0,v212,v214
M a[120:123],a[240:243],a[228:231],a[120:123]
s_waitcnt lgkmcnt(1)
v_fmac_f32 v214,-2.0,v212
v_cvt_pk_bf16_f32 v204,v232,v204
M a[120:123],a[216:219],v[224:227],a[120:123]
s_waitcnt lgkmcnt(0)
v_cvt_pk_bf16_f32 v206,v237,v206
v_cvt_pk_bf16_f32 v208,v233,v208
M a[124:127],a[216:219],v[228:231],a[124:127]
buffer_load_dwordx4 a[216:219],v250,s[20:23],s46 offen offset:1024 sc1
M a[124:127],a[240:243],v[224:227],a[124:127]
v_cvt_pk_bf16_f32 v212,v234,v210
v_cvt_pk_bf16_f32 v210,v238,v235
M a[124:127],v[216:219],a[228:231],a[124:127]
s_waitcnt vmcnt(10)
buffer_load_dwordx4 a[240:243],v250,s[20:23],s46 offen offset:2048 sc1
M a[128:131],a[196:199],a[220:223],a[128:131]
s_waitcnt vmcnt(10)
s_add_u32 s47,s73,30720
v_cvt_pk_bf16_f32 v214,v236,v214
v_permlane32_swap_b32 v209,v211
M a[128:131],a[192:195],a[208:211],a[128:131]
s_waitcnt vmcnt(9)
v_permlane32_swap_b32 v205,v207
v_permlane32_swap_b32 v213,v215
M a[128:131],a[200:203],a[232:235],a[128:131]
v_lshlrev_b32 v234,16,v211
v_lshlrev_b32 v232,16,v205
M a[132:135],a[200:203],a[204:207],a[132:135]
buffer_load_dwordx4 v[216:219],v250,s[20:23],s47 offen offset:0 sc1
M a[132:135],a[192:195],a[232:235],a[132:135]
v_lshlrev_b32 v233,16,v209
v_lshlrev_b32 v237,16,v207
M a[132:135],a[196:199],a[208:211],a[132:135]
v_lshlrev_b32 v236,16,v215
v_lshlrev_b32 v235,16,v213
M a[136:139],a[196:199],a[232:235],a[136:139]
v_fmac_f32 v232,s43,v234
v_fmac_f32 v237,4.0,v233
M a[136:139],a[192:195],a[204:207],a[136:139]
v_fma_f32 v238,-4.0,v234,v236
v_fmac_f32 v232,s45,v236
M a[136:139],a[200:203],a[236:239],a[136:139]
v_fmac_f32 v237,s41,v235
v_sub_f32 v236,v236,v234
M a[140:143],a[200:203],v[220:223],a[140:143]
v_fma_f32 v234,-4.0,v233,v235
v_sub_f32 v235,v235,v233
M a[140:143],a[192:195],a[236:239],a[140:143]
v_add_f32 v233,v238,v234
v_sub_f32 v238,v238,v234
M a[140:143],a[196:199],a[204:207],a[140:143]
v_fma_f32 v234,2.0,v235,v236
v_fmac_f32 v236,-2.0,v235
M a[144:147],a[196:199],a[236:239],a[144:147]
v_and_b32 v211,s42,v211
v_and_b32 v205,s42,v205
M a[144:147],a[192:195],v[220:223],a[144:147]
v_and_b32 v209,s42,v209
v_and_b32 v207,s42,v207
M a[144:147],a[200:203],a[224:227],a[144:147]
v_and_b32 v215,s42,v215
v_and_b32 v213,s42,v213
M a[148:151],a[200:203],a[228:231],a[148:151]
v_fmac_f32 v205,s43,v211
v_fmac_f32 v207,4.0,v209
M a[148:151],a[192:195],a[224:227],a[148:151]
v_fma_f32 v235,-4.0,v211,v215
v_fmac_f32 v205,s45,v215
M a[148:151],a[196:199],v[220:223],a[148:151]
v_fmac_f32 v207,s41,v213
v_sub_f32 v215,v215,v211
M a[152:155],a[196:199],a[224:227],a[152:155]
v_fma_f32 v211,-4.0,v209,v213
v_sub_f32 v213,v213,v209
M a[152:155],a[192:195],a[228:231],a[152:155]
v_add_f32 v209,v235,v211
v_sub_f32 v235,v235,v211
M a[152:155],a[200:203],v[224:227],a[152:155]
v_fma_f32 v211,2.0,v213,v215
v_fmac_f32 v215,-2.0,v213
M a[156:159],a[200:203],v[228:231],a[156:159]
buffer_load_dwordx4 a[200:203],v250,s[20:23],s47 offen offset:1024 sc1
M a[156:159],a[192:195],v[224:227],a[156:159]
v_cvt_pk_bf16_f32 v205,v232,v205
v_cvt_pk_bf16_f32 v207,v237,v207
M a[156:159],a[196:199],a[228:231],a[156:159]
s_waitcnt vmcnt(10)
buffer_load_dwordx4 a[192:195],v250,s[20:23],s47 offen offset:2048 sc1
M a[160:163],a[248:251],a[220:223],a[160:163]
s_waitcnt vmcnt(10)
s_add_u32 s48,s73,33792
v_cvt_pk_bf16_f32 v209,v233,v209
v_cvt_pk_bf16_f32 v213,v234,v211
M a[160:163],a[212:215],a[208:211],a[160:163]
s_waitcnt vmcnt(9)
v_cvt_pk_bf16_f32 v211,v238,v235
v_cvt_pk_bf16_f32 v215,v236,v215
M a[160:163],a[244:247],a[232:235],a[160:163]
ds_write2st64_b64 v247,v[204:205],v[206:207] offset0:205 offset1:222
M a[164:167],a[244:247],a[204:207],a[164:167]
s_add_u32 s28,s68,7471104
buffer_load_dwordx4 a[196:199],v250,s[20:23],s48 offen offset:0 sc1
M a[164:167],a[212:215],a[232:235],a[164:167]
v_fmac_f32 v239,s43,v241
v_fmac_f32 v244,4.0,v240
M a[164:167],a[248:251],a[208:211],a[164:167]
ds_write2st64_b64 v247,v[208:209],v[210:211] offset0:35 offset1:52
M a[168:171],a[248:251],a[232:235],a[168:171]
buffer_load_dwordx4 a[220:223],v250,s[20:23],s48 offen offset:1024 sc1
M a[168:171],a[212:215],a[204:207],a[168:171]
v_fma_f32 v232,-4.0,v241,v243
v_fmac_f32 v239,s45,v243
M a[168:171],a[244:247],a[236:239],a[168:171]
ds_write2st64_b64 v247,v[212:213],v[214:215] offset0:69 offset1:86
M a[172:175],a[244:247],v[220:223],a[172:175]
buffer_load_dwordx4 a[208:211],v250,s[20:23],s48 offen offset:2048 sc1
M a[172:175],a[212:215],a[236:239],a[172:175]
s_add_u32 s46,s73,36864
v_fmac_f32 v244,s41,v242
v_sub_f32 v243,v243,v241
M a[172:175],a[248:251],a[204:207],a[172:175]
v_fma_f32 v241,-4.0,v240,v242
v_sub_f32 v242,v242,v240
M a[176:179],a[248:251],a[236:239],a[176:179]
v_add_f32 v240,v232,v241
v_sub_f32 v232,v232,v241
M a[176:179],a[212:215],v[220:223],a[176:179]
buffer_load_dwordx4 a[232:235],v250,s[20:23],s46 offen offset:0 sc1
M a[176:179],a[244:247],a[224:227],a[176:179]
v_add_u32 v248,0x4400,v248
v_add_u32 v249,0x4400,v249
M a[180:183],a[244:247],a[228:231],a[180:183]
v_fma_f32 v241,2.0,v242,v243
v_fmac_f32 v243,-2.0,v242
M a[180:183],a[212:215],a[224:227],a[180:183]
ds_read_b128 a[204:207],v248 offset:52224
v_cvt_pk_bf16_f32 v233,v239,v244
M a[180:183],a[248:251],v[220:223],a[180:183]
buffer_load_dwordx4 v[204:207],v251,s[88:91],s28 offen offset:0
M a[184:187],a[248:251],a[224:227],a[184:187]
ds_read_b128 a[236:239],v249 offset:52224
ds_read_b128 v[220:223],v248 offset:52736
M a[184:187],a[212:215],a[228:231],a[184:187]
ds_read_b128 a[224:227],v249 offset:52736
v_cvt_pk_bf16_f32 v234,v240,v232
M a[184:187],a[244:247],v[224:227],a[184:187]
v_cvt_pk_bf16_f32 v235,v241,v243
v_add_u32 v232,104448,v252
M a[188:191],a[244:247],v[228:231],a[188:191]
buffer_load_dwordx4 v[208:211],v245,s[8:11],s28 offen offset:0
M a[188:191],a[212:215],v[224:227],a[188:191]
ds_write_b16 v232,v233 offset:0
M a[188:191],a[248:251],a[228:231],a[188:191]
s_waitcnt vmcnt(14) lgkmcnt(4)
ds_write_b16_d16_hi v232,v233 offset:8704
M v[0:3],a[252:255],a[204:207],v[0:3]
s_waitcnt vmcnt(10) lgkmcnt(4)
ds_read_b128 a[244:247],v248 offset:53248
ds_write_b16 v252,v234 offset:17408
M v[0:3],a[216:219],a[236:239],v[0:3]
s_waitcnt vmcnt(9) lgkmcnt(5)
buffer_load_dwordx4 v[212:215],v245,s[8:11],s28 offen offset:768
M v[0:3],a[240:243],v[220:223],v[0:3]
s_waitcnt lgkmcnt(4)
s_add_u32 s29,s69,6291456
ds_read_b128 v[228:231],v249 offset:53248
ds_write_b16_d16_hi v252,v234 offset:26112
M v[4:7],a[240:243],a[224:227],v[4:7]
ds_write_b16 v252,v235 offset:34816
M v[4:7],a[216:219],v[220:223],v[4:7]
ds_write_b16_d16_hi v252,v235 offset:43520
M v[4:7],a[252:255],a[236:239],v[4:7]
buffer_load_short_d16_hi v239,v246,s[12:15],s29 offen offset:0
M v[8:11],a[252:255],v[220:223],v[8:11]
ds_read_b128 a[212:215],v248 offset:53760
v_permlane32_swap_b32 v196,v198
M v[8:11],a[216:219],a[224:227],v[8:11]
s_waitcnt lgkmcnt(6)
buffer_load_short_d16_hi v240,v246,s[8:11],s29 offen offset:0
M v[8:11],a[240:243],a[244:247],v[8:11]
s_waitcnt lgkmcnt(4)
ds_read_b128 v[224:227],v249 offset:53760
v_permlane32_swap_b32 v192,v194
M v[12:15],a[240:243],v[228:231],v[12:15]
buffer_load_short_d16_hi v241,v246,s[8:11],s29 offen offset:384
M v[12:15],a[216:219],a[244:247],v[12:15]
v_permlane32_swap_b32 v200,v202
v_lshlrev_b32 v234,16,v198
M v[12:15],a[252:255],a[224:227],v[12:15]
buffer_load_short_d16_hi v242,v246,s[8:11],s29 offen offset:768
M v[16:19],a[252:255],a[244:247],v[16:19]
ds_read_b128 a[228:231],v249 offset:54272
v_lshlrev_b32 v232,16,v192
M v[16:19],a[216:219],v[228:231],v[16:19]
s_waitcnt lgkmcnt(2)
buffer_load_short_d16_hi v243,v246,s[8:11],s29 offen offset:1152
M v[16:19],a[240:243],a[212:215],v[16:19]
s_waitcnt lgkmcnt(1)
ds_read_b128 a[248:251],v248 offset:54272
v_lshlrev_b32 v233,16,v196
M v[20:23],a[240:243],v[224:227],v[20:23]
buffer_load_short_d16_hi v244,v246,s[16:19],s29 offen offset:1536
M v[20:23],a[216:219],a[212:215],v[20:23]
v_lshlrev_b32 v237,16,v194
v_lshlrev_b32 v236,16,v202
M v[20:23],a[252:255],v[228:231],v[20:23]
v_lshlrev_b32 v235,16,v200
v_fmac_f32 v232,s43,v234
M v[24:27],a[252:255],a[212:215],v[24:27]
v_fmac_f32 v237,4.0,v233
v_fma_f32 v238,-4.0,v234,v236
M v[24:27],a[216:219],v[224:227],v[24:27]
s_waitcnt lgkmcnt(1)
v_fmac_f32 v232,s45,v236
v_fmac_f32 v237,s41,v235
M v[24:27],a[240:243],a[228:231],v[24:27]
s_waitcnt lgkmcnt(0)
v_sub_f32 v236,v236,v234
v_fma_f32 v234,-4.0,v233,v235
M v[28:31],a[240:243],a[248:251],v[28:31]
buffer_load_dwordx4 a[240:243],v250,s[20:23],s46 offen offset:1024 sc1
M v[28:31],a[216:219],a[228:231],v[28:31]
v_sub_f32 v235,v235,v233
v_add_f32 v233,v238,v234
M v[28:31],a[252:255],v[224:227],v[28:31]
s_waitcnt vmcnt(16)
buffer_load_dwordx4 a[216:219],v250,s[20:23],s46 offen offset:2048 sc1
M v[32:35],v[216:219],a[204:207],v[32:35]
s_waitcnt vmcnt(16)
s_add_u32 s47,s73,39936
v_sub_f32 v238,v238,v234
v_fma_f32 v234,2.0,v235,v236
M v[32:35],a[200:203],a[236:239],v[32:35]
s_waitcnt vmcnt(15)
v_fmac_f32 v236,-2.0,v235
v_and_b32 v198,s42,v198
M v[32:35],a[192:195],v[220:223],v[32:35]
v_and_b32 v192,s42,v192
v_and_b32 v196,s42,v196
M v[36:39],a[192:195],a[224:227],v[36:39]
buffer_load_dwordx4 a[252:255],v250,s[20:23],s47 offen offset:0 sc1
M v[36:39],a[200:203],v[220:223],v[36:39]
v_and_b32 v194,s42,v194
v_and_b32 v202,s42,v202
M v[36:39],v[216:219],a[236:239],v[36:39]
v_and_b32 v200,s42,v200
v_fmac_f32 v192,s43,v198
M v[40:43],v[216:219],v[220:223],v[40:43]
v_fmac_f32 v194,4.0,v196
v_fma_f32 v235,-4.0,v198,v202
M v[40:43],a[200:203],a[224:227],v[40:43]
v_fmac_f32 v192,s45,v202
v_fmac_f32 v194,s41,v200
M v[40:43],a[192:195],a[244:247],v[40:43]
v_sub_f32 v202,v202,v198
v_fma_f32 v198,-4.0,v196,v200
M v[44:47],a[192:195],v[228:231],v[44:47]
v_sub_f32 v200,v200,v196
v_add_f32 v196,v235,v198
M v[44:47],a[200:203],a[244:247],v[44:47]
v_sub_f32 v235,v235,v198
v_fma_f32 v198,2.0,v200,v202
M v[44:47],v[216:219],a[224:227],v[44:47]
v_fmac_f32 v202,-2.0,v200
v_cvt_pk_bf16_f32 v192,v232,v192
M v[48:51],v[216:219],a[244:247],v[48:51]
v_cvt_pk_bf16_f32 v194,v237,v194
v_cvt_pk_bf16_f32 v196,v233,v196
M v[48:51],a[200:203],v[228:231],v[48:51]
v_cvt_pk_bf16_f32 v200,v234,v198
v_cvt_pk_bf16_f32 v198,v238,v235
M v[48:51],a[192:195],a[212:215],v[48:51]
v_cvt_pk_bf16_f32 v202,v236,v202
v_permlane32_swap_b32 v197,v199
M v[52:55],a[192:195],v[224:227],v[52:55]
v_permlane32_swap_b32 v193,v195
v_permlane32_swap_b32 v201,v203
M v[52:55],a[200:203],a[212:215],v[52:55]
v_lshlrev_b32 v234,16,v199
v_lshlrev_b32 v232,16,v193
M v[52:55],v[216:219],v[228:231],v[52:55]
v_lshlrev_b32 v233,16,v197
v_lshlrev_b32 v237,16,v195
M v[56:59],v[216:219],a[212:215],v[56:59]
v_lshlrev_b32 v236,16,v203
v_lshlrev_b32 v235,16,v201
M v[56:59],a[200:203],v[224:227],v[56:59]
v_fmac_f32 v232,s43,v234
v_fmac_f32 v237,4.0,v233
M v[56:59],a[192:195],a[228:231],v[56:59]
v_fma_f32 v238,-4.0,v234,v236
v_fmac_f32 v232,s45,v236
M v[60:63],a[192:195],a[248:251],v[60:63]
buffer_load_dwordx4 a[192:195],v250,s[20:23],s47 offen offset:1024 sc1
M v[60:63],a[200:203],a[228:231],v[60:63]
v_fmac_f32 v237,s41,v235
v_sub_f32 v236,v236,v234
M v[60:63],v[216:219],v[224:227],v[60:63]
s_waitcnt vmcnt(16)
buffer_load_dwordx4 a[200:203],v250,s[20:23],s47 offen offset:2048 sc1
M v[64:67],a[196:199],a[204:207],v[64:67]
s_waitcnt vmcnt(16)
s_add_u32 s48,s73,43008
v_fma_f32 v234,-4.0,v233,v235
v_sub_f32 v235,v235,v233
M v[64:67],a[220:223],a[236:239],v[64:67]
s_waitcnt vmcnt(15)
v_add_f32 v233,v238,v234
v_sub_f32 v238,v238,v234
M v[64:67],a[208:211],v[220:223],v[64:67]
v_fma_f32 v234,2.0,v235,v236
v_fmac_f32 v236,-2.0,v235
M v[68:71],a[208:211],a[224:227],v[68:71]
buffer_load_dwordx4 v[216:219],v250,s[20:23],s48 offen offset:0 sc1
M v[68:71],a[220:223],v[220:223],v[68:71]
v_and_b32 v199,s42,v199
v_and_b32 v193,s42,v193
M v[68:71],a[196:199],a[236:239],v[68:71]
v_and_b32 v197,s42,v197
v_and_b32 v195,s42,v195
M v[72:75],a[196:199],v[220:223],v[72:75]
v_and_b32 v203,s42,v203
v_and_b32 v201,s42,v201
M v[72:75],a[220:223],a[224:227],v[72:75]
buffer_load_dwordx4 a[204:207],v250,s[20:23],s48 offen offset:1024 sc1
M v[72:75],a[208:211],a[244:247],v[72:75]
v_fmac_f32 v193,s43,v199
v_fmac_f32 v195,4.0,v197
M v[76:79],a[208:211],v[228:231],v[76:79]
v_fma_f32 v235,-4.0,v199,v203
v_fmac_f32 v193,s45,v203
M v[76:79],a[220:223],a[244:247],v[76:79]
v_fmac_f32 v195,s41,v201
v_sub_f32 v203,v203,v199
M v[76:79],a[196:199],a[224:227],v[76:79]
buffer_load_dwordx4 a[236:239],v250,s[20:23],s48 offen offset:2048 sc1
M v[80:83],a[196:199],a[244:247],v[80:83]
s_add_u32 s46,s74,9216
v_fma_f32 v199,-4.0,v197,v201
v_sub_f32 v201,v201,v197
M v[80:83],a[220:223],v[228:231],v[80:83]
v_add_f32 v197,v235,v199
v_sub_f32 v235,v235,v199
M v[80:83],a[208:211],a[212:215],v[80:83]
v_fma_f32 v199,2.0,v201,v203
v_fmac_f32 v203,-2.0,v201
M v[84:87],a[208:211],v[224:227],v[84:87]
buffer_load_dwordx4 v[220:223],v250,s[20:23],s46 offen offset:0 sc1
M v[84:87],a[220:223],a[212:215],v[84:87]
ds_read_b128 a[224:227],v248 offset:60928
v_cvt_pk_bf16_f32 v193,v232,v193
M v[84:87],a[196:199],v[228:231],v[84:87]
ds_read_b128 a[244:247],v249 offset:60928
v_cvt_pk_bf16_f32 v195,v237,v195
M v[88:91],a[196:199],a[212:215],v[88:91]
ds_read_b128 v[228:231],v248 offset:61440
v_cvt_pk_bf16_f32 v197,v233,v197
M v[88:91],a[220:223],v[224:227],v[88:91]
ds_read_b128 a[212:215],v249 offset:61440
v_cvt_pk_bf16_f32 v201,v234,v199
M v[88:91],a[208:211],a[228:231],v[88:91]
v_cvt_pk_bf16_f32 v199,v238,v235
v_cvt_pk_bf16_f32 v203,v236,v203
M v[92:95],a[208:211],a[248:251],v[92:95]
s_waitcnt vmcnt(16)
v_permlane32_swap_b32 v208,v210
v_permlane32_swap_b32 v204,v206
M v[92:95],a[220:223],a[228:231],v[92:95]
s_waitcnt vmcnt(15)
v_permlane32_swap_b32 v212,v214
v_lshlrev_b32 v234,16,v210
M v[92:95],a[196:199],v[224:227],v[92:95]
s_waitcnt lgkmcnt(3)
ds_write2st64_b64 v247,v[192:193],v[194:195] offset0:206 offset1:223
M v[96:99],a[232:235],a[224:227],v[96:99]
s_waitcnt vmcnt(8) lgkmcnt(3)
s_add_u32 s28,s69,6291456
buffer_load_dwordx4 v[192:195],v251,s[88:91],s28 offen offset:0
M v[96:99],a[240:243],a[244:247],v[96:99]
s_waitcnt vmcnt(8) lgkmcnt(2)
ds_read_b128 a[208:211],v248 offset:61952
ds_read_b128 a[248:251],v249 offset:61952
M v[96:99],a[216:219],v[228:231],v[96:99]
s_waitcnt lgkmcnt(3)
ds_write2st64_b64 v247,v[196:197],v[198:199] offset0:36 offset1:53
M v[100:103],a[216:219],a[212:215],v[100:103]
buffer_load_dwordx4 v[196:199],v245,s[8:11],s28 offen offset:0
M v[100:103],a[240:243],v[228:231],v[100:103]
v_lshlrev_b32 v232,16,v204
v_lshlrev_b32 v233,16,v208
M v[100:103],a[232:235],a[244:247],v[100:103]
ds_write2st64_b64 v247,v[200:201],v[202:203] offset0:70 offset1:87
M v[104:107],a[232:235],v[228:231],v[104:107]
buffer_load_dwordx4 v[200:203],v245,s[8:11],s28 offen offset:768
M v[104:107],a[240:243],a[212:215],v[104:107]
s_waitcnt lgkmcnt(3)
ds_read_b128 a[220:223],v248 offset:62464
ds_read_b128 a[228:231],v249 offset:62464
M v[104:107],a[216:219],a[208:211],v[104:107]
s_waitcnt lgkmcnt(4)
v_lshlrev_b32 v237,16,v206
v_lshlrev_b32 v236,16,v214
M v[108:111],a[216:219],a[248:251],v[108:111]
v_lshlrev_b32 v235,16,v212
v_fmac_f32 v232,s43,v234
M v[108:111],a[240:243],a[208:211],v[108:111]
v_fmac_f32 v237,4.0,v233
v_fma_f32 v238,-4.0,v234,v236
M v[108:111],a[232:235],a[212:215],v[108:111]
v_fmac_f32 v232,s45,v236
v_fmac_f32 v237,s41,v235
M v[112:115],a[232:235],a[208:211],v[112:115]
ds_read_b128 a[196:199],v249 offset:62976
v_sub_f32 v236,v236,v234
M v[112:115],a[240:243],a[248:251],v[112:115]
s_waitcnt lgkmcnt(2)
ds_read_b128 v[224:227],v248 offset:62976
v_fma_f32 v234,-4.0,v233,v235
M v[112:115],a[216:219],a[220:223],v[112:115]
s_waitcnt lgkmcnt(2)
v_sub_f32 v235,v235,v233
v_add_f32 v233,v238,v234
M v[116:119],a[216:219],a[228:231],v[116:119]
v_sub_f32 v238,v238,v234
v_fma_f32 v234,2.0,v235,v236
M v[116:119],a[240:243],a[220:223],v[116:119]
v_fmac_f32 v236,-2.0,v235
v_and_b32 v210,s42,v210
M v[116:119],a[232:235],a[248:251],v[116:119]
v_and_b32 v204,s42,v204
v_and_b32 v208,s42,v208
M v[120:123],a[232:235],a[220:223],v[120:123]
v_and_b32 v206,s42,v206
v_and_b32 v214,s42,v214
M v[120:123],a[240:243],a[228:231],v[120:123]
s_waitcnt lgkmcnt(1)
v_and_b32 v212,s42,v212
v_fmac_f32 v204,s43,v210
M v[120:123],a[216:219],a[196:199],v[120:123]
s_waitcnt lgkmcnt(0)
v_fmac_f32 v206,4.0,v208
v_fma_f32 v235,-4.0,v210,v214
M v[124:127],a[216:219],v[224:227],v[124:127]
buffer_load_dwordx4 a[216:219],v250,s[20:23],s46 offen offset:1024 sc1
M v[124:127],a[240:243],a[196:199],v[124:127]
v_fmac_f32 v204,s45,v214
v_fmac_f32 v206,s41,v212
M v[124:127],a[232:235],a[228:231],v[124:127]
s_waitcnt vmcnt(10)
buffer_load_dwordx4 a[240:243],v250,s[20:23],s46 offen offset:2048 sc1
M v[128:131],a[252:255],a[224:227],v[128:131]
s_waitcnt vmcnt(10)
s_add_u32 s47,s74,12288
v_sub_f32 v214,v214,v210
v_fma_f32 v210,-4.0,v208,v212
M v[128:131],a[192:195],a[244:247],v[128:131]
s_waitcnt vmcnt(9)
v_sub_f32 v212,v212,v208
v_add_f32 v208,v235,v210
M v[128:131],a[200:203],v[228:231],v[128:131]
v_sub_f32 v235,v235,v210
v_fma_f32 v210,2.0,v212,v214
M v[132:135],a[200:203],a[212:215],v[132:135]
buffer_load_dwordx4 a[232:235],v250,s[20:23],s47 offen offset:0 sc1
M v[132:135],a[192:195],v[228:231],v[132:135]
v_fmac_f32 v214,-2.0,v212
v_cvt_pk_bf16_f32 v204,v232,v204
M v[132:135],a[252:255],a[244:247],v[132:135]
v_cvt_pk_bf16_f32 v206,v237,v206
v_cvt_pk_bf16_f32 v208,v233,v208
M v[136:139],a[252:255],v[228:231],v[136:139]
v_cvt_pk_bf16_f32 v212,v234,v210
v_cvt_pk_bf16_f32 v210,v238,v235
M v[136:139],a[192:195],a[212:215],v[136:139]
v_cvt_pk_bf16_f32 v214,v236,v214
v_permlane32_swap_b32 v209,v211
M v[136:139],a[200:203],a[208:211],v[136:139]
v_permlane32_swap_b32 v205,v207
v_permlane32_swap_b32 v213,v215
M v[140:143],a[200:203],a[248:251],v[140:143]
v_lshlrev_b32 v234,16,v211
v_lshlrev_b32 v232,16,v205
M v[140:143],a[192:195],a[208:211],v[140:143]
v_lshlrev_b32 v233,16,v209
v_lshlrev_b32 v237,16,v207
M v[140:143],a[252:255],a[212:215],v[140:143]
v_lshlrev_b32 v236,16,v215
v_lshlrev_b32 v235,16,v213
M v[144:147],a[252:255],a[208:211],v[144:147]
v_fmac_f32 v232,s43,v234
v_fmac_f32 v237,4.0,v233
M v[144:147],a[192:195],a[248:251],v[144:147]
v_fma_f32 v238,-4.0,v234,v236
v_fmac_f32 v232,s45,v236
M v[144:147],a[200:203],a[220:223],v[144:147]
v_fmac_f32 v237,s41,v235
v_sub_f32 v236,v236,v234
M v[148:151],a[200:203],a[228:231],v[148:151]
v_fma_f32 v234,-4.0,v233,v235
v_sub_f32 v235,v235,v233
M v[148:151],a[192:195],a[220:223],v[148:151]
v_add_f32 v233,v238,v234
v_sub_f32 v238,v238,v234
M v[148:151],a[252:255],a[248:251],v[148:151]
v_fma_f32 v234,2.0,v235,v236
v_fmac_f32 v236,-2.0,v235
M v[152:155],a[252:255],a[220:223],v[152:155]
v_and_b32 v211,s42,v211
v_and_b32 v205,s42,v205
M v[152:155],a[192:195],a[228:231],v[152:155]
v_and_b32 v209,s42,v209
v_and_b32 v207,s42,v207
M v[152:155],a[200:203],a[196:199],v[152:155]
v_and_b32 v215,s42,v215
v_and_b32 v213,s42,v213
M v[156:159],a[200:203],v[224:227],v[156:159]
buffer_load_dwordx4 a[200:203],v250,s[20:23],s47 offen offset:1024 sc1
M v[156:159],a[192:195],a[196:199],v[156:159]
v_fmac_f32 v205,s43,v211
v_fmac_f32 v207,4.0,v209
M v[156:159],a[252:255],a[228:231],v[156:159]
s_waitcnt vmcnt(10)
buffer_load_dwordx4 a[192:195],v250,s[20:23],s47 offen offset:2048 sc1
M v[160:163],v[216:219],a[224:227],v[160:163]
s_waitcnt vmcnt(10)
s_add_u32 s48,s74,15360
v_fma_f32 v235,-4.0,v211,v215
v_fmac_f32 v205,s45,v215
v_fmac_f32 v207,s41,v213
M v[160:163],a[204:207],a[244:247],v[160:163]
s_waitcnt vmcnt(9)
v_sub_f32 v215,v215,v211
v_fma_f32 v211,-4.0,v209,v213
v_sub_f32 v213,v213,v209
v_add_f32 v209,v235,v211
M v[160:163],a[236:239],v[228:231],v[160:163]
v_sub_f32 v235,v235,v211
v_fma_f32 v211,2.0,v213,v215
v_fmac_f32 v215,-2.0,v213
v_cvt_pk_bf16_f32 v205,v232,v205
M v[164:167],a[236:239],a[212:215],v[164:167]
buffer_load_dwordx4 a[252:255],v250,s[20:23],s48 offen offset:0 sc1
v_cvt_pk_bf16_f32 v207,v237,v207
v_cvt_pk_bf16_f32 v209,v233,v209
v_cvt_pk_bf16_f32 v213,v234,v211
v_cvt_pk_bf16_f32 v211,v238,v235
M v[164:167],a[204:207],v[228:231],v[164:167]
s_waitcnt vmcnt(7)
v_cvt_pk_bf16_f32 v215,v236,v215
v_permlane32_swap_b32 v196,v198
M v[164:167],v[216:219],a[244:247],v[164:167]
buffer_load_dwordx4 a[224:227],v250,s[20:23],s48 offen offset:1024 sc1
ds_write2st64_b64 v247,v[204:205],v[206:207] offset0:207 offset1:224
M v[168:171],v[216:219],v[228:231],v[168:171]
s_waitcnt vmcnt(7)
s_add_u32 s28,s69,6684672
v_permlane32_swap_b32 v192,v194
v_permlane32_swap_b32 v200,v202
M v[168:171],a[204:207],a[212:215],v[168:171]
v_lshlrev_b32 v234,16,v198
v_lshlrev_b32 v232,16,v192
M v[168:171],a[236:239],a[208:211],v[168:171]
buffer_load_dwordx4 a[244:247],v250,s[20:23],s48 offen offset:2048 sc1
ds_write2st64_b64 v247,v[208:209],v[210:211] offset0:37 offset1:54
M v[172:175],a[236:239],a[248:251],v[172:175]
s_add_u32 s46,s74,18432
v_lshlrev_b32 v233,16,v196
v_lshlrev_b32 v237,16,v194
M v[172:175],a[204:207],a[208:211],v[172:175]
v_lshlrev_b32 v236,16,v202
v_lshlrev_b32 v235,16,v200
M v[172:175],v[216:219],a[212:215],v[172:175]
buffer_load_dwordx4 v[228:231],v250,s[20:23],s46 offen offset:0 sc1
ds_write2st64_b64 v247,v[212:213],v[214:215] offset0:71 offset1:88
M v[176:179],v[216:219],a[208:211],v[176:179]
v_fmac_f32 v232,s43,v234
v_fmac_f32 v237,4.0,v233
M v[176:179],a[204:207],a[248:251],v[176:179]
buffer_load_dwordx4 v[204:207],v251,s[88:91],s28 offen offset:0
M v[176:179],a[236:239],a[220:223],v[176:179]
s_waitcnt lgkmcnt(0)
s_barrier
v_fma_f32 v238,-4.0,v234,v236
M v[180:183],a[236:239],a[228:231],v[180:183]
v_fmac_f32 v232,s45,v236
v_fmac_f32 v237,s41,v235
M v[180:183],a[204:207],a[220:223],v[180:183]
ds_read_b128 a[212:215],v248 offset:0
v_sub_f32 v236,v236,v234
M v[180:183],v[216:219],a[248:251],v[180:183]
buffer_load_dwordx4 v[208:211],v245,s[8:11],s28 offen offset:0
M v[184:187],v[216:219],a[220:223],v[184:187]
ds_read_b128 a[208:211],v249 offset:0
ds_read_b128 a[248:251],v248 offset:512
M v[184:187],a[204:207],a[228:231],v[184:187]
ds_read_b128 a[220:223],v249 offset:512
v_fma_f32 v234,-4.0,v233,v235
M v[184:187],a[236:239],a[196:199],v[184:187]
v_sub_f32 v235,v235,v233
v_add_f32 v233,v238,v234
M v[188:191],a[236:239],v[224:227],v[188:191]
buffer_load_dwordx4 v[212:215],v245,s[8:11],s28 offen offset:768
M v[188:191],a[204:207],a[196:199],v[188:191]
v_sub_f32 v238,v238,v234
v_fma_f32 v234,2.0,v235,v236
M v[188:191],v[216:219],a[228:231],v[188:191]
s_waitcnt lgkmcnt(3)
v_fmac_f32 v236,-2.0,v235
v_and_b32 v198,s42,v198
M a[0:3],v[220:223],a[212:215],a[0:3]
s_waitcnt vmcnt(11) lgkmcnt(2)
ds_read_b128 a[236:239],v248 offset:1024
v_and_b32 v192,s42,v192
M a[0:3],a[216:219],a[208:211],a[0:3]
s_waitcnt vmcnt(10) lgkmcnt(2)
ds_read_b128 v[224:227],v249 offset:1024
v_and_b32 v196,s42,v196
M a[0:3],a[240:243],a[248:251],a[0:3]
s_waitcnt lgkmcnt(2)
v_and_b32 v194,s42,v194
v_and_b32 v202,s42,v202
M a[4:7],a[240:243],a[220:223],a[4:7]
v_and_b32 v200,s42,v200
v_fmac_f32 v192,s43,v198
M a[4:7],a[216:219],a[248:251],a[4:7]
v_fmac_f32 v194,4.0,v196
v_fma_f32 v235,-4.0,v198,v202
M a[4:7],v[220:223],a[208:211],a[4:7]
v_fmac_f32 v192,s45,v202
v_fmac_f32 v194,s41,v200
M a[8:11],v[220:223],a[248:251],a[8:11]
ds_read_b128 a[196:199],v248 offset:1536
v_sub_f32 v202,v202,v198
M a[8:11],a[216:219],a[220:223],a[8:11]
s_waitcnt lgkmcnt(2)
ds_read_b128 a[204:207],v249 offset:1536
v_fma_f32 v198,-4.0,v196,v200
M a[8:11],a[240:243],a[236:239],a[8:11]
s_waitcnt lgkmcnt(2)
v_sub_f32 v200,v200,v196
v_add_f32 v196,v235,v198
M a[12:15],a[240:243],v[224:227],a[12:15]
v_sub_f32 v235,v235,v198
v_fma_f32 v198,2.0,v200,v202
M a[12:15],a[216:219],a[236:239],a[12:15]
v_fmac_f32 v202,-2.0,v200
v_cvt_pk_bf16_f32 v192,v232,v192
M a[12:15],v[220:223],a[220:223],a[12:15]
v_cvt_pk_bf16_f32 v194,v237,v194
v_cvt_pk_bf16_f32 v196,v233,v196
M a[16:19],v[220:223],a[236:239],a[16:19]
ds_read_b128 a[228:231],v249 offset:2048
v_cvt_pk_bf16_f32 v200,v234,v198
M a[16:19],a[216:219],v[224:227],a[16:19]
s_waitcnt lgkmcnt(2)
ds_read_b128 v[216:219],v248 offset:2048
v_cvt_pk_bf16_f32 v198,v238,v235
M a[16:19],a[240:243],a[196:199],a[16:19]
s_waitcnt lgkmcnt(2)
v_cvt_pk_bf16_f32 v202,v236,v202
v_permlane32_swap_b32 v197,v199
M a[20:23],a[240:243],a[204:207],a[20:23]
v_permlane32_swap_b32 v193,v195
v_permlane32_swap_b32 v201,v203
M a[20:23],a[216:219],a[196:199],a[20:23]
v_lshlrev_b32 v234,16,v199
v_lshlrev_b32 v232,16,v193
M a[20:23],v[220:223],v[224:227],a[20:23]
v_lshlrev_b32 v233,16,v197
v_lshlrev_b32 v237,16,v195
M a[24:27],v[220:223],a[196:199],a[24:27]
v_lshlrev_b32 v236,16,v203
v_lshlrev_b32 v235,16,v201
M a[24:27],a[216:219],a[204:207],a[24:27]
s_waitcnt lgkmcnt(1)
v_fmac_f32 v232,s43,v234
v_fmac_f32 v237,4.0,v233
M a[24:27],a[240:243],a[228:231],a[24:27]
s_waitcnt lgkmcnt(0)
v_fma_f32 v238,-4.0,v234,v236
v_fmac_f32 v232,s45,v236
M a[28:31],a[240:243],v[216:219],a[28:31]
buffer_load_dwordx4 a[240:243],v250,s[20:23],s46 offen offset:1024 sc1
M a[28:31],a[216:219],a[228:231],a[28:31]
v_fmac_f32 v237,s41,v235
v_sub_f32 v236,v236,v234
M a[28:31],v[220:223],a[204:207],a[28:31]
s_waitcnt vmcnt(10)
buffer_load_dwordx4 a[216:219],v250,s[20:23],s46 offen offset:2048 sc1
M a[32:35],a[232:235],a[212:215],a[32:35]
s_waitcnt vmcnt(10)
s_add_u32 s47,s74,21504
v_fma_f32 v234,-4.0,v233,v235
v_sub_f32 v235,v235,v233
M a[32:35],a[200:203],a[208:211],a[32:35]
s_waitcnt vmcnt(9)
v_add_f32 v233,v238,v234
v_sub_f32 v238,v238,v234
M a[32:35],a[192:195],a[248:251],a[32:35]
v_fma_f32 v234,2.0,v235,v236
v_fmac_f32 v236,-2.0,v235
M a[36:39],a[192:195],a[220:223],a[36:39]
buffer_load_dwordx4 v[220:223],v250,s[20:23],s47 offen offset:0 sc1
M a[36:39],a[200:203],a[248:251],a[36:39]
v_and_b32 v199,s42,v199
v_and_b32 v193,s42,v193
M a[36:39],a[232:235],a[208:211],a[36:39]
v_and_b32 v197,s42,v197
v_and_b32 v195,s42,v195
M a[40:43],a[232:235],a[248:251],a[40:43]
v_and_b32 v203,s42,v203
v_and_b32 v201,s42,v201
M a[40:43],a[200:203],a[220:223],a[40:43]
v_fmac_f32 v193,s43,v199
v_fmac_f32 v195,4.0,v197
M a[40:43],a[192:195],a[236:239],a[40:43]
v_fma_f32 v235,-4.0,v199,v203
v_fmac_f32 v193,s45,v203
M a[44:47],a[192:195],v[224:227],a[44:47]
v_fmac_f32 v195,s41,v201
v_sub_f32 v203,v203,v199
M a[44:47],a[200:203],a[236:239],a[44:47]
v_fma_f32 v199,-4.0,v197,v201
v_sub_f32 v201,v201,v197
M a[44:47],a[232:235],a[220:223],a[44:47]
v_add_f32 v197,v235,v199
v_sub_f32 v235,v235,v199
M a[48:51],a[232:235],a[236:239],a[48:51]
v_fma_f32 v199,2.0,v201,v203
v_fmac_f32 v203,-2.0,v201
M a[48:51],a[200:203],v[224:227],a[48:51]
v_cvt_pk_bf16_f32 v193,v232,v193
v_cvt_pk_bf16_f32 v195,v237,v195
M a[48:51],a[192:195],a[196:199],a[48:51]
v_cvt_pk_bf16_f32 v197,v233,v197
v_cvt_pk_bf16_f32 v201,v234,v199
M a[52:55],a[192:195],a[204:207],a[52:55]
v_cvt_pk_bf16_f32 v199,v238,v235
v_cvt_pk_bf16_f32 v203,v236,v203
M a[52:55],a[200:203],a[196:199],a[52:55]
s_waitcnt vmcnt(4)
v_permlane32_swap_b32 v208,v210
v_permlane32_swap_b32 v204,v206
M a[52:55],a[232:235],v[224:227],a[52:55]
s_add_u32 s31,s75,s85
ds_write2st64_b64 v247,v[192:193],v[194:195] offset0:238 offset1:255
M a[56:59],a[232:235],a[196:199],a[56:59]
s_add_u32 s28,s69,7077888
buffer_load_dwordx4 v[192:195],v251,s[88:91],s28 offen offset:0
M a[56:59],a[200:203],a[204:207],a[56:59]
s_waitcnt vmcnt(4)
v_permlane32_swap_b32 v212,v214
v_lshlrev_b32 v234,16,v210
M a[56:59],a[192:195],a[228:231],a[56:59]
ds_write2st64_b64 v247,v[196:197],v[198:199] offset0:0 offset1:17
M a[60:63],a[192:195],v[216:219],a[60:63]
buffer_load_dwordx4 v[196:199],v245,s[8:11],s28 offen offset:0
M a[60:63],a[200:203],a[228:231],a[60:63]
v_lshlrev_b32 v232,16,v204
v_lshlrev_b32 v233,16,v208
M a[60:63],a[232:235],a[204:207],a[60:63]
ds_write2st64_b64 v247,v[200:201],v[202:203] offset0:136 offset1:153
M a[64:67],a[252:255],a[212:215],a[64:67]
buffer_load_dwordx4 v[200:203],v245,s[8:11],s28 offen offset:768
M a[64:67],a[224:227],a[208:211],a[64:67]
v_lshlrev_b32 v237,16,v206
v_lshlrev_b32 v236,16,v214
M a[64:67],a[244:247],a[248:251],a[64:67]
v_lshlrev_b32 v235,16,v212
v_fmac_f32 v232,s43,v234
M a[68:71],a[244:247],a[220:223],a[68:71]
buffer_load_dword a192,v250,s[20:23],s31 offen offset:0 sc1
M a[68:71],a[224:227],a[248:251],a[68:71]
v_fmac_f32 v237,4.0,v233
v_fma_f32 v238,-4.0,v234,v236
M a[68:71],a[252:255],a[208:211],a[68:71]
v_fmac_f32 v232,s45,v236
v_fmac_f32 v237,s41,v235
M a[72:75],a[252:255],a[248:251],a[72:75]
v_sub_f32 v236,v236,v234
v_fma_f32 v234,-4.0,v233,v235
M a[72:75],a[224:227],a[220:223],a[72:75]
buffer_load_dword a192,v250,s[20:23],s31 offen offset:128 sc1
M a[72:75],a[244:247],a[236:239],a[72:75]
v_sub_f32 v235,v235,v233
v_add_f32 v233,v238,v234
M a[76:79],a[244:247],v[224:227],a[76:79]
buffer_load_dwordx4 a[192:195],v250,s[20:23],s47 offen offset:1024 sc1
M a[76:79],a[224:227],a[236:239],a[76:79]
buffer_load_dwordx4 a[200:203],v250,s[20:23],s47 offen offset:2048 sc1
M a[76:79],a[252:255],a[220:223],a[76:79]
s_add_u32 s48,s74,24576
v_sub_f32 v238,v238,v234
v_fma_f32 v234,2.0,v235,v236
M a[80:83],a[252:255],a[236:239],a[80:83]
v_fmac_f32 v236,-2.0,v235
v_and_b32 v210,s42,v210
M a[80:83],a[224:227],v[224:227],a[80:83]
v_and_b32 v204,s42,v204
v_and_b32 v208,s42,v208
M a[80:83],a[244:247],a[196:199],a[80:83]
v_and_b32 v206,s42,v206
v_and_b32 v214,s42,v214
M a[84:87],a[244:247],a[204:207],a[84:87]
v_and_b32 v212,s42,v212
v_fmac_f32 v204,s43,v210
M a[84:87],a[224:227],a[196:199],a[84:87]
ds_read_b128 a[220:223],v248 offset:8704
v_fmac_f32 v206,4.0,v208
M a[84:87],a[252:255],v[224:227],a[84:87]
ds_read_b128 a[236:239],v249 offset:8704
v_fma_f32 v235,-4.0,v210,v214
M a[88:91],a[252:255],a[196:199],a[88:91]
ds_read_b128 v[224:227],v248 offset:9216
v_fmac_f32 v204,s45,v214
M a[88:91],a[224:227],a[204:207],a[88:91]
buffer_load_dwordx4 a[232:235],v250,s[20:23],s48 offen offset:0 sc1
M a[88:91],a[244:247],a[228:231],a[88:91]
ds_read_b128 a[196:199],v249 offset:9216
v_fmac_f32 v206,s41,v212
M a[92:95],a[244:247],v[216:219],a[92:95]
v_sub_f32 v214,v214,v210
v_fma_f32 v210,-4.0,v208,v212
M a[92:95],a[224:227],a[228:231],a[92:95]
v_sub_f32 v212,v212,v208
v_add_f32 v208,v235,v210
M a[92:95],a[252:255],a[204:207],a[92:95]
s_waitcnt lgkmcnt(3)
buffer_load_dwordx4 a[212:215],v250,s[20:23],s48 offen offset:1024 sc1
M a[96:99],v[228:231],a[220:223],a[96:99]
s_waitcnt vmcnt(11) lgkmcnt(2)
ds_read_b128 a[244:247],v248 offset:9728
v_sub_f32 v235,v235,v210
M a[96:99],a[240:243],a[236:239],a[96:99]
s_waitcnt vmcnt(10) lgkmcnt(2)
ds_read_b128 v[216:219],v249 offset:9728
v_fma_f32 v210,2.0,v212,v214
M a[96:99],a[216:219],v[224:227],a[96:99]
s_waitcnt lgkmcnt(2)
v_fmac_f32 v214,-2.0,v212
v_cvt_pk_bf16_f32 v204,v232,v204
M a[100:103],a[216:219],a[196:199],a[100:103]
buffer_load_dwordx4 a[208:211],v250,s[20:23],s48 offen offset:2048 sc1
M a[100:103],a[240:243],v[224:227],a[100:103]
s_add_u32 s46,s74,27648
v_cvt_pk_bf16_f32 v206,v237,v206
v_cvt_pk_bf16_f32 v208,v233,v208
M a[100:103],v[228:231],a[236:239],a[100:103]
v_cvt_pk_bf16_f32 v212,v234,v210
v_cvt_pk_bf16_f32 v210,v238,v235
M a[104:107],v[228:231],v[224:227],a[104:107]
ds_read_b128 a[224:227],v248 offset:10240
v_cvt_pk_bf16_f32 v214,v236,v214
M a[104:107],a[240:243],a[196:199],a[104:107]
s_waitcnt lgkmcnt(2)
buffer_load_dwordx4 a[248:251],v250,s[20:23],s46 offen offset:0 sc1
M a[104:107],a[216:219],a[244:247],a[104:107]
s_waitcnt lgkmcnt(1)
ds_read_b128 a[228:231],v249 offset:10240
v_permlane32_swap_b32 v209,v211
M a[108:111],a[216:219],v[216:219],a[108:111]
v_permlane32_swap_b32 v205,v207
v_permlane32_swap_b32 v213,v215
M a[108:111],a[240:243],a[244:247],a[108:111]
v_lshlrev_b32 v234,16,v211
v_lshlrev_b32 v232,16,v205
M a[108:111],v[228:231],a[196:199],a[108:111]
v_lshlrev_b32 v233,16,v209
v_lshlrev_b32 v237,16,v207
M a[112:115],v[228:231],a[244:247],a[112:115]
ds_read_b128 a[204:207],v249 offset:10752
v_lshlrev_b32 v236,16,v215
M a[112:115],a[240:243],v[216:219],a[112:115]
s_waitcnt lgkmcnt(2)
ds_read_b128 a[252:255],v248 offset:10752
v_lshlrev_b32 v235,16,v213
M a[112:115],a[216:219],a[224:227],a[112:115]
s_waitcnt lgkmcnt(2)
v_fmac_f32 v232,s43,v234
v_fmac_f32 v237,4.0,v233
M a[116:119],a[216:219],a[228:231],a[116:119]
v_fma_f32 v238,-4.0,v234,v236
v_fmac_f32 v232,s45,v236
M a[116:119],a[240:243],a[224:227],a[116:119]
v_fmac_f32 v237,s41,v235
v_sub_f32 v236,v236,v234
M a[116:119],v[228:231],v[216:219],a[116:119]
v_fma_f32 v234,-4.0,v233,v235
v_sub_f32 v235,v235,v233
M a[120:123],v[228:231],a[224:227],a[120:123]
v_add_f32 v233,v238,v234
v_sub_f32 v238,v238,v234
M a[120:123],a[240:243],a[228:231],a[120:123]
s_waitcnt lgkmcnt(1)
v_fma_f32 v234,2.0,v235,v236
v_fmac_f32 v236,-2.0,v235
M a[120:123],a[216:219],a[204:207],a[120:123]
s_waitcnt lgkmcnt(0)
v_and_b32 v211,s42,v211
v_and_b32 v205,s42,v205
M a[124:127],a[216:219],a[252:255],a[124:127]
buffer_load_dwordx4 a[216:219],v250,s[20:23],s46 offen offset:1024 sc1
M a[124:127],a[240:243],a[204:207],a[124:127]
v_and_b32 v209,s42,v209
v_and_b32 v207,s42,v207
M a[124:127],v[228:231],a[228:231],a[124:127]
s_waitcnt vmcnt(12)
buffer_load_dwordx4 a[240:243],v250,s[20:23],s46 offen offset:2048 sc1
M a[128:131],v[220:223],a[220:223],a[128:131]
s_waitcnt vmcnt(7)
s_add_u32 s47,s74,30720
v_and_b32 v215,s42,v215
v_and_b32 v213,s42,v213
M a[128:131],a[192:195],a[236:239],a[128:131]
s_waitcnt vmcnt(6)
v_fmac_f32 v205,s43,v211
v_fmac_f32 v207,4.0,v209
M a[128:131],a[200:203],v[224:227],a[128:131]
v_fma_f32 v235,-4.0,v211,v215
v_fmac_f32 v205,s45,v215
M a[132:135],a[200:203],a[196:199],a[132:135]
buffer_load_dwordx4 v[228:231],v250,s[20:23],s47 offen offset:0 sc1
M a[132:135],a[192:195],v[224:227],a[132:135]
v_fmac_f32 v207,s41,v213
v_sub_f32 v215,v215,v211
M a[132:135],v[220:223],a[236:239],a[132:135]
v_fma_f32 v211,-4.0,v209,v213
v_sub_f32 v213,v213,v209
M a[136:139],v[220:223],v[224:227],a[136:139]
v_add_f32 v209,v235,v211
v_sub_f32 v235,v235,v211
M a[136:139],a[192:195],a[196:199],a[136:139]
v_fma_f32 v211,2.0,v213,v215
v_fmac_f32 v215,-2.0,v213
M a[136:139],a[200:203],a[244:247],a[136:139]
v_cvt_pk_bf16_f32 v205,v232,v205
v_cvt_pk_bf16_f32 v207,v237,v207
M a[140:143],a[200:203],v[216:219],a[140:143]
v_cvt_pk_bf16_f32 v209,v233,v209
v_cvt_pk_bf16_f32 v213,v234,v211
M a[140:143],a[192:195],a[244:247],a[140:143]
v_cvt_pk_bf16_f32 v211,v238,v235
v_cvt_pk_bf16_f32 v215,v236,v215
M a[140:143],v[220:223],a[196:199],a[140:143]
v_add_u32 v238,121856,v247
v_fmac_f32 v239,s43,v241
M a[144:147],v[220:223],a[244:247],a[144:147]
v_fmac_f32 v244,4.0,v240
v_fma_f32 v232,-4.0,v241,v243
M a[144:147],a[192:195],v[216:219],a[144:147]
v_fmac_f32 v239,s45,v243
v_fmac_f32 v244,s41,v242
M a[144:147],a[200:203],a[224:227],a[144:147]
ds_write2st64_b64 v238,v[204:205],v[206:207] offset0:1 offset1:18
M a[148:151],a[200:203],a[228:231],a[148:151]
s_add_u32 s28,s69,7471104
buffer_load_dwordx4 v[204:207],v251,s[88:91],s28 offen offset:0
M a[148:151],a[192:195],a[224:227],a[148:151]
v_sub_f32 v243,v243,v241
v_fma_f32 v241,-4.0,v240,v242
M a[148:151],v[220:223],v[216:219],a[148:151]
ds_write2st64_b64 v247,v[208:209],v[210:211] offset0:1 offset1:18
M a[152:155],v[220:223],a[224:227],a[152:155]
buffer_load_dwordx4 v[208:211],v245,s[8:11],s28 offen offset:0
M a[152:155],a[192:195],a[228:231],a[152:155]
v_sub_f32 v242,v242,v240
v_add_f32 v240,v232,v241
M a[152:155],a[200:203],a[204:207],a[152:155]
ds_write2st64_b64 v247,v[212:213],v[214:215] offset0:137 offset1:154
M a[156:159],a[200:203],a[252:255],a[156:159]
buffer_load_dwordx4 a[200:203],v250,s[20:23],s47 offen offset:1024 sc1
M a[156:159],a[192:195],a[204:207],a[156:159]
v_sub_f32 v232,v232,v241
v_fma_f32 v241,2.0,v242,v243
M a[156:159],v[220:223],a[228:231],a[156:159]
s_waitcnt vmcnt(9)
v_fmac_f32 v243,-2.0,v242
v_cvt_pk_bf16_f32 v233,v239,v244
M a[160:163],a[232:235],a[220:223],a[160:163]
s_waitcnt vmcnt(8)
buffer_load_dwordx4 a[192:195],v250,s[20:23],s47 offen offset:2048 sc1
M a[160:163],a[212:215],a[236:239],a[160:163]
s_waitcnt vmcnt(8)
s_add_u32 s48,s74,33792
v_cvt_pk_bf16_f32 v234,v240,v232
v_cvt_pk_bf16_f32 v235,v241,v243
M a[160:163],a[208:211],v[224:227],a[160:163]
v_add_u32 v232,121856,v252
M a[164:167],a[208:211],a[196:199],a[164:167]
ds_write_b16 v232,v233 offset:0
M a[164:167],a[212:215],v[224:227],a[164:167]
buffer_load_dwordx4 v[220:223],v250,s[20:23],s48 offen offset:0 sc1
M a[164:167],a[232:235],a[236:239],a[164:167]
ds_write_b16_d16_hi v232,v233 offset:8704
M a[168:171],a[232:235],v[224:227],a[168:171]
ds_write_b16 v252,v234 offset:0
M a[168:171],a[212:215],a[196:199],a[168:171]
ds_write_b16_d16_hi v252,v234 offset:8704
M a[168:171],a[208:211],a[244:247],a[168:171]
buffer_load_dwordx4 a[220:223],v250,s[20:23],s48 offen offset:1024 sc1
M a[172:175],a[208:211],v[216:219],a[172:175]
v_add_u32 v232,69632,v252
M a[172:175],a[212:215],a[244:247],a[172:175]
ds_write_b16 v232,v235 offset:0
M a[172:175],a[232:235],a[196:199],a[172:175]
ds_write_b16_d16_hi v232,v235 offset:8704
M a[176:179],a[232:235],a[244:247],a[176:179]
buffer_load_dwordx4 a[236:239],v250,s[20:23],s48 offen offset:2048 sc1
M a[176:179],a[212:215],v[216:219],a[176:179]
s_add_u32 s46,s74,36864
v_permlane32_swap_b32 v196,v198
v_permlane32_swap_b32 v192,v194
M a[176:179],a[208:211],a[224:227],a[176:179]
v_permlane32_swap_b32 v200,v202
v_lshlrev_b32 v234,16,v198
M a[180:183],a[208:211],a[228:231],a[180:183]
v_lshlrev_b32 v232,16,v192
v_lshlrev_b32 v233,16,v196
M a[180:183],a[212:215],a[224:227],a[180:183]
buffer_load_dwordx4 v[224:227],v250,s[20:23],s46 offen offset:0 sc1
M a[180:183],a[232:235],v[216:219],a[180:183]
ds_read_b128 a[196:199],v248 offset:17408
ds_read_b128 a[244:247],v249 offset:17408
M a[184:187],a[232:235],a[224:227],a[184:187]
ds_read_b128 v[216:219],v248 offset:17920
v_lshlrev_b32 v237,16,v194
M a[184:187],a[212:215],a[228:231],a[184:187]
ds_read_b128 a[224:227],v249 offset:17920
v_lshlrev_b32 v236,16,v202
M a[184:187],a[208:211],a[204:207],a[184:187]
buffer_load_dwordx4 v[212:215],v245,s[8:11],s28 offen offset:768
M a[188:191],a[208:211],a[252:255],a[188:191]
v_lshlrev_b32 v235,16,v200
v_fmac_f32 v232,s43,v234
M a[188:191],a[212:215],a[204:207],a[188:191]
v_fmac_f32 v237,4.0,v233
v_fma_f32 v238,-4.0,v234,v236
M a[188:191],a[232:235],a[228:231],a[188:191]
s_waitcnt vmcnt(12) lgkmcnt(3)
v_fmac_f32 v232,s45,v236
v_fmac_f32 v237,s41,v235
M v[0:3],a[248:251],a[196:199],v[0:3]
s_waitcnt vmcnt(11) lgkmcnt(2)
ds_read_b128 a[208:211],v248 offset:18432
v_sub_f32 v236,v236,v234
M v[0:3],a[216:219],a[244:247],v[0:3]
s_waitcnt vmcnt(10) lgkmcnt(2)
ds_read_b128 a[252:255],v249 offset:18432
v_fma_f32 v234,-4.0,v233,v235
M v[0:3],a[240:243],v[216:219],v[0:3]
s_waitcnt lgkmcnt(2)
v_sub_f32 v235,v235,v233
v_add_f32 v233,v238,v234
M v[4:7],a[240:243],a[224:227],v[4:7]
v_sub_f32 v238,v238,v234
v_fma_f32 v234,2.0,v235,v236
M v[4:7],a[216:219],v[216:219],v[4:7]
v_fmac_f32 v236,-2.0,v235
v_and_b32 v198,s42,v198
M v[4:7],a[248:251],a[244:247],v[4:7]
v_and_b32 v192,s42,v192
v_and_b32 v196,s42,v196
M v[8:11],a[248:251],v[216:219],v[8:11]
ds_read_b128 a[204:207],v248 offset:18944
v_and_b32 v194,s42,v194
M v[8:11],a[216:219],a[224:227],v[8:11]
s_waitcnt lgkmcnt(2)
ds_read_b128 a[212:215],v249 offset:18944
v_and_b32 v202,s42,v202
M v[8:11],a[240:243],a[208:211],v[8:11]
s_waitcnt lgkmcnt(2)
v_and_b32 v200,s42,v200
v_fmac_f32 v192,s43,v198
M v[12:15],a[240:243],a[252:255],v[12:15]
v_fmac_f32 v194,4.0,v196
v_fma_f32 v235,-4.0,v198,v202
M v[12:15],a[216:219],a[208:211],v[12:15]
v_fmac_f32 v192,s45,v202
v_fmac_f32 v194,s41,v200
M v[12:15],a[248:251],a[224:227],v[12:15]
v_sub_f32 v202,v202,v198
v_fma_f32 v198,-4.0,v196,v200
M v[16:19],a[248:251],a[208:211],v[16:19]
ds_read_b128 a[228:231],v249 offset:19456
v_sub_f32 v200,v200,v196
M v[16:19],a[216:219],a[252:255],v[16:19]
s_waitcnt lgkmcnt(2)
ds_read_b128 a[232:235],v248 offset:19456
v_add_f32 v196,v235,v198
M v[16:19],a[240:243],a[204:207],v[16:19]
s_waitcnt lgkmcnt(2)
v_sub_f32 v235,v235,v198
v_fma_f32 v198,2.0,v200,v202
M v[20:23],a[240:243],a[212:215],v[20:23]
v_fmac_f32 v202,-2.0,v200
v_cvt_pk_bf16_f32 v192,v232,v192
M v[20:23],a[216:219],a[204:207],v[20:23]
v_cvt_pk_bf16_f32 v194,v237,v194
v_cvt_pk_bf16_f32 v196,v233,v196
M v[20:23],a[248:251],a[252:255],v[20:23]
v_cvt_pk_bf16_f32 v200,v234,v198
v_cvt_pk_bf16_f32 v198,v238,v235
M v[24:27],a[248:251],a[204:207],v[24:27]
v_cvt_pk_bf16_f32 v202,v236,v202
v_permlane32_swap_b32 v197,v199
M v[24:27],a[216:219],a[212:215],v[24:27]
s_waitcnt lgkmcnt(1)
v_permlane32_swap_b32 v193,v195
v_permlane32_swap_b32 v201,v203
M v[24:27],a[240:243],a[228:231],v[24:27]
s_waitcnt lgkmcnt(0)
v_lshlrev_b32 v234,16,v199
v_lshlrev_b32 v232,16,v193
M v[28:31],a[240:243],a[232:235],v[28:31]
global_load_dword a240,v250,s[64:65]
M v[28:31],a[216:219],a[228:231],v[28:31]
buffer_load_dwordx4 a[240:243],v250,s[20:23],s46 offen offset:1024 sc1
M v[28:31],a[248:251],a[212:215],v[28:31]
s_waitcnt vmcnt(11)
v_lshlrev_b32 v233,16,v197
v_lshlrev_b32 v237,16,v195
M v[32:35],v[228:231],a[196:199],v[32:35]
s_waitcnt vmcnt(8)
v_lshlrev_b32 v236,16,v203
v_lshlrev_b32 v235,16,v201
M v[32:35],a[200:203],a[244:247],v[32:35]
s_waitcnt vmcnt(7)
buffer_load_dwordx4 a[216:219],v250,s[20:23],s46 offen offset:2048 sc1
M v[32:35],a[192:195],v[216:219],v[32:35]
s_add_u32 s47,s74,39936
v_fmac_f32 v232,s43,v234
v_fmac_f32 v237,4.0,v233
M v[36:39],a[192:195],a[224:227],v[36:39]
v_fma_f32 v238,-4.0,v234,v236
v_fmac_f32 v232,s45,v236
M v[36:39],a[200:203],v[216:219],v[36:39]
v_fmac_f32 v237,s41,v235
v_sub_f32 v236,v236,v234
M v[36:39],v[228:231],a[244:247],v[36:39]
buffer_load_dwordx4 a[248:251],v250,s[20:23],s47 offen offset:0 sc1
M v[40:43],v[228:231],v[216:219],v[40:43]
v_fma_f32 v234,-4.0,v233,v235
v_sub_f32 v235,v235,v233
M v[40:43],a[200:203],a[224:227],v[40:43]
v_add_f32 v233,v238,v234
v_sub_f32 v238,v238,v234
M v[40:43],a[192:195],a[208:211],v[40:43]
v_fma_f32 v234,2.0,v235,v236
v_fmac_f32 v236,-2.0,v235
M v[44:47],a[192:195],a[252:255],v[44:47]
v_and_b32 v199,s42,v199
v_and_b32 v193,s42,v193
M v[44:47],a[200:203],a[208:211],v[44:47]
v_and_b32 v197,s42,v197
v_and_b32 v195,s42,v195
M v[44:47],v[228:231],a[224:227],v[44:47]
v_and_b32 v203,s42,v203
v_and_b32 v201,s42,v201
M v[48:51],v[228:231],a[208:211],v[48:51]
v_fmac_f32 v193,s43,v199
v_fmac_f32 v195,4.0,v197
M v[48:51],a[200:203],a[252:255],v[48:51]
v_fma_f32 v235,-4.0,v199,v203
v_fmac_f32 v193,s45,v203
M v[48:51],a[192:195],a[204:207],v[48:51]
v_fmac_f32 v195,s41,v201
v_sub_f32 v203,v203,v199
M v[52:55],a[192:195],a[212:215],v[52:55]
v_fma_f32 v199,-4.0,v197,v201
v_sub_f32 v201,v201,v197
M v[52:55],a[200:203],a[204:207],v[52:55]
v_add_f32 v197,v235,v199
v_sub_f32 v235,v235,v199
M v[52:55],v[228:231],a[252:255],v[52:55]
v_fma_f32 v199,2.0,v201,v203
v_fmac_f32 v203,-2.0,v201
M v[56:59],v[228:231],a[204:207],v[56:59]
v_cvt_pk_bf16_f32 v193,v232,v193
v_cvt_pk_bf16_f32 v195,v237,v195
M v[56:59],a[200:203],a[212:215],v[56:59]
v_cvt_pk_bf16_f32 v197,v233,v197
v_cvt_pk_bf16_f32 v201,v234,v199
M v[56:59],a[192:195],a[228:231],v[56:59]
v_cvt_pk_bf16_f32 v199,v238,v235
v_cvt_pk_bf16_f32 v203,v236,v203
M v[60:63],a[192:195],a[232:235],v[60:63]
buffer_load_dwordx4 a[192:195],v250,s[20:23],s47 offen offset:1024 sc1
M v[60:63],a[200:203],a[228:231],v[60:63]
v_add_u32 v238,121856,v247
v_permlane32_swap_b32 v208,v210
M v[60:63],v[228:231],a[212:215],v[60:63]
s_waitcnt vmcnt(9)
buffer_load_dwordx4 a[200:203],v250,s[20:23],s47 offen offset:2048 sc1
M v[64:67],v[220:223],a[196:199],v[64:67]
s_waitcnt vmcnt(6)
s_add_u32 s48,s74,43008
v_permlane32_swap_b32 v204,v206
v_permlane32_swap_b32 v212,v214
M v[64:67],a[220:223],a[244:247],v[64:67]
v_lshlrev_b32 v234,16,v210
v_lshlrev_b32 v232,16,v204
M v[64:67],a[236:239],v[216:219],v[64:67]
ds_write2st64_b64 v238,v[192:193],v[194:195] offset0:2 offset1:19
M v[68:71],a[236:239],a[224:227],v[68:71]
s_add_u32 s28,s70,6291456
buffer_load_dwordx4 v[228:231],v250,s[20:23],s48 offen offset:0 sc1
M v[68:71],a[220:223],v[216:219],v[68:71]
v_lshlrev_b32 v233,16,v208
v_lshlrev_b32 v237,16,v206
M v[68:71],v[220:223],a[244:247],v[68:71]
ds_write2st64_b64 v247,v[196:197],v[198:199] offset0:2 offset1:19
M v[72:75],v[220:223],v[216:219],v[72:75]
buffer_load_dwordx4 a[196:199],v250,s[20:23],s48 offen offset:1024 sc1
M v[72:75],a[220:223],a[224:227],v[72:75]
v_lshlrev_b32 v236,16,v214
v_lshlrev_b32 v235,16,v212
M v[72:75],a[236:239],a[208:211],v[72:75]
ds_write2st64_b64 v247,v[200:201],v[202:203] offset0:138 offset1:155
M v[76:79],a[236:239],a[252:255],v[76:79]
buffer_load_dwordx4 a[244:247],v250,s[20:23],s48 offen offset:2048 sc1
M v[76:79],a[220:223],a[208:211],v[76:79]
s_add_u32 s46,s75,9216
v_fmac_f32 v232,s43,v234
v_fmac_f32 v237,4.0,v233
M v[76:79],v[220:223],a[224:227],v[76:79]
v_fma_f32 v238,-4.0,v234,v236
v_fmac_f32 v232,s45,v236
M v[80:83],v[220:223],a[208:211],v[80:83]
v_fmac_f32 v237,s41,v235
v_sub_f32 v236,v236,v234
M v[80:83],a[220:223],a[252:255],v[80:83]
buffer_load_dwordx4 v[216:219],v250,s[20:23],s46 offen offset:0 sc1
M v[80:83],a[236:239],a[204:207],v[80:83]
v_fma_f32 v234,-4.0,v233,v235
v_sub_f32 v235,v235,v233
M v[84:87],a[236:239],a[212:215],v[84:87]
v_add_f32 v233,v238,v234
v_sub_f32 v238,v238,v234
M v[84:87],a[220:223],a[204:207],v[84:87]
ds_read_b128 a[224:227],v248 offset:26112
v_fma_f32 v234,2.0,v235,v236
M v[84:87],v[220:223],a[252:255],v[84:87]
buffer_load_dwordx4 v[192:195],v251,s[88:91],s28 offen offset:0
M v[88:91],v[220:223],a[204:207],v[88:91]
ds_read_b128 a[208:211],v249 offset:26112
ds_read_b128 a[252:255],v248 offset:26624
M v[88:91],a[220:223],a[212:215],v[88:91]
ds_read_b128 a[204:207],v249 offset:26624
v_fmac_f32 v236,-2.0,v235
M v[88:91],a[236:239],a[228:231],v[88:91]
v_and_b32 v210,s42,v210
v_and_b32 v204,s42,v204
M v[92:95],a[236:239],a[232:235],v[92:95]
buffer_load_dwordx4 v[196:199],v245,s[8:11],s28 offen offset:0
M v[92:95],a[220:223],a[228:231],v[92:95]
v_and_b32 v208,s42,v208
v_and_b32 v206,s42,v206
M v[92:95],v[220:223],a[212:215],v[92:95]
s_waitcnt lgkmcnt(3)
v_and_b32 v214,s42,v214
v_and_b32 v212,s42,v212
M v[96:99],v[224:227],a[224:227],v[96:99]
s_waitcnt vmcnt(10) lgkmcnt(2)
ds_read_b128 a[232:235],v248 offset:27136
v_fmac_f32 v204,s43,v210
M v[96:99],a[240:243],a[208:211],v[96:99]
s_waitcnt vmcnt(9) lgkmcnt(2)
buffer_load_dwordx4 v[200:203],v245,s[8:11],s28 offen offset:768
M v[96:99],a[216:219],a[252:255],v[96:99]
s_waitcnt lgkmcnt(1)
s_add_u32 s29,s70,6291456
ds_read_b128 a[236:239],v249 offset:27136
v_fmac_f32 v206,4.0,v208
M v[100:103],a[216:219],a[204:207],v[100:103]
v_fma_f32 v235,-4.0,v210,v214
v_fmac_f32 v204,s45,v214
M v[100:103],a[240:243],a[252:255],v[100:103]
v_fmac_f32 v206,s41,v212
v_sub_f32 v214,v214,v210
M v[100:103],v[224:227],a[208:211],v[100:103]
buffer_load_short_d16_hi v239,v246,s[12:15],s29 offen offset:0
M v[104:107],v[224:227],a[252:255],v[104:107]
ds_read_b128 a[220:223],v248 offset:27648
v_fma_f32 v210,-4.0,v208,v212
M v[104:107],a[240:243],a[204:207],v[104:107]
s_waitcnt lgkmcnt(2)
buffer_load_short_d16_hi v240,v246,s[8:11],s29 offen offset:0
M v[104:107],a[216:219],a[232:235],v[104:107]
s_waitcnt lgkmcnt(1)
ds_read_b128 a[228:231],v249 offset:27648
v_sub_f32 v212,v212,v208
M v[108:111],a[216:219],a[236:239],v[108:111]
buffer_load_short_d16_hi v241,v246,s[8:11],s29 offen offset:384
M v[108:111],a[240:243],a[232:235],v[108:111]
v_add_f32 v208,v235,v210
v_sub_f32 v235,v235,v210
M v[108:111],v[224:227],a[204:207],v[108:111]
buffer_load_short_d16_hi v242,v246,s[8:11],s29 offen offset:768
M v[112:115],v[224:227],a[232:235],v[112:115]
ds_read_b128 a[212:215],v249 offset:28160
v_fma_f32 v210,2.0,v212,v214
M v[112:115],a[240:243],a[236:239],v[112:115]
s_waitcnt lgkmcnt(2)
buffer_load_short_d16_hi v243,v246,s[8:11],s29 offen offset:1152
M v[112:115],a[216:219],a[220:223],v[112:115]
s_waitcnt lgkmcnt(1)
ds_read_b128 v[220:223],v248 offset:28160
v_fmac_f32 v214,-2.0,v212
M v[116:119],a[216:219],a[228:231],v[116:119]
buffer_load_short_d16_hi v244,v246,s[16:19],s29 offen offset:1536
M v[116:119],a[240:243],a[220:223],v[116:119]
v_cvt_pk_bf16_f32 v204,v232,v204
v_cvt_pk_bf16_f32 v206,v237,v206
M v[116:119],v[224:227],a[236:239],v[116:119]
v_cvt_pk_bf16_f32 v208,v233,v208
v_cvt_pk_bf16_f32 v212,v234,v210
M v[120:123],v[224:227],a[220:223],v[120:123]
v_cvt_pk_bf16_f32 v210,v238,v235
v_cvt_pk_bf16_f32 v214,v236,v214
M v[120:123],a[240:243],a[228:231],v[120:123]
s_waitcnt lgkmcnt(1)
v_permlane32_swap_b32 v209,v211
v_permlane32_swap_b32 v205,v207
M v[120:123],a[216:219],a[212:215],v[120:123]
s_waitcnt lgkmcnt(0)
v_permlane32_swap_b32 v213,v215
v_lshlrev_b32 v234,16,v211
M v[124:127],a[216:219],v[220:223],v[124:127]
buffer_load_dwordx4 a[216:219],v250,s[20:23],s46 offen offset:1024 sc1
M v[124:127],a[240:243],a[212:215],v[124:127]
v_lshlrev_b32 v232,16,v205
v_lshlrev_b32 v233,16,v209
M v[124:127],v[224:227],a[228:231],v[124:127]
s_waitcnt vmcnt(16)
buffer_load_dwordx4 a[240:243],v250,s[20:23],s46 offen offset:2048 sc1
M v[128:131],a[248:251],a[224:227],v[128:131]
s_waitcnt vmcnt(16)
s_add_u32 s47,s75,12288
v_lshlrev_b32 v237,16,v207
v_lshlrev_b32 v236,16,v215
M v[128:131],a[192:195],a[208:211],v[128:131]
s_waitcnt vmcnt(15)
v_lshlrev_b32 v235,16,v213
v_fmac_f32 v232,s43,v234
M v[128:131],a[200:203],a[252:255],v[128:131]
v_fmac_f32 v237,4.0,v233
v_fma_f32 v238,-4.0,v234,v236
M v[132:135],a[200:203],a[204:207],v[132:135]
buffer_load_dwordx4 v[224:227],v250,s[20:23],s47 offen offset:0 sc1
M v[132:135],a[192:195],a[252:255],v[132:135]
v_fmac_f32 v232,s45,v236
v_fmac_f32 v237,s41,v235
M v[132:135],a[248:251],a[208:211],v[132:135]
v_sub_f32 v236,v236,v234
v_fma_f32 v234,-4.0,v233,v235
M v[136:139],a[248:251],a[252:255],v[136:139]
v_sub_f32 v235,v235,v233
v_add_f32 v233,v238,v234
M v[136:139],a[192:195],a[204:207],v[136:139]
v_sub_f32 v238,v238,v234
v_fma_f32 v234,2.0,v235,v236
M v[136:139],a[200:203],a[232:235],v[136:139]
v_fmac_f32 v236,-2.0,v235
v_and_b32 v211,s42,v211
M v[140:143],a[200:203],a[236:239],v[140:143]
v_and_b32 v205,s42,v205
v_and_b32 v209,s42,v209
M v[140:143],a[192:195],a[232:235],v[140:143]
v_and_b32 v207,s42,v207
v_and_b32 v215,s42,v215
M v[140:143],a[248:251],a[204:207],v[140:143]
v_and_b32 v213,s42,v213
v_fmac_f32 v205,s43,v211
M v[144:147],a[248:251],a[232:235],v[144:147]
v_fmac_f32 v207,4.0,v209
v_fma_f32 v235,-4.0,v211,v215
M v[144:147],a[192:195],a[236:239],v[144:147]
v_fmac_f32 v205,s45,v215
v_fmac_f32 v207,s41,v213
M v[144:147],a[200:203],a[220:223],v[144:147]
v_sub_f32 v215,v215,v211
v_fma_f32 v211,-4.0,v209,v213
M v[148:151],a[200:203],a[228:231],v[148:151]
v_sub_f32 v213,v213,v209
v_add_f32 v209,v235,v211
M v[148:151],a[192:195],a[220:223],v[148:151]
v_sub_f32 v235,v235,v211
v_fma_f32 v211,2.0,v213,v215
M v[148:151],a[248:251],a[236:239],v[148:151]
v_fmac_f32 v215,-2.0,v213
v_cvt_pk_bf16_f32 v205,v232,v205
M v[152:155],a[248:251],a[220:223],v[152:155]
v_cvt_pk_bf16_f32 v207,v237,v207
v_cvt_pk_bf16_f32 v209,v233,v209
M v[152:155],a[192:195],a[228:231],v[152:155]
v_cvt_pk_bf16_f32 v213,v234,v211
v_cvt_pk_bf16_f32 v211,v238,v235
M v[152:155],a[200:203],a[212:215],v[152:155]
v_cvt_pk_bf16_f32 v215,v236,v215
v_add_u32 v238,121856,v247
M v[156:159],a[200:203],v[220:223],v[156:159]
buffer_load_dwordx4 a[200:203],v250,s[20:23],s47 offen offset:1024 sc1
M v[156:159],a[192:195],a[212:215],v[156:159]
M v[156:159],a[248:251],a[228:231],v[156:159]
s_waitcnt vmcnt(16)
buffer_load_dwordx4 a[192:195],v250,s[20:23],s47 offen offset:2048 sc1
M v[160:163],v[228:231],a[224:227],v[160:163]
s_waitcnt vmcnt(16)
s_add_u32 s48,s75,15360
M v[160:163],a[196:199],a[208:211],v[160:163]
s_waitcnt vmcnt(15)
M v[160:163],a[244:247],a[252:255],v[160:163]
ds_write2st64_b64 v238,v[204:205],v[206:207] offset0:3 offset1:20
M v[164:167],a[244:247],a[204:207],v[164:167]
s_add_u32 s28,s70,6684672
buffer_load_dwordx4 a[248:251],v250,s[20:23],s48 offen offset:0 sc1
M v[164:167],a[196:199],a[252:255],v[164:167]
M v[164:167],v[228:231],a[208:211],v[164:167]
ds_write2st64_b64 v247,v[208:209],v[210:211] offset0:3 offset1:20
M v[168:171],v[228:231],a[252:255],v[168:171]
buffer_load_dwordx4 a[224:227],v250,s[20:23],s48 offen offset:1024 sc1
M v[168:171],a[196:199],a[204:207],v[168:171]
M v[168:171],a[244:247],a[232:235],v[168:171]
ds_write2st64_b64 v247,v[212:213],v[214:215] offset0:139 offset1:156
M v[172:175],a[244:247],a[236:239],v[172:175]
buffer_load_dwordx4 a[208:211],v250,s[20:23],s48 offen offset:2048 sc1
M v[172:175],a[196:199],a[232:235],v[172:175]
s_add_u32 s46,s75,18432
M v[172:175],v[228:231],a[204:207],v[172:175]
M v[176:179],v[228:231],a[232:235],v[176:179]
M v[176:179],a[196:199],a[236:239],v[176:179]
buffer_load_dwordx4 a[252:255],v250,s[20:23],s46 offen offset:0 sc1
M v[176:179],a[244:247],a[220:223],v[176:179]
s_waitcnt lgkmcnt(0)
s_barrier
v_add_u32 v248,0xffffbc00,v248
M v[180:183],a[244:247],a[228:231],v[180:183]
v_add_u32 v249,0xffffbc00,v249
M v[180:183],a[196:199],a[220:223],v[180:183]
ds_read_b128 a[204:207],v248 offset:0
M v[180:183],v[228:231],a[236:239],v[180:183]
buffer_load_dwordx4 v[204:207],v251,s[88:91],s28 offen offset:0
M v[184:187],v[228:231],a[220:223],v[184:187]
ds_read_b128 a[232:235],v249 offset:0
ds_read_b128 a[236:239],v248 offset:512
M v[184:187],a[196:199],a[228:231],v[184:187]
s_waitcnt vmcnt(17)
ds_read_b128 a[220:223],v249 offset:512
v_permlane32_swap_b32 v196,v198
M v[184:187],a[244:247],a[212:215],v[184:187]
s_waitcnt vmcnt(16)
v_permlane32_swap_b32 v192,v194
v_permlane32_swap_b32 v200,v202
M v[188:191],a[244:247],v[220:223],v[188:191]
buffer_load_dwordx4 v[208:211],v245,s[8:11],s28 offen offset:0
M v[188:191],a[196:199],a[212:215],v[188:191]
v_lshlrev_b32 v234,16,v198
v_lshlrev_b32 v232,16,v192
M v[188:191],v[228:231],a[228:231],v[188:191]
s_waitcnt lgkmcnt(3)
v_lshlrev_b32 v233,16,v196
v_lshlrev_b32 v237,16,v194
M a[0:3],v[216:219],a[204:207],a[0:3]
s_waitcnt vmcnt(10) lgkmcnt(2)
ds_read_b128 a[244:247],v248 offset:1024
v_lshlrev_b32 v236,16,v202
M a[0:3],a[216:219],a[232:235],a[0:3]
s_waitcnt vmcnt(9) lgkmcnt(2)
buffer_load_dwordx4 v[212:215],v245,s[8:11],s28 offen offset:768
M a[0:3],a[240:243],a[236:239],a[0:3]
s_waitcnt lgkmcnt(1)
ds_read_b128 v[220:223],v249 offset:1024
v_lshlrev_b32 v235,16,v200
M a[4:7],a[240:243],a[220:223],a[4:7]
v_fmac_f32 v232,s43,v234
v_fmac_f32 v237,4.0,v233
M a[4:7],a[216:219],a[236:239],a[4:7]
v_fma_f32 v238,-4.0,v234,v236
v_fmac_f32 v232,s45,v236
M a[4:7],v[216:219],a[232:235],a[4:7]
v_fmac_f32 v237,s41,v235
v_sub_f32 v236,v236,v234
M a[8:11],v[216:219],a[236:239],a[8:11]
ds_read_b128 a[196:199],v248 offset:1536
v_fma_f32 v234,-4.0,v233,v235
M a[8:11],a[216:219],a[220:223],a[8:11]
s_waitcnt lgkmcnt(2)
ds_read_b128 a[212:215],v249 offset:1536
v_sub_f32 v235,v235,v233
M a[8:11],a[240:243],a[244:247],a[8:11]
s_waitcnt lgkmcnt(2)
v_add_f32 v233,v238,v234
v_sub_f32 v238,v238,v234
M a[12:15],a[240:243],v[220:223],a[12:15]
v_fma_f32 v234,2.0,v235,v236
v_fmac_f32 v236,-2.0,v235
M a[12:15],a[216:219],a[244:247],a[12:15]
v_and_b32 v198,s42,v198
v_and_b32 v192,s42,v192
M a[12:15],v[216:219],a[220:223],a[12:15]
v_and_b32 v196,s42,v196
v_and_b32 v194,s42,v194
M a[16:19],v[216:219],a[244:247],a[16:19]
ds_read_b128 a[228:231],v249 offset:2048
v_and_b32 v202,s42,v202
M a[16:19],a[216:219],v[220:223],a[16:19]
s_waitcnt lgkmcnt(2)
ds_read_b128 v[228:231],v248 offset:2048
v_and_b32 v200,s42,v200
M a[16:19],a[240:243],a[196:199],a[16:19]
s_waitcnt lgkmcnt(2)
v_fmac_f32 v192,s43,v198
v_fmac_f32 v194,4.0,v196
M a[20:23],a[240:243],a[212:215],a[20:23]
v_fma_f32 v235,-4.0,v198,v202
v_fmac_f32 v192,s45,v202
M a[20:23],a[216:219],a[196:199],a[20:23]
v_fmac_f32 v194,s41,v200
v_sub_f32 v202,v202,v198
M a[20:23],v[216:219],v[220:223],a[20:23]
v_fma_f32 v198,-4.0,v196,v200
v_sub_f32 v200,v200,v196
M a[24:27],v[216:219],a[196:199],a[24:27]
v_add_f32 v196,v235,v198
v_sub_f32 v235,v235,v198
M a[24:27],a[216:219],a[212:215],a[24:27]
s_waitcnt lgkmcnt(1)
v_fma_f32 v198,2.0,v200,v202
v_fmac_f32 v202,-2.0,v200
M a[24:27],a[240:243],a[228:231],a[24:27]
s_waitcnt lgkmcnt(0)
v_cvt_pk_bf16_f32 v192,v232,v192
v_cvt_pk_bf16_f32 v194,v237,v194
M a[28:31],a[240:243],v[228:231],a[28:31]
buffer_load_dwordx4 a[240:243],v250,s[20:23],s46 offen offset:1024 sc1
M a[28:31],a[216:219],a[228:231],a[28:31]
v_cvt_pk_bf16_f32 v196,v233,v196
v_cvt_pk_bf16_f32 v200,v234,v198
M a[28:31],v[216:219],a[212:215],a[28:31]
s_waitcnt vmcnt(10)
buffer_load_dwordx4 a[216:219],v250,s[20:23],s46 offen offset:2048 sc1
M a[32:35],v[224:227],a[204:207],a[32:35]
s_waitcnt vmcnt(10)
s_add_u32 s47,s75,21504
v_cvt_pk_bf16_f32 v198,v238,v235
v_cvt_pk_bf16_f32 v202,v236,v202
M a[32:35],a[200:203],a[232:235],a[32:35]
s_waitcnt vmcnt(9)
v_permlane32_swap_b32 v197,v199
v_permlane32_swap_b32 v193,v195
M a[32:35],a[192:195],a[236:239],a[32:35]
v_permlane32_swap_b32 v201,v203
v_lshlrev_b32 v234,16,v199
M a[36:39],a[192:195],a[220:223],a[36:39]
buffer_load_dwordx4 v[216:219],v250,s[20:23],s47 offen offset:0 sc1
M a[36:39],a[200:203],a[236:239],a[36:39]
v_lshlrev_b32 v232,16,v193
v_lshlrev_b32 v233,16,v197
M a[36:39],v[224:227],a[232:235],a[36:39]
v_lshlrev_b32 v237,16,v195
v_lshlrev_b32 v236,16,v203
M a[40:43],v[224:227],a[236:239],a[40:43]
v_lshlrev_b32 v235,16,v201
v_fmac_f32 v232,s43,v234
M a[40:43],a[200:203],a[220:223],a[40:43]
v_fmac_f32 v237,4.0,v233
v_fma_f32 v238,-4.0,v234,v236
M a[40:43],a[192:195],a[244:247],a[40:43]
v_fmac_f32 v232,s45,v236
v_fmac_f32 v237,s41,v235
M a[44:47],a[192:195],v[220:223],a[44:47]
v_sub_f32 v236,v236,v234
v_fma_f32 v234,-4.0,v233,v235
M a[44:47],a[200:203],a[244:247],a[44:47]
v_sub_f32 v235,v235,v233
v_add_f32 v233,v238,v234
M a[44:47],v[224:227],a[220:223],a[44:47]
v_sub_f32 v238,v238,v234
v_fma_f32 v234,2.0,v235,v236
M a[48:51],v[224:227],a[244:247],a[48:51]
v_fmac_f32 v236,-2.0,v235
v_and_b32 v199,s42,v199
M a[48:51],a[200:203],v[220:223],a[48:51]
v_and_b32 v193,s42,v193
v_and_b32 v197,s42,v197
M a[48:51],a[192:195],a[196:199],a[48:51]
v_and_b32 v195,s42,v195
v_and_b32 v203,s42,v203
M a[52:55],a[192:195],a[212:215],a[52:55]
v_and_b32 v201,s42,v201
v_fmac_f32 v193,s43,v199
M a[52:55],a[200:203],a[196:199],a[52:55]
v_fmac_f32 v195,4.0,v197
v_fma_f32 v235,-4.0,v199,v203
M a[52:55],v[224:227],v[220:223],a[52:55]
v_fmac_f32 v193,s45,v203
v_fmac_f32 v195,s41,v201
M a[56:59],v[224:227],a[196:199],a[56:59]
v_sub_f32 v203,v203,v199
v_fma_f32 v199,-4.0,v197,v201
M a[56:59],a[200:203],a[212:215],a[56:59]
v_sub_f32 v201,v201,v197
v_add_f32 v197,v235,v199
M a[56:59],a[192:195],a[228:231],a[56:59]
v_sub_f32 v235,v235,v199
v_fma_f32 v199,2.0,v201,v203
M a[60:63],a[192:195],v[228:231],a[60:63]
buffer_load_dwordx4 a[192:195],v250,s[20:23],s47 offen offset:1024 sc1
M a[60:63],a[200:203],a[228:231],a[60:63]
v_fmac_f32 v203,-2.0,v201
v_cvt_pk_bf16_f32 v193,v232,v193
M a[60:63],v[224:227],a[212:215],a[60:63]
s_waitcnt vmcnt(10)
buffer_load_dwordx4 a[200:203],v250,s[20:23],s47 offen offset:2048 sc1
M a[64:67],a[248:251],a[204:207],a[64:67]
s_waitcnt vmcnt(10)
s_add_u32 s48,s75,24576
v_cvt_pk_bf16_f32 v195,v237,v195
v_cvt_pk_bf16_f32 v197,v233,v197
M a[64:67],a[224:227],a[232:235],a[64:67]
s_waitcnt vmcnt(9)
v_cvt_pk_bf16_f32 v201,v234,v199
v_cvt_pk_bf16_f32 v199,v238,v235
M a[64:67],a[208:211],a[236:239],a[64:67]
v_cvt_pk_bf16_f32 v203,v236,v203
v_add_u32 v238,139264,v247
M a[68:71],a[208:211],a[220:223],a[68:71]
buffer_load_dwordx4 v[224:227],v250,s[20:23],s48 offen offset:0 sc1
M a[68:71],a[224:227],a[236:239],a[68:71]
M a[68:71],a[248:251],a[232:235],a[68:71]
ds_write2st64_b64 v238,v[192:193],v[194:195] offset0:0 offset1:17
M a[72:75],a[248:251],a[236:239],a[72:75]
s_add_u32 s28,s70,7077888
M a[72:75],a[224:227],a[220:223],a[72:75]
buffer_load_dwordx4 a[204:207],v250,s[20:23],s48 offen offset:1024 sc1
M a[72:75],a[208:211],a[244:247],a[72:75]
ds_write2st64_b64 v247,v[196:197],v[198:199] offset0:34 offset1:51
M a[76:79],a[208:211],v[220:223],a[76:79]
M a[76:79],a[224:227],a[244:247],a[76:79]
buffer_load_dwordx4 a[232:235],v250,s[20:23],s48 offen offset:2048 sc1
M a[76:79],a[248:251],a[220:223],a[76:79]
s_add_u32 s46,s75,27648
ds_write2st64_b64 v247,v[200:201],v[202:203] offset0:68 offset1:85
M a[80:83],a[248:251],a[244:247],a[80:83]
M a[80:83],a[224:227],v[220:223],a[80:83]
buffer_load_dwordx4 a[236:239],v250,s[20:23],s46 offen offset:0 sc1
M a[80:83],a[208:211],a[196:199],a[80:83]
M a[84:87],a[208:211],a[212:215],a[84:87]
M a[84:87],a[224:227],a[196:199],a[84:87]
ds_read_b128 a[220:223],v248 offset:8704
M a[84:87],a[248:251],v[220:223],a[84:87]
buffer_load_dwordx4 v[192:195],v251,s[88:91],s28 offen offset:0
M a[88:91],a[248:251],a[196:199],a[88:91]
ds_read_b128 a[244:247],v249 offset:8704
ds_read_b128 v[220:223],v248 offset:9216
M a[88:91],a[224:227],a[212:215],a[88:91]
s_waitcnt vmcnt(11)
ds_read_b128 a[196:199],v249 offset:9216
v_permlane32_swap_b32 v208,v210
M a[88:91],a[208:211],a[228:231],a[88:91]
s_waitcnt vmcnt(10)
v_permlane32_swap_b32 v204,v206
v_permlane32_swap_b32 v212,v214
M a[92:95],a[208:211],v[228:231],a[92:95]
buffer_load_dwordx4 v[196:199],v245,s[8:11],s28 offen offset:0
M a[92:95],a[224:227],a[228:231],a[92:95]
v_lshlrev_b32 v234,16,v210
v_lshlrev_b32 v232,16,v204
M a[92:95],a[248:251],a[212:215],a[92:95]
s_waitcnt lgkmcnt(3)
v_lshlrev_b32 v233,16,v208
v_lshlrev_b32 v237,16,v206
M a[96:99],a[252:255],a[220:223],a[96:99]
s_waitcnt vmcnt(10) lgkmcnt(2)
ds_read_b128 a[208:211],v248 offset:9728
v_lshlrev_b32 v236,16,v214
M a[96:99],a[240:243],a[244:247],a[96:99]
s_waitcnt vmcnt(9) lgkmcnt(2)
buffer_load_dwordx4 v[200:203],v245,s[8:11],s28 offen offset:768
M a[96:99],a[216:219],v[220:223],a[96:99]
s_waitcnt lgkmcnt(1)
ds_read_b128 v[228:231],v249 offset:9728
v_lshlrev_b32 v235,16,v212
M a[100:103],a[216:219],a[196:199],a[100:103]
v_fmac_f32 v232,s43,v234
v_fmac_f32 v237,4.0,v233
M a[100:103],a[240:243],v[220:223],a[100:103]
v_fma_f32 v238,-4.0,v234,v236
v_fmac_f32 v232,s45,v236
M a[100:103],a[252:255],a[244:247],a[100:103]
v_fmac_f32 v237,s41,v235
v_sub_f32 v236,v236,v234
M a[104:107],a[252:255],v[220:223],a[104:107]
ds_read_b128 a[224:227],v248 offset:10240
v_fma_f32 v234,-4.0,v233,v235
M a[104:107],a[240:243],a[196:199],a[104:107]
s_waitcnt lgkmcnt(2)
ds_read_b128 a[228:231],v249 offset:10240
v_sub_f32 v235,v235,v233
M a[104:107],a[216:219],a[208:211],a[104:107]
s_waitcnt lgkmcnt(2)
v_add_f32 v233,v238,v234
v_sub_f32 v238,v238,v234
M a[108:111],a[216:219],v[228:231],a[108:111]
v_fma_f32 v234,2.0,v235,v236
v_fmac_f32 v236,-2.0,v235
M a[108:111],a[240:243],a[208:211],a[108:111]
v_and_b32 v210,s42,v210
v_and_b32 v204,s42,v204
M a[108:111],a[252:255],a[196:199],a[108:111]
v_and_b32 v208,s42,v208
v_and_b32 v206,s42,v206
M a[112:115],a[252:255],a[208:211],a[112:115]
ds_read_b128 a[212:215],v249 offset:10752
v_and_b32 v214,s42,v214
M a[112:115],a[240:243],v[228:231],a[112:115]
s_waitcnt lgkmcnt(2)
ds_read_b128 a[248:251],v248 offset:10752
v_and_b32 v212,s42,v212
M a[112:115],a[216:219],a[224:227],a[112:115]
s_waitcnt lgkmcnt(2)
v_fmac_f32 v204,s43,v210
v_fmac_f32 v206,4.0,v208
M a[116:119],a[216:219],a[228:231],a[116:119]
v_fma_f32 v235,-4.0,v210,v214
v_fmac_f32 v204,s45,v214
M a[116:119],a[240:243],a[224:227],a[116:119]
v_fmac_f32 v206,s41,v212
v_sub_f32 v214,v214,v210
M a[116:119],a[252:255],v[228:231],a[116:119]
v_fma_f32 v210,-4.0,v208,v212
v_sub_f32 v212,v212,v208
M a[120:123],a[252:255],a[224:227],a[120:123]
v_add_f32 v208,v235,v210
v_sub_f32 v235,v235,v210
M a[120:123],a[240:243],a[228:231],a[120:123]
s_waitcnt lgkmcnt(1)
v_fma_f32 v210,2.0,v212,v214
v_fmac_f32 v214,-2.0,v212
M a[120:123],a[216:219],a[212:215],a[120:123]
s_waitcnt lgkmcnt(0)
v_cvt_pk_bf16_f32 v204,v232,v204
v_cvt_pk_bf16_f32 v206,v237,v206
M a[124:127],a[216:219],a[248:251],a[124:127]
buffer_load_dwordx4 a[216:219],v250,s[20:23],s46 offen offset:1024 sc1
M a[124:127],a[240:243],a[212:215],a[124:127]
v_cvt_pk_bf16_f32 v208,v233,v208
v_cvt_pk_bf16_f32 v212,v234,v210
M a[124:127],a[252:255],a[228:231],a[124:127]
s_waitcnt vmcnt(10)
buffer_load_dwordx4 a[240:243],v250,s[20:23],s46 offen offset:2048 sc1
M a[128:131],v[216:219],a[220:223],a[128:131]
s_waitcnt vmcnt(10)
s_add_u32 s47,s75,30720
v_cvt_pk_bf16_f32 v210,v238,v235
v_cvt_pk_bf16_f32 v214,v236,v214
M a[128:131],a[192:195],a[244:247],a[128:131]
s_waitcnt vmcnt(9)
v_permlane32_swap_b32 v209,v211
v_permlane32_swap_b32 v205,v207
M a[128:131],a[200:203],v[220:223],a[128:131]
v_permlane32_swap_b32 v213,v215
v_lshlrev_b32 v234,16,v211
M a[132:135],a[200:203],a[196:199],a[132:135]
buffer_load_dwordx4 a[252:255],v250,s[20:23],s47 offen offset:0 sc1
M a[132:135],a[192:195],v[220:223],a[132:135]
v_lshlrev_b32 v232,16,v205
v_lshlrev_b32 v233,16,v209
M a[132:135],v[216:219],a[244:247],a[132:135]
v_lshlrev_b32 v237,16,v207
v_lshlrev_b32 v236,16,v215
M a[136:139],v[216:219],v[220:223],a[136:139]
v_lshlrev_b32 v235,16,v213
v_fmac_f32 v232,s43,v234
M a[136:139],a[192:195],a[196:199],a[136:139]
v_fmac_f32 v237,4.0,v233
v_fma_f32 v238,-4.0,v234,v236
M a[136:139],a[200:203],a[208:211],a[136:139]
v_fmac_f32 v232,s45,v236
v_fmac_f32 v237,s41,v235
M a[140:143],a[200:203],v[228:231],a[140:143]
v_sub_f32 v236,v236,v234
v_fma_f32 v234,-4.0,v233,v235
M a[140:143],a[192:195],a[208:211],a[140:143]
v_sub_f32 v235,v235,v233
v_add_f32 v233,v238,v234
M a[140:143],v[216:219],a[196:199],a[140:143]
v_sub_f32 v238,v238,v234
v_fma_f32 v234,2.0,v235,v236
M a[144:147],v[216:219],a[208:211],a[144:147]
v_fmac_f32 v236,-2.0,v235
v_and_b32 v211,s42,v211
M a[144:147],a[192:195],v[228:231],a[144:147]
v_and_b32 v205,s42,v205
v_and_b32 v209,s42,v209
M a[144:147],a[200:203],a[224:227],a[144:147]
v_and_b32 v207,s42,v207
v_and_b32 v215,s42,v215
M a[148:151],a[200:203],a[228:231],a[148:151]
v_and_b32 v213,s42,v213
v_fmac_f32 v205,s43,v211
M a[148:151],a[192:195],a[224:227],a[148:151]
v_fmac_f32 v207,4.0,v209
v_fma_f32 v235,-4.0,v211,v215
M a[148:151],v[216:219],v[228:231],a[148:151]
v_fmac_f32 v205,s45,v215
v_fmac_f32 v207,s41,v213
M a[152:155],v[216:219],a[224:227],a[152:155]
v_sub_f32 v215,v215,v211
v_fma_f32 v211,-4.0,v209,v213
M a[152:155],a[192:195],a[228:231],a[152:155]
v_sub_f32 v213,v213,v209
v_add_f32 v209,v235,v211
M a[152:155],a[200:203],a[212:215],a[152:155]
v_sub_f32 v235,v235,v211
v_fma_f32 v211,2.0,v213,v215
M a[156:159],a[200:203],a[248:251],a[156:159]
buffer_load_dwordx4 a[200:203],v250,s[20:23],s47 offen offset:1024 sc1
M a[156:159],a[192:195],a[212:215],a[156:159]
v_fmac_f32 v215,-2.0,v213
v_cvt_pk_bf16_f32 v205,v232,v205
M a[156:159],v[216:219],a[228:231],a[156:159]
s_waitcnt vmcnt(10)
buffer_load_dwordx4 a[192:195],v250,s[20:23],s47 offen offset:2048 sc1
M a[160:163],v[224:227],a[220:223],a[160:163]
s_waitcnt vmcnt(10)
s_add_u32 s48,s75,33792
v_cvt_pk_bf16_f32 v207,v237,v207
v_cvt_pk_bf16_f32 v209,v233,v209
M a[160:163],a[204:207],a[244:247],a[160:163]
s_waitcnt vmcnt(9)
v_cvt_pk_bf16_f32 v213,v234,v211
v_cvt_pk_bf16_f32 v211,v238,v235
M a[160:163],a[232:235],v[220:223],a[160:163]
v_cvt_pk_bf16_f32 v215,v236,v215
v_add_u32 v238,139264,v247
M a[164:167],a[232:235],a[196:199],a[164:167]
buffer_load_dwordx4 v[216:219],v250,s[20:23],s48 offen offset:0 sc1
M a[164:167],a[204:207],v[220:223],a[164:167]
v_fmac_f32 v239,s43,v241
v_fmac_f32 v244,4.0,v240
M a[164:167],v[224:227],a[244:247],a[164:167]
ds_write2st64_b64 v238,v[204:205],v[206:207] offset0:1 offset1:18
M a[168:171],v[224:227],v[220:223],a[168:171]
s_add_u32 s28,s70,7471104
v_fma_f32 v232,-4.0,v241,v243
v_fmac_f32 v239,s45,v243
M a[168:171],a[204:207],a[196:199],a[168:171]
buffer_load_dwordx4 a[220:223],v250,s[20:23],s48 offen offset:1024 sc1
M a[168:171],a[232:235],a[208:211],a[168:171]
ds_write2st64_b64 v247,v[208:209],v[210:211] offset0:35 offset1:52
M a[172:175],a[232:235],v[228:231],a[172:175]
v_fmac_f32 v244,s41,v242
v_sub_f32 v243,v243,v241
M a[172:175],a[204:207],a[208:211],a[172:175]
buffer_load_dwordx4 a[244:247],v250,s[20:23],s48 offen offset:2048 sc1
M a[172:175],v[224:227],a[196:199],a[172:175]
s_add_u32 s46,s75,36864
ds_write2st64_b64 v247,v[212:213],v[214:215] offset0:69 offset1:86
M a[176:179],v[224:227],a[208:211],a[176:179]
v_fma_f32 v241,-4.0,v240,v242
v_sub_f32 v242,v242,v240
M a[176:179],a[204:207],v[228:231],a[176:179]
buffer_load_dwordx4 v[220:223],v250,s[20:23],s46 offen offset:0 sc1
M a[176:179],a[232:235],a[224:227],a[176:179]
v_add_u32 v248,0x4400,v248
v_add_u32 v249,0x4400,v249
M a[180:183],a[232:235],a[228:231],a[180:183]
v_add_f32 v240,v232,v241
v_sub_f32 v232,v232,v241
M a[180:183],a[204:207],a[224:227],a[180:183]
ds_read_b128 a[196:199],v248 offset:52224
v_fma_f32 v241,2.0,v242,v243
M a[180:183],v[224:227],v[228:231],a[180:183]
buffer_load_dwordx4 v[204:207],v251,s[88:91],s28 offen offset:0
M a[184:187],v[224:227],a[224:227],a[184:187]
ds_read_b128 a[208:211],v249 offset:52224
ds_read_b128 v[228:231],v248 offset:52736
M a[184:187],a[204:207],a[228:231],a[184:187]
ds_read_b128 a[224:227],v249 offset:52736
v_fmac_f32 v243,-2.0,v242
M a[184:187],a[232:235],a[212:215],a[184:187]
v_cvt_pk_bf16_f32 v233,v239,v244
v_cvt_pk_bf16_f32 v234,v240,v232
M a[188:191],a[232:235],a[248:251],a[188:191]
buffer_load_dwordx4 v[208:211],v245,s[8:11],s28 offen offset:0
M a[188:191],a[204:207],a[212:215],a[188:191]
v_cvt_pk_bf16_f32 v235,v241,v243
v_add_u32 v232,139264,v252
M a[188:191],v[224:227],a[228:231],a[188:191]
s_waitcnt vmcnt(14) lgkmcnt(3)
ds_write_b16 v232,v233 offset:0
M v[0:3],a[236:239],a[196:199],v[0:3]
s_waitcnt vmcnt(10) lgkmcnt(3)
ds_read_b128 a[232:235],v248 offset:53248
ds_write_b16_d16_hi v232,v233 offset:8704
M v[0:3],a[216:219],a[208:211],v[0:3]
s_waitcnt vmcnt(9) lgkmcnt(4)
buffer_load_dwordx4 v[212:215],v245,s[8:11],s28 offen offset:768
M v[0:3],a[240:243],v[228:231],v[0:3]
s_waitcnt lgkmcnt(3)
s_add_u32 s29,s71,6291456
ds_read_b128 a[248:251],v249 offset:53248
ds_write_b16 v252,v234 offset:17408
M v[4:7],a[240:243],a[224:227],v[4:7]
ds_write_b16_d16_hi v252,v234 offset:26112
M v[4:7],a[216:219],v[228:231],v[4:7]
ds_write_b16 v252,v235 offset:34816
M v[4:7],a[236:239],a[208:211],v[4:7]
buffer_load_short_d16_hi v239,v246,s[12:15],s29 offen offset:0
M v[8:11],a[236:239],v[228:231],v[8:11]
ds_read_b128 a[204:207],v248 offset:53760
ds_write_b16_d16_hi v252,v235 offset:43520
M v[8:11],a[216:219],a[224:227],v[8:11]
s_waitcnt lgkmcnt(7)
buffer_load_short_d16_hi v240,v246,s[8:11],s29 offen offset:0
M v[8:11],a[240:243],a[232:235],v[8:11]
s_waitcnt lgkmcnt(5)
buffer_load_short_d16_hi v241,v246,s[8:11],s29 offen offset:384
M v[12:15],a[240:243],a[248:251],v[12:15]
ds_read_b128 a[212:215],v249 offset:53760
v_permlane32_swap_b32 v196,v198
M v[12:15],a[216:219],a[232:235],v[12:15]
buffer_load_short_d16_hi v242,v246,s[8:11],s29 offen offset:768
M v[12:15],a[236:239],a[224:227],v[12:15]
v_permlane32_swap_b32 v192,v194
v_permlane32_swap_b32 v200,v202
M v[16:19],a[236:239],a[232:235],v[16:19]
buffer_load_short_d16_hi v243,v246,s[8:11],s29 offen offset:1152
M v[16:19],a[216:219],a[248:251],v[16:19]
s_waitcnt lgkmcnt(2)
ds_read_b128 a[228:231],v249 offset:54272
ds_read_b128 v[224:227],v248 offset:54272
M v[16:19],a[240:243],a[204:207],v[16:19]
s_waitcnt lgkmcnt(2)
buffer_load_short_d16_hi v244,v246,s[16:19],s29 offen offset:1536
M v[20:23],a[240:243],a[212:215],v[20:23]
v_lshlrev_b32 v234,16,v198
v_lshlrev_b32 v232,16,v192
M v[20:23],a[216:219],a[204:207],v[20:23]
v_lshlrev_b32 v233,16,v196
v_lshlrev_b32 v237,16,v194
M v[20:23],a[236:239],a[248:251],v[20:23]
v_lshlrev_b32 v236,16,v202
v_lshlrev_b32 v235,16,v200
M v[24:27],a[236:239],a[204:207],v[24:27]
v_fmac_f32 v232,s43,v234
v_fmac_f32 v237,4.0,v233
M v[24:27],a[216:219],a[212:215],v[24:27]
s_waitcnt lgkmcnt(1)
v_fma_f32 v238,-4.0,v234,v236
v_fmac_f32 v232,s45,v236
M v[24:27],a[240:243],a[228:231],v[24:27]
s_waitcnt lgkmcnt(0)
v_fmac_f32 v237,s41,v235
v_sub_f32 v236,v236,v234
M v[28:31],a[240:243],v[224:227],v[28:31]
buffer_load_dwordx4 a[240:243],v250,s[20:23],s46 offen offset:1024 sc1
M v[28:31],a[216:219],a[228:231],v[28:31]
v_fma_f32 v234,-4.0,v233,v235
v_sub_f32 v235,v235,v233
M v[28:31],a[236:239],a[212:215],v[28:31]
s_waitcnt vmcnt(16)
buffer_load_dwordx4 a[216:219],v250,s[20:23],s46 offen offset:2048 sc1
M v[32:35],a[252:255],a[196:199],v[32:35]
s_waitcnt vmcnt(16)
s_add_u32 s47,s75,39936
v_add_f32 v233,v238,v234
v_sub_f32 v238,v238,v234
M v[32:35],a[200:203],a[208:211],v[32:35]
s_waitcnt vmcnt(15)
v_fma_f32 v234,2.0,v235,v236
v_fmac_f32 v236,-2.0,v235
M v[32:35],a[192:195],v[228:231],v[32:35]
v_and_b32 v198,s42,v198
v_and_b32 v192,s42,v192
M v[36:39],a[192:195],a[224:227],v[36:39]
buffer_load_dwordx4 a[236:239],v250,s[20:23],s47 offen offset:0 sc1
M v[36:39],a[200:203],v[228:231],v[36:39]
v_and_b32 v196,s42,v196
v_and_b32 v194,s42,v194
M v[36:39],a[252:255],a[208:211],v[36:39]
v_and_b32 v202,s42,v202
v_and_b32 v200,s42,v200
M v[40:43],a[252:255],v[228:231],v[40:43]
v_fmac_f32 v192,s43,v198
v_fmac_f32 v194,4.0,v196
M v[40:43],a[200:203],a[224:227],v[40:43]
v_fma_f32 v235,-4.0,v198,v202
v_fmac_f32 v192,s45,v202
M v[40:43],a[192:195],a[232:235],v[40:43]
v_fmac_f32 v194,s41,v200
v_sub_f32 v202,v202,v198
M v[44:47],a[192:195],a[248:251],v[44:47]
v_fma_f32 v198,-4.0,v196,v200
v_sub_f32 v200,v200,v196
M v[44:47],a[200:203],a[232:235],v[44:47]
v_add_f32 v196,v235,v198
v_sub_f32 v235,v235,v198
M v[44:47],a[252:255],a[224:227],v[44:47]
v_fma_f32 v198,2.0,v200,v202
v_fmac_f32 v202,-2.0,v200
M v[48:51],a[252:255],a[232:235],v[48:51]
v_cvt_pk_bf16_f32 v192,v232,v192
v_cvt_pk_bf16_f32 v194,v237,v194
M v[48:51],a[200:203],a[248:251],v[48:51]
v_cvt_pk_bf16_f32 v196,v233,v196
v_cvt_pk_bf16_f32 v200,v234,v198
M v[48:51],a[192:195],a[204:207],v[48:51]
v_cvt_pk_bf16_f32 v198,v238,v235
v_cvt_pk_bf16_f32 v202,v236,v202
M v[52:55],a[192:195],a[212:215],v[52:55]
v_permlane32_swap_b32 v197,v199
v_permlane32_swap_b32 v193,v195
M v[52:55],a[200:203],a[204:207],v[52:55]
v_permlane32_swap_b32 v201,v203
v_lshlrev_b32 v234,16,v199
M v[52:55],a[252:255],a[248:251],v[52:55]
v_lshlrev_b32 v232,16,v193
v_lshlrev_b32 v233,16,v197
M v[56:59],a[252:255],a[204:207],v[56:59]
v_lshlrev_b32 v237,16,v195
v_lshlrev_b32 v236,16,v203
M v[56:59],a[200:203],a[212:215],v[56:59]
v_lshlrev_b32 v235,16,v201
v_fmac_f32 v232,s43,v234
M v[56:59],a[192:195],a[228:231],v[56:59]
v_fmac_f32 v237,4.0,v233
v_fma_f32 v238,-4.0,v234,v236
M v[60:63],a[192:195],v[224:227],v[60:63]
buffer_load_dwordx4 a[192:195],v250,s[20:23],s47 offen offset:1024 sc1
M v[60:63],a[200:203],a[228:231],v[60:63]
v_fmac_f32 v232,s45,v236
v_fmac_f32 v237,s41,v235
M v[60:63],a[252:255],a[212:215],v[60:63]
s_waitcnt vmcnt(16)
buffer_load_dwordx4 a[200:203],v250,s[20:23],s47 offen offset:2048 sc1
M v[64:67],v[216:219],a[196:199],v[64:67]
s_waitcnt vmcnt(16)
s_add_u32 s48,s75,43008
v_sub_f32 v236,v236,v234
v_fma_f32 v234,-4.0,v233,v235
M v[64:67],a[220:223],a[208:211],v[64:67]
s_waitcnt vmcnt(15)
v_sub_f32 v235,v235,v233
v_add_f32 v233,v238,v234
M v[64:67],a[244:247],v[228:231],v[64:67]
v_sub_f32 v238,v238,v234
v_fma_f32 v234,2.0,v235,v236
M v[68:71],a[244:247],a[224:227],v[68:71]
buffer_load_dwordx4 a[252:255],v250,s[20:23],s48 offen offset:0 sc1
M v[68:71],a[220:223],v[228:231],v[68:71]
v_fmac_f32 v236,-2.0,v235
v_and_b32 v199,s42,v199
M v[68:71],v[216:219],a[208:211],v[68:71]
v_and_b32 v193,s42,v193
v_and_b32 v197,s42,v197
M v[72:75],v[216:219],v[228:231],v[72:75]
v_and_b32 v195,s42,v195
v_and_b32 v203,s42,v203
M v[72:75],a[220:223],a[224:227],v[72:75]
buffer_load_dwordx4 a[196:199],v250,s[20:23],s48 offen offset:1024 sc1
M v[72:75],a[244:247],a[232:235],v[72:75]
v_and_b32 v201,s42,v201
v_fmac_f32 v193,s43,v199
M v[76:79],a[244:247],a[248:251],v[76:79]
v_fmac_f32 v195,4.0,v197
v_fma_f32 v235,-4.0,v199,v203
M v[76:79],a[220:223],a[232:235],v[76:79]
v_fmac_f32 v193,s45,v203
v_fmac_f32 v195,s41,v201
M v[76:79],v[216:219],a[224:227],v[76:79]
buffer_load_dwordx4 a[208:211],v250,s[20:23],s48 offen offset:2048 sc1
M v[80:83],v[216:219],a[232:235],v[80:83]
s_add_u32 s46,s76,9216
v_sub_f32 v203,v203,v199
v_fma_f32 v199,-4.0,v197,v201
M v[80:83],a[220:223],a[248:251],v[80:83]
v_sub_f32 v201,v201,v197
v_add_f32 v197,v235,v199
M v[80:83],a[244:247],a[204:207],v[80:83]
v_sub_f32 v235,v235,v199
v_fma_f32 v199,2.0,v201,v203
M v[84:87],a[244:247],a[212:215],v[84:87]
buffer_load_dwordx4 v[228:231],v250,s[20:23],s46 offen offset:0 sc1
M v[84:87],a[220:223],a[204:207],v[84:87]
ds_read_b128 a[224:227],v248 offset:60928
v_fmac_f32 v203,-2.0,v201
M v[84:87],v[216:219],a[248:251],v[84:87]
ds_read_b128 a[232:235],v249 offset:60928
v_cvt_pk_bf16_f32 v193,v232,v193
M v[88:91],v[216:219],a[204:207],v[88:91]
ds_read_b128 a[248:251],v248 offset:61440
v_cvt_pk_bf16_f32 v195,v237,v195
M v[88:91],a[220:223],a[212:215],v[88:91]
ds_read_b128 a[204:207],v249 offset:61440
v_cvt_pk_bf16_f32 v197,v233,v197
M v[88:91],a[244:247],a[228:231],v[88:91]
v_cvt_pk_bf16_f32 v201,v234,v199
v_cvt_pk_bf16_f32 v199,v238,v235
M v[92:95],a[244:247],v[224:227],v[92:95]
v_cvt_pk_bf16_f32 v203,v236,v203
v_add_u32 v238,139264,v247
M v[92:95],a[220:223],a[228:231],v[92:95]
s_waitcnt vmcnt(16)
v_permlane32_swap_b32 v208,v210
v_permlane32_swap_b32 v204,v206
M v[92:95],v[216:219],a[212:215],v[92:95]
s_waitcnt lgkmcnt(3)
ds_write2st64_b64 v238,v[192:193],v[194:195] offset0:2 offset1:19
M v[96:99],v[220:223],a[224:227],v[96:99]
s_waitcnt vmcnt(8) lgkmcnt(3)
s_add_u32 s28,s71,6291456
buffer_load_dwordx4 v[192:195],v251,s[88:91],s28 offen offset:0
M v[96:99],a[240:243],a[232:235],v[96:99]
s_waitcnt vmcnt(8) lgkmcnt(2)
ds_read_b128 a[244:247],v248 offset:61952
ds_read_b128 v[224:227],v249 offset:61952
M v[96:99],a[216:219],a[248:251],v[96:99]
s_waitcnt lgkmcnt(3)
ds_write2st64_b64 v247,v[196:197],v[198:199] offset0:36 offset1:53
M v[100:103],a[216:219],a[204:207],v[100:103]
buffer_load_dwordx4 v[196:199],v245,s[8:11],s28 offen offset:0
M v[100:103],a[240:243],a[248:251],v[100:103]
v_permlane32_swap_b32 v212,v214
v_lshlrev_b32 v234,16,v210
M v[100:103],v[220:223],a[232:235],v[100:103]
ds_write2st64_b64 v247,v[200:201],v[202:203] offset0:70 offset1:87
M v[104:107],v[220:223],a[248:251],v[104:107]
buffer_load_dwordx4 v[200:203],v245,s[8:11],s28 offen offset:768
M v[104:107],a[240:243],a[204:207],v[104:107]
s_waitcnt lgkmcnt(3)
ds_read_b128 a[220:223],v248 offset:62464
ds_read_b128 a[228:231],v249 offset:62464
M v[104:107],a[216:219],a[244:247],v[104:107]
s_waitcnt lgkmcnt(4)
v_lshlrev_b32 v232,16,v204
v_lshlrev_b32 v233,16,v208
M v[108:111],a[216:219],v[224:227],v[108:111]
v_lshlrev_b32 v237,16,v206
v_lshlrev_b32 v236,16,v214
M v[108:111],a[240:243],a[244:247],v[108:111]
v_lshlrev_b32 v235,16,v212
v_fmac_f32 v232,s43,v234
M v[108:111],v[220:223],a[204:207],v[108:111]
v_fmac_f32 v237,4.0,v233
v_fma_f32 v238,-4.0,v234,v236
M v[112:115],v[220:223],a[244:247],v[112:115]
ds_read_b128 a[212:215],v249 offset:62976
v_fmac_f32 v232,s45,v236
M v[112:115],a[240:243],v[224:227],v[112:115]
s_waitcnt lgkmcnt(2)
ds_read_b128 v[216:219],v248 offset:62976
v_fmac_f32 v237,s41,v235
M v[112:115],a[216:219],a[220:223],v[112:115]
s_waitcnt lgkmcnt(2)
v_sub_f32 v236,v236,v234
v_fma_f32 v234,-4.0,v233,v235
M v[116:119],a[216:219],a[228:231],v[116:119]
v_sub_f32 v235,v235,v233
v_add_f32 v233,v238,v234
M v[116:119],a[240:243],a[220:223],v[116:119]
v_sub_f32 v238,v238,v234
v_fma_f32 v234,2.0,v235,v236
M v[116:119],v[220:223],v[224:227],v[116:119]
v_fmac_f32 v236,-2.0,v235
v_and_b32 v210,s42,v210
M v[120:123],v[220:223],a[220:223],v[120:123]
v_and_b32 v204,s42,v204
v_and_b32 v208,s42,v208
M v[120:123],a[240:243],a[228:231],v[120:123]
s_waitcnt lgkmcnt(1)
v_and_b32 v206,s42,v206
v_and_b32 v214,s42,v214
M v[120:123],a[216:219],a[212:215],v[120:123]
s_waitcnt lgkmcnt(0)
v_and_b32 v212,s42,v212
v_fmac_f32 v204,s43,v210
M v[124:127],a[216:219],v[216:219],v[124:127]
buffer_load_dwordx4 a[216:219],v250,s[20:23],s46 offen offset:1024 sc1
M v[124:127],a[240:243],a[212:215],v[124:127]
v_fmac_f32 v206,4.0,v208
v_fma_f32 v235,-4.0,v210,v214
M v[124:127],v[220:223],a[228:231],v[124:127]
s_waitcnt vmcnt(10)
buffer_load_dwordx4 a[240:243],v250,s[20:23],s46 offen offset:2048 sc1
M v[128:131],a[236:239],a[224:227],v[128:131]
s_waitcnt vmcnt(10)
s_add_u32 s47,s76,12288
v_fmac_f32 v204,s45,v214
v_fmac_f32 v206,s41,v212
M v[128:131],a[192:195],a[232:235],v[128:131]
s_waitcnt vmcnt(9)
v_sub_f32 v214,v214,v210
v_fma_f32 v210,-4.0,v208,v212
M v[128:131],a[200:203],a[248:251],v[128:131]
v_sub_f32 v212,v212,v208
v_add_f32 v208,v235,v210
M v[132:135],a[200:203],a[204:207],v[132:135]
buffer_load_dwordx4 v[220:223],v250,s[20:23],s47 offen offset:0 sc1
M v[132:135],a[192:195],a[248:251],v[132:135]
v_sub_f32 v235,v235,v210
v_fma_f32 v210,2.0,v212,v214
M v[132:135],a[236:239],a[232:235],v[132:135]
v_fmac_f32 v214,-2.0,v212
v_cvt_pk_bf16_f32 v204,v232,v204
M v[136:139],a[236:239],a[248:251],v[136:139]
v_cvt_pk_bf16_f32 v206,v237,v206
v_cvt_pk_bf16_f32 v208,v233,v208
M v[136:139],a[192:195],a[204:207],v[136:139]
v_cvt_pk_bf16_f32 v212,v234,v210
v_cvt_pk_bf16_f32 v210,v238,v235
M v[136:139],a[200:203],a[244:247],v[136:139]
v_cvt_pk_bf16_f32 v214,v236,v214
v_permlane32_swap_b32 v209,v211
M v[140:143],a[200:203],v[224:227],v[140:143]
v_permlane32_swap_b32 v205,v207
v_permlane32_swap_b32 v213,v215
M v[140:143],a[192:195],a[244:247],v[140:143]
v_lshlrev_b32 v234,16,v211
v_lshlrev_b32 v232,16,v205
M v[140:143],a[236:239],a[204:207],v[140:143]
v_lshlrev_b32 v233,16,v209
v_lshlrev_b32 v237,16,v207
M v[144:147],a[236:239],a[244:247],v[144:147]
v_lshlrev_b32 v236,16,v215
v_lshlrev_b32 v235,16,v213
M v[144:147],a[192:195],v[224:227],v[144:147]
v_fmac_f32 v232,s43,v234
v_fmac_f32 v237,4.0,v233
M v[144:147],a[200:203],a[220:223],v[144:147]
v_fma_f32 v238,-4.0,v234,v236
v_fmac_f32 v232,s45,v236
M v[148:151],a[200:203],a[228:231],v[148:151]
v_fmac_f32 v237,s41,v235
v_sub_f32 v236,v236,v234
M v[148:151],a[192:195],a[220:223],v[148:151]
v_fma_f32 v234,-4.0,v233,v235
v_sub_f32 v235,v235,v233
M v[148:151],a[236:239],v[224:227],v[148:151]
v_add_f32 v233,v238,v234
v_sub_f32 v238,v238,v234
M v[152:155],a[236:239],a[220:223],v[152:155]
v_fma_f32 v234,2.0,v235,v236
v_fmac_f32 v236,-2.0,v235
M v[152:155],a[192:195],a[228:231],v[152:155]
v_and_b32 v211,s42,v211
v_and_b32 v205,s42,v205
M v[152:155],a[200:203],a[212:215],v[152:155]
v_and_b32 v209,s42,v209
v_and_b32 v207,s42,v207
M v[156:159],a[200:203],v[216:219],v[156:159]
buffer_load_dwordx4 a[200:203],v250,s[20:23],s47 offen offset:1024 sc1
M v[156:159],a[192:195],a[212:215],v[156:159]
v_and_b32 v215,s42,v215
v_and_b32 v213,s42,v213
M v[156:159],a[236:239],a[228:231],v[156:159]
s_waitcnt vmcnt(10)
buffer_load_dwordx4 a[192:195],v250,s[20:23],s47 offen offset:2048 sc1
v_fmac_f32 v205,s43,v211
v_fmac_f32 v207,4.0,v209
M v[160:163],a[252:255],a[224:227],v[160:163]
s_waitcnt vmcnt(10)
s_add_u32 s48,s76,15360
v_fma_f32 v235,-4.0,v211,v215
v_fmac_f32 v205,s45,v215
v_fmac_f32 v207,s41,v213
v_sub_f32 v215,v215,v211
M v[160:163],a[196:199],a[232:235],v[160:163]
s_waitcnt vmcnt(9)
v_fma_f32 v211,-4.0,v209,v213
v_sub_f32 v213,v213,v209
v_add_f32 v209,v235,v211
v_sub_f32 v235,v235,v211
M v[160:163],a[208:211],a[248:251],v[160:163]
buffer_load_dwordx4 a[236:239],v250,s[20:23],s48 offen offset:0 sc1
v_fma_f32 v211,2.0,v213,v215
v_fmac_f32 v215,-2.0,v213
v_cvt_pk_bf16_f32 v205,v232,v205
v_cvt_pk_bf16_f32 v207,v237,v207
M v[164:167],a[208:211],a[204:207],v[164:167]
v_cvt_pk_bf16_f32 v209,v233,v209
v_cvt_pk_bf16_f32 v213,v234,v211
v_cvt_pk_bf16_f32 v211,v238,v235
v_cvt_pk_bf16_f32 v215,v236,v215
M v[164:167],a[196:199],a[248:251],v[164:167]
buffer_load_dwordx4 a[224:227],v250,s[20:23],s48 offen offset:1024 sc1
v_add_u32 v238,139264,v247
M v[164:167],a[252:255],a[232:235],v[164:167]
ds_write2st64_b64 v238,v[204:205],v[206:207] offset0:3 offset1:20
M v[168:171],a[252:255],a[248:251],v[168:171]
s_waitcnt vmcnt(8)
s_add_u32 s28,s71,6684672
v_permlane32_swap_b32 v196,v198
v_permlane32_swap_b32 v192,v194
M v[168:171],a[196:199],a[204:207],v[168:171]
buffer_load_dwordx4 a[232:235],v250,s[20:23],s48 offen offset:2048 sc1
M v[168:171],a[208:211],a[244:247],v[168:171]
s_add_u32 s46,s76,18432
ds_write2st64_b64 v247,v[208:209],v[210:211] offset0:37 offset1:54
M v[172:175],a[208:211],v[224:227],v[172:175]
s_waitcnt vmcnt(8)
v_permlane32_swap_b32 v200,v202
v_lshlrev_b32 v234,16,v198
M v[172:175],a[196:199],a[244:247],v[172:175]
v_lshlrev_b32 v232,16,v192
v_lshlrev_b32 v233,16,v196
M v[172:175],a[252:255],a[204:207],v[172:175]
buffer_load_dwordx4 a[248:251],v250,s[20:23],s46 offen offset:0 sc1
ds_write2st64_b64 v247,v[212:213],v[214:215] offset0:71 offset1:88
M v[176:179],a[252:255],a[244:247],v[176:179]
v_lshlrev_b32 v237,16,v194
v_lshlrev_b32 v236,16,v202
M v[176:179],a[196:199],v[224:227],v[176:179]
buffer_load_dwordx4 v[204:207],v251,s[88:91],s28 offen offset:0
M v[176:179],a[208:211],a[220:223],v[176:179]
s_waitcnt lgkmcnt(0)
s_barrier
v_lshlrev_b32 v235,16,v200
M v[180:183],a[208:211],a[228:231],v[180:183]
v_fmac_f32 v232,s43,v234
v_fmac_f32 v237,4.0,v233
M v[180:183],a[196:199],a[220:223],v[180:183]
ds_read_b128 a[204:207],v248 offset:0
v_fma_f32 v238,-4.0,v234,v236
M v[180:183],a[252:255],v[224:227],v[180:183]
buffer_load_dwordx4 v[208:211],v245,s[8:11],s28 offen offset:0
M v[184:187],a[252:255],a[220:223],v[184:187]
ds_read_b128 a[244:247],v249 offset:0
ds_read_b128 v[224:227],v248 offset:512
M v[184:187],a[196:199],a[228:231],v[184:187]
ds_read_b128 a[220:223],v249 offset:512
v_fmac_f32 v232,s45,v236
M v[184:187],a[208:211],a[212:215],v[184:187]
v_fmac_f32 v237,s41,v235
v_sub_f32 v236,v236,v234
M v[188:191],a[208:211],v[216:219],v[188:191]
buffer_load_dwordx4 v[212:215],v245,s[8:11],s28 offen offset:768
M v[188:191],a[196:199],a[212:215],v[188:191]
v_fma_f32 v234,-4.0,v233,v235
v_sub_f32 v235,v235,v233
M v[188:191],a[252:255],a[228:231],v[188:191]
s_waitcnt lgkmcnt(3)
v_add_f32 v233,v238,v234
v_sub_f32 v238,v238,v234
M a[0:3],v[228:231],a[204:207],a[0:3]
s_waitcnt vmcnt(11) lgkmcnt(2)
ds_read_b128 a[208:211],v248 offset:1024
v_fma_f32 v234,2.0,v235,v236
M a[0:3],a[216:219],a[244:247],a[0:3]
s_waitcnt vmcnt(10) lgkmcnt(2)
ds_read_b128 v[216:219],v249 offset:1024
v_fmac_f32 v236,-2.0,v235
M a[0:3],a[240:243],v[224:227],a[0:3]
s_waitcnt lgkmcnt(2)
v_and_b32 v198,s42,v198
v_and_b32 v192,s42,v192
M a[4:7],a[240:243],a[220:223],a[4:7]
v_and_b32 v196,s42,v196
v_and_b32 v194,s42,v194
M a[4:7],a[216:219],v[224:227],a[4:7]
v_and_b32 v202,s42,v202
v_and_b32 v200,s42,v200
M a[4:7],v[228:231],a[244:247],a[4:7]
v_fmac_f32 v192,s43,v198
v_fmac_f32 v194,4.0,v196
M a[8:11],v[228:231],v[224:227],a[8:11]
ds_read_b128 a[196:199],v248 offset:1536
v_fma_f32 v235,-4.0,v198,v202
M a[8:11],a[216:219],a[220:223],a[8:11]
s_waitcnt lgkmcnt(2)
ds_read_b128 a[212:215],v249 offset:1536
v_fmac_f32 v192,s45,v202
M a[8:11],a[240:243],a[208:211],a[8:11]
s_waitcnt lgkmcnt(2)
v_fmac_f32 v194,s41,v200
v_sub_f32 v202,v202,v198
M a[12:15],a[240:243],v[216:219],a[12:15]
v_fma_f32 v198,-4.0,v196,v200
v_sub_f32 v200,v200,v196
M a[12:15],a[216:219],a[208:211],a[12:15]
v_add_f32 v196,v235,v198
v_sub_f32 v235,v235,v198
M a[12:15],v[228:231],a[220:223],a[12:15]
v_fma_f32 v198,2.0,v200,v202
v_fmac_f32 v202,-2.0,v200
M a[16:19],v[228:231],a[208:211],a[16:19]
ds_read_b128 a[228:231],v249 offset:2048
v_cvt_pk_bf16_f32 v192,v232,v192
M a[16:19],a[216:219],v[216:219],a[16:19]
s_waitcnt lgkmcnt(2)
ds_read_b128 a[252:255],v248 offset:2048
v_cvt_pk_bf16_f32 v194,v237,v194
M a[16:19],a[240:243],a[196:199],a[16:19]
s_waitcnt lgkmcnt(2)
v_cvt_pk_bf16_f32 v196,v233,v196
v_cvt_pk_bf16_f32 v200,v234,v198
M a[20:23],a[240:243],a[212:215],a[20:23]
v_cvt_pk_bf16_f32 v198,v238,v235
v_cvt_pk_bf16_f32 v202,v236,v202
M a[20:23],a[216:219],a[196:199],a[20:23]
v_permlane32_swap_b32 v197,v199
v_permlane32_swap_b32 v193,v195
M a[20:23],v[228:231],v[216:219],a[20:23]
v_permlane32_swap_b32 v201,v203
v_lshlrev_b32 v234,16,v199
M a[24:27],v[228:231],a[196:199],a[24:27]
v_lshlrev_b32 v232,16,v193
v_lshlrev_b32 v233,16,v197
M a[24:27],a[216:219],a[212:215],a[24:27]
s_waitcnt lgkmcnt(1)
v_lshlrev_b32 v237,16,v195
v_lshlrev_b32 v236,16,v203
M a[24:27],a[240:243],a[228:231],a[24:27]
s_waitcnt lgkmcnt(0)
v_lshlrev_b32 v235,16,v201
v_fmac_f32 v232,s43,v234
M a[28:31],a[240:243],a[252:255],a[28:31]
buffer_load_dwordx4 a[240:243],v250,s[20:23],s46 offen offset:1024 sc1
M a[28:31],a[216:219],a[228:231],a[28:31]
v_fmac_f32 v237,4.0,v233
v_fma_f32 v238,-4.0,v234,v236
M a[28:31],v[228:231],a[212:215],a[28:31]
s_waitcnt vmcnt(10)
buffer_load_dwordx4 a[216:219],v250,s[20:23],s46 offen offset:2048 sc1
M a[32:35],v[220:223],a[204:207],a[32:35]
s_waitcnt vmcnt(10)
s_add_u32 s47,s76,21504
v_fmac_f32 v232,s45,v236
v_fmac_f32 v237,s41,v235
M a[32:35],a[200:203],a[244:247],a[32:35]
s_waitcnt vmcnt(9)
v_sub_f32 v236,v236,v234
v_fma_f32 v234,-4.0,v233,v235
M a[32:35],a[192:195],v[224:227],a[32:35]
v_sub_f32 v235,v235,v233
v_add_f32 v233,v238,v234
M a[36:39],a[192:195],a[220:223],a[36:39]
buffer_load_dwordx4 v[228:231],v250,s[20:23],s47 offen offset:0 sc1
M a[36:39],a[200:203],v[224:227],a[36:39]
v_sub_f32 v238,v238,v234
v_fma_f32 v234,2.0,v235,v236
M a[36:39],v[220:223],a[244:247],a[36:39]
v_fmac_f32 v236,-2.0,v235
v_and_b32 v199,s42,v199
M a[40:43],v[220:223],v[224:227],a[40:43]
v_and_b32 v193,s42,v193
v_and_b32 v197,s42,v197
M a[40:43],a[200:203],a[220:223],a[40:43]
v_and_b32 v195,s42,v195
v_and_b32 v203,s42,v203
M a[40:43],a[192:195],a[208:211],a[40:43]
v_and_b32 v201,s42,v201
v_fmac_f32 v193,s43,v199
M a[44:47],a[192:195],v[216:219],a[44:47]
v_fmac_f32 v195,4.0,v197
v_fma_f32 v235,-4.0,v199,v203
M a[44:47],a[200:203],a[208:211],a[44:47]
v_fmac_f32 v193,s45,v203
v_fmac_f32 v195,s41,v201
M a[44:47],v[220:223],a[220:223],a[44:47]
v_sub_f32 v203,v203,v199
v_fma_f32 v199,-4.0,v197,v201
M a[48:51],v[220:223],a[208:211],a[48:51]
v_sub_f32 v201,v201,v197
v_add_f32 v197,v235,v199
M a[48:51],a[200:203],v[216:219],a[48:51]
v_sub_f32 v235,v235,v199
v_fma_f32 v199,2.0,v201,v203
M a[48:51],a[192:195],a[196:199],a[48:51]
v_fmac_f32 v203,-2.0,v201
v_cvt_pk_bf16_f32 v193,v232,v193
M a[52:55],a[192:195],a[212:215],a[52:55]
v_cvt_pk_bf16_f32 v195,v237,v195
v_cvt_pk_bf16_f32 v197,v233,v197
M a[52:55],a[200:203],a[196:199],a[52:55]
v_cvt_pk_bf16_f32 v201,v234,v199
v_cvt_pk_bf16_f32 v199,v238,v235
M a[52:55],v[220:223],v[216:219],a[52:55]
s_waitcnt vmcnt(4)
v_cvt_pk_bf16_f32 v203,v236,v203
v_permlane32_swap_b32 v208,v210
M a[56:59],v[220:223],a[196:199],a[56:59]
s_waitcnt vmcnt(3)
v_permlane32_swap_b32 v204,v206
v_permlane32_swap_b32 v212,v214
M a[56:59],a[200:203],a[212:215],a[56:59]
v_lshlrev_b32 v234,16,v210
v_lshlrev_b32 v232,16,v204
M a[56:59],a[192:195],a[228:231],a[56:59]
ds_write2st64_b64 v247,v[192:193],v[194:195] offset0:136 offset1:153
M a[60:63],a[192:195],a[252:255],a[60:63]
s_add_u32 s28,s71,7077888
buffer_load_dwordx4 a[192:195],v250,s[20:23],s47 offen offset:1024 sc1
M a[60:63],a[200:203],a[228:231],a[60:63]
v_lshlrev_b32 v233,16,v208
v_lshlrev_b32 v237,16,v206
M a[60:63],v[220:223],a[212:215],a[60:63]
buffer_load_dwordx4 a[200:203],v250,s[20:23],s47 offen offset:2048 sc1
M a[64:67],a[236:239],a[204:207],a[64:67]
s_add_u32 s48,s76,24576
v_lshlrev_b32 v236,16,v214
v_lshlrev_b32 v235,16,v212
M a[64:67],a[224:227],a[244:247],a[64:67]
v_fmac_f32 v232,s43,v234
v_fmac_f32 v237,4.0,v233
M a[64:67],a[232:235],v[224:227],a[64:67]
ds_write2st64_b64 v247,v[196:197],v[198:199] offset0:0 offset1:17
M a[68:71],a[232:235],a[220:223],a[68:71]
buffer_load_dwordx4 v[220:223],v250,s[20:23],s48 offen offset:0 sc1
M a[68:71],a[224:227],v[224:227],a[68:71]
v_fma_f32 v238,-4.0,v234,v236
v_fmac_f32 v232,s45,v236
M a[68:71],a[236:239],a[244:247],a[68:71]
v_fmac_f32 v237,s41,v235
v_sub_f32 v236,v236,v234
M a[72:75],a[236:239],v[224:227],a[72:75]
v_fma_f32 v234,-4.0,v233,v235
v_sub_f32 v235,v235,v233
M a[72:75],a[224:227],a[220:223],a[72:75]
buffer_load_dwordx4 a[204:207],v250,s[20:23],s48 offen offset:1024 sc1
M a[72:75],a[232:235],a[208:211],a[72:75]
v_add_f32 v233,v238,v234
v_sub_f32 v238,v238,v234
M a[76:79],a[232:235],v[216:219],a[76:79]
v_fma_f32 v234,2.0,v235,v236
v_fmac_f32 v236,-2.0,v235
M a[76:79],a[224:227],a[208:211],a[76:79]
v_and_b32 v210,s42,v210
v_and_b32 v204,s42,v204
M a[76:79],a[236:239],a[220:223],a[76:79]
buffer_load_dwordx4 a[244:247],v250,s[20:23],s48 offen offset:2048 sc1
M a[80:83],a[236:239],a[208:211],a[80:83]
s_add_u32 s46,s76,27648
v_and_b32 v208,s42,v208
v_and_b32 v206,s42,v206
M a[80:83],a[224:227],v[216:219],a[80:83]
v_and_b32 v214,s42,v214
v_and_b32 v212,s42,v212
M a[80:83],a[232:235],a[196:199],a[80:83]
v_fmac_f32 v204,s43,v210
v_fmac_f32 v206,4.0,v208
M a[84:87],a[232:235],a[212:215],a[84:87]
buffer_load_dwordx4 v[224:227],v250,s[20:23],s46 offen offset:0 sc1
M a[84:87],a[224:227],a[196:199],a[84:87]
ds_read_b128 a[220:223],v248 offset:8704
v_fma_f32 v235,-4.0,v210,v214
M a[84:87],a[236:239],v[216:219],a[84:87]
ds_read_b128 a[208:211],v249 offset:8704
v_fmac_f32 v204,s45,v214
M a[88:91],a[236:239],a[196:199],a[88:91]
ds_read_b128 v[216:219],v248 offset:9216
v_fmac_f32 v206,s41,v212
M a[88:91],a[224:227],a[212:215],a[88:91]
buffer_load_dwordx4 v[192:195],v251,s[88:91],s28 offen offset:0
M a[88:91],a[232:235],a[228:231],a[88:91]
ds_read_b128 a[196:199],v249 offset:9216
v_sub_f32 v214,v214,v210
M a[92:95],a[232:235],a[252:255],a[92:95]
v_fma_f32 v210,-4.0,v208,v212
v_sub_f32 v212,v212,v208
M a[92:95],a[224:227],a[228:231],a[92:95]
v_add_f32 v208,v235,v210
v_sub_f32 v235,v235,v210
M a[92:95],a[236:239],a[212:215],a[92:95]
s_waitcnt lgkmcnt(3)
buffer_load_dwordx4 v[196:199],v245,s[8:11],s28 offen offset:0
M a[96:99],a[248:251],a[220:223],a[96:99]
s_waitcnt vmcnt(10) lgkmcnt(2)
ds_read_b128 a[232:235],v248 offset:9728
v_fma_f32 v210,2.0,v212,v214
M a[96:99],a[240:243],a[208:211],a[96:99]
s_waitcnt vmcnt(9) lgkmcnt(2)
ds_read_b128 a[252:255],v249 offset:9728
v_fmac_f32 v214,-2.0,v212
M a[96:99],a[216:219],v[216:219],a[96:99]
s_waitcnt lgkmcnt(2)
v_cvt_pk_bf16_f32 v204,v232,v204
v_cvt_pk_bf16_f32 v206,v237,v206
M a[100:103],a[216:219],a[196:199],a[100:103]
v_cvt_pk_bf16_f32 v208,v233,v208
v_cvt_pk_bf16_f32 v212,v234,v210
M a[100:103],a[240:243],v[216:219],a[100:103]
v_cvt_pk_bf16_f32 v210,v238,v235
v_cvt_pk_bf16_f32 v214,v236,v214
M a[100:103],a[248:251],a[208:211],a[100:103]
v_permlane32_swap_b32 v209,v211
v_permlane32_swap_b32 v205,v207
M a[104:107],a[248:251],v[216:219],a[104:107]
ds_read_b128 a[224:227],v248 offset:10240
v_permlane32_swap_b32 v213,v215
M a[104:107],a[240:243],a[196:199],a[104:107]
s_waitcnt lgkmcnt(2)
ds_read_b128 a[228:231],v249 offset:10240
v_lshlrev_b32 v234,16,v211
M a[104:107],a[216:219],a[232:235],a[104:107]
s_waitcnt lgkmcnt(2)
v_lshlrev_b32 v232,16,v205
v_lshlrev_b32 v233,16,v209
M a[108:111],a[216:219],a[252:255],a[108:111]
v_lshlrev_b32 v237,16,v207
v_lshlrev_b32 v236,16,v215
M a[108:111],a[240:243],a[232:235],a[108:111]
v_lshlrev_b32 v235,16,v213
v_fmac_f32 v232,s43,v234
M a[108:111],a[248:251],a[196:199],a[108:111]
v_fmac_f32 v237,4.0,v233
v_fma_f32 v238,-4.0,v234,v236
M a[112:115],a[248:251],a[232:235],a[112:115]
ds_read_b128 a[212:215],v249 offset:10752
v_fmac_f32 v232,s45,v236
M a[112:115],a[240:243],a[252:255],a[112:115]
s_waitcnt lgkmcnt(2)
ds_read_b128 a[236:239],v248 offset:10752
v_fmac_f32 v237,s41,v235
M a[112:115],a[216:219],a[224:227],a[112:115]
s_waitcnt lgkmcnt(2)
v_sub_f32 v236,v236,v234
v_fma_f32 v234,-4.0,v233,v235
M a[116:119],a[216:219],a[228:231],a[116:119]
v_sub_f32 v235,v235,v233
v_add_f32 v233,v238,v234
M a[116:119],a[240:243],a[224:227],a[116:119]
v_sub_f32 v238,v238,v234
v_fma_f32 v234,2.0,v235,v236
M a[116:119],a[248:251],a[252:255],a[116:119]
v_fmac_f32 v236,-2.0,v235
v_and_b32 v211,s42,v211
M a[120:123],a[248:251],a[224:227],a[120:123]
v_and_b32 v205,s42,v205
v_and_b32 v209,s42,v209
M a[120:123],a[240:243],a[228:231],a[120:123]
s_waitcnt lgkmcnt(1)
v_and_b32 v207,s42,v207
v_and_b32 v215,s42,v215
M a[120:123],a[216:219],a[212:215],a[120:123]
s_waitcnt lgkmcnt(0)
v_and_b32 v213,s42,v213
v_fmac_f32 v205,s43,v211
M a[124:127],a[216:219],a[236:239],a[124:127]
buffer_load_dwordx4 a[216:219],v250,s[20:23],s46 offen offset:1024 sc1
M a[124:127],a[240:243],a[212:215],a[124:127]
v_fmac_f32 v207,4.0,v209
v_fma_f32 v235,-4.0,v211,v215
M a[124:127],a[248:251],a[228:231],a[124:127]
s_waitcnt vmcnt(9)
buffer_load_dwordx4 a[240:243],v250,s[20:23],s46 offen offset:2048 sc1
M a[128:131],v[228:231],a[220:223],a[128:131]
s_waitcnt vmcnt(9)
s_add_u32 s47,s76,30720
v_fmac_f32 v205,s45,v215
v_fmac_f32 v207,s41,v213
M a[128:131],a[192:195],a[208:211],a[128:131]
s_waitcnt vmcnt(8)
v_sub_f32 v215,v215,v211
v_fma_f32 v211,-4.0,v209,v213
M a[128:131],a[200:203],v[216:219],a[128:131]
v_sub_f32 v213,v213,v209
v_add_f32 v209,v235,v211
M a[132:135],a[200:203],a[196:199],a[132:135]
buffer_load_dwordx4 a[248:251],v250,s[20:23],s47 offen offset:0 sc1
M a[132:135],a[192:195],v[216:219],a[132:135]
v_sub_f32 v235,v235,v211
v_fma_f32 v211,2.0,v213,v215
M a[132:135],v[228:231],a[208:211],a[132:135]
v_fmac_f32 v215,-2.0,v213
v_cvt_pk_bf16_f32 v205,v232,v205
M a[136:139],v[228:231],v[216:219],a[136:139]
s_barrier
v_cvt_pk_bf16_f32 v207,v237,v207
M a[136:139],a[192:195],a[196:199],a[136:139]
v_cvt_pk_bf16_f32 v209,v233,v209
v_cvt_pk_bf16_f32 v213,v234,v211
M a[136:139],a[200:203],a[232:235],a[136:139]
ds_write2st64_b64 v247,v[200:201],v[202:203] offset0:34 offset1:51
M a[140:143],a[200:203],a[252:255],a[140:143]
buffer_load_dwordx4 v[200:203],v245,s[8:11],s28 offen offset:768
M a[140:143],a[192:195],a[232:235],a[140:143]
v_cvt_pk_bf16_f32 v211,v238,v235
v_cvt_pk_bf16_f32 v215,v236,v215
M a[140:143],v[228:231],a[196:199],a[140:143]
ds_write2st64_b64 v247,v[204:205],v[206:207] offset0:137 offset1:154
M a[144:147],v[228:231],a[232:235],a[144:147]
s_add_u32 s28,s71,7471104
buffer_load_dwordx4 v[204:207],v251,s[88:91],s28 offen offset:0
M a[144:147],a[192:195],a[252:255],a[144:147]
v_fmac_f32 v239,s43,v241
v_fmac_f32 v244,4.0,v240
M a[144:147],a[200:203],a[224:227],a[144:147]
ds_write2st64_b64 v247,v[208:209],v[210:211] offset0:1 offset1:18
M a[148:151],a[200:203],a[228:231],a[148:151]
buffer_load_dwordx4 v[208:211],v245,s[8:11],s28 offen offset:0
M a[148:151],a[192:195],a[224:227],a[148:151]
v_fma_f32 v232,-4.0,v241,v243
v_fmac_f32 v239,s45,v243
M a[148:151],v[228:231],a[252:255],a[148:151]
ds_write2st64_b64 v247,v[212:213],v[214:215] offset0:35 offset1:52
M a[152:155],v[228:231],a[224:227],a[152:155]
buffer_load_dwordx4 v[212:215],v245,s[8:11],s28 offen offset:768
M a[152:155],a[192:195],a[228:231],a[152:155]
v_fmac_f32 v244,s41,v242
v_sub_f32 v243,v243,v241
M a[152:155],a[200:203],a[212:215],a[152:155]
v_fma_f32 v241,-4.0,v240,v242
v_sub_f32 v242,v242,v240
M a[156:159],a[200:203],a[236:239],a[156:159]
buffer_load_dwordx4 a[200:203],v250,s[20:23],s47 offen offset:1024 sc1
M a[156:159],a[192:195],a[212:215],a[156:159]
v_add_f32 v240,v232,v241
v_sub_f32 v232,v232,v241
M a[156:159],v[228:231],a[228:231],a[156:159]
s_waitcnt vmcnt(13)
v_fma_f32 v241,2.0,v242,v243
v_fmac_f32 v243,-2.0,v242
M a[160:163],v[220:223],a[220:223],a[160:163]
s_waitcnt vmcnt(12)
v_cvt_pk_bf16_f32 v233,v239,v244
v_cvt_pk_bf16_f32 v234,v240,v232
M a[160:163],a[204:207],a[208:211],a[160:163]
s_waitcnt vmcnt(11)
buffer_load_dwordx4 a[192:195],v250,s[20:23],s47 offen offset:2048 sc1
M a[160:163],a[244:247],v[216:219],a[160:163]
s_add_u32 s48,s76,33792
v_cvt_pk_bf16_f32 v235,v241,v243
v_add_u32 v232,69632,v252
M a[164:167],a[244:247],a[196:199],a[164:167]
ds_write_b16 v232,v233 offset:0
M a[164:167],a[204:207],v[216:219],a[164:167]
ds_write_b16_d16_hi v232,v233 offset:8704
M a[164:167],v[220:223],a[208:211],a[164:167]
buffer_load_dwordx4 v[228:231],v250,s[20:23],s48 offen offset:0 sc1
M a[168:171],v[220:223],v[216:219],a[168:171]
ds_write_b16 v252,v234 offset:0
M a[168:171],a[204:207],a[196:199],a[168:171]
ds_write_b16_d16_hi v252,v234 offset:8704
M a[168:171],a[244:247],a[232:235],a[168:171]
ds_write_b16 v252,v235 offset:17408
M a[172:175],a[244:247],a[252:255],a[172:175]
buffer_load_dwordx4 a[220:223],v250,s[20:23],s48 offen offset:1024 sc1
M a[172:175],a[204:207],a[232:235],a[172:175]
ds_write_b16_d16_hi v252,v235 offset:26112
M a[172:175],v[220:223],a[196:199],a[172:175]
M a[176:179],v[220:223],a[232:235],a[176:179]
M a[176:179],a[204:207],a[252:255],a[176:179]
buffer_load_dwordx4 a[208:211],v250,s[20:23],s48 offen offset:2048 sc1
M a[176:179],a[244:247],a[224:227],a[176:179]
s_add_u32 s46,s76,36864
M a[180:183],a[244:247],a[228:231],a[180:183]
s_waitcnt vmcnt(12)
v_permlane32_swap_b32 v196,v198
v_permlane32_swap_b32 v192,v194
M a[180:183],a[204:207],a[224:227],a[180:183]
s_waitcnt vmcnt(8)
ds_read_b128 a[196:199],v248 offset:17408
v_permlane32_swap_b32 v200,v202
M a[180:183],v[220:223],a[252:255],a[180:183]
buffer_load_dwordx4 v[216:219],v250,s[20:23],s46 offen offset:0 sc1
M a[184:187],v[220:223],a[224:227],a[184:187]
ds_read_b128 a[232:235],v249 offset:17408
ds_read_b128 a[252:255],v248 offset:17920
M a[184:187],a[204:207],a[228:231],a[184:187]
ds_read_b128 a[224:227],v249 offset:17920
v_lshlrev_b32 v234,16,v198
M a[184:187],a[244:247],a[212:215],a[184:187]
v_lshlrev_b32 v232,16,v192
v_lshlrev_b32 v233,16,v196
M a[188:191],a[244:247],a[236:239],a[188:191]
v_lshlrev_b32 v237,16,v194
v_lshlrev_b32 v236,16,v202
M a[188:191],a[204:207],a[212:215],a[188:191]
v_lshlrev_b32 v235,16,v200
v_fmac_f32 v232,s43,v234
M a[188:191],v[220:223],a[228:231],a[188:191]
s_waitcnt lgkmcnt(3)
v_fmac_f32 v237,4.0,v233
v_fma_f32 v238,-4.0,v234,v236
M v[0:3],v[224:227],a[196:199],v[0:3]
s_waitcnt lgkmcnt(2)
ds_read_b128 a[236:239],v248 offset:18432
v_fmac_f32 v232,s45,v236
M v[0:3],a[216:219],a[232:235],v[0:3]
s_waitcnt lgkmcnt(2)
ds_read_b128 a[244:247],v249 offset:18432
v_fmac_f32 v237,s41,v235
M v[0:3],a[240:243],a[252:255],v[0:3]
s_waitcnt lgkmcnt(2)
v_sub_f32 v236,v236,v234
v_fma_f32 v234,-4.0,v233,v235
M v[4:7],a[240:243],a[224:227],v[4:7]
v_sub_f32 v235,v235,v233
v_add_f32 v233,v238,v234
M v[4:7],a[216:219],a[252:255],v[4:7]
v_sub_f32 v238,v238,v234
v_fma_f32 v234,2.0,v235,v236
M v[4:7],v[224:227],a[232:235],v[4:7]
v_fmac_f32 v236,-2.0,v235
v_and_b32 v198,s42,v198
M v[8:11],v[224:227],a[252:255],v[8:11]
ds_read_b128 a[204:207],v248 offset:18944
v_and_b32 v192,s42,v192
M v[8:11],a[216:219],a[224:227],v[8:11]
s_waitcnt lgkmcnt(2)
ds_read_b128 a[212:215],v249 offset:18944
v_and_b32 v196,s42,v196
M v[8:11],a[240:243],a[236:239],v[8:11]
s_waitcnt lgkmcnt(2)
v_and_b32 v194,s42,v194
v_and_b32 v202,s42,v202
M v[12:15],a[240:243],a[244:247],v[12:15]
v_and_b32 v200,s42,v200
v_fmac_f32 v192,s43,v198
M v[12:15],a[216:219],a[236:239],v[12:15]
v_fmac_f32 v194,4.0,v196
v_fma_f32 v235,-4.0,v198,v202
M v[12:15],v[224:227],a[224:227],v[12:15]
v_fmac_f32 v192,s45,v202
v_fmac_f32 v194,s41,v200
M v[16:19],v[224:227],a[236:239],v[16:19]
ds_read_b128 a[228:231],v249 offset:19456
v_sub_f32 v202,v202,v198
M v[16:19],a[216:219],a[244:247],v[16:19]
s_waitcnt lgkmcnt(2)
ds_read_b128 v[220:223],v248 offset:19456
v_fma_f32 v198,-4.0,v196,v200
M v[16:19],a[240:243],a[204:207],v[16:19]
s_waitcnt lgkmcnt(2)
v_sub_f32 v200,v200,v196
v_add_f32 v196,v235,v198
M v[20:23],a[240:243],a[212:215],v[20:23]
v_sub_f32 v235,v235,v198
v_fma_f32 v198,2.0,v200,v202
M v[20:23],a[216:219],a[204:207],v[20:23]
v_fmac_f32 v202,-2.0,v200
v_cvt_pk_bf16_f32 v192,v232,v192
M v[20:23],v[224:227],a[244:247],v[20:23]
v_cvt_pk_bf16_f32 v194,v237,v194
v_cvt_pk_bf16_f32 v196,v233,v196
M v[24:27],v[224:227],a[204:207],v[24:27]
v_cvt_pk_bf16_f32 v200,v234,v198
v_cvt_pk_bf16_f32 v198,v238,v235
M v[24:27],a[216:219],a[212:215],v[24:27]
s_waitcnt lgkmcnt(1)
v_cvt_pk_bf16_f32 v202,v236,v202
v_permlane32_swap_b32 v197,v199
M v[24:27],a[240:243],a[228:231],v[24:27]
s_waitcnt lgkmcnt(0)
v_permlane32_swap_b32 v193,v195
v_permlane32_swap_b32 v201,v203
M v[28:31],a[240:243],v[220:223],v[28:31]
global_load_dword a240,v250,s[64:65]
M v[28:31],a[216:219],a[228:231],v[28:31]
buffer_load_dwordx4 a[240:243],v250,s[20:23],s46 offen offset:1024 sc1
M v[28:31],v[224:227],a[212:215],v[28:31]
v_lshlrev_b32 v234,16,v199
v_lshlrev_b32 v232,16,v193
M v[32:35],a[248:251],a[196:199],v[32:35]
s_waitcnt vmcnt(7)
v_lshlrev_b32 v233,16,v197
v_lshlrev_b32 v237,16,v195
M v[32:35],a[200:203],a[232:235],v[32:35]
s_waitcnt vmcnt(6)
buffer_load_dwordx4 a[216:219],v250,s[20:23],s46 offen offset:2048 sc1
M v[32:35],a[192:195],a[252:255],v[32:35]
s_add_u32 s47,s76,39936
v_lshlrev_b32 v236,16,v203
v_lshlrev_b32 v235,16,v201
M v[36:39],a[192:195],a[224:227],v[36:39]
v_fmac_f32 v232,s43,v234
v_fmac_f32 v237,4.0,v233
M v[36:39],a[200:203],a[252:255],v[36:39]
v_fma_f32 v238,-4.0,v234,v236
v_fmac_f32 v232,s45,v236
M v[36:39],a[248:251],a[232:235],v[36:39]
buffer_load_dwordx4 v[224:227],v250,s[20:23],s47 offen offset:0 sc1
M v[40:43],a[248:251],a[252:255],v[40:43]
v_fmac_f32 v237,s41,v235
v_sub_f32 v236,v236,v234
M v[40:43],a[200:203],a[224:227],v[40:43]
v_fma_f32 v234,-4.0,v233,v235
v_sub_f32 v235,v235,v233
M v[40:43],a[192:195],a[236:239],v[40:43]
v_add_f32 v233,v238,v234
v_sub_f32 v238,v238,v234
M v[44:47],a[192:195],a[244:247],v[44:47]
v_fma_f32 v234,2.0,v235,v236
v_fmac_f32 v236,-2.0,v235
M v[44:47],a[200:203],a[236:239],v[44:47]
v_and_b32 v199,s42,v199
v_and_b32 v193,s42,v193
M v[44:47],a[248:251],a[224:227],v[44:47]
v_and_b32 v197,s42,v197
v_and_b32 v195,s42,v195
M v[48:51],a[248:251],a[236:239],v[48:51]
v_and_b32 v203,s42,v203
v_and_b32 v201,s42,v201
M v[48:51],a[200:203],a[244:247],v[48:51]
v_fmac_f32 v193,s43,v199
v_fmac_f32 v195,4.0,v197
M v[48:51],a[192:195],a[204:207],v[48:51]
v_fma_f32 v235,-4.0,v199,v203
v_fmac_f32 v193,s45,v203
M v[52:55],a[192:195],a[212:215],v[52:55]
v_fmac_f32 v195,s41,v201
v_sub_f32 v203,v203,v199
M v[52:55],a[200:203],a[204:207],v[52:55]
v_fma_f32 v199,-4.0,v197,v201
v_sub_f32 v201,v201,v197
M v[52:55],a[248:251],a[244:247],v[52:55]
v_add_f32 v197,v235,v199
v_sub_f32 v235,v235,v199
M v[56:59],a[248:251],a[204:207],v[56:59]
v_fma_f32 v199,2.0,v201,v203
v_fmac_f32 v203,-2.0,v201
M v[56:59],a[200:203],a[212:215],v[56:59]
v_cvt_pk_bf16_f32 v193,v232,v193
v_cvt_pk_bf16_f32 v195,v237,v195
M v[56:59],a[192:195],a[228:231],v[56:59]
v_cvt_pk_bf16_f32 v197,v233,v197
v_cvt_pk_bf16_f32 v201,v234,v199
M v[60:63],a[192:195],v[220:223],v[60:63]
buffer_load_dwordx4 a[192:195],v250,s[20:23],s47 offen offset:1024 sc1
M v[60:63],a[200:203],a[228:231],v[60:63]
v_cvt_pk_bf16_f32 v199,v238,v235
v_cvt_pk_bf16_f32 v203,v236,v203
M v[60:63],a[248:251],a[212:215],v[60:63]
s_waitcnt vmcnt(8)
buffer_load_dwordx4 a[200:203],v250,s[20:23],s47 offen offset:2048 sc1
M v[64:67],v[228:231],a[196:199],v[64:67]
s_waitcnt vmcnt(8)
s_add_u32 s48,s76,43008
v_permlane32_swap_b32 v208,v210
v_permlane32_swap_b32 v204,v206
M v[64:67],a[220:223],a[232:235],v[64:67]
s_waitcnt vmcnt(7)
v_permlane32_swap_b32 v212,v214
v_lshlrev_b32 v234,16,v210
M v[64:67],a[208:211],a[252:255],v[64:67]
ds_write2st64_b64 v247,v[192:193],v[194:195] offset0:138 offset1:155
M v[68:71],a[208:211],a[224:227],v[68:71]
buffer_load_dwordx4 a[248:251],v250,s[20:23],s48 offen offset:0 sc1
M v[68:71],a[220:223],a[252:255],v[68:71]
v_lshlrev_b32 v232,16,v204
v_lshlrev_b32 v233,16,v208
M v[68:71],v[228:231],a[232:235],v[68:71]
ds_write2st64_b64 v247,v[196:197],v[198:199] offset0:2 offset1:19
M v[72:75],v[228:231],a[252:255],v[72:75]
buffer_load_dwordx4 a[196:199],v250,s[20:23],s48 offen offset:1024 sc1
M v[72:75],a[220:223],a[224:227],v[72:75]
v_lshlrev_b32 v237,16,v206
v_lshlrev_b32 v236,16,v214
M v[72:75],a[208:211],a[236:239],v[72:75]
ds_write2st64_b64 v247,v[200:201],v[202:203] offset0:36 offset1:53
M v[76:79],a[208:211],a[244:247],v[76:79]
buffer_load_dwordx4 a[232:235],v250,s[20:23],s48 offen offset:2048 sc1
M v[76:79],a[220:223],a[236:239],v[76:79]
s_add_u32 s46,s77,9216
v_lshlrev_b32 v235,16,v212
v_fmac_f32 v232,s43,v234
M v[76:79],v[228:231],a[224:227],v[76:79]
v_fmac_f32 v237,4.0,v233
v_fma_f32 v238,-4.0,v234,v236
M v[80:83],v[228:231],a[236:239],v[80:83]
v_fmac_f32 v232,s45,v236
v_fmac_f32 v237,s41,v235
M v[80:83],a[220:223],a[244:247],v[80:83]
buffer_load_dwordx4 a[252:255],v250,s[20:23],s46 offen offset:0 sc1
M v[80:83],a[208:211],a[204:207],v[80:83]
v_sub_f32 v236,v236,v234
v_fma_f32 v234,-4.0,v233,v235
M v[84:87],a[208:211],a[212:215],v[84:87]
v_sub_f32 v235,v235,v233
v_add_f32 v233,v238,v234
M v[84:87],a[220:223],a[204:207],v[84:87]
ds_read_b128 a[224:227],v248 offset:26112
v_sub_f32 v238,v238,v234
M v[84:87],v[228:231],a[244:247],v[84:87]
ds_read_b128 a[236:239],v249 offset:26112
v_fma_f32 v234,2.0,v235,v236
M v[88:91],v[228:231],a[204:207],v[88:91]
ds_read_b128 a[244:247],v248 offset:26624
v_fmac_f32 v236,-2.0,v235
M v[88:91],a[220:223],a[212:215],v[88:91]
ds_read_b128 a[204:207],v249 offset:26624
v_and_b32 v210,s42,v210
M v[88:91],a[208:211],a[228:231],v[88:91]
v_and_b32 v204,s42,v204
v_and_b32 v208,s42,v208
M v[92:95],a[208:211],v[220:223],v[92:95]
v_and_b32 v206,s42,v206
v_and_b32 v214,s42,v214
M v[92:95],a[220:223],a[228:231],v[92:95]
v_and_b32 v212,s42,v212
v_fmac_f32 v204,s43,v210
M v[92:95],v[228:231],a[212:215],v[92:95]
s_waitcnt vmcnt(10) lgkmcnt(3)
v_fmac_f32 v206,4.0,v208
v_fma_f32 v235,-4.0,v210,v214
M v[96:99],v[216:219],a[224:227],v[96:99]
s_waitcnt vmcnt(8) lgkmcnt(2)
ds_read_b128 a[208:211],v248 offset:27136
v_fmac_f32 v204,s45,v214
M v[96:99],a[240:243],a[236:239],v[96:99]
s_waitcnt vmcnt(7) lgkmcnt(2)
ds_read_b128 v[220:223],v249 offset:27136
v_fmac_f32 v206,s41,v212
M v[96:99],a[216:219],a[244:247],v[96:99]
s_waitcnt lgkmcnt(2)
v_sub_f32 v214,v214,v210
v_fma_f32 v210,-4.0,v208,v212
M v[100:103],a[216:219],a[204:207],v[100:103]
v_sub_f32 v212,v212,v208
v_add_f32 v208,v235,v210
M v[100:103],a[240:243],a[244:247],v[100:103]
v_sub_f32 v235,v235,v210
v_fma_f32 v210,2.0,v212,v214
M v[100:103],v[216:219],a[236:239],v[100:103]
v_fmac_f32 v214,-2.0,v212
v_cvt_pk_bf16_f32 v204,v232,v204
M v[104:107],v[216:219],a[244:247],v[104:107]
ds_read_b128 a[220:223],v248 offset:27648
v_cvt_pk_bf16_f32 v206,v237,v206
M v[104:107],a[240:243],a[204:207],v[104:107]
s_waitcnt lgkmcnt(2)
ds_read_b128 a[228:231],v249 offset:27648
v_cvt_pk_bf16_f32 v208,v233,v208
M v[104:107],a[216:219],a[208:211],v[104:107]
s_waitcnt lgkmcnt(2)
v_cvt_pk_bf16_f32 v212,v234,v210
v_cvt_pk_bf16_f32 v210,v238,v235
M v[108:111],a[216:219],v[220:223],v[108:111]
v_cvt_pk_bf16_f32 v214,v236,v214
v_permlane32_swap_b32 v209,v211
M v[108:111],a[240:243],a[208:211],v[108:111]
v_permlane32_swap_b32 v205,v207
v_permlane32_swap_b32 v213,v215
M v[108:111],v[216:219],a[204:207],v[108:111]
v_lshlrev_b32 v234,16,v211
v_lshlrev_b32 v232,16,v205
M v[112:115],v[216:219],a[208:211],v[112:115]
ds_read_b128 a[212:215],v249 offset:28160
v_lshlrev_b32 v233,16,v209
M v[112:115],a[240:243],v[220:223],v[112:115]
s_waitcnt lgkmcnt(2)
ds_read_b128 v[228:231],v248 offset:28160
v_lshlrev_b32 v237,16,v207
M v[112:115],a[216:219],a[220:223],v[112:115]
s_waitcnt lgkmcnt(2)
v_lshlrev_b32 v236,16,v215
v_lshlrev_b32 v235,16,v213
M v[116:119],a[216:219],a[228:231],v[116:119]
v_fmac_f32 v232,s43,v234
v_fmac_f32 v237,4.0,v233
M v[116:119],a[240:243],a[220:223],v[116:119]
v_fma_f32 v238,-4.0,v234,v236
v_fmac_f32 v232,s45,v236
M v[116:119],v[216:219],v[220:223],v[116:119]
v_fmac_f32 v237,s41,v235
v_sub_f32 v236,v236,v234
M v[120:123],v[216:219],a[220:223],v[120:123]
v_fma_f32 v234,-4.0,v233,v235
v_sub_f32 v235,v235,v233
M v[120:123],a[240:243],a[228:231],v[120:123]
s_waitcnt lgkmcnt(1)
v_add_f32 v233,v238,v234
v_sub_f32 v238,v238,v234
M v[120:123],a[216:219],a[212:215],v[120:123]
s_waitcnt lgkmcnt(0)
v_fma_f32 v234,2.0,v235,v236
v_fmac_f32 v236,-2.0,v235
M v[124:127],a[216:219],v[228:231],v[124:127]
buffer_load_dwordx4 a[216:219],v250,s[20:23],s46 offen offset:1024 sc1
M v[124:127],a[240:243],a[212:215],v[124:127]
v_and_b32 v211,s42,v211
v_and_b32 v205,s42,v205
M v[124:127],v[216:219],a[228:231],v[124:127]
s_waitcnt vmcnt(7)
buffer_load_dwordx4 a[240:243],v250,s[20:23],s46 offen offset:2048 sc1
M v[128:131],v[224:227],a[224:227],v[128:131]
s_waitcnt vmcnt(7)
s_add_u32 s46,s77,18432
v_and_b32 v209,s42,v209
v_and_b32 v207,s42,v207
M v[128:131],a[192:195],a[236:239],v[128:131]
s_waitcnt vmcnt(6)
v_and_b32 v215,s42,v215
v_and_b32 v213,s42,v213
M v[128:131],a[200:203],a[244:247],v[128:131]
v_fmac_f32 v205,s43,v211
v_fmac_f32 v207,4.0,v209
M v[132:135],a[200:203],a[204:207],v[132:135]
buffer_load_dwordx4 v[216:219],v250,s[20:23],s46 offen offset:0 sc1
M v[132:135],a[192:195],a[244:247],v[132:135]
v_fma_f32 v235,-4.0,v211,v215
v_fmac_f32 v205,s45,v215
M v[132:135],v[224:227],a[236:239],v[132:135]
v_fmac_f32 v207,s41,v213
v_sub_f32 v215,v215,v211
M v[136:139],v[224:227],a[244:247],v[136:139]
v_fma_f32 v211,-4.0,v209,v213
v_sub_f32 v213,v213,v209
M v[136:139],a[192:195],a[204:207],v[136:139]
v_add_f32 v209,v235,v211
v_sub_f32 v235,v235,v211
M v[136:139],a[200:203],a[208:211],v[136:139]
v_fma_f32 v211,2.0,v213,v215
v_fmac_f32 v215,-2.0,v213
M v[140:143],a[200:203],v[220:223],v[140:143]
v_cvt_pk_bf16_f32 v205,v232,v205
v_cvt_pk_bf16_f32 v207,v237,v207
M v[140:143],a[192:195],a[208:211],v[140:143]
v_cvt_pk_bf16_f32 v209,v233,v209
v_cvt_pk_bf16_f32 v213,v234,v211
M v[140:143],v[224:227],a[204:207],v[140:143]
v_cvt_pk_bf16_f32 v211,v238,v235
v_cvt_pk_bf16_f32 v215,v236,v215
M v[144:147],v[224:227],a[208:211],v[144:147]
M v[144:147],a[192:195],v[220:223],v[144:147]
M v[144:147],a[200:203],a[220:223],v[144:147]
ds_write2st64_b64 v247,v[204:205],v[206:207] offset0:139 offset1:156
M v[148:151],a[200:203],a[228:231],v[148:151]
M v[148:151],a[192:195],a[220:223],v[148:151]
M v[148:151],v[224:227],v[220:223],v[148:151]
ds_write2st64_b64 v247,v[208:209],v[210:211] offset0:3 offset1:20
M v[152:155],v[224:227],a[220:223],v[152:155]
M v[152:155],a[192:195],a[228:231],v[152:155]
M v[152:155],a[200:203],a[212:215],v[152:155]
ds_write2st64_b64 v247,v[212:213],v[214:215] offset0:37 offset1:54
M v[156:159],a[200:203],v[228:231],v[156:159]
buffer_load_dwordx4 a[200:203],v250,s[20:23],s46 offen offset:1024 sc1
M v[156:159],a[192:195],a[212:215],v[156:159]
M v[156:159],v[224:227],a[228:231],v[156:159]
s_waitcnt vmcnt(7)
buffer_load_dwordx4 a[192:195],v250,s[20:23],s46 offen offset:2048 sc1
M v[160:163],a[248:251],a[224:227],v[160:163]
s_waitcnt vmcnt(7)
s_add_u32 s46,s77,27648
M v[160:163],a[196:199],a[236:239],v[160:163]
s_waitcnt vmcnt(6)
M v[160:163],a[232:235],a[244:247],v[160:163]
M v[164:167],a[232:235],a[204:207],v[164:167]
buffer_load_dwordx4 v[224:227],v250,s[20:23],s46 offen offset:0 sc1
M v[164:167],a[196:199],a[244:247],v[164:167]
M v[164:167],a[248:251],a[236:239],v[164:167]
M v[168:171],a[248:251],a[244:247],v[168:171]
M v[168:171],a[196:199],a[204:207],v[168:171]
buffer_load_dwordx4 a[224:227],v250,s[20:23],s46 offen offset:1024 sc1
M v[168:171],a[232:235],a[208:211],v[168:171]
M v[172:175],a[232:235],v[220:223],v[172:175]
M v[172:175],a[196:199],a[208:211],v[172:175]
M v[172:175],a[248:251],a[204:207],v[172:175]
buffer_load_dwordx4 a[236:239],v250,s[20:23],s46 offen offset:2048 sc1
M v[176:179],a[248:251],a[208:211],v[176:179]
s_add_u32 s46,s77,36864
M v[176:179],a[196:199],v[220:223],v[176:179]
v_add_u32 v248,0xffffbc00,v248
v_add_u32 v249,0xffffbc00,v249
M v[176:179],a[232:235],a[220:223],v[176:179]
s_waitcnt lgkmcnt(0)
s_barrier
M v[180:183],a[232:235],a[228:231],v[180:183]
buffer_load_dwordx4 a[244:247],v250,s[20:23],s46 offen offset:0 sc1
M v[180:183],a[196:199],a[220:223],v[180:183]
ds_read_b128 a[204:207],v248 offset:0
M v[180:183],a[248:251],v[220:223],v[180:183]
ds_read_b128 a[208:211],v249 offset:0
M v[184:187],a[248:251],a[220:223],v[184:187]
ds_read_b128 v[220:223],v248 offset:512
M v[184:187],a[196:199],a[228:231],v[184:187]
ds_read_b128 a[220:223],v249 offset:512
M v[184:187],a[232:235],a[212:215],v[184:187]
M v[188:191],a[232:235],v[228:231],v[188:191]
buffer_load_dwordx4 a[232:235],v250,s[20:23],s46 offen offset:1024 sc1
M v[188:191],a[196:199],a[212:215],v[188:191]
M v[188:191],a[248:251],a[228:231],v[188:191]
s_waitcnt vmcnt(10) lgkmcnt(3)
buffer_load_dwordx4 v[228:231],v250,s[20:23],s46 offen offset:2048 sc1
M a[0:3],a[252:255],a[204:207],a[0:3]
s_waitcnt vmcnt(10) lgkmcnt(2)
s_add_u32 s47,s77,12288
ds_read_b128 a[212:215],v248 offset:1024
M a[0:3],a[216:219],a[208:211],a[0:3]
s_waitcnt vmcnt(9) lgkmcnt(2)
ds_read_b128 a[228:231],v249 offset:1024
M a[0:3],a[240:243],v[220:223],a[0:3]
s_waitcnt lgkmcnt(2)
M a[4:7],a[240:243],a[220:223],a[4:7]
buffer_load_dwordx4 a[196:199],v250,s[20:23],s47 offen offset:0 sc1
M a[4:7],a[216:219],v[220:223],a[4:7]
M a[4:7],a[252:255],a[208:211],a[4:7]
M a[8:11],a[252:255],v[220:223],a[8:11]
ds_read_b128 a[248:251],v248 offset:1536
M a[8:11],a[216:219],a[220:223],a[8:11]
s_waitcnt lgkmcnt(2)
ds_read_b128 a[204:207],v249 offset:1536
M a[8:11],a[240:243],a[212:215],a[8:11]
s_waitcnt lgkmcnt(2)
M a[12:15],a[240:243],a[228:231],a[12:15]
M a[12:15],a[216:219],a[212:215],a[12:15]
M a[12:15],a[252:255],a[220:223],a[12:15]
M a[16:19],a[252:255],a[212:215],a[16:19]
ds_read_b128 a[208:211],v249 offset:2048
M a[16:19],a[216:219],a[228:231],a[16:19]
s_waitcnt lgkmcnt(2)
ds_read_b128 v[220:223],v248 offset:2048
M a[16:19],a[240:243],a[248:251],a[16:19]
s_waitcnt lgkmcnt(2)
M a[20:23],a[240:243],a[204:207],a[20:23]
M a[20:23],a[216:219],a[248:251],a[20:23]
ds_read_b128 a[220:223],v248 offset:8704
M a[20:23],a[252:255],a[228:231],a[20:23]
ds_read_b128 a[212:215],v249 offset:8704
M a[24:27],a[252:255],a[248:251],a[24:27]
ds_read_b128 a[228:231],v248 offset:9216
M a[24:27],a[216:219],a[204:207],a[24:27]
s_waitcnt lgkmcnt(4)
ds_read_b128 a[248:251],v249 offset:9216
M a[24:27],a[240:243],a[208:211],a[24:27]
s_waitcnt lgkmcnt(4)
M a[28:31],a[240:243],v[220:223],a[28:31]
buffer_load_dwordx4 a[240:243],v250,s[20:23],s47 offen offset:1024 sc1
M a[28:31],a[216:219],a[208:211],a[28:31]
M a[28:31],a[252:255],a[204:207],a[28:31]
s_waitcnt vmcnt(10) lgkmcnt(3)
buffer_load_dwordx4 v[220:223],v250,s[20:23],s47 offen offset:2048 sc1
M a[96:99],v[216:219],a[220:223],a[96:99]
s_waitcnt vmcnt(10) lgkmcnt(2)
s_add_u32 s48,s77,15360
ds_read_b128 a[216:219],v248 offset:9728
M a[96:99],a[200:203],a[212:215],a[96:99]
s_waitcnt vmcnt(9) lgkmcnt(2)
ds_read_b128 a[204:207],v249 offset:9728
M a[96:99],a[192:195],a[228:231],a[96:99]
s_waitcnt lgkmcnt(2)
M a[100:103],a[192:195],a[248:251],a[100:103]
buffer_load_dwordx4 a[208:211],v250,s[20:23],s48 offen offset:0 sc1
M a[100:103],a[200:203],a[228:231],a[100:103]
M a[100:103],v[216:219],a[212:215],a[100:103]
M a[104:107],v[216:219],a[228:231],a[104:107]
ds_read_b128 a[252:255],v248 offset:10240
M a[104:107],a[200:203],a[248:251],a[104:107]
s_waitcnt lgkmcnt(2)
ds_read_b128 a[220:223],v249 offset:10240
M a[104:107],a[192:195],a[216:219],a[104:107]
s_waitcnt lgkmcnt(2)
M a[108:111],a[192:195],a[204:207],a[108:111]
M a[108:111],a[200:203],a[216:219],a[108:111]
M a[108:111],v[216:219],a[248:251],a[108:111]
M a[112:115],v[216:219],a[216:219],a[112:115]
ds_read_b128 a[212:215],v249 offset:10752
M a[112:115],a[200:203],a[204:207],a[112:115]
s_waitcnt lgkmcnt(2)
ds_read_b128 a[228:231],v248 offset:10752
M a[112:115],a[192:195],a[252:255],a[112:115]
s_waitcnt lgkmcnt(2)
M a[116:119],a[192:195],a[220:223],a[116:119]
M a[116:119],a[200:203],a[252:255],a[116:119]
ds_read_b128 a[248:251],v248 offset:17408
M a[116:119],v[216:219],a[204:207],a[116:119]
ds_read_b128 a[216:219],v249 offset:17408
M a[120:123],v[216:219],a[252:255],a[120:123]
ds_read_b128 a[204:207],v248 offset:17920
M a[120:123],a[200:203],a[220:223],a[120:123]
s_waitcnt lgkmcnt(4)
ds_read_b128 a[252:255],v249 offset:17920
M a[120:123],a[192:195],a[212:215],a[120:123]
s_waitcnt lgkmcnt(4)
M a[124:127],a[192:195],a[228:231],a[124:127]
buffer_load_dwordx4 a[192:195],v250,s[20:23],s48 offen offset:1024 sc1
M a[124:127],a[200:203],a[212:215],a[124:127]
M a[124:127],v[216:219],a[220:223],a[124:127]
s_waitcnt vmcnt(10) lgkmcnt(3)
buffer_load_dwordx4 a[228:231],v250,s[20:23],s48 offen offset:2048 sc1
M v[0:3],v[224:227],a[248:251],v[0:3]
s_waitcnt vmcnt(10) lgkmcnt(2)
s_add_u32 s47,s77,21504
ds_read_b128 a[212:215],v248 offset:18432
M v[0:3],a[224:227],a[216:219],v[0:3]
s_waitcnt vmcnt(9) lgkmcnt(2)
ds_read_b128 a[220:223],v249 offset:18432
M v[0:3],a[236:239],a[204:207],v[0:3]
s_waitcnt lgkmcnt(2)
M v[4:7],a[236:239],a[252:255],v[4:7]
buffer_load_dwordx4 a[200:203],v250,s[20:23],s47 offen offset:0 sc1
M v[4:7],a[224:227],a[204:207],v[4:7]
M v[4:7],v[224:227],a[216:219],v[4:7]
M v[8:11],v[224:227],a[204:207],v[8:11]
ds_read_b128 v[216:219],v248 offset:18944
M v[8:11],a[224:227],a[252:255],v[8:11]
s_waitcnt lgkmcnt(2)
ds_read_b128 a[248:251],v249 offset:18944
M v[8:11],a[236:239],a[212:215],v[8:11]
s_waitcnt lgkmcnt(2)
M v[12:15],a[236:239],a[220:223],v[12:15]
M v[12:15],a[224:227],a[212:215],v[12:15]
M v[12:15],v[224:227],a[252:255],v[12:15]
M v[16:19],v[224:227],a[212:215],v[16:19]
ds_read_b128 a[216:219],v249 offset:19456
M v[16:19],a[224:227],a[220:223],v[16:19]
s_waitcnt lgkmcnt(2)
ds_read_b128 a[204:207],v248 offset:19456
M v[16:19],a[236:239],v[216:219],v[16:19]
s_waitcnt lgkmcnt(2)
M v[20:23],a[236:239],a[248:251],v[20:23]
M v[20:23],a[224:227],v[216:219],v[20:23]
ds_read_b128 a[252:255],v248 offset:26112
M v[20:23],v[224:227],a[220:223],v[20:23]
ds_read_b128 a[212:215],v249 offset:26112
M v[24:27],v[224:227],v[216:219],v[24:27]
ds_read_b128 a[220:223],v248 offset:26624
M v[24:27],a[224:227],a[248:251],v[24:27]
s_waitcnt lgkmcnt(4)
ds_read_b128 v[216:219],v249 offset:26624
M v[24:27],a[236:239],a[216:219],v[24:27]
s_waitcnt lgkmcnt(4)
M v[28:31],a[236:239],a[204:207],v[28:31]
buffer_load_dwordx4 a[204:207],v250,s[20:23],s47 offen offset:1024 sc1
M v[28:31],a[224:227],a[216:219],v[28:31]
M v[28:31],v[224:227],a[248:251],v[28:31]
s_waitcnt vmcnt(10) lgkmcnt(3)
buffer_load_dwordx4 a[236:239],v250,s[20:23],s47 offen offset:2048 sc1
M v[96:99],a[244:247],a[252:255],v[96:99]
s_waitcnt vmcnt(10) lgkmcnt(2)
s_add_u32 s48,s77,24576
ds_read_b128 a[224:227],v248 offset:27136
M v[96:99],a[232:235],a[212:215],v[96:99]
s_waitcnt vmcnt(9) lgkmcnt(2)
ds_read_b128 a[248:251],v249 offset:27136
M v[96:99],v[228:231],a[220:223],v[96:99]
s_waitcnt lgkmcnt(2)
M v[100:103],v[228:231],v[216:219],v[100:103]
buffer_load_dwordx4 a[216:219],v250,s[20:23],s48 offen offset:0 sc1
M v[100:103],a[232:235],a[220:223],v[100:103]
M v[100:103],a[244:247],a[212:215],v[100:103]
v_accvgpr_read_b32 v238,a0
v_accvgpr_read_b32 v232,a96
M v[104:107],a[244:247],a[220:223],v[104:107]
ds_read_b128 v[224:227],v248 offset:27648
v_add_f32 v234,v238,v232
M v[104:107],a[232:235],v[216:219],v[104:107]
s_waitcnt lgkmcnt(2)
ds_read_b128 a[252:255],v249 offset:27648
v_sub_f32 v238,v238,v232
M v[104:107],v[228:231],a[224:227],v[104:107]
s_waitcnt lgkmcnt(2)
v_add_f32 v232,v0,v96
v_sub_f32 v96,v0,v96
M v[108:111],v[228:231],a[248:251],v[108:111]
v_add_f32 v0,v234,v232
v_fmac_f32 v234,4.0,v232
M v[108:111],a[232:235],a[224:227],v[108:111]
v_fma_f32 v232,2.0,v96,v238
v_fma_f32 v96,s40,v96,v238
M v[108:111],a[244:247],v[216:219],v[108:111]
v_accvgpr_read_b32 v238,a1
v_accvgpr_read_b32 v237,a97
M v[112:115],a[244:247],a[224:227],v[112:115]
ds_read_b128 a[212:215],v249 offset:28160
v_add_f32 v236,v238,v237
M v[112:115],a[232:235],a[248:251],v[112:115]
s_waitcnt lgkmcnt(2)
ds_read_b128 a[220:223],v248 offset:28160
v_sub_f32 v238,v238,v237
M v[112:115],v[228:231],v[224:227],v[112:115]
s_waitcnt lgkmcnt(2)
v_add_f32 v237,v1,v97
v_sub_f32 v97,v1,v97
M v[116:119],v[228:231],a[252:255],v[116:119]
v_add_f32 v1,v236,v237
v_fmac_f32 v236,4.0,v237
M v[116:119],a[232:235],v[224:227],v[116:119]
ds_read_b128 v[216:219],v248 offset:0
v_fma_f32 v237,2.0,v97,v238
M v[116:119],a[244:247],a[248:251],v[116:119]
ds_read_b128 a[224:227],v249 offset:0
v_fma_f32 v97,s40,v97,v238
M v[120:123],a[244:247],v[224:227],v[120:123]
ds_read_b128 a[248:251],v248 offset:512
v_cvt_pk_bf16_f32 v232,v232,v237
M v[120:123],a[232:235],a[252:255],v[120:123]
s_waitcnt lgkmcnt(4)
ds_read_b128 v[224:227],v249 offset:512
v_cvt_pk_bf16_f32 v234,v234,v236
M v[120:123],v[228:231],a[212:215],v[120:123]
s_waitcnt lgkmcnt(4)
v_accvgpr_read_b32 v238,a2
v_accvgpr_read_b32 v233,a98
M v[124:127],v[228:231],a[220:223],v[124:127]
buffer_load_dwordx4 a[220:223],v250,s[20:23],s48 offen offset:1024 sc1
M v[124:127],a[232:235],a[212:215],v[124:127]
v_add_f32 v235,v238,v233
v_sub_f32 v238,v238,v233
M v[124:127],a[244:247],a[252:255],v[124:127]
s_waitcnt vmcnt(10) lgkmcnt(3)
v_add_f32 v233,v2,v98
v_sub_f32 v98,v2,v98
M a[32:35],a[196:199],v[216:219],a[32:35]
s_waitcnt vmcnt(9) lgkmcnt(2)
ds_read_b128 v[228:231],v248 offset:1024
v_add_f32 v2,v235,v233
M a[32:35],a[240:243],a[224:227],a[32:35]
s_waitcnt vmcnt(8) lgkmcnt(2)
ds_read_b128 a[212:215],v249 offset:1024
v_fmac_f32 v235,4.0,v233
M a[32:35],v[220:223],a[248:251],a[32:35]
s_waitcnt lgkmcnt(2)
v_fma_f32 v233,2.0,v98,v238
v_fma_f32 v98,s40,v98,v238
M a[36:39],v[220:223],v[224:227],a[36:39]
v_accvgpr_read_b32 v238,a3
v_accvgpr_read_b32 v237,a99
M a[36:39],a[240:243],a[248:251],a[36:39]
v_add_f32 v236,v238,v237
v_sub_f32 v238,v238,v237
M a[36:39],a[196:199],a[224:227],a[36:39]
v_add_f32 v237,v3,v99
v_sub_f32 v99,v3,v99
M a[40:43],a[196:199],a[248:251],a[40:43]
ds_read_b128 a[96:99],v248 offset:1536
v_add_f32 v3,v236,v237
M a[40:43],a[240:243],v[224:227],a[40:43]
s_waitcnt lgkmcnt(2)
ds_read_b128 a[232:235],v249 offset:1536
v_fmac_f32 v236,4.0,v237
M a[40:43],v[220:223],v[228:231],a[40:43]
s_waitcnt lgkmcnt(2)
v_fma_f32 v237,2.0,v99,v238
v_fma_f32 v99,s40,v99,v238
M a[44:47],v[220:223],a[212:215],a[44:47]
v_cvt_pk_bf16_f32 v233,v233,v237
v_cvt_pk_bf16_f32 v235,v235,v236
M a[44:47],a[240:243],v[228:231],a[44:47]
ds_write2st64_b64 v254,v[232:233],v[234:235] offset0:68 offset1:72
M a[44:47],a[196:199],v[224:227],a[44:47]
v_accvgpr_read_b32 v238,a4
v_accvgpr_read_b32 v232,a100
M a[48:51],a[196:199],v[228:231],a[48:51]
ds_read_b128 a[244:247],v249 offset:2048
v_add_f32 v234,v238,v232
M a[48:51],a[240:243],a[212:215],a[48:51]
s_waitcnt lgkmcnt(3)
ds_read_b128 a[252:255],v248 offset:2048
v_sub_f32 v238,v238,v232
M a[48:51],v[220:223],a[96:99],a[48:51]
s_waitcnt lgkmcnt(3)
v_add_f32 v232,v4,v100
v_sub_f32 v100,v4,v100
M a[52:55],v[220:223],a[232:235],a[52:55]
v_add_f32 v4,v234,v232
v_fmac_f32 v234,4.0,v232
M a[52:55],a[240:243],a[96:99],a[52:55]
v_fma_f32 v232,2.0,v100,v238
v_fma_f32 v100,s40,v100,v238
M a[52:55],a[196:199],a[212:215],a[52:55]
v_accvgpr_read_b32 v238,a5
v_accvgpr_read_b32 v237,a101
M a[56:59],a[196:199],a[96:99],a[56:59]
v_add_f32 v236,v238,v237
v_sub_f32 v238,v238,v237
M a[56:59],a[240:243],a[232:235],a[56:59]
s_waitcnt lgkmcnt(1)
v_add_f32 v237,v5,v101
v_sub_f32 v101,v5,v101
M a[56:59],v[220:223],a[244:247],a[56:59]
s_waitcnt lgkmcnt(0)
v_add_f32 v5,v236,v237
v_fmac_f32 v236,4.0,v237
M a[60:63],v[220:223],a[252:255],a[60:63]
buffer_load_dwordx4 v[220:223],v250,s[20:23],s48 offen offset:2048 sc1
M a[60:63],a[240:243],a[244:247],a[60:63]
s_add_u32 s47,s77,30720
v_fma_f32 v237,2.0,v101,v238
v_fma_f32 v101,s40,v101,v238
M a[60:63],a[196:199],a[232:235],a[60:63]
s_waitcnt vmcnt(8)
buffer_load_dwordx4 a[240:243],v250,s[20:23],s47 offen offset:0 sc1
M a[64:67],a[208:211],v[216:219],a[64:67]
s_waitcnt vmcnt(8)
v_cvt_pk_bf16_f32 v232,v232,v237
v_cvt_pk_bf16_f32 v234,v234,v236
M a[64:67],a[192:195],a[224:227],a[64:67]
s_waitcnt vmcnt(7)
v_accvgpr_read_b32 v238,a6
v_accvgpr_read_b32 v233,a102
M a[64:67],a[228:231],a[248:251],a[64:67]
v_add_f32 v235,v238,v233
v_sub_f32 v238,v238,v233
M a[68:71],a[228:231],v[224:227],a[68:71]
buffer_load_dwordx4 a[196:199],v250,s[20:23],s47 offen offset:1024 sc1
M a[68:71],a[192:195],a[248:251],a[68:71]
v_add_f32 v233,v6,v102
v_sub_f32 v102,v6,v102
M a[68:71],a[208:211],a[224:227],a[68:71]
v_add_f32 v6,v235,v233
v_fmac_f32 v235,4.0,v233
M a[72:75],a[208:211],a[248:251],a[72:75]
v_fma_f32 v233,2.0,v102,v238
v_fma_f32 v102,s40,v102,v238
M a[72:75],a[192:195],v[224:227],a[72:75]
buffer_load_dwordx4 v[216:219],v250,s[20:23],s47 offen offset:2048 sc1
M a[72:75],a[228:231],v[228:231],a[72:75]
s_add_u32 s48,s77,33792
v_accvgpr_read_b32 v238,a7
v_accvgpr_read_b32 v237,a103
M a[76:79],a[228:231],a[212:215],a[76:79]
v_add_f32 v236,v238,v237
v_sub_f32 v238,v238,v237
M a[76:79],a[192:195],v[228:231],a[76:79]
v_add_f32 v237,v7,v103
v_sub_f32 v103,v7,v103
M a[76:79],a[208:211],v[224:227],a[76:79]
buffer_load_dwordx4 a[224:227],v250,s[20:23],s48 offen offset:0 sc1
M a[80:83],a[208:211],v[228:231],a[80:83]
v_add_f32 v7,v236,v237
v_fmac_f32 v236,4.0,v237
M a[80:83],a[192:195],a[212:215],a[80:83]
v_fma_f32 v237,2.0,v103,v238
v_fma_f32 v103,s40,v103,v238
M a[80:83],a[228:231],a[96:99],a[80:83]
v_cvt_pk_bf16_f32 v233,v233,v237
v_cvt_pk_bf16_f32 v235,v235,v236
M a[84:87],a[228:231],a[232:235],a[84:87]
buffer_load_dwordx4 a[248:251],v250,s[20:23],s48 offen offset:1024 sc1
M a[84:87],a[192:195],a[96:99],a[84:87]
ds_read_b128 v[224:227],v248 offset:8704
ds_write2st64_b64 v254,v[232:233],v[234:235] offset0:76 offset1:80
M a[84:87],a[208:211],a[212:215],a[84:87]
ds_read_b128 v[228:231],v249 offset:8704
v_accvgpr_read_b32 v238,a8
M a[88:91],a[208:211],a[96:99],a[88:91]
buffer_load_dwordx4 a[100:103],v250,s[20:23],s48 offen offset:2048 sc1
M a[88:91],a[192:195],a[232:235],a[88:91]
ds_read_b128 a[96:99],v248 offset:9216
ds_read_b128 a[212:215],v249 offset:9216
M a[88:91],a[228:231],a[244:247],a[88:91]
v_accvgpr_read_b32 v232,a104
v_add_f32 v234,v238,v232
M a[92:95],a[228:231],a[252:255],a[92:95]
v_sub_f32 v238,v238,v232
v_add_f32 v232,v8,v104
M a[92:95],a[192:195],a[244:247],a[92:95]
v_sub_f32 v104,v8,v104
v_add_f32 v8,v234,v232
M a[92:95],a[208:211],a[232:235],a[92:95]
s_waitcnt vmcnt(11) lgkmcnt(4)
v_fmac_f32 v234,4.0,v232
v_fma_f32 v232,2.0,v104,v238
M a[128:131],a[200:203],v[224:227],a[128:131]
s_waitcnt vmcnt(10) lgkmcnt(2)
ds_read_b128 a[228:231],v248 offset:9728
v_fma_f32 v104,s40,v104,v238
M a[128:131],a[204:207],v[228:231],a[128:131]
s_waitcnt vmcnt(9) lgkmcnt(2)
s_barrier
ds_read_b128 a[0:3],v250 offset:34816
M a[128:131],a[236:239],a[96:99],a[128:131]
s_waitcnt lgkmcnt(2)
ds_read_b128 a[4:7],v250 offset:38912
ds_read_b128 a[252:255],v249 offset:9728
M a[132:135],a[236:239],a[212:215],a[132:135]
v_accvgpr_read_b32 v238,a9
v_accvgpr_read_b32 v237,a105
M a[132:135],a[204:207],a[96:99],a[132:135]
v_add_f32 v236,v238,v237
v_sub_f32 v238,v238,v237
M a[132:135],a[200:203],v[228:231],a[132:135]
v_add_f32 v237,v9,v105
v_sub_f32 v105,v9,v105
M a[136:139],a[200:203],a[96:99],a[136:139]
s_add_u32 s34,s32,6291456
ds_read_b128 a[192:195],v248 offset:10240
v_add_f32 v9,v236,v237
M a[136:139],a[204:207],a[212:215],a[136:139]
s_waitcnt lgkmcnt(4)
ds_read_b128 a[244:247],v249 offset:10240
v_fmac_f32 v236,4.0,v237
M a[136:139],a[236:239],a[228:231],a[136:139]
s_waitcnt lgkmcnt(2)
buffer_store_dwordx4 a[0:3],v253,s[24:27],s34 offen offset:384 nt
M a[140:143],a[236:239],a[252:255],a[140:143]
v_fma_f32 v237,2.0,v105,v238
v_fma_f32 v105,s40,v105,v238
M a[140:143],a[204:207],a[228:231],a[140:143]
v_cvt_pk_bf16_f32 v232,v232,v237
v_cvt_pk_bf16_f32 v234,v234,v236
M a[140:143],a[200:203],a[212:215],a[140:143]
v_accvgpr_read_b32 v238,a10
v_accvgpr_read_b32 v233,a106
M a[144:147],a[200:203],a[228:231],a[144:147]
ds_read_b128 a[208:211],v249 offset:10752
v_add_f32 v235,v238,v233
M a[144:147],a[204:207],a[252:255],a[144:147]
s_waitcnt lgkmcnt(2)
ds_read_b128 a[232:235],v248 offset:10752
v_sub_f32 v238,v238,v233
M a[144:147],a[236:239],a[192:195],a[144:147]
s_waitcnt lgkmcnt(2)
v_add_f32 v233,v10,v106
v_sub_f32 v106,v10,v106
M a[148:151],a[236:239],a[244:247],a[148:151]
s_add_u32 s47,s77,39936
v_add_f32 v10,v235,v233
v_fmac_f32 v235,4.0,v233
M a[148:151],a[204:207],a[192:195],a[148:151]
v_fma_f32 v233,2.0,v106,v238
v_fma_f32 v106,s40,v106,v238
M a[148:151],a[200:203],a[252:255],a[148:151]
v_accvgpr_read_b32 v238,a11
v_accvgpr_read_b32 v237,a107
M a[152:155],a[200:203],a[192:195],a[152:155]
v_add_f32 v236,v238,v237
v_sub_f32 v238,v238,v237
M a[152:155],a[204:207],a[244:247],a[152:155]
s_waitcnt lgkmcnt(1)
v_add_f32 v237,v11,v107
v_sub_f32 v107,v11,v107
M a[152:155],a[236:239],a[208:211],a[152:155]
s_waitcnt lgkmcnt(0)
v_add_f32 v11,v236,v237
v_fmac_f32 v236,4.0,v237
M a[156:159],a[236:239],a[232:235],a[156:159]
buffer_load_dwordx4 a[104:107],v250,s[20:23],s47 offen offset:0 sc1
M a[156:159],a[204:207],a[208:211],a[156:159]
v_fma_f32 v237,2.0,v107,v238
v_fma_f32 v107,s40,v107,v238
M a[156:159],a[200:203],a[244:247],a[156:159]
s_waitcnt vmcnt(10)
buffer_load_dwordx4 a[236:239],v250,s[20:23],s47 offen offset:1024 sc1
M a[160:163],a[216:219],v[224:227],a[160:163]
s_waitcnt vmcnt(10)
v_cvt_pk_bf16_f32 v233,v233,v237
v_cvt_pk_bf16_f32 v235,v235,v236
M a[160:163],a[220:223],v[228:231],a[160:163]
s_waitcnt vmcnt(9)
ds_write2st64_b64 v254,v[232:233],v[234:235] offset0:85 offset1:89
M a[160:163],v[220:223],a[96:99],a[160:163]
v_accvgpr_read_b32 v204,a12
v_accvgpr_read_b32 v208,a108
M a[164:167],v[220:223],a[212:215],a[164:167]
buffer_load_dwordx4 a[204:207],v250,s[20:23],s47 offen offset:2048 sc1
M a[164:167],a[220:223],a[96:99],a[164:167]
s_add_u32 s48,s77,43008
s_add_u32 s34,s32,6488064
v_accvgpr_read_b32 v205,a13
M a[164:167],a[216:219],v[228:231],a[164:167]
v_accvgpr_read_b32 v209,a109
v_accvgpr_read_b32 v206,a14
M a[168:171],a[216:219],a[96:99],a[168:171]
v_accvgpr_read_b32 v210,a110
v_accvgpr_read_b32 v207,a15
v_accvgpr_read_b32 v211,a111
v_pk_add_f32 v[212:213],v[204:205],v[208:209]
v_pk_add_f32 v[214:215],v[206:207],v[210:211]
v_pk_add_f32 v[204:205],v[204:205],v[208:209] neg_lo:[0,1] neg_hi:[0,1]
v_pk_add_f32 v[206:207],v[206:207],v[210:211] neg_lo:[0,1] neg_hi:[0,1]
v_pk_add_f32 v[208:209],v[12:13],v[108:109]
v_pk_add_f32 v[210:211],v[14:15],v[110:111]
v_pk_add_f32 v[108:109],v[12:13],v[108:109] neg_lo:[0,1] neg_hi:[0,1]
v_pk_add_f32 v[110:111],v[14:15],v[110:111] neg_lo:[0,1] neg_hi:[0,1]
v_pk_add_f32 v[12:13],v[212:213],v[208:209]
v_pk_add_f32 v[14:15],v[214:215],v[210:211]
v_pk_fma_f32 v[212:213],v[208:209],4.0,v[212:213] op_sel_hi:[1,0,1]
v_pk_fma_f32 v[214:215],v[210:211],4.0,v[214:215] op_sel_hi:[1,0,1]
v_pk_fma_f32 v[208:209],v[108:109],2.0,v[204:205] op_sel_hi:[1,0,1]
v_pk_fma_f32 v[210:211],v[110:111],2.0,v[206:207] op_sel_hi:[1,0,1]
v_pk_fma_f32 v[108:109],v[108:109],s[40:41],v[204:205] op_sel_hi:[1,0,1]
v_pk_fma_f32 v[110:111],v[110:111],s[40:41],v[206:207] op_sel_hi:[1,0,1]
M a[168:171],a[220:223],a[212:215],a[168:171]
buffer_load_dwordx4 a[200:203],v250,s[20:23],s48 offen offset:0 sc1
M a[168:171],v[220:223],a[228:231],a[168:171]
v_cvt_pk_bf16_f32 v208,v208,v209
v_cvt_pk_bf16_f32 v209,v210,v211
M a[172:175],v[220:223],a[252:255],a[172:175]
buffer_load_dwordx4 v[224:227],v250,s[20:23],s48 offen offset:1024 sc1
M a[172:175],a[220:223],a[228:231],a[172:175]
v_cvt_pk_bf16_f32 v212,v212,v213
v_cvt_pk_bf16_f32 v213,v214,v215
M a[172:175],a[216:219],a[212:215],a[172:175]
ds_write2st64_b64 v254,v[208:209],v[212:213] offset0:93 offset1:97
M a[176:179],a[216:219],a[228:231],a[176:179]
v_accvgpr_read_b32 v238,a16
v_accvgpr_read_b32 v232,a112
M a[176:179],a[220:223],a[252:255],a[176:179]
buffer_load_dwordx4 v[228:231],v250,s[20:23],s48 offen offset:2048 sc1
M a[176:179],v[220:223],a[192:195],a[176:179]
s_add_u32 s46,s72,0
v_add_f32 v234,v238,v232
v_sub_f32 v238,v238,v232
M a[180:183],v[220:223],a[244:247],a[180:183]
v_add_f32 v232,v16,v112
v_sub_f32 v112,v16,v112
M a[180:183],a[220:223],a[192:195],a[180:183]
ds_read_b128 a[212:215],v248 offset:17408
v_add_f32 v16,v234,v232
M a[180:183],a[216:219],a[252:255],a[180:183]
buffer_store_dwordx4 a[4:7],v253,s[24:27],s34 offen offset:384 nt
M a[184:187],a[216:219],a[192:195],a[184:187]
ds_read_b128 a[228:231],v249 offset:17408
ds_read_b128 a[252:255],v248 offset:17920
M a[184:187],a[220:223],a[244:247],a[184:187]
ds_read_b128 a[192:195],v249 offset:17920
v_fmac_f32 v234,4.0,v232
M a[184:187],v[220:223],a[208:211],a[184:187]
buffer_load_dwordx4 a[96:99],v250,s[20:23],s46 offen offset:0 sc1
M a[188:191],v[220:223],a[232:235],a[188:191]
v_fma_f32 v232,2.0,v112,v238
v_fma_f32 v112,s40,v112,v238
M a[188:191],a[220:223],a[208:211],a[188:191]
s_waitcnt lgkmcnt(4)
s_barrier
ds_read_b128 a[8:11],v250 offset:43520
M a[188:191],a[216:219],a[244:247],a[188:191]
s_waitcnt vmcnt(14) lgkmcnt(4)
ds_read_b128 a[12:15],v250 offset:47616
v_accvgpr_read_b32 v238,a17
M v[32:35],a[240:243],a[212:215],v[32:35]
s_waitcnt vmcnt(13) lgkmcnt(4)
buffer_load_dwordx4 a[108:111],v250,s[20:23],s46 offen offset:1024 sc1
M v[32:35],a[196:199],a[228:231],v[32:35]
s_waitcnt vmcnt(13) lgkmcnt(3)
ds_read_b128 a[232:235],v248 offset:18432
ds_read_b128 v[220:223],v249 offset:18432
M v[32:35],v[216:219],a[252:255],v[32:35]
s_waitcnt lgkmcnt(4)
v_accvgpr_read_b32 v237,a113
v_add_f32 v236,v238,v237
M v[36:39],v[216:219],a[192:195],v[36:39]
s_add_u32 s34,s32,6684672
v_sub_f32 v238,v238,v237
v_add_f32 v237,v17,v113
M v[36:39],a[196:199],a[252:255],v[36:39]
v_sub_f32 v113,v17,v113
v_add_f32 v17,v236,v237
M v[36:39],a[240:243],a[228:231],v[36:39]
s_waitcnt lgkmcnt(3)
buffer_store_dwordx4 a[8:11],v253,s[24:27],s34 offen offset:384 nt
M v[40:43],a[240:243],a[252:255],v[40:43]
ds_read_b128 a[208:211],v248 offset:18944
v_fmac_f32 v236,4.0,v237
M v[40:43],a[196:199],a[192:195],v[40:43]
s_waitcnt lgkmcnt(2)
ds_read_b128 a[220:223],v249 offset:18944
v_fma_f32 v237,2.0,v113,v238
M v[40:43],v[216:219],a[232:235],v[40:43]
s_waitcnt lgkmcnt(2)
v_fma_f32 v113,s40,v113,v238
v_cvt_pk_bf16_f32 v232,v232,v237
M v[44:47],v[216:219],v[220:223],v[44:47]
v_cvt_pk_bf16_f32 v234,v234,v236
v_accvgpr_read_b32 v238,a18
M v[44:47],a[196:199],a[232:235],v[44:47]
v_accvgpr_read_b32 v233,a114
v_add_f32 v235,v238,v233
M v[44:47],a[240:243],a[192:195],v[44:47]
v_sub_f32 v238,v238,v233
v_add_f32 v233,v18,v114
M v[48:51],a[240:243],a[232:235],v[48:51]
ds_read_b128 a[216:219],v249 offset:19456
v_sub_f32 v114,v18,v114
M v[48:51],a[196:199],v[220:223],v[48:51]
s_waitcnt lgkmcnt(2)
ds_read_b128 a[244:247],v248 offset:19456
v_add_f32 v18,v235,v233
M v[48:51],v[216:219],a[208:211],v[48:51]
s_waitcnt lgkmcnt(2)
v_fmac_f32 v235,4.0,v233
v_fma_f32 v233,2.0,v114,v238
M v[52:55],v[216:219],a[220:223],v[52:55]
v_fma_f32 v114,s40,v114,v238
v_accvgpr_read_b32 v238,a19
M v[52:55],a[196:199],a[208:211],v[52:55]
v_accvgpr_read_b32 v237,a115
v_add_f32 v236,v238,v237
M v[52:55],a[240:243],v[220:223],v[52:55]
v_sub_f32 v238,v238,v237
v_add_f32 v237,v19,v115
M v[56:59],a[240:243],a[208:211],v[56:59]
v_sub_f32 v115,v19,v115
v_add_f32 v19,v236,v237
M v[56:59],a[196:199],a[220:223],v[56:59]
s_waitcnt lgkmcnt(1)
v_fmac_f32 v236,4.0,v237
v_fma_f32 v237,2.0,v115,v238
M v[56:59],v[216:219],a[216:219],v[56:59]
s_waitcnt lgkmcnt(0)
v_fma_f32 v115,s40,v115,v238
v_cvt_pk_bf16_f32 v233,v233,v237
M v[60:63],v[216:219],a[244:247],v[60:63]
buffer_load_dwordx4 a[112:115],v250,s[20:23],s46 offen offset:2048 sc1
M v[60:63],a[196:199],a[216:219],v[60:63]
s_add_u32 s46,s73,0
v_cvt_pk_bf16_f32 v235,v235,v236
M v[60:63],a[240:243],a[220:223],v[60:63]
s_waitcnt vmcnt(14)
buffer_load_dwordx4 v[216:219],v250,s[20:23],s46 offen offset:0 sc1
M v[64:67],a[224:227],a[212:215],v[64:67]
s_waitcnt vmcnt(14)
s_add_u32 s34,s32,6881280
ds_write2st64_b64 v254,v[232:233],v[234:235] offset0:68 offset1:72
M v[64:67],a[248:251],a[228:231],v[64:67]
s_waitcnt vmcnt(13)
v_accvgpr_read_b32 v238,a20
v_accvgpr_read_b32 v232,a116
M v[64:67],a[100:103],a[252:255],v[64:67]
v_add_f32 v234,v238,v232
v_sub_f32 v238,v238,v232
M v[68:71],a[100:103],a[192:195],v[68:71]
buffer_load_dwordx4 a[196:199],v250,s[20:23],s46 offen offset:1024 sc1
M v[68:71],a[248:251],a[252:255],v[68:71]
v_add_f32 v232,v20,v116
v_sub_f32 v116,v20,v116
M v[68:71],a[224:227],a[228:231],v[68:71]
v_add_f32 v20,v234,v232
v_fmac_f32 v234,4.0,v232
M v[72:75],a[224:227],a[252:255],v[72:75]
v_fma_f32 v232,2.0,v116,v238
v_fma_f32 v116,s40,v116,v238
M v[72:75],a[248:251],a[192:195],v[72:75]
buffer_load_dwordx4 a[240:243],v250,s[20:23],s46 offen offset:2048 sc1
M v[72:75],a[100:103],a[232:235],v[72:75]
s_add_u32 s46,s74,0
v_accvgpr_read_b32 v238,a21
v_accvgpr_read_b32 v237,a117
M v[76:79],a[100:103],v[220:223],v[76:79]
v_add_f32 v236,v238,v237
v_sub_f32 v238,v238,v237
M v[76:79],a[248:251],a[232:235],v[76:79]
v_add_f32 v237,v21,v117
v_sub_f32 v117,v21,v117
M v[76:79],a[224:227],a[192:195],v[76:79]
buffer_store_dwordx4 a[12:15],v253,s[24:27],s34 offen offset:384 nt
M v[80:83],a[224:227],a[232:235],v[80:83]
v_add_f32 v21,v236,v237
v_fmac_f32 v236,4.0,v237
M v[80:83],a[248:251],v[220:223],v[80:83]
v_fma_f32 v237,2.0,v117,v238
v_fma_f32 v117,s40,v117,v238
M v[80:83],a[100:103],a[208:211],v[80:83]
buffer_load_dwordx4 a[212:215],v250,s[20:23],s46 offen offset:0 sc1
M v[84:87],a[100:103],a[220:223],v[84:87]
v_cvt_pk_bf16_f32 v232,v232,v237
v_cvt_pk_bf16_f32 v234,v234,v236
M v[84:87],a[248:251],a[208:211],v[84:87]
ds_read_b128 a[192:195],v248 offset:26112
v_accvgpr_read_b32 v238,a22
M v[84:87],a[224:227],v[220:223],v[84:87]
ds_read_b128 a[232:235],v249 offset:26112
v_accvgpr_read_b32 v233,a118
M v[88:91],a[224:227],a[208:211],v[88:91]
buffer_load_dwordx4 a[228:231],v250,s[20:23],s46 offen offset:1024 sc1
M v[88:91],a[248:251],a[220:223],v[88:91]
ds_read_b128 v[220:223],v248 offset:26624
ds_read_b128 a[208:211],v249 offset:26624
M v[88:91],a[100:103],a[216:219],v[88:91]
v_add_f32 v235,v238,v233
v_sub_f32 v238,v238,v233
M v[92:95],a[100:103],a[244:247],v[92:95]
v_add_f32 v233,v22,v118
v_sub_f32 v118,v22,v118
M v[92:95],a[248:251],a[216:219],v[92:95]
buffer_load_dwordx4 a[252:255],v250,s[20:23],s46 offen offset:2048 sc1
M v[92:95],a[224:227],a[220:223],v[92:95]
s_waitcnt vmcnt(17) lgkmcnt(3)
s_add_u32 s46,s75,0
v_add_f32 v22,v235,v233
v_fmac_f32 v235,4.0,v233
M v[128:131],a[104:107],a[192:195],v[128:131]
s_waitcnt vmcnt(16) lgkmcnt(2)
ds_read_b128 a[244:247],v248 offset:27136
v_fma_f32 v233,2.0,v118,v238
M v[128:131],a[236:239],a[232:235],v[128:131]
s_waitcnt vmcnt(15) lgkmcnt(2)
ds_read_b128 a[216:219],v249 offset:27136
v_fma_f32 v118,s40,v118,v238
M v[128:131],a[204:207],v[220:223],v[128:131]
s_waitcnt lgkmcnt(2)
buffer_load_dwordx4 a[100:103],v250,s[20:23],s46 offen offset:0 sc1
M v[132:135],a[204:207],a[208:211],v[132:135]
v_accvgpr_read_b32 v238,a23
v_accvgpr_read_b32 v237,a119
M v[132:135],a[236:239],v[220:223],v[132:135]
v_add_f32 v236,v238,v237
v_sub_f32 v238,v238,v237
M v[132:135],a[104:107],a[232:235],v[132:135]
v_add_f32 v237,v23,v119
v_sub_f32 v119,v23,v119
M v[136:139],a[104:107],v[220:223],v[136:139]
ds_read_b128 a[116:119],v248 offset:27648
v_add_f32 v23,v236,v237
M v[136:139],a[236:239],a[208:211],v[136:139]
s_waitcnt lgkmcnt(2)
ds_read_b128 a[248:251],v249 offset:27648
v_fmac_f32 v236,4.0,v237
M v[136:139],a[204:207],a[244:247],v[136:139]
s_waitcnt lgkmcnt(2)
v_fma_f32 v237,2.0,v119,v238
v_fma_f32 v119,s40,v119,v238
M v[140:143],a[204:207],a[216:219],v[140:143]
v_cvt_pk_bf16_f32 v233,v233,v237
v_cvt_pk_bf16_f32 v235,v235,v236
M v[140:143],a[236:239],a[244:247],v[140:143]
ds_write2st64_b64 v254,v[232:233],v[234:235] offset0:76 offset1:80
M v[140:143],a[104:107],a[208:211],v[140:143]
v_accvgpr_read_b32 v238,a24
v_accvgpr_read_b32 v232,a120
M v[144:147],a[104:107],a[244:247],v[144:147]
ds_read_b128 a[220:223],v249 offset:28160
v_add_f32 v234,v238,v232
M v[144:147],a[236:239],a[216:219],v[144:147]
s_waitcnt lgkmcnt(3)
ds_read_b128 a[224:227],v248 offset:28160
v_sub_f32 v238,v238,v232
M v[144:147],a[204:207],a[116:119],v[144:147]
s_waitcnt lgkmcnt(3)
v_add_f32 v232,v24,v120
v_sub_f32 v120,v24,v120
M v[148:151],a[204:207],a[248:251],v[148:151]
v_add_f32 v24,v234,v232
v_fmac_f32 v234,4.0,v232
M v[148:151],a[236:239],a[116:119],v[148:151]
v_fma_f32 v232,2.0,v120,v238
v_fma_f32 v120,s40,v120,v238
M v[148:151],a[104:107],a[216:219],v[148:151]
s_waitcnt lgkmcnt(2)
s_barrier
ds_read_b128 a[16:19],v250 offset:34816
M v[152:155],a[104:107],a[116:119],v[152:155]
ds_read_b128 a[20:23],v250 offset:38912
v_accvgpr_read_b32 v238,a25
M v[152:155],a[236:239],a[248:251],v[152:155]
s_waitcnt lgkmcnt(3)
v_accvgpr_read_b32 v237,a121
v_add_f32 v236,v238,v237
M v[152:155],a[204:207],a[220:223],v[152:155]
s_waitcnt lgkmcnt(2)
v_sub_f32 v238,v238,v237
v_add_f32 v237,v25,v121
M v[156:159],a[204:207],a[224:227],v[156:159]
buffer_load_dwordx4 a[204:207],v250,s[20:23],s46 offen offset:1024 sc1
M v[156:159],a[236:239],a[220:223],v[156:159]
s_add_u32 s34,s32,7077888
v_sub_f32 v121,v25,v121
v_add_f32 v25,v236,v237
M v[156:159],a[104:107],a[248:251],v[156:159]
s_waitcnt vmcnt(16) lgkmcnt(1)
buffer_store_dwordx4 a[16:19],v253,s[24:27],s34 offen offset:384 nt
M v[160:163],a[200:203],a[192:195],v[160:163]
s_waitcnt vmcnt(16)
s_add_u32 s34,s32,7274496
v_fmac_f32 v236,4.0,v237
v_fma_f32 v237,2.0,v121,v238
M v[160:163],v[224:227],a[232:235],v[160:163]
s_waitcnt vmcnt(15)
v_fma_f32 v121,s40,v121,v238
v_cvt_pk_bf16_f32 v232,v232,v237
M v[160:163],v[228:231],v[220:223],v[160:163]
s_waitcnt lgkmcnt(0)
buffer_store_dwordx4 a[20:23],v253,s[24:27],s34 offen offset:384 nt
M v[164:167],v[228:231],a[208:211],v[164:167]
v_cvt_pk_bf16_f32 v234,v234,v236
v_accvgpr_read_b32 v238,a26
M v[164:167],v[224:227],v[220:223],v[164:167]
v_accvgpr_read_b32 v233,a122
v_add_f32 v235,v238,v233
M v[164:167],a[200:203],a[232:235],v[164:167]
buffer_load_dwordx4 a[236:239],v250,s[20:23],s46 offen offset:2048 sc1
M v[168:171],a[200:203],v[220:223],v[168:171]
s_add_u32 s46,s76,0
v_sub_f32 v238,v238,v233
v_add_f32 v233,v26,v122
M v[168:171],v[224:227],a[208:211],v[168:171]
v_sub_f32 v122,v26,v122
v_add_f32 v26,v235,v233
M v[168:171],v[228:231],a[244:247],v[168:171]
v_fmac_f32 v235,4.0,v233
v_fma_f32 v233,2.0,v122,v238
M v[172:175],v[228:231],a[216:219],v[172:175]
buffer_load_dwordx4 a[104:107],v250,s[20:23],s46 offen offset:0 sc1
M v[172:175],v[224:227],a[244:247],v[172:175]
v_fma_f32 v122,s40,v122,v238
v_accvgpr_read_b32 v238,a27
M v[172:175],a[200:203],a[208:211],v[172:175]
v_accvgpr_read_b32 v237,a123
v_add_f32 v236,v238,v237
M v[176:179],a[200:203],a[244:247],v[176:179]
v_sub_f32 v238,v238,v237
v_add_f32 v237,v27,v123
M v[176:179],v[224:227],a[216:219],v[176:179]
buffer_load_dwordx4 a[192:195],v250,s[20:23],s46 offen offset:1024 sc1
M v[176:179],v[228:231],a[116:119],v[176:179]
v_sub_f32 v123,v27,v123
v_add_f32 v27,v236,v237
M v[180:183],v[228:231],a[248:251],v[180:183]
v_fmac_f32 v236,4.0,v237
v_fma_f32 v237,2.0,v123,v238
M v[180:183],v[224:227],a[116:119],v[180:183]
ds_read_b128 a[120:123],v248 offset:52224
v_fma_f32 v123,s40,v123,v238
M v[180:183],a[200:203],a[216:219],v[180:183]
buffer_load_dwordx4 a[232:235],v250,s[20:23],s46 offen offset:2048 sc1
M v[184:187],a[200:203],a[116:119],v[184:187]
s_add_u32 s46,s77,0
ds_read_b128 a[208:211],v249 offset:52224
ds_read_b128 a[116:119],v248 offset:52736
M v[184:187],v[224:227],a[248:251],v[184:187]
ds_read_b128 a[244:247],v249 offset:52736
v_cvt_pk_bf16_f32 v233,v233,v237
M v[184:187],v[228:231],a[220:223],v[184:187]
v_cvt_pk_bf16_f32 v235,v235,v236
M v[188:191],v[228:231],a[224:227],v[188:191]
buffer_load_dwordx4 v[220:223],v250,s[20:23],s46 offen offset:0 sc1
M v[188:191],v[224:227],a[220:223],v[188:191]
ds_write2st64_b64 v254,v[232:233],v[234:235] offset0:85 offset1:89
M v[188:191],a[200:203],a[248:251],v[188:191]
s_waitcnt vmcnt(19) lgkmcnt(4)
v_accvgpr_read_b32 v204,a28
v_accvgpr_read_b32 v208,a124
M v[0:3],a[96:99],a[120:123],v[0:3]
s_waitcnt vmcnt(18) lgkmcnt(3)
ds_read_b128 a[120:123],v248 offset:53248
v_accvgpr_read_b32 v205,a29
M v[0:3],a[108:111],a[208:211],v[0:3]
s_waitcnt vmcnt(16) lgkmcnt(3)
buffer_load_dwordx4 a[216:219],v250,s[20:23],s46 offen offset:1024 sc1
M v[0:3],a[112:115],a[116:119],v[0:3]
s_waitcnt lgkmcnt(2)
ds_read_b128 a[200:203],v249 offset:53248
v_accvgpr_read_b32 v209,a125
M v[4:7],a[112:115],a[244:247],v[4:7]
v_accvgpr_read_b32 v206,a30
v_accvgpr_read_b32 v210,a126
v_accvgpr_read_b32 v207,a31
v_accvgpr_read_b32 v211,a127
v_pk_add_f32 v[212:213],v[204:205],v[208:209]
v_pk_add_f32 v[214:215],v[206:207],v[210:211]
v_pk_add_f32 v[204:205],v[204:205],v[208:209] neg_lo:[0,1] neg_hi:[0,1]
v_pk_add_f32 v[206:207],v[206:207],v[210:211] neg_lo:[0,1] neg_hi:[0,1]
v_pk_add_f32 v[208:209],v[28:29],v[124:125]
v_pk_add_f32 v[210:211],v[30:31],v[126:127]
v_pk_add_f32 v[124:125],v[28:29],v[124:125] neg_lo:[0,1] neg_hi:[0,1]
v_pk_add_f32 v[126:127],v[30:31],v[126:127] neg_lo:[0,1] neg_hi:[0,1]
v_pk_add_f32 v[28:29],v[212:213],v[208:209]
v_pk_add_f32 v[30:31],v[214:215],v[210:211]
v_pk_fma_f32 v[212:213],v[208:209],4.0,v[212:213] op_sel_hi:[1,0,1]
v_pk_fma_f32 v[214:215],v[210:211],4.0,v[214:215] op_sel_hi:[1,0,1]
v_pk_fma_f32 v[208:209],v[124:125],2.0,v[204:205] op_sel_hi:[1,0,1]
v_pk_fma_f32 v[210:211],v[126:127],2.0,v[206:207] op_sel_hi:[1,0,1]
v_pk_fma_f32 v[124:125],v[124:125],s[40:41],v[204:205] op_sel_hi:[1,0,1]
v_pk_fma_f32 v[126:127],v[126:127],s[40:41],v[206:207] op_sel_hi:[1,0,1]
M v[4:7],a[108:111],a[116:119],v[4:7]
buffer_load_dwordx4 a[224:227],v250,s[20:23],s46 offen offset:2048 sc1
M v[4:7],a[96:99],a[208:211],v[4:7]
s_add_u32 s46,s72,46080
v_cvt_pk_bf16_f32 v208,v208,v209
v_cvt_pk_bf16_f32 v209,v210,v211
M v[8:11],a[96:99],a[116:119],v[8:11]
buffer_load_dwordx4 v[228:231],v250,s[20:23],s46 offen offset:0 sc1
M v[8:11],a[108:111],a[244:247],v[8:11]
s_waitcnt lgkmcnt(1)
ds_read_b128 a[124:127],v248 offset:53760
ds_read_b128 a[116:119],v249 offset:53760
M v[8:11],a[112:115],a[120:123],v[8:11]
s_waitcnt lgkmcnt(2)
v_cvt_pk_bf16_f32 v212,v212,v213
v_cvt_pk_bf16_f32 v213,v214,v215
M v[12:15],a[112:115],a[200:203],v[12:15]
ds_write2st64_b64 v254,v[208:209],v[212:213] offset0:93 offset1:97
M v[12:15],a[108:111],a[120:123],v[12:15]
buffer_load_dwordx4 a[220:223],v250,s[20:23],s46 offen offset:1024 sc1
M v[12:15],a[96:99],a[244:247],v[12:15]
v_accvgpr_read_b32 v238,a32
v_accvgpr_read_b32 v232,a128
M v[16:19],a[96:99],a[120:123],v[16:19]
ds_read_b128 a[120:123],v249 offset:54272
v_add_f32 v234,v238,v232
M v[16:19],a[108:111],a[200:203],v[16:19]
s_waitcnt lgkmcnt(3)
ds_read_b128 a[248:251],v248 offset:54272
v_add_u32 v248,0x15400,v248
M v[16:19],a[112:115],a[124:127],v[16:19]
s_waitcnt lgkmcnt(3)
buffer_load_dwordx4 v[224:227],v250,s[20:23],s46 offen offset:2048 sc1
M v[20:23],a[112:115],a[116:119],v[20:23]
s_add_u32 s47,s72,49152
v_add_u32 v249,0x15400,v249
v_sub_f32 v238,v238,v232
M v[20:23],a[108:111],a[124:127],v[20:23]
ds_read_b128 a[208:211],v248 offset:0
v_add_f32 v232,v32,v128
M v[20:23],a[96:99],a[200:203],v[20:23]
ds_read_b128 a[244:247],v249 offset:0
v_sub_f32 v128,v32,v128
M v[24:27],a[96:99],a[124:127],v[24:27]
ds_read_b128 a[124:127],v248 offset:512
v_add_f32 v32,v234,v232
M v[24:27],a[108:111],a[116:119],v[24:27]
s_waitcnt lgkmcnt(4)
ds_read_b128 a[200:203],v249 offset:512
v_fmac_f32 v234,4.0,v232
M v[24:27],a[112:115],a[120:123],v[24:27]
s_waitcnt lgkmcnt(4)
v_fma_f32 v232,2.0,v128,v238
v_fma_f32 v128,s40,v128,v238
M v[28:31],a[112:115],a[248:251],v[28:31]
s_barrier
ds_read_b128 a[24:27],v250 offset:43520
M v[28:31],a[108:111],a[120:123],v[28:31]
ds_read_b128 a[28:31],v250 offset:47616
v_accvgpr_read_b32 v238,a33
M v[28:31],a[96:99],a[116:119],v[28:31]
s_waitcnt vmcnt(20) lgkmcnt(5)
buffer_load_dwordx4 a[112:115],v250,s[20:23],s47 offen offset:0 sc1
M v[0:3],v[216:219],a[208:211],v[0:3]
s_waitcnt vmcnt(20) lgkmcnt(4)
ds_read_b128 a[120:123],v248 offset:1024
v_accvgpr_read_b32 v237,a129
M v[0:3],a[196:199],a[244:247],v[0:3]
s_waitcnt vmcnt(19) lgkmcnt(4)
buffer_load_dwordx4 a[248:251],v250,s[20:23],s47 offen offset:1024 sc1
M v[0:3],a[240:243],a[124:127],v[0:3]
s_waitcnt lgkmcnt(3)
s_add_u32 s34,s32,7471104
ds_read_b128 a[96:99],v249 offset:1024
v_add_f32 v236,v238,v237
M v[4:7],a[240:243],a[200:203],v[4:7]
v_sub_f32 v238,v238,v237
v_add_f32 v237,v33,v129
M v[4:7],a[196:199],a[124:127],v[4:7]
v_sub_f32 v129,v33,v129
v_add_f32 v33,v236,v237
M v[4:7],v[216:219],a[244:247],v[4:7]
s_waitcnt lgkmcnt(3)
buffer_store_dwordx4 a[24:27],v253,s[24:27],s34 offen offset:384 nt
M v[8:11],v[216:219],a[124:127],v[8:11]
s_add_u32 s34,s32,7667712
ds_read_b128 a[116:119],v248 offset:1536
v_fmac_f32 v236,4.0,v237
M v[8:11],a[196:199],a[200:203],v[8:11]
s_waitcnt lgkmcnt(2)
ds_read_b128 a[124:127],v249 offset:1536
v_fma_f32 v237,2.0,v129,v238
M v[8:11],a[240:243],a[120:123],v[8:11]
s_waitcnt lgkmcnt(2)
buffer_store_dwordx4 a[28:31],v253,s[24:27],s34 offen offset:384 nt
M v[12:15],a[240:243],a[96:99],v[12:15]
v_fma_f32 v129,s40,v129,v238
v_cvt_pk_bf16_f32 v232,v232,v237
M v[12:15],a[196:199],a[120:123],v[12:15]
v_cvt_pk_bf16_f32 v234,v234,v236
v_accvgpr_read_b32 v238,a34
M v[12:15],v[216:219],a[200:203],v[12:15]
buffer_load_dwordx4 a[108:111],v250,s[20:23],s47 offen offset:2048 sc1
M v[16:19],v[216:219],a[120:123],v[16:19]
ds_read_b128 a[120:123],v249 offset:2048
v_accvgpr_read_b32 v233,a130
M v[16:19],a[196:199],a[96:99],v[16:19]
s_waitcnt lgkmcnt(2)
ds_read_b128 a[208:211],v248 offset:2048
v_add_f32 v235,v238,v233
M v[16:19],a[240:243],a[116:119],v[16:19]
s_waitcnt lgkmcnt(2)
v_sub_f32 v238,v238,v233
v_add_f32 v233,v34,v130
M v[20:23],a[240:243],a[124:127],v[20:23]
s_add_u32 s46,s73,46080
v_sub_f32 v130,v34,v130
v_add_f32 v34,v235,v233
M v[20:23],a[196:199],a[116:119],v[20:23]
ds_read_b128 a[244:247],v248 offset:17408
v_fmac_f32 v235,4.0,v233
M v[20:23],v[216:219],a[96:99],v[20:23]
ds_read_b128 a[96:99],v249 offset:17408
v_fma_f32 v233,2.0,v130,v238
M v[24:27],v[216:219],a[116:119],v[24:27]
ds_read_b128 a[116:119],v248 offset:17920
v_fma_f32 v130,s40,v130,v238
M v[24:27],a[196:199],a[124:127],v[24:27]
s_waitcnt lgkmcnt(4)
v_accvgpr_read_b32 v238,a35
v_accvgpr_read_b32 v237,a131
M v[24:27],a[240:243],a[120:123],v[24:27]
s_waitcnt lgkmcnt(3)
ds_read_b128 a[128:131],v249 offset:17920
v_add_f32 v236,v238,v237
M v[28:31],a[240:243],a[208:211],v[28:31]
buffer_load_dwordx4 a[200:203],v250,s[20:23],s46 offen offset:0 sc1
M v[28:31],a[196:199],a[120:123],v[28:31]
v_sub_f32 v238,v238,v237
v_add_f32 v237,v35,v131
M v[28:31],v[216:219],a[124:127],v[28:31]
s_waitcnt vmcnt(22) lgkmcnt(3)
buffer_load_dwordx4 a[208:211],v250,s[20:23],s46 offen offset:1024 sc1
M v[0:3],a[212:215],a[244:247],v[0:3]
s_waitcnt vmcnt(22) lgkmcnt(2)
ds_read_b128 a[124:127],v248 offset:18432
v_sub_f32 v131,v35,v131
M v[0:3],a[228:231],a[96:99],v[0:3]
s_waitcnt vmcnt(21) lgkmcnt(2)
ds_read_b128 a[240:243],v249 offset:18432
v_add_f32 v35,v236,v237
M v[0:3],a[252:255],a[116:119],v[0:3]
s_waitcnt lgkmcnt(2)
v_fmac_f32 v236,4.0,v237
v_fma_f32 v237,2.0,v131,v238
M v[4:7],a[252:255],a[128:131],v[4:7]
buffer_load_dwordx4 a[120:123],v250,s[20:23],s46 offen offset:2048 sc1
M v[4:7],a[228:231],a[116:119],v[4:7]
v_fma_f32 v131,s40,v131,v238
v_cvt_pk_bf16_f32 v233,v233,v237
M v[4:7],a[212:215],a[96:99],v[4:7]
v_cvt_pk_bf16_f32 v235,v235,v236
M v[8:11],a[212:215],a[116:119],v[8:11]
ds_read_b128 a[96:99],v248 offset:18944
ds_write2st64_b64 v254,v[232:233],v[234:235] offset0:34 offset1:38
M v[8:11],a[228:231],a[128:131],v[8:11]
s_waitcnt lgkmcnt(3)
ds_read_b128 a[116:119],v249 offset:18944
v_accvgpr_read_b32 v204,a36
M v[8:11],a[252:255],a[124:127],v[8:11]
s_waitcnt lgkmcnt(3)
v_accvgpr_read_b32 v208,a132
v_accvgpr_read_b32 v205,a37
M v[12:15],a[252:255],a[240:243],v[12:15]
v_accvgpr_read_b32 v209,a133
v_accvgpr_read_b32 v206,a38
M v[12:15],a[228:231],a[124:127],v[12:15]
v_accvgpr_read_b32 v210,a134
v_accvgpr_read_b32 v207,a39
v_accvgpr_read_b32 v211,a135
v_pk_add_f32 v[212:213],v[204:205],v[208:209]
v_pk_add_f32 v[214:215],v[206:207],v[210:211]
v_pk_add_f32 v[204:205],v[204:205],v[208:209] neg_lo:[0,1] neg_hi:[0,1]
v_pk_add_f32 v[206:207],v[206:207],v[210:211] neg_lo:[0,1] neg_hi:[0,1]
v_pk_add_f32 v[208:209],v[36:37],v[132:133]
v_pk_add_f32 v[210:211],v[38:39],v[134:135]
v_pk_add_f32 v[132:133],v[36:37],v[132:133] neg_lo:[0,1] neg_hi:[0,1]
v_pk_add_f32 v[134:135],v[38:39],v[134:135] neg_lo:[0,1] neg_hi:[0,1]
v_pk_add_f32 v[36:37],v[212:213],v[208:209]
v_pk_add_f32 v[38:39],v[214:215],v[210:211]
v_pk_fma_f32 v[212:213],v[208:209],4.0,v[212:213] op_sel_hi:[1,0,1]
v_pk_fma_f32 v[214:215],v[210:211],4.0,v[214:215] op_sel_hi:[1,0,1]
v_pk_fma_f32 v[208:209],v[132:133],2.0,v[204:205] op_sel_hi:[1,0,1]
v_pk_fma_f32 v[210:211],v[134:135],2.0,v[206:207] op_sel_hi:[1,0,1]
v_pk_fma_f32 v[132:133],v[132:133],s[40:41],v[204:205] op_sel_hi:[1,0,1]
v_pk_fma_f32 v[134:135],v[134:135],s[40:41],v[206:207] op_sel_hi:[1,0,1]
M v[12:15],a[212:215],a[128:131],v[12:15]
v_cvt_pk_bf16_f32 v208,v208,v209
v_cvt_pk_bf16_f32 v209,v210,v211
M v[16:19],a[212:215],a[124:127],v[16:19]
s_add_u32 s47,s73,49152
ds_read_b128 a[128:131],v249 offset:19456
v_cvt_pk_bf16_f32 v212,v212,v213
M v[16:19],a[228:231],a[240:243],v[16:19]
s_waitcnt lgkmcnt(3)
ds_read_b128 a[132:135],v248 offset:19456
v_cvt_pk_bf16_f32 v213,v214,v215
M v[16:19],a[252:255],a[96:99],v[16:19]
s_waitcnt lgkmcnt(2)
ds_write2st64_b64 v254,v[208:209],v[212:213] offset0:42 offset1:46
M v[20:23],a[252:255],a[116:119],v[20:23]
v_accvgpr_read_b32 v204,a40
v_accvgpr_read_b32 v208,a136
M v[20:23],a[228:231],a[96:99],v[20:23]
ds_read_b128 a[124:127],v248 offset:34816
v_accvgpr_read_b32 v205,a41
M v[20:23],a[212:215],a[240:243],v[20:23]
ds_read_b128 a[196:199],v249 offset:34816
v_accvgpr_read_b32 v209,a137
M v[24:27],a[212:215],a[96:99],v[24:27]
buffer_load_dwordx4 a[96:99],v250,s[20:23],s47 offen offset:0 sc1
M v[24:27],a[228:231],a[116:119],v[24:27]
s_waitcnt lgkmcnt(4)
v_accvgpr_read_b32 v206,a42
v_accvgpr_read_b32 v210,a138
v_accvgpr_read_b32 v207,a43
v_accvgpr_read_b32 v211,a139
v_pk_add_f32 v[212:213],v[204:205],v[208:209]
v_pk_add_f32 v[214:215],v[206:207],v[210:211]
v_pk_add_f32 v[204:205],v[204:205],v[208:209] neg_lo:[0,1] neg_hi:[0,1]
v_pk_add_f32 v[206:207],v[206:207],v[210:211] neg_lo:[0,1] neg_hi:[0,1]
v_pk_add_f32 v[208:209],v[40:41],v[136:137]
v_pk_add_f32 v[210:211],v[42:43],v[138:139]
v_pk_add_f32 v[136:137],v[40:41],v[136:137] neg_lo:[0,1] neg_hi:[0,1]
v_pk_add_f32 v[138:139],v[42:43],v[138:139] neg_lo:[0,1] neg_hi:[0,1]
v_pk_add_f32 v[40:41],v[212:213],v[208:209]
v_pk_add_f32 v[42:43],v[214:215],v[210:211]
v_pk_fma_f32 v[212:213],v[208:209],4.0,v[212:213] op_sel_hi:[1,0,1]
v_pk_fma_f32 v[214:215],v[210:211],4.0,v[214:215] op_sel_hi:[1,0,1]
v_pk_fma_f32 v[208:209],v[136:137],2.0,v[204:205] op_sel_hi:[1,0,1]
v_pk_fma_f32 v[210:211],v[138:139],2.0,v[206:207] op_sel_hi:[1,0,1]
v_pk_fma_f32 v[136:137],v[136:137],s[40:41],v[204:205] op_sel_hi:[1,0,1]
v_pk_fma_f32 v[138:139],v[138:139],s[40:41],v[206:207] op_sel_hi:[1,0,1]
M v[24:27],a[252:255],a[128:131],v[24:27]
s_waitcnt lgkmcnt(3)
ds_read_b128 a[136:139],v248 offset:35328
ds_read_b128 v[216:219],v249 offset:35328
M v[28:31],a[252:255],a[132:135],v[28:31]
buffer_load_dwordx4 a[244:247],v250,s[20:23],s47 offen offset:1024 sc1
M v[28:31],a[228:231],a[128:131],v[28:31]
v_cvt_pk_bf16_f32 v208,v208,v209
v_cvt_pk_bf16_f32 v209,v210,v211
M v[28:31],a[212:215],a[116:119],v[28:31]
s_waitcnt vmcnt(23) lgkmcnt(3)
buffer_load_dwordx4 a[132:135],v250,s[20:23],s47 offen offset:2048 sc1
M v[0:3],a[100:103],a[124:127],v[0:3]
s_waitcnt vmcnt(23) lgkmcnt(2)
ds_read_b128 a[128:131],v248 offset:35840
v_cvt_pk_bf16_f32 v212,v212,v213
M v[0:3],a[204:207],a[196:199],v[0:3]
s_waitcnt vmcnt(20) lgkmcnt(2)
ds_read_b128 a[116:119],v249 offset:35840
v_cvt_pk_bf16_f32 v213,v214,v215
M v[0:3],a[236:239],a[136:139],v[0:3]
s_waitcnt lgkmcnt(2)
ds_write2st64_b64 v254,v[208:209],v[212:213] offset0:51 offset1:55
M v[4:7],a[236:239],v[216:219],v[4:7]
v_accvgpr_read_b32 v204,a44
v_accvgpr_read_b32 v208,a140
M v[4:7],a[204:207],a[136:139],v[4:7]
v_accvgpr_read_b32 v205,a45
v_accvgpr_read_b32 v209,a141
M v[4:7],a[100:103],a[196:199],v[4:7]
v_accvgpr_read_b32 v206,a46
v_accvgpr_read_b32 v210,a142
v_accvgpr_read_b32 v207,a47
v_accvgpr_read_b32 v211,a143
v_pk_add_f32 v[212:213],v[204:205],v[208:209]
v_pk_add_f32 v[214:215],v[206:207],v[210:211]
v_pk_add_f32 v[204:205],v[204:205],v[208:209] neg_lo:[0,1] neg_hi:[0,1]
v_pk_add_f32 v[206:207],v[206:207],v[210:211] neg_lo:[0,1] neg_hi:[0,1]
v_pk_add_f32 v[208:209],v[44:45],v[140:141]
v_pk_add_f32 v[210:211],v[46:47],v[142:143]
v_pk_add_f32 v[140:141],v[44:45],v[140:141] neg_lo:[0,1] neg_hi:[0,1]
v_pk_add_f32 v[142:143],v[46:47],v[142:143] neg_lo:[0,1] neg_hi:[0,1]
v_pk_add_f32 v[44:45],v[212:213],v[208:209]
v_pk_add_f32 v[46:47],v[214:215],v[210:211]
v_pk_fma_f32 v[212:213],v[208:209],4.0,v[212:213] op_sel_hi:[1,0,1]
v_pk_fma_f32 v[214:215],v[210:211],4.0,v[214:215] op_sel_hi:[1,0,1]
v_pk_fma_f32 v[208:209],v[140:141],2.0,v[204:205] op_sel_hi:[1,0,1]
v_pk_fma_f32 v[210:211],v[142:143],2.0,v[206:207] op_sel_hi:[1,0,1]
v_pk_fma_f32 v[140:141],v[140:141],s[40:41],v[204:205] op_sel_hi:[1,0,1]
v_pk_fma_f32 v[142:143],v[142:143],s[40:41],v[206:207] op_sel_hi:[1,0,1]
M v[8:11],a[100:103],a[136:139],v[8:11]
ds_read_b128 a[124:127],v248 offset:36352
v_cvt_pk_bf16_f32 v208,v208,v209
M v[8:11],a[204:207],v[216:219],v[8:11]
s_waitcnt lgkmcnt(3)
ds_read_b128 a[136:139],v249 offset:36352
v_cvt_pk_bf16_f32 v209,v210,v211
M v[8:11],a[236:239],a[128:131],v[8:11]
s_waitcnt lgkmcnt(3)
v_cvt_pk_bf16_f32 v212,v212,v213
v_cvt_pk_bf16_f32 v213,v214,v215
M v[12:15],a[236:239],a[116:119],v[12:15]
ds_write2st64_b64 v254,v[208:209],v[212:213] offset0:59 offset1:63
M v[12:15],a[204:207],a[128:131],v[12:15]
v_accvgpr_read_b32 v238,a48
v_accvgpr_read_b32 v232,a144
M v[12:15],a[100:103],v[216:219],v[12:15]
v_add_f32 v234,v238,v232
v_sub_f32 v238,v238,v232
M v[16:19],a[100:103],a[128:131],v[16:19]
s_add_u32 s46,s74,46080
ds_read_b128 a[140:143],v249 offset:36864
v_add_f32 v232,v48,v144
M v[16:19],a[204:207],a[116:119],v[16:19]
s_waitcnt lgkmcnt(3)
ds_read_b128 a[128:131],v248 offset:36864
v_sub_f32 v144,v48,v144
M v[16:19],a[236:239],a[124:127],v[16:19]
s_waitcnt lgkmcnt(3)
v_add_f32 v48,v234,v232
v_fmac_f32 v234,4.0,v232
M v[20:23],a[236:239],a[136:139],v[20:23]
v_fma_f32 v232,2.0,v144,v238
v_fma_f32 v144,s40,v144,v238
M v[20:23],a[204:207],a[124:127],v[20:23]
ds_read_b128 a[240:243],v248 offset:52224
v_accvgpr_read_b32 v238,a49
M v[20:23],a[100:103],a[116:119],v[20:23]
ds_read_b128 a[116:119],v249 offset:52224
v_accvgpr_read_b32 v237,a145
M v[24:27],a[100:103],a[124:127],v[24:27]
buffer_load_dwordx4 a[124:127],v250,s[20:23],s46 offen offset:0 sc1
M v[24:27],a[204:207],a[136:139],v[24:27]
s_waitcnt lgkmcnt(3)
ds_read_b128 a[252:255],v248 offset:52736
ds_read_b128 a[212:215],v249 offset:52736
M v[24:27],a[236:239],a[140:143],v[24:27]
s_waitcnt lgkmcnt(4)
buffer_load_dwordx4 a[228:231],v250,s[20:23],s46 offen offset:1024 sc1
M v[28:31],a[236:239],a[128:131],v[28:31]
v_add_f32 v236,v238,v237
v_sub_f32 v238,v238,v237
M v[28:31],a[204:207],a[140:143],v[28:31]
v_add_f32 v237,v49,v145
v_sub_f32 v145,v49,v145
M v[28:31],a[100:103],a[136:139],v[28:31]
s_waitcnt vmcnt(21) lgkmcnt(3)
v_add_f32 v49,v236,v237
v_fmac_f32 v236,4.0,v237
M v[0:3],a[104:107],a[240:243],v[0:3]
s_waitcnt vmcnt(20) lgkmcnt(2)
buffer_load_dwordx4 a[196:199],v250,s[20:23],s46 offen offset:2048 sc1
M v[0:3],a[192:195],a[116:119],v[0:3]
s_waitcnt vmcnt(20) lgkmcnt(1)
ds_read_b128 a[128:131],v248 offset:53248
ds_read_b128 a[140:143],v249 offset:53248
M v[0:3],a[232:235],a[252:255],v[0:3]
s_waitcnt lgkmcnt(2)
v_fma_f32 v237,2.0,v145,v238
v_fma_f32 v145,s40,v145,v238
M v[4:7],a[232:235],a[212:215],v[4:7]
v_cvt_pk_bf16_f32 v232,v232,v237
v_cvt_pk_bf16_f32 v234,v234,v236
M v[4:7],a[192:195],a[252:255],v[4:7]
v_accvgpr_read_b32 v238,a50
v_accvgpr_read_b32 v233,a146
M v[4:7],a[104:107],a[116:119],v[4:7]
v_add_f32 v235,v238,v233
v_sub_f32 v238,v238,v233
M v[8:11],a[104:107],a[252:255],v[8:11]
ds_read_b128 a[100:103],v248 offset:53760
v_add_f32 v233,v50,v146
M v[8:11],a[192:195],a[212:215],v[8:11]
s_waitcnt lgkmcnt(2)
ds_read_b128 a[136:139],v249 offset:53760
v_sub_f32 v146,v50,v146
M v[8:11],a[232:235],a[128:131],v[8:11]
s_waitcnt lgkmcnt(2)
v_add_f32 v50,v235,v233
v_fmac_f32 v235,4.0,v233
M v[12:15],a[232:235],a[140:143],v[12:15]
v_fma_f32 v233,2.0,v146,v238
v_fma_f32 v146,s40,v146,v238
M v[12:15],a[192:195],a[128:131],v[12:15]
v_accvgpr_read_b32 v238,a51
v_accvgpr_read_b32 v237,a147
M v[12:15],a[104:107],a[212:215],v[12:15]
v_add_f32 v236,v238,v237
v_sub_f32 v238,v238,v237
M v[16:19],a[104:107],a[128:131],v[16:19]
s_add_u32 s47,s74,49152
ds_read_b128 a[116:119],v249 offset:54272
v_add_f32 v237,v51,v147
M v[16:19],a[192:195],a[140:143],v[16:19]
s_waitcnt lgkmcnt(2)
ds_read_b128 a[144:147],v248 offset:54272
v_add_u32 v248,0xffff9a00,v248
M v[16:19],a[232:235],a[100:103],v[16:19]
s_waitcnt lgkmcnt(2)
v_add_u32 v249,0xffff9a00,v249
v_sub_f32 v147,v51,v147
M v[20:23],a[232:235],a[136:139],v[20:23]
v_add_f32 v51,v236,v237
v_fmac_f32 v236,4.0,v237
M v[20:23],a[192:195],a[100:103],v[20:23]
ds_read_b128 a[128:131],v248 offset:8704
v_fma_f32 v237,2.0,v147,v238
M v[20:23],a[104:107],a[140:143],v[20:23]
ds_read_b128 a[140:143],v249 offset:8704
v_fma_f32 v147,s40,v147,v238
M v[24:27],a[104:107],a[100:103],v[24:27]
buffer_load_dwordx4 a[100:103],v250,s[20:23],s47 offen offset:0 sc1
M v[24:27],a[192:195],a[136:139],v[24:27]
s_waitcnt lgkmcnt(3)
ds_read_b128 v[216:219],v248 offset:9216
ds_read_b128 a[204:207],v249 offset:9216
M v[24:27],a[232:235],a[116:119],v[24:27]
s_waitcnt lgkmcnt(4)
buffer_load_dwordx4 a[236:239],v250,s[20:23],s47 offen offset:1024 sc1
M v[28:31],a[232:235],a[144:147],v[28:31]
v_cvt_pk_bf16_f32 v233,v233,v237
v_cvt_pk_bf16_f32 v235,v235,v236
M v[28:31],a[192:195],a[116:119],v[28:31]
ds_write2st64_b64 v254,v[232:233],v[234:235] offset0:0 offset1:4
M v[28:31],a[104:107],a[136:139],v[28:31]
s_waitcnt vmcnt(21) lgkmcnt(4)
v_accvgpr_read_b32 v204,a52
v_accvgpr_read_b32 v208,a148
M v[0:3],v[220:223],a[128:131],v[0:3]
s_waitcnt vmcnt(20) lgkmcnt(3)
buffer_load_dwordx4 a[240:243],v250,s[20:23],s47 offen offset:2048 sc1
M v[0:3],a[216:219],a[140:143],v[0:3]
s_waitcnt vmcnt(20) lgkmcnt(2)
ds_read_b128 a[144:147],v248 offset:9728
ds_read_b128 a[116:119],v249 offset:9728
M v[0:3],a[224:227],v[216:219],v[0:3]
s_waitcnt lgkmcnt(3)
v_accvgpr_read_b32 v205,a53
v_accvgpr_read_b32 v209,a149
M v[4:7],a[224:227],a[204:207],v[4:7]
v_accvgpr_read_b32 v206,a54
v_accvgpr_read_b32 v210,a150
v_accvgpr_read_b32 v207,a55
v_accvgpr_read_b32 v211,a151
v_pk_add_f32 v[212:213],v[204:205],v[208:209]
v_pk_add_f32 v[214:215],v[206:207],v[210:211]
v_pk_add_f32 v[204:205],v[204:205],v[208:209] neg_lo:[0,1] neg_hi:[0,1]
v_pk_add_f32 v[206:207],v[206:207],v[210:211] neg_lo:[0,1] neg_hi:[0,1]
v_pk_add_f32 v[208:209],v[52:53],v[148:149]
v_pk_add_f32 v[210:211],v[54:55],v[150:151]
v_pk_add_f32 v[148:149],v[52:53],v[148:149] neg_lo:[0,1] neg_hi:[0,1]
v_pk_add_f32 v[150:151],v[54:55],v[150:151] neg_lo:[0,1] neg_hi:[0,1]
v_pk_add_f32 v[52:53],v[212:213],v[208:209]
v_pk_add_f32 v[54:55],v[214:215],v[210:211]
v_pk_fma_f32 v[212:213],v[208:209],4.0,v[212:213] op_sel_hi:[1,0,1]
v_pk_fma_f32 v[214:215],v[210:211],4.0,v[214:215] op_sel_hi:[1,0,1]
v_pk_fma_f32 v[208:209],v[148:149],2.0,v[204:205] op_sel_hi:[1,0,1]
v_pk_fma_f32 v[210:211],v[150:151],2.0,v[206:207] op_sel_hi:[1,0,1]
v_pk_fma_f32 v[148:149],v[148:149],s[40:41],v[204:205] op_sel_hi:[1,0,1]
v_pk_fma_f32 v[150:151],v[150:151],s[40:41],v[206:207] op_sel_hi:[1,0,1]
M v[4:7],a[216:219],v[216:219],v[4:7]
v_cvt_pk_bf16_f32 v208,v208,v209
v_cvt_pk_bf16_f32 v209,v210,v211
M v[4:7],v[220:223],a[140:143],v[4:7]
v_cvt_pk_bf16_f32 v212,v212,v213
v_cvt_pk_bf16_f32 v213,v214,v215
M v[8:11],v[220:223],v[216:219],v[8:11]
ds_read_b128 a[104:107],v248 offset:10240
ds_write2st64_b64 v254,v[208:209],v[212:213] offset0:8 offset1:12
M v[8:11],a[216:219],a[204:207],v[8:11]
s_waitcnt lgkmcnt(3)
ds_read_b128 a[136:139],v249 offset:10240
v_accvgpr_read_b32 v204,a56
M v[8:11],a[224:227],a[144:147],v[8:11]
s_waitcnt lgkmcnt(3)
v_accvgpr_read_b32 v208,a152
v_accvgpr_read_b32 v205,a57
M v[12:15],a[224:227],a[116:119],v[12:15]
v_accvgpr_read_b32 v209,a153
v_accvgpr_read_b32 v206,a58
M v[12:15],a[216:219],a[144:147],v[12:15]
v_accvgpr_read_b32 v210,a154
v_accvgpr_read_b32 v207,a59
v_accvgpr_read_b32 v211,a155
v_pk_add_f32 v[212:213],v[204:205],v[208:209]
v_pk_add_f32 v[214:215],v[206:207],v[210:211]
v_pk_add_f32 v[204:205],v[204:205],v[208:209] neg_lo:[0,1] neg_hi:[0,1]
v_pk_add_f32 v[206:207],v[206:207],v[210:211] neg_lo:[0,1] neg_hi:[0,1]
v_pk_add_f32 v[208:209],v[56:57],v[152:153]
v_pk_add_f32 v[210:211],v[58:59],v[154:155]
v_pk_add_f32 v[152:153],v[56:57],v[152:153] neg_lo:[0,1] neg_hi:[0,1]
v_pk_add_f32 v[154:155],v[58:59],v[154:155] neg_lo:[0,1] neg_hi:[0,1]
v_pk_add_f32 v[56:57],v[212:213],v[208:209]
v_pk_add_f32 v[58:59],v[214:215],v[210:211]
v_pk_fma_f32 v[212:213],v[208:209],4.0,v[212:213] op_sel_hi:[1,0,1]
v_pk_fma_f32 v[214:215],v[210:211],4.0,v[214:215] op_sel_hi:[1,0,1]
v_pk_fma_f32 v[208:209],v[152:153],2.0,v[204:205] op_sel_hi:[1,0,1]
v_pk_fma_f32 v[210:211],v[154:155],2.0,v[206:207] op_sel_hi:[1,0,1]
v_pk_fma_f32 v[152:153],v[152:153],s[40:41],v[204:205] op_sel_hi:[1,0,1]
v_pk_fma_f32 v[154:155],v[154:155],s[40:41],v[206:207] op_sel_hi:[1,0,1]
M v[12:15],v[220:223],a[204:207],v[12:15]
v_cvt_pk_bf16_f32 v208,v208,v209
v_cvt_pk_bf16_f32 v209,v210,v211
M v[16:19],v[220:223],a[144:147],v[16:19]
s_add_u32 s46,s75,46080
ds_read_b128 a[128:131],v249 offset:10752
v_cvt_pk_bf16_f32 v212,v212,v213
M v[16:19],a[216:219],a[116:119],v[16:19]
s_waitcnt lgkmcnt(3)
ds_read_b128 a[148:151],v248 offset:10752
v_cvt_pk_bf16_f32 v213,v214,v215
M v[16:19],a[224:227],a[104:107],v[16:19]
s_waitcnt lgkmcnt(2)
ds_write2st64_b64 v254,v[208:209],v[212:213] offset0:17 offset1:21
M v[20:23],a[224:227],a[136:139],v[20:23]
v_accvgpr_read_b32 v204,a60
v_accvgpr_read_b32 v208,a156
M v[20:23],a[216:219],a[104:107],v[20:23]
ds_read_b128 a[140:143],v248 offset:0
v_accvgpr_read_b32 v205,a61
M v[20:23],v[220:223],a[116:119],v[20:23]
ds_read_b128 a[152:155],v249 offset:0
v_accvgpr_read_b32 v209,a157
M v[24:27],v[220:223],a[104:107],v[24:27]
buffer_load_dwordx4 a[144:147],v250,s[20:23],s46 offen offset:0 sc1
M v[24:27],a[216:219],a[136:139],v[24:27]
s_waitcnt lgkmcnt(4)
ds_read_b128 a[116:119],v248 offset:512
ds_read_b128 a[252:255],v249 offset:512
M v[24:27],a[224:227],a[128:131],v[24:27]
s_waitcnt lgkmcnt(5)
buffer_load_dwordx4 a[104:107],v250,s[20:23],s46 offen offset:1024 sc1
M v[28:31],a[224:227],a[148:151],v[28:31]
v_accvgpr_read_b32 v206,a62
v_accvgpr_read_b32 v210,a158
v_accvgpr_read_b32 v207,a63
v_accvgpr_read_b32 v211,a159
v_pk_add_f32 v[212:213],v[204:205],v[208:209]
v_pk_add_f32 v[214:215],v[206:207],v[210:211]
v_pk_add_f32 v[204:205],v[204:205],v[208:209] neg_lo:[0,1] neg_hi:[0,1]
v_pk_add_f32 v[206:207],v[206:207],v[210:211] neg_lo:[0,1] neg_hi:[0,1]
v_pk_add_f32 v[208:209],v[60:61],v[156:157]
v_pk_add_f32 v[210:211],v[62:63],v[158:159]
v_pk_add_f32 v[156:157],v[60:61],v[156:157] neg_lo:[0,1] neg_hi:[0,1]
v_pk_add_f32 v[158:159],v[62:63],v[158:159] neg_lo:[0,1] neg_hi:[0,1]
v_pk_add_f32 v[60:61],v[212:213],v[208:209]
v_pk_add_f32 v[62:63],v[214:215],v[210:211]
v_pk_fma_f32 v[212:213],v[208:209],4.0,v[212:213] op_sel_hi:[1,0,1]
v_pk_fma_f32 v[214:215],v[210:211],4.0,v[214:215] op_sel_hi:[1,0,1]
v_pk_fma_f32 v[208:209],v[156:157],2.0,v[204:205] op_sel_hi:[1,0,1]
v_pk_fma_f32 v[210:211],v[158:159],2.0,v[206:207] op_sel_hi:[1,0,1]
v_pk_fma_f32 v[156:157],v[156:157],s[40:41],v[204:205] op_sel_hi:[1,0,1]
v_pk_fma_f32 v[158:159],v[158:159],s[40:41],v[206:207] op_sel_hi:[1,0,1]
M v[28:31],a[216:219],a[128:131],v[28:31]
buffer_load_dwordx4 a[156:159],v250,s[20:23],s46 offen offset:2048 sc1
M v[28:31],v[220:223],a[136:139],v[28:31]
s_waitcnt vmcnt(22) lgkmcnt(3)
v_cvt_pk_bf16_f32 v208,v208,v209
v_cvt_pk_bf16_f32 v209,v210,v211
M v[96:99],v[228:231],a[140:143],v[96:99]
s_waitcnt vmcnt(21) lgkmcnt(2)
ds_read_b128 a[148:151],v248 offset:1024
v_cvt_pk_bf16_f32 v212,v212,v213
M v[96:99],a[220:223],a[152:155],v[96:99]
s_waitcnt vmcnt(20) lgkmcnt(2)
ds_read_b128 a[128:131],v249 offset:1024
v_cvt_pk_bf16_f32 v213,v214,v215
M v[96:99],v[224:227],a[116:119],v[96:99]
s_waitcnt lgkmcnt(2)
ds_write2st64_b64 v254,v[208:209],v[212:213] offset0:25 offset1:29
M v[100:103],v[224:227],a[252:255],v[100:103]
v_cvt_pk_bf16_f32 v0,v0,v1
v_cvt_pk_bf16_f32 v1,v2,v3
M v[100:103],a[220:223],a[116:119],v[100:103]
v_cvt_pk_bf16_f32 v4,v4,v5
v_cvt_pk_bf16_f32 v5,v6,v7
M v[100:103],v[228:231],a[152:155],v[100:103]
s_waitcnt lgkmcnt(0)
s_barrier
ds_read_b128 a[32:35],v250 offset:17408
M v[104:107],v[228:231],a[116:119],v[104:107]
ds_read_b128 a[36:39],v250 offset:21504
ds_read_b128 a[40:43],v250 offset:26112
M v[104:107],a[220:223],a[252:255],v[104:107]
ds_read_b128 a[44:47],v250 offset:30208
ds_read_b128 a[48:51],v250 offset:0
M v[104:107],v[224:227],a[148:151],v[104:107]
ds_read_b128 a[52:55],v250 offset:4096
ds_read_b128 a[56:59],v250 offset:8704
M v[108:111],v[224:227],a[128:131],v[108:111]
ds_read_b128 a[60:63],v250 offset:12800
ds_read_b128 a[136:139],v248 offset:1536
M v[108:111],a[220:223],a[148:151],v[108:111]
s_add_u32 s34,s32,6291456
ds_read_b128 a[212:215],v249 offset:1536
ds_write2st64_b64 v254,v[0:1],v[4:5] offset0:68 offset1:72
M v[108:111],v[228:231],a[252:255],v[108:111]
s_waitcnt lgkmcnt(10)
buffer_store_dwordx4 a[32:35],v253,s[24:27],s34 offen offset:512 nt
M v[112:115],v[228:231],a[148:151],v[112:115]
s_add_u32 s34,s32,6488064
ds_read_b128 a[232:235],v249 offset:2048
v_cvt_pk_bf16_f32 v8,v8,v9
M v[112:115],a[220:223],a[128:131],v[112:115]
s_waitcnt lgkmcnt(3)
ds_read_b128 a[192:195],v248 offset:2048
v_cvt_pk_bf16_f32 v9,v10,v11
M v[112:115],v[224:227],a[136:139],v[112:115]
s_waitcnt lgkmcnt(3)
buffer_store_dwordx4 a[36:39],v253,s[24:27],s34 offen offset:512 nt
M v[116:119],v[224:227],a[212:215],v[116:119]
s_add_u32 s34,s32,6684672
v_cvt_pk_bf16_f32 v12,v12,v13
v_cvt_pk_bf16_f32 v13,v14,v15
M v[116:119],a[220:223],a[136:139],v[116:119]
ds_write2st64_b64 v254,v[8:9],v[12:13] offset0:76 offset1:80
M v[116:119],v[228:231],a[128:131],v[116:119]
buffer_store_dwordx4 a[40:43],v253,s[24:27],s34 offen offset:512 nt
M v[120:123],v[228:231],a[136:139],v[120:123]
s_add_u32 s34,s32,6881280
global_load_dword v216,v250,s[64:65]
M v[120:123],a[220:223],a[212:215],v[120:123]
s_waitcnt lgkmcnt(2)
s_add_u32 s47,s75,49152
v_cvt_pk_bf16_f32 v16,v16,v17
v_cvt_pk_bf16_f32 v17,v18,v19
M v[120:123],v[224:227],a[232:235],v[120:123]
s_waitcnt lgkmcnt(1)
buffer_store_dwordx4 a[44:47],v253,s[24:27],s34 offen offset:512 nt
M v[124:127],v[224:227],a[192:195],v[124:127]
s_add_u32 s34,s32,7077888
v_cvt_pk_bf16_f32 v20,v20,v21
v_cvt_pk_bf16_f32 v21,v22,v23
M v[124:127],a[220:223],a[232:235],v[124:127]
ds_write2st64_b64 v254,v[16:17],v[20:21] offset0:85 offset1:89
M v[124:127],v[228:231],a[212:215],v[124:127]
s_waitcnt vmcnt(24)
buffer_store_dwordx4 a[48:51],v253,s[24:27],s34 offen offset:512 nt
M v[128:131],a[112:115],a[140:143],v[128:131]
s_waitcnt vmcnt(24)
s_add_u32 s34,s32,7274496
v_cvt_pk_bf16_f32 v24,v24,v25
v_cvt_pk_bf16_f32 v25,v26,v27
M v[128:131],a[248:251],a[152:155],v[128:131]
s_waitcnt vmcnt(21)
v_cvt_pk_bf16_f32 v28,v28,v29
v_cvt_pk_bf16_f32 v29,v30,v31
M v[128:131],a[108:111],a[116:119],v[128:131]
buffer_store_dwordx4 a[52:55],v253,s[24:27],s34 offen offset:512 nt
M v[132:135],a[108:111],a[252:255],v[132:135]
s_add_u32 s34,s32,7471104
ds_write2st64_b64 v254,v[24:25],v[28:29] offset0:93 offset1:97
M v[132:135],a[248:251],a[116:119],v[132:135]
buffer_load_dwordx4 v[216:219],v250,s[20:23],s47 offen offset:0 sc1
M v[132:135],a[112:115],a[152:155],v[132:135]
v_accvgpr_read_b32 v238,a64
v_accvgpr_read_b32 v232,a160
M v[136:139],a[112:115],a[116:119],v[136:139]
v_add_f32 v234,v238,v232
v_sub_f32 v238,v238,v232
M v[136:139],a[248:251],a[252:255],v[136:139]
v_add_f32 v232,v64,v160
v_sub_f32 v160,v64,v160
M v[136:139],a[108:111],a[148:151],v[136:139]
buffer_load_dwordx4 a[204:207],v250,s[20:23],s47 offen offset:1024 sc1
M v[140:143],a[108:111],a[128:131],v[140:143]
v_add_f32 v64,v234,v232
v_fmac_f32 v234,4.0,v232
M v[140:143],a[248:251],a[148:151],v[140:143]
v_fma_f32 v232,2.0,v160,v238
v_fma_f32 v160,s40,v160,v238
M v[140:143],a[112:115],a[252:255],v[140:143]
s_waitcnt lgkmcnt(0)
s_barrier
ds_read_b128 v[0:3],v250 offset:34816
M v[144:147],a[112:115],a[148:151],v[144:147]
ds_read_b128 v[8:11],v250 offset:38912
ds_read_b128 v[16:19],v250 offset:43520
M v[144:147],a[248:251],a[128:131],v[144:147]
ds_read_b128 v[24:27],v250 offset:47616
v_accvgpr_read_b32 v238,a65
M v[144:147],a[108:111],a[136:139],v[144:147]
buffer_load_dwordx4 a[224:227],v250,s[20:23],s47 offen offset:2048 sc1
M v[148:151],a[108:111],a[212:215],v[148:151]
s_add_u32 s46,s76,46080
v_accvgpr_read_b32 v237,a161
v_add_f32 v236,v238,v237
M v[148:151],a[248:251],a[136:139],v[148:151]
ds_read_b128 a[140:143],v248 offset:34816
v_sub_f32 v238,v238,v237
M v[148:151],a[112:115],a[128:131],v[148:151]
buffer_store_dwordx4 a[56:59],v253,s[24:27],s34 offen offset:512 nt
M v[152:155],a[112:115],a[136:139],v[152:155]
ds_read_b128 a[152:155],v249 offset:34816
ds_read_b128 a[148:151],v248 offset:35328
M v[152:155],a[248:251],a[212:215],v[152:155]
buffer_load_dwordx4 a[116:119],v250,s[20:23],s46 offen offset:0 sc1
M v[152:155],a[108:111],a[232:235],v[152:155]
ds_read_b128 a[136:139],v249 offset:35328
v_add_f32 v237,v65,v161
M v[156:159],a[108:111],a[192:195],v[156:159]
v_sub_f32 v161,v65,v161
v_add_f32 v65,v236,v237
M v[156:159],a[248:251],a[232:235],v[156:159]
v_fmac_f32 v236,4.0,v237
v_fma_f32 v237,2.0,v161,v238
M v[156:159],a[112:115],a[212:215],v[156:159]
s_waitcnt vmcnt(26) lgkmcnt(3)
buffer_load_dwordx4 a[128:131],v250,s[20:23],s46 offen offset:1024 sc1
M v[96:99],a[200:203],a[140:143],v[96:99]
s_waitcnt vmcnt(26) lgkmcnt(2)
ds_read_b128 a[108:111],v248 offset:35840
v_fma_f32 v161,s40,v161,v238
M v[96:99],a[208:211],a[152:155],v[96:99]
s_waitcnt vmcnt(25) lgkmcnt(2)
s_add_u32 s34,s32,7667712
ds_read_b128 a[112:115],v249 offset:35840
v_cvt_pk_bf16_f32 v232,v232,v237
M v[96:99],a[120:123],a[148:151],v[96:99]
s_waitcnt lgkmcnt(2)
v_cvt_pk_bf16_f32 v234,v234,v236
v_accvgpr_read_b32 v238,a66
M v[100:103],a[120:123],a[136:139],v[100:103]
buffer_load_dwordx4 a[216:219],v250,s[20:23],s46 offen offset:2048 sc1
M v[100:103],a[208:211],a[148:151],v[100:103]
v_accvgpr_read_b32 v233,a162
v_add_f32 v235,v238,v233
M v[100:103],a[200:203],a[152:155],v[100:103]
v_sub_f32 v238,v238,v233
v_add_f32 v233,v66,v162
M v[104:107],a[200:203],a[148:151],v[104:107]
ds_read_b128 v[220:223],v248 offset:36352
v_sub_f32 v162,v66,v162
M v[104:107],a[208:211],a[136:139],v[104:107]
s_waitcnt lgkmcnt(2)
ds_read_b128 v[224:227],v249 offset:36352
v_add_f32 v66,v235,v233
M v[104:107],a[120:123],a[108:111],v[104:107]
s_waitcnt lgkmcnt(2)
buffer_store_dwordx4 a[60:63],v253,s[24:27],s34 offen offset:512 nt
M v[108:111],a[120:123],a[112:115],v[108:111]
v_fmac_f32 v235,4.0,v233
v_fma_f32 v233,2.0,v162,v238
M v[108:111],a[208:211],a[108:111],v[108:111]
v_fma_f32 v162,s40,v162,v238
v_accvgpr_read_b32 v238,a67
M v[108:111],a[200:203],a[136:139],v[108:111]
v_accvgpr_read_b32 v237,a163
v_add_f32 v236,v238,v237
M v[112:115],a[200:203],a[108:111],v[112:115]
s_add_u32 s47,s76,49152
ds_read_b128 a[160:163],v249 offset:36864
v_sub_f32 v238,v238,v237
M v[112:115],a[208:211],a[112:115],v[112:115]
s_waitcnt lgkmcnt(2)
ds_read_b128 a[220:223],v248 offset:36864
v_add_f32 v237,v67,v163
M v[112:115],a[120:123],v[220:223],v[112:115]
s_waitcnt lgkmcnt(2)
v_sub_f32 v163,v67,v163
v_add_f32 v67,v236,v237
M v[116:119],a[120:123],v[224:227],v[116:119]
v_fmac_f32 v236,4.0,v237
v_fma_f32 v237,2.0,v163,v238
M v[116:119],a[208:211],v[220:223],v[116:119]
v_fma_f32 v163,s40,v163,v238
v_cvt_pk_bf16_f32 v233,v233,v237
M v[116:119],a[200:203],a[112:115],v[116:119]
v_cvt_pk_bf16_f32 v235,v235,v236
M v[120:123],a[200:203],v[220:223],v[120:123]
buffer_load_dwordx4 v[228:231],v250,s[20:23],s47 offen offset:0 sc1
M v[120:123],a[208:211],v[224:227],v[120:123]
s_waitcnt lgkmcnt(1)
ds_write2st64_b64 v254,v[232:233],v[234:235] offset0:34 offset1:38
M v[120:123],a[120:123],a[160:163],v[120:123]
s_waitcnt lgkmcnt(1)
buffer_load_dwordx4 a[252:255],v250,s[20:23],s47 offen offset:1024 sc1
M v[124:127],a[120:123],a[220:223],v[124:127]
v_accvgpr_read_b32 v238,a68
v_accvgpr_read_b32 v232,a164
M v[124:127],a[208:211],a[160:163],v[124:127]
v_add_f32 v234,v238,v232
v_sub_f32 v238,v238,v232
M v[124:127],a[200:203],v[224:227],v[124:127]
s_waitcnt vmcnt(28)
s_add_u32 s34,s33,6291456
v_add_f32 v232,v68,v164
v_sub_f32 v164,v68,v164
M v[128:131],a[96:99],a[140:143],v[128:131]
s_waitcnt vmcnt(27)
buffer_load_dwordx4 a[192:195],v250,s[20:23],s47 offen offset:2048 sc1
M v[128:131],a[244:247],a[152:155],v[128:131]
s_waitcnt vmcnt(27)
v_add_f32 v68,v234,v232
v_fmac_f32 v234,4.0,v232
M v[128:131],a[132:135],a[148:151],v[128:131]
v_fma_f32 v232,2.0,v164,v238
v_fma_f32 v164,s40,v164,v238
M v[132:135],a[132:135],a[136:139],v[132:135]
v_accvgpr_read_b32 v238,a69
v_accvgpr_read_b32 v237,a165
M v[132:135],a[244:247],a[148:151],v[132:135]
v_add_f32 v236,v238,v237
v_sub_f32 v238,v238,v237
M v[132:135],a[96:99],a[152:155],v[132:135]
buffer_store_dwordx4 v[0:3],v253,s[24:27],s34 offen offset:0 nt
M v[136:139],a[96:99],a[148:151],v[136:139]
v_add_f32 v237,v69,v165
v_sub_f32 v165,v69,v165
M v[136:139],a[244:247],a[136:139],v[136:139]
v_add_f32 v69,v236,v237
v_fmac_f32 v236,4.0,v237
M v[136:139],a[132:135],a[108:111],v[136:139]
v_fma_f32 v237,2.0,v165,v238
v_fma_f32 v165,s40,v165,v238
M v[140:143],a[132:135],a[112:115],v[140:143]
v_cvt_pk_bf16_f32 v232,v232,v237
v_cvt_pk_bf16_f32 v234,v234,v236
M v[140:143],a[244:247],a[108:111],v[140:143]
v_accvgpr_read_b32 v238,a70
v_accvgpr_read_b32 v233,a166
M v[140:143],a[96:99],a[136:139],v[140:143]
v_add_f32 v235,v238,v233
v_sub_f32 v238,v238,v233
M v[144:147],a[96:99],a[108:111],v[144:147]
s_add_u32 s46,s77,46080
v_add_f32 v233,v70,v166
v_sub_f32 v166,v70,v166
M v[144:147],a[244:247],a[112:115],v[144:147]
v_add_f32 v70,v235,v233
v_fmac_f32 v235,4.0,v233
M v[144:147],a[132:135],v[220:223],v[144:147]
v_fma_f32 v233,2.0,v166,v238
v_fma_f32 v166,s40,v166,v238
M v[148:151],a[132:135],v[224:227],v[148:151]
v_accvgpr_read_b32 v238,a71
v_accvgpr_read_b32 v237,a167
M v[148:151],a[244:247],v[220:223],v[148:151]
ds_read_b128 a[120:123],v248 offset:52224
v_add_f32 v236,v238,v237
M v[148:151],a[96:99],a[112:115],v[148:151]
ds_read_b128 a[140:143],v249 offset:52224
v_sub_f32 v238,v238,v237
M v[152:155],a[96:99],v[220:223],v[152:155]
buffer_load_dwordx4 a[152:155],v250,s[20:23],s46 offen offset:0 sc1
M v[152:155],a[244:247],v[224:227],v[152:155]
ds_read_b128 a[148:151],v248 offset:52736
ds_read_b128 a[108:111],v249 offset:52736
M v[152:155],a[132:135],a[160:163],v[152:155]
buffer_load_dwordx4 a[136:139],v250,s[20:23],s46 offen offset:1024 sc1
M v[156:159],a[132:135],a[220:223],v[156:159]
s_add_u32 s34,s33,6684672
v_add_f32 v237,v71,v167
v_sub_f32 v167,v71,v167
M v[156:159],a[244:247],a[160:163],v[156:159]
v_add_f32 v71,v236,v237
v_fmac_f32 v236,4.0,v237
M v[156:159],a[96:99],v[224:227],v[156:159]
s_waitcnt vmcnt(29) lgkmcnt(3)
v_fma_f32 v237,2.0,v167,v238
v_fma_f32 v167,s40,v167,v238
M v[96:99],a[124:127],a[120:123],v[96:99]
s_waitcnt vmcnt(28) lgkmcnt(2)
buffer_load_dwordx4 a[164:167],v250,s[20:23],s46 offen offset:2048 sc1
M v[96:99],a[228:231],a[140:143],v[96:99]
s_waitcnt vmcnt(28) lgkmcnt(1)
ds_read_b128 a[112:115],v248 offset:53248
ds_read_b128 a[132:135],v249 offset:53248
M v[96:99],a[196:199],a[148:151],v[96:99]
s_waitcnt lgkmcnt(2)
v_cvt_pk_bf16_f32 v233,v233,v237
v_cvt_pk_bf16_f32 v235,v235,v236
M v[100:103],a[196:199],a[108:111],v[100:103]
ds_write2st64_b64 v254,v[232:233],v[234:235] offset0:42 offset1:46
M v[100:103],a[228:231],a[148:151],v[100:103]
v_accvgpr_read_b32 v238,a72
v_accvgpr_read_b32 v232,a168
M v[100:103],a[124:127],a[140:143],v[100:103]
buffer_store_dwordx4 v[8:11],v253,s[24:27],s34 offen offset:0 nt
M v[104:107],a[124:127],a[148:151],v[104:107]
ds_read_b128 a[160:163],v248 offset:53760
v_add_f32 v234,v238,v232
M v[104:107],a[228:231],a[108:111],v[104:107]
s_waitcnt lgkmcnt(3)
ds_read_b128 a[96:99],v249 offset:53760
v_sub_f32 v238,v238,v232
M v[104:107],a[196:199],a[112:115],v[104:107]
s_waitcnt lgkmcnt(3)
v_add_f32 v232,v72,v168
v_sub_f32 v168,v72,v168
M v[108:111],a[196:199],a[132:135],v[108:111]
v_add_f32 v72,v234,v232
v_fmac_f32 v234,4.0,v232
M v[108:111],a[228:231],a[112:115],v[108:111]
v_fma_f32 v232,2.0,v168,v238
v_fma_f32 v168,s40,v168,v238
M v[108:111],a[124:127],a[108:111],v[108:111]
v_accvgpr_read_b32 v238,a73
v_accvgpr_read_b32 v237,a169
M v[112:115],a[124:127],a[112:115],v[112:115]
s_add_u32 s47,s77,49152
ds_read_b128 a[232:235],v249 offset:54272
v_add_f32 v236,v238,v237
M v[112:115],a[228:231],a[132:135],v[112:115]
s_waitcnt lgkmcnt(2)
ds_read_b128 a[248:251],v248 offset:54272
v_sub_f32 v238,v238,v237
M v[112:115],a[196:199],a[160:163],v[112:115]
s_waitcnt lgkmcnt(2)
v_add_f32 v237,v73,v169
v_sub_f32 v169,v73,v169
M v[116:119],a[196:199],a[96:99],v[116:119]
v_add_f32 v73,v236,v237
v_fmac_f32 v236,4.0,v237
M v[116:119],a[228:231],a[160:163],v[116:119]
v_fma_f32 v237,2.0,v169,v238
v_fma_f32 v169,s40,v169,v238
M v[116:119],a[124:127],a[132:135],v[116:119]
v_cvt_pk_bf16_f32 v232,v232,v237
v_cvt_pk_bf16_f32 v234,v234,v236
M v[120:123],a[124:127],a[160:163],v[120:123]
buffer_load_dwordx4 a[212:215],v250,s[20:23],s47 offen offset:0 sc1
M v[120:123],a[228:231],a[96:99],v[120:123]
s_waitcnt lgkmcnt(1)
s_add_u32 s34,s33,7077888
v_accvgpr_read_b32 v238,a74
v_accvgpr_read_b32 v233,a170
M v[120:123],a[196:199],a[232:235],v[120:123]
s_waitcnt lgkmcnt(0)
buffer_load_dwordx4 a[208:211],v250,s[20:23],s47 offen offset:1024 sc1
M v[124:127],a[196:199],a[248:251],v[124:127]
v_add_f32 v235,v238,v233
v_sub_f32 v238,v238,v233
M v[124:127],a[228:231],a[232:235],v[124:127]
v_add_f32 v233,v74,v170
v_sub_f32 v170,v74,v170
M v[124:127],a[124:127],a[96:99],v[124:127]
s_waitcnt vmcnt(30)
v_add_f32 v74,v235,v233
v_fmac_f32 v235,4.0,v233
M v[128:131],a[100:103],a[120:123],v[128:131]
s_waitcnt vmcnt(29)
buffer_load_dwordx4 a[200:203],v250,s[20:23],s47 offen offset:2048 sc1
M v[128:131],a[236:239],a[140:143],v[128:131]
s_waitcnt vmcnt(29)
v_fma_f32 v233,2.0,v170,v238
v_fma_f32 v170,s40,v170,v238
M v[128:131],a[240:243],a[148:151],v[128:131]
v_accvgpr_read_b32 v238,a75
v_accvgpr_read_b32 v237,a171
M v[132:135],a[240:243],a[108:111],v[132:135]
v_add_f32 v236,v238,v237
v_sub_f32 v238,v238,v237
M v[132:135],a[236:239],a[148:151],v[132:135]
v_add_f32 v237,v75,v171
v_sub_f32 v171,v75,v171
M v[132:135],a[100:103],a[140:143],v[132:135]
buffer_store_dwordx4 v[16:19],v253,s[24:27],s34 offen offset:0 nt
M v[136:139],a[100:103],a[148:151],v[136:139]
v_add_f32 v75,v236,v237
v_fmac_f32 v236,4.0,v237
M v[136:139],a[236:239],a[108:111],v[136:139]
v_fma_f32 v237,2.0,v171,v238
v_fma_f32 v171,s40,v171,v238
M v[136:139],a[240:243],a[112:115],v[136:139]
v_cvt_pk_bf16_f32 v233,v233,v237
v_cvt_pk_bf16_f32 v235,v235,v236
M v[140:143],a[240:243],a[132:135],v[140:143]
ds_write2st64_b64 v254,v[232:233],v[234:235] offset0:51 offset1:55
M v[140:143],a[236:239],a[112:115],v[140:143]
v_accvgpr_read_b32 v238,a76
v_accvgpr_read_b32 v232,a172
M v[140:143],a[100:103],a[108:111],v[140:143]
v_add_f32 v234,v238,v232
v_sub_f32 v238,v238,v232
M v[144:147],a[100:103],a[112:115],v[144:147]
s_add_u32 s47,s72,3072
v_add_f32 v232,v76,v172
v_sub_f32 v172,v76,v172
M v[144:147],a[236:239],a[132:135],v[144:147]
v_add_u32 v248,0x11000,v248
v_add_u32 v249,0x11000,v249
M v[144:147],a[240:243],a[160:163],v[144:147]
v_add_f32 v76,v234,v232
v_fmac_f32 v234,4.0,v232
M v[148:151],a[240:243],a[96:99],v[148:151]
v_fma_f32 v232,2.0,v172,v238
v_fma_f32 v172,s40,v172,v238
M v[148:151],a[236:239],a[160:163],v[148:151]
ds_read_b128 a[124:127],v248 offset:0
v_accvgpr_read_b32 v238,a77
M v[148:151],a[100:103],a[132:135],v[148:151]
s_add_u32 s34,s33,7471104
buffer_store_dwordx4 v[24:27],v253,s[24:27],s34 offen offset:0 nt
M v[152:155],a[100:103],a[160:163],v[152:155]
buffer_load_dwordx4 a[168:171],v250,s[20:23],s47 offen offset:0 sc1
M v[152:155],a[236:239],a[96:99],v[152:155]
ds_read_b128 a[120:123],v249 offset:0
ds_read_b128 a[140:143],v248 offset:512
M v[152:155],a[240:243],a[232:235],v[152:155]
ds_read_b128 a[108:111],v249 offset:512
v_accvgpr_read_b32 v237,a173
M v[156:159],a[240:243],a[248:251],v[156:159]
v_add_f32 v236,v238,v237
v_sub_f32 v238,v238,v237
M v[156:159],a[236:239],a[232:235],v[156:159]
buffer_load_dwordx4 a[148:151],v250,s[20:23],s47 offen offset:1024 sc1
M v[156:159],a[100:103],a[96:99],v[156:159]
s_waitcnt vmcnt(32) lgkmcnt(3)
v_add_f32 v237,v77,v173
v_sub_f32 v173,v77,v173
M v[96:99],a[144:147],a[124:127],v[96:99]
s_waitcnt vmcnt(31) lgkmcnt(2)
ds_read_b128 a[132:135],v248 offset:1024
v_add_f32 v77,v236,v237
M v[96:99],a[104:107],a[120:123],v[96:99]
s_waitcnt vmcnt(30) lgkmcnt(2)
ds_read_b128 a[160:163],v249 offset:1024
v_fmac_f32 v236,4.0,v237
M v[96:99],a[156:159],a[140:143],v[96:99]
s_waitcnt lgkmcnt(2)
buffer_load_dwordx4 a[112:115],v250,s[20:23],s47 offen offset:2048 sc1
M v[100:103],a[156:159],a[108:111],v[100:103]
v_fma_f32 v237,2.0,v173,v238
v_fma_f32 v173,s40,v173,v238
M v[100:103],a[104:107],a[140:143],v[100:103]
v_cvt_pk_bf16_f32 v232,v232,v237
v_cvt_pk_bf16_f32 v234,v234,v236
M v[100:103],a[144:147],a[120:123],v[100:103]
v_accvgpr_read_b32 v238,a78
v_accvgpr_read_b32 v233,a174
M v[104:107],a[144:147],a[140:143],v[104:107]
ds_read_b128 a[96:99],v248 offset:1536
v_add_f32 v235,v238,v233
M v[104:107],a[104:107],a[108:111],v[104:107]
s_waitcnt lgkmcnt(2)
ds_read_b128 a[100:103],v249 offset:1536
v_sub_f32 v238,v238,v233
M v[104:107],a[156:159],a[132:135],v[104:107]
s_waitcnt lgkmcnt(2)
v_add_f32 v233,v78,v174
v_sub_f32 v174,v78,v174
M v[108:111],a[156:159],a[160:163],v[108:111]
v_add_f32 v78,v235,v233
v_fmac_f32 v235,4.0,v233
M v[108:111],a[104:107],a[132:135],v[108:111]
v_fma_f32 v233,2.0,v174,v238
v_fma_f32 v174,s40,v174,v238
M v[108:111],a[144:147],a[108:111],v[108:111]
v_accvgpr_read_b32 v238,a79
v_accvgpr_read_b32 v237,a175
M v[112:115],a[144:147],a[132:135],v[112:115]
s_add_u32 s48,s72,6144
ds_read_b128 a[172:175],v249 offset:2048
v_add_f32 v236,v238,v237
M v[112:115],a[104:107],a[160:163],v[112:115]
s_waitcnt lgkmcnt(2)
ds_read_b128 v[220:223],v248 offset:2048
v_sub_f32 v238,v238,v237
M v[112:115],a[156:159],a[96:99],v[112:115]
s_waitcnt lgkmcnt(2)
v_add_f32 v237,v79,v175
v_sub_f32 v175,v79,v175
M v[116:119],a[156:159],a[100:103],v[116:119]
v_add_f32 v79,v236,v237
v_fmac_f32 v236,4.0,v237
M v[116:119],a[104:107],a[96:99],v[116:119]
v_fma_f32 v237,2.0,v175,v238
v_fma_f32 v175,s40,v175,v238
M v[116:119],a[144:147],a[160:163],v[116:119]
v_cvt_pk_bf16_f32 v233,v233,v237
v_cvt_pk_bf16_f32 v235,v235,v236
M v[120:123],a[144:147],a[96:99],v[120:123]
buffer_load_dwordx4 a[220:223],v250,s[20:23],s48 offen offset:0 sc1
M v[120:123],a[104:107],a[100:103],v[120:123]
s_waitcnt lgkmcnt(1)
ds_write2st64_b64 v254,v[232:233],v[234:235] offset0:59 offset1:63
M v[120:123],a[156:159],a[172:175],v[120:123]
s_waitcnt lgkmcnt(1)
buffer_load_dwordx4 a[244:247],v250,s[20:23],s48 offen offset:1024 sc1
M v[124:127],a[156:159],v[220:223],v[124:127]
v_accvgpr_read_b32 v238,a80
v_accvgpr_read_b32 v232,a176
M v[124:127],a[104:107],a[172:175],v[124:127]
v_add_f32 v234,v238,v232
v_sub_f32 v238,v238,v232
M v[124:127],a[144:147],a[100:103],v[124:127]
s_waitcnt vmcnt(25)
v_add_f32 v232,v80,v176
v_sub_f32 v176,v80,v176
M v[128:131],v[216:219],a[124:127],v[128:131]
s_waitcnt vmcnt(24)
buffer_load_dwordx4 v[224:227],v250,s[20:23],s48 offen offset:2048 sc1
M v[128:131],a[204:207],a[120:123],v[128:131]
s_waitcnt vmcnt(24)
v_add_f32 v80,v234,v232
v_fmac_f32 v234,4.0,v232
M v[128:131],a[224:227],a[140:143],v[128:131]
v_fma_f32 v232,2.0,v176,v238
v_fma_f32 v176,s40,v176,v238
M v[132:135],a[224:227],a[108:111],v[132:135]
v_accvgpr_read_b32 v238,a81
v_accvgpr_read_b32 v237,a177
M v[132:135],a[204:207],a[140:143],v[132:135]
v_add_f32 v236,v238,v237
v_sub_f32 v238,v238,v237
M v[132:135],v[216:219],a[120:123],v[132:135]
v_add_f32 v237,v81,v177
v_sub_f32 v177,v81,v177
M v[136:139],v[216:219],a[140:143],v[136:139]
v_add_f32 v81,v236,v237
v_fmac_f32 v236,4.0,v237
M v[136:139],a[204:207],a[108:111],v[136:139]
v_fma_f32 v237,2.0,v177,v238
v_fma_f32 v177,s40,v177,v238
M v[136:139],a[224:227],a[132:135],v[136:139]
v_cvt_pk_bf16_f32 v232,v232,v237
v_cvt_pk_bf16_f32 v234,v234,v236
M v[140:143],a[224:227],a[160:163],v[140:143]
v_accvgpr_read_b32 v238,a82
v_accvgpr_read_b32 v233,a178
M v[140:143],a[204:207],a[132:135],v[140:143]
v_add_f32 v235,v238,v233
v_sub_f32 v238,v238,v233
M v[140:143],v[216:219],a[108:111],v[140:143]
v_add_f32 v233,v82,v178
v_sub_f32 v178,v82,v178
M v[144:147],v[216:219],a[132:135],v[144:147]
s_add_u32 s47,s73,3072
v_add_f32 v82,v235,v233
v_fmac_f32 v235,4.0,v233
M v[144:147],a[204:207],a[160:163],v[144:147]
v_fma_f32 v233,2.0,v178,v238
v_fma_f32 v178,s40,v178,v238
M v[144:147],a[224:227],a[96:99],v[144:147]
v_accvgpr_read_b32 v238,a83
v_accvgpr_read_b32 v237,a179
M v[148:151],a[224:227],a[100:103],v[148:151]
v_add_f32 v236,v238,v237
v_sub_f32 v238,v238,v237
M v[148:151],a[204:207],a[96:99],v[148:151]
ds_read_b128 a[156:159],v248 offset:17408
v_add_f32 v237,v83,v179
M v[148:151],v[216:219],a[160:163],v[148:151]
ds_read_b128 a[104:107],v249 offset:17408
v_sub_f32 v179,v83,v179
M v[152:155],v[216:219],a[96:99],v[152:155]
buffer_load_dwordx4 a[144:147],v250,s[20:23],s47 offen offset:0 sc1
M v[152:155],a[204:207],a[100:103],v[152:155]
ds_read_b128 a[124:127],v248 offset:17920
ds_read_b128 a[140:143],v249 offset:17920
M v[152:155],a[224:227],a[172:175],v[152:155]
buffer_load_dwordx4 a[120:123],v250,s[20:23],s47 offen offset:1024 sc1
M v[156:159],a[224:227],v[220:223],v[156:159]
v_add_f32 v83,v236,v237
v_fmac_f32 v236,4.0,v237
M v[156:159],a[204:207],a[172:175],v[156:159]
v_fma_f32 v237,2.0,v179,v238
v_fma_f32 v179,s40,v179,v238
M v[156:159],v[216:219],a[100:103],v[156:159]
s_waitcnt vmcnt(24) lgkmcnt(3)
v_cvt_pk_bf16_f32 v233,v233,v237
v_cvt_pk_bf16_f32 v235,v235,v236
M v[96:99],a[116:119],a[156:159],v[96:99]
s_waitcnt vmcnt(23) lgkmcnt(2)
buffer_load_dwordx4 a[108:111],v250,s[20:23],s47 offen offset:2048 sc1
M v[96:99],a[128:131],a[104:107],v[96:99]
s_waitcnt vmcnt(23) lgkmcnt(1)
ds_read_b128 a[132:135],v248 offset:18432
ds_read_b128 a[176:179],v249 offset:18432
M v[96:99],a[216:219],a[124:127],v[96:99]
s_waitcnt lgkmcnt(2)
ds_write2st64_b64 v254,v[232:233],v[234:235] offset0:0 offset1:4
M v[100:103],a[216:219],a[140:143],v[100:103]
v_accvgpr_read_b32 v238,a84
v_accvgpr_read_b32 v232,a180
M v[100:103],a[128:131],a[124:127],v[100:103]
v_add_f32 v234,v238,v232
v_sub_f32 v238,v238,v232
M v[100:103],a[116:119],a[104:107],v[100:103]
v_add_f32 v232,v84,v180
v_sub_f32 v180,v84,v180
M v[104:107],a[116:119],a[124:127],v[104:107]
ds_read_b128 a[160:163],v248 offset:18944
v_add_f32 v84,v234,v232
M v[104:107],a[128:131],a[140:143],v[104:107]
s_waitcnt lgkmcnt(3)
ds_read_b128 a[96:99],v249 offset:18944
v_fmac_f32 v234,4.0,v232
M v[104:107],a[216:219],a[132:135],v[104:107]
s_waitcnt lgkmcnt(3)
v_fma_f32 v232,2.0,v180,v238
v_fma_f32 v180,s40,v180,v238
M v[108:111],a[216:219],a[176:179],v[108:111]
v_accvgpr_read_b32 v238,a85
v_accvgpr_read_b32 v237,a181
M v[108:111],a[128:131],a[132:135],v[108:111]
v_add_f32 v236,v238,v237
v_sub_f32 v238,v238,v237
M v[108:111],a[116:119],a[140:143],v[108:111]
v_add_f32 v237,v85,v181
v_sub_f32 v181,v85,v181
M v[112:115],a[116:119],a[132:135],v[112:115]
s_add_u32 s48,s73,6144
ds_read_b128 a[172:175],v249 offset:19456
v_add_f32 v85,v236,v237
M v[112:115],a[128:131],a[176:179],v[112:115]
s_waitcnt lgkmcnt(2)
ds_read_b128 a[100:103],v248 offset:19456
v_fmac_f32 v236,4.0,v237
M v[112:115],a[216:219],a[160:163],v[112:115]
s_waitcnt lgkmcnt(2)
v_fma_f32 v237,2.0,v181,v238
v_fma_f32 v181,s40,v181,v238
M v[116:119],a[216:219],a[96:99],v[116:119]
v_cvt_pk_bf16_f32 v232,v232,v237
v_cvt_pk_bf16_f32 v234,v234,v236
M v[116:119],a[128:131],a[160:163],v[116:119]
v_accvgpr_read_b32 v238,a86
v_accvgpr_read_b32 v233,a182
M v[116:119],a[116:119],a[176:179],v[116:119]
v_add_f32 v235,v238,v233
v_sub_f32 v238,v238,v233
M v[120:123],a[116:119],a[160:163],v[120:123]
buffer_load_dwordx4 a[196:199],v250,s[20:23],s48 offen offset:0 sc1
M v[120:123],a[128:131],a[96:99],v[120:123]
s_waitcnt lgkmcnt(1)
v_add_f32 v233,v86,v182
v_sub_f32 v182,v86,v182
M v[120:123],a[216:219],a[172:175],v[120:123]
s_waitcnt lgkmcnt(0)
buffer_load_dwordx4 a[228:231],v250,s[20:23],s48 offen offset:1024 sc1
M v[124:127],a[216:219],a[100:103],v[124:127]
v_add_f32 v86,v235,v233
v_fmac_f32 v235,4.0,v233
M v[124:127],a[128:131],a[172:175],v[124:127]
v_fma_f32 v233,2.0,v182,v238
v_fma_f32 v182,s40,v182,v238
M v[124:127],a[116:119],a[96:99],v[124:127]
s_waitcnt vmcnt(23)
v_accvgpr_read_b32 v238,a87
v_accvgpr_read_b32 v237,a183
M v[128:131],v[228:231],a[156:159],v[128:131]
s_waitcnt vmcnt(22)
buffer_load_dwordx4 a[240:243],v250,s[20:23],s48 offen offset:2048 sc1
M v[128:131],a[252:255],a[104:107],v[128:131]
s_waitcnt vmcnt(22)
v_add_f32 v236,v238,v237
v_sub_f32 v238,v238,v237
M v[128:131],a[192:195],a[124:127],v[128:131]
v_add_f32 v237,v87,v183
v_sub_f32 v183,v87,v183
M v[132:135],a[192:195],a[140:143],v[132:135]
v_add_f32 v87,v236,v237
v_fmac_f32 v236,4.0,v237
M v[132:135],a[252:255],a[124:127],v[132:135]
v_fma_f32 v237,2.0,v183,v238
v_fma_f32 v183,s40,v183,v238
M v[132:135],v[228:231],a[104:107],v[132:135]
v_cvt_pk_bf16_f32 v233,v233,v237
v_cvt_pk_bf16_f32 v235,v235,v236
M v[136:139],v[228:231],a[124:127],v[136:139]
ds_write2st64_b64 v254,v[232:233],v[234:235] offset0:8 offset1:12
M v[136:139],a[252:255],a[140:143],v[136:139]
v_accvgpr_read_b32 v238,a88
v_accvgpr_read_b32 v232,a184
M v[136:139],a[192:195],a[132:135],v[136:139]
v_add_f32 v234,v238,v232
v_sub_f32 v238,v238,v232
M v[140:143],a[192:195],a[176:179],v[140:143]
v_add_f32 v232,v88,v184
v_sub_f32 v184,v88,v184
M v[140:143],a[252:255],a[132:135],v[140:143]
v_add_f32 v88,v234,v232
v_fmac_f32 v234,4.0,v232
M v[140:143],v[228:231],a[140:143],v[140:143]
v_fma_f32 v232,2.0,v184,v238
v_fma_f32 v184,s40,v184,v238
M v[144:147],v[228:231],a[132:135],v[144:147]
s_add_u32 s47,s74,3072
v_accvgpr_read_b32 v238,a89
v_accvgpr_read_b32 v237,a185
M v[144:147],a[252:255],a[176:179],v[144:147]
v_add_u32 v248,0xfffece00,v248
v_add_u32 v249,0xfffece00,v249
M v[144:147],a[192:195],a[160:163],v[144:147]
v_add_f32 v236,v238,v237
v_sub_f32 v238,v238,v237
M v[148:151],a[192:195],a[96:99],v[148:151]
v_add_f32 v237,v89,v185
v_sub_f32 v185,v89,v185
M v[148:151],a[252:255],a[160:163],v[148:151]
ds_read_b128 a[128:131],v248 offset:26112
v_add_f32 v89,v236,v237
M v[148:151],v[228:231],a[176:179],v[148:151]
ds_read_b128 a[116:119],v249 offset:26112
v_fmac_f32 v236,4.0,v237
M v[152:155],v[228:231],a[160:163],v[152:155]
buffer_load_dwordx4 a[156:159],v250,s[20:23],s47 offen offset:0 sc1
M v[152:155],a[252:255],a[96:99],v[152:155]
ds_read_b128 a[180:183],v248 offset:26624
ds_read_b128 a[124:127],v249 offset:26624
M v[152:155],a[192:195],a[172:175],v[152:155]
buffer_load_dwordx4 a[104:107],v250,s[20:23],s47 offen offset:1024 sc1
M v[156:159],a[192:195],a[100:103],v[156:159]
v_fma_f32 v237,2.0,v185,v238
v_fma_f32 v185,s40,v185,v238
M v[156:159],a[252:255],a[172:175],v[156:159]
v_cvt_pk_bf16_f32 v232,v232,v237
v_cvt_pk_bf16_f32 v234,v234,v236
M v[156:159],v[228:231],a[96:99],v[156:159]
s_waitcnt vmcnt(22) lgkmcnt(3)
v_accvgpr_read_b32 v238,a90
v_accvgpr_read_b32 v233,a186
M v[96:99],a[152:155],a[128:131],v[96:99]
s_waitcnt vmcnt(21) lgkmcnt(2)
buffer_load_dwordx4 a[140:143],v250,s[20:23],s47 offen offset:2048 sc1
M v[96:99],a[136:139],a[116:119],v[96:99]
s_waitcnt vmcnt(21) lgkmcnt(1)
ds_read_b128 a[132:135],v248 offset:27136
ds_read_b128 a[176:179],v249 offset:27136
M v[96:99],a[164:167],a[180:183],v[96:99]
s_waitcnt lgkmcnt(2)
v_add_f32 v235,v238,v233
v_sub_f32 v238,v238,v233
M v[100:103],a[164:167],a[124:127],v[100:103]
v_add_f32 v233,v90,v186
v_sub_f32 v186,v90,v186
M v[100:103],a[136:139],a[180:183],v[100:103]
v_add_f32 v90,v235,v233
v_fmac_f32 v235,4.0,v233
M v[100:103],a[152:155],a[116:119],v[100:103]
v_fma_f32 v233,2.0,v186,v238
v_fma_f32 v186,s40,v186,v238
M v[104:107],a[152:155],a[180:183],v[104:107]
ds_read_b128 a[160:163],v248 offset:27648
v_accvgpr_read_b32 v238,a91
M v[104:107],a[136:139],a[124:127],v[104:107]
s_waitcnt lgkmcnt(2)
ds_read_b128 a[100:103],v249 offset:27648
v_accvgpr_read_b32 v237,a187
M v[104:107],a[164:167],a[132:135],v[104:107]
s_waitcnt lgkmcnt(2)
v_add_f32 v236,v238,v237
v_sub_f32 v238,v238,v237
M v[108:111],a[164:167],a[176:179],v[108:111]
v_add_f32 v237,v91,v187
v_sub_f32 v187,v91,v187
M v[108:111],a[136:139],a[132:135],v[108:111]
v_add_f32 v91,v236,v237
v_fmac_f32 v236,4.0,v237
M v[108:111],a[152:155],a[124:127],v[108:111]
v_fma_f32 v237,2.0,v187,v238
v_fma_f32 v187,s40,v187,v238
M v[112:115],a[152:155],a[132:135],v[112:115]
s_add_u32 s48,s74,6144
ds_read_b128 a[172:175],v249 offset:28160
v_cvt_pk_bf16_f32 v233,v233,v237
M v[112:115],a[136:139],a[176:179],v[112:115]
s_waitcnt lgkmcnt(2)
ds_read_b128 a[96:99],v248 offset:28160
v_cvt_pk_bf16_f32 v235,v235,v236
M v[112:115],a[164:167],a[160:163],v[112:115]
s_waitcnt lgkmcnt(2)
ds_write2st64_b64 v254,v[232:233],v[234:235] offset0:17 offset1:21
M v[116:119],a[164:167],a[100:103],v[116:119]
v_accvgpr_read_b32 v238,a92
v_accvgpr_read_b32 v232,a188
M v[116:119],a[136:139],a[160:163],v[116:119]
v_add_f32 v234,v238,v232
v_sub_f32 v238,v238,v232
M v[116:119],a[152:155],a[176:179],v[116:119]
v_add_f32 v232,v92,v188
v_sub_f32 v188,v92,v188
M v[120:123],a[152:155],a[160:163],v[120:123]
buffer_load_dwordx4 a[184:187],v250,s[20:23],s48 offen offset:0 sc1
M v[120:123],a[136:139],a[100:103],v[120:123]
s_waitcnt lgkmcnt(2)
v_add_f32 v92,v234,v232
v_fmac_f32 v234,4.0,v232
M v[120:123],a[164:167],a[172:175],v[120:123]
s_waitcnt lgkmcnt(1)
buffer_load_dwordx4 a[248:251],v250,s[20:23],s48 offen offset:1024 sc1
M v[124:127],a[164:167],a[96:99],v[124:127]
v_fma_f32 v232,2.0,v188,v238
v_fma_f32 v188,s40,v188,v238
M v[124:127],a[136:139],a[172:175],v[124:127]
v_accvgpr_read_b32 v238,a93
v_accvgpr_read_b32 v237,a189
M v[124:127],a[152:155],a[100:103],v[124:127]
s_waitcnt vmcnt(21)
v_add_f32 v236,v238,v237
v_sub_f32 v238,v238,v237
M v[128:131],a[212:215],a[128:131],v[128:131]
s_waitcnt vmcnt(20)
buffer_load_dwordx4 a[232:235],v250,s[20:23],s48 offen offset:2048 sc1
M v[128:131],a[208:211],a[116:119],v[128:131]
s_waitcnt vmcnt(20)
v_add_f32 v237,v93,v189
v_sub_f32 v189,v93,v189
M v[128:131],a[200:203],a[180:183],v[128:131]
v_add_f32 v93,v236,v237
v_fmac_f32 v236,4.0,v237
M v[132:135],a[200:203],a[124:127],v[132:135]
v_fma_f32 v237,2.0,v189,v238
v_fma_f32 v189,s40,v189,v238
M v[132:135],a[208:211],a[180:183],v[132:135]
v_cvt_pk_bf16_f32 v232,v232,v237
v_cvt_pk_bf16_f32 v234,v234,v236
M v[132:135],a[212:215],a[116:119],v[132:135]
v_accvgpr_read_b32 v238,a94
v_accvgpr_read_b32 v233,a190
M v[136:139],a[212:215],a[180:183],v[136:139]
v_add_f32 v235,v238,v233
v_sub_f32 v238,v238,v233
M v[136:139],a[208:211],a[124:127],v[136:139]
v_add_f32 v233,v94,v190
v_sub_f32 v190,v94,v190
M v[136:139],a[200:203],a[132:135],v[136:139]
v_add_f32 v94,v235,v233
v_fmac_f32 v235,4.0,v233
M v[140:143],a[200:203],a[176:179],v[140:143]
v_fma_f32 v233,2.0,v190,v238
v_fma_f32 v190,s40,v190,v238
M v[140:143],a[208:211],a[132:135],v[140:143]
v_accvgpr_read_b32 v238,a95
v_accvgpr_read_b32 v237,a191
M v[140:143],a[212:215],a[124:127],v[140:143]
v_add_f32 v236,v238,v237
v_sub_f32 v238,v238,v237
M v[144:147],a[212:215],a[132:135],v[144:147]
s_add_u32 s47,s75,3072
v_add_f32 v237,v95,v191
v_sub_f32 v191,v95,v191
M v[144:147],a[208:211],a[176:179],v[144:147]
v_add_f32 v95,v236,v237
v_fmac_f32 v236,4.0,v237
M v[144:147],a[200:203],a[160:163],v[144:147]
v_fma_f32 v237,2.0,v191,v238
v_fma_f32 v191,s40,v191,v238
M v[148:151],a[200:203],a[100:103],v[148:151]
v_cvt_pk_bf16_f32 v233,v233,v237
v_cvt_pk_bf16_f32 v235,v235,v236
M v[148:151],a[208:211],a[160:163],v[148:151]
ds_read_b128 a[164:167],v248 offset:0
ds_write2st64_b64 v254,v[232:233],v[234:235] offset0:25 offset1:29
M v[148:151],a[212:215],a[176:179],v[148:151]
ds_read_b128 a[136:139],v249 offset:0
v_cvt_pk_bf16_f32 v96,v96,v97
M v[152:155],a[212:215],a[160:163],v[152:155]
buffer_load_dwordx4 a[152:155],v250,s[20:23],s47 offen offset:0 sc1
M v[152:155],a[208:211],a[100:103],v[152:155]
ds_read_b128 a[128:131],v248 offset:512
ds_read_b128 a[180:183],v249 offset:512
M v[152:155],a[200:203],a[172:175],v[152:155]
buffer_load_dwordx4 a[116:119],v250,s[20:23],s47 offen offset:1024 sc1
M v[156:159],a[200:203],a[96:99],v[156:159]
v_cvt_pk_bf16_f32 v97,v98,v99
v_cvt_pk_bf16_f32 v100,v100,v101
M v[156:159],a[208:211],a[172:175],v[156:159]
v_cvt_pk_bf16_f32 v101,v102,v103
M v[156:159],a[212:215],a[100:103],v[156:159]
s_waitcnt vmcnt(19) lgkmcnt(3)
s_barrier
ds_read_b128 a[64:67],v250 offset:17408
M v[32:35],a[168:171],a[164:167],v[32:35]
s_waitcnt vmcnt(18) lgkmcnt(3)
ds_read_b128 a[68:71],v250 offset:21504
ds_read_b128 a[72:75],v250 offset:26112
M v[32:35],a[148:151],a[136:139],v[32:35]
s_waitcnt vmcnt(17) lgkmcnt(4)
ds_read_b128 a[76:79],v250 offset:30208
ds_read_b128 a[80:83],v250 offset:0
M v[32:35],a[112:115],a[128:131],v[32:35]
s_waitcnt lgkmcnt(5)
ds_read_b128 a[84:87],v250 offset:4096
ds_read_b128 a[88:91],v250 offset:8704
M v[36:39],a[112:115],a[180:183],v[36:39]
ds_read_b128 a[92:95],v250 offset:12800
ds_read_b128 a[188:191],v248 offset:1024
M v[36:39],a[148:151],a[128:131],v[36:39]
s_add_u32 s34,s32,6291456
buffer_load_dwordx4 a[124:127],v250,s[20:23],s47 offen offset:2048 sc1
ds_read_b128 a[132:135],v249 offset:1024
M v[36:39],a[168:171],a[136:139],v[36:39]
ds_write2st64_b64 v254,v[96:97],v[100:101] offset0:68 offset1:72
M v[40:43],a[168:171],a[128:131],v[40:43]
ds_read_b128 a[176:179],v248 offset:1536
v_cvt_pk_bf16_f32 v104,v104,v105
M v[40:43],a[148:151],a[180:183],v[40:43]
s_waitcnt lgkmcnt(3)
ds_read_b128 a[160:163],v249 offset:1536
v_cvt_pk_bf16_f32 v105,v106,v107
M v[40:43],a[112:115],a[188:191],v[40:43]
s_waitcnt lgkmcnt(3)
buffer_store_dwordx4 a[64:67],v253,s[24:27],s34 offen offset:640 nt
M v[44:47],a[112:115],a[132:135],v[44:47]
s_add_u32 s34,s32,6488064
v_cvt_pk_bf16_f32 v108,v108,v109
v_cvt_pk_bf16_f32 v109,v110,v111
M v[44:47],a[148:151],a[188:191],v[44:47]
ds_write2st64_b64 v254,v[104:105],v[108:109] offset0:76 offset1:80
M v[44:47],a[168:171],a[180:183],v[44:47]
buffer_store_dwordx4 a[68:71],v253,s[24:27],s34 offen offset:640 nt
M v[48:51],a[168:171],a[188:191],v[48:51]
s_add_u32 s34,s32,6684672
ds_read_b128 a[96:99],v249 offset:2048
s_add_u32 s48,s75,6144
M v[48:51],a[148:151],a[132:135],v[48:51]
s_waitcnt lgkmcnt(3)
ds_read_b128 a[172:175],v248 offset:2048
v_cvt_pk_bf16_f32 v112,v112,v113
M v[48:51],a[112:115],a[176:179],v[48:51]
s_waitcnt lgkmcnt(3)
buffer_store_dwordx4 a[72:75],v253,s[24:27],s34 offen offset:640 nt
M v[52:55],a[112:115],a[160:163],v[52:55]
s_add_u32 s34,s32,6881280
v_cvt_pk_bf16_f32 v113,v114,v115
v_cvt_pk_bf16_f32 v116,v116,v117
M v[52:55],a[148:151],a[176:179],v[52:55]
v_cvt_pk_bf16_f32 v117,v118,v119
M v[52:55],a[168:171],a[132:135],v[52:55]
buffer_store_dwordx4 a[76:79],v253,s[24:27],s34 offen offset:640 nt
M v[56:59],a[168:171],a[176:179],v[56:59]
s_add_u32 s34,s32,7077888
buffer_load_dwordx4 a[100:103],v250,s[20:23],s48 offen offset:0 sc1
M v[56:59],a[148:151],a[160:163],v[56:59]
s_waitcnt lgkmcnt(1)
ds_write2st64_b64 v254,v[112:113],v[116:117] offset0:85 offset1:89
M v[56:59],a[112:115],a[96:99],v[56:59]
s_waitcnt lgkmcnt(1)
v_cvt_pk_bf16_f32 v120,v120,v121
v_cvt_pk_bf16_f32 v121,v122,v123
M v[60:63],a[112:115],a[172:175],v[60:63]
v_cvt_pk_bf16_f32 v124,v124,v125
v_cvt_pk_bf16_f32 v125,v126,v127
M v[60:63],a[148:151],a[96:99],v[60:63]
buffer_load_dwordx4 a[236:239],v250,s[20:23],s48 offen offset:1024 sc1
M v[60:63],a[168:171],a[160:163],v[60:63]
s_waitcnt vmcnt(23)
ds_write2st64_b64 v254,v[120:121],v[124:125] offset0:93 offset1:97
M v[64:67],a[220:223],a[164:167],v[64:67]
s_waitcnt vmcnt(22)
v_cvt_pk_bf16_f32 v128,v128,v129
v_cvt_pk_bf16_f32 v129,v130,v131
M v[64:67],a[244:247],a[136:139],v[64:67]
s_waitcnt vmcnt(21)
buffer_load_dwordx4 a[224:227],v250,s[20:23],s48 offen offset:2048 sc1
M v[64:67],v[224:227],a[128:131],v[64:67]
v_cvt_pk_bf16_f32 v132,v132,v133
v_cvt_pk_bf16_f32 v133,v134,v135
M v[68:71],v[224:227],a[180:183],v[68:71]
s_waitcnt lgkmcnt(0)
s_barrier
ds_read_b128 v[96:99],v250 offset:34816
M v[68:71],a[244:247],a[128:131],v[68:71]
ds_read_b128 v[104:107],v250 offset:38912
ds_read_b128 v[112:115],v250 offset:43520
M v[68:71],a[220:223],a[136:139],v[68:71]
ds_read_b128 v[120:123],v250 offset:47616
buffer_store_dwordx4 a[80:83],v253,s[24:27],s34 offen offset:640 nt
M v[72:75],a[220:223],a[128:131],v[72:75]
s_add_u32 s34,s32,7274496
ds_write2st64_b64 v254,v[128:129],v[132:133] offset0:34 offset1:38
M v[72:75],a[244:247],a[180:183],v[72:75]
v_cvt_pk_bf16_f32 v136,v136,v137
v_cvt_pk_bf16_f32 v137,v138,v139
M v[72:75],v[224:227],a[188:191],v[72:75]
buffer_store_dwordx4 a[84:87],v253,s[24:27],s34 offen offset:640 nt
M v[76:79],v[224:227],a[132:135],v[76:79]
s_add_u32 s34,s32,7471104
v_cvt_pk_bf16_f32 v140,v140,v141
v_cvt_pk_bf16_f32 v141,v142,v143
M v[76:79],a[244:247],a[188:191],v[76:79]
ds_write2st64_b64 v254,v[136:137],v[140:141] offset0:42 offset1:46
M v[76:79],a[220:223],a[180:183],v[76:79]
buffer_store_dwordx4 a[88:91],v253,s[24:27],s34 offen offset:640 nt
M v[80:83],a[220:223],a[188:191],v[80:83]
s_add_u32 s34,s32,7667712
s_add_u32 s47,s76,3072
v_cvt_pk_bf16_f32 v144,v144,v145
M v[80:83],a[244:247],a[132:135],v[80:83]
v_cvt_pk_bf16_f32 v145,v146,v147
v_cvt_pk_bf16_f32 v148,v148,v149
M v[80:83],v[224:227],a[176:179],v[80:83]
buffer_store_dwordx4 a[92:95],v253,s[24:27],s34 offen offset:640 nt
M v[84:87],v[224:227],a[160:163],v[84:87]
v_cvt_pk_bf16_f32 v149,v150,v151
M v[84:87],a[244:247],a[176:179],v[84:87]
ds_read_b128 a[112:115],v248 offset:34816
ds_write2st64_b64 v254,v[144:145],v[148:149] offset0:51 offset1:55
M v[84:87],a[220:223],a[132:135],v[84:87]
ds_read_b128 a[148:151],v249 offset:34816
v_cvt_pk_bf16_f32 v152,v152,v153
M v[88:91],a[220:223],a[176:179],v[88:91]
buffer_load_dwordx4 a[168:171],v250,s[20:23],s47 offen offset:0 sc1
M v[88:91],a[244:247],a[160:163],v[88:91]
ds_read_b128 a[164:167],v248 offset:35328
ds_read_b128 a[128:131],v249 offset:35328
M v[88:91],v[224:227],a[96:99],v[88:91]
buffer_load_dwordx4 a[136:139],v250,s[20:23],s47 offen offset:1024 sc1
M v[92:95],v[224:227],a[172:175],v[92:95]
v_cvt_pk_bf16_f32 v153,v154,v155
v_cvt_pk_bf16_f32 v156,v156,v157
M v[92:95],a[244:247],a[96:99],v[92:95]
v_cvt_pk_bf16_f32 v157,v158,v159
M v[92:95],a[220:223],a[160:163],v[92:95]
s_waitcnt vmcnt(27) lgkmcnt(4)
ds_write2st64_b64 v254,v[152:153],v[156:157] offset0:59 offset1:63
M v[32:35],a[144:147],a[112:115],v[32:35]
s_waitcnt vmcnt(26) lgkmcnt(3)
s_add_u32 s34,s33,6291456
buffer_load_dwordx4 a[180:183],v250,s[20:23],s47 offen offset:2048 sc1
M v[32:35],a[120:123],a[148:151],v[32:35]
s_waitcnt vmcnt(26) lgkmcnt(2)
ds_read_b128 a[188:191],v248 offset:35840
ds_read_b128 a[132:135],v249 offset:35840
M v[32:35],a[108:111],a[164:167],v[32:35]
s_waitcnt lgkmcnt(2)
s_barrier
ds_read_b128 v[128:131],v250 offset:17408
M v[36:39],a[108:111],a[128:131],v[36:39]
ds_read_b128 v[136:139],v250 offset:21504
ds_read_b128 v[144:147],v250 offset:26112
M v[36:39],a[120:123],a[164:167],v[36:39]
ds_read_b128 v[152:155],v250 offset:30208
M v[36:39],a[144:147],a[148:151],v[36:39]
buffer_store_dwordx4 v[96:99],v253,s[24:27],s34 offen offset:1152 nt
M v[40:43],a[144:147],a[164:167],v[40:43]
ds_read_b128 a[176:179],v248 offset:36352
M v[40:43],a[120:123],a[128:131],v[40:43]
s_waitcnt lgkmcnt(6)
ds_read_b128 a[172:175],v249 offset:36352
M v[40:43],a[108:111],a[188:191],v[40:43]
s_waitcnt lgkmcnt(2)
s_barrier
M v[44:47],a[108:111],a[132:135],v[44:47]
M v[44:47],a[120:123],a[188:191],v[44:47]
M v[44:47],a[144:147],a[128:131],v[44:47]
M v[48:51],a[144:147],a[188:191],v[48:51]
s_add_u32 s48,s76,6144
ds_read_b128 a[96:99],v249 offset:36864
M v[48:51],a[120:123],a[132:135],v[48:51]
s_waitcnt lgkmcnt(2)
ds_read_b128 a[160:163],v248 offset:36864
M v[48:51],a[108:111],a[176:179],v[48:51]
s_waitcnt lgkmcnt(2)
M v[52:55],a[108:111],a[172:175],v[52:55]
M v[52:55],a[120:123],a[176:179],v[52:55]
M v[52:55],a[144:147],a[132:135],v[52:55]
M v[56:59],a[144:147],a[176:179],v[56:59]
buffer_load_dwordx4 v[220:223],v250,s[20:23],s48 offen offset:0 sc1
M v[56:59],a[120:123],a[172:175],v[56:59]
s_waitcnt lgkmcnt(1)
M v[56:59],a[108:111],a[96:99],v[56:59]
s_waitcnt lgkmcnt(0)
buffer_load_dwordx4 a[204:207],v250,s[20:23],s48 offen offset:1024 sc1
M v[60:63],a[108:111],a[160:163],v[60:63]
M v[60:63],a[120:123],a[96:99],v[60:63]
s_add_u32 s34,s33,6684672
M v[60:63],a[144:147],a[172:175],v[60:63]
s_waitcnt vmcnt(28)
M v[64:67],a[196:199],a[112:115],v[64:67]
s_waitcnt vmcnt(27)
buffer_load_dwordx4 v[216:219],v250,s[20:23],s48 offen offset:2048 sc1
M v[64:67],a[228:231],a[148:151],v[64:67]
s_waitcnt vmcnt(27)
M v[64:67],a[240:243],a[164:167],v[64:67]
M v[68:71],a[240:243],a[128:131],v[68:71]
M v[68:71],a[228:231],a[164:167],v[68:71]
M v[68:71],a[196:199],a[148:151],v[68:71]
buffer_store_dwordx4 v[104:107],v253,s[24:27],s34 offen offset:1152 nt
M v[72:75],a[196:199],a[164:167],v[72:75]
M v[72:75],a[228:231],a[128:131],v[72:75]
M v[72:75],a[240:243],a[188:191],v[72:75]
M v[76:79],a[240:243],a[132:135],v[76:79]
M v[76:79],a[228:231],a[188:191],v[76:79]
M v[76:79],a[196:199],a[128:131],v[76:79]
M v[80:83],a[196:199],a[188:191],v[80:83]
s_add_u32 s47,s77,3072
M v[80:83],a[228:231],a[132:135],v[80:83]
M v[80:83],a[240:243],a[176:179],v[80:83]
M v[84:87],a[240:243],a[172:175],v[84:87]
M v[84:87],a[228:231],a[176:179],v[84:87]
ds_read_b128 a[108:111],v248 offset:52224
M v[84:87],a[196:199],a[132:135],v[84:87]
ds_read_b128 a[120:123],v249 offset:52224
M v[88:91],a[196:199],a[176:179],v[88:91]
buffer_load_dwordx4 a[144:147],v250,s[20:23],s47 offen offset:0 sc1
M v[88:91],a[228:231],a[172:175],v[88:91]
ds_read_b128 a[112:115],v248 offset:52736
ds_read_b128 a[164:167],v249 offset:52736
M v[88:91],a[240:243],a[96:99],v[88:91]
s_add_u32 s34,s33,7077888
buffer_load_dwordx4 a[148:151],v250,s[20:23],s47 offen offset:1024 sc1
M v[92:95],a[240:243],a[160:163],v[92:95]
M v[92:95],a[228:231],a[96:99],v[92:95]
M v[92:95],a[196:199],a[172:175],v[92:95]
s_waitcnt vmcnt(29) lgkmcnt(3)
M v[32:35],a[156:159],a[108:111],v[32:35]
s_waitcnt vmcnt(28) lgkmcnt(2)
buffer_load_dwordx4 a[128:131],v250,s[20:23],s47 offen offset:2048 sc1
M v[32:35],a[104:107],a[120:123],v[32:35]
s_waitcnt vmcnt(28) lgkmcnt(1)
ds_read_b128 a[188:191],v248 offset:53248
ds_read_b128 a[132:135],v249 offset:53248
M v[32:35],a[140:143],a[112:115],v[32:35]
s_waitcnt lgkmcnt(2)
M v[36:39],a[140:143],a[164:167],v[36:39]
M v[36:39],a[104:107],a[112:115],v[36:39]
M v[36:39],a[156:159],a[120:123],v[36:39]
buffer_store_dwordx4 v[112:115],v253,s[24:27],s34 offen offset:1152 nt
M v[40:43],a[156:159],a[112:115],v[40:43]
ds_read_b128 a[176:179],v248 offset:53760
M v[40:43],a[104:107],a[164:167],v[40:43]
s_waitcnt lgkmcnt(2)
ds_read_b128 a[160:163],v249 offset:53760
M v[40:43],a[140:143],a[188:191],v[40:43]
s_waitcnt lgkmcnt(2)
M v[44:47],a[140:143],a[132:135],v[44:47]
M v[44:47],a[104:107],a[188:191],v[44:47]
M v[44:47],a[156:159],a[164:167],v[44:47]
M v[48:51],a[156:159],a[188:191],v[48:51]
s_add_u32 s48,s77,6144
ds_read_b128 a[96:99],v249 offset:54272
M v[48:51],a[104:107],a[132:135],v[48:51]
s_waitcnt lgkmcnt(2)
ds_read_b128 a[172:175],v248 offset:54272
M v[48:51],a[140:143],a[176:179],v[48:51]
s_waitcnt lgkmcnt(2)
M v[52:55],a[140:143],a[160:163],v[52:55]
M v[52:55],a[104:107],a[176:179],v[52:55]
M v[52:55],a[156:159],a[132:135],v[52:55]
M v[56:59],a[156:159],a[176:179],v[56:59]
s_add_u32 s34,s33,7471104
buffer_load_dwordx4 a[216:219],v250,s[20:23],s48 offen offset:0 sc1
M v[56:59],a[104:107],a[160:163],v[56:59]
s_waitcnt lgkmcnt(1)
M v[56:59],a[140:143],a[96:99],v[56:59]
s_waitcnt lgkmcnt(0)
buffer_store_dwordx4 v[120:123],v253,s[24:27],s34 offen offset:1152 nt
M v[60:63],a[140:143],a[172:175],v[60:63]
M v[60:63],a[104:107],a[96:99],v[60:63]
M v[60:63],a[156:159],a[160:163],v[60:63]
s_waitcnt vmcnt(30)
buffer_load_dwordx4 a[192:195],v250,s[20:23],s48 offen offset:1024 sc1
M v[64:67],a[184:187],a[108:111],v[64:67]
s_waitcnt vmcnt(30)
M v[64:67],a[248:251],a[120:123],v[64:67]
s_waitcnt vmcnt(29)
M v[64:67],a[232:235],a[112:115],v[64:67]
M v[68:71],a[232:235],a[164:167],v[68:71]
buffer_load_dwordx4 a[252:255],v250,s[20:23],s48 offen offset:2048 sc1
M v[68:71],a[248:251],a[112:115],v[68:71]
M v[68:71],a[184:187],a[120:123],v[68:71]
M v[72:75],a[184:187],a[112:115],v[72:75]
M v[72:75],a[248:251],a[164:167],v[72:75]
M v[72:75],a[232:235],a[188:191],v[72:75]
M v[76:79],a[232:235],a[132:135],v[76:79]
M v[76:79],a[248:251],a[188:191],v[76:79]
M v[76:79],a[184:187],a[164:167],v[76:79]
M v[80:83],a[184:187],a[188:191],v[80:83]
s_add_u32 s48,s72,52224
M v[80:83],a[248:251],a[132:135],v[80:83]
v_add_u32 v248,0x11000,v248
v_add_u32 v249,0x11000,v249
M v[80:83],a[232:235],a[176:179],v[80:83]
M v[84:87],a[232:235],a[160:163],v[84:87]
M v[84:87],a[248:251],a[176:179],v[84:87]
s_add_u32 s34,s33,6291456
ds_read_b128 a[140:143],v248 offset:0
M v[84:87],a[184:187],a[132:135],v[84:87]
buffer_store_dwordx4 v[128:131],v253,s[24:27],s34 offen offset:1280 nt
M v[88:91],a[184:187],a[176:179],v[88:91]
buffer_load_dwordx4 a[156:159],v250,s[20:23],s48 offen offset:0 sc1
M v[88:91],a[248:251],a[160:163],v[88:91]
ds_read_b128 a[104:107],v249 offset:0
ds_read_b128 a[108:111],v248 offset:512
M v[88:91],a[232:235],a[96:99],v[88:91]
ds_read_b128 a[112:115],v249 offset:512
M v[92:95],a[232:235],a[172:175],v[92:95]
M v[92:95],a[248:251],a[96:99],v[92:95]
buffer_load_dwordx4 a[120:123],v250,s[20:23],s48 offen offset:1024 sc1
M v[92:95],a[184:187],a[160:163],v[92:95]
s_waitcnt vmcnt(32) lgkmcnt(3)
M v[32:35],a[152:155],a[140:143],v[32:35]
s_waitcnt vmcnt(31) lgkmcnt(2)
ds_read_b128 a[188:191],v248 offset:1024
M v[32:35],a[116:119],a[104:107],v[32:35]
s_waitcnt vmcnt(30) lgkmcnt(2)
ds_read_b128 a[132:135],v249 offset:1024
M v[32:35],a[124:127],a[108:111],v[32:35]
s_waitcnt lgkmcnt(2)
buffer_load_dwordx4 a[164:167],v250,s[20:23],s48 offen offset:2048 sc1
M v[36:39],a[124:127],a[112:115],v[36:39]
M v[36:39],a[116:119],a[108:111],v[36:39]
M v[36:39],a[152:155],a[104:107],v[36:39]
M v[40:43],a[152:155],a[108:111],v[40:43]
ds_read_b128 a[176:179],v248 offset:1536
M v[40:43],a[116:119],a[112:115],v[40:43]
s_waitcnt lgkmcnt(2)
ds_read_b128 a[172:175],v249 offset:1536
M v[40:43],a[124:127],a[188:191],v[40:43]
s_waitcnt lgkmcnt(2)
M v[44:47],a[124:127],a[132:135],v[44:47]
M v[44:47],a[116:119],a[188:191],v[44:47]
M v[44:47],a[152:155],a[112:115],v[44:47]
M v[48:51],a[152:155],a[188:191],v[48:51]
s_add_u32 s48,s73,52224
ds_read_b128 a[96:99],v249 offset:2048
M v[48:51],a[116:119],a[132:135],v[48:51]
s_waitcnt lgkmcnt(2)
ds_read_b128 a[160:163],v248 offset:2048
M v[48:51],a[124:127],a[176:179],v[48:51]
s_waitcnt lgkmcnt(2)
M v[52:55],a[124:127],a[172:175],v[52:55]
s_add_u32 s34,s33,6684672
M v[52:55],a[116:119],a[176:179],v[52:55]
M v[52:55],a[152:155],a[132:135],v[52:55]
buffer_store_dwordx4 v[136:139],v253,s[24:27],s34 offen offset:1280 nt
M v[56:59],a[152:155],a[176:179],v[56:59]
buffer_load_dwordx4 a[184:187],v250,s[20:23],s48 offen offset:0 sc1
M v[56:59],a[116:119],a[172:175],v[56:59]
s_waitcnt lgkmcnt(1)
M v[56:59],a[124:127],a[96:99],v[56:59]
s_waitcnt lgkmcnt(0)
M v[60:63],a[124:127],a[160:163],v[60:63]
M v[60:63],a[116:119],a[96:99],v[60:63]
buffer_load_dwordx4 v[228:231],v250,s[20:23],s48 offen offset:1024 sc1
M v[60:63],a[152:155],a[172:175],v[60:63]
s_waitcnt vmcnt(29)
M v[64:67],a[100:103],a[140:143],v[64:67]
s_waitcnt vmcnt(28)
M v[64:67],a[236:239],a[104:107],v[64:67]
s_waitcnt vmcnt(27)
M v[64:67],a[224:227],a[108:111],v[64:67]
buffer_load_dwordx4 a[200:203],v250,s[20:23],s48 offen offset:2048 sc1
M v[68:71],a[224:227],a[112:115],v[68:71]
M v[68:71],a[236:239],a[108:111],v[68:71]
M v[68:71],a[100:103],a[104:107],v[68:71]
M v[72:75],a[100:103],a[108:111],v[72:75]
M v[72:75],a[236:239],a[112:115],v[72:75]
M v[72:75],a[224:227],a[188:191],v[72:75]
M v[76:79],a[224:227],a[132:135],v[76:79]
M v[76:79],a[236:239],a[188:191],v[76:79]
M v[76:79],a[100:103],a[112:115],v[76:79]
M v[80:83],a[100:103],a[188:191],v[80:83]
s_add_u32 s48,s74,52224
M v[80:83],a[236:239],a[132:135],v[80:83]
s_add_u32 s34,s33,7077888
M v[80:83],a[224:227],a[176:179],v[80:83]
buffer_store_dwordx4 v[144:147],v253,s[24:27],s34 offen offset:1280 nt
M v[84:87],a[224:227],a[172:175],v[84:87]
M v[84:87],a[236:239],a[176:179],v[84:87]
ds_read_b128 a[124:127],v248 offset:17408
M v[84:87],a[100:103],a[132:135],v[84:87]
ds_read_b128 a[116:119],v249 offset:17408
M v[88:91],a[100:103],a[176:179],v[88:91]
buffer_load_dwordx4 a[152:155],v250,s[20:23],s48 offen offset:0 sc1
M v[88:91],a[236:239],a[172:175],v[88:91]
ds_read_b128 a[140:143],v248 offset:17920
ds_read_b128 a[108:111],v249 offset:17920
M v[88:91],a[224:227],a[96:99],v[88:91]
buffer_load_dwordx4 a[104:107],v250,s[20:23],s48 offen offset:1024 sc1
M v[92:95],a[224:227],a[160:163],v[92:95]
M v[92:95],a[236:239],a[96:99],v[92:95]
M v[92:95],a[100:103],a[172:175],v[92:95]
s_waitcnt vmcnt(26) lgkmcnt(3)
M v[32:35],a[168:171],a[124:127],v[32:35]
s_waitcnt vmcnt(25) lgkmcnt(2)
buffer_load_dwordx4 a[112:115],v250,s[20:23],s48 offen offset:2048 sc1
M v[32:35],a[136:139],a[116:119],v[32:35]
s_waitcnt vmcnt(25) lgkmcnt(1)
ds_read_b128 a[188:191],v248 offset:18432
ds_read_b128 a[132:135],v249 offset:18432
M v[32:35],a[180:183],a[140:143],v[32:35]
s_waitcnt lgkmcnt(2)
M v[36:39],a[180:183],a[108:111],v[36:39]
M v[36:39],a[136:139],a[140:143],v[36:39]
M v[36:39],a[168:171],a[116:119],v[36:39]
M v[40:43],a[168:171],a[140:143],v[40:43]
ds_read_b128 a[176:179],v248 offset:18944
M v[40:43],a[136:139],a[108:111],v[40:43]
s_waitcnt lgkmcnt(2)
ds_read_b128 a[160:163],v249 offset:18944
M v[40:43],a[180:183],a[188:191],v[40:43]
s_waitcnt lgkmcnt(2)
M v[44:47],a[180:183],a[132:135],v[44:47]
M v[44:47],a[136:139],a[188:191],v[44:47]
M v[44:47],a[168:171],a[108:111],v[44:47]
s_add_u32 s34,s33,7471104
buffer_store_dwordx4 v[152:155],v253,s[24:27],s34 offen offset:1280 nt
M v[48:51],a[168:171],a[188:191],v[48:51]
s_add_u32 s48,s75,52224
ds_read_b128 a[96:99],v249 offset:19456
M v[48:51],a[136:139],a[132:135],v[48:51]
s_waitcnt lgkmcnt(2)
ds_read_b128 a[100:103],v248 offset:19456
M v[48:51],a[180:183],a[176:179],v[48:51]
s_waitcnt lgkmcnt(2)
M v[52:55],a[180:183],a[160:163],v[52:55]
M v[52:55],a[136:139],a[176:179],v[52:55]
M v[52:55],a[168:171],a[132:135],v[52:55]
M v[56:59],a[168:171],a[176:179],v[56:59]
buffer_load_dwordx4 a[172:175],v250,s[20:23],s48 offen offset:0 sc1
M v[56:59],a[136:139],a[160:163],v[56:59]
s_waitcnt lgkmcnt(1)
M v[56:59],a[180:183],a[96:99],v[56:59]
s_waitcnt lgkmcnt(0)
buffer_load_dwordx4 a[208:211],v250,s[20:23],s48 offen offset:1024 sc1
M v[60:63],a[180:183],a[100:103],v[60:63]
M v[60:63],a[136:139],a[96:99],v[60:63]
M v[60:63],a[168:171],a[160:163],v[60:63]
s_waitcnt vmcnt(26)
M v[64:67],v[220:223],a[124:127],v[64:67]
s_waitcnt vmcnt(25)
buffer_load_dwordx4 a[212:215],v250,s[20:23],s48 offen offset:2048 sc1
M v[64:67],a[204:207],a[116:119],v[64:67]
s_waitcnt vmcnt(25)
M v[64:67],v[216:219],a[140:143],v[64:67]
M v[68:71],v[216:219],a[108:111],v[68:71]
M v[68:71],a[204:207],a[140:143],v[68:71]
M v[68:71],v[220:223],a[116:119],v[68:71]
M v[72:75],v[220:223],a[140:143],v[72:75]
M v[72:75],a[204:207],a[108:111],v[72:75]
M v[72:75],v[216:219],a[188:191],v[72:75]
M v[76:79],v[216:219],a[132:135],v[76:79]
M v[76:79],a[204:207],a[188:191],v[76:79]
M v[76:79],v[220:223],a[108:111],v[76:79]
M v[80:83],v[220:223],a[188:191],v[80:83]
s_add_u32 s48,s76,52224
M v[80:83],a[204:207],a[132:135],v[80:83]
v_add_u32 v248,0xffff1200,v248
v_add_u32 v249,0xffff1200,v249
M v[80:83],v[216:219],a[176:179],v[80:83]
M v[84:87],v[216:219],a[160:163],v[84:87]
M v[84:87],a[204:207],a[176:179],v[84:87]
ds_read_b128 a[180:183],v248 offset:8704
M v[84:87],v[220:223],a[132:135],v[84:87]
ds_read_b128 a[136:139],v249 offset:8704
M v[88:91],v[220:223],a[176:179],v[88:91]
buffer_load_dwordx4 a[168:171],v250,s[20:23],s48 offen offset:0 sc1
M v[88:91],a[204:207],a[160:163],v[88:91]
ds_read_b128 a[124:127],v248 offset:9216
ds_read_b128 a[140:143],v249 offset:9216
M v[88:91],v[216:219],a[96:99],v[88:91]
buffer_load_dwordx4 a[116:119],v250,s[20:23],s48 offen offset:1024 sc1
M v[92:95],v[216:219],a[100:103],v[92:95]
M v[92:95],a[204:207],a[96:99],v[92:95]
M v[92:95],v[220:223],a[160:163],v[92:95]
s_waitcnt vmcnt(25) lgkmcnt(3)
M v[32:35],a[144:147],a[180:183],v[32:35]
s_waitcnt vmcnt(24) lgkmcnt(2)
buffer_load_dwordx4 a[108:111],v250,s[20:23],s48 offen offset:2048 sc1
M v[32:35],a[148:151],a[136:139],v[32:35]
s_waitcnt vmcnt(24) lgkmcnt(1)
s_add_u32 s48,s77,52224
ds_read_b128 a[100:103],v248 offset:9728
ds_read_b128 a[96:99],v249 offset:9728
M v[32:35],a[128:131],a[124:127],v[32:35]
s_waitcnt lgkmcnt(2)
M v[36:39],a[128:131],a[140:143],v[36:39]
M v[36:39],a[148:151],a[124:127],v[36:39]
buffer_load_dwordx4 a[188:191],v250,s[20:23],s48 offen offset:0 sc1
M v[36:39],a[144:147],a[136:139],v[36:39]
s_nop 2
v_cvt_pk_bf16_f32 v32,v32,v33
v_cvt_pk_bf16_f32 v33,v34,v35
M v[40:43],a[144:147],a[124:127],v[40:43]
ds_read_b128 a[160:163],v248 offset:10240
M v[40:43],a[148:151],a[140:143],v[40:43]
s_waitcnt lgkmcnt(2)
ds_read_b128 v[224:227],v249 offset:10240
M v[40:43],a[128:131],a[100:103],v[40:43]
s_waitcnt lgkmcnt(2)
buffer_load_dwordx4 a[132:135],v250,s[20:23],s48 offen offset:1024 sc1
M v[44:47],a[128:131],a[96:99],v[44:47]
v_cvt_pk_bf16_f32 v36,v36,v37
v_cvt_pk_bf16_f32 v37,v38,v39
M v[44:47],a[148:151],a[100:103],v[44:47]
ds_write2st64_b64 v254,v[32:33],v[36:37] offset0:34 offset1:38
M v[44:47],a[144:147],a[140:143],v[44:47]
v_cvt_pk_bf16_f32 v40,v40,v41
v_cvt_pk_bf16_f32 v41,v42,v43
M v[48:51],a[144:147],a[100:103],v[48:51]
buffer_load_dwordx4 a[176:179],v250,s[20:23],s48 offen offset:2048 sc1
M v[48:51],a[148:151],a[96:99],v[48:51]
s_waitcnt lgkmcnt(2)
ds_read_b128 a[244:247],v249 offset:10752
ds_read_b128 a[220:223],v248 offset:10752
M v[48:51],a[128:131],a[160:163],v[48:51]
s_waitcnt lgkmcnt(3)
v_cvt_pk_bf16_f32 v44,v44,v45
v_cvt_pk_bf16_f32 v45,v46,v47
M v[52:55],a[128:131],v[224:227],v[52:55]
ds_write2st64_b64 v254,v[40:41],v[44:45] offset0:42 offset1:46
M v[52:55],a[148:151],a[160:163],v[52:55]
M v[52:55],a[144:147],a[96:99],v[52:55]
s_nop 0
v_cvt_pk_bf16_f32 v48,v48,v49
v_cvt_pk_bf16_f32 v49,v50,v51
M v[56:59],a[144:147],a[160:163],v[56:59]
M v[56:59],a[148:151],v[224:227],v[56:59]
s_waitcnt lgkmcnt(2)
M v[56:59],a[128:131],a[244:247],v[56:59]
s_waitcnt lgkmcnt(1)
v_cvt_pk_bf16_f32 v52,v52,v53
v_cvt_pk_bf16_f32 v53,v54,v55
M v[60:63],a[128:131],a[220:223],v[60:63]
ds_write2st64_b64 v254,v[48:49],v[52:53] offset0:51 offset1:55
M v[60:63],a[148:151],a[244:247],v[60:63]
M v[60:63],a[144:147],v[224:227],v[60:63]
s_waitcnt vmcnt(25)
v_cvt_pk_bf16_f32 v56,v56,v57
v_cvt_pk_bf16_f32 v57,v58,v59
M v[64:67],a[216:219],a[180:183],v[64:67]
s_waitcnt vmcnt(23)
M v[64:67],a[192:195],a[136:139],v[64:67]
s_waitcnt vmcnt(22)
M v[64:67],a[252:255],a[124:127],v[64:67]
v_cvt_pk_bf16_f32 v60,v60,v61
v_cvt_pk_bf16_f32 v61,v62,v63
M v[68:71],a[252:255],a[140:143],v[68:71]
ds_write2st64_b64 v254,v[56:57],v[60:61] offset0:59 offset1:63
M v[68:71],a[192:195],a[124:127],v[68:71]
M v[68:71],a[216:219],a[136:139],v[68:71]
s_nop 1
v_cvt_pk_bf16_f32 v64,v64,v65
v_cvt_pk_bf16_f32 v65,v66,v67
M v[72:75],a[216:219],a[124:127],v[72:75]
M v[72:75],a[192:195],a[140:143],v[72:75]
M v[72:75],a[252:255],a[100:103],v[72:75]
s_nop 0
v_cvt_pk_bf16_f32 v68,v68,v69
v_cvt_pk_bf16_f32 v69,v70,v71
M v[76:79],a[252:255],a[96:99],v[76:79]
ds_write2st64_b64 v254,v[64:65],v[68:69] offset0:0 offset1:4
M v[76:79],a[192:195],a[100:103],v[76:79]
M v[76:79],a[216:219],a[140:143],v[76:79]
s_nop 0
v_cvt_pk_bf16_f32 v72,v72,v73
v_cvt_pk_bf16_f32 v73,v74,v75
M v[80:83],a[216:219],a[100:103],v[80:83]
M v[80:83],a[192:195],a[96:99],v[80:83]
M v[80:83],a[252:255],a[160:163],v[80:83]
s_nop 1
v_cvt_pk_bf16_f32 v76,v76,v77
v_cvt_pk_bf16_f32 v77,v78,v79
M v[84:87],a[252:255],v[224:227],v[84:87]
ds_write2st64_b64 v254,v[72:73],v[76:77] offset0:8 offset1:12
M v[84:87],a[192:195],a[160:163],v[84:87]
ds_read_b128 a[128:131],v248 offset:0
M v[84:87],a[216:219],a[96:99],v[84:87]
ds_read_b128 a[148:151],v249 offset:0
v_cvt_pk_bf16_f32 v80,v80,v81
M v[88:91],a[216:219],a[160:163],v[88:91]
ds_read_b128 a[144:147],v248 offset:512
v_cvt_pk_bf16_f32 v81,v82,v83
M v[88:91],a[192:195],v[224:227],v[88:91]
ds_read_b128 a[180:183],v249 offset:512
M v[88:91],a[252:255],a[244:247],v[88:91]
v_cvt_pk_bf16_f32 v84,v84,v85
v_cvt_pk_bf16_f32 v85,v86,v87
M v[92:95],a[252:255],a[220:223],v[92:95]
ds_write2st64_b64 v254,v[80:81],v[84:85] offset0:17 offset1:21
M v[92:95],a[192:195],a[244:247],v[92:95]
M v[92:95],a[216:219],v[224:227],v[92:95]
s_waitcnt vmcnt(20) lgkmcnt(4)
s_nop 0
v_cvt_pk_bf16_f32 v88,v88,v89
v_cvt_pk_bf16_f32 v89,v90,v91
M v[160:163],a[156:159],a[128:131],v[160:163]
s_waitcnt vmcnt(19) lgkmcnt(3)
ds_read_b128 a[136:139],v248 offset:1024
M v[160:163],a[120:123],a[148:151],v[160:163]
s_waitcnt vmcnt(18) lgkmcnt(3)
ds_read_b128 a[124:127],v249 offset:1024
M v[160:163],a[164:167],a[144:147],v[160:163]
s_waitcnt lgkmcnt(3)
v_cvt_pk_bf16_f32 v92,v92,v93
v_cvt_pk_bf16_f32 v93,v94,v95
M v[164:167],a[164:167],a[180:183],v[164:167]
ds_write2st64_b64 v254,v[88:89],v[92:93] offset0:25 offset1:29
M v[164:167],a[120:123],a[144:147],v[164:167]
M v[164:167],a[156:159],a[148:151],v[164:167]
M v[168:171],a[156:159],a[144:147],v[168:171]
s_waitcnt lgkmcnt(0)
s_barrier
ds_read_b128 v[32:35],v250 offset:17408
M v[168:171],a[120:123],a[180:183],v[168:171]
ds_read_b128 v[40:43],v250 offset:21504
ds_read_b128 v[48:51],v250 offset:26112
M v[168:171],a[164:167],a[136:139],v[168:171]
ds_read_b128 v[56:59],v250 offset:30208
ds_read_b128 v[64:67],v250 offset:0
M v[172:175],a[164:167],a[124:127],v[172:175]
ds_read_b128 v[72:75],v250 offset:4096
ds_read_b128 v[80:83],v250 offset:8704
ds_read_b128 a[140:143],v248 offset:1536
M v[172:175],a[120:123],a[136:139],v[172:175]
ds_read_b128 v[88:91],v250 offset:12800
ds_read_b128 a[100:103],v249 offset:1536
M v[172:175],a[156:159],a[180:183],v[172:175]
s_waitcnt lgkmcnt(9)
s_add_u32 s34,s33,6291456
buffer_store_dwordx4 v[32:35],v253,s[24:27],s34 offen offset:128 nt
M v[176:179],a[156:159],a[136:139],v[176:179]
s_add_u32 s34,s33,6684672
ds_read_b128 a[96:99],v249 offset:2048
M v[176:179],a[120:123],a[124:127],v[176:179]
s_waitcnt lgkmcnt(3)
ds_read_b128 a[160:163],v248 offset:2048
M v[176:179],a[164:167],a[140:143],v[176:179]
s_waitcnt lgkmcnt(2)
buffer_store_dwordx4 v[40:43],v253,s[24:27],s34 offen offset:128 nt
M v[180:183],a[164:167],a[100:103],v[180:183]
s_add_u32 s34,s33,7077888
M v[180:183],a[120:123],a[140:143],v[180:183]
ds_read_b128 a[128:131],v248 offset:34816
M v[180:183],a[156:159],a[124:127],v[180:183]
buffer_store_dwordx4 v[48:51],v253,s[24:27],s34 offen offset:128 nt
M v[184:187],a[156:159],a[140:143],v[184:187]
s_add_u32 s34,s33,7471104
ds_read_b128 a[148:151],v249 offset:34816
ds_read_b128 a[144:147],v248 offset:35328
M v[184:187],a[120:123],a[100:103],v[184:187]
s_waitcnt lgkmcnt(4)
ds_read_b128 a[180:183],v249 offset:35328
M v[184:187],a[164:167],a[96:99],v[184:187]
s_waitcnt lgkmcnt(4)
buffer_store_dwordx4 v[56:59],v253,s[24:27],s34 offen offset:128 nt
M v[188:191],a[164:167],a[160:163],v[188:191]
M v[188:191],a[120:123],a[96:99],v[188:191]
M v[188:191],a[156:159],a[100:103],v[188:191]
s_waitcnt vmcnt(20) lgkmcnt(3)
M v[160:163],a[184:187],a[128:131],v[160:163]
s_waitcnt vmcnt(19) lgkmcnt(2)
ds_read_b128 a[136:139],v248 offset:35840
M v[160:163],v[228:231],a[148:151],v[160:163]
s_waitcnt vmcnt(18) lgkmcnt(2)
s_add_u32 s34,s33,6291456
ds_read_b128 a[124:127],v249 offset:35840
M v[160:163],a[200:203],a[144:147],v[160:163]
s_waitcnt lgkmcnt(2)
buffer_store_dwordx4 v[64:67],v253,s[24:27],s34 offen offset:256 nt
M v[164:167],a[200:203],a[180:183],v[164:167]
M v[164:167],v[228:231],a[144:147],v[164:167]
M v[164:167],a[184:187],a[148:151],v[164:167]
M v[168:171],a[184:187],a[144:147],v[168:171]
ds_read_b128 a[140:143],v248 offset:36352
M v[168:171],v[228:231],a[180:183],v[168:171]
s_waitcnt lgkmcnt(2)
ds_read_b128 a[160:163],v249 offset:36352
M v[168:171],a[200:203],a[136:139],v[168:171]
s_waitcnt lgkmcnt(2)
M v[172:175],a[200:203],a[124:127],v[172:175]
M v[172:175],v[228:231],a[136:139],v[172:175]
M v[172:175],a[184:187],a[180:183],v[172:175]
M v[176:179],a[184:187],a[136:139],v[176:179]
ds_read_b128 a[164:167],v249 offset:36864
M v[176:179],v[228:231],a[124:127],v[176:179]
s_waitcnt lgkmcnt(2)
ds_read_b128 a[96:99],v248 offset:36864
M v[176:179],a[200:203],a[140:143],v[176:179]
s_waitcnt lgkmcnt(2)
M v[180:183],a[200:203],a[160:163],v[180:183]
M v[180:183],v[228:231],a[140:143],v[180:183]
ds_read_b128 a[120:123],v248 offset:52224
M v[180:183],a[184:187],a[124:127],v[180:183]
ds_read_b128 a[100:103],v249 offset:52224
M v[184:187],a[184:187],a[140:143],v[184:187]
ds_read_b128 a[156:159],v248 offset:52736
M v[184:187],v[228:231],a[160:163],v[184:187]
s_waitcnt lgkmcnt(4)
ds_read_b128 a[128:131],v249 offset:52736
M v[184:187],a[200:203],a[164:167],v[184:187]
s_waitcnt lgkmcnt(4)
M v[188:191],a[200:203],a[96:99],v[188:191]
M v[188:191],v[228:231],a[164:167],v[188:191]
M v[188:191],a[184:187],a[160:163],v[188:191]
s_waitcnt vmcnt(17) lgkmcnt(3)
s_add_u32 s34,s33,6684672
buffer_store_dwordx4 v[72:75],v253,s[24:27],s34 offen offset:256 nt
M v[160:163],a[152:155],a[120:123],v[160:163]
s_waitcnt vmcnt(17) lgkmcnt(2)
ds_read_b128 a[148:151],v248 offset:53248
M v[160:163],a[104:107],a[100:103],v[160:163]
s_waitcnt vmcnt(16) lgkmcnt(2)
ds_read_b128 a[144:147],v249 offset:53248
M v[160:163],a[112:115],a[156:159],v[160:163]
s_waitcnt lgkmcnt(2)
M v[164:167],a[112:115],a[128:131],v[164:167]
M v[164:167],a[104:107],a[156:159],v[164:167]
M v[164:167],a[152:155],a[100:103],v[164:167]
M v[168:171],a[152:155],a[156:159],v[168:171]
ds_read_b128 a[180:183],v248 offset:53760
M v[168:171],a[104:107],a[128:131],v[168:171]
s_waitcnt lgkmcnt(2)
ds_read_b128 a[136:139],v249 offset:53760
M v[168:171],a[112:115],a[148:151],v[168:171]
s_waitcnt lgkmcnt(2)
M v[172:175],a[112:115],a[144:147],v[172:175]
M v[172:175],a[104:107],a[148:151],v[172:175]
M v[172:175],a[152:155],a[128:131],v[172:175]
M v[176:179],a[152:155],a[148:151],v[176:179]
ds_read_b128 a[124:127],v249 offset:54272
M v[176:179],a[104:107],a[144:147],v[176:179]
s_waitcnt lgkmcnt(2)
ds_read_b128 a[140:143],v248 offset:54272
v_add_u32 v248,0x11000,v248
M v[176:179],a[112:115],a[180:183],v[176:179]
s_waitcnt lgkmcnt(2)
v_add_u32 v249,0x11000,v249
M v[180:183],a[112:115],a[136:139],v[180:183]
M v[180:183],a[104:107],a[180:183],v[180:183]
ds_read_b128 a[96:99],v248 offset:0
M v[180:183],a[152:155],a[144:147],v[180:183]
ds_read_b128 a[164:167],v249 offset:0
M v[184:187],a[152:155],a[180:183],v[184:187]
ds_read_b128 a[160:163],v248 offset:512
M v[184:187],a[104:107],a[136:139],v[184:187]
s_waitcnt lgkmcnt(4)
ds_read_b128 a[184:187],v249 offset:512
M v[184:187],a[112:115],a[124:127],v[184:187]
s_waitcnt lgkmcnt(4)
M v[188:191],a[112:115],a[140:143],v[188:191]
s_add_u32 s34,s33,7077888
M v[188:191],a[104:107],a[124:127],v[188:191]
M v[188:191],a[152:155],a[136:139],v[188:191]
s_waitcnt vmcnt(14) lgkmcnt(3)
buffer_store_dwordx4 v[80:83],v253,s[24:27],s34 offen offset:256 nt
M v[160:163],a[172:175],a[96:99],v[160:163]
s_waitcnt vmcnt(14) lgkmcnt(2)
ds_read_b128 a[120:123],v248 offset:1024
M v[160:163],a[208:211],a[164:167],v[160:163]
s_waitcnt vmcnt(13) lgkmcnt(2)
ds_read_b128 a[100:103],v249 offset:1024
M v[160:163],a[212:215],a[160:163],v[160:163]
s_waitcnt lgkmcnt(2)
M v[164:167],a[212:215],a[184:187],v[164:167]
M v[164:167],a[208:211],a[160:163],v[164:167]
M v[164:167],a[172:175],a[164:167],v[164:167]
M v[168:171],a[172:175],a[160:163],v[168:171]
ds_read_b128 a[156:159],v248 offset:1536
M v[168:171],a[208:211],a[184:187],v[168:171]
s_waitcnt lgkmcnt(2)
ds_read_b128 a[128:131],v249 offset:1536
M v[168:171],a[212:215],a[120:123],v[168:171]
s_waitcnt lgkmcnt(2)
M v[172:175],a[212:215],a[100:103],v[172:175]
M v[172:175],a[208:211],a[120:123],v[172:175]
M v[172:175],a[172:175],a[184:187],v[172:175]
M v[176:179],a[172:175],a[120:123],v[176:179]
ds_read_b128 a[148:151],v249 offset:2048
M v[176:179],a[208:211],a[100:103],v[176:179]
s_waitcnt lgkmcnt(2)
ds_read_b128 a[144:147],v248 offset:2048
M v[176:179],a[212:215],a[156:159],v[176:179]
s_waitcnt lgkmcnt(2)
M v[180:183],a[212:215],a[128:131],v[180:183]
M v[180:183],a[208:211],a[156:159],v[180:183]
ds_read_b128 a[180:183],v248 offset:17408
M v[180:183],a[172:175],a[100:103],v[180:183]
ds_read_b128 a[112:115],v249 offset:17408
M v[184:187],a[172:175],a[156:159],v[184:187]
ds_read_b128 a[140:143],v248 offset:17920
v_add_u32 v248,0xffff3400,v248
M v[184:187],a[208:211],a[128:131],v[184:187]
s_waitcnt lgkmcnt(4)
s_add_u32 s34,s33,7471104
v_add_u32 v249,0xffff3400,v249
M v[184:187],a[212:215],a[148:151],v[184:187]
s_waitcnt lgkmcnt(3)
buffer_store_dwordx4 v[88:91],v253,s[24:27],s34 offen offset:256 nt
M v[188:191],a[212:215],a[144:147],v[188:191]
ds_read_b128 a[104:107],v248 offset:0
ds_read_b128 a[124:127],v249 offset:0
M v[188:191],a[208:211],a[148:151],v[188:191]
ds_read_b128 a[136:139],v248 offset:512
ds_read_b128 a[152:155],v249 offset:512
M v[188:191],a[172:175],a[128:131],v[188:191]
s_waitcnt vmcnt(13) lgkmcnt(6)
v_add_u32 v248,0x11200,v248
v_add_u32 v249,0x11200,v249
M v[160:163],a[168:171],a[180:183],v[160:163]
s_waitcnt vmcnt(12) lgkmcnt(5)
M v[160:163],a[116:119],a[112:115],v[160:163]
s_waitcnt vmcnt(11) lgkmcnt(4)
ds_read_b128 a[96:99],v249 offset:0
M v[160:163],a[108:111],a[140:143],v[160:163]
s_waitcnt vmcnt(10) lgkmcnt(4)
M v[160:163],a[188:191],a[104:107],v[160:163]
s_waitcnt vmcnt(9) lgkmcnt(3)
M v[160:163],a[132:135],a[124:127],v[160:163]
s_waitcnt vmcnt(8) lgkmcnt(2)
M v[160:163],a[176:179],a[136:139],v[160:163]
s_waitcnt lgkmcnt(1)
M v[164:167],a[176:179],a[152:155],v[164:167]
ds_read_b128 a[164:167],v248 offset:512
v_add_u32 v248,0xfffef200,v248
M v[164:167],a[132:135],a[136:139],v[164:167]
v_add_u32 v249,0xfffef200,v249
M v[164:167],a[188:191],a[124:127],v[164:167]
s_waitcnt lgkmcnt(1)
v_cvt_pk_bf16_f32 v160,v160,v161
v_cvt_pk_bf16_f32 v161,v162,v163
M v[164:167],a[108:111],a[96:99],v[164:167]
ds_read_b128 a[160:163],v248 offset:0
M v[164:167],a[116:119],a[140:143],v[164:167]
ds_read_b128 a[184:187],v249 offset:0
v_add_u32 v248,0x11000,v248
M v[164:167],a[168:171],a[112:115],v[164:167]
v_add_u32 v249,0x11000,v249
M v[168:171],a[168:171],a[140:143],v[168:171]
M v[168:171],a[116:119],a[96:99],v[168:171]
s_waitcnt lgkmcnt(2)
ds_read_b128 a[120:123],v249 offset:0
M v[168:171],a[108:111],a[164:167],v[168:171]
s_nop 1
v_cvt_pk_bf16_f32 v164,v164,v165
v_cvt_pk_bf16_f32 v165,v166,v167
M v[168:171],a[188:191],a[136:139],v[168:171]
ds_write2st64_b64 v254,v[160:161],v[164:165] offset0:68 offset1:72
M v[168:171],a[132:135],a[152:155],v[168:171]
s_waitcnt lgkmcnt(3)
M v[168:171],a[176:179],a[160:163],v[168:171]
s_waitcnt lgkmcnt(2)
M v[172:175],a[176:179],a[184:187],v[172:175]
ds_read_b128 a[100:103],v248 offset:512
v_add_u32 v248,0xfffef200,v248
M v[172:175],a[132:135],a[160:163],v[172:175]
v_add_u32 v249,0xfffef200,v249
M v[172:175],a[188:191],a[152:155],v[172:175]
s_waitcnt lgkmcnt(2)
v_cvt_pk_bf16_f32 v168,v168,v169
v_cvt_pk_bf16_f32 v169,v170,v171
M v[172:175],a[108:111],a[120:123],v[172:175]
ds_read_b128 a[156:159],v248 offset:0
M v[172:175],a[116:119],a[164:167],v[172:175]
ds_read_b128 a[144:147],v249 offset:0
v_add_u32 v248,0x11000,v248
M v[172:175],a[168:171],a[96:99],v[172:175]
v_add_u32 v249,0x11000,v249
M v[176:179],a[168:171],a[164:167],v[176:179]
M v[176:179],a[116:119],a[120:123],v[176:179]
s_waitcnt lgkmcnt(2)
ds_read_b128 a[148:151],v249 offset:0
M v[176:179],a[108:111],a[100:103],v[176:179]
s_nop 1
v_cvt_pk_bf16_f32 v172,v172,v173
v_cvt_pk_bf16_f32 v173,v174,v175
M v[176:179],a[188:191],a[160:163],v[176:179]
ds_write2st64_b64 v254,v[168:169],v[172:173] offset0:76 offset1:80
M v[176:179],a[132:135],a[184:187],v[176:179]
s_waitcnt lgkmcnt(3)
M v[176:179],a[176:179],a[156:159],v[176:179]
s_waitcnt lgkmcnt(2)
M v[180:183],a[176:179],a[144:147],v[180:183]
s_waitcnt lgkmcnt(0)
s_barrier
ds_read_b128 v[160:163],v250 offset:34816
M v[180:183],a[132:135],a[156:159],v[180:183]
ds_read_b128 v[168:171],v250 offset:38912
ds_read_b128 a[128:131],v249 offset:512
M v[180:183],a[188:191],a[184:187],v[180:183]
v_add_u32 v248,0xfffef200,v248
v_add_u32 v249,0xfffef200,v249
M v[180:183],a[108:111],a[148:151],v[180:183]
ds_read_b128 a[172:175],v249 offset:0
v_cvt_pk_bf16_f32 v176,v176,v177
M v[180:183],a[116:119],a[100:103],v[180:183]
ds_read_b128 a[180:183],v248 offset:0
v_add_u32 v248,0x11000,v248
M v[180:183],a[168:171],a[120:123],v[180:183]
s_waitcnt lgkmcnt(4)
s_add_u32 s34,s33,6291456
buffer_store_dwordx4 v[160:163],v253,s[24:27],s34 offen offset:1408 nt
M v[184:187],a[168:171],a[100:103],v[184:187]
s_add_u32 s34,s33,6684672
v_add_u32 v249,0x11000,v249
v_cvt_pk_bf16_f32 v177,v178,v179
M v[184:187],a[116:119],a[148:151],v[184:187]
s_waitcnt lgkmcnt(2)
ds_read_b128 a[104:107],v248 offset:0
M v[184:187],a[108:111],a[128:131],v[184:187]
v_cvt_pk_bf16_f32 v180,v180,v181
v_cvt_pk_bf16_f32 v181,v182,v183
M v[184:187],a[188:191],a[156:159],v[184:187]
ds_write2st64_b64 v254,v[176:177],v[180:181] offset0:85 offset1:89
M v[184:187],a[132:135],a[144:147],v[184:187]
s_waitcnt lgkmcnt(3)
M v[184:187],a[176:179],a[172:175],v[184:187]
s_waitcnt lgkmcnt(2)
buffer_store_dwordx4 v[168:171],v253,s[24:27],s34 offen offset:1408 nt
M v[188:191],a[176:179],a[180:183],v[188:191]
s_waitcnt lgkmcnt(0)
s_barrier
ds_read_b128 v[176:179],v250 offset:43520
M v[188:191],a[132:135],a[172:175],v[188:191]
M v[188:191],a[188:191],a[144:147],v[188:191]
v_cvt_pk_bf16_f32 v184,v184,v185
v_cvt_pk_bf16_f32 v185,v186,v187
M v[188:191],a[108:111],a[104:107],v[188:191]
M v[188:191],a[116:119],a[128:131],v[188:191]
M v[188:191],a[168:171],a[148:151],v[188:191]
s_add_u32 s34,s33,7077888
s_waitcnt lgkmcnt(0)
buffer_store_dwordx4 v[176:179],v253,s[24:27],s34 offen offset:1408 nt
s_nop 4
v_cvt_pk_bf16_f32 v188,v188,v189
v_cvt_pk_bf16_f32 v189,v190,v191
ds_write2st64_b64 v254,v[184:185],v[188:189] offset0:93 offset1:97
s_waitcnt lgkmcnt(0)
s_barrier
ds_read_b128 v[184:187],v250 offset:47616
s_add_u32 s34,s33,7471104
s_waitcnt lgkmcnt(0)
buffer_store_dwordx4 v[184:187],v253,s[24:27],s34 offen offset:1408 nt
s_endpgm
L_code_end:
L_fallback:
s_mov_b32 s84,0
L_itemF:
s_and_b32 s85,s84,3
s_lshr_b32 s86,s84,2
s_mul_hi_u32 s87,s86,0x55555556
s_mul_i32 s88,s87,3
s_sub_u32 s86,s86,s88
s_mul_hi_u32 s88,s87,0x2aaaaaab
s_mul_i32 s89,s88,6
s_sub_u32 s87,s87,s89
s_mul_i32 s89,s86,221184
s_mul_i32 s90,s87,12288
s_add_u32 s89,s89,s90
s_mul_i32 s90,s85,3072
s_add_u32 s89,s89,s90
s_lshl_b32 s90,s88,7
s_add_u32 s89,s89,s90
s_add_u32 s90,s89,73728
s_add_u32 s91,s90,73728
v_lshlrev_b32 v149,1,v164
buffer_load_short_d16_hi v68,v149,s[36:39],s89 offen offset:0
buffer_load_short_d16_hi v69,v149,s[36:39],s89 offen offset:384
buffer_load_short_d16_hi v70,v149,s[36:39],s89 offen offset:768
buffer_load_short_d16_hi v71,v149,s[36:39],s89 offen offset:1152
buffer_load_short_d16_hi v72,v149,s[36:39],s89 offen offset:1536
buffer_load_short_d16_hi v73,v149,s[36:39],s89 offen offset:1920
buffer_load_short_d16_hi v74,v149,s[36:39],s89 offen offset:2304
buffer_load_short_d16_hi v75,v149,s[36:39],s89 offen offset:2688
buffer_load_short_d16_hi v76,v149,s[36:39],s90 offen offset:0
buffer_load_short_d16_hi v77,v149,s[36:39],s90 offen offset:384
buffer_load_short_d16_hi v78,v149,s[36:39],s90 offen offset:768
buffer_load_short_d16_hi v79,v149,s[36:39],s90 offen offset:1152
buffer_load_short_d16_hi v80,v149,s[36:39],s90 offen offset:1536
buffer_load_short_d16_hi v81,v149,s[36:39],s90 offen offset:1920
buffer_load_short_d16_hi v82,v149,s[36:39],s90 offen offset:2304
buffer_load_short_d16_hi v83,v149,s[36:39],s90 offen offset:2688
buffer_load_short_d16_hi v84,v149,s[36:39],s91 offen offset:0
buffer_load_short_d16_hi v85,v149,s[36:39],s91 offen offset:384
buffer_load_short_d16_hi v86,v149,s[36:39],s91 offen offset:768
buffer_load_short_d16_hi v87,v149,s[36:39],s91 offen offset:1152
buffer_load_short_d16_hi v88,v149,s[36:39],s91 offen offset:1536
buffer_load_short_d16_hi v89,v149,s[36:39],s91 offen offset:1920
buffer_load_short_d16_hi v90,v149,s[36:39],s91 offen offset:2304
buffer_load_short_d16_hi v91,v149,s[36:39],s91 offen offset:2688
s_and_b32 s92,s85,1
s_lshl_b32 s92,s92,2
s_lshr_b32 s85,s85,1
s_lshl_b32 s85,s85,2
v_bfe_u32 v148,v164,2,2
v_or_b32 v148,s92,v148
v_and_b32 v151,3,v164
v_or_b32 v151,s85,v151
v_xor_b32 v151,v151,v148
v_lshrrev_b32 v150,4,v164
v_mul_u32_u24 v150,331776,v150
v_lshl_add_u32 v150,v148,7,v150
v_lshl_add_u32 v150,v151,4,v150
s_mul_i32 s87,s87,55296
s_mul_i32 s88,s88,3072
s_add_u32 s87,s87,s88
s_lshl_b32 s86,s86,10
s_add_u32 s87,s87,s86
s_mov_b32 s85,0xbe2aaaab
s_mov_b32 s86,0x3d2aaaab
s_mov_b32 s88,0x3e2aaaab
s_mov_b32 s92,0x3daaaaab
s_waitcnt vmcnt(0)
v_add_f32 v148,v68,v84
v_add_f32 v92,v148,v76
v_sub_f32 v100,v148,v76
v_mul_f32 v92,s85,v92
v_mul_f32 v100,s85,v100
v_mul_f32 v148,s86,v68
v_fmac_f32 v148,s88,v84
v_fma_f32 v108,s92,v76,v148
v_fma_f32 v116,-s92,v76,v148
v_add_f32 v148,v69,v85
v_add_f32 v93,v148,v77
v_sub_f32 v101,v148,v77
v_mul_f32 v93,s85,v93
v_mul_f32 v101,s85,v101
v_mul_f32 v148,s86,v69
v_fmac_f32 v148,s88,v85
v_fma_f32 v109,s92,v77,v148
v_fma_f32 v117,-s92,v77,v148
v_add_f32 v148,v70,v86
v_add_f32 v94,v148,v78
v_sub_f32 v102,v148,v78
v_mul_f32 v94,s85,v94
v_mul_f32 v102,s85,v102
v_mul_f32 v148,s86,v70
v_fmac_f32 v148,s88,v86
v_fma_f32 v110,s92,v78,v148
v_fma_f32 v118,-s92,v78,v148
v_add_f32 v148,v71,v87
v_add_f32 v95,v148,v79
v_sub_f32 v103,v148,v79
v_mul_f32 v95,s85,v95
v_mul_f32 v103,s85,v103
v_mul_f32 v148,s86,v71
v_fmac_f32 v148,s88,v87
v_fma_f32 v111,s92,v79,v148
v_fma_f32 v119,-s92,v79,v148
v_add_f32 v148,v72,v88
v_add_f32 v96,v148,v80
v_sub_f32 v104,v148,v80
v_mul_f32 v96,s85,v96
v_mul_f32 v104,s85,v104
v_mul_f32 v148,s86,v72
v_fmac_f32 v148,s88,v88
v_fma_f32 v112,s92,v80,v148
v_fma_f32 v120,-s92,v80,v148
v_add_f32 v148,v73,v89
v_add_f32 v97,v148,v81
v_sub_f32 v105,v148,v81
v_mul_f32 v97,s85,v97
v_mul_f32 v105,s85,v105
v_mul_f32 v148,s86,v73
v_fmac_f32 v148,s88,v89
v_fma_f32 v113,s92,v81,v148
v_fma_f32 v121,-s92,v81,v148
v_add_f32 v148,v74,v90
v_add_f32 v98,v148,v82
v_sub_f32 v106,v148,v82
v_mul_f32 v98,s85,v98
v_mul_f32 v106,s85,v106
v_mul_f32 v148,s86,v74
v_fmac_f32 v148,s88,v90
v_fma_f32 v114,s92,v82,v148
v_fma_f32 v122,-s92,v82,v148
v_add_f32 v148,v75,v91
v_add_f32 v99,v148,v83
v_sub_f32 v107,v148,v83
v_mul_f32 v99,s85,v99
v_mul_f32 v107,s85,v107
v_mul_f32 v148,s86,v75
v_fmac_f32 v148,s88,v91
v_fma_f32 v115,s92,v83,v148
v_fma_f32 v123,-s92,v83,v148
v_cvt_pk_bf16_f32 v124,v68,v69
v_cvt_pk_bf16_f32 v125,v70,v71
v_cvt_pk_bf16_f32 v126,v72,v73
v_cvt_pk_bf16_f32 v127,v74,v75
s_add_u32 s89,s87,0
buffer_store_dwordx4 v[124:127],v150,s[20:23],s89 offen sc1
v_cvt_pk_bf16_f32 v144,v84,v85
v_cvt_pk_bf16_f32 v145,v86,v87
v_cvt_pk_bf16_f32 v146,v88,v89
v_cvt_pk_bf16_f32 v147,v90,v91
s_add_u32 s89,s87,46080
buffer_store_dwordx4 v[144:147],v150,s[20:23],s89 offen sc1
v_cvt_pk_bf16_f32 v128,v92,v93
v_cvt_pk_bf16_f32 v129,v94,v95
v_cvt_pk_bf16_f32 v130,v96,v97
v_cvt_pk_bf16_f32 v131,v98,v99
s_add_u32 s89,s87,9216
buffer_store_dwordx4 v[128:131],v150,s[20:23],s89 offen sc1
v_cvt_pk_bf16_f32 v132,v100,v101
v_cvt_pk_bf16_f32 v133,v102,v103
v_cvt_pk_bf16_f32 v134,v104,v105
v_cvt_pk_bf16_f32 v135,v106,v107
s_add_u32 s89,s87,18432
buffer_store_dwordx4 v[132:135],v150,s[20:23],s89 offen sc1
v_cvt_pk_bf16_f32 v136,v108,v109
v_cvt_pk_bf16_f32 v137,v110,v111
v_cvt_pk_bf16_f32 v138,v112,v113
v_cvt_pk_bf16_f32 v139,v114,v115
s_add_u32 s89,s87,27648
buffer_store_dwordx4 v[136:139],v150,s[20:23],s89 offen sc1
v_cvt_pk_bf16_f32 v140,v116,v117
v_cvt_pk_bf16_f32 v141,v118,v119
v_cvt_pk_bf16_f32 v142,v120,v121
v_cvt_pk_bf16_f32 v143,v122,v123
s_add_u32 s89,s87,36864
buffer_store_dwordx4 v[140:143],v150,s[20:23],s89 offen sc1
s_waitcnt vmcnt(0)
s_add_u32 s84,s84,1
s_cmp_lt_u32 s84,216
s_cbranch_scc1 L_itemF
s_branch L_uready
.section .rodata,"a"
.p2align 6
.amdhsa_kernel standalone__winograd__vision_kernel
  .amdhsa_next_free_vgpr 512
  .amdhsa_next_free_sgpr 96
  .amdhsa_accum_offset 256
  .amdhsa_group_segment_fixed_size 0
  .amdhsa_kernarg_size 40
  .amdhsa_user_sgpr_count 2
  .amdhsa_user_sgpr_kernarg_segment_ptr 1
  .amdhsa_system_sgpr_workgroup_id_x 1
  .amdhsa_float_denorm_mode_32 3
.end_amdhsa_kernel
```
